```python
import torch

def _softmax(x, axis=-1):
    return torch.softmax(x, dim=axis)

def _gelu(x):
    return torch.nn.functional.gelu(x, approximate='tanh')

def _silu(x):
    return torch.nn.functional.silu(x)

def _sigmoid(x):
    return torch.sigmoid(x)

def _layernorm(x, axis=-1, eps=1e-05):
    m = x.mean(dim=axis, keepdim=True)
    v = x.var(dim=axis, keepdim=True, unbiased=False)
    return (x - m) / torch.sqrt(v + eps)

def _scatter_add(tgt, idx, src, axis=0):
    return tgt.clone().index_add_(axis, idx, src)

def _segment_sum(src, seg, n):
    out = torch.zeros((n,) + src.shape[1:], dtype=src.dtype)
    return out.index_add_(0, seg, src)

def _pad(x, pw):
    flat = tuple((v for pair in reversed(pw) for v in pair))
    return torch.nn.functional.pad(x, flat)
kernel_name = 'interleave_layers__memory_aug_recurrent_mem_tr__mixer_s_mlp__prompt'

def setup_inputs():

    _w = lambda a: (lambda t: t.to(torch.bfloat16) if t.is_floating_point() else t)(torch.as_tensor(a))

    def _A_setup():
        B, S, Dm = (1, 2048, 640)
        H, Dh = (32, 192)
        M, seg = (8, 32)
        seg = min(seg, S)
        S = S // seg * seg
        return {'x': _w((lambda *s: torch.randn(*s, dtype=torch.bfloat16) * 0.05)(B, S, Dm)), 'mem0': _w((lambda *s: torch.randn(*s, dtype=torch.bfloat16) * 0.8)(B, M, Dm)), 'Wq': _w((lambda *s: torch.randn(*s, dtype=torch.bfloat16) * 0.8)(Dm, H, Dh) * Dm ** (-0.5)), 'Wk': _w((lambda *s: torch.randn(*s, dtype=torch.bfloat16) * 0.8)(Dm, H, Dh) * Dm ** (-0.5)), 'Wv': _w((lambda *s: torch.randn(*s, dtype=torch.bfloat16) * 0.8)(Dm, H, Dh) * Dm ** (-0.5)), 'Wo': _w((lambda *s: torch.randn(*s, dtype=torch.bfloat16) * 0.8)(H, Dh, Dm) * (H * Dh) ** (-0.5)), 'seg_len': seg}
    _A_in = _A_setup()

    def _B_setup():
        B, S, D, F = (1, 2048, 640, 1536)
        return {'x': _w((lambda *s: torch.randn(*s, dtype=torch.bfloat16) * 0.05)(B, S, D)), 'w1': _w((lambda *s: torch.randn(*s, dtype=torch.bfloat16) * 0.8)(D, D) * D ** (-0.5)), 'w2': _w((lambda *s: torch.randn(*s, dtype=torch.bfloat16) * 0.8)(D, D) * D ** (-0.5)), 'w3': _w((lambda *s: torch.randn(*s, dtype=torch.bfloat16) * 0.8)(D, F) * D ** (-0.5)), 'w4': _w((lambda *s: torch.randn(*s, dtype=torch.bfloat16) * 0.8)(F, D) * F ** (-0.5))}
    _B_in = _B_setup()
    return {'A_x': _A_in['x'], 'A_mem0': _A_in['mem0'], 'A_Wq': _A_in['Wq'], 'A_Wk': _A_in['Wk'], 'A_Wv': _A_in['Wv'], 'A_Wo': _A_in['Wo'], 'A_seg_len': _A_in['seg_len'], 'B_x': _B_in['x'], 'B_w1': _B_in['w1'], 'B_w2': _B_in['w2'], 'B_w3': _B_in['w3'], 'B_w4': _B_in['w4']}

def reference(A_x, A_mem0, A_Wq, A_Wk, A_Wv, A_Wo, A_seg_len, B_x, B_w1, B_w2, B_w3, B_w4):

    def _A_ref(x, mem0, Wq, Wk, Wv, Wo, seg_len):
        B, S, Dm = x.shape
        H, Dh = (Wq.shape[1], Wq.shape[2])
        M = mem0.shape[1]
        scale = Dh ** (-0.5)
        n_seg = S // seg_len
        L = M + seg_len
        idx = torch.arange(L)
        mask = (idx[:, None] < M) | (idx[:, None] >= idx[None, :])
        mem = mem0
        outs = []
        for s in range(n_seg):
            xs = x[:, s * seg_len:(s + 1) * seg_len, :].clone()
            h = torch.concatenate([mem, xs], axis=1)
            q = torch.einsum('btd,dhe->bhte', h, Wq)
            k = torch.einsum('btd,dhe->bhte', h, Wk)
            v = torch.einsum('btd,dhe->bhte', h, Wv)
            scores = torch.einsum('bhqe,bhke->bhqk', q, k) * scale
            scores = torch.where(mask[None, None], scores, -1000000000.0)
            p = _softmax(scores, axis=-1)
            o = torch.einsum('bhqk,bhke->bhqe', p, v)
            o = torch.einsum('bhte,hed->btd', o, Wo)
            mem = o[:, :M, :].clone()
            outs.append(o[:, M:, :])
        return torch.concatenate(outs, axis=1)

    def _B_ref(x, w1, w2, w3, w4):
        B, S, D = x.shape
        h = _gelu(_layernorm(x, axis=-1) @ w1)
        c = D // 4
        g0 = _pad(h[:, :, 0 * c:1 * c], ((0, 0), (1, 0), (0, 0)))[:, :S, :]
        g1 = _pad(h[:, :, 1 * c:2 * c], ((0, 0), (0, 1), (0, 0)))[:, 1:, :]
        g2 = _pad(h[:, :, 2 * c:3 * c], ((0, 0), (2, 0), (0, 0)))[:, :S, :]
        g3 = _pad(h[:, :, 3 * c:], ((0, 0), (0, 2), (0, 0)))[:, 2:, :]
        hs = torch.concatenate([g0, g1, g2, g3], axis=-1) @ w2
        x1 = x + hs
        h2 = _gelu(_layernorm(x1, axis=-1) @ w3) @ w4
        return x1 + h2
    x = A_x
    x = x + _A_ref(_layernorm(x, axis=-1), A_mem0, A_Wq, A_Wk, A_Wv, A_Wo, A_seg_len)
    x = x + _B_ref(_layernorm(x, axis=-1), B_w1, B_w2, B_w3, B_w4)
    x = x + _A_ref(_layernorm(x, axis=-1), A_mem0, A_Wq, A_Wk, A_Wv, A_Wo, A_seg_len)
    x = x + _B_ref(_layernorm(x, axis=-1), B_w1, B_w2, B_w3, B_w4)
    return x
```

```asm
; @launch grid=(256,1,1) block=(256,1,1) lds=163840
.amdgcn_target "amdgcn-amd-amdhsa--gfx950"
.text
.globl interleave_layers__memory_aug_recurrent_mem_tr__mixer_s_mlp__prompt_kernel
.p2align 8
.type interleave_layers__memory_aug_recurrent_mem_tr__mixer_s_mlp__prompt_kernel,@function
interleave_layers__memory_aug_recurrent_mem_tr__mixer_s_mlp__prompt_kernel:
s_cmp_ge_u32 s2,256
s_cbranch_scc1 EXIT
s_load_dwordx16 s[16:31],s[0:1],0
s_load_dwordx8 s[32:39],s[0:1],64
s_load_dwordx4 s[40:43],s[0:1],96
s_load_dwordx2 s[44:45],s[0:1],112
v_lshrrev_b32 v1,6,v0
v_and_b32 v0,63,v0
v_readfirstlane_b32 s46,v1
s_mov_b32 s47,200000
s_mov_b32 s49,0
s_getreg_b32 s4,hwreg(HW_REG_XCC_ID)
s_and_b32 s4,s4,7
s_waitcnt lgkmcnt(0)
s_mov_b32 s8,s44
s_mov_b32 s9,s45
s_mov_b32 s10,268435456
s_mov_b32 s11,0x20000
s_mov_b32 s12,s42
s_mov_b32 s13,s43
s_mov_b32 s14,256
s_mov_b32 s15,0x20000
v_lshlrev_b32 v1,4,v0
v_mov_b32 v4,0
v_mov_b32 v5,0
v_mov_b32 v6,0
v_mov_b32 v7,0
s_lshl_b32 s5,s2,2
s_add_u32 s5,s5,s46
s_lshl_b32 s5,s5,10
buffer_store_dwordx4 v[4:7],v1,s[8:11],s5 offen sc1
s_cmp_ge_u32 s4,4
s_cbranch_scc1 VOTE_DONE
s_cmp_lg_u32 s46,1
s_cbranch_scc1 VOTE_DONE
s_and_b32 s52,s2,24
s_cbranch_scc1 VOTE_DONE
s_mov_b64 exec,1
v_mov_b32 v12,0
s_and_b32 s53,s2,63
s_lshl_b32 s53,s53,7
s_lshr_b32 s52,s2,6
s_mul_i32 s52,s52,3
s_add_u32 s52,s52,s46
s_lshl_b32 s52,s52,14
s_add_u32 s53,s53,s52
s_add_u32 s53,s53,11796480
s_add_u32 s59,s53,0x2000
buffer_store_dword v12,v12,s[8:11],s53 offen sc1
buffer_store_dword v12,v12,s[8:11],s59 offen sc1
s_waitcnt vmcnt(0)
s_memtime s[54:55]
s_waitcnt lgkmcnt(0)
buffer_load_dword v13,v12,s[8:11],s53 offen sc1
s_waitcnt vmcnt(0)
s_memtime s[56:57]
s_waitcnt lgkmcnt(0)
s_sub_u32 s50,s56,s54
s_memtime s[54:55]
s_waitcnt lgkmcnt(0)
buffer_load_dword v13,v12,s[8:11],s59 offen sc1
s_waitcnt vmcnt(0)
s_memtime s[56:57]
s_waitcnt lgkmcnt(0)
s_sub_u32 s51,s56,s54
s_cmp_lt_u32 s51,s50
s_cselect_b32 s52,1,-1
v_mov_b32 v13,s52
v_mov_b32 v12,192
buffer_atomic_add v13,v12,s[12:15],0 offen sc1
s_mov_b64 exec,-1
VOTE_DONE:
v_mov_b32 v2,0
s_cmp_lg_u32 s46,0
s_cbranch_scc1 TK_DONE
s_mov_b64 exec,1
v_mov_b32 v1,1
s_lshl_b32 s5,s4,2
v_mov_b32 v3,s5
buffer_atomic_add v1,v3,s[12:15],0 offen offset:32 sc0 sc1
s_waitcnt vmcnt(0)
v_readfirstlane_b32 s5,v1
s_lshl_b32 s6,s4,5
s_add_u32 s6,s6,s5
s_cmp_lt_u32 s5,32
s_cselect_b32 s6,s6,999
v_mov_b32 v1,s6
ds_write_b32 v2,v1
s_mov_b64 exec,-1
s_waitcnt lgkmcnt(0)
TK_DONE:
s_barrier
ds_read_b32 v1,v2
s_waitcnt lgkmcnt(0)
v_readfirstlane_b32 s3,v1
s_barrier
s_nop 2
s_branch DISPATCH
ROLE_CS:
s_lshr_b32 s28,s48,4
s_and_b32 s29,s48,15
s_mul_i32 s82,s28,2097152
s_add_u32 s82,s82,2097152
v_lshlrev_b32 v1,4,v0
v_and_b32 v12,1,v0
v_mul_u32_u24 v2,0xaaaa,v12
v_or_b32 v2,0x4444,v2
s_add_u32 s60,s46,1
s_and_b32 s60,s60,3
s_lshl_b32 s60,s60,11
s_add_u32 s60,s60,131072
v_add_u32 v3,s60,v1
s_add_u32 s60,s46,2
s_and_b32 s60,s60,3
s_lshl_b32 s60,s60,11
s_add_u32 s60,s60,131072
v_add_u32 v4,s60,v1
s_add_u32 s60,s46,3
s_and_b32 s60,s60,3
s_lshl_b32 s60,s60,11
s_add_u32 s60,s60,131072
v_add_u32 v5,s60,v1
v_add_u32 v59,139264,v1
s_lshl_b32 s60,s46,11
s_add_u32 s60,s60,131072
v_add_u32 v22,s60,v1
s_lshr_b32 s60,s46,1
s_lshl_b32 s60,s60,10
s_and_b32 s61,s46,1
s_lshl_b32 s61,s61,3
s_add_u32 s60,s60,s61
v_add_u32 v23,s60,v59
s_mul_i32 s60,s46,20480
v_add_u32 v21,s60,v1
v_and_b32 v11,7,v0
v_lshlrev_b32 v11,2,v11
v_bfe_u32 v12,v0,3,2
v_lshl_add_u32 v11,v12,7,v11
s_xor_b32 s60,s28,1
s_lshl_b32 s60,s60,19
s_lshl_b32 s61,s46,14
s_add_u32 s83,s60,s61
s_add_u32 s83,s83,10485760
s_mov_b32 s36,0
s_mov_b32 s88,0xcccccccc
s_mov_b32 s89,0xcccccccc
s_mov_b32 s90,0x33333333
s_mov_b32 s91,0x33333333
s_mov_b32 s87,0x3dd53b95
v_lshrrev_b32 v14,4,v0
v_and_b32 v15,15,v0
v_lshrrev_b32 v12,2,v15
v_add_u32 v12,v12,v14
v_and_b32 v12,3,v12
v_lshlrev_b32 v6,3,v12
v_lshl_add_u32 v6,v15,5,v6
s_mul_i32 s60,s46,1536
s_add_u32 s60,s60,141312
v_add_u32 v6,s60,v6
v_add_u32 v12,v0,v14
v_and_b32 v12,3,v12
v_lshlrev_b32 v7,3,v12
v_lshrrev_b32 v12,2,v0
v_lshl_add_u32 v7,v12,5,v7
v_add_u32 v7,141312,v7
s_min_u32 s62,s46,2
v_lshrrev_b32 v12,2,v15
v_and_b32 v13,1,v15
v_lshl_add_u32 v12,v12,1,v13
v_bfe_u32 v13,v15,1,1
v_lshlrev_b32 v8,8,v14
v_lshl_add_u32 v8,v12,5,v8
v_xor_b32 v16,1,v13
v_lshl_add_u32 v8,v16,4,v8
v_lshlrev_b32 v20,8,v14
v_lshl_add_u32 v20,v13,7,v20
v_and_b32 v16,3,v12
v_lshl_add_u32 v20,v16,5,v20
v_lshrrev_b32 v16,2,v12
v_lshl_add_u32 v20,v16,4,v20
v_min_u32 v12,5,v0
s_mul_i32 s60,s48,3
v_add_u32 v9,s60,v12
v_lshlrev_b32 v9,2,v9
v_add_u32 v13,65524,v9
v_cmp_lt_u32 vcc,2,v12
s_nop 1
v_cndmask_b32 v9,v9,v13,vcc
s_mul_i32 s84,s48,12288
s_add_u32 s84,s84,74448896
s_mul_i32 s60,s29,3072
s_lshl_b32 s61,s62,10
s_add_u32 s60,s60,s61
s_add_u32 s60,s60,s82
s_add_u32 s33,s60,163840
s_add_u32 s34,s60,557056
s_mul_i32 s85,s48,6144
s_add_u32 s85,s85,24117248
s_lshl_b32 s86,s48,5
s_lshl_b32 s61,s62,2
s_add_u32 s86,s86,688128
s_lshr_b32 s60,s29,2
s_lshl_b32 s60,s60,7
s_and_b32 s63,s29,3
s_mul_i32 s63,s63,12
s_add_u32 s60,s60,s63
s_add_u32 s60,s60,s61
s_add_u32 s60,s60,s82
s_add_u32 s35,s60,951296
s_cmp_eq_u32 s46,3
s_cbranch_scc1 si_1
v_mov_b32 v12,-1
v_mov_b32 v13,0
s_cmp_lg_u32 s49,0
s_cbranch_scc1 ls_2
s_add_u32 s60,s33,0
buffer_store_dword v12,v1,s[8:11],s60 offen
s_add_u32 s60,s33,49152
buffer_store_dword v12,v1,s[8:11],s60 offen
s_add_u32 s60,s33,98304
buffer_store_dword v12,v1,s[8:11],s60 offen
s_add_u32 s60,s33,147456
buffer_store_dword v12,v1,s[8:11],s60 offen
s_add_u32 s60,s33,196608
buffer_store_dword v12,v1,s[8:11],s60 offen
s_add_u32 s60,s33,245760
buffer_store_dword v12,v1,s[8:11],s60 offen
s_add_u32 s60,s33,294912
buffer_store_dword v12,v1,s[8:11],s60 offen
s_add_u32 s60,s33,344064
buffer_store_dword v12,v1,s[8:11],s60 offen
s_mov_b64 exec,1
buffer_store_dword v13,v1,s[8:11],s35 offen
buffer_store_dword v13,v1,s[8:11],s35 offen offset:512
s_mov_b64 exec,-1
s_branch ls_3
ls_2:
s_add_u32 s60,s33,0
buffer_store_dword v12,v1,s[8:11],s60 offen sc1
s_add_u32 s60,s33,49152
buffer_store_dword v12,v1,s[8:11],s60 offen sc1
s_add_u32 s60,s33,98304
buffer_store_dword v12,v1,s[8:11],s60 offen sc1
s_add_u32 s60,s33,147456
buffer_store_dword v12,v1,s[8:11],s60 offen sc1
s_add_u32 s60,s33,196608
buffer_store_dword v12,v1,s[8:11],s60 offen sc1
s_add_u32 s60,s33,245760
buffer_store_dword v12,v1,s[8:11],s60 offen sc1
s_add_u32 s60,s33,294912
buffer_store_dword v12,v1,s[8:11],s60 offen sc1
s_add_u32 s60,s33,344064
buffer_store_dword v12,v1,s[8:11],s60 offen sc1
s_mov_b64 exec,1
buffer_store_dword v13,v1,s[8:11],s35 offen sc1
buffer_store_dword v13,v1,s[8:11],s35 offen offset:512 sc1
s_mov_b64 exec,-1
ls_3:
si_1:
s_mul_i32 s73,s48,384
s_mov_b32 s74,s73
v_add_u32 v12,0,v0
v_mul_u32_u24 v13,2731,v12
v_lshrrev_b32 v13,16,v13
v_mul_u32_u24 v16,24,v13
v_sub_u32 v12,v12,v16
v_mul_u32_u24 v104,12288,v13
v_lshl_add_u32 v104,v12,4,v104
v_add_u32 v12,64,v0
v_mul_u32_u24 v13,2731,v12
v_lshrrev_b32 v13,16,v13
v_mul_u32_u24 v16,24,v13
v_sub_u32 v12,v12,v16
v_mul_u32_u24 v105,12288,v13
v_lshl_add_u32 v105,v12,4,v105
v_add_u32 v12,128,v0
v_mul_u32_u24 v13,2731,v12
v_lshrrev_b32 v13,16,v13
v_mul_u32_u24 v16,24,v13
v_sub_u32 v12,v12,v16
v_mul_u32_u24 v106,12288,v13
v_lshl_add_u32 v106,v12,4,v106
s_mov_b32 s4,s20
s_mov_b32 s5,s21
s_mov_b32 s6,7864320
s_mov_b32 s7,0x20000
s_mov_b32 s52,s22
s_mov_b32 s53,s23
s_mov_b32 s54,7864320
s_mov_b32 s55,0x20000
s_branch SV_LOAD
ROLE_CV:
s_lshr_b32 s28,s48,3
s_and_b32 s29,s48,7
s_mul_i32 s82,s28,2097152
s_add_u32 s82,s82,2097152
v_lshlrev_b32 v1,4,v0
v_and_b32 v12,1,v0
v_mul_u32_u24 v2,0xaaaa,v12
v_or_b32 v2,0x4444,v2
s_add_u32 s60,s46,1
s_and_b32 s60,s60,3
s_lshl_b32 s60,s60,11
s_add_u32 s60,s60,131072
v_add_u32 v3,s60,v1
s_add_u32 s60,s46,2
s_and_b32 s60,s60,3
s_lshl_b32 s60,s60,11
s_add_u32 s60,s60,131072
v_add_u32 v4,s60,v1
s_add_u32 s60,s46,3
s_and_b32 s60,s60,3
s_lshl_b32 s60,s60,11
s_add_u32 s60,s60,131072
v_add_u32 v5,s60,v1
v_add_u32 v59,139264,v1
s_lshl_b32 s60,s46,11
s_add_u32 s60,s60,131072
v_add_u32 v22,s60,v1
s_lshr_b32 s60,s46,1
s_lshl_b32 s60,s60,10
s_and_b32 s61,s46,1
s_lshl_b32 s61,s61,3
s_add_u32 s60,s60,s61
v_add_u32 v23,s60,v59
s_mul_i32 s60,s46,20480
v_add_u32 v21,s60,v1
v_and_b32 v11,7,v0
v_lshlrev_b32 v11,2,v11
v_bfe_u32 v12,v0,3,2
v_lshl_add_u32 v11,v12,7,v11
s_xor_b32 s60,s28,1
s_lshl_b32 s60,s60,19
s_lshl_b32 s61,s46,14
s_add_u32 s83,s60,s61
s_add_u32 s83,s83,10485760
s_mov_b32 s36,1
v_mov_b32 v8,0
v_mov_b32 v9,0
v_mov_b32 v20,0
s_and_b32 s62,s46,1
s_lshl_b32 s60,s62,11
v_add_u32 v6,s60,v1
s_lshl_b32 s60,s62,3
s_add_u32 s60,s60,1024
v_add_u32 v7,s60,v1
s_lshr_b32 s61,s46,1
s_lshl_b32 s60,s29,1
s_add_u32 s60,s60,s61
s_mul_i32 s60,s60,3072
s_add_u32 s60,s60,s82
s_add_u32 s34,s60,557056
s_lshl_b32 s60,s48,1
s_add_u32 s60,s60,s61
s_mul_i32 s85,s60,6144
s_add_u32 s85,s85,24120320
s_lshl_b32 s86,s60,5
s_lshl_b32 s61,s62,2
s_add_u32 s86,s86,s61
s_add_u32 s86,s86,688132
v_mov_b32 v12,-1
v_mov_b32 v13,-1
v_mov_b32 v14,-1
v_mov_b32 v15,-1
s_cmp_lg_u32 s49,0
s_cbranch_scc1 ls_4
s_add_u32 s60,s34,0
buffer_store_dwordx4 v[12:15],v6,s[8:11],s60 offen
buffer_store_dwordx2 v[12:13],v7,s[8:11],s60 offen
s_add_u32 s60,s34,49152
buffer_store_dwordx4 v[12:15],v6,s[8:11],s60 offen
buffer_store_dwordx2 v[12:13],v7,s[8:11],s60 offen
s_add_u32 s60,s34,98304
buffer_store_dwordx4 v[12:15],v6,s[8:11],s60 offen
buffer_store_dwordx2 v[12:13],v7,s[8:11],s60 offen
s_add_u32 s60,s34,147456
buffer_store_dwordx4 v[12:15],v6,s[8:11],s60 offen
buffer_store_dwordx2 v[12:13],v7,s[8:11],s60 offen
s_add_u32 s60,s34,196608
buffer_store_dwordx4 v[12:15],v6,s[8:11],s60 offen
buffer_store_dwordx2 v[12:13],v7,s[8:11],s60 offen
s_add_u32 s60,s34,245760
buffer_store_dwordx4 v[12:15],v6,s[8:11],s60 offen
buffer_store_dwordx2 v[12:13],v7,s[8:11],s60 offen
s_add_u32 s60,s34,294912
buffer_store_dwordx4 v[12:15],v6,s[8:11],s60 offen
buffer_store_dwordx2 v[12:13],v7,s[8:11],s60 offen
s_add_u32 s60,s34,344064
buffer_store_dwordx4 v[12:15],v6,s[8:11],s60 offen
buffer_store_dwordx2 v[12:13],v7,s[8:11],s60 offen
s_branch ls_5
ls_4:
s_add_u32 s60,s34,0
buffer_store_dwordx4 v[12:15],v6,s[8:11],s60 offen sc1
buffer_store_dwordx2 v[12:13],v7,s[8:11],s60 offen sc1
s_add_u32 s60,s34,49152
buffer_store_dwordx4 v[12:15],v6,s[8:11],s60 offen sc1
buffer_store_dwordx2 v[12:13],v7,s[8:11],s60 offen sc1
s_add_u32 s60,s34,98304
buffer_store_dwordx4 v[12:15],v6,s[8:11],s60 offen sc1
buffer_store_dwordx2 v[12:13],v7,s[8:11],s60 offen sc1
s_add_u32 s60,s34,147456
buffer_store_dwordx4 v[12:15],v6,s[8:11],s60 offen sc1
buffer_store_dwordx2 v[12:13],v7,s[8:11],s60 offen sc1
s_add_u32 s60,s34,196608
buffer_store_dwordx4 v[12:15],v6,s[8:11],s60 offen sc1
buffer_store_dwordx2 v[12:13],v7,s[8:11],s60 offen sc1
s_add_u32 s60,s34,245760
buffer_store_dwordx4 v[12:15],v6,s[8:11],s60 offen sc1
buffer_store_dwordx2 v[12:13],v7,s[8:11],s60 offen sc1
s_add_u32 s60,s34,294912
buffer_store_dwordx4 v[12:15],v6,s[8:11],s60 offen sc1
buffer_store_dwordx2 v[12:13],v7,s[8:11],s60 offen sc1
s_add_u32 s60,s34,344064
buffer_store_dwordx4 v[12:15],v6,s[8:11],s60 offen sc1
buffer_store_dwordx2 v[12:13],v7,s[8:11],s60 offen sc1
s_nop 0
ls_5:
s_mul_i32 s73,s48,768
s_add_u32 s74,s73,96
v_add_u32 v12,0,v0
v_mul_u32_u24 v13,2731,v12
v_lshrrev_b32 v13,16,v13
v_mul_u32_u24 v16,24,v13
v_sub_u32 v12,v12,v16
v_mul_u32_u24 v104,12288,v13
v_lshl_add_u32 v104,v12,4,v104
v_mul_u32_u24 v13,43,v12
v_lshrrev_b32 v13,8,v13
v_mul_u32_u24 v13,96,v13
v_add_u32 v104,v104,v13
v_add_u32 v12,64,v0
v_mul_u32_u24 v13,2731,v12
v_lshrrev_b32 v13,16,v13
v_mul_u32_u24 v16,24,v13
v_sub_u32 v12,v12,v16
v_mul_u32_u24 v105,12288,v13
v_lshl_add_u32 v105,v12,4,v105
v_mul_u32_u24 v13,43,v12
v_lshrrev_b32 v13,8,v13
v_mul_u32_u24 v13,96,v13
v_add_u32 v105,v105,v13
v_add_u32 v12,128,v0
v_mul_u32_u24 v13,2731,v12
v_lshrrev_b32 v13,16,v13
v_mul_u32_u24 v16,24,v13
v_sub_u32 v12,v12,v16
v_mul_u32_u24 v106,12288,v13
v_lshl_add_u32 v106,v12,4,v106
v_mul_u32_u24 v13,43,v12
v_lshrrev_b32 v13,8,v13
v_mul_u32_u24 v13,96,v13
v_add_u32 v106,v106,v13
s_mov_b32 s4,s24
s_mov_b32 s5,s25
s_mov_b32 s6,7864320
s_mov_b32 s7,0x20000
s_mov_b32 s52,s24
s_mov_b32 s53,s25
s_mov_b32 s54,7864320
s_mov_b32 s55,0x20000
SV_LOAD:
s_waitcnt vmcnt(0)
s_barrier
s_cmp_lg_u32 s46,0
s_cbranch_scc1 arr_6
v_mov_b32 v12,1
s_lshl_b32 s3,s49,2
v_mov_b32 v13,s3
s_mov_b64 exec,1
buffer_atomic_add v12,v13,s[12:15],0 offen sc1
s_mov_b64 exec,-1
arr_6:
s_and_b32 s60,s46,1
s_mul_i32 s60,s60,196608
s_lshr_b32 s61,s46,1
s_mul_i32 s75,s61,393216
s_add_u32 s75,s75,s60
s_mul_i32 s76,s61,1966080
s_add_u32 s76,s76,s60
s_mul_i32 s77,s46,6144
v_lshrrev_b32 v14,4,v0
v_and_b32 v15,15,v0
v_and_b32 v12,1,v14
v_lshlrev_b32 v12,5,v12
v_lshrrev_b32 v13,1,v14
v_lshl_add_u32 v12,v13,3,v12
v_bfe_u32 v13,v0,2,1
v_add_u32 v12,v12,v13
v_bfe_u32 v13,v0,3,1
v_lshl_add_u32 v12,v13,2,v12
v_mul_u32_u24 v107,384,v12
v_and_b32 v13,3,v0
v_lshl_add_u32 v107,v13,3,v107
s_mul_i32 s60,s46,96
v_add_u32 v107,s60,v107
s_add_u32 s60,s75,s73
s_add_u32 m0,s77,0
s_add_u32 s61,s60,0
buffer_load_dwordx4 v104,s[4:7],s61 offen lds
s_add_u32 m0,s77,1024
s_add_u32 s61,s60,0
buffer_load_dwordx4 v105,s[4:7],s61 offen lds
s_add_u32 m0,s77,2048
s_add_u32 s61,s60,0
buffer_load_dwordx4 v106,s[4:7],s61 offen lds
s_add_u32 m0,s77,3072
s_add_u32 s61,s60,98304
buffer_load_dwordx4 v104,s[4:7],s61 offen lds
s_add_u32 m0,s77,4096
s_add_u32 s61,s60,98304
buffer_load_dwordx4 v105,s[4:7],s61 offen lds
s_add_u32 m0,s77,5120
s_add_u32 s61,s60,98304
buffer_load_dwordx4 v106,s[4:7],s61 offen lds
s_add_u32 s60,s75,s74
s_add_u32 m0,s77,24576
s_add_u32 s61,s60,0
buffer_load_dwordx4 v104,s[52:55],s61 offen lds
s_add_u32 m0,s77,25600
s_add_u32 s61,s60,0
buffer_load_dwordx4 v105,s[52:55],s61 offen lds
s_add_u32 m0,s77,26624
s_add_u32 s61,s60,0
buffer_load_dwordx4 v106,s[52:55],s61 offen lds
s_add_u32 m0,s77,27648
s_add_u32 s61,s60,98304
buffer_load_dwordx4 v104,s[52:55],s61 offen lds
s_add_u32 m0,s77,28672
s_add_u32 s61,s60,98304
buffer_load_dwordx4 v105,s[52:55],s61 offen lds
s_add_u32 m0,s77,29696
s_add_u32 s61,s60,98304
buffer_load_dwordx4 v106,s[52:55],s61 offen lds
s_add_u32 s60,s75,s73
s_add_u32 m0,s77,49152
s_add_u32 s61,s60,786432
buffer_load_dwordx4 v104,s[4:7],s61 offen lds
s_add_u32 m0,s77,50176
s_add_u32 s61,s60,786432
buffer_load_dwordx4 v105,s[4:7],s61 offen lds
s_add_u32 m0,s77,51200
s_add_u32 s61,s60,786432
buffer_load_dwordx4 v106,s[4:7],s61 offen lds
s_add_u32 m0,s77,52224
s_add_u32 s61,s60,884736
buffer_load_dwordx4 v104,s[4:7],s61 offen lds
s_add_u32 m0,s77,53248
s_add_u32 s61,s60,884736
buffer_load_dwordx4 v105,s[4:7],s61 offen lds
s_add_u32 m0,s77,54272
s_add_u32 s61,s60,884736
buffer_load_dwordx4 v106,s[4:7],s61 offen lds
s_add_u32 s60,s75,s74
s_add_u32 m0,s77,73728
s_add_u32 s61,s60,786432
buffer_load_dwordx4 v104,s[52:55],s61 offen lds
s_add_u32 m0,s77,74752
s_add_u32 s61,s60,786432
buffer_load_dwordx4 v105,s[52:55],s61 offen lds
s_add_u32 m0,s77,75776
s_add_u32 s61,s60,786432
buffer_load_dwordx4 v106,s[52:55],s61 offen lds
s_add_u32 m0,s77,76800
s_add_u32 s61,s60,884736
buffer_load_dwordx4 v104,s[52:55],s61 offen lds
s_add_u32 m0,s77,77824
s_add_u32 s61,s60,884736
buffer_load_dwordx4 v105,s[52:55],s61 offen lds
s_add_u32 m0,s77,78848
s_add_u32 s61,s60,884736
buffer_load_dwordx4 v106,s[52:55],s61 offen lds
s_add_u32 s60,s75,s73
s_add_u32 m0,s77,98304
s_add_u32 s61,s60,1966080
buffer_load_dwordx4 v104,s[4:7],s61 offen lds
s_add_u32 m0,s77,99328
s_add_u32 s61,s60,1966080
buffer_load_dwordx4 v105,s[4:7],s61 offen lds
s_add_u32 m0,s77,100352
s_add_u32 s61,s60,1966080
buffer_load_dwordx4 v106,s[4:7],s61 offen lds
s_add_u32 m0,s77,101376
s_add_u32 s61,s60,2064384
buffer_load_dwordx4 v104,s[4:7],s61 offen lds
s_add_u32 m0,s77,102400
s_add_u32 s61,s60,2064384
buffer_load_dwordx4 v105,s[4:7],s61 offen lds
s_add_u32 m0,s77,103424
s_add_u32 s61,s60,2064384
buffer_load_dwordx4 v106,s[4:7],s61 offen lds
s_waitcnt vmcnt(24)
s_barrier
s_add_u32 s60,s75,s74
s_add_u32 m0,s77,122880
s_add_u32 s61,s60,1966080
buffer_load_dwordx4 v104,s[52:55],s61 offen lds
s_add_u32 m0,s77,123904
s_add_u32 s61,s60,1966080
buffer_load_dwordx4 v105,s[52:55],s61 offen lds
s_add_u32 m0,s77,124928
s_add_u32 s61,s60,1966080
buffer_load_dwordx4 v106,s[52:55],s61 offen lds
s_add_u32 m0,s77,125952
s_add_u32 s61,s60,2064384
buffer_load_dwordx4 v104,s[52:55],s61 offen lds
s_add_u32 m0,s77,126976
s_add_u32 s61,s60,2064384
buffer_load_dwordx4 v105,s[52:55],s61 offen lds
s_add_u32 m0,s77,128000
s_add_u32 s61,s60,2064384
buffer_load_dwordx4 v106,s[52:55],s61 offen lds
v_add_u32 v12,0,v107
s_cmp_eq_u32 s46,1
s_cbranch_scc1 lw_9
s_cmp_eq_u32 s46,2
s_cbranch_scc1 lw_10
s_cmp_eq_u32 s46,3
s_cbranch_scc1 lw_11
lw_8:
ds_read_b64_tr_b16 a[0:1],v12 offset:0
ds_read_b64_tr_b16 a[2:3],v12 offset:768
ds_read_b64_tr_b16 a[4:5],v12 offset:6144
ds_read_b64_tr_b16 a[6:7],v12 offset:6912
ds_read_b64_tr_b16 a[8:9],v12 offset:32
ds_read_b64_tr_b16 a[10:11],v12 offset:800
ds_read_b64_tr_b16 a[12:13],v12 offset:6176
ds_read_b64_tr_b16 a[14:15],v12 offset:6944
ds_read_b64_tr_b16 a[16:17],v12 offset:64
ds_read_b64_tr_b16 a[18:19],v12 offset:832
ds_read_b64_tr_b16 a[20:21],v12 offset:6208
ds_read_b64_tr_b16 a[22:23],v12 offset:6976
s_branch ld_7
lw_9:
ds_read_b64_tr_b16 a[240:241],v12 offset:0
ds_read_b64_tr_b16 a[242:243],v12 offset:768
ds_read_b64_tr_b16 a[244:245],v12 offset:6144
ds_read_b64_tr_b16 a[246:247],v12 offset:6912
ds_read_b64_tr_b16 a[248:249],v12 offset:32
ds_read_b64_tr_b16 a[250:251],v12 offset:800
ds_read_b64_tr_b16 a[252:253],v12 offset:6176
ds_read_b64_tr_b16 a[254:255],v12 offset:6944
ds_read_b64_tr_b16 v[112:113],v12 offset:64
ds_read_b64_tr_b16 v[114:115],v12 offset:832
ds_read_b64_tr_b16 v[116:117],v12 offset:6208
ds_read_b64_tr_b16 v[118:119],v12 offset:6976
s_branch ld_7
lw_10:
ds_read_b64_tr_b16 a[160:161],v12 offset:0
ds_read_b64_tr_b16 a[162:163],v12 offset:768
ds_read_b64_tr_b16 a[164:165],v12 offset:6144
ds_read_b64_tr_b16 a[166:167],v12 offset:6912
ds_read_b64_tr_b16 a[168:169],v12 offset:32
ds_read_b64_tr_b16 a[170:171],v12 offset:800
ds_read_b64_tr_b16 a[172:173],v12 offset:6176
ds_read_b64_tr_b16 a[174:175],v12 offset:6944
ds_read_b64_tr_b16 a[176:177],v12 offset:64
ds_read_b64_tr_b16 a[178:179],v12 offset:832
ds_read_b64_tr_b16 a[180:181],v12 offset:6208
ds_read_b64_tr_b16 a[182:183],v12 offset:6976
s_branch ld_7
lw_11:
ds_read_b64_tr_b16 a[80:81],v12 offset:0
ds_read_b64_tr_b16 a[82:83],v12 offset:768
ds_read_b64_tr_b16 a[84:85],v12 offset:6144
ds_read_b64_tr_b16 a[86:87],v12 offset:6912
ds_read_b64_tr_b16 a[88:89],v12 offset:32
ds_read_b64_tr_b16 a[90:91],v12 offset:800
ds_read_b64_tr_b16 a[92:93],v12 offset:6176
ds_read_b64_tr_b16 a[94:95],v12 offset:6944
ds_read_b64_tr_b16 a[96:97],v12 offset:64
ds_read_b64_tr_b16 a[98:99],v12 offset:832
ds_read_b64_tr_b16 a[100:101],v12 offset:6208
ds_read_b64_tr_b16 a[102:103],v12 offset:6976
ld_7:
s_waitcnt lgkmcnt(0)
s_waitcnt vmcnt(24)
s_barrier
s_add_u32 s60,s75,s73
s_add_u32 m0,s77,0
s_add_u32 s61,s60,2752512
buffer_load_dwordx4 v104,s[4:7],s61 offen lds
s_add_u32 m0,s77,1024
s_add_u32 s61,s60,2752512
buffer_load_dwordx4 v105,s[4:7],s61 offen lds
s_add_u32 m0,s77,2048
s_add_u32 s61,s60,2752512
buffer_load_dwordx4 v106,s[4:7],s61 offen lds
s_add_u32 m0,s77,3072
s_add_u32 s61,s60,2850816
buffer_load_dwordx4 v104,s[4:7],s61 offen lds
s_add_u32 m0,s77,4096
s_add_u32 s61,s60,2850816
buffer_load_dwordx4 v105,s[4:7],s61 offen lds
s_add_u32 m0,s77,5120
s_add_u32 s61,s60,2850816
buffer_load_dwordx4 v106,s[4:7],s61 offen lds
v_add_u32 v12,24576,v107
s_cmp_eq_u32 s46,1
s_cbranch_scc1 lw_14
s_cmp_eq_u32 s46,2
s_cbranch_scc1 lw_15
s_cmp_eq_u32 s46,3
s_cbranch_scc1 lw_16
lw_13:
ds_read_b64_tr_b16 a[24:25],v12 offset:0
ds_read_b64_tr_b16 a[26:27],v12 offset:768
ds_read_b64_tr_b16 a[28:29],v12 offset:6144
ds_read_b64_tr_b16 a[30:31],v12 offset:6912
ds_read_b64_tr_b16 a[32:33],v12 offset:32
ds_read_b64_tr_b16 a[34:35],v12 offset:800
ds_read_b64_tr_b16 a[36:37],v12 offset:6176
ds_read_b64_tr_b16 a[38:39],v12 offset:6944
ds_read_b64_tr_b16 v[24:25],v12 offset:64
ds_read_b64_tr_b16 v[26:27],v12 offset:832
ds_read_b64_tr_b16 v[28:29],v12 offset:6208
ds_read_b64_tr_b16 v[30:31],v12 offset:6976
s_branch ld_12
lw_14:
ds_read_b64_tr_b16 v[120:121],v12 offset:0
ds_read_b64_tr_b16 v[122:123],v12 offset:768
ds_read_b64_tr_b16 v[124:125],v12 offset:6144
ds_read_b64_tr_b16 v[126:127],v12 offset:6912
ds_read_b64_tr_b16 v[128:129],v12 offset:32
ds_read_b64_tr_b16 v[130:131],v12 offset:800
ds_read_b64_tr_b16 v[132:133],v12 offset:6176
ds_read_b64_tr_b16 v[134:135],v12 offset:6944
ds_read_b64_tr_b16 v[72:73],v12 offset:64
ds_read_b64_tr_b16 v[74:75],v12 offset:832
ds_read_b64_tr_b16 v[76:77],v12 offset:6208
ds_read_b64_tr_b16 v[78:79],v12 offset:6976
s_branch ld_12
lw_15:
ds_read_b64_tr_b16 a[184:185],v12 offset:0
ds_read_b64_tr_b16 a[186:187],v12 offset:768
ds_read_b64_tr_b16 a[188:189],v12 offset:6144
ds_read_b64_tr_b16 a[190:191],v12 offset:6912
ds_read_b64_tr_b16 a[192:193],v12 offset:32
ds_read_b64_tr_b16 a[194:195],v12 offset:800
ds_read_b64_tr_b16 a[196:197],v12 offset:6176
ds_read_b64_tr_b16 a[198:199],v12 offset:6944
ds_read_b64_tr_b16 v[56:57],v12 offset:64
ds_read_b64_tr_b16 v[58:59],v12 offset:832
ds_read_b64_tr_b16 v[60:61],v12 offset:6208
ds_read_b64_tr_b16 v[62:63],v12 offset:6976
s_branch ld_12
lw_16:
ds_read_b64_tr_b16 a[104:105],v12 offset:0
ds_read_b64_tr_b16 a[106:107],v12 offset:768
ds_read_b64_tr_b16 a[108:109],v12 offset:6144
ds_read_b64_tr_b16 a[110:111],v12 offset:6912
ds_read_b64_tr_b16 a[112:113],v12 offset:32
ds_read_b64_tr_b16 a[114:115],v12 offset:800
ds_read_b64_tr_b16 a[116:117],v12 offset:6176
ds_read_b64_tr_b16 a[118:119],v12 offset:6944
ds_read_b64_tr_b16 v[40:41],v12 offset:64
ds_read_b64_tr_b16 v[42:43],v12 offset:832
ds_read_b64_tr_b16 v[44:45],v12 offset:6208
ds_read_b64_tr_b16 v[46:47],v12 offset:6976
ld_12:
s_waitcnt lgkmcnt(0)
s_waitcnt vmcnt(24)
s_barrier
s_add_u32 s60,s75,s74
s_add_u32 m0,s77,24576
s_add_u32 s61,s60,2752512
buffer_load_dwordx4 v104,s[52:55],s61 offen lds
s_add_u32 m0,s77,25600
s_add_u32 s61,s60,2752512
buffer_load_dwordx4 v105,s[52:55],s61 offen lds
s_add_u32 m0,s77,26624
s_add_u32 s61,s60,2752512
buffer_load_dwordx4 v106,s[52:55],s61 offen lds
s_add_u32 m0,s77,27648
s_add_u32 s61,s60,2850816
buffer_load_dwordx4 v104,s[52:55],s61 offen lds
s_add_u32 m0,s77,28672
s_add_u32 s61,s60,2850816
buffer_load_dwordx4 v105,s[52:55],s61 offen lds
s_add_u32 m0,s77,29696
s_add_u32 s61,s60,2850816
buffer_load_dwordx4 v106,s[52:55],s61 offen lds
v_add_u32 v12,49152,v107
s_cmp_eq_u32 s46,1
s_cbranch_scc1 lw_19
s_cmp_eq_u32 s46,2
s_cbranch_scc1 lw_20
s_cmp_eq_u32 s46,3
s_cbranch_scc1 lw_21
lw_18:
ds_read_b64_tr_b16 a[40:41],v12 offset:0
ds_read_b64_tr_b16 a[42:43],v12 offset:768
ds_read_b64_tr_b16 a[44:45],v12 offset:6144
ds_read_b64_tr_b16 a[46:47],v12 offset:6912
ds_read_b64_tr_b16 a[48:49],v12 offset:32
ds_read_b64_tr_b16 a[50:51],v12 offset:800
ds_read_b64_tr_b16 a[52:53],v12 offset:6176
ds_read_b64_tr_b16 a[54:55],v12 offset:6944
ds_read_b64_tr_b16 a[56:57],v12 offset:64
ds_read_b64_tr_b16 a[58:59],v12 offset:832
ds_read_b64_tr_b16 a[60:61],v12 offset:6208
ds_read_b64_tr_b16 a[62:63],v12 offset:6976
s_branch ld_17
lw_19:
ds_read_b64_tr_b16 v[136:137],v12 offset:0
ds_read_b64_tr_b16 v[138:139],v12 offset:768
ds_read_b64_tr_b16 v[140:141],v12 offset:6144
ds_read_b64_tr_b16 v[142:143],v12 offset:6912
ds_read_b64_tr_b16 v[144:145],v12 offset:32
ds_read_b64_tr_b16 v[146:147],v12 offset:800
ds_read_b64_tr_b16 v[148:149],v12 offset:6176
ds_read_b64_tr_b16 v[150:151],v12 offset:6944
ds_read_b64_tr_b16 v[152:153],v12 offset:64
ds_read_b64_tr_b16 v[154:155],v12 offset:832
ds_read_b64_tr_b16 v[156:157],v12 offset:6208
ds_read_b64_tr_b16 v[158:159],v12 offset:6976
s_branch ld_17
lw_20:
ds_read_b64_tr_b16 a[200:201],v12 offset:0
ds_read_b64_tr_b16 a[202:203],v12 offset:768
ds_read_b64_tr_b16 a[204:205],v12 offset:6144
ds_read_b64_tr_b16 a[206:207],v12 offset:6912
ds_read_b64_tr_b16 a[208:209],v12 offset:32
ds_read_b64_tr_b16 a[210:211],v12 offset:800
ds_read_b64_tr_b16 a[212:213],v12 offset:6176
ds_read_b64_tr_b16 a[214:215],v12 offset:6944
ds_read_b64_tr_b16 a[216:217],v12 offset:64
ds_read_b64_tr_b16 a[218:219],v12 offset:832
ds_read_b64_tr_b16 a[220:221],v12 offset:6208
ds_read_b64_tr_b16 a[222:223],v12 offset:6976
s_branch ld_17
lw_21:
ds_read_b64_tr_b16 a[120:121],v12 offset:0
ds_read_b64_tr_b16 a[122:123],v12 offset:768
ds_read_b64_tr_b16 a[124:125],v12 offset:6144
ds_read_b64_tr_b16 a[126:127],v12 offset:6912
ds_read_b64_tr_b16 a[128:129],v12 offset:32
ds_read_b64_tr_b16 a[130:131],v12 offset:800
ds_read_b64_tr_b16 a[132:133],v12 offset:6176
ds_read_b64_tr_b16 a[134:135],v12 offset:6944
ds_read_b64_tr_b16 a[136:137],v12 offset:64
ds_read_b64_tr_b16 a[138:139],v12 offset:832
ds_read_b64_tr_b16 a[140:141],v12 offset:6208
ds_read_b64_tr_b16 a[142:143],v12 offset:6976
ld_17:
s_waitcnt lgkmcnt(0)
s_waitcnt vmcnt(24)
s_barrier
s_add_u32 s60,s75,s73
s_add_u32 m0,s77,49152
s_add_u32 s61,s60,3932160
buffer_load_dwordx4 v104,s[4:7],s61 offen lds
s_add_u32 m0,s77,50176
s_add_u32 s61,s60,3932160
buffer_load_dwordx4 v105,s[4:7],s61 offen lds
s_add_u32 m0,s77,51200
s_add_u32 s61,s60,3932160
buffer_load_dwordx4 v106,s[4:7],s61 offen lds
s_add_u32 m0,s77,52224
s_add_u32 s61,s60,4030464
buffer_load_dwordx4 v104,s[4:7],s61 offen lds
s_add_u32 m0,s77,53248
s_add_u32 s61,s60,4030464
buffer_load_dwordx4 v105,s[4:7],s61 offen lds
s_add_u32 m0,s77,54272
s_add_u32 s61,s60,4030464
buffer_load_dwordx4 v106,s[4:7],s61 offen lds
v_add_u32 v12,73728,v107
s_cmp_eq_u32 s46,1
s_cbranch_scc1 lw_24
s_cmp_eq_u32 s46,2
s_cbranch_scc1 lw_25
s_cmp_eq_u32 s46,3
s_cbranch_scc1 lw_26
lw_23:
ds_read_b64_tr_b16 a[64:65],v12 offset:0
ds_read_b64_tr_b16 a[66:67],v12 offset:768
ds_read_b64_tr_b16 a[68:69],v12 offset:6144
ds_read_b64_tr_b16 a[70:71],v12 offset:6912
ds_read_b64_tr_b16 a[72:73],v12 offset:32
ds_read_b64_tr_b16 a[74:75],v12 offset:800
ds_read_b64_tr_b16 a[76:77],v12 offset:6176
ds_read_b64_tr_b16 a[78:79],v12 offset:6944
ds_read_b64_tr_b16 v[32:33],v12 offset:64
ds_read_b64_tr_b16 v[34:35],v12 offset:832
ds_read_b64_tr_b16 v[36:37],v12 offset:6208
ds_read_b64_tr_b16 v[38:39],v12 offset:6976
s_branch ld_22
lw_24:
ds_read_b64_tr_b16 v[160:161],v12 offset:0
ds_read_b64_tr_b16 v[162:163],v12 offset:768
ds_read_b64_tr_b16 v[164:165],v12 offset:6144
ds_read_b64_tr_b16 v[166:167],v12 offset:6912
ds_read_b64_tr_b16 v[168:169],v12 offset:32
ds_read_b64_tr_b16 v[170:171],v12 offset:800
ds_read_b64_tr_b16 v[172:173],v12 offset:6176
ds_read_b64_tr_b16 v[174:175],v12 offset:6944
ds_read_b64_tr_b16 v[80:81],v12 offset:64
ds_read_b64_tr_b16 v[82:83],v12 offset:832
ds_read_b64_tr_b16 v[84:85],v12 offset:6208
ds_read_b64_tr_b16 v[86:87],v12 offset:6976
s_branch ld_22
lw_25:
ds_read_b64_tr_b16 a[224:225],v12 offset:0
ds_read_b64_tr_b16 a[226:227],v12 offset:768
ds_read_b64_tr_b16 a[228:229],v12 offset:6144
ds_read_b64_tr_b16 a[230:231],v12 offset:6912
ds_read_b64_tr_b16 a[232:233],v12 offset:32
ds_read_b64_tr_b16 a[234:235],v12 offset:800
ds_read_b64_tr_b16 a[236:237],v12 offset:6176
ds_read_b64_tr_b16 a[238:239],v12 offset:6944
ds_read_b64_tr_b16 v[64:65],v12 offset:64
ds_read_b64_tr_b16 v[66:67],v12 offset:832
ds_read_b64_tr_b16 v[68:69],v12 offset:6208
ds_read_b64_tr_b16 v[70:71],v12 offset:6976
s_branch ld_22
lw_26:
ds_read_b64_tr_b16 a[144:145],v12 offset:0
ds_read_b64_tr_b16 a[146:147],v12 offset:768
ds_read_b64_tr_b16 a[148:149],v12 offset:6144
ds_read_b64_tr_b16 a[150:151],v12 offset:6912
ds_read_b64_tr_b16 a[152:153],v12 offset:32
ds_read_b64_tr_b16 a[154:155],v12 offset:800
ds_read_b64_tr_b16 a[156:157],v12 offset:6176
ds_read_b64_tr_b16 a[158:159],v12 offset:6944
ds_read_b64_tr_b16 v[48:49],v12 offset:64
ds_read_b64_tr_b16 v[50:51],v12 offset:832
ds_read_b64_tr_b16 v[52:53],v12 offset:6208
ds_read_b64_tr_b16 v[54:55],v12 offset:6976
ld_22:
s_waitcnt lgkmcnt(0)
s_waitcnt vmcnt(24)
s_barrier
s_add_u32 s60,s75,s74
s_add_u32 m0,s77,73728
s_add_u32 s61,s60,3932160
buffer_load_dwordx4 v104,s[52:55],s61 offen lds
s_add_u32 m0,s77,74752
s_add_u32 s61,s60,3932160
buffer_load_dwordx4 v105,s[52:55],s61 offen lds
s_add_u32 m0,s77,75776
s_add_u32 s61,s60,3932160
buffer_load_dwordx4 v106,s[52:55],s61 offen lds
s_add_u32 m0,s77,76800
s_add_u32 s61,s60,4030464
buffer_load_dwordx4 v104,s[52:55],s61 offen lds
s_add_u32 m0,s77,77824
s_add_u32 s61,s60,4030464
buffer_load_dwordx4 v105,s[52:55],s61 offen lds
s_add_u32 m0,s77,78848
s_add_u32 s61,s60,4030464
buffer_load_dwordx4 v106,s[52:55],s61 offen lds
v_add_u32 v12,98304,v107
s_cmp_eq_u32 s46,1
s_cbranch_scc1 lw_29
s_cmp_eq_u32 s46,2
s_cbranch_scc1 lw_30
s_cmp_eq_u32 s46,3
s_cbranch_scc1 lw_31
lw_28:
ds_read_b64_tr_b16 a[80:81],v12 offset:0
ds_read_b64_tr_b16 a[82:83],v12 offset:768
ds_read_b64_tr_b16 a[84:85],v12 offset:6144
ds_read_b64_tr_b16 a[86:87],v12 offset:6912
ds_read_b64_tr_b16 a[88:89],v12 offset:32
ds_read_b64_tr_b16 a[90:91],v12 offset:800
ds_read_b64_tr_b16 a[92:93],v12 offset:6176
ds_read_b64_tr_b16 a[94:95],v12 offset:6944
ds_read_b64_tr_b16 a[96:97],v12 offset:64
ds_read_b64_tr_b16 a[98:99],v12 offset:832
ds_read_b64_tr_b16 a[100:101],v12 offset:6208
ds_read_b64_tr_b16 a[102:103],v12 offset:6976
s_branch ld_27
lw_29:
ds_read_b64_tr_b16 a[0:1],v12 offset:0
ds_read_b64_tr_b16 a[2:3],v12 offset:768
ds_read_b64_tr_b16 a[4:5],v12 offset:6144
ds_read_b64_tr_b16 a[6:7],v12 offset:6912
ds_read_b64_tr_b16 a[8:9],v12 offset:32
ds_read_b64_tr_b16 a[10:11],v12 offset:800
ds_read_b64_tr_b16 a[12:13],v12 offset:6176
ds_read_b64_tr_b16 a[14:15],v12 offset:6944
ds_read_b64_tr_b16 a[16:17],v12 offset:64
ds_read_b64_tr_b16 a[18:19],v12 offset:832
ds_read_b64_tr_b16 a[20:21],v12 offset:6208
ds_read_b64_tr_b16 a[22:23],v12 offset:6976
s_branch ld_27
lw_30:
ds_read_b64_tr_b16 a[240:241],v12 offset:0
ds_read_b64_tr_b16 a[242:243],v12 offset:768
ds_read_b64_tr_b16 a[244:245],v12 offset:6144
ds_read_b64_tr_b16 a[246:247],v12 offset:6912
ds_read_b64_tr_b16 a[248:249],v12 offset:32
ds_read_b64_tr_b16 a[250:251],v12 offset:800
ds_read_b64_tr_b16 a[252:253],v12 offset:6176
ds_read_b64_tr_b16 a[254:255],v12 offset:6944
ds_read_b64_tr_b16 v[112:113],v12 offset:64
ds_read_b64_tr_b16 v[114:115],v12 offset:832
ds_read_b64_tr_b16 v[116:117],v12 offset:6208
ds_read_b64_tr_b16 v[118:119],v12 offset:6976
s_branch ld_27
lw_31:
ds_read_b64_tr_b16 a[160:161],v12 offset:0
ds_read_b64_tr_b16 a[162:163],v12 offset:768
ds_read_b64_tr_b16 a[164:165],v12 offset:6144
ds_read_b64_tr_b16 a[166:167],v12 offset:6912
ds_read_b64_tr_b16 a[168:169],v12 offset:32
ds_read_b64_tr_b16 a[170:171],v12 offset:800
ds_read_b64_tr_b16 a[172:173],v12 offset:6176
ds_read_b64_tr_b16 a[174:175],v12 offset:6944
ds_read_b64_tr_b16 a[176:177],v12 offset:64
ds_read_b64_tr_b16 a[178:179],v12 offset:832
ds_read_b64_tr_b16 a[180:181],v12 offset:6208
ds_read_b64_tr_b16 a[182:183],v12 offset:6976
ld_27:
s_waitcnt lgkmcnt(0)
s_waitcnt vmcnt(24)
s_barrier
s_add_u32 s60,s75,s73
s_add_u32 m0,s77,98304
s_add_u32 s61,s60,4718592
buffer_load_dwordx4 v104,s[4:7],s61 offen lds
s_add_u32 m0,s77,99328
s_add_u32 s61,s60,4718592
buffer_load_dwordx4 v105,s[4:7],s61 offen lds
s_add_u32 m0,s77,100352
s_add_u32 s61,s60,4718592
buffer_load_dwordx4 v106,s[4:7],s61 offen lds
s_add_u32 m0,s77,101376
s_add_u32 s61,s60,4816896
buffer_load_dwordx4 v104,s[4:7],s61 offen lds
s_add_u32 m0,s77,102400
s_add_u32 s61,s60,4816896
buffer_load_dwordx4 v105,s[4:7],s61 offen lds
s_add_u32 m0,s77,103424
s_add_u32 s61,s60,4816896
buffer_load_dwordx4 v106,s[4:7],s61 offen lds
v_add_u32 v12,122880,v107
s_cmp_eq_u32 s46,1
s_cbranch_scc1 lw_34
s_cmp_eq_u32 s46,2
s_cbranch_scc1 lw_35
s_cmp_eq_u32 s46,3
s_cbranch_scc1 lw_36
lw_33:
ds_read_b64_tr_b16 a[104:105],v12 offset:0
ds_read_b64_tr_b16 a[106:107],v12 offset:768
ds_read_b64_tr_b16 a[108:109],v12 offset:6144
ds_read_b64_tr_b16 a[110:111],v12 offset:6912
ds_read_b64_tr_b16 a[112:113],v12 offset:32
ds_read_b64_tr_b16 a[114:115],v12 offset:800
ds_read_b64_tr_b16 a[116:117],v12 offset:6176
ds_read_b64_tr_b16 a[118:119],v12 offset:6944
ds_read_b64_tr_b16 v[40:41],v12 offset:64
ds_read_b64_tr_b16 v[42:43],v12 offset:832
ds_read_b64_tr_b16 v[44:45],v12 offset:6208
ds_read_b64_tr_b16 v[46:47],v12 offset:6976
s_branch ld_32
lw_34:
ds_read_b64_tr_b16 a[24:25],v12 offset:0
ds_read_b64_tr_b16 a[26:27],v12 offset:768
ds_read_b64_tr_b16 a[28:29],v12 offset:6144
ds_read_b64_tr_b16 a[30:31],v12 offset:6912
ds_read_b64_tr_b16 a[32:33],v12 offset:32
ds_read_b64_tr_b16 a[34:35],v12 offset:800
ds_read_b64_tr_b16 a[36:37],v12 offset:6176
ds_read_b64_tr_b16 a[38:39],v12 offset:6944
ds_read_b64_tr_b16 v[24:25],v12 offset:64
ds_read_b64_tr_b16 v[26:27],v12 offset:832
ds_read_b64_tr_b16 v[28:29],v12 offset:6208
ds_read_b64_tr_b16 v[30:31],v12 offset:6976
s_branch ld_32
lw_35:
ds_read_b64_tr_b16 v[120:121],v12 offset:0
ds_read_b64_tr_b16 v[122:123],v12 offset:768
ds_read_b64_tr_b16 v[124:125],v12 offset:6144
ds_read_b64_tr_b16 v[126:127],v12 offset:6912
ds_read_b64_tr_b16 v[128:129],v12 offset:32
ds_read_b64_tr_b16 v[130:131],v12 offset:800
ds_read_b64_tr_b16 v[132:133],v12 offset:6176
ds_read_b64_tr_b16 v[134:135],v12 offset:6944
ds_read_b64_tr_b16 v[72:73],v12 offset:64
ds_read_b64_tr_b16 v[74:75],v12 offset:832
ds_read_b64_tr_b16 v[76:77],v12 offset:6208
ds_read_b64_tr_b16 v[78:79],v12 offset:6976
s_branch ld_32
lw_36:
ds_read_b64_tr_b16 a[184:185],v12 offset:0
ds_read_b64_tr_b16 a[186:187],v12 offset:768
ds_read_b64_tr_b16 a[188:189],v12 offset:6144
ds_read_b64_tr_b16 a[190:191],v12 offset:6912
ds_read_b64_tr_b16 a[192:193],v12 offset:32
ds_read_b64_tr_b16 a[194:195],v12 offset:800
ds_read_b64_tr_b16 a[196:197],v12 offset:6176
ds_read_b64_tr_b16 a[198:199],v12 offset:6944
ds_read_b64_tr_b16 v[56:57],v12 offset:64
ds_read_b64_tr_b16 v[58:59],v12 offset:832
ds_read_b64_tr_b16 v[60:61],v12 offset:6208
ds_read_b64_tr_b16 v[62:63],v12 offset:6976
ld_32:
s_waitcnt lgkmcnt(0)
s_waitcnt vmcnt(24)
s_barrier
s_add_u32 s60,s75,s74
s_add_u32 m0,s77,122880
s_add_u32 s61,s60,4718592
buffer_load_dwordx4 v104,s[52:55],s61 offen lds
s_add_u32 m0,s77,123904
s_add_u32 s61,s60,4718592
buffer_load_dwordx4 v105,s[52:55],s61 offen lds
s_add_u32 m0,s77,124928
s_add_u32 s61,s60,4718592
buffer_load_dwordx4 v106,s[52:55],s61 offen lds
s_add_u32 m0,s77,125952
s_add_u32 s61,s60,4816896
buffer_load_dwordx4 v104,s[52:55],s61 offen lds
s_add_u32 m0,s77,126976
s_add_u32 s61,s60,4816896
buffer_load_dwordx4 v105,s[52:55],s61 offen lds
s_add_u32 m0,s77,128000
s_add_u32 s61,s60,4816896
buffer_load_dwordx4 v106,s[52:55],s61 offen lds
v_add_u32 v12,0,v107
s_cmp_eq_u32 s46,1
s_cbranch_scc1 lw_39
s_cmp_eq_u32 s46,2
s_cbranch_scc1 lw_40
s_cmp_eq_u32 s46,3
s_cbranch_scc1 lw_41
lw_38:
ds_read_b64_tr_b16 a[120:121],v12 offset:0
ds_read_b64_tr_b16 a[122:123],v12 offset:768
ds_read_b64_tr_b16 a[124:125],v12 offset:6144
ds_read_b64_tr_b16 a[126:127],v12 offset:6912
ds_read_b64_tr_b16 a[128:129],v12 offset:32
ds_read_b64_tr_b16 a[130:131],v12 offset:800
ds_read_b64_tr_b16 a[132:133],v12 offset:6176
ds_read_b64_tr_b16 a[134:135],v12 offset:6944
ds_read_b64_tr_b16 a[136:137],v12 offset:64
ds_read_b64_tr_b16 a[138:139],v12 offset:832
ds_read_b64_tr_b16 a[140:141],v12 offset:6208
ds_read_b64_tr_b16 a[142:143],v12 offset:6976
s_branch ld_37
lw_39:
ds_read_b64_tr_b16 a[40:41],v12 offset:0
ds_read_b64_tr_b16 a[42:43],v12 offset:768
ds_read_b64_tr_b16 a[44:45],v12 offset:6144
ds_read_b64_tr_b16 a[46:47],v12 offset:6912
ds_read_b64_tr_b16 a[48:49],v12 offset:32
ds_read_b64_tr_b16 a[50:51],v12 offset:800
ds_read_b64_tr_b16 a[52:53],v12 offset:6176
ds_read_b64_tr_b16 a[54:55],v12 offset:6944
ds_read_b64_tr_b16 a[56:57],v12 offset:64
ds_read_b64_tr_b16 a[58:59],v12 offset:832
ds_read_b64_tr_b16 a[60:61],v12 offset:6208
ds_read_b64_tr_b16 a[62:63],v12 offset:6976
s_branch ld_37
lw_40:
ds_read_b64_tr_b16 v[136:137],v12 offset:0
ds_read_b64_tr_b16 v[138:139],v12 offset:768
ds_read_b64_tr_b16 v[140:141],v12 offset:6144
ds_read_b64_tr_b16 v[142:143],v12 offset:6912
ds_read_b64_tr_b16 v[144:145],v12 offset:32
ds_read_b64_tr_b16 v[146:147],v12 offset:800
ds_read_b64_tr_b16 v[148:149],v12 offset:6176
ds_read_b64_tr_b16 v[150:151],v12 offset:6944
ds_read_b64_tr_b16 v[152:153],v12 offset:64
ds_read_b64_tr_b16 v[154:155],v12 offset:832
ds_read_b64_tr_b16 v[156:157],v12 offset:6208
ds_read_b64_tr_b16 v[158:159],v12 offset:6976
s_branch ld_37
lw_41:
ds_read_b64_tr_b16 a[200:201],v12 offset:0
ds_read_b64_tr_b16 a[202:203],v12 offset:768
ds_read_b64_tr_b16 a[204:205],v12 offset:6144
ds_read_b64_tr_b16 a[206:207],v12 offset:6912
ds_read_b64_tr_b16 a[208:209],v12 offset:32
ds_read_b64_tr_b16 a[210:211],v12 offset:800
ds_read_b64_tr_b16 a[212:213],v12 offset:6176
ds_read_b64_tr_b16 a[214:215],v12 offset:6944
ds_read_b64_tr_b16 a[216:217],v12 offset:64
ds_read_b64_tr_b16 a[218:219],v12 offset:832
ds_read_b64_tr_b16 a[220:221],v12 offset:6208
ds_read_b64_tr_b16 a[222:223],v12 offset:6976
ld_37:
s_waitcnt lgkmcnt(0)
s_waitcnt vmcnt(24)
s_barrier
s_add_u32 s60,s75,s73
s_add_u32 m0,s77,0
s_add_u32 s61,s60,5898240
buffer_load_dwordx4 v104,s[4:7],s61 offen lds
s_add_u32 m0,s77,1024
s_add_u32 s61,s60,5898240
buffer_load_dwordx4 v105,s[4:7],s61 offen lds
s_add_u32 m0,s77,2048
s_add_u32 s61,s60,5898240
buffer_load_dwordx4 v106,s[4:7],s61 offen lds
s_add_u32 m0,s77,3072
s_add_u32 s61,s60,5996544
buffer_load_dwordx4 v104,s[4:7],s61 offen lds
s_add_u32 m0,s77,4096
s_add_u32 s61,s60,5996544
buffer_load_dwordx4 v105,s[4:7],s61 offen lds
s_add_u32 m0,s77,5120
s_add_u32 s61,s60,5996544
buffer_load_dwordx4 v106,s[4:7],s61 offen lds
v_add_u32 v12,24576,v107
s_cmp_eq_u32 s46,1
s_cbranch_scc1 lw_44
s_cmp_eq_u32 s46,2
s_cbranch_scc1 lw_45
s_cmp_eq_u32 s46,3
s_cbranch_scc1 lw_46
lw_43:
ds_read_b64_tr_b16 a[144:145],v12 offset:0
ds_read_b64_tr_b16 a[146:147],v12 offset:768
ds_read_b64_tr_b16 a[148:149],v12 offset:6144
ds_read_b64_tr_b16 a[150:151],v12 offset:6912
ds_read_b64_tr_b16 a[152:153],v12 offset:32
ds_read_b64_tr_b16 a[154:155],v12 offset:800
ds_read_b64_tr_b16 a[156:157],v12 offset:6176
ds_read_b64_tr_b16 a[158:159],v12 offset:6944
ds_read_b64_tr_b16 v[48:49],v12 offset:64
ds_read_b64_tr_b16 v[50:51],v12 offset:832
ds_read_b64_tr_b16 v[52:53],v12 offset:6208
ds_read_b64_tr_b16 v[54:55],v12 offset:6976
s_branch ld_42
lw_44:
ds_read_b64_tr_b16 a[64:65],v12 offset:0
ds_read_b64_tr_b16 a[66:67],v12 offset:768
ds_read_b64_tr_b16 a[68:69],v12 offset:6144
ds_read_b64_tr_b16 a[70:71],v12 offset:6912
ds_read_b64_tr_b16 a[72:73],v12 offset:32
ds_read_b64_tr_b16 a[74:75],v12 offset:800
ds_read_b64_tr_b16 a[76:77],v12 offset:6176
ds_read_b64_tr_b16 a[78:79],v12 offset:6944
ds_read_b64_tr_b16 v[32:33],v12 offset:64
ds_read_b64_tr_b16 v[34:35],v12 offset:832
ds_read_b64_tr_b16 v[36:37],v12 offset:6208
ds_read_b64_tr_b16 v[38:39],v12 offset:6976
s_branch ld_42
lw_45:
ds_read_b64_tr_b16 v[160:161],v12 offset:0
ds_read_b64_tr_b16 v[162:163],v12 offset:768
ds_read_b64_tr_b16 v[164:165],v12 offset:6144
ds_read_b64_tr_b16 v[166:167],v12 offset:6912
ds_read_b64_tr_b16 v[168:169],v12 offset:32
ds_read_b64_tr_b16 v[170:171],v12 offset:800
ds_read_b64_tr_b16 v[172:173],v12 offset:6176
ds_read_b64_tr_b16 v[174:175],v12 offset:6944
ds_read_b64_tr_b16 v[80:81],v12 offset:64
ds_read_b64_tr_b16 v[82:83],v12 offset:832
ds_read_b64_tr_b16 v[84:85],v12 offset:6208
ds_read_b64_tr_b16 v[86:87],v12 offset:6976
s_branch ld_42
lw_46:
ds_read_b64_tr_b16 a[224:225],v12 offset:0
ds_read_b64_tr_b16 a[226:227],v12 offset:768
ds_read_b64_tr_b16 a[228:229],v12 offset:6144
ds_read_b64_tr_b16 a[230:231],v12 offset:6912
ds_read_b64_tr_b16 a[232:233],v12 offset:32
ds_read_b64_tr_b16 a[234:235],v12 offset:800
ds_read_b64_tr_b16 a[236:237],v12 offset:6176
ds_read_b64_tr_b16 a[238:239],v12 offset:6944
ds_read_b64_tr_b16 v[64:65],v12 offset:64
ds_read_b64_tr_b16 v[66:67],v12 offset:832
ds_read_b64_tr_b16 v[68:69],v12 offset:6208
ds_read_b64_tr_b16 v[70:71],v12 offset:6976
ld_42:
s_waitcnt lgkmcnt(0)
s_waitcnt vmcnt(24)
s_barrier
s_add_u32 s60,s75,s74
s_add_u32 m0,s77,24576
s_add_u32 s61,s60,5898240
buffer_load_dwordx4 v104,s[52:55],s61 offen lds
s_add_u32 m0,s77,25600
s_add_u32 s61,s60,5898240
buffer_load_dwordx4 v105,s[52:55],s61 offen lds
s_add_u32 m0,s77,26624
s_add_u32 s61,s60,5898240
buffer_load_dwordx4 v106,s[52:55],s61 offen lds
s_add_u32 m0,s77,27648
s_add_u32 s61,s60,5996544
buffer_load_dwordx4 v104,s[52:55],s61 offen lds
s_add_u32 m0,s77,28672
s_add_u32 s61,s60,5996544
buffer_load_dwordx4 v105,s[52:55],s61 offen lds
s_add_u32 m0,s77,29696
s_add_u32 s61,s60,5996544
buffer_load_dwordx4 v106,s[52:55],s61 offen lds
v_add_u32 v12,49152,v107
s_cmp_eq_u32 s46,1
s_cbranch_scc1 lw_49
s_cmp_eq_u32 s46,2
s_cbranch_scc1 lw_50
s_cmp_eq_u32 s46,3
s_cbranch_scc1 lw_51
lw_48:
ds_read_b64_tr_b16 a[160:161],v12 offset:0
ds_read_b64_tr_b16 a[162:163],v12 offset:768
ds_read_b64_tr_b16 a[164:165],v12 offset:6144
ds_read_b64_tr_b16 a[166:167],v12 offset:6912
ds_read_b64_tr_b16 a[168:169],v12 offset:32
ds_read_b64_tr_b16 a[170:171],v12 offset:800
ds_read_b64_tr_b16 a[172:173],v12 offset:6176
ds_read_b64_tr_b16 a[174:175],v12 offset:6944
ds_read_b64_tr_b16 a[176:177],v12 offset:64
ds_read_b64_tr_b16 a[178:179],v12 offset:832
ds_read_b64_tr_b16 a[180:181],v12 offset:6208
ds_read_b64_tr_b16 a[182:183],v12 offset:6976
s_branch ld_47
lw_49:
ds_read_b64_tr_b16 a[80:81],v12 offset:0
ds_read_b64_tr_b16 a[82:83],v12 offset:768
ds_read_b64_tr_b16 a[84:85],v12 offset:6144
ds_read_b64_tr_b16 a[86:87],v12 offset:6912
ds_read_b64_tr_b16 a[88:89],v12 offset:32
ds_read_b64_tr_b16 a[90:91],v12 offset:800
ds_read_b64_tr_b16 a[92:93],v12 offset:6176
ds_read_b64_tr_b16 a[94:95],v12 offset:6944
ds_read_b64_tr_b16 a[96:97],v12 offset:64
ds_read_b64_tr_b16 a[98:99],v12 offset:832
ds_read_b64_tr_b16 a[100:101],v12 offset:6208
ds_read_b64_tr_b16 a[102:103],v12 offset:6976
s_branch ld_47
lw_50:
ds_read_b64_tr_b16 a[0:1],v12 offset:0
ds_read_b64_tr_b16 a[2:3],v12 offset:768
ds_read_b64_tr_b16 a[4:5],v12 offset:6144
ds_read_b64_tr_b16 a[6:7],v12 offset:6912
ds_read_b64_tr_b16 a[8:9],v12 offset:32
ds_read_b64_tr_b16 a[10:11],v12 offset:800
ds_read_b64_tr_b16 a[12:13],v12 offset:6176
ds_read_b64_tr_b16 a[14:15],v12 offset:6944
ds_read_b64_tr_b16 a[16:17],v12 offset:64
ds_read_b64_tr_b16 a[18:19],v12 offset:832
ds_read_b64_tr_b16 a[20:21],v12 offset:6208
ds_read_b64_tr_b16 a[22:23],v12 offset:6976
s_branch ld_47
lw_51:
ds_read_b64_tr_b16 a[240:241],v12 offset:0
ds_read_b64_tr_b16 a[242:243],v12 offset:768
ds_read_b64_tr_b16 a[244:245],v12 offset:6144
ds_read_b64_tr_b16 a[246:247],v12 offset:6912
ds_read_b64_tr_b16 a[248:249],v12 offset:32
ds_read_b64_tr_b16 a[250:251],v12 offset:800
ds_read_b64_tr_b16 a[252:253],v12 offset:6176
ds_read_b64_tr_b16 a[254:255],v12 offset:6944
ds_read_b64_tr_b16 v[112:113],v12 offset:64
ds_read_b64_tr_b16 v[114:115],v12 offset:832
ds_read_b64_tr_b16 v[116:117],v12 offset:6208
ds_read_b64_tr_b16 v[118:119],v12 offset:6976
ld_47:
s_waitcnt lgkmcnt(0)
s_waitcnt vmcnt(24)
s_barrier
s_add_u32 s60,s75,s73
s_add_u32 m0,s77,49152
s_add_u32 s61,s60,6684672
buffer_load_dwordx4 v104,s[4:7],s61 offen lds
s_add_u32 m0,s77,50176
s_add_u32 s61,s60,6684672
buffer_load_dwordx4 v105,s[4:7],s61 offen lds
s_add_u32 m0,s77,51200
s_add_u32 s61,s60,6684672
buffer_load_dwordx4 v106,s[4:7],s61 offen lds
s_add_u32 m0,s77,52224
s_add_u32 s61,s60,6782976
buffer_load_dwordx4 v104,s[4:7],s61 offen lds
s_add_u32 m0,s77,53248
s_add_u32 s61,s60,6782976
buffer_load_dwordx4 v105,s[4:7],s61 offen lds
s_add_u32 m0,s77,54272
s_add_u32 s61,s60,6782976
buffer_load_dwordx4 v106,s[4:7],s61 offen lds
v_add_u32 v12,73728,v107
s_cmp_eq_u32 s46,1
s_cbranch_scc1 lw_54
s_cmp_eq_u32 s46,2
s_cbranch_scc1 lw_55
s_cmp_eq_u32 s46,3
s_cbranch_scc1 lw_56
lw_53:
ds_read_b64_tr_b16 a[184:185],v12 offset:0
ds_read_b64_tr_b16 a[186:187],v12 offset:768
ds_read_b64_tr_b16 a[188:189],v12 offset:6144
ds_read_b64_tr_b16 a[190:191],v12 offset:6912
ds_read_b64_tr_b16 a[192:193],v12 offset:32
ds_read_b64_tr_b16 a[194:195],v12 offset:800
ds_read_b64_tr_b16 a[196:197],v12 offset:6176
ds_read_b64_tr_b16 a[198:199],v12 offset:6944
ds_read_b64_tr_b16 v[56:57],v12 offset:64
ds_read_b64_tr_b16 v[58:59],v12 offset:832
ds_read_b64_tr_b16 v[60:61],v12 offset:6208
ds_read_b64_tr_b16 v[62:63],v12 offset:6976
s_branch ld_52
lw_54:
ds_read_b64_tr_b16 a[104:105],v12 offset:0
ds_read_b64_tr_b16 a[106:107],v12 offset:768
ds_read_b64_tr_b16 a[108:109],v12 offset:6144
ds_read_b64_tr_b16 a[110:111],v12 offset:6912
ds_read_b64_tr_b16 a[112:113],v12 offset:32
ds_read_b64_tr_b16 a[114:115],v12 offset:800
ds_read_b64_tr_b16 a[116:117],v12 offset:6176
ds_read_b64_tr_b16 a[118:119],v12 offset:6944
ds_read_b64_tr_b16 v[40:41],v12 offset:64
ds_read_b64_tr_b16 v[42:43],v12 offset:832
ds_read_b64_tr_b16 v[44:45],v12 offset:6208
ds_read_b64_tr_b16 v[46:47],v12 offset:6976
s_branch ld_52
lw_55:
ds_read_b64_tr_b16 a[24:25],v12 offset:0
ds_read_b64_tr_b16 a[26:27],v12 offset:768
ds_read_b64_tr_b16 a[28:29],v12 offset:6144
ds_read_b64_tr_b16 a[30:31],v12 offset:6912
ds_read_b64_tr_b16 a[32:33],v12 offset:32
ds_read_b64_tr_b16 a[34:35],v12 offset:800
ds_read_b64_tr_b16 a[36:37],v12 offset:6176
ds_read_b64_tr_b16 a[38:39],v12 offset:6944
ds_read_b64_tr_b16 v[24:25],v12 offset:64
ds_read_b64_tr_b16 v[26:27],v12 offset:832
ds_read_b64_tr_b16 v[28:29],v12 offset:6208
ds_read_b64_tr_b16 v[30:31],v12 offset:6976
s_branch ld_52
lw_56:
ds_read_b64_tr_b16 v[120:121],v12 offset:0
ds_read_b64_tr_b16 v[122:123],v12 offset:768
ds_read_b64_tr_b16 v[124:125],v12 offset:6144
ds_read_b64_tr_b16 v[126:127],v12 offset:6912
ds_read_b64_tr_b16 v[128:129],v12 offset:32
ds_read_b64_tr_b16 v[130:131],v12 offset:800
ds_read_b64_tr_b16 v[132:133],v12 offset:6176
ds_read_b64_tr_b16 v[134:135],v12 offset:6944
ds_read_b64_tr_b16 v[72:73],v12 offset:64
ds_read_b64_tr_b16 v[74:75],v12 offset:832
ds_read_b64_tr_b16 v[76:77],v12 offset:6208
ds_read_b64_tr_b16 v[78:79],v12 offset:6976
ld_52:
s_waitcnt lgkmcnt(0)
s_waitcnt vmcnt(24)
s_barrier
s_add_u32 s60,s75,s74
s_add_u32 m0,s77,73728
s_add_u32 s61,s60,6684672
buffer_load_dwordx4 v104,s[52:55],s61 offen lds
s_add_u32 m0,s77,74752
s_add_u32 s61,s60,6684672
buffer_load_dwordx4 v105,s[52:55],s61 offen lds
s_add_u32 m0,s77,75776
s_add_u32 s61,s60,6684672
buffer_load_dwordx4 v106,s[52:55],s61 offen lds
s_add_u32 m0,s77,76800
s_add_u32 s61,s60,6782976
buffer_load_dwordx4 v104,s[52:55],s61 offen lds
s_add_u32 m0,s77,77824
s_add_u32 s61,s60,6782976
buffer_load_dwordx4 v105,s[52:55],s61 offen lds
s_add_u32 m0,s77,78848
s_add_u32 s61,s60,6782976
buffer_load_dwordx4 v106,s[52:55],s61 offen lds
v_add_u32 v12,98304,v107
s_cmp_eq_u32 s46,1
s_cbranch_scc1 lw_59
s_cmp_eq_u32 s46,2
s_cbranch_scc1 lw_60
s_cmp_eq_u32 s46,3
s_cbranch_scc1 lw_61
lw_58:
ds_read_b64_tr_b16 a[200:201],v12 offset:0
ds_read_b64_tr_b16 a[202:203],v12 offset:768
ds_read_b64_tr_b16 a[204:205],v12 offset:6144
ds_read_b64_tr_b16 a[206:207],v12 offset:6912
ds_read_b64_tr_b16 a[208:209],v12 offset:32
ds_read_b64_tr_b16 a[210:211],v12 offset:800
ds_read_b64_tr_b16 a[212:213],v12 offset:6176
ds_read_b64_tr_b16 a[214:215],v12 offset:6944
ds_read_b64_tr_b16 a[216:217],v12 offset:64
ds_read_b64_tr_b16 a[218:219],v12 offset:832
ds_read_b64_tr_b16 a[220:221],v12 offset:6208
ds_read_b64_tr_b16 a[222:223],v12 offset:6976
s_branch ld_57
lw_59:
ds_read_b64_tr_b16 a[120:121],v12 offset:0
ds_read_b64_tr_b16 a[122:123],v12 offset:768
ds_read_b64_tr_b16 a[124:125],v12 offset:6144
ds_read_b64_tr_b16 a[126:127],v12 offset:6912
ds_read_b64_tr_b16 a[128:129],v12 offset:32
ds_read_b64_tr_b16 a[130:131],v12 offset:800
ds_read_b64_tr_b16 a[132:133],v12 offset:6176
ds_read_b64_tr_b16 a[134:135],v12 offset:6944
ds_read_b64_tr_b16 a[136:137],v12 offset:64
ds_read_b64_tr_b16 a[138:139],v12 offset:832
ds_read_b64_tr_b16 a[140:141],v12 offset:6208
ds_read_b64_tr_b16 a[142:143],v12 offset:6976
s_branch ld_57
lw_60:
ds_read_b64_tr_b16 a[40:41],v12 offset:0
ds_read_b64_tr_b16 a[42:43],v12 offset:768
ds_read_b64_tr_b16 a[44:45],v12 offset:6144
ds_read_b64_tr_b16 a[46:47],v12 offset:6912
ds_read_b64_tr_b16 a[48:49],v12 offset:32
ds_read_b64_tr_b16 a[50:51],v12 offset:800
ds_read_b64_tr_b16 a[52:53],v12 offset:6176
ds_read_b64_tr_b16 a[54:55],v12 offset:6944
ds_read_b64_tr_b16 a[56:57],v12 offset:64
ds_read_b64_tr_b16 a[58:59],v12 offset:832
ds_read_b64_tr_b16 a[60:61],v12 offset:6208
ds_read_b64_tr_b16 a[62:63],v12 offset:6976
s_branch ld_57
lw_61:
ds_read_b64_tr_b16 v[136:137],v12 offset:0
ds_read_b64_tr_b16 v[138:139],v12 offset:768
ds_read_b64_tr_b16 v[140:141],v12 offset:6144
ds_read_b64_tr_b16 v[142:143],v12 offset:6912
ds_read_b64_tr_b16 v[144:145],v12 offset:32
ds_read_b64_tr_b16 v[146:147],v12 offset:800
ds_read_b64_tr_b16 v[148:149],v12 offset:6176
ds_read_b64_tr_b16 v[150:151],v12 offset:6944
ds_read_b64_tr_b16 v[152:153],v12 offset:64
ds_read_b64_tr_b16 v[154:155],v12 offset:832
ds_read_b64_tr_b16 v[156:157],v12 offset:6208
ds_read_b64_tr_b16 v[158:159],v12 offset:6976
ld_57:
s_waitcnt lgkmcnt(0)
s_waitcnt vmcnt(24)
s_barrier
s_add_u32 s60,s76,s73
s_add_u32 m0,s77,98304
s_add_u32 s61,s60,1572864
buffer_load_dwordx4 v104,s[4:7],s61 offen lds
s_add_u32 m0,s77,99328
s_add_u32 s61,s60,1572864
buffer_load_dwordx4 v105,s[4:7],s61 offen lds
s_add_u32 m0,s77,100352
s_add_u32 s61,s60,1572864
buffer_load_dwordx4 v106,s[4:7],s61 offen lds
s_add_u32 m0,s77,101376
s_add_u32 s61,s60,1671168
buffer_load_dwordx4 v104,s[4:7],s61 offen lds
s_add_u32 m0,s77,102400
s_add_u32 s61,s60,1671168
buffer_load_dwordx4 v105,s[4:7],s61 offen lds
s_add_u32 m0,s77,103424
s_add_u32 s61,s60,1671168
buffer_load_dwordx4 v106,s[4:7],s61 offen lds
v_add_u32 v12,122880,v107
s_cmp_eq_u32 s46,1
s_cbranch_scc1 lw_64
s_cmp_eq_u32 s46,2
s_cbranch_scc1 lw_65
s_cmp_eq_u32 s46,3
s_cbranch_scc1 lw_66
lw_63:
ds_read_b64_tr_b16 a[224:225],v12 offset:0
ds_read_b64_tr_b16 a[226:227],v12 offset:768
ds_read_b64_tr_b16 a[228:229],v12 offset:6144
ds_read_b64_tr_b16 a[230:231],v12 offset:6912
ds_read_b64_tr_b16 a[232:233],v12 offset:32
ds_read_b64_tr_b16 a[234:235],v12 offset:800
ds_read_b64_tr_b16 a[236:237],v12 offset:6176
ds_read_b64_tr_b16 a[238:239],v12 offset:6944
ds_read_b64_tr_b16 v[64:65],v12 offset:64
ds_read_b64_tr_b16 v[66:67],v12 offset:832
ds_read_b64_tr_b16 v[68:69],v12 offset:6208
ds_read_b64_tr_b16 v[70:71],v12 offset:6976
s_branch ld_62
lw_64:
ds_read_b64_tr_b16 a[144:145],v12 offset:0
ds_read_b64_tr_b16 a[146:147],v12 offset:768
ds_read_b64_tr_b16 a[148:149],v12 offset:6144
ds_read_b64_tr_b16 a[150:151],v12 offset:6912
ds_read_b64_tr_b16 a[152:153],v12 offset:32
ds_read_b64_tr_b16 a[154:155],v12 offset:800
ds_read_b64_tr_b16 a[156:157],v12 offset:6176
ds_read_b64_tr_b16 a[158:159],v12 offset:6944
ds_read_b64_tr_b16 v[48:49],v12 offset:64
ds_read_b64_tr_b16 v[50:51],v12 offset:832
ds_read_b64_tr_b16 v[52:53],v12 offset:6208
ds_read_b64_tr_b16 v[54:55],v12 offset:6976
s_branch ld_62
lw_65:
ds_read_b64_tr_b16 a[64:65],v12 offset:0
ds_read_b64_tr_b16 a[66:67],v12 offset:768
ds_read_b64_tr_b16 a[68:69],v12 offset:6144
ds_read_b64_tr_b16 a[70:71],v12 offset:6912
ds_read_b64_tr_b16 a[72:73],v12 offset:32
ds_read_b64_tr_b16 a[74:75],v12 offset:800
ds_read_b64_tr_b16 a[76:77],v12 offset:6176
ds_read_b64_tr_b16 a[78:79],v12 offset:6944
ds_read_b64_tr_b16 v[32:33],v12 offset:64
ds_read_b64_tr_b16 v[34:35],v12 offset:832
ds_read_b64_tr_b16 v[36:37],v12 offset:6208
ds_read_b64_tr_b16 v[38:39],v12 offset:6976
s_branch ld_62
lw_66:
ds_read_b64_tr_b16 v[160:161],v12 offset:0
ds_read_b64_tr_b16 v[162:163],v12 offset:768
ds_read_b64_tr_b16 v[164:165],v12 offset:6144
ds_read_b64_tr_b16 v[166:167],v12 offset:6912
ds_read_b64_tr_b16 v[168:169],v12 offset:32
ds_read_b64_tr_b16 v[170:171],v12 offset:800
ds_read_b64_tr_b16 v[172:173],v12 offset:6176
ds_read_b64_tr_b16 v[174:175],v12 offset:6944
ds_read_b64_tr_b16 v[80:81],v12 offset:64
ds_read_b64_tr_b16 v[82:83],v12 offset:832
ds_read_b64_tr_b16 v[84:85],v12 offset:6208
ds_read_b64_tr_b16 v[86:87],v12 offset:6976
ld_62:
s_waitcnt lgkmcnt(0)
s_waitcnt vmcnt(24)
s_barrier
s_add_u32 s60,s76,s74
s_add_u32 m0,s77,122880
s_add_u32 s61,s60,1572864
buffer_load_dwordx4 v104,s[52:55],s61 offen lds
s_add_u32 m0,s77,123904
s_add_u32 s61,s60,1572864
buffer_load_dwordx4 v105,s[52:55],s61 offen lds
s_add_u32 m0,s77,124928
s_add_u32 s61,s60,1572864
buffer_load_dwordx4 v106,s[52:55],s61 offen lds
s_add_u32 m0,s77,125952
s_add_u32 s61,s60,1671168
buffer_load_dwordx4 v104,s[52:55],s61 offen lds
s_add_u32 m0,s77,126976
s_add_u32 s61,s60,1671168
buffer_load_dwordx4 v105,s[52:55],s61 offen lds
s_add_u32 m0,s77,128000
s_add_u32 s61,s60,1671168
buffer_load_dwordx4 v106,s[52:55],s61 offen lds
v_add_u32 v12,0,v107
s_cmp_eq_u32 s46,1
s_cbranch_scc1 lw_69
s_cmp_eq_u32 s46,2
s_cbranch_scc1 lw_70
s_cmp_eq_u32 s46,3
s_cbranch_scc1 lw_71
lw_68:
ds_read_b64_tr_b16 a[240:241],v12 offset:0
ds_read_b64_tr_b16 a[242:243],v12 offset:768
ds_read_b64_tr_b16 a[244:245],v12 offset:6144
ds_read_b64_tr_b16 a[246:247],v12 offset:6912
ds_read_b64_tr_b16 a[248:249],v12 offset:32
ds_read_b64_tr_b16 a[250:251],v12 offset:800
ds_read_b64_tr_b16 a[252:253],v12 offset:6176
ds_read_b64_tr_b16 a[254:255],v12 offset:6944
ds_read_b64_tr_b16 v[112:113],v12 offset:64
ds_read_b64_tr_b16 v[114:115],v12 offset:832
ds_read_b64_tr_b16 v[116:117],v12 offset:6208
ds_read_b64_tr_b16 v[118:119],v12 offset:6976
s_branch ld_67
lw_69:
ds_read_b64_tr_b16 a[160:161],v12 offset:0
ds_read_b64_tr_b16 a[162:163],v12 offset:768
ds_read_b64_tr_b16 a[164:165],v12 offset:6144
ds_read_b64_tr_b16 a[166:167],v12 offset:6912
ds_read_b64_tr_b16 a[168:169],v12 offset:32
ds_read_b64_tr_b16 a[170:171],v12 offset:800
ds_read_b64_tr_b16 a[172:173],v12 offset:6176
ds_read_b64_tr_b16 a[174:175],v12 offset:6944
ds_read_b64_tr_b16 a[176:177],v12 offset:64
ds_read_b64_tr_b16 a[178:179],v12 offset:832
ds_read_b64_tr_b16 a[180:181],v12 offset:6208
ds_read_b64_tr_b16 a[182:183],v12 offset:6976
s_branch ld_67
lw_70:
ds_read_b64_tr_b16 a[80:81],v12 offset:0
ds_read_b64_tr_b16 a[82:83],v12 offset:768
ds_read_b64_tr_b16 a[84:85],v12 offset:6144
ds_read_b64_tr_b16 a[86:87],v12 offset:6912
ds_read_b64_tr_b16 a[88:89],v12 offset:32
ds_read_b64_tr_b16 a[90:91],v12 offset:800
ds_read_b64_tr_b16 a[92:93],v12 offset:6176
ds_read_b64_tr_b16 a[94:95],v12 offset:6944
ds_read_b64_tr_b16 a[96:97],v12 offset:64
ds_read_b64_tr_b16 a[98:99],v12 offset:832
ds_read_b64_tr_b16 a[100:101],v12 offset:6208
ds_read_b64_tr_b16 a[102:103],v12 offset:6976
s_branch ld_67
lw_71:
ds_read_b64_tr_b16 a[0:1],v12 offset:0
ds_read_b64_tr_b16 a[2:3],v12 offset:768
ds_read_b64_tr_b16 a[4:5],v12 offset:6144
ds_read_b64_tr_b16 a[6:7],v12 offset:6912
ds_read_b64_tr_b16 a[8:9],v12 offset:32
ds_read_b64_tr_b16 a[10:11],v12 offset:800
ds_read_b64_tr_b16 a[12:13],v12 offset:6176
ds_read_b64_tr_b16 a[14:15],v12 offset:6944
ds_read_b64_tr_b16 a[16:17],v12 offset:64
ds_read_b64_tr_b16 a[18:19],v12 offset:832
ds_read_b64_tr_b16 a[20:21],v12 offset:6208
ds_read_b64_tr_b16 a[22:23],v12 offset:6976
ld_67:
s_waitcnt lgkmcnt(0)
s_waitcnt vmcnt(24)
s_barrier
s_add_u32 s60,s76,s73
s_add_u32 m0,s77,0
s_add_u32 s61,s60,5505024
buffer_load_dwordx4 v104,s[4:7],s61 offen lds
s_add_u32 m0,s77,1024
s_add_u32 s61,s60,5505024
buffer_load_dwordx4 v105,s[4:7],s61 offen lds
s_add_u32 m0,s77,2048
s_add_u32 s61,s60,5505024
buffer_load_dwordx4 v106,s[4:7],s61 offen lds
s_add_u32 m0,s77,3072
s_add_u32 s61,s60,5603328
buffer_load_dwordx4 v104,s[4:7],s61 offen lds
s_add_u32 m0,s77,4096
s_add_u32 s61,s60,5603328
buffer_load_dwordx4 v105,s[4:7],s61 offen lds
s_add_u32 m0,s77,5120
s_add_u32 s61,s60,5603328
buffer_load_dwordx4 v106,s[4:7],s61 offen lds
v_add_u32 v12,24576,v107
s_cmp_eq_u32 s46,1
s_cbranch_scc1 lw_74
s_cmp_eq_u32 s46,2
s_cbranch_scc1 lw_75
s_cmp_eq_u32 s46,3
s_cbranch_scc1 lw_76
lw_73:
ds_read_b64_tr_b16 v[120:121],v12 offset:0
ds_read_b64_tr_b16 v[122:123],v12 offset:768
ds_read_b64_tr_b16 v[124:125],v12 offset:6144
ds_read_b64_tr_b16 v[126:127],v12 offset:6912
ds_read_b64_tr_b16 v[128:129],v12 offset:32
ds_read_b64_tr_b16 v[130:131],v12 offset:800
ds_read_b64_tr_b16 v[132:133],v12 offset:6176
ds_read_b64_tr_b16 v[134:135],v12 offset:6944
ds_read_b64_tr_b16 v[72:73],v12 offset:64
ds_read_b64_tr_b16 v[74:75],v12 offset:832
ds_read_b64_tr_b16 v[76:77],v12 offset:6208
ds_read_b64_tr_b16 v[78:79],v12 offset:6976
s_branch ld_72
lw_74:
ds_read_b64_tr_b16 a[184:185],v12 offset:0
ds_read_b64_tr_b16 a[186:187],v12 offset:768
ds_read_b64_tr_b16 a[188:189],v12 offset:6144
ds_read_b64_tr_b16 a[190:191],v12 offset:6912
ds_read_b64_tr_b16 a[192:193],v12 offset:32
ds_read_b64_tr_b16 a[194:195],v12 offset:800
ds_read_b64_tr_b16 a[196:197],v12 offset:6176
ds_read_b64_tr_b16 a[198:199],v12 offset:6944
ds_read_b64_tr_b16 v[56:57],v12 offset:64
ds_read_b64_tr_b16 v[58:59],v12 offset:832
ds_read_b64_tr_b16 v[60:61],v12 offset:6208
ds_read_b64_tr_b16 v[62:63],v12 offset:6976
s_branch ld_72
lw_75:
ds_read_b64_tr_b16 a[104:105],v12 offset:0
ds_read_b64_tr_b16 a[106:107],v12 offset:768
ds_read_b64_tr_b16 a[108:109],v12 offset:6144
ds_read_b64_tr_b16 a[110:111],v12 offset:6912
ds_read_b64_tr_b16 a[112:113],v12 offset:32
ds_read_b64_tr_b16 a[114:115],v12 offset:800
ds_read_b64_tr_b16 a[116:117],v12 offset:6176
ds_read_b64_tr_b16 a[118:119],v12 offset:6944
ds_read_b64_tr_b16 v[40:41],v12 offset:64
ds_read_b64_tr_b16 v[42:43],v12 offset:832
ds_read_b64_tr_b16 v[44:45],v12 offset:6208
ds_read_b64_tr_b16 v[46:47],v12 offset:6976
s_branch ld_72
lw_76:
ds_read_b64_tr_b16 a[24:25],v12 offset:0
ds_read_b64_tr_b16 a[26:27],v12 offset:768
ds_read_b64_tr_b16 a[28:29],v12 offset:6144
ds_read_b64_tr_b16 a[30:31],v12 offset:6912
ds_read_b64_tr_b16 a[32:33],v12 offset:32
ds_read_b64_tr_b16 a[34:35],v12 offset:800
ds_read_b64_tr_b16 a[36:37],v12 offset:6176
ds_read_b64_tr_b16 a[38:39],v12 offset:6944
ds_read_b64_tr_b16 v[24:25],v12 offset:64
ds_read_b64_tr_b16 v[26:27],v12 offset:832
ds_read_b64_tr_b16 v[28:29],v12 offset:6208
ds_read_b64_tr_b16 v[30:31],v12 offset:6976
ld_72:
s_waitcnt lgkmcnt(0)
s_waitcnt vmcnt(24)
s_barrier
s_add_u32 s60,s76,s74
s_add_u32 m0,s77,24576
s_add_u32 s61,s60,5505024
buffer_load_dwordx4 v104,s[52:55],s61 offen lds
s_add_u32 m0,s77,25600
s_add_u32 s61,s60,5505024
buffer_load_dwordx4 v105,s[52:55],s61 offen lds
s_add_u32 m0,s77,26624
s_add_u32 s61,s60,5505024
buffer_load_dwordx4 v106,s[52:55],s61 offen lds
s_add_u32 m0,s77,27648
s_add_u32 s61,s60,5603328
buffer_load_dwordx4 v104,s[52:55],s61 offen lds
s_add_u32 m0,s77,28672
s_add_u32 s61,s60,5603328
buffer_load_dwordx4 v105,s[52:55],s61 offen lds
s_add_u32 m0,s77,29696
s_add_u32 s61,s60,5603328
buffer_load_dwordx4 v106,s[52:55],s61 offen lds
v_add_u32 v12,49152,v107
s_cmp_eq_u32 s46,1
s_cbranch_scc1 lw_79
s_cmp_eq_u32 s46,2
s_cbranch_scc1 lw_80
s_cmp_eq_u32 s46,3
s_cbranch_scc1 lw_81
lw_78:
ds_read_b64_tr_b16 v[136:137],v12 offset:0
ds_read_b64_tr_b16 v[138:139],v12 offset:768
ds_read_b64_tr_b16 v[140:141],v12 offset:6144
ds_read_b64_tr_b16 v[142:143],v12 offset:6912
ds_read_b64_tr_b16 v[144:145],v12 offset:32
ds_read_b64_tr_b16 v[146:147],v12 offset:800
ds_read_b64_tr_b16 v[148:149],v12 offset:6176
ds_read_b64_tr_b16 v[150:151],v12 offset:6944
ds_read_b64_tr_b16 v[152:153],v12 offset:64
ds_read_b64_tr_b16 v[154:155],v12 offset:832
ds_read_b64_tr_b16 v[156:157],v12 offset:6208
ds_read_b64_tr_b16 v[158:159],v12 offset:6976
s_branch ld_77
lw_79:
ds_read_b64_tr_b16 a[200:201],v12 offset:0
ds_read_b64_tr_b16 a[202:203],v12 offset:768
ds_read_b64_tr_b16 a[204:205],v12 offset:6144
ds_read_b64_tr_b16 a[206:207],v12 offset:6912
ds_read_b64_tr_b16 a[208:209],v12 offset:32
ds_read_b64_tr_b16 a[210:211],v12 offset:800
ds_read_b64_tr_b16 a[212:213],v12 offset:6176
ds_read_b64_tr_b16 a[214:215],v12 offset:6944
ds_read_b64_tr_b16 a[216:217],v12 offset:64
ds_read_b64_tr_b16 a[218:219],v12 offset:832
ds_read_b64_tr_b16 a[220:221],v12 offset:6208
ds_read_b64_tr_b16 a[222:223],v12 offset:6976
s_branch ld_77
lw_80:
ds_read_b64_tr_b16 a[120:121],v12 offset:0
ds_read_b64_tr_b16 a[122:123],v12 offset:768
ds_read_b64_tr_b16 a[124:125],v12 offset:6144
ds_read_b64_tr_b16 a[126:127],v12 offset:6912
ds_read_b64_tr_b16 a[128:129],v12 offset:32
ds_read_b64_tr_b16 a[130:131],v12 offset:800
ds_read_b64_tr_b16 a[132:133],v12 offset:6176
ds_read_b64_tr_b16 a[134:135],v12 offset:6944
ds_read_b64_tr_b16 a[136:137],v12 offset:64
ds_read_b64_tr_b16 a[138:139],v12 offset:832
ds_read_b64_tr_b16 a[140:141],v12 offset:6208
ds_read_b64_tr_b16 a[142:143],v12 offset:6976
s_branch ld_77
lw_81:
ds_read_b64_tr_b16 a[40:41],v12 offset:0
ds_read_b64_tr_b16 a[42:43],v12 offset:768
ds_read_b64_tr_b16 a[44:45],v12 offset:6144
ds_read_b64_tr_b16 a[46:47],v12 offset:6912
ds_read_b64_tr_b16 a[48:49],v12 offset:32
ds_read_b64_tr_b16 a[50:51],v12 offset:800
ds_read_b64_tr_b16 a[52:53],v12 offset:6176
ds_read_b64_tr_b16 a[54:55],v12 offset:6944
ds_read_b64_tr_b16 a[56:57],v12 offset:64
ds_read_b64_tr_b16 a[58:59],v12 offset:832
ds_read_b64_tr_b16 a[60:61],v12 offset:6208
ds_read_b64_tr_b16 a[62:63],v12 offset:6976
ld_77:
s_waitcnt lgkmcnt(0)
s_waitcnt vmcnt(24)
s_barrier
v_add_u32 v12,73728,v107
s_cmp_eq_u32 s46,1
s_cbranch_scc1 lw_84
s_cmp_eq_u32 s46,2
s_cbranch_scc1 lw_85
s_cmp_eq_u32 s46,3
s_cbranch_scc1 lw_86
lw_83:
ds_read_b64_tr_b16 v[160:161],v12 offset:0
ds_read_b64_tr_b16 v[162:163],v12 offset:768
ds_read_b64_tr_b16 v[164:165],v12 offset:6144
ds_read_b64_tr_b16 v[166:167],v12 offset:6912
ds_read_b64_tr_b16 v[168:169],v12 offset:32
ds_read_b64_tr_b16 v[170:171],v12 offset:800
ds_read_b64_tr_b16 v[172:173],v12 offset:6176
ds_read_b64_tr_b16 v[174:175],v12 offset:6944
ds_read_b64_tr_b16 v[80:81],v12 offset:64
ds_read_b64_tr_b16 v[82:83],v12 offset:832
ds_read_b64_tr_b16 v[84:85],v12 offset:6208
ds_read_b64_tr_b16 v[86:87],v12 offset:6976
s_branch ld_82
lw_84:
ds_read_b64_tr_b16 a[224:225],v12 offset:0
ds_read_b64_tr_b16 a[226:227],v12 offset:768
ds_read_b64_tr_b16 a[228:229],v12 offset:6144
ds_read_b64_tr_b16 a[230:231],v12 offset:6912
ds_read_b64_tr_b16 a[232:233],v12 offset:32
ds_read_b64_tr_b16 a[234:235],v12 offset:800
ds_read_b64_tr_b16 a[236:237],v12 offset:6176
ds_read_b64_tr_b16 a[238:239],v12 offset:6944
ds_read_b64_tr_b16 v[64:65],v12 offset:64
ds_read_b64_tr_b16 v[66:67],v12 offset:832
ds_read_b64_tr_b16 v[68:69],v12 offset:6208
ds_read_b64_tr_b16 v[70:71],v12 offset:6976
s_branch ld_82
lw_85:
ds_read_b64_tr_b16 a[144:145],v12 offset:0
ds_read_b64_tr_b16 a[146:147],v12 offset:768
ds_read_b64_tr_b16 a[148:149],v12 offset:6144
ds_read_b64_tr_b16 a[150:151],v12 offset:6912
ds_read_b64_tr_b16 a[152:153],v12 offset:32
ds_read_b64_tr_b16 a[154:155],v12 offset:800
ds_read_b64_tr_b16 a[156:157],v12 offset:6176
ds_read_b64_tr_b16 a[158:159],v12 offset:6944
ds_read_b64_tr_b16 v[48:49],v12 offset:64
ds_read_b64_tr_b16 v[50:51],v12 offset:832
ds_read_b64_tr_b16 v[52:53],v12 offset:6208
ds_read_b64_tr_b16 v[54:55],v12 offset:6976
s_branch ld_82
lw_86:
ds_read_b64_tr_b16 a[64:65],v12 offset:0
ds_read_b64_tr_b16 a[66:67],v12 offset:768
ds_read_b64_tr_b16 a[68:69],v12 offset:6144
ds_read_b64_tr_b16 a[70:71],v12 offset:6912
ds_read_b64_tr_b16 a[72:73],v12 offset:32
ds_read_b64_tr_b16 a[74:75],v12 offset:800
ds_read_b64_tr_b16 a[76:77],v12 offset:6176
ds_read_b64_tr_b16 a[78:79],v12 offset:6944
ds_read_b64_tr_b16 v[32:33],v12 offset:64
ds_read_b64_tr_b16 v[34:35],v12 offset:832
ds_read_b64_tr_b16 v[36:37],v12 offset:6208
ds_read_b64_tr_b16 v[38:39],v12 offset:6976
ld_82:
s_waitcnt lgkmcnt(0)
s_waitcnt vmcnt(18)
s_barrier
v_add_u32 v12,98304,v107
ds_read_b64_tr_b16 v[176:177],v12 offset:0
ds_read_b64_tr_b16 v[178:179],v12 offset:768
ds_read_b64_tr_b16 v[180:181],v12 offset:6144
ds_read_b64_tr_b16 v[182:183],v12 offset:6912
ds_read_b64_tr_b16 v[184:185],v12 offset:32
ds_read_b64_tr_b16 v[186:187],v12 offset:800
ds_read_b64_tr_b16 v[188:189],v12 offset:6176
ds_read_b64_tr_b16 v[190:191],v12 offset:6944
ds_read_b64_tr_b16 v[192:193],v12 offset:64
ds_read_b64_tr_b16 v[194:195],v12 offset:832
ds_read_b64_tr_b16 v[196:197],v12 offset:6208
ds_read_b64_tr_b16 v[198:199],v12 offset:6976
s_waitcnt lgkmcnt(0)
s_waitcnt vmcnt(12)
s_barrier
v_add_u32 v12,122880,v107
ds_read_b64_tr_b16 v[200:201],v12 offset:0
ds_read_b64_tr_b16 v[202:203],v12 offset:768
ds_read_b64_tr_b16 v[204:205],v12 offset:6144
ds_read_b64_tr_b16 v[206:207],v12 offset:6912
ds_read_b64_tr_b16 v[208:209],v12 offset:32
ds_read_b64_tr_b16 v[210:211],v12 offset:800
ds_read_b64_tr_b16 v[212:213],v12 offset:6176
ds_read_b64_tr_b16 v[214:215],v12 offset:6944
ds_read_b64_tr_b16 v[88:89],v12 offset:64
ds_read_b64_tr_b16 v[90:91],v12 offset:832
ds_read_b64_tr_b16 v[92:93],v12 offset:6208
ds_read_b64_tr_b16 v[94:95],v12 offset:6976
s_waitcnt lgkmcnt(0)
s_waitcnt vmcnt(6)
s_barrier
v_add_u32 v12,0,v107
ds_read_b64_tr_b16 v[216:217],v12 offset:0
ds_read_b64_tr_b16 v[218:219],v12 offset:768
ds_read_b64_tr_b16 v[220:221],v12 offset:6144
ds_read_b64_tr_b16 v[222:223],v12 offset:6912
ds_read_b64_tr_b16 v[224:225],v12 offset:32
ds_read_b64_tr_b16 v[226:227],v12 offset:800
ds_read_b64_tr_b16 v[228:229],v12 offset:6176
ds_read_b64_tr_b16 v[230:231],v12 offset:6944
ds_read_b64_tr_b16 v[232:233],v12 offset:64
ds_read_b64_tr_b16 v[234:235],v12 offset:832
ds_read_b64_tr_b16 v[236:237],v12 offset:6208
ds_read_b64_tr_b16 v[238:239],v12 offset:6976
s_waitcnt lgkmcnt(0)
s_waitcnt vmcnt(0)
s_barrier
v_add_u32 v12,24576,v107
ds_read_b64_tr_b16 v[240:241],v12 offset:0
ds_read_b64_tr_b16 v[242:243],v12 offset:768
ds_read_b64_tr_b16 v[244:245],v12 offset:6144
ds_read_b64_tr_b16 v[246:247],v12 offset:6912
ds_read_b64_tr_b16 v[248:249],v12 offset:32
ds_read_b64_tr_b16 v[250:251],v12 offset:800
ds_read_b64_tr_b16 v[252:253],v12 offset:6176
ds_read_b64_tr_b16 v[254:255],v12 offset:6944
ds_read_b64_tr_b16 v[96:97],v12 offset:64
ds_read_b64_tr_b16 v[98:99],v12 offset:832
ds_read_b64_tr_b16 v[100:101],v12 offset:6208
ds_read_b64_tr_b16 v[102:103],v12 offset:6976
s_waitcnt lgkmcnt(0)
s_barrier
ds_write_b128 v21,v[24:27] offset:0
ds_write_b128 v21,v[28:31] offset:1024
ds_write_b128 v21,v[32:35] offset:2048
ds_write_b128 v21,v[36:39] offset:3072
ds_write_b128 v21,v[40:43] offset:4096
ds_write_b128 v21,v[44:47] offset:5120
ds_write_b128 v21,v[48:51] offset:6144
ds_write_b128 v21,v[52:55] offset:7168
ds_write_b128 v21,v[56:59] offset:8192
ds_write_b128 v21,v[60:63] offset:9216
ds_write_b128 v21,v[64:67] offset:10240
ds_write_b128 v21,v[68:71] offset:11264
ds_write_b128 v21,v[72:75] offset:12288
ds_write_b128 v21,v[76:79] offset:13312
ds_write_b128 v21,v[80:83] offset:14336
ds_write_b128 v21,v[84:87] offset:15360
ds_write_b128 v21,v[88:91] offset:16384
ds_write_b128 v21,v[92:95] offset:17408
ds_write_b128 v21,v[96:99] offset:18432
ds_write_b128 v21,v[100:103] offset:19456
s_waitcnt lgkmcnt(0)
v_add_u32 v59,139264,v1
s_barrier
s_lshl_b32 s3,s49,2
v_mov_b32 v13,s3
s_nop 1
ibw_87:
buffer_load_dword v12,v13,s[12:15],0 offen sc1
s_waitcnt vmcnt(0)
v_cmp_ne_u32 vcc,256,v12
s_nop 0
s_cbranch_vccz ok_88
s_sleep 8
s_sub_u32 s47,s47,1
s_cbranch_scc1 ABORT
s_branch ibw_87
ok_88:
s_cmp_lg_u32 s49,0
s_cbranch_scc1 ibok_89
v_and_b32 v13,7,v0
v_lshlrev_b32 v13,2,v13
buffer_load_dword v12,v13,s[12:15],0 offen offset:32 sc1
s_waitcnt vmcnt(0)
v_cmp_ne_u32 vcc,32,v12
s_nop 0
s_cbranch_vccz ibok_89
s_barrier
s_mov_b32 s49,1
s_mov_b32 s3,s2
s_load_dwordx16 s[16:31],s[0:1],0
s_load_dwordx8 s[32:39],s[0:1],64
s_waitcnt lgkmcnt(0)
s_branch DISPATCH
ibok_89:
v_mov_b32 v13,192
buffer_load_dword v12,v13,s[12:15],0 offen sc1
s_waitcnt vmcnt(0)
v_readfirstlane_b32 s60,v12
s_cmp_gt_i32 s60,0
s_cselect_b32 s60,0x2000,0
s_add_u32 s83,s83,s60
s_mul_i32 s6,s46,5120
s_add_u32 s6,s6,s82
s_mov_b32 s7,0
s_add_u32 s7,s7,s82
s_add_u32 s7,s7,950272
v_add_u32 v18,4096,v1
s_mov_b32 s50,0
s_mov_b32 s4,0
s_mov_b32 s5,0
s_mov_b32 s78,-1
s_mov_b32 s79,-1
s_mov_b32 s30,-1
s_sub_u32 s60,s4,s5
s_cmp_gt_i32 s60,14
s_cselect_b32 s51,1,0
s_cmp_eq_u32 s4,64
s_cselect_b32 s51,1,s51
s_cmp_eq_u32 s51,0
s_cselect_b32 s52,s4,s5
s_addc_u32 s4,s4,0
s_add_u32 s5,s5,s51
s_and_b32 s60,s52,3
s_lshl2_add_u32 s60,s51,s60
s_lshl_b32 s68,s60,16
s_add_u32 s68,s68,s83
s_mul_i32 s59,s60,20480
s_add_u32 s59,s59,s6
s_lshl_b32 s69,s51,9
s_add_u32 s69,s69,s7
s_bfe_u32 s57,s52,0x10002
s_add_u32 s58,s52,1
s_cmp_lg_u32 s36,0
s_cbranch_scc1 CV_START
s_cmp_eq_u32 s46,3
s_cbranch_scc1 CH_START
s_lshl_b32 s60,s46,2
s_add_u32 s60,s60,147456
v_mov_b32 v20,s60
v_mov_b32 v12,0
ds_write_b32 v20,v12
v_add_u32 v58,106496,v1
v_mov_b32 v9,147468
s_lshl_b32 s85,s46,12
s_add_u32 s84,s84,s85
s_add_u32 s74,s85,81920
s_add_u32 s75,s74,s74
s_add_u32 s75,s75,24576
s_mov_b64 vcc,-1
s_waitcnt lgkmcnt(0)
s_cmp_lg_u32 s49,0
s_cbranch_scc1 CS_LOOP_S
CS_LOOP_F:
s_barrier
buffer_load_dwordx4 v[76:79],v18,s[8:11],s59 offen sc1
buffer_load_dwordx4 v[60:63],v1,s[8:11],s59 offen sc1
buffer_load_dwordx4 v[64:67],v1,s[8:11],s59 offen offset:1024 sc1
buffer_load_dwordx4 v[68:71],v1,s[8:11],s59 offen offset:2048 sc1
buffer_load_dwordx4 v[72:75],v1,s[8:11],s59 offen offset:3072 sc1
s_cbranch_vccz CS_FAST_F
v_mov_b32 v24,0
v_mov_b32 v25,0
v_mov_b32 v26,0
v_mov_b32 v27,0
v_mov_b32 v28,0
v_mov_b32 v29,0
v_mov_b32 v30,0
v_mov_b32 v31,0
v_mov_b32 v32,0
v_mov_b32 v33,0
v_mov_b32 v34,0
v_mov_b32 v35,0
v_mov_b32 v36,0
v_mov_b32 v37,0
v_mov_b32 v38,0
v_mov_b32 v39,0
v_mov_b32 v40,0
v_mov_b32 v41,0
v_mov_b32 v42,0
v_mov_b32 v43,0
v_mov_b32 v44,0
v_mov_b32 v45,0
v_mov_b32 v46,0
v_mov_b32 v47,0
s_waitcnt vmcnt(4)
buffer_load_dwordx4 v[96:99],v18,s[8:11],s68 offen sc1
buffer_load_dwordx4 v[80:83],v1,s[8:11],s68 offen sc1
buffer_load_dwordx4 v[84:87],v1,s[8:11],s68 offen offset:1024 sc1
buffer_load_dwordx4 v[88:91],v1,s[8:11],s68 offen offset:2048 sc1
buffer_load_dwordx4 v[92:95],v1,s[8:11],s68 offen offset:3072 sc1
fj_92:
fa_90:
s_waitcnt vmcnt(4)
v_pk_add_f32 v[12:13],v[76:77],v[96:97]
v_pk_add_f32 v[14:15],v[78:79],v[98:99]
v_bitop3_b32 v16,v76,v96,s57 bitop3:0x7e
v_cvt_pk_bf16_f32 v56,v12,v13
v_cvt_pk_bf16_f32 v57,v14,v15
ds_write_b64 v23,v[56:57]
s_waitcnt vmcnt(3)
v_pk_add_f32 v[12:13],v[60:61],v[80:81]
v_pk_add_f32 v[14:15],v[62:63],v[82:83]
v_bitop3_b32 v17,v60,v80,s57 bitop3:0x7e
v_cvt_pk_bf16_f32 v48,v12,v13
v_cvt_pk_bf16_f32 v49,v14,v15
v_or_b32 v16,v16,v17
s_waitcnt vmcnt(2)
v_pk_add_f32 v[12:13],v[64:65],v[84:85]
v_pk_add_f32 v[14:15],v[66:67],v[86:87]
v_bitop3_b32 v17,v64,v84,s57 bitop3:0x7e
v_cvt_pk_bf16_f32 v50,v12,v13
v_cvt_pk_bf16_f32 v51,v14,v15
v_or_b32 v16,v16,v17
ds_write_b128 v22,v[48:51] offset:0
s_waitcnt vmcnt(1)
v_pk_add_f32 v[12:13],v[68:69],v[88:89]
v_pk_add_f32 v[14:15],v[70:71],v[90:91]
v_bitop3_b32 v17,v68,v88,s57 bitop3:0x7e
v_cvt_pk_bf16_f32 v52,v12,v13
v_cvt_pk_bf16_f32 v53,v14,v15
v_or_b32 v16,v16,v17
s_waitcnt vmcnt(0)
v_pk_add_f32 v[12:13],v[72:73],v[92:93]
v_pk_add_f32 v[14:15],v[74:75],v[94:95]
v_bitop3_b32 v17,v72,v92,s57 bitop3:0x7e
v_cvt_pk_bf16_f32 v54,v12,v13
v_cvt_pk_bf16_f32 v55,v14,v15
v_bitop3_b32 v16,v16,v17,1 bitop3:0xa8
v_cmp_ne_u32 vcc,0,v16
ds_write_b128 v22,v[52:55] offset:1024
s_cbranch_vccnz fr_91
v_smfmac_f32_16x16x64_bf16 v[24:27],v[48:51],a[0:7],v2
ds_read_b128 v[72:75],v21 offset:0
v_xor_b32 v58,57344,v58
v_smfmac_f32_16x16x64_bf16 v[28:31],v[48:51],a[8:15],v2
ds_read_b128 v[76:79],v21 offset:1024
s_sub_u32 s60,s4,s5
v_smfmac_f32_16x16x64_bf16 v[32:35],v[48:51],a[16:23],v2
ds_read_b128 v[80:83],v21 offset:2048
v_smfmac_f32_16x16x64_bf16 v[36:39],v[48:51],a[24:31],v2
ds_read_b128 v[84:87],v21 offset:3072
s_waitcnt lgkmcnt(4)
s_barrier
v_smfmac_f32_16x16x64_bf16 v[40:43],v[48:51],a[32:39],v2
ds_read_b128 v[60:63],v3 offset:0
v_smfmac_f32_16x16x64_bf16 v[24:27],v[52:55],a[40:47],v2
ds_read_b128 v[64:67],v3 offset:1024
v_smfmac_f32_16x16x64_bf16 v[28:31],v[52:55],a[48:55],v2
ds_read_b128 v[68:71],v4 offset:0
v_smfmac_f32_16x16x64_bf16 v[32:35],v[52:55],a[56:63],v2
s_cmp_gt_i32 s60,14
s_cselect_b32 s53,1,0
v_smfmac_f32_16x16x64_bf16 v[36:39],v[52:55],a[64:71],v2
s_cmp_eq_u32 s4,64
s_cselect_b32 s53,1,s53
v_smfmac_f32_16x16x64_bf16 v[40:43],v[52:55],a[72:79],v2
s_waitcnt lgkmcnt(5)
v_smfmac_f32_16x16x64_bf16 v[44:47],v[48:51],v[72:79],v2
ds_read_b128 v[72:75],v21 offset:4096
s_waitcnt lgkmcnt(4)
v_smfmac_f32_16x16x64_bf16 v[44:47],v[52:55],v[80:87],v2
ds_read_b128 v[76:79],v21 offset:5120
s_waitcnt lgkmcnt(4)
v_smfmac_f32_16x16x64_bf16 v[24:27],v[60:63],a[80:87],v2
ds_read_b128 v[80:83],v21 offset:6144
v_smfmac_f32_16x16x64_bf16 v[28:31],v[60:63],a[88:95],v2
ds_read_b128 v[84:87],v21 offset:7168
v_smfmac_f32_16x16x64_bf16 v[32:35],v[60:63],a[96:103],v2
s_cmp_eq_u32 s53,0
s_cselect_b32 s54,s4,s5
s_addc_u32 s4,s4,0
v_smfmac_f32_16x16x64_bf16 v[36:39],v[60:63],a[104:111],v2
s_add_u32 s5,s5,s53
s_mul_i32 s73,s54,393216
s_add_u32 s73,s73,s84
v_smfmac_f32_16x16x64_bf16 v[40:43],v[60:63],a[112:119],v2
s_sub_u32 s74,s75,s74
s_mov_b32 m0,s74
s_waitcnt lgkmcnt(2)
v_smfmac_f32_16x16x64_bf16 v[44:47],v[60:63],v[72:79],v2
ds_read_b128 v[60:63],v4 offset:1024
s_and_b32 s60,s52,3
v_smfmac_f32_16x16x64_bf16 v[24:27],v[64:67],a[120:127],v2
ds_read_b128 v[72:75],v21 offset:8192
s_lshl2_add_u32 s60,s51,s60
v_smfmac_f32_16x16x64_bf16 v[28:31],v[64:67],a[128:135],v2
ds_read_b128 v[76:79],v21 offset:9216
s_mul_i32 s60,s60,49152
v_smfmac_f32_16x16x64_bf16 v[32:35],v[64:67],a[136:143],v2
s_add_u32 s71,s60,s34
s_add_u32 s70,s60,s33
s_lshl_b32 s60,s51,9
v_smfmac_f32_16x16x64_bf16 v[36:39],v[64:67],a[144:151],v2
s_add_u32 s72,s60,s35
buffer_load_dwordx4 v1,s[8:11],s73 offen nt sc1 lds
v_smfmac_f32_16x16x64_bf16 v[40:43],v[64:67],a[152:159],v2
buffer_load_dwordx4 v1,s[8:11],s73 offen offset:1024 nt sc1 lds
s_waitcnt lgkmcnt(3)
v_smfmac_f32_16x16x64_bf16 v[44:47],v[64:67],v[80:87],v2
ds_read_b128 v[64:67],v5 offset:0
v_smfmac_f32_16x16x64_bf16 v[24:27],v[68:71],a[160:167],v2
ds_read_b128 v[80:83],v21 offset:10240
v_smfmac_f32_16x16x64_bf16 v[28:31],v[68:71],a[168:175],v2
ds_read_b128 v[84:87],v21 offset:11264
v_smfmac_f32_16x16x64_bf16 v[32:35],v[68:71],a[176:183],v2
buffer_load_dwordx4 v1,s[8:11],s73 offen offset:2048 nt sc1 lds
v_smfmac_f32_16x16x64_bf16 v[36:39],v[68:71],a[184:191],v2
buffer_load_dwordx4 v1,s[8:11],s73 offen offset:3072 nt sc1 lds
s_and_b32 s60,s54,3
v_smfmac_f32_16x16x64_bf16 v[40:43],v[68:71],a[192:199],v2
s_lshl2_add_u32 s60,s53,s60
s_lshl_b32 s68,s60,16
s_waitcnt lgkmcnt(3)
v_smfmac_f32_16x16x64_bf16 v[44:47],v[68:71],v[72:79],v2
ds_read_b128 v[68:71],v5 offset:1024
s_add_u32 s68,s68,s83
v_smfmac_f32_16x16x64_bf16 v[24:27],v[60:63],a[200:207],v2
ds_read_b128 v[72:75],v21 offset:12288
s_mul_i32 s59,s60,20480
v_smfmac_f32_16x16x64_bf16 v[28:31],v[60:63],a[208:215],v2
ds_read_b128 v[76:79],v21 offset:13312
s_add_u32 s59,s59,s6
v_smfmac_f32_16x16x64_bf16 v[32:35],v[60:63],a[216:223],v2
s_lshl_b32 s69,s53,9
s_add_u32 s69,s69,s7
s_bfe_u32 s31,s54,0x10002
v_smfmac_f32_16x16x64_bf16 v[36:39],v[60:63],a[224:231],v2
s_add_u32 s32,s54,1
v_add_u32 v17,s85,v58
v_smfmac_f32_16x16x64_bf16 v[40:43],v[60:63],a[232:239],v2
v_mov_b32 v16,s58
s_waitcnt lgkmcnt(3)
v_smfmac_f32_16x16x64_bf16 v[44:47],v[60:63],v[80:87],v2
ds_read_b128 v[60:63],v59 offset:0
v_mov_b32 v15,0
v_smfmac_f32_16x16x64_bf16 v[24:27],v[64:67],a[240:247],v2
ds_read_b128 v[80:83],v21 offset:14336
v_smfmac_f32_16x16x64_bf16 v[28:31],v[64:67],a[248:255],v2
ds_read_b128 v[84:87],v21 offset:15360
v_smfmac_f32_16x16x64_bf16 v[32:35],v[64:67],v[112:119],v2
ds_read_b128 v[88:91],v58 offset:0
v_smfmac_f32_16x16x64_bf16 v[36:39],v[64:67],v[120:127],v2
ds_read_b128 v[92:95],v58 offset:1024
v_smfmac_f32_16x16x64_bf16 v[40:43],v[64:67],v[128:135],v2
ds_read_b128 v[96:99],v58 offset:2048
s_waitcnt lgkmcnt(6)
v_smfmac_f32_16x16x64_bf16 v[44:47],v[64:67],v[72:79],v2
ds_read_b128 v[64:67],v59 offset:1024
v_smfmac_f32_16x16x64_bf16 v[24:27],v[68:71],v[136:143],v2
ds_read_b128 v[72:75],v21 offset:16384
v_smfmac_f32_16x16x64_bf16 v[28:31],v[68:71],v[144:151],v2
ds_read_b128 v[76:79],v21 offset:17408
v_smfmac_f32_16x16x64_bf16 v[32:35],v[68:71],v[152:159],v2
ds_read_b128 v[100:103],v58 offset:3072
v_smfmac_f32_16x16x64_bf16 v[36:39],v[68:71],v[160:167],v2
ds_read_b128 v[104:107],v58 offset:4096
v_smfmac_f32_16x16x64_bf16 v[40:43],v[68:71],v[168:175],v2
ds_read_b128 v[108:111],v58 offset:5120
s_waitcnt lgkmcnt(9)
v_smfmac_f32_16x16x64_bf16 v[44:47],v[68:71],v[80:87],v2
ds_read_b128 v[80:83],v21 offset:18432
v_smfmac_f32_16x16x64_bf16 v[24:27],v[60:63],v[176:183],v2
ds_read_b128 v[84:87],v21 offset:19456
v_smfmac_f32_16x16x64_bf16 v[36:39],v[60:63],v[200:207],v2
ds_read_b128 v[48:51],v58 offset:6144
s_waitcnt lgkmcnt(8)
v_smfmac_f32_16x16x64_bf16 v[24:27],v[64:67],v[216:223],v2
ds_read_b128 v[52:55],v58 offset:7168
v_smfmac_f32_16x16x64_bf16 v[36:39],v[64:67],v[240:247],v2
v_smfmac_f32_16x16x64_bf16 v[28:31],v[60:63],v[184:191],v2
v_smfmac_f32_16x16x64_bf16 v[40:43],v[60:63],v[208:215],v2
s_nop 3
v_add_f32 v24,v24,v25
v_smfmac_f32_16x16x64_bf16 v[28:31],v[64:67],v[224:231],v2
v_add_f32 v26,v26,v27
v_smfmac_f32_16x16x64_bf16 v[40:43],v[64:67],v[248:255],v2
v_add_f32 v36,v36,v37
v_smfmac_f32_16x16x64_bf16 v[32:35],v[60:63],v[192:199],v2
v_add_f32 v38,v38,v39
s_waitcnt lgkmcnt(7)
v_smfmac_f32_16x16x64_bf16 v[44:47],v[60:63],v[72:79],v2
v_cvt_pk_bf16_f32 v37,v24,v26
v_smfmac_f32_16x16x64_bf16 v[32:35],v[64:67],v[232:239],v2
v_cvt_pk_bf16_f32 v36,v36,v38
s_waitcnt lgkmcnt(2)
v_smfmac_f32_16x16x64_bf16 v[44:47],v[64:67],v[80:87],v2
ds_write_b64 v6,v[36:37] offset:0
v_add_f32 v28,v28,v29
v_add_f32 v30,v30,v31
v_add_f32 v40,v40,v41
v_add_f32 v42,v42,v43
v_cvt_pk_bf16_f32 v41,v28,v30
v_cvt_pk_bf16_f32 v40,v40,v42
ds_write_b64 v6,v[40:41] offset:512
v_add_f32 v32,v32,v33
v_add_f32 v34,v34,v35
v_add_f32 v44,v44,v45
v_add_f32 v46,v46,v47
v_cvt_pk_bf16_f32 v45,v32,v34
v_cvt_pk_bf16_f32 v44,v44,v46
ds_write_b64 v6,v[44:45] offset:1024
s_cmp_eq_u32 s52,63
s_cbranch_scc1 last_93
ds_read_b128 v[72:75],v58 offset:8192
ds_read_b128 v[76:79],v58 offset:9216
s_waitcnt lgkmcnt(2)
s_barrier
ds_read_b64_tr_b16 v[24:25],v7 offset:0
ds_read_b64_tr_b16 v[26:27],v7 offset:512
ds_read_b64_tr_b16 v[28:29],v7 offset:1024
ds_read_b64_tr_b16 v[30:31],v7 offset:1536
ds_read_b64_tr_b16 v[32:33],v7 offset:2048
ds_read_b64_tr_b16 v[34:35],v7 offset:2560
ds_read_b64_tr_b16 v[36:37],v7 offset:3072
ds_read_b64_tr_b16 v[38:39],v7 offset:3584
s_waitcnt lgkmcnt(6)
v_mfma_f32_16x16x32_bf16 v[60:63],v[88:91],v[24:27],0
ds_read_b64_tr_b16 v[40:41],v7 offset:4096
s_mov_b64 vcc,s[88:89]
v_mfma_f32_16x16x32_bf16 v[64:67],v[92:95],v[24:27],0
ds_read_b64_tr_b16 v[42:43],v7 offset:4608
v_mfma_f32_16x16x32_bf16 v[68:71],v[24:27],v[24:27],0
ds_read_b128 v[80:83],v58 offset:10240
s_waitcnt lgkmcnt(7)
v_mfma_f32_16x16x32_bf16 v[60:63],v[96:99],v[28:31],v[60:63]
ds_read_b128 v[84:87],v58 offset:11264
v_mfma_f32_16x16x32_bf16 v[64:67],v[100:103],v[28:31],v[64:67]
ds_read_b64_tr_b16 v[44:45],v7 offset:5120
v_mfma_f32_16x16x32_bf16 v[68:71],v[28:31],v[28:31],v[68:71]
ds_read_b64_tr_b16 v[46:47],v7 offset:5632
s_waitcnt lgkmcnt(8)
v_mfma_f32_16x16x32_bf16 v[60:63],v[104:107],v[32:35],v[60:63]
ds_read_b128 v[88:91],v17 offset:12288
v_mfma_f32_16x16x32_bf16 v[64:67],v[108:111],v[32:35],v[64:67]
ds_read_b128 v[92:95],v17 offset:13312
v_mfma_f32_16x16x32_bf16 v[68:71],v[32:35],v[32:35],v[68:71]
ds_read_b128 v[96:99],v17 offset:14336
s_waitcnt lgkmcnt(9)
v_mfma_f32_16x16x32_bf16 v[60:63],v[48:51],v[36:39],v[60:63]
ds_read_b128 v[100:103],v17 offset:15360
v_mfma_f32_16x16x32_bf16 v[64:67],v[52:55],v[36:39],v[64:67]
v_mfma_f32_16x16x32_bf16 v[68:71],v[36:39],v[36:39],v[68:71]
s_waitcnt lgkmcnt(8)
v_mfma_f32_16x16x32_bf16 v[60:63],v[72:75],v[40:43],v[60:63]
v_mfma_f32_16x16x32_bf16 v[64:67],v[76:79],v[40:43],v[64:67]
v_mfma_f32_16x16x32_bf16 v[68:71],v[40:43],v[40:43],v[68:71]
s_waitcnt lgkmcnt(4)
v_mfma_f32_16x16x32_bf16 v[60:63],v[80:83],v[44:47],v[60:63]
v_mfma_f32_16x16x32_bf16 v[64:67],v[84:87],v[44:47],v[64:67]
buffer_load_dwordx4 v[104:107],v1,s[8:11],s71 offen sc1
v_mfma_f32_16x16x32_bf16 v[68:71],v[44:47],v[44:47],v[68:71]
s_nop 5
v_cndmask_b32_dpp v60,v64,v60,vcc quad_perm:[2,3,2,3] row_mask:0xf bank_mask:0xf
v_cndmask_b32_dpp v61,v65,v61,vcc quad_perm:[2,3,2,3] row_mask:0xf bank_mask:0xf
v_cndmask_b32_dpp v62,v66,v62,vcc quad_perm:[2,3,2,3] row_mask:0xf bank_mask:0xf
v_cndmask_b32_dpp v63,v67,v63,vcc quad_perm:[2,3,2,3] row_mask:0xf bank_mask:0xf
v_max3_f32 v12,v60,v61,v62
v_cndmask_b32_dpp v68,v69,v68,vcc quad_perm:[2,3,2,3] row_mask:0xf bank_mask:0xf
v_max3_f32 v12,v12,v63,v68
s_nop 1
v_max_f32_dpp v13,v12,v12 quad_perm:[2,3,0,1] row_mask:0xf bank_mask:0xf
v_max_f32_dpp v12,v12,v12 quad_perm:[2,3,0,1] row_mask:0xf bank_mask:0xf
s_nop 1
v_permlane32_swap_b32 v12,v13
v_max_f32 v64,v12,v13
v_max_f32 v12,v12,v13
s_mov_b64 exec,1
buffer_store_dword v16,v1,s[8:11],s72 offen
s_mov_b64 exec,-1
v_permlane16_swap_b32 v12,v64
v_max_f32 v12,v12,v64
v_mul_f32 v12,s87,v12
v_fma_f32 v60,v60,s87,-v12
v_fma_f32 v61,v61,s87,-v12
v_fma_f32 v62,v62,s87,-v12
v_fma_f32 v63,v63,s87,-v12
v_fma_f32 v68,v68,s87,-v12
v_exp_f32 v60,v60
v_exp_f32 v61,v61
v_exp_f32 v62,v62
v_exp_f32 v63,v63
v_exp_f32 v68,v68
v_cvt_pk_bf16_f32 v34,v60,v61
v_cvt_pk_bf16_f32 v35,v62,v63
v_cndmask_b32 v30,v34,v15,vcc
v_cndmask_b32 v31,v35,v15,vcc
v_cndmask_b32_dpp v28,v34,v15,vcc quad_perm:[2,3,0,1] row_mask:0xf bank_mask:0xf
v_cndmask_b32_dpp v29,v35,v15,vcc quad_perm:[2,3,0,1] row_mask:0xf bank_mask:0xf
s_mov_b64 vcc,s[90:91]
s_waitcnt lgkmcnt(0)
v_cndmask_b32 v24,v34,v15,vcc
v_mfma_f32_16x16x32_bf16 v[36:39],v[92:95],v[28:31],0
v_cndmask_b32 v25,v35,v15,vcc
v_cndmask_b32_dpp v26,v34,v15,vcc quad_perm:[2,3,0,1] row_mask:0xf bank_mask:0xf
v_mfma_f32_16x16x32_bf16 v[40:43],v[100:103],v[28:31],0
v_cndmask_b32_dpp v27,v35,v15,vcc quad_perm:[2,3,0,1] row_mask:0xf bank_mask:0xf
v_mov_b32_dpp v14,v68 quad_perm:[2,3,0,1] row_mask:0xf bank_mask:0xf
v_add_f32 v12,v60,v61
v_mfma_f32_16x16x32_bf16 v[36:39],v[88:91],v[24:27],v[36:39]
v_cvt_pk_bf16_f32 v32,v68,v14
v_cvt_pk_bf16_f32 v33,v14,v68
v_mfma_f32_16x16x32_bf16 v[40:43],v[96:99],v[24:27],v[40:43]
v_cndmask_b32 v32,v32,v15,vcc
v_cndmask_b32 v33,v15,v33,vcc
ds_read_b32 v10,v9
s_waitcnt vmcnt(1)
v_bitop3_b32 v17,v104,v106,s57 bitop3:0x7e
v_add_f32 v13,v62,v63
v_and_b32 v17,1,v17
v_add_f32 v12,v12,v68
v_cmp_ne_u32 vcc,0,v17
v_add_f32 v12,v12,v13
s_cbranch_vccnz vb_94
vo_95:
v_mfma_f32_16x16x16_bf16 v[36:39],v[104:105],v[32:33],v[36:39]
v_add_f32_dpp v13,v12,v12 quad_perm:[2,3,0,1] row_mask:0xf bank_mask:0xf
v_add_f32_dpp v12,v12,v12 quad_perm:[2,3,0,1] row_mask:0xf bank_mask:0xf
v_mfma_f32_16x16x16_bf16 v[40:43],v[106:107],v[32:33],v[40:43]
s_nop 0
v_permlane32_swap_b32 v12,v13
v_add_f32 v64,v12,v13
v_add_f32 v12,v12,v13
s_add_u32 s50,s50,1
s_mov_b32 s51,s53
v_permlane16_swap_b32 v12,v64
v_add_f32 v12,v12,v64
v_rcp_f32 v12,v12
s_mov_b32 s52,s54
v_pk_mul_f32 v[36:37],v[36:37],v[12:13] op_sel_hi:[1,0]
v_pk_mul_f32 v[38:39],v[38:39],v[12:13] op_sel_hi:[1,0]
v_pk_mul_f32 v[40:41],v[40:41],v[12:13] op_sel_hi:[1,0]
v_pk_mul_f32 v[42:43],v[42:43],v[12:13] op_sel_hi:[1,0]
v_cvt_pk_bf16_f32 v48,v36,v37
v_cvt_pk_bf16_f32 v49,v38,v39
v_cvt_pk_bf16_f32 v50,v40,v41
v_cvt_pk_bf16_f32 v51,v42,v43
v_and_or_b32 v48,v48,-2,s57
buffer_store_dwordx4 v[48:51],v8,s[8:11],s70 offen
s_mov_b32 s57,s31
s_mov_b32 s58,s32
s_waitcnt lgkmcnt(0)
v_cmp_ne_u32 vcc,s50,v10
v_mov_b32 v12,s50
ds_write_b32 v20,v12
s_branch CS_LOOP_F
last_93:
s_waitcnt lgkmcnt(0)
s_barrier
s_add_u32 s50,s50,1
s_mov_b32 s51,s53
s_mov_b32 s52,s54
s_mov_b32 s57,s31
s_mov_b32 s58,s32
s_mov_b64 vcc,-1
s_waitcnt vmcnt(0)
v_mov_b32 v12,s50
ds_write_b32 v20,v12
s_cmp_lt_u32 s50,128
s_cbranch_scc1 CS_LOOP_F
s_branch CS_DONE
fr_91:
v_bitop3_b32 v12,v60,v64,s57 bitop3:0x7e
v_bitop3_b32 v13,v68,v72,s57 bitop3:0x7e
v_xor_b32 v14,s57,v76
v_or3_b32 v12,v12,v13,v14
v_and_b32 v12,1,v12
v_cmp_ne_u32 vcc,0,v12
s_cbranch_vccz sk_96
buffer_load_dwordx4 v[76:79],v18,s[8:11],s59 offen sc1
buffer_load_dwordx4 v[60:63],v1,s[8:11],s59 offen sc1
buffer_load_dwordx4 v[64:67],v1,s[8:11],s59 offen offset:1024 sc1
buffer_load_dwordx4 v[68:71],v1,s[8:11],s59 offen offset:2048 sc1
buffer_load_dwordx4 v[72:75],v1,s[8:11],s59 offen offset:3072 sc1
sk_96:
buffer_load_dwordx4 v[96:99],v18,s[8:11],s68 offen sc1
buffer_load_dwordx4 v[80:83],v1,s[8:11],s68 offen sc1
buffer_load_dwordx4 v[84:87],v1,s[8:11],s68 offen offset:1024 sc1
buffer_load_dwordx4 v[88:91],v1,s[8:11],s68 offen offset:2048 sc1
buffer_load_dwordx4 v[92:95],v1,s[8:11],s68 offen offset:3072 sc1
s_sub_u32 s47,s47,1
s_cbranch_scc1 ABORT
s_waitcnt lgkmcnt(0)
s_branch fa_90
CS_FAST_F:
buffer_load_dwordx4 v[96:99],v18,s[8:11],s68 offen sc1
buffer_load_dwordx4 v[80:83],v1,s[8:11],s68 offen sc1
buffer_load_dwordx4 v[84:87],v1,s[8:11],s68 offen offset:1024 sc1
buffer_load_dwordx4 v[88:91],v1,s[8:11],s68 offen offset:2048 sc1
buffer_load_dwordx4 v[92:95],v1,s[8:11],s68 offen offset:3072 sc1
v_mov_b32 v24,0
v_mov_b32 v25,0
v_mov_b32 v26,0
v_mov_b32 v27,0
v_mov_b32 v28,0
v_mov_b32 v29,0
v_mov_b32 v30,0
v_mov_b32 v31,0
v_mov_b32 v32,0
v_mov_b32 v33,0
v_mov_b32 v34,0
v_mov_b32 v35,0
v_mov_b32 v36,0
v_mov_b32 v37,0
v_mov_b32 v38,0
v_mov_b32 v39,0
v_mov_b32 v40,0
v_mov_b32 v41,0
v_mov_b32 v42,0
v_mov_b32 v43,0
v_mov_b32 v44,0
v_mov_b32 v45,0
v_mov_b32 v46,0
v_mov_b32 v47,0
s_nop 0
s_branch fj_92
vb_94:
s_sub_u32 s47,s47,1
s_cbranch_scc1 ABORT
buffer_load_dwordx4 v[104:107],v1,s[8:11],s71 offen sc1
s_waitcnt vmcnt(0)
v_bitop3_b32 v17,v104,v106,s57 bitop3:0x7e
v_and_b32 v17,1,v17
v_cmp_ne_u32 vcc,0,v17
s_nop 0
s_cbranch_vccnz vb_94
s_branch vo_95
CS_LOOP_S:
s_barrier
buffer_load_dwordx4 v[76:79],v18,s[8:11],s59 offen sc1
buffer_load_dwordx4 v[60:63],v1,s[8:11],s59 offen sc1
buffer_load_dwordx4 v[64:67],v1,s[8:11],s59 offen offset:1024 sc1
buffer_load_dwordx4 v[68:71],v1,s[8:11],s59 offen offset:2048 sc1
buffer_load_dwordx4 v[72:75],v1,s[8:11],s59 offen offset:3072 sc1
s_cbranch_vccz CS_FAST_S
v_mov_b32 v24,0
v_mov_b32 v25,0
v_mov_b32 v26,0
v_mov_b32 v27,0
v_mov_b32 v28,0
v_mov_b32 v29,0
v_mov_b32 v30,0
v_mov_b32 v31,0
v_mov_b32 v32,0
v_mov_b32 v33,0
v_mov_b32 v34,0
v_mov_b32 v35,0
v_mov_b32 v36,0
v_mov_b32 v37,0
v_mov_b32 v38,0
v_mov_b32 v39,0
v_mov_b32 v40,0
v_mov_b32 v41,0
v_mov_b32 v42,0
v_mov_b32 v43,0
v_mov_b32 v44,0
v_mov_b32 v45,0
v_mov_b32 v46,0
v_mov_b32 v47,0
s_waitcnt vmcnt(4)
buffer_load_dwordx4 v[96:99],v18,s[8:11],s68 offen sc1
buffer_load_dwordx4 v[80:83],v1,s[8:11],s68 offen sc1
buffer_load_dwordx4 v[84:87],v1,s[8:11],s68 offen offset:1024 sc1
buffer_load_dwordx4 v[88:91],v1,s[8:11],s68 offen offset:2048 sc1
buffer_load_dwordx4 v[92:95],v1,s[8:11],s68 offen offset:3072 sc1
fj_99:
fa_97:
s_waitcnt vmcnt(4)
v_pk_add_f32 v[12:13],v[76:77],v[96:97]
v_pk_add_f32 v[14:15],v[78:79],v[98:99]
v_bitop3_b32 v16,v76,v96,s57 bitop3:0x7e
v_cvt_pk_bf16_f32 v56,v12,v13
v_cvt_pk_bf16_f32 v57,v14,v15
ds_write_b64 v23,v[56:57]
s_waitcnt vmcnt(3)
v_pk_add_f32 v[12:13],v[60:61],v[80:81]
v_pk_add_f32 v[14:15],v[62:63],v[82:83]
v_bitop3_b32 v17,v60,v80,s57 bitop3:0x7e
v_cvt_pk_bf16_f32 v48,v12,v13
v_cvt_pk_bf16_f32 v49,v14,v15
v_or_b32 v16,v16,v17
s_waitcnt vmcnt(2)
v_pk_add_f32 v[12:13],v[64:65],v[84:85]
v_pk_add_f32 v[14:15],v[66:67],v[86:87]
v_bitop3_b32 v17,v64,v84,s57 bitop3:0x7e
v_cvt_pk_bf16_f32 v50,v12,v13
v_cvt_pk_bf16_f32 v51,v14,v15
v_or_b32 v16,v16,v17
ds_write_b128 v22,v[48:51] offset:0
s_waitcnt vmcnt(1)
v_pk_add_f32 v[12:13],v[68:69],v[88:89]
v_pk_add_f32 v[14:15],v[70:71],v[90:91]
v_bitop3_b32 v17,v68,v88,s57 bitop3:0x7e
v_cvt_pk_bf16_f32 v52,v12,v13
v_cvt_pk_bf16_f32 v53,v14,v15
v_or_b32 v16,v16,v17
s_waitcnt vmcnt(0)
v_pk_add_f32 v[12:13],v[72:73],v[92:93]
v_pk_add_f32 v[14:15],v[74:75],v[94:95]
v_bitop3_b32 v17,v72,v92,s57 bitop3:0x7e
v_cvt_pk_bf16_f32 v54,v12,v13
v_cvt_pk_bf16_f32 v55,v14,v15
v_bitop3_b32 v16,v16,v17,1 bitop3:0xa8
v_cmp_ne_u32 vcc,0,v16
ds_write_b128 v22,v[52:55] offset:1024
s_cbranch_vccnz fr_98
v_smfmac_f32_16x16x64_bf16 v[24:27],v[48:51],a[0:7],v2
ds_read_b128 v[72:75],v21 offset:0
v_xor_b32 v58,57344,v58
v_smfmac_f32_16x16x64_bf16 v[28:31],v[48:51],a[8:15],v2
ds_read_b128 v[76:79],v21 offset:1024
s_sub_u32 s60,s4,s5
v_smfmac_f32_16x16x64_bf16 v[32:35],v[48:51],a[16:23],v2
ds_read_b128 v[80:83],v21 offset:2048
v_smfmac_f32_16x16x64_bf16 v[36:39],v[48:51],a[24:31],v2
ds_read_b128 v[84:87],v21 offset:3072
s_waitcnt lgkmcnt(4)
s_barrier
v_smfmac_f32_16x16x64_bf16 v[40:43],v[48:51],a[32:39],v2
ds_read_b128 v[60:63],v3 offset:0
v_smfmac_f32_16x16x64_bf16 v[24:27],v[52:55],a[40:47],v2
ds_read_b128 v[64:67],v3 offset:1024
v_smfmac_f32_16x16x64_bf16 v[28:31],v[52:55],a[48:55],v2
ds_read_b128 v[68:71],v4 offset:0
v_smfmac_f32_16x16x64_bf16 v[32:35],v[52:55],a[56:63],v2
s_cmp_gt_i32 s60,14
s_cselect_b32 s53,1,0
v_smfmac_f32_16x16x64_bf16 v[36:39],v[52:55],a[64:71],v2
s_cmp_eq_u32 s4,64
s_cselect_b32 s53,1,s53
v_smfmac_f32_16x16x64_bf16 v[40:43],v[52:55],a[72:79],v2
s_waitcnt lgkmcnt(5)
v_smfmac_f32_16x16x64_bf16 v[44:47],v[48:51],v[72:79],v2
ds_read_b128 v[72:75],v21 offset:4096
s_waitcnt lgkmcnt(4)
v_smfmac_f32_16x16x64_bf16 v[44:47],v[52:55],v[80:87],v2
ds_read_b128 v[76:79],v21 offset:5120
s_waitcnt lgkmcnt(4)
v_smfmac_f32_16x16x64_bf16 v[24:27],v[60:63],a[80:87],v2
ds_read_b128 v[80:83],v21 offset:6144
v_smfmac_f32_16x16x64_bf16 v[28:31],v[60:63],a[88:95],v2
ds_read_b128 v[84:87],v21 offset:7168
v_smfmac_f32_16x16x64_bf16 v[32:35],v[60:63],a[96:103],v2
s_cmp_eq_u32 s53,0
s_cselect_b32 s54,s4,s5
s_addc_u32 s4,s4,0
v_smfmac_f32_16x16x64_bf16 v[36:39],v[60:63],a[104:111],v2
s_add_u32 s5,s5,s53
s_mul_i32 s73,s54,393216
s_add_u32 s73,s73,s84
v_smfmac_f32_16x16x64_bf16 v[40:43],v[60:63],a[112:119],v2
s_sub_u32 s74,s75,s74
s_mov_b32 m0,s74
s_waitcnt lgkmcnt(2)
v_smfmac_f32_16x16x64_bf16 v[44:47],v[60:63],v[72:79],v2
ds_read_b128 v[60:63],v4 offset:1024
s_and_b32 s60,s52,3
v_smfmac_f32_16x16x64_bf16 v[24:27],v[64:67],a[120:127],v2
ds_read_b128 v[72:75],v21 offset:8192
s_lshl2_add_u32 s60,s51,s60
v_smfmac_f32_16x16x64_bf16 v[28:31],v[64:67],a[128:135],v2
ds_read_b128 v[76:79],v21 offset:9216
s_mul_i32 s60,s60,49152
v_smfmac_f32_16x16x64_bf16 v[32:35],v[64:67],a[136:143],v2
s_add_u32 s71,s60,s34
s_add_u32 s70,s60,s33
s_lshl_b32 s60,s51,9
v_smfmac_f32_16x16x64_bf16 v[36:39],v[64:67],a[144:151],v2
s_add_u32 s72,s60,s35
buffer_load_dwordx4 v1,s[8:11],s73 offen nt sc1 lds
v_smfmac_f32_16x16x64_bf16 v[40:43],v[64:67],a[152:159],v2
buffer_load_dwordx4 v1,s[8:11],s73 offen offset:1024 nt sc1 lds
s_waitcnt lgkmcnt(3)
v_smfmac_f32_16x16x64_bf16 v[44:47],v[64:67],v[80:87],v2
ds_read_b128 v[64:67],v5 offset:0
v_smfmac_f32_16x16x64_bf16 v[24:27],v[68:71],a[160:167],v2
ds_read_b128 v[80:83],v21 offset:10240
v_smfmac_f32_16x16x64_bf16 v[28:31],v[68:71],a[168:175],v2
ds_read_b128 v[84:87],v21 offset:11264
v_smfmac_f32_16x16x64_bf16 v[32:35],v[68:71],a[176:183],v2
buffer_load_dwordx4 v1,s[8:11],s73 offen offset:2048 nt sc1 lds
v_smfmac_f32_16x16x64_bf16 v[36:39],v[68:71],a[184:191],v2
buffer_load_dwordx4 v1,s[8:11],s73 offen offset:3072 nt sc1 lds
s_and_b32 s60,s54,3
v_smfmac_f32_16x16x64_bf16 v[40:43],v[68:71],a[192:199],v2
s_lshl2_add_u32 s60,s53,s60
s_lshl_b32 s68,s60,16
s_waitcnt lgkmcnt(3)
v_smfmac_f32_16x16x64_bf16 v[44:47],v[68:71],v[72:79],v2
ds_read_b128 v[68:71],v5 offset:1024
s_add_u32 s68,s68,s83
v_smfmac_f32_16x16x64_bf16 v[24:27],v[60:63],a[200:207],v2
ds_read_b128 v[72:75],v21 offset:12288
s_mul_i32 s59,s60,20480
v_smfmac_f32_16x16x64_bf16 v[28:31],v[60:63],a[208:215],v2
ds_read_b128 v[76:79],v21 offset:13312
s_add_u32 s59,s59,s6
v_smfmac_f32_16x16x64_bf16 v[32:35],v[60:63],a[216:223],v2
s_lshl_b32 s69,s53,9
s_add_u32 s69,s69,s7
s_bfe_u32 s31,s54,0x10002
v_smfmac_f32_16x16x64_bf16 v[36:39],v[60:63],a[224:231],v2
s_add_u32 s32,s54,1
v_add_u32 v17,s85,v58
v_smfmac_f32_16x16x64_bf16 v[40:43],v[60:63],a[232:239],v2
v_mov_b32 v16,s58
s_waitcnt lgkmcnt(3)
v_smfmac_f32_16x16x64_bf16 v[44:47],v[60:63],v[80:87],v2
ds_read_b128 v[60:63],v59 offset:0
v_mov_b32 v15,0
v_smfmac_f32_16x16x64_bf16 v[24:27],v[64:67],a[240:247],v2
ds_read_b128 v[80:83],v21 offset:14336
v_smfmac_f32_16x16x64_bf16 v[28:31],v[64:67],a[248:255],v2
ds_read_b128 v[84:87],v21 offset:15360
v_smfmac_f32_16x16x64_bf16 v[32:35],v[64:67],v[112:119],v2
ds_read_b128 v[88:91],v58 offset:0
v_smfmac_f32_16x16x64_bf16 v[36:39],v[64:67],v[120:127],v2
ds_read_b128 v[92:95],v58 offset:1024
v_smfmac_f32_16x16x64_bf16 v[40:43],v[64:67],v[128:135],v2
ds_read_b128 v[96:99],v58 offset:2048
s_waitcnt lgkmcnt(6)
v_smfmac_f32_16x16x64_bf16 v[44:47],v[64:67],v[72:79],v2
ds_read_b128 v[64:67],v59 offset:1024
v_smfmac_f32_16x16x64_bf16 v[24:27],v[68:71],v[136:143],v2
ds_read_b128 v[72:75],v21 offset:16384
v_smfmac_f32_16x16x64_bf16 v[28:31],v[68:71],v[144:151],v2
ds_read_b128 v[76:79],v21 offset:17408
v_smfmac_f32_16x16x64_bf16 v[32:35],v[68:71],v[152:159],v2
ds_read_b128 v[100:103],v58 offset:3072
v_smfmac_f32_16x16x64_bf16 v[36:39],v[68:71],v[160:167],v2
ds_read_b128 v[104:107],v58 offset:4096
v_smfmac_f32_16x16x64_bf16 v[40:43],v[68:71],v[168:175],v2
ds_read_b128 v[108:111],v58 offset:5120
s_waitcnt lgkmcnt(9)
v_smfmac_f32_16x16x64_bf16 v[44:47],v[68:71],v[80:87],v2
ds_read_b128 v[80:83],v21 offset:18432
v_smfmac_f32_16x16x64_bf16 v[24:27],v[60:63],v[176:183],v2
ds_read_b128 v[84:87],v21 offset:19456
v_smfmac_f32_16x16x64_bf16 v[36:39],v[60:63],v[200:207],v2
ds_read_b128 v[48:51],v58 offset:6144
s_waitcnt lgkmcnt(8)
v_smfmac_f32_16x16x64_bf16 v[24:27],v[64:67],v[216:223],v2
ds_read_b128 v[52:55],v58 offset:7168
v_smfmac_f32_16x16x64_bf16 v[36:39],v[64:67],v[240:247],v2
v_smfmac_f32_16x16x64_bf16 v[28:31],v[60:63],v[184:191],v2
v_smfmac_f32_16x16x64_bf16 v[40:43],v[60:63],v[208:215],v2
s_nop 3
v_add_f32 v24,v24,v25
v_smfmac_f32_16x16x64_bf16 v[28:31],v[64:67],v[224:231],v2
v_add_f32 v26,v26,v27
v_smfmac_f32_16x16x64_bf16 v[40:43],v[64:67],v[248:255],v2
v_add_f32 v36,v36,v37
v_smfmac_f32_16x16x64_bf16 v[32:35],v[60:63],v[192:199],v2
v_add_f32 v38,v38,v39
s_waitcnt lgkmcnt(7)
v_smfmac_f32_16x16x64_bf16 v[44:47],v[60:63],v[72:79],v2
v_cvt_pk_bf16_f32 v37,v24,v26
v_smfmac_f32_16x16x64_bf16 v[32:35],v[64:67],v[232:239],v2
v_cvt_pk_bf16_f32 v36,v36,v38
s_waitcnt lgkmcnt(2)
v_smfmac_f32_16x16x64_bf16 v[44:47],v[64:67],v[80:87],v2
ds_write_b64 v6,v[36:37] offset:0
v_add_f32 v28,v28,v29
v_add_f32 v30,v30,v31
v_add_f32 v40,v40,v41
v_add_f32 v42,v42,v43
v_cvt_pk_bf16_f32 v41,v28,v30
v_cvt_pk_bf16_f32 v40,v40,v42
ds_write_b64 v6,v[40:41] offset:512
v_add_f32 v32,v32,v33
v_add_f32 v34,v34,v35
v_add_f32 v44,v44,v45
v_add_f32 v46,v46,v47
v_cvt_pk_bf16_f32 v45,v32,v34
v_cvt_pk_bf16_f32 v44,v44,v46
ds_write_b64 v6,v[44:45] offset:1024
s_cmp_eq_u32 s52,63
s_cbranch_scc1 last_100
ds_read_b128 v[72:75],v58 offset:8192
ds_read_b128 v[76:79],v58 offset:9216
s_waitcnt lgkmcnt(2)
s_barrier
ds_read_b64_tr_b16 v[24:25],v7 offset:0
ds_read_b64_tr_b16 v[26:27],v7 offset:512
ds_read_b64_tr_b16 v[28:29],v7 offset:1024
ds_read_b64_tr_b16 v[30:31],v7 offset:1536
ds_read_b64_tr_b16 v[32:33],v7 offset:2048
ds_read_b64_tr_b16 v[34:35],v7 offset:2560
ds_read_b64_tr_b16 v[36:37],v7 offset:3072
ds_read_b64_tr_b16 v[38:39],v7 offset:3584
s_waitcnt lgkmcnt(6)
v_mfma_f32_16x16x32_bf16 v[60:63],v[88:91],v[24:27],0
ds_read_b64_tr_b16 v[40:41],v7 offset:4096
s_mov_b64 vcc,s[88:89]
v_mfma_f32_16x16x32_bf16 v[64:67],v[92:95],v[24:27],0
ds_read_b64_tr_b16 v[42:43],v7 offset:4608
v_mfma_f32_16x16x32_bf16 v[68:71],v[24:27],v[24:27],0
ds_read_b128 v[80:83],v58 offset:10240
s_waitcnt lgkmcnt(7)
v_mfma_f32_16x16x32_bf16 v[60:63],v[96:99],v[28:31],v[60:63]
ds_read_b128 v[84:87],v58 offset:11264
v_mfma_f32_16x16x32_bf16 v[64:67],v[100:103],v[28:31],v[64:67]
ds_read_b64_tr_b16 v[44:45],v7 offset:5120
v_mfma_f32_16x16x32_bf16 v[68:71],v[28:31],v[28:31],v[68:71]
ds_read_b64_tr_b16 v[46:47],v7 offset:5632
s_waitcnt lgkmcnt(8)
v_mfma_f32_16x16x32_bf16 v[60:63],v[104:107],v[32:35],v[60:63]
ds_read_b128 v[88:91],v17 offset:12288
v_mfma_f32_16x16x32_bf16 v[64:67],v[108:111],v[32:35],v[64:67]
ds_read_b128 v[92:95],v17 offset:13312
v_mfma_f32_16x16x32_bf16 v[68:71],v[32:35],v[32:35],v[68:71]
ds_read_b128 v[96:99],v17 offset:14336
s_waitcnt lgkmcnt(9)
v_mfma_f32_16x16x32_bf16 v[60:63],v[48:51],v[36:39],v[60:63]
ds_read_b128 v[100:103],v17 offset:15360
v_mfma_f32_16x16x32_bf16 v[64:67],v[52:55],v[36:39],v[64:67]
v_mfma_f32_16x16x32_bf16 v[68:71],v[36:39],v[36:39],v[68:71]
s_waitcnt lgkmcnt(8)
v_mfma_f32_16x16x32_bf16 v[60:63],v[72:75],v[40:43],v[60:63]
v_mfma_f32_16x16x32_bf16 v[64:67],v[76:79],v[40:43],v[64:67]
v_mfma_f32_16x16x32_bf16 v[68:71],v[40:43],v[40:43],v[68:71]
s_waitcnt lgkmcnt(4)
v_mfma_f32_16x16x32_bf16 v[60:63],v[80:83],v[44:47],v[60:63]
v_mfma_f32_16x16x32_bf16 v[64:67],v[84:87],v[44:47],v[64:67]
buffer_load_dwordx4 v[104:107],v1,s[8:11],s71 offen sc1
v_mfma_f32_16x16x32_bf16 v[68:71],v[44:47],v[44:47],v[68:71]
s_nop 5
v_cndmask_b32_dpp v60,v64,v60,vcc quad_perm:[2,3,2,3] row_mask:0xf bank_mask:0xf
v_cndmask_b32_dpp v61,v65,v61,vcc quad_perm:[2,3,2,3] row_mask:0xf bank_mask:0xf
v_cndmask_b32_dpp v62,v66,v62,vcc quad_perm:[2,3,2,3] row_mask:0xf bank_mask:0xf
v_cndmask_b32_dpp v63,v67,v63,vcc quad_perm:[2,3,2,3] row_mask:0xf bank_mask:0xf
v_max3_f32 v12,v60,v61,v62
v_cndmask_b32_dpp v68,v69,v68,vcc quad_perm:[2,3,2,3] row_mask:0xf bank_mask:0xf
v_max3_f32 v12,v12,v63,v68
s_nop 1
v_max_f32_dpp v13,v12,v12 quad_perm:[2,3,0,1] row_mask:0xf bank_mask:0xf
v_max_f32_dpp v12,v12,v12 quad_perm:[2,3,0,1] row_mask:0xf bank_mask:0xf
s_nop 1
v_permlane32_swap_b32 v12,v13
v_max_f32 v64,v12,v13
v_max_f32 v12,v12,v13
s_mov_b64 exec,1
buffer_store_dword v16,v1,s[8:11],s72 offen sc1
s_mov_b64 exec,-1
v_permlane16_swap_b32 v12,v64
v_max_f32 v12,v12,v64
v_mul_f32 v12,s87,v12
v_fma_f32 v60,v60,s87,-v12
v_fma_f32 v61,v61,s87,-v12
v_fma_f32 v62,v62,s87,-v12
v_fma_f32 v63,v63,s87,-v12
v_fma_f32 v68,v68,s87,-v12
v_exp_f32 v60,v60
v_exp_f32 v61,v61
v_exp_f32 v62,v62
v_exp_f32 v63,v63
v_exp_f32 v68,v68
v_cvt_pk_bf16_f32 v34,v60,v61
v_cvt_pk_bf16_f32 v35,v62,v63
v_cndmask_b32 v30,v34,v15,vcc
v_cndmask_b32 v31,v35,v15,vcc
v_cndmask_b32_dpp v28,v34,v15,vcc quad_perm:[2,3,0,1] row_mask:0xf bank_mask:0xf
v_cndmask_b32_dpp v29,v35,v15,vcc quad_perm:[2,3,0,1] row_mask:0xf bank_mask:0xf
s_mov_b64 vcc,s[90:91]
s_waitcnt lgkmcnt(0)
v_cndmask_b32 v24,v34,v15,vcc
v_mfma_f32_16x16x32_bf16 v[36:39],v[92:95],v[28:31],0
v_cndmask_b32 v25,v35,v15,vcc
v_cndmask_b32_dpp v26,v34,v15,vcc quad_perm:[2,3,0,1] row_mask:0xf bank_mask:0xf
v_mfma_f32_16x16x32_bf16 v[40:43],v[100:103],v[28:31],0
v_cndmask_b32_dpp v27,v35,v15,vcc quad_perm:[2,3,0,1] row_mask:0xf bank_mask:0xf
v_mov_b32_dpp v14,v68 quad_perm:[2,3,0,1] row_mask:0xf bank_mask:0xf
v_add_f32 v12,v60,v61
v_mfma_f32_16x16x32_bf16 v[36:39],v[88:91],v[24:27],v[36:39]
v_cvt_pk_bf16_f32 v32,v68,v14
v_cvt_pk_bf16_f32 v33,v14,v68
v_mfma_f32_16x16x32_bf16 v[40:43],v[96:99],v[24:27],v[40:43]
v_cndmask_b32 v32,v32,v15,vcc
v_cndmask_b32 v33,v15,v33,vcc
ds_read_b32 v10,v9
s_waitcnt vmcnt(1)
v_bitop3_b32 v17,v104,v106,s57 bitop3:0x7e
v_add_f32 v13,v62,v63
v_and_b32 v17,1,v17
v_add_f32 v12,v12,v68
v_cmp_ne_u32 vcc,0,v17
v_add_f32 v12,v12,v13
s_cbranch_vccnz vb_101
vo_102:
v_mfma_f32_16x16x16_bf16 v[36:39],v[104:105],v[32:33],v[36:39]
v_add_f32_dpp v13,v12,v12 quad_perm:[2,3,0,1] row_mask:0xf bank_mask:0xf
v_add_f32_dpp v12,v12,v12 quad_perm:[2,3,0,1] row_mask:0xf bank_mask:0xf
v_mfma_f32_16x16x16_bf16 v[40:43],v[106:107],v[32:33],v[40:43]
s_nop 0
v_permlane32_swap_b32 v12,v13
v_add_f32 v64,v12,v13
v_add_f32 v12,v12,v13
s_add_u32 s50,s50,1
s_mov_b32 s51,s53
v_permlane16_swap_b32 v12,v64
v_add_f32 v12,v12,v64
v_rcp_f32 v12,v12
s_mov_b32 s52,s54
v_pk_mul_f32 v[36:37],v[36:37],v[12:13] op_sel_hi:[1,0]
v_pk_mul_f32 v[38:39],v[38:39],v[12:13] op_sel_hi:[1,0]
v_pk_mul_f32 v[40:41],v[40:41],v[12:13] op_sel_hi:[1,0]
v_pk_mul_f32 v[42:43],v[42:43],v[12:13] op_sel_hi:[1,0]
v_cvt_pk_bf16_f32 v48,v36,v37
v_cvt_pk_bf16_f32 v49,v38,v39
v_cvt_pk_bf16_f32 v50,v40,v41
v_cvt_pk_bf16_f32 v51,v42,v43
v_and_or_b32 v48,v48,-2,s57
buffer_store_dwordx4 v[48:51],v8,s[8:11],s70 offen sc1
s_mov_b32 s57,s31
s_mov_b32 s58,s32
s_waitcnt lgkmcnt(0)
v_cmp_ne_u32 vcc,s50,v10
v_mov_b32 v12,s50
ds_write_b32 v20,v12
s_branch CS_LOOP_S
last_100:
s_waitcnt lgkmcnt(0)
s_barrier
s_add_u32 s50,s50,1
s_mov_b32 s51,s53
s_mov_b32 s52,s54
s_mov_b32 s57,s31
s_mov_b32 s58,s32
s_mov_b64 vcc,-1
s_waitcnt vmcnt(0)
v_mov_b32 v12,s50
ds_write_b32 v20,v12
s_cmp_lt_u32 s50,128
s_cbranch_scc1 CS_LOOP_S
s_branch CS_DONE
fr_98:
v_bitop3_b32 v12,v60,v64,s57 bitop3:0x7e
v_bitop3_b32 v13,v68,v72,s57 bitop3:0x7e
v_xor_b32 v14,s57,v76
v_or3_b32 v12,v12,v13,v14
v_and_b32 v12,1,v12
v_cmp_ne_u32 vcc,0,v12
s_cbranch_vccz sk_103
buffer_load_dwordx4 v[76:79],v18,s[8:11],s59 offen sc1
buffer_load_dwordx4 v[60:63],v1,s[8:11],s59 offen sc1
buffer_load_dwordx4 v[64:67],v1,s[8:11],s59 offen offset:1024 sc1
buffer_load_dwordx4 v[68:71],v1,s[8:11],s59 offen offset:2048 sc1
buffer_load_dwordx4 v[72:75],v1,s[8:11],s59 offen offset:3072 sc1
sk_103:
buffer_load_dwordx4 v[96:99],v18,s[8:11],s68 offen sc1
buffer_load_dwordx4 v[80:83],v1,s[8:11],s68 offen sc1
buffer_load_dwordx4 v[84:87],v1,s[8:11],s68 offen offset:1024 sc1
buffer_load_dwordx4 v[88:91],v1,s[8:11],s68 offen offset:2048 sc1
buffer_load_dwordx4 v[92:95],v1,s[8:11],s68 offen offset:3072 sc1
s_sub_u32 s47,s47,1
s_cbranch_scc1 ABORT
s_waitcnt lgkmcnt(0)
s_branch fa_97
CS_FAST_S:
buffer_load_dwordx4 v[96:99],v18,s[8:11],s68 offen sc1
buffer_load_dwordx4 v[80:83],v1,s[8:11],s68 offen sc1
buffer_load_dwordx4 v[84:87],v1,s[8:11],s68 offen offset:1024 sc1
buffer_load_dwordx4 v[88:91],v1,s[8:11],s68 offen offset:2048 sc1
buffer_load_dwordx4 v[92:95],v1,s[8:11],s68 offen offset:3072 sc1
v_mov_b32 v24,0
v_mov_b32 v25,0
v_mov_b32 v26,0
v_mov_b32 v27,0
v_mov_b32 v28,0
v_mov_b32 v29,0
v_mov_b32 v30,0
v_mov_b32 v31,0
v_mov_b32 v32,0
v_mov_b32 v33,0
v_mov_b32 v34,0
v_mov_b32 v35,0
v_mov_b32 v36,0
v_mov_b32 v37,0
v_mov_b32 v38,0
v_mov_b32 v39,0
v_mov_b32 v40,0
v_mov_b32 v41,0
v_mov_b32 v42,0
v_mov_b32 v43,0
v_mov_b32 v44,0
v_mov_b32 v45,0
v_mov_b32 v46,0
v_mov_b32 v47,0
s_nop 0
s_branch fj_99
vb_101:
s_sub_u32 s47,s47,1
s_cbranch_scc1 ABORT
buffer_load_dwordx4 v[104:107],v1,s[8:11],s71 offen sc1
s_waitcnt vmcnt(0)
v_bitop3_b32 v17,v104,v106,s57 bitop3:0x7e
v_and_b32 v17,1,v17
v_cmp_ne_u32 vcc,0,v17
s_nop 0
s_cbranch_vccnz vb_101
s_branch vo_102
CH_START:
s_sub_u32 s60,s4,s5
s_cmp_gt_i32 s60,14
s_cselect_b32 s53,1,0
s_cmp_eq_u32 s4,64
s_cselect_b32 s53,1,s53
s_cmp_eq_u32 s53,0
s_cselect_b32 s54,s4,s5
s_addc_u32 s4,s4,0
s_add_u32 s5,s5,s53
s_sub_u32 s60,s4,s5
s_cmp_gt_i32 s60,14
s_cselect_b32 s55,1,0
s_cmp_eq_u32 s4,64
s_cselect_b32 s55,1,s55
s_cmp_eq_u32 s55,0
s_cselect_b32 s56,s4,s5
s_addc_u32 s4,s4,0
s_add_u32 s5,s5,s55
s_mov_b32 s74,81920
s_mul_i32 s73,s52,393216
s_add_u32 s73,s73,s84
s_lshl_b32 s75,s51,6
s_add_u32 s75,s75,s52
s_lshl_b32 s75,s75,9
s_add_u32 s75,s75,131072
fl_104:
buffer_load_dword v12,v9,s[8:11],s75 offen sc1
s_waitcnt vmcnt(0)
v_cmp_eq_u32 vcc,0,v12
s_nop 0
s_cbranch_vccz ok_105
s_sleep 1
s_sub_u32 s47,s47,1
s_cbranch_scc1 ABORT
s_branch fl_104
ok_105:
s_add_u32 m0,s74,0
s_add_u32 s67,s73,0
buffer_load_dwordx4 v1,s[8:11],s67 offen nt sc1 lds
buffer_load_dwordx4 v1,s[8:11],s67 offen offset:1024 nt sc1 lds
buffer_load_dwordx4 v1,s[8:11],s67 offen offset:2048 nt sc1 lds
buffer_load_dwordx4 v1,s[8:11],s67 offen offset:3072 nt sc1 lds
s_add_u32 m0,s74,4096
s_add_u32 s67,s73,4096
buffer_load_dwordx4 v1,s[8:11],s67 offen nt sc1 lds
buffer_load_dwordx4 v1,s[8:11],s67 offen offset:1024 nt sc1 lds
buffer_load_dwordx4 v1,s[8:11],s67 offen offset:2048 nt sc1 lds
buffer_load_dwordx4 v1,s[8:11],s67 offen offset:3072 nt sc1 lds
s_add_u32 m0,s74,8192
s_add_u32 s67,s73,8192
buffer_load_dwordx4 v1,s[8:11],s67 offen nt sc1 lds
buffer_load_dwordx4 v1,s[8:11],s67 offen offset:1024 nt sc1 lds
buffer_load_dwordx4 v1,s[8:11],s67 offen offset:2048 nt sc1 lds
buffer_load_dwordx4 v1,s[8:11],s67 offen offset:3072 nt sc1 lds
s_add_u32 m0,s74,12288
s_add_u32 s67,s73,25165824
buffer_load_dwordx4 v1,s[8:11],s67 offen nt sc1 lds
buffer_load_dwordx4 v1,s[8:11],s67 offen offset:1024 nt sc1 lds
buffer_load_dwordx4 v1,s[8:11],s67 offen offset:2048 nt sc1 lds
buffer_load_dwordx4 v1,s[8:11],s67 offen offset:3072 nt sc1 lds
s_add_u32 m0,s74,16384
s_add_u32 s67,s73,25169920
buffer_load_dwordx4 v1,s[8:11],s67 offen nt sc1 lds
buffer_load_dwordx4 v1,s[8:11],s67 offen offset:1024 nt sc1 lds
buffer_load_dwordx4 v1,s[8:11],s67 offen offset:2048 nt sc1 lds
buffer_load_dwordx4 v1,s[8:11],s67 offen offset:3072 nt sc1 lds
s_add_u32 m0,s74,20480
s_add_u32 s67,s73,25174016
buffer_load_dwordx4 v1,s[8:11],s67 offen nt sc1 lds
buffer_load_dwordx4 v1,s[8:11],s67 offen offset:1024 nt sc1 lds
buffer_load_dwordx4 v1,s[8:11],s67 offen offset:2048 nt sc1 lds
buffer_load_dwordx4 v1,s[8:11],s67 offen offset:3072 nt sc1 lds
s_mov_b32 s74,106496
s_mul_i32 s73,s54,393216
s_add_u32 s73,s73,s84
s_lshl_b32 s75,s53,6
s_add_u32 s75,s75,s54
s_lshl_b32 s75,s75,9
s_add_u32 s75,s75,131072
s_lshl_b32 s76,s55,6
s_add_u32 s76,s76,s56
s_lshl_b32 s76,s76,9
s_add_u32 s76,s76,131072
s_mov_b32 s77,1
v_min_u32 v8,2,v0
v_lshlrev_b32 v8,2,v8
v_add_u32 v8,147456,v8
v_mov_b32 v58,147468
s_nop 1
CH_LOOP:
v_mov_b32 v24,0
v_mov_b32 v25,0
v_mov_b32 v26,0
v_mov_b32 v27,0
v_mov_b32 v28,0
v_mov_b32 v29,0
v_mov_b32 v30,0
v_mov_b32 v31,0
v_mov_b32 v32,0
v_mov_b32 v33,0
v_mov_b32 v34,0
v_mov_b32 v35,0
v_mov_b32 v36,0
v_mov_b32 v37,0
v_mov_b32 v38,0
v_mov_b32 v39,0
v_mov_b32 v40,0
v_mov_b32 v41,0
v_mov_b32 v42,0
v_mov_b32 v43,0
v_mov_b32 v44,0
v_mov_b32 v45,0
v_mov_b32 v46,0
v_mov_b32 v47,0
v_mov_b32 v14,s50
s_nop 1
db_109:
buffer_load_dword v12,v11,s[8:11],s69 offen sc1
s_waitcnt vmcnt(0)
v_cmp_gt_u32 vcc,s58,v12
s_cbranch_vccz dbok_110
s_sub_u32 s47,s47,1
s_cbranch_scc1 ABORT
s_branch db_109
dbok_110:
ds_write_b32 v58,v14
buffer_load_dwordx4 v[76:79],v18,s[8:11],s59 offen sc1
buffer_load_dwordx4 v[60:63],v1,s[8:11],s59 offen sc1
buffer_load_dwordx4 v[64:67],v1,s[8:11],s59 offen offset:1024 sc1
buffer_load_dwordx4 v[68:71],v1,s[8:11],s59 offen offset:2048 sc1
buffer_load_dwordx4 v[72:75],v1,s[8:11],s59 offen offset:3072 sc1
s_barrier
s_waitcnt vmcnt(4)
buffer_load_dwordx4 v[96:99],v18,s[8:11],s68 offen sc1
buffer_load_dwordx4 v[80:83],v1,s[8:11],s68 offen sc1
buffer_load_dwordx4 v[84:87],v1,s[8:11],s68 offen offset:1024 sc1
buffer_load_dwordx4 v[88:91],v1,s[8:11],s68 offen offset:2048 sc1
buffer_load_dwordx4 v[92:95],v1,s[8:11],s68 offen offset:3072 sc1
fj_108:
fa_106:
s_waitcnt vmcnt(4)
v_pk_add_f32 v[12:13],v[76:77],v[96:97]
v_pk_add_f32 v[14:15],v[78:79],v[98:99]
v_bitop3_b32 v16,v76,v96,s57 bitop3:0x7e
v_cvt_pk_bf16_f32 v56,v12,v13
v_cvt_pk_bf16_f32 v57,v14,v15
ds_write_b64 v23,v[56:57]
s_waitcnt vmcnt(3)
v_pk_add_f32 v[12:13],v[60:61],v[80:81]
v_pk_add_f32 v[14:15],v[62:63],v[82:83]
v_bitop3_b32 v17,v60,v80,s57 bitop3:0x7e
v_cvt_pk_bf16_f32 v48,v12,v13
v_cvt_pk_bf16_f32 v49,v14,v15
v_or_b32 v16,v16,v17
s_waitcnt vmcnt(2)
v_pk_add_f32 v[12:13],v[64:65],v[84:85]
v_pk_add_f32 v[14:15],v[66:67],v[86:87]
v_bitop3_b32 v17,v64,v84,s57 bitop3:0x7e
v_cvt_pk_bf16_f32 v50,v12,v13
v_cvt_pk_bf16_f32 v51,v14,v15
v_or_b32 v16,v16,v17
ds_write_b128 v22,v[48:51] offset:0
s_waitcnt vmcnt(1)
v_pk_add_f32 v[12:13],v[68:69],v[88:89]
v_pk_add_f32 v[14:15],v[70:71],v[90:91]
v_bitop3_b32 v17,v68,v88,s57 bitop3:0x7e
v_cvt_pk_bf16_f32 v52,v12,v13
v_cvt_pk_bf16_f32 v53,v14,v15
v_or_b32 v16,v16,v17
s_waitcnt vmcnt(0)
v_pk_add_f32 v[12:13],v[72:73],v[92:93]
v_pk_add_f32 v[14:15],v[74:75],v[94:95]
v_bitop3_b32 v17,v72,v92,s57 bitop3:0x7e
v_cvt_pk_bf16_f32 v54,v12,v13
v_cvt_pk_bf16_f32 v55,v14,v15
v_bitop3_b32 v16,v16,v17,1 bitop3:0xa8
v_cmp_ne_u32 vcc,0,v16
ds_write_b128 v22,v[52:55] offset:1024
s_cbranch_vccnz fr_107
v_smfmac_f32_16x16x64_bf16 v[24:27],v[48:51],a[0:7],v2
ds_read_b128 v[72:75],v21 offset:0
v_smfmac_f32_16x16x64_bf16 v[28:31],v[48:51],a[8:15],v2
ds_read_b128 v[76:79],v21 offset:1024
v_smfmac_f32_16x16x64_bf16 v[32:35],v[48:51],a[16:23],v2
ds_read_b128 v[80:83],v21 offset:2048
v_smfmac_f32_16x16x64_bf16 v[36:39],v[48:51],a[24:31],v2
ds_read_b128 v[84:87],v21 offset:3072
s_waitcnt lgkmcnt(4)
s_barrier
v_smfmac_f32_16x16x64_bf16 v[40:43],v[48:51],a[32:39],v2
ds_read_b128 v[60:63],v3 offset:0
v_smfmac_f32_16x16x64_bf16 v[24:27],v[52:55],a[40:47],v2
ds_read_b128 v[64:67],v3 offset:1024
v_smfmac_f32_16x16x64_bf16 v[28:31],v[52:55],a[48:55],v2
ds_read_b128 v[68:71],v4 offset:0
v_smfmac_f32_16x16x64_bf16 v[32:35],v[52:55],a[56:63],v2
s_add_u32 m0,s74,12288
s_add_u32 s67,s73,25165824
v_smfmac_f32_16x16x64_bf16 v[36:39],v[52:55],a[64:71],v2
buffer_load_dwordx4 v1,s[8:11],s67 offen nt sc1 lds
v_smfmac_f32_16x16x64_bf16 v[40:43],v[52:55],a[72:79],v2
buffer_load_dwordx4 v1,s[8:11],s67 offen offset:1024 nt sc1 lds
s_waitcnt lgkmcnt(5)
v_smfmac_f32_16x16x64_bf16 v[44:47],v[48:51],v[72:79],v2
ds_read_b128 v[72:75],v21 offset:4096
s_waitcnt lgkmcnt(4)
v_smfmac_f32_16x16x64_bf16 v[44:47],v[52:55],v[80:87],v2
ds_read_b128 v[76:79],v21 offset:5120
s_waitcnt lgkmcnt(4)
v_smfmac_f32_16x16x64_bf16 v[24:27],v[60:63],a[80:87],v2
ds_read_b128 v[80:83],v21 offset:6144
v_smfmac_f32_16x16x64_bf16 v[28:31],v[60:63],a[88:95],v2
ds_read_b128 v[84:87],v21 offset:7168
v_smfmac_f32_16x16x64_bf16 v[32:35],v[60:63],a[96:103],v2
buffer_load_dwordx4 v1,s[8:11],s67 offen offset:2048 nt sc1 lds
v_smfmac_f32_16x16x64_bf16 v[36:39],v[60:63],a[104:111],v2
buffer_load_dwordx4 v1,s[8:11],s67 offen offset:3072 nt sc1 lds
v_smfmac_f32_16x16x64_bf16 v[40:43],v[60:63],a[112:119],v2
s_add_u32 m0,s74,16384
s_add_u32 s67,s73,25169920
s_waitcnt lgkmcnt(2)
v_smfmac_f32_16x16x64_bf16 v[44:47],v[60:63],v[72:79],v2
ds_read_b128 v[60:63],v4 offset:1024
v_smfmac_f32_16x16x64_bf16 v[24:27],v[64:67],a[120:127],v2
ds_read_b128 v[72:75],v21 offset:8192
v_smfmac_f32_16x16x64_bf16 v[28:31],v[64:67],a[128:135],v2
ds_read_b128 v[76:79],v21 offset:9216
v_smfmac_f32_16x16x64_bf16 v[32:35],v[64:67],a[136:143],v2
buffer_load_dwordx4 v1,s[8:11],s67 offen nt sc1 lds
v_smfmac_f32_16x16x64_bf16 v[36:39],v[64:67],a[144:151],v2
buffer_load_dwordx4 v1,s[8:11],s67 offen offset:1024 nt sc1 lds
v_smfmac_f32_16x16x64_bf16 v[40:43],v[64:67],a[152:159],v2
buffer_load_dwordx4 v1,s[8:11],s67 offen offset:2048 nt sc1 lds
s_waitcnt lgkmcnt(3)
v_smfmac_f32_16x16x64_bf16 v[44:47],v[64:67],v[80:87],v2
ds_read_b128 v[64:67],v5 offset:0
v_smfmac_f32_16x16x64_bf16 v[24:27],v[68:71],a[160:167],v2
ds_read_b128 v[80:83],v21 offset:10240
v_smfmac_f32_16x16x64_bf16 v[28:31],v[68:71],a[168:175],v2
ds_read_b128 v[84:87],v21 offset:11264
v_smfmac_f32_16x16x64_bf16 v[32:35],v[68:71],a[176:183],v2
buffer_load_dwordx4 v1,s[8:11],s67 offen offset:3072 nt sc1 lds
v_smfmac_f32_16x16x64_bf16 v[36:39],v[68:71],a[184:191],v2
s_add_u32 m0,s74,20480
s_add_u32 s67,s73,25174016
v_smfmac_f32_16x16x64_bf16 v[40:43],v[68:71],a[192:199],v2
buffer_load_dwordx4 v1,s[8:11],s67 offen nt sc1 lds
s_waitcnt lgkmcnt(3)
v_smfmac_f32_16x16x64_bf16 v[44:47],v[68:71],v[72:79],v2
ds_read_b128 v[68:71],v5 offset:1024
v_smfmac_f32_16x16x64_bf16 v[24:27],v[60:63],a[200:207],v2
ds_read_b128 v[72:75],v21 offset:12288
v_smfmac_f32_16x16x64_bf16 v[28:31],v[60:63],a[208:215],v2
ds_read_b128 v[76:79],v21 offset:13312
v_smfmac_f32_16x16x64_bf16 v[32:35],v[60:63],a[216:223],v2
buffer_load_dwordx4 v1,s[8:11],s67 offen offset:1024 nt sc1 lds
v_smfmac_f32_16x16x64_bf16 v[36:39],v[60:63],a[224:231],v2
buffer_load_dwordx4 v1,s[8:11],s67 offen offset:2048 nt sc1 lds
v_smfmac_f32_16x16x64_bf16 v[40:43],v[60:63],a[232:239],v2
buffer_load_dwordx4 v1,s[8:11],s67 offen offset:3072 nt sc1 lds
s_waitcnt lgkmcnt(3)
v_smfmac_f32_16x16x64_bf16 v[44:47],v[60:63],v[80:87],v2
ds_read_b128 v[60:63],v59 offset:0
v_smfmac_f32_16x16x64_bf16 v[24:27],v[64:67],a[240:247],v2
ds_read_b128 v[80:83],v21 offset:14336
v_smfmac_f32_16x16x64_bf16 v[28:31],v[64:67],a[248:255],v2
ds_read_b128 v[84:87],v21 offset:15360
v_smfmac_f32_16x16x64_bf16 v[32:35],v[64:67],v[112:119],v2
s_cmp_eq_u32 s79,-1
s_cbranch_scc1 pf_111
v_mov_b32 v17,1
s_mov_b64 exec,1
buffer_store_dword v17,v1,s[8:11],s79 offen sc1
s_mov_b64 exec,-1
s_mov_b32 s79,-1
pf_111:
v_smfmac_f32_16x16x64_bf16 v[36:39],v[64:67],v[120:127],v2
s_cmp_eq_u32 s78,-1
s_cbranch_scc1 pk_112
buffer_store_dwordx4 v[100:103],v20,s[8:11],s78 offen sc1
buffer_store_dwordx4 v[104:107],v20,s[8:11],s78 offen offset:1024 sc1
buffer_store_dwordx4 v[108:111],v20,s[8:11],s78 offen offset:2048 sc1
s_mov_b32 s79,s30
s_mov_b32 s78,-1
pk_112:
v_smfmac_f32_16x16x64_bf16 v[40:43],v[64:67],v[128:135],v2
buffer_load_dword v10,v9,s[8:11],s76 offen sc1
s_waitcnt lgkmcnt(3)
v_smfmac_f32_16x16x64_bf16 v[44:47],v[64:67],v[72:79],v2
ds_read_b128 v[64:67],v59 offset:1024
v_smfmac_f32_16x16x64_bf16 v[24:27],v[68:71],v[136:143],v2
ds_read_b128 v[72:75],v21 offset:16384
v_smfmac_f32_16x16x64_bf16 v[28:31],v[68:71],v[144:151],v2
ds_read_b128 v[76:79],v21 offset:17408
v_smfmac_f32_16x16x64_bf16 v[32:35],v[68:71],v[152:159],v2
v_smfmac_f32_16x16x64_bf16 v[36:39],v[68:71],v[160:167],v2
v_smfmac_f32_16x16x64_bf16 v[40:43],v[68:71],v[168:175],v2
s_waitcnt lgkmcnt(3)
v_smfmac_f32_16x16x64_bf16 v[44:47],v[68:71],v[80:87],v2
ds_read_b128 v[80:83],v21 offset:18432
v_smfmac_f32_16x16x64_bf16 v[24:27],v[60:63],v[176:183],v2
ds_read_b128 v[84:87],v21 offset:19456
v_smfmac_f32_16x16x64_bf16 v[36:39],v[60:63],v[200:207],v2
s_waitcnt lgkmcnt(4)
v_smfmac_f32_16x16x64_bf16 v[24:27],v[64:67],v[216:223],v2
v_smfmac_f32_16x16x64_bf16 v[36:39],v[64:67],v[240:247],v2
v_smfmac_f32_16x16x64_bf16 v[28:31],v[60:63],v[184:191],v2
v_smfmac_f32_16x16x64_bf16 v[40:43],v[60:63],v[208:215],v2
s_nop 4
v_add_f32 v24,v24,v25
v_smfmac_f32_16x16x64_bf16 v[28:31],v[64:67],v[224:231],v2
v_add_f32 v26,v26,v27
v_smfmac_f32_16x16x64_bf16 v[40:43],v[64:67],v[248:255],v2
v_add_f32 v36,v36,v37
v_smfmac_f32_16x16x64_bf16 v[32:35],v[60:63],v[192:199],v2
v_add_f32 v38,v38,v39
s_waitcnt lgkmcnt(2)
v_smfmac_f32_16x16x64_bf16 v[44:47],v[60:63],v[72:79],v2
v_cvt_pk_bf16_f32 v37,v24,v26
v_smfmac_f32_16x16x64_bf16 v[32:35],v[64:67],v[232:239],v2
v_cvt_pk_bf16_f32 v36,v36,v38
s_waitcnt lgkmcnt(0)
v_smfmac_f32_16x16x64_bf16 v[44:47],v[64:67],v[80:87],v2
ds_write_b64 v6,v[36:37] offset:0
v_add_f32 v28,v28,v29
v_add_f32 v30,v30,v31
v_add_f32 v40,v40,v41
v_add_f32 v42,v42,v43
v_cvt_pk_bf16_f32 v41,v28,v30
v_cvt_pk_bf16_f32 v40,v40,v42
ds_write_b64 v6,v[40:41] offset:512
v_add_f32 v32,v32,v33
v_add_f32 v34,v34,v35
v_add_f32 v44,v44,v45
v_add_f32 v46,v46,v47
v_cvt_pk_bf16_f32 v45,v32,v34
v_cvt_pk_bf16_f32 v44,v44,v46
ds_write_b64 v6,v[44:45] offset:1024
s_waitcnt lgkmcnt(0)
s_barrier
ds_read_b64_tr_b16 v[24:25],v7 offset:0
ds_read_b64_tr_b16 v[26:27],v7 offset:512
ds_read_b64_tr_b16 v[28:29],v7 offset:1024
ds_read_b64_tr_b16 v[30:31],v7 offset:1536
ds_read_b64_tr_b16 v[32:33],v7 offset:2048
ds_read_b64_tr_b16 v[34:35],v7 offset:2560
ds_read_b64_tr_b16 v[36:37],v7 offset:3072
ds_read_b64_tr_b16 v[38:39],v7 offset:3584
ds_read_b64_tr_b16 v[40:41],v7 offset:4096
ds_read_b64_tr_b16 v[42:43],v7 offset:4608
ds_read_b64_tr_b16 v[44:45],v7 offset:5120
ds_read_b64_tr_b16 v[46:47],v7 offset:5632
s_lshl_b32 s60,s51,6
s_add_u32 s60,s60,s52
s_mul_i32 s78,s60,196608
s_add_u32 s78,s78,s85
s_lshl_b32 s60,s60,10
s_add_u32 s30,s60,s86
s_and_b32 s60,s54,3
s_lshl2_add_u32 s60,s53,s60
s_lshl_b32 s68,s60,16
s_add_u32 s68,s68,s83
s_mul_i32 s59,s60,20480
s_add_u32 s59,s59,s6
s_lshl_b32 s69,s53,9
s_add_u32 s69,s69,s7
s_bfe_u32 s31,s54,0x10002
s_add_u32 s32,s54,1
s_mov_b64 vcc,s[90:91]
s_waitcnt lgkmcnt(0)
v_cndmask_b32_dpp v100,v28,v24,vcc quad_perm:[0,1,0,1] row_mask:0xf bank_mask:0xf
v_cndmask_b32_dpp v101,v29,v25,vcc quad_perm:[0,1,0,1] row_mask:0xf bank_mask:0xf
v_cndmask_b32_dpp v102,v30,v26,vcc quad_perm:[0,1,0,1] row_mask:0xf bank_mask:0xf
v_cndmask_b32_dpp v103,v31,v27,vcc quad_perm:[0,1,0,1] row_mask:0xf bank_mask:0xf
v_cndmask_b32_dpp v104,v36,v32,vcc quad_perm:[0,1,0,1] row_mask:0xf bank_mask:0xf
v_cndmask_b32_dpp v105,v37,v33,vcc quad_perm:[0,1,0,1] row_mask:0xf bank_mask:0xf
v_cndmask_b32_dpp v106,v38,v34,vcc quad_perm:[0,1,0,1] row_mask:0xf bank_mask:0xf
v_cndmask_b32_dpp v107,v39,v35,vcc quad_perm:[0,1,0,1] row_mask:0xf bank_mask:0xf
v_cndmask_b32_dpp v108,v44,v40,vcc quad_perm:[0,1,0,1] row_mask:0xf bank_mask:0xf
v_cndmask_b32_dpp v109,v45,v41,vcc quad_perm:[0,1,0,1] row_mask:0xf bank_mask:0xf
v_cndmask_b32_dpp v110,v46,v42,vcc quad_perm:[0,1,0,1] row_mask:0xf bank_mask:0xf
v_cndmask_b32_dpp v111,v47,v43,vcc quad_perm:[0,1,0,1] row_mask:0xf bank_mask:0xf
s_cmp_ge_u32 s54,63
s_cselect_b32 s77,0,s77
s_cmp_eq_u32 s53,s51
s_cselect_b32 s60,1,s77
s_cmp_eq_u32 s60,0
s_cbranch_scc1 nd_114
sp_115:
ds_read_b32 v12,v8
s_waitcnt lgkmcnt(0)
v_cmp_ge_u32 vcc,s50,v12
s_nop 0
s_cbranch_vccz ok_116
s_sleep 1
s_sub_u32 s47,s47,1
s_cbranch_scc1 ABORT
s_branch sp_115
ok_116:
s_waitcnt vmcnt(0)
s_cmp_eq_u32 s79,-1
s_cbranch_scc1 pf_117
v_mov_b32 v17,1
s_mov_b64 exec,1
buffer_store_dword v17,v1,s[8:11],s79 offen sc1
s_mov_b64 exec,-1
s_mov_b32 s79,-1
pf_117:
s_cmp_eq_u32 s78,-1
s_cbranch_scc1 pk_118
buffer_store_dwordx4 v[100:103],v20,s[8:11],s78 offen sc1
buffer_store_dwordx4 v[104:107],v20,s[8:11],s78 offen offset:1024 sc1
buffer_store_dwordx4 v[108:111],v20,s[8:11],s78 offen offset:2048 sc1
s_mov_b32 s79,s30
s_mov_b32 s78,-1
pk_118:
s_waitcnt vmcnt(0)
s_cmp_eq_u32 s79,-1
s_cbranch_scc1 pf_119
v_mov_b32 v17,1
s_mov_b64 exec,1
buffer_store_dword v17,v1,s[8:11],s79 offen sc1
s_mov_b64 exec,-1
s_mov_b32 s79,-1
pf_119:
nx_113:
s_cmp_eq_u32 s77,0
s_cbranch_scc1 nd_114
fl_120:
buffer_load_dword v12,v9,s[8:11],s75 offen sc1
s_waitcnt vmcnt(0)
v_cmp_eq_u32 vcc,0,v12
s_nop 0
s_cbranch_vccz ok_121
s_sleep 1
s_sub_u32 s47,s47,1
s_cbranch_scc1 ABORT
s_branch fl_120
ok_121:
s_add_u32 m0,s74,0
s_add_u32 s67,s73,0
buffer_load_dwordx4 v1,s[8:11],s67 offen nt sc1 lds
buffer_load_dwordx4 v1,s[8:11],s67 offen offset:1024 nt sc1 lds
buffer_load_dwordx4 v1,s[8:11],s67 offen offset:2048 nt sc1 lds
buffer_load_dwordx4 v1,s[8:11],s67 offen offset:3072 nt sc1 lds
s_add_u32 m0,s74,4096
s_add_u32 s67,s73,4096
buffer_load_dwordx4 v1,s[8:11],s67 offen nt sc1 lds
buffer_load_dwordx4 v1,s[8:11],s67 offen offset:1024 nt sc1 lds
buffer_load_dwordx4 v1,s[8:11],s67 offen offset:2048 nt sc1 lds
buffer_load_dwordx4 v1,s[8:11],s67 offen offset:3072 nt sc1 lds
s_add_u32 m0,s74,8192
s_add_u32 s67,s73,8192
buffer_load_dwordx4 v1,s[8:11],s67 offen nt sc1 lds
buffer_load_dwordx4 v1,s[8:11],s67 offen offset:1024 nt sc1 lds
buffer_load_dwordx4 v1,s[8:11],s67 offen offset:2048 nt sc1 lds
buffer_load_dwordx4 v1,s[8:11],s67 offen offset:3072 nt sc1 lds
s_add_u32 m0,s74,12288
s_add_u32 s67,s73,25165824
buffer_load_dwordx4 v1,s[8:11],s67 offen nt sc1 lds
buffer_load_dwordx4 v1,s[8:11],s67 offen offset:1024 nt sc1 lds
buffer_load_dwordx4 v1,s[8:11],s67 offen offset:2048 nt sc1 lds
buffer_load_dwordx4 v1,s[8:11],s67 offen offset:3072 nt sc1 lds
s_add_u32 m0,s74,16384
s_add_u32 s67,s73,25169920
buffer_load_dwordx4 v1,s[8:11],s67 offen nt sc1 lds
buffer_load_dwordx4 v1,s[8:11],s67 offen offset:1024 nt sc1 lds
buffer_load_dwordx4 v1,s[8:11],s67 offen offset:2048 nt sc1 lds
buffer_load_dwordx4 v1,s[8:11],s67 offen offset:3072 nt sc1 lds
s_add_u32 m0,s74,20480
s_add_u32 s67,s73,25174016
buffer_load_dwordx4 v1,s[8:11],s67 offen nt sc1 lds
buffer_load_dwordx4 v1,s[8:11],s67 offen offset:1024 nt sc1 lds
buffer_load_dwordx4 v1,s[8:11],s67 offen offset:2048 nt sc1 lds
buffer_load_dwordx4 v1,s[8:11],s67 offen offset:3072 nt sc1 lds
nd_114:
s_add_u32 s50,s50,1
s_mov_b32 s51,s53
s_mov_b32 s52,s54
s_mov_b32 s57,s31
s_mov_b32 s58,s32
s_mov_b32 s53,s55
s_mov_b32 s54,s56
s_mov_b32 s75,s76
s_sub_u32 s60,s4,s5
s_cmp_gt_i32 s60,14
s_cselect_b32 s55,1,0
s_cmp_eq_u32 s4,64
s_cselect_b32 s55,1,s55
s_cmp_eq_u32 s55,0
s_cselect_b32 s56,s4,s5
s_addc_u32 s4,s4,0
s_add_u32 s5,s5,s55
s_lshl_b32 s76,s55,6
s_add_u32 s76,s76,s56
s_lshl_b32 s76,s76,9
s_add_u32 s76,s76,131072
s_mul_i32 s73,s54,393216
s_add_u32 s73,s73,s84
s_xor_b32 s74,s74,57344
s_waitcnt vmcnt(0)
v_cmp_eq_u32 vcc,0,v10
s_cmp_lg_u64 vcc,0
s_cselect_b32 s77,1,0
s_cmp_lt_u32 s50,128
s_cbranch_scc1 CH_LOOP
s_branch CS_DONE
fr_107:
v_bitop3_b32 v12,v60,v64,s57 bitop3:0x7e
v_bitop3_b32 v13,v68,v72,s57 bitop3:0x7e
v_xor_b32 v14,s57,v76
v_or3_b32 v12,v12,v13,v14
v_and_b32 v12,1,v12
v_cmp_ne_u32 vcc,0,v12
s_cbranch_vccz sk_122
buffer_load_dwordx4 v[76:79],v18,s[8:11],s59 offen sc1
buffer_load_dwordx4 v[60:63],v1,s[8:11],s59 offen sc1
buffer_load_dwordx4 v[64:67],v1,s[8:11],s59 offen offset:1024 sc1
buffer_load_dwordx4 v[68:71],v1,s[8:11],s59 offen offset:2048 sc1
buffer_load_dwordx4 v[72:75],v1,s[8:11],s59 offen offset:3072 sc1
sk_122:
buffer_load_dwordx4 v[96:99],v18,s[8:11],s68 offen sc1
buffer_load_dwordx4 v[80:83],v1,s[8:11],s68 offen sc1
buffer_load_dwordx4 v[84:87],v1,s[8:11],s68 offen offset:1024 sc1
buffer_load_dwordx4 v[88:91],v1,s[8:11],s68 offen offset:2048 sc1
buffer_load_dwordx4 v[92:95],v1,s[8:11],s68 offen offset:3072 sc1
s_sub_u32 s47,s47,1
s_cbranch_scc1 ABORT
s_waitcnt lgkmcnt(0)
s_branch fa_106
CS_DONE:
s_add_u32 s61,s48,0
s_endpgm
CV_START:
s_and_b32 s60,s46,1
s_lshl1_add_u32 s60,s49,s60
s_cmp_eq_u32 s60,1
s_cbranch_scc1 CV_LOOP_F1
s_cmp_eq_u32 s60,2
s_cbranch_scc1 CV_LOOP_S0
s_cmp_eq_u32 s60,3
s_cbranch_scc1 CV_LOOP_S1
CV_LOOP_F0:
v_mov_b32 v24,0
v_mov_b32 v25,0
v_mov_b32 v26,0
v_mov_b32 v27,0
v_mov_b32 v28,0
v_mov_b32 v29,0
v_mov_b32 v30,0
v_mov_b32 v31,0
v_mov_b32 v32,0
v_mov_b32 v33,0
v_mov_b32 v34,0
v_mov_b32 v35,0
v_mov_b32 v36,0
v_mov_b32 v37,0
v_mov_b32 v38,0
v_mov_b32 v39,0
v_mov_b32 v40,0
v_mov_b32 v41,0
v_mov_b32 v42,0
v_mov_b32 v43,0
v_mov_b32 v44,0
v_mov_b32 v45,0
v_mov_b32 v46,0
v_mov_b32 v47,0
s_cmp_lg_u32 s46,0
s_cbranch_scc1 np_126
db_127:
buffer_load_dword v12,v11,s[8:11],s69 offen sc1
s_waitcnt vmcnt(0)
v_cmp_gt_u32 vcc,s58,v12
s_cbranch_vccz dbok_128
s_sub_u32 s47,s47,1
s_cbranch_scc1 ABORT
s_branch db_127
dbok_128:
np_126:
s_barrier
buffer_load_dwordx4 v[76:79],v18,s[8:11],s59 offen sc1
buffer_load_dwordx4 v[60:63],v1,s[8:11],s59 offen sc1
buffer_load_dwordx4 v[64:67],v1,s[8:11],s59 offen offset:1024 sc1
buffer_load_dwordx4 v[68:71],v1,s[8:11],s59 offen offset:2048 sc1
buffer_load_dwordx4 v[72:75],v1,s[8:11],s59 offen offset:3072 sc1
s_waitcnt vmcnt(4)
buffer_load_dwordx4 v[96:99],v18,s[8:11],s68 offen sc1
buffer_load_dwordx4 v[80:83],v1,s[8:11],s68 offen sc1
buffer_load_dwordx4 v[84:87],v1,s[8:11],s68 offen offset:1024 sc1
buffer_load_dwordx4 v[88:91],v1,s[8:11],s68 offen offset:2048 sc1
buffer_load_dwordx4 v[92:95],v1,s[8:11],s68 offen offset:3072 sc1
fj_125:
fa_123:
s_waitcnt vmcnt(4)
v_pk_add_f32 v[12:13],v[76:77],v[96:97]
v_pk_add_f32 v[14:15],v[78:79],v[98:99]
v_bitop3_b32 v16,v76,v96,s57 bitop3:0x7e
v_cvt_pk_bf16_f32 v56,v12,v13
v_cvt_pk_bf16_f32 v57,v14,v15
ds_write_b64 v23,v[56:57]
s_waitcnt vmcnt(3)
v_pk_add_f32 v[12:13],v[60:61],v[80:81]
v_pk_add_f32 v[14:15],v[62:63],v[82:83]
v_bitop3_b32 v17,v60,v80,s57 bitop3:0x7e
v_cvt_pk_bf16_f32 v48,v12,v13
v_cvt_pk_bf16_f32 v49,v14,v15
v_or_b32 v16,v16,v17
s_waitcnt vmcnt(2)
v_pk_add_f32 v[12:13],v[64:65],v[84:85]
v_pk_add_f32 v[14:15],v[66:67],v[86:87]
v_bitop3_b32 v17,v64,v84,s57 bitop3:0x7e
v_cvt_pk_bf16_f32 v50,v12,v13
v_cvt_pk_bf16_f32 v51,v14,v15
v_or_b32 v16,v16,v17
ds_write_b128 v22,v[48:51] offset:0
s_waitcnt vmcnt(1)
v_pk_add_f32 v[12:13],v[68:69],v[88:89]
v_pk_add_f32 v[14:15],v[70:71],v[90:91]
v_bitop3_b32 v17,v68,v88,s57 bitop3:0x7e
v_cvt_pk_bf16_f32 v52,v12,v13
v_cvt_pk_bf16_f32 v53,v14,v15
v_or_b32 v16,v16,v17
s_waitcnt vmcnt(0)
v_pk_add_f32 v[12:13],v[72:73],v[92:93]
v_pk_add_f32 v[14:15],v[74:75],v[94:95]
v_bitop3_b32 v17,v72,v92,s57 bitop3:0x7e
v_cvt_pk_bf16_f32 v54,v12,v13
v_cvt_pk_bf16_f32 v55,v14,v15
v_bitop3_b32 v16,v16,v17,1 bitop3:0xa8
v_cmp_ne_u32 vcc,0,v16
ds_write_b128 v22,v[52:55] offset:1024
s_cbranch_vccnz fr_124
v_smfmac_f32_16x16x64_bf16 v[24:27],v[48:51],a[0:7],v2
ds_read_b128 v[72:75],v21 offset:0
s_and_b32 s60,s52,3
v_smfmac_f32_16x16x64_bf16 v[28:31],v[48:51],a[8:15],v2
ds_read_b128 v[76:79],v21 offset:1024
s_lshl2_add_u32 s60,s51,s60
v_smfmac_f32_16x16x64_bf16 v[32:35],v[48:51],a[16:23],v2
ds_read_b128 v[80:83],v21 offset:2048
s_mul_i32 s60,s60,49152
v_smfmac_f32_16x16x64_bf16 v[36:39],v[48:51],a[24:31],v2
ds_read_b128 v[84:87],v21 offset:3072
s_add_u32 s71,s60,s34
s_waitcnt lgkmcnt(4)
s_barrier
v_smfmac_f32_16x16x64_bf16 v[40:43],v[48:51],a[32:39],v2
ds_read_b128 v[60:63],v3 offset:0
v_smfmac_f32_16x16x64_bf16 v[24:27],v[52:55],a[40:47],v2
ds_read_b128 v[64:67],v3 offset:1024
v_smfmac_f32_16x16x64_bf16 v[28:31],v[52:55],a[48:55],v2
ds_read_b128 v[68:71],v4 offset:0
v_smfmac_f32_16x16x64_bf16 v[32:35],v[52:55],a[56:63],v2
v_smfmac_f32_16x16x64_bf16 v[36:39],v[52:55],a[64:71],v2
v_smfmac_f32_16x16x64_bf16 v[40:43],v[52:55],a[72:79],v2
s_waitcnt lgkmcnt(5)
v_smfmac_f32_16x16x64_bf16 v[44:47],v[48:51],v[72:79],v2
ds_read_b128 v[72:75],v21 offset:4096
s_waitcnt lgkmcnt(4)
v_smfmac_f32_16x16x64_bf16 v[44:47],v[52:55],v[80:87],v2
ds_read_b128 v[76:79],v21 offset:5120
s_waitcnt lgkmcnt(4)
v_smfmac_f32_16x16x64_bf16 v[24:27],v[60:63],a[80:87],v2
ds_read_b128 v[80:83],v21 offset:6144
v_smfmac_f32_16x16x64_bf16 v[28:31],v[60:63],a[88:95],v2
ds_read_b128 v[84:87],v21 offset:7168
v_smfmac_f32_16x16x64_bf16 v[32:35],v[60:63],a[96:103],v2
v_smfmac_f32_16x16x64_bf16 v[36:39],v[60:63],a[104:111],v2
v_smfmac_f32_16x16x64_bf16 v[40:43],v[60:63],a[112:119],v2
s_waitcnt lgkmcnt(2)
v_smfmac_f32_16x16x64_bf16 v[44:47],v[60:63],v[72:79],v2
ds_read_b128 v[60:63],v4 offset:1024
v_smfmac_f32_16x16x64_bf16 v[24:27],v[64:67],a[120:127],v2
ds_read_b128 v[72:75],v21 offset:8192
v_smfmac_f32_16x16x64_bf16 v[28:31],v[64:67],a[128:135],v2
ds_read_b128 v[76:79],v21 offset:9216
v_smfmac_f32_16x16x64_bf16 v[32:35],v[64:67],a[136:143],v2
v_smfmac_f32_16x16x64_bf16 v[36:39],v[64:67],a[144:151],v2
v_smfmac_f32_16x16x64_bf16 v[40:43],v[64:67],a[152:159],v2
s_waitcnt lgkmcnt(3)
v_smfmac_f32_16x16x64_bf16 v[44:47],v[64:67],v[80:87],v2
ds_read_b128 v[64:67],v5 offset:0
v_smfmac_f32_16x16x64_bf16 v[24:27],v[68:71],a[160:167],v2
ds_read_b128 v[80:83],v21 offset:10240
v_smfmac_f32_16x16x64_bf16 v[28:31],v[68:71],a[168:175],v2
ds_read_b128 v[84:87],v21 offset:11264
v_smfmac_f32_16x16x64_bf16 v[32:35],v[68:71],a[176:183],v2
v_smfmac_f32_16x16x64_bf16 v[36:39],v[68:71],a[184:191],v2
v_smfmac_f32_16x16x64_bf16 v[40:43],v[68:71],a[192:199],v2
s_waitcnt lgkmcnt(3)
v_smfmac_f32_16x16x64_bf16 v[44:47],v[68:71],v[72:79],v2
ds_read_b128 v[68:71],v5 offset:1024
v_smfmac_f32_16x16x64_bf16 v[24:27],v[60:63],a[200:207],v2
ds_read_b128 v[72:75],v21 offset:12288
v_smfmac_f32_16x16x64_bf16 v[28:31],v[60:63],a[208:215],v2
ds_read_b128 v[76:79],v21 offset:13312
v_smfmac_f32_16x16x64_bf16 v[32:35],v[60:63],a[216:223],v2
v_smfmac_f32_16x16x64_bf16 v[36:39],v[60:63],a[224:231],v2
v_smfmac_f32_16x16x64_bf16 v[40:43],v[60:63],a[232:239],v2
s_waitcnt lgkmcnt(3)
v_smfmac_f32_16x16x64_bf16 v[44:47],v[60:63],v[80:87],v2
ds_read_b128 v[60:63],v59 offset:0
v_smfmac_f32_16x16x64_bf16 v[24:27],v[64:67],a[240:247],v2
ds_read_b128 v[80:83],v21 offset:14336
v_smfmac_f32_16x16x64_bf16 v[28:31],v[64:67],a[248:255],v2
ds_read_b128 v[84:87],v21 offset:15360
v_smfmac_f32_16x16x64_bf16 v[32:35],v[64:67],v[112:119],v2
s_cmp_eq_u32 s79,-1
s_cbranch_scc1 pf_129
v_mov_b32 v17,1
s_mov_b64 exec,1
buffer_store_dword v17,v1,s[8:11],s79 offen sc1
s_mov_b64 exec,-1
s_mov_b32 s79,-1
pf_129:
v_smfmac_f32_16x16x64_bf16 v[36:39],v[64:67],v[120:127],v2
s_cmp_eq_u32 s78,-1
s_cbranch_scc1 pk_130
buffer_store_dwordx4 v[100:103],v6,s[8:11],s78 offen sc1
buffer_store_dwordx2 v[104:105],v7,s[8:11],s78 offen sc1
s_mov_b32 s79,s30
s_mov_b32 s78,-1
pk_130:
v_smfmac_f32_16x16x64_bf16 v[40:43],v[64:67],v[128:135],v2
s_waitcnt lgkmcnt(3)
v_smfmac_f32_16x16x64_bf16 v[44:47],v[64:67],v[72:79],v2
ds_read_b128 v[64:67],v59 offset:1024
v_smfmac_f32_16x16x64_bf16 v[24:27],v[68:71],v[136:143],v2
ds_read_b128 v[72:75],v21 offset:16384
v_smfmac_f32_16x16x64_bf16 v[28:31],v[68:71],v[144:151],v2
ds_read_b128 v[76:79],v21 offset:17408
v_smfmac_f32_16x16x64_bf16 v[32:35],v[68:71],v[152:159],v2
v_smfmac_f32_16x16x64_bf16 v[36:39],v[68:71],v[160:167],v2
v_smfmac_f32_16x16x64_bf16 v[40:43],v[68:71],v[168:175],v2
s_waitcnt lgkmcnt(3)
v_smfmac_f32_16x16x64_bf16 v[44:47],v[68:71],v[80:87],v2
ds_read_b128 v[80:83],v21 offset:18432
v_smfmac_f32_16x16x64_bf16 v[24:27],v[60:63],v[176:183],v2
ds_read_b128 v[84:87],v21 offset:19456
v_smfmac_f32_16x16x64_bf16 v[28:31],v[60:63],v[184:191],v2
s_waitcnt lgkmcnt(4)
v_smfmac_f32_16x16x64_bf16 v[24:27],v[64:67],v[216:223],v2
v_smfmac_f32_16x16x64_bf16 v[28:31],v[64:67],v[224:231],v2
v_smfmac_f32_16x16x64_bf16 v[32:35],v[60:63],v[192:199],v2
v_smfmac_f32_16x16x64_bf16 v[36:39],v[60:63],v[200:207],v2
s_nop 4
v_add_f32 v24,v24,v25
v_smfmac_f32_16x16x64_bf16 v[32:35],v[64:67],v[232:239],v2
v_add_f32 v26,v26,v27
v_smfmac_f32_16x16x64_bf16 v[36:39],v[64:67],v[240:247],v2
v_add_f32 v28,v28,v29
v_smfmac_f32_16x16x64_bf16 v[40:43],v[60:63],v[208:215],v2
v_add_f32 v30,v30,v31
s_waitcnt lgkmcnt(2)
v_smfmac_f32_16x16x64_bf16 v[44:47],v[60:63],v[72:79],v2
v_cvt_pk_bf16_f32 v100,v24,v26
v_smfmac_f32_16x16x64_bf16 v[40:43],v[64:67],v[248:255],v2
v_cvt_pk_bf16_f32 v101,v28,v30
s_waitcnt lgkmcnt(0)
v_smfmac_f32_16x16x64_bf16 v[44:47],v[64:67],v[80:87],v2
v_and_or_b32 v100,v100,-2,s57
v_add_f32 v32,v32,v33
v_add_f32 v34,v34,v35
v_add_f32 v36,v36,v37
v_add_f32 v38,v38,v39
v_cvt_pk_bf16_f32 v102,v32,v34
v_cvt_pk_bf16_f32 v103,v36,v38
v_and_or_b32 v102,v102,-2,s57
buffer_store_dwordx4 v[100:103],v6,s[8:11],s71 offen
v_add_f32 v40,v40,v41
v_add_f32 v42,v42,v43
v_add_f32 v44,v44,v45
v_add_f32 v46,v46,v47
v_cvt_pk_bf16_f32 v104,v40,v42
v_cvt_pk_bf16_f32 v105,v44,v46
v_and_or_b32 v104,v104,-2,s57
buffer_store_dwordx2 v[104:105],v7,s[8:11],s71 offen
s_lshl_b32 s60,s51,6
s_add_u32 s60,s60,s52
s_mul_i32 s78,s60,196608
s_add_u32 s78,s78,s85
s_lshl_b32 s60,s60,10
s_add_u32 s30,s60,s86
s_sub_u32 s60,s4,s5
s_cmp_gt_i32 s60,14
s_cselect_b32 s53,1,0
s_cmp_eq_u32 s4,64
s_cselect_b32 s53,1,s53
s_cmp_eq_u32 s53,0
s_cselect_b32 s54,s4,s5
s_addc_u32 s4,s4,0
s_add_u32 s5,s5,s53
s_and_b32 s60,s54,3
s_lshl2_add_u32 s60,s53,s60
s_lshl_b32 s68,s60,16
s_add_u32 s68,s68,s83
s_mul_i32 s59,s60,20480
s_add_u32 s59,s59,s6
s_lshl_b32 s69,s53,9
s_add_u32 s69,s69,s7
s_bfe_u32 s31,s54,0x10002
s_add_u32 s32,s54,1
s_cmp_lg_u32 s53,s51
s_cbranch_scc1 nx_131
s_waitcnt vmcnt(0)
s_cmp_eq_u32 s79,-1
s_cbranch_scc1 pf_132
v_mov_b32 v17,1
s_mov_b64 exec,1
buffer_store_dword v17,v1,s[8:11],s79 offen sc1
s_mov_b64 exec,-1
s_mov_b32 s79,-1
pf_132:
s_cmp_eq_u32 s78,-1
s_cbranch_scc1 pk_133
buffer_store_dwordx4 v[100:103],v6,s[8:11],s78 offen sc1
buffer_store_dwordx2 v[104:105],v7,s[8:11],s78 offen sc1
s_mov_b32 s79,s30
s_mov_b32 s78,-1
pk_133:
s_waitcnt vmcnt(0)
s_cmp_eq_u32 s79,-1
s_cbranch_scc1 pf_134
v_mov_b32 v17,1
s_mov_b64 exec,1
buffer_store_dword v17,v1,s[8:11],s79 offen sc1
s_mov_b64 exec,-1
s_mov_b32 s79,-1
pf_134:
nx_131:
s_add_u32 s50,s50,1
s_mov_b32 s51,s53
s_mov_b32 s52,s54
s_mov_b32 s57,s31
s_mov_b32 s58,s32
s_cmp_lt_u32 s50,128
s_cbranch_scc1 CV_LOOP_F0
s_branch CV_DONE
fr_124:
v_bitop3_b32 v12,v60,v64,s57 bitop3:0x7e
v_bitop3_b32 v13,v68,v72,s57 bitop3:0x7e
v_xor_b32 v14,s57,v76
v_or3_b32 v12,v12,v13,v14
v_and_b32 v12,1,v12
v_cmp_ne_u32 vcc,0,v12
s_cbranch_vccz sk_135
buffer_load_dwordx4 v[76:79],v18,s[8:11],s59 offen sc1
buffer_load_dwordx4 v[60:63],v1,s[8:11],s59 offen sc1
buffer_load_dwordx4 v[64:67],v1,s[8:11],s59 offen offset:1024 sc1
buffer_load_dwordx4 v[68:71],v1,s[8:11],s59 offen offset:2048 sc1
buffer_load_dwordx4 v[72:75],v1,s[8:11],s59 offen offset:3072 sc1
sk_135:
buffer_load_dwordx4 v[96:99],v18,s[8:11],s68 offen sc1
buffer_load_dwordx4 v[80:83],v1,s[8:11],s68 offen sc1
buffer_load_dwordx4 v[84:87],v1,s[8:11],s68 offen offset:1024 sc1
buffer_load_dwordx4 v[88:91],v1,s[8:11],s68 offen offset:2048 sc1
buffer_load_dwordx4 v[92:95],v1,s[8:11],s68 offen offset:3072 sc1
s_sub_u32 s47,s47,1
s_cbranch_scc1 ABORT
s_waitcnt lgkmcnt(0)
s_branch fa_123
CV_LOOP_F1:
v_mov_b32 v24,0
v_mov_b32 v25,0
v_mov_b32 v26,0
v_mov_b32 v27,0
v_mov_b32 v28,0
v_mov_b32 v29,0
v_mov_b32 v30,0
v_mov_b32 v31,0
v_mov_b32 v32,0
v_mov_b32 v33,0
v_mov_b32 v34,0
v_mov_b32 v35,0
v_mov_b32 v36,0
v_mov_b32 v37,0
v_mov_b32 v38,0
v_mov_b32 v39,0
v_mov_b32 v40,0
v_mov_b32 v41,0
v_mov_b32 v42,0
v_mov_b32 v43,0
v_mov_b32 v44,0
v_mov_b32 v45,0
v_mov_b32 v46,0
v_mov_b32 v47,0
s_barrier
buffer_load_dwordx4 v[76:79],v18,s[8:11],s59 offen sc1
buffer_load_dwordx4 v[60:63],v1,s[8:11],s59 offen sc1
buffer_load_dwordx4 v[64:67],v1,s[8:11],s59 offen offset:1024 sc1
buffer_load_dwordx4 v[68:71],v1,s[8:11],s59 offen offset:2048 sc1
buffer_load_dwordx4 v[72:75],v1,s[8:11],s59 offen offset:3072 sc1
s_waitcnt vmcnt(4)
buffer_load_dwordx4 v[96:99],v18,s[8:11],s68 offen sc1
buffer_load_dwordx4 v[80:83],v1,s[8:11],s68 offen sc1
buffer_load_dwordx4 v[84:87],v1,s[8:11],s68 offen offset:1024 sc1
buffer_load_dwordx4 v[88:91],v1,s[8:11],s68 offen offset:2048 sc1
buffer_load_dwordx4 v[92:95],v1,s[8:11],s68 offen offset:3072 sc1
fj_138:
fa_136:
s_waitcnt vmcnt(4)
v_pk_add_f32 v[12:13],v[76:77],v[96:97]
v_pk_add_f32 v[14:15],v[78:79],v[98:99]
v_bitop3_b32 v16,v76,v96,s57 bitop3:0x7e
v_cvt_pk_bf16_f32 v56,v12,v13
v_cvt_pk_bf16_f32 v57,v14,v15
ds_write_b64 v23,v[56:57]
s_waitcnt vmcnt(3)
v_pk_add_f32 v[12:13],v[60:61],v[80:81]
v_pk_add_f32 v[14:15],v[62:63],v[82:83]
v_bitop3_b32 v17,v60,v80,s57 bitop3:0x7e
v_cvt_pk_bf16_f32 v48,v12,v13
v_cvt_pk_bf16_f32 v49,v14,v15
v_or_b32 v16,v16,v17
s_waitcnt vmcnt(2)
v_pk_add_f32 v[12:13],v[64:65],v[84:85]
v_pk_add_f32 v[14:15],v[66:67],v[86:87]
v_bitop3_b32 v17,v64,v84,s57 bitop3:0x7e
v_cvt_pk_bf16_f32 v50,v12,v13
v_cvt_pk_bf16_f32 v51,v14,v15
v_or_b32 v16,v16,v17
ds_write_b128 v22,v[48:51] offset:0
s_waitcnt vmcnt(1)
v_pk_add_f32 v[12:13],v[68:69],v[88:89]
v_pk_add_f32 v[14:15],v[70:71],v[90:91]
v_bitop3_b32 v17,v68,v88,s57 bitop3:0x7e
v_cvt_pk_bf16_f32 v52,v12,v13
v_cvt_pk_bf16_f32 v53,v14,v15
v_or_b32 v16,v16,v17
s_waitcnt vmcnt(0)
v_pk_add_f32 v[12:13],v[72:73],v[92:93]
v_pk_add_f32 v[14:15],v[74:75],v[94:95]
v_bitop3_b32 v17,v72,v92,s57 bitop3:0x7e
v_cvt_pk_bf16_f32 v54,v12,v13
v_cvt_pk_bf16_f32 v55,v14,v15
v_bitop3_b32 v16,v16,v17,1 bitop3:0xa8
v_cmp_ne_u32 vcc,0,v16
ds_write_b128 v22,v[52:55] offset:1024
s_cbranch_vccnz fr_137
v_smfmac_f32_16x16x64_bf16 v[24:27],v[48:51],a[0:7],v2
ds_read_b128 v[72:75],v21 offset:0
s_and_b32 s60,s52,3
v_smfmac_f32_16x16x64_bf16 v[28:31],v[48:51],a[8:15],v2
ds_read_b128 v[76:79],v21 offset:1024
s_lshl2_add_u32 s60,s51,s60
v_smfmac_f32_16x16x64_bf16 v[32:35],v[48:51],a[16:23],v2
ds_read_b128 v[80:83],v21 offset:2048
s_mul_i32 s60,s60,49152
v_smfmac_f32_16x16x64_bf16 v[36:39],v[48:51],a[24:31],v2
ds_read_b128 v[84:87],v21 offset:3072
s_add_u32 s71,s60,s34
s_waitcnt lgkmcnt(4)
s_barrier
v_smfmac_f32_16x16x64_bf16 v[40:43],v[48:51],a[32:39],v2
ds_read_b128 v[60:63],v3 offset:0
v_smfmac_f32_16x16x64_bf16 v[24:27],v[52:55],a[40:47],v2
ds_read_b128 v[64:67],v3 offset:1024
v_smfmac_f32_16x16x64_bf16 v[28:31],v[52:55],a[48:55],v2
ds_read_b128 v[68:71],v4 offset:0
v_smfmac_f32_16x16x64_bf16 v[32:35],v[52:55],a[56:63],v2
v_smfmac_f32_16x16x64_bf16 v[36:39],v[52:55],a[64:71],v2
v_smfmac_f32_16x16x64_bf16 v[40:43],v[52:55],a[72:79],v2
s_waitcnt lgkmcnt(5)
v_smfmac_f32_16x16x64_bf16 v[44:47],v[48:51],v[72:79],v2
ds_read_b128 v[72:75],v21 offset:4096
s_waitcnt lgkmcnt(4)
v_smfmac_f32_16x16x64_bf16 v[44:47],v[52:55],v[80:87],v2
ds_read_b128 v[76:79],v21 offset:5120
s_waitcnt lgkmcnt(4)
v_smfmac_f32_16x16x64_bf16 v[24:27],v[60:63],a[80:87],v2
ds_read_b128 v[80:83],v21 offset:6144
v_smfmac_f32_16x16x64_bf16 v[28:31],v[60:63],a[88:95],v2
ds_read_b128 v[84:87],v21 offset:7168
v_smfmac_f32_16x16x64_bf16 v[32:35],v[60:63],a[96:103],v2
v_smfmac_f32_16x16x64_bf16 v[36:39],v[60:63],a[104:111],v2
v_smfmac_f32_16x16x64_bf16 v[40:43],v[60:63],a[112:119],v2
s_waitcnt lgkmcnt(2)
v_smfmac_f32_16x16x64_bf16 v[44:47],v[60:63],v[72:79],v2
ds_read_b128 v[60:63],v4 offset:1024
v_smfmac_f32_16x16x64_bf16 v[24:27],v[64:67],a[120:127],v2
ds_read_b128 v[72:75],v21 offset:8192
v_smfmac_f32_16x16x64_bf16 v[28:31],v[64:67],a[128:135],v2
ds_read_b128 v[76:79],v21 offset:9216
v_smfmac_f32_16x16x64_bf16 v[32:35],v[64:67],a[136:143],v2
v_smfmac_f32_16x16x64_bf16 v[36:39],v[64:67],a[144:151],v2
v_smfmac_f32_16x16x64_bf16 v[40:43],v[64:67],a[152:159],v2
s_waitcnt lgkmcnt(3)
v_smfmac_f32_16x16x64_bf16 v[44:47],v[64:67],v[80:87],v2
ds_read_b128 v[64:67],v5 offset:0
v_smfmac_f32_16x16x64_bf16 v[24:27],v[68:71],a[160:167],v2
ds_read_b128 v[80:83],v21 offset:10240
v_smfmac_f32_16x16x64_bf16 v[28:31],v[68:71],a[168:175],v2
ds_read_b128 v[84:87],v21 offset:11264
v_smfmac_f32_16x16x64_bf16 v[32:35],v[68:71],a[176:183],v2
v_smfmac_f32_16x16x64_bf16 v[36:39],v[68:71],a[184:191],v2
v_smfmac_f32_16x16x64_bf16 v[40:43],v[68:71],a[192:199],v2
s_waitcnt lgkmcnt(3)
v_smfmac_f32_16x16x64_bf16 v[44:47],v[68:71],v[72:79],v2
ds_read_b128 v[68:71],v5 offset:1024
v_smfmac_f32_16x16x64_bf16 v[24:27],v[60:63],a[200:207],v2
ds_read_b128 v[72:75],v21 offset:12288
v_smfmac_f32_16x16x64_bf16 v[28:31],v[60:63],a[208:215],v2
ds_read_b128 v[76:79],v21 offset:13312
v_smfmac_f32_16x16x64_bf16 v[32:35],v[60:63],a[216:223],v2
v_smfmac_f32_16x16x64_bf16 v[36:39],v[60:63],a[224:231],v2
v_smfmac_f32_16x16x64_bf16 v[40:43],v[60:63],a[232:239],v2
s_waitcnt lgkmcnt(3)
v_smfmac_f32_16x16x64_bf16 v[44:47],v[60:63],v[80:87],v2
ds_read_b128 v[60:63],v59 offset:0
v_smfmac_f32_16x16x64_bf16 v[24:27],v[64:67],a[240:247],v2
ds_read_b128 v[80:83],v21 offset:14336
v_smfmac_f32_16x16x64_bf16 v[28:31],v[64:67],a[248:255],v2
ds_read_b128 v[84:87],v21 offset:15360
v_smfmac_f32_16x16x64_bf16 v[32:35],v[64:67],v[112:119],v2
s_cmp_eq_u32 s79,-1
s_cbranch_scc1 pf_139
v_mov_b32 v17,1
s_mov_b64 exec,1
buffer_store_dword v17,v1,s[8:11],s79 offen sc1
s_mov_b64 exec,-1
s_mov_b32 s79,-1
pf_139:
v_smfmac_f32_16x16x64_bf16 v[36:39],v[64:67],v[120:127],v2
s_cmp_eq_u32 s78,-1
s_cbranch_scc1 pk_140
buffer_store_dwordx4 v[102:105],v6,s[8:11],s78 offen sc1
buffer_store_dwordx2 v[100:101],v7,s[8:11],s78 offen sc1
s_mov_b32 s79,s30
s_mov_b32 s78,-1
pk_140:
v_smfmac_f32_16x16x64_bf16 v[40:43],v[64:67],v[128:135],v2
s_waitcnt lgkmcnt(3)
v_smfmac_f32_16x16x64_bf16 v[44:47],v[64:67],v[72:79],v2
ds_read_b128 v[64:67],v59 offset:1024
v_smfmac_f32_16x16x64_bf16 v[24:27],v[68:71],v[136:143],v2
ds_read_b128 v[72:75],v21 offset:16384
v_smfmac_f32_16x16x64_bf16 v[28:31],v[68:71],v[144:151],v2
ds_read_b128 v[76:79],v21 offset:17408
v_smfmac_f32_16x16x64_bf16 v[32:35],v[68:71],v[152:159],v2
v_smfmac_f32_16x16x64_bf16 v[36:39],v[68:71],v[160:167],v2
v_smfmac_f32_16x16x64_bf16 v[40:43],v[68:71],v[168:175],v2
s_waitcnt lgkmcnt(3)
v_smfmac_f32_16x16x64_bf16 v[44:47],v[68:71],v[80:87],v2
ds_read_b128 v[80:83],v21 offset:18432
v_smfmac_f32_16x16x64_bf16 v[24:27],v[60:63],v[176:183],v2
ds_read_b128 v[84:87],v21 offset:19456
v_smfmac_f32_16x16x64_bf16 v[28:31],v[60:63],v[184:191],v2
s_waitcnt lgkmcnt(4)
v_smfmac_f32_16x16x64_bf16 v[24:27],v[64:67],v[216:223],v2
v_smfmac_f32_16x16x64_bf16 v[28:31],v[64:67],v[224:231],v2
v_smfmac_f32_16x16x64_bf16 v[32:35],v[60:63],v[192:199],v2
v_smfmac_f32_16x16x64_bf16 v[36:39],v[60:63],v[200:207],v2
s_nop 4
v_add_f32 v24,v24,v25
v_smfmac_f32_16x16x64_bf16 v[32:35],v[64:67],v[232:239],v2
v_add_f32 v26,v26,v27
v_smfmac_f32_16x16x64_bf16 v[36:39],v[64:67],v[240:247],v2
v_add_f32 v28,v28,v29
v_smfmac_f32_16x16x64_bf16 v[40:43],v[60:63],v[208:215],v2
v_add_f32 v30,v30,v31
s_waitcnt lgkmcnt(2)
v_smfmac_f32_16x16x64_bf16 v[44:47],v[60:63],v[72:79],v2
v_cvt_pk_bf16_f32 v100,v24,v26
v_smfmac_f32_16x16x64_bf16 v[40:43],v[64:67],v[248:255],v2
v_cvt_pk_bf16_f32 v101,v28,v30
s_waitcnt lgkmcnt(0)
v_smfmac_f32_16x16x64_bf16 v[44:47],v[64:67],v[80:87],v2
v_and_or_b32 v100,v100,-2,s57
buffer_store_dwordx2 v[100:101],v7,s[8:11],s71 offen
v_add_f32 v32,v32,v33
v_add_f32 v34,v34,v35
v_add_f32 v36,v36,v37
v_add_f32 v38,v38,v39
v_cvt_pk_bf16_f32 v102,v32,v34
v_cvt_pk_bf16_f32 v103,v36,v38
v_and_or_b32 v102,v102,-2,s57
v_add_f32 v40,v40,v41
v_add_f32 v42,v42,v43
v_add_f32 v44,v44,v45
v_add_f32 v46,v46,v47
v_cvt_pk_bf16_f32 v104,v40,v42
v_cvt_pk_bf16_f32 v105,v44,v46
v_and_or_b32 v104,v104,-2,s57
buffer_store_dwordx4 v[102:105],v6,s[8:11],s71 offen
s_lshl_b32 s60,s51,6
s_add_u32 s60,s60,s52
s_mul_i32 s78,s60,196608
s_add_u32 s78,s78,s85
s_lshl_b32 s60,s60,10
s_add_u32 s30,s60,s86
s_sub_u32 s60,s4,s5
s_cmp_gt_i32 s60,14
s_cselect_b32 s53,1,0
s_cmp_eq_u32 s4,64
s_cselect_b32 s53,1,s53
s_cmp_eq_u32 s53,0
s_cselect_b32 s54,s4,s5
s_addc_u32 s4,s4,0
s_add_u32 s5,s5,s53
s_and_b32 s60,s54,3
s_lshl2_add_u32 s60,s53,s60
s_lshl_b32 s68,s60,16
s_add_u32 s68,s68,s83
s_mul_i32 s59,s60,20480
s_add_u32 s59,s59,s6
s_lshl_b32 s69,s53,9
s_add_u32 s69,s69,s7
s_bfe_u32 s31,s54,0x10002
s_add_u32 s32,s54,1
s_cmp_lg_u32 s53,s51
s_cbranch_scc1 nx_141
s_waitcnt vmcnt(0)
s_cmp_eq_u32 s79,-1
s_cbranch_scc1 pf_142
v_mov_b32 v17,1
s_mov_b64 exec,1
buffer_store_dword v17,v1,s[8:11],s79 offen sc1
s_mov_b64 exec,-1
s_mov_b32 s79,-1
pf_142:
s_cmp_eq_u32 s78,-1
s_cbranch_scc1 pk_143
buffer_store_dwordx4 v[102:105],v6,s[8:11],s78 offen sc1
buffer_store_dwordx2 v[100:101],v7,s[8:11],s78 offen sc1
s_mov_b32 s79,s30
s_mov_b32 s78,-1
pk_143:
s_waitcnt vmcnt(0)
s_cmp_eq_u32 s79,-1
s_cbranch_scc1 pf_144
v_mov_b32 v17,1
s_mov_b64 exec,1
buffer_store_dword v17,v1,s[8:11],s79 offen sc1
s_mov_b64 exec,-1
s_mov_b32 s79,-1
pf_144:
nx_141:
s_add_u32 s50,s50,1
s_mov_b32 s51,s53
s_mov_b32 s52,s54
s_mov_b32 s57,s31
s_mov_b32 s58,s32
s_cmp_lt_u32 s50,128
s_cbranch_scc1 CV_LOOP_F1
s_branch CV_DONE
fr_137:
v_bitop3_b32 v12,v60,v64,s57 bitop3:0x7e
v_bitop3_b32 v13,v68,v72,s57 bitop3:0x7e
v_xor_b32 v14,s57,v76
v_or3_b32 v12,v12,v13,v14
v_and_b32 v12,1,v12
v_cmp_ne_u32 vcc,0,v12
s_cbranch_vccz sk_145
buffer_load_dwordx4 v[76:79],v18,s[8:11],s59 offen sc1
buffer_load_dwordx4 v[60:63],v1,s[8:11],s59 offen sc1
buffer_load_dwordx4 v[64:67],v1,s[8:11],s59 offen offset:1024 sc1
buffer_load_dwordx4 v[68:71],v1,s[8:11],s59 offen offset:2048 sc1
buffer_load_dwordx4 v[72:75],v1,s[8:11],s59 offen offset:3072 sc1
sk_145:
buffer_load_dwordx4 v[96:99],v18,s[8:11],s68 offen sc1
buffer_load_dwordx4 v[80:83],v1,s[8:11],s68 offen sc1
buffer_load_dwordx4 v[84:87],v1,s[8:11],s68 offen offset:1024 sc1
buffer_load_dwordx4 v[88:91],v1,s[8:11],s68 offen offset:2048 sc1
buffer_load_dwordx4 v[92:95],v1,s[8:11],s68 offen offset:3072 sc1
s_sub_u32 s47,s47,1
s_cbranch_scc1 ABORT
s_waitcnt lgkmcnt(0)
s_branch fa_136
CV_LOOP_S0:
v_mov_b32 v24,0
v_mov_b32 v25,0
v_mov_b32 v26,0
v_mov_b32 v27,0
v_mov_b32 v28,0
v_mov_b32 v29,0
v_mov_b32 v30,0
v_mov_b32 v31,0
v_mov_b32 v32,0
v_mov_b32 v33,0
v_mov_b32 v34,0
v_mov_b32 v35,0
v_mov_b32 v36,0
v_mov_b32 v37,0
v_mov_b32 v38,0
v_mov_b32 v39,0
v_mov_b32 v40,0
v_mov_b32 v41,0
v_mov_b32 v42,0
v_mov_b32 v43,0
v_mov_b32 v44,0
v_mov_b32 v45,0
v_mov_b32 v46,0
v_mov_b32 v47,0
s_cmp_lg_u32 s46,0
s_cbranch_scc1 np_149
db_150:
buffer_load_dword v12,v11,s[8:11],s69 offen sc1
s_waitcnt vmcnt(0)
v_cmp_gt_u32 vcc,s58,v12
s_cbranch_vccz dbok_151
s_sub_u32 s47,s47,1
s_cbranch_scc1 ABORT
s_branch db_150
dbok_151:
np_149:
s_barrier
buffer_load_dwordx4 v[76:79],v18,s[8:11],s59 offen sc1
buffer_load_dwordx4 v[60:63],v1,s[8:11],s59 offen sc1
buffer_load_dwordx4 v[64:67],v1,s[8:11],s59 offen offset:1024 sc1
buffer_load_dwordx4 v[68:71],v1,s[8:11],s59 offen offset:2048 sc1
buffer_load_dwordx4 v[72:75],v1,s[8:11],s59 offen offset:3072 sc1
s_waitcnt vmcnt(4)
buffer_load_dwordx4 v[96:99],v18,s[8:11],s68 offen sc1
buffer_load_dwordx4 v[80:83],v1,s[8:11],s68 offen sc1
buffer_load_dwordx4 v[84:87],v1,s[8:11],s68 offen offset:1024 sc1
buffer_load_dwordx4 v[88:91],v1,s[8:11],s68 offen offset:2048 sc1
buffer_load_dwordx4 v[92:95],v1,s[8:11],s68 offen offset:3072 sc1
fj_148:
fa_146:
s_waitcnt vmcnt(4)
v_pk_add_f32 v[12:13],v[76:77],v[96:97]
v_pk_add_f32 v[14:15],v[78:79],v[98:99]
v_bitop3_b32 v16,v76,v96,s57 bitop3:0x7e
v_cvt_pk_bf16_f32 v56,v12,v13
v_cvt_pk_bf16_f32 v57,v14,v15
ds_write_b64 v23,v[56:57]
s_waitcnt vmcnt(3)
v_pk_add_f32 v[12:13],v[60:61],v[80:81]
v_pk_add_f32 v[14:15],v[62:63],v[82:83]
v_bitop3_b32 v17,v60,v80,s57 bitop3:0x7e
v_cvt_pk_bf16_f32 v48,v12,v13
v_cvt_pk_bf16_f32 v49,v14,v15
v_or_b32 v16,v16,v17
s_waitcnt vmcnt(2)
v_pk_add_f32 v[12:13],v[64:65],v[84:85]
v_pk_add_f32 v[14:15],v[66:67],v[86:87]
v_bitop3_b32 v17,v64,v84,s57 bitop3:0x7e
v_cvt_pk_bf16_f32 v50,v12,v13
v_cvt_pk_bf16_f32 v51,v14,v15
v_or_b32 v16,v16,v17
ds_write_b128 v22,v[48:51] offset:0
s_waitcnt vmcnt(1)
v_pk_add_f32 v[12:13],v[68:69],v[88:89]
v_pk_add_f32 v[14:15],v[70:71],v[90:91]
v_bitop3_b32 v17,v68,v88,s57 bitop3:0x7e
v_cvt_pk_bf16_f32 v52,v12,v13
v_cvt_pk_bf16_f32 v53,v14,v15
v_or_b32 v16,v16,v17
s_waitcnt vmcnt(0)
v_pk_add_f32 v[12:13],v[72:73],v[92:93]
v_pk_add_f32 v[14:15],v[74:75],v[94:95]
v_bitop3_b32 v17,v72,v92,s57 bitop3:0x7e
v_cvt_pk_bf16_f32 v54,v12,v13
v_cvt_pk_bf16_f32 v55,v14,v15
v_bitop3_b32 v16,v16,v17,1 bitop3:0xa8
v_cmp_ne_u32 vcc,0,v16
ds_write_b128 v22,v[52:55] offset:1024
s_cbranch_vccnz fr_147
v_smfmac_f32_16x16x64_bf16 v[24:27],v[48:51],a[0:7],v2
ds_read_b128 v[72:75],v21 offset:0
s_and_b32 s60,s52,3
v_smfmac_f32_16x16x64_bf16 v[28:31],v[48:51],a[8:15],v2
ds_read_b128 v[76:79],v21 offset:1024
s_lshl2_add_u32 s60,s51,s60
v_smfmac_f32_16x16x64_bf16 v[32:35],v[48:51],a[16:23],v2
ds_read_b128 v[80:83],v21 offset:2048
s_mul_i32 s60,s60,49152
v_smfmac_f32_16x16x64_bf16 v[36:39],v[48:51],a[24:31],v2
ds_read_b128 v[84:87],v21 offset:3072
s_add_u32 s71,s60,s34
s_waitcnt lgkmcnt(4)
s_barrier
v_smfmac_f32_16x16x64_bf16 v[40:43],v[48:51],a[32:39],v2
ds_read_b128 v[60:63],v3 offset:0
v_smfmac_f32_16x16x64_bf16 v[24:27],v[52:55],a[40:47],v2
ds_read_b128 v[64:67],v3 offset:1024
v_smfmac_f32_16x16x64_bf16 v[28:31],v[52:55],a[48:55],v2
ds_read_b128 v[68:71],v4 offset:0
v_smfmac_f32_16x16x64_bf16 v[32:35],v[52:55],a[56:63],v2
v_smfmac_f32_16x16x64_bf16 v[36:39],v[52:55],a[64:71],v2
v_smfmac_f32_16x16x64_bf16 v[40:43],v[52:55],a[72:79],v2
s_waitcnt lgkmcnt(5)
v_smfmac_f32_16x16x64_bf16 v[44:47],v[48:51],v[72:79],v2
ds_read_b128 v[72:75],v21 offset:4096
s_waitcnt lgkmcnt(4)
v_smfmac_f32_16x16x64_bf16 v[44:47],v[52:55],v[80:87],v2
ds_read_b128 v[76:79],v21 offset:5120
s_waitcnt lgkmcnt(4)
v_smfmac_f32_16x16x64_bf16 v[24:27],v[60:63],a[80:87],v2
ds_read_b128 v[80:83],v21 offset:6144
v_smfmac_f32_16x16x64_bf16 v[28:31],v[60:63],a[88:95],v2
ds_read_b128 v[84:87],v21 offset:7168
v_smfmac_f32_16x16x64_bf16 v[32:35],v[60:63],a[96:103],v2
v_smfmac_f32_16x16x64_bf16 v[36:39],v[60:63],a[104:111],v2
v_smfmac_f32_16x16x64_bf16 v[40:43],v[60:63],a[112:119],v2
s_waitcnt lgkmcnt(2)
v_smfmac_f32_16x16x64_bf16 v[44:47],v[60:63],v[72:79],v2
ds_read_b128 v[60:63],v4 offset:1024
v_smfmac_f32_16x16x64_bf16 v[24:27],v[64:67],a[120:127],v2
ds_read_b128 v[72:75],v21 offset:8192
v_smfmac_f32_16x16x64_bf16 v[28:31],v[64:67],a[128:135],v2
ds_read_b128 v[76:79],v21 offset:9216
v_smfmac_f32_16x16x64_bf16 v[32:35],v[64:67],a[136:143],v2
v_smfmac_f32_16x16x64_bf16 v[36:39],v[64:67],a[144:151],v2
v_smfmac_f32_16x16x64_bf16 v[40:43],v[64:67],a[152:159],v2
s_waitcnt lgkmcnt(3)
v_smfmac_f32_16x16x64_bf16 v[44:47],v[64:67],v[80:87],v2
ds_read_b128 v[64:67],v5 offset:0
v_smfmac_f32_16x16x64_bf16 v[24:27],v[68:71],a[160:167],v2
ds_read_b128 v[80:83],v21 offset:10240
v_smfmac_f32_16x16x64_bf16 v[28:31],v[68:71],a[168:175],v2
ds_read_b128 v[84:87],v21 offset:11264
v_smfmac_f32_16x16x64_bf16 v[32:35],v[68:71],a[176:183],v2
v_smfmac_f32_16x16x64_bf16 v[36:39],v[68:71],a[184:191],v2
v_smfmac_f32_16x16x64_bf16 v[40:43],v[68:71],a[192:199],v2
s_waitcnt lgkmcnt(3)
v_smfmac_f32_16x16x64_bf16 v[44:47],v[68:71],v[72:79],v2
ds_read_b128 v[68:71],v5 offset:1024
v_smfmac_f32_16x16x64_bf16 v[24:27],v[60:63],a[200:207],v2
ds_read_b128 v[72:75],v21 offset:12288
v_smfmac_f32_16x16x64_bf16 v[28:31],v[60:63],a[208:215],v2
ds_read_b128 v[76:79],v21 offset:13312
v_smfmac_f32_16x16x64_bf16 v[32:35],v[60:63],a[216:223],v2
v_smfmac_f32_16x16x64_bf16 v[36:39],v[60:63],a[224:231],v2
v_smfmac_f32_16x16x64_bf16 v[40:43],v[60:63],a[232:239],v2
s_waitcnt lgkmcnt(3)
v_smfmac_f32_16x16x64_bf16 v[44:47],v[60:63],v[80:87],v2
ds_read_b128 v[60:63],v59 offset:0
v_smfmac_f32_16x16x64_bf16 v[24:27],v[64:67],a[240:247],v2
ds_read_b128 v[80:83],v21 offset:14336
v_smfmac_f32_16x16x64_bf16 v[28:31],v[64:67],a[248:255],v2
ds_read_b128 v[84:87],v21 offset:15360
v_smfmac_f32_16x16x64_bf16 v[32:35],v[64:67],v[112:119],v2
s_cmp_eq_u32 s79,-1
s_cbranch_scc1 pf_152
v_mov_b32 v17,1
s_mov_b64 exec,1
buffer_store_dword v17,v1,s[8:11],s79 offen sc1
s_mov_b64 exec,-1
s_mov_b32 s79,-1
pf_152:
v_smfmac_f32_16x16x64_bf16 v[36:39],v[64:67],v[120:127],v2
s_cmp_eq_u32 s78,-1
s_cbranch_scc1 pk_153
buffer_store_dwordx4 v[100:103],v6,s[8:11],s78 offen sc1
buffer_store_dwordx2 v[104:105],v7,s[8:11],s78 offen sc1
s_mov_b32 s79,s30
s_mov_b32 s78,-1
pk_153:
v_smfmac_f32_16x16x64_bf16 v[40:43],v[64:67],v[128:135],v2
s_waitcnt lgkmcnt(3)
v_smfmac_f32_16x16x64_bf16 v[44:47],v[64:67],v[72:79],v2
ds_read_b128 v[64:67],v59 offset:1024
v_smfmac_f32_16x16x64_bf16 v[24:27],v[68:71],v[136:143],v2
ds_read_b128 v[72:75],v21 offset:16384
v_smfmac_f32_16x16x64_bf16 v[28:31],v[68:71],v[144:151],v2
ds_read_b128 v[76:79],v21 offset:17408
v_smfmac_f32_16x16x64_bf16 v[32:35],v[68:71],v[152:159],v2
v_smfmac_f32_16x16x64_bf16 v[36:39],v[68:71],v[160:167],v2
v_smfmac_f32_16x16x64_bf16 v[40:43],v[68:71],v[168:175],v2
s_waitcnt lgkmcnt(3)
v_smfmac_f32_16x16x64_bf16 v[44:47],v[68:71],v[80:87],v2
ds_read_b128 v[80:83],v21 offset:18432
v_smfmac_f32_16x16x64_bf16 v[24:27],v[60:63],v[176:183],v2
ds_read_b128 v[84:87],v21 offset:19456
v_smfmac_f32_16x16x64_bf16 v[28:31],v[60:63],v[184:191],v2
s_waitcnt lgkmcnt(4)
v_smfmac_f32_16x16x64_bf16 v[24:27],v[64:67],v[216:223],v2
v_smfmac_f32_16x16x64_bf16 v[28:31],v[64:67],v[224:231],v2
v_smfmac_f32_16x16x64_bf16 v[32:35],v[60:63],v[192:199],v2
v_smfmac_f32_16x16x64_bf16 v[36:39],v[60:63],v[200:207],v2
s_nop 4
v_add_f32 v24,v24,v25
v_smfmac_f32_16x16x64_bf16 v[32:35],v[64:67],v[232:239],v2
v_add_f32 v26,v26,v27
v_smfmac_f32_16x16x64_bf16 v[36:39],v[64:67],v[240:247],v2
v_add_f32 v28,v28,v29
v_smfmac_f32_16x16x64_bf16 v[40:43],v[60:63],v[208:215],v2
v_add_f32 v30,v30,v31
s_waitcnt lgkmcnt(2)
v_smfmac_f32_16x16x64_bf16 v[44:47],v[60:63],v[72:79],v2
v_cvt_pk_bf16_f32 v100,v24,v26
v_smfmac_f32_16x16x64_bf16 v[40:43],v[64:67],v[248:255],v2
v_cvt_pk_bf16_f32 v101,v28,v30
s_waitcnt lgkmcnt(0)
v_smfmac_f32_16x16x64_bf16 v[44:47],v[64:67],v[80:87],v2
v_and_or_b32 v100,v100,-2,s57
v_add_f32 v32,v32,v33
v_add_f32 v34,v34,v35
v_add_f32 v36,v36,v37
v_add_f32 v38,v38,v39
v_cvt_pk_bf16_f32 v102,v32,v34
v_cvt_pk_bf16_f32 v103,v36,v38
v_and_or_b32 v102,v102,-2,s57
buffer_store_dwordx4 v[100:103],v6,s[8:11],s71 offen sc1
v_add_f32 v40,v40,v41
v_add_f32 v42,v42,v43
v_add_f32 v44,v44,v45
v_add_f32 v46,v46,v47
v_cvt_pk_bf16_f32 v104,v40,v42
v_cvt_pk_bf16_f32 v105,v44,v46
v_and_or_b32 v104,v104,-2,s57
buffer_store_dwordx2 v[104:105],v7,s[8:11],s71 offen sc1
s_lshl_b32 s60,s51,6
s_add_u32 s60,s60,s52
s_mul_i32 s78,s60,196608
s_add_u32 s78,s78,s85
s_lshl_b32 s60,s60,10
s_add_u32 s30,s60,s86
s_sub_u32 s60,s4,s5
s_cmp_gt_i32 s60,14
s_cselect_b32 s53,1,0
s_cmp_eq_u32 s4,64
s_cselect_b32 s53,1,s53
s_cmp_eq_u32 s53,0
s_cselect_b32 s54,s4,s5
s_addc_u32 s4,s4,0
s_add_u32 s5,s5,s53
s_and_b32 s60,s54,3
s_lshl2_add_u32 s60,s53,s60
s_lshl_b32 s68,s60,16
s_add_u32 s68,s68,s83
s_mul_i32 s59,s60,20480
s_add_u32 s59,s59,s6
s_lshl_b32 s69,s53,9
s_add_u32 s69,s69,s7
s_bfe_u32 s31,s54,0x10002
s_add_u32 s32,s54,1
s_cmp_lg_u32 s53,s51
s_cbranch_scc1 nx_154
s_waitcnt vmcnt(0)
s_cmp_eq_u32 s79,-1
s_cbranch_scc1 pf_155
v_mov_b32 v17,1
s_mov_b64 exec,1
buffer_store_dword v17,v1,s[8:11],s79 offen sc1
s_mov_b64 exec,-1
s_mov_b32 s79,-1
pf_155:
s_cmp_eq_u32 s78,-1
s_cbranch_scc1 pk_156
buffer_store_dwordx4 v[100:103],v6,s[8:11],s78 offen sc1
buffer_store_dwordx2 v[104:105],v7,s[8:11],s78 offen sc1
s_mov_b32 s79,s30
s_mov_b32 s78,-1
pk_156:
s_waitcnt vmcnt(0)
s_cmp_eq_u32 s79,-1
s_cbranch_scc1 pf_157
v_mov_b32 v17,1
s_mov_b64 exec,1
buffer_store_dword v17,v1,s[8:11],s79 offen sc1
s_mov_b64 exec,-1
s_mov_b32 s79,-1
pf_157:
nx_154:
s_add_u32 s50,s50,1
s_mov_b32 s51,s53
s_mov_b32 s52,s54
s_mov_b32 s57,s31
s_mov_b32 s58,s32
s_cmp_lt_u32 s50,128
s_cbranch_scc1 CV_LOOP_S0
s_branch CV_DONE
fr_147:
v_bitop3_b32 v12,v60,v64,s57 bitop3:0x7e
v_bitop3_b32 v13,v68,v72,s57 bitop3:0x7e
v_xor_b32 v14,s57,v76
v_or3_b32 v12,v12,v13,v14
v_and_b32 v12,1,v12
v_cmp_ne_u32 vcc,0,v12
s_cbranch_vccz sk_158
buffer_load_dwordx4 v[76:79],v18,s[8:11],s59 offen sc1
buffer_load_dwordx4 v[60:63],v1,s[8:11],s59 offen sc1
buffer_load_dwordx4 v[64:67],v1,s[8:11],s59 offen offset:1024 sc1
buffer_load_dwordx4 v[68:71],v1,s[8:11],s59 offen offset:2048 sc1
buffer_load_dwordx4 v[72:75],v1,s[8:11],s59 offen offset:3072 sc1
sk_158:
buffer_load_dwordx4 v[96:99],v18,s[8:11],s68 offen sc1
buffer_load_dwordx4 v[80:83],v1,s[8:11],s68 offen sc1
buffer_load_dwordx4 v[84:87],v1,s[8:11],s68 offen offset:1024 sc1
buffer_load_dwordx4 v[88:91],v1,s[8:11],s68 offen offset:2048 sc1
buffer_load_dwordx4 v[92:95],v1,s[8:11],s68 offen offset:3072 sc1
s_sub_u32 s47,s47,1
s_cbranch_scc1 ABORT
s_waitcnt lgkmcnt(0)
s_branch fa_146
CV_LOOP_S1:
v_mov_b32 v24,0
v_mov_b32 v25,0
v_mov_b32 v26,0
v_mov_b32 v27,0
v_mov_b32 v28,0
v_mov_b32 v29,0
v_mov_b32 v30,0
v_mov_b32 v31,0
v_mov_b32 v32,0
v_mov_b32 v33,0
v_mov_b32 v34,0
v_mov_b32 v35,0
v_mov_b32 v36,0
v_mov_b32 v37,0
v_mov_b32 v38,0
v_mov_b32 v39,0
v_mov_b32 v40,0
v_mov_b32 v41,0
v_mov_b32 v42,0
v_mov_b32 v43,0
v_mov_b32 v44,0
v_mov_b32 v45,0
v_mov_b32 v46,0
v_mov_b32 v47,0
s_barrier
buffer_load_dwordx4 v[76:79],v18,s[8:11],s59 offen sc1
buffer_load_dwordx4 v[60:63],v1,s[8:11],s59 offen sc1
buffer_load_dwordx4 v[64:67],v1,s[8:11],s59 offen offset:1024 sc1
buffer_load_dwordx4 v[68:71],v1,s[8:11],s59 offen offset:2048 sc1
buffer_load_dwordx4 v[72:75],v1,s[8:11],s59 offen offset:3072 sc1
s_waitcnt vmcnt(4)
buffer_load_dwordx4 v[96:99],v18,s[8:11],s68 offen sc1
buffer_load_dwordx4 v[80:83],v1,s[8:11],s68 offen sc1
buffer_load_dwordx4 v[84:87],v1,s[8:11],s68 offen offset:1024 sc1
buffer_load_dwordx4 v[88:91],v1,s[8:11],s68 offen offset:2048 sc1
buffer_load_dwordx4 v[92:95],v1,s[8:11],s68 offen offset:3072 sc1
fj_161:
fa_159:
s_waitcnt vmcnt(4)
v_pk_add_f32 v[12:13],v[76:77],v[96:97]
v_pk_add_f32 v[14:15],v[78:79],v[98:99]
v_bitop3_b32 v16,v76,v96,s57 bitop3:0x7e
v_cvt_pk_bf16_f32 v56,v12,v13
v_cvt_pk_bf16_f32 v57,v14,v15
ds_write_b64 v23,v[56:57]
s_waitcnt vmcnt(3)
v_pk_add_f32 v[12:13],v[60:61],v[80:81]
v_pk_add_f32 v[14:15],v[62:63],v[82:83]
v_bitop3_b32 v17,v60,v80,s57 bitop3:0x7e
v_cvt_pk_bf16_f32 v48,v12,v13
v_cvt_pk_bf16_f32 v49,v14,v15
v_or_b32 v16,v16,v17
s_waitcnt vmcnt(2)
v_pk_add_f32 v[12:13],v[64:65],v[84:85]
v_pk_add_f32 v[14:15],v[66:67],v[86:87]
v_bitop3_b32 v17,v64,v84,s57 bitop3:0x7e
v_cvt_pk_bf16_f32 v50,v12,v13
v_cvt_pk_bf16_f32 v51,v14,v15
v_or_b32 v16,v16,v17
ds_write_b128 v22,v[48:51] offset:0
s_waitcnt vmcnt(1)
v_pk_add_f32 v[12:13],v[68:69],v[88:89]
v_pk_add_f32 v[14:15],v[70:71],v[90:91]
v_bitop3_b32 v17,v68,v88,s57 bitop3:0x7e
v_cvt_pk_bf16_f32 v52,v12,v13
v_cvt_pk_bf16_f32 v53,v14,v15
v_or_b32 v16,v16,v17
s_waitcnt vmcnt(0)
v_pk_add_f32 v[12:13],v[72:73],v[92:93]
v_pk_add_f32 v[14:15],v[74:75],v[94:95]
v_bitop3_b32 v17,v72,v92,s57 bitop3:0x7e
v_cvt_pk_bf16_f32 v54,v12,v13
v_cvt_pk_bf16_f32 v55,v14,v15
v_bitop3_b32 v16,v16,v17,1 bitop3:0xa8
v_cmp_ne_u32 vcc,0,v16
ds_write_b128 v22,v[52:55] offset:1024
s_cbranch_vccnz fr_160
v_smfmac_f32_16x16x64_bf16 v[24:27],v[48:51],a[0:7],v2
ds_read_b128 v[72:75],v21 offset:0
s_and_b32 s60,s52,3
v_smfmac_f32_16x16x64_bf16 v[28:31],v[48:51],a[8:15],v2
ds_read_b128 v[76:79],v21 offset:1024
s_lshl2_add_u32 s60,s51,s60
v_smfmac_f32_16x16x64_bf16 v[32:35],v[48:51],a[16:23],v2
ds_read_b128 v[80:83],v21 offset:2048
s_mul_i32 s60,s60,49152
v_smfmac_f32_16x16x64_bf16 v[36:39],v[48:51],a[24:31],v2
ds_read_b128 v[84:87],v21 offset:3072
s_add_u32 s71,s60,s34
s_waitcnt lgkmcnt(4)
s_barrier
v_smfmac_f32_16x16x64_bf16 v[40:43],v[48:51],a[32:39],v2
ds_read_b128 v[60:63],v3 offset:0
v_smfmac_f32_16x16x64_bf16 v[24:27],v[52:55],a[40:47],v2
ds_read_b128 v[64:67],v3 offset:1024
v_smfmac_f32_16x16x64_bf16 v[28:31],v[52:55],a[48:55],v2
ds_read_b128 v[68:71],v4 offset:0
v_smfmac_f32_16x16x64_bf16 v[32:35],v[52:55],a[56:63],v2
v_smfmac_f32_16x16x64_bf16 v[36:39],v[52:55],a[64:71],v2
v_smfmac_f32_16x16x64_bf16 v[40:43],v[52:55],a[72:79],v2
s_waitcnt lgkmcnt(5)
v_smfmac_f32_16x16x64_bf16 v[44:47],v[48:51],v[72:79],v2
ds_read_b128 v[72:75],v21 offset:4096
s_waitcnt lgkmcnt(4)
v_smfmac_f32_16x16x64_bf16 v[44:47],v[52:55],v[80:87],v2
ds_read_b128 v[76:79],v21 offset:5120
s_waitcnt lgkmcnt(4)
v_smfmac_f32_16x16x64_bf16 v[24:27],v[60:63],a[80:87],v2
ds_read_b128 v[80:83],v21 offset:6144
v_smfmac_f32_16x16x64_bf16 v[28:31],v[60:63],a[88:95],v2
ds_read_b128 v[84:87],v21 offset:7168
v_smfmac_f32_16x16x64_bf16 v[32:35],v[60:63],a[96:103],v2
v_smfmac_f32_16x16x64_bf16 v[36:39],v[60:63],a[104:111],v2
v_smfmac_f32_16x16x64_bf16 v[40:43],v[60:63],a[112:119],v2
s_waitcnt lgkmcnt(2)
v_smfmac_f32_16x16x64_bf16 v[44:47],v[60:63],v[72:79],v2
ds_read_b128 v[60:63],v4 offset:1024
v_smfmac_f32_16x16x64_bf16 v[24:27],v[64:67],a[120:127],v2
ds_read_b128 v[72:75],v21 offset:8192
v_smfmac_f32_16x16x64_bf16 v[28:31],v[64:67],a[128:135],v2
ds_read_b128 v[76:79],v21 offset:9216
v_smfmac_f32_16x16x64_bf16 v[32:35],v[64:67],a[136:143],v2
v_smfmac_f32_16x16x64_bf16 v[36:39],v[64:67],a[144:151],v2
v_smfmac_f32_16x16x64_bf16 v[40:43],v[64:67],a[152:159],v2
s_waitcnt lgkmcnt(3)
v_smfmac_f32_16x16x64_bf16 v[44:47],v[64:67],v[80:87],v2
ds_read_b128 v[64:67],v5 offset:0
v_smfmac_f32_16x16x64_bf16 v[24:27],v[68:71],a[160:167],v2
ds_read_b128 v[80:83],v21 offset:10240
v_smfmac_f32_16x16x64_bf16 v[28:31],v[68:71],a[168:175],v2
ds_read_b128 v[84:87],v21 offset:11264
v_smfmac_f32_16x16x64_bf16 v[32:35],v[68:71],a[176:183],v2
v_smfmac_f32_16x16x64_bf16 v[36:39],v[68:71],a[184:191],v2
v_smfmac_f32_16x16x64_bf16 v[40:43],v[68:71],a[192:199],v2
s_waitcnt lgkmcnt(3)
v_smfmac_f32_16x16x64_bf16 v[44:47],v[68:71],v[72:79],v2
ds_read_b128 v[68:71],v5 offset:1024
v_smfmac_f32_16x16x64_bf16 v[24:27],v[60:63],a[200:207],v2
ds_read_b128 v[72:75],v21 offset:12288
v_smfmac_f32_16x16x64_bf16 v[28:31],v[60:63],a[208:215],v2
ds_read_b128 v[76:79],v21 offset:13312
v_smfmac_f32_16x16x64_bf16 v[32:35],v[60:63],a[216:223],v2
v_smfmac_f32_16x16x64_bf16 v[36:39],v[60:63],a[224:231],v2
v_smfmac_f32_16x16x64_bf16 v[40:43],v[60:63],a[232:239],v2
s_waitcnt lgkmcnt(3)
v_smfmac_f32_16x16x64_bf16 v[44:47],v[60:63],v[80:87],v2
ds_read_b128 v[60:63],v59 offset:0
v_smfmac_f32_16x16x64_bf16 v[24:27],v[64:67],a[240:247],v2
ds_read_b128 v[80:83],v21 offset:14336
v_smfmac_f32_16x16x64_bf16 v[28:31],v[64:67],a[248:255],v2
ds_read_b128 v[84:87],v21 offset:15360
v_smfmac_f32_16x16x64_bf16 v[32:35],v[64:67],v[112:119],v2
s_cmp_eq_u32 s79,-1
s_cbranch_scc1 pf_162
v_mov_b32 v17,1
s_mov_b64 exec,1
buffer_store_dword v17,v1,s[8:11],s79 offen sc1
s_mov_b64 exec,-1
s_mov_b32 s79,-1
pf_162:
v_smfmac_f32_16x16x64_bf16 v[36:39],v[64:67],v[120:127],v2
s_cmp_eq_u32 s78,-1
s_cbranch_scc1 pk_163
buffer_store_dwordx4 v[102:105],v6,s[8:11],s78 offen sc1
buffer_store_dwordx2 v[100:101],v7,s[8:11],s78 offen sc1
s_mov_b32 s79,s30
s_mov_b32 s78,-1
pk_163:
v_smfmac_f32_16x16x64_bf16 v[40:43],v[64:67],v[128:135],v2
s_waitcnt lgkmcnt(3)
v_smfmac_f32_16x16x64_bf16 v[44:47],v[64:67],v[72:79],v2
ds_read_b128 v[64:67],v59 offset:1024
v_smfmac_f32_16x16x64_bf16 v[24:27],v[68:71],v[136:143],v2
ds_read_b128 v[72:75],v21 offset:16384
v_smfmac_f32_16x16x64_bf16 v[28:31],v[68:71],v[144:151],v2
ds_read_b128 v[76:79],v21 offset:17408
v_smfmac_f32_16x16x64_bf16 v[32:35],v[68:71],v[152:159],v2
v_smfmac_f32_16x16x64_bf16 v[36:39],v[68:71],v[160:167],v2
v_smfmac_f32_16x16x64_bf16 v[40:43],v[68:71],v[168:175],v2
s_waitcnt lgkmcnt(3)
v_smfmac_f32_16x16x64_bf16 v[44:47],v[68:71],v[80:87],v2
ds_read_b128 v[80:83],v21 offset:18432
v_smfmac_f32_16x16x64_bf16 v[24:27],v[60:63],v[176:183],v2
ds_read_b128 v[84:87],v21 offset:19456
v_smfmac_f32_16x16x64_bf16 v[28:31],v[60:63],v[184:191],v2
s_waitcnt lgkmcnt(4)
v_smfmac_f32_16x16x64_bf16 v[24:27],v[64:67],v[216:223],v2
v_smfmac_f32_16x16x64_bf16 v[28:31],v[64:67],v[224:231],v2
v_smfmac_f32_16x16x64_bf16 v[32:35],v[60:63],v[192:199],v2
v_smfmac_f32_16x16x64_bf16 v[36:39],v[60:63],v[200:207],v2
s_nop 4
v_add_f32 v24,v24,v25
v_smfmac_f32_16x16x64_bf16 v[32:35],v[64:67],v[232:239],v2
v_add_f32 v26,v26,v27
v_smfmac_f32_16x16x64_bf16 v[36:39],v[64:67],v[240:247],v2
v_add_f32 v28,v28,v29
v_smfmac_f32_16x16x64_bf16 v[40:43],v[60:63],v[208:215],v2
v_add_f32 v30,v30,v31
s_waitcnt lgkmcnt(2)
v_smfmac_f32_16x16x64_bf16 v[44:47],v[60:63],v[72:79],v2
v_cvt_pk_bf16_f32 v100,v24,v26
v_smfmac_f32_16x16x64_bf16 v[40:43],v[64:67],v[248:255],v2
v_cvt_pk_bf16_f32 v101,v28,v30
s_waitcnt lgkmcnt(0)
v_smfmac_f32_16x16x64_bf16 v[44:47],v[64:67],v[80:87],v2
v_and_or_b32 v100,v100,-2,s57
buffer_store_dwordx2 v[100:101],v7,s[8:11],s71 offen sc1
v_add_f32 v32,v32,v33
v_add_f32 v34,v34,v35
v_add_f32 v36,v36,v37
v_add_f32 v38,v38,v39
v_cvt_pk_bf16_f32 v102,v32,v34
v_cvt_pk_bf16_f32 v103,v36,v38
v_and_or_b32 v102,v102,-2,s57
v_add_f32 v40,v40,v41
v_add_f32 v42,v42,v43
v_add_f32 v44,v44,v45
v_add_f32 v46,v46,v47
v_cvt_pk_bf16_f32 v104,v40,v42
v_cvt_pk_bf16_f32 v105,v44,v46
v_and_or_b32 v104,v104,-2,s57
buffer_store_dwordx4 v[102:105],v6,s[8:11],s71 offen sc1
s_lshl_b32 s60,s51,6
s_add_u32 s60,s60,s52
s_mul_i32 s78,s60,196608
s_add_u32 s78,s78,s85
s_lshl_b32 s60,s60,10
s_add_u32 s30,s60,s86
s_sub_u32 s60,s4,s5
s_cmp_gt_i32 s60,14
s_cselect_b32 s53,1,0
s_cmp_eq_u32 s4,64
s_cselect_b32 s53,1,s53
s_cmp_eq_u32 s53,0
s_cselect_b32 s54,s4,s5
s_addc_u32 s4,s4,0
s_add_u32 s5,s5,s53
s_and_b32 s60,s54,3
s_lshl2_add_u32 s60,s53,s60
s_lshl_b32 s68,s60,16
s_add_u32 s68,s68,s83
s_mul_i32 s59,s60,20480
s_add_u32 s59,s59,s6
s_lshl_b32 s69,s53,9
s_add_u32 s69,s69,s7
s_bfe_u32 s31,s54,0x10002
s_add_u32 s32,s54,1
s_cmp_lg_u32 s53,s51
s_cbranch_scc1 nx_164
s_waitcnt vmcnt(0)
s_cmp_eq_u32 s79,-1
s_cbranch_scc1 pf_165
v_mov_b32 v17,1
s_mov_b64 exec,1
buffer_store_dword v17,v1,s[8:11],s79 offen sc1
s_mov_b64 exec,-1
s_mov_b32 s79,-1
pf_165:
s_cmp_eq_u32 s78,-1
s_cbranch_scc1 pk_166
buffer_store_dwordx4 v[102:105],v6,s[8:11],s78 offen sc1
buffer_store_dwordx2 v[100:101],v7,s[8:11],s78 offen sc1
s_mov_b32 s79,s30
s_mov_b32 s78,-1
pk_166:
s_waitcnt vmcnt(0)
s_cmp_eq_u32 s79,-1
s_cbranch_scc1 pf_167
v_mov_b32 v17,1
s_mov_b64 exec,1
buffer_store_dword v17,v1,s[8:11],s79 offen sc1
s_mov_b64 exec,-1
s_mov_b32 s79,-1
pf_167:
nx_164:
s_add_u32 s50,s50,1
s_mov_b32 s51,s53
s_mov_b32 s52,s54
s_mov_b32 s57,s31
s_mov_b32 s58,s32
s_cmp_lt_u32 s50,128
s_cbranch_scc1 CV_LOOP_S1
s_branch CV_DONE
fr_160:
v_bitop3_b32 v12,v60,v64,s57 bitop3:0x7e
v_bitop3_b32 v13,v68,v72,s57 bitop3:0x7e
v_xor_b32 v14,s57,v76
v_or3_b32 v12,v12,v13,v14
v_and_b32 v12,1,v12
v_cmp_ne_u32 vcc,0,v12
s_cbranch_vccz sk_168
buffer_load_dwordx4 v[76:79],v18,s[8:11],s59 offen sc1
buffer_load_dwordx4 v[60:63],v1,s[8:11],s59 offen sc1
buffer_load_dwordx4 v[64:67],v1,s[8:11],s59 offen offset:1024 sc1
buffer_load_dwordx4 v[68:71],v1,s[8:11],s59 offen offset:2048 sc1
buffer_load_dwordx4 v[72:75],v1,s[8:11],s59 offen offset:3072 sc1
sk_168:
buffer_load_dwordx4 v[96:99],v18,s[8:11],s68 offen sc1
buffer_load_dwordx4 v[80:83],v1,s[8:11],s68 offen sc1
buffer_load_dwordx4 v[84:87],v1,s[8:11],s68 offen offset:1024 sc1
buffer_load_dwordx4 v[88:91],v1,s[8:11],s68 offen offset:2048 sc1
buffer_load_dwordx4 v[92:95],v1,s[8:11],s68 offen offset:3072 sc1
s_sub_u32 s47,s47,1
s_cbranch_scc1 ABORT
s_waitcnt lgkmcnt(0)
s_branch fa_159
CV_DONE:
s_add_u32 s61,s48,32
s_endpgm
ROLE_CW:
s_lshr_b32 s28,s48,3
s_and_b32 s29,s48,7
s_mul_i32 s82,s28,2097152
s_add_u32 s82,s82,2097152
v_lshlrev_b32 v1,4,v0
v_and_b32 v12,1,v0
v_mul_u32_u24 v2,0xaaaa,v12
v_or_b32 v2,0x4444,v2
v_lshrrev_b32 v14,4,v0
v_and_b32 v15,15,v0
v_min_u32 v3,11,v15
v_lshlrev_b32 v3,2,v3
v_lshl_add_u32 v3,v14,7,v3
s_mul_i32 s60,s46,24576
v_add_u32 v4,s60,v1
v_mul_u32_u24 v5,704,v14
v_lshl_add_u32 v5,v15,2,v5
s_mul_i32 s60,s46,2816
s_add_u32 s60,s60,98304
v_add_u32 v5,s60,v5
v_min_u32 v12,39,v0
s_mul_i32 s60,s46,40
v_add_u32 v12,s60,v12
v_lshlrev_b32 v9,4,v12
v_bfe_u32 v13,v12,1,3
v_mul_u32_u24 v6,352,v13
v_mul_u32_u24 v17,1280,v13
v_lshrrev_b32 v13,4,v12
v_lshl_add_u32 v6,v13,5,v6
v_lshl_add_u32 v17,v13,4,v17
v_and_b32 v13,1,v12
v_lshl_add_u32 v6,v13,4,v6
v_lshl_add_u32 v17,v13,3,v17
v_add_u32 v6,98304,v6
s_mov_b32 s88,-1
s_mov_b32 s89,0xff
s_mov_b32 s4,s18
s_mov_b32 s5,s19
s_mov_b32 s6,10240
s_mov_b32 s7,0x20000
s_mul_i32 s60,s29,160
buffer_load_dwordx2 v[32:33],v17,s[4:7],s60 offen
s_mul_i32 s84,s29,2560
s_add_u32 s84,s84,s82
s_lshl_b32 s83,s28,19
s_lshr_b32 s60,s29,1
s_lshl_b32 s61,s60,14
s_add_u32 s83,s83,s61
s_and_b32 s61,s29,1
s_mul_i32 s62,s61,2560
s_add_u32 s83,s83,s62
s_add_u32 s83,s83,10485760
s_lshl_b32 s85,s60,7
s_lshl_b32 s61,s61,2
s_add_u32 s61,s61,s46
s_lshl_b32 s61,s61,2
s_add_u32 s85,s85,s61
s_add_u32 s85,s85,s82
s_add_u32 s85,s85,950272
s_mul_i32 s33,s46,12288
s_add_u32 s33,s33,s82
s_add_u32 s33,s33,163840
s_mov_b32 s35,0
s_add_u32 s35,s35,s82
s_add_u32 s35,s35,951296
s_cmp_eq_u32 s28,0
s_cselect_b32 s63,0xffff0000,0
s_waitcnt vmcnt(0)
v_lshlrev_b32 v36,16,v32
v_and_b32 v36,s63,v36
v_and_b32 v37,s63,v32
v_lshlrev_b32 v38,16,v33
v_and_b32 v38,s63,v38
v_and_b32 v39,s63,v33
v_mov_b32 v40,-1
v_mov_b32 v41,-1
v_mov_b32 v42,-1
v_mov_b32 v43,-1
v_mov_b32 v44,1
s_mov_b64 exec,s[88:89]
s_add_u32 s60,s83,0
buffer_store_dwordx4 v[36:39],v9,s[8:11],s60 offen sc1
s_add_u32 s60,s83,8192
buffer_store_dwordx4 v[36:39],v9,s[8:11],s60 offen sc1
s_add_u32 s60,s83,65536
buffer_store_dwordx4 v[40:43],v9,s[8:11],s60 offen sc1
s_add_u32 s60,s83,73728
buffer_store_dwordx4 v[40:43],v9,s[8:11],s60 offen sc1
s_add_u32 s60,s83,131072
buffer_store_dwordx4 v[40:43],v9,s[8:11],s60 offen sc1
s_add_u32 s60,s83,139264
buffer_store_dwordx4 v[40:43],v9,s[8:11],s60 offen sc1
s_add_u32 s60,s83,196608
buffer_store_dwordx4 v[40:43],v9,s[8:11],s60 offen sc1
s_add_u32 s60,s83,204800
buffer_store_dwordx4 v[40:43],v9,s[8:11],s60 offen sc1
s_add_u32 s60,s83,262144
buffer_store_dwordx4 v[36:39],v9,s[8:11],s60 offen sc1
s_add_u32 s60,s83,270336
buffer_store_dwordx4 v[36:39],v9,s[8:11],s60 offen sc1
s_add_u32 s60,s83,327680
buffer_store_dwordx4 v[40:43],v9,s[8:11],s60 offen sc1
s_add_u32 s60,s83,335872
buffer_store_dwordx4 v[40:43],v9,s[8:11],s60 offen sc1
s_add_u32 s60,s83,393216
buffer_store_dwordx4 v[40:43],v9,s[8:11],s60 offen sc1
s_add_u32 s60,s83,401408
buffer_store_dwordx4 v[40:43],v9,s[8:11],s60 offen sc1
s_add_u32 s60,s83,458752
buffer_store_dwordx4 v[40:43],v9,s[8:11],s60 offen sc1
s_add_u32 s60,s83,466944
buffer_store_dwordx4 v[40:43],v9,s[8:11],s60 offen sc1
s_cmp_lg_u32 s49,0
s_cbranch_scc1 ls_169
s_add_u32 s60,s84,0
buffer_store_dwordx4 v[36:39],v9,s[8:11],s60 offen
s_add_u32 s60,s84,20480
buffer_store_dwordx4 v[40:43],v9,s[8:11],s60 offen
s_add_u32 s60,s84,40960
buffer_store_dwordx4 v[40:43],v9,s[8:11],s60 offen
s_add_u32 s60,s84,61440
buffer_store_dwordx4 v[40:43],v9,s[8:11],s60 offen
s_add_u32 s60,s84,81920
buffer_store_dwordx4 v[36:39],v9,s[8:11],s60 offen
s_add_u32 s60,s84,102400
buffer_store_dwordx4 v[40:43],v9,s[8:11],s60 offen
s_add_u32 s60,s84,122880
buffer_store_dwordx4 v[40:43],v9,s[8:11],s60 offen
s_add_u32 s60,s84,143360
buffer_store_dwordx4 v[40:43],v9,s[8:11],s60 offen
s_mov_b64 exec,1
buffer_store_dword v44,v1,s[8:11],s85 offen
buffer_store_dword v44,v1,s[8:11],s85 offen offset:512
s_branch ls_170
ls_169:
s_add_u32 s60,s84,0
buffer_store_dwordx4 v[36:39],v9,s[8:11],s60 offen sc1
s_add_u32 s60,s84,20480
buffer_store_dwordx4 v[40:43],v9,s[8:11],s60 offen sc1
s_add_u32 s60,s84,40960
buffer_store_dwordx4 v[40:43],v9,s[8:11],s60 offen sc1
s_add_u32 s60,s84,61440
buffer_store_dwordx4 v[40:43],v9,s[8:11],s60 offen sc1
s_add_u32 s60,s84,81920
buffer_store_dwordx4 v[36:39],v9,s[8:11],s60 offen sc1
s_add_u32 s60,s84,102400
buffer_store_dwordx4 v[40:43],v9,s[8:11],s60 offen sc1
s_add_u32 s60,s84,122880
buffer_store_dwordx4 v[40:43],v9,s[8:11],s60 offen sc1
s_add_u32 s60,s84,143360
buffer_store_dwordx4 v[40:43],v9,s[8:11],s60 offen sc1
s_mov_b64 exec,1
buffer_store_dword v44,v1,s[8:11],s85 offen sc1
buffer_store_dword v44,v1,s[8:11],s85 offen offset:512 sc1
ls_170:
s_mov_b64 exec,-1
s_waitcnt vmcnt(0)
s_barrier
s_cmp_lg_u32 s46,0
s_cbranch_scc1 arr_171
v_mov_b32 v12,1
s_lshl_b32 s3,s49,2
v_mov_b32 v13,s3
s_mov_b64 exec,1
buffer_atomic_add v12,v13,s[12:15],0 offen sc1
s_mov_b64 exec,-1
arr_171:
s_mov_b32 s4,s26
s_mov_b32 s5,s27
s_mov_b32 s6,7864320
s_mov_b32 s7,0x20000
s_lshl_b32 s60,s28,2
s_add_u32 s60,s60,s46
s_mul_i32 s73,s60,983040
s_mul_i32 s60,s29,160
s_add_u32 s73,s73,s60
s_mul_i32 s74,s46,40960
v_add_u32 v12,0,v0
v_mul_u32_u24 v13,6554,v12
v_lshrrev_b32 v13,16,v13
v_mul_u32_u24 v16,10,v13
v_sub_u32 v12,v12,v16
v_mul_u32_u24 v20,1280,v13
v_lshl_add_u32 v20,v12,4,v20
v_add_u32 v12,64,v0
v_mul_u32_u24 v13,6554,v12
v_lshrrev_b32 v13,16,v13
v_mul_u32_u24 v16,10,v13
v_sub_u32 v12,v12,v16
v_mul_u32_u24 v21,1280,v13
v_lshl_add_u32 v21,v12,4,v21
v_add_u32 v12,128,v0
v_mul_u32_u24 v13,6554,v12
v_lshrrev_b32 v13,16,v13
v_mul_u32_u24 v16,10,v13
v_sub_u32 v12,v12,v16
v_mul_u32_u24 v22,1280,v13
v_lshl_add_u32 v22,v12,4,v22
v_add_u32 v12,192,v0
v_mul_u32_u24 v13,6554,v12
v_lshrrev_b32 v13,16,v13
v_mul_u32_u24 v16,10,v13
v_sub_u32 v12,v12,v16
v_mul_u32_u24 v23,1280,v13
v_lshl_add_u32 v23,v12,4,v23
v_add_u32 v12,256,v0
v_mul_u32_u24 v13,6554,v12
v_lshrrev_b32 v13,16,v13
v_mul_u32_u24 v16,10,v13
v_sub_u32 v12,v12,v16
v_mul_u32_u24 v24,1280,v13
v_lshl_add_u32 v24,v12,4,v24
v_add_u32 v12,320,v0
v_mul_u32_u24 v13,6554,v12
v_lshrrev_b32 v13,16,v13
v_mul_u32_u24 v16,10,v13
v_sub_u32 v12,v12,v16
v_mul_u32_u24 v25,1280,v13
v_lshl_add_u32 v25,v12,4,v25
v_add_u32 v12,384,v0
v_mul_u32_u24 v13,6554,v12
v_lshrrev_b32 v13,16,v13
v_mul_u32_u24 v16,10,v13
v_sub_u32 v12,v12,v16
v_mul_u32_u24 v26,1280,v13
v_lshl_add_u32 v26,v12,4,v26
v_add_u32 v12,448,v0
v_mul_u32_u24 v13,6554,v12
v_lshrrev_b32 v13,16,v13
v_mul_u32_u24 v16,10,v13
v_sub_u32 v12,v12,v16
v_mul_u32_u24 v27,1280,v13
v_lshl_add_u32 v27,v12,4,v27
v_add_u32 v12,512,v0
v_mul_u32_u24 v13,6554,v12
v_lshrrev_b32 v13,16,v13
v_mul_u32_u24 v16,10,v13
v_sub_u32 v12,v12,v16
v_mul_u32_u24 v28,1280,v13
v_lshl_add_u32 v28,v12,4,v28
v_add_u32 v12,576,v0
v_mul_u32_u24 v13,6554,v12
v_lshrrev_b32 v13,16,v13
v_mul_u32_u24 v16,10,v13
v_sub_u32 v12,v12,v16
v_mul_u32_u24 v29,1280,v13
v_lshl_add_u32 v29,v12,4,v29
v_lshrrev_b32 v14,4,v0
v_and_b32 v12,1,v14
v_lshlrev_b32 v12,5,v12
v_lshrrev_b32 v13,1,v14
v_lshl_add_u32 v12,v13,2,v12
v_bfe_u32 v13,v0,2,1
v_add_u32 v12,v12,v13
v_bfe_u32 v13,v0,3,1
v_lshl_add_u32 v12,v13,4,v12
v_mul_u32_u24 v30,160,v12
v_and_b32 v13,3,v0
v_lshl_add_u32 v30,v13,3,v30
v_add_u32 v30,s74,v30
s_add_u32 s61,s73,0
s_add_u32 m0,s74,0
s_nop 0
buffer_load_dwordx4 v20,s[4:7],s61 offen lds
s_add_u32 m0,s74,1024
s_nop 0
buffer_load_dwordx4 v21,s[4:7],s61 offen lds
s_add_u32 m0,s74,2048
s_nop 0
buffer_load_dwordx4 v22,s[4:7],s61 offen lds
s_add_u32 m0,s74,3072
s_nop 0
buffer_load_dwordx4 v23,s[4:7],s61 offen lds
s_add_u32 m0,s74,4096
s_nop 0
buffer_load_dwordx4 v24,s[4:7],s61 offen lds
s_add_u32 m0,s74,5120
s_nop 0
buffer_load_dwordx4 v25,s[4:7],s61 offen lds
s_add_u32 m0,s74,6144
s_nop 0
buffer_load_dwordx4 v26,s[4:7],s61 offen lds
s_add_u32 m0,s74,7168
s_nop 0
buffer_load_dwordx4 v27,s[4:7],s61 offen lds
s_add_u32 m0,s74,8192
s_nop 0
buffer_load_dwordx4 v28,s[4:7],s61 offen lds
s_add_u32 m0,s74,9216
s_nop 0
buffer_load_dwordx4 v29,s[4:7],s61 offen lds
s_add_u32 s61,s73,81920
s_add_u32 m0,s74,10240
s_nop 0
buffer_load_dwordx4 v20,s[4:7],s61 offen lds
s_add_u32 m0,s74,11264
s_nop 0
buffer_load_dwordx4 v21,s[4:7],s61 offen lds
s_add_u32 m0,s74,12288
s_nop 0
buffer_load_dwordx4 v22,s[4:7],s61 offen lds
s_add_u32 m0,s74,13312
s_nop 0
buffer_load_dwordx4 v23,s[4:7],s61 offen lds
s_add_u32 m0,s74,14336
s_nop 0
buffer_load_dwordx4 v24,s[4:7],s61 offen lds
s_add_u32 m0,s74,15360
s_nop 0
buffer_load_dwordx4 v25,s[4:7],s61 offen lds
s_add_u32 m0,s74,16384
s_nop 0
buffer_load_dwordx4 v26,s[4:7],s61 offen lds
s_add_u32 m0,s74,17408
s_nop 0
buffer_load_dwordx4 v27,s[4:7],s61 offen lds
s_add_u32 m0,s74,18432
s_nop 0
buffer_load_dwordx4 v28,s[4:7],s61 offen lds
s_add_u32 m0,s74,19456
s_nop 0
buffer_load_dwordx4 v29,s[4:7],s61 offen lds
s_add_u32 s61,s73,163840
s_add_u32 m0,s74,20480
s_nop 0
buffer_load_dwordx4 v20,s[4:7],s61 offen lds
s_add_u32 m0,s74,21504
s_nop 0
buffer_load_dwordx4 v21,s[4:7],s61 offen lds
s_add_u32 m0,s74,22528
s_nop 0
buffer_load_dwordx4 v22,s[4:7],s61 offen lds
s_add_u32 m0,s74,23552
s_nop 0
buffer_load_dwordx4 v23,s[4:7],s61 offen lds
s_add_u32 m0,s74,24576
s_nop 0
buffer_load_dwordx4 v24,s[4:7],s61 offen lds
s_add_u32 m0,s74,25600
s_nop 0
buffer_load_dwordx4 v25,s[4:7],s61 offen lds
s_add_u32 m0,s74,26624
s_nop 0
buffer_load_dwordx4 v26,s[4:7],s61 offen lds
s_add_u32 m0,s74,27648
s_nop 0
buffer_load_dwordx4 v27,s[4:7],s61 offen lds
s_add_u32 m0,s74,28672
s_nop 0
buffer_load_dwordx4 v28,s[4:7],s61 offen lds
s_add_u32 m0,s74,29696
s_nop 0
buffer_load_dwordx4 v29,s[4:7],s61 offen lds
s_add_u32 s61,s73,245760
s_add_u32 m0,s74,30720
s_nop 0
buffer_load_dwordx4 v20,s[4:7],s61 offen lds
s_add_u32 m0,s74,31744
s_nop 0
buffer_load_dwordx4 v21,s[4:7],s61 offen lds
s_add_u32 m0,s74,32768
s_nop 0
buffer_load_dwordx4 v22,s[4:7],s61 offen lds
s_add_u32 m0,s74,33792
s_nop 0
buffer_load_dwordx4 v23,s[4:7],s61 offen lds
s_add_u32 m0,s74,34816
s_nop 0
buffer_load_dwordx4 v24,s[4:7],s61 offen lds
s_add_u32 m0,s74,35840
s_nop 0
buffer_load_dwordx4 v25,s[4:7],s61 offen lds
s_add_u32 m0,s74,36864
s_nop 0
buffer_load_dwordx4 v26,s[4:7],s61 offen lds
s_add_u32 m0,s74,37888
s_nop 0
buffer_load_dwordx4 v27,s[4:7],s61 offen lds
s_add_u32 m0,s74,38912
s_nop 0
buffer_load_dwordx4 v28,s[4:7],s61 offen lds
s_add_u32 m0,s74,39936
s_nop 0
buffer_load_dwordx4 v29,s[4:7],s61 offen lds
s_waitcnt vmcnt(30)
ds_read_b64_tr_b16 a[0:1],v30 offset:0
ds_read_b64_tr_b16 a[2:3],v30 offset:320
ds_read_b64_tr_b16 a[4:5],v30 offset:1280
ds_read_b64_tr_b16 a[6:7],v30 offset:1600
ds_read_b64_tr_b16 a[8:9],v30 offset:32
ds_read_b64_tr_b16 a[10:11],v30 offset:352
ds_read_b64_tr_b16 a[12:13],v30 offset:1312
ds_read_b64_tr_b16 a[14:15],v30 offset:1632
ds_read_b64_tr_b16 a[16:17],v30 offset:64
ds_read_b64_tr_b16 a[18:19],v30 offset:384
ds_read_b64_tr_b16 a[20:21],v30 offset:1344
ds_read_b64_tr_b16 a[22:23],v30 offset:1664
s_waitcnt lgkmcnt(4)
ds_read_b64_tr_b16 a[24:25],v30 offset:96
ds_read_b64_tr_b16 a[26:27],v30 offset:416
ds_read_b64_tr_b16 a[28:29],v30 offset:1376
ds_read_b64_tr_b16 a[30:31],v30 offset:1696
ds_read_b64_tr_b16 v[32:33],v30 offset:128
ds_read_b64_tr_b16 v[34:35],v30 offset:448
ds_read_b64_tr_b16 v[36:37],v30 offset:1408
ds_read_b64_tr_b16 v[38:39],v30 offset:1728
s_waitcnt lgkmcnt(0)
s_add_u32 s61,s73,327680
s_add_u32 m0,s74,0
s_nop 0
buffer_load_dwordx4 v20,s[4:7],s61 offen lds
s_add_u32 m0,s74,1024
s_nop 0
buffer_load_dwordx4 v21,s[4:7],s61 offen lds
s_add_u32 m0,s74,2048
s_nop 0
buffer_load_dwordx4 v22,s[4:7],s61 offen lds
s_add_u32 m0,s74,3072
s_nop 0
buffer_load_dwordx4 v23,s[4:7],s61 offen lds
s_add_u32 m0,s74,4096
s_nop 0
buffer_load_dwordx4 v24,s[4:7],s61 offen lds
s_add_u32 m0,s74,5120
s_nop 0
buffer_load_dwordx4 v25,s[4:7],s61 offen lds
s_add_u32 m0,s74,6144
s_nop 0
buffer_load_dwordx4 v26,s[4:7],s61 offen lds
s_add_u32 m0,s74,7168
s_nop 0
buffer_load_dwordx4 v27,s[4:7],s61 offen lds
s_add_u32 m0,s74,8192
s_nop 0
buffer_load_dwordx4 v28,s[4:7],s61 offen lds
s_add_u32 m0,s74,9216
s_nop 0
buffer_load_dwordx4 v29,s[4:7],s61 offen lds
s_waitcnt vmcnt(30)
ds_read_b64_tr_b16 a[32:33],v30 offset:10240
ds_read_b64_tr_b16 a[34:35],v30 offset:10560
ds_read_b64_tr_b16 a[36:37],v30 offset:11520
ds_read_b64_tr_b16 a[38:39],v30 offset:11840
ds_read_b64_tr_b16 a[40:41],v30 offset:10272
ds_read_b64_tr_b16 a[42:43],v30 offset:10592
ds_read_b64_tr_b16 a[44:45],v30 offset:11552
ds_read_b64_tr_b16 a[46:47],v30 offset:11872
ds_read_b64_tr_b16 a[48:49],v30 offset:10304
ds_read_b64_tr_b16 a[50:51],v30 offset:10624
ds_read_b64_tr_b16 a[52:53],v30 offset:11584
ds_read_b64_tr_b16 a[54:55],v30 offset:11904
s_waitcnt lgkmcnt(4)
ds_read_b64_tr_b16 a[56:57],v30 offset:10336
ds_read_b64_tr_b16 a[58:59],v30 offset:10656
ds_read_b64_tr_b16 a[60:61],v30 offset:11616
ds_read_b64_tr_b16 a[62:63],v30 offset:11936
ds_read_b64_tr_b16 v[40:41],v30 offset:10368
ds_read_b64_tr_b16 v[42:43],v30 offset:10688
ds_read_b64_tr_b16 v[44:45],v30 offset:11648
ds_read_b64_tr_b16 v[46:47],v30 offset:11968
s_waitcnt lgkmcnt(0)
s_add_u32 s61,s73,409600
s_add_u32 m0,s74,10240
s_nop 0
buffer_load_dwordx4 v20,s[4:7],s61 offen lds
s_add_u32 m0,s74,11264
s_nop 0
buffer_load_dwordx4 v21,s[4:7],s61 offen lds
s_add_u32 m0,s74,12288
s_nop 0
buffer_load_dwordx4 v22,s[4:7],s61 offen lds
s_add_u32 m0,s74,13312
s_nop 0
buffer_load_dwordx4 v23,s[4:7],s61 offen lds
s_add_u32 m0,s74,14336
s_nop 0
buffer_load_dwordx4 v24,s[4:7],s61 offen lds
s_add_u32 m0,s74,15360
s_nop 0
buffer_load_dwordx4 v25,s[4:7],s61 offen lds
s_add_u32 m0,s74,16384
s_nop 0
buffer_load_dwordx4 v26,s[4:7],s61 offen lds
s_add_u32 m0,s74,17408
s_nop 0
buffer_load_dwordx4 v27,s[4:7],s61 offen lds
s_add_u32 m0,s74,18432
s_nop 0
buffer_load_dwordx4 v28,s[4:7],s61 offen lds
s_add_u32 m0,s74,19456
s_nop 0
buffer_load_dwordx4 v29,s[4:7],s61 offen lds
s_waitcnt vmcnt(30)
ds_read_b64_tr_b16 a[64:65],v30 offset:20480
ds_read_b64_tr_b16 a[66:67],v30 offset:20800
ds_read_b64_tr_b16 a[68:69],v30 offset:21760
ds_read_b64_tr_b16 a[70:71],v30 offset:22080
ds_read_b64_tr_b16 a[72:73],v30 offset:20512
ds_read_b64_tr_b16 a[74:75],v30 offset:20832
ds_read_b64_tr_b16 a[76:77],v30 offset:21792
ds_read_b64_tr_b16 a[78:79],v30 offset:22112
ds_read_b64_tr_b16 a[80:81],v30 offset:20544
ds_read_b64_tr_b16 a[82:83],v30 offset:20864
ds_read_b64_tr_b16 a[84:85],v30 offset:21824
ds_read_b64_tr_b16 a[86:87],v30 offset:22144
s_waitcnt lgkmcnt(4)
ds_read_b64_tr_b16 a[88:89],v30 offset:20576
ds_read_b64_tr_b16 a[90:91],v30 offset:20896
ds_read_b64_tr_b16 a[92:93],v30 offset:21856
ds_read_b64_tr_b16 a[94:95],v30 offset:22176
ds_read_b64_tr_b16 v[48:49],v30 offset:20608
ds_read_b64_tr_b16 v[50:51],v30 offset:20928
ds_read_b64_tr_b16 v[52:53],v30 offset:21888
ds_read_b64_tr_b16 v[54:55],v30 offset:22208
s_waitcnt lgkmcnt(0)
s_add_u32 s61,s73,491520
s_add_u32 m0,s74,20480
s_nop 0
buffer_load_dwordx4 v20,s[4:7],s61 offen lds
s_add_u32 m0,s74,21504
s_nop 0
buffer_load_dwordx4 v21,s[4:7],s61 offen lds
s_add_u32 m0,s74,22528
s_nop 0
buffer_load_dwordx4 v22,s[4:7],s61 offen lds
s_add_u32 m0,s74,23552
s_nop 0
buffer_load_dwordx4 v23,s[4:7],s61 offen lds
s_add_u32 m0,s74,24576
s_nop 0
buffer_load_dwordx4 v24,s[4:7],s61 offen lds
s_add_u32 m0,s74,25600
s_nop 0
buffer_load_dwordx4 v25,s[4:7],s61 offen lds
s_add_u32 m0,s74,26624
s_nop 0
buffer_load_dwordx4 v26,s[4:7],s61 offen lds
s_add_u32 m0,s74,27648
s_nop 0
buffer_load_dwordx4 v27,s[4:7],s61 offen lds
s_add_u32 m0,s74,28672
s_nop 0
buffer_load_dwordx4 v28,s[4:7],s61 offen lds
s_add_u32 m0,s74,29696
s_nop 0
buffer_load_dwordx4 v29,s[4:7],s61 offen lds
s_waitcnt vmcnt(30)
ds_read_b64_tr_b16 a[96:97],v30 offset:30720
ds_read_b64_tr_b16 a[98:99],v30 offset:31040
ds_read_b64_tr_b16 a[100:101],v30 offset:32000
ds_read_b64_tr_b16 a[102:103],v30 offset:32320
ds_read_b64_tr_b16 a[104:105],v30 offset:30752
ds_read_b64_tr_b16 a[106:107],v30 offset:31072
ds_read_b64_tr_b16 a[108:109],v30 offset:32032
ds_read_b64_tr_b16 a[110:111],v30 offset:32352
ds_read_b64_tr_b16 a[112:113],v30 offset:30784
ds_read_b64_tr_b16 a[114:115],v30 offset:31104
ds_read_b64_tr_b16 a[116:117],v30 offset:32064
ds_read_b64_tr_b16 a[118:119],v30 offset:32384
s_waitcnt lgkmcnt(4)
ds_read_b64_tr_b16 a[120:121],v30 offset:30816
ds_read_b64_tr_b16 a[122:123],v30 offset:31136
ds_read_b64_tr_b16 a[124:125],v30 offset:32096
ds_read_b64_tr_b16 a[126:127],v30 offset:32416
ds_read_b64_tr_b16 v[56:57],v30 offset:30848
ds_read_b64_tr_b16 v[58:59],v30 offset:31168
ds_read_b64_tr_b16 v[60:61],v30 offset:32128
ds_read_b64_tr_b16 v[62:63],v30 offset:32448
s_waitcnt lgkmcnt(0)
s_add_u32 s61,s73,573440
s_add_u32 m0,s74,30720
s_nop 0
buffer_load_dwordx4 v20,s[4:7],s61 offen lds
s_add_u32 m0,s74,31744
s_nop 0
buffer_load_dwordx4 v21,s[4:7],s61 offen lds
s_add_u32 m0,s74,32768
s_nop 0
buffer_load_dwordx4 v22,s[4:7],s61 offen lds
s_add_u32 m0,s74,33792
s_nop 0
buffer_load_dwordx4 v23,s[4:7],s61 offen lds
s_add_u32 m0,s74,34816
s_nop 0
buffer_load_dwordx4 v24,s[4:7],s61 offen lds
s_add_u32 m0,s74,35840
s_nop 0
buffer_load_dwordx4 v25,s[4:7],s61 offen lds
s_add_u32 m0,s74,36864
s_nop 0
buffer_load_dwordx4 v26,s[4:7],s61 offen lds
s_add_u32 m0,s74,37888
s_nop 0
buffer_load_dwordx4 v27,s[4:7],s61 offen lds
s_add_u32 m0,s74,38912
s_nop 0
buffer_load_dwordx4 v28,s[4:7],s61 offen lds
s_add_u32 m0,s74,39936
s_nop 0
buffer_load_dwordx4 v29,s[4:7],s61 offen lds
s_waitcnt vmcnt(30)
ds_read_b64_tr_b16 a[128:129],v30 offset:0
ds_read_b64_tr_b16 a[130:131],v30 offset:320
ds_read_b64_tr_b16 a[132:133],v30 offset:1280
ds_read_b64_tr_b16 a[134:135],v30 offset:1600
ds_read_b64_tr_b16 a[136:137],v30 offset:32
ds_read_b64_tr_b16 a[138:139],v30 offset:352
ds_read_b64_tr_b16 a[140:141],v30 offset:1312
ds_read_b64_tr_b16 a[142:143],v30 offset:1632
ds_read_b64_tr_b16 a[144:145],v30 offset:64
ds_read_b64_tr_b16 a[146:147],v30 offset:384
ds_read_b64_tr_b16 a[148:149],v30 offset:1344
ds_read_b64_tr_b16 a[150:151],v30 offset:1664
s_waitcnt lgkmcnt(4)
ds_read_b64_tr_b16 a[152:153],v30 offset:96
ds_read_b64_tr_b16 a[154:155],v30 offset:416
ds_read_b64_tr_b16 a[156:157],v30 offset:1376
ds_read_b64_tr_b16 a[158:159],v30 offset:1696
ds_read_b64_tr_b16 v[64:65],v30 offset:128
ds_read_b64_tr_b16 v[66:67],v30 offset:448
ds_read_b64_tr_b16 v[68:69],v30 offset:1408
ds_read_b64_tr_b16 v[70:71],v30 offset:1728
s_waitcnt lgkmcnt(0)
s_add_u32 s61,s73,655360
s_add_u32 m0,s74,0
s_nop 0
buffer_load_dwordx4 v20,s[4:7],s61 offen lds
s_add_u32 m0,s74,1024
s_nop 0
buffer_load_dwordx4 v21,s[4:7],s61 offen lds
s_add_u32 m0,s74,2048
s_nop 0
buffer_load_dwordx4 v22,s[4:7],s61 offen lds
s_add_u32 m0,s74,3072
s_nop 0
buffer_load_dwordx4 v23,s[4:7],s61 offen lds
s_add_u32 m0,s74,4096
s_nop 0
buffer_load_dwordx4 v24,s[4:7],s61 offen lds
s_add_u32 m0,s74,5120
s_nop 0
buffer_load_dwordx4 v25,s[4:7],s61 offen lds
s_add_u32 m0,s74,6144
s_nop 0
buffer_load_dwordx4 v26,s[4:7],s61 offen lds
s_add_u32 m0,s74,7168
s_nop 0
buffer_load_dwordx4 v27,s[4:7],s61 offen lds
s_add_u32 m0,s74,8192
s_nop 0
buffer_load_dwordx4 v28,s[4:7],s61 offen lds
s_add_u32 m0,s74,9216
s_nop 0
buffer_load_dwordx4 v29,s[4:7],s61 offen lds
s_waitcnt vmcnt(30)
ds_read_b64_tr_b16 a[160:161],v30 offset:10240
ds_read_b64_tr_b16 a[162:163],v30 offset:10560
ds_read_b64_tr_b16 a[164:165],v30 offset:11520
ds_read_b64_tr_b16 a[166:167],v30 offset:11840
ds_read_b64_tr_b16 a[168:169],v30 offset:10272
ds_read_b64_tr_b16 a[170:171],v30 offset:10592
ds_read_b64_tr_b16 a[172:173],v30 offset:11552
ds_read_b64_tr_b16 a[174:175],v30 offset:11872
ds_read_b64_tr_b16 a[176:177],v30 offset:10304
ds_read_b64_tr_b16 a[178:179],v30 offset:10624
ds_read_b64_tr_b16 a[180:181],v30 offset:11584
ds_read_b64_tr_b16 a[182:183],v30 offset:11904
s_waitcnt lgkmcnt(4)
ds_read_b64_tr_b16 a[184:185],v30 offset:10336
ds_read_b64_tr_b16 a[186:187],v30 offset:10656
ds_read_b64_tr_b16 a[188:189],v30 offset:11616
ds_read_b64_tr_b16 a[190:191],v30 offset:11936
ds_read_b64_tr_b16 v[72:73],v30 offset:10368
ds_read_b64_tr_b16 v[74:75],v30 offset:10688
ds_read_b64_tr_b16 v[76:77],v30 offset:11648
ds_read_b64_tr_b16 v[78:79],v30 offset:11968
s_waitcnt lgkmcnt(0)
s_add_u32 s61,s73,737280
s_add_u32 m0,s74,10240
s_nop 0
buffer_load_dwordx4 v20,s[4:7],s61 offen lds
s_add_u32 m0,s74,11264
s_nop 0
buffer_load_dwordx4 v21,s[4:7],s61 offen lds
s_add_u32 m0,s74,12288
s_nop 0
buffer_load_dwordx4 v22,s[4:7],s61 offen lds
s_add_u32 m0,s74,13312
s_nop 0
buffer_load_dwordx4 v23,s[4:7],s61 offen lds
s_add_u32 m0,s74,14336
s_nop 0
buffer_load_dwordx4 v24,s[4:7],s61 offen lds
s_add_u32 m0,s74,15360
s_nop 0
buffer_load_dwordx4 v25,s[4:7],s61 offen lds
s_add_u32 m0,s74,16384
s_nop 0
buffer_load_dwordx4 v26,s[4:7],s61 offen lds
s_add_u32 m0,s74,17408
s_nop 0
buffer_load_dwordx4 v27,s[4:7],s61 offen lds
s_add_u32 m0,s74,18432
s_nop 0
buffer_load_dwordx4 v28,s[4:7],s61 offen lds
s_add_u32 m0,s74,19456
s_nop 0
buffer_load_dwordx4 v29,s[4:7],s61 offen lds
s_waitcnt vmcnt(30)
ds_read_b64_tr_b16 a[192:193],v30 offset:20480
ds_read_b64_tr_b16 a[194:195],v30 offset:20800
ds_read_b64_tr_b16 a[196:197],v30 offset:21760
ds_read_b64_tr_b16 a[198:199],v30 offset:22080
ds_read_b64_tr_b16 a[200:201],v30 offset:20512
ds_read_b64_tr_b16 a[202:203],v30 offset:20832
ds_read_b64_tr_b16 a[204:205],v30 offset:21792
ds_read_b64_tr_b16 a[206:207],v30 offset:22112
ds_read_b64_tr_b16 a[208:209],v30 offset:20544
ds_read_b64_tr_b16 a[210:211],v30 offset:20864
ds_read_b64_tr_b16 a[212:213],v30 offset:21824
ds_read_b64_tr_b16 a[214:215],v30 offset:22144
s_waitcnt lgkmcnt(4)
ds_read_b64_tr_b16 a[216:217],v30 offset:20576
ds_read_b64_tr_b16 a[218:219],v30 offset:20896
ds_read_b64_tr_b16 a[220:221],v30 offset:21856
ds_read_b64_tr_b16 a[222:223],v30 offset:22176
ds_read_b64_tr_b16 v[80:81],v30 offset:20608
ds_read_b64_tr_b16 v[82:83],v30 offset:20928
ds_read_b64_tr_b16 v[84:85],v30 offset:21888
ds_read_b64_tr_b16 v[86:87],v30 offset:22208
s_waitcnt lgkmcnt(0)
s_add_u32 s61,s73,819200
s_add_u32 m0,s74,20480
s_nop 0
buffer_load_dwordx4 v20,s[4:7],s61 offen lds
s_add_u32 m0,s74,21504
s_nop 0
buffer_load_dwordx4 v21,s[4:7],s61 offen lds
s_add_u32 m0,s74,22528
s_nop 0
buffer_load_dwordx4 v22,s[4:7],s61 offen lds
s_add_u32 m0,s74,23552
s_nop 0
buffer_load_dwordx4 v23,s[4:7],s61 offen lds
s_add_u32 m0,s74,24576
s_nop 0
buffer_load_dwordx4 v24,s[4:7],s61 offen lds
s_add_u32 m0,s74,25600
s_nop 0
buffer_load_dwordx4 v25,s[4:7],s61 offen lds
s_add_u32 m0,s74,26624
s_nop 0
buffer_load_dwordx4 v26,s[4:7],s61 offen lds
s_add_u32 m0,s74,27648
s_nop 0
buffer_load_dwordx4 v27,s[4:7],s61 offen lds
s_add_u32 m0,s74,28672
s_nop 0
buffer_load_dwordx4 v28,s[4:7],s61 offen lds
s_add_u32 m0,s74,29696
s_nop 0
buffer_load_dwordx4 v29,s[4:7],s61 offen lds
s_waitcnt vmcnt(30)
ds_read_b64_tr_b16 a[224:225],v30 offset:30720
ds_read_b64_tr_b16 a[226:227],v30 offset:31040
ds_read_b64_tr_b16 a[228:229],v30 offset:32000
ds_read_b64_tr_b16 a[230:231],v30 offset:32320
ds_read_b64_tr_b16 a[232:233],v30 offset:30752
ds_read_b64_tr_b16 a[234:235],v30 offset:31072
ds_read_b64_tr_b16 a[236:237],v30 offset:32032
ds_read_b64_tr_b16 a[238:239],v30 offset:32352
ds_read_b64_tr_b16 a[240:241],v30 offset:30784
ds_read_b64_tr_b16 a[242:243],v30 offset:31104
ds_read_b64_tr_b16 a[244:245],v30 offset:32064
ds_read_b64_tr_b16 a[246:247],v30 offset:32384
s_waitcnt lgkmcnt(4)
ds_read_b64_tr_b16 a[248:249],v30 offset:30816
ds_read_b64_tr_b16 a[250:251],v30 offset:31136
ds_read_b64_tr_b16 a[252:253],v30 offset:32096
ds_read_b64_tr_b16 a[254:255],v30 offset:32416
ds_read_b64_tr_b16 v[88:89],v30 offset:30848
ds_read_b64_tr_b16 v[90:91],v30 offset:31168
ds_read_b64_tr_b16 v[92:93],v30 offset:32128
ds_read_b64_tr_b16 v[94:95],v30 offset:32448
s_waitcnt lgkmcnt(0)
s_add_u32 s61,s73,901120
s_add_u32 m0,s74,30720
s_nop 0
buffer_load_dwordx4 v20,s[4:7],s61 offen lds
s_add_u32 m0,s74,31744
s_nop 0
buffer_load_dwordx4 v21,s[4:7],s61 offen lds
s_add_u32 m0,s74,32768
s_nop 0
buffer_load_dwordx4 v22,s[4:7],s61 offen lds
s_add_u32 m0,s74,33792
s_nop 0
buffer_load_dwordx4 v23,s[4:7],s61 offen lds
s_add_u32 m0,s74,34816
s_nop 0
buffer_load_dwordx4 v24,s[4:7],s61 offen lds
s_add_u32 m0,s74,35840
s_nop 0
buffer_load_dwordx4 v25,s[4:7],s61 offen lds
s_add_u32 m0,s74,36864
s_nop 0
buffer_load_dwordx4 v26,s[4:7],s61 offen lds
s_add_u32 m0,s74,37888
s_nop 0
buffer_load_dwordx4 v27,s[4:7],s61 offen lds
s_add_u32 m0,s74,38912
s_nop 0
buffer_load_dwordx4 v28,s[4:7],s61 offen lds
s_add_u32 m0,s74,39936
s_nop 0
buffer_load_dwordx4 v29,s[4:7],s61 offen lds
s_waitcnt vmcnt(30)
ds_read_b64_tr_b16 v[128:129],v30 offset:0
ds_read_b64_tr_b16 v[130:131],v30 offset:320
ds_read_b64_tr_b16 v[132:133],v30 offset:1280
ds_read_b64_tr_b16 v[134:135],v30 offset:1600
ds_read_b64_tr_b16 v[136:137],v30 offset:32
ds_read_b64_tr_b16 v[138:139],v30 offset:352
ds_read_b64_tr_b16 v[140:141],v30 offset:1312
ds_read_b64_tr_b16 v[142:143],v30 offset:1632
ds_read_b64_tr_b16 v[144:145],v30 offset:64
ds_read_b64_tr_b16 v[146:147],v30 offset:384
ds_read_b64_tr_b16 v[148:149],v30 offset:1344
ds_read_b64_tr_b16 v[150:151],v30 offset:1664
s_waitcnt lgkmcnt(4)
ds_read_b64_tr_b16 v[152:153],v30 offset:96
ds_read_b64_tr_b16 v[154:155],v30 offset:416
ds_read_b64_tr_b16 v[156:157],v30 offset:1376
ds_read_b64_tr_b16 v[158:159],v30 offset:1696
ds_read_b64_tr_b16 v[96:97],v30 offset:128
ds_read_b64_tr_b16 v[98:99],v30 offset:448
ds_read_b64_tr_b16 v[100:101],v30 offset:1408
ds_read_b64_tr_b16 v[102:103],v30 offset:1728
s_waitcnt lgkmcnt(0)
s_waitcnt vmcnt(20)
ds_read_b64_tr_b16 v[160:161],v30 offset:10240
ds_read_b64_tr_b16 v[162:163],v30 offset:10560
ds_read_b64_tr_b16 v[164:165],v30 offset:11520
ds_read_b64_tr_b16 v[166:167],v30 offset:11840
ds_read_b64_tr_b16 v[168:169],v30 offset:10272
ds_read_b64_tr_b16 v[170:171],v30 offset:10592
ds_read_b64_tr_b16 v[172:173],v30 offset:11552
ds_read_b64_tr_b16 v[174:175],v30 offset:11872
ds_read_b64_tr_b16 v[176:177],v30 offset:10304
ds_read_b64_tr_b16 v[178:179],v30 offset:10624
ds_read_b64_tr_b16 v[180:181],v30 offset:11584
ds_read_b64_tr_b16 v[182:183],v30 offset:11904
s_waitcnt lgkmcnt(4)
ds_read_b64_tr_b16 v[184:185],v30 offset:10336
ds_read_b64_tr_b16 v[186:187],v30 offset:10656
ds_read_b64_tr_b16 v[188:189],v30 offset:11616
ds_read_b64_tr_b16 v[190:191],v30 offset:11936
ds_read_b64_tr_b16 v[104:105],v30 offset:10368
ds_read_b64_tr_b16 v[106:107],v30 offset:10688
ds_read_b64_tr_b16 v[108:109],v30 offset:11648
ds_read_b64_tr_b16 v[110:111],v30 offset:11968
s_waitcnt lgkmcnt(0)
s_waitcnt vmcnt(10)
ds_read_b64_tr_b16 v[192:193],v30 offset:20480
ds_read_b64_tr_b16 v[194:195],v30 offset:20800
ds_read_b64_tr_b16 v[196:197],v30 offset:21760
ds_read_b64_tr_b16 v[198:199],v30 offset:22080
ds_read_b64_tr_b16 v[200:201],v30 offset:20512
ds_read_b64_tr_b16 v[202:203],v30 offset:20832
ds_read_b64_tr_b16 v[204:205],v30 offset:21792
ds_read_b64_tr_b16 v[206:207],v30 offset:22112
ds_read_b64_tr_b16 v[208:209],v30 offset:20544
ds_read_b64_tr_b16 v[210:211],v30 offset:20864
ds_read_b64_tr_b16 v[212:213],v30 offset:21824
ds_read_b64_tr_b16 v[214:215],v30 offset:22144
s_waitcnt lgkmcnt(4)
ds_read_b64_tr_b16 v[216:217],v30 offset:20576
ds_read_b64_tr_b16 v[218:219],v30 offset:20896
ds_read_b64_tr_b16 v[220:221],v30 offset:21856
ds_read_b64_tr_b16 v[222:223],v30 offset:22176
ds_read_b64_tr_b16 v[112:113],v30 offset:20608
ds_read_b64_tr_b16 v[114:115],v30 offset:20928
ds_read_b64_tr_b16 v[116:117],v30 offset:21888
ds_read_b64_tr_b16 v[118:119],v30 offset:22208
s_waitcnt lgkmcnt(0)
s_waitcnt vmcnt(0)
ds_read_b64_tr_b16 v[224:225],v30 offset:30720
ds_read_b64_tr_b16 v[226:227],v30 offset:31040
ds_read_b64_tr_b16 v[228:229],v30 offset:32000
ds_read_b64_tr_b16 v[230:231],v30 offset:32320
ds_read_b64_tr_b16 v[232:233],v30 offset:30752
ds_read_b64_tr_b16 v[234:235],v30 offset:31072
ds_read_b64_tr_b16 v[236:237],v30 offset:32032
ds_read_b64_tr_b16 v[238:239],v30 offset:32352
ds_read_b64_tr_b16 v[240:241],v30 offset:30784
ds_read_b64_tr_b16 v[242:243],v30 offset:31104
ds_read_b64_tr_b16 v[244:245],v30 offset:32064
ds_read_b64_tr_b16 v[246:247],v30 offset:32384
s_waitcnt lgkmcnt(4)
ds_read_b64_tr_b16 v[248:249],v30 offset:30816
ds_read_b64_tr_b16 v[250:251],v30 offset:31136
ds_read_b64_tr_b16 v[252:253],v30 offset:32096
ds_read_b64_tr_b16 v[254:255],v30 offset:32416
ds_read_b64_tr_b16 v[120:121],v30 offset:30848
ds_read_b64_tr_b16 v[122:123],v30 offset:31168
ds_read_b64_tr_b16 v[124:125],v30 offset:32128
ds_read_b64_tr_b16 v[126:127],v30 offset:32448
s_waitcnt lgkmcnt(0)
s_barrier
ds_write_b128 v4,v[32:35] offset:0
ds_write_b128 v4,v[36:39] offset:1024
ds_write_b128 v4,v[40:43] offset:2048
ds_write_b128 v4,v[44:47] offset:3072
ds_write_b128 v4,v[48:51] offset:4096
ds_write_b128 v4,v[52:55] offset:5120
ds_write_b128 v4,v[56:59] offset:6144
ds_write_b128 v4,v[60:63] offset:7168
s_waitcnt lgkmcnt(0)
ds_write_b128 v4,v[64:67] offset:8192
ds_write_b128 v4,v[68:71] offset:9216
ds_write_b128 v4,v[72:75] offset:10240
ds_write_b128 v4,v[76:79] offset:11264
ds_write_b128 v4,v[80:83] offset:12288
ds_write_b128 v4,v[84:87] offset:13312
ds_write_b128 v4,v[88:91] offset:14336
ds_write_b128 v4,v[92:95] offset:15360
s_waitcnt lgkmcnt(0)
ds_write_b128 v4,v[96:99] offset:16384
ds_write_b128 v4,v[100:103] offset:17408
ds_write_b128 v4,v[104:107] offset:18432
ds_write_b128 v4,v[108:111] offset:19456
ds_write_b128 v4,v[112:115] offset:20480
ds_write_b128 v4,v[116:119] offset:21504
ds_write_b128 v4,v[120:123] offset:22528
ds_write_b128 v4,v[124:127] offset:23552
s_waitcnt lgkmcnt(0)
s_barrier
s_lshl_b32 s3,s49,2
v_mov_b32 v13,s3
s_nop 1
ibw_172:
buffer_load_dword v12,v13,s[12:15],0 offen sc1
s_waitcnt vmcnt(0)
v_cmp_ne_u32 vcc,256,v12
s_nop 0
s_cbranch_vccz ok_173
s_sleep 8
s_sub_u32 s47,s47,1
s_cbranch_scc1 ABORT
s_branch ibw_172
ok_173:
s_cmp_lg_u32 s49,0
s_cbranch_scc1 ibok_174
v_and_b32 v13,7,v0
v_lshlrev_b32 v13,2,v13
buffer_load_dword v12,v13,s[12:15],0 offen offset:32 sc1
s_waitcnt vmcnt(0)
v_cmp_ne_u32 vcc,32,v12
s_nop 0
s_cbranch_vccz ibok_174
s_barrier
s_mov_b32 s49,1
s_mov_b32 s3,s2
s_load_dwordx16 s[16:31],s[0:1],0
s_load_dwordx8 s[32:39],s[0:1],64
s_waitcnt lgkmcnt(0)
s_branch DISPATCH
ibok_174:
v_mov_b32 v13,192
buffer_load_dword v12,v13,s[12:15],0 offen sc1
s_waitcnt vmcnt(0)
v_readfirstlane_b32 s60,v12
s_cmp_gt_i32 s60,0
s_cselect_b32 s60,0x2000,0
s_add_u32 s83,s83,s60
s_mov_b32 s50,0
s_mov_b32 s77,0
s_cmp_lg_u32 s49,0
s_cbranch_scc1 CW_LOOP_S
CW_LOOP_F:
s_sub_u32 s60,s50,14
s_lshr_b32 s52,s60,1
s_and_b32 s51,s60,1
s_cmp_eq_u32 s51,0
s_cselect_b32 s61,14,0
s_add_u32 s52,s52,s61
s_sub_u32 s61,s60,50
s_cmp_ge_u32 s60,100
s_cselect_b32 s52,s61,s52
s_cselect_b32 s51,1,s51
s_cmp_lt_u32 s50,14
s_cselect_b32 s52,s50,s52
s_cselect_b32 s51,0,s51
s_cmp_eq_u32 s52,63
s_cbranch_scc1 CW_NEXT_F
s_add_u32 s58,s52,1
s_lshl_b32 s61,s51,9
s_add_u32 s72,s61,s35
s_add_u32 s69,s61,s85
s_lshl_b32 s61,s51,2
s_and_b32 s60,s52,3
s_add_u32 s60,s60,s61
s_mul_i32 s70,s60,49152
s_add_u32 s70,s70,s33
s_add_u32 s71,s70,4096
s_add_u32 s80,s70,8192
s_bfe_u32 s57,s52,0x10002
s_bfe_u32 s31,s58,0x10002
s_and_b32 s60,s58,3
s_add_u32 s60,s60,s61
s_mul_i32 s59,s60,20480
s_add_u32 s59,s59,s84
s_lshl_b32 s68,s60,16
s_add_u32 s68,s68,s83
s_xor_b32 s77,s77,11264
v_add_u32 v7,s77,v5
v_add_u32 v8,s77,v6
s_add_u32 s60,s52,2
v_mov_b32 v16,s60
v_mov_b32 v80,0
v_mov_b32 v81,0
v_mov_b32 v82,0
v_mov_b32 v83,0
v_mov_b32 v84,0
v_mov_b32 v85,0
v_mov_b32 v86,0
v_mov_b32 v87,0
v_mov_b32 v88,0
v_mov_b32 v89,0
v_mov_b32 v90,0
v_mov_b32 v91,0
v_mov_b32 v92,0
v_mov_b32 v93,0
v_mov_b32 v94,0
v_mov_b32 v95,0
v_mov_b32 v96,0
v_mov_b32 v97,0
v_mov_b32 v98,0
v_mov_b32 v99,0
ds_read_b128 v[100:103],v4 offset:0
ds_read_b128 v[104:107],v4 offset:1024
ds_read_b128 v[108:111],v4 offset:2048
ds_read_b128 v[112:115],v4 offset:3072
s_cmp_lg_u32 s46,0
s_cbranch_scc1 np_175
db_176:
buffer_load_dword v12,v3,s[8:11],s72 offen sc1
s_waitcnt vmcnt(0)
v_cmp_gt_u32 vcc,s58,v12
s_cbranch_vccz dbok_177
s_sub_u32 s47,s47,1
s_cbranch_scc1 ABORT
s_branch db_176
dbok_177:
np_175:
s_barrier
buffer_load_dwordx4 v[32:35],v1,s[8:11],s70 offen sc1
s_nop 7
buffer_load_dwordx4 v[36:39],v1,s[8:11],s70 offen offset:1024 sc1
s_nop 7
buffer_load_dwordx4 v[40:43],v1,s[8:11],s70 offen offset:2048 sc1
s_nop 7
buffer_load_dwordx4 v[44:47],v1,s[8:11],s70 offen offset:3072 sc1
s_nop 7
buffer_load_dwordx4 v[48:51],v1,s[8:11],s71 offen sc1
s_waitcnt vmcnt(4)
v_and_b32 v12,1,v32
v_cmp_ne_u32 vcc,s57,v12
s_cbranch_vccnz ws_178
wg_187:
v_smfmac_f32_16x16x64_bf16 v[80:83],v[32:35],a[0:7],v2
buffer_load_dwordx4 v[52:55],v1,s[8:11],s71 offen offset:1024 sc1
v_smfmac_f32_16x16x64_bf16 v[84:87],v[32:35],a[8:15],v2
s_waitcnt vmcnt(4)
v_and_b32 v12,1,v36
v_smfmac_f32_16x16x64_bf16 v[88:91],v[32:35],a[16:23],v2
v_cmp_ne_u32 vcc,s57,v12
v_smfmac_f32_16x16x64_bf16 v[92:95],v[32:35],a[24:31],v2
s_waitcnt lgkmcnt(2)
v_smfmac_f32_16x16x64_bf16 v[96:99],v[32:35],v[100:107],v2
s_cbranch_vccnz ws_179
wg_188:
v_smfmac_f32_16x16x64_bf16 v[80:83],v[36:39],a[32:39],v2
buffer_load_dwordx4 v[56:59],v1,s[8:11],s71 offen offset:2048 sc1
v_smfmac_f32_16x16x64_bf16 v[84:87],v[36:39],a[40:47],v2
s_waitcnt vmcnt(4)
v_and_b32 v12,1,v40
v_smfmac_f32_16x16x64_bf16 v[88:91],v[36:39],a[48:55],v2
v_cmp_ne_u32 vcc,s57,v12
ds_read_b128 v[100:103],v4 offset:4096
v_smfmac_f32_16x16x64_bf16 v[92:95],v[36:39],a[56:63],v2
ds_read_b128 v[104:107],v4 offset:5120
s_waitcnt lgkmcnt(2)
v_smfmac_f32_16x16x64_bf16 v[96:99],v[36:39],v[108:115],v2
s_cbranch_vccnz ws_180
wg_189:
v_smfmac_f32_16x16x64_bf16 v[80:83],v[40:43],a[64:71],v2
buffer_load_dwordx4 v[60:63],v1,s[8:11],s71 offen offset:3072 sc1
v_smfmac_f32_16x16x64_bf16 v[84:87],v[40:43],a[72:79],v2
s_waitcnt vmcnt(4)
v_and_b32 v12,1,v44
v_smfmac_f32_16x16x64_bf16 v[88:91],v[40:43],a[80:87],v2
v_cmp_ne_u32 vcc,s57,v12
ds_read_b128 v[108:111],v4 offset:6144
v_smfmac_f32_16x16x64_bf16 v[92:95],v[40:43],a[88:95],v2
ds_read_b128 v[112:115],v4 offset:7168
s_waitcnt lgkmcnt(2)
v_smfmac_f32_16x16x64_bf16 v[96:99],v[40:43],v[100:107],v2
s_cbranch_vccnz ws_181
wg_190:
v_smfmac_f32_16x16x64_bf16 v[80:83],v[44:47],a[96:103],v2
buffer_load_dwordx4 v[64:67],v1,s[8:11],s80 offen sc1
v_smfmac_f32_16x16x64_bf16 v[84:87],v[44:47],a[104:111],v2
s_waitcnt vmcnt(4)
v_and_b32 v12,1,v48
v_smfmac_f32_16x16x64_bf16 v[88:91],v[44:47],a[112:119],v2
v_cmp_ne_u32 vcc,s57,v12
ds_read_b128 v[100:103],v4 offset:8192
v_smfmac_f32_16x16x64_bf16 v[92:95],v[44:47],a[120:127],v2
ds_read_b128 v[104:107],v4 offset:9216
s_waitcnt lgkmcnt(2)
v_smfmac_f32_16x16x64_bf16 v[96:99],v[44:47],v[108:115],v2
s_cbranch_vccnz ws_182
wg_191:
v_smfmac_f32_16x16x64_bf16 v[80:83],v[48:51],a[128:135],v2
buffer_load_dwordx4 v[68:71],v1,s[8:11],s80 offen offset:1024 sc1
v_smfmac_f32_16x16x64_bf16 v[84:87],v[48:51],a[136:143],v2
s_waitcnt vmcnt(4)
v_and_b32 v12,1,v52
v_smfmac_f32_16x16x64_bf16 v[88:91],v[48:51],a[144:151],v2
v_cmp_ne_u32 vcc,s57,v12
ds_read_b128 v[108:111],v4 offset:10240
v_smfmac_f32_16x16x64_bf16 v[92:95],v[48:51],a[152:159],v2
ds_read_b128 v[112:115],v4 offset:11264
s_waitcnt lgkmcnt(2)
v_smfmac_f32_16x16x64_bf16 v[96:99],v[48:51],v[100:107],v2
s_cbranch_vccnz ws_183
wg_192:
v_smfmac_f32_16x16x64_bf16 v[80:83],v[52:55],a[160:167],v2
s_waitcnt vmcnt(2)
v_bitop3_b32 v12,v56,v60,s57 bitop3:0x7e
v_smfmac_f32_16x16x64_bf16 v[84:87],v[52:55],a[168:175],v2
v_and_b32 v12,1,v12
buffer_load_dwordx4 v[72:75],v1,s[8:11],s80 offen offset:2048 sc1
v_smfmac_f32_16x16x64_bf16 v[88:91],v[52:55],a[176:183],v2
v_cmp_ne_u32 vcc,0,v12
ds_read_b128 v[100:103],v4 offset:12288
v_smfmac_f32_16x16x64_bf16 v[92:95],v[52:55],a[184:191],v2
ds_read_b128 v[104:107],v4 offset:13312
s_waitcnt lgkmcnt(2)
v_smfmac_f32_16x16x64_bf16 v[96:99],v[52:55],v[108:115],v2
s_cbranch_vccnz ws_184
wg_193:
v_smfmac_f32_16x16x64_bf16 v[80:83],v[56:59],a[192:199],v2
buffer_load_dwordx4 v[76:79],v1,s[8:11],s80 offen offset:3072 sc1
v_smfmac_f32_16x16x64_bf16 v[84:87],v[56:59],a[200:207],v2
ds_read_b128 v[108:111],v4 offset:14336
v_smfmac_f32_16x16x64_bf16 v[88:91],v[56:59],a[208:215],v2
ds_read_b128 v[112:115],v4 offset:15360
v_smfmac_f32_16x16x64_bf16 v[92:95],v[56:59],a[216:223],v2
s_waitcnt lgkmcnt(2)
v_smfmac_f32_16x16x64_bf16 v[96:99],v[56:59],v[100:107],v2
ds_read_b128 v[100:103],v4 offset:16384
v_smfmac_f32_16x16x64_bf16 v[80:83],v[60:63],a[224:231],v2
s_waitcnt vmcnt(2)
v_bitop3_b32 v12,v64,v68,s57 bitop3:0x7e
v_smfmac_f32_16x16x64_bf16 v[84:87],v[60:63],a[232:239],v2
v_and_b32 v12,1,v12
ds_read_b128 v[104:107],v4 offset:17408
v_smfmac_f32_16x16x64_bf16 v[88:91],v[60:63],a[240:247],v2
v_cmp_ne_u32 vcc,0,v12
v_smfmac_f32_16x16x64_bf16 v[92:95],v[60:63],a[248:255],v2
s_waitcnt lgkmcnt(2)
v_smfmac_f32_16x16x64_bf16 v[96:99],v[60:63],v[108:115],v2
s_cbranch_vccnz ws_185
wg_194:
v_smfmac_f32_16x16x64_bf16 v[80:83],v[64:67],v[128:135],v2
ds_read_b128 v[108:111],v4 offset:18432
v_smfmac_f32_16x16x64_bf16 v[84:87],v[64:67],v[136:143],v2
ds_read_b128 v[112:115],v4 offset:19456
v_smfmac_f32_16x16x64_bf16 v[88:91],v[64:67],v[144:151],v2
v_smfmac_f32_16x16x64_bf16 v[92:95],v[64:67],v[152:159],v2
s_waitcnt lgkmcnt(2)
v_smfmac_f32_16x16x64_bf16 v[96:99],v[64:67],v[100:107],v2
ds_read_b128 v[100:103],v4 offset:20480
v_smfmac_f32_16x16x64_bf16 v[80:83],v[68:71],v[160:167],v2
s_waitcnt vmcnt(0)
v_bitop3_b32 v12,v72,v76,s57 bitop3:0x7e
v_smfmac_f32_16x16x64_bf16 v[84:87],v[68:71],v[168:175],v2
v_and_b32 v12,1,v12
ds_read_b128 v[104:107],v4 offset:21504
v_smfmac_f32_16x16x64_bf16 v[88:91],v[68:71],v[176:183],v2
v_cmp_ne_u32 vcc,0,v12
v_smfmac_f32_16x16x64_bf16 v[92:95],v[68:71],v[184:191],v2
s_waitcnt lgkmcnt(2)
v_smfmac_f32_16x16x64_bf16 v[96:99],v[68:71],v[108:115],v2
s_cbranch_vccnz ws_186
wg_195:
v_smfmac_f32_16x16x64_bf16 v[80:83],v[72:75],v[192:199],v2
ds_read_b128 v[108:111],v4 offset:22528
v_smfmac_f32_16x16x64_bf16 v[80:83],v[76:79],v[224:231],v2
ds_read_b128 v[112:115],v4 offset:23552
v_smfmac_f32_16x16x64_bf16 v[84:87],v[72:75],v[200:207],v2
v_smfmac_f32_16x16x64_bf16 v[84:87],v[76:79],v[232:239],v2
v_smfmac_f32_16x16x64_bf16 v[88:91],v[72:75],v[208:215],v2
s_nop 3
v_add_f32 v80,v80,v81
v_smfmac_f32_16x16x64_bf16 v[88:91],v[76:79],v[240:247],v2
v_add_f32 v82,v82,v83
ds_write2_b32 v7,v80,v82 offset0:0 offset1:88
v_smfmac_f32_16x16x64_bf16 v[92:95],v[72:75],v[216:223],v2
v_add_f32 v84,v84,v85
v_smfmac_f32_16x16x64_bf16 v[92:95],v[76:79],v[248:255],v2
v_add_f32 v86,v86,v87
s_waitcnt lgkmcnt(3)
v_smfmac_f32_16x16x64_bf16 v[96:99],v[72:75],v[100:107],v2
ds_write2_b32 v7,v84,v86 offset0:16 offset1:104
s_waitcnt lgkmcnt(2)
v_smfmac_f32_16x16x64_bf16 v[96:99],v[76:79],v[108:115],v2
v_add_f32 v88,v88,v89
v_add_f32 v90,v90,v91
ds_write2_b32 v7,v88,v90 offset0:32 offset1:120
v_add_f32 v92,v92,v93
v_add_f32 v94,v94,v95
ds_write2_b32 v7,v92,v94 offset0:48 offset1:136
s_nop 1
v_add_f32 v96,v96,v97
v_add_f32 v98,v98,v99
ds_write2_b32 v7,v96,v98 offset0:64 offset1:152
s_mov_b64 exec,1
buffer_store_dword v16,v1,s[8:11],s69 offen
s_mov_b64 exec,-1
s_waitcnt lgkmcnt(0)
s_barrier
ds_read_b128 v[32:35],v8 offset:0
ds_read_b128 v[36:39],v8 offset:2816
ds_read_b128 v[40:43],v8 offset:5632
ds_read_b128 v[44:47],v8 offset:8448
s_mov_b64 exec,s[88:89]
s_waitcnt lgkmcnt(2)
v_pk_add_f32 v[32:33],v[32:33],v[36:37]
v_pk_add_f32 v[34:35],v[34:35],v[38:39]
s_waitcnt lgkmcnt(0)
v_pk_add_f32 v[40:41],v[40:41],v[44:45]
v_pk_add_f32 v[42:43],v[42:43],v[46:47]
v_pk_add_f32 v[32:33],v[32:33],v[40:41]
v_pk_add_f32 v[34:35],v[34:35],v[42:43]
v_and_or_b32 v32,v32,-2,s31
buffer_store_dwordx4 v[32:35],v9,s[8:11],s59 offen
s_barrier
buffer_store_dwordx4 v[32:35],v9,s[8:11],s68 offen sc1
s_mov_b64 exec,-1
s_nop 0
CW_NEXT_F:
s_add_u32 s50,s50,1
s_cmp_lt_u32 s50,128
s_cbranch_scc1 CW_LOOP_F
s_branch CW_DONE
ws_178:
buffer_load_dwordx4 v[32:35],v1,s[8:11],s70 offen sc1
buffer_load_dwordx4 v[36:39],v1,s[8:11],s70 offen offset:1024 sc1
buffer_load_dwordx4 v[40:43],v1,s[8:11],s70 offen offset:2048 sc1
buffer_load_dwordx4 v[44:47],v1,s[8:11],s70 offen offset:3072 sc1
buffer_load_dwordx4 v[48:51],v1,s[8:11],s71 offen sc1
s_sub_u32 s47,s47,1
s_cbranch_scc1 ABORT
s_waitcnt vmcnt(4)
v_and_b32 v12,1,v32
v_cmp_ne_u32 vcc,s57,v12
s_nop 0
s_cbranch_vccnz ws_178
s_branch wg_187
ws_179:
buffer_load_dwordx4 v[36:39],v1,s[8:11],s70 offen offset:1024 sc1
buffer_load_dwordx4 v[40:43],v1,s[8:11],s70 offen offset:2048 sc1
buffer_load_dwordx4 v[44:47],v1,s[8:11],s70 offen offset:3072 sc1
buffer_load_dwordx4 v[48:51],v1,s[8:11],s71 offen sc1
buffer_load_dwordx4 v[52:55],v1,s[8:11],s71 offen offset:1024 sc1
s_sub_u32 s47,s47,1
s_cbranch_scc1 ABORT
s_waitcnt vmcnt(4)
v_and_b32 v12,1,v36
v_cmp_ne_u32 vcc,s57,v12
s_nop 0
s_cbranch_vccnz ws_179
s_branch wg_188
ws_180:
buffer_load_dwordx4 v[40:43],v1,s[8:11],s70 offen offset:2048 sc1
buffer_load_dwordx4 v[44:47],v1,s[8:11],s70 offen offset:3072 sc1
buffer_load_dwordx4 v[48:51],v1,s[8:11],s71 offen sc1
buffer_load_dwordx4 v[52:55],v1,s[8:11],s71 offen offset:1024 sc1
buffer_load_dwordx4 v[56:59],v1,s[8:11],s71 offen offset:2048 sc1
s_sub_u32 s47,s47,1
s_cbranch_scc1 ABORT
s_waitcnt vmcnt(4)
v_and_b32 v12,1,v40
v_cmp_ne_u32 vcc,s57,v12
s_nop 0
s_cbranch_vccnz ws_180
s_branch wg_189
ws_181:
buffer_load_dwordx4 v[44:47],v1,s[8:11],s70 offen offset:3072 sc1
buffer_load_dwordx4 v[48:51],v1,s[8:11],s71 offen sc1
buffer_load_dwordx4 v[52:55],v1,s[8:11],s71 offen offset:1024 sc1
buffer_load_dwordx4 v[56:59],v1,s[8:11],s71 offen offset:2048 sc1
buffer_load_dwordx4 v[60:63],v1,s[8:11],s71 offen offset:3072 sc1
s_sub_u32 s47,s47,1
s_cbranch_scc1 ABORT
s_waitcnt vmcnt(4)
v_and_b32 v12,1,v44
v_cmp_ne_u32 vcc,s57,v12
s_nop 0
s_cbranch_vccnz ws_181
s_branch wg_190
ws_182:
buffer_load_dwordx4 v[48:51],v1,s[8:11],s71 offen sc1
buffer_load_dwordx4 v[52:55],v1,s[8:11],s71 offen offset:1024 sc1
buffer_load_dwordx4 v[56:59],v1,s[8:11],s71 offen offset:2048 sc1
buffer_load_dwordx4 v[60:63],v1,s[8:11],s71 offen offset:3072 sc1
buffer_load_dwordx4 v[64:67],v1,s[8:11],s80 offen sc1
s_sub_u32 s47,s47,1
s_cbranch_scc1 ABORT
s_waitcnt vmcnt(4)
v_and_b32 v12,1,v48
v_cmp_ne_u32 vcc,s57,v12
s_nop 0
s_cbranch_vccnz ws_182
s_branch wg_191
ws_183:
buffer_load_dwordx4 v[52:55],v1,s[8:11],s71 offen offset:1024 sc1
buffer_load_dwordx4 v[56:59],v1,s[8:11],s71 offen offset:2048 sc1
buffer_load_dwordx4 v[60:63],v1,s[8:11],s71 offen offset:3072 sc1
buffer_load_dwordx4 v[64:67],v1,s[8:11],s80 offen sc1
buffer_load_dwordx4 v[68:71],v1,s[8:11],s80 offen offset:1024 sc1
s_sub_u32 s47,s47,1
s_cbranch_scc1 ABORT
s_waitcnt vmcnt(4)
v_and_b32 v12,1,v52
v_cmp_ne_u32 vcc,s57,v12
s_nop 0
s_cbranch_vccnz ws_183
s_branch wg_192
ws_184:
buffer_load_dwordx4 v[56:59],v1,s[8:11],s71 offen offset:2048 sc1
buffer_load_dwordx4 v[60:63],v1,s[8:11],s71 offen offset:3072 sc1
buffer_load_dwordx4 v[64:67],v1,s[8:11],s80 offen sc1
buffer_load_dwordx4 v[68:71],v1,s[8:11],s80 offen offset:1024 sc1
buffer_load_dwordx4 v[72:75],v1,s[8:11],s80 offen offset:2048 sc1
s_sub_u32 s47,s47,1
s_cbranch_scc1 ABORT
s_waitcnt vmcnt(3)
v_bitop3_b32 v12,v56,v60,s57 bitop3:0x7e
v_and_b32 v12,1,v12
v_cmp_ne_u32 vcc,0,v12
s_nop 0
s_cbranch_vccnz ws_184
s_branch wg_193
ws_185:
buffer_load_dwordx4 v[64:67],v1,s[8:11],s80 offen sc1
buffer_load_dwordx4 v[68:71],v1,s[8:11],s80 offen offset:1024 sc1
buffer_load_dwordx4 v[72:75],v1,s[8:11],s80 offen offset:2048 sc1
buffer_load_dwordx4 v[76:79],v1,s[8:11],s80 offen offset:3072 sc1
s_sub_u32 s47,s47,1
s_cbranch_scc1 ABORT
s_waitcnt vmcnt(2)
v_bitop3_b32 v12,v64,v68,s57 bitop3:0x7e
v_and_b32 v12,1,v12
v_cmp_ne_u32 vcc,0,v12
s_nop 0
s_cbranch_vccnz ws_185
s_branch wg_194
ws_186:
buffer_load_dwordx4 v[72:75],v1,s[8:11],s80 offen offset:2048 sc1
buffer_load_dwordx4 v[76:79],v1,s[8:11],s80 offen offset:3072 sc1
s_sub_u32 s47,s47,1
s_cbranch_scc1 ABORT
s_waitcnt vmcnt(0)
v_bitop3_b32 v12,v72,v76,s57 bitop3:0x7e
v_and_b32 v12,1,v12
v_cmp_ne_u32 vcc,0,v12
s_nop 0
s_cbranch_vccnz ws_186
s_branch wg_195
CW_LOOP_S:
s_sub_u32 s60,s50,14
s_lshr_b32 s52,s60,1
s_and_b32 s51,s60,1
s_cmp_eq_u32 s51,0
s_cselect_b32 s61,14,0
s_add_u32 s52,s52,s61
s_sub_u32 s61,s60,50
s_cmp_ge_u32 s60,100
s_cselect_b32 s52,s61,s52
s_cselect_b32 s51,1,s51
s_cmp_lt_u32 s50,14
s_cselect_b32 s52,s50,s52
s_cselect_b32 s51,0,s51
s_cmp_eq_u32 s52,63
s_cbranch_scc1 CW_NEXT_S
s_add_u32 s58,s52,1
s_lshl_b32 s61,s51,9
s_add_u32 s72,s61,s35
s_add_u32 s69,s61,s85
s_lshl_b32 s61,s51,2
s_and_b32 s60,s52,3
s_add_u32 s60,s60,s61
s_mul_i32 s70,s60,49152
s_add_u32 s70,s70,s33
s_add_u32 s71,s70,4096
s_add_u32 s80,s70,8192
s_bfe_u32 s57,s52,0x10002
s_bfe_u32 s31,s58,0x10002
s_and_b32 s60,s58,3
s_add_u32 s60,s60,s61
s_mul_i32 s59,s60,20480
s_add_u32 s59,s59,s84
s_lshl_b32 s68,s60,16
s_add_u32 s68,s68,s83
s_xor_b32 s77,s77,11264
v_add_u32 v7,s77,v5
v_add_u32 v8,s77,v6
s_add_u32 s60,s52,2
v_mov_b32 v16,s60
v_mov_b32 v80,0
v_mov_b32 v81,0
v_mov_b32 v82,0
v_mov_b32 v83,0
v_mov_b32 v84,0
v_mov_b32 v85,0
v_mov_b32 v86,0
v_mov_b32 v87,0
v_mov_b32 v88,0
v_mov_b32 v89,0
v_mov_b32 v90,0
v_mov_b32 v91,0
v_mov_b32 v92,0
v_mov_b32 v93,0
v_mov_b32 v94,0
v_mov_b32 v95,0
v_mov_b32 v96,0
v_mov_b32 v97,0
v_mov_b32 v98,0
v_mov_b32 v99,0
ds_read_b128 v[100:103],v4 offset:0
ds_read_b128 v[104:107],v4 offset:1024
ds_read_b128 v[108:111],v4 offset:2048
ds_read_b128 v[112:115],v4 offset:3072
s_cmp_lg_u32 s46,0
s_cbranch_scc1 np_196
db_197:
buffer_load_dword v12,v3,s[8:11],s72 offen sc1
s_waitcnt vmcnt(0)
v_cmp_gt_u32 vcc,s58,v12
s_cbranch_vccz dbok_198
s_sub_u32 s47,s47,1
s_cbranch_scc1 ABORT
s_branch db_197
dbok_198:
np_196:
s_barrier
buffer_load_dwordx4 v[32:35],v1,s[8:11],s70 offen sc1
s_nop 7
buffer_load_dwordx4 v[36:39],v1,s[8:11],s70 offen offset:1024 sc1
s_nop 7
buffer_load_dwordx4 v[40:43],v1,s[8:11],s70 offen offset:2048 sc1
s_nop 7
buffer_load_dwordx4 v[44:47],v1,s[8:11],s70 offen offset:3072 sc1
s_nop 7
buffer_load_dwordx4 v[48:51],v1,s[8:11],s71 offen sc1
s_waitcnt vmcnt(4)
v_and_b32 v12,1,v32
v_cmp_ne_u32 vcc,s57,v12
s_cbranch_vccnz ws_199
wg_208:
v_smfmac_f32_16x16x64_bf16 v[80:83],v[32:35],a[0:7],v2
buffer_load_dwordx4 v[52:55],v1,s[8:11],s71 offen offset:1024 sc1
v_smfmac_f32_16x16x64_bf16 v[84:87],v[32:35],a[8:15],v2
s_waitcnt vmcnt(4)
v_and_b32 v12,1,v36
v_smfmac_f32_16x16x64_bf16 v[88:91],v[32:35],a[16:23],v2
v_cmp_ne_u32 vcc,s57,v12
v_smfmac_f32_16x16x64_bf16 v[92:95],v[32:35],a[24:31],v2
s_waitcnt lgkmcnt(2)
v_smfmac_f32_16x16x64_bf16 v[96:99],v[32:35],v[100:107],v2
s_cbranch_vccnz ws_200
wg_209:
v_smfmac_f32_16x16x64_bf16 v[80:83],v[36:39],a[32:39],v2
buffer_load_dwordx4 v[56:59],v1,s[8:11],s71 offen offset:2048 sc1
v_smfmac_f32_16x16x64_bf16 v[84:87],v[36:39],a[40:47],v2
s_waitcnt vmcnt(4)
v_and_b32 v12,1,v40
v_smfmac_f32_16x16x64_bf16 v[88:91],v[36:39],a[48:55],v2
v_cmp_ne_u32 vcc,s57,v12
ds_read_b128 v[100:103],v4 offset:4096
v_smfmac_f32_16x16x64_bf16 v[92:95],v[36:39],a[56:63],v2
ds_read_b128 v[104:107],v4 offset:5120
s_waitcnt lgkmcnt(2)
v_smfmac_f32_16x16x64_bf16 v[96:99],v[36:39],v[108:115],v2
s_cbranch_vccnz ws_201
wg_210:
v_smfmac_f32_16x16x64_bf16 v[80:83],v[40:43],a[64:71],v2
buffer_load_dwordx4 v[60:63],v1,s[8:11],s71 offen offset:3072 sc1
v_smfmac_f32_16x16x64_bf16 v[84:87],v[40:43],a[72:79],v2
s_waitcnt vmcnt(4)
v_and_b32 v12,1,v44
v_smfmac_f32_16x16x64_bf16 v[88:91],v[40:43],a[80:87],v2
v_cmp_ne_u32 vcc,s57,v12
ds_read_b128 v[108:111],v4 offset:6144
v_smfmac_f32_16x16x64_bf16 v[92:95],v[40:43],a[88:95],v2
ds_read_b128 v[112:115],v4 offset:7168
s_waitcnt lgkmcnt(2)
v_smfmac_f32_16x16x64_bf16 v[96:99],v[40:43],v[100:107],v2
s_cbranch_vccnz ws_202
wg_211:
v_smfmac_f32_16x16x64_bf16 v[80:83],v[44:47],a[96:103],v2
buffer_load_dwordx4 v[64:67],v1,s[8:11],s80 offen sc1
v_smfmac_f32_16x16x64_bf16 v[84:87],v[44:47],a[104:111],v2
s_waitcnt vmcnt(4)
v_and_b32 v12,1,v48
v_smfmac_f32_16x16x64_bf16 v[88:91],v[44:47],a[112:119],v2
v_cmp_ne_u32 vcc,s57,v12
ds_read_b128 v[100:103],v4 offset:8192
v_smfmac_f32_16x16x64_bf16 v[92:95],v[44:47],a[120:127],v2
ds_read_b128 v[104:107],v4 offset:9216
s_waitcnt lgkmcnt(2)
v_smfmac_f32_16x16x64_bf16 v[96:99],v[44:47],v[108:115],v2
s_cbranch_vccnz ws_203
wg_212:
v_smfmac_f32_16x16x64_bf16 v[80:83],v[48:51],a[128:135],v2
buffer_load_dwordx4 v[68:71],v1,s[8:11],s80 offen offset:1024 sc1
v_smfmac_f32_16x16x64_bf16 v[84:87],v[48:51],a[136:143],v2
s_waitcnt vmcnt(4)
v_and_b32 v12,1,v52
v_smfmac_f32_16x16x64_bf16 v[88:91],v[48:51],a[144:151],v2
v_cmp_ne_u32 vcc,s57,v12
ds_read_b128 v[108:111],v4 offset:10240
v_smfmac_f32_16x16x64_bf16 v[92:95],v[48:51],a[152:159],v2
ds_read_b128 v[112:115],v4 offset:11264
s_waitcnt lgkmcnt(2)
v_smfmac_f32_16x16x64_bf16 v[96:99],v[48:51],v[100:107],v2
s_cbranch_vccnz ws_204
wg_213:
v_smfmac_f32_16x16x64_bf16 v[80:83],v[52:55],a[160:167],v2
s_waitcnt vmcnt(2)
v_bitop3_b32 v12,v56,v60,s57 bitop3:0x7e
v_smfmac_f32_16x16x64_bf16 v[84:87],v[52:55],a[168:175],v2
v_and_b32 v12,1,v12
buffer_load_dwordx4 v[72:75],v1,s[8:11],s80 offen offset:2048 sc1
v_smfmac_f32_16x16x64_bf16 v[88:91],v[52:55],a[176:183],v2
v_cmp_ne_u32 vcc,0,v12
ds_read_b128 v[100:103],v4 offset:12288
v_smfmac_f32_16x16x64_bf16 v[92:95],v[52:55],a[184:191],v2
ds_read_b128 v[104:107],v4 offset:13312
s_waitcnt lgkmcnt(2)
v_smfmac_f32_16x16x64_bf16 v[96:99],v[52:55],v[108:115],v2
s_cbranch_vccnz ws_205
wg_214:
v_smfmac_f32_16x16x64_bf16 v[80:83],v[56:59],a[192:199],v2
buffer_load_dwordx4 v[76:79],v1,s[8:11],s80 offen offset:3072 sc1
v_smfmac_f32_16x16x64_bf16 v[84:87],v[56:59],a[200:207],v2
ds_read_b128 v[108:111],v4 offset:14336
v_smfmac_f32_16x16x64_bf16 v[88:91],v[56:59],a[208:215],v2
ds_read_b128 v[112:115],v4 offset:15360
v_smfmac_f32_16x16x64_bf16 v[92:95],v[56:59],a[216:223],v2
s_waitcnt lgkmcnt(2)
v_smfmac_f32_16x16x64_bf16 v[96:99],v[56:59],v[100:107],v2
ds_read_b128 v[100:103],v4 offset:16384
v_smfmac_f32_16x16x64_bf16 v[80:83],v[60:63],a[224:231],v2
s_waitcnt vmcnt(2)
v_bitop3_b32 v12,v64,v68,s57 bitop3:0x7e
v_smfmac_f32_16x16x64_bf16 v[84:87],v[60:63],a[232:239],v2
v_and_b32 v12,1,v12
ds_read_b128 v[104:107],v4 offset:17408
v_smfmac_f32_16x16x64_bf16 v[88:91],v[60:63],a[240:247],v2
v_cmp_ne_u32 vcc,0,v12
v_smfmac_f32_16x16x64_bf16 v[92:95],v[60:63],a[248:255],v2
s_waitcnt lgkmcnt(2)
v_smfmac_f32_16x16x64_bf16 v[96:99],v[60:63],v[108:115],v2
s_cbranch_vccnz ws_206
wg_215:
v_smfmac_f32_16x16x64_bf16 v[80:83],v[64:67],v[128:135],v2
ds_read_b128 v[108:111],v4 offset:18432
v_smfmac_f32_16x16x64_bf16 v[84:87],v[64:67],v[136:143],v2
ds_read_b128 v[112:115],v4 offset:19456
v_smfmac_f32_16x16x64_bf16 v[88:91],v[64:67],v[144:151],v2
v_smfmac_f32_16x16x64_bf16 v[92:95],v[64:67],v[152:159],v2
s_waitcnt lgkmcnt(2)
v_smfmac_f32_16x16x64_bf16 v[96:99],v[64:67],v[100:107],v2
ds_read_b128 v[100:103],v4 offset:20480
v_smfmac_f32_16x16x64_bf16 v[80:83],v[68:71],v[160:167],v2
s_waitcnt vmcnt(0)
v_bitop3_b32 v12,v72,v76,s57 bitop3:0x7e
v_smfmac_f32_16x16x64_bf16 v[84:87],v[68:71],v[168:175],v2
v_and_b32 v12,1,v12
ds_read_b128 v[104:107],v4 offset:21504
v_smfmac_f32_16x16x64_bf16 v[88:91],v[68:71],v[176:183],v2
v_cmp_ne_u32 vcc,0,v12
v_smfmac_f32_16x16x64_bf16 v[92:95],v[68:71],v[184:191],v2
s_waitcnt lgkmcnt(2)
v_smfmac_f32_16x16x64_bf16 v[96:99],v[68:71],v[108:115],v2
s_cbranch_vccnz ws_207
wg_216:
v_smfmac_f32_16x16x64_bf16 v[80:83],v[72:75],v[192:199],v2
ds_read_b128 v[108:111],v4 offset:22528
v_smfmac_f32_16x16x64_bf16 v[80:83],v[76:79],v[224:231],v2
ds_read_b128 v[112:115],v4 offset:23552
v_smfmac_f32_16x16x64_bf16 v[84:87],v[72:75],v[200:207],v2
v_smfmac_f32_16x16x64_bf16 v[84:87],v[76:79],v[232:239],v2
v_smfmac_f32_16x16x64_bf16 v[88:91],v[72:75],v[208:215],v2
s_nop 3
v_add_f32 v80,v80,v81
v_smfmac_f32_16x16x64_bf16 v[88:91],v[76:79],v[240:247],v2
v_add_f32 v82,v82,v83
ds_write2_b32 v7,v80,v82 offset0:0 offset1:88
v_smfmac_f32_16x16x64_bf16 v[92:95],v[72:75],v[216:223],v2
v_add_f32 v84,v84,v85
v_smfmac_f32_16x16x64_bf16 v[92:95],v[76:79],v[248:255],v2
v_add_f32 v86,v86,v87
s_waitcnt lgkmcnt(3)
v_smfmac_f32_16x16x64_bf16 v[96:99],v[72:75],v[100:107],v2
ds_write2_b32 v7,v84,v86 offset0:16 offset1:104
s_waitcnt lgkmcnt(2)
v_smfmac_f32_16x16x64_bf16 v[96:99],v[76:79],v[108:115],v2
v_add_f32 v88,v88,v89
v_add_f32 v90,v90,v91
ds_write2_b32 v7,v88,v90 offset0:32 offset1:120
v_add_f32 v92,v92,v93
v_add_f32 v94,v94,v95
ds_write2_b32 v7,v92,v94 offset0:48 offset1:136
s_nop 1
v_add_f32 v96,v96,v97
v_add_f32 v98,v98,v99
ds_write2_b32 v7,v96,v98 offset0:64 offset1:152
s_mov_b64 exec,1
buffer_store_dword v16,v1,s[8:11],s69 offen sc1
s_mov_b64 exec,-1
s_waitcnt lgkmcnt(0)
s_barrier
ds_read_b128 v[32:35],v8 offset:0
ds_read_b128 v[36:39],v8 offset:2816
ds_read_b128 v[40:43],v8 offset:5632
ds_read_b128 v[44:47],v8 offset:8448
s_mov_b64 exec,s[88:89]
s_waitcnt lgkmcnt(2)
v_pk_add_f32 v[32:33],v[32:33],v[36:37]
v_pk_add_f32 v[34:35],v[34:35],v[38:39]
s_waitcnt lgkmcnt(0)
v_pk_add_f32 v[40:41],v[40:41],v[44:45]
v_pk_add_f32 v[42:43],v[42:43],v[46:47]
v_pk_add_f32 v[32:33],v[32:33],v[40:41]
v_pk_add_f32 v[34:35],v[34:35],v[42:43]
v_and_or_b32 v32,v32,-2,s31
buffer_store_dwordx4 v[32:35],v9,s[8:11],s59 offen sc1
s_barrier
buffer_store_dwordx4 v[32:35],v9,s[8:11],s68 offen sc1
s_mov_b64 exec,-1
s_nop 0
CW_NEXT_S:
s_add_u32 s50,s50,1
s_cmp_lt_u32 s50,128
s_cbranch_scc1 CW_LOOP_S
s_branch CW_DONE
ws_199:
buffer_load_dwordx4 v[32:35],v1,s[8:11],s70 offen sc1
buffer_load_dwordx4 v[36:39],v1,s[8:11],s70 offen offset:1024 sc1
buffer_load_dwordx4 v[40:43],v1,s[8:11],s70 offen offset:2048 sc1
buffer_load_dwordx4 v[44:47],v1,s[8:11],s70 offen offset:3072 sc1
buffer_load_dwordx4 v[48:51],v1,s[8:11],s71 offen sc1
s_sub_u32 s47,s47,1
s_cbranch_scc1 ABORT
s_waitcnt vmcnt(4)
v_and_b32 v12,1,v32
v_cmp_ne_u32 vcc,s57,v12
s_nop 0
s_cbranch_vccnz ws_199
s_branch wg_208
ws_200:
buffer_load_dwordx4 v[36:39],v1,s[8:11],s70 offen offset:1024 sc1
buffer_load_dwordx4 v[40:43],v1,s[8:11],s70 offen offset:2048 sc1
buffer_load_dwordx4 v[44:47],v1,s[8:11],s70 offen offset:3072 sc1
buffer_load_dwordx4 v[48:51],v1,s[8:11],s71 offen sc1
buffer_load_dwordx4 v[52:55],v1,s[8:11],s71 offen offset:1024 sc1
s_sub_u32 s47,s47,1
s_cbranch_scc1 ABORT
s_waitcnt vmcnt(4)
v_and_b32 v12,1,v36
v_cmp_ne_u32 vcc,s57,v12
s_nop 0
s_cbranch_vccnz ws_200
s_branch wg_209
ws_201:
buffer_load_dwordx4 v[40:43],v1,s[8:11],s70 offen offset:2048 sc1
buffer_load_dwordx4 v[44:47],v1,s[8:11],s70 offen offset:3072 sc1
buffer_load_dwordx4 v[48:51],v1,s[8:11],s71 offen sc1
buffer_load_dwordx4 v[52:55],v1,s[8:11],s71 offen offset:1024 sc1
buffer_load_dwordx4 v[56:59],v1,s[8:11],s71 offen offset:2048 sc1
s_sub_u32 s47,s47,1
s_cbranch_scc1 ABORT
s_waitcnt vmcnt(4)
v_and_b32 v12,1,v40
v_cmp_ne_u32 vcc,s57,v12
s_nop 0
s_cbranch_vccnz ws_201
s_branch wg_210
ws_202:
buffer_load_dwordx4 v[44:47],v1,s[8:11],s70 offen offset:3072 sc1
buffer_load_dwordx4 v[48:51],v1,s[8:11],s71 offen sc1
buffer_load_dwordx4 v[52:55],v1,s[8:11],s71 offen offset:1024 sc1
buffer_load_dwordx4 v[56:59],v1,s[8:11],s71 offen offset:2048 sc1
buffer_load_dwordx4 v[60:63],v1,s[8:11],s71 offen offset:3072 sc1
s_sub_u32 s47,s47,1
s_cbranch_scc1 ABORT
s_waitcnt vmcnt(4)
v_and_b32 v12,1,v44
v_cmp_ne_u32 vcc,s57,v12
s_nop 0
s_cbranch_vccnz ws_202
s_branch wg_211
ws_203:
buffer_load_dwordx4 v[48:51],v1,s[8:11],s71 offen sc1
buffer_load_dwordx4 v[52:55],v1,s[8:11],s71 offen offset:1024 sc1
buffer_load_dwordx4 v[56:59],v1,s[8:11],s71 offen offset:2048 sc1
buffer_load_dwordx4 v[60:63],v1,s[8:11],s71 offen offset:3072 sc1
buffer_load_dwordx4 v[64:67],v1,s[8:11],s80 offen sc1
s_sub_u32 s47,s47,1
s_cbranch_scc1 ABORT
s_waitcnt vmcnt(4)
v_and_b32 v12,1,v48
v_cmp_ne_u32 vcc,s57,v12
s_nop 0
s_cbranch_vccnz ws_203
s_branch wg_212
ws_204:
buffer_load_dwordx4 v[52:55],v1,s[8:11],s71 offen offset:1024 sc1
buffer_load_dwordx4 v[56:59],v1,s[8:11],s71 offen offset:2048 sc1
buffer_load_dwordx4 v[60:63],v1,s[8:11],s71 offen offset:3072 sc1
buffer_load_dwordx4 v[64:67],v1,s[8:11],s80 offen sc1
buffer_load_dwordx4 v[68:71],v1,s[8:11],s80 offen offset:1024 sc1
s_sub_u32 s47,s47,1
s_cbranch_scc1 ABORT
s_waitcnt vmcnt(4)
v_and_b32 v12,1,v52
v_cmp_ne_u32 vcc,s57,v12
s_nop 0
s_cbranch_vccnz ws_204
s_branch wg_213
ws_205:
buffer_load_dwordx4 v[56:59],v1,s[8:11],s71 offen offset:2048 sc1
buffer_load_dwordx4 v[60:63],v1,s[8:11],s71 offen offset:3072 sc1
buffer_load_dwordx4 v[64:67],v1,s[8:11],s80 offen sc1
buffer_load_dwordx4 v[68:71],v1,s[8:11],s80 offen offset:1024 sc1
buffer_load_dwordx4 v[72:75],v1,s[8:11],s80 offen offset:2048 sc1
s_sub_u32 s47,s47,1
s_cbranch_scc1 ABORT
s_waitcnt vmcnt(3)
v_bitop3_b32 v12,v56,v60,s57 bitop3:0x7e
v_and_b32 v12,1,v12
v_cmp_ne_u32 vcc,0,v12
s_nop 0
s_cbranch_vccnz ws_205
s_branch wg_214
ws_206:
buffer_load_dwordx4 v[64:67],v1,s[8:11],s80 offen sc1
buffer_load_dwordx4 v[68:71],v1,s[8:11],s80 offen offset:1024 sc1
buffer_load_dwordx4 v[72:75],v1,s[8:11],s80 offen offset:2048 sc1
buffer_load_dwordx4 v[76:79],v1,s[8:11],s80 offen offset:3072 sc1
s_sub_u32 s47,s47,1
s_cbranch_scc1 ABORT
s_waitcnt vmcnt(2)
v_bitop3_b32 v12,v64,v68,s57 bitop3:0x7e
v_and_b32 v12,1,v12
v_cmp_ne_u32 vcc,0,v12
s_nop 0
s_cbranch_vccnz ws_206
s_branch wg_215
ws_207:
buffer_load_dwordx4 v[72:75],v1,s[8:11],s80 offen offset:2048 sc1
buffer_load_dwordx4 v[76:79],v1,s[8:11],s80 offen offset:3072 sc1
s_sub_u32 s47,s47,1
s_cbranch_scc1 ABORT
s_waitcnt vmcnt(0)
v_bitop3_b32 v12,v72,v76,s57 bitop3:0x7e
v_and_b32 v12,1,v12
v_cmp_ne_u32 vcc,0,v12
s_nop 0
s_cbranch_vccnz ws_207
s_branch wg_216
CW_DONE:
s_add_u32 s61,s48,48
s_endpgm
DISPATCH:
s_sub_u32 s48,s3,0
s_cmp_lt_u32 s3,16
s_cbranch_scc1 ROLE_CS
s_sub_u32 s48,s3,16
s_cmp_lt_u32 s3,24
s_cbranch_scc1 ROLE_CV
s_sub_u32 s48,s3,24
s_cmp_lt_u32 s3,32
s_cbranch_scc1 ROLE_CW
s_sub_u32 s48,s3,16
s_cmp_lt_u32 s3,48
s_cbranch_scc1 ROLE_CS
s_sub_u32 s48,s3,40
s_cmp_lt_u32 s3,56
s_cbranch_scc1 ROLE_CV
s_sub_u32 s48,s3,48
s_cmp_lt_u32 s3,64
s_cbranch_scc1 ROLE_CW
s_sub_u32 s48,s3,64
s_cmp_lt_u32 s3,74
s_cbranch_scc1 ROLE_W4
s_sub_u32 s48,s3,74
s_cmp_lt_u32 s3,79
s_cbranch_scc1 ROLE_W1
s_sub_u32 s48,s3,79
s_cmp_lt_u32 s3,91
s_cbranch_scc1 ROLE_W3
s_sub_u32 s48,s3,91
s_cmp_lt_u32 s3,96
s_cbranch_scc1 ROLE_W2
s_sub_u32 s48,s3,96
s_cmp_lt_u32 s3,104
s_cbranch_scc1 ROLE_QKVQ
s_sub_u32 s48,s3,104
s_cmp_lt_u32 s3,112
s_cbranch_scc1 ROLE_QKVV
s_sub_u32 s48,s3,112
s_cmp_lt_u32 s3,128
s_cbranch_scc1 ROLE_R1
s_sub_u32 s48,s3,128
s_cmp_lt_u32 s3,138
s_cbranch_scc1 ROLE_WO
s_sub_u32 s48,s3,138
s_cmp_lt_u32 s3,146
s_cbranch_scc1 ROLE_ATT
s_sub_u32 s48,s3,138
s_cmp_lt_u32 s3,156
s_cbranch_scc1 ROLE_QKVQ
s_sub_u32 s48,s3,148
s_cmp_lt_u32 s3,160
s_cbranch_scc1 ROLE_QKVV
s_sub_u32 s48,s3,150
s_cmp_lt_u32 s3,170
s_cbranch_scc1 ROLE_WO
s_sub_u32 s48,s3,162
s_cmp_lt_u32 s3,178
s_cbranch_scc1 ROLE_ATT
s_sub_u32 s48,s3,160
s_cmp_lt_u32 s3,188
s_cbranch_scc1 ROLE_QKVQ
s_sub_u32 s48,s3,176
s_cmp_lt_u32 s3,192
s_cbranch_scc1 ROLE_QKVV
s_sub_u32 s48,s3,172
s_cmp_lt_u32 s3,202
s_cbranch_scc1 ROLE_WO
s_sub_u32 s48,s3,186
s_cmp_lt_u32 s3,210
s_cbranch_scc1 ROLE_ATT
s_sub_u32 s48,s3,182
s_cmp_lt_u32 s3,220
s_cbranch_scc1 ROLE_QKVQ
s_sub_u32 s48,s3,204
s_cmp_lt_u32 s3,224
s_cbranch_scc1 ROLE_QKVV
s_sub_u32 s48,s3,194
s_cmp_lt_u32 s3,234
s_cbranch_scc1 ROLE_WO
s_sub_u32 s48,s3,210
s_cmp_lt_u32 s3,242
s_cbranch_scc1 ROLE_ATT
s_sub_u32 s48,s3,204
s_cmp_lt_u32 s3,252
s_cbranch_scc1 ROLE_QKVQ
s_sub_u32 s48,s3,232
s_cmp_lt_u32 s3,256
s_cbranch_scc1 ROLE_QKVV
s_branch ROLE_SPARE
EXIT:
s_endpgm
ABORT:
s_mov_b64 exec,1
v_mov_b32 v1,s2
v_add_u32 v1,0x10000,v1
v_mov_b32 v2,8
buffer_store_dword v1,v2,s[12:15],0 offen
s_endpgm
ROLE_SPARE:
s_waitcnt vmcnt(0)
s_barrier
s_cmp_lg_u32 s46,0
s_cbranch_scc1 arr_217
v_mov_b32 v12,1
s_lshl_b32 s3,s49,2
v_mov_b32 v13,s3
s_mov_b64 exec,1
buffer_atomic_add v12,v13,s[12:15],0 offen sc1
s_mov_b64 exec,-1
arr_217:
s_lshl_b32 s3,s49,2
v_mov_b32 v13,s3
s_nop 1
ibw_218:
buffer_load_dword v12,v13,s[12:15],0 offen sc1
s_waitcnt vmcnt(0)
v_cmp_ne_u32 vcc,256,v12
s_nop 0
s_cbranch_vccz ok_219
s_sleep 8
s_sub_u32 s47,s47,1
s_cbranch_scc1 ABORT
s_branch ibw_218
ok_219:
s_cmp_lg_u32 s49,0
s_cbranch_scc1 ibok_220
v_and_b32 v13,7,v0
v_lshlrev_b32 v13,2,v13
buffer_load_dword v12,v13,s[12:15],0 offen offset:32 sc1
s_waitcnt vmcnt(0)
v_cmp_ne_u32 vcc,32,v12
s_nop 0
s_cbranch_vccz ibok_220
s_barrier
s_mov_b32 s49,1
s_mov_b32 s3,s2
s_load_dwordx16 s[16:31],s[0:1],0
s_load_dwordx8 s[32:39],s[0:1],64
s_waitcnt lgkmcnt(0)
s_branch DISPATCH
ibok_220:
s_endpgm
ROLE_QKVQ:
v_lshlrev_b32 v1,4,v0
v_mov_b32 v5,1
s_lshl_b32 s56,s48,2
s_add_u32 s56,s56,s46
v_bfe_u32 v6,v0,2,2
v_lshrrev_b32 v7,4,v0
v_add_u32 v7,v6,v7
v_and_b32 v7,3,v7
v_and_b32 v15,3,v0
v_lshlrev_b32 v15,4,v15
v_lshl_add_u32 v15,v7,6,v15
v_lshl_add_u32 v15,v6,8,v15
v_lshrrev_b32 v6,5,v0
v_bfe_u32 v7,v0,4,1
v_lshlrev_b32 v16,10,v7
v_bfe_u32 v7,v0,2,2
v_lshl_add_u32 v16,v7,8,v16
v_add_u32 v6,v6,v7
v_and_b32 v6,3,v6
v_lshl_add_u32 v16,v6,6,v16
v_and_b32 v6,3,v0
v_lshl_add_u32 v16,v6,4,v16
v_add_u32 v18,46080,v16
v_lshrrev_b32 v6,5,v0
v_bfe_u32 v7,v0,4,1
v_lshlrev_b32 v20,10,v7
v_lshl_add_u32 v20,v6,8,v20
v_and_b32 v6,15,v0
v_lshl_add_u32 v20,v6,4,v20
v_lshrrev_b32 v6,5,v0
v_add_u32 v6,2,v6
v_bfe_u32 v7,v0,4,1
v_lshlrev_b32 v17,10,v7
v_bfe_u32 v7,v0,2,2
v_lshl_add_u32 v17,v7,8,v17
v_add_u32 v6,v6,v7
v_and_b32 v6,3,v6
v_lshl_add_u32 v17,v6,6,v17
v_and_b32 v6,3,v0
v_lshl_add_u32 v17,v6,4,v17
v_add_u32 v19,46080,v17
v_lshrrev_b32 v6,5,v0
v_add_u32 v6,2,v6
v_bfe_u32 v7,v0,4,1
v_lshlrev_b32 v21,10,v7
v_lshl_add_u32 v21,v6,8,v21
v_and_b32 v6,15,v0
v_lshl_add_u32 v21,v6,4,v21
s_cmp_ge_u32 s48,24
s_cselect_b32 s68,1,0
s_mul_i32 s60,s68,96
s_sub_u32 s69,s56,s60
s_mul_i32 s70,s68,50331648
s_add_u32 s70,s70,74448896
s_mul_i32 s60,s68,65536
s_sub_u32 s71,131072,s60
s_lshl_b32 s60,s69,12
s_add_u32 s70,s70,s60
v_lshrrev_b32 v6,5,v0
v_mul_u32_u24 v188,2560,v6
v_and_b32 v6,31,v0
v_lshl_add_u32 v188,v6,3,v188
v_add_u32 v188,0xa000,v188
v_min_u32 v12,7,v0
v_lshlrev_b32 v12,2,v12
v_min_u32 v13,39,v0
v_lshlrev_b32 v13,2,v13
v_mov_b32 v14,93184
s_waitcnt vmcnt(0)
s_barrier
s_cmp_lg_u32 s46,0
s_cbranch_scc1 arr_221
v_mov_b32 v6,1
s_lshl_b32 s3,s49,2
v_mov_b32 v7,s3
s_mov_b64 exec,1
buffer_atomic_add v6,v7,s[12:15],0 offen sc1
s_mov_b64 exec,-1
arr_221:
s_lshl_b32 s58,s69,7
s_mul_i32 s63,s46,40960
s_cmp_eq_u32 s68,0
s_cselect_b32 s4,s22,s20
s_cselect_b32 s5,s23,s21
s_mov_b32 s6,7864320
s_mov_b32 s7,0x20000
v_lshrrev_b32 v9,3,v0
s_mov_b32 s64,12288
v_mul_lo_u32 v9,v9,s64
v_and_b32 v10,7,v0
v_lshl_add_u32 v6,v10,4,v9
s_add_u32 m0,s63,0
s_add_u32 s65,s58,0
buffer_load_dwordx4 v6,s[4:7],s65 offen lds
s_add_u32 m0,s63,1024
s_add_u32 s65,s58,98304
buffer_load_dwordx4 v6,s[4:7],s65 offen lds
s_add_u32 m0,s63,2048
s_add_u32 s65,s58,196608
buffer_load_dwordx4 v6,s[4:7],s65 offen lds
s_add_u32 m0,s63,3072
s_add_u32 s65,s58,294912
buffer_load_dwordx4 v6,s[4:7],s65 offen lds
s_add_u32 m0,s63,4096
s_add_u32 s65,s58,393216
buffer_load_dwordx4 v6,s[4:7],s65 offen lds
s_add_u32 m0,s63,5120
s_add_u32 s65,s58,491520
buffer_load_dwordx4 v6,s[4:7],s65 offen lds
s_add_u32 m0,s63,6144
s_add_u32 s65,s58,589824
buffer_load_dwordx4 v6,s[4:7],s65 offen lds
s_add_u32 m0,s63,7168
s_add_u32 s65,s58,688128
buffer_load_dwordx4 v6,s[4:7],s65 offen lds
s_add_u32 m0,s63,8192
s_add_u32 s65,s58,786432
buffer_load_dwordx4 v6,s[4:7],s65 offen lds
s_add_u32 m0,s63,9216
s_add_u32 s65,s58,884736
buffer_load_dwordx4 v6,s[4:7],s65 offen lds
s_add_u32 m0,s63,10240
s_add_u32 s65,s58,983040
buffer_load_dwordx4 v6,s[4:7],s65 offen lds
s_add_u32 m0,s63,11264
s_add_u32 s65,s58,1081344
buffer_load_dwordx4 v6,s[4:7],s65 offen lds
s_add_u32 m0,s63,12288
s_add_u32 s65,s58,1179648
buffer_load_dwordx4 v6,s[4:7],s65 offen lds
s_add_u32 m0,s63,13312
s_add_u32 s65,s58,1277952
buffer_load_dwordx4 v6,s[4:7],s65 offen lds
s_add_u32 m0,s63,14336
s_add_u32 s65,s58,1376256
buffer_load_dwordx4 v6,s[4:7],s65 offen lds
s_add_u32 m0,s63,15360
s_add_u32 s65,s58,1474560
buffer_load_dwordx4 v6,s[4:7],s65 offen lds
s_add_u32 m0,s63,16384
s_add_u32 s65,s58,1572864
buffer_load_dwordx4 v6,s[4:7],s65 offen lds
s_add_u32 m0,s63,17408
s_add_u32 s65,s58,1671168
buffer_load_dwordx4 v6,s[4:7],s65 offen lds
s_add_u32 m0,s63,18432
s_add_u32 s65,s58,1769472
buffer_load_dwordx4 v6,s[4:7],s65 offen lds
s_add_u32 m0,s63,19456
s_add_u32 s65,s58,1867776
buffer_load_dwordx4 v6,s[4:7],s65 offen lds
s_add_u32 m0,s63,20480
s_add_u32 s65,s58,1966080
buffer_load_dwordx4 v6,s[4:7],s65 offen lds
s_add_u32 m0,s63,21504
s_add_u32 s65,s58,2064384
buffer_load_dwordx4 v6,s[4:7],s65 offen lds
s_add_u32 m0,s63,22528
s_add_u32 s65,s58,2162688
buffer_load_dwordx4 v6,s[4:7],s65 offen lds
s_add_u32 m0,s63,23552
s_add_u32 s65,s58,2260992
buffer_load_dwordx4 v6,s[4:7],s65 offen lds
s_add_u32 m0,s63,24576
s_add_u32 s65,s58,2359296
buffer_load_dwordx4 v6,s[4:7],s65 offen lds
s_add_u32 m0,s63,25600
s_add_u32 s65,s58,2457600
buffer_load_dwordx4 v6,s[4:7],s65 offen lds
s_add_u32 m0,s63,26624
s_add_u32 s65,s58,2555904
buffer_load_dwordx4 v6,s[4:7],s65 offen lds
s_add_u32 m0,s63,27648
s_add_u32 s65,s58,2654208
buffer_load_dwordx4 v6,s[4:7],s65 offen lds
s_add_u32 m0,s63,28672
s_add_u32 s65,s58,2752512
buffer_load_dwordx4 v6,s[4:7],s65 offen lds
s_add_u32 m0,s63,29696
s_add_u32 s65,s58,2850816
buffer_load_dwordx4 v6,s[4:7],s65 offen lds
s_add_u32 m0,s63,30720
s_add_u32 s65,s58,2949120
buffer_load_dwordx4 v6,s[4:7],s65 offen lds
s_add_u32 m0,s63,31744
s_add_u32 s65,s58,3047424
buffer_load_dwordx4 v6,s[4:7],s65 offen lds
s_add_u32 m0,s63,32768
s_add_u32 s65,s58,3145728
buffer_load_dwordx4 v6,s[4:7],s65 offen lds
s_add_u32 m0,s63,33792
s_add_u32 s65,s58,3244032
buffer_load_dwordx4 v6,s[4:7],s65 offen lds
s_add_u32 m0,s63,34816
s_add_u32 s65,s58,3342336
buffer_load_dwordx4 v6,s[4:7],s65 offen lds
s_add_u32 m0,s63,35840
s_add_u32 s65,s58,3440640
buffer_load_dwordx4 v6,s[4:7],s65 offen lds
s_add_u32 m0,s63,36864
s_add_u32 s65,s58,3538944
buffer_load_dwordx4 v6,s[4:7],s65 offen lds
s_add_u32 m0,s63,37888
s_add_u32 s65,s58,3637248
buffer_load_dwordx4 v6,s[4:7],s65 offen lds
s_add_u32 m0,s63,38912
s_add_u32 s65,s58,3735552
buffer_load_dwordx4 v6,s[4:7],s65 offen lds
s_add_u32 m0,s63,39936
s_add_u32 s65,s58,3833856
buffer_load_dwordx4 v6,s[4:7],s65 offen lds
s_waitcnt vmcnt(20)
v_bfe_u32 v9,v0,2,2
v_lshrrev_b32 v10,5,v0
v_lshl_add_u32 v9,v10,2,v9
v_mul_u32_u24 v9,128,v9
v_and_b32 v10,1,v0
v_lshl_add_u32 v9,v10,3,v9
v_bfe_u32 v10,v0,1,1
v_lshl_add_u32 v9,v10,5,v9
v_bfe_u32 v10,v0,4,1
v_lshl_add_u32 v9,v10,4,v9
v_add_u32 v7,s63,v9
ds_read_b64_tr_b16 a[0:1],v7 offset:0
ds_read_b64_tr_b16 a[2:3],v7 offset:2048
ds_read_b64_tr_b16 a[4:5],v7 offset:1024
ds_read_b64_tr_b16 a[6:7],v7 offset:3072
ds_read_b64_tr_b16 a[160:161],v7 offset:64
ds_read_b64_tr_b16 a[162:163],v7 offset:2112
ds_read_b64_tr_b16 a[164:165],v7 offset:1088
ds_read_b64_tr_b16 a[166:167],v7 offset:3136
ds_read_b64_tr_b16 a[8:9],v7 offset:4096
ds_read_b64_tr_b16 a[10:11],v7 offset:6144
ds_read_b64_tr_b16 a[12:13],v7 offset:5120
ds_read_b64_tr_b16 a[14:15],v7 offset:7168
s_waitcnt lgkmcnt(4)
ds_read_b64_tr_b16 a[168:169],v7 offset:4160
ds_read_b64_tr_b16 a[170:171],v7 offset:6208
ds_read_b64_tr_b16 a[172:173],v7 offset:5184
ds_read_b64_tr_b16 a[174:175],v7 offset:7232
ds_read_b64_tr_b16 a[16:17],v7 offset:8192
ds_read_b64_tr_b16 a[18:19],v7 offset:10240
ds_read_b64_tr_b16 a[20:21],v7 offset:9216
ds_read_b64_tr_b16 a[22:23],v7 offset:11264
ds_read_b64_tr_b16 a[176:177],v7 offset:8256
ds_read_b64_tr_b16 a[178:179],v7 offset:10304
ds_read_b64_tr_b16 a[180:181],v7 offset:9280
ds_read_b64_tr_b16 a[182:183],v7 offset:11328
s_waitcnt lgkmcnt(4)
ds_read_b64_tr_b16 a[24:25],v7 offset:12288
ds_read_b64_tr_b16 a[26:27],v7 offset:14336
ds_read_b64_tr_b16 a[28:29],v7 offset:13312
ds_read_b64_tr_b16 a[30:31],v7 offset:15360
ds_read_b64_tr_b16 a[184:185],v7 offset:12352
ds_read_b64_tr_b16 a[186:187],v7 offset:14400
ds_read_b64_tr_b16 a[188:189],v7 offset:13376
ds_read_b64_tr_b16 a[190:191],v7 offset:15424
ds_read_b64_tr_b16 a[32:33],v7 offset:16384
ds_read_b64_tr_b16 a[34:35],v7 offset:18432
ds_read_b64_tr_b16 a[36:37],v7 offset:17408
ds_read_b64_tr_b16 a[38:39],v7 offset:19456
s_waitcnt lgkmcnt(4)
ds_read_b64_tr_b16 a[192:193],v7 offset:16448
ds_read_b64_tr_b16 a[194:195],v7 offset:18496
ds_read_b64_tr_b16 a[196:197],v7 offset:17472
ds_read_b64_tr_b16 a[198:199],v7 offset:19520
s_waitcnt lgkmcnt(0)
s_add_u32 m0,s63,0
s_add_u32 s65,s58,3932160
buffer_load_dwordx4 v6,s[4:7],s65 offen lds
s_add_u32 m0,s63,1024
s_add_u32 s65,s58,4030464
buffer_load_dwordx4 v6,s[4:7],s65 offen lds
s_add_u32 m0,s63,2048
s_add_u32 s65,s58,4128768
buffer_load_dwordx4 v6,s[4:7],s65 offen lds
s_add_u32 m0,s63,3072
s_add_u32 s65,s58,4227072
buffer_load_dwordx4 v6,s[4:7],s65 offen lds
s_add_u32 m0,s63,4096
s_add_u32 s65,s58,4325376
buffer_load_dwordx4 v6,s[4:7],s65 offen lds
s_add_u32 m0,s63,5120
s_add_u32 s65,s58,4423680
buffer_load_dwordx4 v6,s[4:7],s65 offen lds
s_add_u32 m0,s63,6144
s_add_u32 s65,s58,4521984
buffer_load_dwordx4 v6,s[4:7],s65 offen lds
s_add_u32 m0,s63,7168
s_add_u32 s65,s58,4620288
buffer_load_dwordx4 v6,s[4:7],s65 offen lds
s_add_u32 m0,s63,8192
s_add_u32 s65,s58,4718592
buffer_load_dwordx4 v6,s[4:7],s65 offen lds
s_add_u32 m0,s63,9216
s_add_u32 s65,s58,4816896
buffer_load_dwordx4 v6,s[4:7],s65 offen lds
s_add_u32 m0,s63,10240
s_add_u32 s65,s58,4915200
buffer_load_dwordx4 v6,s[4:7],s65 offen lds
s_add_u32 m0,s63,11264
s_add_u32 s65,s58,5013504
buffer_load_dwordx4 v6,s[4:7],s65 offen lds
s_add_u32 m0,s63,12288
s_add_u32 s65,s58,5111808
buffer_load_dwordx4 v6,s[4:7],s65 offen lds
s_add_u32 m0,s63,13312
s_add_u32 s65,s58,5210112
buffer_load_dwordx4 v6,s[4:7],s65 offen lds
s_add_u32 m0,s63,14336
s_add_u32 s65,s58,5308416
buffer_load_dwordx4 v6,s[4:7],s65 offen lds
s_add_u32 m0,s63,15360
s_add_u32 s65,s58,5406720
buffer_load_dwordx4 v6,s[4:7],s65 offen lds
s_add_u32 m0,s63,16384
s_add_u32 s65,s58,5505024
buffer_load_dwordx4 v6,s[4:7],s65 offen lds
s_add_u32 m0,s63,17408
s_add_u32 s65,s58,5603328
buffer_load_dwordx4 v6,s[4:7],s65 offen lds
s_add_u32 m0,s63,18432
s_add_u32 s65,s58,5701632
buffer_load_dwordx4 v6,s[4:7],s65 offen lds
s_add_u32 m0,s63,19456
s_add_u32 s65,s58,5799936
buffer_load_dwordx4 v6,s[4:7],s65 offen lds
s_waitcnt vmcnt(20)
v_bfe_u32 v9,v0,2,2
v_lshrrev_b32 v10,5,v0
v_lshl_add_u32 v9,v10,2,v9
v_mul_u32_u24 v9,128,v9
v_and_b32 v10,1,v0
v_lshl_add_u32 v9,v10,3,v9
v_bfe_u32 v10,v0,1,1
v_lshl_add_u32 v9,v10,5,v9
v_bfe_u32 v10,v0,4,1
v_lshl_add_u32 v9,v10,4,v9
v_add_u32 v7,s63,v9
ds_read_b64_tr_b16 a[40:41],v7 offset:20480
ds_read_b64_tr_b16 a[42:43],v7 offset:22528
ds_read_b64_tr_b16 a[44:45],v7 offset:21504
ds_read_b64_tr_b16 a[46:47],v7 offset:23552
ds_read_b64_tr_b16 a[200:201],v7 offset:20544
ds_read_b64_tr_b16 a[202:203],v7 offset:22592
ds_read_b64_tr_b16 a[204:205],v7 offset:21568
ds_read_b64_tr_b16 a[206:207],v7 offset:23616
ds_read_b64_tr_b16 a[48:49],v7 offset:24576
ds_read_b64_tr_b16 a[50:51],v7 offset:26624
ds_read_b64_tr_b16 a[52:53],v7 offset:25600
ds_read_b64_tr_b16 a[54:55],v7 offset:27648
s_waitcnt lgkmcnt(4)
ds_read_b64_tr_b16 a[208:209],v7 offset:24640
ds_read_b64_tr_b16 a[210:211],v7 offset:26688
ds_read_b64_tr_b16 a[212:213],v7 offset:25664
ds_read_b64_tr_b16 a[214:215],v7 offset:27712
ds_read_b64_tr_b16 a[56:57],v7 offset:28672
ds_read_b64_tr_b16 a[58:59],v7 offset:30720
ds_read_b64_tr_b16 a[60:61],v7 offset:29696
ds_read_b64_tr_b16 a[62:63],v7 offset:31744
ds_read_b64_tr_b16 a[216:217],v7 offset:28736
ds_read_b64_tr_b16 a[218:219],v7 offset:30784
ds_read_b64_tr_b16 a[220:221],v7 offset:29760
ds_read_b64_tr_b16 a[222:223],v7 offset:31808
s_waitcnt lgkmcnt(4)
ds_read_b64_tr_b16 a[64:65],v7 offset:32768
ds_read_b64_tr_b16 a[66:67],v7 offset:34816
ds_read_b64_tr_b16 a[68:69],v7 offset:33792
ds_read_b64_tr_b16 a[70:71],v7 offset:35840
ds_read_b64_tr_b16 a[224:225],v7 offset:32832
ds_read_b64_tr_b16 a[226:227],v7 offset:34880
ds_read_b64_tr_b16 a[228:229],v7 offset:33856
ds_read_b64_tr_b16 a[230:231],v7 offset:35904
ds_read_b64_tr_b16 a[72:73],v7 offset:36864
ds_read_b64_tr_b16 a[74:75],v7 offset:38912
ds_read_b64_tr_b16 a[76:77],v7 offset:37888
ds_read_b64_tr_b16 a[78:79],v7 offset:39936
s_waitcnt lgkmcnt(4)
ds_read_b64_tr_b16 a[232:233],v7 offset:36928
ds_read_b64_tr_b16 a[234:235],v7 offset:38976
ds_read_b64_tr_b16 a[236:237],v7 offset:37952
ds_read_b64_tr_b16 a[238:239],v7 offset:40000
s_waitcnt lgkmcnt(0)
s_add_u32 m0,s63,20480
s_add_u32 s65,s58,5898240
buffer_load_dwordx4 v6,s[4:7],s65 offen lds
s_add_u32 m0,s63,21504
s_add_u32 s65,s58,5996544
buffer_load_dwordx4 v6,s[4:7],s65 offen lds
s_add_u32 m0,s63,22528
s_add_u32 s65,s58,6094848
buffer_load_dwordx4 v6,s[4:7],s65 offen lds
s_add_u32 m0,s63,23552
s_add_u32 s65,s58,6193152
buffer_load_dwordx4 v6,s[4:7],s65 offen lds
s_add_u32 m0,s63,24576
s_add_u32 s65,s58,6291456
buffer_load_dwordx4 v6,s[4:7],s65 offen lds
s_add_u32 m0,s63,25600
s_add_u32 s65,s58,6389760
buffer_load_dwordx4 v6,s[4:7],s65 offen lds
s_add_u32 m0,s63,26624
s_add_u32 s65,s58,6488064
buffer_load_dwordx4 v6,s[4:7],s65 offen lds
s_add_u32 m0,s63,27648
s_add_u32 s65,s58,6586368
buffer_load_dwordx4 v6,s[4:7],s65 offen lds
s_add_u32 m0,s63,28672
s_add_u32 s65,s58,6684672
buffer_load_dwordx4 v6,s[4:7],s65 offen lds
s_add_u32 m0,s63,29696
s_add_u32 s65,s58,6782976
buffer_load_dwordx4 v6,s[4:7],s65 offen lds
s_add_u32 m0,s63,30720
s_add_u32 s65,s58,6881280
buffer_load_dwordx4 v6,s[4:7],s65 offen lds
s_add_u32 m0,s63,31744
s_add_u32 s65,s58,6979584
buffer_load_dwordx4 v6,s[4:7],s65 offen lds
s_add_u32 m0,s63,32768
s_add_u32 s65,s58,7077888
buffer_load_dwordx4 v6,s[4:7],s65 offen lds
s_add_u32 m0,s63,33792
s_add_u32 s65,s58,7176192
buffer_load_dwordx4 v6,s[4:7],s65 offen lds
s_add_u32 m0,s63,34816
s_add_u32 s65,s58,7274496
buffer_load_dwordx4 v6,s[4:7],s65 offen lds
s_add_u32 m0,s63,35840
s_add_u32 s65,s58,7372800
buffer_load_dwordx4 v6,s[4:7],s65 offen lds
s_add_u32 m0,s63,36864
s_add_u32 s65,s58,7471104
buffer_load_dwordx4 v6,s[4:7],s65 offen lds
s_add_u32 m0,s63,37888
s_add_u32 s65,s58,7569408
buffer_load_dwordx4 v6,s[4:7],s65 offen lds
s_add_u32 m0,s63,38912
s_add_u32 s65,s58,7667712
buffer_load_dwordx4 v6,s[4:7],s65 offen lds
s_add_u32 m0,s63,39936
s_add_u32 s65,s58,7766016
buffer_load_dwordx4 v6,s[4:7],s65 offen lds
s_waitcnt vmcnt(20)
v_bfe_u32 v9,v0,2,2
v_lshrrev_b32 v10,5,v0
v_lshl_add_u32 v9,v10,2,v9
v_mul_u32_u24 v9,128,v9
v_and_b32 v10,1,v0
v_lshl_add_u32 v9,v10,3,v9
v_bfe_u32 v10,v0,1,1
v_lshl_add_u32 v9,v10,5,v9
v_bfe_u32 v10,v0,4,1
v_lshl_add_u32 v9,v10,4,v9
v_add_u32 v7,s63,v9
ds_read_b64_tr_b16 a[80:81],v7 offset:0
ds_read_b64_tr_b16 a[82:83],v7 offset:2048
ds_read_b64_tr_b16 a[84:85],v7 offset:1024
ds_read_b64_tr_b16 a[86:87],v7 offset:3072
ds_read_b64_tr_b16 a[240:241],v7 offset:64
ds_read_b64_tr_b16 a[242:243],v7 offset:2112
ds_read_b64_tr_b16 a[244:245],v7 offset:1088
ds_read_b64_tr_b16 a[246:247],v7 offset:3136
ds_read_b64_tr_b16 a[88:89],v7 offset:4096
ds_read_b64_tr_b16 a[90:91],v7 offset:6144
ds_read_b64_tr_b16 a[92:93],v7 offset:5120
ds_read_b64_tr_b16 a[94:95],v7 offset:7168
s_waitcnt lgkmcnt(4)
ds_read_b64_tr_b16 a[248:249],v7 offset:4160
ds_read_b64_tr_b16 a[250:251],v7 offset:6208
ds_read_b64_tr_b16 a[252:253],v7 offset:5184
ds_read_b64_tr_b16 a[254:255],v7 offset:7232
ds_read_b64_tr_b16 a[96:97],v7 offset:8192
ds_read_b64_tr_b16 a[98:99],v7 offset:10240
ds_read_b64_tr_b16 a[100:101],v7 offset:9216
ds_read_b64_tr_b16 a[102:103],v7 offset:11264
ds_read_b64_tr_b16 v[192:193],v7 offset:8256
ds_read_b64_tr_b16 v[194:195],v7 offset:10304
ds_read_b64_tr_b16 v[196:197],v7 offset:9280
ds_read_b64_tr_b16 v[198:199],v7 offset:11328
s_waitcnt lgkmcnt(4)
ds_read_b64_tr_b16 a[104:105],v7 offset:12288
ds_read_b64_tr_b16 a[106:107],v7 offset:14336
ds_read_b64_tr_b16 a[108:109],v7 offset:13312
ds_read_b64_tr_b16 a[110:111],v7 offset:15360
ds_read_b64_tr_b16 v[200:201],v7 offset:12352
ds_read_b64_tr_b16 v[202:203],v7 offset:14400
ds_read_b64_tr_b16 v[204:205],v7 offset:13376
ds_read_b64_tr_b16 v[206:207],v7 offset:15424
ds_read_b64_tr_b16 a[112:113],v7 offset:16384
ds_read_b64_tr_b16 a[114:115],v7 offset:18432
ds_read_b64_tr_b16 a[116:117],v7 offset:17408
ds_read_b64_tr_b16 a[118:119],v7 offset:19456
s_waitcnt lgkmcnt(4)
ds_read_b64_tr_b16 v[208:209],v7 offset:16448
ds_read_b64_tr_b16 v[210:211],v7 offset:18496
ds_read_b64_tr_b16 v[212:213],v7 offset:17472
ds_read_b64_tr_b16 v[214:215],v7 offset:19520
s_waitcnt lgkmcnt(0)
s_waitcnt vmcnt(0)
v_bfe_u32 v9,v0,2,2
v_lshrrev_b32 v10,5,v0
v_lshl_add_u32 v9,v10,2,v9
v_mul_u32_u24 v9,128,v9
v_and_b32 v10,1,v0
v_lshl_add_u32 v9,v10,3,v9
v_bfe_u32 v10,v0,1,1
v_lshl_add_u32 v9,v10,5,v9
v_bfe_u32 v10,v0,4,1
v_lshl_add_u32 v9,v10,4,v9
v_add_u32 v7,s63,v9
ds_read_b64_tr_b16 a[120:121],v7 offset:20480
ds_read_b64_tr_b16 a[122:123],v7 offset:22528
ds_read_b64_tr_b16 a[124:125],v7 offset:21504
ds_read_b64_tr_b16 a[126:127],v7 offset:23552
ds_read_b64_tr_b16 v[216:217],v7 offset:20544
ds_read_b64_tr_b16 v[218:219],v7 offset:22592
ds_read_b64_tr_b16 v[220:221],v7 offset:21568
ds_read_b64_tr_b16 v[222:223],v7 offset:23616
ds_read_b64_tr_b16 a[128:129],v7 offset:24576
ds_read_b64_tr_b16 a[130:131],v7 offset:26624
ds_read_b64_tr_b16 a[132:133],v7 offset:25600
ds_read_b64_tr_b16 a[134:135],v7 offset:27648
s_waitcnt lgkmcnt(4)
ds_read_b64_tr_b16 v[224:225],v7 offset:24640
ds_read_b64_tr_b16 v[226:227],v7 offset:26688
ds_read_b64_tr_b16 v[228:229],v7 offset:25664
ds_read_b64_tr_b16 v[230:231],v7 offset:27712
ds_read_b64_tr_b16 a[136:137],v7 offset:28672
ds_read_b64_tr_b16 a[138:139],v7 offset:30720
ds_read_b64_tr_b16 a[140:141],v7 offset:29696
ds_read_b64_tr_b16 a[142:143],v7 offset:31744
ds_read_b64_tr_b16 v[232:233],v7 offset:28736
ds_read_b64_tr_b16 v[234:235],v7 offset:30784
ds_read_b64_tr_b16 v[236:237],v7 offset:29760
ds_read_b64_tr_b16 v[238:239],v7 offset:31808
s_waitcnt lgkmcnt(4)
ds_read_b64_tr_b16 a[144:145],v7 offset:32768
ds_read_b64_tr_b16 a[146:147],v7 offset:34816
ds_read_b64_tr_b16 a[148:149],v7 offset:33792
ds_read_b64_tr_b16 a[150:151],v7 offset:35840
ds_read_b64_tr_b16 v[240:241],v7 offset:32832
ds_read_b64_tr_b16 v[242:243],v7 offset:34880
ds_read_b64_tr_b16 v[244:245],v7 offset:33856
ds_read_b64_tr_b16 v[246:247],v7 offset:35904
ds_read_b64_tr_b16 a[152:153],v7 offset:36864
ds_read_b64_tr_b16 a[154:155],v7 offset:38912
ds_read_b64_tr_b16 a[156:157],v7 offset:37888
ds_read_b64_tr_b16 a[158:159],v7 offset:39936
s_waitcnt lgkmcnt(4)
ds_read_b64_tr_b16 v[248:249],v7 offset:36928
ds_read_b64_tr_b16 v[250:251],v7 offset:38976
ds_read_b64_tr_b16 v[252:253],v7 offset:37952
ds_read_b64_tr_b16 v[254:255],v7 offset:40000
s_waitcnt lgkmcnt(0)
v_mov_b32 v24,0x3f803f80
v_mov_b32 v25,0x3f803f80
v_mov_b32 v26,0x3f803f80
v_mov_b32 v27,0x3f803f80
s_nop 1
v_mfma_f32_32x32x16_bf16 v[120:135],a[0:3],v[24:27],0
v_mfma_f32_32x32x16_bf16 v[136:151],a[160:163],v[24:27],0
v_mfma_f32_32x32x16_bf16 v[120:135],a[4:7],v[24:27],v[120:135]
v_mfma_f32_32x32x16_bf16 v[136:151],a[164:167],v[24:27],v[136:151]
v_mfma_f32_32x32x16_bf16 v[120:135],a[8:11],v[24:27],v[120:135]
v_mfma_f32_32x32x16_bf16 v[136:151],a[168:171],v[24:27],v[136:151]
v_mfma_f32_32x32x16_bf16 v[120:135],a[12:15],v[24:27],v[120:135]
v_mfma_f32_32x32x16_bf16 v[136:151],a[172:175],v[24:27],v[136:151]
v_mfma_f32_32x32x16_bf16 v[120:135],a[16:19],v[24:27],v[120:135]
v_mfma_f32_32x32x16_bf16 v[136:151],a[176:179],v[24:27],v[136:151]
v_mfma_f32_32x32x16_bf16 v[120:135],a[20:23],v[24:27],v[120:135]
v_mfma_f32_32x32x16_bf16 v[136:151],a[180:183],v[24:27],v[136:151]
v_mfma_f32_32x32x16_bf16 v[120:135],a[24:27],v[24:27],v[120:135]
v_mfma_f32_32x32x16_bf16 v[136:151],a[184:187],v[24:27],v[136:151]
v_mfma_f32_32x32x16_bf16 v[120:135],a[28:31],v[24:27],v[120:135]
v_mfma_f32_32x32x16_bf16 v[136:151],a[188:191],v[24:27],v[136:151]
v_mfma_f32_32x32x16_bf16 v[120:135],a[32:35],v[24:27],v[120:135]
v_mfma_f32_32x32x16_bf16 v[136:151],a[192:195],v[24:27],v[136:151]
v_mfma_f32_32x32x16_bf16 v[120:135],a[36:39],v[24:27],v[120:135]
v_mfma_f32_32x32x16_bf16 v[136:151],a[196:199],v[24:27],v[136:151]
v_mfma_f32_32x32x16_bf16 v[120:135],a[40:43],v[24:27],v[120:135]
v_mfma_f32_32x32x16_bf16 v[136:151],a[200:203],v[24:27],v[136:151]
v_mfma_f32_32x32x16_bf16 v[120:135],a[44:47],v[24:27],v[120:135]
v_mfma_f32_32x32x16_bf16 v[136:151],a[204:207],v[24:27],v[136:151]
v_mfma_f32_32x32x16_bf16 v[120:135],a[48:51],v[24:27],v[120:135]
v_mfma_f32_32x32x16_bf16 v[136:151],a[208:211],v[24:27],v[136:151]
v_mfma_f32_32x32x16_bf16 v[120:135],a[52:55],v[24:27],v[120:135]
v_mfma_f32_32x32x16_bf16 v[136:151],a[212:215],v[24:27],v[136:151]
v_mfma_f32_32x32x16_bf16 v[120:135],a[56:59],v[24:27],v[120:135]
v_mfma_f32_32x32x16_bf16 v[136:151],a[216:219],v[24:27],v[136:151]
v_mfma_f32_32x32x16_bf16 v[120:135],a[60:63],v[24:27],v[120:135]
v_mfma_f32_32x32x16_bf16 v[136:151],a[220:223],v[24:27],v[136:151]
v_mfma_f32_32x32x16_bf16 v[120:135],a[64:67],v[24:27],v[120:135]
v_mfma_f32_32x32x16_bf16 v[136:151],a[224:227],v[24:27],v[136:151]
v_mfma_f32_32x32x16_bf16 v[120:135],a[68:71],v[24:27],v[120:135]
v_mfma_f32_32x32x16_bf16 v[136:151],a[228:231],v[24:27],v[136:151]
v_mfma_f32_32x32x16_bf16 v[120:135],a[72:75],v[24:27],v[120:135]
v_mfma_f32_32x32x16_bf16 v[136:151],a[232:235],v[24:27],v[136:151]
v_mfma_f32_32x32x16_bf16 v[120:135],a[76:79],v[24:27],v[120:135]
v_mfma_f32_32x32x16_bf16 v[136:151],a[236:239],v[24:27],v[136:151]
v_mfma_f32_32x32x16_bf16 v[120:135],a[80:83],v[24:27],v[120:135]
v_mfma_f32_32x32x16_bf16 v[136:151],a[240:243],v[24:27],v[136:151]
v_mfma_f32_32x32x16_bf16 v[120:135],a[84:87],v[24:27],v[120:135]
v_mfma_f32_32x32x16_bf16 v[136:151],a[244:247],v[24:27],v[136:151]
v_mfma_f32_32x32x16_bf16 v[120:135],a[88:91],v[24:27],v[120:135]
v_mfma_f32_32x32x16_bf16 v[136:151],a[248:251],v[24:27],v[136:151]
v_mfma_f32_32x32x16_bf16 v[120:135],a[92:95],v[24:27],v[120:135]
v_mfma_f32_32x32x16_bf16 v[136:151],a[252:255],v[24:27],v[136:151]
v_mfma_f32_32x32x16_bf16 v[120:135],a[96:99],v[24:27],v[120:135]
v_mfma_f32_32x32x16_bf16 v[136:151],v[192:195],v[24:27],v[136:151]
v_mfma_f32_32x32x16_bf16 v[120:135],a[100:103],v[24:27],v[120:135]
v_mfma_f32_32x32x16_bf16 v[136:151],v[196:199],v[24:27],v[136:151]
v_mfma_f32_32x32x16_bf16 v[120:135],a[104:107],v[24:27],v[120:135]
v_mfma_f32_32x32x16_bf16 v[136:151],v[200:203],v[24:27],v[136:151]
v_mfma_f32_32x32x16_bf16 v[120:135],a[108:111],v[24:27],v[120:135]
v_mfma_f32_32x32x16_bf16 v[136:151],v[204:207],v[24:27],v[136:151]
v_mfma_f32_32x32x16_bf16 v[120:135],a[112:115],v[24:27],v[120:135]
v_mfma_f32_32x32x16_bf16 v[136:151],v[208:211],v[24:27],v[136:151]
v_mfma_f32_32x32x16_bf16 v[120:135],a[116:119],v[24:27],v[120:135]
v_mfma_f32_32x32x16_bf16 v[136:151],v[212:215],v[24:27],v[136:151]
v_mfma_f32_32x32x16_bf16 v[120:135],a[120:123],v[24:27],v[120:135]
v_mfma_f32_32x32x16_bf16 v[136:151],v[216:219],v[24:27],v[136:151]
v_mfma_f32_32x32x16_bf16 v[120:135],a[124:127],v[24:27],v[120:135]
v_mfma_f32_32x32x16_bf16 v[136:151],v[220:223],v[24:27],v[136:151]
v_mfma_f32_32x32x16_bf16 v[120:135],a[128:131],v[24:27],v[120:135]
v_mfma_f32_32x32x16_bf16 v[136:151],v[224:227],v[24:27],v[136:151]
v_mfma_f32_32x32x16_bf16 v[120:135],a[132:135],v[24:27],v[120:135]
v_mfma_f32_32x32x16_bf16 v[136:151],v[228:231],v[24:27],v[136:151]
v_mfma_f32_32x32x16_bf16 v[120:135],a[136:139],v[24:27],v[120:135]
v_mfma_f32_32x32x16_bf16 v[136:151],v[232:235],v[24:27],v[136:151]
v_mfma_f32_32x32x16_bf16 v[120:135],a[140:143],v[24:27],v[120:135]
v_mfma_f32_32x32x16_bf16 v[136:151],v[236:239],v[24:27],v[136:151]
v_mfma_f32_32x32x16_bf16 v[120:135],a[144:147],v[24:27],v[120:135]
v_mfma_f32_32x32x16_bf16 v[136:151],v[240:243],v[24:27],v[136:151]
v_mfma_f32_32x32x16_bf16 v[120:135],a[148:151],v[24:27],v[120:135]
v_mfma_f32_32x32x16_bf16 v[136:151],v[244:247],v[24:27],v[136:151]
v_mfma_f32_32x32x16_bf16 v[120:135],a[152:155],v[24:27],v[120:135]
v_mfma_f32_32x32x16_bf16 v[136:151],v[248:251],v[24:27],v[136:151]
v_mfma_f32_32x32x16_bf16 v[120:135],a[156:159],v[24:27],v[120:135]
v_mfma_f32_32x32x16_bf16 v[136:151],v[252:255],v[24:27],v[136:151]
s_barrier
s_lshl_b32 s3,s49,2
v_mov_b32 v7,s3
s_nop 8
ibw_222:
buffer_load_dword v6,v7,s[12:15],0 offen sc1
s_waitcnt vmcnt(0)
v_cmp_ne_u32 vcc,256,v6
s_nop 0
s_cbranch_vccz ok_223
s_sleep 8
s_sub_u32 s47,s47,1
s_cbranch_scc1 ABORT
s_branch ibw_222
ok_223:
s_cmp_lg_u32 s49,0
s_cbranch_scc1 ibok_224
v_and_b32 v7,7,v0
v_lshlrev_b32 v7,2,v7
buffer_load_dword v6,v7,s[12:15],0 offen offset:32 sc1
s_waitcnt vmcnt(0)
v_cmp_ne_u32 vcc,32,v6
s_nop 0
s_cbranch_vccz ibok_224
s_barrier
s_mov_b32 s49,1
s_mov_b32 s3,s2
s_load_dwordx16 s[16:31],s[0:1],0
s_load_dwordx8 s[32:39],s[0:1],64
s_waitcnt lgkmcnt(0)
s_branch DISPATCH
ibok_224:
s_mov_b32 s50,0
s_mov_b32 s32,0
s_mov_b32 s57,0
s_mov_b32 s59,2147483648
s_mov_b32 s82,2147483648
s_mov_b32 s39,2147483648
v_mov_b32 v22,94208
s_mov_b32 s72,0
s_mov_b32 s73,0
s_mov_b32 s83,s100
s_min_u32 s62,s32,127
s_sub_u32 s60,s62,20
s_lshr_b32 s34,s60,1
s_and_b32 s33,s60,1
s_xor_b32 s33,s33,1
s_cmp_eq_u32 s33,0
s_cselect_b32 s61,20,0
s_add_u32 s34,s34,s61
s_sub_u32 s61,s60,44
s_cmp_ge_u32 s60,88
s_cselect_b32 s34,s61,s34
s_cselect_b32 s33,1,s33
s_cmp_lt_u32 s62,20
s_cselect_b32 s34,s62,s34
s_cselect_b32 s33,0,s33
s_lshl_b32 s35,s33,6
s_add_u32 s35,s35,s34
s_lshl_b32 s35,s35,9
s_add_u32 s35,s35,0
s_lshl_b32 s60,s33,5
s_add_u32 s60,s60,7
v_min_u32 v2,s60,v0
v_lshlrev_b32 v2,2,v2
s_nop 1
QKVQ_COLD0:
s_cmp_lg_u32 s46,0
s_cbranch_scc1 cp_225
fb_226:
buffer_load_dword v3,v2,s[8:11],s35 offen sc1
s_waitcnt vmcnt(0)
v_cmp_eq_u32 vcc,0,v3
s_nop 0
s_cbranch_vccz ok_227
s_sleep 7
s_sub_u32 s47,s47,1
s_cbranch_scc1 ABORT
s_branch fb_226
ok_227:
cp_225:
s_barrier
s_lshl_b32 s60,s33,6
s_add_u32 s60,s60,s34
s_mul_i32 s60,s60,46080
s_add_u32 s60,s60,206569472
s_lshl_b32 s62,s46,10
s_add_u32 s62,s62,40960
s_add_u32 m0,s57,s62
s_add_u32 s63,s60,s62
buffer_load_dwordx4 v1,s[8:11],s63 offen sc1 lds
s_add_u32 m0,s57,45056
s_add_u32 s63,s60,45056
buffer_load_dwordx4 v1,s[8:11],s63 offen sc1 lds
s_mul_i32 s61,s46,10240
s_add_u32 s60,s60,s61
s_add_u32 s61,s61,s57
s_add_u32 m0,s61,0
s_add_u32 s63,s60,0
buffer_load_dwordx4 v1,s[8:11],s63 offen sc1 lds
buffer_load_dwordx4 v1,s[8:11],s63 offen offset:1024 sc1 lds
buffer_load_dwordx4 v1,s[8:11],s63 offen offset:2048 sc1 lds
buffer_load_dwordx4 v1,s[8:11],s63 offen offset:3072 sc1 lds
s_add_u32 m0,s61,4096
s_add_u32 s63,s60,4096
buffer_load_dwordx4 v1,s[8:11],s63 offen sc1 lds
buffer_load_dwordx4 v1,s[8:11],s63 offen offset:1024 sc1 lds
buffer_load_dwordx4 v1,s[8:11],s63 offen offset:2048 sc1 lds
buffer_load_dwordx4 v1,s[8:11],s63 offen offset:3072 sc1 lds
s_add_u32 m0,s61,8192
s_add_u32 s63,s60,8192
buffer_load_dwordx4 v1,s[8:11],s63 offen sc1 lds
buffer_load_dwordx4 v1,s[8:11],s63 offen offset:1024 sc1 lds
QKVQ_CD0:
s_mov_b32 s51,s33
s_mov_b32 s52,s34
s_add_u32 s32,s32,1
s_min_u32 s62,s32,127
s_sub_u32 s60,s62,20
s_lshr_b32 s34,s60,1
s_and_b32 s33,s60,1
s_xor_b32 s33,s33,1
s_cmp_eq_u32 s33,0
s_cselect_b32 s61,20,0
s_add_u32 s34,s34,s61
s_sub_u32 s61,s60,44
s_cmp_ge_u32 s60,88
s_cselect_b32 s34,s61,s34
s_cselect_b32 s33,1,s33
s_cmp_lt_u32 s62,20
s_cselect_b32 s34,s62,s34
s_cselect_b32 s33,0,s33
s_lshl_b32 s35,s33,6
s_add_u32 s35,s35,s34
s_lshl_b32 s35,s35,9
s_add_u32 s35,s35,0
s_lshl_b32 s60,s33,5
s_add_u32 s60,s60,7
v_min_u32 v2,s60,v0
v_lshlrev_b32 v2,2,v2
s_cmp_lg_u32 s46,0
s_cbranch_scc1 w0_228
buffer_load_dword v3,v2,s[8:11],s35 offen sc1
w0_228:
s_waitcnt vmcnt(0)
s_mov_b64 exec,1
buffer_store_dword v5,v1,s[8:11],s59 offen sc1
s_mov_b64 exec,-1
s_mov_b32 s59,2147483648
s_cmp_lg_u32 s46,0
s_cbranch_scc1 w0_229
v_cmp_eq_u32 vcc,0,v3
s_cmp_eq_u64 vcc,0
s_cselect_b32 s36,0,2147483648
s_cmp_lt_u32 s32,128
s_cselect_b32 s36,s36,2147483648
v_mov_b32 v23,s36
ds_write_b32 v22,v23
w0_229:
s_waitcnt lgkmcnt(0)
s_barrier
ds_read_b32 v23,v22
ds_read_b128 v[24:27],v16 offset:0
ds_read_b128 v[28:31],v17 offset:0
ds_read_b128 v[32:35],v16 offset:2048
ds_read_b128 v[36:39],v17 offset:2048
ds_read_b128 v[40:43],v16 offset:4096
s_waitcnt lgkmcnt(5)
v_readfirstlane_b32 s37,v23
s_nop 4
QKVQ_B0:
s_waitcnt lgkmcnt(3)
v_mfma_f32_32x32x16_bf16 v[56:71],a[0:3],v[24:27],0
ds_read_b128 v[44:47],v17 offset:4096
v_add_u32 v189,s57,v188
v_mfma_f32_32x32x16_bf16 v[72:87],a[160:163],v[24:27],0
v_add_u32 v8,0x800,v189
s_sub_u32 s66,46080,s57
s_lshl_b32 s60,s33,6
s_add_u32 s60,s60,s34
s_mul_i32 s60,s60,46080
s_add_u32 s60,s60,s37
v_mfma_f32_32x32x16_bf16 v[56:71],a[4:7],v[28:31],v[56:71]
ds_read_b128 v[48:51],v16 offset:6144
ds_read2_b64 v[156:159],v189 offset0:0 offset1:32
s_add_u32 s60,s60,206569472
s_lshl_b32 s62,s46,10
v_mfma_f32_32x32x16_bf16 v[72:87],a[164:167],v[28:31],v[72:87]
ds_read2_b64 v[160:163],v189 offset0:64 offset1:96
s_add_u32 s62,s62,40960
s_add_u32 m0,s66,s62
s_add_u32 s63,s60,s62
s_waitcnt lgkmcnt(5)
v_mfma_f32_32x32x16_bf16 v[56:71],a[8:11],v[32:35],v[56:71]
ds_read_b128 v[52:55],v17 offset:6144
ds_read2_b64 v[164:167],v189 offset0:128 offset1:160
buffer_load_dwordx4 v1,s[8:11],s63 offen sc1 lds
v_mfma_f32_32x32x16_bf16 v[72:87],a[168:171],v[32:35],v[72:87]
ds_read2_b64 v[168:171],v189 offset0:192 offset1:224
s_add_u32 m0,s66,45056
s_add_u32 s63,s60,45056
s_mul_i32 s74,s73,393216
s_add_u32 s74,s74,s39
v_mfma_f32_32x32x16_bf16 v[56:71],a[12:15],v[36:39],v[56:71]
ds_read_b128 v[24:27],v16 offset:8192
ds_read2_b64 v[172:175],v8 offset0:0 offset1:32
s_add_u32 s74,s74,s70
v_fma_f32 v88,-v176,v120,v88
v_mfma_f32_32x32x16_bf16 v[72:87],a[172:175],v[36:39],v[72:87]
buffer_load_dwordx4 v1,s[8:11],s63 offen sc1 lds
s_mul_i32 s61,s46,10240
s_add_u32 s60,s60,s61
s_add_u32 s61,s61,s66
s_waitcnt lgkmcnt(8)
v_mfma_f32_32x32x16_bf16 v[56:71],a[16:19],v[40:43],v[56:71]
ds_read_b128 v[28:31],v17 offset:8192
s_add_u32 m0,s61,0
s_add_u32 s63,s60,0
v_fma_f32 v89,-v176,v121,v89
v_fma_f32 v90,-v176,v122,v90
v_mfma_f32_32x32x16_bf16 v[72:87],a[176:179],v[40:43],v[72:87]
v_fma_f32 v91,-v176,v123,v91
v_fma_f32 v92,-v176,v124,v92
v_fma_f32 v93,-v176,v125,v93
v_fma_f32 v94,-v176,v126,v94
v_fma_f32 v95,-v176,v127,v95
v_mul_f32 v88,v88,v177
v_mfma_f32_32x32x16_bf16 v[56:71],a[20:23],v[44:47],v[56:71]
ds_read_b128 v[32:35],v16 offset:10240
buffer_load_dwordx4 v1,s[8:11],s63 offen sc1 lds
v_mul_f32 v89,v89,v177
v_mul_f32 v90,v90,v177
v_mfma_f32_32x32x16_bf16 v[72:87],a[180:183],v[44:47],v[72:87]
v_mul_f32 v91,v91,v177
v_mul_f32 v92,v92,v177
v_mul_f32 v93,v93,v177
v_mul_f32 v94,v94,v177
v_mul_f32 v95,v95,v177
s_waitcnt lgkmcnt(6)
v_mfma_f32_32x32x16_bf16 v[56:71],a[24:27],v[48:51],v[56:71]
ds_read_b128 v[36:39],v17 offset:10240
v_cvt_pk_bf16_f32 v180,v88,v89
v_cvt_pk_bf16_f32 v181,v90,v91
v_cvt_pk_bf16_f32 v182,v92,v93
v_cvt_pk_bf16_f32 v183,v94,v95
v_mfma_f32_32x32x16_bf16 v[72:87],a[184:187],v[48:51],v[72:87]
buffer_load_dwordx4 v1,s[8:11],s63 offen offset:1024 sc1 lds
buffer_store_dwordx4 v[180:183],v20,s[8:11],s74 offen sc1
v_fma_f32 v96,-v176,v128,v96
v_fma_f32 v97,-v176,v129,v97
v_mfma_f32_32x32x16_bf16 v[56:71],a[28:31],v[52:55],v[56:71]
ds_read_b128 v[40:43],v16 offset:12288
v_fma_f32 v98,-v176,v130,v98
v_fma_f32 v99,-v176,v131,v99
v_fma_f32 v100,-v176,v132,v100
v_fma_f32 v101,-v176,v133,v101
v_mfma_f32_32x32x16_bf16 v[72:87],a[188:191],v[52:55],v[72:87]
v_fma_f32 v102,-v176,v134,v102
v_fma_f32 v103,-v176,v135,v103
v_mul_f32 v96,v96,v177
v_mul_f32 v97,v97,v177
v_mul_f32 v98,v98,v177
s_waitcnt lgkmcnt(3)
v_mfma_f32_32x32x16_bf16 v[56:71],a[32:35],v[24:27],v[56:71]
ds_read_b128 v[44:47],v17 offset:12288
buffer_load_dwordx4 v1,s[8:11],s63 offen offset:2048 sc1 lds
v_mul_f32 v99,v99,v177
v_mul_f32 v100,v100,v177
v_mfma_f32_32x32x16_bf16 v[72:87],a[192:195],v[24:27],v[72:87]
v_mul_f32 v101,v101,v177
v_mul_f32 v102,v102,v177
v_mul_f32 v103,v103,v177
v_cvt_pk_bf16_f32 v184,v96,v97
v_cvt_pk_bf16_f32 v185,v98,v99
v_cvt_pk_bf16_f32 v186,v100,v101
v_mfma_f32_32x32x16_bf16 v[56:71],a[36:39],v[28:31],v[56:71]
ds_read_b128 v[48:51],v16 offset:14336
v_cvt_pk_bf16_f32 v187,v102,v103
buffer_store_dwordx4 v[184:187],v21,s[8:11],s74 offen sc1
v_fma_f32 v104,-v176,v136,v104
v_mfma_f32_32x32x16_bf16 v[72:87],a[196:199],v[28:31],v[72:87]
buffer_load_dwordx4 v1,s[8:11],s63 offen offset:3072 sc1 lds
s_add_u32 m0,s61,4096
s_add_u32 s63,s60,4096
v_fma_f32 v105,-v176,v137,v105
s_waitcnt lgkmcnt(3)
v_mfma_f32_32x32x16_bf16 v[56:71],a[40:43],v[32:35],v[56:71]
ds_read_b128 v[52:55],v17 offset:14336
v_fma_f32 v106,-v176,v138,v106
v_fma_f32 v107,-v176,v139,v107
v_fma_f32 v108,-v176,v140,v108
v_fma_f32 v109,-v176,v141,v109
v_mfma_f32_32x32x16_bf16 v[72:87],a[200:203],v[32:35],v[72:87]
v_fma_f32 v110,-v176,v142,v110
v_fma_f32 v111,-v176,v143,v111
v_mul_f32 v104,v104,v177
v_mul_f32 v105,v105,v177
v_mul_f32 v106,v106,v177
v_mul_f32 v107,v107,v177
v_mfma_f32_32x32x16_bf16 v[56:71],a[44:47],v[36:39],v[56:71]
ds_read_b128 v[24:27],v16 offset:16384
buffer_load_dwordx4 v1,s[8:11],s63 offen sc1 lds
v_mul_f32 v108,v108,v177
v_mul_f32 v109,v109,v177
v_mfma_f32_32x32x16_bf16 v[72:87],a[204:207],v[36:39],v[72:87]
v_mul_f32 v110,v110,v177
v_mul_f32 v111,v111,v177
v_cvt_pk_bf16_f32 v180,v104,v105
v_cvt_pk_bf16_f32 v181,v106,v107
v_cvt_pk_bf16_f32 v182,v108,v109
s_waitcnt lgkmcnt(3)
v_mfma_f32_32x32x16_bf16 v[56:71],a[48:51],v[40:43],v[56:71]
ds_read_b128 v[28:31],v17 offset:16384
v_cvt_pk_bf16_f32 v183,v110,v111
buffer_store_dwordx4 v[180:183],v20,s[8:11],s74 offen offset:2048 sc1
v_fma_f32 v112,-v176,v144,v112
v_mfma_f32_32x32x16_bf16 v[72:87],a[208:211],v[40:43],v[72:87]
buffer_load_dwordx4 v1,s[8:11],s63 offen offset:1024 sc1 lds
v_fma_f32 v113,-v176,v145,v113
v_fma_f32 v114,-v176,v146,v114
v_fma_f32 v115,-v176,v147,v115
v_fma_f32 v116,-v176,v148,v116
v_mfma_f32_32x32x16_bf16 v[56:71],a[52:55],v[44:47],v[56:71]
ds_read_b128 v[32:35],v16 offset:18432
v_fma_f32 v117,-v176,v149,v117
v_fma_f32 v118,-v176,v150,v118
v_fma_f32 v119,-v176,v151,v119
v_mul_f32 v112,v112,v177
v_mfma_f32_32x32x16_bf16 v[72:87],a[212:215],v[44:47],v[72:87]
v_mul_f32 v113,v113,v177
v_mul_f32 v114,v114,v177
v_mul_f32 v115,v115,v177
v_mul_f32 v116,v116,v177
v_mul_f32 v117,v117,v177
s_waitcnt lgkmcnt(3)
v_mfma_f32_32x32x16_bf16 v[56:71],a[56:59],v[48:51],v[56:71]
ds_read_b128 v[36:39],v17 offset:18432
buffer_load_dwordx4 v1,s[8:11],s63 offen offset:2048 sc1 lds
v_mul_f32 v118,v118,v177
v_mul_f32 v119,v119,v177
v_mfma_f32_32x32x16_bf16 v[72:87],a[216:219],v[48:51],v[72:87]
v_cvt_pk_bf16_f32 v184,v112,v113
v_cvt_pk_bf16_f32 v185,v114,v115
v_cvt_pk_bf16_f32 v186,v116,v117
v_cvt_pk_bf16_f32 v187,v118,v119
buffer_store_dwordx4 v[184:187],v21,s[8:11],s74 offen offset:2048 sc1
v_mfma_f32_32x32x16_bf16 v[56:71],a[60:63],v[52:55],v[56:71]
ds_read_b128 v[40:43],v16 offset:20480
s_waitcnt vmcnt(13)
s_mov_b64 exec,1
buffer_store_dword v5,v1,s[8:11],s59 offen sc1
s_mov_b64 exec,-1
s_mov_b32 s59,2147483648
v_mfma_f32_32x32x16_bf16 v[72:87],a[220:223],v[52:55],v[72:87]
buffer_load_dwordx4 v1,s[8:11],s63 offen offset:3072 sc1 lds
s_add_u32 m0,s61,8192
s_add_u32 s63,s60,8192
s_lshl_b32 s82,s72,6
s_waitcnt lgkmcnt(3)
v_mfma_f32_32x32x16_bf16 v[56:71],a[64:67],v[24:27],v[56:71]
ds_read_b128 v[44:47],v17 offset:20480
s_add_u32 s82,s82,s73
s_lshl_b32 s82,s82,9
s_add_u32 s82,s82,s71
s_lshl_b32 s75,s69,2
v_mfma_f32_32x32x16_bf16 v[72:87],a[224:227],v[24:27],v[72:87]
s_add_u32 s82,s82,s75
s_add_u32 s82,s82,s39
v_pk_add_f32 v[156:157],v[156:157],v[166:167]
v_mfma_f32_32x32x16_bf16 v[56:71],a[68:71],v[28:31],v[56:71]
ds_read_b128 v[48:51],v16 offset:22528
buffer_load_dwordx4 v1,s[8:11],s63 offen sc1 lds
v_pk_add_f32 v[158:159],v[158:159],v[168:169]
v_mfma_f32_32x32x16_bf16 v[72:87],a[228:231],v[28:31],v[72:87]
v_pk_add_f32 v[160:161],v[160:161],v[170:171]
v_pk_add_f32 v[162:163],v[162:163],v[172:173]
s_waitcnt lgkmcnt(3)
v_mfma_f32_32x32x16_bf16 v[56:71],a[72:75],v[32:35],v[56:71]
ds_read_b128 v[52:55],v17 offset:22528
v_pk_add_f32 v[164:165],v[164:165],v[174:175]
v_pk_add_f32 v[156:157],v[156:157],v[158:159]
v_mfma_f32_32x32x16_bf16 v[72:87],a[232:235],v[32:35],v[72:87]
buffer_load_dwordx4 v1,s[8:11],s63 offen offset:1024 sc1 lds
s_mov_b32 s53,s33
s_mov_b32 s54,s34
s_cmp_eq_u32 s37,0
s_addc_u32 s32,s32,0
v_mfma_f32_32x32x16_bf16 v[56:71],a[76:79],v[36:39],v[56:71]
ds_read_b128 v[24:27],v16 offset:24576
s_min_u32 s62,s32,127
s_sub_u32 s60,s62,20
s_lshr_b32 s34,s60,1
s_and_b32 s33,s60,1
v_mfma_f32_32x32x16_bf16 v[72:87],a[236:239],v[36:39],v[72:87]
s_xor_b32 s33,s33,1
s_cmp_eq_u32 s33,0
s_cselect_b32 s61,20,0
s_add_u32 s34,s34,s61
s_sub_u32 s61,s60,44
s_waitcnt lgkmcnt(3)
v_mfma_f32_32x32x16_bf16 v[56:71],a[80:83],v[40:43],v[56:71]
ds_read_b128 v[28:31],v17 offset:24576
s_cmp_ge_u32 s60,88
s_cselect_b32 s34,s61,s34
s_cselect_b32 s33,1,s33
v_mfma_f32_32x32x16_bf16 v[72:87],a[240:243],v[40:43],v[72:87]
s_cmp_lt_u32 s62,20
s_cselect_b32 s34,s62,s34
s_cselect_b32 s33,0,s33
s_lshl_b32 s35,s33,6
s_add_u32 s35,s35,s34
s_lshl_b32 s35,s35,9
v_mfma_f32_32x32x16_bf16 v[56:71],a[84:87],v[44:47],v[56:71]
ds_read_b128 v[32:35],v16 offset:26624
s_add_u32 s35,s35,0
s_lshl_b32 s60,s33,5
s_add_u32 s60,s60,7
v_min_u32 v2,s60,v0
v_mfma_f32_32x32x16_bf16 v[72:87],a[244:247],v[44:47],v[72:87]
v_lshlrev_b32 v2,2,v2
v_pk_add_f32 v[160:161],v[160:161],v[162:163]
v_pk_add_f32 v[156:157],v[156:157],v[160:161]
s_waitcnt lgkmcnt(3)
v_mfma_f32_32x32x16_bf16 v[56:71],a[88:91],v[48:51],v[56:71]
ds_read_b128 v[36:39],v17 offset:26624
s_cmp_lg_u32 s46,0
s_cbranch_scc1 w0_230
buffer_load_dword v3,v2,s[8:11],s35 offen sc1
w0_230:
v_mfma_f32_32x32x16_bf16 v[72:87],a[248:251],v[48:51],v[72:87]
v_pk_add_f32 v[156:157],v[156:157],v[164:165]
v_mov_b32 v158,v156
v_mov_b32 v159,v157
s_nop 0
v_permlane32_swap_b32 v156,v158
v_permlane32_swap_b32 v157,v159
v_mfma_f32_32x32x16_bf16 v[56:71],a[92:95],v[52:55],v[56:71]
ds_read_b128 v[40:43],v16 offset:28672
v_add_f32 v176,v156,v158
v_add_f32 v177,v157,v159
v_mul_f32 v176,0x3acccccd,v176
v_mul_f32 v177,0x3acccccd,v177
v_mfma_f32_32x32x16_bf16 v[72:87],a[252:255],v[52:55],v[72:87]
v_fma_f32 v177,-v176,v176,v177
v_max_f32 v177,0,v177
v_cvt_pk_bf16_f32 v8,v176,v177
v_lshlrev_b32 v176,16,v8
v_and_b32 v177,0xffff0000,v8
s_waitcnt lgkmcnt(3)
v_mfma_f32_32x32x16_bf16 v[56:71],a[96:99],v[24:27],v[56:71]
ds_read_b128 v[44:47],v17 offset:28672
v_add_f32 v177,0x3727c5ac,v177
v_cvt_pk_bf16_f32 v8,v177,v177
v_lshlrev_b32 v177,16,v8
v_mfma_f32_32x32x16_bf16 v[72:87],v[192:195],v[24:27],v[72:87]
v_sqrt_f32 v177,v177
s_nop 0
v_cvt_pk_bf16_f32 v8,v177,v177
v_lshlrev_b32 v177,16,v8
v_rcp_f32 v177,v177
v_mfma_f32_32x32x16_bf16 v[56:71],a[100:103],v[28:31],v[56:71]
ds_read_b128 v[48:51],v16 offset:30720
s_cmp_eq_u32 s51,0
s_cselect_b64 s[76:77],-1,0
v_cndmask_b32 v176,v176,0,s[76:77]
v_cndmask_b32 v177,v177,1.0,s[76:77]
v_mfma_f32_32x32x16_bf16 v[72:87],v[196:199],v[28:31],v[72:87]
s_mov_b32 s72,s51
s_mov_b32 s73,s52
s_waitcnt lgkmcnt(3)
v_mfma_f32_32x32x16_bf16 v[56:71],a[104:107],v[32:35],v[56:71]
ds_read_b128 v[52:55],v17 offset:30720
v_mfma_f32_32x32x16_bf16 v[72:87],v[200:203],v[32:35],v[72:87]
v_mfma_f32_32x32x16_bf16 v[56:71],a[108:111],v[36:39],v[56:71]
ds_read_b128 v[24:27],v16 offset:32768
v_mfma_f32_32x32x16_bf16 v[72:87],v[204:207],v[36:39],v[72:87]
s_waitcnt lgkmcnt(3)
v_mfma_f32_32x32x16_bf16 v[56:71],a[112:115],v[40:43],v[56:71]
ds_read_b128 v[28:31],v17 offset:32768
v_mfma_f32_32x32x16_bf16 v[72:87],v[208:211],v[40:43],v[72:87]
v_mfma_f32_32x32x16_bf16 v[56:71],a[116:119],v[44:47],v[56:71]
ds_read_b128 v[32:35],v16 offset:34816
v_mfma_f32_32x32x16_bf16 v[72:87],v[212:215],v[44:47],v[72:87]
s_waitcnt lgkmcnt(3)
v_mfma_f32_32x32x16_bf16 v[56:71],a[120:123],v[48:51],v[56:71]
ds_read_b128 v[36:39],v17 offset:34816
v_mfma_f32_32x32x16_bf16 v[72:87],v[216:219],v[48:51],v[72:87]
v_mfma_f32_32x32x16_bf16 v[56:71],a[124:127],v[52:55],v[56:71]
ds_read_b128 v[40:43],v16 offset:36864
v_mfma_f32_32x32x16_bf16 v[72:87],v[220:223],v[52:55],v[72:87]
s_waitcnt vmcnt(0)
s_cmp_lg_u32 s46,0
s_cbranch_scc1 w0_231
v_cmp_eq_u32 vcc,0,v3
s_cmp_eq_u64 vcc,0
s_cselect_b32 s36,0,2147483648
s_cmp_lt_u32 s32,128
s_cselect_b32 s36,s36,2147483648
v_mov_b32 v23,s36
ds_write_b32 v22,v23
w0_231:
s_waitcnt lgkmcnt(3)
v_mfma_f32_32x32x16_bf16 v[56:71],a[128:131],v[24:27],v[56:71]
ds_read_b128 v[44:47],v17 offset:36864
s_mov_b64 exec,1
buffer_store_dword v5,v1,s[8:11],s82 offen sc1
s_mov_b64 exec,-1
s_mov_b32 s82,2147483648
v_mfma_f32_32x32x16_bf16 v[72:87],v[224:227],v[24:27],v[72:87]
v_mfma_f32_32x32x16_bf16 v[56:71],a[132:135],v[28:31],v[56:71]
ds_read_b128 v[48:51],v16 offset:38912
v_mfma_f32_32x32x16_bf16 v[72:87],v[228:231],v[28:31],v[72:87]
s_waitcnt lgkmcnt(3)
v_mfma_f32_32x32x16_bf16 v[56:71],a[136:139],v[32:35],v[56:71]
ds_read_b128 v[52:55],v17 offset:38912
v_mfma_f32_32x32x16_bf16 v[72:87],v[232:235],v[32:35],v[72:87]
s_waitcnt lgkmcnt(2)
s_barrier
ds_read_b32 v23,v22
v_mfma_f32_32x32x16_bf16 v[56:71],a[140:143],v[36:39],v[56:71]
ds_read_b128 v[24:27],v18 offset:0
v_mfma_f32_32x32x16_bf16 v[72:87],v[236:239],v[36:39],v[72:87]
v_mfma_f32_32x32x16_bf16 v[56:71],a[144:147],v[40:43],v[56:71]
ds_read_b128 v[28:31],v19 offset:0
v_mfma_f32_32x32x16_bf16 v[72:87],v[240:243],v[40:43],v[72:87]
v_mfma_f32_32x32x16_bf16 v[56:71],a[148:151],v[44:47],v[56:71]
ds_read_b128 v[32:35],v18 offset:2048
v_mfma_f32_32x32x16_bf16 v[72:87],v[244:247],v[44:47],v[72:87]
s_waitcnt lgkmcnt(4)
v_mfma_f32_32x32x16_bf16 v[56:71],a[152:155],v[48:51],v[56:71]
ds_read_b128 v[36:39],v19 offset:2048
s_waitcnt lgkmcnt(4)
v_readfirstlane_b32 s38,v23
v_mfma_f32_32x32x16_bf16 v[72:87],v[248:251],v[48:51],v[72:87]
v_mfma_f32_32x32x16_bf16 v[56:71],a[156:159],v[52:55],v[56:71]
ds_read_b128 v[40:43],v18 offset:4096
v_mfma_f32_32x32x16_bf16 v[72:87],v[252:255],v[52:55],v[72:87]
s_cmp_lg_u32 s37,0
s_cbranch_scc1 nf_232
s_cmp_lt_u32 s50,2
s_cbranch_scc1 now_233
s_mov_b32 s39,0
s_add_u32 s50,s50,1
s_sub_u32 s57,46080,s57
s_mov_b32 s51,s53
s_mov_b32 s52,s54
s_mov_b32 s37,s38
s_branch QKVQ_B1
s_nop 0
now_233:
s_mov_b32 s55,0
s_branch nt_234
nf_232:
s_mov_b32 s55,2
s_cmp_lg_u32 s38,0
s_cbranch_scc1 nt_234
s_mov_b32 s55,1
s_mov_b32 s37,0
s_sub_u32 s66,46080,s57
s_lshl_b32 s60,s33,6
s_add_u32 s60,s60,s34
s_mul_i32 s60,s60,46080
s_add_u32 s60,s60,s37
s_add_u32 s60,s60,206569472
s_lshl_b32 s62,s46,10
s_add_u32 s62,s62,40960
s_add_u32 m0,s66,s62
s_add_u32 s63,s60,s62
buffer_load_dwordx4 v1,s[8:11],s63 offen sc1 lds
s_add_u32 m0,s66,45056
s_add_u32 s63,s60,45056
buffer_load_dwordx4 v1,s[8:11],s63 offen sc1 lds
s_mul_i32 s61,s46,10240
s_add_u32 s60,s60,s61
s_add_u32 s61,s61,s66
s_add_u32 m0,s61,0
s_add_u32 s63,s60,0
buffer_load_dwordx4 v1,s[8:11],s63 offen sc1 lds
buffer_load_dwordx4 v1,s[8:11],s63 offen offset:1024 sc1 lds
buffer_load_dwordx4 v1,s[8:11],s63 offen offset:2048 sc1 lds
buffer_load_dwordx4 v1,s[8:11],s63 offen offset:3072 sc1 lds
s_add_u32 m0,s61,4096
s_add_u32 s63,s60,4096
buffer_load_dwordx4 v1,s[8:11],s63 offen sc1 lds
buffer_load_dwordx4 v1,s[8:11],s63 offen offset:1024 sc1 lds
buffer_load_dwordx4 v1,s[8:11],s63 offen offset:2048 sc1 lds
buffer_load_dwordx4 v1,s[8:11],s63 offen offset:3072 sc1 lds
s_add_u32 m0,s61,8192
s_add_u32 s63,s60,8192
buffer_load_dwordx4 v1,s[8:11],s63 offen sc1 lds
buffer_load_dwordx4 v1,s[8:11],s63 offen offset:1024 sc1 lds
nt_234:
s_mov_b32 s39,0
s_mul_i32 s74,s73,393216
s_add_u32 s74,s74,s39
s_add_u32 s74,s74,s70
v_fma_f32 v56,-v176,v120,v56
v_fma_f32 v57,-v176,v121,v57
v_fma_f32 v58,-v176,v122,v58
v_fma_f32 v59,-v176,v123,v59
v_fma_f32 v60,-v176,v124,v60
v_fma_f32 v61,-v176,v125,v61
v_fma_f32 v62,-v176,v126,v62
v_fma_f32 v63,-v176,v127,v63
v_mul_f32 v56,v56,v177
v_mul_f32 v57,v57,v177
v_mul_f32 v58,v58,v177
v_mul_f32 v59,v59,v177
v_mul_f32 v60,v60,v177
v_mul_f32 v61,v61,v177
v_mul_f32 v62,v62,v177
v_mul_f32 v63,v63,v177
v_cvt_pk_bf16_f32 v180,v56,v57
v_cvt_pk_bf16_f32 v181,v58,v59
v_cvt_pk_bf16_f32 v182,v60,v61
v_cvt_pk_bf16_f32 v183,v62,v63
buffer_store_dwordx4 v[180:183],v20,s[8:11],s74 offen sc1
v_fma_f32 v64,-v176,v128,v64
v_fma_f32 v65,-v176,v129,v65
v_fma_f32 v66,-v176,v130,v66
v_fma_f32 v67,-v176,v131,v67
v_fma_f32 v68,-v176,v132,v68
v_fma_f32 v69,-v176,v133,v69
v_fma_f32 v70,-v176,v134,v70
v_fma_f32 v71,-v176,v135,v71
v_mul_f32 v64,v64,v177
v_mul_f32 v65,v65,v177
v_mul_f32 v66,v66,v177
v_mul_f32 v67,v67,v177
v_mul_f32 v68,v68,v177
v_mul_f32 v69,v69,v177
v_mul_f32 v70,v70,v177
v_mul_f32 v71,v71,v177
v_cvt_pk_bf16_f32 v184,v64,v65
v_cvt_pk_bf16_f32 v185,v66,v67
v_cvt_pk_bf16_f32 v186,v68,v69
v_cvt_pk_bf16_f32 v187,v70,v71
buffer_store_dwordx4 v[184:187],v21,s[8:11],s74 offen sc1
v_fma_f32 v72,-v176,v136,v72
v_fma_f32 v73,-v176,v137,v73
v_fma_f32 v74,-v176,v138,v74
v_fma_f32 v75,-v176,v139,v75
v_fma_f32 v76,-v176,v140,v76
v_fma_f32 v77,-v176,v141,v77
v_fma_f32 v78,-v176,v142,v78
v_fma_f32 v79,-v176,v143,v79
v_mul_f32 v72,v72,v177
v_mul_f32 v73,v73,v177
v_mul_f32 v74,v74,v177
v_mul_f32 v75,v75,v177
v_mul_f32 v76,v76,v177
v_mul_f32 v77,v77,v177
v_mul_f32 v78,v78,v177
v_mul_f32 v79,v79,v177
v_cvt_pk_bf16_f32 v180,v72,v73
v_cvt_pk_bf16_f32 v181,v74,v75
v_cvt_pk_bf16_f32 v182,v76,v77
v_cvt_pk_bf16_f32 v183,v78,v79
buffer_store_dwordx4 v[180:183],v20,s[8:11],s74 offen offset:2048 sc1
v_fma_f32 v80,-v176,v144,v80
v_fma_f32 v81,-v176,v145,v81
v_fma_f32 v82,-v176,v146,v82
v_fma_f32 v83,-v176,v147,v83
v_fma_f32 v84,-v176,v148,v84
v_fma_f32 v85,-v176,v149,v85
v_fma_f32 v86,-v176,v150,v86
v_fma_f32 v87,-v176,v151,v87
v_mul_f32 v80,v80,v177
v_mul_f32 v81,v81,v177
v_mul_f32 v82,v82,v177
v_mul_f32 v83,v83,v177
v_mul_f32 v84,v84,v177
v_mul_f32 v85,v85,v177
v_mul_f32 v86,v86,v177
v_mul_f32 v87,v87,v177
v_cvt_pk_bf16_f32 v184,v80,v81
v_cvt_pk_bf16_f32 v185,v82,v83
v_cvt_pk_bf16_f32 v186,v84,v85
v_cvt_pk_bf16_f32 v187,v86,v87
buffer_store_dwordx4 v[184:187],v21,s[8:11],s74 offen offset:2048 sc1
s_lshl_b32 s82,s72,6
s_add_u32 s82,s82,s73
s_lshl_b32 s82,s82,9
s_add_u32 s82,s82,s71
s_lshl_b32 s75,s69,2
s_add_u32 s82,s82,s75
s_add_u32 s82,s82,s39
s_mov_b32 s59,s82
s_mov_b32 s82,2147483648
s_mov_b32 s39,2147483648
s_add_u32 s50,s50,1
s_sub_u32 s57,46080,s57
s_mov_b32 s51,s53
s_mov_b32 s52,s54
s_mov_b32 s37,s38
s_cmp_eq_u32 s55,0
s_cbranch_scc1 QKVQ_B1
s_cmp_eq_u32 s55,1
s_cbranch_scc1 QKVQ_CD1
s_waitcnt vmcnt(0)
s_mov_b64 exec,1
buffer_store_dword v5,v1,s[8:11],s59 offen sc1
s_mov_b64 exec,-1
s_mov_b32 s59,2147483648
s_cmp_eq_u32 s50,128
s_cbranch_scc1 QKVQ_END
s_branch QKVQ_COLD1
QKVQ_COLD1:
s_cmp_lg_u32 s46,0
s_cbranch_scc1 cp_235
fb_236:
buffer_load_dword v3,v2,s[8:11],s35 offen sc1
s_waitcnt vmcnt(0)
v_cmp_eq_u32 vcc,0,v3
s_nop 0
s_cbranch_vccz ok_237
s_sleep 7
s_sub_u32 s47,s47,1
s_cbranch_scc1 ABORT
s_branch fb_236
ok_237:
cp_235:
s_barrier
s_lshl_b32 s60,s33,6
s_add_u32 s60,s60,s34
s_mul_i32 s60,s60,46080
s_add_u32 s60,s60,206569472
s_lshl_b32 s62,s46,10
s_add_u32 s62,s62,40960
s_add_u32 m0,s57,s62
s_add_u32 s63,s60,s62
buffer_load_dwordx4 v1,s[8:11],s63 offen sc1 lds
s_add_u32 m0,s57,45056
s_add_u32 s63,s60,45056
buffer_load_dwordx4 v1,s[8:11],s63 offen sc1 lds
s_mul_i32 s61,s46,10240
s_add_u32 s60,s60,s61
s_add_u32 s61,s61,s57
s_add_u32 m0,s61,0
s_add_u32 s63,s60,0
buffer_load_dwordx4 v1,s[8:11],s63 offen sc1 lds
buffer_load_dwordx4 v1,s[8:11],s63 offen offset:1024 sc1 lds
buffer_load_dwordx4 v1,s[8:11],s63 offen offset:2048 sc1 lds
buffer_load_dwordx4 v1,s[8:11],s63 offen offset:3072 sc1 lds
s_add_u32 m0,s61,4096
s_add_u32 s63,s60,4096
buffer_load_dwordx4 v1,s[8:11],s63 offen sc1 lds
buffer_load_dwordx4 v1,s[8:11],s63 offen offset:1024 sc1 lds
buffer_load_dwordx4 v1,s[8:11],s63 offen offset:2048 sc1 lds
buffer_load_dwordx4 v1,s[8:11],s63 offen offset:3072 sc1 lds
s_add_u32 m0,s61,8192
s_add_u32 s63,s60,8192
buffer_load_dwordx4 v1,s[8:11],s63 offen sc1 lds
buffer_load_dwordx4 v1,s[8:11],s63 offen offset:1024 sc1 lds
QKVQ_CD1:
s_mov_b32 s51,s33
s_mov_b32 s52,s34
s_add_u32 s32,s32,1
s_min_u32 s62,s32,127
s_sub_u32 s60,s62,20
s_lshr_b32 s34,s60,1
s_and_b32 s33,s60,1
s_xor_b32 s33,s33,1
s_cmp_eq_u32 s33,0
s_cselect_b32 s61,20,0
s_add_u32 s34,s34,s61
s_sub_u32 s61,s60,44
s_cmp_ge_u32 s60,88
s_cselect_b32 s34,s61,s34
s_cselect_b32 s33,1,s33
s_cmp_lt_u32 s62,20
s_cselect_b32 s34,s62,s34
s_cselect_b32 s33,0,s33
s_lshl_b32 s35,s33,6
s_add_u32 s35,s35,s34
s_lshl_b32 s35,s35,9
s_add_u32 s35,s35,0
s_lshl_b32 s60,s33,5
s_add_u32 s60,s60,7
v_min_u32 v2,s60,v0
v_lshlrev_b32 v2,2,v2
s_cmp_lg_u32 s46,0
s_cbranch_scc1 w0_238
buffer_load_dword v3,v2,s[8:11],s35 offen sc1
w0_238:
s_waitcnt vmcnt(0)
s_mov_b64 exec,1
buffer_store_dword v5,v1,s[8:11],s59 offen sc1
s_mov_b64 exec,-1
s_mov_b32 s59,2147483648
s_cmp_lg_u32 s46,0
s_cbranch_scc1 w0_239
v_cmp_eq_u32 vcc,0,v3
s_cmp_eq_u64 vcc,0
s_cselect_b32 s36,0,2147483648
s_cmp_lt_u32 s32,128
s_cselect_b32 s36,s36,2147483648
v_mov_b32 v23,s36
ds_write_b32 v22,v23
w0_239:
s_waitcnt lgkmcnt(0)
s_barrier
ds_read_b32 v23,v22
ds_read_b128 v[24:27],v18 offset:0
ds_read_b128 v[28:31],v19 offset:0
ds_read_b128 v[32:35],v18 offset:2048
ds_read_b128 v[36:39],v19 offset:2048
ds_read_b128 v[40:43],v18 offset:4096
s_waitcnt lgkmcnt(5)
v_readfirstlane_b32 s37,v23
s_nop 4
QKVQ_B1:
s_waitcnt lgkmcnt(3)
v_mfma_f32_32x32x16_bf16 v[88:103],a[0:3],v[24:27],0
ds_read_b128 v[44:47],v19 offset:4096
v_add_u32 v189,s57,v188
v_mfma_f32_32x32x16_bf16 v[104:119],a[160:163],v[24:27],0
v_add_u32 v8,0x800,v189
s_sub_u32 s66,46080,s57
s_lshl_b32 s60,s33,6
s_add_u32 s60,s60,s34
s_mul_i32 s60,s60,46080
s_add_u32 s60,s60,s37
v_mfma_f32_32x32x16_bf16 v[88:103],a[4:7],v[28:31],v[88:103]
ds_read_b128 v[48:51],v18 offset:6144
ds_read2_b64 v[156:159],v189 offset0:0 offset1:32
s_add_u32 s60,s60,206569472
s_lshl_b32 s62,s46,10
v_mfma_f32_32x32x16_bf16 v[104:119],a[164:167],v[28:31],v[104:119]
ds_read2_b64 v[160:163],v189 offset0:64 offset1:96
s_add_u32 s62,s62,40960
s_add_u32 m0,s66,s62
s_add_u32 s63,s60,s62
s_waitcnt lgkmcnt(5)
v_mfma_f32_32x32x16_bf16 v[88:103],a[8:11],v[32:35],v[88:103]
ds_read_b128 v[52:55],v19 offset:6144
ds_read2_b64 v[164:167],v189 offset0:128 offset1:160
buffer_load_dwordx4 v1,s[8:11],s63 offen sc1 lds
v_mfma_f32_32x32x16_bf16 v[104:119],a[168:171],v[32:35],v[104:119]
ds_read2_b64 v[168:171],v189 offset0:192 offset1:224
s_add_u32 m0,s66,45056
s_add_u32 s63,s60,45056
s_mul_i32 s74,s73,393216
s_add_u32 s74,s74,s39
v_mfma_f32_32x32x16_bf16 v[88:103],a[12:15],v[36:39],v[88:103]
ds_read_b128 v[24:27],v18 offset:8192
ds_read2_b64 v[172:175],v8 offset0:0 offset1:32
s_add_u32 s74,s74,s70
v_fma_f32 v56,-v176,v120,v56
v_mfma_f32_32x32x16_bf16 v[104:119],a[172:175],v[36:39],v[104:119]
buffer_load_dwordx4 v1,s[8:11],s63 offen sc1 lds
s_mul_i32 s61,s46,10240
s_add_u32 s60,s60,s61
s_add_u32 s61,s61,s66
s_waitcnt lgkmcnt(8)
v_mfma_f32_32x32x16_bf16 v[88:103],a[16:19],v[40:43],v[88:103]
ds_read_b128 v[28:31],v19 offset:8192
s_add_u32 m0,s61,0
s_add_u32 s63,s60,0
v_fma_f32 v57,-v176,v121,v57
v_fma_f32 v58,-v176,v122,v58
v_mfma_f32_32x32x16_bf16 v[104:119],a[176:179],v[40:43],v[104:119]
v_fma_f32 v59,-v176,v123,v59
v_fma_f32 v60,-v176,v124,v60
v_fma_f32 v61,-v176,v125,v61
v_fma_f32 v62,-v176,v126,v62
v_fma_f32 v63,-v176,v127,v63
v_mul_f32 v56,v56,v177
v_mfma_f32_32x32x16_bf16 v[88:103],a[20:23],v[44:47],v[88:103]
ds_read_b128 v[32:35],v18 offset:10240
buffer_load_dwordx4 v1,s[8:11],s63 offen sc1 lds
v_mul_f32 v57,v57,v177
v_mul_f32 v58,v58,v177
v_mfma_f32_32x32x16_bf16 v[104:119],a[180:183],v[44:47],v[104:119]
v_mul_f32 v59,v59,v177
v_mul_f32 v60,v60,v177
v_mul_f32 v61,v61,v177
v_mul_f32 v62,v62,v177
v_mul_f32 v63,v63,v177
s_waitcnt lgkmcnt(6)
v_mfma_f32_32x32x16_bf16 v[88:103],a[24:27],v[48:51],v[88:103]
ds_read_b128 v[36:39],v19 offset:10240
v_cvt_pk_bf16_f32 v180,v56,v57
v_cvt_pk_bf16_f32 v181,v58,v59
v_cvt_pk_bf16_f32 v182,v60,v61
v_cvt_pk_bf16_f32 v183,v62,v63
v_mfma_f32_32x32x16_bf16 v[104:119],a[184:187],v[48:51],v[104:119]
buffer_load_dwordx4 v1,s[8:11],s63 offen offset:1024 sc1 lds
buffer_store_dwordx4 v[180:183],v20,s[8:11],s74 offen sc1
v_fma_f32 v64,-v176,v128,v64
v_fma_f32 v65,-v176,v129,v65
v_mfma_f32_32x32x16_bf16 v[88:103],a[28:31],v[52:55],v[88:103]
ds_read_b128 v[40:43],v18 offset:12288
v_fma_f32 v66,-v176,v130,v66
v_fma_f32 v67,-v176,v131,v67
v_fma_f32 v68,-v176,v132,v68
v_fma_f32 v69,-v176,v133,v69
v_mfma_f32_32x32x16_bf16 v[104:119],a[188:191],v[52:55],v[104:119]
v_fma_f32 v70,-v176,v134,v70
v_fma_f32 v71,-v176,v135,v71
v_mul_f32 v64,v64,v177
v_mul_f32 v65,v65,v177
v_mul_f32 v66,v66,v177
s_waitcnt lgkmcnt(3)
v_mfma_f32_32x32x16_bf16 v[88:103],a[32:35],v[24:27],v[88:103]
ds_read_b128 v[44:47],v19 offset:12288
buffer_load_dwordx4 v1,s[8:11],s63 offen offset:2048 sc1 lds
v_mul_f32 v67,v67,v177
v_mul_f32 v68,v68,v177
v_mfma_f32_32x32x16_bf16 v[104:119],a[192:195],v[24:27],v[104:119]
v_mul_f32 v69,v69,v177
v_mul_f32 v70,v70,v177
v_mul_f32 v71,v71,v177
v_cvt_pk_bf16_f32 v184,v64,v65
v_cvt_pk_bf16_f32 v185,v66,v67
v_cvt_pk_bf16_f32 v186,v68,v69
v_mfma_f32_32x32x16_bf16 v[88:103],a[36:39],v[28:31],v[88:103]
ds_read_b128 v[48:51],v18 offset:14336
v_cvt_pk_bf16_f32 v187,v70,v71
buffer_store_dwordx4 v[184:187],v21,s[8:11],s74 offen sc1
v_fma_f32 v72,-v176,v136,v72
v_mfma_f32_32x32x16_bf16 v[104:119],a[196:199],v[28:31],v[104:119]
buffer_load_dwordx4 v1,s[8:11],s63 offen offset:3072 sc1 lds
s_add_u32 m0,s61,4096
s_add_u32 s63,s60,4096
v_fma_f32 v73,-v176,v137,v73
s_waitcnt lgkmcnt(3)
v_mfma_f32_32x32x16_bf16 v[88:103],a[40:43],v[32:35],v[88:103]
ds_read_b128 v[52:55],v19 offset:14336
v_fma_f32 v74,-v176,v138,v74
v_fma_f32 v75,-v176,v139,v75
v_fma_f32 v76,-v176,v140,v76
v_fma_f32 v77,-v176,v141,v77
v_mfma_f32_32x32x16_bf16 v[104:119],a[200:203],v[32:35],v[104:119]
v_fma_f32 v78,-v176,v142,v78
v_fma_f32 v79,-v176,v143,v79
v_mul_f32 v72,v72,v177
v_mul_f32 v73,v73,v177
v_mul_f32 v74,v74,v177
v_mul_f32 v75,v75,v177
v_mfma_f32_32x32x16_bf16 v[88:103],a[44:47],v[36:39],v[88:103]
ds_read_b128 v[24:27],v18 offset:16384
buffer_load_dwordx4 v1,s[8:11],s63 offen sc1 lds
v_mul_f32 v76,v76,v177
v_mul_f32 v77,v77,v177
v_mfma_f32_32x32x16_bf16 v[104:119],a[204:207],v[36:39],v[104:119]
v_mul_f32 v78,v78,v177
v_mul_f32 v79,v79,v177
v_cvt_pk_bf16_f32 v180,v72,v73
v_cvt_pk_bf16_f32 v181,v74,v75
v_cvt_pk_bf16_f32 v182,v76,v77
s_waitcnt lgkmcnt(3)
v_mfma_f32_32x32x16_bf16 v[88:103],a[48:51],v[40:43],v[88:103]
ds_read_b128 v[28:31],v19 offset:16384
v_cvt_pk_bf16_f32 v183,v78,v79
buffer_store_dwordx4 v[180:183],v20,s[8:11],s74 offen offset:2048 sc1
v_fma_f32 v80,-v176,v144,v80
v_mfma_f32_32x32x16_bf16 v[104:119],a[208:211],v[40:43],v[104:119]
buffer_load_dwordx4 v1,s[8:11],s63 offen offset:1024 sc1 lds
v_fma_f32 v81,-v176,v145,v81
v_fma_f32 v82,-v176,v146,v82
v_fma_f32 v83,-v176,v147,v83
v_fma_f32 v84,-v176,v148,v84
v_mfma_f32_32x32x16_bf16 v[88:103],a[52:55],v[44:47],v[88:103]
ds_read_b128 v[32:35],v18 offset:18432
v_fma_f32 v85,-v176,v149,v85
v_fma_f32 v86,-v176,v150,v86
v_fma_f32 v87,-v176,v151,v87
v_mul_f32 v80,v80,v177
v_mfma_f32_32x32x16_bf16 v[104:119],a[212:215],v[44:47],v[104:119]
v_mul_f32 v81,v81,v177
v_mul_f32 v82,v82,v177
v_mul_f32 v83,v83,v177
v_mul_f32 v84,v84,v177
v_mul_f32 v85,v85,v177
s_waitcnt lgkmcnt(3)
v_mfma_f32_32x32x16_bf16 v[88:103],a[56:59],v[48:51],v[88:103]
ds_read_b128 v[36:39],v19 offset:18432
buffer_load_dwordx4 v1,s[8:11],s63 offen offset:2048 sc1 lds
v_mul_f32 v86,v86,v177
v_mul_f32 v87,v87,v177
v_mfma_f32_32x32x16_bf16 v[104:119],a[216:219],v[48:51],v[104:119]
v_cvt_pk_bf16_f32 v184,v80,v81
v_cvt_pk_bf16_f32 v185,v82,v83
v_cvt_pk_bf16_f32 v186,v84,v85
v_cvt_pk_bf16_f32 v187,v86,v87
buffer_store_dwordx4 v[184:187],v21,s[8:11],s74 offen offset:2048 sc1
v_mfma_f32_32x32x16_bf16 v[88:103],a[60:63],v[52:55],v[88:103]
ds_read_b128 v[40:43],v18 offset:20480
s_waitcnt vmcnt(13)
s_mov_b64 exec,1
buffer_store_dword v5,v1,s[8:11],s59 offen sc1
s_mov_b64 exec,-1
s_mov_b32 s59,2147483648
v_mfma_f32_32x32x16_bf16 v[104:119],a[220:223],v[52:55],v[104:119]
buffer_load_dwordx4 v1,s[8:11],s63 offen offset:3072 sc1 lds
s_add_u32 m0,s61,8192
s_add_u32 s63,s60,8192
s_lshl_b32 s82,s72,6
s_waitcnt lgkmcnt(3)
v_mfma_f32_32x32x16_bf16 v[88:103],a[64:67],v[24:27],v[88:103]
ds_read_b128 v[44:47],v19 offset:20480
s_add_u32 s82,s82,s73
s_lshl_b32 s82,s82,9
s_add_u32 s82,s82,s71
s_lshl_b32 s75,s69,2
v_mfma_f32_32x32x16_bf16 v[104:119],a[224:227],v[24:27],v[104:119]
s_add_u32 s82,s82,s75
s_add_u32 s82,s82,s39
v_pk_add_f32 v[156:157],v[156:157],v[166:167]
v_mfma_f32_32x32x16_bf16 v[88:103],a[68:71],v[28:31],v[88:103]
ds_read_b128 v[48:51],v18 offset:22528
buffer_load_dwordx4 v1,s[8:11],s63 offen sc1 lds
v_pk_add_f32 v[158:159],v[158:159],v[168:169]
v_mfma_f32_32x32x16_bf16 v[104:119],a[228:231],v[28:31],v[104:119]
v_pk_add_f32 v[160:161],v[160:161],v[170:171]
v_pk_add_f32 v[162:163],v[162:163],v[172:173]
s_waitcnt lgkmcnt(3)
v_mfma_f32_32x32x16_bf16 v[88:103],a[72:75],v[32:35],v[88:103]
ds_read_b128 v[52:55],v19 offset:22528
v_pk_add_f32 v[164:165],v[164:165],v[174:175]
v_pk_add_f32 v[156:157],v[156:157],v[158:159]
v_mfma_f32_32x32x16_bf16 v[104:119],a[232:235],v[32:35],v[104:119]
buffer_load_dwordx4 v1,s[8:11],s63 offen offset:1024 sc1 lds
s_mov_b32 s53,s33
s_mov_b32 s54,s34
s_cmp_eq_u32 s37,0
s_addc_u32 s32,s32,0
v_mfma_f32_32x32x16_bf16 v[88:103],a[76:79],v[36:39],v[88:103]
ds_read_b128 v[24:27],v18 offset:24576
s_min_u32 s62,s32,127
s_sub_u32 s60,s62,20
s_lshr_b32 s34,s60,1
s_and_b32 s33,s60,1
v_mfma_f32_32x32x16_bf16 v[104:119],a[236:239],v[36:39],v[104:119]
s_xor_b32 s33,s33,1
s_cmp_eq_u32 s33,0
s_cselect_b32 s61,20,0
s_add_u32 s34,s34,s61
s_sub_u32 s61,s60,44
s_waitcnt lgkmcnt(3)
v_mfma_f32_32x32x16_bf16 v[88:103],a[80:83],v[40:43],v[88:103]
ds_read_b128 v[28:31],v19 offset:24576
s_cmp_ge_u32 s60,88
s_cselect_b32 s34,s61,s34
s_cselect_b32 s33,1,s33
v_mfma_f32_32x32x16_bf16 v[104:119],a[240:243],v[40:43],v[104:119]
s_cmp_lt_u32 s62,20
s_cselect_b32 s34,s62,s34
s_cselect_b32 s33,0,s33
s_lshl_b32 s35,s33,6
s_add_u32 s35,s35,s34
s_lshl_b32 s35,s35,9
v_mfma_f32_32x32x16_bf16 v[88:103],a[84:87],v[44:47],v[88:103]
ds_read_b128 v[32:35],v18 offset:26624
s_add_u32 s35,s35,0
s_lshl_b32 s60,s33,5
s_add_u32 s60,s60,7
v_min_u32 v2,s60,v0
v_mfma_f32_32x32x16_bf16 v[104:119],a[244:247],v[44:47],v[104:119]
v_lshlrev_b32 v2,2,v2
v_pk_add_f32 v[160:161],v[160:161],v[162:163]
v_pk_add_f32 v[156:157],v[156:157],v[160:161]
s_waitcnt lgkmcnt(3)
v_mfma_f32_32x32x16_bf16 v[88:103],a[88:91],v[48:51],v[88:103]
ds_read_b128 v[36:39],v19 offset:26624
s_cmp_lg_u32 s46,0
s_cbranch_scc1 w0_240
buffer_load_dword v3,v2,s[8:11],s35 offen sc1
w0_240:
v_mfma_f32_32x32x16_bf16 v[104:119],a[248:251],v[48:51],v[104:119]
v_pk_add_f32 v[156:157],v[156:157],v[164:165]
v_mov_b32 v158,v156
v_mov_b32 v159,v157
s_nop 0
v_permlane32_swap_b32 v156,v158
v_permlane32_swap_b32 v157,v159
v_mfma_f32_32x32x16_bf16 v[88:103],a[92:95],v[52:55],v[88:103]
ds_read_b128 v[40:43],v18 offset:28672
v_add_f32 v176,v156,v158
v_add_f32 v177,v157,v159
v_mul_f32 v176,0x3acccccd,v176
v_mul_f32 v177,0x3acccccd,v177
v_mfma_f32_32x32x16_bf16 v[104:119],a[252:255],v[52:55],v[104:119]
v_fma_f32 v177,-v176,v176,v177
v_max_f32 v177,0,v177
v_cvt_pk_bf16_f32 v8,v176,v177
v_lshlrev_b32 v176,16,v8
v_and_b32 v177,0xffff0000,v8
s_waitcnt lgkmcnt(3)
v_mfma_f32_32x32x16_bf16 v[88:103],a[96:99],v[24:27],v[88:103]
ds_read_b128 v[44:47],v19 offset:28672
v_add_f32 v177,0x3727c5ac,v177
v_cvt_pk_bf16_f32 v8,v177,v177
v_lshlrev_b32 v177,16,v8
v_mfma_f32_32x32x16_bf16 v[104:119],v[192:195],v[24:27],v[104:119]
v_sqrt_f32 v177,v177
s_nop 0
v_cvt_pk_bf16_f32 v8,v177,v177
v_lshlrev_b32 v177,16,v8
v_rcp_f32 v177,v177
v_mfma_f32_32x32x16_bf16 v[88:103],a[100:103],v[28:31],v[88:103]
ds_read_b128 v[48:51],v18 offset:30720
s_cmp_eq_u32 s51,0
s_cselect_b64 s[76:77],-1,0
v_cndmask_b32 v176,v176,0,s[76:77]
v_cndmask_b32 v177,v177,1.0,s[76:77]
v_mfma_f32_32x32x16_bf16 v[104:119],v[196:199],v[28:31],v[104:119]
s_mov_b32 s72,s51
s_mov_b32 s73,s52
s_waitcnt lgkmcnt(3)
v_mfma_f32_32x32x16_bf16 v[88:103],a[104:107],v[32:35],v[88:103]
ds_read_b128 v[52:55],v19 offset:30720
v_mfma_f32_32x32x16_bf16 v[104:119],v[200:203],v[32:35],v[104:119]
v_mfma_f32_32x32x16_bf16 v[88:103],a[108:111],v[36:39],v[88:103]
ds_read_b128 v[24:27],v18 offset:32768
v_mfma_f32_32x32x16_bf16 v[104:119],v[204:207],v[36:39],v[104:119]
s_waitcnt lgkmcnt(3)
v_mfma_f32_32x32x16_bf16 v[88:103],a[112:115],v[40:43],v[88:103]
ds_read_b128 v[28:31],v19 offset:32768
v_mfma_f32_32x32x16_bf16 v[104:119],v[208:211],v[40:43],v[104:119]
v_mfma_f32_32x32x16_bf16 v[88:103],a[116:119],v[44:47],v[88:103]
ds_read_b128 v[32:35],v18 offset:34816
v_mfma_f32_32x32x16_bf16 v[104:119],v[212:215],v[44:47],v[104:119]
s_waitcnt lgkmcnt(3)
v_mfma_f32_32x32x16_bf16 v[88:103],a[120:123],v[48:51],v[88:103]
ds_read_b128 v[36:39],v19 offset:34816
v_mfma_f32_32x32x16_bf16 v[104:119],v[216:219],v[48:51],v[104:119]
v_mfma_f32_32x32x16_bf16 v[88:103],a[124:127],v[52:55],v[88:103]
ds_read_b128 v[40:43],v18 offset:36864
v_mfma_f32_32x32x16_bf16 v[104:119],v[220:223],v[52:55],v[104:119]
s_waitcnt vmcnt(0)
s_cmp_lg_u32 s46,0
s_cbranch_scc1 w0_241
v_cmp_eq_u32 vcc,0,v3
s_cmp_eq_u64 vcc,0
s_cselect_b32 s36,0,2147483648
s_cmp_lt_u32 s32,128
s_cselect_b32 s36,s36,2147483648
v_mov_b32 v23,s36
ds_write_b32 v22,v23
w0_241:
s_waitcnt lgkmcnt(3)
v_mfma_f32_32x32x16_bf16 v[88:103],a[128:131],v[24:27],v[88:103]
ds_read_b128 v[44:47],v19 offset:36864
s_mov_b64 exec,1
buffer_store_dword v5,v1,s[8:11],s82 offen sc1
s_mov_b64 exec,-1
s_mov_b32 s82,2147483648
v_mfma_f32_32x32x16_bf16 v[104:119],v[224:227],v[24:27],v[104:119]
v_mfma_f32_32x32x16_bf16 v[88:103],a[132:135],v[28:31],v[88:103]
ds_read_b128 v[48:51],v18 offset:38912
v_mfma_f32_32x32x16_bf16 v[104:119],v[228:231],v[28:31],v[104:119]
s_waitcnt lgkmcnt(3)
v_mfma_f32_32x32x16_bf16 v[88:103],a[136:139],v[32:35],v[88:103]
ds_read_b128 v[52:55],v19 offset:38912
v_mfma_f32_32x32x16_bf16 v[104:119],v[232:235],v[32:35],v[104:119]
s_waitcnt lgkmcnt(2)
s_barrier
ds_read_b32 v23,v22
v_mfma_f32_32x32x16_bf16 v[88:103],a[140:143],v[36:39],v[88:103]
ds_read_b128 v[24:27],v16 offset:0
v_mfma_f32_32x32x16_bf16 v[104:119],v[236:239],v[36:39],v[104:119]
v_mfma_f32_32x32x16_bf16 v[88:103],a[144:147],v[40:43],v[88:103]
ds_read_b128 v[28:31],v17 offset:0
v_mfma_f32_32x32x16_bf16 v[104:119],v[240:243],v[40:43],v[104:119]
v_mfma_f32_32x32x16_bf16 v[88:103],a[148:151],v[44:47],v[88:103]
ds_read_b128 v[32:35],v16 offset:2048
v_mfma_f32_32x32x16_bf16 v[104:119],v[244:247],v[44:47],v[104:119]
s_waitcnt lgkmcnt(4)
v_mfma_f32_32x32x16_bf16 v[88:103],a[152:155],v[48:51],v[88:103]
ds_read_b128 v[36:39],v17 offset:2048
s_waitcnt lgkmcnt(4)
v_readfirstlane_b32 s38,v23
v_mfma_f32_32x32x16_bf16 v[104:119],v[248:251],v[48:51],v[104:119]
v_mfma_f32_32x32x16_bf16 v[88:103],a[156:159],v[52:55],v[88:103]
ds_read_b128 v[40:43],v16 offset:4096
v_mfma_f32_32x32x16_bf16 v[104:119],v[252:255],v[52:55],v[104:119]
s_cmp_lg_u32 s37,0
s_cbranch_scc1 nf_242
s_cmp_lt_u32 s50,2
s_cbranch_scc1 now_243
s_mov_b32 s39,0
s_add_u32 s50,s50,1
s_sub_u32 s57,46080,s57
s_mov_b32 s51,s53
s_mov_b32 s52,s54
s_mov_b32 s37,s38
s_branch QKVQ_B0
s_nop 0
now_243:
s_mov_b32 s55,0
s_branch nt_244
nf_242:
s_mov_b32 s55,2
s_cmp_lg_u32 s38,0
s_cbranch_scc1 nt_244
s_mov_b32 s55,1
s_mov_b32 s37,0
s_sub_u32 s66,46080,s57
s_lshl_b32 s60,s33,6
s_add_u32 s60,s60,s34
s_mul_i32 s60,s60,46080
s_add_u32 s60,s60,s37
s_add_u32 s60,s60,206569472
s_lshl_b32 s62,s46,10
s_add_u32 s62,s62,40960
s_add_u32 m0,s66,s62
s_add_u32 s63,s60,s62
buffer_load_dwordx4 v1,s[8:11],s63 offen sc1 lds
s_add_u32 m0,s66,45056
s_add_u32 s63,s60,45056
buffer_load_dwordx4 v1,s[8:11],s63 offen sc1 lds
s_mul_i32 s61,s46,10240
s_add_u32 s60,s60,s61
s_add_u32 s61,s61,s66
s_add_u32 m0,s61,0
s_add_u32 s63,s60,0
buffer_load_dwordx4 v1,s[8:11],s63 offen sc1 lds
buffer_load_dwordx4 v1,s[8:11],s63 offen offset:1024 sc1 lds
buffer_load_dwordx4 v1,s[8:11],s63 offen offset:2048 sc1 lds
buffer_load_dwordx4 v1,s[8:11],s63 offen offset:3072 sc1 lds
s_add_u32 m0,s61,4096
s_add_u32 s63,s60,4096
buffer_load_dwordx4 v1,s[8:11],s63 offen sc1 lds
buffer_load_dwordx4 v1,s[8:11],s63 offen offset:1024 sc1 lds
buffer_load_dwordx4 v1,s[8:11],s63 offen offset:2048 sc1 lds
buffer_load_dwordx4 v1,s[8:11],s63 offen offset:3072 sc1 lds
s_add_u32 m0,s61,8192
s_add_u32 s63,s60,8192
buffer_load_dwordx4 v1,s[8:11],s63 offen sc1 lds
buffer_load_dwordx4 v1,s[8:11],s63 offen offset:1024 sc1 lds
nt_244:
s_mov_b32 s39,0
s_mul_i32 s74,s73,393216
s_add_u32 s74,s74,s39
s_add_u32 s74,s74,s70
v_fma_f32 v88,-v176,v120,v88
v_fma_f32 v89,-v176,v121,v89
v_fma_f32 v90,-v176,v122,v90
v_fma_f32 v91,-v176,v123,v91
v_fma_f32 v92,-v176,v124,v92
v_fma_f32 v93,-v176,v125,v93
v_fma_f32 v94,-v176,v126,v94
v_fma_f32 v95,-v176,v127,v95
v_mul_f32 v88,v88,v177
v_mul_f32 v89,v89,v177
v_mul_f32 v90,v90,v177
v_mul_f32 v91,v91,v177
v_mul_f32 v92,v92,v177
v_mul_f32 v93,v93,v177
v_mul_f32 v94,v94,v177
v_mul_f32 v95,v95,v177
v_cvt_pk_bf16_f32 v180,v88,v89
v_cvt_pk_bf16_f32 v181,v90,v91
v_cvt_pk_bf16_f32 v182,v92,v93
v_cvt_pk_bf16_f32 v183,v94,v95
buffer_store_dwordx4 v[180:183],v20,s[8:11],s74 offen sc1
v_fma_f32 v96,-v176,v128,v96
v_fma_f32 v97,-v176,v129,v97
v_fma_f32 v98,-v176,v130,v98
v_fma_f32 v99,-v176,v131,v99
v_fma_f32 v100,-v176,v132,v100
v_fma_f32 v101,-v176,v133,v101
v_fma_f32 v102,-v176,v134,v102
v_fma_f32 v103,-v176,v135,v103
v_mul_f32 v96,v96,v177
v_mul_f32 v97,v97,v177
v_mul_f32 v98,v98,v177
v_mul_f32 v99,v99,v177
v_mul_f32 v100,v100,v177
v_mul_f32 v101,v101,v177
v_mul_f32 v102,v102,v177
v_mul_f32 v103,v103,v177
v_cvt_pk_bf16_f32 v184,v96,v97
v_cvt_pk_bf16_f32 v185,v98,v99
v_cvt_pk_bf16_f32 v186,v100,v101
v_cvt_pk_bf16_f32 v187,v102,v103
buffer_store_dwordx4 v[184:187],v21,s[8:11],s74 offen sc1
v_fma_f32 v104,-v176,v136,v104
v_fma_f32 v105,-v176,v137,v105
v_fma_f32 v106,-v176,v138,v106
v_fma_f32 v107,-v176,v139,v107
v_fma_f32 v108,-v176,v140,v108
v_fma_f32 v109,-v176,v141,v109
v_fma_f32 v110,-v176,v142,v110
v_fma_f32 v111,-v176,v143,v111
v_mul_f32 v104,v104,v177
v_mul_f32 v105,v105,v177
v_mul_f32 v106,v106,v177
v_mul_f32 v107,v107,v177
v_mul_f32 v108,v108,v177
v_mul_f32 v109,v109,v177
v_mul_f32 v110,v110,v177
v_mul_f32 v111,v111,v177
v_cvt_pk_bf16_f32 v180,v104,v105
v_cvt_pk_bf16_f32 v181,v106,v107
v_cvt_pk_bf16_f32 v182,v108,v109
v_cvt_pk_bf16_f32 v183,v110,v111
buffer_store_dwordx4 v[180:183],v20,s[8:11],s74 offen offset:2048 sc1
v_fma_f32 v112,-v176,v144,v112
v_fma_f32 v113,-v176,v145,v113
v_fma_f32 v114,-v176,v146,v114
v_fma_f32 v115,-v176,v147,v115
v_fma_f32 v116,-v176,v148,v116
v_fma_f32 v117,-v176,v149,v117
v_fma_f32 v118,-v176,v150,v118
v_fma_f32 v119,-v176,v151,v119
v_mul_f32 v112,v112,v177
v_mul_f32 v113,v113,v177
v_mul_f32 v114,v114,v177
v_mul_f32 v115,v115,v177
v_mul_f32 v116,v116,v177
v_mul_f32 v117,v117,v177
v_mul_f32 v118,v118,v177
v_mul_f32 v119,v119,v177
v_cvt_pk_bf16_f32 v184,v112,v113
v_cvt_pk_bf16_f32 v185,v114,v115
v_cvt_pk_bf16_f32 v186,v116,v117
v_cvt_pk_bf16_f32 v187,v118,v119
buffer_store_dwordx4 v[184:187],v21,s[8:11],s74 offen offset:2048 sc1
s_lshl_b32 s82,s72,6
s_add_u32 s82,s82,s73
s_lshl_b32 s82,s82,9
s_add_u32 s82,s82,s71
s_lshl_b32 s75,s69,2
s_add_u32 s82,s82,s75
s_add_u32 s82,s82,s39
s_mov_b32 s59,s82
s_mov_b32 s82,2147483648
s_mov_b32 s39,2147483648
s_add_u32 s50,s50,1
s_sub_u32 s57,46080,s57
s_mov_b32 s51,s53
s_mov_b32 s52,s54
s_mov_b32 s37,s38
s_cmp_eq_u32 s55,0
s_cbranch_scc1 QKVQ_B0
s_cmp_eq_u32 s55,1
s_cbranch_scc1 QKVQ_CD0
s_waitcnt vmcnt(0)
s_mov_b64 exec,1
buffer_store_dword v5,v1,s[8:11],s59 offen sc1
s_mov_b64 exec,-1
s_mov_b32 s59,2147483648
s_cmp_eq_u32 s50,128
s_cbranch_scc1 QKVQ_END
s_branch QKVQ_COLD0
QKVQ_END:
s_endpgm
ROLE_QKVV:
v_lshlrev_b32 v1,4,v0
v_mov_b32 v5,1
s_lshl_b32 s56,s48,2
s_add_u32 s56,s56,s46
v_bfe_u32 v6,v0,2,2
v_lshrrev_b32 v7,4,v0
v_add_u32 v7,v6,v7
v_and_b32 v7,3,v7
v_and_b32 v15,3,v0
v_lshlrev_b32 v15,4,v15
v_lshl_add_u32 v15,v7,6,v15
v_lshl_add_u32 v15,v6,8,v15
v_lshrrev_b32 v6,5,v0
v_bfe_u32 v7,v0,4,1
v_lshlrev_b32 v16,10,v7
v_bfe_u32 v7,v0,2,2
v_lshl_add_u32 v16,v7,8,v16
v_add_u32 v6,v6,v7
v_and_b32 v6,3,v6
v_lshl_add_u32 v16,v6,6,v16
v_and_b32 v6,3,v0
v_lshl_add_u32 v16,v6,4,v16
v_add_u32 v18,46080,v16
v_lshrrev_b32 v6,5,v0
v_bfe_u32 v7,v0,4,1
v_lshlrev_b32 v20,10,v7
v_lshl_add_u32 v20,v6,8,v20
v_and_b32 v6,15,v0
v_lshl_add_u32 v20,v6,4,v20
v_lshrrev_b32 v6,5,v0
v_add_u32 v6,2,v6
v_bfe_u32 v7,v0,4,1
v_lshlrev_b32 v17,10,v7
v_bfe_u32 v7,v0,2,2
v_lshl_add_u32 v17,v7,8,v17
v_add_u32 v6,v6,v7
v_and_b32 v6,3,v6
v_lshl_add_u32 v17,v6,6,v17
v_and_b32 v6,3,v0
v_lshl_add_u32 v17,v6,4,v17
v_add_u32 v19,46080,v17
v_lshrrev_b32 v6,5,v0
v_add_u32 v6,2,v6
v_bfe_u32 v7,v0,4,1
v_lshlrev_b32 v21,10,v7
v_lshl_add_u32 v21,v6,8,v21
v_and_b32 v6,15,v0
v_lshl_add_u32 v21,v6,4,v21
s_mov_b32 s69,s56
s_mov_b32 s70,99614720
s_mov_b32 s71,196608
s_lshl_b32 s60,s69,12
s_add_u32 s70,s70,s60
v_lshrrev_b32 v6,5,v0
v_mul_u32_u24 v188,2560,v6
v_and_b32 v6,31,v0
v_lshl_add_u32 v188,v6,3,v188
v_add_u32 v188,0xa000,v188
v_min_u32 v12,7,v0
v_lshlrev_b32 v12,2,v12
v_min_u32 v13,39,v0
v_lshlrev_b32 v13,2,v13
v_mov_b32 v14,93184
s_lshl_b32 s60,s46,8
s_add_u32 s60,s60,92160
v_and_b32 v6,31,v0
v_lshlrev_b32 v190,3,v6
v_add_u32 v190,s60,v190
v_lshrrev_b32 v6,5,v0
v_lshlrev_b32 v191,5,v6
v_add_u32 v191,s60,v191
s_waitcnt vmcnt(0)
s_barrier
s_cmp_lg_u32 s46,0
s_cbranch_scc1 arr_245
v_mov_b32 v6,1
s_lshl_b32 s3,s49,2
v_mov_b32 v7,s3
s_mov_b64 exec,1
buffer_atomic_add v6,v7,s[12:15],0 offen sc1
s_mov_b64 exec,-1
arr_245:
s_lshl_b32 s58,s69,7
s_mul_i32 s63,s46,40960
s_mov_b32 s4,s24
s_mov_b32 s5,s25
s_mov_b32 s6,7864320
s_mov_b32 s7,0x20000
v_lshrrev_b32 v9,3,v0
s_mov_b32 s64,12288
v_mul_lo_u32 v9,v9,s64
v_and_b32 v10,7,v0
v_lshl_add_u32 v6,v10,4,v9
s_add_u32 m0,s63,0
s_add_u32 s65,s58,0
buffer_load_dwordx4 v6,s[4:7],s65 offen lds
s_add_u32 m0,s63,1024
s_add_u32 s65,s58,98304
buffer_load_dwordx4 v6,s[4:7],s65 offen lds
s_add_u32 m0,s63,2048
s_add_u32 s65,s58,196608
buffer_load_dwordx4 v6,s[4:7],s65 offen lds
s_add_u32 m0,s63,3072
s_add_u32 s65,s58,294912
buffer_load_dwordx4 v6,s[4:7],s65 offen lds
s_add_u32 m0,s63,4096
s_add_u32 s65,s58,393216
buffer_load_dwordx4 v6,s[4:7],s65 offen lds
s_add_u32 m0,s63,5120
s_add_u32 s65,s58,491520
buffer_load_dwordx4 v6,s[4:7],s65 offen lds
s_add_u32 m0,s63,6144
s_add_u32 s65,s58,589824
buffer_load_dwordx4 v6,s[4:7],s65 offen lds
s_add_u32 m0,s63,7168
s_add_u32 s65,s58,688128
buffer_load_dwordx4 v6,s[4:7],s65 offen lds
s_add_u32 m0,s63,8192
s_add_u32 s65,s58,786432
buffer_load_dwordx4 v6,s[4:7],s65 offen lds
s_add_u32 m0,s63,9216
s_add_u32 s65,s58,884736
buffer_load_dwordx4 v6,s[4:7],s65 offen lds
s_add_u32 m0,s63,10240
s_add_u32 s65,s58,983040
buffer_load_dwordx4 v6,s[4:7],s65 offen lds
s_add_u32 m0,s63,11264
s_add_u32 s65,s58,1081344
buffer_load_dwordx4 v6,s[4:7],s65 offen lds
s_add_u32 m0,s63,12288
s_add_u32 s65,s58,1179648
buffer_load_dwordx4 v6,s[4:7],s65 offen lds
s_add_u32 m0,s63,13312
s_add_u32 s65,s58,1277952
buffer_load_dwordx4 v6,s[4:7],s65 offen lds
s_add_u32 m0,s63,14336
s_add_u32 s65,s58,1376256
buffer_load_dwordx4 v6,s[4:7],s65 offen lds
s_add_u32 m0,s63,15360
s_add_u32 s65,s58,1474560
buffer_load_dwordx4 v6,s[4:7],s65 offen lds
s_add_u32 m0,s63,16384
s_add_u32 s65,s58,1572864
buffer_load_dwordx4 v6,s[4:7],s65 offen lds
s_add_u32 m0,s63,17408
s_add_u32 s65,s58,1671168
buffer_load_dwordx4 v6,s[4:7],s65 offen lds
s_add_u32 m0,s63,18432
s_add_u32 s65,s58,1769472
buffer_load_dwordx4 v6,s[4:7],s65 offen lds
s_add_u32 m0,s63,19456
s_add_u32 s65,s58,1867776
buffer_load_dwordx4 v6,s[4:7],s65 offen lds
s_add_u32 m0,s63,20480
s_add_u32 s65,s58,1966080
buffer_load_dwordx4 v6,s[4:7],s65 offen lds
s_add_u32 m0,s63,21504
s_add_u32 s65,s58,2064384
buffer_load_dwordx4 v6,s[4:7],s65 offen lds
s_add_u32 m0,s63,22528
s_add_u32 s65,s58,2162688
buffer_load_dwordx4 v6,s[4:7],s65 offen lds
s_add_u32 m0,s63,23552
s_add_u32 s65,s58,2260992
buffer_load_dwordx4 v6,s[4:7],s65 offen lds
s_add_u32 m0,s63,24576
s_add_u32 s65,s58,2359296
buffer_load_dwordx4 v6,s[4:7],s65 offen lds
s_add_u32 m0,s63,25600
s_add_u32 s65,s58,2457600
buffer_load_dwordx4 v6,s[4:7],s65 offen lds
s_add_u32 m0,s63,26624
s_add_u32 s65,s58,2555904
buffer_load_dwordx4 v6,s[4:7],s65 offen lds
s_add_u32 m0,s63,27648
s_add_u32 s65,s58,2654208
buffer_load_dwordx4 v6,s[4:7],s65 offen lds
s_add_u32 m0,s63,28672
s_add_u32 s65,s58,2752512
buffer_load_dwordx4 v6,s[4:7],s65 offen lds
s_add_u32 m0,s63,29696
s_add_u32 s65,s58,2850816
buffer_load_dwordx4 v6,s[4:7],s65 offen lds
s_add_u32 m0,s63,30720
s_add_u32 s65,s58,2949120
buffer_load_dwordx4 v6,s[4:7],s65 offen lds
s_add_u32 m0,s63,31744
s_add_u32 s65,s58,3047424
buffer_load_dwordx4 v6,s[4:7],s65 offen lds
s_add_u32 m0,s63,32768
s_add_u32 s65,s58,3145728
buffer_load_dwordx4 v6,s[4:7],s65 offen lds
s_add_u32 m0,s63,33792
s_add_u32 s65,s58,3244032
buffer_load_dwordx4 v6,s[4:7],s65 offen lds
s_add_u32 m0,s63,34816
s_add_u32 s65,s58,3342336
buffer_load_dwordx4 v6,s[4:7],s65 offen lds
s_add_u32 m0,s63,35840
s_add_u32 s65,s58,3440640
buffer_load_dwordx4 v6,s[4:7],s65 offen lds
s_add_u32 m0,s63,36864
s_add_u32 s65,s58,3538944
buffer_load_dwordx4 v6,s[4:7],s65 offen lds
s_add_u32 m0,s63,37888
s_add_u32 s65,s58,3637248
buffer_load_dwordx4 v6,s[4:7],s65 offen lds
s_add_u32 m0,s63,38912
s_add_u32 s65,s58,3735552
buffer_load_dwordx4 v6,s[4:7],s65 offen lds
s_add_u32 m0,s63,39936
s_add_u32 s65,s58,3833856
buffer_load_dwordx4 v6,s[4:7],s65 offen lds
s_waitcnt vmcnt(20)
v_bfe_u32 v9,v0,2,2
v_lshrrev_b32 v10,5,v0
v_lshl_add_u32 v9,v10,2,v9
v_mul_u32_u24 v9,128,v9
v_and_b32 v10,1,v0
v_lshl_add_u32 v9,v10,3,v9
v_bfe_u32 v10,v0,1,1
v_lshl_add_u32 v9,v10,4,v9
v_bfe_u32 v10,v0,4,1
v_lshl_add_u32 v9,v10,5,v9
v_add_u32 v7,s63,v9
ds_read_b64_tr_b16 a[0:1],v7 offset:0
ds_read_b64_tr_b16 a[2:3],v7 offset:2048
ds_read_b64_tr_b16 a[4:5],v7 offset:1024
ds_read_b64_tr_b16 a[6:7],v7 offset:3072
ds_read_b64_tr_b16 a[160:161],v7 offset:64
ds_read_b64_tr_b16 a[162:163],v7 offset:2112
ds_read_b64_tr_b16 a[164:165],v7 offset:1088
ds_read_b64_tr_b16 a[166:167],v7 offset:3136
ds_read_b64_tr_b16 a[8:9],v7 offset:4096
ds_read_b64_tr_b16 a[10:11],v7 offset:6144
ds_read_b64_tr_b16 a[12:13],v7 offset:5120
ds_read_b64_tr_b16 a[14:15],v7 offset:7168
s_waitcnt lgkmcnt(4)
ds_read_b64_tr_b16 a[168:169],v7 offset:4160
ds_read_b64_tr_b16 a[170:171],v7 offset:6208
ds_read_b64_tr_b16 a[172:173],v7 offset:5184
ds_read_b64_tr_b16 a[174:175],v7 offset:7232
ds_read_b64_tr_b16 a[16:17],v7 offset:8192
ds_read_b64_tr_b16 a[18:19],v7 offset:10240
ds_read_b64_tr_b16 a[20:21],v7 offset:9216
ds_read_b64_tr_b16 a[22:23],v7 offset:11264
ds_read_b64_tr_b16 a[176:177],v7 offset:8256
ds_read_b64_tr_b16 a[178:179],v7 offset:10304
ds_read_b64_tr_b16 a[180:181],v7 offset:9280
ds_read_b64_tr_b16 a[182:183],v7 offset:11328
s_waitcnt lgkmcnt(4)
ds_read_b64_tr_b16 a[24:25],v7 offset:12288
ds_read_b64_tr_b16 a[26:27],v7 offset:14336
ds_read_b64_tr_b16 a[28:29],v7 offset:13312
ds_read_b64_tr_b16 a[30:31],v7 offset:15360
ds_read_b64_tr_b16 a[184:185],v7 offset:12352
ds_read_b64_tr_b16 a[186:187],v7 offset:14400
ds_read_b64_tr_b16 a[188:189],v7 offset:13376
ds_read_b64_tr_b16 a[190:191],v7 offset:15424
ds_read_b64_tr_b16 a[32:33],v7 offset:16384
ds_read_b64_tr_b16 a[34:35],v7 offset:18432
ds_read_b64_tr_b16 a[36:37],v7 offset:17408
ds_read_b64_tr_b16 a[38:39],v7 offset:19456
s_waitcnt lgkmcnt(4)
ds_read_b64_tr_b16 a[192:193],v7 offset:16448
ds_read_b64_tr_b16 a[194:195],v7 offset:18496
ds_read_b64_tr_b16 a[196:197],v7 offset:17472
ds_read_b64_tr_b16 a[198:199],v7 offset:19520
s_waitcnt lgkmcnt(0)
s_add_u32 m0,s63,0
s_add_u32 s65,s58,3932160
buffer_load_dwordx4 v6,s[4:7],s65 offen lds
s_add_u32 m0,s63,1024
s_add_u32 s65,s58,4030464
buffer_load_dwordx4 v6,s[4:7],s65 offen lds
s_add_u32 m0,s63,2048
s_add_u32 s65,s58,4128768
buffer_load_dwordx4 v6,s[4:7],s65 offen lds
s_add_u32 m0,s63,3072
s_add_u32 s65,s58,4227072
buffer_load_dwordx4 v6,s[4:7],s65 offen lds
s_add_u32 m0,s63,4096
s_add_u32 s65,s58,4325376
buffer_load_dwordx4 v6,s[4:7],s65 offen lds
s_add_u32 m0,s63,5120
s_add_u32 s65,s58,4423680
buffer_load_dwordx4 v6,s[4:7],s65 offen lds
s_add_u32 m0,s63,6144
s_add_u32 s65,s58,4521984
buffer_load_dwordx4 v6,s[4:7],s65 offen lds
s_add_u32 m0,s63,7168
s_add_u32 s65,s58,4620288
buffer_load_dwordx4 v6,s[4:7],s65 offen lds
s_add_u32 m0,s63,8192
s_add_u32 s65,s58,4718592
buffer_load_dwordx4 v6,s[4:7],s65 offen lds
s_add_u32 m0,s63,9216
s_add_u32 s65,s58,4816896
buffer_load_dwordx4 v6,s[4:7],s65 offen lds
s_add_u32 m0,s63,10240
s_add_u32 s65,s58,4915200
buffer_load_dwordx4 v6,s[4:7],s65 offen lds
s_add_u32 m0,s63,11264
s_add_u32 s65,s58,5013504
buffer_load_dwordx4 v6,s[4:7],s65 offen lds
s_add_u32 m0,s63,12288
s_add_u32 s65,s58,5111808
buffer_load_dwordx4 v6,s[4:7],s65 offen lds
s_add_u32 m0,s63,13312
s_add_u32 s65,s58,5210112
buffer_load_dwordx4 v6,s[4:7],s65 offen lds
s_add_u32 m0,s63,14336
s_add_u32 s65,s58,5308416
buffer_load_dwordx4 v6,s[4:7],s65 offen lds
s_add_u32 m0,s63,15360
s_add_u32 s65,s58,5406720
buffer_load_dwordx4 v6,s[4:7],s65 offen lds
s_add_u32 m0,s63,16384
s_add_u32 s65,s58,5505024
buffer_load_dwordx4 v6,s[4:7],s65 offen lds
s_add_u32 m0,s63,17408
s_add_u32 s65,s58,5603328
buffer_load_dwordx4 v6,s[4:7],s65 offen lds
s_add_u32 m0,s63,18432
s_add_u32 s65,s58,5701632
buffer_load_dwordx4 v6,s[4:7],s65 offen lds
s_add_u32 m0,s63,19456
s_add_u32 s65,s58,5799936
buffer_load_dwordx4 v6,s[4:7],s65 offen lds
s_waitcnt vmcnt(20)
v_bfe_u32 v9,v0,2,2
v_lshrrev_b32 v10,5,v0
v_lshl_add_u32 v9,v10,2,v9
v_mul_u32_u24 v9,128,v9
v_and_b32 v10,1,v0
v_lshl_add_u32 v9,v10,3,v9
v_bfe_u32 v10,v0,1,1
v_lshl_add_u32 v9,v10,4,v9
v_bfe_u32 v10,v0,4,1
v_lshl_add_u32 v9,v10,5,v9
v_add_u32 v7,s63,v9
ds_read_b64_tr_b16 a[40:41],v7 offset:20480
ds_read_b64_tr_b16 a[42:43],v7 offset:22528
ds_read_b64_tr_b16 a[44:45],v7 offset:21504
ds_read_b64_tr_b16 a[46:47],v7 offset:23552
ds_read_b64_tr_b16 a[200:201],v7 offset:20544
ds_read_b64_tr_b16 a[202:203],v7 offset:22592
ds_read_b64_tr_b16 a[204:205],v7 offset:21568
ds_read_b64_tr_b16 a[206:207],v7 offset:23616
ds_read_b64_tr_b16 a[48:49],v7 offset:24576
ds_read_b64_tr_b16 a[50:51],v7 offset:26624
ds_read_b64_tr_b16 a[52:53],v7 offset:25600
ds_read_b64_tr_b16 a[54:55],v7 offset:27648
s_waitcnt lgkmcnt(4)
ds_read_b64_tr_b16 a[208:209],v7 offset:24640
ds_read_b64_tr_b16 a[210:211],v7 offset:26688
ds_read_b64_tr_b16 a[212:213],v7 offset:25664
ds_read_b64_tr_b16 a[214:215],v7 offset:27712
ds_read_b64_tr_b16 a[56:57],v7 offset:28672
ds_read_b64_tr_b16 a[58:59],v7 offset:30720
ds_read_b64_tr_b16 a[60:61],v7 offset:29696
ds_read_b64_tr_b16 a[62:63],v7 offset:31744
ds_read_b64_tr_b16 a[216:217],v7 offset:28736
ds_read_b64_tr_b16 a[218:219],v7 offset:30784
ds_read_b64_tr_b16 a[220:221],v7 offset:29760
ds_read_b64_tr_b16 a[222:223],v7 offset:31808
s_waitcnt lgkmcnt(4)
ds_read_b64_tr_b16 a[64:65],v7 offset:32768
ds_read_b64_tr_b16 a[66:67],v7 offset:34816
ds_read_b64_tr_b16 a[68:69],v7 offset:33792
ds_read_b64_tr_b16 a[70:71],v7 offset:35840
ds_read_b64_tr_b16 a[224:225],v7 offset:32832
ds_read_b64_tr_b16 a[226:227],v7 offset:34880
ds_read_b64_tr_b16 a[228:229],v7 offset:33856
ds_read_b64_tr_b16 a[230:231],v7 offset:35904
ds_read_b64_tr_b16 a[72:73],v7 offset:36864
ds_read_b64_tr_b16 a[74:75],v7 offset:38912
ds_read_b64_tr_b16 a[76:77],v7 offset:37888
ds_read_b64_tr_b16 a[78:79],v7 offset:39936
s_waitcnt lgkmcnt(4)
ds_read_b64_tr_b16 a[232:233],v7 offset:36928
ds_read_b64_tr_b16 a[234:235],v7 offset:38976
ds_read_b64_tr_b16 a[236:237],v7 offset:37952
ds_read_b64_tr_b16 a[238:239],v7 offset:40000
s_waitcnt lgkmcnt(0)
s_add_u32 m0,s63,20480
s_add_u32 s65,s58,5898240
buffer_load_dwordx4 v6,s[4:7],s65 offen lds
s_add_u32 m0,s63,21504
s_add_u32 s65,s58,5996544
buffer_load_dwordx4 v6,s[4:7],s65 offen lds
s_add_u32 m0,s63,22528
s_add_u32 s65,s58,6094848
buffer_load_dwordx4 v6,s[4:7],s65 offen lds
s_add_u32 m0,s63,23552
s_add_u32 s65,s58,6193152
buffer_load_dwordx4 v6,s[4:7],s65 offen lds
s_add_u32 m0,s63,24576
s_add_u32 s65,s58,6291456
buffer_load_dwordx4 v6,s[4:7],s65 offen lds
s_add_u32 m0,s63,25600
s_add_u32 s65,s58,6389760
buffer_load_dwordx4 v6,s[4:7],s65 offen lds
s_add_u32 m0,s63,26624
s_add_u32 s65,s58,6488064
buffer_load_dwordx4 v6,s[4:7],s65 offen lds
s_add_u32 m0,s63,27648
s_add_u32 s65,s58,6586368
buffer_load_dwordx4 v6,s[4:7],s65 offen lds
s_add_u32 m0,s63,28672
s_add_u32 s65,s58,6684672
buffer_load_dwordx4 v6,s[4:7],s65 offen lds
s_add_u32 m0,s63,29696
s_add_u32 s65,s58,6782976
buffer_load_dwordx4 v6,s[4:7],s65 offen lds
s_add_u32 m0,s63,30720
s_add_u32 s65,s58,6881280
buffer_load_dwordx4 v6,s[4:7],s65 offen lds
s_add_u32 m0,s63,31744
s_add_u32 s65,s58,6979584
buffer_load_dwordx4 v6,s[4:7],s65 offen lds
s_add_u32 m0,s63,32768
s_add_u32 s65,s58,7077888
buffer_load_dwordx4 v6,s[4:7],s65 offen lds
s_add_u32 m0,s63,33792
s_add_u32 s65,s58,7176192
buffer_load_dwordx4 v6,s[4:7],s65 offen lds
s_add_u32 m0,s63,34816
s_add_u32 s65,s58,7274496
buffer_load_dwordx4 v6,s[4:7],s65 offen lds
s_add_u32 m0,s63,35840
s_add_u32 s65,s58,7372800
buffer_load_dwordx4 v6,s[4:7],s65 offen lds
s_add_u32 m0,s63,36864
s_add_u32 s65,s58,7471104
buffer_load_dwordx4 v6,s[4:7],s65 offen lds
s_add_u32 m0,s63,37888
s_add_u32 s65,s58,7569408
buffer_load_dwordx4 v6,s[4:7],s65 offen lds
s_add_u32 m0,s63,38912
s_add_u32 s65,s58,7667712
buffer_load_dwordx4 v6,s[4:7],s65 offen lds
s_add_u32 m0,s63,39936
s_add_u32 s65,s58,7766016
buffer_load_dwordx4 v6,s[4:7],s65 offen lds
s_waitcnt vmcnt(20)
v_bfe_u32 v9,v0,2,2
v_lshrrev_b32 v10,5,v0
v_lshl_add_u32 v9,v10,2,v9
v_mul_u32_u24 v9,128,v9
v_and_b32 v10,1,v0
v_lshl_add_u32 v9,v10,3,v9
v_bfe_u32 v10,v0,1,1
v_lshl_add_u32 v9,v10,4,v9
v_bfe_u32 v10,v0,4,1
v_lshl_add_u32 v9,v10,5,v9
v_add_u32 v7,s63,v9
ds_read_b64_tr_b16 a[80:81],v7 offset:0
ds_read_b64_tr_b16 a[82:83],v7 offset:2048
ds_read_b64_tr_b16 a[84:85],v7 offset:1024
ds_read_b64_tr_b16 a[86:87],v7 offset:3072
ds_read_b64_tr_b16 a[240:241],v7 offset:64
ds_read_b64_tr_b16 a[242:243],v7 offset:2112
ds_read_b64_tr_b16 a[244:245],v7 offset:1088
ds_read_b64_tr_b16 a[246:247],v7 offset:3136
ds_read_b64_tr_b16 a[88:89],v7 offset:4096
ds_read_b64_tr_b16 a[90:91],v7 offset:6144
ds_read_b64_tr_b16 a[92:93],v7 offset:5120
ds_read_b64_tr_b16 a[94:95],v7 offset:7168
s_waitcnt lgkmcnt(4)
ds_read_b64_tr_b16 a[248:249],v7 offset:4160
ds_read_b64_tr_b16 a[250:251],v7 offset:6208
ds_read_b64_tr_b16 a[252:253],v7 offset:5184
ds_read_b64_tr_b16 a[254:255],v7 offset:7232
ds_read_b64_tr_b16 a[96:97],v7 offset:8192
ds_read_b64_tr_b16 a[98:99],v7 offset:10240
ds_read_b64_tr_b16 a[100:101],v7 offset:9216
ds_read_b64_tr_b16 a[102:103],v7 offset:11264
ds_read_b64_tr_b16 v[192:193],v7 offset:8256
ds_read_b64_tr_b16 v[194:195],v7 offset:10304
ds_read_b64_tr_b16 v[196:197],v7 offset:9280
ds_read_b64_tr_b16 v[198:199],v7 offset:11328
s_waitcnt lgkmcnt(4)
ds_read_b64_tr_b16 a[104:105],v7 offset:12288
ds_read_b64_tr_b16 a[106:107],v7 offset:14336
ds_read_b64_tr_b16 a[108:109],v7 offset:13312
ds_read_b64_tr_b16 a[110:111],v7 offset:15360
ds_read_b64_tr_b16 v[200:201],v7 offset:12352
ds_read_b64_tr_b16 v[202:203],v7 offset:14400
ds_read_b64_tr_b16 v[204:205],v7 offset:13376
ds_read_b64_tr_b16 v[206:207],v7 offset:15424
ds_read_b64_tr_b16 a[112:113],v7 offset:16384
ds_read_b64_tr_b16 a[114:115],v7 offset:18432
ds_read_b64_tr_b16 a[116:117],v7 offset:17408
ds_read_b64_tr_b16 a[118:119],v7 offset:19456
s_waitcnt lgkmcnt(4)
ds_read_b64_tr_b16 v[208:209],v7 offset:16448
ds_read_b64_tr_b16 v[210:211],v7 offset:18496
ds_read_b64_tr_b16 v[212:213],v7 offset:17472
ds_read_b64_tr_b16 v[214:215],v7 offset:19520
s_waitcnt lgkmcnt(0)
s_waitcnt vmcnt(0)
v_bfe_u32 v9,v0,2,2
v_lshrrev_b32 v10,5,v0
v_lshl_add_u32 v9,v10,2,v9
v_mul_u32_u24 v9,128,v9
v_and_b32 v10,1,v0
v_lshl_add_u32 v9,v10,3,v9
v_bfe_u32 v10,v0,1,1
v_lshl_add_u32 v9,v10,4,v9
v_bfe_u32 v10,v0,4,1
v_lshl_add_u32 v9,v10,5,v9
v_add_u32 v7,s63,v9
ds_read_b64_tr_b16 a[120:121],v7 offset:20480
ds_read_b64_tr_b16 a[122:123],v7 offset:22528
ds_read_b64_tr_b16 a[124:125],v7 offset:21504
ds_read_b64_tr_b16 a[126:127],v7 offset:23552
ds_read_b64_tr_b16 v[216:217],v7 offset:20544
ds_read_b64_tr_b16 v[218:219],v7 offset:22592
ds_read_b64_tr_b16 v[220:221],v7 offset:21568
ds_read_b64_tr_b16 v[222:223],v7 offset:23616
ds_read_b64_tr_b16 a[128:129],v7 offset:24576
ds_read_b64_tr_b16 a[130:131],v7 offset:26624
ds_read_b64_tr_b16 a[132:133],v7 offset:25600
ds_read_b64_tr_b16 a[134:135],v7 offset:27648
s_waitcnt lgkmcnt(4)
ds_read_b64_tr_b16 v[224:225],v7 offset:24640
ds_read_b64_tr_b16 v[226:227],v7 offset:26688
ds_read_b64_tr_b16 v[228:229],v7 offset:25664
ds_read_b64_tr_b16 v[230:231],v7 offset:27712
ds_read_b64_tr_b16 a[136:137],v7 offset:28672
ds_read_b64_tr_b16 a[138:139],v7 offset:30720
ds_read_b64_tr_b16 a[140:141],v7 offset:29696
ds_read_b64_tr_b16 a[142:143],v7 offset:31744
ds_read_b64_tr_b16 v[232:233],v7 offset:28736
ds_read_b64_tr_b16 v[234:235],v7 offset:30784
ds_read_b64_tr_b16 v[236:237],v7 offset:29760
ds_read_b64_tr_b16 v[238:239],v7 offset:31808
s_waitcnt lgkmcnt(4)
ds_read_b64_tr_b16 a[144:145],v7 offset:32768
ds_read_b64_tr_b16 a[146:147],v7 offset:34816
ds_read_b64_tr_b16 a[148:149],v7 offset:33792
ds_read_b64_tr_b16 a[150:151],v7 offset:35840
ds_read_b64_tr_b16 v[240:241],v7 offset:32832
ds_read_b64_tr_b16 v[242:243],v7 offset:34880
ds_read_b64_tr_b16 v[244:245],v7 offset:33856
ds_read_b64_tr_b16 v[246:247],v7 offset:35904
ds_read_b64_tr_b16 a[152:153],v7 offset:36864
ds_read_b64_tr_b16 a[154:155],v7 offset:38912
ds_read_b64_tr_b16 a[156:157],v7 offset:37888
ds_read_b64_tr_b16 a[158:159],v7 offset:39936
s_waitcnt lgkmcnt(4)
ds_read_b64_tr_b16 v[248:249],v7 offset:36928
ds_read_b64_tr_b16 v[250:251],v7 offset:38976
ds_read_b64_tr_b16 v[252:253],v7 offset:37952
ds_read_b64_tr_b16 v[254:255],v7 offset:40000
s_waitcnt lgkmcnt(0)
v_mov_b32 v24,0x3f803f80
v_mov_b32 v25,0x3f803f80
v_mov_b32 v26,0x3f803f80
v_mov_b32 v27,0x3f803f80
s_nop 1
v_mfma_f32_32x32x16_bf16 v[56:71],v[24:27],a[0:3],0
v_mfma_f32_32x32x16_bf16 v[72:87],v[24:27],a[160:163],0
v_mfma_f32_32x32x16_bf16 v[56:71],v[24:27],a[4:7],v[56:71]
v_mfma_f32_32x32x16_bf16 v[72:87],v[24:27],a[164:167],v[72:87]
v_mfma_f32_32x32x16_bf16 v[56:71],v[24:27],a[8:11],v[56:71]
v_mfma_f32_32x32x16_bf16 v[72:87],v[24:27],a[168:171],v[72:87]
v_mfma_f32_32x32x16_bf16 v[56:71],v[24:27],a[12:15],v[56:71]
v_mfma_f32_32x32x16_bf16 v[72:87],v[24:27],a[172:175],v[72:87]
v_mfma_f32_32x32x16_bf16 v[56:71],v[24:27],a[16:19],v[56:71]
v_mfma_f32_32x32x16_bf16 v[72:87],v[24:27],a[176:179],v[72:87]
v_mfma_f32_32x32x16_bf16 v[56:71],v[24:27],a[20:23],v[56:71]
v_mfma_f32_32x32x16_bf16 v[72:87],v[24:27],a[180:183],v[72:87]
v_mfma_f32_32x32x16_bf16 v[56:71],v[24:27],a[24:27],v[56:71]
v_mfma_f32_32x32x16_bf16 v[72:87],v[24:27],a[184:187],v[72:87]
v_mfma_f32_32x32x16_bf16 v[56:71],v[24:27],a[28:31],v[56:71]
v_mfma_f32_32x32x16_bf16 v[72:87],v[24:27],a[188:191],v[72:87]
v_mfma_f32_32x32x16_bf16 v[56:71],v[24:27],a[32:35],v[56:71]
v_mfma_f32_32x32x16_bf16 v[72:87],v[24:27],a[192:195],v[72:87]
v_mfma_f32_32x32x16_bf16 v[56:71],v[24:27],a[36:39],v[56:71]
v_mfma_f32_32x32x16_bf16 v[72:87],v[24:27],a[196:199],v[72:87]
v_mfma_f32_32x32x16_bf16 v[56:71],v[24:27],a[40:43],v[56:71]
v_mfma_f32_32x32x16_bf16 v[72:87],v[24:27],a[200:203],v[72:87]
v_mfma_f32_32x32x16_bf16 v[56:71],v[24:27],a[44:47],v[56:71]
v_mfma_f32_32x32x16_bf16 v[72:87],v[24:27],a[204:207],v[72:87]
v_mfma_f32_32x32x16_bf16 v[56:71],v[24:27],a[48:51],v[56:71]
v_mfma_f32_32x32x16_bf16 v[72:87],v[24:27],a[208:211],v[72:87]
v_mfma_f32_32x32x16_bf16 v[56:71],v[24:27],a[52:55],v[56:71]
v_mfma_f32_32x32x16_bf16 v[72:87],v[24:27],a[212:215],v[72:87]
v_mfma_f32_32x32x16_bf16 v[56:71],v[24:27],a[56:59],v[56:71]
v_mfma_f32_32x32x16_bf16 v[72:87],v[24:27],a[216:219],v[72:87]
v_mfma_f32_32x32x16_bf16 v[56:71],v[24:27],a[60:63],v[56:71]
v_mfma_f32_32x32x16_bf16 v[72:87],v[24:27],a[220:223],v[72:87]
v_mfma_f32_32x32x16_bf16 v[56:71],v[24:27],a[64:67],v[56:71]
v_mfma_f32_32x32x16_bf16 v[72:87],v[24:27],a[224:227],v[72:87]
v_mfma_f32_32x32x16_bf16 v[56:71],v[24:27],a[68:71],v[56:71]
v_mfma_f32_32x32x16_bf16 v[72:87],v[24:27],a[228:231],v[72:87]
v_mfma_f32_32x32x16_bf16 v[56:71],v[24:27],a[72:75],v[56:71]
v_mfma_f32_32x32x16_bf16 v[72:87],v[24:27],a[232:235],v[72:87]
v_mfma_f32_32x32x16_bf16 v[56:71],v[24:27],a[76:79],v[56:71]
v_mfma_f32_32x32x16_bf16 v[72:87],v[24:27],a[236:239],v[72:87]
v_mfma_f32_32x32x16_bf16 v[56:71],v[24:27],a[80:83],v[56:71]
v_mfma_f32_32x32x16_bf16 v[72:87],v[24:27],a[240:243],v[72:87]
v_mfma_f32_32x32x16_bf16 v[56:71],v[24:27],a[84:87],v[56:71]
v_mfma_f32_32x32x16_bf16 v[72:87],v[24:27],a[244:247],v[72:87]
v_mfma_f32_32x32x16_bf16 v[56:71],v[24:27],a[88:91],v[56:71]
v_mfma_f32_32x32x16_bf16 v[72:87],v[24:27],a[248:251],v[72:87]
v_mfma_f32_32x32x16_bf16 v[56:71],v[24:27],a[92:95],v[56:71]
v_mfma_f32_32x32x16_bf16 v[72:87],v[24:27],a[252:255],v[72:87]
v_mfma_f32_32x32x16_bf16 v[56:71],v[24:27],a[96:99],v[56:71]
v_mfma_f32_32x32x16_bf16 v[72:87],v[24:27],v[192:195],v[72:87]
v_mfma_f32_32x32x16_bf16 v[56:71],v[24:27],a[100:103],v[56:71]
v_mfma_f32_32x32x16_bf16 v[72:87],v[24:27],v[196:199],v[72:87]
v_mfma_f32_32x32x16_bf16 v[56:71],v[24:27],a[104:107],v[56:71]
v_mfma_f32_32x32x16_bf16 v[72:87],v[24:27],v[200:203],v[72:87]
v_mfma_f32_32x32x16_bf16 v[56:71],v[24:27],a[108:111],v[56:71]
v_mfma_f32_32x32x16_bf16 v[72:87],v[24:27],v[204:207],v[72:87]
v_mfma_f32_32x32x16_bf16 v[56:71],v[24:27],a[112:115],v[56:71]
v_mfma_f32_32x32x16_bf16 v[72:87],v[24:27],v[208:211],v[72:87]
v_mfma_f32_32x32x16_bf16 v[56:71],v[24:27],a[116:119],v[56:71]
v_mfma_f32_32x32x16_bf16 v[72:87],v[24:27],v[212:215],v[72:87]
v_mfma_f32_32x32x16_bf16 v[56:71],v[24:27],a[120:123],v[56:71]
v_mfma_f32_32x32x16_bf16 v[72:87],v[24:27],v[216:219],v[72:87]
v_mfma_f32_32x32x16_bf16 v[56:71],v[24:27],a[124:127],v[56:71]
v_mfma_f32_32x32x16_bf16 v[72:87],v[24:27],v[220:223],v[72:87]
v_mfma_f32_32x32x16_bf16 v[56:71],v[24:27],a[128:131],v[56:71]
v_mfma_f32_32x32x16_bf16 v[72:87],v[24:27],v[224:227],v[72:87]
v_mfma_f32_32x32x16_bf16 v[56:71],v[24:27],a[132:135],v[56:71]
v_mfma_f32_32x32x16_bf16 v[72:87],v[24:27],v[228:231],v[72:87]
v_mfma_f32_32x32x16_bf16 v[56:71],v[24:27],a[136:139],v[56:71]
v_mfma_f32_32x32x16_bf16 v[72:87],v[24:27],v[232:235],v[72:87]
v_mfma_f32_32x32x16_bf16 v[56:71],v[24:27],a[140:143],v[56:71]
v_mfma_f32_32x32x16_bf16 v[72:87],v[24:27],v[236:239],v[72:87]
v_mfma_f32_32x32x16_bf16 v[56:71],v[24:27],a[144:147],v[56:71]
v_mfma_f32_32x32x16_bf16 v[72:87],v[24:27],v[240:243],v[72:87]
v_mfma_f32_32x32x16_bf16 v[56:71],v[24:27],a[148:151],v[56:71]
v_mfma_f32_32x32x16_bf16 v[72:87],v[24:27],v[244:247],v[72:87]
v_mfma_f32_32x32x16_bf16 v[56:71],v[24:27],a[152:155],v[56:71]
v_mfma_f32_32x32x16_bf16 v[72:87],v[24:27],v[248:251],v[72:87]
v_mfma_f32_32x32x16_bf16 v[56:71],v[24:27],a[156:159],v[56:71]
v_mfma_f32_32x32x16_bf16 v[72:87],v[24:27],v[252:255],v[72:87]
s_nop 10
v_mov_b32 v120,v56
v_mov_b32 v121,v72
s_barrier
s_lshl_b32 s3,s49,2
v_mov_b32 v7,s3
s_nop 1
ibw_246:
buffer_load_dword v6,v7,s[12:15],0 offen sc1
s_waitcnt vmcnt(0)
v_cmp_ne_u32 vcc,256,v6
s_nop 0
s_cbranch_vccz ok_247
s_sleep 8
s_sub_u32 s47,s47,1
s_cbranch_scc1 ABORT
s_branch ibw_246
ok_247:
s_cmp_lg_u32 s49,0
s_cbranch_scc1 ibok_248
v_and_b32 v7,7,v0
v_lshlrev_b32 v7,2,v7
buffer_load_dword v6,v7,s[12:15],0 offen offset:32 sc1
s_waitcnt vmcnt(0)
v_cmp_ne_u32 vcc,32,v6
s_nop 0
s_cbranch_vccz ibok_248
s_barrier
s_mov_b32 s49,1
s_mov_b32 s3,s2
s_load_dwordx16 s[16:31],s[0:1],0
s_load_dwordx8 s[32:39],s[0:1],64
s_waitcnt lgkmcnt(0)
s_branch DISPATCH
ibok_248:
s_mov_b32 s50,0
s_mov_b32 s32,0
s_mov_b32 s57,0
s_mov_b32 s59,2147483648
s_mov_b32 s82,2147483648
s_mov_b32 s39,2147483648
v_mov_b32 v22,94208
s_mov_b32 s72,0
s_mov_b32 s73,0
s_mov_b32 s83,s100
s_min_u32 s62,s32,127
s_sub_u32 s60,s62,20
s_lshr_b32 s34,s60,1
s_and_b32 s33,s60,1
s_xor_b32 s33,s33,1
s_cmp_eq_u32 s33,0
s_cselect_b32 s61,20,0
s_add_u32 s34,s34,s61
s_sub_u32 s61,s60,44
s_cmp_ge_u32 s60,88
s_cselect_b32 s34,s61,s34
s_cselect_b32 s33,1,s33
s_cmp_lt_u32 s62,20
s_cselect_b32 s34,s62,s34
s_cselect_b32 s33,0,s33
s_lshl_b32 s35,s33,6
s_add_u32 s35,s35,s34
s_lshl_b32 s35,s35,9
s_add_u32 s35,s35,0
s_lshl_b32 s60,s33,5
s_add_u32 s60,s60,7
v_min_u32 v2,s60,v0
v_lshlrev_b32 v2,2,v2
s_nop 1
QKVV_COLD0:
s_cmp_lg_u32 s46,0
s_cbranch_scc1 cp_249
fb_250:
buffer_load_dword v3,v2,s[8:11],s35 offen sc1
s_waitcnt vmcnt(0)
v_cmp_eq_u32 vcc,0,v3
s_nop 0
s_cbranch_vccz ok_251
s_sleep 7
s_sub_u32 s47,s47,1
s_cbranch_scc1 ABORT
s_branch fb_250
ok_251:
cp_249:
s_barrier
s_lshl_b32 s60,s33,6
s_add_u32 s60,s60,s34
s_mul_i32 s60,s60,46080
s_add_u32 s60,s60,206569472
s_lshl_b32 s62,s46,10
s_add_u32 s62,s62,40960
s_add_u32 m0,s57,s62
s_add_u32 s63,s60,s62
buffer_load_dwordx4 v1,s[8:11],s63 offen sc1 lds
s_add_u32 m0,s57,45056
s_add_u32 s63,s60,45056
buffer_load_dwordx4 v1,s[8:11],s63 offen sc1 lds
s_mul_i32 s61,s46,10240
s_add_u32 s60,s60,s61
s_add_u32 s61,s61,s57
s_add_u32 m0,s61,0
s_add_u32 s63,s60,0
buffer_load_dwordx4 v1,s[8:11],s63 offen sc1 lds
buffer_load_dwordx4 v1,s[8:11],s63 offen offset:1024 sc1 lds
buffer_load_dwordx4 v1,s[8:11],s63 offen offset:2048 sc1 lds
buffer_load_dwordx4 v1,s[8:11],s63 offen offset:3072 sc1 lds
s_add_u32 m0,s61,4096
s_add_u32 s63,s60,4096
buffer_load_dwordx4 v1,s[8:11],s63 offen sc1 lds
buffer_load_dwordx4 v1,s[8:11],s63 offen offset:1024 sc1 lds
buffer_load_dwordx4 v1,s[8:11],s63 offen offset:2048 sc1 lds
buffer_load_dwordx4 v1,s[8:11],s63 offen offset:3072 sc1 lds
s_add_u32 m0,s61,8192
s_add_u32 s63,s60,8192
buffer_load_dwordx4 v1,s[8:11],s63 offen sc1 lds
buffer_load_dwordx4 v1,s[8:11],s63 offen offset:1024 sc1 lds
QKVV_CD0:
s_mov_b32 s51,s33
s_mov_b32 s52,s34
s_add_u32 s32,s32,1
s_min_u32 s62,s32,127
s_sub_u32 s60,s62,20
s_lshr_b32 s34,s60,1
s_and_b32 s33,s60,1
s_xor_b32 s33,s33,1
s_cmp_eq_u32 s33,0
s_cselect_b32 s61,20,0
s_add_u32 s34,s34,s61
s_sub_u32 s61,s60,44
s_cmp_ge_u32 s60,88
s_cselect_b32 s34,s61,s34
s_cselect_b32 s33,1,s33
s_cmp_lt_u32 s62,20
s_cselect_b32 s34,s62,s34
s_cselect_b32 s33,0,s33
s_lshl_b32 s35,s33,6
s_add_u32 s35,s35,s34
s_lshl_b32 s35,s35,9
s_add_u32 s35,s35,0
s_lshl_b32 s60,s33,5
s_add_u32 s60,s60,7
v_min_u32 v2,s60,v0
v_lshlrev_b32 v2,2,v2
s_cmp_lg_u32 s46,0
s_cbranch_scc1 w0_252
buffer_load_dword v3,v2,s[8:11],s35 offen sc1
w0_252:
s_waitcnt vmcnt(0)
s_mov_b64 exec,1
buffer_store_dword v5,v1,s[8:11],s59 offen sc1
s_mov_b64 exec,-1
s_mov_b32 s59,2147483648
s_cmp_lg_u32 s46,0
s_cbranch_scc1 w0_253
v_cmp_eq_u32 vcc,0,v3
s_cmp_eq_u64 vcc,0
s_cselect_b32 s36,0,2147483648
s_cmp_lt_u32 s32,128
s_cselect_b32 s36,s36,2147483648
v_mov_b32 v23,s36
ds_write_b32 v22,v23
w0_253:
s_waitcnt lgkmcnt(0)
s_barrier
ds_read_b32 v23,v22
ds_read_b128 v[24:27],v16 offset:0
ds_read_b128 v[28:31],v17 offset:0
ds_read_b128 v[32:35],v16 offset:2048
ds_read_b128 v[36:39],v17 offset:2048
ds_read_b128 v[40:43],v16 offset:4096
s_waitcnt lgkmcnt(5)
v_readfirstlane_b32 s37,v23
s_nop 4
QKVV_B0:
s_waitcnt lgkmcnt(3)
v_mfma_f32_32x32x16_bf16 v[56:71],v[24:27],a[0:3],0
ds_read_b128 v[44:47],v17 offset:4096
v_add_u32 v189,s57,v188
v_mfma_f32_32x32x16_bf16 v[72:87],v[24:27],a[160:163],0
v_add_u32 v8,0x800,v189
s_sub_u32 s66,46080,s57
s_lshl_b32 s60,s33,6
s_add_u32 s60,s60,s34
s_mul_i32 s60,s60,46080
s_add_u32 s60,s60,s37
v_mfma_f32_32x32x16_bf16 v[56:71],v[28:31],a[4:7],v[56:71]
ds_read_b128 v[48:51],v16 offset:6144
ds_read2_b64 v[156:159],v189 offset0:0 offset1:32
s_add_u32 s60,s60,206569472
s_lshl_b32 s62,s46,10
v_mfma_f32_32x32x16_bf16 v[72:87],v[28:31],a[164:167],v[72:87]
ds_read2_b64 v[160:163],v189 offset0:64 offset1:96
s_add_u32 s62,s62,40960
s_add_u32 m0,s66,s62
s_add_u32 s63,s60,s62
s_waitcnt lgkmcnt(5)
v_mfma_f32_32x32x16_bf16 v[56:71],v[32:35],a[8:11],v[56:71]
ds_read_b128 v[52:55],v17 offset:6144
ds_read2_b64 v[164:167],v189 offset0:128 offset1:160
buffer_load_dwordx4 v1,s[8:11],s63 offen sc1 lds
v_mfma_f32_32x32x16_bf16 v[72:87],v[32:35],a[168:171],v[72:87]
ds_read2_b64 v[168:171],v189 offset0:192 offset1:224
s_add_u32 m0,s66,45056
s_add_u32 s63,s60,45056
s_mul_i32 s74,s73,393216
s_add_u32 s74,s74,s39
v_mfma_f32_32x32x16_bf16 v[56:71],v[36:39],a[12:15],v[56:71]
ds_read_b128 v[24:27],v16 offset:8192
ds_read2_b64 v[172:175],v8 offset0:0 offset1:32
s_add_u32 s74,s74,s70
v_fma_f32 v88,-v124,v120,v88
v_mfma_f32_32x32x16_bf16 v[72:87],v[36:39],a[172:175],v[72:87]
buffer_load_dwordx4 v1,s[8:11],s63 offen sc1 lds
s_mul_i32 s61,s46,10240
s_add_u32 s60,s60,s61
s_add_u32 s61,s61,s66
s_waitcnt lgkmcnt(8)
v_mfma_f32_32x32x16_bf16 v[56:71],v[40:43],a[16:19],v[56:71]
ds_read_b128 v[28:31],v17 offset:8192
s_add_u32 m0,s61,0
s_add_u32 s63,s60,0
v_fma_f32 v89,-v126,v120,v89
v_fma_f32 v90,-v128,v120,v90
v_mfma_f32_32x32x16_bf16 v[72:87],v[40:43],a[176:179],v[72:87]
v_fma_f32 v91,-v130,v120,v91
v_fma_f32 v96,-v140,v120,v96
v_fma_f32 v97,-v142,v120,v97
v_fma_f32 v98,-v144,v120,v98
v_fma_f32 v99,-v146,v120,v99
v_mul_f32 v88,v88,v125
v_mfma_f32_32x32x16_bf16 v[56:71],v[44:47],a[20:23],v[56:71]
ds_read_b128 v[32:35],v16 offset:10240
buffer_load_dwordx4 v1,s[8:11],s63 offen sc1 lds
v_mul_f32 v89,v89,v127
v_mul_f32 v90,v90,v129
v_mfma_f32_32x32x16_bf16 v[72:87],v[44:47],a[180:183],v[72:87]
v_mul_f32 v91,v91,v131
v_mul_f32 v96,v96,v141
v_mul_f32 v97,v97,v143
v_mul_f32 v98,v98,v145
v_mul_f32 v99,v99,v147
s_waitcnt lgkmcnt(6)
v_mfma_f32_32x32x16_bf16 v[56:71],v[48:51],a[24:27],v[56:71]
ds_read_b128 v[36:39],v17 offset:10240
v_cvt_pk_bf16_f32 v180,v88,v89
v_cvt_pk_bf16_f32 v181,v90,v91
v_cvt_pk_bf16_f32 v182,v96,v97
v_cvt_pk_bf16_f32 v183,v98,v99
v_mfma_f32_32x32x16_bf16 v[72:87],v[48:51],a[184:187],v[72:87]
buffer_load_dwordx4 v1,s[8:11],s63 offen offset:1024 sc1 lds
buffer_store_dwordx4 v[180:183],v20,s[8:11],s74 offen sc1
v_fma_f32 v92,-v132,v120,v92
v_fma_f32 v93,-v134,v120,v93
v_mfma_f32_32x32x16_bf16 v[56:71],v[52:55],a[28:31],v[56:71]
ds_read_b128 v[40:43],v16 offset:12288
v_fma_f32 v94,-v136,v120,v94
v_fma_f32 v95,-v138,v120,v95
v_fma_f32 v100,-v148,v120,v100
v_fma_f32 v101,-v150,v120,v101
v_mfma_f32_32x32x16_bf16 v[72:87],v[52:55],a[188:191],v[72:87]
v_fma_f32 v102,-v152,v120,v102
v_fma_f32 v103,-v154,v120,v103
v_mul_f32 v92,v92,v133
v_mul_f32 v93,v93,v135
v_mul_f32 v94,v94,v137
s_waitcnt lgkmcnt(3)
v_mfma_f32_32x32x16_bf16 v[56:71],v[24:27],a[32:35],v[56:71]
ds_read_b128 v[44:47],v17 offset:12288
buffer_load_dwordx4 v1,s[8:11],s63 offen offset:2048 sc1 lds
v_mul_f32 v95,v95,v139
v_mul_f32 v100,v100,v149
v_mfma_f32_32x32x16_bf16 v[72:87],v[24:27],a[192:195],v[72:87]
v_mul_f32 v101,v101,v151
v_mul_f32 v102,v102,v153
v_mul_f32 v103,v103,v155
v_cvt_pk_bf16_f32 v184,v92,v93
v_cvt_pk_bf16_f32 v185,v94,v95
v_cvt_pk_bf16_f32 v186,v100,v101
v_mfma_f32_32x32x16_bf16 v[56:71],v[28:31],a[36:39],v[56:71]
ds_read_b128 v[48:51],v16 offset:14336
v_cvt_pk_bf16_f32 v187,v102,v103
buffer_store_dwordx4 v[184:187],v21,s[8:11],s74 offen sc1
v_fma_f32 v104,-v124,v121,v104
v_mfma_f32_32x32x16_bf16 v[72:87],v[28:31],a[196:199],v[72:87]
buffer_load_dwordx4 v1,s[8:11],s63 offen offset:3072 sc1 lds
s_add_u32 m0,s61,4096
s_add_u32 s63,s60,4096
v_fma_f32 v105,-v126,v121,v105
s_waitcnt lgkmcnt(3)
v_mfma_f32_32x32x16_bf16 v[56:71],v[32:35],a[40:43],v[56:71]
ds_read_b128 v[52:55],v17 offset:14336
v_fma_f32 v106,-v128,v121,v106
v_fma_f32 v107,-v130,v121,v107
v_fma_f32 v112,-v140,v121,v112
v_fma_f32 v113,-v142,v121,v113
v_mfma_f32_32x32x16_bf16 v[72:87],v[32:35],a[200:203],v[72:87]
v_fma_f32 v114,-v144,v121,v114
v_fma_f32 v115,-v146,v121,v115
v_mul_f32 v104,v104,v125
v_mul_f32 v105,v105,v127
v_mul_f32 v106,v106,v129
v_mul_f32 v107,v107,v131
v_mfma_f32_32x32x16_bf16 v[56:71],v[36:39],a[44:47],v[56:71]
ds_read_b128 v[24:27],v16 offset:16384
buffer_load_dwordx4 v1,s[8:11],s63 offen sc1 lds
v_mul_f32 v112,v112,v141
v_mul_f32 v113,v113,v143
v_mfma_f32_32x32x16_bf16 v[72:87],v[36:39],a[204:207],v[72:87]
v_mul_f32 v114,v114,v145
v_mul_f32 v115,v115,v147
v_cvt_pk_bf16_f32 v180,v104,v105
v_cvt_pk_bf16_f32 v181,v106,v107
v_cvt_pk_bf16_f32 v182,v112,v113
s_waitcnt lgkmcnt(3)
v_mfma_f32_32x32x16_bf16 v[56:71],v[40:43],a[48:51],v[56:71]
ds_read_b128 v[28:31],v17 offset:16384
v_cvt_pk_bf16_f32 v183,v114,v115
buffer_store_dwordx4 v[180:183],v20,s[8:11],s74 offen offset:2048 sc1
v_fma_f32 v108,-v132,v121,v108
v_mfma_f32_32x32x16_bf16 v[72:87],v[40:43],a[208:211],v[72:87]
buffer_load_dwordx4 v1,s[8:11],s63 offen offset:1024 sc1 lds
v_fma_f32 v109,-v134,v121,v109
v_fma_f32 v110,-v136,v121,v110
v_fma_f32 v111,-v138,v121,v111
v_fma_f32 v116,-v148,v121,v116
v_mfma_f32_32x32x16_bf16 v[56:71],v[44:47],a[52:55],v[56:71]
ds_read_b128 v[32:35],v16 offset:18432
v_fma_f32 v117,-v150,v121,v117
v_fma_f32 v118,-v152,v121,v118
v_fma_f32 v119,-v154,v121,v119
v_mul_f32 v108,v108,v133
v_mfma_f32_32x32x16_bf16 v[72:87],v[44:47],a[212:215],v[72:87]
v_mul_f32 v109,v109,v135
v_mul_f32 v110,v110,v137
v_mul_f32 v111,v111,v139
v_mul_f32 v116,v116,v149
v_mul_f32 v117,v117,v151
s_waitcnt lgkmcnt(3)
v_mfma_f32_32x32x16_bf16 v[56:71],v[48:51],a[56:59],v[56:71]
ds_read_b128 v[36:39],v17 offset:18432
buffer_load_dwordx4 v1,s[8:11],s63 offen offset:2048 sc1 lds
v_mul_f32 v118,v118,v153
v_mul_f32 v119,v119,v155
v_mfma_f32_32x32x16_bf16 v[72:87],v[48:51],a[216:219],v[72:87]
v_cvt_pk_bf16_f32 v184,v108,v109
v_cvt_pk_bf16_f32 v185,v110,v111
v_cvt_pk_bf16_f32 v186,v116,v117
v_cvt_pk_bf16_f32 v187,v118,v119
buffer_store_dwordx4 v[184:187],v21,s[8:11],s74 offen offset:2048 sc1
v_mfma_f32_32x32x16_bf16 v[56:71],v[52:55],a[60:63],v[56:71]
ds_read_b128 v[40:43],v16 offset:20480
s_waitcnt vmcnt(13)
s_mov_b64 exec,1
buffer_store_dword v5,v1,s[8:11],s59 offen sc1
s_mov_b64 exec,-1
s_mov_b32 s59,2147483648
v_mfma_f32_32x32x16_bf16 v[72:87],v[52:55],a[220:223],v[72:87]
buffer_load_dwordx4 v1,s[8:11],s63 offen offset:3072 sc1 lds
s_add_u32 m0,s61,8192
s_add_u32 s63,s60,8192
s_lshl_b32 s82,s72,6
s_waitcnt lgkmcnt(3)
v_mfma_f32_32x32x16_bf16 v[56:71],v[24:27],a[64:67],v[56:71]
ds_read_b128 v[44:47],v17 offset:20480
s_add_u32 s82,s82,s73
s_lshl_b32 s82,s82,9
s_add_u32 s82,s82,s71
s_lshl_b32 s75,s69,2
v_mfma_f32_32x32x16_bf16 v[72:87],v[24:27],a[224:227],v[72:87]
s_add_u32 s82,s82,s75
s_add_u32 s82,s82,s39
v_pk_add_f32 v[156:157],v[156:157],v[166:167]
v_mfma_f32_32x32x16_bf16 v[56:71],v[28:31],a[68:71],v[56:71]
ds_read_b128 v[48:51],v16 offset:22528
buffer_load_dwordx4 v1,s[8:11],s63 offen sc1 lds
v_pk_add_f32 v[158:159],v[158:159],v[168:169]
v_mfma_f32_32x32x16_bf16 v[72:87],v[28:31],a[228:231],v[72:87]
v_pk_add_f32 v[160:161],v[160:161],v[170:171]
v_pk_add_f32 v[162:163],v[162:163],v[172:173]
s_waitcnt lgkmcnt(3)
v_mfma_f32_32x32x16_bf16 v[56:71],v[32:35],a[72:75],v[56:71]
ds_read_b128 v[52:55],v17 offset:22528
v_pk_add_f32 v[164:165],v[164:165],v[174:175]
v_pk_add_f32 v[156:157],v[156:157],v[158:159]
v_mfma_f32_32x32x16_bf16 v[72:87],v[32:35],a[232:235],v[72:87]
buffer_load_dwordx4 v1,s[8:11],s63 offen offset:1024 sc1 lds
s_mov_b32 s53,s33
s_mov_b32 s54,s34
s_cmp_eq_u32 s37,0
s_addc_u32 s32,s32,0
v_mfma_f32_32x32x16_bf16 v[56:71],v[36:39],a[76:79],v[56:71]
ds_read_b128 v[24:27],v16 offset:24576
s_min_u32 s62,s32,127
s_sub_u32 s60,s62,20
s_lshr_b32 s34,s60,1
s_and_b32 s33,s60,1
v_mfma_f32_32x32x16_bf16 v[72:87],v[36:39],a[236:239],v[72:87]
s_xor_b32 s33,s33,1
s_cmp_eq_u32 s33,0
s_cselect_b32 s61,20,0
s_add_u32 s34,s34,s61
s_sub_u32 s61,s60,44
s_waitcnt lgkmcnt(3)
v_mfma_f32_32x32x16_bf16 v[56:71],v[40:43],a[80:83],v[56:71]
ds_read_b128 v[28:31],v17 offset:24576
s_cmp_ge_u32 s60,88
s_cselect_b32 s34,s61,s34
s_cselect_b32 s33,1,s33
v_mfma_f32_32x32x16_bf16 v[72:87],v[40:43],a[240:243],v[72:87]
s_cmp_lt_u32 s62,20
s_cselect_b32 s34,s62,s34
s_cselect_b32 s33,0,s33
s_lshl_b32 s35,s33,6
s_add_u32 s35,s35,s34
s_lshl_b32 s35,s35,9
v_mfma_f32_32x32x16_bf16 v[56:71],v[44:47],a[84:87],v[56:71]
ds_read_b128 v[32:35],v16 offset:26624
s_add_u32 s35,s35,0
s_lshl_b32 s60,s33,5
s_add_u32 s60,s60,7
v_min_u32 v2,s60,v0
v_mfma_f32_32x32x16_bf16 v[72:87],v[44:47],a[244:247],v[72:87]
v_lshlrev_b32 v2,2,v2
v_pk_add_f32 v[160:161],v[160:161],v[162:163]
v_pk_add_f32 v[156:157],v[156:157],v[160:161]
s_waitcnt lgkmcnt(3)
v_mfma_f32_32x32x16_bf16 v[56:71],v[48:51],a[88:91],v[56:71]
ds_read_b128 v[36:39],v17 offset:26624
s_cmp_lg_u32 s46,0
s_cbranch_scc1 w0_254
buffer_load_dword v3,v2,s[8:11],s35 offen sc1
w0_254:
v_mfma_f32_32x32x16_bf16 v[72:87],v[48:51],a[248:251],v[72:87]
v_pk_add_f32 v[156:157],v[156:157],v[164:165]
v_mov_b32 v158,v156
v_mov_b32 v159,v157
s_nop 0
v_permlane32_swap_b32 v156,v158
v_permlane32_swap_b32 v157,v159
v_mfma_f32_32x32x16_bf16 v[56:71],v[52:55],a[92:95],v[56:71]
ds_read_b128 v[40:43],v16 offset:28672
v_add_f32 v176,v156,v158
v_add_f32 v177,v157,v159
v_mul_f32 v176,0x3acccccd,v176
v_mul_f32 v177,0x3acccccd,v177
v_mfma_f32_32x32x16_bf16 v[72:87],v[52:55],a[252:255],v[72:87]
v_fma_f32 v177,-v176,v176,v177
v_max_f32 v177,0,v177
v_cvt_pk_bf16_f32 v8,v176,v177
v_lshlrev_b32 v176,16,v8
v_and_b32 v177,0xffff0000,v8
s_waitcnt lgkmcnt(3)
v_mfma_f32_32x32x16_bf16 v[56:71],v[24:27],a[96:99],v[56:71]
ds_read_b128 v[44:47],v17 offset:28672
v_add_f32 v177,0x3727c5ac,v177
v_cvt_pk_bf16_f32 v8,v177,v177
v_lshlrev_b32 v177,16,v8
v_mfma_f32_32x32x16_bf16 v[72:87],v[24:27],v[192:195],v[72:87]
v_sqrt_f32 v177,v177
s_nop 0
v_cvt_pk_bf16_f32 v8,v177,v177
v_lshlrev_b32 v177,16,v8
v_rcp_f32 v177,v177
v_mfma_f32_32x32x16_bf16 v[56:71],v[28:31],a[100:103],v[56:71]
ds_read_b128 v[48:51],v16 offset:30720
s_cmp_eq_u32 s51,0
s_cselect_b64 s[76:77],-1,0
v_cndmask_b32 v176,v176,0,s[76:77]
v_cndmask_b32 v177,v177,1.0,s[76:77]
v_mfma_f32_32x32x16_bf16 v[72:87],v[28:31],v[196:199],v[72:87]
s_mov_b32 s72,s51
s_mov_b32 s73,s52
ds_write_b64 v190,v[176:177]
s_waitcnt lgkmcnt(4)
v_mfma_f32_32x32x16_bf16 v[56:71],v[32:35],a[104:107],v[56:71]
ds_read_b128 v[52:55],v17 offset:30720
ds_read_b128 v[124:127],v191 offset:0
ds_read_b128 v[128:131],v191 offset:16
v_mfma_f32_32x32x16_bf16 v[72:87],v[32:35],v[200:203],v[72:87]
ds_read_b128 v[132:135],v191 offset:64
ds_read_b128 v[136:139],v191 offset:80
ds_read_b128 v[140:143],v191 offset:128
v_mfma_f32_32x32x16_bf16 v[56:71],v[36:39],a[108:111],v[56:71]
ds_read_b128 v[24:27],v16 offset:32768
ds_read_b128 v[144:147],v191 offset:144
ds_read_b128 v[148:151],v191 offset:192
v_mfma_f32_32x32x16_bf16 v[72:87],v[36:39],v[204:207],v[72:87]
ds_read_b128 v[152:155],v191 offset:208
s_waitcnt lgkmcnt(12)
v_mfma_f32_32x32x16_bf16 v[56:71],v[40:43],a[112:115],v[56:71]
ds_read_b128 v[28:31],v17 offset:32768
v_mfma_f32_32x32x16_bf16 v[72:87],v[40:43],v[208:211],v[72:87]
v_mfma_f32_32x32x16_bf16 v[56:71],v[44:47],a[116:119],v[56:71]
ds_read_b128 v[32:35],v16 offset:34816
v_mfma_f32_32x32x16_bf16 v[72:87],v[44:47],v[212:215],v[72:87]
s_waitcnt lgkmcnt(11)
v_mfma_f32_32x32x16_bf16 v[56:71],v[48:51],a[120:123],v[56:71]
ds_read_b128 v[36:39],v17 offset:34816
v_mfma_f32_32x32x16_bf16 v[72:87],v[48:51],v[216:219],v[72:87]
v_mfma_f32_32x32x16_bf16 v[56:71],v[52:55],a[124:127],v[56:71]
ds_read_b128 v[40:43],v16 offset:36864
v_mfma_f32_32x32x16_bf16 v[72:87],v[52:55],v[220:223],v[72:87]
s_waitcnt vmcnt(0)
s_cmp_lg_u32 s46,0
s_cbranch_scc1 w0_255
v_cmp_eq_u32 vcc,0,v3
s_cmp_eq_u64 vcc,0
s_cselect_b32 s36,0,2147483648
s_cmp_lt_u32 s32,128
s_cselect_b32 s36,s36,2147483648
v_mov_b32 v23,s36
ds_write_b32 v22,v23
w0_255:
s_waitcnt lgkmcnt(3)
v_mfma_f32_32x32x16_bf16 v[56:71],v[24:27],a[128:131],v[56:71]
ds_read_b128 v[44:47],v17 offset:36864
s_mov_b64 exec,1
buffer_store_dword v5,v1,s[8:11],s82 offen sc1
s_mov_b64 exec,-1
s_mov_b32 s82,2147483648
v_mfma_f32_32x32x16_bf16 v[72:87],v[24:27],v[224:227],v[72:87]
v_mfma_f32_32x32x16_bf16 v[56:71],v[28:31],a[132:135],v[56:71]
ds_read_b128 v[48:51],v16 offset:38912
v_mfma_f32_32x32x16_bf16 v[72:87],v[28:31],v[228:231],v[72:87]
s_waitcnt lgkmcnt(3)
v_mfma_f32_32x32x16_bf16 v[56:71],v[32:35],a[136:139],v[56:71]
ds_read_b128 v[52:55],v17 offset:38912
v_mfma_f32_32x32x16_bf16 v[72:87],v[32:35],v[232:235],v[72:87]
s_waitcnt lgkmcnt(2)
s_barrier
ds_read_b32 v23,v22
v_mfma_f32_32x32x16_bf16 v[56:71],v[36:39],a[140:143],v[56:71]
ds_read_b128 v[24:27],v18 offset:0
v_mfma_f32_32x32x16_bf16 v[72:87],v[36:39],v[236:239],v[72:87]
v_mfma_f32_32x32x16_bf16 v[56:71],v[40:43],a[144:147],v[56:71]
ds_read_b128 v[28:31],v19 offset:0
v_mfma_f32_32x32x16_bf16 v[72:87],v[40:43],v[240:243],v[72:87]
v_mfma_f32_32x32x16_bf16 v[56:71],v[44:47],a[148:151],v[56:71]
ds_read_b128 v[32:35],v18 offset:2048
v_mfma_f32_32x32x16_bf16 v[72:87],v[44:47],v[244:247],v[72:87]
s_waitcnt lgkmcnt(4)
v_mfma_f32_32x32x16_bf16 v[56:71],v[48:51],a[152:155],v[56:71]
ds_read_b128 v[36:39],v19 offset:2048
s_waitcnt lgkmcnt(4)
v_readfirstlane_b32 s38,v23
v_mfma_f32_32x32x16_bf16 v[72:87],v[48:51],v[248:251],v[72:87]
v_mfma_f32_32x32x16_bf16 v[56:71],v[52:55],a[156:159],v[56:71]
ds_read_b128 v[40:43],v18 offset:4096
v_mfma_f32_32x32x16_bf16 v[72:87],v[52:55],v[252:255],v[72:87]
s_cmp_lg_u32 s37,0
s_cbranch_scc1 nf_256
s_cmp_lt_u32 s50,2
s_cbranch_scc1 now_257
s_mov_b32 s39,0
s_add_u32 s50,s50,1
s_sub_u32 s57,46080,s57
s_mov_b32 s51,s53
s_mov_b32 s52,s54
s_mov_b32 s37,s38
s_branch QKVV_B1
s_nop 0
now_257:
s_mov_b32 s55,0
s_branch nt_258
nf_256:
s_mov_b32 s55,2
s_cmp_lg_u32 s38,0
s_cbranch_scc1 nt_258
s_mov_b32 s55,1
s_mov_b32 s37,0
s_sub_u32 s66,46080,s57
s_lshl_b32 s60,s33,6
s_add_u32 s60,s60,s34
s_mul_i32 s60,s60,46080
s_add_u32 s60,s60,s37
s_add_u32 s60,s60,206569472
s_lshl_b32 s62,s46,10
s_add_u32 s62,s62,40960
s_add_u32 m0,s66,s62
s_add_u32 s63,s60,s62
buffer_load_dwordx4 v1,s[8:11],s63 offen sc1 lds
s_add_u32 m0,s66,45056
s_add_u32 s63,s60,45056
buffer_load_dwordx4 v1,s[8:11],s63 offen sc1 lds
s_mul_i32 s61,s46,10240
s_add_u32 s60,s60,s61
s_add_u32 s61,s61,s66
s_add_u32 m0,s61,0
s_add_u32 s63,s60,0
buffer_load_dwordx4 v1,s[8:11],s63 offen sc1 lds
buffer_load_dwordx4 v1,s[8:11],s63 offen offset:1024 sc1 lds
buffer_load_dwordx4 v1,s[8:11],s63 offen offset:2048 sc1 lds
buffer_load_dwordx4 v1,s[8:11],s63 offen offset:3072 sc1 lds
s_add_u32 m0,s61,4096
s_add_u32 s63,s60,4096
buffer_load_dwordx4 v1,s[8:11],s63 offen sc1 lds
buffer_load_dwordx4 v1,s[8:11],s63 offen offset:1024 sc1 lds
buffer_load_dwordx4 v1,s[8:11],s63 offen offset:2048 sc1 lds
buffer_load_dwordx4 v1,s[8:11],s63 offen offset:3072 sc1 lds
s_add_u32 m0,s61,8192
s_add_u32 s63,s60,8192
buffer_load_dwordx4 v1,s[8:11],s63 offen sc1 lds
buffer_load_dwordx4 v1,s[8:11],s63 offen offset:1024 sc1 lds
nt_258:
s_mov_b32 s39,0
s_mul_i32 s74,s73,393216
s_add_u32 s74,s74,s39
s_add_u32 s74,s74,s70
v_fma_f32 v56,-v124,v120,v56
v_fma_f32 v57,-v126,v120,v57
v_fma_f32 v58,-v128,v120,v58
v_fma_f32 v59,-v130,v120,v59
v_fma_f32 v64,-v140,v120,v64
v_fma_f32 v65,-v142,v120,v65
v_fma_f32 v66,-v144,v120,v66
v_fma_f32 v67,-v146,v120,v67
v_mul_f32 v56,v56,v125
v_mul_f32 v57,v57,v127
v_mul_f32 v58,v58,v129
v_mul_f32 v59,v59,v131
v_mul_f32 v64,v64,v141
v_mul_f32 v65,v65,v143
v_mul_f32 v66,v66,v145
v_mul_f32 v67,v67,v147
v_cvt_pk_bf16_f32 v180,v56,v57
v_cvt_pk_bf16_f32 v181,v58,v59
v_cvt_pk_bf16_f32 v182,v64,v65
v_cvt_pk_bf16_f32 v183,v66,v67
buffer_store_dwordx4 v[180:183],v20,s[8:11],s74 offen sc1
v_fma_f32 v60,-v132,v120,v60
v_fma_f32 v61,-v134,v120,v61
v_fma_f32 v62,-v136,v120,v62
v_fma_f32 v63,-v138,v120,v63
v_fma_f32 v68,-v148,v120,v68
v_fma_f32 v69,-v150,v120,v69
v_fma_f32 v70,-v152,v120,v70
v_fma_f32 v71,-v154,v120,v71
v_mul_f32 v60,v60,v133
v_mul_f32 v61,v61,v135
v_mul_f32 v62,v62,v137
v_mul_f32 v63,v63,v139
v_mul_f32 v68,v68,v149
v_mul_f32 v69,v69,v151
v_mul_f32 v70,v70,v153
v_mul_f32 v71,v71,v155
v_cvt_pk_bf16_f32 v184,v60,v61
v_cvt_pk_bf16_f32 v185,v62,v63
v_cvt_pk_bf16_f32 v186,v68,v69
v_cvt_pk_bf16_f32 v187,v70,v71
buffer_store_dwordx4 v[184:187],v21,s[8:11],s74 offen sc1
v_fma_f32 v72,-v124,v121,v72
v_fma_f32 v73,-v126,v121,v73
v_fma_f32 v74,-v128,v121,v74
v_fma_f32 v75,-v130,v121,v75
v_fma_f32 v80,-v140,v121,v80
v_fma_f32 v81,-v142,v121,v81
v_fma_f32 v82,-v144,v121,v82
v_fma_f32 v83,-v146,v121,v83
v_mul_f32 v72,v72,v125
v_mul_f32 v73,v73,v127
v_mul_f32 v74,v74,v129
v_mul_f32 v75,v75,v131
v_mul_f32 v80,v80,v141
v_mul_f32 v81,v81,v143
v_mul_f32 v82,v82,v145
v_mul_f32 v83,v83,v147
v_cvt_pk_bf16_f32 v180,v72,v73
v_cvt_pk_bf16_f32 v181,v74,v75
v_cvt_pk_bf16_f32 v182,v80,v81
v_cvt_pk_bf16_f32 v183,v82,v83
buffer_store_dwordx4 v[180:183],v20,s[8:11],s74 offen offset:2048 sc1
v_fma_f32 v76,-v132,v121,v76
v_fma_f32 v77,-v134,v121,v77
v_fma_f32 v78,-v136,v121,v78
v_fma_f32 v79,-v138,v121,v79
v_fma_f32 v84,-v148,v121,v84
v_fma_f32 v85,-v150,v121,v85
v_fma_f32 v86,-v152,v121,v86
v_fma_f32 v87,-v154,v121,v87
v_mul_f32 v76,v76,v133
v_mul_f32 v77,v77,v135
v_mul_f32 v78,v78,v137
v_mul_f32 v79,v79,v139
v_mul_f32 v84,v84,v149
v_mul_f32 v85,v85,v151
v_mul_f32 v86,v86,v153
v_mul_f32 v87,v87,v155
v_cvt_pk_bf16_f32 v184,v76,v77
v_cvt_pk_bf16_f32 v185,v78,v79
v_cvt_pk_bf16_f32 v186,v84,v85
v_cvt_pk_bf16_f32 v187,v86,v87
buffer_store_dwordx4 v[184:187],v21,s[8:11],s74 offen offset:2048 sc1
s_lshl_b32 s82,s72,6
s_add_u32 s82,s82,s73
s_lshl_b32 s82,s82,9
s_add_u32 s82,s82,s71
s_lshl_b32 s75,s69,2
s_add_u32 s82,s82,s75
s_add_u32 s82,s82,s39
s_mov_b32 s59,s82
s_mov_b32 s82,2147483648
s_mov_b32 s39,2147483648
s_add_u32 s50,s50,1
s_sub_u32 s57,46080,s57
s_mov_b32 s51,s53
s_mov_b32 s52,s54
s_mov_b32 s37,s38
s_cmp_eq_u32 s55,0
s_cbranch_scc1 QKVV_B1
s_cmp_eq_u32 s55,1
s_cbranch_scc1 QKVV_CD1
s_waitcnt vmcnt(0)
s_mov_b64 exec,1
buffer_store_dword v5,v1,s[8:11],s59 offen sc1
s_mov_b64 exec,-1
s_mov_b32 s59,2147483648
s_cmp_eq_u32 s50,128
s_cbranch_scc1 QKVV_END
s_branch QKVV_COLD1
QKVV_COLD1:
s_cmp_lg_u32 s46,0
s_cbranch_scc1 cp_259
fb_260:
buffer_load_dword v3,v2,s[8:11],s35 offen sc1
s_waitcnt vmcnt(0)
v_cmp_eq_u32 vcc,0,v3
s_nop 0
s_cbranch_vccz ok_261
s_sleep 7
s_sub_u32 s47,s47,1
s_cbranch_scc1 ABORT
s_branch fb_260
ok_261:
cp_259:
s_barrier
s_lshl_b32 s60,s33,6
s_add_u32 s60,s60,s34
s_mul_i32 s60,s60,46080
s_add_u32 s60,s60,206569472
s_lshl_b32 s62,s46,10
s_add_u32 s62,s62,40960
s_add_u32 m0,s57,s62
s_add_u32 s63,s60,s62
buffer_load_dwordx4 v1,s[8:11],s63 offen sc1 lds
s_add_u32 m0,s57,45056
s_add_u32 s63,s60,45056
buffer_load_dwordx4 v1,s[8:11],s63 offen sc1 lds
s_mul_i32 s61,s46,10240
s_add_u32 s60,s60,s61
s_add_u32 s61,s61,s57
s_add_u32 m0,s61,0
s_add_u32 s63,s60,0
buffer_load_dwordx4 v1,s[8:11],s63 offen sc1 lds
buffer_load_dwordx4 v1,s[8:11],s63 offen offset:1024 sc1 lds
buffer_load_dwordx4 v1,s[8:11],s63 offen offset:2048 sc1 lds
buffer_load_dwordx4 v1,s[8:11],s63 offen offset:3072 sc1 lds
s_add_u32 m0,s61,4096
s_add_u32 s63,s60,4096
buffer_load_dwordx4 v1,s[8:11],s63 offen sc1 lds
buffer_load_dwordx4 v1,s[8:11],s63 offen offset:1024 sc1 lds
buffer_load_dwordx4 v1,s[8:11],s63 offen offset:2048 sc1 lds
buffer_load_dwordx4 v1,s[8:11],s63 offen offset:3072 sc1 lds
s_add_u32 m0,s61,8192
s_add_u32 s63,s60,8192
buffer_load_dwordx4 v1,s[8:11],s63 offen sc1 lds
buffer_load_dwordx4 v1,s[8:11],s63 offen offset:1024 sc1 lds
QKVV_CD1:
s_mov_b32 s51,s33
s_mov_b32 s52,s34
s_add_u32 s32,s32,1
s_min_u32 s62,s32,127
s_sub_u32 s60,s62,20
s_lshr_b32 s34,s60,1
s_and_b32 s33,s60,1
s_xor_b32 s33,s33,1
s_cmp_eq_u32 s33,0
s_cselect_b32 s61,20,0
s_add_u32 s34,s34,s61
s_sub_u32 s61,s60,44
s_cmp_ge_u32 s60,88
s_cselect_b32 s34,s61,s34
s_cselect_b32 s33,1,s33
s_cmp_lt_u32 s62,20
s_cselect_b32 s34,s62,s34
s_cselect_b32 s33,0,s33
s_lshl_b32 s35,s33,6
s_add_u32 s35,s35,s34
s_lshl_b32 s35,s35,9
s_add_u32 s35,s35,0
s_lshl_b32 s60,s33,5
s_add_u32 s60,s60,7
v_min_u32 v2,s60,v0
v_lshlrev_b32 v2,2,v2
s_cmp_lg_u32 s46,0
s_cbranch_scc1 w0_262
buffer_load_dword v3,v2,s[8:11],s35 offen sc1
w0_262:
s_waitcnt vmcnt(0)
s_mov_b64 exec,1
buffer_store_dword v5,v1,s[8:11],s59 offen sc1
s_mov_b64 exec,-1
s_mov_b32 s59,2147483648
s_cmp_lg_u32 s46,0
s_cbranch_scc1 w0_263
v_cmp_eq_u32 vcc,0,v3
s_cmp_eq_u64 vcc,0
s_cselect_b32 s36,0,2147483648
s_cmp_lt_u32 s32,128
s_cselect_b32 s36,s36,2147483648
v_mov_b32 v23,s36
ds_write_b32 v22,v23
w0_263:
s_waitcnt lgkmcnt(0)
s_barrier
ds_read_b32 v23,v22
ds_read_b128 v[24:27],v18 offset:0
ds_read_b128 v[28:31],v19 offset:0
ds_read_b128 v[32:35],v18 offset:2048
ds_read_b128 v[36:39],v19 offset:2048
ds_read_b128 v[40:43],v18 offset:4096
s_waitcnt lgkmcnt(5)
v_readfirstlane_b32 s37,v23
s_nop 4
QKVV_B1:
s_waitcnt lgkmcnt(3)
v_mfma_f32_32x32x16_bf16 v[88:103],v[24:27],a[0:3],0
ds_read_b128 v[44:47],v19 offset:4096
v_add_u32 v189,s57,v188
v_mfma_f32_32x32x16_bf16 v[104:119],v[24:27],a[160:163],0
v_add_u32 v8,0x800,v189
s_sub_u32 s66,46080,s57
s_lshl_b32 s60,s33,6
s_add_u32 s60,s60,s34
s_mul_i32 s60,s60,46080
s_add_u32 s60,s60,s37
v_mfma_f32_32x32x16_bf16 v[88:103],v[28:31],a[4:7],v[88:103]
ds_read_b128 v[48:51],v18 offset:6144
ds_read2_b64 v[156:159],v189 offset0:0 offset1:32
s_add_u32 s60,s60,206569472
s_lshl_b32 s62,s46,10
v_mfma_f32_32x32x16_bf16 v[104:119],v[28:31],a[164:167],v[104:119]
ds_read2_b64 v[160:163],v189 offset0:64 offset1:96
s_add_u32 s62,s62,40960
s_add_u32 m0,s66,s62
s_add_u32 s63,s60,s62
s_waitcnt lgkmcnt(5)
v_mfma_f32_32x32x16_bf16 v[88:103],v[32:35],a[8:11],v[88:103]
ds_read_b128 v[52:55],v19 offset:6144
ds_read2_b64 v[164:167],v189 offset0:128 offset1:160
buffer_load_dwordx4 v1,s[8:11],s63 offen sc1 lds
v_mfma_f32_32x32x16_bf16 v[104:119],v[32:35],a[168:171],v[104:119]
ds_read2_b64 v[168:171],v189 offset0:192 offset1:224
s_add_u32 m0,s66,45056
s_add_u32 s63,s60,45056
s_mul_i32 s74,s73,393216
s_add_u32 s74,s74,s39
v_mfma_f32_32x32x16_bf16 v[88:103],v[36:39],a[12:15],v[88:103]
ds_read_b128 v[24:27],v18 offset:8192
ds_read2_b64 v[172:175],v8 offset0:0 offset1:32
s_add_u32 s74,s74,s70
v_fma_f32 v56,-v124,v120,v56
v_mfma_f32_32x32x16_bf16 v[104:119],v[36:39],a[172:175],v[104:119]
buffer_load_dwordx4 v1,s[8:11],s63 offen sc1 lds
s_mul_i32 s61,s46,10240
s_add_u32 s60,s60,s61
s_add_u32 s61,s61,s66
s_waitcnt lgkmcnt(8)
v_mfma_f32_32x32x16_bf16 v[88:103],v[40:43],a[16:19],v[88:103]
ds_read_b128 v[28:31],v19 offset:8192
s_add_u32 m0,s61,0
s_add_u32 s63,s60,0
v_fma_f32 v57,-v126,v120,v57
v_fma_f32 v58,-v128,v120,v58
v_mfma_f32_32x32x16_bf16 v[104:119],v[40:43],a[176:179],v[104:119]
v_fma_f32 v59,-v130,v120,v59
v_fma_f32 v64,-v140,v120,v64
v_fma_f32 v65,-v142,v120,v65
v_fma_f32 v66,-v144,v120,v66
v_fma_f32 v67,-v146,v120,v67
v_mul_f32 v56,v56,v125
v_mfma_f32_32x32x16_bf16 v[88:103],v[44:47],a[20:23],v[88:103]
ds_read_b128 v[32:35],v18 offset:10240
buffer_load_dwordx4 v1,s[8:11],s63 offen sc1 lds
v_mul_f32 v57,v57,v127
v_mul_f32 v58,v58,v129
v_mfma_f32_32x32x16_bf16 v[104:119],v[44:47],a[180:183],v[104:119]
v_mul_f32 v59,v59,v131
v_mul_f32 v64,v64,v141
v_mul_f32 v65,v65,v143
v_mul_f32 v66,v66,v145
v_mul_f32 v67,v67,v147
s_waitcnt lgkmcnt(6)
v_mfma_f32_32x32x16_bf16 v[88:103],v[48:51],a[24:27],v[88:103]
ds_read_b128 v[36:39],v19 offset:10240
v_cvt_pk_bf16_f32 v180,v56,v57
v_cvt_pk_bf16_f32 v181,v58,v59
v_cvt_pk_bf16_f32 v182,v64,v65
v_cvt_pk_bf16_f32 v183,v66,v67
v_mfma_f32_32x32x16_bf16 v[104:119],v[48:51],a[184:187],v[104:119]
buffer_load_dwordx4 v1,s[8:11],s63 offen offset:1024 sc1 lds
buffer_store_dwordx4 v[180:183],v20,s[8:11],s74 offen sc1
v_fma_f32 v60,-v132,v120,v60
v_fma_f32 v61,-v134,v120,v61
v_mfma_f32_32x32x16_bf16 v[88:103],v[52:55],a[28:31],v[88:103]
ds_read_b128 v[40:43],v18 offset:12288
v_fma_f32 v62,-v136,v120,v62
v_fma_f32 v63,-v138,v120,v63
v_fma_f32 v68,-v148,v120,v68
v_fma_f32 v69,-v150,v120,v69
v_mfma_f32_32x32x16_bf16 v[104:119],v[52:55],a[188:191],v[104:119]
v_fma_f32 v70,-v152,v120,v70
v_fma_f32 v71,-v154,v120,v71
v_mul_f32 v60,v60,v133
v_mul_f32 v61,v61,v135
v_mul_f32 v62,v62,v137
s_waitcnt lgkmcnt(3)
v_mfma_f32_32x32x16_bf16 v[88:103],v[24:27],a[32:35],v[88:103]
ds_read_b128 v[44:47],v19 offset:12288
buffer_load_dwordx4 v1,s[8:11],s63 offen offset:2048 sc1 lds
v_mul_f32 v63,v63,v139
v_mul_f32 v68,v68,v149
v_mfma_f32_32x32x16_bf16 v[104:119],v[24:27],a[192:195],v[104:119]
v_mul_f32 v69,v69,v151
v_mul_f32 v70,v70,v153
v_mul_f32 v71,v71,v155
v_cvt_pk_bf16_f32 v184,v60,v61
v_cvt_pk_bf16_f32 v185,v62,v63
v_cvt_pk_bf16_f32 v186,v68,v69
v_mfma_f32_32x32x16_bf16 v[88:103],v[28:31],a[36:39],v[88:103]
ds_read_b128 v[48:51],v18 offset:14336
v_cvt_pk_bf16_f32 v187,v70,v71
buffer_store_dwordx4 v[184:187],v21,s[8:11],s74 offen sc1
v_fma_f32 v72,-v124,v121,v72
v_mfma_f32_32x32x16_bf16 v[104:119],v[28:31],a[196:199],v[104:119]
buffer_load_dwordx4 v1,s[8:11],s63 offen offset:3072 sc1 lds
s_add_u32 m0,s61,4096
s_add_u32 s63,s60,4096
v_fma_f32 v73,-v126,v121,v73
s_waitcnt lgkmcnt(3)
v_mfma_f32_32x32x16_bf16 v[88:103],v[32:35],a[40:43],v[88:103]
ds_read_b128 v[52:55],v19 offset:14336
v_fma_f32 v74,-v128,v121,v74
v_fma_f32 v75,-v130,v121,v75
v_fma_f32 v80,-v140,v121,v80
v_fma_f32 v81,-v142,v121,v81
v_mfma_f32_32x32x16_bf16 v[104:119],v[32:35],a[200:203],v[104:119]
v_fma_f32 v82,-v144,v121,v82
v_fma_f32 v83,-v146,v121,v83
v_mul_f32 v72,v72,v125
v_mul_f32 v73,v73,v127
v_mul_f32 v74,v74,v129
v_mul_f32 v75,v75,v131
v_mfma_f32_32x32x16_bf16 v[88:103],v[36:39],a[44:47],v[88:103]
ds_read_b128 v[24:27],v18 offset:16384
buffer_load_dwordx4 v1,s[8:11],s63 offen sc1 lds
v_mul_f32 v80,v80,v141
v_mul_f32 v81,v81,v143
v_mfma_f32_32x32x16_bf16 v[104:119],v[36:39],a[204:207],v[104:119]
v_mul_f32 v82,v82,v145
v_mul_f32 v83,v83,v147
v_cvt_pk_bf16_f32 v180,v72,v73
v_cvt_pk_bf16_f32 v181,v74,v75
v_cvt_pk_bf16_f32 v182,v80,v81
s_waitcnt lgkmcnt(3)
v_mfma_f32_32x32x16_bf16 v[88:103],v[40:43],a[48:51],v[88:103]
ds_read_b128 v[28:31],v19 offset:16384
v_cvt_pk_bf16_f32 v183,v82,v83
buffer_store_dwordx4 v[180:183],v20,s[8:11],s74 offen offset:2048 sc1
v_fma_f32 v76,-v132,v121,v76
v_mfma_f32_32x32x16_bf16 v[104:119],v[40:43],a[208:211],v[104:119]
buffer_load_dwordx4 v1,s[8:11],s63 offen offset:1024 sc1 lds
v_fma_f32 v77,-v134,v121,v77
v_fma_f32 v78,-v136,v121,v78
v_fma_f32 v79,-v138,v121,v79
v_fma_f32 v84,-v148,v121,v84
v_mfma_f32_32x32x16_bf16 v[88:103],v[44:47],a[52:55],v[88:103]
ds_read_b128 v[32:35],v18 offset:18432
v_fma_f32 v85,-v150,v121,v85
v_fma_f32 v86,-v152,v121,v86
v_fma_f32 v87,-v154,v121,v87
v_mul_f32 v76,v76,v133
v_mfma_f32_32x32x16_bf16 v[104:119],v[44:47],a[212:215],v[104:119]
v_mul_f32 v77,v77,v135
v_mul_f32 v78,v78,v137
v_mul_f32 v79,v79,v139
v_mul_f32 v84,v84,v149
v_mul_f32 v85,v85,v151
s_waitcnt lgkmcnt(3)
v_mfma_f32_32x32x16_bf16 v[88:103],v[48:51],a[56:59],v[88:103]
ds_read_b128 v[36:39],v19 offset:18432
buffer_load_dwordx4 v1,s[8:11],s63 offen offset:2048 sc1 lds
v_mul_f32 v86,v86,v153
v_mul_f32 v87,v87,v155
v_mfma_f32_32x32x16_bf16 v[104:119],v[48:51],a[216:219],v[104:119]
v_cvt_pk_bf16_f32 v184,v76,v77
v_cvt_pk_bf16_f32 v185,v78,v79
v_cvt_pk_bf16_f32 v186,v84,v85
v_cvt_pk_bf16_f32 v187,v86,v87
buffer_store_dwordx4 v[184:187],v21,s[8:11],s74 offen offset:2048 sc1
v_mfma_f32_32x32x16_bf16 v[88:103],v[52:55],a[60:63],v[88:103]
ds_read_b128 v[40:43],v18 offset:20480
s_waitcnt vmcnt(13)
s_mov_b64 exec,1
buffer_store_dword v5,v1,s[8:11],s59 offen sc1
s_mov_b64 exec,-1
s_mov_b32 s59,2147483648
v_mfma_f32_32x32x16_bf16 v[104:119],v[52:55],a[220:223],v[104:119]
buffer_load_dwordx4 v1,s[8:11],s63 offen offset:3072 sc1 lds
s_add_u32 m0,s61,8192
s_add_u32 s63,s60,8192
s_lshl_b32 s82,s72,6
s_waitcnt lgkmcnt(3)
v_mfma_f32_32x32x16_bf16 v[88:103],v[24:27],a[64:67],v[88:103]
ds_read_b128 v[44:47],v19 offset:20480
s_add_u32 s82,s82,s73
s_lshl_b32 s82,s82,9
s_add_u32 s82,s82,s71
s_lshl_b32 s75,s69,2
v_mfma_f32_32x32x16_bf16 v[104:119],v[24:27],a[224:227],v[104:119]
s_add_u32 s82,s82,s75
s_add_u32 s82,s82,s39
v_pk_add_f32 v[156:157],v[156:157],v[166:167]
v_mfma_f32_32x32x16_bf16 v[88:103],v[28:31],a[68:71],v[88:103]
ds_read_b128 v[48:51],v18 offset:22528
buffer_load_dwordx4 v1,s[8:11],s63 offen sc1 lds
v_pk_add_f32 v[158:159],v[158:159],v[168:169]
v_mfma_f32_32x32x16_bf16 v[104:119],v[28:31],a[228:231],v[104:119]
v_pk_add_f32 v[160:161],v[160:161],v[170:171]
v_pk_add_f32 v[162:163],v[162:163],v[172:173]
s_waitcnt lgkmcnt(3)
v_mfma_f32_32x32x16_bf16 v[88:103],v[32:35],a[72:75],v[88:103]
ds_read_b128 v[52:55],v19 offset:22528
v_pk_add_f32 v[164:165],v[164:165],v[174:175]
v_pk_add_f32 v[156:157],v[156:157],v[158:159]
v_mfma_f32_32x32x16_bf16 v[104:119],v[32:35],a[232:235],v[104:119]
buffer_load_dwordx4 v1,s[8:11],s63 offen offset:1024 sc1 lds
s_mov_b32 s53,s33
s_mov_b32 s54,s34
s_cmp_eq_u32 s37,0
s_addc_u32 s32,s32,0
v_mfma_f32_32x32x16_bf16 v[88:103],v[36:39],a[76:79],v[88:103]
ds_read_b128 v[24:27],v18 offset:24576
s_min_u32 s62,s32,127
s_sub_u32 s60,s62,20
s_lshr_b32 s34,s60,1
s_and_b32 s33,s60,1
v_mfma_f32_32x32x16_bf16 v[104:119],v[36:39],a[236:239],v[104:119]
s_xor_b32 s33,s33,1
s_cmp_eq_u32 s33,0
s_cselect_b32 s61,20,0
s_add_u32 s34,s34,s61
s_sub_u32 s61,s60,44
s_waitcnt lgkmcnt(3)
v_mfma_f32_32x32x16_bf16 v[88:103],v[40:43],a[80:83],v[88:103]
ds_read_b128 v[28:31],v19 offset:24576
s_cmp_ge_u32 s60,88
s_cselect_b32 s34,s61,s34
s_cselect_b32 s33,1,s33
v_mfma_f32_32x32x16_bf16 v[104:119],v[40:43],a[240:243],v[104:119]
s_cmp_lt_u32 s62,20
s_cselect_b32 s34,s62,s34
s_cselect_b32 s33,0,s33
s_lshl_b32 s35,s33,6
s_add_u32 s35,s35,s34
s_lshl_b32 s35,s35,9
v_mfma_f32_32x32x16_bf16 v[88:103],v[44:47],a[84:87],v[88:103]
ds_read_b128 v[32:35],v18 offset:26624
s_add_u32 s35,s35,0
s_lshl_b32 s60,s33,5
s_add_u32 s60,s60,7
v_min_u32 v2,s60,v0
v_mfma_f32_32x32x16_bf16 v[104:119],v[44:47],a[244:247],v[104:119]
v_lshlrev_b32 v2,2,v2
v_pk_add_f32 v[160:161],v[160:161],v[162:163]
v_pk_add_f32 v[156:157],v[156:157],v[160:161]
s_waitcnt lgkmcnt(3)
v_mfma_f32_32x32x16_bf16 v[88:103],v[48:51],a[88:91],v[88:103]
ds_read_b128 v[36:39],v19 offset:26624
s_cmp_lg_u32 s46,0
s_cbranch_scc1 w0_264
buffer_load_dword v3,v2,s[8:11],s35 offen sc1
w0_264:
v_mfma_f32_32x32x16_bf16 v[104:119],v[48:51],a[248:251],v[104:119]
v_pk_add_f32 v[156:157],v[156:157],v[164:165]
v_mov_b32 v158,v156
v_mov_b32 v159,v157
s_nop 0
v_permlane32_swap_b32 v156,v158
v_permlane32_swap_b32 v157,v159
v_mfma_f32_32x32x16_bf16 v[88:103],v[52:55],a[92:95],v[88:103]
ds_read_b128 v[40:43],v18 offset:28672
v_add_f32 v176,v156,v158
v_add_f32 v177,v157,v159
v_mul_f32 v176,0x3acccccd,v176
v_mul_f32 v177,0x3acccccd,v177
v_mfma_f32_32x32x16_bf16 v[104:119],v[52:55],a[252:255],v[104:119]
v_fma_f32 v177,-v176,v176,v177
v_max_f32 v177,0,v177
v_cvt_pk_bf16_f32 v8,v176,v177
v_lshlrev_b32 v176,16,v8
v_and_b32 v177,0xffff0000,v8
s_waitcnt lgkmcnt(3)
v_mfma_f32_32x32x16_bf16 v[88:103],v[24:27],a[96:99],v[88:103]
ds_read_b128 v[44:47],v19 offset:28672
v_add_f32 v177,0x3727c5ac,v177
v_cvt_pk_bf16_f32 v8,v177,v177
v_lshlrev_b32 v177,16,v8
v_mfma_f32_32x32x16_bf16 v[104:119],v[24:27],v[192:195],v[104:119]
v_sqrt_f32 v177,v177
s_nop 0
v_cvt_pk_bf16_f32 v8,v177,v177
v_lshlrev_b32 v177,16,v8
v_rcp_f32 v177,v177
v_mfma_f32_32x32x16_bf16 v[88:103],v[28:31],a[100:103],v[88:103]
ds_read_b128 v[48:51],v18 offset:30720
s_cmp_eq_u32 s51,0
s_cselect_b64 s[76:77],-1,0
v_cndmask_b32 v176,v176,0,s[76:77]
v_cndmask_b32 v177,v177,1.0,s[76:77]
v_mfma_f32_32x32x16_bf16 v[104:119],v[28:31],v[196:199],v[104:119]
s_mov_b32 s72,s51
s_mov_b32 s73,s52
ds_write_b64 v190,v[176:177]
s_waitcnt lgkmcnt(4)
v_mfma_f32_32x32x16_bf16 v[88:103],v[32:35],a[104:107],v[88:103]
ds_read_b128 v[52:55],v19 offset:30720
ds_read_b128 v[124:127],v191 offset:0
ds_read_b128 v[128:131],v191 offset:16
v_mfma_f32_32x32x16_bf16 v[104:119],v[32:35],v[200:203],v[104:119]
ds_read_b128 v[132:135],v191 offset:64
ds_read_b128 v[136:139],v191 offset:80
ds_read_b128 v[140:143],v191 offset:128
v_mfma_f32_32x32x16_bf16 v[88:103],v[36:39],a[108:111],v[88:103]
ds_read_b128 v[24:27],v18 offset:32768
ds_read_b128 v[144:147],v191 offset:144
ds_read_b128 v[148:151],v191 offset:192
v_mfma_f32_32x32x16_bf16 v[104:119],v[36:39],v[204:207],v[104:119]
ds_read_b128 v[152:155],v191 offset:208
s_waitcnt lgkmcnt(12)
v_mfma_f32_32x32x16_bf16 v[88:103],v[40:43],a[112:115],v[88:103]
ds_read_b128 v[28:31],v19 offset:32768
v_mfma_f32_32x32x16_bf16 v[104:119],v[40:43],v[208:211],v[104:119]
v_mfma_f32_32x32x16_bf16 v[88:103],v[44:47],a[116:119],v[88:103]
ds_read_b128 v[32:35],v18 offset:34816
v_mfma_f32_32x32x16_bf16 v[104:119],v[44:47],v[212:215],v[104:119]
s_waitcnt lgkmcnt(11)
v_mfma_f32_32x32x16_bf16 v[88:103],v[48:51],a[120:123],v[88:103]
ds_read_b128 v[36:39],v19 offset:34816
v_mfma_f32_32x32x16_bf16 v[104:119],v[48:51],v[216:219],v[104:119]
v_mfma_f32_32x32x16_bf16 v[88:103],v[52:55],a[124:127],v[88:103]
ds_read_b128 v[40:43],v18 offset:36864
v_mfma_f32_32x32x16_bf16 v[104:119],v[52:55],v[220:223],v[104:119]
s_waitcnt vmcnt(0)
s_cmp_lg_u32 s46,0
s_cbranch_scc1 w0_265
v_cmp_eq_u32 vcc,0,v3
s_cmp_eq_u64 vcc,0
s_cselect_b32 s36,0,2147483648
s_cmp_lt_u32 s32,128
s_cselect_b32 s36,s36,2147483648
v_mov_b32 v23,s36
ds_write_b32 v22,v23
w0_265:
s_waitcnt lgkmcnt(3)
v_mfma_f32_32x32x16_bf16 v[88:103],v[24:27],a[128:131],v[88:103]
ds_read_b128 v[44:47],v19 offset:36864
s_mov_b64 exec,1
buffer_store_dword v5,v1,s[8:11],s82 offen sc1
s_mov_b64 exec,-1
s_mov_b32 s82,2147483648
v_mfma_f32_32x32x16_bf16 v[104:119],v[24:27],v[224:227],v[104:119]
v_mfma_f32_32x32x16_bf16 v[88:103],v[28:31],a[132:135],v[88:103]
ds_read_b128 v[48:51],v18 offset:38912
v_mfma_f32_32x32x16_bf16 v[104:119],v[28:31],v[228:231],v[104:119]
s_waitcnt lgkmcnt(3)
v_mfma_f32_32x32x16_bf16 v[88:103],v[32:35],a[136:139],v[88:103]
ds_read_b128 v[52:55],v19 offset:38912
v_mfma_f32_32x32x16_bf16 v[104:119],v[32:35],v[232:235],v[104:119]
s_waitcnt lgkmcnt(2)
s_barrier
ds_read_b32 v23,v22
v_mfma_f32_32x32x16_bf16 v[88:103],v[36:39],a[140:143],v[88:103]
ds_read_b128 v[24:27],v16 offset:0
v_mfma_f32_32x32x16_bf16 v[104:119],v[36:39],v[236:239],v[104:119]
v_mfma_f32_32x32x16_bf16 v[88:103],v[40:43],a[144:147],v[88:103]
ds_read_b128 v[28:31],v17 offset:0
v_mfma_f32_32x32x16_bf16 v[104:119],v[40:43],v[240:243],v[104:119]
v_mfma_f32_32x32x16_bf16 v[88:103],v[44:47],a[148:151],v[88:103]
ds_read_b128 v[32:35],v16 offset:2048
v_mfma_f32_32x32x16_bf16 v[104:119],v[44:47],v[244:247],v[104:119]
s_waitcnt lgkmcnt(4)
v_mfma_f32_32x32x16_bf16 v[88:103],v[48:51],a[152:155],v[88:103]
ds_read_b128 v[36:39],v17 offset:2048
s_waitcnt lgkmcnt(4)
v_readfirstlane_b32 s38,v23
v_mfma_f32_32x32x16_bf16 v[104:119],v[48:51],v[248:251],v[104:119]
v_mfma_f32_32x32x16_bf16 v[88:103],v[52:55],a[156:159],v[88:103]
ds_read_b128 v[40:43],v16 offset:4096
v_mfma_f32_32x32x16_bf16 v[104:119],v[52:55],v[252:255],v[104:119]
s_cmp_lg_u32 s37,0
s_cbranch_scc1 nf_266
s_cmp_lt_u32 s50,2
s_cbranch_scc1 now_267
s_mov_b32 s39,0
s_add_u32 s50,s50,1
s_sub_u32 s57,46080,s57
s_mov_b32 s51,s53
s_mov_b32 s52,s54
s_mov_b32 s37,s38
s_branch QKVV_B0
s_nop 0
now_267:
s_mov_b32 s55,0
s_branch nt_268
nf_266:
s_mov_b32 s55,2
s_cmp_lg_u32 s38,0
s_cbranch_scc1 nt_268
s_mov_b32 s55,1
s_mov_b32 s37,0
s_sub_u32 s66,46080,s57
s_lshl_b32 s60,s33,6
s_add_u32 s60,s60,s34
s_mul_i32 s60,s60,46080
s_add_u32 s60,s60,s37
s_add_u32 s60,s60,206569472
s_lshl_b32 s62,s46,10
s_add_u32 s62,s62,40960
s_add_u32 m0,s66,s62
s_add_u32 s63,s60,s62
buffer_load_dwordx4 v1,s[8:11],s63 offen sc1 lds
s_add_u32 m0,s66,45056
s_add_u32 s63,s60,45056
buffer_load_dwordx4 v1,s[8:11],s63 offen sc1 lds
s_mul_i32 s61,s46,10240
s_add_u32 s60,s60,s61
s_add_u32 s61,s61,s66
s_add_u32 m0,s61,0
s_add_u32 s63,s60,0
buffer_load_dwordx4 v1,s[8:11],s63 offen sc1 lds
buffer_load_dwordx4 v1,s[8:11],s63 offen offset:1024 sc1 lds
buffer_load_dwordx4 v1,s[8:11],s63 offen offset:2048 sc1 lds
buffer_load_dwordx4 v1,s[8:11],s63 offen offset:3072 sc1 lds
s_add_u32 m0,s61,4096
s_add_u32 s63,s60,4096
buffer_load_dwordx4 v1,s[8:11],s63 offen sc1 lds
buffer_load_dwordx4 v1,s[8:11],s63 offen offset:1024 sc1 lds
buffer_load_dwordx4 v1,s[8:11],s63 offen offset:2048 sc1 lds
buffer_load_dwordx4 v1,s[8:11],s63 offen offset:3072 sc1 lds
s_add_u32 m0,s61,8192
s_add_u32 s63,s60,8192
buffer_load_dwordx4 v1,s[8:11],s63 offen sc1 lds
buffer_load_dwordx4 v1,s[8:11],s63 offen offset:1024 sc1 lds
nt_268:
s_mov_b32 s39,0
s_mul_i32 s74,s73,393216
s_add_u32 s74,s74,s39
s_add_u32 s74,s74,s70
v_fma_f32 v88,-v124,v120,v88
v_fma_f32 v89,-v126,v120,v89
v_fma_f32 v90,-v128,v120,v90
v_fma_f32 v91,-v130,v120,v91
v_fma_f32 v96,-v140,v120,v96
v_fma_f32 v97,-v142,v120,v97
v_fma_f32 v98,-v144,v120,v98
v_fma_f32 v99,-v146,v120,v99
v_mul_f32 v88,v88,v125
v_mul_f32 v89,v89,v127
v_mul_f32 v90,v90,v129
v_mul_f32 v91,v91,v131
v_mul_f32 v96,v96,v141
v_mul_f32 v97,v97,v143
v_mul_f32 v98,v98,v145
v_mul_f32 v99,v99,v147
v_cvt_pk_bf16_f32 v180,v88,v89
v_cvt_pk_bf16_f32 v181,v90,v91
v_cvt_pk_bf16_f32 v182,v96,v97
v_cvt_pk_bf16_f32 v183,v98,v99
buffer_store_dwordx4 v[180:183],v20,s[8:11],s74 offen sc1
v_fma_f32 v92,-v132,v120,v92
v_fma_f32 v93,-v134,v120,v93
v_fma_f32 v94,-v136,v120,v94
v_fma_f32 v95,-v138,v120,v95
v_fma_f32 v100,-v148,v120,v100
v_fma_f32 v101,-v150,v120,v101
v_fma_f32 v102,-v152,v120,v102
v_fma_f32 v103,-v154,v120,v103
v_mul_f32 v92,v92,v133
v_mul_f32 v93,v93,v135
v_mul_f32 v94,v94,v137
v_mul_f32 v95,v95,v139
v_mul_f32 v100,v100,v149
v_mul_f32 v101,v101,v151
v_mul_f32 v102,v102,v153
v_mul_f32 v103,v103,v155
v_cvt_pk_bf16_f32 v184,v92,v93
v_cvt_pk_bf16_f32 v185,v94,v95
v_cvt_pk_bf16_f32 v186,v100,v101
v_cvt_pk_bf16_f32 v187,v102,v103
buffer_store_dwordx4 v[184:187],v21,s[8:11],s74 offen sc1
v_fma_f32 v104,-v124,v121,v104
v_fma_f32 v105,-v126,v121,v105
v_fma_f32 v106,-v128,v121,v106
v_fma_f32 v107,-v130,v121,v107
v_fma_f32 v112,-v140,v121,v112
v_fma_f32 v113,-v142,v121,v113
v_fma_f32 v114,-v144,v121,v114
v_fma_f32 v115,-v146,v121,v115
v_mul_f32 v104,v104,v125
v_mul_f32 v105,v105,v127
v_mul_f32 v106,v106,v129
v_mul_f32 v107,v107,v131
v_mul_f32 v112,v112,v141
v_mul_f32 v113,v113,v143
v_mul_f32 v114,v114,v145
v_mul_f32 v115,v115,v147
v_cvt_pk_bf16_f32 v180,v104,v105
v_cvt_pk_bf16_f32 v181,v106,v107
v_cvt_pk_bf16_f32 v182,v112,v113
v_cvt_pk_bf16_f32 v183,v114,v115
buffer_store_dwordx4 v[180:183],v20,s[8:11],s74 offen offset:2048 sc1
v_fma_f32 v108,-v132,v121,v108
v_fma_f32 v109,-v134,v121,v109
v_fma_f32 v110,-v136,v121,v110
v_fma_f32 v111,-v138,v121,v111
v_fma_f32 v116,-v148,v121,v116
v_fma_f32 v117,-v150,v121,v117
v_fma_f32 v118,-v152,v121,v118
v_fma_f32 v119,-v154,v121,v119
v_mul_f32 v108,v108,v133
v_mul_f32 v109,v109,v135
v_mul_f32 v110,v110,v137
v_mul_f32 v111,v111,v139
v_mul_f32 v116,v116,v149
v_mul_f32 v117,v117,v151
v_mul_f32 v118,v118,v153
v_mul_f32 v119,v119,v155
v_cvt_pk_bf16_f32 v184,v108,v109
v_cvt_pk_bf16_f32 v185,v110,v111
v_cvt_pk_bf16_f32 v186,v116,v117
v_cvt_pk_bf16_f32 v187,v118,v119
buffer_store_dwordx4 v[184:187],v21,s[8:11],s74 offen offset:2048 sc1
s_lshl_b32 s82,s72,6
s_add_u32 s82,s82,s73
s_lshl_b32 s82,s82,9
s_add_u32 s82,s82,s71
s_lshl_b32 s75,s69,2
s_add_u32 s82,s82,s75
s_add_u32 s82,s82,s39
s_mov_b32 s59,s82
s_mov_b32 s82,2147483648
s_mov_b32 s39,2147483648
s_add_u32 s50,s50,1
s_sub_u32 s57,46080,s57
s_mov_b32 s51,s53
s_mov_b32 s52,s54
s_mov_b32 s37,s38
s_cmp_eq_u32 s55,0
s_cbranch_scc1 QKVV_B0
s_cmp_eq_u32 s55,1
s_cbranch_scc1 QKVV_CD0
s_waitcnt vmcnt(0)
s_mov_b64 exec,1
buffer_store_dword v5,v1,s[8:11],s59 offen sc1
s_mov_b64 exec,-1
s_mov_b32 s59,2147483648
s_cmp_eq_u32 s50,128
s_cbranch_scc1 QKVV_END
s_branch QKVV_COLD0
QKVV_END:
s_endpgm
ROLE_ATT:
v_lshlrev_b32 v1,4,v0
v_mov_b32 v5,1
s_lshl_b32 s56,s48,2
s_add_u32 s56,s56,s46
v_bfe_u32 v6,v0,2,2
v_lshrrev_b32 v7,4,v0
v_add_u32 v7,v6,v7
v_and_b32 v7,3,v7
v_and_b32 v15,3,v0
v_lshlrev_b32 v15,4,v15
v_lshl_add_u32 v15,v7,6,v15
v_lshl_add_u32 v15,v6,8,v15
s_mov_b32 s68,s48
s_and_b32 s51,s46,1
s_lshr_b32 s86,s46,1
s_lshr_b32 s87,s68,3
s_lshl_b32 s87,s87,5
s_and_b32 s60,s68,7
s_add_u32 s87,s87,s60
v_lshlrev_b32 v229,3,v0
v_mov_b32 v230,0xff800000
s_mov_b32 s80,-1
s_mov_b32 s81,0
s_mov_b32 s84,0x3d93cd3a
s_mov_b32 s85,0x3fb8aa3b
v_min_u32 v6,8,v0
v_mul_u32_u24 v7,86,v6
v_lshrrev_b32 v7,8,v7
v_mul_u32_u24 v8,3,v7
v_sub_u32 v6,v6,v8
s_mul_i32 s60,s68,3
v_add_u32 v6,s60,v6
v_lshlrev_b32 v2,2,v6
v_lshl_add_u32 v2,v7,16,v2
v_min_u32 v228,2,v0
v_lshlrev_b32 v228,2,v228
v_lshrrev_b32 v6,4,v0
v_lshlrev_b32 v6,2,v6
v_and_b32 v7,15,v0
v_add_u32 v8,0,v6
v_cmp_le_u32 s[72:73],v8,v7
v_add_u32 v8,1,v6
v_cmp_le_u32 s[74:75],v8,v7
v_add_u32 v8,2,v6
v_cmp_le_u32 s[76:77],v8,v7
v_add_u32 v8,3,v6
v_cmp_le_u32 s[78:79],v8,v7
s_mul_i32 s71,s68,12288
s_mul_i32 s60,s51,14
s_mul_i32 s69,s60,589824
s_mul_i32 s61,s68,18432
s_add_u32 s69,s69,s61
s_mul_i32 s61,s51,9216
s_add_u32 s69,s69,s61
s_add_u32 s69,s69,24120320
s_mul_i32 s70,s60,2048
s_lshl_b32 s61,s68,6
s_add_u32 s70,s70,s61
s_add_u32 s70,s70,688128
s_mul_i32 s69,s51,12582912
s_mul_i32 s61,s68,6144
s_add_u32 s69,s69,s61
s_add_u32 s69,s69,24117248
s_mul_i32 s70,s51,65536
s_lshl_b32 s61,s68,5
s_add_u32 s70,s70,s61
s_add_u32 s70,s70,688128
s_waitcnt vmcnt(0)
s_barrier
s_cmp_lg_u32 s46,0
s_cbranch_scc1 arr_269
v_mov_b32 v6,1
s_lshl_b32 s3,s49,2
v_mov_b32 v7,s3
s_mov_b64 exec,1
buffer_atomic_add v6,v7,s[12:15],0 offen sc1
s_mov_b64 exec,-1
arr_269:
s_mov_b32 s66,s56
s_and_b32 s53,s66,7
s_lshr_b32 s54,s66,3
v_lshrrev_b32 v6,4,v0
v_bfe_u32 v7,v0,2,2
v_and_b32 v8,3,v0
s_and_b32 s61,s53,3
s_lshl_b32 s60,s53,8
v_lshlrev_b32 v132,11,v6
v_lshrrev_b32 v9,1,v6
v_lshlrev_b32 v132,11,v9
v_and_b32 v9,1,v6
v_lshl_add_u32 v132,v9,12,v132
v_add_u32 v9,s61,v7
v_and_b32 v9,3,v9
v_lshl_add_u32 v132,v9,6,v132
v_lshl_add_u32 v132,v8,4,v132
v_add_u32 v132,s60,v132
s_lshl_b32 s60,s53,2
v_add_u32 v9,s60,v8
v_mul_u32_u24 v133,1280,v9
v_lshl_add_u32 v133,v6,5,v133
v_lshl_add_u32 v133,v7,3,v133
s_mov_b32 s4,s16
s_mov_b32 s5,s17
s_mov_b32 s6,2621440
s_mov_b32 s7,0x20000
s_mov_b32 s55,0
s_mul_i32 s62,s54,40960
buffer_load_dwordx2 v[32:33],v133,s[4:7],s62 offen offset:0
buffer_load_dwordx2 v[34:35],v133,s[4:7],s62 offen offset:128
buffer_load_dwordx2 v[36:37],v133,s[4:7],s62 offen offset:256
buffer_load_dwordx2 v[38:39],v133,s[4:7],s62 offen offset:384
buffer_load_dwordx2 v[40:41],v133,s[4:7],s62 offen offset:512
buffer_load_dwordx2 v[42:43],v133,s[4:7],s62 offen offset:640
buffer_load_dwordx2 v[44:45],v133,s[4:7],s62 offen offset:768
buffer_load_dwordx2 v[46:47],v133,s[4:7],s62 offen offset:896
buffer_load_dwordx2 v[48:49],v133,s[4:7],s62 offen offset:1024
buffer_load_dwordx2 v[50:51],v133,s[4:7],s62 offen offset:1152
s_add_u32 s66,s54,16
s_min_u32 s66,s66,63
s_mul_i32 s62,s66,40960
buffer_load_dwordx2 v[52:53],v133,s[4:7],s62 offen offset:0
buffer_load_dwordx2 v[54:55],v133,s[4:7],s62 offen offset:128
buffer_load_dwordx2 v[56:57],v133,s[4:7],s62 offen offset:256
buffer_load_dwordx2 v[58:59],v133,s[4:7],s62 offen offset:384
buffer_load_dwordx2 v[60:61],v133,s[4:7],s62 offen offset:512
buffer_load_dwordx2 v[62:63],v133,s[4:7],s62 offen offset:640
buffer_load_dwordx2 v[64:65],v133,s[4:7],s62 offen offset:768
buffer_load_dwordx2 v[66:67],v133,s[4:7],s62 offen offset:896
buffer_load_dwordx2 v[68:69],v133,s[4:7],s62 offen offset:1024
buffer_load_dwordx2 v[70:71],v133,s[4:7],s62 offen offset:1152
s_mul_i32 s64,s54,40960
s_add_u32 s64,s64,234749952
s_mul_i32 s65,s54,46080
s_add_u32 s65,s65,206569472
s_waitcnt vmcnt(10)
v_lshlrev_b32 v72,16,v32
v_and_b32 v73,0xffff0000,v32
v_lshlrev_b32 v74,16,v33
v_and_b32 v75,0xffff0000,v33
v_lshlrev_b32 v76,16,v34
v_and_b32 v77,0xffff0000,v34
v_lshlrev_b32 v78,16,v35
v_and_b32 v79,0xffff0000,v35
v_lshlrev_b32 v80,16,v36
v_and_b32 v81,0xffff0000,v36
v_lshlrev_b32 v82,16,v37
v_and_b32 v83,0xffff0000,v37
v_lshlrev_b32 v84,16,v38
v_and_b32 v85,0xffff0000,v38
v_lshlrev_b32 v86,16,v39
v_and_b32 v87,0xffff0000,v39
v_lshlrev_b32 v88,16,v40
v_and_b32 v89,0xffff0000,v40
v_lshlrev_b32 v90,16,v41
v_and_b32 v91,0xffff0000,v41
v_lshlrev_b32 v92,16,v42
v_and_b32 v93,0xffff0000,v42
v_lshlrev_b32 v94,16,v43
v_and_b32 v95,0xffff0000,v43
v_lshlrev_b32 v96,16,v44
v_and_b32 v97,0xffff0000,v44
v_lshlrev_b32 v98,16,v45
v_and_b32 v99,0xffff0000,v45
v_lshlrev_b32 v100,16,v46
v_and_b32 v101,0xffff0000,v46
v_lshlrev_b32 v102,16,v47
v_and_b32 v103,0xffff0000,v47
v_lshlrev_b32 v104,16,v48
v_and_b32 v105,0xffff0000,v48
v_lshlrev_b32 v106,16,v49
v_and_b32 v107,0xffff0000,v49
v_lshlrev_b32 v108,16,v50
v_and_b32 v109,0xffff0000,v50
v_lshlrev_b32 v110,16,v51
v_and_b32 v111,0xffff0000,v51
v_pk_add_f32 v[28:29],v[72:73],v[74:75]
v_pk_mul_f32 v[26:27],v[72:73],v[72:73]
v_pk_fma_f32 v[26:27],v[74:75],v[74:75],v[26:27]
v_pk_add_f32 v[28:29],v[28:29],v[76:77]
v_pk_fma_f32 v[26:27],v[76:77],v[76:77],v[26:27]
v_pk_add_f32 v[28:29],v[28:29],v[78:79]
v_pk_fma_f32 v[26:27],v[78:79],v[78:79],v[26:27]
v_pk_add_f32 v[28:29],v[28:29],v[80:81]
v_pk_fma_f32 v[26:27],v[80:81],v[80:81],v[26:27]
v_pk_add_f32 v[28:29],v[28:29],v[82:83]
v_pk_fma_f32 v[26:27],v[82:83],v[82:83],v[26:27]
v_pk_add_f32 v[28:29],v[28:29],v[84:85]
v_pk_fma_f32 v[26:27],v[84:85],v[84:85],v[26:27]
v_pk_add_f32 v[28:29],v[28:29],v[86:87]
v_pk_fma_f32 v[26:27],v[86:87],v[86:87],v[26:27]
v_pk_add_f32 v[28:29],v[28:29],v[88:89]
v_pk_fma_f32 v[26:27],v[88:89],v[88:89],v[26:27]
v_pk_add_f32 v[28:29],v[28:29],v[90:91]
v_pk_fma_f32 v[26:27],v[90:91],v[90:91],v[26:27]
v_pk_add_f32 v[28:29],v[28:29],v[92:93]
v_pk_fma_f32 v[26:27],v[92:93],v[92:93],v[26:27]
v_pk_add_f32 v[28:29],v[28:29],v[94:95]
v_pk_fma_f32 v[26:27],v[94:95],v[94:95],v[26:27]
v_pk_add_f32 v[28:29],v[28:29],v[96:97]
v_pk_fma_f32 v[26:27],v[96:97],v[96:97],v[26:27]
v_pk_add_f32 v[28:29],v[28:29],v[98:99]
v_pk_fma_f32 v[26:27],v[98:99],v[98:99],v[26:27]
v_pk_add_f32 v[28:29],v[28:29],v[100:101]
v_pk_fma_f32 v[26:27],v[100:101],v[100:101],v[26:27]
v_pk_add_f32 v[28:29],v[28:29],v[102:103]
v_pk_fma_f32 v[26:27],v[102:103],v[102:103],v[26:27]
v_pk_add_f32 v[28:29],v[28:29],v[104:105]
v_pk_fma_f32 v[26:27],v[104:105],v[104:105],v[26:27]
v_pk_add_f32 v[28:29],v[28:29],v[106:107]
v_pk_fma_f32 v[26:27],v[106:107],v[106:107],v[26:27]
v_pk_add_f32 v[28:29],v[28:29],v[108:109]
v_pk_fma_f32 v[26:27],v[108:109],v[108:109],v[26:27]
v_pk_add_f32 v[28:29],v[28:29],v[110:111]
v_pk_fma_f32 v[26:27],v[110:111],v[110:111],v[26:27]
v_add_f32 v24,v28,v29
v_add_f32 v25,v26,v27
s_nop 0
v_add_f32_dpp v24,v24,v24 row_ror:4 row_mask:0xf bank_mask:0xf
v_add_f32_dpp v25,v25,v25 row_ror:4 row_mask:0xf bank_mask:0xf
s_nop 0
v_add_f32_dpp v24,v24,v24 row_ror:8 row_mask:0xf bank_mask:0xf
v_add_f32_dpp v25,v25,v25 row_ror:8 row_mask:0xf bank_mask:0xf
v_mov_b32 v26,v24
v_mov_b32 v27,v25
s_nop 0
v_permlane32_swap_b32 v24,v26
v_permlane32_swap_b32 v25,v27
v_add_f32 v24,v24,v26
v_add_f32 v25,v25,v27
v_mov_b32 v26,v24
v_mov_b32 v27,v25
s_nop 0
v_permlane16_swap_b32 v24,v26
v_permlane16_swap_b32 v25,v27
v_add_f32 v24,v24,v26
v_add_f32 v25,v25,v27
v_mul_f32 v24,0x3acccccd,v24
v_mul_f32 v25,0x3acccccd,v25
v_fma_f32 v25,-v24,v24,v25
v_max_f32 v25,0,v25
v_cvt_pk_bf16_f32 v6,v24,v25
v_lshlrev_b32 v24,16,v6
v_and_b32 v25,0xffff0000,v6
v_add_f32 v25,0x3727c5ac,v25
v_cvt_pk_bf16_f32 v6,v25,v25
v_lshlrev_b32 v25,16,v6
v_sqrt_f32 v25,v25
s_nop 0
v_cvt_pk_bf16_f32 v6,v25,v25
v_lshlrev_b32 v25,16,v6
v_rcp_f32 v25,v25
s_nop 0
v_pk_add_f32 v[72:73],v[72:73],v[24:25] op_sel_hi:[1,0] neg_lo:[0,1] neg_hi:[0,1]
v_pk_add_f32 v[74:75],v[74:75],v[24:25] op_sel_hi:[1,0] neg_lo:[0,1] neg_hi:[0,1]
v_pk_add_f32 v[76:77],v[76:77],v[24:25] op_sel_hi:[1,0] neg_lo:[0,1] neg_hi:[0,1]
v_pk_add_f32 v[78:79],v[78:79],v[24:25] op_sel_hi:[1,0] neg_lo:[0,1] neg_hi:[0,1]
v_pk_add_f32 v[80:81],v[80:81],v[24:25] op_sel_hi:[1,0] neg_lo:[0,1] neg_hi:[0,1]
v_pk_add_f32 v[82:83],v[82:83],v[24:25] op_sel_hi:[1,0] neg_lo:[0,1] neg_hi:[0,1]
v_pk_add_f32 v[84:85],v[84:85],v[24:25] op_sel_hi:[1,0] neg_lo:[0,1] neg_hi:[0,1]
v_pk_add_f32 v[86:87],v[86:87],v[24:25] op_sel_hi:[1,0] neg_lo:[0,1] neg_hi:[0,1]
v_pk_add_f32 v[88:89],v[88:89],v[24:25] op_sel_hi:[1,0] neg_lo:[0,1] neg_hi:[0,1]
v_pk_add_f32 v[90:91],v[90:91],v[24:25] op_sel_hi:[1,0] neg_lo:[0,1] neg_hi:[0,1]
v_pk_add_f32 v[92:93],v[92:93],v[24:25] op_sel_hi:[1,0] neg_lo:[0,1] neg_hi:[0,1]
v_pk_add_f32 v[94:95],v[94:95],v[24:25] op_sel_hi:[1,0] neg_lo:[0,1] neg_hi:[0,1]
v_pk_add_f32 v[96:97],v[96:97],v[24:25] op_sel_hi:[1,0] neg_lo:[0,1] neg_hi:[0,1]
v_pk_add_f32 v[98:99],v[98:99],v[24:25] op_sel_hi:[1,0] neg_lo:[0,1] neg_hi:[0,1]
v_pk_add_f32 v[100:101],v[100:101],v[24:25] op_sel_hi:[1,0] neg_lo:[0,1] neg_hi:[0,1]
v_pk_add_f32 v[102:103],v[102:103],v[24:25] op_sel_hi:[1,0] neg_lo:[0,1] neg_hi:[0,1]
v_pk_add_f32 v[104:105],v[104:105],v[24:25] op_sel_hi:[1,0] neg_lo:[0,1] neg_hi:[0,1]
v_pk_add_f32 v[106:107],v[106:107],v[24:25] op_sel_hi:[1,0] neg_lo:[0,1] neg_hi:[0,1]
v_pk_add_f32 v[108:109],v[108:109],v[24:25] op_sel_hi:[1,0] neg_lo:[0,1] neg_hi:[0,1]
v_pk_add_f32 v[110:111],v[110:111],v[24:25] op_sel_hi:[1,0] neg_lo:[0,1] neg_hi:[0,1]
v_cvt_pk_bf16_f32 v6,v72,v73
v_lshlrev_b32 v72,16,v6
v_and_b32 v73,0xffff0000,v6
v_cvt_pk_bf16_f32 v8,v74,v75
v_lshlrev_b32 v74,16,v8
v_and_b32 v75,0xffff0000,v8
v_cvt_pk_bf16_f32 v6,v76,v77
v_lshlrev_b32 v76,16,v6
v_and_b32 v77,0xffff0000,v6
v_cvt_pk_bf16_f32 v8,v78,v79
v_lshlrev_b32 v78,16,v8
v_and_b32 v79,0xffff0000,v8
v_cvt_pk_bf16_f32 v6,v80,v81
v_lshlrev_b32 v80,16,v6
v_and_b32 v81,0xffff0000,v6
v_cvt_pk_bf16_f32 v8,v82,v83
v_lshlrev_b32 v82,16,v8
v_and_b32 v83,0xffff0000,v8
v_cvt_pk_bf16_f32 v6,v84,v85
v_lshlrev_b32 v84,16,v6
v_and_b32 v85,0xffff0000,v6
v_cvt_pk_bf16_f32 v8,v86,v87
v_lshlrev_b32 v86,16,v8
v_and_b32 v87,0xffff0000,v8
v_cvt_pk_bf16_f32 v6,v88,v89
v_lshlrev_b32 v88,16,v6
v_and_b32 v89,0xffff0000,v6
v_cvt_pk_bf16_f32 v8,v90,v91
v_lshlrev_b32 v90,16,v8
v_and_b32 v91,0xffff0000,v8
v_cvt_pk_bf16_f32 v6,v92,v93
v_lshlrev_b32 v92,16,v6
v_and_b32 v93,0xffff0000,v6
v_cvt_pk_bf16_f32 v8,v94,v95
v_lshlrev_b32 v94,16,v8
v_and_b32 v95,0xffff0000,v8
v_cvt_pk_bf16_f32 v6,v96,v97
v_lshlrev_b32 v96,16,v6
v_and_b32 v97,0xffff0000,v6
v_cvt_pk_bf16_f32 v8,v98,v99
v_lshlrev_b32 v98,16,v8
v_and_b32 v99,0xffff0000,v8
v_cvt_pk_bf16_f32 v6,v100,v101
v_lshlrev_b32 v100,16,v6
v_and_b32 v101,0xffff0000,v6
v_cvt_pk_bf16_f32 v8,v102,v103
v_lshlrev_b32 v102,16,v8
v_and_b32 v103,0xffff0000,v8
v_cvt_pk_bf16_f32 v6,v104,v105
v_lshlrev_b32 v104,16,v6
v_and_b32 v105,0xffff0000,v6
v_cvt_pk_bf16_f32 v8,v106,v107
v_lshlrev_b32 v106,16,v8
v_and_b32 v107,0xffff0000,v8
v_cvt_pk_bf16_f32 v6,v108,v109
v_lshlrev_b32 v108,16,v6
v_and_b32 v109,0xffff0000,v6
v_cvt_pk_bf16_f32 v8,v110,v111
v_lshlrev_b32 v110,16,v8
v_and_b32 v111,0xffff0000,v8
v_pk_mul_f32 v[72:73],v[72:73],v[24:25] op_sel:[0,1] op_sel_hi:[1,1]
v_pk_mul_f32 v[74:75],v[74:75],v[24:25] op_sel:[0,1] op_sel_hi:[1,1]
v_pk_mul_f32 v[76:77],v[76:77],v[24:25] op_sel:[0,1] op_sel_hi:[1,1]
v_pk_mul_f32 v[78:79],v[78:79],v[24:25] op_sel:[0,1] op_sel_hi:[1,1]
v_pk_mul_f32 v[80:81],v[80:81],v[24:25] op_sel:[0,1] op_sel_hi:[1,1]
v_pk_mul_f32 v[82:83],v[82:83],v[24:25] op_sel:[0,1] op_sel_hi:[1,1]
v_pk_mul_f32 v[84:85],v[84:85],v[24:25] op_sel:[0,1] op_sel_hi:[1,1]
v_pk_mul_f32 v[86:87],v[86:87],v[24:25] op_sel:[0,1] op_sel_hi:[1,1]
v_pk_mul_f32 v[88:89],v[88:89],v[24:25] op_sel:[0,1] op_sel_hi:[1,1]
v_pk_mul_f32 v[90:91],v[90:91],v[24:25] op_sel:[0,1] op_sel_hi:[1,1]
v_pk_mul_f32 v[92:93],v[92:93],v[24:25] op_sel:[0,1] op_sel_hi:[1,1]
v_pk_mul_f32 v[94:95],v[94:95],v[24:25] op_sel:[0,1] op_sel_hi:[1,1]
v_pk_mul_f32 v[96:97],v[96:97],v[24:25] op_sel:[0,1] op_sel_hi:[1,1]
v_pk_mul_f32 v[98:99],v[98:99],v[24:25] op_sel:[0,1] op_sel_hi:[1,1]
v_pk_mul_f32 v[100:101],v[100:101],v[24:25] op_sel:[0,1] op_sel_hi:[1,1]
v_pk_mul_f32 v[102:103],v[102:103],v[24:25] op_sel:[0,1] op_sel_hi:[1,1]
v_pk_mul_f32 v[104:105],v[104:105],v[24:25] op_sel:[0,1] op_sel_hi:[1,1]
v_pk_mul_f32 v[106:107],v[106:107],v[24:25] op_sel:[0,1] op_sel_hi:[1,1]
v_pk_mul_f32 v[108:109],v[108:109],v[24:25] op_sel:[0,1] op_sel_hi:[1,1]
v_pk_mul_f32 v[110:111],v[110:111],v[24:25] op_sel:[0,1] op_sel_hi:[1,1]
v_cvt_pk_bf16_f32 v112,v72,v73
v_lshlrev_b32 v72,16,v112
v_and_b32 v73,0xffff0000,v112
v_cvt_pk_bf16_f32 v113,v74,v75
v_lshlrev_b32 v74,16,v113
v_and_b32 v75,0xffff0000,v113
v_cvt_pk_bf16_f32 v114,v76,v77
v_lshlrev_b32 v76,16,v114
v_and_b32 v77,0xffff0000,v114
v_cvt_pk_bf16_f32 v115,v78,v79
v_lshlrev_b32 v78,16,v115
v_and_b32 v79,0xffff0000,v115
v_cvt_pk_bf16_f32 v116,v80,v81
v_lshlrev_b32 v80,16,v116
v_and_b32 v81,0xffff0000,v116
v_cvt_pk_bf16_f32 v117,v82,v83
v_lshlrev_b32 v82,16,v117
v_and_b32 v83,0xffff0000,v117
v_cvt_pk_bf16_f32 v118,v84,v85
v_lshlrev_b32 v84,16,v118
v_and_b32 v85,0xffff0000,v118
v_cvt_pk_bf16_f32 v119,v86,v87
v_lshlrev_b32 v86,16,v119
v_and_b32 v87,0xffff0000,v119
v_cvt_pk_bf16_f32 v120,v88,v89
v_lshlrev_b32 v88,16,v120
v_and_b32 v89,0xffff0000,v120
v_cvt_pk_bf16_f32 v121,v90,v91
v_lshlrev_b32 v90,16,v121
v_and_b32 v91,0xffff0000,v121
v_cvt_pk_bf16_f32 v122,v92,v93
v_lshlrev_b32 v92,16,v122
v_and_b32 v93,0xffff0000,v122
v_cvt_pk_bf16_f32 v123,v94,v95
v_lshlrev_b32 v94,16,v123
v_and_b32 v95,0xffff0000,v123
v_cvt_pk_bf16_f32 v124,v96,v97
v_lshlrev_b32 v96,16,v124
v_and_b32 v97,0xffff0000,v124
v_cvt_pk_bf16_f32 v125,v98,v99
v_lshlrev_b32 v98,16,v125
v_and_b32 v99,0xffff0000,v125
v_cvt_pk_bf16_f32 v126,v100,v101
v_lshlrev_b32 v100,16,v126
v_and_b32 v101,0xffff0000,v126
v_cvt_pk_bf16_f32 v127,v102,v103
v_lshlrev_b32 v102,16,v127
v_and_b32 v103,0xffff0000,v127
v_cvt_pk_bf16_f32 v128,v104,v105
v_lshlrev_b32 v104,16,v128
v_and_b32 v105,0xffff0000,v128
v_cvt_pk_bf16_f32 v129,v106,v107
v_lshlrev_b32 v106,16,v129
v_and_b32 v107,0xffff0000,v129
v_cvt_pk_bf16_f32 v130,v108,v109
v_lshlrev_b32 v108,16,v130
v_and_b32 v109,0xffff0000,v130
v_cvt_pk_bf16_f32 v131,v110,v111
v_lshlrev_b32 v110,16,v131
v_and_b32 v111,0xffff0000,v131
s_add_u32 s63,s65,0
v_permlane16_swap_b32 v112,v114
v_permlane16_swap_b32 v113,v115
buffer_store_dwordx4 v[112:115],v132,s[8:11],s63 offen sc1
s_add_u32 s63,s65,8192
v_permlane16_swap_b32 v116,v118
v_permlane16_swap_b32 v117,v119
buffer_store_dwordx4 v[116:119],v132,s[8:11],s63 offen sc1
s_add_u32 s63,s65,16384
v_permlane16_swap_b32 v120,v122
v_permlane16_swap_b32 v121,v123
buffer_store_dwordx4 v[120:123],v132,s[8:11],s63 offen sc1
s_add_u32 s63,s65,24576
v_permlane16_swap_b32 v124,v126
v_permlane16_swap_b32 v125,v127
buffer_store_dwordx4 v[124:127],v132,s[8:11],s63 offen sc1
s_add_u32 s63,s65,32768
v_permlane16_swap_b32 v128,v130
v_permlane16_swap_b32 v129,v131
buffer_store_dwordx4 v[128:131],v132,s[8:11],s63 offen sc1
s_add_u32 s63,s64,0
v_permlane16_swap_b32 v32,v34
v_permlane16_swap_b32 v33,v35
buffer_store_dwordx4 v[32:35],v132,s[8:11],s63 offen sc1
s_add_u32 s63,s64,8192
v_permlane16_swap_b32 v36,v38
v_permlane16_swap_b32 v37,v39
buffer_store_dwordx4 v[36:39],v132,s[8:11],s63 offen sc1
s_add_u32 s63,s64,16384
v_permlane16_swap_b32 v40,v42
v_permlane16_swap_b32 v41,v43
buffer_store_dwordx4 v[40:43],v132,s[8:11],s63 offen sc1
s_add_u32 s63,s64,24576
v_permlane16_swap_b32 v44,v46
v_permlane16_swap_b32 v45,v47
buffer_store_dwordx4 v[44:47],v132,s[8:11],s63 offen sc1
s_add_u32 s63,s64,32768
v_permlane16_swap_b32 v48,v50
v_permlane16_swap_b32 v49,v51
buffer_store_dwordx4 v[48:51],v132,s[8:11],s63 offen sc1
s_lshl_b32 s82,s55,6
s_add_u32 s82,s82,s54
s_lshl_b32 s82,s82,9
s_add_u32 s82,s82,0
s_lshl_b32 s61,s53,2
s_add_u32 s82,s82,s61
s_add_u32 s54,s54,16
s_lshl_b32 s3,s49,2
v_mov_b32 v7,s3
s_nop 1
ibw_270:
buffer_load_dword v6,v7,s[12:15],0 offen sc1
s_waitcnt vmcnt(0)
v_cmp_ne_u32 vcc,256,v6
s_nop 0
s_cbranch_vccz ok_271
s_sleep 8
s_sub_u32 s47,s47,1
s_cbranch_scc1 ABORT
s_branch ibw_270
ok_271:
s_cmp_lg_u32 s49,0
s_cbranch_scc1 ibok_272
v_and_b32 v7,7,v0
v_lshlrev_b32 v7,2,v7
buffer_load_dword v6,v7,s[12:15],0 offen offset:32 sc1
s_waitcnt vmcnt(0)
v_cmp_ne_u32 vcc,32,v6
s_nop 0
s_cbranch_vccz ibok_272
s_barrier
s_mov_b32 s49,1
s_mov_b32 s3,s2
s_load_dwordx16 s[16:31],s[0:1],0
s_load_dwordx8 s[32:39],s[0:1],64
s_waitcnt lgkmcnt(0)
s_branch DISPATCH
ibok_272:
s_mov_b64 exec,1
buffer_store_dword v5,v1,s[8:11],s82 offen sc1
s_mov_b64 exec,-1
s_add_u32 s66,s54,16
s_min_u32 s66,s66,63
s_mul_i32 s62,s66,40960
buffer_load_dwordx2 v[32:33],v133,s[4:7],s62 offen offset:0
buffer_load_dwordx2 v[34:35],v133,s[4:7],s62 offen offset:128
buffer_load_dwordx2 v[36:37],v133,s[4:7],s62 offen offset:256
buffer_load_dwordx2 v[38:39],v133,s[4:7],s62 offen offset:384
buffer_load_dwordx2 v[40:41],v133,s[4:7],s62 offen offset:512
buffer_load_dwordx2 v[42:43],v133,s[4:7],s62 offen offset:640
buffer_load_dwordx2 v[44:45],v133,s[4:7],s62 offen offset:768
buffer_load_dwordx2 v[46:47],v133,s[4:7],s62 offen offset:896
buffer_load_dwordx2 v[48:49],v133,s[4:7],s62 offen offset:1024
buffer_load_dwordx2 v[50:51],v133,s[4:7],s62 offen offset:1152
s_mul_i32 s64,s54,40960
s_add_u32 s64,s64,234749952
s_mul_i32 s65,s54,46080
s_add_u32 s65,s65,206569472
s_waitcnt vmcnt(10)
v_lshlrev_b32 v72,16,v52
v_and_b32 v73,0xffff0000,v52
v_lshlrev_b32 v74,16,v53
v_and_b32 v75,0xffff0000,v53
v_lshlrev_b32 v76,16,v54
v_and_b32 v77,0xffff0000,v54
v_lshlrev_b32 v78,16,v55
v_and_b32 v79,0xffff0000,v55
v_lshlrev_b32 v80,16,v56
v_and_b32 v81,0xffff0000,v56
v_lshlrev_b32 v82,16,v57
v_and_b32 v83,0xffff0000,v57
v_lshlrev_b32 v84,16,v58
v_and_b32 v85,0xffff0000,v58
v_lshlrev_b32 v86,16,v59
v_and_b32 v87,0xffff0000,v59
v_lshlrev_b32 v88,16,v60
v_and_b32 v89,0xffff0000,v60
v_lshlrev_b32 v90,16,v61
v_and_b32 v91,0xffff0000,v61
v_lshlrev_b32 v92,16,v62
v_and_b32 v93,0xffff0000,v62
v_lshlrev_b32 v94,16,v63
v_and_b32 v95,0xffff0000,v63
v_lshlrev_b32 v96,16,v64
v_and_b32 v97,0xffff0000,v64
v_lshlrev_b32 v98,16,v65
v_and_b32 v99,0xffff0000,v65
v_lshlrev_b32 v100,16,v66
v_and_b32 v101,0xffff0000,v66
v_lshlrev_b32 v102,16,v67
v_and_b32 v103,0xffff0000,v67
v_lshlrev_b32 v104,16,v68
v_and_b32 v105,0xffff0000,v68
v_lshlrev_b32 v106,16,v69
v_and_b32 v107,0xffff0000,v69
v_lshlrev_b32 v108,16,v70
v_and_b32 v109,0xffff0000,v70
v_lshlrev_b32 v110,16,v71
v_and_b32 v111,0xffff0000,v71
v_pk_add_f32 v[28:29],v[72:73],v[74:75]
v_pk_mul_f32 v[26:27],v[72:73],v[72:73]
v_pk_fma_f32 v[26:27],v[74:75],v[74:75],v[26:27]
v_pk_add_f32 v[28:29],v[28:29],v[76:77]
v_pk_fma_f32 v[26:27],v[76:77],v[76:77],v[26:27]
v_pk_add_f32 v[28:29],v[28:29],v[78:79]
v_pk_fma_f32 v[26:27],v[78:79],v[78:79],v[26:27]
v_pk_add_f32 v[28:29],v[28:29],v[80:81]
v_pk_fma_f32 v[26:27],v[80:81],v[80:81],v[26:27]
v_pk_add_f32 v[28:29],v[28:29],v[82:83]
v_pk_fma_f32 v[26:27],v[82:83],v[82:83],v[26:27]
v_pk_add_f32 v[28:29],v[28:29],v[84:85]
v_pk_fma_f32 v[26:27],v[84:85],v[84:85],v[26:27]
v_pk_add_f32 v[28:29],v[28:29],v[86:87]
v_pk_fma_f32 v[26:27],v[86:87],v[86:87],v[26:27]
v_pk_add_f32 v[28:29],v[28:29],v[88:89]
v_pk_fma_f32 v[26:27],v[88:89],v[88:89],v[26:27]
v_pk_add_f32 v[28:29],v[28:29],v[90:91]
v_pk_fma_f32 v[26:27],v[90:91],v[90:91],v[26:27]
v_pk_add_f32 v[28:29],v[28:29],v[92:93]
v_pk_fma_f32 v[26:27],v[92:93],v[92:93],v[26:27]
v_pk_add_f32 v[28:29],v[28:29],v[94:95]
v_pk_fma_f32 v[26:27],v[94:95],v[94:95],v[26:27]
v_pk_add_f32 v[28:29],v[28:29],v[96:97]
v_pk_fma_f32 v[26:27],v[96:97],v[96:97],v[26:27]
v_pk_add_f32 v[28:29],v[28:29],v[98:99]
v_pk_fma_f32 v[26:27],v[98:99],v[98:99],v[26:27]
v_pk_add_f32 v[28:29],v[28:29],v[100:101]
v_pk_fma_f32 v[26:27],v[100:101],v[100:101],v[26:27]
v_pk_add_f32 v[28:29],v[28:29],v[102:103]
v_pk_fma_f32 v[26:27],v[102:103],v[102:103],v[26:27]
v_pk_add_f32 v[28:29],v[28:29],v[104:105]
v_pk_fma_f32 v[26:27],v[104:105],v[104:105],v[26:27]
v_pk_add_f32 v[28:29],v[28:29],v[106:107]
v_pk_fma_f32 v[26:27],v[106:107],v[106:107],v[26:27]
v_pk_add_f32 v[28:29],v[28:29],v[108:109]
v_pk_fma_f32 v[26:27],v[108:109],v[108:109],v[26:27]
v_pk_add_f32 v[28:29],v[28:29],v[110:111]
v_pk_fma_f32 v[26:27],v[110:111],v[110:111],v[26:27]
v_add_f32 v24,v28,v29
v_add_f32 v25,v26,v27
s_nop 0
v_add_f32_dpp v24,v24,v24 row_ror:4 row_mask:0xf bank_mask:0xf
v_add_f32_dpp v25,v25,v25 row_ror:4 row_mask:0xf bank_mask:0xf
s_nop 0
v_add_f32_dpp v24,v24,v24 row_ror:8 row_mask:0xf bank_mask:0xf
v_add_f32_dpp v25,v25,v25 row_ror:8 row_mask:0xf bank_mask:0xf
v_mov_b32 v26,v24
v_mov_b32 v27,v25
s_nop 0
v_permlane32_swap_b32 v24,v26
v_permlane32_swap_b32 v25,v27
v_add_f32 v24,v24,v26
v_add_f32 v25,v25,v27
v_mov_b32 v26,v24
v_mov_b32 v27,v25
s_nop 0
v_permlane16_swap_b32 v24,v26
v_permlane16_swap_b32 v25,v27
v_add_f32 v24,v24,v26
v_add_f32 v25,v25,v27
v_mul_f32 v24,0x3acccccd,v24
v_mul_f32 v25,0x3acccccd,v25
v_fma_f32 v25,-v24,v24,v25
v_max_f32 v25,0,v25
v_cvt_pk_bf16_f32 v6,v24,v25
v_lshlrev_b32 v24,16,v6
v_and_b32 v25,0xffff0000,v6
v_add_f32 v25,0x3727c5ac,v25
v_cvt_pk_bf16_f32 v6,v25,v25
v_lshlrev_b32 v25,16,v6
v_sqrt_f32 v25,v25
s_nop 0
v_cvt_pk_bf16_f32 v6,v25,v25
v_lshlrev_b32 v25,16,v6
v_rcp_f32 v25,v25
s_nop 0
v_pk_add_f32 v[72:73],v[72:73],v[24:25] op_sel_hi:[1,0] neg_lo:[0,1] neg_hi:[0,1]
v_pk_add_f32 v[74:75],v[74:75],v[24:25] op_sel_hi:[1,0] neg_lo:[0,1] neg_hi:[0,1]
v_pk_add_f32 v[76:77],v[76:77],v[24:25] op_sel_hi:[1,0] neg_lo:[0,1] neg_hi:[0,1]
v_pk_add_f32 v[78:79],v[78:79],v[24:25] op_sel_hi:[1,0] neg_lo:[0,1] neg_hi:[0,1]
v_pk_add_f32 v[80:81],v[80:81],v[24:25] op_sel_hi:[1,0] neg_lo:[0,1] neg_hi:[0,1]
v_pk_add_f32 v[82:83],v[82:83],v[24:25] op_sel_hi:[1,0] neg_lo:[0,1] neg_hi:[0,1]
v_pk_add_f32 v[84:85],v[84:85],v[24:25] op_sel_hi:[1,0] neg_lo:[0,1] neg_hi:[0,1]
v_pk_add_f32 v[86:87],v[86:87],v[24:25] op_sel_hi:[1,0] neg_lo:[0,1] neg_hi:[0,1]
v_pk_add_f32 v[88:89],v[88:89],v[24:25] op_sel_hi:[1,0] neg_lo:[0,1] neg_hi:[0,1]
v_pk_add_f32 v[90:91],v[90:91],v[24:25] op_sel_hi:[1,0] neg_lo:[0,1] neg_hi:[0,1]
v_pk_add_f32 v[92:93],v[92:93],v[24:25] op_sel_hi:[1,0] neg_lo:[0,1] neg_hi:[0,1]
v_pk_add_f32 v[94:95],v[94:95],v[24:25] op_sel_hi:[1,0] neg_lo:[0,1] neg_hi:[0,1]
v_pk_add_f32 v[96:97],v[96:97],v[24:25] op_sel_hi:[1,0] neg_lo:[0,1] neg_hi:[0,1]
v_pk_add_f32 v[98:99],v[98:99],v[24:25] op_sel_hi:[1,0] neg_lo:[0,1] neg_hi:[0,1]
v_pk_add_f32 v[100:101],v[100:101],v[24:25] op_sel_hi:[1,0] neg_lo:[0,1] neg_hi:[0,1]
v_pk_add_f32 v[102:103],v[102:103],v[24:25] op_sel_hi:[1,0] neg_lo:[0,1] neg_hi:[0,1]
v_pk_add_f32 v[104:105],v[104:105],v[24:25] op_sel_hi:[1,0] neg_lo:[0,1] neg_hi:[0,1]
v_pk_add_f32 v[106:107],v[106:107],v[24:25] op_sel_hi:[1,0] neg_lo:[0,1] neg_hi:[0,1]
v_pk_add_f32 v[108:109],v[108:109],v[24:25] op_sel_hi:[1,0] neg_lo:[0,1] neg_hi:[0,1]
v_pk_add_f32 v[110:111],v[110:111],v[24:25] op_sel_hi:[1,0] neg_lo:[0,1] neg_hi:[0,1]
v_cvt_pk_bf16_f32 v6,v72,v73
v_lshlrev_b32 v72,16,v6
v_and_b32 v73,0xffff0000,v6
v_cvt_pk_bf16_f32 v8,v74,v75
v_lshlrev_b32 v74,16,v8
v_and_b32 v75,0xffff0000,v8
v_cvt_pk_bf16_f32 v6,v76,v77
v_lshlrev_b32 v76,16,v6
v_and_b32 v77,0xffff0000,v6
v_cvt_pk_bf16_f32 v8,v78,v79
v_lshlrev_b32 v78,16,v8
v_and_b32 v79,0xffff0000,v8
v_cvt_pk_bf16_f32 v6,v80,v81
v_lshlrev_b32 v80,16,v6
v_and_b32 v81,0xffff0000,v6
v_cvt_pk_bf16_f32 v8,v82,v83
v_lshlrev_b32 v82,16,v8
v_and_b32 v83,0xffff0000,v8
v_cvt_pk_bf16_f32 v6,v84,v85
v_lshlrev_b32 v84,16,v6
v_and_b32 v85,0xffff0000,v6
v_cvt_pk_bf16_f32 v8,v86,v87
v_lshlrev_b32 v86,16,v8
v_and_b32 v87,0xffff0000,v8
v_cvt_pk_bf16_f32 v6,v88,v89
v_lshlrev_b32 v88,16,v6
v_and_b32 v89,0xffff0000,v6
v_cvt_pk_bf16_f32 v8,v90,v91
v_lshlrev_b32 v90,16,v8
v_and_b32 v91,0xffff0000,v8
v_cvt_pk_bf16_f32 v6,v92,v93
v_lshlrev_b32 v92,16,v6
v_and_b32 v93,0xffff0000,v6
v_cvt_pk_bf16_f32 v8,v94,v95
v_lshlrev_b32 v94,16,v8
v_and_b32 v95,0xffff0000,v8
v_cvt_pk_bf16_f32 v6,v96,v97
v_lshlrev_b32 v96,16,v6
v_and_b32 v97,0xffff0000,v6
v_cvt_pk_bf16_f32 v8,v98,v99
v_lshlrev_b32 v98,16,v8
v_and_b32 v99,0xffff0000,v8
v_cvt_pk_bf16_f32 v6,v100,v101
v_lshlrev_b32 v100,16,v6
v_and_b32 v101,0xffff0000,v6
v_cvt_pk_bf16_f32 v8,v102,v103
v_lshlrev_b32 v102,16,v8
v_and_b32 v103,0xffff0000,v8
v_cvt_pk_bf16_f32 v6,v104,v105
v_lshlrev_b32 v104,16,v6
v_and_b32 v105,0xffff0000,v6
v_cvt_pk_bf16_f32 v8,v106,v107
v_lshlrev_b32 v106,16,v8
v_and_b32 v107,0xffff0000,v8
v_cvt_pk_bf16_f32 v6,v108,v109
v_lshlrev_b32 v108,16,v6
v_and_b32 v109,0xffff0000,v6
v_cvt_pk_bf16_f32 v8,v110,v111
v_lshlrev_b32 v110,16,v8
v_and_b32 v111,0xffff0000,v8
v_pk_mul_f32 v[72:73],v[72:73],v[24:25] op_sel:[0,1] op_sel_hi:[1,1]
v_pk_mul_f32 v[74:75],v[74:75],v[24:25] op_sel:[0,1] op_sel_hi:[1,1]
v_pk_mul_f32 v[76:77],v[76:77],v[24:25] op_sel:[0,1] op_sel_hi:[1,1]
v_pk_mul_f32 v[78:79],v[78:79],v[24:25] op_sel:[0,1] op_sel_hi:[1,1]
v_pk_mul_f32 v[80:81],v[80:81],v[24:25] op_sel:[0,1] op_sel_hi:[1,1]
v_pk_mul_f32 v[82:83],v[82:83],v[24:25] op_sel:[0,1] op_sel_hi:[1,1]
v_pk_mul_f32 v[84:85],v[84:85],v[24:25] op_sel:[0,1] op_sel_hi:[1,1]
v_pk_mul_f32 v[86:87],v[86:87],v[24:25] op_sel:[0,1] op_sel_hi:[1,1]
v_pk_mul_f32 v[88:89],v[88:89],v[24:25] op_sel:[0,1] op_sel_hi:[1,1]
v_pk_mul_f32 v[90:91],v[90:91],v[24:25] op_sel:[0,1] op_sel_hi:[1,1]
v_pk_mul_f32 v[92:93],v[92:93],v[24:25] op_sel:[0,1] op_sel_hi:[1,1]
v_pk_mul_f32 v[94:95],v[94:95],v[24:25] op_sel:[0,1] op_sel_hi:[1,1]
v_pk_mul_f32 v[96:97],v[96:97],v[24:25] op_sel:[0,1] op_sel_hi:[1,1]
v_pk_mul_f32 v[98:99],v[98:99],v[24:25] op_sel:[0,1] op_sel_hi:[1,1]
v_pk_mul_f32 v[100:101],v[100:101],v[24:25] op_sel:[0,1] op_sel_hi:[1,1]
v_pk_mul_f32 v[102:103],v[102:103],v[24:25] op_sel:[0,1] op_sel_hi:[1,1]
v_pk_mul_f32 v[104:105],v[104:105],v[24:25] op_sel:[0,1] op_sel_hi:[1,1]
v_pk_mul_f32 v[106:107],v[106:107],v[24:25] op_sel:[0,1] op_sel_hi:[1,1]
v_pk_mul_f32 v[108:109],v[108:109],v[24:25] op_sel:[0,1] op_sel_hi:[1,1]
v_pk_mul_f32 v[110:111],v[110:111],v[24:25] op_sel:[0,1] op_sel_hi:[1,1]
v_cvt_pk_bf16_f32 v112,v72,v73
v_lshlrev_b32 v72,16,v112
v_and_b32 v73,0xffff0000,v112
v_cvt_pk_bf16_f32 v113,v74,v75
v_lshlrev_b32 v74,16,v113
v_and_b32 v75,0xffff0000,v113
v_cvt_pk_bf16_f32 v114,v76,v77
v_lshlrev_b32 v76,16,v114
v_and_b32 v77,0xffff0000,v114
v_cvt_pk_bf16_f32 v115,v78,v79
v_lshlrev_b32 v78,16,v115
v_and_b32 v79,0xffff0000,v115
v_cvt_pk_bf16_f32 v116,v80,v81
v_lshlrev_b32 v80,16,v116
v_and_b32 v81,0xffff0000,v116
v_cvt_pk_bf16_f32 v117,v82,v83
v_lshlrev_b32 v82,16,v117
v_and_b32 v83,0xffff0000,v117
v_cvt_pk_bf16_f32 v118,v84,v85
v_lshlrev_b32 v84,16,v118
v_and_b32 v85,0xffff0000,v118
v_cvt_pk_bf16_f32 v119,v86,v87
v_lshlrev_b32 v86,16,v119
v_and_b32 v87,0xffff0000,v119
v_cvt_pk_bf16_f32 v120,v88,v89
v_lshlrev_b32 v88,16,v120
v_and_b32 v89,0xffff0000,v120
v_cvt_pk_bf16_f32 v121,v90,v91
v_lshlrev_b32 v90,16,v121
v_and_b32 v91,0xffff0000,v121
v_cvt_pk_bf16_f32 v122,v92,v93
v_lshlrev_b32 v92,16,v122
v_and_b32 v93,0xffff0000,v122
v_cvt_pk_bf16_f32 v123,v94,v95
v_lshlrev_b32 v94,16,v123
v_and_b32 v95,0xffff0000,v123
v_cvt_pk_bf16_f32 v124,v96,v97
v_lshlrev_b32 v96,16,v124
v_and_b32 v97,0xffff0000,v124
v_cvt_pk_bf16_f32 v125,v98,v99
v_lshlrev_b32 v98,16,v125
v_and_b32 v99,0xffff0000,v125
v_cvt_pk_bf16_f32 v126,v100,v101
v_lshlrev_b32 v100,16,v126
v_and_b32 v101,0xffff0000,v126
v_cvt_pk_bf16_f32 v127,v102,v103
v_lshlrev_b32 v102,16,v127
v_and_b32 v103,0xffff0000,v127
v_cvt_pk_bf16_f32 v128,v104,v105
v_lshlrev_b32 v104,16,v128
v_and_b32 v105,0xffff0000,v128
v_cvt_pk_bf16_f32 v129,v106,v107
v_lshlrev_b32 v106,16,v129
v_and_b32 v107,0xffff0000,v129
v_cvt_pk_bf16_f32 v130,v108,v109
v_lshlrev_b32 v108,16,v130
v_and_b32 v109,0xffff0000,v130
v_cvt_pk_bf16_f32 v131,v110,v111
v_lshlrev_b32 v110,16,v131
v_and_b32 v111,0xffff0000,v131
s_add_u32 s63,s65,0
v_permlane16_swap_b32 v112,v114
v_permlane16_swap_b32 v113,v115
buffer_store_dwordx4 v[112:115],v132,s[8:11],s63 offen sc1
s_add_u32 s63,s65,8192
v_permlane16_swap_b32 v116,v118
v_permlane16_swap_b32 v117,v119
buffer_store_dwordx4 v[116:119],v132,s[8:11],s63 offen sc1
s_add_u32 s63,s65,16384
v_permlane16_swap_b32 v120,v122
v_permlane16_swap_b32 v121,v123
buffer_store_dwordx4 v[120:123],v132,s[8:11],s63 offen sc1
s_add_u32 s63,s65,24576
v_permlane16_swap_b32 v124,v126
v_permlane16_swap_b32 v125,v127
buffer_store_dwordx4 v[124:127],v132,s[8:11],s63 offen sc1
s_add_u32 s63,s65,32768
v_permlane16_swap_b32 v128,v130
v_permlane16_swap_b32 v129,v131
buffer_store_dwordx4 v[128:131],v132,s[8:11],s63 offen sc1
s_add_u32 s63,s64,0
v_permlane16_swap_b32 v52,v54
v_permlane16_swap_b32 v53,v55
buffer_store_dwordx4 v[52:55],v132,s[8:11],s63 offen sc1
s_add_u32 s63,s64,8192
v_permlane16_swap_b32 v56,v58
v_permlane16_swap_b32 v57,v59
buffer_store_dwordx4 v[56:59],v132,s[8:11],s63 offen sc1
s_add_u32 s63,s64,16384
v_permlane16_swap_b32 v60,v62
v_permlane16_swap_b32 v61,v63
buffer_store_dwordx4 v[60:63],v132,s[8:11],s63 offen sc1
s_add_u32 s63,s64,24576
v_permlane16_swap_b32 v64,v66
v_permlane16_swap_b32 v65,v67
buffer_store_dwordx4 v[64:67],v132,s[8:11],s63 offen sc1
s_add_u32 s63,s64,32768
v_permlane16_swap_b32 v68,v70
v_permlane16_swap_b32 v69,v71
buffer_store_dwordx4 v[68:71],v132,s[8:11],s63 offen sc1
s_lshl_b32 s82,s55,6
s_add_u32 s82,s82,s54
s_lshl_b32 s82,s82,9
s_add_u32 s82,s82,0
s_lshl_b32 s61,s53,2
s_add_u32 s82,s82,s61
s_add_u32 s54,s54,16
R0_LOOPA:
s_add_u32 s66,s54,16
s_min_u32 s66,s66,63
s_mul_i32 s62,s66,40960
buffer_load_dwordx2 v[52:53],v133,s[4:7],s62 offen offset:0
buffer_load_dwordx2 v[54:55],v133,s[4:7],s62 offen offset:128
buffer_load_dwordx2 v[56:57],v133,s[4:7],s62 offen offset:256
buffer_load_dwordx2 v[58:59],v133,s[4:7],s62 offen offset:384
buffer_load_dwordx2 v[60:61],v133,s[4:7],s62 offen offset:512
buffer_load_dwordx2 v[62:63],v133,s[4:7],s62 offen offset:640
buffer_load_dwordx2 v[64:65],v133,s[4:7],s62 offen offset:768
buffer_load_dwordx2 v[66:67],v133,s[4:7],s62 offen offset:896
buffer_load_dwordx2 v[68:69],v133,s[4:7],s62 offen offset:1024
buffer_load_dwordx2 v[70:71],v133,s[4:7],s62 offen offset:1152
s_mul_i32 s64,s54,40960
s_add_u32 s64,s64,234749952
s_mul_i32 s65,s54,46080
s_add_u32 s65,s65,206569472
s_waitcnt vmcnt(10)
s_mov_b64 exec,1
buffer_store_dword v5,v1,s[8:11],s82 offen sc1
s_mov_b64 exec,-1
v_lshlrev_b32 v72,16,v32
v_and_b32 v73,0xffff0000,v32
v_lshlrev_b32 v74,16,v33
v_and_b32 v75,0xffff0000,v33
v_lshlrev_b32 v76,16,v34
v_and_b32 v77,0xffff0000,v34
v_lshlrev_b32 v78,16,v35
v_and_b32 v79,0xffff0000,v35
v_lshlrev_b32 v80,16,v36
v_and_b32 v81,0xffff0000,v36
v_lshlrev_b32 v82,16,v37
v_and_b32 v83,0xffff0000,v37
v_lshlrev_b32 v84,16,v38
v_and_b32 v85,0xffff0000,v38
v_lshlrev_b32 v86,16,v39
v_and_b32 v87,0xffff0000,v39
v_lshlrev_b32 v88,16,v40
v_and_b32 v89,0xffff0000,v40
v_lshlrev_b32 v90,16,v41
v_and_b32 v91,0xffff0000,v41
v_lshlrev_b32 v92,16,v42
v_and_b32 v93,0xffff0000,v42
v_lshlrev_b32 v94,16,v43
v_and_b32 v95,0xffff0000,v43
v_lshlrev_b32 v96,16,v44
v_and_b32 v97,0xffff0000,v44
v_lshlrev_b32 v98,16,v45
v_and_b32 v99,0xffff0000,v45
v_lshlrev_b32 v100,16,v46
v_and_b32 v101,0xffff0000,v46
v_lshlrev_b32 v102,16,v47
v_and_b32 v103,0xffff0000,v47
v_lshlrev_b32 v104,16,v48
v_and_b32 v105,0xffff0000,v48
v_lshlrev_b32 v106,16,v49
v_and_b32 v107,0xffff0000,v49
v_lshlrev_b32 v108,16,v50
v_and_b32 v109,0xffff0000,v50
v_lshlrev_b32 v110,16,v51
v_and_b32 v111,0xffff0000,v51
v_pk_add_f32 v[28:29],v[72:73],v[74:75]
v_pk_mul_f32 v[26:27],v[72:73],v[72:73]
v_pk_fma_f32 v[26:27],v[74:75],v[74:75],v[26:27]
v_pk_add_f32 v[28:29],v[28:29],v[76:77]
v_pk_fma_f32 v[26:27],v[76:77],v[76:77],v[26:27]
v_pk_add_f32 v[28:29],v[28:29],v[78:79]
v_pk_fma_f32 v[26:27],v[78:79],v[78:79],v[26:27]
v_pk_add_f32 v[28:29],v[28:29],v[80:81]
v_pk_fma_f32 v[26:27],v[80:81],v[80:81],v[26:27]
v_pk_add_f32 v[28:29],v[28:29],v[82:83]
v_pk_fma_f32 v[26:27],v[82:83],v[82:83],v[26:27]
v_pk_add_f32 v[28:29],v[28:29],v[84:85]
v_pk_fma_f32 v[26:27],v[84:85],v[84:85],v[26:27]
v_pk_add_f32 v[28:29],v[28:29],v[86:87]
v_pk_fma_f32 v[26:27],v[86:87],v[86:87],v[26:27]
v_pk_add_f32 v[28:29],v[28:29],v[88:89]
v_pk_fma_f32 v[26:27],v[88:89],v[88:89],v[26:27]
v_pk_add_f32 v[28:29],v[28:29],v[90:91]
v_pk_fma_f32 v[26:27],v[90:91],v[90:91],v[26:27]
v_pk_add_f32 v[28:29],v[28:29],v[92:93]
v_pk_fma_f32 v[26:27],v[92:93],v[92:93],v[26:27]
v_pk_add_f32 v[28:29],v[28:29],v[94:95]
v_pk_fma_f32 v[26:27],v[94:95],v[94:95],v[26:27]
v_pk_add_f32 v[28:29],v[28:29],v[96:97]
v_pk_fma_f32 v[26:27],v[96:97],v[96:97],v[26:27]
v_pk_add_f32 v[28:29],v[28:29],v[98:99]
v_pk_fma_f32 v[26:27],v[98:99],v[98:99],v[26:27]
v_pk_add_f32 v[28:29],v[28:29],v[100:101]
v_pk_fma_f32 v[26:27],v[100:101],v[100:101],v[26:27]
v_pk_add_f32 v[28:29],v[28:29],v[102:103]
v_pk_fma_f32 v[26:27],v[102:103],v[102:103],v[26:27]
v_pk_add_f32 v[28:29],v[28:29],v[104:105]
v_pk_fma_f32 v[26:27],v[104:105],v[104:105],v[26:27]
v_pk_add_f32 v[28:29],v[28:29],v[106:107]
v_pk_fma_f32 v[26:27],v[106:107],v[106:107],v[26:27]
v_pk_add_f32 v[28:29],v[28:29],v[108:109]
v_pk_fma_f32 v[26:27],v[108:109],v[108:109],v[26:27]
v_pk_add_f32 v[28:29],v[28:29],v[110:111]
v_pk_fma_f32 v[26:27],v[110:111],v[110:111],v[26:27]
v_add_f32 v24,v28,v29
v_add_f32 v25,v26,v27
s_nop 0
v_add_f32_dpp v24,v24,v24 row_ror:4 row_mask:0xf bank_mask:0xf
v_add_f32_dpp v25,v25,v25 row_ror:4 row_mask:0xf bank_mask:0xf
s_nop 0
v_add_f32_dpp v24,v24,v24 row_ror:8 row_mask:0xf bank_mask:0xf
v_add_f32_dpp v25,v25,v25 row_ror:8 row_mask:0xf bank_mask:0xf
v_mov_b32 v26,v24
v_mov_b32 v27,v25
s_nop 0
v_permlane32_swap_b32 v24,v26
v_permlane32_swap_b32 v25,v27
v_add_f32 v24,v24,v26
v_add_f32 v25,v25,v27
v_mov_b32 v26,v24
v_mov_b32 v27,v25
s_nop 0
v_permlane16_swap_b32 v24,v26
v_permlane16_swap_b32 v25,v27
v_add_f32 v24,v24,v26
v_add_f32 v25,v25,v27
v_mul_f32 v24,0x3acccccd,v24
v_mul_f32 v25,0x3acccccd,v25
v_fma_f32 v25,-v24,v24,v25
v_max_f32 v25,0,v25
v_cvt_pk_bf16_f32 v6,v24,v25
v_lshlrev_b32 v24,16,v6
v_and_b32 v25,0xffff0000,v6
v_add_f32 v25,0x3727c5ac,v25
v_cvt_pk_bf16_f32 v6,v25,v25
v_lshlrev_b32 v25,16,v6
v_sqrt_f32 v25,v25
s_nop 0
v_cvt_pk_bf16_f32 v6,v25,v25
v_lshlrev_b32 v25,16,v6
v_rcp_f32 v25,v25
s_nop 0
v_pk_add_f32 v[72:73],v[72:73],v[24:25] op_sel_hi:[1,0] neg_lo:[0,1] neg_hi:[0,1]
v_pk_add_f32 v[74:75],v[74:75],v[24:25] op_sel_hi:[1,0] neg_lo:[0,1] neg_hi:[0,1]
v_pk_add_f32 v[76:77],v[76:77],v[24:25] op_sel_hi:[1,0] neg_lo:[0,1] neg_hi:[0,1]
v_pk_add_f32 v[78:79],v[78:79],v[24:25] op_sel_hi:[1,0] neg_lo:[0,1] neg_hi:[0,1]
v_pk_add_f32 v[80:81],v[80:81],v[24:25] op_sel_hi:[1,0] neg_lo:[0,1] neg_hi:[0,1]
v_pk_add_f32 v[82:83],v[82:83],v[24:25] op_sel_hi:[1,0] neg_lo:[0,1] neg_hi:[0,1]
v_pk_add_f32 v[84:85],v[84:85],v[24:25] op_sel_hi:[1,0] neg_lo:[0,1] neg_hi:[0,1]
v_pk_add_f32 v[86:87],v[86:87],v[24:25] op_sel_hi:[1,0] neg_lo:[0,1] neg_hi:[0,1]
v_pk_add_f32 v[88:89],v[88:89],v[24:25] op_sel_hi:[1,0] neg_lo:[0,1] neg_hi:[0,1]
v_pk_add_f32 v[90:91],v[90:91],v[24:25] op_sel_hi:[1,0] neg_lo:[0,1] neg_hi:[0,1]
v_pk_add_f32 v[92:93],v[92:93],v[24:25] op_sel_hi:[1,0] neg_lo:[0,1] neg_hi:[0,1]
v_pk_add_f32 v[94:95],v[94:95],v[24:25] op_sel_hi:[1,0] neg_lo:[0,1] neg_hi:[0,1]
v_pk_add_f32 v[96:97],v[96:97],v[24:25] op_sel_hi:[1,0] neg_lo:[0,1] neg_hi:[0,1]
v_pk_add_f32 v[98:99],v[98:99],v[24:25] op_sel_hi:[1,0] neg_lo:[0,1] neg_hi:[0,1]
v_pk_add_f32 v[100:101],v[100:101],v[24:25] op_sel_hi:[1,0] neg_lo:[0,1] neg_hi:[0,1]
v_pk_add_f32 v[102:103],v[102:103],v[24:25] op_sel_hi:[1,0] neg_lo:[0,1] neg_hi:[0,1]
v_pk_add_f32 v[104:105],v[104:105],v[24:25] op_sel_hi:[1,0] neg_lo:[0,1] neg_hi:[0,1]
v_pk_add_f32 v[106:107],v[106:107],v[24:25] op_sel_hi:[1,0] neg_lo:[0,1] neg_hi:[0,1]
v_pk_add_f32 v[108:109],v[108:109],v[24:25] op_sel_hi:[1,0] neg_lo:[0,1] neg_hi:[0,1]
v_pk_add_f32 v[110:111],v[110:111],v[24:25] op_sel_hi:[1,0] neg_lo:[0,1] neg_hi:[0,1]
v_cvt_pk_bf16_f32 v6,v72,v73
v_lshlrev_b32 v72,16,v6
v_and_b32 v73,0xffff0000,v6
v_cvt_pk_bf16_f32 v8,v74,v75
v_lshlrev_b32 v74,16,v8
v_and_b32 v75,0xffff0000,v8
v_cvt_pk_bf16_f32 v6,v76,v77
v_lshlrev_b32 v76,16,v6
v_and_b32 v77,0xffff0000,v6
v_cvt_pk_bf16_f32 v8,v78,v79
v_lshlrev_b32 v78,16,v8
v_and_b32 v79,0xffff0000,v8
v_cvt_pk_bf16_f32 v6,v80,v81
v_lshlrev_b32 v80,16,v6
v_and_b32 v81,0xffff0000,v6
v_cvt_pk_bf16_f32 v8,v82,v83
v_lshlrev_b32 v82,16,v8
v_and_b32 v83,0xffff0000,v8
v_cvt_pk_bf16_f32 v6,v84,v85
v_lshlrev_b32 v84,16,v6
v_and_b32 v85,0xffff0000,v6
v_cvt_pk_bf16_f32 v8,v86,v87
v_lshlrev_b32 v86,16,v8
v_and_b32 v87,0xffff0000,v8
v_cvt_pk_bf16_f32 v6,v88,v89
v_lshlrev_b32 v88,16,v6
v_and_b32 v89,0xffff0000,v6
v_cvt_pk_bf16_f32 v8,v90,v91
v_lshlrev_b32 v90,16,v8
v_and_b32 v91,0xffff0000,v8
v_cvt_pk_bf16_f32 v6,v92,v93
v_lshlrev_b32 v92,16,v6
v_and_b32 v93,0xffff0000,v6
v_cvt_pk_bf16_f32 v8,v94,v95
v_lshlrev_b32 v94,16,v8
v_and_b32 v95,0xffff0000,v8
v_cvt_pk_bf16_f32 v6,v96,v97
v_lshlrev_b32 v96,16,v6
v_and_b32 v97,0xffff0000,v6
v_cvt_pk_bf16_f32 v8,v98,v99
v_lshlrev_b32 v98,16,v8
v_and_b32 v99,0xffff0000,v8
v_cvt_pk_bf16_f32 v6,v100,v101
v_lshlrev_b32 v100,16,v6
v_and_b32 v101,0xffff0000,v6
v_cvt_pk_bf16_f32 v8,v102,v103
v_lshlrev_b32 v102,16,v8
v_and_b32 v103,0xffff0000,v8
v_cvt_pk_bf16_f32 v6,v104,v105
v_lshlrev_b32 v104,16,v6
v_and_b32 v105,0xffff0000,v6
v_cvt_pk_bf16_f32 v8,v106,v107
v_lshlrev_b32 v106,16,v8
v_and_b32 v107,0xffff0000,v8
v_cvt_pk_bf16_f32 v6,v108,v109
v_lshlrev_b32 v108,16,v6
v_and_b32 v109,0xffff0000,v6
v_cvt_pk_bf16_f32 v8,v110,v111
v_lshlrev_b32 v110,16,v8
v_and_b32 v111,0xffff0000,v8
v_pk_mul_f32 v[72:73],v[72:73],v[24:25] op_sel:[0,1] op_sel_hi:[1,1]
v_pk_mul_f32 v[74:75],v[74:75],v[24:25] op_sel:[0,1] op_sel_hi:[1,1]
v_pk_mul_f32 v[76:77],v[76:77],v[24:25] op_sel:[0,1] op_sel_hi:[1,1]
v_pk_mul_f32 v[78:79],v[78:79],v[24:25] op_sel:[0,1] op_sel_hi:[1,1]
v_pk_mul_f32 v[80:81],v[80:81],v[24:25] op_sel:[0,1] op_sel_hi:[1,1]
v_pk_mul_f32 v[82:83],v[82:83],v[24:25] op_sel:[0,1] op_sel_hi:[1,1]
v_pk_mul_f32 v[84:85],v[84:85],v[24:25] op_sel:[0,1] op_sel_hi:[1,1]
v_pk_mul_f32 v[86:87],v[86:87],v[24:25] op_sel:[0,1] op_sel_hi:[1,1]
v_pk_mul_f32 v[88:89],v[88:89],v[24:25] op_sel:[0,1] op_sel_hi:[1,1]
v_pk_mul_f32 v[90:91],v[90:91],v[24:25] op_sel:[0,1] op_sel_hi:[1,1]
v_pk_mul_f32 v[92:93],v[92:93],v[24:25] op_sel:[0,1] op_sel_hi:[1,1]
v_pk_mul_f32 v[94:95],v[94:95],v[24:25] op_sel:[0,1] op_sel_hi:[1,1]
v_pk_mul_f32 v[96:97],v[96:97],v[24:25] op_sel:[0,1] op_sel_hi:[1,1]
v_pk_mul_f32 v[98:99],v[98:99],v[24:25] op_sel:[0,1] op_sel_hi:[1,1]
v_pk_mul_f32 v[100:101],v[100:101],v[24:25] op_sel:[0,1] op_sel_hi:[1,1]
v_pk_mul_f32 v[102:103],v[102:103],v[24:25] op_sel:[0,1] op_sel_hi:[1,1]
v_pk_mul_f32 v[104:105],v[104:105],v[24:25] op_sel:[0,1] op_sel_hi:[1,1]
v_pk_mul_f32 v[106:107],v[106:107],v[24:25] op_sel:[0,1] op_sel_hi:[1,1]
v_pk_mul_f32 v[108:109],v[108:109],v[24:25] op_sel:[0,1] op_sel_hi:[1,1]
v_pk_mul_f32 v[110:111],v[110:111],v[24:25] op_sel:[0,1] op_sel_hi:[1,1]
v_cvt_pk_bf16_f32 v112,v72,v73
v_lshlrev_b32 v72,16,v112
v_and_b32 v73,0xffff0000,v112
v_cvt_pk_bf16_f32 v113,v74,v75
v_lshlrev_b32 v74,16,v113
v_and_b32 v75,0xffff0000,v113
v_cvt_pk_bf16_f32 v114,v76,v77
v_lshlrev_b32 v76,16,v114
v_and_b32 v77,0xffff0000,v114
v_cvt_pk_bf16_f32 v115,v78,v79
v_lshlrev_b32 v78,16,v115
v_and_b32 v79,0xffff0000,v115
v_cvt_pk_bf16_f32 v116,v80,v81
v_lshlrev_b32 v80,16,v116
v_and_b32 v81,0xffff0000,v116
v_cvt_pk_bf16_f32 v117,v82,v83
v_lshlrev_b32 v82,16,v117
v_and_b32 v83,0xffff0000,v117
v_cvt_pk_bf16_f32 v118,v84,v85
v_lshlrev_b32 v84,16,v118
v_and_b32 v85,0xffff0000,v118
v_cvt_pk_bf16_f32 v119,v86,v87
v_lshlrev_b32 v86,16,v119
v_and_b32 v87,0xffff0000,v119
v_cvt_pk_bf16_f32 v120,v88,v89
v_lshlrev_b32 v88,16,v120
v_and_b32 v89,0xffff0000,v120
v_cvt_pk_bf16_f32 v121,v90,v91
v_lshlrev_b32 v90,16,v121
v_and_b32 v91,0xffff0000,v121
v_cvt_pk_bf16_f32 v122,v92,v93
v_lshlrev_b32 v92,16,v122
v_and_b32 v93,0xffff0000,v122
v_cvt_pk_bf16_f32 v123,v94,v95
v_lshlrev_b32 v94,16,v123
v_and_b32 v95,0xffff0000,v123
v_cvt_pk_bf16_f32 v124,v96,v97
v_lshlrev_b32 v96,16,v124
v_and_b32 v97,0xffff0000,v124
v_cvt_pk_bf16_f32 v125,v98,v99
v_lshlrev_b32 v98,16,v125
v_and_b32 v99,0xffff0000,v125
v_cvt_pk_bf16_f32 v126,v100,v101
v_lshlrev_b32 v100,16,v126
v_and_b32 v101,0xffff0000,v126
v_cvt_pk_bf16_f32 v127,v102,v103
v_lshlrev_b32 v102,16,v127
v_and_b32 v103,0xffff0000,v127
v_cvt_pk_bf16_f32 v128,v104,v105
v_lshlrev_b32 v104,16,v128
v_and_b32 v105,0xffff0000,v128
v_cvt_pk_bf16_f32 v129,v106,v107
v_lshlrev_b32 v106,16,v129
v_and_b32 v107,0xffff0000,v129
v_cvt_pk_bf16_f32 v130,v108,v109
v_lshlrev_b32 v108,16,v130
v_and_b32 v109,0xffff0000,v130
v_cvt_pk_bf16_f32 v131,v110,v111
v_lshlrev_b32 v110,16,v131
v_and_b32 v111,0xffff0000,v131
s_add_u32 s63,s65,0
v_permlane16_swap_b32 v112,v114
v_permlane16_swap_b32 v113,v115
buffer_store_dwordx4 v[112:115],v132,s[8:11],s63 offen sc1
s_add_u32 s63,s65,8192
v_permlane16_swap_b32 v116,v118
v_permlane16_swap_b32 v117,v119
buffer_store_dwordx4 v[116:119],v132,s[8:11],s63 offen sc1
s_add_u32 s63,s65,16384
v_permlane16_swap_b32 v120,v122
v_permlane16_swap_b32 v121,v123
buffer_store_dwordx4 v[120:123],v132,s[8:11],s63 offen sc1
s_add_u32 s63,s65,24576
v_permlane16_swap_b32 v124,v126
v_permlane16_swap_b32 v125,v127
buffer_store_dwordx4 v[124:127],v132,s[8:11],s63 offen sc1
s_add_u32 s63,s65,32768
v_permlane16_swap_b32 v128,v130
v_permlane16_swap_b32 v129,v131
buffer_store_dwordx4 v[128:131],v132,s[8:11],s63 offen sc1
s_add_u32 s63,s64,0
v_permlane16_swap_b32 v32,v34
v_permlane16_swap_b32 v33,v35
buffer_store_dwordx4 v[32:35],v132,s[8:11],s63 offen sc1
s_add_u32 s63,s64,8192
v_permlane16_swap_b32 v36,v38
v_permlane16_swap_b32 v37,v39
buffer_store_dwordx4 v[36:39],v132,s[8:11],s63 offen sc1
s_add_u32 s63,s64,16384
v_permlane16_swap_b32 v40,v42
v_permlane16_swap_b32 v41,v43
buffer_store_dwordx4 v[40:43],v132,s[8:11],s63 offen sc1
s_add_u32 s63,s64,24576
v_permlane16_swap_b32 v44,v46
v_permlane16_swap_b32 v45,v47
buffer_store_dwordx4 v[44:47],v132,s[8:11],s63 offen sc1
s_add_u32 s63,s64,32768
v_permlane16_swap_b32 v48,v50
v_permlane16_swap_b32 v49,v51
buffer_store_dwordx4 v[48:51],v132,s[8:11],s63 offen sc1
s_lshl_b32 s82,s55,6
s_add_u32 s82,s82,s54
s_lshl_b32 s82,s82,9
s_add_u32 s82,s82,0
s_lshl_b32 s61,s53,2
s_add_u32 s82,s82,s61
s_add_u32 s54,s54,16
s_cmp_ge_u32 s54,64
s_cbranch_scc1 R0_ENDA
s_add_u32 s66,s54,16
s_min_u32 s66,s66,63
s_mul_i32 s62,s66,40960
buffer_load_dwordx2 v[32:33],v133,s[4:7],s62 offen offset:0
buffer_load_dwordx2 v[34:35],v133,s[4:7],s62 offen offset:128
buffer_load_dwordx2 v[36:37],v133,s[4:7],s62 offen offset:256
buffer_load_dwordx2 v[38:39],v133,s[4:7],s62 offen offset:384
buffer_load_dwordx2 v[40:41],v133,s[4:7],s62 offen offset:512
buffer_load_dwordx2 v[42:43],v133,s[4:7],s62 offen offset:640
buffer_load_dwordx2 v[44:45],v133,s[4:7],s62 offen offset:768
buffer_load_dwordx2 v[46:47],v133,s[4:7],s62 offen offset:896
buffer_load_dwordx2 v[48:49],v133,s[4:7],s62 offen offset:1024
buffer_load_dwordx2 v[50:51],v133,s[4:7],s62 offen offset:1152
s_mul_i32 s64,s54,40960
s_add_u32 s64,s64,234749952
s_mul_i32 s65,s54,46080
s_add_u32 s65,s65,206569472
s_waitcnt vmcnt(10)
s_mov_b64 exec,1
buffer_store_dword v5,v1,s[8:11],s82 offen sc1
s_mov_b64 exec,-1
v_lshlrev_b32 v72,16,v52
v_and_b32 v73,0xffff0000,v52
v_lshlrev_b32 v74,16,v53
v_and_b32 v75,0xffff0000,v53
v_lshlrev_b32 v76,16,v54
v_and_b32 v77,0xffff0000,v54
v_lshlrev_b32 v78,16,v55
v_and_b32 v79,0xffff0000,v55
v_lshlrev_b32 v80,16,v56
v_and_b32 v81,0xffff0000,v56
v_lshlrev_b32 v82,16,v57
v_and_b32 v83,0xffff0000,v57
v_lshlrev_b32 v84,16,v58
v_and_b32 v85,0xffff0000,v58
v_lshlrev_b32 v86,16,v59
v_and_b32 v87,0xffff0000,v59
v_lshlrev_b32 v88,16,v60
v_and_b32 v89,0xffff0000,v60
v_lshlrev_b32 v90,16,v61
v_and_b32 v91,0xffff0000,v61
v_lshlrev_b32 v92,16,v62
v_and_b32 v93,0xffff0000,v62
v_lshlrev_b32 v94,16,v63
v_and_b32 v95,0xffff0000,v63
v_lshlrev_b32 v96,16,v64
v_and_b32 v97,0xffff0000,v64
v_lshlrev_b32 v98,16,v65
v_and_b32 v99,0xffff0000,v65
v_lshlrev_b32 v100,16,v66
v_and_b32 v101,0xffff0000,v66
v_lshlrev_b32 v102,16,v67
v_and_b32 v103,0xffff0000,v67
v_lshlrev_b32 v104,16,v68
v_and_b32 v105,0xffff0000,v68
v_lshlrev_b32 v106,16,v69
v_and_b32 v107,0xffff0000,v69
v_lshlrev_b32 v108,16,v70
v_and_b32 v109,0xffff0000,v70
v_lshlrev_b32 v110,16,v71
v_and_b32 v111,0xffff0000,v71
v_pk_add_f32 v[28:29],v[72:73],v[74:75]
v_pk_mul_f32 v[26:27],v[72:73],v[72:73]
v_pk_fma_f32 v[26:27],v[74:75],v[74:75],v[26:27]
v_pk_add_f32 v[28:29],v[28:29],v[76:77]
v_pk_fma_f32 v[26:27],v[76:77],v[76:77],v[26:27]
v_pk_add_f32 v[28:29],v[28:29],v[78:79]
v_pk_fma_f32 v[26:27],v[78:79],v[78:79],v[26:27]
v_pk_add_f32 v[28:29],v[28:29],v[80:81]
v_pk_fma_f32 v[26:27],v[80:81],v[80:81],v[26:27]
v_pk_add_f32 v[28:29],v[28:29],v[82:83]
v_pk_fma_f32 v[26:27],v[82:83],v[82:83],v[26:27]
v_pk_add_f32 v[28:29],v[28:29],v[84:85]
v_pk_fma_f32 v[26:27],v[84:85],v[84:85],v[26:27]
v_pk_add_f32 v[28:29],v[28:29],v[86:87]
v_pk_fma_f32 v[26:27],v[86:87],v[86:87],v[26:27]
v_pk_add_f32 v[28:29],v[28:29],v[88:89]
v_pk_fma_f32 v[26:27],v[88:89],v[88:89],v[26:27]
v_pk_add_f32 v[28:29],v[28:29],v[90:91]
v_pk_fma_f32 v[26:27],v[90:91],v[90:91],v[26:27]
v_pk_add_f32 v[28:29],v[28:29],v[92:93]
v_pk_fma_f32 v[26:27],v[92:93],v[92:93],v[26:27]
v_pk_add_f32 v[28:29],v[28:29],v[94:95]
v_pk_fma_f32 v[26:27],v[94:95],v[94:95],v[26:27]
v_pk_add_f32 v[28:29],v[28:29],v[96:97]
v_pk_fma_f32 v[26:27],v[96:97],v[96:97],v[26:27]
v_pk_add_f32 v[28:29],v[28:29],v[98:99]
v_pk_fma_f32 v[26:27],v[98:99],v[98:99],v[26:27]
v_pk_add_f32 v[28:29],v[28:29],v[100:101]
v_pk_fma_f32 v[26:27],v[100:101],v[100:101],v[26:27]
v_pk_add_f32 v[28:29],v[28:29],v[102:103]
v_pk_fma_f32 v[26:27],v[102:103],v[102:103],v[26:27]
v_pk_add_f32 v[28:29],v[28:29],v[104:105]
v_pk_fma_f32 v[26:27],v[104:105],v[104:105],v[26:27]
v_pk_add_f32 v[28:29],v[28:29],v[106:107]
v_pk_fma_f32 v[26:27],v[106:107],v[106:107],v[26:27]
v_pk_add_f32 v[28:29],v[28:29],v[108:109]
v_pk_fma_f32 v[26:27],v[108:109],v[108:109],v[26:27]
v_pk_add_f32 v[28:29],v[28:29],v[110:111]
v_pk_fma_f32 v[26:27],v[110:111],v[110:111],v[26:27]
v_add_f32 v24,v28,v29
v_add_f32 v25,v26,v27
s_nop 0
v_add_f32_dpp v24,v24,v24 row_ror:4 row_mask:0xf bank_mask:0xf
v_add_f32_dpp v25,v25,v25 row_ror:4 row_mask:0xf bank_mask:0xf
s_nop 0
v_add_f32_dpp v24,v24,v24 row_ror:8 row_mask:0xf bank_mask:0xf
v_add_f32_dpp v25,v25,v25 row_ror:8 row_mask:0xf bank_mask:0xf
v_mov_b32 v26,v24
v_mov_b32 v27,v25
s_nop 0
v_permlane32_swap_b32 v24,v26
v_permlane32_swap_b32 v25,v27
v_add_f32 v24,v24,v26
v_add_f32 v25,v25,v27
v_mov_b32 v26,v24
v_mov_b32 v27,v25
s_nop 0
v_permlane16_swap_b32 v24,v26
v_permlane16_swap_b32 v25,v27
v_add_f32 v24,v24,v26
v_add_f32 v25,v25,v27
v_mul_f32 v24,0x3acccccd,v24
v_mul_f32 v25,0x3acccccd,v25
v_fma_f32 v25,-v24,v24,v25
v_max_f32 v25,0,v25
v_cvt_pk_bf16_f32 v6,v24,v25
v_lshlrev_b32 v24,16,v6
v_and_b32 v25,0xffff0000,v6
v_add_f32 v25,0x3727c5ac,v25
v_cvt_pk_bf16_f32 v6,v25,v25
v_lshlrev_b32 v25,16,v6
v_sqrt_f32 v25,v25
s_nop 0
v_cvt_pk_bf16_f32 v6,v25,v25
v_lshlrev_b32 v25,16,v6
v_rcp_f32 v25,v25
s_nop 0
v_pk_add_f32 v[72:73],v[72:73],v[24:25] op_sel_hi:[1,0] neg_lo:[0,1] neg_hi:[0,1]
v_pk_add_f32 v[74:75],v[74:75],v[24:25] op_sel_hi:[1,0] neg_lo:[0,1] neg_hi:[0,1]
v_pk_add_f32 v[76:77],v[76:77],v[24:25] op_sel_hi:[1,0] neg_lo:[0,1] neg_hi:[0,1]
v_pk_add_f32 v[78:79],v[78:79],v[24:25] op_sel_hi:[1,0] neg_lo:[0,1] neg_hi:[0,1]
v_pk_add_f32 v[80:81],v[80:81],v[24:25] op_sel_hi:[1,0] neg_lo:[0,1] neg_hi:[0,1]
v_pk_add_f32 v[82:83],v[82:83],v[24:25] op_sel_hi:[1,0] neg_lo:[0,1] neg_hi:[0,1]
v_pk_add_f32 v[84:85],v[84:85],v[24:25] op_sel_hi:[1,0] neg_lo:[0,1] neg_hi:[0,1]
v_pk_add_f32 v[86:87],v[86:87],v[24:25] op_sel_hi:[1,0] neg_lo:[0,1] neg_hi:[0,1]
v_pk_add_f32 v[88:89],v[88:89],v[24:25] op_sel_hi:[1,0] neg_lo:[0,1] neg_hi:[0,1]
v_pk_add_f32 v[90:91],v[90:91],v[24:25] op_sel_hi:[1,0] neg_lo:[0,1] neg_hi:[0,1]
v_pk_add_f32 v[92:93],v[92:93],v[24:25] op_sel_hi:[1,0] neg_lo:[0,1] neg_hi:[0,1]
v_pk_add_f32 v[94:95],v[94:95],v[24:25] op_sel_hi:[1,0] neg_lo:[0,1] neg_hi:[0,1]
v_pk_add_f32 v[96:97],v[96:97],v[24:25] op_sel_hi:[1,0] neg_lo:[0,1] neg_hi:[0,1]
v_pk_add_f32 v[98:99],v[98:99],v[24:25] op_sel_hi:[1,0] neg_lo:[0,1] neg_hi:[0,1]
v_pk_add_f32 v[100:101],v[100:101],v[24:25] op_sel_hi:[1,0] neg_lo:[0,1] neg_hi:[0,1]
v_pk_add_f32 v[102:103],v[102:103],v[24:25] op_sel_hi:[1,0] neg_lo:[0,1] neg_hi:[0,1]
v_pk_add_f32 v[104:105],v[104:105],v[24:25] op_sel_hi:[1,0] neg_lo:[0,1] neg_hi:[0,1]
v_pk_add_f32 v[106:107],v[106:107],v[24:25] op_sel_hi:[1,0] neg_lo:[0,1] neg_hi:[0,1]
v_pk_add_f32 v[108:109],v[108:109],v[24:25] op_sel_hi:[1,0] neg_lo:[0,1] neg_hi:[0,1]
v_pk_add_f32 v[110:111],v[110:111],v[24:25] op_sel_hi:[1,0] neg_lo:[0,1] neg_hi:[0,1]
v_cvt_pk_bf16_f32 v6,v72,v73
v_lshlrev_b32 v72,16,v6
v_and_b32 v73,0xffff0000,v6
v_cvt_pk_bf16_f32 v8,v74,v75
v_lshlrev_b32 v74,16,v8
v_and_b32 v75,0xffff0000,v8
v_cvt_pk_bf16_f32 v6,v76,v77
v_lshlrev_b32 v76,16,v6
v_and_b32 v77,0xffff0000,v6
v_cvt_pk_bf16_f32 v8,v78,v79
v_lshlrev_b32 v78,16,v8
v_and_b32 v79,0xffff0000,v8
v_cvt_pk_bf16_f32 v6,v80,v81
v_lshlrev_b32 v80,16,v6
v_and_b32 v81,0xffff0000,v6
v_cvt_pk_bf16_f32 v8,v82,v83
v_lshlrev_b32 v82,16,v8
v_and_b32 v83,0xffff0000,v8
v_cvt_pk_bf16_f32 v6,v84,v85
v_lshlrev_b32 v84,16,v6
v_and_b32 v85,0xffff0000,v6
v_cvt_pk_bf16_f32 v8,v86,v87
v_lshlrev_b32 v86,16,v8
v_and_b32 v87,0xffff0000,v8
v_cvt_pk_bf16_f32 v6,v88,v89
v_lshlrev_b32 v88,16,v6
v_and_b32 v89,0xffff0000,v6
v_cvt_pk_bf16_f32 v8,v90,v91
v_lshlrev_b32 v90,16,v8
v_and_b32 v91,0xffff0000,v8
v_cvt_pk_bf16_f32 v6,v92,v93
v_lshlrev_b32 v92,16,v6
v_and_b32 v93,0xffff0000,v6
v_cvt_pk_bf16_f32 v8,v94,v95
v_lshlrev_b32 v94,16,v8
v_and_b32 v95,0xffff0000,v8
v_cvt_pk_bf16_f32 v6,v96,v97
v_lshlrev_b32 v96,16,v6
v_and_b32 v97,0xffff0000,v6
v_cvt_pk_bf16_f32 v8,v98,v99
v_lshlrev_b32 v98,16,v8
v_and_b32 v99,0xffff0000,v8
v_cvt_pk_bf16_f32 v6,v100,v101
v_lshlrev_b32 v100,16,v6
v_and_b32 v101,0xffff0000,v6
v_cvt_pk_bf16_f32 v8,v102,v103
v_lshlrev_b32 v102,16,v8
v_and_b32 v103,0xffff0000,v8
v_cvt_pk_bf16_f32 v6,v104,v105
v_lshlrev_b32 v104,16,v6
v_and_b32 v105,0xffff0000,v6
v_cvt_pk_bf16_f32 v8,v106,v107
v_lshlrev_b32 v106,16,v8
v_and_b32 v107,0xffff0000,v8
v_cvt_pk_bf16_f32 v6,v108,v109
v_lshlrev_b32 v108,16,v6
v_and_b32 v109,0xffff0000,v6
v_cvt_pk_bf16_f32 v8,v110,v111
v_lshlrev_b32 v110,16,v8
v_and_b32 v111,0xffff0000,v8
v_pk_mul_f32 v[72:73],v[72:73],v[24:25] op_sel:[0,1] op_sel_hi:[1,1]
v_pk_mul_f32 v[74:75],v[74:75],v[24:25] op_sel:[0,1] op_sel_hi:[1,1]
v_pk_mul_f32 v[76:77],v[76:77],v[24:25] op_sel:[0,1] op_sel_hi:[1,1]
v_pk_mul_f32 v[78:79],v[78:79],v[24:25] op_sel:[0,1] op_sel_hi:[1,1]
v_pk_mul_f32 v[80:81],v[80:81],v[24:25] op_sel:[0,1] op_sel_hi:[1,1]
v_pk_mul_f32 v[82:83],v[82:83],v[24:25] op_sel:[0,1] op_sel_hi:[1,1]
v_pk_mul_f32 v[84:85],v[84:85],v[24:25] op_sel:[0,1] op_sel_hi:[1,1]
v_pk_mul_f32 v[86:87],v[86:87],v[24:25] op_sel:[0,1] op_sel_hi:[1,1]
v_pk_mul_f32 v[88:89],v[88:89],v[24:25] op_sel:[0,1] op_sel_hi:[1,1]
v_pk_mul_f32 v[90:91],v[90:91],v[24:25] op_sel:[0,1] op_sel_hi:[1,1]
v_pk_mul_f32 v[92:93],v[92:93],v[24:25] op_sel:[0,1] op_sel_hi:[1,1]
v_pk_mul_f32 v[94:95],v[94:95],v[24:25] op_sel:[0,1] op_sel_hi:[1,1]
v_pk_mul_f32 v[96:97],v[96:97],v[24:25] op_sel:[0,1] op_sel_hi:[1,1]
v_pk_mul_f32 v[98:99],v[98:99],v[24:25] op_sel:[0,1] op_sel_hi:[1,1]
v_pk_mul_f32 v[100:101],v[100:101],v[24:25] op_sel:[0,1] op_sel_hi:[1,1]
v_pk_mul_f32 v[102:103],v[102:103],v[24:25] op_sel:[0,1] op_sel_hi:[1,1]
v_pk_mul_f32 v[104:105],v[104:105],v[24:25] op_sel:[0,1] op_sel_hi:[1,1]
v_pk_mul_f32 v[106:107],v[106:107],v[24:25] op_sel:[0,1] op_sel_hi:[1,1]
v_pk_mul_f32 v[108:109],v[108:109],v[24:25] op_sel:[0,1] op_sel_hi:[1,1]
v_pk_mul_f32 v[110:111],v[110:111],v[24:25] op_sel:[0,1] op_sel_hi:[1,1]
v_cvt_pk_bf16_f32 v112,v72,v73
v_lshlrev_b32 v72,16,v112
v_and_b32 v73,0xffff0000,v112
v_cvt_pk_bf16_f32 v113,v74,v75
v_lshlrev_b32 v74,16,v113
v_and_b32 v75,0xffff0000,v113
v_cvt_pk_bf16_f32 v114,v76,v77
v_lshlrev_b32 v76,16,v114
v_and_b32 v77,0xffff0000,v114
v_cvt_pk_bf16_f32 v115,v78,v79
v_lshlrev_b32 v78,16,v115
v_and_b32 v79,0xffff0000,v115
v_cvt_pk_bf16_f32 v116,v80,v81
v_lshlrev_b32 v80,16,v116
v_and_b32 v81,0xffff0000,v116
v_cvt_pk_bf16_f32 v117,v82,v83
v_lshlrev_b32 v82,16,v117
v_and_b32 v83,0xffff0000,v117
v_cvt_pk_bf16_f32 v118,v84,v85
v_lshlrev_b32 v84,16,v118
v_and_b32 v85,0xffff0000,v118
v_cvt_pk_bf16_f32 v119,v86,v87
v_lshlrev_b32 v86,16,v119
v_and_b32 v87,0xffff0000,v119
v_cvt_pk_bf16_f32 v120,v88,v89
v_lshlrev_b32 v88,16,v120
v_and_b32 v89,0xffff0000,v120
v_cvt_pk_bf16_f32 v121,v90,v91
v_lshlrev_b32 v90,16,v121
v_and_b32 v91,0xffff0000,v121
v_cvt_pk_bf16_f32 v122,v92,v93
v_lshlrev_b32 v92,16,v122
v_and_b32 v93,0xffff0000,v122
v_cvt_pk_bf16_f32 v123,v94,v95
v_lshlrev_b32 v94,16,v123
v_and_b32 v95,0xffff0000,v123
v_cvt_pk_bf16_f32 v124,v96,v97
v_lshlrev_b32 v96,16,v124
v_and_b32 v97,0xffff0000,v124
v_cvt_pk_bf16_f32 v125,v98,v99
v_lshlrev_b32 v98,16,v125
v_and_b32 v99,0xffff0000,v125
v_cvt_pk_bf16_f32 v126,v100,v101
v_lshlrev_b32 v100,16,v126
v_and_b32 v101,0xffff0000,v126
v_cvt_pk_bf16_f32 v127,v102,v103
v_lshlrev_b32 v102,16,v127
v_and_b32 v103,0xffff0000,v127
v_cvt_pk_bf16_f32 v128,v104,v105
v_lshlrev_b32 v104,16,v128
v_and_b32 v105,0xffff0000,v128
v_cvt_pk_bf16_f32 v129,v106,v107
v_lshlrev_b32 v106,16,v129
v_and_b32 v107,0xffff0000,v129
v_cvt_pk_bf16_f32 v130,v108,v109
v_lshlrev_b32 v108,16,v130
v_and_b32 v109,0xffff0000,v130
v_cvt_pk_bf16_f32 v131,v110,v111
v_lshlrev_b32 v110,16,v131
v_and_b32 v111,0xffff0000,v131
s_add_u32 s63,s65,0
v_permlane16_swap_b32 v112,v114
v_permlane16_swap_b32 v113,v115
buffer_store_dwordx4 v[112:115],v132,s[8:11],s63 offen sc1
s_add_u32 s63,s65,8192
v_permlane16_swap_b32 v116,v118
v_permlane16_swap_b32 v117,v119
buffer_store_dwordx4 v[116:119],v132,s[8:11],s63 offen sc1
s_add_u32 s63,s65,16384
v_permlane16_swap_b32 v120,v122
v_permlane16_swap_b32 v121,v123
buffer_store_dwordx4 v[120:123],v132,s[8:11],s63 offen sc1
s_add_u32 s63,s65,24576
v_permlane16_swap_b32 v124,v126
v_permlane16_swap_b32 v125,v127
buffer_store_dwordx4 v[124:127],v132,s[8:11],s63 offen sc1
s_add_u32 s63,s65,32768
v_permlane16_swap_b32 v128,v130
v_permlane16_swap_b32 v129,v131
buffer_store_dwordx4 v[128:131],v132,s[8:11],s63 offen sc1
s_add_u32 s63,s64,0
v_permlane16_swap_b32 v52,v54
v_permlane16_swap_b32 v53,v55
buffer_store_dwordx4 v[52:55],v132,s[8:11],s63 offen sc1
s_add_u32 s63,s64,8192
v_permlane16_swap_b32 v56,v58
v_permlane16_swap_b32 v57,v59
buffer_store_dwordx4 v[56:59],v132,s[8:11],s63 offen sc1
s_add_u32 s63,s64,16384
v_permlane16_swap_b32 v60,v62
v_permlane16_swap_b32 v61,v63
buffer_store_dwordx4 v[60:63],v132,s[8:11],s63 offen sc1
s_add_u32 s63,s64,24576
v_permlane16_swap_b32 v64,v66
v_permlane16_swap_b32 v65,v67
buffer_store_dwordx4 v[64:67],v132,s[8:11],s63 offen sc1
s_add_u32 s63,s64,32768
v_permlane16_swap_b32 v68,v70
v_permlane16_swap_b32 v69,v71
buffer_store_dwordx4 v[68:71],v132,s[8:11],s63 offen sc1
s_lshl_b32 s82,s55,6
s_add_u32 s82,s82,s54
s_lshl_b32 s82,s82,9
s_add_u32 s82,s82,0
s_lshl_b32 s61,s53,2
s_add_u32 s82,s82,s61
s_add_u32 s54,s54,16
s_cmp_lt_u32 s54,64
s_cbranch_scc1 R0_LOOPA
R0_ENDA:
s_waitcnt vmcnt(0)
s_mov_b64 exec,1
buffer_store_dword v5,v1,s[8:11],s82 offen sc1
s_mov_b64 exec,-1
s_mov_b32 s52,s86
s_mul_i32 s60,s86,196608
s_add_u32 s69,s69,s60
s_mul_i32 s60,s86,1024
s_add_u32 s70,s70,s60
ATT_LOOP:
s_lshl_b32 s67,s51,6
s_add_u32 s67,s67,s52
s_lshl_b32 s67,s67,9
s_add_u32 s67,s67,65536
s_mul_i32 s66,s52,393216
s_add_u32 s66,s66,s71
fb_273:
buffer_load_dword v3,v2,s[8:11],s67 offen sc1
s_waitcnt vmcnt(0)
v_cmp_eq_u32 vcc,0,v3
s_nop 0
s_cbranch_vccz ok_274
s_sleep 20
s_sub_u32 s47,s47,1
s_cbranch_scc1 ABORT
s_branch fb_273
ok_274:
s_add_u32 s63,s66,124780544
buffer_load_dwordx4 v[16:19],v1,s[8:11],s63 offen sc1
buffer_load_dwordx4 v[20:23],v1,s[8:11],s63 offen offset:1024 sc1
buffer_load_dwordx4 v[24:27],v1,s[8:11],s63 offen offset:2048 sc1
buffer_load_dwordx4 v[28:31],v1,s[8:11],s63 offen offset:3072 sc1
s_add_u32 s63,s66,124784640
buffer_load_dwordx4 v[32:35],v1,s[8:11],s63 offen sc1
buffer_load_dwordx4 v[36:39],v1,s[8:11],s63 offen offset:1024 sc1
buffer_load_dwordx4 v[40:43],v1,s[8:11],s63 offen offset:2048 sc1
buffer_load_dwordx4 v[44:47],v1,s[8:11],s63 offen offset:3072 sc1
s_add_u32 s63,s66,124788736
buffer_load_dwordx4 v[48:51],v1,s[8:11],s63 offen sc1
buffer_load_dwordx4 v[52:55],v1,s[8:11],s63 offen offset:1024 sc1
buffer_load_dwordx4 v[56:59],v1,s[8:11],s63 offen offset:2048 sc1
buffer_load_dwordx4 v[60:63],v1,s[8:11],s63 offen offset:3072 sc1
s_add_u32 s63,s66,74448896
buffer_load_dwordx4 v[64:67],v1,s[8:11],s63 offen sc1
buffer_load_dwordx4 v[68:71],v1,s[8:11],s63 offen offset:1024 sc1
buffer_load_dwordx4 v[72:75],v1,s[8:11],s63 offen offset:2048 sc1
buffer_load_dwordx4 v[76:79],v1,s[8:11],s63 offen offset:3072 sc1
s_add_u32 s63,s66,74452992
buffer_load_dwordx4 v[80:83],v1,s[8:11],s63 offen sc1
buffer_load_dwordx4 v[84:87],v1,s[8:11],s63 offen offset:1024 sc1
buffer_load_dwordx4 v[88:91],v1,s[8:11],s63 offen offset:2048 sc1
buffer_load_dwordx4 v[92:95],v1,s[8:11],s63 offen offset:3072 sc1
s_add_u32 s63,s66,74457088
buffer_load_dwordx4 v[96:99],v1,s[8:11],s63 offen sc1
buffer_load_dwordx4 v[100:103],v1,s[8:11],s63 offen offset:1024 sc1
buffer_load_dwordx4 v[104:107],v1,s[8:11],s63 offen offset:2048 sc1
buffer_load_dwordx4 v[108:111],v1,s[8:11],s63 offen offset:3072 sc1
s_add_u32 s63,s66,99614720
buffer_load_dwordx4 v[112:115],v1,s[8:11],s63 offen sc1
buffer_load_dwordx4 v[116:119],v1,s[8:11],s63 offen offset:1024 sc1
buffer_load_dwordx4 v[120:123],v1,s[8:11],s63 offen offset:2048 sc1
buffer_load_dwordx4 v[124:127],v1,s[8:11],s63 offen offset:3072 sc1
s_add_u32 s63,s66,99618816
buffer_load_dwordx4 v[128:131],v1,s[8:11],s63 offen sc1
buffer_load_dwordx4 v[132:135],v1,s[8:11],s63 offen offset:1024 sc1
buffer_load_dwordx4 v[136:139],v1,s[8:11],s63 offen offset:2048 sc1
buffer_load_dwordx4 v[140:143],v1,s[8:11],s63 offen offset:3072 sc1
s_add_u32 s63,s66,99622912
buffer_load_dwordx4 v[144:147],v1,s[8:11],s63 offen sc1
buffer_load_dwordx4 v[148:151],v1,s[8:11],s63 offen offset:1024 sc1
buffer_load_dwordx4 v[152:155],v1,s[8:11],s63 offen offset:2048 sc1
buffer_load_dwordx4 v[156:159],v1,s[8:11],s63 offen offset:3072 sc1
s_waitcnt vmcnt(12)
v_mfma_f32_16x16x32_bf16 v[184:187],v[64:67],v[16:19],0
v_mfma_f32_16x16x32_bf16 v[188:191],v[64:67],v[20:23],0
v_mfma_f32_16x16x32_bf16 v[192:195],v[68:71],v[20:23],0
v_mfma_f32_16x16x32_bf16 v[184:187],v[72:75],v[24:27],v[184:187]
v_mfma_f32_16x16x32_bf16 v[188:191],v[72:75],v[28:31],v[188:191]
v_mfma_f32_16x16x32_bf16 v[192:195],v[76:79],v[28:31],v[192:195]
v_mfma_f32_16x16x32_bf16 v[184:187],v[80:83],v[32:35],v[184:187]
v_mfma_f32_16x16x32_bf16 v[188:191],v[80:83],v[36:39],v[188:191]
v_mfma_f32_16x16x32_bf16 v[192:195],v[84:87],v[36:39],v[192:195]
v_mfma_f32_16x16x32_bf16 v[184:187],v[88:91],v[40:43],v[184:187]
v_mfma_f32_16x16x32_bf16 v[188:191],v[88:91],v[44:47],v[188:191]
v_mfma_f32_16x16x32_bf16 v[192:195],v[92:95],v[44:47],v[192:195]
v_mfma_f32_16x16x32_bf16 v[184:187],v[96:99],v[48:51],v[184:187]
v_mfma_f32_16x16x32_bf16 v[188:191],v[96:99],v[52:55],v[188:191]
v_mfma_f32_16x16x32_bf16 v[192:195],v[100:103],v[52:55],v[192:195]
v_mfma_f32_16x16x32_bf16 v[184:187],v[104:107],v[56:59],v[184:187]
v_mfma_f32_16x16x32_bf16 v[188:191],v[104:107],v[60:63],v[188:191]
v_mfma_f32_16x16x32_bf16 v[192:195],v[108:111],v[60:63],v[192:195]
s_nop 5
v_cvt_pk_bf16_f32 v6,v184,v185
v_lshlrev_b32 v184,16,v6
v_and_b32 v185,0xffff0000,v6
v_cvt_pk_bf16_f32 v6,v186,v187
v_lshlrev_b32 v186,16,v6
v_and_b32 v187,0xffff0000,v6
v_cvt_pk_bf16_f32 v6,v188,v189
v_lshlrev_b32 v188,16,v6
v_and_b32 v189,0xffff0000,v6
v_cvt_pk_bf16_f32 v6,v190,v191
v_lshlrev_b32 v190,16,v6
v_and_b32 v191,0xffff0000,v6
v_cvt_pk_bf16_f32 v6,v192,v193
v_lshlrev_b32 v192,16,v6
v_and_b32 v193,0xffff0000,v6
v_cvt_pk_bf16_f32 v6,v194,v195
v_lshlrev_b32 v194,16,v6
v_and_b32 v195,0xffff0000,v6
v_mul_f32 v184,s84,v184
v_mul_f32 v185,s84,v185
v_mul_f32 v186,s84,v186
v_mul_f32 v187,s84,v187
v_mul_f32 v188,s84,v188
v_mul_f32 v189,s84,v189
v_mul_f32 v190,s84,v190
v_mul_f32 v191,s84,v191
v_mul_f32 v192,s84,v192
v_mul_f32 v193,s84,v193
v_mul_f32 v194,s84,v194
v_mul_f32 v195,s84,v195
v_cvt_pk_bf16_f32 v6,v184,v185
v_lshlrev_b32 v184,16,v6
v_and_b32 v185,0xffff0000,v6
v_cvt_pk_bf16_f32 v6,v186,v187
v_lshlrev_b32 v186,16,v6
v_and_b32 v187,0xffff0000,v6
v_cvt_pk_bf16_f32 v6,v188,v189
v_lshlrev_b32 v188,16,v6
v_and_b32 v189,0xffff0000,v6
v_cvt_pk_bf16_f32 v6,v190,v191
v_lshlrev_b32 v190,16,v6
v_and_b32 v191,0xffff0000,v6
v_cvt_pk_bf16_f32 v6,v192,v193
v_lshlrev_b32 v192,16,v6
v_and_b32 v193,0xffff0000,v6
v_cvt_pk_bf16_f32 v6,v194,v195
v_lshlrev_b32 v194,16,v6
v_and_b32 v195,0xffff0000,v6
v_cndmask_b32 v184,v230,v184,s[72:73]
v_cndmask_b32 v185,v230,v185,s[74:75]
v_cndmask_b32 v186,v230,v186,s[76:77]
v_cndmask_b32 v187,v230,v187,s[78:79]
v_cndmask_b32 v192,v230,v192,s[72:73]
v_cndmask_b32 v193,v230,v193,s[74:75]
v_cndmask_b32 v194,v230,v194,s[76:77]
v_cndmask_b32 v195,v230,v195,s[78:79]
s_nop 1
fb_275:
buffer_load_dword v3,v228,s[8:11],s70 offen sc1
s_waitcnt vmcnt(0)
v_cmp_eq_u32 vcc,0,v3
s_nop 0
s_cbranch_vccz ok_276
s_sleep 10
s_sub_u32 s47,s47,1
s_cbranch_scc1 ABORT
s_branch fb_275
ok_276:
buffer_load_dwordx4 v[160:163],v1,s[8:11],s69 offen sc1
buffer_load_dwordx4 v[164:167],v1,s[8:11],s69 offen offset:1024 sc1
buffer_load_dwordx4 v[168:171],v1,s[8:11],s69 offen offset:2048 sc1
s_add_u32 s63,s69,3072
buffer_load_dwordx4 v[172:175],v1,s[8:11],s63 offen sc1
buffer_load_dwordx4 v[176:179],v1,s[8:11],s63 offen offset:1024 sc1
buffer_load_dwordx4 v[180:183],v1,s[8:11],s63 offen offset:2048 sc1
s_waitcnt vmcnt(3)
v_mfma_f32_16x16x32_bf16 v[196:199],v[160:163],v[16:19],0
v_mfma_f32_16x16x32_bf16 v[200:203],v[160:163],v[24:27],0
v_mfma_f32_16x16x32_bf16 v[204:207],v[160:163],v[20:23],0
v_mfma_f32_16x16x32_bf16 v[208:211],v[160:163],v[28:31],0
v_mfma_f32_16x16x32_bf16 v[196:199],v[164:167],v[32:35],v[196:199]
v_mfma_f32_16x16x32_bf16 v[200:203],v[164:167],v[40:43],v[200:203]
v_mfma_f32_16x16x32_bf16 v[204:207],v[164:167],v[36:39],v[204:207]
v_mfma_f32_16x16x32_bf16 v[208:211],v[164:167],v[44:47],v[208:211]
v_mfma_f32_16x16x32_bf16 v[196:199],v[168:171],v[48:51],v[196:199]
v_mfma_f32_16x16x32_bf16 v[200:203],v[168:171],v[56:59],v[200:203]
v_mfma_f32_16x16x32_bf16 v[204:207],v[168:171],v[52:55],v[204:207]
v_mfma_f32_16x16x32_bf16 v[208:211],v[168:171],v[60:63],v[208:211]
s_nop 4
v_permlane32_swap_b32 v196,v197
v_permlane32_swap_b32 v200,v201
v_permlane32_swap_b32 v198,v199
v_permlane32_swap_b32 v202,v203
v_add_f32 v196,v196,v201
v_add_f32 v197,v198,v203
v_permlane32_swap_b32 v204,v205
v_permlane32_swap_b32 v208,v209
v_permlane32_swap_b32 v206,v207
v_permlane32_swap_b32 v210,v211
v_add_f32 v204,v204,v209
v_add_f32 v205,v206,v211
v_cvt_pk_bf16_f32 v6,v196,v197
v_lshlrev_b32 v196,16,v6
v_and_b32 v197,0xffff0000,v6
v_cvt_pk_bf16_f32 v6,v204,v205
v_lshlrev_b32 v204,16,v6
v_and_b32 v205,0xffff0000,v6
v_mul_f32 v196,s84,v196
v_mul_f32 v197,s84,v197
v_mul_f32 v204,s84,v204
v_mul_f32 v205,s84,v205
v_cvt_pk_bf16_f32 v6,v196,v197
v_lshlrev_b32 v196,16,v6
v_and_b32 v197,0xffff0000,v6
v_cvt_pk_bf16_f32 v6,v204,v205
v_lshlrev_b32 v204,16,v6
v_and_b32 v205,0xffff0000,v6
v_max3_f32 v6,v184,v185,v186
v_max3_f32 v6,v6,v187,v196
v_max_f32 v6,v6,v197
v_mov_b32 v7,v6
s_nop 1
v_permlane32_swap_b32 v6,v7
v_max_f32 v6,v6,v7
v_mov_b32 v7,v6
s_nop 1
v_permlane16_swap_b32 v6,v7
v_max_f32 v6,v6,v7
v_mul_f32 v6,s85,v6
v_fma_f32 v184,v184,s85,-v6
v_fma_f32 v185,v185,s85,-v6
v_fma_f32 v186,v186,s85,-v6
v_fma_f32 v187,v187,s85,-v6
v_fma_f32 v196,v196,s85,-v6
v_fma_f32 v197,v197,s85,-v6
v_exp_f32 v184,v184
v_exp_f32 v185,v185
v_exp_f32 v186,v186
v_exp_f32 v187,v187
v_exp_f32 v196,v196
v_exp_f32 v197,v197
v_add_f32 v6,v184,v185
v_add_f32 v6,v6,v186
v_add_f32 v6,v6,v187
v_add_f32 v6,v6,v196
v_add_f32 v6,v6,v197
v_mov_b32 v7,v6
s_nop 1
v_permlane32_swap_b32 v6,v7
v_add_f32 v6,v6,v7
v_mov_b32 v7,v6
s_nop 1
v_permlane16_swap_b32 v6,v7
v_add_f32 v6,v6,v7
v_rcp_f32 v6,v6
s_nop 0
v_mul_f32 v184,v184,v6
v_mul_f32 v185,v185,v6
v_mul_f32 v186,v186,v6
v_mul_f32 v187,v187,v6
v_mul_f32 v196,v196,v6
v_mul_f32 v197,v197,v6
v_cvt_pk_bf16_f32 v212,v184,v185
v_cvt_pk_bf16_f32 v213,v186,v187
v_mov_b32 v214,0
v_mov_b32 v215,0
v_cvt_pk_bf16_f32 v216,v196,v197
v_mov_b32 v217,0
v_mov_b32 v218,0
v_cvt_pk_bf16_f32 v219,v196,v197
v_max3_f32 v8,v188,v189,v190
v_max3_f32 v8,v8,v191,v192
v_max3_f32 v8,v8,v193,v194
v_max3_f32 v8,v8,v195,v204
v_max_f32 v8,v8,v205
v_mov_b32 v9,v8
s_nop 1
v_permlane32_swap_b32 v8,v9
v_max_f32 v8,v8,v9
v_mov_b32 v9,v8
s_nop 1
v_permlane16_swap_b32 v8,v9
v_max_f32 v8,v8,v9
v_mul_f32 v8,s85,v8
v_fma_f32 v188,v188,s85,-v8
v_fma_f32 v189,v189,s85,-v8
v_fma_f32 v190,v190,s85,-v8
v_fma_f32 v191,v191,s85,-v8
v_fma_f32 v192,v192,s85,-v8
v_fma_f32 v193,v193,s85,-v8
v_fma_f32 v194,v194,s85,-v8
v_fma_f32 v195,v195,s85,-v8
v_fma_f32 v204,v204,s85,-v8
v_fma_f32 v205,v205,s85,-v8
v_exp_f32 v188,v188
v_exp_f32 v189,v189
v_exp_f32 v190,v190
v_exp_f32 v191,v191
v_exp_f32 v192,v192
v_exp_f32 v193,v193
v_exp_f32 v194,v194
v_exp_f32 v195,v195
v_exp_f32 v204,v204
v_exp_f32 v205,v205
v_add_f32 v8,v188,v189
v_add_f32 v8,v8,v190
v_add_f32 v8,v8,v191
v_add_f32 v8,v8,v192
v_add_f32 v8,v8,v193
v_add_f32 v8,v8,v194
v_add_f32 v8,v8,v195
v_add_f32 v8,v8,v204
v_add_f32 v8,v8,v205
v_mov_b32 v9,v8
s_nop 1
v_permlane32_swap_b32 v8,v9
v_add_f32 v8,v8,v9
v_mov_b32 v9,v8
s_nop 1
v_permlane16_swap_b32 v8,v9
v_add_f32 v8,v8,v9
v_rcp_f32 v8,v8
s_nop 0
v_mul_f32 v188,v188,v8
v_mul_f32 v189,v189,v8
v_mul_f32 v190,v190,v8
v_mul_f32 v191,v191,v8
v_mul_f32 v192,v192,v8
v_mul_f32 v193,v193,v8
v_mul_f32 v194,v194,v8
v_mul_f32 v195,v195,v8
v_mul_f32 v204,v204,v8
v_mul_f32 v205,v205,v8
v_cvt_pk_bf16_f32 v220,v188,v189
v_cvt_pk_bf16_f32 v221,v190,v191
v_cvt_pk_bf16_f32 v222,v192,v193
v_cvt_pk_bf16_f32 v223,v194,v195
v_cvt_pk_bf16_f32 v224,v204,v205
v_mov_b32 v225,0
v_mov_b32 v226,0
v_cvt_pk_bf16_f32 v227,v204,v205
s_waitcnt vmcnt(0)
s_add_u32 s66,s66,149946368
v_mfma_f32_16x16x32_bf16 v[16:19],v[112:115],v[212:215],0
v_mfma_f32_16x16x32_bf16 v[20:23],v[116:119],v[212:215],0
v_mfma_f32_16x16x32_bf16 v[24:27],v[120:123],v[212:215],0
v_mfma_f32_16x16x32_bf16 v[28:31],v[124:127],v[212:215],0
v_mfma_f32_16x16x32_bf16 v[32:35],v[128:131],v[212:215],0
v_mfma_f32_16x16x32_bf16 v[36:39],v[132:135],v[212:215],0
v_mfma_f32_16x16x32_bf16 v[40:43],v[136:139],v[212:215],0
v_mfma_f32_16x16x32_bf16 v[44:47],v[140:143],v[212:215],0
v_mfma_f32_16x16x32_bf16 v[48:51],v[144:147],v[212:215],0
v_mfma_f32_16x16x32_bf16 v[52:55],v[148:151],v[212:215],0
v_mfma_f32_16x16x32_bf16 v[56:59],v[152:155],v[212:215],0
v_mfma_f32_16x16x32_bf16 v[60:63],v[156:159],v[212:215],0
v_mfma_f32_16x16x16_bf16 v[16:19],v[172:173],v[216:217],v[16:19]
v_mfma_f32_16x16x16_bf16 v[20:23],v[172:173],v[218:219],v[20:23]
v_mfma_f32_16x16x16_bf16 v[24:27],v[174:175],v[216:217],v[24:27]
v_mfma_f32_16x16x16_bf16 v[28:31],v[174:175],v[218:219],v[28:31]
v_mfma_f32_16x16x16_bf16 v[32:35],v[176:177],v[216:217],v[32:35]
v_mfma_f32_16x16x16_bf16 v[36:39],v[176:177],v[218:219],v[36:39]
v_mfma_f32_16x16x16_bf16 v[40:43],v[178:179],v[216:217],v[40:43]
v_mfma_f32_16x16x16_bf16 v[44:47],v[178:179],v[218:219],v[44:47]
v_mfma_f32_16x16x16_bf16 v[48:51],v[180:181],v[216:217],v[48:51]
v_mfma_f32_16x16x16_bf16 v[52:55],v[180:181],v[218:219],v[52:55]
v_mfma_f32_16x16x16_bf16 v[56:59],v[182:183],v[216:217],v[56:59]
v_mfma_f32_16x16x16_bf16 v[60:63],v[182:183],v[218:219],v[60:63]
v_mfma_f32_16x16x32_bf16 v[64:67],v[112:115],v[220:223],0
v_mfma_f32_16x16x32_bf16 v[68:71],v[116:119],v[220:223],0
v_mfma_f32_16x16x32_bf16 v[72:75],v[120:123],v[220:223],0
v_mfma_f32_16x16x32_bf16 v[76:79],v[124:127],v[220:223],0
v_mfma_f32_16x16x32_bf16 v[80:83],v[128:131],v[220:223],0
v_mfma_f32_16x16x32_bf16 v[84:87],v[132:135],v[220:223],0
v_mfma_f32_16x16x32_bf16 v[88:91],v[136:139],v[220:223],0
v_mfma_f32_16x16x32_bf16 v[92:95],v[140:143],v[220:223],0
v_mfma_f32_16x16x32_bf16 v[96:99],v[144:147],v[220:223],0
v_mfma_f32_16x16x32_bf16 v[100:103],v[148:151],v[220:223],0
v_mfma_f32_16x16x32_bf16 v[104:107],v[152:155],v[220:223],0
v_mfma_f32_16x16x32_bf16 v[108:111],v[156:159],v[220:223],0
v_mfma_f32_16x16x16_bf16 v[64:67],v[172:173],v[224:225],v[64:67]
v_mfma_f32_16x16x16_bf16 v[68:71],v[172:173],v[226:227],v[68:71]
v_mfma_f32_16x16x16_bf16 v[72:75],v[174:175],v[224:225],v[72:75]
v_mfma_f32_16x16x16_bf16 v[76:79],v[174:175],v[226:227],v[76:79]
v_mfma_f32_16x16x16_bf16 v[80:83],v[176:177],v[224:225],v[80:83]
v_mfma_f32_16x16x16_bf16 v[84:87],v[176:177],v[226:227],v[84:87]
v_mfma_f32_16x16x16_bf16 v[88:91],v[178:179],v[224:225],v[88:91]
v_mfma_f32_16x16x16_bf16 v[92:95],v[178:179],v[226:227],v[92:95]
v_mfma_f32_16x16x16_bf16 v[96:99],v[180:181],v[224:225],v[96:99]
v_mfma_f32_16x16x16_bf16 v[100:103],v[180:181],v[226:227],v[100:103]
v_mfma_f32_16x16x16_bf16 v[104:107],v[182:183],v[224:225],v[104:107]
v_mfma_f32_16x16x16_bf16 v[108:111],v[182:183],v[226:227],v[108:111]
s_cmp_lg_u32 s49,0
s_nop 5
s_cbranch_scc1 ATT_OS
v_cvt_pk_bf16_f32 v232,v16,v17
v_cvt_pk_bf16_f32 v233,v18,v19
v_cvt_pk_bf16_f32 v234,v20,v21
v_cvt_pk_bf16_f32 v235,v22,v23
s_add_u32 s63,s66,0
buffer_store_dwordx4 v[232:235],v1,s[8:11],s63 offen offset:0
v_cvt_pk_bf16_f32 v236,v24,v25
v_cvt_pk_bf16_f32 v237,v26,v27
v_cvt_pk_bf16_f32 v238,v28,v29
v_cvt_pk_bf16_f32 v239,v30,v31
buffer_store_dwordx4 v[236:239],v1,s[8:11],s63 offen offset:2048
v_cvt_pk_bf16_f32 v232,v32,v33
v_cvt_pk_bf16_f32 v233,v34,v35
v_cvt_pk_bf16_f32 v234,v36,v37
v_cvt_pk_bf16_f32 v235,v38,v39
s_add_u32 s63,s66,4096
buffer_store_dwordx4 v[232:235],v1,s[8:11],s63 offen offset:0
v_cvt_pk_bf16_f32 v236,v40,v41
v_cvt_pk_bf16_f32 v237,v42,v43
v_cvt_pk_bf16_f32 v238,v44,v45
v_cvt_pk_bf16_f32 v239,v46,v47
buffer_store_dwordx4 v[236:239],v1,s[8:11],s63 offen offset:2048
v_cvt_pk_bf16_f32 v232,v48,v49
v_cvt_pk_bf16_f32 v233,v50,v51
v_cvt_pk_bf16_f32 v234,v52,v53
v_cvt_pk_bf16_f32 v235,v54,v55
s_add_u32 s63,s66,8192
buffer_store_dwordx4 v[232:235],v1,s[8:11],s63 offen offset:0
v_cvt_pk_bf16_f32 v236,v56,v57
v_cvt_pk_bf16_f32 v237,v58,v59
v_cvt_pk_bf16_f32 v238,v60,v61
v_cvt_pk_bf16_f32 v239,v62,v63
buffer_store_dwordx4 v[236:239],v1,s[8:11],s63 offen offset:2048
v_cvt_pk_bf16_f32 v232,v64,v65
v_cvt_pk_bf16_f32 v233,v66,v67
v_cvt_pk_bf16_f32 v234,v68,v69
v_cvt_pk_bf16_f32 v235,v70,v71
s_add_u32 s63,s66,1024
buffer_store_dwordx4 v[232:235],v1,s[8:11],s63 offen offset:0
v_cvt_pk_bf16_f32 v236,v72,v73
v_cvt_pk_bf16_f32 v237,v74,v75
v_cvt_pk_bf16_f32 v238,v76,v77
v_cvt_pk_bf16_f32 v239,v78,v79
buffer_store_dwordx4 v[236:239],v1,s[8:11],s63 offen offset:2048
v_cvt_pk_bf16_f32 v232,v80,v81
v_cvt_pk_bf16_f32 v233,v82,v83
v_cvt_pk_bf16_f32 v234,v84,v85
v_cvt_pk_bf16_f32 v235,v86,v87
s_add_u32 s63,s66,5120
buffer_store_dwordx4 v[232:235],v1,s[8:11],s63 offen offset:0
v_cvt_pk_bf16_f32 v236,v88,v89
v_cvt_pk_bf16_f32 v237,v90,v91
v_cvt_pk_bf16_f32 v238,v92,v93
v_cvt_pk_bf16_f32 v239,v94,v95
buffer_store_dwordx4 v[236:239],v1,s[8:11],s63 offen offset:2048
v_cvt_pk_bf16_f32 v232,v96,v97
v_cvt_pk_bf16_f32 v233,v98,v99
v_cvt_pk_bf16_f32 v234,v100,v101
v_cvt_pk_bf16_f32 v235,v102,v103
s_add_u32 s63,s66,9216
buffer_store_dwordx4 v[232:235],v1,s[8:11],s63 offen offset:0
v_cvt_pk_bf16_f32 v236,v104,v105
v_cvt_pk_bf16_f32 v237,v106,v107
v_cvt_pk_bf16_f32 v238,v108,v109
v_cvt_pk_bf16_f32 v239,v110,v111
buffer_store_dwordx4 v[236:239],v1,s[8:11],s63 offen offset:2048
s_lshl_b32 s60,s51,6
s_add_u32 s60,s60,s52
s_lshl_b32 s60,s60,9
s_add_u32 s60,s60,262144
s_lshl_b32 s61,s87,2
s_add_u32 s60,s60,s61
s_waitcnt vmcnt(0)
s_mov_b64 exec,1
buffer_store_dword v5,v1,s[8:11],s60 offen
s_mov_b64 exec,-1
s_branch ATT_OJ
ATT_OS:
v_cvt_pk_bf16_f32 v232,v16,v17
v_cvt_pk_bf16_f32 v233,v18,v19
v_cvt_pk_bf16_f32 v234,v20,v21
v_cvt_pk_bf16_f32 v235,v22,v23
s_add_u32 s63,s66,0
buffer_store_dwordx4 v[232:235],v1,s[8:11],s63 offen sc1
v_cvt_pk_bf16_f32 v236,v24,v25
v_cvt_pk_bf16_f32 v237,v26,v27
v_cvt_pk_bf16_f32 v238,v28,v29
v_cvt_pk_bf16_f32 v239,v30,v31
buffer_store_dwordx4 v[236:239],v1,s[8:11],s63 offen offset:2048 sc1
v_cvt_pk_bf16_f32 v232,v32,v33
v_cvt_pk_bf16_f32 v233,v34,v35
v_cvt_pk_bf16_f32 v234,v36,v37
v_cvt_pk_bf16_f32 v235,v38,v39
s_add_u32 s63,s66,4096
buffer_store_dwordx4 v[232:235],v1,s[8:11],s63 offen sc1
v_cvt_pk_bf16_f32 v236,v40,v41
v_cvt_pk_bf16_f32 v237,v42,v43
v_cvt_pk_bf16_f32 v238,v44,v45
v_cvt_pk_bf16_f32 v239,v46,v47
buffer_store_dwordx4 v[236:239],v1,s[8:11],s63 offen offset:2048 sc1
v_cvt_pk_bf16_f32 v232,v48,v49
v_cvt_pk_bf16_f32 v233,v50,v51
v_cvt_pk_bf16_f32 v234,v52,v53
v_cvt_pk_bf16_f32 v235,v54,v55
s_add_u32 s63,s66,8192
buffer_store_dwordx4 v[232:235],v1,s[8:11],s63 offen sc1
v_cvt_pk_bf16_f32 v236,v56,v57
v_cvt_pk_bf16_f32 v237,v58,v59
v_cvt_pk_bf16_f32 v238,v60,v61
v_cvt_pk_bf16_f32 v239,v62,v63
buffer_store_dwordx4 v[236:239],v1,s[8:11],s63 offen offset:2048 sc1
v_cvt_pk_bf16_f32 v232,v64,v65
v_cvt_pk_bf16_f32 v233,v66,v67
v_cvt_pk_bf16_f32 v234,v68,v69
v_cvt_pk_bf16_f32 v235,v70,v71
s_add_u32 s63,s66,1024
buffer_store_dwordx4 v[232:235],v1,s[8:11],s63 offen sc1
v_cvt_pk_bf16_f32 v236,v72,v73
v_cvt_pk_bf16_f32 v237,v74,v75
v_cvt_pk_bf16_f32 v238,v76,v77
v_cvt_pk_bf16_f32 v239,v78,v79
buffer_store_dwordx4 v[236:239],v1,s[8:11],s63 offen offset:2048 sc1
v_cvt_pk_bf16_f32 v232,v80,v81
v_cvt_pk_bf16_f32 v233,v82,v83
v_cvt_pk_bf16_f32 v234,v84,v85
v_cvt_pk_bf16_f32 v235,v86,v87
s_add_u32 s63,s66,5120
buffer_store_dwordx4 v[232:235],v1,s[8:11],s63 offen sc1
v_cvt_pk_bf16_f32 v236,v88,v89
v_cvt_pk_bf16_f32 v237,v90,v91
v_cvt_pk_bf16_f32 v238,v92,v93
v_cvt_pk_bf16_f32 v239,v94,v95
buffer_store_dwordx4 v[236:239],v1,s[8:11],s63 offen offset:2048 sc1
v_cvt_pk_bf16_f32 v232,v96,v97
v_cvt_pk_bf16_f32 v233,v98,v99
v_cvt_pk_bf16_f32 v234,v100,v101
v_cvt_pk_bf16_f32 v235,v102,v103
s_add_u32 s63,s66,9216
buffer_store_dwordx4 v[232:235],v1,s[8:11],s63 offen sc1
v_cvt_pk_bf16_f32 v236,v104,v105
v_cvt_pk_bf16_f32 v237,v106,v107
v_cvt_pk_bf16_f32 v238,v108,v109
v_cvt_pk_bf16_f32 v239,v110,v111
buffer_store_dwordx4 v[236:239],v1,s[8:11],s63 offen offset:2048 sc1
s_lshl_b32 s60,s51,6
s_add_u32 s60,s60,s52
s_lshl_b32 s60,s60,9
s_add_u32 s60,s60,262144
s_lshl_b32 s61,s87,2
s_add_u32 s60,s60,s61
s_waitcnt vmcnt(0)
s_mov_b64 exec,1
buffer_store_dword v5,v1,s[8:11],s60 offen sc1
s_mov_b64 exec,-1
ATT_OJ:
s_add_u32 s69,s69,393216
s_add_u32 s70,s70,2048
s_add_u32 s52,s52,2
s_cmp_lt_u32 s52,64
s_cbranch_scc1 ATT_LOOP
s_endpgm
ROLE_WO:
v_lshlrev_b32 v1,4,v0
v_mov_b32 v5,1
s_lshl_b32 s56,s48,2
s_add_u32 s56,s56,s46
v_bfe_u32 v6,v0,2,2
v_lshrrev_b32 v7,4,v0
v_add_u32 v7,v6,v7
v_and_b32 v7,3,v7
v_and_b32 v15,3,v0
v_lshlrev_b32 v15,4,v15
v_lshl_add_u32 v15,v7,6,v15
v_lshl_add_u32 v15,v6,8,v15
v_lshrrev_b32 v6,5,v0
v_bfe_u32 v7,v0,4,1
v_lshlrev_b32 v208,10,v7
v_lshl_add_u32 v208,v6,8,v208
v_and_b32 v6,15,v0
v_lshl_add_u32 v208,v6,4,v208
v_lshrrev_b32 v6,5,v0
v_add_u32 v6,2,v6
v_bfe_u32 v7,v0,4,1
v_lshlrev_b32 v209,10,v7
v_lshl_add_u32 v209,v6,8,v209
v_and_b32 v6,15,v0
v_lshl_add_u32 v209,v6,4,v209
s_mul_i32 s64,s48,6554
s_lshr_b32 s64,s64,16
s_mul_i32 s60,s64,10
s_sub_u32 s65,s48,s60
v_min_u32 v2,1,v0
s_lshl_b32 s60,s64,4
s_add_u32 s60,s60,s46
s_lshl_b32 s60,s60,1
v_add_u32 v2,s60,v2
v_lshlrev_b32 v2,2,v2
s_and_b32 s60,s46,1
s_lshl_b32 s68,s65,1
s_add_u32 s68,s68,s60
s_lshr_b32 s69,s46,1
s_mul_i32 s71,s46,24576
s_mul_i32 s58,s46,491520
s_lshl_b32 s61,s65,7
s_add_u32 s58,s58,s61
s_mul_i32 s61,s64,1966080
s_add_u32 s58,s58,s61
s_mul_i32 s61,s64,98304
s_add_u32 s71,s71,s61
s_add_u32 s71,s71,149946368
v_bfe_u32 v6,v0,2,2
v_mul_u32_u24 v205,10240,v6
v_and_b32 v6,3,v0
v_lshl_add_u32 v205,v6,4,v205
v_lshrrev_b32 v6,4,v0
v_lshl_add_u32 v205,v6,6,v205
s_mul_i32 s74,s64,81920
s_mul_i32 s61,s69,40960
s_add_u32 s74,s74,s61
s_lshl_b32 s61,s68,9
s_add_u32 s74,s74,s61
s_add_u32 s74,s74,175112192
s_lshl1_add_u32 s75,s48,s60
s_lshl_b32 s75,s75,2
s_mul_i32 s61,s69,320
s_add_u32 s75,s75,s61
s_add_u32 s75,s75,819200
v_bfe_u32 v6,v0,4,1
v_lshlrev_b32 v206,14,v6
v_lshrrev_b32 v6,5,v0
v_lshl_add_u32 v206,v6,8,v206
v_and_b32 v6,15,v0
v_lshl_add_u32 v206,v6,4,v206
s_lshl_b32 s60,s46,11
v_add_u32 v206,s60,v206
s_lshl_b32 s60,s46,13
v_add_u32 v207,s60,v1
s_waitcnt vmcnt(0)
s_barrier
s_cmp_lg_u32 s46,0
s_cbranch_scc1 arr_277
v_mov_b32 v6,1
s_lshl_b32 s3,s49,2
v_mov_b32 v7,s3
s_mov_b64 exec,1
buffer_atomic_add v6,v7,s[12:15],0 offen sc1
s_mov_b64 exec,-1
arr_277:
s_mul_i32 s63,s46,40960
s_mov_b32 s4,s26
s_mov_b32 s5,s27
s_mov_b32 s6,7864320
s_mov_b32 s7,0x20000
v_lshrrev_b32 v9,3,v0
s_mov_b32 s64,1280
v_mul_lo_u32 v9,v9,s64
v_and_b32 v10,7,v0
v_lshl_add_u32 v6,v10,4,v9
s_add_u32 m0,s63,0
s_add_u32 s65,s58,0
buffer_load_dwordx4 v6,s[4:7],s65 offen lds
s_add_u32 m0,s63,1024
s_add_u32 s65,s58,10240
buffer_load_dwordx4 v6,s[4:7],s65 offen lds
s_add_u32 m0,s63,2048
s_add_u32 s65,s58,20480
buffer_load_dwordx4 v6,s[4:7],s65 offen lds
s_add_u32 m0,s63,3072
s_add_u32 s65,s58,30720
buffer_load_dwordx4 v6,s[4:7],s65 offen lds
s_add_u32 m0,s63,4096
s_add_u32 s65,s58,40960
buffer_load_dwordx4 v6,s[4:7],s65 offen lds
s_add_u32 m0,s63,5120
s_add_u32 s65,s58,51200
buffer_load_dwordx4 v6,s[4:7],s65 offen lds
s_add_u32 m0,s63,6144
s_add_u32 s65,s58,61440
buffer_load_dwordx4 v6,s[4:7],s65 offen lds
s_add_u32 m0,s63,7168
s_add_u32 s65,s58,71680
buffer_load_dwordx4 v6,s[4:7],s65 offen lds
s_add_u32 m0,s63,8192
s_add_u32 s65,s58,81920
buffer_load_dwordx4 v6,s[4:7],s65 offen lds
s_add_u32 m0,s63,9216
s_add_u32 s65,s58,92160
buffer_load_dwordx4 v6,s[4:7],s65 offen lds
s_add_u32 m0,s63,10240
s_add_u32 s65,s58,102400
buffer_load_dwordx4 v6,s[4:7],s65 offen lds
s_add_u32 m0,s63,11264
s_add_u32 s65,s58,112640
buffer_load_dwordx4 v6,s[4:7],s65 offen lds
s_add_u32 m0,s63,12288
s_add_u32 s65,s58,122880
buffer_load_dwordx4 v6,s[4:7],s65 offen lds
s_add_u32 m0,s63,13312
s_add_u32 s65,s58,133120
buffer_load_dwordx4 v6,s[4:7],s65 offen lds
s_add_u32 m0,s63,14336
s_add_u32 s65,s58,143360
buffer_load_dwordx4 v6,s[4:7],s65 offen lds
s_add_u32 m0,s63,15360
s_add_u32 s65,s58,153600
buffer_load_dwordx4 v6,s[4:7],s65 offen lds
s_add_u32 m0,s63,16384
s_add_u32 s65,s58,163840
buffer_load_dwordx4 v6,s[4:7],s65 offen lds
s_add_u32 m0,s63,17408
s_add_u32 s65,s58,174080
buffer_load_dwordx4 v6,s[4:7],s65 offen lds
s_add_u32 m0,s63,18432
s_add_u32 s65,s58,184320
buffer_load_dwordx4 v6,s[4:7],s65 offen lds
s_add_u32 m0,s63,19456
s_add_u32 s65,s58,194560
buffer_load_dwordx4 v6,s[4:7],s65 offen lds
s_add_u32 m0,s63,20480
s_add_u32 s65,s58,204800
buffer_load_dwordx4 v6,s[4:7],s65 offen lds
s_add_u32 m0,s63,21504
s_add_u32 s65,s58,215040
buffer_load_dwordx4 v6,s[4:7],s65 offen lds
s_add_u32 m0,s63,22528
s_add_u32 s65,s58,225280
buffer_load_dwordx4 v6,s[4:7],s65 offen lds
s_add_u32 m0,s63,23552
s_add_u32 s65,s58,235520
buffer_load_dwordx4 v6,s[4:7],s65 offen lds
s_add_u32 m0,s63,24576
s_add_u32 s65,s58,245760
buffer_load_dwordx4 v6,s[4:7],s65 offen lds
s_add_u32 m0,s63,25600
s_add_u32 s65,s58,256000
buffer_load_dwordx4 v6,s[4:7],s65 offen lds
s_add_u32 m0,s63,26624
s_add_u32 s65,s58,266240
buffer_load_dwordx4 v6,s[4:7],s65 offen lds
s_add_u32 m0,s63,27648
s_add_u32 s65,s58,276480
buffer_load_dwordx4 v6,s[4:7],s65 offen lds
s_add_u32 m0,s63,28672
s_add_u32 s65,s58,286720
buffer_load_dwordx4 v6,s[4:7],s65 offen lds
s_add_u32 m0,s63,29696
s_add_u32 s65,s58,296960
buffer_load_dwordx4 v6,s[4:7],s65 offen lds
s_add_u32 m0,s63,30720
s_add_u32 s65,s58,307200
buffer_load_dwordx4 v6,s[4:7],s65 offen lds
s_add_u32 m0,s63,31744
s_add_u32 s65,s58,317440
buffer_load_dwordx4 v6,s[4:7],s65 offen lds
s_add_u32 m0,s63,32768
s_add_u32 s65,s58,327680
buffer_load_dwordx4 v6,s[4:7],s65 offen lds
s_add_u32 m0,s63,33792
s_add_u32 s65,s58,337920
buffer_load_dwordx4 v6,s[4:7],s65 offen lds
s_add_u32 m0,s63,34816
s_add_u32 s65,s58,348160
buffer_load_dwordx4 v6,s[4:7],s65 offen lds
s_add_u32 m0,s63,35840
s_add_u32 s65,s58,358400
buffer_load_dwordx4 v6,s[4:7],s65 offen lds
s_add_u32 m0,s63,36864
s_add_u32 s65,s58,368640
buffer_load_dwordx4 v6,s[4:7],s65 offen lds
s_add_u32 m0,s63,37888
s_add_u32 s65,s58,378880
buffer_load_dwordx4 v6,s[4:7],s65 offen lds
s_add_u32 m0,s63,38912
s_add_u32 s65,s58,389120
buffer_load_dwordx4 v6,s[4:7],s65 offen lds
s_add_u32 m0,s63,39936
s_add_u32 s65,s58,399360
buffer_load_dwordx4 v6,s[4:7],s65 offen lds
s_waitcnt vmcnt(20)
v_bfe_u32 v9,v0,2,2
v_lshrrev_b32 v10,5,v0
v_lshl_add_u32 v9,v10,2,v9
v_mul_u32_u24 v9,128,v9
v_and_b32 v10,1,v0
v_lshl_add_u32 v9,v10,3,v9
v_bfe_u32 v10,v0,1,1
v_lshl_add_u32 v9,v10,5,v9
v_bfe_u32 v10,v0,4,1
v_lshl_add_u32 v9,v10,4,v9
v_add_u32 v7,s63,v9
ds_read_b64_tr_b16 a[0:1],v7 offset:0
ds_read_b64_tr_b16 a[2:3],v7 offset:2048
ds_read_b64_tr_b16 a[4:5],v7 offset:1024
ds_read_b64_tr_b16 a[6:7],v7 offset:3072
ds_read_b64_tr_b16 a[96:97],v7 offset:64
ds_read_b64_tr_b16 a[98:99],v7 offset:2112
ds_read_b64_tr_b16 a[100:101],v7 offset:1088
ds_read_b64_tr_b16 a[102:103],v7 offset:3136
ds_read_b64_tr_b16 a[8:9],v7 offset:4096
ds_read_b64_tr_b16 a[10:11],v7 offset:6144
ds_read_b64_tr_b16 a[12:13],v7 offset:5120
ds_read_b64_tr_b16 a[14:15],v7 offset:7168
s_waitcnt lgkmcnt(4)
ds_read_b64_tr_b16 a[104:105],v7 offset:4160
ds_read_b64_tr_b16 a[106:107],v7 offset:6208
ds_read_b64_tr_b16 a[108:109],v7 offset:5184
ds_read_b64_tr_b16 a[110:111],v7 offset:7232
ds_read_b64_tr_b16 a[16:17],v7 offset:8192
ds_read_b64_tr_b16 a[18:19],v7 offset:10240
ds_read_b64_tr_b16 a[20:21],v7 offset:9216
ds_read_b64_tr_b16 a[22:23],v7 offset:11264
ds_read_b64_tr_b16 a[112:113],v7 offset:8256
ds_read_b64_tr_b16 a[114:115],v7 offset:10304
ds_read_b64_tr_b16 a[116:117],v7 offset:9280
ds_read_b64_tr_b16 a[118:119],v7 offset:11328
s_waitcnt lgkmcnt(4)
ds_read_b64_tr_b16 a[24:25],v7 offset:12288
ds_read_b64_tr_b16 a[26:27],v7 offset:14336
ds_read_b64_tr_b16 a[28:29],v7 offset:13312
ds_read_b64_tr_b16 a[30:31],v7 offset:15360
ds_read_b64_tr_b16 a[120:121],v7 offset:12352
ds_read_b64_tr_b16 a[122:123],v7 offset:14400
ds_read_b64_tr_b16 a[124:125],v7 offset:13376
ds_read_b64_tr_b16 a[126:127],v7 offset:15424
ds_read_b64_tr_b16 a[32:33],v7 offset:16384
ds_read_b64_tr_b16 a[34:35],v7 offset:18432
ds_read_b64_tr_b16 a[36:37],v7 offset:17408
ds_read_b64_tr_b16 a[38:39],v7 offset:19456
s_waitcnt lgkmcnt(4)
ds_read_b64_tr_b16 a[128:129],v7 offset:16448
ds_read_b64_tr_b16 a[130:131],v7 offset:18496
ds_read_b64_tr_b16 a[132:133],v7 offset:17472
ds_read_b64_tr_b16 a[134:135],v7 offset:19520
s_waitcnt lgkmcnt(0)
s_add_u32 m0,s63,0
s_add_u32 s65,s58,409600
buffer_load_dwordx4 v6,s[4:7],s65 offen lds
s_add_u32 m0,s63,1024
s_add_u32 s65,s58,419840
buffer_load_dwordx4 v6,s[4:7],s65 offen lds
s_add_u32 m0,s63,2048
s_add_u32 s65,s58,430080
buffer_load_dwordx4 v6,s[4:7],s65 offen lds
s_add_u32 m0,s63,3072
s_add_u32 s65,s58,440320
buffer_load_dwordx4 v6,s[4:7],s65 offen lds
s_add_u32 m0,s63,4096
s_add_u32 s65,s58,450560
buffer_load_dwordx4 v6,s[4:7],s65 offen lds
s_add_u32 m0,s63,5120
s_add_u32 s65,s58,460800
buffer_load_dwordx4 v6,s[4:7],s65 offen lds
s_add_u32 m0,s63,6144
s_add_u32 s65,s58,471040
buffer_load_dwordx4 v6,s[4:7],s65 offen lds
s_add_u32 m0,s63,7168
s_add_u32 s65,s58,481280
buffer_load_dwordx4 v6,s[4:7],s65 offen lds
s_waitcnt vmcnt(8)
v_bfe_u32 v9,v0,2,2
v_lshrrev_b32 v10,5,v0
v_lshl_add_u32 v9,v10,2,v9
v_mul_u32_u24 v9,128,v9
v_and_b32 v10,1,v0
v_lshl_add_u32 v9,v10,3,v9
v_bfe_u32 v10,v0,1,1
v_lshl_add_u32 v9,v10,5,v9
v_bfe_u32 v10,v0,4,1
v_lshl_add_u32 v9,v10,4,v9
v_add_u32 v7,s63,v9
ds_read_b64_tr_b16 a[40:41],v7 offset:20480
ds_read_b64_tr_b16 a[42:43],v7 offset:22528
ds_read_b64_tr_b16 a[44:45],v7 offset:21504
ds_read_b64_tr_b16 a[46:47],v7 offset:23552
ds_read_b64_tr_b16 a[136:137],v7 offset:20544
ds_read_b64_tr_b16 a[138:139],v7 offset:22592
ds_read_b64_tr_b16 a[140:141],v7 offset:21568
ds_read_b64_tr_b16 a[142:143],v7 offset:23616
ds_read_b64_tr_b16 a[48:49],v7 offset:24576
ds_read_b64_tr_b16 a[50:51],v7 offset:26624
ds_read_b64_tr_b16 a[52:53],v7 offset:25600
ds_read_b64_tr_b16 a[54:55],v7 offset:27648
s_waitcnt lgkmcnt(4)
ds_read_b64_tr_b16 a[144:145],v7 offset:24640
ds_read_b64_tr_b16 a[146:147],v7 offset:26688
ds_read_b64_tr_b16 a[148:149],v7 offset:25664
ds_read_b64_tr_b16 a[150:151],v7 offset:27712
ds_read_b64_tr_b16 a[56:57],v7 offset:28672
ds_read_b64_tr_b16 a[58:59],v7 offset:30720
ds_read_b64_tr_b16 a[60:61],v7 offset:29696
ds_read_b64_tr_b16 a[62:63],v7 offset:31744
ds_read_b64_tr_b16 a[152:153],v7 offset:28736
ds_read_b64_tr_b16 a[154:155],v7 offset:30784
ds_read_b64_tr_b16 a[156:157],v7 offset:29760
ds_read_b64_tr_b16 a[158:159],v7 offset:31808
s_waitcnt lgkmcnt(4)
ds_read_b64_tr_b16 a[64:65],v7 offset:32768
ds_read_b64_tr_b16 a[66:67],v7 offset:34816
ds_read_b64_tr_b16 a[68:69],v7 offset:33792
ds_read_b64_tr_b16 a[70:71],v7 offset:35840
ds_read_b64_tr_b16 a[160:161],v7 offset:32832
ds_read_b64_tr_b16 a[162:163],v7 offset:34880
ds_read_b64_tr_b16 a[164:165],v7 offset:33856
ds_read_b64_tr_b16 a[166:167],v7 offset:35904
ds_read_b64_tr_b16 a[72:73],v7 offset:36864
ds_read_b64_tr_b16 a[74:75],v7 offset:38912
ds_read_b64_tr_b16 a[76:77],v7 offset:37888
ds_read_b64_tr_b16 a[78:79],v7 offset:39936
s_waitcnt lgkmcnt(4)
ds_read_b64_tr_b16 a[168:169],v7 offset:36928
ds_read_b64_tr_b16 a[170:171],v7 offset:38976
ds_read_b64_tr_b16 a[172:173],v7 offset:37952
ds_read_b64_tr_b16 a[174:175],v7 offset:40000
s_waitcnt lgkmcnt(0)
s_waitcnt vmcnt(0)
v_bfe_u32 v9,v0,2,2
v_lshrrev_b32 v10,5,v0
v_lshl_add_u32 v9,v10,2,v9
v_mul_u32_u24 v9,128,v9
v_and_b32 v10,1,v0
v_lshl_add_u32 v9,v10,3,v9
v_bfe_u32 v10,v0,1,1
v_lshl_add_u32 v9,v10,5,v9
v_bfe_u32 v10,v0,4,1
v_lshl_add_u32 v9,v10,4,v9
v_add_u32 v7,s63,v9
ds_read_b64_tr_b16 a[80:81],v7 offset:0
ds_read_b64_tr_b16 a[82:83],v7 offset:2048
ds_read_b64_tr_b16 a[84:85],v7 offset:1024
ds_read_b64_tr_b16 a[86:87],v7 offset:3072
ds_read_b64_tr_b16 a[176:177],v7 offset:64
ds_read_b64_tr_b16 a[178:179],v7 offset:2112
ds_read_b64_tr_b16 a[180:181],v7 offset:1088
ds_read_b64_tr_b16 a[182:183],v7 offset:3136
ds_read_b64_tr_b16 a[88:89],v7 offset:4096
ds_read_b64_tr_b16 a[90:91],v7 offset:6144
ds_read_b64_tr_b16 a[92:93],v7 offset:5120
ds_read_b64_tr_b16 a[94:95],v7 offset:7168
s_waitcnt lgkmcnt(4)
ds_read_b64_tr_b16 a[184:185],v7 offset:4160
ds_read_b64_tr_b16 a[186:187],v7 offset:6208
ds_read_b64_tr_b16 a[188:189],v7 offset:5184
ds_read_b64_tr_b16 a[190:191],v7 offset:7232
s_waitcnt lgkmcnt(0)
s_barrier
s_lshl_b32 s3,s49,2
v_mov_b32 v7,s3
s_nop 1
ibw_278:
buffer_load_dword v6,v7,s[12:15],0 offen sc1
s_waitcnt vmcnt(0)
v_cmp_ne_u32 vcc,256,v6
s_nop 0
s_cbranch_vccz ok_279
s_sleep 8
s_sub_u32 s47,s47,1
s_cbranch_scc1 ABORT
s_branch ibw_278
ok_279:
s_cmp_lg_u32 s49,0
s_cbranch_scc1 ibok_280
v_and_b32 v7,7,v0
v_lshlrev_b32 v7,2,v7
buffer_load_dword v6,v7,s[12:15],0 offen offset:32 sc1
s_waitcnt vmcnt(0)
v_cmp_ne_u32 vcc,32,v6
s_nop 0
s_cbranch_vccz ibok_280
s_barrier
s_mov_b32 s49,1
s_mov_b32 s3,s2
s_load_dwordx16 s[16:31],s[0:1],0
s_load_dwordx8 s[32:39],s[0:1],64
s_waitcnt lgkmcnt(0)
s_branch DISPATCH
ibok_280:
s_mov_b32 s83,s100
s_mov_b32 s32,0
s_mov_b32 s59,2147483648
s_min_u32 s62,s32,127
s_sub_u32 s60,s62,14
s_lshr_b32 s34,s60,1
s_and_b32 s33,s60,1
s_cmp_eq_u32 s33,0
s_cselect_b32 s61,14,0
s_add_u32 s34,s34,s61
s_sub_u32 s61,s60,50
s_cmp_ge_u32 s60,100
s_cselect_b32 s34,s61,s34
s_cselect_b32 s33,1,s33
s_cmp_lt_u32 s62,14
s_cselect_b32 s34,s62,s34
s_cselect_b32 s33,0,s33
s_lshl_b32 s35,s33,6
s_add_u32 s35,s35,s34
s_lshl_b32 s35,s35,9
s_add_u32 s35,s35,262144
s_mul_i32 s73,s34,393216
s_add_u32 s73,s73,s71
WO_COLD:
fb_281:
buffer_load_dword v3,v2,s[8:11],s35 offen sc1
s_waitcnt vmcnt(0)
v_cmp_eq_u32 vcc,0,v3
s_nop 0
s_cbranch_vccz ok_282
s_sleep 2
s_sub_u32 s47,s47,1
s_cbranch_scc1 ABORT
s_branch fb_281
ok_282:
s_add_u32 s63,s73,0
buffer_load_dwordx4 v[16:19],v208,s[8:11],s63 offen sc1
s_nop 7
buffer_load_dwordx4 v[20:23],v209,s[8:11],s63 offen sc1
s_nop 7
buffer_load_dwordx4 v[24:27],v208,s[8:11],s63 offen offset:2048 sc1
s_nop 7
buffer_load_dwordx4 v[28:31],v209,s[8:11],s63 offen offset:2048 sc1
s_nop 7
s_add_u32 s63,s73,4096
buffer_load_dwordx4 v[32:35],v208,s[8:11],s63 offen sc1
s_nop 7
buffer_load_dwordx4 v[36:39],v209,s[8:11],s63 offen sc1
s_nop 7
buffer_load_dwordx4 v[40:43],v208,s[8:11],s63 offen offset:2048 sc1
s_nop 7
buffer_load_dwordx4 v[44:47],v209,s[8:11],s63 offen offset:2048 sc1
s_nop 7
s_add_u32 s63,s73,8192
buffer_load_dwordx4 v[48:51],v208,s[8:11],s63 offen sc1
s_nop 7
buffer_load_dwordx4 v[52:55],v209,s[8:11],s63 offen sc1
WO_NEXT:
s_mov_b32 s51,s33
s_mov_b32 s52,s34
s_mov_b32 s72,s73
s_add_u32 s32,s32,1
s_waitcnt vmcnt(9)
v_mfma_f32_32x32x16_bf16 v[112:127],a[0:3],v[16:19],0
s_add_u32 s63,s72,8192
buffer_load_dwordx4 v[56:59],v208,s[8:11],s63 offen offset:2048 sc1
s_min_u32 s62,s32,127
s_sub_u32 s60,s62,14
s_lshr_b32 s34,s60,1
v_mfma_f32_32x32x16_bf16 v[128:143],a[96:99],v[16:19],0
s_and_b32 s33,s60,1
s_cmp_eq_u32 s33,0
s_cselect_b32 s61,14,0
s_add_u32 s34,s34,s61
s_sub_u32 s61,s60,50
v_xor_b32 v206,0x8000,v206
s_waitcnt vmcnt(9)
v_mfma_f32_32x32x16_bf16 v[112:127],a[4:7],v[20:23],v[112:127]
buffer_load_dwordx4 v[60:63],v209,s[8:11],s63 offen offset:2048 sc1
s_cmp_ge_u32 s60,100
s_cselect_b32 s34,s61,s34
s_cselect_b32 s33,1,s33
v_xor_b32 v207,0x8000,v207
v_mfma_f32_32x32x16_bf16 v[128:143],a[100:103],v[20:23],v[128:143]
s_cmp_lt_u32 s62,14
s_cselect_b32 s34,s62,s34
s_cselect_b32 s33,0,s33
s_lshl_b32 s35,s33,6
s_add_u32 s35,s35,s34
s_lshl_b32 s35,s35,9
s_waitcnt vmcnt(9)
v_mfma_f32_32x32x16_bf16 v[112:127],a[8:11],v[24:27],v[112:127]
s_add_u32 s63,s72,12288
buffer_load_dwordx4 v[64:67],v208,s[8:11],s63 offen sc1
s_add_u32 s35,s35,262144
s_mul_i32 s73,s34,393216
s_add_u32 s73,s73,s71
v_mfma_f32_32x32x16_bf16 v[128:143],a[104:107],v[24:27],v[128:143]
buffer_load_dword v3,v2,s[8:11],s35 offen sc1
s_mul_i32 s64,s52,491520
s_add_u32 s64,s64,s74
s_lshl_b32 s65,s51,6
s_add_u32 s65,s65,s52
s_waitcnt vmcnt(10)
v_mfma_f32_32x32x16_bf16 v[112:127],a[12:15],v[28:31],v[112:127]
buffer_load_dwordx4 v[68:71],v209,s[8:11],s63 offen sc1
s_mul_i32 s65,s65,640
s_add_u32 s82,s65,s75
v_mfma_f32_32x32x16_bf16 v[128:143],a[108:111],v[28:31],v[128:143]
s_waitcnt vmcnt(10)
v_mfma_f32_32x32x16_bf16 v[112:127],a[16:19],v[32:35],v[112:127]
buffer_load_dwordx4 v[72:75],v208,s[8:11],s63 offen offset:2048 sc1
v_mfma_f32_32x32x16_bf16 v[128:143],a[112:115],v[32:35],v[128:143]
s_waitcnt vmcnt(10)
v_mfma_f32_32x32x16_bf16 v[112:127],a[20:23],v[36:39],v[112:127]
buffer_load_dwordx4 v[76:79],v209,s[8:11],s63 offen offset:2048 sc1
v_mfma_f32_32x32x16_bf16 v[128:143],a[116:119],v[36:39],v[128:143]
s_waitcnt vmcnt(10)
v_mfma_f32_32x32x16_bf16 v[112:127],a[24:27],v[40:43],v[112:127]
s_add_u32 s63,s72,16384
buffer_load_dwordx4 v[80:83],v208,s[8:11],s63 offen sc1
v_mfma_f32_32x32x16_bf16 v[128:143],a[120:123],v[40:43],v[128:143]
s_waitcnt vmcnt(10)
v_mfma_f32_32x32x16_bf16 v[112:127],a[28:31],v[44:47],v[112:127]
buffer_load_dwordx4 v[84:87],v209,s[8:11],s63 offen sc1
v_mfma_f32_32x32x16_bf16 v[128:143],a[124:127],v[44:47],v[128:143]
s_waitcnt vmcnt(10)
v_mfma_f32_32x32x16_bf16 v[112:127],a[32:35],v[48:51],v[112:127]
buffer_load_dwordx4 v[88:91],v208,s[8:11],s63 offen offset:2048 sc1
v_mfma_f32_32x32x16_bf16 v[128:143],a[128:131],v[48:51],v[128:143]
s_waitcnt vmcnt(10)
v_mfma_f32_32x32x16_bf16 v[112:127],a[36:39],v[52:55],v[112:127]
buffer_load_dwordx4 v[92:95],v209,s[8:11],s63 offen offset:2048 sc1
v_mfma_f32_32x32x16_bf16 v[128:143],a[132:135],v[52:55],v[128:143]
s_waitcnt vmcnt(10)
v_mfma_f32_32x32x16_bf16 v[112:127],a[40:43],v[56:59],v[112:127]
s_add_u32 s63,s72,20480
buffer_load_dwordx4 v[96:99],v208,s[8:11],s63 offen sc1
v_mfma_f32_32x32x16_bf16 v[128:143],a[136:139],v[56:59],v[128:143]
s_waitcnt vmcnt(10)
v_mfma_f32_32x32x16_bf16 v[112:127],a[44:47],v[60:63],v[112:127]
buffer_load_dwordx4 v[100:103],v209,s[8:11],s63 offen sc1
v_mfma_f32_32x32x16_bf16 v[128:143],a[140:143],v[60:63],v[128:143]
s_waitcnt vmcnt(10)
v_mfma_f32_32x32x16_bf16 v[112:127],a[48:51],v[64:67],v[112:127]
buffer_load_dwordx4 v[104:107],v208,s[8:11],s63 offen offset:2048 sc1
v_mfma_f32_32x32x16_bf16 v[128:143],a[144:147],v[64:67],v[128:143]
s_waitcnt vmcnt(10)
v_cmp_eq_u32 vcc,0,v3
s_cmp_eq_u64 vcc,0
s_cselect_b32 s37,0,2147483648
s_cmp_lt_u32 s32,128
s_cselect_b32 s37,s37,2147483648
s_waitcnt vmcnt(9)
v_mfma_f32_32x32x16_bf16 v[112:127],a[52:55],v[68:71],v[112:127]
buffer_load_dwordx4 v[108:111],v209,s[8:11],s63 offen offset:2048 sc1
s_add_u32 s67,s73,s37
v_mfma_f32_32x32x16_bf16 v[128:143],a[148:151],v[68:71],v[128:143]
s_mov_b64 exec,1
buffer_store_dword v5,v1,s[8:11],s59 offen sc1
s_mov_b64 exec,-1
s_mov_b32 s59,2147483648
s_waitcnt vmcnt(10)
v_mfma_f32_32x32x16_bf16 v[112:127],a[56:59],v[72:75],v[112:127]
s_add_u32 s63,s67,0
buffer_load_dwordx4 v[16:19],v208,s[8:11],s63 offen sc1
v_mfma_f32_32x32x16_bf16 v[128:143],a[152:155],v[72:75],v[128:143]
s_waitcnt vmcnt(10)
v_mfma_f32_32x32x16_bf16 v[112:127],a[60:63],v[76:79],v[112:127]
buffer_load_dwordx4 v[20:23],v209,s[8:11],s63 offen sc1
v_mfma_f32_32x32x16_bf16 v[128:143],a[156:159],v[76:79],v[128:143]
s_waitcnt vmcnt(10)
v_mfma_f32_32x32x16_bf16 v[112:127],a[64:67],v[80:83],v[112:127]
buffer_load_dwordx4 v[24:27],v208,s[8:11],s63 offen offset:2048 sc1
v_mfma_f32_32x32x16_bf16 v[128:143],a[160:163],v[80:83],v[128:143]
s_waitcnt vmcnt(10)
v_mfma_f32_32x32x16_bf16 v[112:127],a[68:71],v[84:87],v[112:127]
buffer_load_dwordx4 v[28:31],v209,s[8:11],s63 offen offset:2048 sc1
v_mfma_f32_32x32x16_bf16 v[128:143],a[164:167],v[84:87],v[128:143]
s_waitcnt vmcnt(10)
v_mfma_f32_32x32x16_bf16 v[112:127],a[72:75],v[88:91],v[112:127]
s_add_u32 s63,s67,4096
buffer_load_dwordx4 v[32:35],v208,s[8:11],s63 offen sc1
buffer_load_dword v3,v2,s[8:11],s35 offen sc1
v_mfma_f32_32x32x16_bf16 v[128:143],a[168:171],v[88:91],v[128:143]
s_waitcnt vmcnt(11)
v_mfma_f32_32x32x16_bf16 v[112:127],a[76:79],v[92:95],v[112:127]
buffer_load_dwordx4 v[36:39],v209,s[8:11],s63 offen sc1
v_mfma_f32_32x32x16_bf16 v[128:143],a[172:175],v[92:95],v[128:143]
s_waitcnt vmcnt(11)
v_mfma_f32_32x32x16_bf16 v[112:127],a[80:83],v[96:99],v[112:127]
buffer_load_dwordx4 v[40:43],v208,s[8:11],s63 offen offset:2048 sc1
v_mfma_f32_32x32x16_bf16 v[128:143],a[176:179],v[96:99],v[128:143]
s_waitcnt vmcnt(11)
v_mfma_f32_32x32x16_bf16 v[112:127],a[84:87],v[100:103],v[112:127]
buffer_load_dwordx4 v[44:47],v209,s[8:11],s63 offen offset:2048 sc1
v_mfma_f32_32x32x16_bf16 v[128:143],a[180:183],v[100:103],v[128:143]
s_waitcnt vmcnt(11)
v_mfma_f32_32x32x16_bf16 v[112:127],a[88:91],v[104:107],v[112:127]
s_add_u32 s63,s67,8192
buffer_load_dwordx4 v[48:51],v208,s[8:11],s63 offen sc1
v_mfma_f32_32x32x16_bf16 v[128:143],a[184:187],v[104:107],v[128:143]
s_waitcnt vmcnt(11)
v_mfma_f32_32x32x16_bf16 v[112:127],a[92:95],v[108:111],v[112:127]
buffer_load_dwordx4 v[52:55],v209,s[8:11],s63 offen sc1
v_mfma_f32_32x32x16_bf16 v[128:143],a[188:191],v[108:111],v[128:143]
s_cmp_eq_u32 s37,0
s_cbranch_scc1 ep_283
s_waitcnt vmcnt(0)
v_cmp_eq_u32 vcc,0,v3
s_cmp_eq_u64 vcc,0
s_cselect_b32 s37,0,2147483648
s_cmp_lt_u32 s32,128
s_cselect_b32 s37,s37,2147483648
s_cmp_lg_u32 s37,0
s_cbranch_scc1 ep_283
s_add_u32 s63,s73,0
buffer_load_dwordx4 v[16:19],v208,s[8:11],s63 offen sc1
buffer_load_dwordx4 v[20:23],v209,s[8:11],s63 offen sc1
buffer_load_dwordx4 v[24:27],v208,s[8:11],s63 offen offset:2048 sc1
buffer_load_dwordx4 v[28:31],v209,s[8:11],s63 offen offset:2048 sc1
s_add_u32 s63,s73,4096
buffer_load_dwordx4 v[32:35],v208,s[8:11],s63 offen sc1
buffer_load_dwordx4 v[36:39],v209,s[8:11],s63 offen sc1
buffer_load_dwordx4 v[40:43],v208,s[8:11],s63 offen offset:2048 sc1
buffer_load_dwordx4 v[44:47],v209,s[8:11],s63 offen offset:2048 sc1
s_add_u32 s63,s73,8192
buffer_load_dwordx4 v[48:51],v208,s[8:11],s63 offen sc1
buffer_load_dwordx4 v[52:55],v209,s[8:11],s63 offen sc1
ep_283:
s_nop 7
ds_write_b128 v206,v[112:115] offset:0
ds_write_b128 v206,v[116:119] offset:1024
ds_write_b128 v206,v[120:123] offset:512
ds_write_b128 v206,v[124:127] offset:1536
s_nop 0
ds_write_b128 v206,v[128:131] offset:8192
ds_write_b128 v206,v[132:135] offset:9216
ds_write_b128 v206,v[136:139] offset:8704
ds_write_b128 v206,v[140:143] offset:9728
s_waitcnt lgkmcnt(0)
s_barrier
ds_read_b128 v[144:147],v207 offset:0
ds_read_b128 v[148:151],v207 offset:1024
ds_read_b128 v[152:155],v207 offset:2048
ds_read_b128 v[156:159],v207 offset:3072
ds_read_b128 v[160:163],v207 offset:4096
ds_read_b128 v[164:167],v207 offset:5120
ds_read_b128 v[168:171],v207 offset:6144
ds_read_b128 v[172:175],v207 offset:7168
s_waitcnt lgkmcnt(4)
v_pk_add_f32 v[144:145],v[144:145],v[152:153]
v_pk_add_f32 v[146:147],v[146:147],v[154:155]
v_pk_add_f32 v[148:149],v[148:149],v[156:157]
v_pk_add_f32 v[150:151],v[150:151],v[158:159]
s_waitcnt lgkmcnt(0)
v_pk_add_f32 v[160:161],v[160:161],v[168:169]
v_pk_add_f32 v[162:163],v[162:163],v[170:171]
v_pk_add_f32 v[164:165],v[164:165],v[172:173]
v_pk_add_f32 v[166:167],v[166:167],v[174:175]
v_pk_add_f32 v[144:145],v[144:145],v[160:161]
v_pk_add_f32 v[146:147],v[146:147],v[162:163]
v_pk_add_f32 v[148:149],v[148:149],v[164:165]
v_pk_add_f32 v[150:151],v[150:151],v[166:167]
buffer_store_dwordx4 v[144:147],v205,s[8:11],s64 offen sc1
buffer_store_dwordx4 v[148:151],v205,s[8:11],s64 offen offset:256 sc1
s_mov_b32 s59,s82
s_cmp_eq_u32 s37,0
s_cbranch_scc1 WO_NEXT
s_waitcnt vmcnt(0)
s_mov_b64 exec,1
buffer_store_dword v5,v1,s[8:11],s59 offen sc1
s_mov_b64 exec,-1
s_mov_b32 s59,2147483648
s_cmp_lt_u32 s32,128
s_cbranch_scc1 WO_COLD
s_endpgm
ROLE_R1:
s_lshr_b32 s80,s48,3
s_and_b32 s48,s48,7
v_lshlrev_b32 v1,4,v0
v_mov_b32 v5,1
s_lshl_b32 s56,s48,2
s_add_u32 s56,s56,s46
v_bfe_u32 v6,v0,2,2
v_lshrrev_b32 v7,4,v0
v_add_u32 v7,v6,v7
v_and_b32 v7,3,v7
v_and_b32 v15,3,v0
v_lshlrev_b32 v15,4,v15
v_lshl_add_u32 v15,v7,6,v15
v_lshl_add_u32 v15,v6,8,v15
v_lshrrev_b32 v6,4,v0
v_bfe_u32 v7,v0,2,2
v_and_b32 v8,3,v0
s_lshr_b32 s60,s48,2
s_lshl_b32 s70,s60,10
s_and_b32 s61,s48,3
s_lshl_b32 s60,s61,8
s_add_u32 s70,s70,s60
v_lshrrev_b32 v9,1,v6
v_lshlrev_b32 v18,11,v9
v_add_u32 v9,s61,v7
v_and_b32 v9,3,v9
v_lshl_add_u32 v18,v9,6,v18
v_lshl_add_u32 v18,v8,4,v18
v_add_u32 v18,s70,v18
v_and_b32 v9,1,v6
v_lshl_add_u32 v16,v9,3,v18
v_lshl_add_u32 v17,v9,14,v18
s_lshl_b32 s60,s48,2
v_add_u32 v9,s60,v8
v_mul_u32_u24 v19,1280,v9
v_lshl_add_u32 v19,v6,5,v19
v_lshl_add_u32 v19,v7,3,v19
v_lshlrev_b32 v21,5,v8
s_lshl_b32 s60,s46,3
v_add_u32 v20,s60,v21
v_min_u32 v2,39,v0
v_lshlrev_b32 v2,3,v2
s_lshr_b32 s60,s48,2
s_mul_i32 s60,s60,320
v_add_u32 v2,s60,v2
s_cmp_lt_u32 s46,2
s_cselect_b32 s68,0,2147483648
s_cselect_b32 s69,1.0,0
s_waitcnt vmcnt(0)
s_barrier
s_cmp_lg_u32 s46,0
s_cbranch_scc1 arr_284
v_mov_b32 v6,1
s_lshl_b32 s3,s49,2
v_mov_b32 v7,s3
s_mov_b64 exec,1
buffer_atomic_add v6,v7,s[12:15],0 offen sc1
s_mov_b64 exec,-1
arr_284:
s_lshl_b32 s3,s49,2
v_mov_b32 v7,s3
s_nop 1
ibw_285:
buffer_load_dword v6,v7,s[12:15],0 offen sc1
s_waitcnt vmcnt(0)
v_cmp_ne_u32 vcc,256,v6
s_nop 0
s_cbranch_vccz ok_286
s_sleep 8
s_sub_u32 s47,s47,1
s_cbranch_scc1 ABORT
s_branch ibw_285
ok_286:
s_cmp_lg_u32 s49,0
s_cbranch_scc1 ibok_287
v_and_b32 v7,7,v0
v_lshlrev_b32 v7,2,v7
buffer_load_dword v6,v7,s[12:15],0 offen offset:32 sc1
s_waitcnt vmcnt(0)
v_cmp_ne_u32 vcc,32,v6
s_nop 0
s_cbranch_vccz ibok_287
s_barrier
s_mov_b32 s49,1
s_mov_b32 s3,s2
s_load_dwordx16 s[16:31],s[0:1],0
s_load_dwordx8 s[32:39],s[0:1],64
s_waitcnt lgkmcnt(0)
s_branch DISPATCH
ibok_287:
R1_GO:
s_mov_b32 s83,s100
s_mov_b32 s50,64
s_mov_b32 s55,1
s_mov_b32 s59,1600000
v_mov_b32 v238,1024
v_mov_b32 v239,0
ds_write_b32 v238,v239
s_waitcnt lgkmcnt(0)
s_barrier
s_mov_b32 s82,-1
v_mov_b32 v40,0
v_mov_b32 v41,0
v_mov_b32 v42,0
v_mov_b32 v43,0
v_mov_b32 v52,0
v_mov_b32 v53,0
v_mov_b32 v54,0
v_mov_b32 v55,0
v_mov_b32 v64,0
v_mov_b32 v65,0
v_mov_b32 v66,0
v_mov_b32 v67,0
v_mov_b32 v76,0
v_mov_b32 v77,0
v_mov_b32 v78,0
v_mov_b32 v79,0
v_mov_b32 v108,0
v_mov_b32 v109,0
v_mov_b32 v120,0
v_mov_b32 v121,0
v_mov_b32 v122,0
v_mov_b32 v123,0
v_mov_b32 v132,0
v_mov_b32 v133,0
v_mov_b32 v134,0
v_mov_b32 v135,0
v_mov_b32 v144,0
v_mov_b32 v145,0
v_mov_b32 v146,0
v_mov_b32 v147,0
v_mov_b32 v156,0
v_mov_b32 v157,0
v_mov_b32 v158,0
v_mov_b32 v159,0
v_mov_b32 v188,0
v_mov_b32 v189,0
s_mov_b32 s51,s80
s_sub_u32 s52,s50,64
s_lshl_b32 s67,s51,6
s_add_u32 s67,s67,s52
s_mul_i32 s67,s67,640
s_add_u32 s67,s67,819200
fb_288:
buffer_load_dwordx2 v[236:237],v2,s[8:11],s67 offen sc1
s_waitcnt vmcnt(0)
v_min_u32 v236,v236,v237
v_cmp_eq_u32 vcc,0,v236
s_nop 0
s_cbranch_vccz ok_289
s_sleep 20
s_sub_u32 s47,s47,1
s_cbranch_scc1 ABORT
s_branch fb_288
ok_289:
s_mul_i32 s66,s52,491520
s_mul_i32 s60,s48,10240
s_add_u32 s66,s66,s60
s_lshl_b32 s60,s46,10
s_add_u32 s66,s66,s60
s_add_u32 s66,s66,175112192
s_mul_i32 s60,s52,40960
s_add_u32 s60,s60,234749952
s_mul_i32 s61,s52,46080
s_add_u32 s61,s61,209518592
s_cmp_eq_u32 s51,0
s_cselect_b32 s65,s60,s61
s_lshl_b32 s60,s46,12
s_add_u32 s65,s65,s60
s_cmp_lt_u32 s46,2
s_cbranch_scc1 g2_290
v_mov_b32 v40,0
v_mov_b32 v41,0
v_mov_b32 v42,0
v_mov_b32 v43,0
s_nop 0
s_branch g3_291
g2_290:
s_add_u32 s63,s65,32768
buffer_load_dwordx2 v[108:109],v16,s[8:11],s63 offen sc1
s_add_u32 s63,s66,8192
buffer_load_dwordx4 v[40:43],v1,s[8:11],s63 offen sc1
s_add_u32 s63,s66,90112
buffer_load_dwordx4 v[52:55],v1,s[8:11],s63 offen sc1
s_add_u32 s63,s66,172032
buffer_load_dwordx4 v[64:67],v1,s[8:11],s63 offen sc1
s_add_u32 s63,s66,253952
buffer_load_dwordx4 v[76:79],v1,s[8:11],s63 offen sc1
g3_291:
s_add_u32 s63,s65,0
buffer_load_dwordx2 v[104:105],v16,s[8:11],s63 offen sc1
s_add_u32 s63,s65,16384
buffer_load_dwordx2 v[106:107],v16,s[8:11],s63 offen sc1
s_add_u32 s63,s66,0
buffer_load_dwordx4 v[32:35],v1,s[8:11],s63 offen sc1
s_add_u32 s63,s66,4096
buffer_load_dwordx4 v[36:39],v1,s[8:11],s63 offen sc1
s_add_u32 s63,s66,81920
buffer_load_dwordx4 v[44:47],v1,s[8:11],s63 offen sc1
s_add_u32 s63,s66,86016
buffer_load_dwordx4 v[48:51],v1,s[8:11],s63 offen sc1
s_add_u32 s63,s66,163840
buffer_load_dwordx4 v[56:59],v1,s[8:11],s63 offen sc1
s_add_u32 s63,s66,167936
buffer_load_dwordx4 v[60:63],v1,s[8:11],s63 offen sc1
s_add_u32 s63,s66,245760
buffer_load_dwordx4 v[68:71],v1,s[8:11],s63 offen sc1
s_add_u32 s63,s66,249856
buffer_load_dwordx4 v[72:75],v1,s[8:11],s63 offen sc1
R1_A:
s_add_u32 s66,s50,1
s_min_u32 s66,s66,127
s_mov_b32 s53,s80
s_sub_u32 s54,s66,64
s_lshl_b32 s67,s53,6
s_add_u32 s67,s67,s54
s_mul_i32 s67,s67,640
s_add_u32 s67,s67,819200
s_lshl_b32 s60,s51,6
s_add_u32 s60,s60,s52
s_mul_i32 s71,s60,40960
s_mul_i32 s73,s60,5120
s_lshl_b32 s60,s46,12
s_add_u32 s71,s71,s60
s_add_u32 s72,s71,32768
s_add_u32 s72,s72,s68
s_cmp_eq_u32 s55,0
s_cbranch_scc1 r1p_292
s_waitcnt vmcnt(8)
v_lshlrev_b32 v192,16,v104
v_and_b32 v193,0xffff0000,v104
v_lshlrev_b32 v194,16,v105
v_and_b32 v195,0xffff0000,v105
v_lshlrev_b32 v196,16,v106
v_and_b32 v197,0xffff0000,v106
v_lshlrev_b32 v198,16,v107
v_and_b32 v199,0xffff0000,v107
v_lshlrev_b32 v200,16,v108
v_and_b32 v201,0xffff0000,v108
v_lshlrev_b32 v202,16,v109
v_and_b32 v203,0xffff0000,v109
s_waitcnt vmcnt(4)
v_pk_add_f32 v[32:33],v[32:33],v[44:45]
v_pk_add_f32 v[34:35],v[34:35],v[46:47]
v_pk_add_f32 v[36:37],v[36:37],v[48:49]
v_pk_add_f32 v[38:39],v[38:39],v[50:51]
v_pk_add_f32 v[40:41],v[40:41],v[52:53]
v_pk_add_f32 v[42:43],v[42:43],v[54:55]
s_waitcnt vmcnt(2)
v_pk_add_f32 v[32:33],v[32:33],v[56:57]
v_pk_add_f32 v[34:35],v[34:35],v[58:59]
v_pk_add_f32 v[36:37],v[36:37],v[60:61]
v_pk_add_f32 v[38:39],v[38:39],v[62:63]
v_pk_add_f32 v[40:41],v[40:41],v[64:65]
v_pk_add_f32 v[42:43],v[42:43],v[66:67]
s_waitcnt vmcnt(0)
v_pk_add_f32 v[32:33],v[32:33],v[68:69]
v_pk_add_f32 v[34:35],v[34:35],v[70:71]
v_pk_add_f32 v[36:37],v[36:37],v[72:73]
v_pk_add_f32 v[38:39],v[38:39],v[74:75]
v_pk_add_f32 v[40:41],v[40:41],v[76:77]
v_pk_add_f32 v[42:43],v[42:43],v[78:79]
s_nop 0
s_branch r1j_293
r1p_292:
s_waitcnt vmcnt(9)
v_lshlrev_b32 v192,16,v104
v_and_b32 v193,0xffff0000,v104
v_lshlrev_b32 v194,16,v105
v_and_b32 v195,0xffff0000,v105
v_lshlrev_b32 v196,16,v106
v_and_b32 v197,0xffff0000,v106
v_lshlrev_b32 v198,16,v107
v_and_b32 v199,0xffff0000,v107
v_lshlrev_b32 v200,16,v108
v_and_b32 v201,0xffff0000,v108
v_lshlrev_b32 v202,16,v109
v_and_b32 v203,0xffff0000,v109
s_waitcnt vmcnt(5)
v_pk_add_f32 v[32:33],v[32:33],v[44:45]
v_pk_add_f32 v[34:35],v[34:35],v[46:47]
v_pk_add_f32 v[36:37],v[36:37],v[48:49]
v_pk_add_f32 v[38:39],v[38:39],v[50:51]
v_pk_add_f32 v[40:41],v[40:41],v[52:53]
v_pk_add_f32 v[42:43],v[42:43],v[54:55]
s_waitcnt vmcnt(3)
v_pk_add_f32 v[32:33],v[32:33],v[56:57]
v_pk_add_f32 v[34:35],v[34:35],v[58:59]
v_pk_add_f32 v[36:37],v[36:37],v[60:61]
v_pk_add_f32 v[38:39],v[38:39],v[62:63]
v_pk_add_f32 v[40:41],v[40:41],v[64:65]
v_pk_add_f32 v[42:43],v[42:43],v[66:67]
s_waitcnt vmcnt(1)
v_pk_add_f32 v[32:33],v[32:33],v[68:69]
v_pk_add_f32 v[34:35],v[34:35],v[70:71]
v_pk_add_f32 v[36:37],v[36:37],v[72:73]
v_pk_add_f32 v[38:39],v[38:39],v[74:75]
v_pk_add_f32 v[40:41],v[40:41],v[76:77]
v_pk_add_f32 v[42:43],v[42:43],v[78:79]
s_nop 1
r1j_293:
v_cvt_pk_bf16_f32 v6,v32,v33
v_lshlrev_b32 v32,16,v6
v_and_b32 v33,0xffff0000,v6
v_cvt_pk_bf16_f32 v6,v34,v35
v_lshlrev_b32 v34,16,v6
v_and_b32 v35,0xffff0000,v6
v_cvt_pk_bf16_f32 v6,v36,v37
v_lshlrev_b32 v36,16,v6
v_and_b32 v37,0xffff0000,v6
v_cvt_pk_bf16_f32 v6,v38,v39
v_lshlrev_b32 v38,16,v6
v_and_b32 v39,0xffff0000,v6
v_cvt_pk_bf16_f32 v6,v40,v41
v_lshlrev_b32 v40,16,v6
v_and_b32 v41,0xffff0000,v6
v_cvt_pk_bf16_f32 v6,v42,v43
v_lshlrev_b32 v42,16,v6
v_and_b32 v43,0xffff0000,v6
v_pk_add_f32 v[32:33],v[32:33],v[192:193]
v_pk_add_f32 v[34:35],v[34:35],v[194:195]
v_pk_add_f32 v[36:37],v[36:37],v[196:197]
v_pk_add_f32 v[38:39],v[38:39],v[198:199]
v_pk_add_f32 v[40:41],v[40:41],v[200:201]
v_pk_add_f32 v[42:43],v[42:43],v[202:203]
v_cvt_pk_bf16_f32 v204,v32,v33
v_lshlrev_b32 v32,16,v204
v_and_b32 v33,0xffff0000,v204
v_cvt_pk_bf16_f32 v205,v34,v35
v_lshlrev_b32 v34,16,v205
v_and_b32 v35,0xffff0000,v205
v_cvt_pk_bf16_f32 v206,v36,v37
v_lshlrev_b32 v36,16,v206
v_and_b32 v37,0xffff0000,v206
v_cvt_pk_bf16_f32 v207,v38,v39
v_lshlrev_b32 v38,16,v207
v_and_b32 v39,0xffff0000,v207
v_cvt_pk_bf16_f32 v208,v40,v41
v_lshlrev_b32 v40,16,v208
v_and_b32 v41,0xffff0000,v208
v_cvt_pk_bf16_f32 v209,v42,v43
v_lshlrev_b32 v42,16,v209
v_and_b32 v43,0xffff0000,v209
v_pk_add_f32 v[28:29],v[32:33],v[34:35]
v_pk_mul_f32 v[26:27],v[32:33],v[32:33]
v_pk_fma_f32 v[26:27],v[34:35],v[34:35],v[26:27]
v_pk_add_f32 v[28:29],v[28:29],v[36:37]
v_pk_fma_f32 v[26:27],v[36:37],v[36:37],v[26:27]
v_pk_add_f32 v[28:29],v[28:29],v[38:39]
v_pk_fma_f32 v[26:27],v[38:39],v[38:39],v[26:27]
v_pk_add_f32 v[28:29],v[28:29],v[40:41]
v_pk_fma_f32 v[26:27],v[40:41],v[40:41],v[26:27]
v_pk_add_f32 v[28:29],v[28:29],v[42:43]
v_pk_fma_f32 v[26:27],v[42:43],v[42:43],v[26:27]
v_add_f32 v24,v28,v29
v_add_f32 v25,v26,v27
s_nop 0
v_add_f32_dpp v24,v24,v24 row_ror:4 row_mask:0xf bank_mask:0xf
v_add_f32_dpp v25,v25,v25 row_ror:4 row_mask:0xf bank_mask:0xf
s_nop 0
v_add_f32_dpp v24,v24,v24 row_ror:8 row_mask:0xf bank_mask:0xf
v_add_f32_dpp v25,v25,v25 row_ror:8 row_mask:0xf bank_mask:0xf
v_mov_b32 v26,v24
v_mov_b32 v27,v25
s_nop 0
v_permlane32_swap_b32 v24,v26
v_permlane32_swap_b32 v25,v27
v_add_f32 v24,v24,v26
v_add_f32 v25,v25,v27
v_mov_b32 v26,v24
v_mov_b32 v27,v25
s_nop 0
v_permlane16_swap_b32 v24,v26
v_permlane16_swap_b32 v25,v27
v_add_f32 v24,v24,v26
v_add_f32 v25,v25,v27
ds_write_b64 v20,v[24:25] offset:0
s_waitcnt lgkmcnt(0)
s_barrier
ds_read_b128 v[228:231],v21 offset:0
ds_read_b128 v[232:235],v21 offset:16
buffer_load_dwordx2 v[236:237],v2,s[8:11],s67 offen sc1
v_mov_b32 v210,v208
v_mov_b32 v211,v209
s_add_u32 s63,s71,218365952
v_permlane16_swap_b32 v204,v206
v_permlane16_swap_b32 v205,v207
buffer_store_dwordx4 v[204:207],v17,s[8:11],s63 offen sc1
s_add_u32 s63,s72,218365952
v_permlane16_swap_b32 v208,v210
v_permlane16_swap_b32 v209,v211
buffer_store_dwordx4 v[208:211],v18,s[8:11],s63 offen sc1
s_waitcnt lgkmcnt(0)
v_pk_add_f32 v[228:229],v[228:229],v[230:231]
v_pk_add_f32 v[232:233],v[232:233],v[234:235]
v_pk_add_f32 v[24:25],v[228:229],v[232:233]
v_mul_f32 v24,0x3acccccd,v24
v_mul_f32 v25,0x3acccccd,v25
v_fma_f32 v25,-v24,v24,v25
v_max_f32 v25,0,v25
v_mov_b32 v28,v24
v_mov_b32 v29,v25
v_cvt_pk_bf16_f32 v6,v24,v25
v_lshlrev_b32 v24,16,v6
v_and_b32 v25,0xffff0000,v6
v_add_f32 v25,0x3727c5ac,v25
v_cvt_pk_bf16_f32 v6,v25,v25
v_lshlrev_b32 v25,16,v6
v_sqrt_f32 v25,v25
s_nop 0
v_cvt_pk_bf16_f32 v6,v25,v25
v_lshlrev_b32 v25,16,v6
v_rcp_f32 v25,v25
s_nop 0
v_pk_add_f32 v[32:33],v[32:33],v[24:25] op_sel_hi:[1,0] neg_lo:[0,1] neg_hi:[0,1]
v_pk_add_f32 v[34:35],v[34:35],v[24:25] op_sel_hi:[1,0] neg_lo:[0,1] neg_hi:[0,1]
v_pk_add_f32 v[36:37],v[36:37],v[24:25] op_sel_hi:[1,0] neg_lo:[0,1] neg_hi:[0,1]
v_pk_add_f32 v[38:39],v[38:39],v[24:25] op_sel_hi:[1,0] neg_lo:[0,1] neg_hi:[0,1]
v_pk_add_f32 v[40:41],v[40:41],v[24:25] op_sel_hi:[1,0] neg_lo:[0,1] neg_hi:[0,1]
v_pk_add_f32 v[42:43],v[42:43],v[24:25] op_sel_hi:[1,0] neg_lo:[0,1] neg_hi:[0,1]
v_cvt_pk_bf16_f32 v6,v32,v33
v_lshlrev_b32 v32,16,v6
v_and_b32 v33,0xffff0000,v6
v_cvt_pk_bf16_f32 v8,v34,v35
v_lshlrev_b32 v34,16,v8
v_and_b32 v35,0xffff0000,v8
v_cvt_pk_bf16_f32 v6,v36,v37
v_lshlrev_b32 v36,16,v6
v_and_b32 v37,0xffff0000,v6
v_cvt_pk_bf16_f32 v8,v38,v39
v_lshlrev_b32 v38,16,v8
v_and_b32 v39,0xffff0000,v8
v_cvt_pk_bf16_f32 v6,v40,v41
v_lshlrev_b32 v40,16,v6
v_and_b32 v41,0xffff0000,v6
v_cvt_pk_bf16_f32 v8,v42,v43
v_lshlrev_b32 v42,16,v8
v_and_b32 v43,0xffff0000,v8
v_pk_mul_f32 v[32:33],v[32:33],v[24:25] op_sel:[0,1] op_sel_hi:[1,1]
v_pk_mul_f32 v[34:35],v[34:35],v[24:25] op_sel:[0,1] op_sel_hi:[1,1]
v_pk_mul_f32 v[36:37],v[36:37],v[24:25] op_sel:[0,1] op_sel_hi:[1,1]
v_pk_mul_f32 v[38:39],v[38:39],v[24:25] op_sel:[0,1] op_sel_hi:[1,1]
v_pk_mul_f32 v[40:41],v[40:41],v[24:25] op_sel:[0,1] op_sel_hi:[1,1]
v_pk_mul_f32 v[42:43],v[42:43],v[24:25] op_sel:[0,1] op_sel_hi:[1,1]
v_cvt_pk_bf16_f32 v212,v32,v33
v_lshlrev_b32 v32,16,v212
v_and_b32 v33,0xffff0000,v212
v_cvt_pk_bf16_f32 v213,v34,v35
v_lshlrev_b32 v34,16,v213
v_and_b32 v35,0xffff0000,v213
v_cvt_pk_bf16_f32 v214,v36,v37
v_lshlrev_b32 v36,16,v214
v_and_b32 v37,0xffff0000,v214
v_cvt_pk_bf16_f32 v215,v38,v39
v_lshlrev_b32 v38,16,v215
v_and_b32 v39,0xffff0000,v215
v_cvt_pk_bf16_f32 v216,v40,v41
v_lshlrev_b32 v40,16,v216
v_and_b32 v41,0xffff0000,v216
v_cvt_pk_bf16_f32 v217,v42,v43
v_lshlrev_b32 v42,16,v217
v_and_b32 v43,0xffff0000,v217
v_mov_b32 v218,v216
v_mov_b32 v219,v217
s_add_u32 s63,s71,223608832
s_add_u32 s63,s63,s73
v_permlane16_swap_b32 v212,v214
v_permlane16_swap_b32 v213,v215
buffer_store_dwordx4 v[212:215],v17,s[8:11],s63 offen sc1
s_add_u32 s63,s72,223608832
s_add_u32 s63,s63,s73
v_permlane16_swap_b32 v216,v218
v_permlane16_swap_b32 v217,v219
buffer_store_dwordx4 v[216:219],v18,s[8:11],s63 offen sc1
v_sub_f32 v28,v28,v24
v_mul_f32 v29,v29,v25
v_mul_f32 v28,v28,v25
v_mul_f32 v29,v29,v25
v_cvt_pk_bf16_f32 v6,v28,v29
v_lshlrev_b32 v28,16,v6
v_and_b32 v29,0xffff0000,v6
v_add_f32 v29,0x3727c5ac,v29
v_cvt_pk_bf16_f32 v6,v29,v29
v_lshlrev_b32 v29,16,v6
v_sqrt_f32 v29,v29
s_nop 0
v_cvt_pk_bf16_f32 v6,v29,v29
v_lshlrev_b32 v29,16,v6
v_rcp_f32 v29,v29
s_lshl_b32 s60,s46,12
s_sub_u32 s63,s71,s60
s_add_u32 s63,s63,s73
s_lshl_b32 s60,s48,5
s_add_u32 s63,s63,s60
s_add_u32 s63,s63,223649792
v_lshlrev_b32 v6,3,v0
s_cmp_lg_u32 s46,3
s_cbranch_scc1 zs_294
s_mov_b64 exec,15
buffer_store_dwordx2 v[28:29],v6,s[8:11],s63 offen sc1
s_mov_b64 exec,-1
zs_294:
s_lshl_b32 s82,s51,6
s_add_u32 s82,s82,s52
s_lshl_b32 s82,s82,9
s_add_u32 s82,s82,393216
s_lshl_b32 s61,s56,2
s_add_u32 s82,s82,s61
s_add_u32 s50,s50,1
s_cmp_eq_u32 s50,128
s_cbranch_scc1 R1_END
s_mov_b32 s51,s53
s_mov_b32 s52,s54
s_waitcnt vmcnt(4)
v_min_u32 v236,v236,v237
v_cmp_eq_u32 vcc,0,v236
s_nop 0
s_cbranch_vccnz nr_295
s_add_u32 s60,s50,0
v_mov_b32 v239,s60
ds_write_b32 v238,v239
s_mul_i32 s66,s52,491520
s_mul_i32 s60,s48,10240
s_add_u32 s66,s66,s60
s_lshl_b32 s60,s46,10
s_add_u32 s66,s66,s60
s_add_u32 s66,s66,175112192
s_mul_i32 s60,s52,40960
s_add_u32 s60,s60,234749952
s_mul_i32 s61,s52,46080
s_add_u32 s61,s61,209518592
s_cmp_eq_u32 s51,0
s_cselect_b32 s65,s60,s61
s_lshl_b32 s60,s46,12
s_add_u32 s65,s65,s60
s_cmp_lt_u32 s46,2
s_cbranch_scc1 g2_296
v_mov_b32 v120,0
v_mov_b32 v121,0
v_mov_b32 v122,0
v_mov_b32 v123,0
s_nop 0
s_branch g3_297
g2_296:
s_add_u32 s63,s65,32768
buffer_load_dwordx2 v[188:189],v16,s[8:11],s63 offen sc1
s_add_u32 s63,s66,8192
buffer_load_dwordx4 v[120:123],v1,s[8:11],s63 offen sc1
s_add_u32 s63,s66,90112
buffer_load_dwordx4 v[132:135],v1,s[8:11],s63 offen sc1
s_add_u32 s63,s66,172032
buffer_load_dwordx4 v[144:147],v1,s[8:11],s63 offen sc1
s_add_u32 s63,s66,253952
buffer_load_dwordx4 v[156:159],v1,s[8:11],s63 offen sc1
g3_297:
s_add_u32 s63,s65,0
buffer_load_dwordx2 v[184:185],v16,s[8:11],s63 offen sc1
s_add_u32 s63,s65,16384
buffer_load_dwordx2 v[186:187],v16,s[8:11],s63 offen sc1
s_add_u32 s63,s66,0
buffer_load_dwordx4 v[112:115],v1,s[8:11],s63 offen sc1
s_add_u32 s63,s66,4096
buffer_load_dwordx4 v[116:119],v1,s[8:11],s63 offen sc1
s_add_u32 s63,s66,81920
buffer_load_dwordx4 v[124:127],v1,s[8:11],s63 offen sc1
s_add_u32 s63,s66,86016
buffer_load_dwordx4 v[128:131],v1,s[8:11],s63 offen sc1
s_add_u32 s63,s66,163840
buffer_load_dwordx4 v[136:139],v1,s[8:11],s63 offen sc1
s_add_u32 s63,s66,167936
buffer_load_dwordx4 v[140:143],v1,s[8:11],s63 offen sc1
s_add_u32 s63,s66,245760
buffer_load_dwordx4 v[148:151],v1,s[8:11],s63 offen sc1
s_add_u32 s63,s66,249856
buffer_load_dwordx4 v[152:155],v1,s[8:11],s63 offen sc1
s_waitcnt vmcnt(10)
s_mov_b64 exec,1
buffer_store_dword v5,v1,s[8:11],s82 offen sc1
s_mov_b64 exec,-1
s_mov_b32 s55,0
s_branch R1_B
nr_295:
s_mov_b32 s55,1
s_waitcnt vmcnt(0)
s_mov_b64 exec,1
buffer_store_dword v5,v1,s[8:11],s82 offen sc1
s_mov_b64 exec,-1
s_mov_b32 s82,-1
s_lshl_b32 s67,s51,6
s_add_u32 s67,s67,s52
s_mul_i32 s67,s67,640
s_add_u32 s67,s67,819200
s_cmp_lg_u32 s46,0
s_cbranch_scc1 wo_298
fb_300:
buffer_load_dwordx2 v[236:237],v2,s[8:11],s67 offen sc1
s_waitcnt vmcnt(0)
v_min_u32 v236,v236,v237
v_cmp_eq_u32 vcc,0,v236
s_nop 0
s_cbranch_vccz ok_301
s_sleep 7
s_sub_u32 s47,s47,1
s_cbranch_scc1 ABORT
s_branch fb_300
ok_301:
s_add_u32 s60,s50,0
v_mov_b32 v239,s60
ds_write_b32 v238,v239
s_branch wd_299
wo_298:
ds_read_b32 v239,v238
s_waitcnt lgkmcnt(0)
v_cmp_gt_u32 vcc,s50,v239
s_nop 0
s_cbranch_vccz wd_299
s_sleep 1
s_sub_u32 s59,s59,1
s_cbranch_scc1 ABORT
s_branch wo_298
wd_299:
s_mul_i32 s66,s52,491520
s_mul_i32 s60,s48,10240
s_add_u32 s66,s66,s60
s_lshl_b32 s60,s46,10
s_add_u32 s66,s66,s60
s_add_u32 s66,s66,175112192
s_mul_i32 s60,s52,40960
s_add_u32 s60,s60,234749952
s_mul_i32 s61,s52,46080
s_add_u32 s61,s61,209518592
s_cmp_eq_u32 s51,0
s_cselect_b32 s65,s60,s61
s_lshl_b32 s60,s46,12
s_add_u32 s65,s65,s60
s_cmp_lt_u32 s46,2
s_cbranch_scc1 g2_302
v_mov_b32 v120,0
v_mov_b32 v121,0
v_mov_b32 v122,0
v_mov_b32 v123,0
s_nop 0
s_branch g3_303
g2_302:
s_add_u32 s63,s65,32768
buffer_load_dwordx2 v[188:189],v16,s[8:11],s63 offen sc1
s_add_u32 s63,s66,8192
buffer_load_dwordx4 v[120:123],v1,s[8:11],s63 offen sc1
s_add_u32 s63,s66,90112
buffer_load_dwordx4 v[132:135],v1,s[8:11],s63 offen sc1
s_add_u32 s63,s66,172032
buffer_load_dwordx4 v[144:147],v1,s[8:11],s63 offen sc1
s_add_u32 s63,s66,253952
buffer_load_dwordx4 v[156:159],v1,s[8:11],s63 offen sc1
g3_303:
s_add_u32 s63,s65,0
buffer_load_dwordx2 v[184:185],v16,s[8:11],s63 offen sc1
s_add_u32 s63,s65,16384
buffer_load_dwordx2 v[186:187],v16,s[8:11],s63 offen sc1
s_add_u32 s63,s66,0
buffer_load_dwordx4 v[112:115],v1,s[8:11],s63 offen sc1
s_add_u32 s63,s66,4096
buffer_load_dwordx4 v[116:119],v1,s[8:11],s63 offen sc1
s_add_u32 s63,s66,81920
buffer_load_dwordx4 v[124:127],v1,s[8:11],s63 offen sc1
s_add_u32 s63,s66,86016
buffer_load_dwordx4 v[128:131],v1,s[8:11],s63 offen sc1
s_add_u32 s63,s66,163840
buffer_load_dwordx4 v[136:139],v1,s[8:11],s63 offen sc1
s_add_u32 s63,s66,167936
buffer_load_dwordx4 v[140:143],v1,s[8:11],s63 offen sc1
s_add_u32 s63,s66,245760
buffer_load_dwordx4 v[148:151],v1,s[8:11],s63 offen sc1
s_add_u32 s63,s66,249856
buffer_load_dwordx4 v[152:155],v1,s[8:11],s63 offen sc1
s_branch R1_B
R1_B:
s_add_u32 s66,s50,1
s_min_u32 s66,s66,127
s_mov_b32 s53,s80
s_sub_u32 s54,s66,64
s_lshl_b32 s67,s53,6
s_add_u32 s67,s67,s54
s_mul_i32 s67,s67,640
s_add_u32 s67,s67,819200
s_lshl_b32 s60,s51,6
s_add_u32 s60,s60,s52
s_mul_i32 s71,s60,40960
s_mul_i32 s73,s60,5120
s_lshl_b32 s60,s46,12
s_add_u32 s71,s71,s60
s_add_u32 s72,s71,32768
s_add_u32 s72,s72,s68
s_cmp_eq_u32 s55,0
s_cbranch_scc1 r1p_304
s_waitcnt vmcnt(8)
v_lshlrev_b32 v192,16,v184
v_and_b32 v193,0xffff0000,v184
v_lshlrev_b32 v194,16,v185
v_and_b32 v195,0xffff0000,v185
v_lshlrev_b32 v196,16,v186
v_and_b32 v197,0xffff0000,v186
v_lshlrev_b32 v198,16,v187
v_and_b32 v199,0xffff0000,v187
v_lshlrev_b32 v200,16,v188
v_and_b32 v201,0xffff0000,v188
v_lshlrev_b32 v202,16,v189
v_and_b32 v203,0xffff0000,v189
s_waitcnt vmcnt(4)
v_pk_add_f32 v[112:113],v[112:113],v[124:125]
v_pk_add_f32 v[114:115],v[114:115],v[126:127]
v_pk_add_f32 v[116:117],v[116:117],v[128:129]
v_pk_add_f32 v[118:119],v[118:119],v[130:131]
v_pk_add_f32 v[120:121],v[120:121],v[132:133]
v_pk_add_f32 v[122:123],v[122:123],v[134:135]
s_waitcnt vmcnt(2)
v_pk_add_f32 v[112:113],v[112:113],v[136:137]
v_pk_add_f32 v[114:115],v[114:115],v[138:139]
v_pk_add_f32 v[116:117],v[116:117],v[140:141]
v_pk_add_f32 v[118:119],v[118:119],v[142:143]
v_pk_add_f32 v[120:121],v[120:121],v[144:145]
v_pk_add_f32 v[122:123],v[122:123],v[146:147]
s_waitcnt vmcnt(0)
v_pk_add_f32 v[112:113],v[112:113],v[148:149]
v_pk_add_f32 v[114:115],v[114:115],v[150:151]
v_pk_add_f32 v[116:117],v[116:117],v[152:153]
v_pk_add_f32 v[118:119],v[118:119],v[154:155]
v_pk_add_f32 v[120:121],v[120:121],v[156:157]
v_pk_add_f32 v[122:123],v[122:123],v[158:159]
s_nop 0
s_branch r1j_305
r1p_304:
s_waitcnt vmcnt(9)
v_lshlrev_b32 v192,16,v184
v_and_b32 v193,0xffff0000,v184
v_lshlrev_b32 v194,16,v185
v_and_b32 v195,0xffff0000,v185
v_lshlrev_b32 v196,16,v186
v_and_b32 v197,0xffff0000,v186
v_lshlrev_b32 v198,16,v187
v_and_b32 v199,0xffff0000,v187
v_lshlrev_b32 v200,16,v188
v_and_b32 v201,0xffff0000,v188
v_lshlrev_b32 v202,16,v189
v_and_b32 v203,0xffff0000,v189
s_waitcnt vmcnt(5)
v_pk_add_f32 v[112:113],v[112:113],v[124:125]
v_pk_add_f32 v[114:115],v[114:115],v[126:127]
v_pk_add_f32 v[116:117],v[116:117],v[128:129]
v_pk_add_f32 v[118:119],v[118:119],v[130:131]
v_pk_add_f32 v[120:121],v[120:121],v[132:133]
v_pk_add_f32 v[122:123],v[122:123],v[134:135]
s_waitcnt vmcnt(3)
v_pk_add_f32 v[112:113],v[112:113],v[136:137]
v_pk_add_f32 v[114:115],v[114:115],v[138:139]
v_pk_add_f32 v[116:117],v[116:117],v[140:141]
v_pk_add_f32 v[118:119],v[118:119],v[142:143]
v_pk_add_f32 v[120:121],v[120:121],v[144:145]
v_pk_add_f32 v[122:123],v[122:123],v[146:147]
s_waitcnt vmcnt(1)
v_pk_add_f32 v[112:113],v[112:113],v[148:149]
v_pk_add_f32 v[114:115],v[114:115],v[150:151]
v_pk_add_f32 v[116:117],v[116:117],v[152:153]
v_pk_add_f32 v[118:119],v[118:119],v[154:155]
v_pk_add_f32 v[120:121],v[120:121],v[156:157]
v_pk_add_f32 v[122:123],v[122:123],v[158:159]
s_nop 1
r1j_305:
v_cvt_pk_bf16_f32 v6,v112,v113
v_lshlrev_b32 v112,16,v6
v_and_b32 v113,0xffff0000,v6
v_cvt_pk_bf16_f32 v6,v114,v115
v_lshlrev_b32 v114,16,v6
v_and_b32 v115,0xffff0000,v6
v_cvt_pk_bf16_f32 v6,v116,v117
v_lshlrev_b32 v116,16,v6
v_and_b32 v117,0xffff0000,v6
v_cvt_pk_bf16_f32 v6,v118,v119
v_lshlrev_b32 v118,16,v6
v_and_b32 v119,0xffff0000,v6
v_cvt_pk_bf16_f32 v6,v120,v121
v_lshlrev_b32 v120,16,v6
v_and_b32 v121,0xffff0000,v6
v_cvt_pk_bf16_f32 v6,v122,v123
v_lshlrev_b32 v122,16,v6
v_and_b32 v123,0xffff0000,v6
v_pk_add_f32 v[112:113],v[112:113],v[192:193]
v_pk_add_f32 v[114:115],v[114:115],v[194:195]
v_pk_add_f32 v[116:117],v[116:117],v[196:197]
v_pk_add_f32 v[118:119],v[118:119],v[198:199]
v_pk_add_f32 v[120:121],v[120:121],v[200:201]
v_pk_add_f32 v[122:123],v[122:123],v[202:203]
v_cvt_pk_bf16_f32 v204,v112,v113
v_lshlrev_b32 v112,16,v204
v_and_b32 v113,0xffff0000,v204
v_cvt_pk_bf16_f32 v205,v114,v115
v_lshlrev_b32 v114,16,v205
v_and_b32 v115,0xffff0000,v205
v_cvt_pk_bf16_f32 v206,v116,v117
v_lshlrev_b32 v116,16,v206
v_and_b32 v117,0xffff0000,v206
v_cvt_pk_bf16_f32 v207,v118,v119
v_lshlrev_b32 v118,16,v207
v_and_b32 v119,0xffff0000,v207
v_cvt_pk_bf16_f32 v208,v120,v121
v_lshlrev_b32 v120,16,v208
v_and_b32 v121,0xffff0000,v208
v_cvt_pk_bf16_f32 v209,v122,v123
v_lshlrev_b32 v122,16,v209
v_and_b32 v123,0xffff0000,v209
v_pk_add_f32 v[28:29],v[112:113],v[114:115]
v_pk_mul_f32 v[26:27],v[112:113],v[112:113]
v_pk_fma_f32 v[26:27],v[114:115],v[114:115],v[26:27]
v_pk_add_f32 v[28:29],v[28:29],v[116:117]
v_pk_fma_f32 v[26:27],v[116:117],v[116:117],v[26:27]
v_pk_add_f32 v[28:29],v[28:29],v[118:119]
v_pk_fma_f32 v[26:27],v[118:119],v[118:119],v[26:27]
v_pk_add_f32 v[28:29],v[28:29],v[120:121]
v_pk_fma_f32 v[26:27],v[120:121],v[120:121],v[26:27]
v_pk_add_f32 v[28:29],v[28:29],v[122:123]
v_pk_fma_f32 v[26:27],v[122:123],v[122:123],v[26:27]
v_add_f32 v24,v28,v29
v_add_f32 v25,v26,v27
s_nop 0
v_add_f32_dpp v24,v24,v24 row_ror:4 row_mask:0xf bank_mask:0xf
v_add_f32_dpp v25,v25,v25 row_ror:4 row_mask:0xf bank_mask:0xf
s_nop 0
v_add_f32_dpp v24,v24,v24 row_ror:8 row_mask:0xf bank_mask:0xf
v_add_f32_dpp v25,v25,v25 row_ror:8 row_mask:0xf bank_mask:0xf
v_mov_b32 v26,v24
v_mov_b32 v27,v25
s_nop 0
v_permlane32_swap_b32 v24,v26
v_permlane32_swap_b32 v25,v27
v_add_f32 v24,v24,v26
v_add_f32 v25,v25,v27
v_mov_b32 v26,v24
v_mov_b32 v27,v25
s_nop 0
v_permlane16_swap_b32 v24,v26
v_permlane16_swap_b32 v25,v27
v_add_f32 v24,v24,v26
v_add_f32 v25,v25,v27
ds_write_b64 v20,v[24:25] offset:128
s_waitcnt lgkmcnt(0)
s_barrier
ds_read_b128 v[228:231],v21 offset:128
ds_read_b128 v[232:235],v21 offset:144
buffer_load_dwordx2 v[236:237],v2,s[8:11],s67 offen sc1
v_mov_b32 v210,v208
v_mov_b32 v211,v209
s_add_u32 s63,s71,218365952
v_permlane16_swap_b32 v204,v206
v_permlane16_swap_b32 v205,v207
buffer_store_dwordx4 v[204:207],v17,s[8:11],s63 offen sc1
s_add_u32 s63,s72,218365952
v_permlane16_swap_b32 v208,v210
v_permlane16_swap_b32 v209,v211
buffer_store_dwordx4 v[208:211],v18,s[8:11],s63 offen sc1
s_waitcnt lgkmcnt(0)
v_pk_add_f32 v[228:229],v[228:229],v[230:231]
v_pk_add_f32 v[232:233],v[232:233],v[234:235]
v_pk_add_f32 v[24:25],v[228:229],v[232:233]
v_mul_f32 v24,0x3acccccd,v24
v_mul_f32 v25,0x3acccccd,v25
v_fma_f32 v25,-v24,v24,v25
v_max_f32 v25,0,v25
v_mov_b32 v28,v24
v_mov_b32 v29,v25
v_cvt_pk_bf16_f32 v6,v24,v25
v_lshlrev_b32 v24,16,v6
v_and_b32 v25,0xffff0000,v6
v_add_f32 v25,0x3727c5ac,v25
v_cvt_pk_bf16_f32 v6,v25,v25
v_lshlrev_b32 v25,16,v6
v_sqrt_f32 v25,v25
s_nop 0
v_cvt_pk_bf16_f32 v6,v25,v25
v_lshlrev_b32 v25,16,v6
v_rcp_f32 v25,v25
s_nop 0
v_pk_add_f32 v[112:113],v[112:113],v[24:25] op_sel_hi:[1,0] neg_lo:[0,1] neg_hi:[0,1]
v_pk_add_f32 v[114:115],v[114:115],v[24:25] op_sel_hi:[1,0] neg_lo:[0,1] neg_hi:[0,1]
v_pk_add_f32 v[116:117],v[116:117],v[24:25] op_sel_hi:[1,0] neg_lo:[0,1] neg_hi:[0,1]
v_pk_add_f32 v[118:119],v[118:119],v[24:25] op_sel_hi:[1,0] neg_lo:[0,1] neg_hi:[0,1]
v_pk_add_f32 v[120:121],v[120:121],v[24:25] op_sel_hi:[1,0] neg_lo:[0,1] neg_hi:[0,1]
v_pk_add_f32 v[122:123],v[122:123],v[24:25] op_sel_hi:[1,0] neg_lo:[0,1] neg_hi:[0,1]
v_cvt_pk_bf16_f32 v6,v112,v113
v_lshlrev_b32 v112,16,v6
v_and_b32 v113,0xffff0000,v6
v_cvt_pk_bf16_f32 v8,v114,v115
v_lshlrev_b32 v114,16,v8
v_and_b32 v115,0xffff0000,v8
v_cvt_pk_bf16_f32 v6,v116,v117
v_lshlrev_b32 v116,16,v6
v_and_b32 v117,0xffff0000,v6
v_cvt_pk_bf16_f32 v8,v118,v119
v_lshlrev_b32 v118,16,v8
v_and_b32 v119,0xffff0000,v8
v_cvt_pk_bf16_f32 v6,v120,v121
v_lshlrev_b32 v120,16,v6
v_and_b32 v121,0xffff0000,v6
v_cvt_pk_bf16_f32 v8,v122,v123
v_lshlrev_b32 v122,16,v8
v_and_b32 v123,0xffff0000,v8
v_pk_mul_f32 v[112:113],v[112:113],v[24:25] op_sel:[0,1] op_sel_hi:[1,1]
v_pk_mul_f32 v[114:115],v[114:115],v[24:25] op_sel:[0,1] op_sel_hi:[1,1]
v_pk_mul_f32 v[116:117],v[116:117],v[24:25] op_sel:[0,1] op_sel_hi:[1,1]
v_pk_mul_f32 v[118:119],v[118:119],v[24:25] op_sel:[0,1] op_sel_hi:[1,1]
v_pk_mul_f32 v[120:121],v[120:121],v[24:25] op_sel:[0,1] op_sel_hi:[1,1]
v_pk_mul_f32 v[122:123],v[122:123],v[24:25] op_sel:[0,1] op_sel_hi:[1,1]
v_cvt_pk_bf16_f32 v212,v112,v113
v_lshlrev_b32 v112,16,v212
v_and_b32 v113,0xffff0000,v212
v_cvt_pk_bf16_f32 v213,v114,v115
v_lshlrev_b32 v114,16,v213
v_and_b32 v115,0xffff0000,v213
v_cvt_pk_bf16_f32 v214,v116,v117
v_lshlrev_b32 v116,16,v214
v_and_b32 v117,0xffff0000,v214
v_cvt_pk_bf16_f32 v215,v118,v119
v_lshlrev_b32 v118,16,v215
v_and_b32 v119,0xffff0000,v215
v_cvt_pk_bf16_f32 v216,v120,v121
v_lshlrev_b32 v120,16,v216
v_and_b32 v121,0xffff0000,v216
v_cvt_pk_bf16_f32 v217,v122,v123
v_lshlrev_b32 v122,16,v217
v_and_b32 v123,0xffff0000,v217
v_mov_b32 v218,v216
v_mov_b32 v219,v217
s_add_u32 s63,s71,223608832
s_add_u32 s63,s63,s73
v_permlane16_swap_b32 v212,v214
v_permlane16_swap_b32 v213,v215
buffer_store_dwordx4 v[212:215],v17,s[8:11],s63 offen sc1
s_add_u32 s63,s72,223608832
s_add_u32 s63,s63,s73
v_permlane16_swap_b32 v216,v218
v_permlane16_swap_b32 v217,v219
buffer_store_dwordx4 v[216:219],v18,s[8:11],s63 offen sc1
v_sub_f32 v28,v28,v24
v_mul_f32 v29,v29,v25
v_mul_f32 v28,v28,v25
v_mul_f32 v29,v29,v25
v_cvt_pk_bf16_f32 v6,v28,v29
v_lshlrev_b32 v28,16,v6
v_and_b32 v29,0xffff0000,v6
v_add_f32 v29,0x3727c5ac,v29
v_cvt_pk_bf16_f32 v6,v29,v29
v_lshlrev_b32 v29,16,v6
v_sqrt_f32 v29,v29
s_nop 0
v_cvt_pk_bf16_f32 v6,v29,v29
v_lshlrev_b32 v29,16,v6
v_rcp_f32 v29,v29
s_lshl_b32 s60,s46,12
s_sub_u32 s63,s71,s60
s_add_u32 s63,s63,s73
s_lshl_b32 s60,s48,5
s_add_u32 s63,s63,s60
s_add_u32 s63,s63,223649792
v_lshlrev_b32 v6,3,v0
s_cmp_lg_u32 s46,3
s_cbranch_scc1 zs_306
s_mov_b64 exec,15
buffer_store_dwordx2 v[28:29],v6,s[8:11],s63 offen sc1
s_mov_b64 exec,-1
zs_306:
s_lshl_b32 s82,s51,6
s_add_u32 s82,s82,s52
s_lshl_b32 s82,s82,9
s_add_u32 s82,s82,393216
s_lshl_b32 s61,s56,2
s_add_u32 s82,s82,s61
s_add_u32 s50,s50,1
s_cmp_eq_u32 s50,128
s_cbranch_scc1 R1_END
s_mov_b32 s51,s53
s_mov_b32 s52,s54
s_waitcnt vmcnt(4)
v_min_u32 v236,v236,v237
v_cmp_eq_u32 vcc,0,v236
s_nop 0
s_cbranch_vccnz nr_307
s_add_u32 s60,s50,0
v_mov_b32 v239,s60
ds_write_b32 v238,v239
s_mul_i32 s66,s52,491520
s_mul_i32 s60,s48,10240
s_add_u32 s66,s66,s60
s_lshl_b32 s60,s46,10
s_add_u32 s66,s66,s60
s_add_u32 s66,s66,175112192
s_mul_i32 s60,s52,40960
s_add_u32 s60,s60,234749952
s_mul_i32 s61,s52,46080
s_add_u32 s61,s61,209518592
s_cmp_eq_u32 s51,0
s_cselect_b32 s65,s60,s61
s_lshl_b32 s60,s46,12
s_add_u32 s65,s65,s60
s_cmp_lt_u32 s46,2
s_cbranch_scc1 g2_308
v_mov_b32 v40,0
v_mov_b32 v41,0
v_mov_b32 v42,0
v_mov_b32 v43,0
s_nop 0
s_branch g3_309
g2_308:
s_add_u32 s63,s65,32768
buffer_load_dwordx2 v[108:109],v16,s[8:11],s63 offen sc1
s_add_u32 s63,s66,8192
buffer_load_dwordx4 v[40:43],v1,s[8:11],s63 offen sc1
s_add_u32 s63,s66,90112
buffer_load_dwordx4 v[52:55],v1,s[8:11],s63 offen sc1
s_add_u32 s63,s66,172032
buffer_load_dwordx4 v[64:67],v1,s[8:11],s63 offen sc1
s_add_u32 s63,s66,253952
buffer_load_dwordx4 v[76:79],v1,s[8:11],s63 offen sc1
g3_309:
s_add_u32 s63,s65,0
buffer_load_dwordx2 v[104:105],v16,s[8:11],s63 offen sc1
s_add_u32 s63,s65,16384
buffer_load_dwordx2 v[106:107],v16,s[8:11],s63 offen sc1
s_add_u32 s63,s66,0
buffer_load_dwordx4 v[32:35],v1,s[8:11],s63 offen sc1
s_add_u32 s63,s66,4096
buffer_load_dwordx4 v[36:39],v1,s[8:11],s63 offen sc1
s_add_u32 s63,s66,81920
buffer_load_dwordx4 v[44:47],v1,s[8:11],s63 offen sc1
s_add_u32 s63,s66,86016
buffer_load_dwordx4 v[48:51],v1,s[8:11],s63 offen sc1
s_add_u32 s63,s66,163840
buffer_load_dwordx4 v[56:59],v1,s[8:11],s63 offen sc1
s_add_u32 s63,s66,167936
buffer_load_dwordx4 v[60:63],v1,s[8:11],s63 offen sc1
s_add_u32 s63,s66,245760
buffer_load_dwordx4 v[68:71],v1,s[8:11],s63 offen sc1
s_add_u32 s63,s66,249856
buffer_load_dwordx4 v[72:75],v1,s[8:11],s63 offen sc1
s_waitcnt vmcnt(10)
s_mov_b64 exec,1
buffer_store_dword v5,v1,s[8:11],s82 offen sc1
s_mov_b64 exec,-1
s_mov_b32 s55,0
s_branch R1_A
nr_307:
s_mov_b32 s55,1
s_waitcnt vmcnt(0)
s_mov_b64 exec,1
buffer_store_dword v5,v1,s[8:11],s82 offen sc1
s_mov_b64 exec,-1
s_mov_b32 s82,-1
s_lshl_b32 s67,s51,6
s_add_u32 s67,s67,s52
s_mul_i32 s67,s67,640
s_add_u32 s67,s67,819200
s_cmp_lg_u32 s46,0
s_cbranch_scc1 wo_310
fb_312:
buffer_load_dwordx2 v[236:237],v2,s[8:11],s67 offen sc1
s_waitcnt vmcnt(0)
v_min_u32 v236,v236,v237
v_cmp_eq_u32 vcc,0,v236
s_nop 0
s_cbranch_vccz ok_313
s_sleep 7
s_sub_u32 s47,s47,1
s_cbranch_scc1 ABORT
s_branch fb_312
ok_313:
s_add_u32 s60,s50,0
v_mov_b32 v239,s60
ds_write_b32 v238,v239
s_branch wd_311
wo_310:
ds_read_b32 v239,v238
s_waitcnt lgkmcnt(0)
v_cmp_gt_u32 vcc,s50,v239
s_nop 0
s_cbranch_vccz wd_311
s_sleep 1
s_sub_u32 s59,s59,1
s_cbranch_scc1 ABORT
s_branch wo_310
wd_311:
s_mul_i32 s66,s52,491520
s_mul_i32 s60,s48,10240
s_add_u32 s66,s66,s60
s_lshl_b32 s60,s46,10
s_add_u32 s66,s66,s60
s_add_u32 s66,s66,175112192
s_mul_i32 s60,s52,40960
s_add_u32 s60,s60,234749952
s_mul_i32 s61,s52,46080
s_add_u32 s61,s61,209518592
s_cmp_eq_u32 s51,0
s_cselect_b32 s65,s60,s61
s_lshl_b32 s60,s46,12
s_add_u32 s65,s65,s60
s_cmp_lt_u32 s46,2
s_cbranch_scc1 g2_314
v_mov_b32 v40,0
v_mov_b32 v41,0
v_mov_b32 v42,0
v_mov_b32 v43,0
s_nop 0
s_branch g3_315
g2_314:
s_add_u32 s63,s65,32768
buffer_load_dwordx2 v[108:109],v16,s[8:11],s63 offen sc1
s_add_u32 s63,s66,8192
buffer_load_dwordx4 v[40:43],v1,s[8:11],s63 offen sc1
s_add_u32 s63,s66,90112
buffer_load_dwordx4 v[52:55],v1,s[8:11],s63 offen sc1
s_add_u32 s63,s66,172032
buffer_load_dwordx4 v[64:67],v1,s[8:11],s63 offen sc1
s_add_u32 s63,s66,253952
buffer_load_dwordx4 v[76:79],v1,s[8:11],s63 offen sc1
g3_315:
s_add_u32 s63,s65,0
buffer_load_dwordx2 v[104:105],v16,s[8:11],s63 offen sc1
s_add_u32 s63,s65,16384
buffer_load_dwordx2 v[106:107],v16,s[8:11],s63 offen sc1
s_add_u32 s63,s66,0
buffer_load_dwordx4 v[32:35],v1,s[8:11],s63 offen sc1
s_add_u32 s63,s66,4096
buffer_load_dwordx4 v[36:39],v1,s[8:11],s63 offen sc1
s_add_u32 s63,s66,81920
buffer_load_dwordx4 v[44:47],v1,s[8:11],s63 offen sc1
s_add_u32 s63,s66,86016
buffer_load_dwordx4 v[48:51],v1,s[8:11],s63 offen sc1
s_add_u32 s63,s66,163840
buffer_load_dwordx4 v[56:59],v1,s[8:11],s63 offen sc1
s_add_u32 s63,s66,167936
buffer_load_dwordx4 v[60:63],v1,s[8:11],s63 offen sc1
s_add_u32 s63,s66,245760
buffer_load_dwordx4 v[68:71],v1,s[8:11],s63 offen sc1
s_add_u32 s63,s66,249856
buffer_load_dwordx4 v[72:75],v1,s[8:11],s63 offen sc1
s_branch R1_A
R1_END:
s_waitcnt vmcnt(0)
s_mov_b64 exec,1
buffer_store_dword v5,v1,s[8:11],s82 offen sc1
s_mov_b64 exec,-1
s_endpgm
ROLE_W1:
v_lshlrev_b32 v1,4,v0
v_mov_b32 v5,1
s_lshl_b32 s56,s48,2
s_add_u32 s56,s56,s46
v_bfe_u32 v6,v0,2,2
v_lshrrev_b32 v7,4,v0
v_add_u32 v7,v6,v7
v_and_b32 v7,3,v7
v_and_b32 v15,3,v0
v_lshlrev_b32 v15,4,v15
v_lshl_add_u32 v15,v7,6,v15
v_lshl_add_u32 v15,v6,8,v15
v_lshrrev_b32 v6,5,v0
v_bfe_u32 v7,v0,4,1
v_lshlrev_b32 v16,10,v7
v_bfe_u32 v7,v0,2,2
v_lshl_add_u32 v16,v7,8,v16
v_add_u32 v6,v6,v7
v_and_b32 v6,3,v6
v_lshl_add_u32 v16,v6,6,v16
v_and_b32 v6,3,v0
v_lshl_add_u32 v16,v6,4,v16
v_add_u32 v18,46080,v16
v_lshrrev_b32 v6,5,v0
v_bfe_u32 v7,v0,4,1
v_lshlrev_b32 v20,10,v7
v_lshl_add_u32 v20,v6,8,v20
v_and_b32 v6,15,v0
v_lshl_add_u32 v20,v6,4,v20
v_lshrrev_b32 v6,5,v0
v_add_u32 v6,2,v6
v_bfe_u32 v7,v0,4,1
v_lshlrev_b32 v17,10,v7
v_bfe_u32 v7,v0,2,2
v_lshl_add_u32 v17,v7,8,v17
v_add_u32 v6,v6,v7
v_and_b32 v6,3,v6
v_lshl_add_u32 v17,v6,6,v17
v_and_b32 v6,3,v0
v_lshl_add_u32 v17,v6,4,v17
v_add_u32 v19,46080,v17
v_lshrrev_b32 v6,5,v0
v_add_u32 v6,2,v6
v_bfe_u32 v7,v0,4,1
v_lshlrev_b32 v21,10,v7
v_lshl_add_u32 v21,v6,8,v21
v_and_b32 v6,15,v0
v_lshl_add_u32 v21,v6,4,v21
v_min_u32 v2,31,v0
v_lshlrev_b32 v2,2,v2
v_mov_b32 v112,0xc0135761
v_mov_b32 v113,0xbdd2d3e8
s_mov_b32 s68,0xbdd2d3e8
v_mov_b32 v116,0
v_mov_b32 v117,0
v_mov_b32 v118,0
v_mov_b32 v119,0
s_lshl_b32 s60,s56,11
s_add_u32 s61,s60,237371392
buffer_store_dwordx4 v[116:119],v1,s[8:11],s61 offen sc1
buffer_store_dwordx4 v[116:119],v1,s[8:11],s61 offen offset:1024 sc1
s_add_u32 s61,s60,240033792
buffer_store_dwordx4 v[116:119],v1,s[8:11],s61 offen sc1
buffer_store_dwordx4 v[116:119],v1,s[8:11],s61 offen offset:1024 sc1
s_add_u32 s61,s60,240074752
buffer_store_dwordx4 v[116:119],v1,s[8:11],s61 offen sc1
buffer_store_dwordx4 v[116:119],v1,s[8:11],s61 offen offset:1024 sc1
s_add_u32 s61,s60,242737152
buffer_store_dwordx4 v[116:119],v1,s[8:11],s61 offen sc1
buffer_store_dwordx4 v[116:119],v1,s[8:11],s61 offen offset:1024 sc1
s_waitcnt vmcnt(0)
s_barrier
s_cmp_lg_u32 s46,0
s_cbranch_scc1 arr_316
v_mov_b32 v6,1
s_lshl_b32 s3,s49,2
v_mov_b32 v7,s3
s_mov_b64 exec,1
buffer_atomic_add v6,v7,s[12:15],0 offen sc1
s_mov_b64 exec,-1
arr_316:
s_lshl_b32 s58,s56,6
s_mul_i32 s63,s46,40960
s_mov_b32 s4,s32
s_mov_b32 s5,s33
s_mov_b32 s6,819200
s_mov_b32 s7,0x20000
v_lshrrev_b32 v9,2,v0
s_mov_b32 s64,1280
v_mul_lo_u32 v9,v9,s64
v_and_b32 v10,3,v0
v_lshl_add_u32 v6,v10,4,v9
s_add_u32 m0,s63,0
s_add_u32 s65,s58,0
buffer_load_dwordx4 v6,s[4:7],s65 offen lds
s_add_u32 m0,s63,1024
s_add_u32 s65,s58,20480
buffer_load_dwordx4 v6,s[4:7],s65 offen lds
s_add_u32 m0,s63,2048
s_add_u32 s65,s58,40960
buffer_load_dwordx4 v6,s[4:7],s65 offen lds
s_add_u32 m0,s63,3072
s_add_u32 s65,s58,61440
buffer_load_dwordx4 v6,s[4:7],s65 offen lds
s_add_u32 m0,s63,4096
s_add_u32 s65,s58,81920
buffer_load_dwordx4 v6,s[4:7],s65 offen lds
s_add_u32 m0,s63,5120
s_add_u32 s65,s58,102400
buffer_load_dwordx4 v6,s[4:7],s65 offen lds
s_add_u32 m0,s63,6144
s_add_u32 s65,s58,122880
buffer_load_dwordx4 v6,s[4:7],s65 offen lds
s_add_u32 m0,s63,7168
s_add_u32 s65,s58,143360
buffer_load_dwordx4 v6,s[4:7],s65 offen lds
s_add_u32 m0,s63,8192
s_add_u32 s65,s58,163840
buffer_load_dwordx4 v6,s[4:7],s65 offen lds
s_add_u32 m0,s63,9216
s_add_u32 s65,s58,184320
buffer_load_dwordx4 v6,s[4:7],s65 offen lds
s_add_u32 m0,s63,10240
s_add_u32 s65,s58,204800
buffer_load_dwordx4 v6,s[4:7],s65 offen lds
s_add_u32 m0,s63,11264
s_add_u32 s65,s58,225280
buffer_load_dwordx4 v6,s[4:7],s65 offen lds
s_add_u32 m0,s63,12288
s_add_u32 s65,s58,245760
buffer_load_dwordx4 v6,s[4:7],s65 offen lds
s_add_u32 m0,s63,13312
s_add_u32 s65,s58,266240
buffer_load_dwordx4 v6,s[4:7],s65 offen lds
s_add_u32 m0,s63,14336
s_add_u32 s65,s58,286720
buffer_load_dwordx4 v6,s[4:7],s65 offen lds
s_add_u32 m0,s63,15360
s_add_u32 s65,s58,307200
buffer_load_dwordx4 v6,s[4:7],s65 offen lds
s_add_u32 m0,s63,16384
s_add_u32 s65,s58,327680
buffer_load_dwordx4 v6,s[4:7],s65 offen lds
s_add_u32 m0,s63,17408
s_add_u32 s65,s58,348160
buffer_load_dwordx4 v6,s[4:7],s65 offen lds
s_add_u32 m0,s63,18432
s_add_u32 s65,s58,368640
buffer_load_dwordx4 v6,s[4:7],s65 offen lds
s_add_u32 m0,s63,19456
s_add_u32 s65,s58,389120
buffer_load_dwordx4 v6,s[4:7],s65 offen lds
s_add_u32 m0,s63,20480
s_add_u32 s65,s58,409600
buffer_load_dwordx4 v6,s[4:7],s65 offen lds
s_add_u32 m0,s63,21504
s_add_u32 s65,s58,430080
buffer_load_dwordx4 v6,s[4:7],s65 offen lds
s_add_u32 m0,s63,22528
s_add_u32 s65,s58,450560
buffer_load_dwordx4 v6,s[4:7],s65 offen lds
s_add_u32 m0,s63,23552
s_add_u32 s65,s58,471040
buffer_load_dwordx4 v6,s[4:7],s65 offen lds
s_add_u32 m0,s63,24576
s_add_u32 s65,s58,491520
buffer_load_dwordx4 v6,s[4:7],s65 offen lds
s_add_u32 m0,s63,25600
s_add_u32 s65,s58,512000
buffer_load_dwordx4 v6,s[4:7],s65 offen lds
s_add_u32 m0,s63,26624
s_add_u32 s65,s58,532480
buffer_load_dwordx4 v6,s[4:7],s65 offen lds
s_add_u32 m0,s63,27648
s_add_u32 s65,s58,552960
buffer_load_dwordx4 v6,s[4:7],s65 offen lds
s_add_u32 m0,s63,28672
s_add_u32 s65,s58,573440
buffer_load_dwordx4 v6,s[4:7],s65 offen lds
s_add_u32 m0,s63,29696
s_add_u32 s65,s58,593920
buffer_load_dwordx4 v6,s[4:7],s65 offen lds
s_add_u32 m0,s63,30720
s_add_u32 s65,s58,614400
buffer_load_dwordx4 v6,s[4:7],s65 offen lds
s_add_u32 m0,s63,31744
s_add_u32 s65,s58,634880
buffer_load_dwordx4 v6,s[4:7],s65 offen lds
s_add_u32 m0,s63,32768
s_add_u32 s65,s58,655360
buffer_load_dwordx4 v6,s[4:7],s65 offen lds
s_add_u32 m0,s63,33792
s_add_u32 s65,s58,675840
buffer_load_dwordx4 v6,s[4:7],s65 offen lds
s_add_u32 m0,s63,34816
s_add_u32 s65,s58,696320
buffer_load_dwordx4 v6,s[4:7],s65 offen lds
s_add_u32 m0,s63,35840
s_add_u32 s65,s58,716800
buffer_load_dwordx4 v6,s[4:7],s65 offen lds
s_add_u32 m0,s63,36864
s_add_u32 s65,s58,737280
buffer_load_dwordx4 v6,s[4:7],s65 offen lds
s_add_u32 m0,s63,37888
s_add_u32 s65,s58,757760
buffer_load_dwordx4 v6,s[4:7],s65 offen lds
s_add_u32 m0,s63,38912
s_add_u32 s65,s58,778240
buffer_load_dwordx4 v6,s[4:7],s65 offen lds
s_add_u32 m0,s63,39936
s_add_u32 s65,s58,798720
buffer_load_dwordx4 v6,s[4:7],s65 offen lds
s_waitcnt vmcnt(20)
v_bfe_u32 v9,v0,2,2
v_lshrrev_b32 v10,5,v0
v_lshl_add_u32 v9,v10,2,v9
v_mul_u32_u24 v9,64,v9
v_and_b32 v10,1,v0
v_lshl_add_u32 v9,v10,3,v9
v_bfe_u32 v10,v0,1,1
v_lshl_add_u32 v9,v10,5,v9
v_bfe_u32 v10,v0,4,1
v_lshl_add_u32 v9,v10,4,v9
v_add_u32 v7,s63,v9
ds_read_b64_tr_b16 a[0:1],v7 offset:0
ds_read_b64_tr_b16 a[2:3],v7 offset:1024
ds_read_b64_tr_b16 a[4:5],v7 offset:512
ds_read_b64_tr_b16 a[6:7],v7 offset:1536
ds_read_b64_tr_b16 a[8:9],v7 offset:2048
ds_read_b64_tr_b16 a[10:11],v7 offset:3072
ds_read_b64_tr_b16 a[12:13],v7 offset:2560
ds_read_b64_tr_b16 a[14:15],v7 offset:3584
ds_read_b64_tr_b16 a[16:17],v7 offset:4096
ds_read_b64_tr_b16 a[18:19],v7 offset:5120
ds_read_b64_tr_b16 a[20:21],v7 offset:4608
ds_read_b64_tr_b16 a[22:23],v7 offset:5632
s_waitcnt lgkmcnt(4)
ds_read_b64_tr_b16 a[24:25],v7 offset:6144
ds_read_b64_tr_b16 a[26:27],v7 offset:7168
ds_read_b64_tr_b16 a[28:29],v7 offset:6656
ds_read_b64_tr_b16 a[30:31],v7 offset:7680
ds_read_b64_tr_b16 a[32:33],v7 offset:8192
ds_read_b64_tr_b16 a[34:35],v7 offset:9216
ds_read_b64_tr_b16 a[36:37],v7 offset:8704
ds_read_b64_tr_b16 a[38:39],v7 offset:9728
ds_read_b64_tr_b16 a[40:41],v7 offset:10240
ds_read_b64_tr_b16 a[42:43],v7 offset:11264
ds_read_b64_tr_b16 a[44:45],v7 offset:10752
ds_read_b64_tr_b16 a[46:47],v7 offset:11776
s_waitcnt lgkmcnt(4)
ds_read_b64_tr_b16 a[48:49],v7 offset:12288
ds_read_b64_tr_b16 a[50:51],v7 offset:13312
ds_read_b64_tr_b16 a[52:53],v7 offset:12800
ds_read_b64_tr_b16 a[54:55],v7 offset:13824
ds_read_b64_tr_b16 a[56:57],v7 offset:14336
ds_read_b64_tr_b16 a[58:59],v7 offset:15360
ds_read_b64_tr_b16 a[60:61],v7 offset:14848
ds_read_b64_tr_b16 a[62:63],v7 offset:15872
ds_read_b64_tr_b16 a[64:65],v7 offset:16384
ds_read_b64_tr_b16 a[66:67],v7 offset:17408
ds_read_b64_tr_b16 a[68:69],v7 offset:16896
ds_read_b64_tr_b16 a[70:71],v7 offset:17920
s_waitcnt lgkmcnt(4)
ds_read_b64_tr_b16 a[72:73],v7 offset:18432
ds_read_b64_tr_b16 a[74:75],v7 offset:19456
ds_read_b64_tr_b16 a[76:77],v7 offset:18944
ds_read_b64_tr_b16 a[78:79],v7 offset:19968
s_waitcnt lgkmcnt(0)
s_waitcnt vmcnt(0)
v_bfe_u32 v9,v0,2,2
v_lshrrev_b32 v10,5,v0
v_lshl_add_u32 v9,v10,2,v9
v_mul_u32_u24 v9,64,v9
v_and_b32 v10,1,v0
v_lshl_add_u32 v9,v10,3,v9
v_bfe_u32 v10,v0,1,1
v_lshl_add_u32 v9,v10,5,v9
v_bfe_u32 v10,v0,4,1
v_lshl_add_u32 v9,v10,4,v9
v_add_u32 v7,s63,v9
ds_read_b64_tr_b16 a[80:81],v7 offset:20480
ds_read_b64_tr_b16 a[82:83],v7 offset:21504
ds_read_b64_tr_b16 a[84:85],v7 offset:20992
ds_read_b64_tr_b16 a[86:87],v7 offset:22016
ds_read_b64_tr_b16 a[88:89],v7 offset:22528
ds_read_b64_tr_b16 a[90:91],v7 offset:23552
ds_read_b64_tr_b16 a[92:93],v7 offset:23040
ds_read_b64_tr_b16 a[94:95],v7 offset:24064
ds_read_b64_tr_b16 a[96:97],v7 offset:24576
ds_read_b64_tr_b16 a[98:99],v7 offset:25600
ds_read_b64_tr_b16 a[100:101],v7 offset:25088
ds_read_b64_tr_b16 a[102:103],v7 offset:26112
s_waitcnt lgkmcnt(4)
ds_read_b64_tr_b16 a[104:105],v7 offset:26624
ds_read_b64_tr_b16 a[106:107],v7 offset:27648
ds_read_b64_tr_b16 a[108:109],v7 offset:27136
ds_read_b64_tr_b16 a[110:111],v7 offset:28160
ds_read_b64_tr_b16 a[112:113],v7 offset:28672
ds_read_b64_tr_b16 a[114:115],v7 offset:29696
ds_read_b64_tr_b16 a[116:117],v7 offset:29184
ds_read_b64_tr_b16 a[118:119],v7 offset:30208
ds_read_b64_tr_b16 a[120:121],v7 offset:30720
ds_read_b64_tr_b16 a[122:123],v7 offset:31744
ds_read_b64_tr_b16 a[124:125],v7 offset:31232
ds_read_b64_tr_b16 a[126:127],v7 offset:32256
s_waitcnt lgkmcnt(4)
ds_read_b64_tr_b16 a[128:129],v7 offset:32768
ds_read_b64_tr_b16 a[130:131],v7 offset:33792
ds_read_b64_tr_b16 a[132:133],v7 offset:33280
ds_read_b64_tr_b16 a[134:135],v7 offset:34304
ds_read_b64_tr_b16 a[136:137],v7 offset:34816
ds_read_b64_tr_b16 a[138:139],v7 offset:35840
ds_read_b64_tr_b16 a[140:141],v7 offset:35328
ds_read_b64_tr_b16 a[142:143],v7 offset:36352
ds_read_b64_tr_b16 a[144:145],v7 offset:36864
ds_read_b64_tr_b16 a[146:147],v7 offset:37888
ds_read_b64_tr_b16 a[148:149],v7 offset:37376
ds_read_b64_tr_b16 a[150:151],v7 offset:38400
s_waitcnt lgkmcnt(4)
ds_read_b64_tr_b16 a[152:153],v7 offset:38912
ds_read_b64_tr_b16 a[154:155],v7 offset:39936
ds_read_b64_tr_b16 a[156:157],v7 offset:39424
ds_read_b64_tr_b16 a[158:159],v7 offset:40448
s_waitcnt lgkmcnt(0)
v_mov_b32 v24,0x3f803f80
v_mov_b32 v25,0x3f803f80
v_mov_b32 v26,0x3f803f80
v_mov_b32 v27,0x3f803f80
s_nop 1
v_mfma_f32_32x32x16_bf16 v[144:159],a[0:3],v[24:27],0
v_mfma_f32_32x32x16_bf16 v[144:159],a[4:7],v[24:27],v[144:159]
v_mfma_f32_32x32x16_bf16 v[144:159],a[8:11],v[24:27],v[144:159]
v_mfma_f32_32x32x16_bf16 v[144:159],a[12:15],v[24:27],v[144:159]
v_mfma_f32_32x32x16_bf16 v[144:159],a[16:19],v[24:27],v[144:159]
v_mfma_f32_32x32x16_bf16 v[144:159],a[20:23],v[24:27],v[144:159]
v_mfma_f32_32x32x16_bf16 v[144:159],a[24:27],v[24:27],v[144:159]
v_mfma_f32_32x32x16_bf16 v[144:159],a[28:31],v[24:27],v[144:159]
v_mfma_f32_32x32x16_bf16 v[144:159],a[32:35],v[24:27],v[144:159]
v_mfma_f32_32x32x16_bf16 v[144:159],a[36:39],v[24:27],v[144:159]
v_mfma_f32_32x32x16_bf16 v[144:159],a[40:43],v[24:27],v[144:159]
v_mfma_f32_32x32x16_bf16 v[144:159],a[44:47],v[24:27],v[144:159]
v_mfma_f32_32x32x16_bf16 v[144:159],a[48:51],v[24:27],v[144:159]
v_mfma_f32_32x32x16_bf16 v[144:159],a[52:55],v[24:27],v[144:159]
v_mfma_f32_32x32x16_bf16 v[144:159],a[56:59],v[24:27],v[144:159]
v_mfma_f32_32x32x16_bf16 v[144:159],a[60:63],v[24:27],v[144:159]
v_mfma_f32_32x32x16_bf16 v[144:159],a[64:67],v[24:27],v[144:159]
v_mfma_f32_32x32x16_bf16 v[144:159],a[68:71],v[24:27],v[144:159]
v_mfma_f32_32x32x16_bf16 v[144:159],a[72:75],v[24:27],v[144:159]
v_mfma_f32_32x32x16_bf16 v[144:159],a[76:79],v[24:27],v[144:159]
v_mfma_f32_32x32x16_bf16 v[144:159],a[80:83],v[24:27],v[144:159]
v_mfma_f32_32x32x16_bf16 v[144:159],a[84:87],v[24:27],v[144:159]
v_mfma_f32_32x32x16_bf16 v[144:159],a[88:91],v[24:27],v[144:159]
v_mfma_f32_32x32x16_bf16 v[144:159],a[92:95],v[24:27],v[144:159]
v_mfma_f32_32x32x16_bf16 v[144:159],a[96:99],v[24:27],v[144:159]
v_mfma_f32_32x32x16_bf16 v[144:159],a[100:103],v[24:27],v[144:159]
v_mfma_f32_32x32x16_bf16 v[144:159],a[104:107],v[24:27],v[144:159]
v_mfma_f32_32x32x16_bf16 v[144:159],a[108:111],v[24:27],v[144:159]
v_mfma_f32_32x32x16_bf16 v[144:159],a[112:115],v[24:27],v[144:159]
v_mfma_f32_32x32x16_bf16 v[144:159],a[116:119],v[24:27],v[144:159]
v_mfma_f32_32x32x16_bf16 v[144:159],a[120:123],v[24:27],v[144:159]
v_mfma_f32_32x32x16_bf16 v[144:159],a[124:127],v[24:27],v[144:159]
v_mfma_f32_32x32x16_bf16 v[144:159],a[128:131],v[24:27],v[144:159]
v_mfma_f32_32x32x16_bf16 v[144:159],a[132:135],v[24:27],v[144:159]
v_mfma_f32_32x32x16_bf16 v[144:159],a[136:139],v[24:27],v[144:159]
v_mfma_f32_32x32x16_bf16 v[144:159],a[140:143],v[24:27],v[144:159]
v_mfma_f32_32x32x16_bf16 v[144:159],a[144:147],v[24:27],v[144:159]
v_mfma_f32_32x32x16_bf16 v[144:159],a[148:151],v[24:27],v[144:159]
v_mfma_f32_32x32x16_bf16 v[144:159],a[152:155],v[24:27],v[144:159]
v_mfma_f32_32x32x16_bf16 v[144:159],a[156:159],v[24:27],v[144:159]
v_and_b32 v182,31,v0
v_lshlrev_b32 v182,3,v182
v_add_u32 v182,0xa000,v182
s_barrier
s_lshl_b32 s3,s49,2
v_mov_b32 v7,s3
s_nop 5
ibw_317:
buffer_load_dword v6,v7,s[12:15],0 offen sc1
s_waitcnt vmcnt(0)
v_cmp_ne_u32 vcc,256,v6
s_nop 0
s_cbranch_vccz ok_318
s_sleep 8
s_sub_u32 s47,s47,1
s_cbranch_scc1 ABORT
s_branch ibw_317
ok_318:
s_cmp_lg_u32 s49,0
s_cbranch_scc1 ibok_319
v_and_b32 v7,7,v0
v_lshlrev_b32 v7,2,v7
buffer_load_dword v6,v7,s[12:15],0 offen offset:32 sc1
s_waitcnt vmcnt(0)
v_cmp_ne_u32 vcc,32,v6
s_nop 0
s_cbranch_vccz ibok_319
s_barrier
s_mov_b32 s49,1
s_mov_b32 s3,s2
s_load_dwordx16 s[16:31],s[0:1],0
s_load_dwordx8 s[32:39],s[0:1],64
s_waitcnt lgkmcnt(0)
s_branch DISPATCH
ibok_319:
s_mov_b32 s50,0
s_mov_b32 s32,0
s_mov_b32 s57,0
s_mov_b32 s59,2147483648
s_mov_b32 s82,2147483648
s_mov_b32 s39,2147483648
v_mov_b32 v22,94208
v_mov_b32 v23,0
ds_write_b32 v22,v23
s_mov_b32 s39,1600000
s_waitcnt lgkmcnt(0)
s_barrier
s_mov_b32 s83,s100
s_min_u32 s62,s32,127
s_sub_u32 s60,s62,14
s_lshr_b32 s34,s60,1
s_and_b32 s33,s60,1
s_cmp_eq_u32 s33,0
s_cselect_b32 s61,14,0
s_add_u32 s34,s34,s61
s_sub_u32 s61,s60,50
s_cmp_ge_u32 s60,100
s_cselect_b32 s34,s61,s34
s_cselect_b32 s33,1,s33
s_cmp_lt_u32 s62,14
s_cselect_b32 s34,s62,s34
s_cselect_b32 s33,0,s33
s_lshl_b32 s35,s33,6
s_add_u32 s35,s35,s34
s_lshl_b32 s35,s35,9
s_add_u32 s35,s35,393216
s_sub_u32 s57,46080,s57
v_swap_b32 v16,v18
v_swap_b32 v17,v19
s_mov_b32 s50,-1
s_nop 0
W1_COLD:
s_mov_b32 s37,0
s_cmp_lg_u32 s46,0
s_cbranch_scc1 wo_320
fb_322:
buffer_load_dword v3,v2,s[8:11],s35 offen sc1
s_waitcnt vmcnt(0)
v_cmp_eq_u32 vcc,0,v3
s_nop 0
s_cbranch_vccz ok_323
s_sleep 7
s_sub_u32 s47,s47,1
s_cbranch_scc1 ABORT
s_branch fb_322
ok_323:
s_add_u32 s65,s32,1
s_or_b32 s65,s65,s37
v_mov_b32 v23,s65
ds_max_i32 v22,v23
s_branch wd_321
wo_320:
ds_read_b32 v23,v22
s_waitcnt lgkmcnt(0)
v_cmp_ge_u32 vcc,s32,v23
s_nop 0
s_cbranch_vccz wd_321
s_sleep 1
s_sub_u32 s39,s39,1
s_cbranch_scc1 ABORT
s_branch wo_320
wd_321:
s_sub_u32 s66,46080,s57
s_lshl_b32 s60,s33,6
s_add_u32 s60,s60,s34
s_mul_i32 s60,s60,46080
s_add_u32 s60,s60,s37
s_add_u32 s60,s60,223608832
s_add_u32 m0,s66,40960
s_add_u32 s63,s60,40960
buffer_load_dwordx4 v1,s[8:11],s63 offen sc1 lds
s_mul_i32 s61,s46,10240
s_add_u32 s60,s60,s61
s_add_u32 s61,s61,s66
s_add_u32 m0,s61,0
s_add_u32 s63,s60,0
buffer_load_dwordx4 v1,s[8:11],s63 offen sc1 lds
buffer_load_dwordx4 v1,s[8:11],s63 offen offset:1024 sc1 lds
buffer_load_dwordx4 v1,s[8:11],s63 offen offset:2048 sc1 lds
buffer_load_dwordx4 v1,s[8:11],s63 offen offset:3072 sc1 lds
s_add_u32 m0,s61,4096
s_add_u32 s63,s60,4096
buffer_load_dwordx4 v1,s[8:11],s63 offen sc1 lds
buffer_load_dwordx4 v1,s[8:11],s63 offen offset:1024 sc1 lds
buffer_load_dwordx4 v1,s[8:11],s63 offen offset:2048 sc1 lds
buffer_load_dwordx4 v1,s[8:11],s63 offen offset:3072 sc1 lds
s_add_u32 m0,s61,8192
s_add_u32 s63,s60,8192
buffer_load_dwordx4 v1,s[8:11],s63 offen sc1 lds
buffer_load_dwordx4 v1,s[8:11],s63 offen offset:1024 sc1 lds
s_mov_b32 s55,1
W1_NEXT:
s_add_u32 s50,s50,1
s_sub_u32 s57,46080,s57
v_swap_b32 v16,v18
v_swap_b32 v17,v19
s_mov_b32 s51,s33
s_mov_b32 s52,s34
s_add_u32 s32,s32,1
s_min_u32 s62,s32,127
s_sub_u32 s60,s62,14
s_lshr_b32 s34,s60,1
s_and_b32 s33,s60,1
s_cmp_eq_u32 s33,0
s_cselect_b32 s61,14,0
s_add_u32 s34,s34,s61
s_sub_u32 s61,s60,50
s_cmp_ge_u32 s60,100
s_cselect_b32 s34,s61,s34
s_cselect_b32 s33,1,s33
s_cmp_lt_u32 s62,14
s_cselect_b32 s34,s62,s34
s_cselect_b32 s33,0,s33
s_lshl_b32 s35,s33,6
s_add_u32 s35,s35,s34
s_lshl_b32 s35,s35,9
s_add_u32 s35,s35,393216
s_waitcnt vmcnt(2)
s_cmp_eq_u32 s55,0
s_cbranch_scc1 wv_324
s_waitcnt vmcnt(0)
wv_324:
s_barrier
ds_read_b128 v[24:27],v16 offset:0
ds_read_b128 v[28:31],v17 offset:0
ds_read_b128 v[32:35],v16 offset:2048
ds_read_b128 v[36:39],v17 offset:2048
ds_read_b128 v[40:43],v16 offset:4096
ds_read_b128 v[44:47],v17 offset:4096
ds_read_b128 v[48:51],v16 offset:6144
buffer_load_dword v3,v2,s[8:11],s35 offen sc1
s_waitcnt lgkmcnt(6)
v_mfma_f32_32x32x16_bf16 v[56:71],a[0:3],v[24:27],0
ds_read_b128 v[52:55],v17 offset:6144
v_add_u32 v183,s57,v182
s_waitcnt lgkmcnt(6)
v_mfma_f32_32x32x16_bf16 v[56:71],a[4:7],v[28:31],v[56:71]
ds_read_b128 v[24:27],v16 offset:8192
ds_read_b64 v[180:181],v183
s_waitcnt lgkmcnt(6)
v_mfma_f32_32x32x16_bf16 v[56:71],a[8:11],v[32:35],v[56:71]
ds_read_b128 v[28:31],v17 offset:8192
v_mfma_f32_32x32x16_bf16 v[56:71],a[12:15],v[36:39],v[56:71]
ds_read_b128 v[32:35],v16 offset:10240
s_waitcnt lgkmcnt(6)
v_mfma_f32_32x32x16_bf16 v[56:71],a[16:19],v[40:43],v[56:71]
ds_read_b128 v[36:39],v17 offset:10240
v_mfma_f32_32x32x16_bf16 v[56:71],a[20:23],v[44:47],v[56:71]
ds_read_b128 v[40:43],v16 offset:12288
s_waitcnt lgkmcnt(6)
v_mfma_f32_32x32x16_bf16 v[56:71],a[24:27],v[48:51],v[56:71]
ds_read_b128 v[44:47],v17 offset:12288
v_mfma_f32_32x32x16_bf16 v[56:71],a[28:31],v[52:55],v[56:71]
ds_read_b128 v[48:51],v16 offset:14336
s_waitcnt lgkmcnt(5)
v_mfma_f32_32x32x16_bf16 v[56:71],a[32:35],v[24:27],v[56:71]
ds_read_b128 v[52:55],v17 offset:14336
v_mfma_f32_32x32x16_bf16 v[56:71],a[36:39],v[28:31],v[56:71]
ds_read_b128 v[24:27],v16 offset:16384
s_waitcnt lgkmcnt(5)
v_mfma_f32_32x32x16_bf16 v[56:71],a[40:43],v[32:35],v[56:71]
ds_read_b128 v[28:31],v17 offset:16384
v_mfma_f32_32x32x16_bf16 v[56:71],a[44:47],v[36:39],v[56:71]
ds_read_b128 v[32:35],v16 offset:18432
s_waitcnt lgkmcnt(5)
v_mfma_f32_32x32x16_bf16 v[56:71],a[48:51],v[40:43],v[56:71]
ds_read_b128 v[36:39],v17 offset:18432
v_mfma_f32_32x32x16_bf16 v[56:71],a[52:55],v[44:47],v[56:71]
ds_read_b128 v[40:43],v16 offset:20480
s_waitcnt lgkmcnt(5)
v_mfma_f32_32x32x16_bf16 v[56:71],a[56:59],v[48:51],v[56:71]
ds_read_b128 v[44:47],v17 offset:20480
v_mfma_f32_32x32x16_bf16 v[56:71],a[60:63],v[52:55],v[56:71]
ds_read_b128 v[48:51],v16 offset:22528
s_waitcnt lgkmcnt(5)
v_mfma_f32_32x32x16_bf16 v[56:71],a[64:67],v[24:27],v[56:71]
ds_read_b128 v[52:55],v17 offset:22528
v_mfma_f32_32x32x16_bf16 v[56:71],a[68:71],v[28:31],v[56:71]
ds_read_b128 v[24:27],v16 offset:24576
s_waitcnt lgkmcnt(5)
v_mfma_f32_32x32x16_bf16 v[56:71],a[72:75],v[32:35],v[56:71]
ds_read_b128 v[28:31],v17 offset:24576
v_mfma_f32_32x32x16_bf16 v[56:71],a[76:79],v[36:39],v[56:71]
ds_read_b128 v[32:35],v16 offset:26624
s_waitcnt lgkmcnt(5)
v_mfma_f32_32x32x16_bf16 v[56:71],a[80:83],v[40:43],v[56:71]
ds_read_b128 v[36:39],v17 offset:26624
v_mfma_f32_32x32x16_bf16 v[56:71],a[84:87],v[44:47],v[56:71]
ds_read_b128 v[40:43],v16 offset:28672
s_waitcnt lgkmcnt(5)
v_mfma_f32_32x32x16_bf16 v[56:71],a[88:91],v[48:51],v[56:71]
ds_read_b128 v[44:47],v17 offset:28672
s_waitcnt vmcnt(0)
s_mov_b64 exec,1
s_cmp_lg_u32 s49,0
s_cbranch_scc0 ls_325
buffer_store_dword v5,v1,s[8:11],s59 offen sc1
s_branch ls_326
ls_325:
buffer_store_dword v5,v1,s[8:11],s59 offen
ls_326:
s_mov_b64 exec,-1
s_mov_b32 s59,2147483648
v_mfma_f32_32x32x16_bf16 v[56:71],a[92:95],v[52:55],v[56:71]
ds_read_b128 v[48:51],v16 offset:30720
v_cmp_eq_u32 vcc,0,v3
s_cmp_eq_u64 vcc,0
s_cselect_b32 s37,0,2147483648
s_waitcnt lgkmcnt(5)
v_mfma_f32_32x32x16_bf16 v[56:71],a[96:99],v[24:27],v[56:71]
ds_read_b128 v[52:55],v17 offset:30720
s_cmp_lt_u32 s32,128
s_cselect_b32 s37,s37,2147483648
s_add_u32 s65,s32,1
s_or_b32 s65,s65,s37
v_mfma_f32_32x32x16_bf16 v[56:71],a[100:103],v[28:31],v[56:71]
ds_read_b128 v[24:27],v16 offset:32768
v_mov_b32 v23,s65
ds_max_i32 v22,v23
s_waitcnt lgkmcnt(6)
v_mfma_f32_32x32x16_bf16 v[56:71],a[104:107],v[32:35],v[56:71]
ds_read_b128 v[28:31],v17 offset:32768
buffer_load_dword v3,v2,s[8:11],s35 offen sc1
s_sub_u32 s66,46080,s57
v_mfma_f32_32x32x16_bf16 v[56:71],a[108:111],v[36:39],v[56:71]
ds_read_b128 v[32:35],v16 offset:34816
s_lshl_b32 s60,s33,6
s_add_u32 s60,s60,s34
s_mul_i32 s60,s60,46080
s_waitcnt lgkmcnt(6)
v_mfma_f32_32x32x16_bf16 v[56:71],a[112:115],v[40:43],v[56:71]
ds_read_b128 v[36:39],v17 offset:34816
s_add_u32 s60,s60,s37
s_add_u32 s60,s60,223608832
s_add_u32 m0,s66,40960
s_add_u32 s63,s60,40960
v_mfma_f32_32x32x16_bf16 v[56:71],a[116:119],v[44:47],v[56:71]
ds_read_b128 v[40:43],v16 offset:36864
buffer_load_dwordx4 v1,s[8:11],s63 offen sc1 lds
s_mul_i32 s61,s46,10240
s_waitcnt lgkmcnt(6)
v_mfma_f32_32x32x16_bf16 v[56:71],a[120:123],v[48:51],v[56:71]
ds_read_b128 v[44:47],v17 offset:36864
s_add_u32 s60,s60,s61
s_add_u32 s61,s61,s66
s_add_u32 m0,s61,0
s_add_u32 s63,s60,0
v_mfma_f32_32x32x16_bf16 v[56:71],a[124:127],v[52:55],v[56:71]
ds_read_b128 v[48:51],v16 offset:38912
buffer_load_dwordx4 v1,s[8:11],s63 offen sc1 lds
s_waitcnt lgkmcnt(5)
v_mfma_f32_32x32x16_bf16 v[56:71],a[128:131],v[24:27],v[56:71]
ds_read_b128 v[52:55],v17 offset:38912
buffer_load_dwordx4 v1,s[8:11],s63 offen offset:1024 sc1 lds
v_mfma_f32_32x32x16_bf16 v[56:71],a[132:135],v[28:31],v[56:71]
buffer_load_dwordx4 v1,s[8:11],s63 offen offset:2048 sc1 lds
s_waitcnt lgkmcnt(4)
v_mfma_f32_32x32x16_bf16 v[56:71],a[136:139],v[32:35],v[56:71]
buffer_load_dwordx4 v1,s[8:11],s63 offen offset:3072 sc1 lds
s_add_u32 m0,s61,4096
s_add_u32 s63,s60,4096
v_mfma_f32_32x32x16_bf16 v[56:71],a[140:143],v[36:39],v[56:71]
buffer_load_dwordx4 v1,s[8:11],s63 offen sc1 lds
s_waitcnt lgkmcnt(2)
v_mfma_f32_32x32x16_bf16 v[56:71],a[144:147],v[40:43],v[56:71]
buffer_load_dwordx4 v1,s[8:11],s63 offen offset:1024 sc1 lds
v_mfma_f32_32x32x16_bf16 v[56:71],a[148:151],v[44:47],v[56:71]
buffer_load_dwordx4 v1,s[8:11],s63 offen offset:2048 sc1 lds
s_waitcnt lgkmcnt(0)
v_mfma_f32_32x32x16_bf16 v[56:71],a[152:155],v[48:51],v[56:71]
buffer_load_dwordx4 v1,s[8:11],s63 offen offset:3072 sc1 lds
s_add_u32 m0,s61,8192
s_add_u32 s63,s60,8192
v_mfma_f32_32x32x16_bf16 v[56:71],a[156:159],v[52:55],v[56:71]
buffer_load_dwordx4 v1,s[8:11],s63 offen sc1 lds
buffer_load_dwordx4 v1,s[8:11],s63 offen offset:1024 sc1 lds
s_mov_b32 s55,0
s_cmp_eq_u32 s37,0
s_cbranch_scc1 ep_327
s_waitcnt vmcnt(0)
v_cmp_eq_u32 vcc,0,v3
s_cmp_eq_u64 vcc,0
s_cselect_b32 s37,0,2147483648
s_cmp_lt_u32 s32,128
s_cselect_b32 s37,s37,2147483648
s_cmp_lg_u32 s37,0
s_cbranch_scc1 ep_327
s_add_u32 s65,s32,1
s_or_b32 s65,s65,s37
v_mov_b32 v23,s65
ds_max_i32 v22,v23
s_sub_u32 s66,46080,s57
s_lshl_b32 s60,s33,6
s_add_u32 s60,s60,s34
s_mul_i32 s60,s60,46080
s_add_u32 s60,s60,s37
s_add_u32 s60,s60,223608832
s_add_u32 m0,s66,40960
s_add_u32 s63,s60,40960
buffer_load_dwordx4 v1,s[8:11],s63 offen sc1 lds
s_mul_i32 s61,s46,10240
s_add_u32 s60,s60,s61
s_add_u32 s61,s61,s66
s_add_u32 m0,s61,0
s_add_u32 s63,s60,0
buffer_load_dwordx4 v1,s[8:11],s63 offen sc1 lds
buffer_load_dwordx4 v1,s[8:11],s63 offen offset:1024 sc1 lds
buffer_load_dwordx4 v1,s[8:11],s63 offen offset:2048 sc1 lds
buffer_load_dwordx4 v1,s[8:11],s63 offen offset:3072 sc1 lds
s_add_u32 m0,s61,4096
s_add_u32 s63,s60,4096
buffer_load_dwordx4 v1,s[8:11],s63 offen sc1 lds
buffer_load_dwordx4 v1,s[8:11],s63 offen offset:1024 sc1 lds
buffer_load_dwordx4 v1,s[8:11],s63 offen offset:2048 sc1 lds
buffer_load_dwordx4 v1,s[8:11],s63 offen offset:3072 sc1 lds
s_add_u32 m0,s61,8192
s_add_u32 s63,s60,8192
buffer_load_dwordx4 v1,s[8:11],s63 offen sc1 lds
buffer_load_dwordx4 v1,s[8:11],s63 offen offset:1024 sc1 lds
ep_327:
s_nop 7
s_mul_i32 s62,s51,66
s_add_u32 s62,s62,s52
s_mul_i32 s62,s62,40960
s_lshl_b32 s63,s56,11
s_add_u32 s62,s62,s63
s_add_u32 s62,s62,237412352
v_pk_fma_f32 v[56:57],v[144:145],v[180:181],v[56:57] op_sel_hi:[1,0,1] neg_lo:[0,1,0] neg_hi:[0,1,0]
v_pk_fma_f32 v[58:59],v[146:147],v[180:181],v[58:59] op_sel_hi:[1,0,1] neg_lo:[0,1,0] neg_hi:[0,1,0]
v_pk_fma_f32 v[60:61],v[148:149],v[180:181],v[60:61] op_sel_hi:[1,0,1] neg_lo:[0,1,0] neg_hi:[0,1,0]
v_pk_fma_f32 v[62:63],v[150:151],v[180:181],v[62:63] op_sel_hi:[1,0,1] neg_lo:[0,1,0] neg_hi:[0,1,0]
v_pk_fma_f32 v[64:65],v[152:153],v[180:181],v[64:65] op_sel_hi:[1,0,1] neg_lo:[0,1,0] neg_hi:[0,1,0]
v_pk_fma_f32 v[66:67],v[154:155],v[180:181],v[66:67] op_sel_hi:[1,0,1] neg_lo:[0,1,0] neg_hi:[0,1,0]
v_pk_fma_f32 v[68:69],v[156:157],v[180:181],v[68:69] op_sel_hi:[1,0,1] neg_lo:[0,1,0] neg_hi:[0,1,0]
v_pk_fma_f32 v[70:71],v[158:159],v[180:181],v[70:71] op_sel_hi:[1,0,1] neg_lo:[0,1,0] neg_hi:[0,1,0]
v_pk_mul_f32 v[56:57],v[56:57],v[180:181] op_sel:[0,1] op_sel_hi:[1,1]
v_pk_mul_f32 v[58:59],v[58:59],v[180:181] op_sel:[0,1] op_sel_hi:[1,1]
v_pk_mul_f32 v[60:61],v[60:61],v[180:181] op_sel:[0,1] op_sel_hi:[1,1]
v_pk_mul_f32 v[62:63],v[62:63],v[180:181] op_sel:[0,1] op_sel_hi:[1,1]
v_pk_mul_f32 v[64:65],v[64:65],v[180:181] op_sel:[0,1] op_sel_hi:[1,1]
v_pk_mul_f32 v[66:67],v[66:67],v[180:181] op_sel:[0,1] op_sel_hi:[1,1]
v_pk_mul_f32 v[68:69],v[68:69],v[180:181] op_sel:[0,1] op_sel_hi:[1,1]
v_pk_mul_f32 v[70:71],v[70:71],v[180:181] op_sel:[0,1] op_sel_hi:[1,1]
v_cvt_pk_bf16_f32 v140,v56,v57
v_lshlrev_b32 v56,16,v140
v_and_b32 v57,0xffff0000,v140
v_cvt_pk_bf16_f32 v140,v58,v59
v_lshlrev_b32 v58,16,v140
v_and_b32 v59,0xffff0000,v140
v_cvt_pk_bf16_f32 v140,v60,v61
v_lshlrev_b32 v60,16,v140
v_and_b32 v61,0xffff0000,v140
v_cvt_pk_bf16_f32 v140,v62,v63
v_lshlrev_b32 v62,16,v140
v_and_b32 v63,0xffff0000,v140
v_cvt_pk_bf16_f32 v140,v64,v65
v_lshlrev_b32 v64,16,v140
v_and_b32 v65,0xffff0000,v140
v_cvt_pk_bf16_f32 v140,v66,v67
v_lshlrev_b32 v66,16,v140
v_and_b32 v67,0xffff0000,v140
v_cvt_pk_bf16_f32 v140,v68,v69
v_lshlrev_b32 v68,16,v140
v_and_b32 v69,0xffff0000,v140
v_cvt_pk_bf16_f32 v140,v70,v71
v_lshlrev_b32 v70,16,v140
v_and_b32 v71,0xffff0000,v140
v_pk_mul_f32 v[124:125],v[56:57],v[56:57]
v_pk_mul_f32 v[126:127],v[58:59],v[58:59]
v_pk_mul_f32 v[128:129],v[60:61],v[60:61]
v_pk_mul_f32 v[130:131],v[62:63],v[62:63]
v_pk_mul_f32 v[132:133],v[64:65],v[64:65]
v_pk_mul_f32 v[134:135],v[66:67],v[66:67]
v_pk_mul_f32 v[136:137],v[68:69],v[68:69]
v_pk_mul_f32 v[138:139],v[70:71],v[70:71]
v_pk_fma_f32 v[124:125],v[124:125],v[112:113],v[112:113] op_sel:[0,1,0] op_sel_hi:[1,1,0]
v_pk_fma_f32 v[126:127],v[126:127],v[112:113],v[112:113] op_sel:[0,1,0] op_sel_hi:[1,1,0]
v_pk_fma_f32 v[128:129],v[128:129],v[112:113],v[112:113] op_sel:[0,1,0] op_sel_hi:[1,1,0]
v_pk_fma_f32 v[130:131],v[130:131],v[112:113],v[112:113] op_sel:[0,1,0] op_sel_hi:[1,1,0]
v_pk_fma_f32 v[132:133],v[132:133],v[112:113],v[112:113] op_sel:[0,1,0] op_sel_hi:[1,1,0]
v_pk_fma_f32 v[134:135],v[134:135],v[112:113],v[112:113] op_sel:[0,1,0] op_sel_hi:[1,1,0]
v_pk_fma_f32 v[136:137],v[136:137],v[112:113],v[112:113] op_sel:[0,1,0] op_sel_hi:[1,1,0]
v_pk_fma_f32 v[138:139],v[138:139],v[112:113],v[112:113] op_sel:[0,1,0] op_sel_hi:[1,1,0]
v_pk_mul_f32 v[124:125],v[124:125],v[56:57]
v_pk_mul_f32 v[126:127],v[126:127],v[58:59]
v_pk_mul_f32 v[128:129],v[128:129],v[60:61]
v_pk_mul_f32 v[130:131],v[130:131],v[62:63]
v_pk_mul_f32 v[132:133],v[132:133],v[64:65]
v_pk_mul_f32 v[134:135],v[134:135],v[66:67]
v_pk_mul_f32 v[136:137],v[136:137],v[68:69]
v_pk_mul_f32 v[138:139],v[138:139],v[70:71]
v_exp_f32 v124,v124
v_exp_f32 v125,v125
v_exp_f32 v126,v126
v_exp_f32 v127,v127
v_exp_f32 v128,v128
v_exp_f32 v129,v129
v_exp_f32 v130,v130
v_exp_f32 v131,v131
v_exp_f32 v132,v132
v_exp_f32 v133,v133
v_exp_f32 v134,v134
v_exp_f32 v135,v135
v_exp_f32 v136,v136
v_exp_f32 v137,v137
v_exp_f32 v138,v138
v_exp_f32 v139,v139
v_pk_add_f32 v[124:125],v[124:125],1.0 op_sel_hi:[1,0]
v_pk_add_f32 v[126:127],v[126:127],1.0 op_sel_hi:[1,0]
v_pk_add_f32 v[128:129],v[128:129],1.0 op_sel_hi:[1,0]
v_pk_add_f32 v[130:131],v[130:131],1.0 op_sel_hi:[1,0]
v_pk_add_f32 v[132:133],v[132:133],1.0 op_sel_hi:[1,0]
v_pk_add_f32 v[134:135],v[134:135],1.0 op_sel_hi:[1,0]
v_pk_add_f32 v[136:137],v[136:137],1.0 op_sel_hi:[1,0]
v_pk_add_f32 v[138:139],v[138:139],1.0 op_sel_hi:[1,0]
v_rcp_f32 v124,v124
v_rcp_f32 v125,v125
v_rcp_f32 v126,v126
v_rcp_f32 v127,v127
v_rcp_f32 v128,v128
v_rcp_f32 v129,v129
v_rcp_f32 v130,v130
v_rcp_f32 v131,v131
v_rcp_f32 v132,v132
v_rcp_f32 v133,v133
v_rcp_f32 v134,v134
v_rcp_f32 v135,v135
v_rcp_f32 v136,v136
v_rcp_f32 v137,v137
v_rcp_f32 v138,v138
v_rcp_f32 v139,v139
v_pk_mul_f32 v[56:57],v[56:57],v[124:125]
v_pk_mul_f32 v[58:59],v[58:59],v[126:127]
v_pk_mul_f32 v[60:61],v[60:61],v[128:129]
v_pk_mul_f32 v[62:63],v[62:63],v[130:131]
v_pk_mul_f32 v[64:65],v[64:65],v[132:133]
v_pk_mul_f32 v[66:67],v[66:67],v[134:135]
v_pk_mul_f32 v[68:69],v[68:69],v[136:137]
v_pk_mul_f32 v[70:71],v[70:71],v[138:139]
v_cvt_pk_bf16_f32 v116,v56,v57
v_cvt_pk_bf16_f32 v117,v58,v59
v_cvt_pk_bf16_f32 v118,v60,v61
v_cvt_pk_bf16_f32 v119,v62,v63
v_cvt_pk_bf16_f32 v120,v64,v65
v_cvt_pk_bf16_f32 v121,v66,v67
v_cvt_pk_bf16_f32 v122,v68,v69
v_cvt_pk_bf16_f32 v123,v70,v71
s_cmp_lg_u32 s49,0
s_cbranch_scc0 ls_328
buffer_store_dwordx4 v[116:119],v20,s[8:11],s62 offen sc1
buffer_store_dwordx4 v[120:123],v21,s[8:11],s62 offen sc1
s_branch ls_329
ls_328:
buffer_store_dwordx4 v[116:119],v20,s[8:11],s62 offen
buffer_store_dwordx4 v[120:123],v21,s[8:11],s62 offen
ls_329:
s_lshl_b32 s82,s51,6
s_add_u32 s82,s82,s52
s_lshl_b32 s82,s82,9
s_add_u32 s82,s82,458752
s_lshl_b32 s61,s56,2
s_add_u32 s82,s82,s61
s_mov_b32 s59,s82
s_cmp_eq_u32 s37,0
s_cbranch_scc1 W1_NEXT
s_waitcnt vmcnt(0)
s_mov_b64 exec,1
s_cmp_lg_u32 s49,0
s_cbranch_scc0 ls_330
buffer_store_dword v5,v1,s[8:11],s59 offen sc1
s_branch ls_331
ls_330:
buffer_store_dword v5,v1,s[8:11],s59 offen
ls_331:
s_mov_b64 exec,-1
s_mov_b32 s59,2147483648
s_cmp_lt_u32 s32,128
s_cbranch_scc1 W1_COLD
W1_END:
s_endpgm
ROLE_W2:
v_lshlrev_b32 v1,4,v0
v_mov_b32 v5,1
s_lshl_b32 s56,s48,2
s_add_u32 s56,s56,s46
v_bfe_u32 v6,v0,2,2
v_lshrrev_b32 v7,4,v0
v_add_u32 v7,v6,v7
v_and_b32 v7,3,v7
v_and_b32 v15,3,v0
v_lshlrev_b32 v15,4,v15
v_lshl_add_u32 v15,v7,6,v15
v_lshl_add_u32 v15,v6,8,v15
v_lshrrev_b32 v6,5,v0
v_bfe_u32 v7,v0,4,1
v_lshlrev_b32 v16,10,v7
v_lshl_add_u32 v16,v6,8,v16
v_and_b32 v6,15,v0
v_lshl_add_u32 v16,v6,4,v16
v_add_u32 v18,40960,v16
v_lshrrev_b32 v6,5,v0
v_bfe_u32 v7,v0,4,1
v_lshlrev_b32 v20,10,v7
v_lshl_add_u32 v20,v6,8,v20
v_and_b32 v6,15,v0
v_lshl_add_u32 v20,v6,4,v20
v_lshrrev_b32 v6,5,v0
v_add_u32 v6,2,v6
v_bfe_u32 v7,v0,4,1
v_lshlrev_b32 v17,10,v7
v_lshl_add_u32 v17,v6,8,v17
v_and_b32 v6,15,v0
v_lshl_add_u32 v17,v6,4,v17
v_add_u32 v19,40960,v17
v_lshrrev_b32 v6,5,v0
v_add_u32 v6,2,v6
v_bfe_u32 v7,v0,4,1
v_lshlrev_b32 v21,10,v7
v_lshl_add_u32 v21,v6,8,v21
v_and_b32 v6,15,v0
v_lshl_add_u32 v21,v6,4,v21
v_min_u32 v2,19,v0
v_lshlrev_b32 v2,2,v2
s_lshr_b32 s60,s46,1
s_add_u32 s60,s60,1
s_sub_u32 s61,32,s60
s_add_u32 s60,s60,32
s_bitcmp1_b32 s46,0
s_cselect_b32 s60,s60,s61
v_and_b32 v6,15,v0
v_add_u32 v6,s60,v6
v_lshrrev_b32 v7,5,v6
v_mul_u32_u24 v112,40960,v7
v_bfe_u32 v7,v6,4,1
v_lshl_add_u32 v112,v7,10,v112
v_and_b32 v7,15,v6
v_lshl_add_u32 v112,v7,4,v112
v_lshrrev_b32 v7,4,v0
v_lshl_add_u32 v112,v7,8,v112
v_and_b32 v6,15,v0
v_add_u32 v6,s60,v6
v_add_u32 v6,16,v6
v_lshrrev_b32 v7,5,v6
v_mul_u32_u24 v113,40960,v7
v_bfe_u32 v7,v6,4,1
v_lshl_add_u32 v113,v7,10,v113
v_and_b32 v7,15,v6
v_lshl_add_u32 v113,v7,4,v113
v_lshrrev_b32 v7,4,v0
v_lshl_add_u32 v113,v7,8,v113
v_lshrrev_b32 v6,5,v0
v_and_b32 v7,15,v0
v_lshlrev_b32 v114,3,v7
v_lshl_add_u32 v114,v6,7,v114
v_and_b32 v114,31,v0
v_lshlrev_b32 v114,3,v114
v_lshrrev_b32 v6,5,v0
v_bfe_u32 v7,v0,4,1
v_lshlrev_b32 v116,10,v7
v_bfe_u32 v7,v0,2,2
v_lshl_add_u32 v116,v7,8,v116
v_add_u32 v6,v6,v7
v_and_b32 v6,3,v6
v_lshl_add_u32 v116,v6,6,v116
v_and_b32 v6,3,v0
v_lshl_add_u32 v116,v6,4,v116
v_lshrrev_b32 v6,5,v0
v_add_u32 v6,2,v6
v_bfe_u32 v7,v0,4,1
v_lshlrev_b32 v117,10,v7
v_bfe_u32 v7,v0,2,2
v_lshl_add_u32 v117,v7,8,v117
v_add_u32 v6,v6,v7
v_and_b32 v6,3,v6
v_lshl_add_u32 v117,v6,6,v117
v_and_b32 v6,3,v0
v_lshl_add_u32 v117,v6,4,v117
s_waitcnt vmcnt(0)
s_barrier
s_cmp_lg_u32 s46,0
s_cbranch_scc1 arr_332
v_mov_b32 v6,1
s_lshl_b32 s3,s49,2
v_mov_b32 v7,s3
s_mov_b64 exec,1
buffer_atomic_add v6,v7,s[12:15],0 offen sc1
s_mov_b64 exec,-1
arr_332:
s_lshl_b32 s58,s56,6
s_mul_i32 s63,s46,40960
s_mov_b32 s4,s34
s_mov_b32 s5,s35
s_mov_b32 s6,819200
s_mov_b32 s7,0x20000
v_lshrrev_b32 v9,2,v0
s_mov_b32 s64,1280
v_mul_lo_u32 v9,v9,s64
v_and_b32 v10,3,v0
v_lshl_add_u32 v6,v10,4,v9
s_add_u32 m0,s63,0
s_add_u32 s65,s58,0
buffer_load_dwordx4 v6,s[4:7],s65 offen lds
s_add_u32 m0,s63,1024
s_add_u32 s65,s58,20480
buffer_load_dwordx4 v6,s[4:7],s65 offen lds
s_add_u32 m0,s63,2048
s_add_u32 s65,s58,40960
buffer_load_dwordx4 v6,s[4:7],s65 offen lds
s_add_u32 m0,s63,3072
s_add_u32 s65,s58,61440
buffer_load_dwordx4 v6,s[4:7],s65 offen lds
s_add_u32 m0,s63,4096
s_add_u32 s65,s58,81920
buffer_load_dwordx4 v6,s[4:7],s65 offen lds
s_add_u32 m0,s63,5120
s_add_u32 s65,s58,102400
buffer_load_dwordx4 v6,s[4:7],s65 offen lds
s_add_u32 m0,s63,6144
s_add_u32 s65,s58,122880
buffer_load_dwordx4 v6,s[4:7],s65 offen lds
s_add_u32 m0,s63,7168
s_add_u32 s65,s58,143360
buffer_load_dwordx4 v6,s[4:7],s65 offen lds
s_add_u32 m0,s63,8192
s_add_u32 s65,s58,163840
buffer_load_dwordx4 v6,s[4:7],s65 offen lds
s_add_u32 m0,s63,9216
s_add_u32 s65,s58,184320
buffer_load_dwordx4 v6,s[4:7],s65 offen lds
s_add_u32 m0,s63,10240
s_add_u32 s65,s58,204800
buffer_load_dwordx4 v6,s[4:7],s65 offen lds
s_add_u32 m0,s63,11264
s_add_u32 s65,s58,225280
buffer_load_dwordx4 v6,s[4:7],s65 offen lds
s_add_u32 m0,s63,12288
s_add_u32 s65,s58,245760
buffer_load_dwordx4 v6,s[4:7],s65 offen lds
s_add_u32 m0,s63,13312
s_add_u32 s65,s58,266240
buffer_load_dwordx4 v6,s[4:7],s65 offen lds
s_add_u32 m0,s63,14336
s_add_u32 s65,s58,286720
buffer_load_dwordx4 v6,s[4:7],s65 offen lds
s_add_u32 m0,s63,15360
s_add_u32 s65,s58,307200
buffer_load_dwordx4 v6,s[4:7],s65 offen lds
s_add_u32 m0,s63,16384
s_add_u32 s65,s58,327680
buffer_load_dwordx4 v6,s[4:7],s65 offen lds
s_add_u32 m0,s63,17408
s_add_u32 s65,s58,348160
buffer_load_dwordx4 v6,s[4:7],s65 offen lds
s_add_u32 m0,s63,18432
s_add_u32 s65,s58,368640
buffer_load_dwordx4 v6,s[4:7],s65 offen lds
s_add_u32 m0,s63,19456
s_add_u32 s65,s58,389120
buffer_load_dwordx4 v6,s[4:7],s65 offen lds
s_add_u32 m0,s63,20480
s_add_u32 s65,s58,409600
buffer_load_dwordx4 v6,s[4:7],s65 offen lds
s_add_u32 m0,s63,21504
s_add_u32 s65,s58,430080
buffer_load_dwordx4 v6,s[4:7],s65 offen lds
s_add_u32 m0,s63,22528
s_add_u32 s65,s58,450560
buffer_load_dwordx4 v6,s[4:7],s65 offen lds
s_add_u32 m0,s63,23552
s_add_u32 s65,s58,471040
buffer_load_dwordx4 v6,s[4:7],s65 offen lds
s_add_u32 m0,s63,24576
s_add_u32 s65,s58,491520
buffer_load_dwordx4 v6,s[4:7],s65 offen lds
s_add_u32 m0,s63,25600
s_add_u32 s65,s58,512000
buffer_load_dwordx4 v6,s[4:7],s65 offen lds
s_add_u32 m0,s63,26624
s_add_u32 s65,s58,532480
buffer_load_dwordx4 v6,s[4:7],s65 offen lds
s_add_u32 m0,s63,27648
s_add_u32 s65,s58,552960
buffer_load_dwordx4 v6,s[4:7],s65 offen lds
s_add_u32 m0,s63,28672
s_add_u32 s65,s58,573440
buffer_load_dwordx4 v6,s[4:7],s65 offen lds
s_add_u32 m0,s63,29696
s_add_u32 s65,s58,593920
buffer_load_dwordx4 v6,s[4:7],s65 offen lds
s_add_u32 m0,s63,30720
s_add_u32 s65,s58,614400
buffer_load_dwordx4 v6,s[4:7],s65 offen lds
s_add_u32 m0,s63,31744
s_add_u32 s65,s58,634880
buffer_load_dwordx4 v6,s[4:7],s65 offen lds
s_add_u32 m0,s63,32768
s_add_u32 s65,s58,655360
buffer_load_dwordx4 v6,s[4:7],s65 offen lds
s_add_u32 m0,s63,33792
s_add_u32 s65,s58,675840
buffer_load_dwordx4 v6,s[4:7],s65 offen lds
s_add_u32 m0,s63,34816
s_add_u32 s65,s58,696320
buffer_load_dwordx4 v6,s[4:7],s65 offen lds
s_add_u32 m0,s63,35840
s_add_u32 s65,s58,716800
buffer_load_dwordx4 v6,s[4:7],s65 offen lds
s_add_u32 m0,s63,36864
s_add_u32 s65,s58,737280
buffer_load_dwordx4 v6,s[4:7],s65 offen lds
s_add_u32 m0,s63,37888
s_add_u32 s65,s58,757760
buffer_load_dwordx4 v6,s[4:7],s65 offen lds
s_add_u32 m0,s63,38912
s_add_u32 s65,s58,778240
buffer_load_dwordx4 v6,s[4:7],s65 offen lds
s_add_u32 m0,s63,39936
s_add_u32 s65,s58,798720
buffer_load_dwordx4 v6,s[4:7],s65 offen lds
s_waitcnt vmcnt(20)
v_bfe_u32 v9,v0,2,2
v_lshrrev_b32 v10,5,v0
v_lshl_add_u32 v9,v10,2,v9
v_mul_u32_u24 v9,64,v9
v_and_b32 v10,1,v0
v_lshl_add_u32 v9,v10,3,v9
v_bfe_u32 v10,v0,1,1
v_lshl_add_u32 v9,v10,5,v9
v_bfe_u32 v10,v0,4,1
v_lshl_add_u32 v9,v10,4,v9
v_add_u32 v7,s63,v9
ds_read_b64_tr_b16 a[0:1],v7 offset:0
ds_read_b64_tr_b16 a[2:3],v7 offset:1024
ds_read_b64_tr_b16 a[4:5],v7 offset:512
ds_read_b64_tr_b16 a[6:7],v7 offset:1536
ds_read_b64_tr_b16 a[8:9],v7 offset:2048
ds_read_b64_tr_b16 a[10:11],v7 offset:3072
ds_read_b64_tr_b16 a[12:13],v7 offset:2560
ds_read_b64_tr_b16 a[14:15],v7 offset:3584
ds_read_b64_tr_b16 a[16:17],v7 offset:4096
ds_read_b64_tr_b16 a[18:19],v7 offset:5120
ds_read_b64_tr_b16 a[20:21],v7 offset:4608
ds_read_b64_tr_b16 a[22:23],v7 offset:5632
s_waitcnt lgkmcnt(4)
ds_read_b64_tr_b16 a[24:25],v7 offset:6144
ds_read_b64_tr_b16 a[26:27],v7 offset:7168
ds_read_b64_tr_b16 a[28:29],v7 offset:6656
ds_read_b64_tr_b16 a[30:31],v7 offset:7680
ds_read_b64_tr_b16 a[32:33],v7 offset:8192
ds_read_b64_tr_b16 a[34:35],v7 offset:9216
ds_read_b64_tr_b16 a[36:37],v7 offset:8704
ds_read_b64_tr_b16 a[38:39],v7 offset:9728
ds_read_b64_tr_b16 a[40:41],v7 offset:10240
ds_read_b64_tr_b16 a[42:43],v7 offset:11264
ds_read_b64_tr_b16 a[44:45],v7 offset:10752
ds_read_b64_tr_b16 a[46:47],v7 offset:11776
s_waitcnt lgkmcnt(4)
ds_read_b64_tr_b16 a[48:49],v7 offset:12288
ds_read_b64_tr_b16 a[50:51],v7 offset:13312
ds_read_b64_tr_b16 a[52:53],v7 offset:12800
ds_read_b64_tr_b16 a[54:55],v7 offset:13824
ds_read_b64_tr_b16 a[56:57],v7 offset:14336
ds_read_b64_tr_b16 a[58:59],v7 offset:15360
ds_read_b64_tr_b16 a[60:61],v7 offset:14848
ds_read_b64_tr_b16 a[62:63],v7 offset:15872
ds_read_b64_tr_b16 a[64:65],v7 offset:16384
ds_read_b64_tr_b16 a[66:67],v7 offset:17408
ds_read_b64_tr_b16 a[68:69],v7 offset:16896
ds_read_b64_tr_b16 a[70:71],v7 offset:17920
s_waitcnt lgkmcnt(4)
ds_read_b64_tr_b16 a[72:73],v7 offset:18432
ds_read_b64_tr_b16 a[74:75],v7 offset:19456
ds_read_b64_tr_b16 a[76:77],v7 offset:18944
ds_read_b64_tr_b16 a[78:79],v7 offset:19968
s_waitcnt lgkmcnt(0)
s_waitcnt vmcnt(0)
v_bfe_u32 v9,v0,2,2
v_lshrrev_b32 v10,5,v0
v_lshl_add_u32 v9,v10,2,v9
v_mul_u32_u24 v9,64,v9
v_and_b32 v10,1,v0
v_lshl_add_u32 v9,v10,3,v9
v_bfe_u32 v10,v0,1,1
v_lshl_add_u32 v9,v10,5,v9
v_bfe_u32 v10,v0,4,1
v_lshl_add_u32 v9,v10,4,v9
v_add_u32 v7,s63,v9
ds_read_b64_tr_b16 a[80:81],v7 offset:20480
ds_read_b64_tr_b16 a[82:83],v7 offset:21504
ds_read_b64_tr_b16 a[84:85],v7 offset:20992
ds_read_b64_tr_b16 a[86:87],v7 offset:22016
ds_read_b64_tr_b16 a[88:89],v7 offset:22528
ds_read_b64_tr_b16 a[90:91],v7 offset:23552
ds_read_b64_tr_b16 a[92:93],v7 offset:23040
ds_read_b64_tr_b16 a[94:95],v7 offset:24064
ds_read_b64_tr_b16 a[96:97],v7 offset:24576
ds_read_b64_tr_b16 a[98:99],v7 offset:25600
ds_read_b64_tr_b16 a[100:101],v7 offset:25088
ds_read_b64_tr_b16 a[102:103],v7 offset:26112
s_waitcnt lgkmcnt(4)
ds_read_b64_tr_b16 a[104:105],v7 offset:26624
ds_read_b64_tr_b16 a[106:107],v7 offset:27648
ds_read_b64_tr_b16 a[108:109],v7 offset:27136
ds_read_b64_tr_b16 a[110:111],v7 offset:28160
ds_read_b64_tr_b16 a[112:113],v7 offset:28672
ds_read_b64_tr_b16 a[114:115],v7 offset:29696
ds_read_b64_tr_b16 a[116:117],v7 offset:29184
ds_read_b64_tr_b16 a[118:119],v7 offset:30208
ds_read_b64_tr_b16 a[120:121],v7 offset:30720
ds_read_b64_tr_b16 a[122:123],v7 offset:31744
ds_read_b64_tr_b16 a[124:125],v7 offset:31232
ds_read_b64_tr_b16 a[126:127],v7 offset:32256
s_waitcnt lgkmcnt(4)
ds_read_b64_tr_b16 a[128:129],v7 offset:32768
ds_read_b64_tr_b16 a[130:131],v7 offset:33792
ds_read_b64_tr_b16 a[132:133],v7 offset:33280
ds_read_b64_tr_b16 a[134:135],v7 offset:34304
ds_read_b64_tr_b16 a[136:137],v7 offset:34816
ds_read_b64_tr_b16 a[138:139],v7 offset:35840
ds_read_b64_tr_b16 a[140:141],v7 offset:35328
ds_read_b64_tr_b16 a[142:143],v7 offset:36352
ds_read_b64_tr_b16 a[144:145],v7 offset:36864
ds_read_b64_tr_b16 a[146:147],v7 offset:37888
ds_read_b64_tr_b16 a[148:149],v7 offset:37376
ds_read_b64_tr_b16 a[150:151],v7 offset:38400
s_waitcnt lgkmcnt(4)
ds_read_b64_tr_b16 a[152:153],v7 offset:38912
ds_read_b64_tr_b16 a[154:155],v7 offset:39936
ds_read_b64_tr_b16 a[156:157],v7 offset:39424
ds_read_b64_tr_b16 a[158:159],v7 offset:40448
s_waitcnt lgkmcnt(0)
s_barrier
s_lshl_b32 s3,s49,2
v_mov_b32 v7,s3
s_nop 1
ibw_333:
buffer_load_dword v6,v7,s[12:15],0 offen sc1
s_waitcnt vmcnt(0)
v_cmp_ne_u32 vcc,256,v6
s_nop 0
s_cbranch_vccz ok_334
s_sleep 8
s_sub_u32 s47,s47,1
s_cbranch_scc1 ABORT
s_branch ibw_333
ok_334:
s_cmp_lg_u32 s49,0
s_cbranch_scc1 ibok_335
v_and_b32 v7,7,v0
v_lshlrev_b32 v7,2,v7
buffer_load_dword v6,v7,s[12:15],0 offen offset:32 sc1
s_waitcnt vmcnt(0)
v_cmp_ne_u32 vcc,32,v6
s_nop 0
s_cbranch_vccz ibok_335
s_barrier
s_mov_b32 s49,1
s_mov_b32 s3,s2
s_load_dwordx16 s[16:31],s[0:1],0
s_load_dwordx8 s[32:39],s[0:1],64
s_waitcnt lgkmcnt(0)
s_branch DISPATCH
ibok_335:
s_mov_b32 s50,0
s_mov_b32 s32,0
s_mov_b32 s57,0
s_mov_b32 s59,2147483648
s_mov_b32 s82,2147483648
s_mov_b32 s39,2147483648
v_mov_b32 v22,83968
v_mov_b32 v23,0
ds_write_b32 v22,v23
s_mov_b32 s39,1600000
s_waitcnt lgkmcnt(0)
s_barrier
s_mov_b32 s83,s100
s_min_u32 s62,s32,127
s_sub_u32 s60,s62,14
s_lshr_b32 s34,s60,1
s_and_b32 s33,s60,1
s_cmp_eq_u32 s33,0
s_cselect_b32 s61,14,0
s_add_u32 s34,s34,s61
s_sub_u32 s61,s60,50
s_cmp_ge_u32 s60,100
s_cselect_b32 s34,s61,s34
s_cselect_b32 s33,1,s33
s_cmp_lt_u32 s62,14
s_cselect_b32 s34,s62,s34
s_cselect_b32 s33,0,s33
s_add_u32 s60,s34,1
s_min_u32 s60,s60,63
s_lshl_b32 s35,s33,6
s_add_u32 s35,s35,s60
s_lshl_b32 s35,s35,9
s_add_u32 s35,s35,458752
s_sub_u32 s57,40960,s57
v_swap_b32 v16,v18
v_swap_b32 v17,v19
s_mov_b32 s50,-1
s_nop 0
W2_COLD:
s_mov_b32 s37,0
fb_336:
buffer_load_dword v3,v2,s[8:11],s35 offen sc1
s_waitcnt vmcnt(0)
v_cmp_eq_u32 vcc,0,v3
s_nop 0
s_cbranch_vccz ok_337
s_sleep 2
s_sub_u32 s47,s47,1
s_cbranch_scc1 ABORT
s_branch fb_336
ok_337:
s_sub_u32 s66,40960,s57
s_mul_i32 s60,s33,66
s_add_u32 s60,s60,s34
s_mul_i32 s60,s60,40960
s_add_u32 s60,s60,s37
s_mul_i32 s61,s46,10240
s_add_u32 s60,s60,s61
s_add_u32 s60,s60,237371392
s_add_u32 s61,s61,s66
s_add_u32 m0,s61,0
s_add_u32 s63,s60,0
buffer_load_dwordx4 v112,s[8:11],s63 offen sc1 lds
s_add_u32 m0,s61,1024
s_add_u32 s63,s60,0
buffer_load_dwordx4 v113,s[8:11],s63 offen sc1 lds
s_add_u32 m0,s61,2048
s_add_u32 s63,s60,2048
buffer_load_dwordx4 v112,s[8:11],s63 offen sc1 lds
s_add_u32 m0,s61,3072
s_add_u32 s63,s60,2048
buffer_load_dwordx4 v113,s[8:11],s63 offen sc1 lds
s_add_u32 m0,s61,4096
s_add_u32 s63,s60,4096
buffer_load_dwordx4 v112,s[8:11],s63 offen sc1 lds
s_add_u32 m0,s61,5120
s_add_u32 s63,s60,4096
buffer_load_dwordx4 v113,s[8:11],s63 offen sc1 lds
s_add_u32 m0,s61,6144
s_add_u32 s63,s60,6144
buffer_load_dwordx4 v112,s[8:11],s63 offen sc1 lds
s_add_u32 m0,s61,7168
s_add_u32 s63,s60,6144
buffer_load_dwordx4 v113,s[8:11],s63 offen sc1 lds
s_add_u32 m0,s61,8192
s_add_u32 s63,s60,8192
buffer_load_dwordx4 v112,s[8:11],s63 offen sc1 lds
s_add_u32 m0,s61,9216
s_add_u32 s63,s60,8192
buffer_load_dwordx4 v113,s[8:11],s63 offen sc1 lds
s_mov_b32 s55,1
W2_NEXT:
s_add_u32 s50,s50,1
s_sub_u32 s57,40960,s57
v_swap_b32 v16,v18
v_swap_b32 v17,v19
s_mov_b32 s51,s33
s_mov_b32 s52,s34
s_add_u32 s32,s32,1
s_min_u32 s62,s32,127
s_sub_u32 s60,s62,14
s_lshr_b32 s34,s60,1
s_and_b32 s33,s60,1
s_cmp_eq_u32 s33,0
s_cselect_b32 s61,14,0
s_add_u32 s34,s34,s61
s_sub_u32 s61,s60,50
s_cmp_ge_u32 s60,100
s_cselect_b32 s34,s61,s34
s_cselect_b32 s33,1,s33
s_cmp_lt_u32 s62,14
s_cselect_b32 s34,s62,s34
s_cselect_b32 s33,0,s33
s_add_u32 s60,s34,1
s_min_u32 s60,s60,63
s_lshl_b32 s35,s33,6
s_add_u32 s35,s35,s60
s_lshl_b32 s35,s35,9
s_add_u32 s35,s35,458752
s_waitcnt vmcnt(3)
s_cmp_eq_u32 s55,0
s_cbranch_scc1 wv_338
s_waitcnt vmcnt(0)
wv_338:
s_barrier
ds_read_b128 v[24:27],v16 offset:0
ds_read_b128 v[28:31],v17 offset:0
ds_read_b128 v[32:35],v16 offset:2048
ds_read_b128 v[36:39],v17 offset:2048
ds_read_b128 v[40:43],v16 offset:4096
ds_read_b128 v[44:47],v17 offset:4096
ds_read_b128 v[48:51],v16 offset:6144
buffer_load_dword v3,v2,s[8:11],s35 offen sc1
s_waitcnt lgkmcnt(6)
v_mfma_f32_32x32x16_bf16 v[56:71],a[0:3],v[24:27],0
ds_read_b128 v[52:55],v17 offset:6144
s_lshl_b32 s60,s51,6
s_add_u32 s60,s60,s52
s_mul_i32 s60,s60,46080
s_waitcnt lgkmcnt(6)
v_mfma_f32_32x32x16_bf16 v[56:71],a[4:7],v[28:31],v[56:71]
ds_read_b128 v[24:27],v16 offset:8192
s_lshl_b32 s61,s56,11
s_add_u32 s60,s60,s61
s_add_u32 s60,s60,223608832
s_waitcnt lgkmcnt(5)
v_mfma_f32_32x32x16_bf16 v[56:71],a[8:11],v[32:35],v[56:71]
ds_read_b128 v[28:31],v17 offset:8192
buffer_load_dwordx4 v[120:123],v116,s[8:11],s60 offen sc1
buffer_load_dwordx4 v[124:127],v117,s[8:11],s60 offen sc1
v_mfma_f32_32x32x16_bf16 v[56:71],a[12:15],v[36:39],v[56:71]
ds_read_b128 v[32:35],v16 offset:10240
s_waitcnt lgkmcnt(5)
v_mfma_f32_32x32x16_bf16 v[56:71],a[16:19],v[40:43],v[56:71]
ds_read_b128 v[36:39],v17 offset:10240
v_mfma_f32_32x32x16_bf16 v[56:71],a[20:23],v[44:47],v[56:71]
ds_read_b128 v[40:43],v16 offset:12288
s_waitcnt lgkmcnt(5)
v_mfma_f32_32x32x16_bf16 v[56:71],a[24:27],v[48:51],v[56:71]
ds_read_b128 v[44:47],v17 offset:12288
v_mfma_f32_32x32x16_bf16 v[56:71],a[28:31],v[52:55],v[56:71]
ds_read_b128 v[48:51],v16 offset:14336
s_waitcnt lgkmcnt(5)
v_mfma_f32_32x32x16_bf16 v[56:71],a[32:35],v[24:27],v[56:71]
ds_read_b128 v[52:55],v17 offset:14336
v_mfma_f32_32x32x16_bf16 v[56:71],a[36:39],v[28:31],v[56:71]
ds_read_b128 v[24:27],v16 offset:16384
s_waitcnt lgkmcnt(5)
v_mfma_f32_32x32x16_bf16 v[56:71],a[40:43],v[32:35],v[56:71]
ds_read_b128 v[28:31],v17 offset:16384
v_mfma_f32_32x32x16_bf16 v[56:71],a[44:47],v[36:39],v[56:71]
ds_read_b128 v[32:35],v16 offset:18432
s_waitcnt lgkmcnt(5)
v_mfma_f32_32x32x16_bf16 v[56:71],a[48:51],v[40:43],v[56:71]
ds_read_b128 v[36:39],v17 offset:18432
s_waitcnt vmcnt(2)
s_mov_b64 exec,1
s_cmp_lg_u32 s49,0
s_cbranch_scc0 ls_339
buffer_store_dword v5,v1,s[8:11],s59 offen sc1
s_branch ls_340
ls_339:
buffer_store_dword v5,v1,s[8:11],s59 offen
ls_340:
s_mov_b64 exec,-1
s_mov_b32 s59,2147483648
v_mfma_f32_32x32x16_bf16 v[56:71],a[52:55],v[44:47],v[56:71]
ds_read_b128 v[40:43],v16 offset:20480
v_cmp_eq_u32 vcc,0,v3
s_cmp_eq_u64 vcc,0
s_cselect_b32 s37,0,2147483648
s_waitcnt lgkmcnt(5)
v_mfma_f32_32x32x16_bf16 v[56:71],a[56:59],v[48:51],v[56:71]
ds_read_b128 v[44:47],v17 offset:20480
s_cmp_lt_u32 s32,128
s_cselect_b32 s37,s37,2147483648
s_sub_u32 s66,40960,s57
s_mul_i32 s60,s33,66
v_mfma_f32_32x32x16_bf16 v[56:71],a[60:63],v[52:55],v[56:71]
ds_read_b128 v[48:51],v16 offset:22528
s_add_u32 s60,s60,s34
s_mul_i32 s60,s60,40960
s_add_u32 s60,s60,s37
s_waitcnt lgkmcnt(5)
v_mfma_f32_32x32x16_bf16 v[56:71],a[64:67],v[24:27],v[56:71]
ds_read_b128 v[52:55],v17 offset:22528
s_mul_i32 s61,s46,10240
s_add_u32 s60,s60,s61
s_add_u32 s60,s60,237371392
s_add_u32 s61,s61,s66
v_mfma_f32_32x32x16_bf16 v[56:71],a[68:71],v[28:31],v[56:71]
ds_read_b128 v[24:27],v16 offset:24576
s_add_u32 m0,s61,0
s_add_u32 s63,s60,0
s_waitcnt lgkmcnt(5)
v_mfma_f32_32x32x16_bf16 v[56:71],a[72:75],v[32:35],v[56:71]
ds_read_b128 v[28:31],v17 offset:24576
buffer_load_dwordx4 v112,s[8:11],s63 offen sc1 lds
s_add_u32 m0,s61,1024
s_add_u32 s63,s60,0
v_mfma_f32_32x32x16_bf16 v[56:71],a[76:79],v[36:39],v[56:71]
ds_read_b128 v[32:35],v16 offset:26624
s_waitcnt lgkmcnt(5)
v_mfma_f32_32x32x16_bf16 v[56:71],a[80:83],v[40:43],v[56:71]
ds_read_b128 v[36:39],v17 offset:26624
buffer_load_dwordx4 v113,s[8:11],s63 offen sc1 lds
s_add_u32 m0,s61,2048
s_add_u32 s63,s60,2048
v_mfma_f32_32x32x16_bf16 v[56:71],a[84:87],v[44:47],v[56:71]
ds_read_b128 v[40:43],v16 offset:28672
s_waitcnt lgkmcnt(5)
v_mfma_f32_32x32x16_bf16 v[56:71],a[88:91],v[48:51],v[56:71]
ds_read_b128 v[44:47],v17 offset:28672
buffer_load_dwordx4 v112,s[8:11],s63 offen sc1 lds
s_add_u32 m0,s61,3072
s_add_u32 s63,s60,2048
v_mfma_f32_32x32x16_bf16 v[56:71],a[92:95],v[52:55],v[56:71]
ds_read_b128 v[48:51],v16 offset:30720
s_waitcnt lgkmcnt(5)
v_mfma_f32_32x32x16_bf16 v[56:71],a[96:99],v[24:27],v[56:71]
ds_read_b128 v[52:55],v17 offset:30720
buffer_load_dwordx4 v113,s[8:11],s63 offen sc1 lds
s_add_u32 m0,s61,4096
s_add_u32 s63,s60,4096
v_mfma_f32_32x32x16_bf16 v[56:71],a[100:103],v[28:31],v[56:71]
ds_read_b128 v[24:27],v16 offset:32768
s_waitcnt lgkmcnt(5)
v_mfma_f32_32x32x16_bf16 v[56:71],a[104:107],v[32:35],v[56:71]
ds_read_b128 v[28:31],v17 offset:32768
buffer_load_dwordx4 v112,s[8:11],s63 offen sc1 lds
s_add_u32 m0,s61,5120
s_add_u32 s63,s60,4096
v_mfma_f32_32x32x16_bf16 v[56:71],a[108:111],v[36:39],v[56:71]
ds_read_b128 v[32:35],v16 offset:34816
s_waitcnt lgkmcnt(5)
v_mfma_f32_32x32x16_bf16 v[56:71],a[112:115],v[40:43],v[56:71]
ds_read_b128 v[36:39],v17 offset:34816
buffer_load_dwordx4 v113,s[8:11],s63 offen sc1 lds
s_add_u32 m0,s61,6144
s_add_u32 s63,s60,6144
v_mfma_f32_32x32x16_bf16 v[56:71],a[116:119],v[44:47],v[56:71]
ds_read_b128 v[40:43],v16 offset:36864
s_waitcnt lgkmcnt(5)
v_mfma_f32_32x32x16_bf16 v[56:71],a[120:123],v[48:51],v[56:71]
ds_read_b128 v[44:47],v17 offset:36864
buffer_load_dword v3,v2,s[8:11],s35 offen sc1
v_mfma_f32_32x32x16_bf16 v[56:71],a[124:127],v[52:55],v[56:71]
ds_read_b128 v[48:51],v16 offset:38912
buffer_load_dwordx4 v112,s[8:11],s63 offen sc1 lds
s_add_u32 m0,s61,7168
s_waitcnt lgkmcnt(5)
v_mfma_f32_32x32x16_bf16 v[56:71],a[128:131],v[24:27],v[56:71]
ds_read_b128 v[52:55],v17 offset:38912
s_add_u32 s63,s60,6144
v_mfma_f32_32x32x16_bf16 v[56:71],a[132:135],v[28:31],v[56:71]
buffer_load_dwordx4 v113,s[8:11],s63 offen sc1 lds
s_add_u32 m0,s61,8192
s_add_u32 s63,s60,8192
s_waitcnt lgkmcnt(4)
v_mfma_f32_32x32x16_bf16 v[56:71],a[136:139],v[32:35],v[56:71]
v_mfma_f32_32x32x16_bf16 v[56:71],a[140:143],v[36:39],v[56:71]
buffer_load_dwordx4 v112,s[8:11],s63 offen sc1 lds
s_add_u32 m0,s61,9216
s_add_u32 s63,s60,8192
s_waitcnt lgkmcnt(2)
v_mfma_f32_32x32x16_bf16 v[56:71],a[144:147],v[40:43],v[56:71]
v_mfma_f32_32x32x16_bf16 v[56:71],a[148:151],v[44:47],v[56:71]
buffer_load_dwordx4 v113,s[8:11],s63 offen sc1 lds
s_waitcnt lgkmcnt(0)
v_mfma_f32_32x32x16_bf16 v[56:71],a[152:155],v[48:51],v[56:71]
v_mfma_f32_32x32x16_bf16 v[56:71],a[156:159],v[52:55],v[56:71]
s_mov_b32 s55,0
s_cmp_eq_u32 s37,0
s_cbranch_scc1 ep_341
s_waitcnt vmcnt(0)
v_cmp_eq_u32 vcc,0,v3
s_cmp_eq_u64 vcc,0
s_cselect_b32 s37,0,2147483648
s_cmp_lt_u32 s32,128
s_cselect_b32 s37,s37,2147483648
s_cmp_lg_u32 s37,0
s_cbranch_scc1 ep_341
s_sub_u32 s66,40960,s57
s_mul_i32 s60,s33,66
s_add_u32 s60,s60,s34
s_mul_i32 s60,s60,40960
s_add_u32 s60,s60,s37
s_mul_i32 s61,s46,10240
s_add_u32 s60,s60,s61
s_add_u32 s60,s60,237371392
s_add_u32 s61,s61,s66
s_add_u32 m0,s61,0
s_add_u32 s63,s60,0
buffer_load_dwordx4 v112,s[8:11],s63 offen sc1 lds
s_add_u32 m0,s61,1024
s_add_u32 s63,s60,0
buffer_load_dwordx4 v113,s[8:11],s63 offen sc1 lds
s_add_u32 m0,s61,2048
s_add_u32 s63,s60,2048
buffer_load_dwordx4 v112,s[8:11],s63 offen sc1 lds
s_add_u32 m0,s61,3072
s_add_u32 s63,s60,2048
buffer_load_dwordx4 v113,s[8:11],s63 offen sc1 lds
s_add_u32 m0,s61,4096
s_add_u32 s63,s60,4096
buffer_load_dwordx4 v112,s[8:11],s63 offen sc1 lds
s_add_u32 m0,s61,5120
s_add_u32 s63,s60,4096
buffer_load_dwordx4 v113,s[8:11],s63 offen sc1 lds
s_add_u32 m0,s61,6144
s_add_u32 s63,s60,6144
buffer_load_dwordx4 v112,s[8:11],s63 offen sc1 lds
s_add_u32 m0,s61,7168
s_add_u32 s63,s60,6144
buffer_load_dwordx4 v113,s[8:11],s63 offen sc1 lds
s_add_u32 m0,s61,8192
s_add_u32 s63,s60,8192
buffer_load_dwordx4 v112,s[8:11],s63 offen sc1 lds
s_add_u32 m0,s61,9216
s_add_u32 s63,s60,8192
buffer_load_dwordx4 v113,s[8:11],s63 offen sc1 lds
ep_341:
s_nop 7
s_waitcnt vmcnt(12)
v_lshlrev_b32 v128,16,v120
v_and_b32 v129,0xffff0000,v120
v_lshlrev_b32 v130,16,v121
v_and_b32 v131,0xffff0000,v121
v_lshlrev_b32 v132,16,v122
v_and_b32 v133,0xffff0000,v122
v_lshlrev_b32 v134,16,v123
v_and_b32 v135,0xffff0000,v123
v_lshlrev_b32 v136,16,v124
v_and_b32 v137,0xffff0000,v124
v_lshlrev_b32 v138,16,v125
v_and_b32 v139,0xffff0000,v125
v_lshlrev_b32 v140,16,v126
v_and_b32 v141,0xffff0000,v126
v_lshlrev_b32 v142,16,v127
v_and_b32 v143,0xffff0000,v127
s_lshl_b32 s62,s51,6
s_add_u32 s62,s62,s52
s_mul_i32 s62,s62,46080
s_add_u32 s62,s62,212467712
s_lshl_b32 s63,s56,8
s_add_u32 s63,s63,s62
s_add_u32 s63,s63,40960
s_lshl_b32 s64,s56,11
s_add_u32 s62,s62,s64
v_cvt_pk_bf16_f32 v6,v56,v57
v_lshlrev_b32 v56,16,v6
v_and_b32 v57,0xffff0000,v6
v_cvt_pk_bf16_f32 v6,v58,v59
v_lshlrev_b32 v58,16,v6
v_and_b32 v59,0xffff0000,v6
v_cvt_pk_bf16_f32 v6,v60,v61
v_lshlrev_b32 v60,16,v6
v_and_b32 v61,0xffff0000,v6
v_cvt_pk_bf16_f32 v6,v62,v63
v_lshlrev_b32 v62,16,v6
v_and_b32 v63,0xffff0000,v6
v_cvt_pk_bf16_f32 v6,v64,v65
v_lshlrev_b32 v64,16,v6
v_and_b32 v65,0xffff0000,v6
v_cvt_pk_bf16_f32 v6,v66,v67
v_lshlrev_b32 v66,16,v6
v_and_b32 v67,0xffff0000,v6
v_cvt_pk_bf16_f32 v6,v68,v69
v_lshlrev_b32 v68,16,v6
v_and_b32 v69,0xffff0000,v6
v_cvt_pk_bf16_f32 v6,v70,v71
v_lshlrev_b32 v70,16,v6
v_and_b32 v71,0xffff0000,v6
v_pk_add_f32 v[56:57],v[56:57],v[128:129]
v_pk_add_f32 v[58:59],v[58:59],v[130:131]
v_pk_add_f32 v[60:61],v[60:61],v[132:133]
v_pk_add_f32 v[62:63],v[62:63],v[134:135]
v_pk_add_f32 v[64:65],v[64:65],v[136:137]
v_pk_add_f32 v[66:67],v[66:67],v[138:139]
v_pk_add_f32 v[68:69],v[68:69],v[140:141]
v_pk_add_f32 v[70:71],v[70:71],v[142:143]
v_cvt_pk_bf16_f32 v144,v56,v57
v_lshlrev_b32 v56,16,v144
v_and_b32 v57,0xffff0000,v144
v_cvt_pk_bf16_f32 v145,v58,v59
v_lshlrev_b32 v58,16,v145
v_and_b32 v59,0xffff0000,v145
v_cvt_pk_bf16_f32 v146,v60,v61
v_lshlrev_b32 v60,16,v146
v_and_b32 v61,0xffff0000,v146
v_cvt_pk_bf16_f32 v147,v62,v63
v_lshlrev_b32 v62,16,v147
v_and_b32 v63,0xffff0000,v147
v_cvt_pk_bf16_f32 v148,v64,v65
v_lshlrev_b32 v64,16,v148
v_and_b32 v65,0xffff0000,v148
v_cvt_pk_bf16_f32 v149,v66,v67
v_lshlrev_b32 v66,16,v149
v_and_b32 v67,0xffff0000,v149
v_cvt_pk_bf16_f32 v150,v68,v69
v_lshlrev_b32 v68,16,v150
v_and_b32 v69,0xffff0000,v150
v_cvt_pk_bf16_f32 v151,v70,v71
v_lshlrev_b32 v70,16,v151
v_and_b32 v71,0xffff0000,v151
s_cmp_lg_u32 s49,0
s_cbranch_scc0 ls_342
buffer_store_dwordx4 v[144:147],v20,s[8:11],s62 offen sc1
buffer_store_dwordx4 v[148:151],v21,s[8:11],s62 offen sc1
s_branch ls_343
ls_342:
buffer_store_dwordx4 v[144:147],v20,s[8:11],s62 offen
buffer_store_dwordx4 v[148:151],v21,s[8:11],s62 offen
ls_343:
v_pk_add_f32 v[6:7],v[56:57],v[58:59]
v_pk_mul_f32 v[8:9],v[56:57],v[56:57]
v_pk_fma_f32 v[8:9],v[58:59],v[58:59],v[8:9]
v_pk_add_f32 v[6:7],v[6:7],v[60:61]
v_pk_fma_f32 v[8:9],v[60:61],v[60:61],v[8:9]
v_pk_add_f32 v[6:7],v[6:7],v[62:63]
v_pk_fma_f32 v[8:9],v[62:63],v[62:63],v[8:9]
v_pk_add_f32 v[6:7],v[6:7],v[64:65]
v_pk_fma_f32 v[8:9],v[64:65],v[64:65],v[8:9]
v_pk_add_f32 v[6:7],v[6:7],v[66:67]
v_pk_fma_f32 v[8:9],v[66:67],v[66:67],v[8:9]
v_pk_add_f32 v[6:7],v[6:7],v[68:69]
v_pk_fma_f32 v[8:9],v[68:69],v[68:69],v[8:9]
v_pk_add_f32 v[6:7],v[6:7],v[70:71]
v_pk_fma_f32 v[8:9],v[70:71],v[70:71],v[8:9]
v_add_f32 v6,v6,v7
v_add_f32 v7,v8,v9
v_mov_b32 v8,v6
v_mov_b32 v9,v7
s_nop 0
v_permlane32_swap_b32 v6,v8
v_permlane32_swap_b32 v7,v9
v_pk_add_f32 v[6:7],v[6:7],v[8:9]
s_mov_b32 exec_hi,0
s_cmp_lg_u32 s49,0
s_cbranch_scc0 ls_344
buffer_store_dwordx2 v[6:7],v114,s[8:11],s63 offen sc1
s_branch ls_345
ls_344:
buffer_store_dwordx2 v[6:7],v114,s[8:11],s63 offen
ls_345:
s_mov_b32 exec_hi,-1
s_lshl_b32 s82,s51,6
s_add_u32 s82,s82,s52
s_lshl_b32 s82,s82,9
s_add_u32 s82,s82,524288
s_lshl_b32 s61,s56,2
s_add_u32 s82,s82,s61
s_mov_b32 s59,s82
s_cmp_eq_u32 s37,0
s_cbranch_scc1 W2_NEXT
s_waitcnt vmcnt(0)
s_mov_b64 exec,1
s_cmp_lg_u32 s49,0
s_cbranch_scc0 ls_346
buffer_store_dword v5,v1,s[8:11],s59 offen sc1
s_branch ls_347
ls_346:
buffer_store_dword v5,v1,s[8:11],s59 offen
ls_347:
s_mov_b64 exec,-1
s_mov_b32 s59,2147483648
s_cmp_lt_u32 s32,128
s_cbranch_scc1 W2_COLD
W2_END:
s_endpgm
ROLE_W3:
v_lshlrev_b32 v1,4,v0
v_mov_b32 v5,1
s_lshl_b32 s56,s48,2
s_add_u32 s56,s56,s46
v_bfe_u32 v6,v0,2,2
v_lshrrev_b32 v7,4,v0
v_add_u32 v7,v6,v7
v_and_b32 v7,3,v7
v_and_b32 v15,3,v0
v_lshlrev_b32 v15,4,v15
v_lshl_add_u32 v15,v7,6,v15
v_lshl_add_u32 v15,v6,8,v15
v_lshrrev_b32 v6,5,v0
v_bfe_u32 v7,v0,4,1
v_lshlrev_b32 v16,10,v7
v_lshl_add_u32 v16,v6,8,v16
v_and_b32 v6,15,v0
v_lshl_add_u32 v16,v6,4,v16
v_add_u32 v18,46080,v16
v_lshrrev_b32 v6,5,v0
v_bfe_u32 v7,v0,4,1
v_lshlrev_b32 v20,10,v7
v_lshl_add_u32 v20,v6,8,v20
v_and_b32 v6,15,v0
v_lshl_add_u32 v20,v6,4,v20
v_lshrrev_b32 v6,5,v0
v_add_u32 v6,2,v6
v_bfe_u32 v7,v0,4,1
v_lshlrev_b32 v17,10,v7
v_lshl_add_u32 v17,v6,8,v17
v_and_b32 v6,15,v0
v_lshl_add_u32 v17,v6,4,v17
v_add_u32 v19,46080,v17
v_lshrrev_b32 v6,5,v0
v_add_u32 v6,2,v6
v_bfe_u32 v7,v0,4,1
v_lshlrev_b32 v21,10,v7
v_lshl_add_u32 v21,v6,8,v21
v_and_b32 v6,15,v0
v_lshl_add_u32 v21,v6,4,v21
v_min_u32 v2,19,v0
v_lshlrev_b32 v2,2,v2
v_mov_b32 v112,0xc0135761
v_mov_b32 v113,0xbdd2d3e8
s_mov_b32 s68,0xbdd2d3e8
v_lshrrev_b32 v6,5,v0
v_mul_u32_u24 v182,2560,v6
v_and_b32 v6,31,v0
v_lshl_add_u32 v182,v6,3,v182
v_add_u32 v182,0xa000,v182
s_waitcnt vmcnt(0)
s_barrier
s_cmp_lg_u32 s46,0
s_cbranch_scc1 arr_348
v_mov_b32 v6,1
s_lshl_b32 s3,s49,2
v_mov_b32 v7,s3
s_mov_b64 exec,1
buffer_atomic_add v6,v7,s[12:15],0 offen sc1
s_mov_b64 exec,-1
arr_348:
s_lshl_b32 s58,s56,6
s_mul_i32 s63,s46,40960
s_mov_b32 s4,s36
s_mov_b32 s5,s37
s_mov_b32 s6,1966080
s_mov_b32 s7,0x20000
v_lshrrev_b32 v9,2,v0
s_mov_b32 s64,3072
v_mul_lo_u32 v9,v9,s64
v_and_b32 v10,3,v0
v_lshl_add_u32 v6,v10,4,v9
s_add_u32 m0,s63,0
s_add_u32 s65,s58,0
buffer_load_dwordx4 v6,s[4:7],s65 offen lds
s_add_u32 m0,s63,1024
s_add_u32 s65,s58,49152
buffer_load_dwordx4 v6,s[4:7],s65 offen lds
s_add_u32 m0,s63,2048
s_add_u32 s65,s58,98304
buffer_load_dwordx4 v6,s[4:7],s65 offen lds
s_add_u32 m0,s63,3072
s_add_u32 s65,s58,147456
buffer_load_dwordx4 v6,s[4:7],s65 offen lds
s_add_u32 m0,s63,4096
s_add_u32 s65,s58,196608
buffer_load_dwordx4 v6,s[4:7],s65 offen lds
s_add_u32 m0,s63,5120
s_add_u32 s65,s58,245760
buffer_load_dwordx4 v6,s[4:7],s65 offen lds
s_add_u32 m0,s63,6144
s_add_u32 s65,s58,294912
buffer_load_dwordx4 v6,s[4:7],s65 offen lds
s_add_u32 m0,s63,7168
s_add_u32 s65,s58,344064
buffer_load_dwordx4 v6,s[4:7],s65 offen lds
s_add_u32 m0,s63,8192
s_add_u32 s65,s58,393216
buffer_load_dwordx4 v6,s[4:7],s65 offen lds
s_add_u32 m0,s63,9216
s_add_u32 s65,s58,442368
buffer_load_dwordx4 v6,s[4:7],s65 offen lds
s_add_u32 m0,s63,10240
s_add_u32 s65,s58,491520
buffer_load_dwordx4 v6,s[4:7],s65 offen lds
s_add_u32 m0,s63,11264
s_add_u32 s65,s58,540672
buffer_load_dwordx4 v6,s[4:7],s65 offen lds
s_add_u32 m0,s63,12288
s_add_u32 s65,s58,589824
buffer_load_dwordx4 v6,s[4:7],s65 offen lds
s_add_u32 m0,s63,13312
s_add_u32 s65,s58,638976
buffer_load_dwordx4 v6,s[4:7],s65 offen lds
s_add_u32 m0,s63,14336
s_add_u32 s65,s58,688128
buffer_load_dwordx4 v6,s[4:7],s65 offen lds
s_add_u32 m0,s63,15360
s_add_u32 s65,s58,737280
buffer_load_dwordx4 v6,s[4:7],s65 offen lds
s_add_u32 m0,s63,16384
s_add_u32 s65,s58,786432
buffer_load_dwordx4 v6,s[4:7],s65 offen lds
s_add_u32 m0,s63,17408
s_add_u32 s65,s58,835584
buffer_load_dwordx4 v6,s[4:7],s65 offen lds
s_add_u32 m0,s63,18432
s_add_u32 s65,s58,884736
buffer_load_dwordx4 v6,s[4:7],s65 offen lds
s_add_u32 m0,s63,19456
s_add_u32 s65,s58,933888
buffer_load_dwordx4 v6,s[4:7],s65 offen lds
s_add_u32 m0,s63,20480
s_add_u32 s65,s58,983040
buffer_load_dwordx4 v6,s[4:7],s65 offen lds
s_add_u32 m0,s63,21504
s_add_u32 s65,s58,1032192
buffer_load_dwordx4 v6,s[4:7],s65 offen lds
s_add_u32 m0,s63,22528
s_add_u32 s65,s58,1081344
buffer_load_dwordx4 v6,s[4:7],s65 offen lds
s_add_u32 m0,s63,23552
s_add_u32 s65,s58,1130496
buffer_load_dwordx4 v6,s[4:7],s65 offen lds
s_add_u32 m0,s63,24576
s_add_u32 s65,s58,1179648
buffer_load_dwordx4 v6,s[4:7],s65 offen lds
s_add_u32 m0,s63,25600
s_add_u32 s65,s58,1228800
buffer_load_dwordx4 v6,s[4:7],s65 offen lds
s_add_u32 m0,s63,26624
s_add_u32 s65,s58,1277952
buffer_load_dwordx4 v6,s[4:7],s65 offen lds
s_add_u32 m0,s63,27648
s_add_u32 s65,s58,1327104
buffer_load_dwordx4 v6,s[4:7],s65 offen lds
s_add_u32 m0,s63,28672
s_add_u32 s65,s58,1376256
buffer_load_dwordx4 v6,s[4:7],s65 offen lds
s_add_u32 m0,s63,29696
s_add_u32 s65,s58,1425408
buffer_load_dwordx4 v6,s[4:7],s65 offen lds
s_add_u32 m0,s63,30720
s_add_u32 s65,s58,1474560
buffer_load_dwordx4 v6,s[4:7],s65 offen lds
s_add_u32 m0,s63,31744
s_add_u32 s65,s58,1523712
buffer_load_dwordx4 v6,s[4:7],s65 offen lds
s_add_u32 m0,s63,32768
s_add_u32 s65,s58,1572864
buffer_load_dwordx4 v6,s[4:7],s65 offen lds
s_add_u32 m0,s63,33792
s_add_u32 s65,s58,1622016
buffer_load_dwordx4 v6,s[4:7],s65 offen lds
s_add_u32 m0,s63,34816
s_add_u32 s65,s58,1671168
buffer_load_dwordx4 v6,s[4:7],s65 offen lds
s_add_u32 m0,s63,35840
s_add_u32 s65,s58,1720320
buffer_load_dwordx4 v6,s[4:7],s65 offen lds
s_add_u32 m0,s63,36864
s_add_u32 s65,s58,1769472
buffer_load_dwordx4 v6,s[4:7],s65 offen lds
s_add_u32 m0,s63,37888
s_add_u32 s65,s58,1818624
buffer_load_dwordx4 v6,s[4:7],s65 offen lds
s_add_u32 m0,s63,38912
s_add_u32 s65,s58,1867776
buffer_load_dwordx4 v6,s[4:7],s65 offen lds
s_add_u32 m0,s63,39936
s_add_u32 s65,s58,1916928
buffer_load_dwordx4 v6,s[4:7],s65 offen lds
s_waitcnt vmcnt(20)
v_bfe_u32 v9,v0,2,2
v_lshrrev_b32 v10,5,v0
v_lshl_add_u32 v9,v10,2,v9
v_mul_u32_u24 v9,64,v9
v_and_b32 v10,1,v0
v_lshl_add_u32 v9,v10,3,v9
v_bfe_u32 v10,v0,1,1
v_lshl_add_u32 v9,v10,5,v9
v_bfe_u32 v10,v0,4,1
v_lshl_add_u32 v9,v10,4,v9
v_add_u32 v7,s63,v9
ds_read_b64_tr_b16 a[0:1],v7 offset:0
ds_read_b64_tr_b16 a[2:3],v7 offset:1024
ds_read_b64_tr_b16 a[4:5],v7 offset:512
ds_read_b64_tr_b16 a[6:7],v7 offset:1536
ds_read_b64_tr_b16 a[8:9],v7 offset:2048
ds_read_b64_tr_b16 a[10:11],v7 offset:3072
ds_read_b64_tr_b16 a[12:13],v7 offset:2560
ds_read_b64_tr_b16 a[14:15],v7 offset:3584
ds_read_b64_tr_b16 a[16:17],v7 offset:4096
ds_read_b64_tr_b16 a[18:19],v7 offset:5120
ds_read_b64_tr_b16 a[20:21],v7 offset:4608
ds_read_b64_tr_b16 a[22:23],v7 offset:5632
s_waitcnt lgkmcnt(4)
ds_read_b64_tr_b16 a[24:25],v7 offset:6144
ds_read_b64_tr_b16 a[26:27],v7 offset:7168
ds_read_b64_tr_b16 a[28:29],v7 offset:6656
ds_read_b64_tr_b16 a[30:31],v7 offset:7680
ds_read_b64_tr_b16 a[32:33],v7 offset:8192
ds_read_b64_tr_b16 a[34:35],v7 offset:9216
ds_read_b64_tr_b16 a[36:37],v7 offset:8704
ds_read_b64_tr_b16 a[38:39],v7 offset:9728
ds_read_b64_tr_b16 a[40:41],v7 offset:10240
ds_read_b64_tr_b16 a[42:43],v7 offset:11264
ds_read_b64_tr_b16 a[44:45],v7 offset:10752
ds_read_b64_tr_b16 a[46:47],v7 offset:11776
s_waitcnt lgkmcnt(4)
ds_read_b64_tr_b16 a[48:49],v7 offset:12288
ds_read_b64_tr_b16 a[50:51],v7 offset:13312
ds_read_b64_tr_b16 a[52:53],v7 offset:12800
ds_read_b64_tr_b16 a[54:55],v7 offset:13824
ds_read_b64_tr_b16 a[56:57],v7 offset:14336
ds_read_b64_tr_b16 a[58:59],v7 offset:15360
ds_read_b64_tr_b16 a[60:61],v7 offset:14848
ds_read_b64_tr_b16 a[62:63],v7 offset:15872
ds_read_b64_tr_b16 a[64:65],v7 offset:16384
ds_read_b64_tr_b16 a[66:67],v7 offset:17408
ds_read_b64_tr_b16 a[68:69],v7 offset:16896
ds_read_b64_tr_b16 a[70:71],v7 offset:17920
s_waitcnt lgkmcnt(4)
ds_read_b64_tr_b16 a[72:73],v7 offset:18432
ds_read_b64_tr_b16 a[74:75],v7 offset:19456
ds_read_b64_tr_b16 a[76:77],v7 offset:18944
ds_read_b64_tr_b16 a[78:79],v7 offset:19968
s_waitcnt lgkmcnt(0)
s_waitcnt vmcnt(0)
v_bfe_u32 v9,v0,2,2
v_lshrrev_b32 v10,5,v0
v_lshl_add_u32 v9,v10,2,v9
v_mul_u32_u24 v9,64,v9
v_and_b32 v10,1,v0
v_lshl_add_u32 v9,v10,3,v9
v_bfe_u32 v10,v0,1,1
v_lshl_add_u32 v9,v10,5,v9
v_bfe_u32 v10,v0,4,1
v_lshl_add_u32 v9,v10,4,v9
v_add_u32 v7,s63,v9
ds_read_b64_tr_b16 a[80:81],v7 offset:20480
ds_read_b64_tr_b16 a[82:83],v7 offset:21504
ds_read_b64_tr_b16 a[84:85],v7 offset:20992
ds_read_b64_tr_b16 a[86:87],v7 offset:22016
ds_read_b64_tr_b16 a[88:89],v7 offset:22528
ds_read_b64_tr_b16 a[90:91],v7 offset:23552
ds_read_b64_tr_b16 a[92:93],v7 offset:23040
ds_read_b64_tr_b16 a[94:95],v7 offset:24064
ds_read_b64_tr_b16 a[96:97],v7 offset:24576
ds_read_b64_tr_b16 a[98:99],v7 offset:25600
ds_read_b64_tr_b16 a[100:101],v7 offset:25088
ds_read_b64_tr_b16 a[102:103],v7 offset:26112
s_waitcnt lgkmcnt(4)
ds_read_b64_tr_b16 a[104:105],v7 offset:26624
ds_read_b64_tr_b16 a[106:107],v7 offset:27648
ds_read_b64_tr_b16 a[108:109],v7 offset:27136
ds_read_b64_tr_b16 a[110:111],v7 offset:28160
ds_read_b64_tr_b16 a[112:113],v7 offset:28672
ds_read_b64_tr_b16 a[114:115],v7 offset:29696
ds_read_b64_tr_b16 a[116:117],v7 offset:29184
ds_read_b64_tr_b16 a[118:119],v7 offset:30208
ds_read_b64_tr_b16 a[120:121],v7 offset:30720
ds_read_b64_tr_b16 a[122:123],v7 offset:31744
ds_read_b64_tr_b16 a[124:125],v7 offset:31232
ds_read_b64_tr_b16 a[126:127],v7 offset:32256
s_waitcnt lgkmcnt(4)
ds_read_b64_tr_b16 a[128:129],v7 offset:32768
ds_read_b64_tr_b16 a[130:131],v7 offset:33792
ds_read_b64_tr_b16 a[132:133],v7 offset:33280
ds_read_b64_tr_b16 a[134:135],v7 offset:34304
ds_read_b64_tr_b16 a[136:137],v7 offset:34816
ds_read_b64_tr_b16 a[138:139],v7 offset:35840
ds_read_b64_tr_b16 a[140:141],v7 offset:35328
ds_read_b64_tr_b16 a[142:143],v7 offset:36352
ds_read_b64_tr_b16 a[144:145],v7 offset:36864
ds_read_b64_tr_b16 a[146:147],v7 offset:37888
ds_read_b64_tr_b16 a[148:149],v7 offset:37376
ds_read_b64_tr_b16 a[150:151],v7 offset:38400
s_waitcnt lgkmcnt(4)
ds_read_b64_tr_b16 a[152:153],v7 offset:38912
ds_read_b64_tr_b16 a[154:155],v7 offset:39936
ds_read_b64_tr_b16 a[156:157],v7 offset:39424
ds_read_b64_tr_b16 a[158:159],v7 offset:40448
s_waitcnt lgkmcnt(0)
v_mov_b32 v24,0x3f803f80
v_mov_b32 v25,0x3f803f80
v_mov_b32 v26,0x3f803f80
v_mov_b32 v27,0x3f803f80
s_nop 1
v_mfma_f32_32x32x16_bf16 v[144:159],a[0:3],v[24:27],0
v_mfma_f32_32x32x16_bf16 v[144:159],a[4:7],v[24:27],v[144:159]
v_mfma_f32_32x32x16_bf16 v[144:159],a[8:11],v[24:27],v[144:159]
v_mfma_f32_32x32x16_bf16 v[144:159],a[12:15],v[24:27],v[144:159]
v_mfma_f32_32x32x16_bf16 v[144:159],a[16:19],v[24:27],v[144:159]
v_mfma_f32_32x32x16_bf16 v[144:159],a[20:23],v[24:27],v[144:159]
v_mfma_f32_32x32x16_bf16 v[144:159],a[24:27],v[24:27],v[144:159]
v_mfma_f32_32x32x16_bf16 v[144:159],a[28:31],v[24:27],v[144:159]
v_mfma_f32_32x32x16_bf16 v[144:159],a[32:35],v[24:27],v[144:159]
v_mfma_f32_32x32x16_bf16 v[144:159],a[36:39],v[24:27],v[144:159]
v_mfma_f32_32x32x16_bf16 v[144:159],a[40:43],v[24:27],v[144:159]
v_mfma_f32_32x32x16_bf16 v[144:159],a[44:47],v[24:27],v[144:159]
v_mfma_f32_32x32x16_bf16 v[144:159],a[48:51],v[24:27],v[144:159]
v_mfma_f32_32x32x16_bf16 v[144:159],a[52:55],v[24:27],v[144:159]
v_mfma_f32_32x32x16_bf16 v[144:159],a[56:59],v[24:27],v[144:159]
v_mfma_f32_32x32x16_bf16 v[144:159],a[60:63],v[24:27],v[144:159]
v_mfma_f32_32x32x16_bf16 v[144:159],a[64:67],v[24:27],v[144:159]
v_mfma_f32_32x32x16_bf16 v[144:159],a[68:71],v[24:27],v[144:159]
v_mfma_f32_32x32x16_bf16 v[144:159],a[72:75],v[24:27],v[144:159]
v_mfma_f32_32x32x16_bf16 v[144:159],a[76:79],v[24:27],v[144:159]
v_mfma_f32_32x32x16_bf16 v[144:159],a[80:83],v[24:27],v[144:159]
v_mfma_f32_32x32x16_bf16 v[144:159],a[84:87],v[24:27],v[144:159]
v_mfma_f32_32x32x16_bf16 v[144:159],a[88:91],v[24:27],v[144:159]
v_mfma_f32_32x32x16_bf16 v[144:159],a[92:95],v[24:27],v[144:159]
v_mfma_f32_32x32x16_bf16 v[144:159],a[96:99],v[24:27],v[144:159]
v_mfma_f32_32x32x16_bf16 v[144:159],a[100:103],v[24:27],v[144:159]
v_mfma_f32_32x32x16_bf16 v[144:159],a[104:107],v[24:27],v[144:159]
v_mfma_f32_32x32x16_bf16 v[144:159],a[108:111],v[24:27],v[144:159]
v_mfma_f32_32x32x16_bf16 v[144:159],a[112:115],v[24:27],v[144:159]
v_mfma_f32_32x32x16_bf16 v[144:159],a[116:119],v[24:27],v[144:159]
v_mfma_f32_32x32x16_bf16 v[144:159],a[120:123],v[24:27],v[144:159]
v_mfma_f32_32x32x16_bf16 v[144:159],a[124:127],v[24:27],v[144:159]
v_mfma_f32_32x32x16_bf16 v[144:159],a[128:131],v[24:27],v[144:159]
v_mfma_f32_32x32x16_bf16 v[144:159],a[132:135],v[24:27],v[144:159]
v_mfma_f32_32x32x16_bf16 v[144:159],a[136:139],v[24:27],v[144:159]
v_mfma_f32_32x32x16_bf16 v[144:159],a[140:143],v[24:27],v[144:159]
v_mfma_f32_32x32x16_bf16 v[144:159],a[144:147],v[24:27],v[144:159]
v_mfma_f32_32x32x16_bf16 v[144:159],a[148:151],v[24:27],v[144:159]
v_mfma_f32_32x32x16_bf16 v[144:159],a[152:155],v[24:27],v[144:159]
v_mfma_f32_32x32x16_bf16 v[144:159],a[156:159],v[24:27],v[144:159]
s_barrier
s_lshl_b32 s3,s49,2
v_mov_b32 v7,s3
s_nop 8
ibw_349:
buffer_load_dword v6,v7,s[12:15],0 offen sc1
s_waitcnt vmcnt(0)
v_cmp_ne_u32 vcc,256,v6
s_nop 0
s_cbranch_vccz ok_350
s_sleep 8
s_sub_u32 s47,s47,1
s_cbranch_scc1 ABORT
s_branch ibw_349
ok_350:
s_cmp_lg_u32 s49,0
s_cbranch_scc1 ibok_351
v_and_b32 v7,7,v0
v_lshlrev_b32 v7,2,v7
buffer_load_dword v6,v7,s[12:15],0 offen offset:32 sc1
s_waitcnt vmcnt(0)
v_cmp_ne_u32 vcc,32,v6
s_nop 0
s_cbranch_vccz ibok_351
s_barrier
s_mov_b32 s49,1
s_mov_b32 s3,s2
s_load_dwordx16 s[16:31],s[0:1],0
s_load_dwordx8 s[32:39],s[0:1],64
s_waitcnt lgkmcnt(0)
s_branch DISPATCH
ibok_351:
s_mov_b32 s50,0
s_mov_b32 s32,0
s_mov_b32 s57,0
s_mov_b32 s59,2147483648
s_mov_b32 s82,2147483648
s_mov_b32 s39,2147483648
v_mov_b32 v22,94208
v_mov_b32 v23,0
ds_write_b32 v22,v23
s_mov_b32 s39,1600000
s_waitcnt lgkmcnt(0)
s_barrier
s_mov_b32 s83,s100
s_min_u32 s62,s32,127
s_sub_u32 s60,s62,14
s_lshr_b32 s34,s60,1
s_and_b32 s33,s60,1
s_cmp_eq_u32 s33,0
s_cselect_b32 s61,14,0
s_add_u32 s34,s34,s61
s_sub_u32 s61,s60,50
s_cmp_ge_u32 s60,100
s_cselect_b32 s34,s61,s34
s_cselect_b32 s33,1,s33
s_cmp_lt_u32 s62,14
s_cselect_b32 s34,s62,s34
s_cselect_b32 s33,0,s33
s_lshl_b32 s35,s33,6
s_add_u32 s35,s35,s34
s_lshl_b32 s35,s35,9
s_add_u32 s35,s35,524288
s_sub_u32 s57,46080,s57
v_swap_b32 v16,v18
v_swap_b32 v17,v19
s_mov_b32 s50,-1
s_nop 0
W3_COLD:
s_mov_b32 s37,0
fb_352:
buffer_load_dword v3,v2,s[8:11],s35 offen sc1
s_waitcnt vmcnt(0)
v_cmp_eq_u32 vcc,0,v3
s_nop 0
s_cbranch_vccz ok_353
s_sleep 2
s_sub_u32 s47,s47,1
s_cbranch_scc1 ABORT
s_branch fb_352
ok_353:
s_sub_u32 s66,46080,s57
s_lshl_b32 s60,s33,6
s_add_u32 s60,s60,s34
s_mul_i32 s60,s60,46080
s_add_u32 s60,s60,s37
s_add_u32 s60,s60,212467712
s_lshl_b32 s62,s46,10
s_add_u32 s62,s62,40960
s_add_u32 m0,s66,s62
s_add_u32 s63,s60,s62
buffer_load_dwordx4 v1,s[8:11],s63 offen sc1 lds
s_add_u32 m0,s66,45056
s_add_u32 s63,s60,45056
buffer_load_dwordx4 v1,s[8:11],s63 offen sc1 lds
s_mul_i32 s61,s46,10240
s_add_u32 s60,s60,s61
s_add_u32 s61,s61,s66
s_add_u32 m0,s61,0
s_add_u32 s63,s60,0
buffer_load_dwordx4 v1,s[8:11],s63 offen sc1 lds
buffer_load_dwordx4 v1,s[8:11],s63 offen offset:1024 sc1 lds
buffer_load_dwordx4 v1,s[8:11],s63 offen offset:2048 sc1 lds
buffer_load_dwordx4 v1,s[8:11],s63 offen offset:3072 sc1 lds
s_add_u32 m0,s61,4096
s_add_u32 s63,s60,4096
buffer_load_dwordx4 v1,s[8:11],s63 offen sc1 lds
buffer_load_dwordx4 v1,s[8:11],s63 offen offset:1024 sc1 lds
buffer_load_dwordx4 v1,s[8:11],s63 offen offset:2048 sc1 lds
buffer_load_dwordx4 v1,s[8:11],s63 offen offset:3072 sc1 lds
s_add_u32 m0,s61,8192
s_add_u32 s63,s60,8192
buffer_load_dwordx4 v1,s[8:11],s63 offen sc1 lds
buffer_load_dwordx4 v1,s[8:11],s63 offen offset:1024 sc1 lds
s_mov_b32 s55,1
W3_NEXT:
s_add_u32 s50,s50,1
s_sub_u32 s57,46080,s57
v_swap_b32 v16,v18
v_swap_b32 v17,v19
s_mov_b32 s51,s33
s_mov_b32 s52,s34
s_add_u32 s32,s32,1
s_min_u32 s62,s32,127
s_sub_u32 s60,s62,14
s_lshr_b32 s34,s60,1
s_and_b32 s33,s60,1
s_cmp_eq_u32 s33,0
s_cselect_b32 s61,14,0
s_add_u32 s34,s34,s61
s_sub_u32 s61,s60,50
s_cmp_ge_u32 s60,100
s_cselect_b32 s34,s61,s34
s_cselect_b32 s33,1,s33
s_cmp_lt_u32 s62,14
s_cselect_b32 s34,s62,s34
s_cselect_b32 s33,0,s33
s_lshl_b32 s35,s33,6
s_add_u32 s35,s35,s34
s_lshl_b32 s35,s35,9
s_add_u32 s35,s35,524288
s_waitcnt vmcnt(2)
s_cmp_eq_u32 s55,0
s_cbranch_scc1 wv_354
s_waitcnt vmcnt(0)
wv_354:
s_barrier
ds_read_b128 v[24:27],v16 offset:0
ds_read_b128 v[28:31],v17 offset:0
ds_read_b128 v[32:35],v16 offset:2048
ds_read_b128 v[36:39],v17 offset:2048
ds_read_b128 v[40:43],v16 offset:4096
ds_read_b128 v[44:47],v17 offset:4096
ds_read_b128 v[48:51],v16 offset:6144
buffer_load_dword v3,v2,s[8:11],s35 offen sc1
s_waitcnt lgkmcnt(6)
v_mfma_f32_32x32x16_bf16 v[56:71],a[0:3],v[24:27],0
ds_read_b128 v[52:55],v17 offset:6144
v_add_u32 v183,s57,v182
s_waitcnt lgkmcnt(6)
v_mfma_f32_32x32x16_bf16 v[56:71],a[4:7],v[28:31],v[56:71]
ds_read_b128 v[24:27],v16 offset:8192
v_add_u32 v8,0x800,v183
s_waitcnt lgkmcnt(5)
v_mfma_f32_32x32x16_bf16 v[56:71],a[8:11],v[32:35],v[56:71]
ds_read_b128 v[28:31],v17 offset:8192
ds_read2_b64 v[160:163],v183 offset0:0 offset1:32
v_mfma_f32_32x32x16_bf16 v[56:71],a[12:15],v[36:39],v[56:71]
ds_read_b128 v[32:35],v16 offset:10240
ds_read2_b64 v[164:167],v183 offset0:64 offset1:96
s_waitcnt lgkmcnt(7)
v_mfma_f32_32x32x16_bf16 v[56:71],a[16:19],v[40:43],v[56:71]
ds_read_b128 v[36:39],v17 offset:10240
ds_read2_b64 v[168:171],v183 offset0:128 offset1:160
v_mfma_f32_32x32x16_bf16 v[56:71],a[20:23],v[44:47],v[56:71]
ds_read_b128 v[40:43],v16 offset:12288
ds_read2_b64 v[172:175],v183 offset0:192 offset1:224
s_waitcnt lgkmcnt(9)
v_mfma_f32_32x32x16_bf16 v[56:71],a[24:27],v[48:51],v[56:71]
ds_read_b128 v[44:47],v17 offset:12288
ds_read2_b64 v[176:179],v8 offset0:0 offset1:32
v_mfma_f32_32x32x16_bf16 v[56:71],a[28:31],v[52:55],v[56:71]
ds_read_b128 v[48:51],v16 offset:14336
s_waitcnt lgkmcnt(10)
v_mfma_f32_32x32x16_bf16 v[56:71],a[32:35],v[24:27],v[56:71]
ds_read_b128 v[52:55],v17 offset:14336
v_mfma_f32_32x32x16_bf16 v[56:71],a[36:39],v[28:31],v[56:71]
ds_read_b128 v[24:27],v16 offset:16384
s_waitcnt lgkmcnt(8)
v_mfma_f32_32x32x16_bf16 v[56:71],a[40:43],v[32:35],v[56:71]
ds_read_b128 v[28:31],v17 offset:16384
s_waitcnt lgkmcnt(4)
v_pk_add_f32 v[160:161],v[160:161],v[170:171]
v_mfma_f32_32x32x16_bf16 v[56:71],a[44:47],v[36:39],v[56:71]
ds_read_b128 v[32:35],v16 offset:18432
v_pk_add_f32 v[162:163],v[162:163],v[172:173]
v_pk_add_f32 v[164:165],v[164:165],v[174:175]
v_mfma_f32_32x32x16_bf16 v[56:71],a[48:51],v[40:43],v[56:71]
ds_read_b128 v[36:39],v17 offset:18432
s_waitcnt vmcnt(0)
s_mov_b64 exec,1
s_cmp_lg_u32 s49,0
s_cbranch_scc0 ls_355
buffer_store_dword v5,v1,s[8:11],s59 offen sc1
s_branch ls_356
ls_355:
buffer_store_dword v5,v1,s[8:11],s59 offen
ls_356:
s_mov_b64 exec,-1
s_mov_b32 s59,2147483648
v_mfma_f32_32x32x16_bf16 v[56:71],a[52:55],v[44:47],v[56:71]
ds_read_b128 v[40:43],v16 offset:20480
v_cmp_eq_u32 vcc,0,v3
s_cmp_eq_u64 vcc,0
s_cselect_b32 s37,0,2147483648
s_waitcnt lgkmcnt(5)
v_mfma_f32_32x32x16_bf16 v[56:71],a[56:59],v[48:51],v[56:71]
ds_read_b128 v[44:47],v17 offset:20480
s_cmp_lt_u32 s32,128
s_cselect_b32 s37,s37,2147483648
s_sub_u32 s66,46080,s57
s_lshl_b32 s60,s33,6
v_mfma_f32_32x32x16_bf16 v[56:71],a[60:63],v[52:55],v[56:71]
ds_read_b128 v[48:51],v16 offset:22528
s_add_u32 s60,s60,s34
s_mul_i32 s60,s60,46080
s_add_u32 s60,s60,s37
s_waitcnt lgkmcnt(5)
v_mfma_f32_32x32x16_bf16 v[56:71],a[64:67],v[24:27],v[56:71]
ds_read_b128 v[52:55],v17 offset:22528
s_add_u32 s60,s60,212467712
s_lshl_b32 s62,s46,10
s_add_u32 s62,s62,40960
s_add_u32 m0,s66,s62
v_mfma_f32_32x32x16_bf16 v[56:71],a[68:71],v[28:31],v[56:71]
ds_read_b128 v[24:27],v16 offset:24576
s_add_u32 s63,s60,s62
buffer_load_dwordx4 v1,s[8:11],s63 offen sc1 lds
s_waitcnt lgkmcnt(5)
v_mfma_f32_32x32x16_bf16 v[56:71],a[72:75],v[32:35],v[56:71]
ds_read_b128 v[28:31],v17 offset:24576
s_add_u32 m0,s66,45056
s_add_u32 s63,s60,45056
v_pk_add_f32 v[166:167],v[166:167],v[176:177]
v_mfma_f32_32x32x16_bf16 v[56:71],a[76:79],v[36:39],v[56:71]
ds_read_b128 v[32:35],v16 offset:26624
buffer_load_dwordx4 v1,s[8:11],s63 offen sc1 lds
s_mul_i32 s61,s46,10240
s_waitcnt lgkmcnt(5)
v_mfma_f32_32x32x16_bf16 v[56:71],a[80:83],v[40:43],v[56:71]
ds_read_b128 v[36:39],v17 offset:26624
s_add_u32 s60,s60,s61
s_add_u32 s61,s61,s66
s_add_u32 m0,s61,0
s_add_u32 s63,s60,0
v_mfma_f32_32x32x16_bf16 v[56:71],a[84:87],v[44:47],v[56:71]
ds_read_b128 v[40:43],v16 offset:28672
buffer_load_dwordx4 v1,s[8:11],s63 offen sc1 lds
s_waitcnt lgkmcnt(5)
v_mfma_f32_32x32x16_bf16 v[56:71],a[88:91],v[48:51],v[56:71]
ds_read_b128 v[44:47],v17 offset:28672
v_pk_add_f32 v[168:169],v[168:169],v[178:179]
v_pk_add_f32 v[160:161],v[160:161],v[162:163]
v_mfma_f32_32x32x16_bf16 v[56:71],a[92:95],v[52:55],v[56:71]
ds_read_b128 v[48:51],v16 offset:30720
buffer_load_dwordx4 v1,s[8:11],s63 offen offset:1024 sc1 lds
s_waitcnt lgkmcnt(5)
v_mfma_f32_32x32x16_bf16 v[56:71],a[96:99],v[24:27],v[56:71]
ds_read_b128 v[52:55],v17 offset:30720
v_pk_add_f32 v[164:165],v[164:165],v[166:167]
v_pk_add_f32 v[160:161],v[160:161],v[164:165]
v_mfma_f32_32x32x16_bf16 v[56:71],a[100:103],v[28:31],v[56:71]
ds_read_b128 v[24:27],v16 offset:32768
buffer_load_dwordx4 v1,s[8:11],s63 offen offset:2048 sc1 lds
s_waitcnt lgkmcnt(5)
v_mfma_f32_32x32x16_bf16 v[56:71],a[104:107],v[32:35],v[56:71]
ds_read_b128 v[28:31],v17 offset:32768
v_pk_add_f32 v[160:161],v[160:161],v[168:169]
v_mov_b32 v162,v160
v_mov_b32 v163,v161
v_mfma_f32_32x32x16_bf16 v[56:71],a[108:111],v[36:39],v[56:71]
ds_read_b128 v[32:35],v16 offset:34816
buffer_load_dwordx4 v1,s[8:11],s63 offen offset:3072 sc1 lds
s_add_u32 m0,s61,4096
s_waitcnt lgkmcnt(5)
v_mfma_f32_32x32x16_bf16 v[56:71],a[112:115],v[40:43],v[56:71]
ds_read_b128 v[36:39],v17 offset:34816
s_add_u32 s63,s60,4096
v_permlane32_swap_b32 v160,v162
v_permlane32_swap_b32 v161,v163
v_add_f32 v180,v160,v162
v_mfma_f32_32x32x16_bf16 v[56:71],a[116:119],v[44:47],v[56:71]
ds_read_b128 v[40:43],v16 offset:36864
buffer_load_dwordx4 v1,s[8:11],s63 offen sc1 lds
v_add_f32 v181,v161,v163
s_waitcnt lgkmcnt(5)
v_mfma_f32_32x32x16_bf16 v[56:71],a[120:123],v[48:51],v[56:71]
ds_read_b128 v[44:47],v17 offset:36864
buffer_load_dword v3,v2,s[8:11],s35 offen sc1
v_mul_f32 v180,0x3acccccd,v180
v_mfma_f32_32x32x16_bf16 v[56:71],a[124:127],v[52:55],v[56:71]
ds_read_b128 v[48:51],v16 offset:38912
buffer_load_dwordx4 v1,s[8:11],s63 offen offset:1024 sc1 lds
v_mul_f32 v181,0x3acccccd,v181
s_waitcnt lgkmcnt(5)
v_mfma_f32_32x32x16_bf16 v[56:71],a[128:131],v[24:27],v[56:71]
ds_read_b128 v[52:55],v17 offset:38912
v_fma_f32 v181,-v180,v180,v181
v_max_f32 v181,0,v181
v_cvt_pk_bf16_f32 v8,v180,v181
v_lshlrev_b32 v180,16,v8
v_mfma_f32_32x32x16_bf16 v[56:71],a[132:135],v[28:31],v[56:71]
buffer_load_dwordx4 v1,s[8:11],s63 offen offset:2048 sc1 lds
v_and_b32 v181,0xffff0000,v8
v_add_f32 v181,0x3727c5ac,v181
v_cvt_pk_bf16_f32 v8,v181,v181
s_waitcnt lgkmcnt(4)
v_mfma_f32_32x32x16_bf16 v[56:71],a[136:139],v[32:35],v[56:71]
v_lshlrev_b32 v181,16,v8
v_sqrt_f32 v181,v181
s_nop 0
v_cvt_pk_bf16_f32 v8,v181,v181
v_lshlrev_b32 v181,16,v8
v_mfma_f32_32x32x16_bf16 v[56:71],a[140:143],v[36:39],v[56:71]
buffer_load_dwordx4 v1,s[8:11],s63 offen offset:3072 sc1 lds
s_add_u32 m0,s61,8192
s_add_u32 s63,s60,8192
s_waitcnt lgkmcnt(2)
v_mfma_f32_32x32x16_bf16 v[56:71],a[144:147],v[40:43],v[56:71]
v_rcp_f32 v181,v181
v_mfma_f32_32x32x16_bf16 v[56:71],a[148:151],v[44:47],v[56:71]
buffer_load_dwordx4 v1,s[8:11],s63 offen sc1 lds
s_waitcnt lgkmcnt(0)
v_mfma_f32_32x32x16_bf16 v[56:71],a[152:155],v[48:51],v[56:71]
v_mfma_f32_32x32x16_bf16 v[56:71],a[156:159],v[52:55],v[56:71]
buffer_load_dwordx4 v1,s[8:11],s63 offen offset:1024 sc1 lds
s_mov_b32 s55,0
s_cmp_eq_u32 s37,0
s_cbranch_scc1 ep_357
s_waitcnt vmcnt(0)
v_cmp_eq_u32 vcc,0,v3
s_cmp_eq_u64 vcc,0
s_cselect_b32 s37,0,2147483648
s_cmp_lt_u32 s32,128
s_cselect_b32 s37,s37,2147483648
s_cmp_lg_u32 s37,0
s_cbranch_scc1 ep_357
s_sub_u32 s66,46080,s57
s_lshl_b32 s60,s33,6
s_add_u32 s60,s60,s34
s_mul_i32 s60,s60,46080
s_add_u32 s60,s60,s37
s_add_u32 s60,s60,212467712
s_lshl_b32 s62,s46,10
s_add_u32 s62,s62,40960
s_add_u32 m0,s66,s62
s_add_u32 s63,s60,s62
buffer_load_dwordx4 v1,s[8:11],s63 offen sc1 lds
s_add_u32 m0,s66,45056
s_add_u32 s63,s60,45056
buffer_load_dwordx4 v1,s[8:11],s63 offen sc1 lds
s_mul_i32 s61,s46,10240
s_add_u32 s60,s60,s61
s_add_u32 s61,s61,s66
s_add_u32 m0,s61,0
s_add_u32 s63,s60,0
buffer_load_dwordx4 v1,s[8:11],s63 offen sc1 lds
buffer_load_dwordx4 v1,s[8:11],s63 offen offset:1024 sc1 lds
buffer_load_dwordx4 v1,s[8:11],s63 offen offset:2048 sc1 lds
buffer_load_dwordx4 v1,s[8:11],s63 offen offset:3072 sc1 lds
s_add_u32 m0,s61,4096
s_add_u32 s63,s60,4096
buffer_load_dwordx4 v1,s[8:11],s63 offen sc1 lds
buffer_load_dwordx4 v1,s[8:11],s63 offen offset:1024 sc1 lds
buffer_load_dwordx4 v1,s[8:11],s63 offen offset:2048 sc1 lds
buffer_load_dwordx4 v1,s[8:11],s63 offen offset:3072 sc1 lds
s_add_u32 m0,s61,8192
s_add_u32 s63,s60,8192
buffer_load_dwordx4 v1,s[8:11],s63 offen sc1 lds
buffer_load_dwordx4 v1,s[8:11],s63 offen offset:1024 sc1 lds
ep_357:
s_nop 7
s_lshl_b32 s62,s51,6
s_add_u32 s62,s62,s52
s_mul_i32 s62,s62,98304
s_lshl_b32 s63,s56,11
s_add_u32 s62,s62,s63
s_add_u32 s62,s62,242778112
v_pk_fma_f32 v[56:57],v[144:145],v[180:181],v[56:57] op_sel_hi:[1,0,1] neg_lo:[0,1,0] neg_hi:[0,1,0]
v_pk_fma_f32 v[58:59],v[146:147],v[180:181],v[58:59] op_sel_hi:[1,0,1] neg_lo:[0,1,0] neg_hi:[0,1,0]
v_pk_fma_f32 v[60:61],v[148:149],v[180:181],v[60:61] op_sel_hi:[1,0,1] neg_lo:[0,1,0] neg_hi:[0,1,0]
v_pk_fma_f32 v[62:63],v[150:151],v[180:181],v[62:63] op_sel_hi:[1,0,1] neg_lo:[0,1,0] neg_hi:[0,1,0]
v_pk_fma_f32 v[64:65],v[152:153],v[180:181],v[64:65] op_sel_hi:[1,0,1] neg_lo:[0,1,0] neg_hi:[0,1,0]
v_pk_fma_f32 v[66:67],v[154:155],v[180:181],v[66:67] op_sel_hi:[1,0,1] neg_lo:[0,1,0] neg_hi:[0,1,0]
v_pk_fma_f32 v[68:69],v[156:157],v[180:181],v[68:69] op_sel_hi:[1,0,1] neg_lo:[0,1,0] neg_hi:[0,1,0]
v_pk_fma_f32 v[70:71],v[158:159],v[180:181],v[70:71] op_sel_hi:[1,0,1] neg_lo:[0,1,0] neg_hi:[0,1,0]
v_pk_mul_f32 v[56:57],v[56:57],v[180:181] op_sel:[0,1] op_sel_hi:[1,1]
v_pk_mul_f32 v[58:59],v[58:59],v[180:181] op_sel:[0,1] op_sel_hi:[1,1]
v_pk_mul_f32 v[60:61],v[60:61],v[180:181] op_sel:[0,1] op_sel_hi:[1,1]
v_pk_mul_f32 v[62:63],v[62:63],v[180:181] op_sel:[0,1] op_sel_hi:[1,1]
v_pk_mul_f32 v[64:65],v[64:65],v[180:181] op_sel:[0,1] op_sel_hi:[1,1]
v_pk_mul_f32 v[66:67],v[66:67],v[180:181] op_sel:[0,1] op_sel_hi:[1,1]
v_pk_mul_f32 v[68:69],v[68:69],v[180:181] op_sel:[0,1] op_sel_hi:[1,1]
v_pk_mul_f32 v[70:71],v[70:71],v[180:181] op_sel:[0,1] op_sel_hi:[1,1]
v_cvt_pk_bf16_f32 v140,v56,v57
v_lshlrev_b32 v56,16,v140
v_and_b32 v57,0xffff0000,v140
v_cvt_pk_bf16_f32 v140,v58,v59
v_lshlrev_b32 v58,16,v140
v_and_b32 v59,0xffff0000,v140
v_cvt_pk_bf16_f32 v140,v60,v61
v_lshlrev_b32 v60,16,v140
v_and_b32 v61,0xffff0000,v140
v_cvt_pk_bf16_f32 v140,v62,v63
v_lshlrev_b32 v62,16,v140
v_and_b32 v63,0xffff0000,v140
v_cvt_pk_bf16_f32 v140,v64,v65
v_lshlrev_b32 v64,16,v140
v_and_b32 v65,0xffff0000,v140
v_cvt_pk_bf16_f32 v140,v66,v67
v_lshlrev_b32 v66,16,v140
v_and_b32 v67,0xffff0000,v140
v_cvt_pk_bf16_f32 v140,v68,v69
v_lshlrev_b32 v68,16,v140
v_and_b32 v69,0xffff0000,v140
v_cvt_pk_bf16_f32 v140,v70,v71
v_lshlrev_b32 v70,16,v140
v_and_b32 v71,0xffff0000,v140
v_pk_mul_f32 v[124:125],v[56:57],v[56:57]
v_pk_mul_f32 v[126:127],v[58:59],v[58:59]
v_pk_mul_f32 v[128:129],v[60:61],v[60:61]
v_pk_mul_f32 v[130:131],v[62:63],v[62:63]
v_pk_mul_f32 v[132:133],v[64:65],v[64:65]
v_pk_mul_f32 v[134:135],v[66:67],v[66:67]
v_pk_mul_f32 v[136:137],v[68:69],v[68:69]
v_pk_mul_f32 v[138:139],v[70:71],v[70:71]
v_pk_fma_f32 v[124:125],v[124:125],v[112:113],v[112:113] op_sel:[0,1,0] op_sel_hi:[1,1,0]
v_pk_fma_f32 v[126:127],v[126:127],v[112:113],v[112:113] op_sel:[0,1,0] op_sel_hi:[1,1,0]
v_pk_fma_f32 v[128:129],v[128:129],v[112:113],v[112:113] op_sel:[0,1,0] op_sel_hi:[1,1,0]
v_pk_fma_f32 v[130:131],v[130:131],v[112:113],v[112:113] op_sel:[0,1,0] op_sel_hi:[1,1,0]
v_pk_fma_f32 v[132:133],v[132:133],v[112:113],v[112:113] op_sel:[0,1,0] op_sel_hi:[1,1,0]
v_pk_fma_f32 v[134:135],v[134:135],v[112:113],v[112:113] op_sel:[0,1,0] op_sel_hi:[1,1,0]
v_pk_fma_f32 v[136:137],v[136:137],v[112:113],v[112:113] op_sel:[0,1,0] op_sel_hi:[1,1,0]
v_pk_fma_f32 v[138:139],v[138:139],v[112:113],v[112:113] op_sel:[0,1,0] op_sel_hi:[1,1,0]
v_pk_mul_f32 v[124:125],v[124:125],v[56:57]
v_pk_mul_f32 v[126:127],v[126:127],v[58:59]
v_pk_mul_f32 v[128:129],v[128:129],v[60:61]
v_pk_mul_f32 v[130:131],v[130:131],v[62:63]
v_pk_mul_f32 v[132:133],v[132:133],v[64:65]
v_pk_mul_f32 v[134:135],v[134:135],v[66:67]
v_pk_mul_f32 v[136:137],v[136:137],v[68:69]
v_pk_mul_f32 v[138:139],v[138:139],v[70:71]
v_exp_f32 v124,v124
v_exp_f32 v125,v125
v_exp_f32 v126,v126
v_exp_f32 v127,v127
v_exp_f32 v128,v128
v_exp_f32 v129,v129
v_exp_f32 v130,v130
v_exp_f32 v131,v131
v_exp_f32 v132,v132
v_exp_f32 v133,v133
v_exp_f32 v134,v134
v_exp_f32 v135,v135
v_exp_f32 v136,v136
v_exp_f32 v137,v137
v_exp_f32 v138,v138
v_exp_f32 v139,v139
v_pk_add_f32 v[124:125],v[124:125],1.0 op_sel_hi:[1,0]
v_pk_add_f32 v[126:127],v[126:127],1.0 op_sel_hi:[1,0]
v_pk_add_f32 v[128:129],v[128:129],1.0 op_sel_hi:[1,0]
v_pk_add_f32 v[130:131],v[130:131],1.0 op_sel_hi:[1,0]
v_pk_add_f32 v[132:133],v[132:133],1.0 op_sel_hi:[1,0]
v_pk_add_f32 v[134:135],v[134:135],1.0 op_sel_hi:[1,0]
v_pk_add_f32 v[136:137],v[136:137],1.0 op_sel_hi:[1,0]
v_pk_add_f32 v[138:139],v[138:139],1.0 op_sel_hi:[1,0]
v_rcp_f32 v124,v124
v_rcp_f32 v125,v125
v_rcp_f32 v126,v126
v_rcp_f32 v127,v127
v_rcp_f32 v128,v128
v_rcp_f32 v129,v129
v_rcp_f32 v130,v130
v_rcp_f32 v131,v131
v_rcp_f32 v132,v132
v_rcp_f32 v133,v133
v_rcp_f32 v134,v134
v_rcp_f32 v135,v135
v_rcp_f32 v136,v136
v_rcp_f32 v137,v137
v_rcp_f32 v138,v138
v_rcp_f32 v139,v139
v_pk_mul_f32 v[56:57],v[56:57],v[124:125]
v_pk_mul_f32 v[58:59],v[58:59],v[126:127]
v_pk_mul_f32 v[60:61],v[60:61],v[128:129]
v_pk_mul_f32 v[62:63],v[62:63],v[130:131]
v_pk_mul_f32 v[64:65],v[64:65],v[132:133]
v_pk_mul_f32 v[66:67],v[66:67],v[134:135]
v_pk_mul_f32 v[68:69],v[68:69],v[136:137]
v_pk_mul_f32 v[70:71],v[70:71],v[138:139]
v_cvt_pk_bf16_f32 v116,v56,v57
v_cvt_pk_bf16_f32 v117,v58,v59
v_cvt_pk_bf16_f32 v118,v60,v61
v_cvt_pk_bf16_f32 v119,v62,v63
v_cvt_pk_bf16_f32 v120,v64,v65
v_cvt_pk_bf16_f32 v121,v66,v67
v_cvt_pk_bf16_f32 v122,v68,v69
v_cvt_pk_bf16_f32 v123,v70,v71
s_cmp_lg_u32 s49,0
s_cbranch_scc0 ls_358
buffer_store_dwordx4 v[116:119],v20,s[8:11],s62 offen sc1
buffer_store_dwordx4 v[120:123],v21,s[8:11],s62 offen sc1
s_branch ls_359
ls_358:
buffer_store_dwordx4 v[116:119],v20,s[8:11],s62 offen
buffer_store_dwordx4 v[120:123],v21,s[8:11],s62 offen
ls_359:
s_lshl_b32 s82,s51,6
s_add_u32 s82,s82,s52
s_lshl_b32 s82,s82,9
s_add_u32 s82,s82,589824
s_lshl_b32 s61,s56,2
s_add_u32 s82,s82,s61
s_mov_b32 s59,s82
s_cmp_eq_u32 s37,0
s_cbranch_scc1 W3_NEXT
s_waitcnt vmcnt(0)
s_mov_b64 exec,1
s_cmp_lg_u32 s49,0
s_cbranch_scc0 ls_360
buffer_store_dword v5,v1,s[8:11],s59 offen sc1
s_branch ls_361
ls_360:
buffer_store_dword v5,v1,s[8:11],s59 offen
ls_361:
s_mov_b64 exec,-1
s_mov_b32 s59,2147483648
s_cmp_lt_u32 s32,128
s_cbranch_scc1 W3_COLD
W3_END:
s_endpgm
ROLE_W4:
v_lshlrev_b32 v1,4,v0
v_mov_b32 v5,1
s_lshl_b32 s56,s48,2
s_add_u32 s56,s56,s46
v_bfe_u32 v6,v0,2,2
v_lshrrev_b32 v7,4,v0
v_add_u32 v7,v6,v7
v_and_b32 v7,3,v7
v_and_b32 v15,3,v0
v_lshlrev_b32 v15,4,v15
v_lshl_add_u32 v15,v7,6,v15
v_lshl_add_u32 v15,v6,8,v15
v_lshrrev_b32 v6,5,v0
v_bfe_u32 v7,v0,4,1
v_lshlrev_b32 v208,10,v7
v_lshl_add_u32 v208,v6,8,v208
v_and_b32 v6,15,v0
v_lshl_add_u32 v208,v6,4,v208
v_lshrrev_b32 v6,5,v0
v_add_u32 v6,2,v6
v_bfe_u32 v7,v0,4,1
v_lshlrev_b32 v209,10,v7
v_lshl_add_u32 v209,v6,8,v209
v_and_b32 v6,15,v0
v_lshl_add_u32 v209,v6,4,v209
v_min_u32 v2,11,v0
s_mul_i32 s60,s46,12
v_add_u32 v2,s60,v2
v_lshlrev_b32 v2,2,v2
s_and_b32 s60,s46,1
s_lshl_b32 s68,s48,1
s_add_u32 s68,s68,s60
s_lshr_b32 s69,s46,1
s_mul_i32 s71,s46,24576
s_mul_i32 s58,s46,491520
s_lshl_b32 s61,s48,7
s_add_u32 s58,s58,s61
s_add_u32 s71,s71,242778112
v_and_b32 v6,15,v0
v_lshlrev_b32 v204,3,v6
s_lshl_b32 s60,s69,4
v_add_u32 v6,s60,v6
v_mul_u32_u24 v205,1280,v6
v_lshrrev_b32 v6,4,v0
v_lshl_add_u32 v205,v6,3,v205
s_lshl_b32 s60,s68,6
v_add_u32 v205,s60,v205
s_mov_b32 s76,s40
s_mov_b32 s77,s41
s_mov_b32 s78,2621440
s_mov_b32 s79,0x20000
s_lshl_b32 s70,s68,1
s_add_u32 s70,s70,s69
s_lshl_b32 s70,s70,10
v_bfe_u32 v6,v0,4,1
v_lshlrev_b32 v206,14,v6
v_lshrrev_b32 v6,5,v0
v_lshl_add_u32 v206,v6,8,v206
v_and_b32 v6,15,v0
v_lshl_add_u32 v206,v6,4,v206
s_lshl_b32 s60,s46,11
v_add_u32 v206,s60,v206
s_lshl_b32 s60,s46,13
v_add_u32 v207,s60,v1
s_waitcnt vmcnt(0)
s_barrier
s_cmp_lg_u32 s46,0
s_cbranch_scc1 arr_362
v_mov_b32 v6,1
s_lshl_b32 s3,s49,2
v_mov_b32 v7,s3
s_mov_b64 exec,1
buffer_atomic_add v6,v7,s[12:15],0 offen sc1
s_mov_b64 exec,-1
arr_362:
s_mul_i32 s63,s46,40960
s_mov_b32 s4,s38
s_mov_b32 s5,s39
s_mov_b32 s6,1966080
s_mov_b32 s7,0x20000
v_lshrrev_b32 v9,3,v0
s_mov_b32 s64,1280
v_mul_lo_u32 v9,v9,s64
v_and_b32 v10,7,v0
v_lshl_add_u32 v6,v10,4,v9
s_add_u32 m0,s63,0
s_add_u32 s65,s58,0
buffer_load_dwordx4 v6,s[4:7],s65 offen lds
s_add_u32 m0,s63,1024
s_add_u32 s65,s58,10240
buffer_load_dwordx4 v6,s[4:7],s65 offen lds
s_add_u32 m0,s63,2048
s_add_u32 s65,s58,20480
buffer_load_dwordx4 v6,s[4:7],s65 offen lds
s_add_u32 m0,s63,3072
s_add_u32 s65,s58,30720
buffer_load_dwordx4 v6,s[4:7],s65 offen lds
s_add_u32 m0,s63,4096
s_add_u32 s65,s58,40960
buffer_load_dwordx4 v6,s[4:7],s65 offen lds
s_add_u32 m0,s63,5120
s_add_u32 s65,s58,51200
buffer_load_dwordx4 v6,s[4:7],s65 offen lds
s_add_u32 m0,s63,6144
s_add_u32 s65,s58,61440
buffer_load_dwordx4 v6,s[4:7],s65 offen lds
s_add_u32 m0,s63,7168
s_add_u32 s65,s58,71680
buffer_load_dwordx4 v6,s[4:7],s65 offen lds
s_add_u32 m0,s63,8192
s_add_u32 s65,s58,81920
buffer_load_dwordx4 v6,s[4:7],s65 offen lds
s_add_u32 m0,s63,9216
s_add_u32 s65,s58,92160
buffer_load_dwordx4 v6,s[4:7],s65 offen lds
s_add_u32 m0,s63,10240
s_add_u32 s65,s58,102400
buffer_load_dwordx4 v6,s[4:7],s65 offen lds
s_add_u32 m0,s63,11264
s_add_u32 s65,s58,112640
buffer_load_dwordx4 v6,s[4:7],s65 offen lds
s_add_u32 m0,s63,12288
s_add_u32 s65,s58,122880
buffer_load_dwordx4 v6,s[4:7],s65 offen lds
s_add_u32 m0,s63,13312
s_add_u32 s65,s58,133120
buffer_load_dwordx4 v6,s[4:7],s65 offen lds
s_add_u32 m0,s63,14336
s_add_u32 s65,s58,143360
buffer_load_dwordx4 v6,s[4:7],s65 offen lds
s_add_u32 m0,s63,15360
s_add_u32 s65,s58,153600
buffer_load_dwordx4 v6,s[4:7],s65 offen lds
s_add_u32 m0,s63,16384
s_add_u32 s65,s58,163840
buffer_load_dwordx4 v6,s[4:7],s65 offen lds
s_add_u32 m0,s63,17408
s_add_u32 s65,s58,174080
buffer_load_dwordx4 v6,s[4:7],s65 offen lds
s_add_u32 m0,s63,18432
s_add_u32 s65,s58,184320
buffer_load_dwordx4 v6,s[4:7],s65 offen lds
s_add_u32 m0,s63,19456
s_add_u32 s65,s58,194560
buffer_load_dwordx4 v6,s[4:7],s65 offen lds
s_add_u32 m0,s63,20480
s_add_u32 s65,s58,204800
buffer_load_dwordx4 v6,s[4:7],s65 offen lds
s_add_u32 m0,s63,21504
s_add_u32 s65,s58,215040
buffer_load_dwordx4 v6,s[4:7],s65 offen lds
s_add_u32 m0,s63,22528
s_add_u32 s65,s58,225280
buffer_load_dwordx4 v6,s[4:7],s65 offen lds
s_add_u32 m0,s63,23552
s_add_u32 s65,s58,235520
buffer_load_dwordx4 v6,s[4:7],s65 offen lds
s_add_u32 m0,s63,24576
s_add_u32 s65,s58,245760
buffer_load_dwordx4 v6,s[4:7],s65 offen lds
s_add_u32 m0,s63,25600
s_add_u32 s65,s58,256000
buffer_load_dwordx4 v6,s[4:7],s65 offen lds
s_add_u32 m0,s63,26624
s_add_u32 s65,s58,266240
buffer_load_dwordx4 v6,s[4:7],s65 offen lds
s_add_u32 m0,s63,27648
s_add_u32 s65,s58,276480
buffer_load_dwordx4 v6,s[4:7],s65 offen lds
s_add_u32 m0,s63,28672
s_add_u32 s65,s58,286720
buffer_load_dwordx4 v6,s[4:7],s65 offen lds
s_add_u32 m0,s63,29696
s_add_u32 s65,s58,296960
buffer_load_dwordx4 v6,s[4:7],s65 offen lds
s_add_u32 m0,s63,30720
s_add_u32 s65,s58,307200
buffer_load_dwordx4 v6,s[4:7],s65 offen lds
s_add_u32 m0,s63,31744
s_add_u32 s65,s58,317440
buffer_load_dwordx4 v6,s[4:7],s65 offen lds
s_add_u32 m0,s63,32768
s_add_u32 s65,s58,327680
buffer_load_dwordx4 v6,s[4:7],s65 offen lds
s_add_u32 m0,s63,33792
s_add_u32 s65,s58,337920
buffer_load_dwordx4 v6,s[4:7],s65 offen lds
s_add_u32 m0,s63,34816
s_add_u32 s65,s58,348160
buffer_load_dwordx4 v6,s[4:7],s65 offen lds
s_add_u32 m0,s63,35840
s_add_u32 s65,s58,358400
buffer_load_dwordx4 v6,s[4:7],s65 offen lds
s_add_u32 m0,s63,36864
s_add_u32 s65,s58,368640
buffer_load_dwordx4 v6,s[4:7],s65 offen lds
s_add_u32 m0,s63,37888
s_add_u32 s65,s58,378880
buffer_load_dwordx4 v6,s[4:7],s65 offen lds
s_add_u32 m0,s63,38912
s_add_u32 s65,s58,389120
buffer_load_dwordx4 v6,s[4:7],s65 offen lds
s_add_u32 m0,s63,39936
s_add_u32 s65,s58,399360
buffer_load_dwordx4 v6,s[4:7],s65 offen lds
s_waitcnt vmcnt(20)
v_bfe_u32 v9,v0,2,2
v_lshrrev_b32 v10,5,v0
v_lshl_add_u32 v9,v10,2,v9
v_mul_u32_u24 v9,128,v9
v_and_b32 v10,1,v0
v_lshl_add_u32 v9,v10,3,v9
v_bfe_u32 v10,v0,1,1
v_lshl_add_u32 v9,v10,5,v9
v_bfe_u32 v10,v0,4,1
v_lshl_add_u32 v9,v10,4,v9
v_add_u32 v7,s63,v9
ds_read_b64_tr_b16 a[0:1],v7 offset:0
ds_read_b64_tr_b16 a[2:3],v7 offset:2048
ds_read_b64_tr_b16 a[4:5],v7 offset:1024
ds_read_b64_tr_b16 a[6:7],v7 offset:3072
ds_read_b64_tr_b16 a[96:97],v7 offset:64
ds_read_b64_tr_b16 a[98:99],v7 offset:2112
ds_read_b64_tr_b16 a[100:101],v7 offset:1088
ds_read_b64_tr_b16 a[102:103],v7 offset:3136
ds_read_b64_tr_b16 a[8:9],v7 offset:4096
ds_read_b64_tr_b16 a[10:11],v7 offset:6144
ds_read_b64_tr_b16 a[12:13],v7 offset:5120
ds_read_b64_tr_b16 a[14:15],v7 offset:7168
s_waitcnt lgkmcnt(4)
ds_read_b64_tr_b16 a[104:105],v7 offset:4160
ds_read_b64_tr_b16 a[106:107],v7 offset:6208
ds_read_b64_tr_b16 a[108:109],v7 offset:5184
ds_read_b64_tr_b16 a[110:111],v7 offset:7232
ds_read_b64_tr_b16 a[16:17],v7 offset:8192
ds_read_b64_tr_b16 a[18:19],v7 offset:10240
ds_read_b64_tr_b16 a[20:21],v7 offset:9216
ds_read_b64_tr_b16 a[22:23],v7 offset:11264
ds_read_b64_tr_b16 a[112:113],v7 offset:8256
ds_read_b64_tr_b16 a[114:115],v7 offset:10304
ds_read_b64_tr_b16 a[116:117],v7 offset:9280
ds_read_b64_tr_b16 a[118:119],v7 offset:11328
s_waitcnt lgkmcnt(4)
ds_read_b64_tr_b16 a[24:25],v7 offset:12288
ds_read_b64_tr_b16 a[26:27],v7 offset:14336
ds_read_b64_tr_b16 a[28:29],v7 offset:13312
ds_read_b64_tr_b16 a[30:31],v7 offset:15360
ds_read_b64_tr_b16 a[120:121],v7 offset:12352
ds_read_b64_tr_b16 a[122:123],v7 offset:14400
ds_read_b64_tr_b16 a[124:125],v7 offset:13376
ds_read_b64_tr_b16 a[126:127],v7 offset:15424
ds_read_b64_tr_b16 a[32:33],v7 offset:16384
ds_read_b64_tr_b16 a[34:35],v7 offset:18432
ds_read_b64_tr_b16 a[36:37],v7 offset:17408
ds_read_b64_tr_b16 a[38:39],v7 offset:19456
s_waitcnt lgkmcnt(4)
ds_read_b64_tr_b16 a[128:129],v7 offset:16448
ds_read_b64_tr_b16 a[130:131],v7 offset:18496
ds_read_b64_tr_b16 a[132:133],v7 offset:17472
ds_read_b64_tr_b16 a[134:135],v7 offset:19520
s_waitcnt lgkmcnt(0)
s_add_u32 m0,s63,0
s_add_u32 s65,s58,409600
buffer_load_dwordx4 v6,s[4:7],s65 offen lds
s_add_u32 m0,s63,1024
s_add_u32 s65,s58,419840
buffer_load_dwordx4 v6,s[4:7],s65 offen lds
s_add_u32 m0,s63,2048
s_add_u32 s65,s58,430080
buffer_load_dwordx4 v6,s[4:7],s65 offen lds
s_add_u32 m0,s63,3072
s_add_u32 s65,s58,440320
buffer_load_dwordx4 v6,s[4:7],s65 offen lds
s_add_u32 m0,s63,4096
s_add_u32 s65,s58,450560
buffer_load_dwordx4 v6,s[4:7],s65 offen lds
s_add_u32 m0,s63,5120
s_add_u32 s65,s58,460800
buffer_load_dwordx4 v6,s[4:7],s65 offen lds
s_add_u32 m0,s63,6144
s_add_u32 s65,s58,471040
buffer_load_dwordx4 v6,s[4:7],s65 offen lds
s_add_u32 m0,s63,7168
s_add_u32 s65,s58,481280
buffer_load_dwordx4 v6,s[4:7],s65 offen lds
s_waitcnt vmcnt(8)
v_bfe_u32 v9,v0,2,2
v_lshrrev_b32 v10,5,v0
v_lshl_add_u32 v9,v10,2,v9
v_mul_u32_u24 v9,128,v9
v_and_b32 v10,1,v0
v_lshl_add_u32 v9,v10,3,v9
v_bfe_u32 v10,v0,1,1
v_lshl_add_u32 v9,v10,5,v9
v_bfe_u32 v10,v0,4,1
v_lshl_add_u32 v9,v10,4,v9
v_add_u32 v7,s63,v9
ds_read_b64_tr_b16 a[40:41],v7 offset:20480
ds_read_b64_tr_b16 a[42:43],v7 offset:22528
ds_read_b64_tr_b16 a[44:45],v7 offset:21504
ds_read_b64_tr_b16 a[46:47],v7 offset:23552
ds_read_b64_tr_b16 a[136:137],v7 offset:20544
ds_read_b64_tr_b16 a[138:139],v7 offset:22592
ds_read_b64_tr_b16 a[140:141],v7 offset:21568
ds_read_b64_tr_b16 a[142:143],v7 offset:23616
ds_read_b64_tr_b16 a[48:49],v7 offset:24576
ds_read_b64_tr_b16 a[50:51],v7 offset:26624
ds_read_b64_tr_b16 a[52:53],v7 offset:25600
ds_read_b64_tr_b16 a[54:55],v7 offset:27648
s_waitcnt lgkmcnt(4)
ds_read_b64_tr_b16 a[144:145],v7 offset:24640
ds_read_b64_tr_b16 a[146:147],v7 offset:26688
ds_read_b64_tr_b16 a[148:149],v7 offset:25664
ds_read_b64_tr_b16 a[150:151],v7 offset:27712
ds_read_b64_tr_b16 a[56:57],v7 offset:28672
ds_read_b64_tr_b16 a[58:59],v7 offset:30720
ds_read_b64_tr_b16 a[60:61],v7 offset:29696
ds_read_b64_tr_b16 a[62:63],v7 offset:31744
ds_read_b64_tr_b16 a[152:153],v7 offset:28736
ds_read_b64_tr_b16 a[154:155],v7 offset:30784
ds_read_b64_tr_b16 a[156:157],v7 offset:29760
ds_read_b64_tr_b16 a[158:159],v7 offset:31808
s_waitcnt lgkmcnt(4)
ds_read_b64_tr_b16 a[64:65],v7 offset:32768
ds_read_b64_tr_b16 a[66:67],v7 offset:34816
ds_read_b64_tr_b16 a[68:69],v7 offset:33792
ds_read_b64_tr_b16 a[70:71],v7 offset:35840
ds_read_b64_tr_b16 a[160:161],v7 offset:32832
ds_read_b64_tr_b16 a[162:163],v7 offset:34880
ds_read_b64_tr_b16 a[164:165],v7 offset:33856
ds_read_b64_tr_b16 a[166:167],v7 offset:35904
ds_read_b64_tr_b16 a[72:73],v7 offset:36864
ds_read_b64_tr_b16 a[74:75],v7 offset:38912
ds_read_b64_tr_b16 a[76:77],v7 offset:37888
ds_read_b64_tr_b16 a[78:79],v7 offset:39936
s_waitcnt lgkmcnt(4)
ds_read_b64_tr_b16 a[168:169],v7 offset:36928
ds_read_b64_tr_b16 a[170:171],v7 offset:38976
ds_read_b64_tr_b16 a[172:173],v7 offset:37952
ds_read_b64_tr_b16 a[174:175],v7 offset:40000
s_waitcnt lgkmcnt(0)
s_waitcnt vmcnt(0)
v_bfe_u32 v9,v0,2,2
v_lshrrev_b32 v10,5,v0
v_lshl_add_u32 v9,v10,2,v9
v_mul_u32_u24 v9,128,v9
v_and_b32 v10,1,v0
v_lshl_add_u32 v9,v10,3,v9
v_bfe_u32 v10,v0,1,1
v_lshl_add_u32 v9,v10,5,v9
v_bfe_u32 v10,v0,4,1
v_lshl_add_u32 v9,v10,4,v9
v_add_u32 v7,s63,v9
ds_read_b64_tr_b16 a[80:81],v7 offset:0
ds_read_b64_tr_b16 a[82:83],v7 offset:2048
ds_read_b64_tr_b16 a[84:85],v7 offset:1024
ds_read_b64_tr_b16 a[86:87],v7 offset:3072
ds_read_b64_tr_b16 a[176:177],v7 offset:64
ds_read_b64_tr_b16 a[178:179],v7 offset:2112
ds_read_b64_tr_b16 a[180:181],v7 offset:1088
ds_read_b64_tr_b16 a[182:183],v7 offset:3136
ds_read_b64_tr_b16 a[88:89],v7 offset:4096
ds_read_b64_tr_b16 a[90:91],v7 offset:6144
ds_read_b64_tr_b16 a[92:93],v7 offset:5120
ds_read_b64_tr_b16 a[94:95],v7 offset:7168
s_waitcnt lgkmcnt(4)
ds_read_b64_tr_b16 a[184:185],v7 offset:4160
ds_read_b64_tr_b16 a[186:187],v7 offset:6208
ds_read_b64_tr_b16 a[188:189],v7 offset:5184
ds_read_b64_tr_b16 a[190:191],v7 offset:7232
s_waitcnt lgkmcnt(0)
s_barrier
s_lshl_b32 s3,s49,2
v_mov_b32 v7,s3
s_nop 1
ibw_363:
buffer_load_dword v6,v7,s[12:15],0 offen sc1
s_waitcnt vmcnt(0)
v_cmp_ne_u32 vcc,256,v6
s_nop 0
s_cbranch_vccz ok_364
s_sleep 8
s_sub_u32 s47,s47,1
s_cbranch_scc1 ABORT
s_branch ibw_363
ok_364:
s_cmp_lg_u32 s49,0
s_cbranch_scc1 ibok_365
v_and_b32 v7,7,v0
v_lshlrev_b32 v7,2,v7
buffer_load_dword v6,v7,s[12:15],0 offen offset:32 sc1
s_waitcnt vmcnt(0)
v_cmp_ne_u32 vcc,32,v6
s_nop 0
s_cbranch_vccz ibok_365
s_barrier
s_mov_b32 s49,1
s_mov_b32 s3,s2
s_load_dwordx16 s[16:31],s[0:1],0
s_load_dwordx8 s[32:39],s[0:1],64
s_waitcnt lgkmcnt(0)
s_branch DISPATCH
ibok_365:
s_mov_b32 s83,s100
s_mov_b32 s32,0
s_mov_b32 s59,2147483648
s_min_u32 s62,s32,127
s_sub_u32 s60,s62,14
s_lshr_b32 s34,s60,1
s_and_b32 s33,s60,1
s_cmp_eq_u32 s33,0
s_cselect_b32 s61,14,0
s_add_u32 s34,s34,s61
s_sub_u32 s61,s60,50
s_cmp_ge_u32 s60,100
s_cselect_b32 s34,s61,s34
s_cselect_b32 s33,1,s33
s_cmp_lt_u32 s62,14
s_cselect_b32 s34,s62,s34
s_cselect_b32 s33,0,s33
s_lshl_b32 s35,s33,6
s_add_u32 s35,s35,s34
s_lshl_b32 s35,s35,9
s_add_u32 s35,s35,589824
s_lshl_b32 s60,s33,6
s_add_u32 s60,s60,s34
s_mul_i32 s73,s60,98304
s_add_u32 s73,s73,s71
W4_COLD:
fb_366:
buffer_load_dword v3,v2,s[8:11],s35 offen sc1
s_waitcnt vmcnt(0)
v_cmp_eq_u32 vcc,0,v3
s_nop 0
s_cbranch_vccz ok_367
s_sleep 2
s_sub_u32 s47,s47,1
s_cbranch_scc1 ABORT
s_branch fb_366
ok_367:
s_add_u32 s63,s73,0
buffer_load_dwordx4 v[16:19],v208,s[8:11],s63 offen sc1
s_nop 7
buffer_load_dwordx4 v[20:23],v209,s[8:11],s63 offen sc1
s_nop 7
buffer_load_dwordx4 v[24:27],v208,s[8:11],s63 offen offset:2048 sc1
s_nop 7
buffer_load_dwordx4 v[28:31],v209,s[8:11],s63 offen offset:2048 sc1
s_nop 7
s_add_u32 s63,s73,4096
buffer_load_dwordx4 v[32:35],v208,s[8:11],s63 offen sc1
s_nop 7
buffer_load_dwordx4 v[36:39],v209,s[8:11],s63 offen sc1
s_nop 7
buffer_load_dwordx4 v[40:43],v208,s[8:11],s63 offen offset:2048 sc1
s_nop 7
buffer_load_dwordx4 v[44:47],v209,s[8:11],s63 offen offset:2048 sc1
s_nop 7
s_add_u32 s63,s73,8192
buffer_load_dwordx4 v[48:51],v208,s[8:11],s63 offen sc1
s_nop 7
buffer_load_dwordx4 v[52:55],v209,s[8:11],s63 offen sc1
W4_NEXT:
s_mov_b32 s51,s33
s_mov_b32 s52,s34
s_mov_b32 s72,s73
s_add_u32 s32,s32,1
s_waitcnt vmcnt(9)
v_mfma_f32_32x32x16_bf16 v[112:127],a[0:3],v[16:19],0
s_add_u32 s63,s72,8192
buffer_load_dwordx4 v[56:59],v208,s[8:11],s63 offen offset:2048 sc1
s_min_u32 s62,s32,127
s_sub_u32 s60,s62,14
s_lshr_b32 s34,s60,1
v_mfma_f32_32x32x16_bf16 v[128:143],a[96:99],v[16:19],0
s_and_b32 s33,s60,1
s_cmp_eq_u32 s33,0
s_cselect_b32 s61,14,0
s_add_u32 s34,s34,s61
s_sub_u32 s61,s60,50
v_xor_b32 v206,0x8000,v206
s_waitcnt vmcnt(9)
v_mfma_f32_32x32x16_bf16 v[112:127],a[4:7],v[20:23],v[112:127]
buffer_load_dwordx4 v[60:63],v209,s[8:11],s63 offen offset:2048 sc1
s_cmp_ge_u32 s60,100
s_cselect_b32 s34,s61,s34
s_cselect_b32 s33,1,s33
v_xor_b32 v207,0x8000,v207
v_mfma_f32_32x32x16_bf16 v[128:143],a[100:103],v[20:23],v[128:143]
s_cmp_lt_u32 s62,14
s_cselect_b32 s34,s62,s34
s_cselect_b32 s33,0,s33
s_lshl_b32 s35,s33,6
s_add_u32 s35,s35,s34
s_lshl_b32 s35,s35,9
s_waitcnt vmcnt(9)
v_mfma_f32_32x32x16_bf16 v[112:127],a[8:11],v[24:27],v[112:127]
s_add_u32 s63,s72,12288
buffer_load_dwordx4 v[64:67],v208,s[8:11],s63 offen sc1
s_add_u32 s35,s35,589824
s_lshl_b32 s60,s33,6
s_add_u32 s60,s60,s34
v_mfma_f32_32x32x16_bf16 v[128:143],a[104:107],v[24:27],v[128:143]
s_mul_i32 s73,s60,98304
s_add_u32 s73,s73,s71
buffer_load_dword v3,v2,s[8:11],s35 offen sc1
s_lshl_b32 s64,s51,6
s_add_u32 s64,s64,s52
s_waitcnt vmcnt(10)
v_mfma_f32_32x32x16_bf16 v[112:127],a[12:15],v[28:31],v[112:127]
buffer_load_dwordx4 v[68:71],v209,s[8:11],s63 offen sc1
s_mul_i32 s65,s64,46080
s_add_u32 s65,s65,s70
s_add_u32 s65,s65,212467712
v_mfma_f32_32x32x16_bf16 v[128:143],a[108:111],v[28:31],v[128:143]
buffer_load_dwordx4 v[176:179],v1,s[8:11],s65 offen sc1
s_mul_i32 s65,s64,40960
s_add_u32 s65,s65,s70
s_add_u32 s65,s65,218365952
s_waitcnt vmcnt(11)
v_mfma_f32_32x32x16_bf16 v[112:127],a[16:19],v[32:35],v[112:127]
buffer_load_dwordx4 v[72:75],v208,s[8:11],s63 offen offset:2048 sc1
v_mfma_f32_32x32x16_bf16 v[128:143],a[112:115],v[32:35],v[128:143]
s_waitcnt vmcnt(11)
v_mfma_f32_32x32x16_bf16 v[112:127],a[20:23],v[36:39],v[112:127]
buffer_load_dwordx4 v[76:79],v209,s[8:11],s63 offen offset:2048 sc1
v_mfma_f32_32x32x16_bf16 v[128:143],a[116:119],v[36:39],v[128:143]
s_waitcnt vmcnt(11)
v_mfma_f32_32x32x16_bf16 v[112:127],a[24:27],v[40:43],v[112:127]
s_add_u32 s63,s72,16384
buffer_load_dwordx4 v[80:83],v208,s[8:11],s63 offen sc1
v_mfma_f32_32x32x16_bf16 v[128:143],a[120:123],v[40:43],v[128:143]
s_waitcnt vmcnt(11)
v_mfma_f32_32x32x16_bf16 v[112:127],a[28:31],v[44:47],v[112:127]
buffer_load_dwordx4 v[84:87],v209,s[8:11],s63 offen sc1
v_mfma_f32_32x32x16_bf16 v[128:143],a[124:127],v[44:47],v[128:143]
s_waitcnt vmcnt(11)
v_mfma_f32_32x32x16_bf16 v[112:127],a[32:35],v[48:51],v[112:127]
buffer_load_dwordx4 v[88:91],v208,s[8:11],s63 offen offset:2048 sc1
v_mfma_f32_32x32x16_bf16 v[128:143],a[128:131],v[48:51],v[128:143]
s_waitcnt vmcnt(11)
v_mfma_f32_32x32x16_bf16 v[112:127],a[36:39],v[52:55],v[112:127]
buffer_load_dwordx4 v[92:95],v209,s[8:11],s63 offen offset:2048 sc1
v_mfma_f32_32x32x16_bf16 v[128:143],a[132:135],v[52:55],v[128:143]
s_waitcnt vmcnt(11)
v_mfma_f32_32x32x16_bf16 v[112:127],a[40:43],v[56:59],v[112:127]
s_add_u32 s63,s72,20480
buffer_load_dwordx4 v[96:99],v208,s[8:11],s63 offen sc1
v_mfma_f32_32x32x16_bf16 v[128:143],a[136:139],v[56:59],v[128:143]
s_waitcnt vmcnt(11)
v_mfma_f32_32x32x16_bf16 v[112:127],a[44:47],v[60:63],v[112:127]
buffer_load_dwordx4 v[100:103],v209,s[8:11],s63 offen sc1
v_mfma_f32_32x32x16_bf16 v[128:143],a[140:143],v[60:63],v[128:143]
s_waitcnt vmcnt(11)
v_mfma_f32_32x32x16_bf16 v[112:127],a[48:51],v[64:67],v[112:127]
buffer_load_dwordx4 v[104:107],v208,s[8:11],s63 offen offset:2048 sc1
v_mfma_f32_32x32x16_bf16 v[128:143],a[144:147],v[64:67],v[128:143]
s_waitcnt vmcnt(11)
v_cmp_eq_u32 vcc,0,v3
s_cmp_eq_u64 vcc,0
s_cselect_b32 s37,0,2147483648
s_cmp_lt_u32 s32,128
s_cselect_b32 s37,s37,2147483648
s_waitcnt vmcnt(10)
v_mfma_f32_32x32x16_bf16 v[112:127],a[52:55],v[68:71],v[112:127]
buffer_load_dwordx4 v[108:111],v209,s[8:11],s63 offen offset:2048 sc1
s_add_u32 s67,s73,s37
v_mfma_f32_32x32x16_bf16 v[128:143],a[148:151],v[68:71],v[128:143]
s_mov_b64 exec,1
buffer_store_dword v5,v1,s[8:11],s59 offen sc1
s_mov_b64 exec,-1
s_mov_b32 s59,2147483648
s_waitcnt vmcnt(10)
v_mfma_f32_32x32x16_bf16 v[112:127],a[56:59],v[72:75],v[112:127]
s_add_u32 s63,s67,0
buffer_load_dwordx4 v[16:19],v208,s[8:11],s63 offen sc1
buffer_load_dwordx4 v[180:183],v15,s[8:11],s65 offen sc1
v_mfma_f32_32x32x16_bf16 v[128:143],a[152:155],v[72:75],v[128:143]
s_waitcnt vmcnt(11)
v_mfma_f32_32x32x16_bf16 v[112:127],a[60:63],v[76:79],v[112:127]
buffer_load_dwordx4 v[20:23],v209,s[8:11],s63 offen sc1
v_mfma_f32_32x32x16_bf16 v[128:143],a[156:159],v[76:79],v[128:143]
s_waitcnt vmcnt(11)
v_mfma_f32_32x32x16_bf16 v[112:127],a[64:67],v[80:83],v[112:127]
buffer_load_dwordx4 v[24:27],v208,s[8:11],s63 offen offset:2048 sc1
v_mfma_f32_32x32x16_bf16 v[128:143],a[160:163],v[80:83],v[128:143]
s_waitcnt vmcnt(11)
v_mfma_f32_32x32x16_bf16 v[112:127],a[68:71],v[84:87],v[112:127]
buffer_load_dwordx4 v[28:31],v209,s[8:11],s63 offen offset:2048 sc1
v_mfma_f32_32x32x16_bf16 v[128:143],a[164:167],v[84:87],v[128:143]
s_waitcnt vmcnt(11)
v_mfma_f32_32x32x16_bf16 v[112:127],a[72:75],v[88:91],v[112:127]
s_add_u32 s63,s67,4096
buffer_load_dwordx4 v[32:35],v208,s[8:11],s63 offen sc1
buffer_load_dword v3,v2,s[8:11],s35 offen sc1
v_mfma_f32_32x32x16_bf16 v[128:143],a[168:171],v[88:91],v[128:143]
s_waitcnt vmcnt(12)
v_mfma_f32_32x32x16_bf16 v[112:127],a[76:79],v[92:95],v[112:127]
buffer_load_dwordx4 v[36:39],v209,s[8:11],s63 offen sc1
v_mfma_f32_32x32x16_bf16 v[128:143],a[172:175],v[92:95],v[128:143]
s_waitcnt vmcnt(12)
v_mfma_f32_32x32x16_bf16 v[112:127],a[80:83],v[96:99],v[112:127]
buffer_load_dwordx4 v[40:43],v208,s[8:11],s63 offen offset:2048 sc1
v_mfma_f32_32x32x16_bf16 v[128:143],a[176:179],v[96:99],v[128:143]
s_waitcnt vmcnt(12)
v_mfma_f32_32x32x16_bf16 v[112:127],a[84:87],v[100:103],v[112:127]
buffer_load_dwordx4 v[44:47],v209,s[8:11],s63 offen offset:2048 sc1
v_mfma_f32_32x32x16_bf16 v[128:143],a[180:183],v[100:103],v[128:143]
s_waitcnt vmcnt(12)
v_mfma_f32_32x32x16_bf16 v[112:127],a[88:91],v[104:107],v[112:127]
s_add_u32 s63,s67,8192
buffer_load_dwordx4 v[48:51],v208,s[8:11],s63 offen sc1
v_mfma_f32_32x32x16_bf16 v[128:143],a[184:187],v[104:107],v[128:143]
s_waitcnt vmcnt(12)
v_mfma_f32_32x32x16_bf16 v[112:127],a[92:95],v[108:111],v[112:127]
buffer_load_dwordx4 v[52:55],v209,s[8:11],s63 offen sc1
v_mfma_f32_32x32x16_bf16 v[128:143],a[188:191],v[108:111],v[128:143]
s_cmp_eq_u32 s37,0
s_cbranch_scc1 ep_368
s_waitcnt vmcnt(0)
v_cmp_eq_u32 vcc,0,v3
s_cmp_eq_u64 vcc,0
s_cselect_b32 s37,0,2147483648
s_cmp_lt_u32 s32,128
s_cselect_b32 s37,s37,2147483648
s_cmp_lg_u32 s37,0
s_cbranch_scc1 ep_368
s_add_u32 s63,s73,0
buffer_load_dwordx4 v[16:19],v208,s[8:11],s63 offen sc1
buffer_load_dwordx4 v[20:23],v209,s[8:11],s63 offen sc1
buffer_load_dwordx4 v[24:27],v208,s[8:11],s63 offen offset:2048 sc1
buffer_load_dwordx4 v[28:31],v209,s[8:11],s63 offen offset:2048 sc1
s_add_u32 s63,s73,4096
buffer_load_dwordx4 v[32:35],v208,s[8:11],s63 offen sc1
buffer_load_dwordx4 v[36:39],v209,s[8:11],s63 offen sc1
buffer_load_dwordx4 v[40:43],v208,s[8:11],s63 offen offset:2048 sc1
buffer_load_dwordx4 v[44:47],v209,s[8:11],s63 offen offset:2048 sc1
s_add_u32 s63,s73,8192
buffer_load_dwordx4 v[48:51],v208,s[8:11],s63 offen sc1
buffer_load_dwordx4 v[52:55],v209,s[8:11],s63 offen sc1
ep_368:
s_nop 7
ds_write_b128 v206,v[112:115] offset:0
ds_write_b128 v206,v[116:119] offset:1024
ds_write_b128 v206,v[120:123] offset:512
ds_write_b128 v206,v[124:127] offset:1536
s_nop 0
ds_write_b128 v206,v[128:131] offset:8192
ds_write_b128 v206,v[132:135] offset:9216
ds_write_b128 v206,v[136:139] offset:8704
ds_write_b128 v206,v[140:143] offset:9728
s_waitcnt vmcnt(10)
v_lshlrev_b32 v184,16,v176
v_and_b32 v185,0xffff0000,v176
v_lshlrev_b32 v186,16,v177
v_and_b32 v187,0xffff0000,v177
v_lshlrev_b32 v188,16,v178
v_and_b32 v189,0xffff0000,v178
v_lshlrev_b32 v190,16,v179
v_and_b32 v191,0xffff0000,v179
v_lshlrev_b32 v192,16,v180
v_and_b32 v193,0xffff0000,v180
v_lshlrev_b32 v194,16,v181
v_and_b32 v195,0xffff0000,v181
v_lshlrev_b32 v196,16,v182
v_and_b32 v197,0xffff0000,v182
v_lshlrev_b32 v198,16,v183
v_and_b32 v199,0xffff0000,v183
s_waitcnt lgkmcnt(0)
s_barrier
ds_read_b128 v[144:147],v207 offset:0
ds_read_b128 v[148:151],v207 offset:1024
ds_read_b128 v[152:155],v207 offset:2048
ds_read_b128 v[156:159],v207 offset:3072
ds_read_b128 v[160:163],v207 offset:4096
ds_read_b128 v[164:167],v207 offset:5120
ds_read_b128 v[168:171],v207 offset:6144
ds_read_b128 v[172:175],v207 offset:7168
s_waitcnt lgkmcnt(4)
v_pk_add_f32 v[144:145],v[144:145],v[152:153]
v_pk_add_f32 v[146:147],v[146:147],v[154:155]
v_pk_add_f32 v[148:149],v[148:149],v[156:157]
v_pk_add_f32 v[150:151],v[150:151],v[158:159]
s_waitcnt lgkmcnt(0)
v_pk_add_f32 v[160:161],v[160:161],v[168:169]
v_pk_add_f32 v[162:163],v[162:163],v[170:171]
v_pk_add_f32 v[164:165],v[164:165],v[172:173]
v_pk_add_f32 v[166:167],v[166:167],v[174:175]
v_pk_add_f32 v[144:145],v[144:145],v[160:161]
v_pk_add_f32 v[146:147],v[146:147],v[162:163]
v_pk_add_f32 v[148:149],v[148:149],v[164:165]
v_pk_add_f32 v[150:151],v[150:151],v[166:167]
v_cvt_pk_bf16_f32 v6,v144,v145
v_lshlrev_b32 v144,16,v6
v_and_b32 v145,0xffff0000,v6
v_cvt_pk_bf16_f32 v6,v146,v147
v_lshlrev_b32 v146,16,v6
v_and_b32 v147,0xffff0000,v6
v_cvt_pk_bf16_f32 v6,v148,v149
v_lshlrev_b32 v148,16,v6
v_and_b32 v149,0xffff0000,v6
v_cvt_pk_bf16_f32 v6,v150,v151
v_lshlrev_b32 v150,16,v6
v_and_b32 v151,0xffff0000,v6
v_pk_add_f32 v[144:145],v[144:145],v[184:185]
v_pk_add_f32 v[146:147],v[146:147],v[186:187]
v_pk_add_f32 v[148:149],v[148:149],v[188:189]
v_pk_add_f32 v[150:151],v[150:151],v[190:191]
v_cvt_pk_bf16_f32 v6,v144,v145
v_lshlrev_b32 v144,16,v6
v_and_b32 v145,0xffff0000,v6
v_cvt_pk_bf16_f32 v6,v146,v147
v_lshlrev_b32 v146,16,v6
v_and_b32 v147,0xffff0000,v6
v_cvt_pk_bf16_f32 v6,v148,v149
v_lshlrev_b32 v148,16,v6
v_and_b32 v149,0xffff0000,v6
v_cvt_pk_bf16_f32 v6,v150,v151
v_lshlrev_b32 v150,16,v6
v_and_b32 v151,0xffff0000,v6
v_pk_add_f32 v[144:145],v[144:145],v[192:193]
v_pk_add_f32 v[146:147],v[146:147],v[194:195]
v_pk_add_f32 v[148:149],v[148:149],v[196:197]
v_pk_add_f32 v[150:151],v[150:151],v[198:199]
v_cvt_pk_bf16_f32 v200,v144,v145
v_lshlrev_b32 v144,16,v200
v_and_b32 v145,0xffff0000,v200
v_cvt_pk_bf16_f32 v201,v146,v147
v_lshlrev_b32 v146,16,v201
v_and_b32 v147,0xffff0000,v201
v_cvt_pk_bf16_f32 v202,v148,v149
v_lshlrev_b32 v148,16,v202
v_and_b32 v149,0xffff0000,v202
v_cvt_pk_bf16_f32 v203,v150,v151
v_lshlrev_b32 v150,16,v203
v_and_b32 v151,0xffff0000,v203
s_cmp_lg_u32 s51,0
s_cbranch_scc1 w4o_369
s_mul_i32 s62,s52,46080
s_add_u32 s62,s62,209518592
s_add_u32 s63,s62,s70
buffer_store_dwordx4 v[200:203],v15,s[8:11],s63 offen sc1
v_add_f32 v6,v144,v145
v_mul_f32 v7,v144,v144
v_fmac_f32 v7,v145,v145
v_add_f32 v6,v6,v146
v_fmac_f32 v7,v146,v146
v_add_f32 v6,v6,v147
v_fmac_f32 v7,v147,v147
v_add_f32 v6,v6,v148
v_fmac_f32 v7,v148,v148
v_add_f32 v6,v6,v149
v_fmac_f32 v7,v149,v149
v_add_f32 v6,v6,v150
v_fmac_f32 v7,v150,v150
v_add_f32 v6,v6,v151
v_fmac_f32 v7,v151,v151
v_mov_b32 v8,v6
v_mov_b32 v9,v7
s_nop 0
v_permlane32_swap_b32 v6,v8
v_permlane32_swap_b32 v7,v9
v_add_f32 v6,v6,v8
v_add_f32 v7,v7,v9
v_mov_b32 v8,v6
v_mov_b32 v9,v7
s_nop 0
v_permlane16_swap_b32 v6,v8
v_permlane16_swap_b32 v7,v9
v_add_f32 v6,v6,v8
v_add_f32 v7,v7,v9
s_lshl_b32 s63,s68,8
s_lshl_b32 s60,s69,7
s_add_u32 s63,s63,s60
s_add_u32 s63,s63,s62
s_add_u32 s63,s63,40960
s_mov_b64 exec,0xffff
buffer_store_dwordx2 v[6:7],v204,s[8:11],s63 offen sc1
s_mov_b64 exec,-1
s_mov_b32 s66,1
s_lshl_b32 s59,s66,6
s_add_u32 s59,s59,s52
s_lshl_b32 s59,s59,9
s_add_u32 s59,s59,0
s_lshl_b32 s61,s56,2
s_add_u32 s59,s59,s61
s_branch w4n_370
w4o_369:
s_mul_i32 s62,s52,40960
buffer_store_dwordx2 v[200:201],v205,s[76:79],s62 offen
buffer_store_dwordx2 v[202:203],v205,s[76:79],s62 offen offset:32
w4n_370:
s_cmp_eq_u32 s37,0
s_cbranch_scc1 W4_NEXT
s_waitcnt vmcnt(0)
s_mov_b64 exec,1
buffer_store_dword v5,v1,s[8:11],s59 offen sc1
s_mov_b64 exec,-1
s_mov_b32 s59,2147483648
s_cmp_lt_u32 s32,128
s_cbranch_scc1 W4_COLD
s_endpgm
.section .rodata,"a"
.p2align 6
.amdhsa_kernel interleave_layers__memory_aug_recurrent_mem_tr__mixer_s_mlp__prompt_kernel
  .amdhsa_next_free_vgpr 512
  .amdhsa_next_free_sgpr 102
  .amdhsa_accum_offset 256
  .amdhsa_group_segment_fixed_size 0
  .amdhsa_kernarg_size 120
  .amdhsa_user_sgpr_count 2
  .amdhsa_user_sgpr_kernarg_segment_ptr 1
  .amdhsa_system_sgpr_workgroup_id_x 1
.end_amdhsa_kernel
```

```asm
; @launch grid=(256,1,1) block=(256,1,1) lds=163840
.amdgcn_target "amdgcn-amd-amdhsa--gfx950"
.text
.globl interleave_layers__memory_aug_recurrent_mem_tr__mixer_s_mlp__prompt_kernel
.p2align 8
.type interleave_layers__memory_aug_recurrent_mem_tr__mixer_s_mlp__prompt_kernel,@function
interleave_layers__memory_aug_recurrent_mem_tr__mixer_s_mlp__prompt_kernel:
s_cmp_ge_u32 s2,256
s_cbranch_scc1 EXIT
s_load_dwordx16 s[16:31],s[0:1],0
s_load_dwordx8 s[32:39],s[0:1],64
s_load_dwordx4 s[40:43],s[0:1],96
s_load_dwordx2 s[44:45],s[0:1],112
v_lshrrev_b32 v1,6,v0
v_and_b32 v0,63,v0
v_readfirstlane_b32 s46,v1
s_mov_b32 s47,200000
s_mov_b32 s49,0
s_getreg_b32 s4,hwreg(HW_REG_XCC_ID)
s_and_b32 s4,s4,7
s_waitcnt lgkmcnt(0)
s_mov_b32 s8,s44
s_mov_b32 s9,s45
s_mov_b32 s10,268435456
s_mov_b32 s11,0x20000
s_mov_b32 s12,s42
s_mov_b32 s13,s43
s_mov_b32 s14,256
s_mov_b32 s15,0x20000
v_lshlrev_b32 v1,4,v0
v_mov_b32 v4,0
v_mov_b32 v5,0
v_mov_b32 v6,0
v_mov_b32 v7,0
s_lshl_b32 s5,s2,2
s_add_u32 s5,s5,s46
s_lshl_b32 s5,s5,10
buffer_store_dwordx4 v[4:7],v1,s[8:11],s5 offen sc1
s_cmp_ge_u32 s4,4
s_cbranch_scc1 VOTE_DONE
s_cmp_lg_u32 s46,1
s_cbranch_scc1 VOTE_DONE
s_and_b32 s52,s2,24
s_cbranch_scc1 VOTE_DONE
s_mov_b64 exec,1
v_mov_b32 v12,0
s_and_b32 s53,s2,63
s_lshl_b32 s53,s53,7
s_lshr_b32 s52,s2,6
s_mul_i32 s52,s52,3
s_add_u32 s52,s52,s46
s_lshl_b32 s52,s52,14
s_add_u32 s53,s53,s52
s_add_u32 s53,s53,11796480
s_add_u32 s59,s53,0x2000
buffer_store_dword v12,v12,s[8:11],s53 offen sc1
buffer_store_dword v12,v12,s[8:11],s59 offen sc1
s_waitcnt vmcnt(0)
s_memtime s[54:55]
s_waitcnt lgkmcnt(0)
buffer_load_dword v13,v12,s[8:11],s53 offen sc1
s_waitcnt vmcnt(0)
s_memtime s[56:57]
s_waitcnt lgkmcnt(0)
s_sub_u32 s50,s56,s54
s_memtime s[54:55]
s_waitcnt lgkmcnt(0)
buffer_load_dword v13,v12,s[8:11],s59 offen sc1
s_waitcnt vmcnt(0)
s_memtime s[56:57]
s_waitcnt lgkmcnt(0)
s_sub_u32 s51,s56,s54
s_cmp_lt_u32 s51,s50
s_cselect_b32 s52,1,-1
v_mov_b32 v13,s52
v_mov_b32 v12,192
buffer_atomic_add v13,v12,s[12:15],0 offen sc1
s_mov_b64 exec,-1
VOTE_DONE:
v_mov_b32 v2,0
s_cmp_lg_u32 s46,0
s_cbranch_scc1 TK_DONE
s_mov_b64 exec,1
v_mov_b32 v1,1
s_lshl_b32 s5,s4,2
v_mov_b32 v3,s5
buffer_atomic_add v1,v3,s[12:15],0 offen offset:32 sc0 sc1
s_waitcnt vmcnt(0)
v_readfirstlane_b32 s5,v1
s_lshl_b32 s6,s4,5
s_add_u32 s6,s6,s5
s_cmp_lt_u32 s5,32
s_cselect_b32 s6,s6,999
v_mov_b32 v1,s6
ds_write_b32 v2,v1
s_mov_b64 exec,-1
s_waitcnt lgkmcnt(0)
TK_DONE:
s_barrier
ds_read_b32 v1,v2
s_waitcnt lgkmcnt(0)
v_readfirstlane_b32 s3,v1
s_barrier
s_nop 2
s_branch DISPATCH
ROLE_CS:
s_lshr_b32 s28,s48,4
s_and_b32 s29,s48,15
s_mul_i32 s82,s28,2097152
s_add_u32 s82,s82,2097152
v_lshlrev_b32 v1,4,v0
v_and_b32 v12,1,v0
v_mul_u32_u24 v2,0xaaaa,v12
v_or_b32 v2,0x4444,v2
s_add_u32 s60,s46,1
s_and_b32 s60,s60,3
s_lshl_b32 s60,s60,11
s_add_u32 s60,s60,131072
v_add_u32 v3,s60,v1
s_add_u32 s60,s46,2
s_and_b32 s60,s60,3
s_lshl_b32 s60,s60,11
s_add_u32 s60,s60,131072
v_add_u32 v4,s60,v1
s_add_u32 s60,s46,3
s_and_b32 s60,s60,3
s_lshl_b32 s60,s60,11
s_add_u32 s60,s60,131072
v_add_u32 v5,s60,v1
v_add_u32 v59,139264,v1
s_lshl_b32 s60,s46,11
s_add_u32 s60,s60,131072
v_add_u32 v22,s60,v1
s_lshr_b32 s60,s46,1
s_lshl_b32 s60,s60,10
s_and_b32 s61,s46,1
s_lshl_b32 s61,s61,3
s_add_u32 s60,s60,s61
v_add_u32 v23,s60,v59
s_mul_i32 s60,s46,20480
v_add_u32 v21,s60,v1
v_and_b32 v11,7,v0
v_lshlrev_b32 v11,2,v11
v_bfe_u32 v12,v0,3,2
v_lshl_add_u32 v11,v12,7,v11
s_xor_b32 s60,s28,1
s_lshl_b32 s60,s60,19
s_lshl_b32 s61,s46,14
s_add_u32 s83,s60,s61
s_add_u32 s83,s83,10485760
s_mov_b32 s36,0
s_mov_b32 s88,0xcccccccc
s_mov_b32 s89,0xcccccccc
s_mov_b32 s90,0x33333333
s_mov_b32 s91,0x33333333
s_mov_b32 s87,0x3dd53b95
v_lshrrev_b32 v14,4,v0
v_and_b32 v15,15,v0
v_lshrrev_b32 v12,2,v15
v_add_u32 v12,v12,v14
v_and_b32 v12,3,v12
v_lshlrev_b32 v6,3,v12
v_lshl_add_u32 v6,v15,5,v6
s_mul_i32 s60,s46,1536
s_add_u32 s60,s60,141312
v_add_u32 v6,s60,v6
v_add_u32 v12,v0,v14
v_and_b32 v12,3,v12
v_lshlrev_b32 v7,3,v12
v_lshrrev_b32 v12,2,v0
v_lshl_add_u32 v7,v12,5,v7
v_add_u32 v7,141312,v7
s_min_u32 s62,s46,2
v_lshrrev_b32 v12,2,v15
v_and_b32 v13,1,v15
v_lshl_add_u32 v12,v12,1,v13
v_bfe_u32 v13,v15,1,1
v_lshlrev_b32 v8,8,v14
v_lshl_add_u32 v8,v12,5,v8
v_xor_b32 v16,1,v13
v_lshl_add_u32 v8,v16,4,v8
v_lshlrev_b32 v20,8,v14
v_lshl_add_u32 v20,v13,7,v20
v_and_b32 v16,3,v12
v_lshl_add_u32 v20,v16,5,v20
v_lshrrev_b32 v16,2,v12
v_lshl_add_u32 v20,v16,4,v20
v_min_u32 v12,5,v0
s_mul_i32 s60,s48,3
v_add_u32 v9,s60,v12
v_lshlrev_b32 v9,2,v9
v_add_u32 v13,65524,v9
v_cmp_lt_u32 vcc,2,v12
s_nop 1
v_cndmask_b32 v9,v9,v13,vcc
s_mul_i32 s84,s48,12288
s_add_u32 s84,s84,74448896
s_mul_i32 s60,s29,3072
s_lshl_b32 s61,s62,10
s_add_u32 s60,s60,s61
s_add_u32 s60,s60,s82
s_add_u32 s33,s60,163840
s_add_u32 s34,s60,557056
s_mul_i32 s85,s48,6144
s_add_u32 s85,s85,24117248
s_lshl_b32 s86,s48,5
s_lshl_b32 s61,s62,2
s_add_u32 s86,s86,688128
s_lshr_b32 s60,s29,2
s_lshl_b32 s60,s60,7
s_and_b32 s63,s29,3
s_mul_i32 s63,s63,12
s_add_u32 s60,s60,s63
s_add_u32 s60,s60,s61
s_add_u32 s60,s60,s82
s_add_u32 s35,s60,951296
s_cmp_eq_u32 s46,3
s_cbranch_scc1 si_1
v_mov_b32 v12,-1
v_mov_b32 v13,0
s_cmp_lg_u32 s49,0
s_cbranch_scc1 ls_2
s_add_u32 s60,s33,0
buffer_store_dword v12,v1,s[8:11],s60 offen
buffer_load_dword v24,v1,s[8:11],s60 offen sc1
s_add_u32 s60,s33,49152
buffer_store_dword v12,v1,s[8:11],s60 offen
buffer_load_dword v24,v1,s[8:11],s60 offen sc1
s_add_u32 s60,s33,98304
buffer_store_dword v12,v1,s[8:11],s60 offen
buffer_load_dword v24,v1,s[8:11],s60 offen sc1
s_add_u32 s60,s33,147456
buffer_store_dword v12,v1,s[8:11],s60 offen
buffer_load_dword v24,v1,s[8:11],s60 offen sc1
s_add_u32 s60,s33,196608
buffer_store_dword v12,v1,s[8:11],s60 offen
buffer_load_dword v24,v1,s[8:11],s60 offen sc1
s_add_u32 s60,s33,245760
buffer_store_dword v12,v1,s[8:11],s60 offen
buffer_load_dword v24,v1,s[8:11],s60 offen sc1
s_add_u32 s60,s33,294912
buffer_store_dword v12,v1,s[8:11],s60 offen
buffer_load_dword v24,v1,s[8:11],s60 offen sc1
s_add_u32 s60,s33,344064
buffer_store_dword v12,v1,s[8:11],s60 offen
buffer_load_dword v24,v1,s[8:11],s60 offen sc1
s_mov_b64 exec,1
buffer_store_dword v13,v1,s[8:11],s35 offen
buffer_store_dword v13,v1,s[8:11],s35 offen offset:512
s_mov_b64 exec,-1
s_branch ls_3
ls_2:
s_add_u32 s60,s33,0
buffer_store_dword v12,v1,s[8:11],s60 offen sc1
buffer_load_dword v24,v1,s[8:11],s60 offen sc1
s_add_u32 s60,s33,49152
buffer_store_dword v12,v1,s[8:11],s60 offen sc1
buffer_load_dword v24,v1,s[8:11],s60 offen sc1
s_add_u32 s60,s33,98304
buffer_store_dword v12,v1,s[8:11],s60 offen sc1
buffer_load_dword v24,v1,s[8:11],s60 offen sc1
s_add_u32 s60,s33,147456
buffer_store_dword v12,v1,s[8:11],s60 offen sc1
buffer_load_dword v24,v1,s[8:11],s60 offen sc1
s_add_u32 s60,s33,196608
buffer_store_dword v12,v1,s[8:11],s60 offen sc1
buffer_load_dword v24,v1,s[8:11],s60 offen sc1
s_add_u32 s60,s33,245760
buffer_store_dword v12,v1,s[8:11],s60 offen sc1
buffer_load_dword v24,v1,s[8:11],s60 offen sc1
s_add_u32 s60,s33,294912
buffer_store_dword v12,v1,s[8:11],s60 offen sc1
buffer_load_dword v24,v1,s[8:11],s60 offen sc1
s_add_u32 s60,s33,344064
buffer_store_dword v12,v1,s[8:11],s60 offen sc1
buffer_load_dword v24,v1,s[8:11],s60 offen sc1
s_mov_b64 exec,1
buffer_store_dword v13,v1,s[8:11],s35 offen sc1
buffer_store_dword v13,v1,s[8:11],s35 offen offset:512 sc1
s_mov_b64 exec,-1
ls_3:
si_1:
s_mul_i32 s73,s48,384
s_mov_b32 s74,s73
v_add_u32 v12,0,v0
v_mul_u32_u24 v13,2731,v12
v_lshrrev_b32 v13,16,v13
v_mul_u32_u24 v16,24,v13
v_sub_u32 v12,v12,v16
v_mul_u32_u24 v104,12288,v13
v_lshl_add_u32 v104,v12,4,v104
v_add_u32 v12,64,v0
v_mul_u32_u24 v13,2731,v12
v_lshrrev_b32 v13,16,v13
v_mul_u32_u24 v16,24,v13
v_sub_u32 v12,v12,v16
v_mul_u32_u24 v105,12288,v13
v_lshl_add_u32 v105,v12,4,v105
v_add_u32 v12,128,v0
v_mul_u32_u24 v13,2731,v12
v_lshrrev_b32 v13,16,v13
v_mul_u32_u24 v16,24,v13
v_sub_u32 v12,v12,v16
v_mul_u32_u24 v106,12288,v13
v_lshl_add_u32 v106,v12,4,v106
s_mov_b32 s4,s20
s_mov_b32 s5,s21
s_mov_b32 s6,7864320
s_mov_b32 s7,0x20000
s_mov_b32 s52,s22
s_mov_b32 s53,s23
s_mov_b32 s54,7864320
s_mov_b32 s55,0x20000
s_branch SV_LOAD
ROLE_CV:
s_lshr_b32 s28,s48,3
s_and_b32 s29,s48,7
s_mul_i32 s82,s28,2097152
s_add_u32 s82,s82,2097152
v_lshlrev_b32 v1,4,v0
v_and_b32 v12,1,v0
v_mul_u32_u24 v2,0xaaaa,v12
v_or_b32 v2,0x4444,v2
s_add_u32 s60,s46,1
s_and_b32 s60,s60,3
s_lshl_b32 s60,s60,11
s_add_u32 s60,s60,131072
v_add_u32 v3,s60,v1
s_add_u32 s60,s46,2
s_and_b32 s60,s60,3
s_lshl_b32 s60,s60,11
s_add_u32 s60,s60,131072
v_add_u32 v4,s60,v1
s_add_u32 s60,s46,3
s_and_b32 s60,s60,3
s_lshl_b32 s60,s60,11
s_add_u32 s60,s60,131072
v_add_u32 v5,s60,v1
v_add_u32 v59,139264,v1
s_lshl_b32 s60,s46,11
s_add_u32 s60,s60,131072
v_add_u32 v22,s60,v1
s_lshr_b32 s60,s46,1
s_lshl_b32 s60,s60,10
s_and_b32 s61,s46,1
s_lshl_b32 s61,s61,3
s_add_u32 s60,s60,s61
v_add_u32 v23,s60,v59
s_mul_i32 s60,s46,20480
v_add_u32 v21,s60,v1
v_and_b32 v11,7,v0
v_lshlrev_b32 v11,2,v11
v_bfe_u32 v12,v0,3,2
v_lshl_add_u32 v11,v12,7,v11
s_xor_b32 s60,s28,1
s_lshl_b32 s60,s60,19
s_lshl_b32 s61,s46,14
s_add_u32 s83,s60,s61
s_add_u32 s83,s83,10485760
s_mov_b32 s36,1
v_mov_b32 v8,0
v_mov_b32 v9,0
v_mov_b32 v20,0
s_and_b32 s62,s46,1
s_lshl_b32 s60,s62,11
v_add_u32 v6,s60,v1
s_lshl_b32 s60,s62,3
s_add_u32 s60,s60,1024
v_add_u32 v7,s60,v1
s_lshr_b32 s61,s46,1
s_lshl_b32 s60,s29,1
s_add_u32 s60,s60,s61
s_mul_i32 s60,s60,3072
s_add_u32 s60,s60,s82
s_add_u32 s34,s60,557056
s_lshl_b32 s60,s48,1
s_add_u32 s60,s60,s61
s_mul_i32 s85,s60,6144
s_add_u32 s85,s85,24120320
s_lshl_b32 s86,s60,5
s_lshl_b32 s61,s62,2
s_add_u32 s86,s86,s61
s_add_u32 s86,s86,688132
v_mov_b32 v12,-1
v_mov_b32 v13,-1
v_mov_b32 v14,-1
v_mov_b32 v15,-1
s_cmp_lg_u32 s49,0
s_cbranch_scc1 ls_4
s_add_u32 s60,s34,0
buffer_store_dwordx4 v[12:15],v6,s[8:11],s60 offen
buffer_store_dwordx2 v[12:13],v7,s[8:11],s60 offen
buffer_load_dword v24,v6,s[8:11],s60 offen sc1
buffer_load_dword v24,v7,s[8:11],s60 offen sc1
s_add_u32 s60,s34,49152
buffer_store_dwordx4 v[12:15],v6,s[8:11],s60 offen
buffer_store_dwordx2 v[12:13],v7,s[8:11],s60 offen
buffer_load_dword v24,v6,s[8:11],s60 offen sc1
buffer_load_dword v24,v7,s[8:11],s60 offen sc1
s_add_u32 s60,s34,98304
buffer_store_dwordx4 v[12:15],v6,s[8:11],s60 offen
buffer_store_dwordx2 v[12:13],v7,s[8:11],s60 offen
buffer_load_dword v24,v6,s[8:11],s60 offen sc1
buffer_load_dword v24,v7,s[8:11],s60 offen sc1
s_add_u32 s60,s34,147456
buffer_store_dwordx4 v[12:15],v6,s[8:11],s60 offen
buffer_store_dwordx2 v[12:13],v7,s[8:11],s60 offen
buffer_load_dword v24,v6,s[8:11],s60 offen sc1
buffer_load_dword v24,v7,s[8:11],s60 offen sc1
s_add_u32 s60,s34,196608
buffer_store_dwordx4 v[12:15],v6,s[8:11],s60 offen
buffer_store_dwordx2 v[12:13],v7,s[8:11],s60 offen
buffer_load_dword v24,v6,s[8:11],s60 offen sc1
buffer_load_dword v24,v7,s[8:11],s60 offen sc1
s_add_u32 s60,s34,245760
buffer_store_dwordx4 v[12:15],v6,s[8:11],s60 offen
buffer_store_dwordx2 v[12:13],v7,s[8:11],s60 offen
buffer_load_dword v24,v6,s[8:11],s60 offen sc1
buffer_load_dword v24,v7,s[8:11],s60 offen sc1
s_add_u32 s60,s34,294912
buffer_store_dwordx4 v[12:15],v6,s[8:11],s60 offen
buffer_store_dwordx2 v[12:13],v7,s[8:11],s60 offen
buffer_load_dword v24,v6,s[8:11],s60 offen sc1
buffer_load_dword v24,v7,s[8:11],s60 offen sc1
s_add_u32 s60,s34,344064
buffer_store_dwordx4 v[12:15],v6,s[8:11],s60 offen
buffer_store_dwordx2 v[12:13],v7,s[8:11],s60 offen
buffer_load_dword v24,v6,s[8:11],s60 offen sc1
buffer_load_dword v24,v7,s[8:11],s60 offen sc1
s_branch ls_5
ls_4:
s_add_u32 s60,s34,0
buffer_store_dwordx4 v[12:15],v6,s[8:11],s60 offen sc1
buffer_store_dwordx2 v[12:13],v7,s[8:11],s60 offen sc1
buffer_load_dword v24,v6,s[8:11],s60 offen sc1
buffer_load_dword v24,v7,s[8:11],s60 offen sc1
s_add_u32 s60,s34,49152
buffer_store_dwordx4 v[12:15],v6,s[8:11],s60 offen sc1
buffer_store_dwordx2 v[12:13],v7,s[8:11],s60 offen sc1
buffer_load_dword v24,v6,s[8:11],s60 offen sc1
buffer_load_dword v24,v7,s[8:11],s60 offen sc1
s_add_u32 s60,s34,98304
buffer_store_dwordx4 v[12:15],v6,s[8:11],s60 offen sc1
buffer_store_dwordx2 v[12:13],v7,s[8:11],s60 offen sc1
buffer_load_dword v24,v6,s[8:11],s60 offen sc1
buffer_load_dword v24,v7,s[8:11],s60 offen sc1
s_add_u32 s60,s34,147456
buffer_store_dwordx4 v[12:15],v6,s[8:11],s60 offen sc1
buffer_store_dwordx2 v[12:13],v7,s[8:11],s60 offen sc1
buffer_load_dword v24,v6,s[8:11],s60 offen sc1
buffer_load_dword v24,v7,s[8:11],s60 offen sc1
s_add_u32 s60,s34,196608
buffer_store_dwordx4 v[12:15],v6,s[8:11],s60 offen sc1
buffer_store_dwordx2 v[12:13],v7,s[8:11],s60 offen sc1
buffer_load_dword v24,v6,s[8:11],s60 offen sc1
buffer_load_dword v24,v7,s[8:11],s60 offen sc1
s_add_u32 s60,s34,245760
buffer_store_dwordx4 v[12:15],v6,s[8:11],s60 offen sc1
buffer_store_dwordx2 v[12:13],v7,s[8:11],s60 offen sc1
buffer_load_dword v24,v6,s[8:11],s60 offen sc1
buffer_load_dword v24,v7,s[8:11],s60 offen sc1
s_add_u32 s60,s34,294912
buffer_store_dwordx4 v[12:15],v6,s[8:11],s60 offen sc1
buffer_store_dwordx2 v[12:13],v7,s[8:11],s60 offen sc1
buffer_load_dword v24,v6,s[8:11],s60 offen sc1
buffer_load_dword v24,v7,s[8:11],s60 offen sc1
s_add_u32 s60,s34,344064
buffer_store_dwordx4 v[12:15],v6,s[8:11],s60 offen sc1
buffer_store_dwordx2 v[12:13],v7,s[8:11],s60 offen sc1
buffer_load_dword v24,v6,s[8:11],s60 offen sc1
buffer_load_dword v24,v7,s[8:11],s60 offen sc1
ls_5:
s_mul_i32 s73,s48,768
s_add_u32 s74,s73,96
v_add_u32 v12,0,v0
v_mul_u32_u24 v13,2731,v12
v_lshrrev_b32 v13,16,v13
v_mul_u32_u24 v16,24,v13
v_sub_u32 v12,v12,v16
v_mul_u32_u24 v104,12288,v13
v_lshl_add_u32 v104,v12,4,v104
v_mul_u32_u24 v13,43,v12
v_lshrrev_b32 v13,8,v13
v_mul_u32_u24 v13,96,v13
v_add_u32 v104,v104,v13
v_add_u32 v12,64,v0
v_mul_u32_u24 v13,2731,v12
v_lshrrev_b32 v13,16,v13
v_mul_u32_u24 v16,24,v13
v_sub_u32 v12,v12,v16
v_mul_u32_u24 v105,12288,v13
v_lshl_add_u32 v105,v12,4,v105
v_mul_u32_u24 v13,43,v12
v_lshrrev_b32 v13,8,v13
v_mul_u32_u24 v13,96,v13
v_add_u32 v105,v105,v13
v_add_u32 v12,128,v0
v_mul_u32_u24 v13,2731,v12
v_lshrrev_b32 v13,16,v13
v_mul_u32_u24 v16,24,v13
v_sub_u32 v12,v12,v16
v_mul_u32_u24 v106,12288,v13
v_lshl_add_u32 v106,v12,4,v106
v_mul_u32_u24 v13,43,v12
v_lshrrev_b32 v13,8,v13
v_mul_u32_u24 v13,96,v13
v_add_u32 v106,v106,v13
s_mov_b32 s4,s24
s_mov_b32 s5,s25
s_mov_b32 s6,7864320
s_mov_b32 s7,0x20000
s_mov_b32 s52,s24
s_mov_b32 s53,s25
s_mov_b32 s54,7864320
s_mov_b32 s55,0x20000
SV_LOAD:
s_waitcnt vmcnt(0)
s_barrier
s_cmp_lg_u32 s46,0
s_cbranch_scc1 arr_6
v_mov_b32 v12,1
s_lshl_b32 s3,s49,2
v_mov_b32 v13,s3
s_mov_b64 exec,1
buffer_atomic_add v12,v13,s[12:15],0 offen sc1
s_mov_b64 exec,-1
arr_6:
s_and_b32 s60,s46,1
s_mul_i32 s60,s60,196608
s_lshr_b32 s61,s46,1
s_mul_i32 s75,s61,393216
s_add_u32 s75,s75,s60
s_mul_i32 s76,s61,1966080
s_add_u32 s76,s76,s60
s_mul_i32 s77,s46,6144
v_lshrrev_b32 v14,4,v0
v_and_b32 v15,15,v0
v_and_b32 v12,1,v14
v_lshlrev_b32 v12,5,v12
v_lshrrev_b32 v13,1,v14
v_lshl_add_u32 v12,v13,3,v12
v_bfe_u32 v13,v0,2,1
v_add_u32 v12,v12,v13
v_bfe_u32 v13,v0,3,1
v_lshl_add_u32 v12,v13,2,v12
v_mul_u32_u24 v107,384,v12
v_and_b32 v13,3,v0
v_lshl_add_u32 v107,v13,3,v107
s_mul_i32 s60,s46,96
v_add_u32 v107,s60,v107
s_add_u32 s60,s75,s73
s_add_u32 m0,s77,0
s_add_u32 s61,s60,0
buffer_load_dwordx4 v104,s[4:7],s61 offen lds
s_add_u32 m0,s77,1024
s_add_u32 s61,s60,0
buffer_load_dwordx4 v105,s[4:7],s61 offen lds
s_add_u32 m0,s77,2048
s_add_u32 s61,s60,0
buffer_load_dwordx4 v106,s[4:7],s61 offen lds
s_add_u32 m0,s77,3072
s_add_u32 s61,s60,98304
buffer_load_dwordx4 v104,s[4:7],s61 offen lds
s_add_u32 m0,s77,4096
s_add_u32 s61,s60,98304
buffer_load_dwordx4 v105,s[4:7],s61 offen lds
s_add_u32 m0,s77,5120
s_add_u32 s61,s60,98304
buffer_load_dwordx4 v106,s[4:7],s61 offen lds
s_add_u32 s60,s75,s74
s_add_u32 m0,s77,24576
s_add_u32 s61,s60,0
buffer_load_dwordx4 v104,s[52:55],s61 offen lds
s_add_u32 m0,s77,25600
s_add_u32 s61,s60,0
buffer_load_dwordx4 v105,s[52:55],s61 offen lds
s_add_u32 m0,s77,26624
s_add_u32 s61,s60,0
buffer_load_dwordx4 v106,s[52:55],s61 offen lds
s_add_u32 m0,s77,27648
s_add_u32 s61,s60,98304
buffer_load_dwordx4 v104,s[52:55],s61 offen lds
s_add_u32 m0,s77,28672
s_add_u32 s61,s60,98304
buffer_load_dwordx4 v105,s[52:55],s61 offen lds
s_add_u32 m0,s77,29696
s_add_u32 s61,s60,98304
buffer_load_dwordx4 v106,s[52:55],s61 offen lds
s_add_u32 s60,s75,s73
s_add_u32 m0,s77,49152
s_add_u32 s61,s60,786432
buffer_load_dwordx4 v104,s[4:7],s61 offen lds
s_add_u32 m0,s77,50176
s_add_u32 s61,s60,786432
buffer_load_dwordx4 v105,s[4:7],s61 offen lds
s_add_u32 m0,s77,51200
s_add_u32 s61,s60,786432
buffer_load_dwordx4 v106,s[4:7],s61 offen lds
s_add_u32 m0,s77,52224
s_add_u32 s61,s60,884736
buffer_load_dwordx4 v104,s[4:7],s61 offen lds
s_add_u32 m0,s77,53248
s_add_u32 s61,s60,884736
buffer_load_dwordx4 v105,s[4:7],s61 offen lds
s_add_u32 m0,s77,54272
s_add_u32 s61,s60,884736
buffer_load_dwordx4 v106,s[4:7],s61 offen lds
s_add_u32 s60,s75,s74
s_add_u32 m0,s77,73728
s_add_u32 s61,s60,786432
buffer_load_dwordx4 v104,s[52:55],s61 offen lds
s_add_u32 m0,s77,74752
s_add_u32 s61,s60,786432
buffer_load_dwordx4 v105,s[52:55],s61 offen lds
s_add_u32 m0,s77,75776
s_add_u32 s61,s60,786432
buffer_load_dwordx4 v106,s[52:55],s61 offen lds
s_add_u32 m0,s77,76800
s_add_u32 s61,s60,884736
buffer_load_dwordx4 v104,s[52:55],s61 offen lds
s_add_u32 m0,s77,77824
s_add_u32 s61,s60,884736
buffer_load_dwordx4 v105,s[52:55],s61 offen lds
s_add_u32 m0,s77,78848
s_add_u32 s61,s60,884736
buffer_load_dwordx4 v106,s[52:55],s61 offen lds
s_add_u32 s60,s75,s73
s_add_u32 m0,s77,98304
s_add_u32 s61,s60,1966080
buffer_load_dwordx4 v104,s[4:7],s61 offen lds
s_add_u32 m0,s77,99328
s_add_u32 s61,s60,1966080
buffer_load_dwordx4 v105,s[4:7],s61 offen lds
s_add_u32 m0,s77,100352
s_add_u32 s61,s60,1966080
buffer_load_dwordx4 v106,s[4:7],s61 offen lds
s_add_u32 m0,s77,101376
s_add_u32 s61,s60,2064384
buffer_load_dwordx4 v104,s[4:7],s61 offen lds
s_add_u32 m0,s77,102400
s_add_u32 s61,s60,2064384
buffer_load_dwordx4 v105,s[4:7],s61 offen lds
s_add_u32 m0,s77,103424
s_add_u32 s61,s60,2064384
buffer_load_dwordx4 v106,s[4:7],s61 offen lds
s_waitcnt vmcnt(24)
s_barrier
s_add_u32 s60,s75,s74
s_add_u32 m0,s77,122880
s_add_u32 s61,s60,1966080
buffer_load_dwordx4 v104,s[52:55],s61 offen lds
s_add_u32 m0,s77,123904
s_add_u32 s61,s60,1966080
buffer_load_dwordx4 v105,s[52:55],s61 offen lds
s_add_u32 m0,s77,124928
s_add_u32 s61,s60,1966080
buffer_load_dwordx4 v106,s[52:55],s61 offen lds
s_add_u32 m0,s77,125952
s_add_u32 s61,s60,2064384
buffer_load_dwordx4 v104,s[52:55],s61 offen lds
s_add_u32 m0,s77,126976
s_add_u32 s61,s60,2064384
buffer_load_dwordx4 v105,s[52:55],s61 offen lds
s_add_u32 m0,s77,128000
s_add_u32 s61,s60,2064384
buffer_load_dwordx4 v106,s[52:55],s61 offen lds
v_add_u32 v12,0,v107
s_cmp_eq_u32 s46,1
s_cbranch_scc1 lw_9
s_cmp_eq_u32 s46,2
s_cbranch_scc1 lw_10
s_cmp_eq_u32 s46,3
s_cbranch_scc1 lw_11
lw_8:
ds_read_b64_tr_b16 a[0:1],v12 offset:0
ds_read_b64_tr_b16 a[2:3],v12 offset:768
ds_read_b64_tr_b16 a[4:5],v12 offset:6144
ds_read_b64_tr_b16 a[6:7],v12 offset:6912
ds_read_b64_tr_b16 a[8:9],v12 offset:32
ds_read_b64_tr_b16 a[10:11],v12 offset:800
ds_read_b64_tr_b16 a[12:13],v12 offset:6176
ds_read_b64_tr_b16 a[14:15],v12 offset:6944
ds_read_b64_tr_b16 a[16:17],v12 offset:64
ds_read_b64_tr_b16 a[18:19],v12 offset:832
ds_read_b64_tr_b16 a[20:21],v12 offset:6208
ds_read_b64_tr_b16 a[22:23],v12 offset:6976
s_branch ld_7
lw_9:
ds_read_b64_tr_b16 a[240:241],v12 offset:0
ds_read_b64_tr_b16 a[242:243],v12 offset:768
ds_read_b64_tr_b16 a[244:245],v12 offset:6144
ds_read_b64_tr_b16 a[246:247],v12 offset:6912
ds_read_b64_tr_b16 a[248:249],v12 offset:32
ds_read_b64_tr_b16 a[250:251],v12 offset:800
ds_read_b64_tr_b16 a[252:253],v12 offset:6176
ds_read_b64_tr_b16 a[254:255],v12 offset:6944
ds_read_b64_tr_b16 v[112:113],v12 offset:64
ds_read_b64_tr_b16 v[114:115],v12 offset:832
ds_read_b64_tr_b16 v[116:117],v12 offset:6208
ds_read_b64_tr_b16 v[118:119],v12 offset:6976
s_branch ld_7
lw_10:
ds_read_b64_tr_b16 a[160:161],v12 offset:0
ds_read_b64_tr_b16 a[162:163],v12 offset:768
ds_read_b64_tr_b16 a[164:165],v12 offset:6144
ds_read_b64_tr_b16 a[166:167],v12 offset:6912
ds_read_b64_tr_b16 a[168:169],v12 offset:32
ds_read_b64_tr_b16 a[170:171],v12 offset:800
ds_read_b64_tr_b16 a[172:173],v12 offset:6176
ds_read_b64_tr_b16 a[174:175],v12 offset:6944
ds_read_b64_tr_b16 a[176:177],v12 offset:64
ds_read_b64_tr_b16 a[178:179],v12 offset:832
ds_read_b64_tr_b16 a[180:181],v12 offset:6208
ds_read_b64_tr_b16 a[182:183],v12 offset:6976
s_branch ld_7
lw_11:
ds_read_b64_tr_b16 a[80:81],v12 offset:0
ds_read_b64_tr_b16 a[82:83],v12 offset:768
ds_read_b64_tr_b16 a[84:85],v12 offset:6144
ds_read_b64_tr_b16 a[86:87],v12 offset:6912
ds_read_b64_tr_b16 a[88:89],v12 offset:32
ds_read_b64_tr_b16 a[90:91],v12 offset:800
ds_read_b64_tr_b16 a[92:93],v12 offset:6176
ds_read_b64_tr_b16 a[94:95],v12 offset:6944
ds_read_b64_tr_b16 a[96:97],v12 offset:64
ds_read_b64_tr_b16 a[98:99],v12 offset:832
ds_read_b64_tr_b16 a[100:101],v12 offset:6208
ds_read_b64_tr_b16 a[102:103],v12 offset:6976
ld_7:
s_waitcnt lgkmcnt(0)
s_waitcnt vmcnt(24)
s_barrier
s_add_u32 s60,s75,s73
s_add_u32 m0,s77,0
s_add_u32 s61,s60,2752512
buffer_load_dwordx4 v104,s[4:7],s61 offen lds
s_add_u32 m0,s77,1024
s_add_u32 s61,s60,2752512
buffer_load_dwordx4 v105,s[4:7],s61 offen lds
s_add_u32 m0,s77,2048
s_add_u32 s61,s60,2752512
buffer_load_dwordx4 v106,s[4:7],s61 offen lds
s_add_u32 m0,s77,3072
s_add_u32 s61,s60,2850816
buffer_load_dwordx4 v104,s[4:7],s61 offen lds
s_add_u32 m0,s77,4096
s_add_u32 s61,s60,2850816
buffer_load_dwordx4 v105,s[4:7],s61 offen lds
s_add_u32 m0,s77,5120
s_add_u32 s61,s60,2850816
buffer_load_dwordx4 v106,s[4:7],s61 offen lds
v_add_u32 v12,24576,v107
s_cmp_eq_u32 s46,1
s_cbranch_scc1 lw_14
s_cmp_eq_u32 s46,2
s_cbranch_scc1 lw_15
s_cmp_eq_u32 s46,3
s_cbranch_scc1 lw_16
lw_13:
ds_read_b64_tr_b16 a[24:25],v12 offset:0
ds_read_b64_tr_b16 a[26:27],v12 offset:768
ds_read_b64_tr_b16 a[28:29],v12 offset:6144
ds_read_b64_tr_b16 a[30:31],v12 offset:6912
ds_read_b64_tr_b16 a[32:33],v12 offset:32
ds_read_b64_tr_b16 a[34:35],v12 offset:800
ds_read_b64_tr_b16 a[36:37],v12 offset:6176
ds_read_b64_tr_b16 a[38:39],v12 offset:6944
ds_read_b64_tr_b16 v[24:25],v12 offset:64
ds_read_b64_tr_b16 v[26:27],v12 offset:832
ds_read_b64_tr_b16 v[28:29],v12 offset:6208
ds_read_b64_tr_b16 v[30:31],v12 offset:6976
s_branch ld_12
lw_14:
ds_read_b64_tr_b16 v[120:121],v12 offset:0
ds_read_b64_tr_b16 v[122:123],v12 offset:768
ds_read_b64_tr_b16 v[124:125],v12 offset:6144
ds_read_b64_tr_b16 v[126:127],v12 offset:6912
ds_read_b64_tr_b16 v[128:129],v12 offset:32
ds_read_b64_tr_b16 v[130:131],v12 offset:800
ds_read_b64_tr_b16 v[132:133],v12 offset:6176
ds_read_b64_tr_b16 v[134:135],v12 offset:6944
ds_read_b64_tr_b16 v[72:73],v12 offset:64
ds_read_b64_tr_b16 v[74:75],v12 offset:832
ds_read_b64_tr_b16 v[76:77],v12 offset:6208
ds_read_b64_tr_b16 v[78:79],v12 offset:6976
s_branch ld_12
lw_15:
ds_read_b64_tr_b16 a[184:185],v12 offset:0
ds_read_b64_tr_b16 a[186:187],v12 offset:768
ds_read_b64_tr_b16 a[188:189],v12 offset:6144
ds_read_b64_tr_b16 a[190:191],v12 offset:6912
ds_read_b64_tr_b16 a[192:193],v12 offset:32
ds_read_b64_tr_b16 a[194:195],v12 offset:800
ds_read_b64_tr_b16 a[196:197],v12 offset:6176
ds_read_b64_tr_b16 a[198:199],v12 offset:6944
ds_read_b64_tr_b16 v[56:57],v12 offset:64
ds_read_b64_tr_b16 v[58:59],v12 offset:832
ds_read_b64_tr_b16 v[60:61],v12 offset:6208
ds_read_b64_tr_b16 v[62:63],v12 offset:6976
s_branch ld_12
lw_16:
ds_read_b64_tr_b16 a[104:105],v12 offset:0
ds_read_b64_tr_b16 a[106:107],v12 offset:768
ds_read_b64_tr_b16 a[108:109],v12 offset:6144
ds_read_b64_tr_b16 a[110:111],v12 offset:6912
ds_read_b64_tr_b16 a[112:113],v12 offset:32
ds_read_b64_tr_b16 a[114:115],v12 offset:800
ds_read_b64_tr_b16 a[116:117],v12 offset:6176
ds_read_b64_tr_b16 a[118:119],v12 offset:6944
ds_read_b64_tr_b16 v[40:41],v12 offset:64
ds_read_b64_tr_b16 v[42:43],v12 offset:832
ds_read_b64_tr_b16 v[44:45],v12 offset:6208
ds_read_b64_tr_b16 v[46:47],v12 offset:6976
ld_12:
s_waitcnt lgkmcnt(0)
s_waitcnt vmcnt(24)
s_barrier
s_add_u32 s60,s75,s74
s_add_u32 m0,s77,24576
s_add_u32 s61,s60,2752512
buffer_load_dwordx4 v104,s[52:55],s61 offen lds
s_add_u32 m0,s77,25600
s_add_u32 s61,s60,2752512
buffer_load_dwordx4 v105,s[52:55],s61 offen lds
s_add_u32 m0,s77,26624
s_add_u32 s61,s60,2752512
buffer_load_dwordx4 v106,s[52:55],s61 offen lds
s_add_u32 m0,s77,27648
s_add_u32 s61,s60,2850816
buffer_load_dwordx4 v104,s[52:55],s61 offen lds
s_add_u32 m0,s77,28672
s_add_u32 s61,s60,2850816
buffer_load_dwordx4 v105,s[52:55],s61 offen lds
s_add_u32 m0,s77,29696
s_add_u32 s61,s60,2850816
buffer_load_dwordx4 v106,s[52:55],s61 offen lds
v_add_u32 v12,49152,v107
s_cmp_eq_u32 s46,1
s_cbranch_scc1 lw_19
s_cmp_eq_u32 s46,2
s_cbranch_scc1 lw_20
s_cmp_eq_u32 s46,3
s_cbranch_scc1 lw_21
lw_18:
ds_read_b64_tr_b16 a[40:41],v12 offset:0
ds_read_b64_tr_b16 a[42:43],v12 offset:768
ds_read_b64_tr_b16 a[44:45],v12 offset:6144
ds_read_b64_tr_b16 a[46:47],v12 offset:6912
ds_read_b64_tr_b16 a[48:49],v12 offset:32
ds_read_b64_tr_b16 a[50:51],v12 offset:800
ds_read_b64_tr_b16 a[52:53],v12 offset:6176
ds_read_b64_tr_b16 a[54:55],v12 offset:6944
ds_read_b64_tr_b16 a[56:57],v12 offset:64
ds_read_b64_tr_b16 a[58:59],v12 offset:832
ds_read_b64_tr_b16 a[60:61],v12 offset:6208
ds_read_b64_tr_b16 a[62:63],v12 offset:6976
s_branch ld_17
lw_19:
ds_read_b64_tr_b16 v[136:137],v12 offset:0
ds_read_b64_tr_b16 v[138:139],v12 offset:768
ds_read_b64_tr_b16 v[140:141],v12 offset:6144
ds_read_b64_tr_b16 v[142:143],v12 offset:6912
ds_read_b64_tr_b16 v[144:145],v12 offset:32
ds_read_b64_tr_b16 v[146:147],v12 offset:800
ds_read_b64_tr_b16 v[148:149],v12 offset:6176
ds_read_b64_tr_b16 v[150:151],v12 offset:6944
ds_read_b64_tr_b16 v[152:153],v12 offset:64
ds_read_b64_tr_b16 v[154:155],v12 offset:832
ds_read_b64_tr_b16 v[156:157],v12 offset:6208
ds_read_b64_tr_b16 v[158:159],v12 offset:6976
s_branch ld_17
lw_20:
ds_read_b64_tr_b16 a[200:201],v12 offset:0
ds_read_b64_tr_b16 a[202:203],v12 offset:768
ds_read_b64_tr_b16 a[204:205],v12 offset:6144
ds_read_b64_tr_b16 a[206:207],v12 offset:6912
ds_read_b64_tr_b16 a[208:209],v12 offset:32
ds_read_b64_tr_b16 a[210:211],v12 offset:800
ds_read_b64_tr_b16 a[212:213],v12 offset:6176
ds_read_b64_tr_b16 a[214:215],v12 offset:6944
ds_read_b64_tr_b16 a[216:217],v12 offset:64
ds_read_b64_tr_b16 a[218:219],v12 offset:832
ds_read_b64_tr_b16 a[220:221],v12 offset:6208
ds_read_b64_tr_b16 a[222:223],v12 offset:6976
s_branch ld_17
lw_21:
ds_read_b64_tr_b16 a[120:121],v12 offset:0
ds_read_b64_tr_b16 a[122:123],v12 offset:768
ds_read_b64_tr_b16 a[124:125],v12 offset:6144
ds_read_b64_tr_b16 a[126:127],v12 offset:6912
ds_read_b64_tr_b16 a[128:129],v12 offset:32
ds_read_b64_tr_b16 a[130:131],v12 offset:800
ds_read_b64_tr_b16 a[132:133],v12 offset:6176
ds_read_b64_tr_b16 a[134:135],v12 offset:6944
ds_read_b64_tr_b16 a[136:137],v12 offset:64
ds_read_b64_tr_b16 a[138:139],v12 offset:832
ds_read_b64_tr_b16 a[140:141],v12 offset:6208
ds_read_b64_tr_b16 a[142:143],v12 offset:6976
ld_17:
s_waitcnt lgkmcnt(0)
s_waitcnt vmcnt(24)
s_barrier
s_add_u32 s60,s75,s73
s_add_u32 m0,s77,49152
s_add_u32 s61,s60,3932160
buffer_load_dwordx4 v104,s[4:7],s61 offen lds
s_add_u32 m0,s77,50176
s_add_u32 s61,s60,3932160
buffer_load_dwordx4 v105,s[4:7],s61 offen lds
s_add_u32 m0,s77,51200
s_add_u32 s61,s60,3932160
buffer_load_dwordx4 v106,s[4:7],s61 offen lds
s_add_u32 m0,s77,52224
s_add_u32 s61,s60,4030464
buffer_load_dwordx4 v104,s[4:7],s61 offen lds
s_add_u32 m0,s77,53248
s_add_u32 s61,s60,4030464
buffer_load_dwordx4 v105,s[4:7],s61 offen lds
s_add_u32 m0,s77,54272
s_add_u32 s61,s60,4030464
buffer_load_dwordx4 v106,s[4:7],s61 offen lds
v_add_u32 v12,73728,v107
s_cmp_eq_u32 s46,1
s_cbranch_scc1 lw_24
s_cmp_eq_u32 s46,2
s_cbranch_scc1 lw_25
s_cmp_eq_u32 s46,3
s_cbranch_scc1 lw_26
lw_23:
ds_read_b64_tr_b16 a[64:65],v12 offset:0
ds_read_b64_tr_b16 a[66:67],v12 offset:768
ds_read_b64_tr_b16 a[68:69],v12 offset:6144
ds_read_b64_tr_b16 a[70:71],v12 offset:6912
ds_read_b64_tr_b16 a[72:73],v12 offset:32
ds_read_b64_tr_b16 a[74:75],v12 offset:800
ds_read_b64_tr_b16 a[76:77],v12 offset:6176
ds_read_b64_tr_b16 a[78:79],v12 offset:6944
ds_read_b64_tr_b16 v[32:33],v12 offset:64
ds_read_b64_tr_b16 v[34:35],v12 offset:832
ds_read_b64_tr_b16 v[36:37],v12 offset:6208
ds_read_b64_tr_b16 v[38:39],v12 offset:6976
s_branch ld_22
lw_24:
ds_read_b64_tr_b16 v[160:161],v12 offset:0
ds_read_b64_tr_b16 v[162:163],v12 offset:768
ds_read_b64_tr_b16 v[164:165],v12 offset:6144
ds_read_b64_tr_b16 v[166:167],v12 offset:6912
ds_read_b64_tr_b16 v[168:169],v12 offset:32
ds_read_b64_tr_b16 v[170:171],v12 offset:800
ds_read_b64_tr_b16 v[172:173],v12 offset:6176
ds_read_b64_tr_b16 v[174:175],v12 offset:6944
ds_read_b64_tr_b16 v[80:81],v12 offset:64
ds_read_b64_tr_b16 v[82:83],v12 offset:832
ds_read_b64_tr_b16 v[84:85],v12 offset:6208
ds_read_b64_tr_b16 v[86:87],v12 offset:6976
s_branch ld_22
lw_25:
ds_read_b64_tr_b16 a[224:225],v12 offset:0
ds_read_b64_tr_b16 a[226:227],v12 offset:768
ds_read_b64_tr_b16 a[228:229],v12 offset:6144
ds_read_b64_tr_b16 a[230:231],v12 offset:6912
ds_read_b64_tr_b16 a[232:233],v12 offset:32
ds_read_b64_tr_b16 a[234:235],v12 offset:800
ds_read_b64_tr_b16 a[236:237],v12 offset:6176
ds_read_b64_tr_b16 a[238:239],v12 offset:6944
ds_read_b64_tr_b16 v[64:65],v12 offset:64
ds_read_b64_tr_b16 v[66:67],v12 offset:832
ds_read_b64_tr_b16 v[68:69],v12 offset:6208
ds_read_b64_tr_b16 v[70:71],v12 offset:6976
s_branch ld_22
lw_26:
ds_read_b64_tr_b16 a[144:145],v12 offset:0
ds_read_b64_tr_b16 a[146:147],v12 offset:768
ds_read_b64_tr_b16 a[148:149],v12 offset:6144
ds_read_b64_tr_b16 a[150:151],v12 offset:6912
ds_read_b64_tr_b16 a[152:153],v12 offset:32
ds_read_b64_tr_b16 a[154:155],v12 offset:800
ds_read_b64_tr_b16 a[156:157],v12 offset:6176
ds_read_b64_tr_b16 a[158:159],v12 offset:6944
ds_read_b64_tr_b16 v[48:49],v12 offset:64
ds_read_b64_tr_b16 v[50:51],v12 offset:832
ds_read_b64_tr_b16 v[52:53],v12 offset:6208
ds_read_b64_tr_b16 v[54:55],v12 offset:6976
ld_22:
s_waitcnt lgkmcnt(0)
s_waitcnt vmcnt(24)
s_barrier
s_add_u32 s60,s75,s74
s_add_u32 m0,s77,73728
s_add_u32 s61,s60,3932160
buffer_load_dwordx4 v104,s[52:55],s61 offen lds
s_add_u32 m0,s77,74752
s_add_u32 s61,s60,3932160
buffer_load_dwordx4 v105,s[52:55],s61 offen lds
s_add_u32 m0,s77,75776
s_add_u32 s61,s60,3932160
buffer_load_dwordx4 v106,s[52:55],s61 offen lds
s_add_u32 m0,s77,76800
s_add_u32 s61,s60,4030464
buffer_load_dwordx4 v104,s[52:55],s61 offen lds
s_add_u32 m0,s77,77824
s_add_u32 s61,s60,4030464
buffer_load_dwordx4 v105,s[52:55],s61 offen lds
s_add_u32 m0,s77,78848
s_add_u32 s61,s60,4030464
buffer_load_dwordx4 v106,s[52:55],s61 offen lds
v_add_u32 v12,98304,v107
s_cmp_eq_u32 s46,1
s_cbranch_scc1 lw_29
s_cmp_eq_u32 s46,2
s_cbranch_scc1 lw_30
s_cmp_eq_u32 s46,3
s_cbranch_scc1 lw_31
lw_28:
ds_read_b64_tr_b16 a[80:81],v12 offset:0
ds_read_b64_tr_b16 a[82:83],v12 offset:768
ds_read_b64_tr_b16 a[84:85],v12 offset:6144
ds_read_b64_tr_b16 a[86:87],v12 offset:6912
ds_read_b64_tr_b16 a[88:89],v12 offset:32
ds_read_b64_tr_b16 a[90:91],v12 offset:800
ds_read_b64_tr_b16 a[92:93],v12 offset:6176
ds_read_b64_tr_b16 a[94:95],v12 offset:6944
ds_read_b64_tr_b16 a[96:97],v12 offset:64
ds_read_b64_tr_b16 a[98:99],v12 offset:832
ds_read_b64_tr_b16 a[100:101],v12 offset:6208
ds_read_b64_tr_b16 a[102:103],v12 offset:6976
s_branch ld_27
lw_29:
ds_read_b64_tr_b16 a[0:1],v12 offset:0
ds_read_b64_tr_b16 a[2:3],v12 offset:768
ds_read_b64_tr_b16 a[4:5],v12 offset:6144
ds_read_b64_tr_b16 a[6:7],v12 offset:6912
ds_read_b64_tr_b16 a[8:9],v12 offset:32
ds_read_b64_tr_b16 a[10:11],v12 offset:800
ds_read_b64_tr_b16 a[12:13],v12 offset:6176
ds_read_b64_tr_b16 a[14:15],v12 offset:6944
ds_read_b64_tr_b16 a[16:17],v12 offset:64
ds_read_b64_tr_b16 a[18:19],v12 offset:832
ds_read_b64_tr_b16 a[20:21],v12 offset:6208
ds_read_b64_tr_b16 a[22:23],v12 offset:6976
s_branch ld_27
lw_30:
ds_read_b64_tr_b16 a[240:241],v12 offset:0
ds_read_b64_tr_b16 a[242:243],v12 offset:768
ds_read_b64_tr_b16 a[244:245],v12 offset:6144
ds_read_b64_tr_b16 a[246:247],v12 offset:6912
ds_read_b64_tr_b16 a[248:249],v12 offset:32
ds_read_b64_tr_b16 a[250:251],v12 offset:800
ds_read_b64_tr_b16 a[252:253],v12 offset:6176
ds_read_b64_tr_b16 a[254:255],v12 offset:6944
ds_read_b64_tr_b16 v[112:113],v12 offset:64
ds_read_b64_tr_b16 v[114:115],v12 offset:832
ds_read_b64_tr_b16 v[116:117],v12 offset:6208
ds_read_b64_tr_b16 v[118:119],v12 offset:6976
s_branch ld_27
lw_31:
ds_read_b64_tr_b16 a[160:161],v12 offset:0
ds_read_b64_tr_b16 a[162:163],v12 offset:768
ds_read_b64_tr_b16 a[164:165],v12 offset:6144
ds_read_b64_tr_b16 a[166:167],v12 offset:6912
ds_read_b64_tr_b16 a[168:169],v12 offset:32
ds_read_b64_tr_b16 a[170:171],v12 offset:800
ds_read_b64_tr_b16 a[172:173],v12 offset:6176
ds_read_b64_tr_b16 a[174:175],v12 offset:6944
ds_read_b64_tr_b16 a[176:177],v12 offset:64
ds_read_b64_tr_b16 a[178:179],v12 offset:832
ds_read_b64_tr_b16 a[180:181],v12 offset:6208
ds_read_b64_tr_b16 a[182:183],v12 offset:6976
ld_27:
s_waitcnt lgkmcnt(0)
s_waitcnt vmcnt(24)
s_barrier
s_add_u32 s60,s75,s73
s_add_u32 m0,s77,98304
s_add_u32 s61,s60,4718592
buffer_load_dwordx4 v104,s[4:7],s61 offen lds
s_add_u32 m0,s77,99328
s_add_u32 s61,s60,4718592
buffer_load_dwordx4 v105,s[4:7],s61 offen lds
s_add_u32 m0,s77,100352
s_add_u32 s61,s60,4718592
buffer_load_dwordx4 v106,s[4:7],s61 offen lds
s_add_u32 m0,s77,101376
s_add_u32 s61,s60,4816896
buffer_load_dwordx4 v104,s[4:7],s61 offen lds
s_add_u32 m0,s77,102400
s_add_u32 s61,s60,4816896
buffer_load_dwordx4 v105,s[4:7],s61 offen lds
s_add_u32 m0,s77,103424
s_add_u32 s61,s60,4816896
buffer_load_dwordx4 v106,s[4:7],s61 offen lds
v_add_u32 v12,122880,v107
s_cmp_eq_u32 s46,1
s_cbranch_scc1 lw_34
s_cmp_eq_u32 s46,2
s_cbranch_scc1 lw_35
s_cmp_eq_u32 s46,3
s_cbranch_scc1 lw_36
lw_33:
ds_read_b64_tr_b16 a[104:105],v12 offset:0
ds_read_b64_tr_b16 a[106:107],v12 offset:768
ds_read_b64_tr_b16 a[108:109],v12 offset:6144
ds_read_b64_tr_b16 a[110:111],v12 offset:6912
ds_read_b64_tr_b16 a[112:113],v12 offset:32
ds_read_b64_tr_b16 a[114:115],v12 offset:800
ds_read_b64_tr_b16 a[116:117],v12 offset:6176
ds_read_b64_tr_b16 a[118:119],v12 offset:6944
ds_read_b64_tr_b16 v[40:41],v12 offset:64
ds_read_b64_tr_b16 v[42:43],v12 offset:832
ds_read_b64_tr_b16 v[44:45],v12 offset:6208
ds_read_b64_tr_b16 v[46:47],v12 offset:6976
s_branch ld_32
lw_34:
ds_read_b64_tr_b16 a[24:25],v12 offset:0
ds_read_b64_tr_b16 a[26:27],v12 offset:768
ds_read_b64_tr_b16 a[28:29],v12 offset:6144
ds_read_b64_tr_b16 a[30:31],v12 offset:6912
ds_read_b64_tr_b16 a[32:33],v12 offset:32
ds_read_b64_tr_b16 a[34:35],v12 offset:800
ds_read_b64_tr_b16 a[36:37],v12 offset:6176
ds_read_b64_tr_b16 a[38:39],v12 offset:6944
ds_read_b64_tr_b16 v[24:25],v12 offset:64
ds_read_b64_tr_b16 v[26:27],v12 offset:832
ds_read_b64_tr_b16 v[28:29],v12 offset:6208
ds_read_b64_tr_b16 v[30:31],v12 offset:6976
s_branch ld_32
lw_35:
ds_read_b64_tr_b16 v[120:121],v12 offset:0
ds_read_b64_tr_b16 v[122:123],v12 offset:768
ds_read_b64_tr_b16 v[124:125],v12 offset:6144
ds_read_b64_tr_b16 v[126:127],v12 offset:6912
ds_read_b64_tr_b16 v[128:129],v12 offset:32
ds_read_b64_tr_b16 v[130:131],v12 offset:800
ds_read_b64_tr_b16 v[132:133],v12 offset:6176
ds_read_b64_tr_b16 v[134:135],v12 offset:6944
ds_read_b64_tr_b16 v[72:73],v12 offset:64
ds_read_b64_tr_b16 v[74:75],v12 offset:832
ds_read_b64_tr_b16 v[76:77],v12 offset:6208
ds_read_b64_tr_b16 v[78:79],v12 offset:6976
s_branch ld_32
lw_36:
ds_read_b64_tr_b16 a[184:185],v12 offset:0
ds_read_b64_tr_b16 a[186:187],v12 offset:768
ds_read_b64_tr_b16 a[188:189],v12 offset:6144
ds_read_b64_tr_b16 a[190:191],v12 offset:6912
ds_read_b64_tr_b16 a[192:193],v12 offset:32
ds_read_b64_tr_b16 a[194:195],v12 offset:800
ds_read_b64_tr_b16 a[196:197],v12 offset:6176
ds_read_b64_tr_b16 a[198:199],v12 offset:6944
ds_read_b64_tr_b16 v[56:57],v12 offset:64
ds_read_b64_tr_b16 v[58:59],v12 offset:832
ds_read_b64_tr_b16 v[60:61],v12 offset:6208
ds_read_b64_tr_b16 v[62:63],v12 offset:6976
ld_32:
s_waitcnt lgkmcnt(0)
s_waitcnt vmcnt(24)
s_barrier
s_add_u32 s60,s75,s74
s_add_u32 m0,s77,122880
s_add_u32 s61,s60,4718592
buffer_load_dwordx4 v104,s[52:55],s61 offen lds
s_add_u32 m0,s77,123904
s_add_u32 s61,s60,4718592
buffer_load_dwordx4 v105,s[52:55],s61 offen lds
s_add_u32 m0,s77,124928
s_add_u32 s61,s60,4718592
buffer_load_dwordx4 v106,s[52:55],s61 offen lds
s_add_u32 m0,s77,125952
s_add_u32 s61,s60,4816896
buffer_load_dwordx4 v104,s[52:55],s61 offen lds
s_add_u32 m0,s77,126976
s_add_u32 s61,s60,4816896
buffer_load_dwordx4 v105,s[52:55],s61 offen lds
s_add_u32 m0,s77,128000
s_add_u32 s61,s60,4816896
buffer_load_dwordx4 v106,s[52:55],s61 offen lds
v_add_u32 v12,0,v107
s_cmp_eq_u32 s46,1
s_cbranch_scc1 lw_39
s_cmp_eq_u32 s46,2
s_cbranch_scc1 lw_40
s_cmp_eq_u32 s46,3
s_cbranch_scc1 lw_41
lw_38:
ds_read_b64_tr_b16 a[120:121],v12 offset:0
ds_read_b64_tr_b16 a[122:123],v12 offset:768
ds_read_b64_tr_b16 a[124:125],v12 offset:6144
ds_read_b64_tr_b16 a[126:127],v12 offset:6912
ds_read_b64_tr_b16 a[128:129],v12 offset:32
ds_read_b64_tr_b16 a[130:131],v12 offset:800
ds_read_b64_tr_b16 a[132:133],v12 offset:6176
ds_read_b64_tr_b16 a[134:135],v12 offset:6944
ds_read_b64_tr_b16 a[136:137],v12 offset:64
ds_read_b64_tr_b16 a[138:139],v12 offset:832
ds_read_b64_tr_b16 a[140:141],v12 offset:6208
ds_read_b64_tr_b16 a[142:143],v12 offset:6976
s_branch ld_37
lw_39:
ds_read_b64_tr_b16 a[40:41],v12 offset:0
ds_read_b64_tr_b16 a[42:43],v12 offset:768
ds_read_b64_tr_b16 a[44:45],v12 offset:6144
ds_read_b64_tr_b16 a[46:47],v12 offset:6912
ds_read_b64_tr_b16 a[48:49],v12 offset:32
ds_read_b64_tr_b16 a[50:51],v12 offset:800
ds_read_b64_tr_b16 a[52:53],v12 offset:6176
ds_read_b64_tr_b16 a[54:55],v12 offset:6944
ds_read_b64_tr_b16 a[56:57],v12 offset:64
ds_read_b64_tr_b16 a[58:59],v12 offset:832
ds_read_b64_tr_b16 a[60:61],v12 offset:6208
ds_read_b64_tr_b16 a[62:63],v12 offset:6976
s_branch ld_37
lw_40:
ds_read_b64_tr_b16 v[136:137],v12 offset:0
ds_read_b64_tr_b16 v[138:139],v12 offset:768
ds_read_b64_tr_b16 v[140:141],v12 offset:6144
ds_read_b64_tr_b16 v[142:143],v12 offset:6912
ds_read_b64_tr_b16 v[144:145],v12 offset:32
ds_read_b64_tr_b16 v[146:147],v12 offset:800
ds_read_b64_tr_b16 v[148:149],v12 offset:6176
ds_read_b64_tr_b16 v[150:151],v12 offset:6944
ds_read_b64_tr_b16 v[152:153],v12 offset:64
ds_read_b64_tr_b16 v[154:155],v12 offset:832
ds_read_b64_tr_b16 v[156:157],v12 offset:6208
ds_read_b64_tr_b16 v[158:159],v12 offset:6976
s_branch ld_37
lw_41:
ds_read_b64_tr_b16 a[200:201],v12 offset:0
ds_read_b64_tr_b16 a[202:203],v12 offset:768
ds_read_b64_tr_b16 a[204:205],v12 offset:6144
ds_read_b64_tr_b16 a[206:207],v12 offset:6912
ds_read_b64_tr_b16 a[208:209],v12 offset:32
ds_read_b64_tr_b16 a[210:211],v12 offset:800
ds_read_b64_tr_b16 a[212:213],v12 offset:6176
ds_read_b64_tr_b16 a[214:215],v12 offset:6944
ds_read_b64_tr_b16 a[216:217],v12 offset:64
ds_read_b64_tr_b16 a[218:219],v12 offset:832
ds_read_b64_tr_b16 a[220:221],v12 offset:6208
ds_read_b64_tr_b16 a[222:223],v12 offset:6976
ld_37:
s_waitcnt lgkmcnt(0)
s_waitcnt vmcnt(24)
s_barrier
s_add_u32 s60,s75,s73
s_add_u32 m0,s77,0
s_add_u32 s61,s60,5898240
buffer_load_dwordx4 v104,s[4:7],s61 offen lds
s_add_u32 m0,s77,1024
s_add_u32 s61,s60,5898240
buffer_load_dwordx4 v105,s[4:7],s61 offen lds
s_add_u32 m0,s77,2048
s_add_u32 s61,s60,5898240
buffer_load_dwordx4 v106,s[4:7],s61 offen lds
s_add_u32 m0,s77,3072
s_add_u32 s61,s60,5996544
buffer_load_dwordx4 v104,s[4:7],s61 offen lds
s_add_u32 m0,s77,4096
s_add_u32 s61,s60,5996544
buffer_load_dwordx4 v105,s[4:7],s61 offen lds
s_add_u32 m0,s77,5120
s_add_u32 s61,s60,5996544
buffer_load_dwordx4 v106,s[4:7],s61 offen lds
v_add_u32 v12,24576,v107
s_cmp_eq_u32 s46,1
s_cbranch_scc1 lw_44
s_cmp_eq_u32 s46,2
s_cbranch_scc1 lw_45
s_cmp_eq_u32 s46,3
s_cbranch_scc1 lw_46
lw_43:
ds_read_b64_tr_b16 a[144:145],v12 offset:0
ds_read_b64_tr_b16 a[146:147],v12 offset:768
ds_read_b64_tr_b16 a[148:149],v12 offset:6144
ds_read_b64_tr_b16 a[150:151],v12 offset:6912
ds_read_b64_tr_b16 a[152:153],v12 offset:32
ds_read_b64_tr_b16 a[154:155],v12 offset:800
ds_read_b64_tr_b16 a[156:157],v12 offset:6176
ds_read_b64_tr_b16 a[158:159],v12 offset:6944
ds_read_b64_tr_b16 v[48:49],v12 offset:64
ds_read_b64_tr_b16 v[50:51],v12 offset:832
ds_read_b64_tr_b16 v[52:53],v12 offset:6208
ds_read_b64_tr_b16 v[54:55],v12 offset:6976
s_branch ld_42
lw_44:
ds_read_b64_tr_b16 a[64:65],v12 offset:0
ds_read_b64_tr_b16 a[66:67],v12 offset:768
ds_read_b64_tr_b16 a[68:69],v12 offset:6144
ds_read_b64_tr_b16 a[70:71],v12 offset:6912
ds_read_b64_tr_b16 a[72:73],v12 offset:32
ds_read_b64_tr_b16 a[74:75],v12 offset:800
ds_read_b64_tr_b16 a[76:77],v12 offset:6176
ds_read_b64_tr_b16 a[78:79],v12 offset:6944
ds_read_b64_tr_b16 v[32:33],v12 offset:64
ds_read_b64_tr_b16 v[34:35],v12 offset:832
ds_read_b64_tr_b16 v[36:37],v12 offset:6208
ds_read_b64_tr_b16 v[38:39],v12 offset:6976
s_branch ld_42
lw_45:
ds_read_b64_tr_b16 v[160:161],v12 offset:0
ds_read_b64_tr_b16 v[162:163],v12 offset:768
ds_read_b64_tr_b16 v[164:165],v12 offset:6144
ds_read_b64_tr_b16 v[166:167],v12 offset:6912
ds_read_b64_tr_b16 v[168:169],v12 offset:32
ds_read_b64_tr_b16 v[170:171],v12 offset:800
ds_read_b64_tr_b16 v[172:173],v12 offset:6176
ds_read_b64_tr_b16 v[174:175],v12 offset:6944
ds_read_b64_tr_b16 v[80:81],v12 offset:64
ds_read_b64_tr_b16 v[82:83],v12 offset:832
ds_read_b64_tr_b16 v[84:85],v12 offset:6208
ds_read_b64_tr_b16 v[86:87],v12 offset:6976
s_branch ld_42
lw_46:
ds_read_b64_tr_b16 a[224:225],v12 offset:0
ds_read_b64_tr_b16 a[226:227],v12 offset:768
ds_read_b64_tr_b16 a[228:229],v12 offset:6144
ds_read_b64_tr_b16 a[230:231],v12 offset:6912
ds_read_b64_tr_b16 a[232:233],v12 offset:32
ds_read_b64_tr_b16 a[234:235],v12 offset:800
ds_read_b64_tr_b16 a[236:237],v12 offset:6176
ds_read_b64_tr_b16 a[238:239],v12 offset:6944
ds_read_b64_tr_b16 v[64:65],v12 offset:64
ds_read_b64_tr_b16 v[66:67],v12 offset:832
ds_read_b64_tr_b16 v[68:69],v12 offset:6208
ds_read_b64_tr_b16 v[70:71],v12 offset:6976
ld_42:
s_waitcnt lgkmcnt(0)
s_waitcnt vmcnt(24)
s_barrier
s_add_u32 s60,s75,s74
s_add_u32 m0,s77,24576
s_add_u32 s61,s60,5898240
buffer_load_dwordx4 v104,s[52:55],s61 offen lds
s_add_u32 m0,s77,25600
s_add_u32 s61,s60,5898240
buffer_load_dwordx4 v105,s[52:55],s61 offen lds
s_add_u32 m0,s77,26624
s_add_u32 s61,s60,5898240
buffer_load_dwordx4 v106,s[52:55],s61 offen lds
s_add_u32 m0,s77,27648
s_add_u32 s61,s60,5996544
buffer_load_dwordx4 v104,s[52:55],s61 offen lds
s_add_u32 m0,s77,28672
s_add_u32 s61,s60,5996544
buffer_load_dwordx4 v105,s[52:55],s61 offen lds
s_add_u32 m0,s77,29696
s_add_u32 s61,s60,5996544
buffer_load_dwordx4 v106,s[52:55],s61 offen lds
v_add_u32 v12,49152,v107
s_cmp_eq_u32 s46,1
s_cbranch_scc1 lw_49
s_cmp_eq_u32 s46,2
s_cbranch_scc1 lw_50
s_cmp_eq_u32 s46,3
s_cbranch_scc1 lw_51
lw_48:
ds_read_b64_tr_b16 a[160:161],v12 offset:0
ds_read_b64_tr_b16 a[162:163],v12 offset:768
ds_read_b64_tr_b16 a[164:165],v12 offset:6144
ds_read_b64_tr_b16 a[166:167],v12 offset:6912
ds_read_b64_tr_b16 a[168:169],v12 offset:32
ds_read_b64_tr_b16 a[170:171],v12 offset:800
ds_read_b64_tr_b16 a[172:173],v12 offset:6176
ds_read_b64_tr_b16 a[174:175],v12 offset:6944
ds_read_b64_tr_b16 a[176:177],v12 offset:64
ds_read_b64_tr_b16 a[178:179],v12 offset:832
ds_read_b64_tr_b16 a[180:181],v12 offset:6208
ds_read_b64_tr_b16 a[182:183],v12 offset:6976
s_branch ld_47
lw_49:
ds_read_b64_tr_b16 a[80:81],v12 offset:0
ds_read_b64_tr_b16 a[82:83],v12 offset:768
ds_read_b64_tr_b16 a[84:85],v12 offset:6144
ds_read_b64_tr_b16 a[86:87],v12 offset:6912
ds_read_b64_tr_b16 a[88:89],v12 offset:32
ds_read_b64_tr_b16 a[90:91],v12 offset:800
ds_read_b64_tr_b16 a[92:93],v12 offset:6176
ds_read_b64_tr_b16 a[94:95],v12 offset:6944
ds_read_b64_tr_b16 a[96:97],v12 offset:64
ds_read_b64_tr_b16 a[98:99],v12 offset:832
ds_read_b64_tr_b16 a[100:101],v12 offset:6208
ds_read_b64_tr_b16 a[102:103],v12 offset:6976
s_branch ld_47
lw_50:
ds_read_b64_tr_b16 a[0:1],v12 offset:0
ds_read_b64_tr_b16 a[2:3],v12 offset:768
ds_read_b64_tr_b16 a[4:5],v12 offset:6144
ds_read_b64_tr_b16 a[6:7],v12 offset:6912
ds_read_b64_tr_b16 a[8:9],v12 offset:32
ds_read_b64_tr_b16 a[10:11],v12 offset:800
ds_read_b64_tr_b16 a[12:13],v12 offset:6176
ds_read_b64_tr_b16 a[14:15],v12 offset:6944
ds_read_b64_tr_b16 a[16:17],v12 offset:64
ds_read_b64_tr_b16 a[18:19],v12 offset:832
ds_read_b64_tr_b16 a[20:21],v12 offset:6208
ds_read_b64_tr_b16 a[22:23],v12 offset:6976
s_branch ld_47
lw_51:
ds_read_b64_tr_b16 a[240:241],v12 offset:0
ds_read_b64_tr_b16 a[242:243],v12 offset:768
ds_read_b64_tr_b16 a[244:245],v12 offset:6144
ds_read_b64_tr_b16 a[246:247],v12 offset:6912
ds_read_b64_tr_b16 a[248:249],v12 offset:32
ds_read_b64_tr_b16 a[250:251],v12 offset:800
ds_read_b64_tr_b16 a[252:253],v12 offset:6176
ds_read_b64_tr_b16 a[254:255],v12 offset:6944
ds_read_b64_tr_b16 v[112:113],v12 offset:64
ds_read_b64_tr_b16 v[114:115],v12 offset:832
ds_read_b64_tr_b16 v[116:117],v12 offset:6208
ds_read_b64_tr_b16 v[118:119],v12 offset:6976
ld_47:
s_waitcnt lgkmcnt(0)
s_waitcnt vmcnt(24)
s_barrier
s_add_u32 s60,s75,s73
s_add_u32 m0,s77,49152
s_add_u32 s61,s60,6684672
buffer_load_dwordx4 v104,s[4:7],s61 offen lds
s_add_u32 m0,s77,50176
s_add_u32 s61,s60,6684672
buffer_load_dwordx4 v105,s[4:7],s61 offen lds
s_add_u32 m0,s77,51200
s_add_u32 s61,s60,6684672
buffer_load_dwordx4 v106,s[4:7],s61 offen lds
s_add_u32 m0,s77,52224
s_add_u32 s61,s60,6782976
buffer_load_dwordx4 v104,s[4:7],s61 offen lds
s_add_u32 m0,s77,53248
s_add_u32 s61,s60,6782976
buffer_load_dwordx4 v105,s[4:7],s61 offen lds
s_add_u32 m0,s77,54272
s_add_u32 s61,s60,6782976
buffer_load_dwordx4 v106,s[4:7],s61 offen lds
v_add_u32 v12,73728,v107
s_cmp_eq_u32 s46,1
s_cbranch_scc1 lw_54
s_cmp_eq_u32 s46,2
s_cbranch_scc1 lw_55
s_cmp_eq_u32 s46,3
s_cbranch_scc1 lw_56
lw_53:
ds_read_b64_tr_b16 a[184:185],v12 offset:0
ds_read_b64_tr_b16 a[186:187],v12 offset:768
ds_read_b64_tr_b16 a[188:189],v12 offset:6144
ds_read_b64_tr_b16 a[190:191],v12 offset:6912
ds_read_b64_tr_b16 a[192:193],v12 offset:32
ds_read_b64_tr_b16 a[194:195],v12 offset:800
ds_read_b64_tr_b16 a[196:197],v12 offset:6176
ds_read_b64_tr_b16 a[198:199],v12 offset:6944
ds_read_b64_tr_b16 v[56:57],v12 offset:64
ds_read_b64_tr_b16 v[58:59],v12 offset:832
ds_read_b64_tr_b16 v[60:61],v12 offset:6208
ds_read_b64_tr_b16 v[62:63],v12 offset:6976
s_branch ld_52
lw_54:
ds_read_b64_tr_b16 a[104:105],v12 offset:0
ds_read_b64_tr_b16 a[106:107],v12 offset:768
ds_read_b64_tr_b16 a[108:109],v12 offset:6144
ds_read_b64_tr_b16 a[110:111],v12 offset:6912
ds_read_b64_tr_b16 a[112:113],v12 offset:32
ds_read_b64_tr_b16 a[114:115],v12 offset:800
ds_read_b64_tr_b16 a[116:117],v12 offset:6176
ds_read_b64_tr_b16 a[118:119],v12 offset:6944
ds_read_b64_tr_b16 v[40:41],v12 offset:64
ds_read_b64_tr_b16 v[42:43],v12 offset:832
ds_read_b64_tr_b16 v[44:45],v12 offset:6208
ds_read_b64_tr_b16 v[46:47],v12 offset:6976
s_branch ld_52
lw_55:
ds_read_b64_tr_b16 a[24:25],v12 offset:0
ds_read_b64_tr_b16 a[26:27],v12 offset:768
ds_read_b64_tr_b16 a[28:29],v12 offset:6144
ds_read_b64_tr_b16 a[30:31],v12 offset:6912
ds_read_b64_tr_b16 a[32:33],v12 offset:32
ds_read_b64_tr_b16 a[34:35],v12 offset:800
ds_read_b64_tr_b16 a[36:37],v12 offset:6176
ds_read_b64_tr_b16 a[38:39],v12 offset:6944
ds_read_b64_tr_b16 v[24:25],v12 offset:64
ds_read_b64_tr_b16 v[26:27],v12 offset:832
ds_read_b64_tr_b16 v[28:29],v12 offset:6208
ds_read_b64_tr_b16 v[30:31],v12 offset:6976
s_branch ld_52
lw_56:
ds_read_b64_tr_b16 v[120:121],v12 offset:0
ds_read_b64_tr_b16 v[122:123],v12 offset:768
ds_read_b64_tr_b16 v[124:125],v12 offset:6144
ds_read_b64_tr_b16 v[126:127],v12 offset:6912
ds_read_b64_tr_b16 v[128:129],v12 offset:32
ds_read_b64_tr_b16 v[130:131],v12 offset:800
ds_read_b64_tr_b16 v[132:133],v12 offset:6176
ds_read_b64_tr_b16 v[134:135],v12 offset:6944
ds_read_b64_tr_b16 v[72:73],v12 offset:64
ds_read_b64_tr_b16 v[74:75],v12 offset:832
ds_read_b64_tr_b16 v[76:77],v12 offset:6208
ds_read_b64_tr_b16 v[78:79],v12 offset:6976
ld_52:
s_waitcnt lgkmcnt(0)
s_waitcnt vmcnt(24)
s_barrier
s_add_u32 s60,s75,s74
s_add_u32 m0,s77,73728
s_add_u32 s61,s60,6684672
buffer_load_dwordx4 v104,s[52:55],s61 offen lds
s_add_u32 m0,s77,74752
s_add_u32 s61,s60,6684672
buffer_load_dwordx4 v105,s[52:55],s61 offen lds
s_add_u32 m0,s77,75776
s_add_u32 s61,s60,6684672
buffer_load_dwordx4 v106,s[52:55],s61 offen lds
s_add_u32 m0,s77,76800
s_add_u32 s61,s60,6782976
buffer_load_dwordx4 v104,s[52:55],s61 offen lds
s_add_u32 m0,s77,77824
s_add_u32 s61,s60,6782976
buffer_load_dwordx4 v105,s[52:55],s61 offen lds
s_add_u32 m0,s77,78848
s_add_u32 s61,s60,6782976
buffer_load_dwordx4 v106,s[52:55],s61 offen lds
v_add_u32 v12,98304,v107
s_cmp_eq_u32 s46,1
s_cbranch_scc1 lw_59
s_cmp_eq_u32 s46,2
s_cbranch_scc1 lw_60
s_cmp_eq_u32 s46,3
s_cbranch_scc1 lw_61
lw_58:
ds_read_b64_tr_b16 a[200:201],v12 offset:0
ds_read_b64_tr_b16 a[202:203],v12 offset:768
ds_read_b64_tr_b16 a[204:205],v12 offset:6144
ds_read_b64_tr_b16 a[206:207],v12 offset:6912
ds_read_b64_tr_b16 a[208:209],v12 offset:32
ds_read_b64_tr_b16 a[210:211],v12 offset:800
ds_read_b64_tr_b16 a[212:213],v12 offset:6176
ds_read_b64_tr_b16 a[214:215],v12 offset:6944
ds_read_b64_tr_b16 a[216:217],v12 offset:64
ds_read_b64_tr_b16 a[218:219],v12 offset:832
ds_read_b64_tr_b16 a[220:221],v12 offset:6208
ds_read_b64_tr_b16 a[222:223],v12 offset:6976
s_branch ld_57
lw_59:
ds_read_b64_tr_b16 a[120:121],v12 offset:0
ds_read_b64_tr_b16 a[122:123],v12 offset:768
ds_read_b64_tr_b16 a[124:125],v12 offset:6144
ds_read_b64_tr_b16 a[126:127],v12 offset:6912
ds_read_b64_tr_b16 a[128:129],v12 offset:32
ds_read_b64_tr_b16 a[130:131],v12 offset:800
ds_read_b64_tr_b16 a[132:133],v12 offset:6176
ds_read_b64_tr_b16 a[134:135],v12 offset:6944
ds_read_b64_tr_b16 a[136:137],v12 offset:64
ds_read_b64_tr_b16 a[138:139],v12 offset:832
ds_read_b64_tr_b16 a[140:141],v12 offset:6208
ds_read_b64_tr_b16 a[142:143],v12 offset:6976
s_branch ld_57
lw_60:
ds_read_b64_tr_b16 a[40:41],v12 offset:0
ds_read_b64_tr_b16 a[42:43],v12 offset:768
ds_read_b64_tr_b16 a[44:45],v12 offset:6144
ds_read_b64_tr_b16 a[46:47],v12 offset:6912
ds_read_b64_tr_b16 a[48:49],v12 offset:32
ds_read_b64_tr_b16 a[50:51],v12 offset:800
ds_read_b64_tr_b16 a[52:53],v12 offset:6176
ds_read_b64_tr_b16 a[54:55],v12 offset:6944
ds_read_b64_tr_b16 a[56:57],v12 offset:64
ds_read_b64_tr_b16 a[58:59],v12 offset:832
ds_read_b64_tr_b16 a[60:61],v12 offset:6208
ds_read_b64_tr_b16 a[62:63],v12 offset:6976
s_branch ld_57
lw_61:
ds_read_b64_tr_b16 v[136:137],v12 offset:0
ds_read_b64_tr_b16 v[138:139],v12 offset:768
ds_read_b64_tr_b16 v[140:141],v12 offset:6144
ds_read_b64_tr_b16 v[142:143],v12 offset:6912
ds_read_b64_tr_b16 v[144:145],v12 offset:32
ds_read_b64_tr_b16 v[146:147],v12 offset:800
ds_read_b64_tr_b16 v[148:149],v12 offset:6176
ds_read_b64_tr_b16 v[150:151],v12 offset:6944
ds_read_b64_tr_b16 v[152:153],v12 offset:64
ds_read_b64_tr_b16 v[154:155],v12 offset:832
ds_read_b64_tr_b16 v[156:157],v12 offset:6208
ds_read_b64_tr_b16 v[158:159],v12 offset:6976
ld_57:
s_waitcnt lgkmcnt(0)
s_waitcnt vmcnt(24)
s_barrier
s_add_u32 s60,s76,s73
s_add_u32 m0,s77,98304
s_add_u32 s61,s60,1572864
buffer_load_dwordx4 v104,s[4:7],s61 offen lds
s_add_u32 m0,s77,99328
s_add_u32 s61,s60,1572864
buffer_load_dwordx4 v105,s[4:7],s61 offen lds
s_add_u32 m0,s77,100352
s_add_u32 s61,s60,1572864
buffer_load_dwordx4 v106,s[4:7],s61 offen lds
s_add_u32 m0,s77,101376
s_add_u32 s61,s60,1671168
buffer_load_dwordx4 v104,s[4:7],s61 offen lds
s_add_u32 m0,s77,102400
s_add_u32 s61,s60,1671168
buffer_load_dwordx4 v105,s[4:7],s61 offen lds
s_add_u32 m0,s77,103424
s_add_u32 s61,s60,1671168
buffer_load_dwordx4 v106,s[4:7],s61 offen lds
v_add_u32 v12,122880,v107
s_cmp_eq_u32 s46,1
s_cbranch_scc1 lw_64
s_cmp_eq_u32 s46,2
s_cbranch_scc1 lw_65
s_cmp_eq_u32 s46,3
s_cbranch_scc1 lw_66
lw_63:
ds_read_b64_tr_b16 a[224:225],v12 offset:0
ds_read_b64_tr_b16 a[226:227],v12 offset:768
ds_read_b64_tr_b16 a[228:229],v12 offset:6144
ds_read_b64_tr_b16 a[230:231],v12 offset:6912
ds_read_b64_tr_b16 a[232:233],v12 offset:32
ds_read_b64_tr_b16 a[234:235],v12 offset:800
ds_read_b64_tr_b16 a[236:237],v12 offset:6176
ds_read_b64_tr_b16 a[238:239],v12 offset:6944
ds_read_b64_tr_b16 v[64:65],v12 offset:64
ds_read_b64_tr_b16 v[66:67],v12 offset:832
ds_read_b64_tr_b16 v[68:69],v12 offset:6208
ds_read_b64_tr_b16 v[70:71],v12 offset:6976
s_branch ld_62
lw_64:
ds_read_b64_tr_b16 a[144:145],v12 offset:0
ds_read_b64_tr_b16 a[146:147],v12 offset:768
ds_read_b64_tr_b16 a[148:149],v12 offset:6144
ds_read_b64_tr_b16 a[150:151],v12 offset:6912
ds_read_b64_tr_b16 a[152:153],v12 offset:32
ds_read_b64_tr_b16 a[154:155],v12 offset:800
ds_read_b64_tr_b16 a[156:157],v12 offset:6176
ds_read_b64_tr_b16 a[158:159],v12 offset:6944
ds_read_b64_tr_b16 v[48:49],v12 offset:64
ds_read_b64_tr_b16 v[50:51],v12 offset:832
ds_read_b64_tr_b16 v[52:53],v12 offset:6208
ds_read_b64_tr_b16 v[54:55],v12 offset:6976
s_branch ld_62
lw_65:
ds_read_b64_tr_b16 a[64:65],v12 offset:0
ds_read_b64_tr_b16 a[66:67],v12 offset:768
ds_read_b64_tr_b16 a[68:69],v12 offset:6144
ds_read_b64_tr_b16 a[70:71],v12 offset:6912
ds_read_b64_tr_b16 a[72:73],v12 offset:32
ds_read_b64_tr_b16 a[74:75],v12 offset:800
ds_read_b64_tr_b16 a[76:77],v12 offset:6176
ds_read_b64_tr_b16 a[78:79],v12 offset:6944
ds_read_b64_tr_b16 v[32:33],v12 offset:64
ds_read_b64_tr_b16 v[34:35],v12 offset:832
ds_read_b64_tr_b16 v[36:37],v12 offset:6208
ds_read_b64_tr_b16 v[38:39],v12 offset:6976
s_branch ld_62
lw_66:
ds_read_b64_tr_b16 v[160:161],v12 offset:0
ds_read_b64_tr_b16 v[162:163],v12 offset:768
ds_read_b64_tr_b16 v[164:165],v12 offset:6144
ds_read_b64_tr_b16 v[166:167],v12 offset:6912
ds_read_b64_tr_b16 v[168:169],v12 offset:32
ds_read_b64_tr_b16 v[170:171],v12 offset:800
ds_read_b64_tr_b16 v[172:173],v12 offset:6176
ds_read_b64_tr_b16 v[174:175],v12 offset:6944
ds_read_b64_tr_b16 v[80:81],v12 offset:64
ds_read_b64_tr_b16 v[82:83],v12 offset:832
ds_read_b64_tr_b16 v[84:85],v12 offset:6208
ds_read_b64_tr_b16 v[86:87],v12 offset:6976
ld_62:
s_waitcnt lgkmcnt(0)
s_waitcnt vmcnt(24)
s_barrier
s_add_u32 s60,s76,s74
s_add_u32 m0,s77,122880
s_add_u32 s61,s60,1572864
buffer_load_dwordx4 v104,s[52:55],s61 offen lds
s_add_u32 m0,s77,123904
s_add_u32 s61,s60,1572864
buffer_load_dwordx4 v105,s[52:55],s61 offen lds
s_add_u32 m0,s77,124928
s_add_u32 s61,s60,1572864
buffer_load_dwordx4 v106,s[52:55],s61 offen lds
s_add_u32 m0,s77,125952
s_add_u32 s61,s60,1671168
buffer_load_dwordx4 v104,s[52:55],s61 offen lds
s_add_u32 m0,s77,126976
s_add_u32 s61,s60,1671168
buffer_load_dwordx4 v105,s[52:55],s61 offen lds
s_add_u32 m0,s77,128000
s_add_u32 s61,s60,1671168
buffer_load_dwordx4 v106,s[52:55],s61 offen lds
v_add_u32 v12,0,v107
s_cmp_eq_u32 s46,1
s_cbranch_scc1 lw_69
s_cmp_eq_u32 s46,2
s_cbranch_scc1 lw_70
s_cmp_eq_u32 s46,3
s_cbranch_scc1 lw_71
lw_68:
ds_read_b64_tr_b16 a[240:241],v12 offset:0
ds_read_b64_tr_b16 a[242:243],v12 offset:768
ds_read_b64_tr_b16 a[244:245],v12 offset:6144
ds_read_b64_tr_b16 a[246:247],v12 offset:6912
ds_read_b64_tr_b16 a[248:249],v12 offset:32
ds_read_b64_tr_b16 a[250:251],v12 offset:800
ds_read_b64_tr_b16 a[252:253],v12 offset:6176
ds_read_b64_tr_b16 a[254:255],v12 offset:6944
ds_read_b64_tr_b16 v[112:113],v12 offset:64
ds_read_b64_tr_b16 v[114:115],v12 offset:832
ds_read_b64_tr_b16 v[116:117],v12 offset:6208
ds_read_b64_tr_b16 v[118:119],v12 offset:6976
s_branch ld_67
lw_69:
ds_read_b64_tr_b16 a[160:161],v12 offset:0
ds_read_b64_tr_b16 a[162:163],v12 offset:768
ds_read_b64_tr_b16 a[164:165],v12 offset:6144
ds_read_b64_tr_b16 a[166:167],v12 offset:6912
ds_read_b64_tr_b16 a[168:169],v12 offset:32
ds_read_b64_tr_b16 a[170:171],v12 offset:800
ds_read_b64_tr_b16 a[172:173],v12 offset:6176
ds_read_b64_tr_b16 a[174:175],v12 offset:6944
ds_read_b64_tr_b16 a[176:177],v12 offset:64
ds_read_b64_tr_b16 a[178:179],v12 offset:832
ds_read_b64_tr_b16 a[180:181],v12 offset:6208
ds_read_b64_tr_b16 a[182:183],v12 offset:6976
s_branch ld_67
lw_70:
ds_read_b64_tr_b16 a[80:81],v12 offset:0
ds_read_b64_tr_b16 a[82:83],v12 offset:768
ds_read_b64_tr_b16 a[84:85],v12 offset:6144
ds_read_b64_tr_b16 a[86:87],v12 offset:6912
ds_read_b64_tr_b16 a[88:89],v12 offset:32
ds_read_b64_tr_b16 a[90:91],v12 offset:800
ds_read_b64_tr_b16 a[92:93],v12 offset:6176
ds_read_b64_tr_b16 a[94:95],v12 offset:6944
ds_read_b64_tr_b16 a[96:97],v12 offset:64
ds_read_b64_tr_b16 a[98:99],v12 offset:832
ds_read_b64_tr_b16 a[100:101],v12 offset:6208
ds_read_b64_tr_b16 a[102:103],v12 offset:6976
s_branch ld_67
lw_71:
ds_read_b64_tr_b16 a[0:1],v12 offset:0
ds_read_b64_tr_b16 a[2:3],v12 offset:768
ds_read_b64_tr_b16 a[4:5],v12 offset:6144
ds_read_b64_tr_b16 a[6:7],v12 offset:6912
ds_read_b64_tr_b16 a[8:9],v12 offset:32
ds_read_b64_tr_b16 a[10:11],v12 offset:800
ds_read_b64_tr_b16 a[12:13],v12 offset:6176
ds_read_b64_tr_b16 a[14:15],v12 offset:6944
ds_read_b64_tr_b16 a[16:17],v12 offset:64
ds_read_b64_tr_b16 a[18:19],v12 offset:832
ds_read_b64_tr_b16 a[20:21],v12 offset:6208
ds_read_b64_tr_b16 a[22:23],v12 offset:6976
ld_67:
s_waitcnt lgkmcnt(0)
s_waitcnt vmcnt(24)
s_barrier
s_add_u32 s60,s76,s73
s_add_u32 m0,s77,0
s_add_u32 s61,s60,5505024
buffer_load_dwordx4 v104,s[4:7],s61 offen lds
s_add_u32 m0,s77,1024
s_add_u32 s61,s60,5505024
buffer_load_dwordx4 v105,s[4:7],s61 offen lds
s_add_u32 m0,s77,2048
s_add_u32 s61,s60,5505024
buffer_load_dwordx4 v106,s[4:7],s61 offen lds
s_add_u32 m0,s77,3072
s_add_u32 s61,s60,5603328
buffer_load_dwordx4 v104,s[4:7],s61 offen lds
s_add_u32 m0,s77,4096
s_add_u32 s61,s60,5603328
buffer_load_dwordx4 v105,s[4:7],s61 offen lds
s_add_u32 m0,s77,5120
s_add_u32 s61,s60,5603328
buffer_load_dwordx4 v106,s[4:7],s61 offen lds
v_add_u32 v12,24576,v107
s_cmp_eq_u32 s46,1
s_cbranch_scc1 lw_74
s_cmp_eq_u32 s46,2
s_cbranch_scc1 lw_75
s_cmp_eq_u32 s46,3
s_cbranch_scc1 lw_76
lw_73:
ds_read_b64_tr_b16 v[120:121],v12 offset:0
ds_read_b64_tr_b16 v[122:123],v12 offset:768
ds_read_b64_tr_b16 v[124:125],v12 offset:6144
ds_read_b64_tr_b16 v[126:127],v12 offset:6912
ds_read_b64_tr_b16 v[128:129],v12 offset:32
ds_read_b64_tr_b16 v[130:131],v12 offset:800
ds_read_b64_tr_b16 v[132:133],v12 offset:6176
ds_read_b64_tr_b16 v[134:135],v12 offset:6944
ds_read_b64_tr_b16 v[72:73],v12 offset:64
ds_read_b64_tr_b16 v[74:75],v12 offset:832
ds_read_b64_tr_b16 v[76:77],v12 offset:6208
ds_read_b64_tr_b16 v[78:79],v12 offset:6976
s_branch ld_72
lw_74:
ds_read_b64_tr_b16 a[184:185],v12 offset:0
ds_read_b64_tr_b16 a[186:187],v12 offset:768
ds_read_b64_tr_b16 a[188:189],v12 offset:6144
ds_read_b64_tr_b16 a[190:191],v12 offset:6912
ds_read_b64_tr_b16 a[192:193],v12 offset:32
ds_read_b64_tr_b16 a[194:195],v12 offset:800
ds_read_b64_tr_b16 a[196:197],v12 offset:6176
ds_read_b64_tr_b16 a[198:199],v12 offset:6944
ds_read_b64_tr_b16 v[56:57],v12 offset:64
ds_read_b64_tr_b16 v[58:59],v12 offset:832
ds_read_b64_tr_b16 v[60:61],v12 offset:6208
ds_read_b64_tr_b16 v[62:63],v12 offset:6976
s_branch ld_72
lw_75:
ds_read_b64_tr_b16 a[104:105],v12 offset:0
ds_read_b64_tr_b16 a[106:107],v12 offset:768
ds_read_b64_tr_b16 a[108:109],v12 offset:6144
ds_read_b64_tr_b16 a[110:111],v12 offset:6912
ds_read_b64_tr_b16 a[112:113],v12 offset:32
ds_read_b64_tr_b16 a[114:115],v12 offset:800
ds_read_b64_tr_b16 a[116:117],v12 offset:6176
ds_read_b64_tr_b16 a[118:119],v12 offset:6944
ds_read_b64_tr_b16 v[40:41],v12 offset:64
ds_read_b64_tr_b16 v[42:43],v12 offset:832
ds_read_b64_tr_b16 v[44:45],v12 offset:6208
ds_read_b64_tr_b16 v[46:47],v12 offset:6976
s_branch ld_72
lw_76:
ds_read_b64_tr_b16 a[24:25],v12 offset:0
ds_read_b64_tr_b16 a[26:27],v12 offset:768
ds_read_b64_tr_b16 a[28:29],v12 offset:6144
ds_read_b64_tr_b16 a[30:31],v12 offset:6912
ds_read_b64_tr_b16 a[32:33],v12 offset:32
ds_read_b64_tr_b16 a[34:35],v12 offset:800
ds_read_b64_tr_b16 a[36:37],v12 offset:6176
ds_read_b64_tr_b16 a[38:39],v12 offset:6944
ds_read_b64_tr_b16 v[24:25],v12 offset:64
ds_read_b64_tr_b16 v[26:27],v12 offset:832
ds_read_b64_tr_b16 v[28:29],v12 offset:6208
ds_read_b64_tr_b16 v[30:31],v12 offset:6976
ld_72:
s_waitcnt lgkmcnt(0)
s_waitcnt vmcnt(24)
s_barrier
s_add_u32 s60,s76,s74
s_add_u32 m0,s77,24576
s_add_u32 s61,s60,5505024
buffer_load_dwordx4 v104,s[52:55],s61 offen lds
s_add_u32 m0,s77,25600
s_add_u32 s61,s60,5505024
buffer_load_dwordx4 v105,s[52:55],s61 offen lds
s_add_u32 m0,s77,26624
s_add_u32 s61,s60,5505024
buffer_load_dwordx4 v106,s[52:55],s61 offen lds
s_add_u32 m0,s77,27648
s_add_u32 s61,s60,5603328
buffer_load_dwordx4 v104,s[52:55],s61 offen lds
s_add_u32 m0,s77,28672
s_add_u32 s61,s60,5603328
buffer_load_dwordx4 v105,s[52:55],s61 offen lds
s_add_u32 m0,s77,29696
s_add_u32 s61,s60,5603328
buffer_load_dwordx4 v106,s[52:55],s61 offen lds
v_add_u32 v12,49152,v107
s_cmp_eq_u32 s46,1
s_cbranch_scc1 lw_79
s_cmp_eq_u32 s46,2
s_cbranch_scc1 lw_80
s_cmp_eq_u32 s46,3
s_cbranch_scc1 lw_81
lw_78:
ds_read_b64_tr_b16 v[136:137],v12 offset:0
ds_read_b64_tr_b16 v[138:139],v12 offset:768
ds_read_b64_tr_b16 v[140:141],v12 offset:6144
ds_read_b64_tr_b16 v[142:143],v12 offset:6912
ds_read_b64_tr_b16 v[144:145],v12 offset:32
ds_read_b64_tr_b16 v[146:147],v12 offset:800
ds_read_b64_tr_b16 v[148:149],v12 offset:6176
ds_read_b64_tr_b16 v[150:151],v12 offset:6944
ds_read_b64_tr_b16 v[152:153],v12 offset:64
ds_read_b64_tr_b16 v[154:155],v12 offset:832
ds_read_b64_tr_b16 v[156:157],v12 offset:6208
ds_read_b64_tr_b16 v[158:159],v12 offset:6976
s_branch ld_77
lw_79:
ds_read_b64_tr_b16 a[200:201],v12 offset:0
ds_read_b64_tr_b16 a[202:203],v12 offset:768
ds_read_b64_tr_b16 a[204:205],v12 offset:6144
ds_read_b64_tr_b16 a[206:207],v12 offset:6912
ds_read_b64_tr_b16 a[208:209],v12 offset:32
ds_read_b64_tr_b16 a[210:211],v12 offset:800
ds_read_b64_tr_b16 a[212:213],v12 offset:6176
ds_read_b64_tr_b16 a[214:215],v12 offset:6944
ds_read_b64_tr_b16 a[216:217],v12 offset:64
ds_read_b64_tr_b16 a[218:219],v12 offset:832
ds_read_b64_tr_b16 a[220:221],v12 offset:6208
ds_read_b64_tr_b16 a[222:223],v12 offset:6976
s_branch ld_77
lw_80:
ds_read_b64_tr_b16 a[120:121],v12 offset:0
ds_read_b64_tr_b16 a[122:123],v12 offset:768
ds_read_b64_tr_b16 a[124:125],v12 offset:6144
ds_read_b64_tr_b16 a[126:127],v12 offset:6912
ds_read_b64_tr_b16 a[128:129],v12 offset:32
ds_read_b64_tr_b16 a[130:131],v12 offset:800
ds_read_b64_tr_b16 a[132:133],v12 offset:6176
ds_read_b64_tr_b16 a[134:135],v12 offset:6944
ds_read_b64_tr_b16 a[136:137],v12 offset:64
ds_read_b64_tr_b16 a[138:139],v12 offset:832
ds_read_b64_tr_b16 a[140:141],v12 offset:6208
ds_read_b64_tr_b16 a[142:143],v12 offset:6976
s_branch ld_77
lw_81:
ds_read_b64_tr_b16 a[40:41],v12 offset:0
ds_read_b64_tr_b16 a[42:43],v12 offset:768
ds_read_b64_tr_b16 a[44:45],v12 offset:6144
ds_read_b64_tr_b16 a[46:47],v12 offset:6912
ds_read_b64_tr_b16 a[48:49],v12 offset:32
ds_read_b64_tr_b16 a[50:51],v12 offset:800
ds_read_b64_tr_b16 a[52:53],v12 offset:6176
ds_read_b64_tr_b16 a[54:55],v12 offset:6944
ds_read_b64_tr_b16 a[56:57],v12 offset:64
ds_read_b64_tr_b16 a[58:59],v12 offset:832
ds_read_b64_tr_b16 a[60:61],v12 offset:6208
ds_read_b64_tr_b16 a[62:63],v12 offset:6976
ld_77:
s_waitcnt lgkmcnt(0)
s_waitcnt vmcnt(24)
s_barrier
v_add_u32 v12,73728,v107
s_cmp_eq_u32 s46,1
s_cbranch_scc1 lw_84
s_cmp_eq_u32 s46,2
s_cbranch_scc1 lw_85
s_cmp_eq_u32 s46,3
s_cbranch_scc1 lw_86
lw_83:
ds_read_b64_tr_b16 v[160:161],v12 offset:0
ds_read_b64_tr_b16 v[162:163],v12 offset:768
ds_read_b64_tr_b16 v[164:165],v12 offset:6144
ds_read_b64_tr_b16 v[166:167],v12 offset:6912
ds_read_b64_tr_b16 v[168:169],v12 offset:32
ds_read_b64_tr_b16 v[170:171],v12 offset:800
ds_read_b64_tr_b16 v[172:173],v12 offset:6176
ds_read_b64_tr_b16 v[174:175],v12 offset:6944
ds_read_b64_tr_b16 v[80:81],v12 offset:64
ds_read_b64_tr_b16 v[82:83],v12 offset:832
ds_read_b64_tr_b16 v[84:85],v12 offset:6208
ds_read_b64_tr_b16 v[86:87],v12 offset:6976
s_branch ld_82
lw_84:
ds_read_b64_tr_b16 a[224:225],v12 offset:0
ds_read_b64_tr_b16 a[226:227],v12 offset:768
ds_read_b64_tr_b16 a[228:229],v12 offset:6144
ds_read_b64_tr_b16 a[230:231],v12 offset:6912
ds_read_b64_tr_b16 a[232:233],v12 offset:32
ds_read_b64_tr_b16 a[234:235],v12 offset:800
ds_read_b64_tr_b16 a[236:237],v12 offset:6176
ds_read_b64_tr_b16 a[238:239],v12 offset:6944
ds_read_b64_tr_b16 v[64:65],v12 offset:64
ds_read_b64_tr_b16 v[66:67],v12 offset:832
ds_read_b64_tr_b16 v[68:69],v12 offset:6208
ds_read_b64_tr_b16 v[70:71],v12 offset:6976
s_branch ld_82
lw_85:
ds_read_b64_tr_b16 a[144:145],v12 offset:0
ds_read_b64_tr_b16 a[146:147],v12 offset:768
ds_read_b64_tr_b16 a[148:149],v12 offset:6144
ds_read_b64_tr_b16 a[150:151],v12 offset:6912
ds_read_b64_tr_b16 a[152:153],v12 offset:32
ds_read_b64_tr_b16 a[154:155],v12 offset:800
ds_read_b64_tr_b16 a[156:157],v12 offset:6176
ds_read_b64_tr_b16 a[158:159],v12 offset:6944
ds_read_b64_tr_b16 v[48:49],v12 offset:64
ds_read_b64_tr_b16 v[50:51],v12 offset:832
ds_read_b64_tr_b16 v[52:53],v12 offset:6208
ds_read_b64_tr_b16 v[54:55],v12 offset:6976
s_branch ld_82
lw_86:
ds_read_b64_tr_b16 a[64:65],v12 offset:0
ds_read_b64_tr_b16 a[66:67],v12 offset:768
ds_read_b64_tr_b16 a[68:69],v12 offset:6144
ds_read_b64_tr_b16 a[70:71],v12 offset:6912
ds_read_b64_tr_b16 a[72:73],v12 offset:32
ds_read_b64_tr_b16 a[74:75],v12 offset:800
ds_read_b64_tr_b16 a[76:77],v12 offset:6176
ds_read_b64_tr_b16 a[78:79],v12 offset:6944
ds_read_b64_tr_b16 v[32:33],v12 offset:64
ds_read_b64_tr_b16 v[34:35],v12 offset:832
ds_read_b64_tr_b16 v[36:37],v12 offset:6208
ds_read_b64_tr_b16 v[38:39],v12 offset:6976
ld_82:
s_waitcnt lgkmcnt(0)
s_waitcnt vmcnt(18)
s_barrier
v_add_u32 v12,98304,v107
ds_read_b64_tr_b16 v[176:177],v12 offset:0
ds_read_b64_tr_b16 v[178:179],v12 offset:768
ds_read_b64_tr_b16 v[180:181],v12 offset:6144
ds_read_b64_tr_b16 v[182:183],v12 offset:6912
ds_read_b64_tr_b16 v[184:185],v12 offset:32
ds_read_b64_tr_b16 v[186:187],v12 offset:800
ds_read_b64_tr_b16 v[188:189],v12 offset:6176
ds_read_b64_tr_b16 v[190:191],v12 offset:6944
ds_read_b64_tr_b16 v[192:193],v12 offset:64
ds_read_b64_tr_b16 v[194:195],v12 offset:832
ds_read_b64_tr_b16 v[196:197],v12 offset:6208
ds_read_b64_tr_b16 v[198:199],v12 offset:6976
s_waitcnt lgkmcnt(0)
s_waitcnt vmcnt(12)
s_barrier
v_add_u32 v12,122880,v107
ds_read_b64_tr_b16 v[200:201],v12 offset:0
ds_read_b64_tr_b16 v[202:203],v12 offset:768
ds_read_b64_tr_b16 v[204:205],v12 offset:6144
ds_read_b64_tr_b16 v[206:207],v12 offset:6912
ds_read_b64_tr_b16 v[208:209],v12 offset:32
ds_read_b64_tr_b16 v[210:211],v12 offset:800
ds_read_b64_tr_b16 v[212:213],v12 offset:6176
ds_read_b64_tr_b16 v[214:215],v12 offset:6944
ds_read_b64_tr_b16 v[88:89],v12 offset:64
ds_read_b64_tr_b16 v[90:91],v12 offset:832
ds_read_b64_tr_b16 v[92:93],v12 offset:6208
ds_read_b64_tr_b16 v[94:95],v12 offset:6976
s_waitcnt lgkmcnt(0)
s_waitcnt vmcnt(6)
s_barrier
v_add_u32 v12,0,v107
ds_read_b64_tr_b16 v[216:217],v12 offset:0
ds_read_b64_tr_b16 v[218:219],v12 offset:768
ds_read_b64_tr_b16 v[220:221],v12 offset:6144
ds_read_b64_tr_b16 v[222:223],v12 offset:6912
ds_read_b64_tr_b16 v[224:225],v12 offset:32
ds_read_b64_tr_b16 v[226:227],v12 offset:800
ds_read_b64_tr_b16 v[228:229],v12 offset:6176
ds_read_b64_tr_b16 v[230:231],v12 offset:6944
ds_read_b64_tr_b16 v[232:233],v12 offset:64
ds_read_b64_tr_b16 v[234:235],v12 offset:832
ds_read_b64_tr_b16 v[236:237],v12 offset:6208
ds_read_b64_tr_b16 v[238:239],v12 offset:6976
s_waitcnt lgkmcnt(0)
s_waitcnt vmcnt(0)
s_barrier
v_add_u32 v12,24576,v107
ds_read_b64_tr_b16 v[240:241],v12 offset:0
ds_read_b64_tr_b16 v[242:243],v12 offset:768
ds_read_b64_tr_b16 v[244:245],v12 offset:6144
ds_read_b64_tr_b16 v[246:247],v12 offset:6912
ds_read_b64_tr_b16 v[248:249],v12 offset:32
ds_read_b64_tr_b16 v[250:251],v12 offset:800
ds_read_b64_tr_b16 v[252:253],v12 offset:6176
ds_read_b64_tr_b16 v[254:255],v12 offset:6944
ds_read_b64_tr_b16 v[96:97],v12 offset:64
ds_read_b64_tr_b16 v[98:99],v12 offset:832
ds_read_b64_tr_b16 v[100:101],v12 offset:6208
ds_read_b64_tr_b16 v[102:103],v12 offset:6976
s_waitcnt lgkmcnt(0)
s_barrier
ds_write_b128 v21,v[24:27] offset:0
ds_write_b128 v21,v[28:31] offset:1024
ds_write_b128 v21,v[32:35] offset:2048
ds_write_b128 v21,v[36:39] offset:3072
ds_write_b128 v21,v[40:43] offset:4096
ds_write_b128 v21,v[44:47] offset:5120
ds_write_b128 v21,v[48:51] offset:6144
ds_write_b128 v21,v[52:55] offset:7168
ds_write_b128 v21,v[56:59] offset:8192
ds_write_b128 v21,v[60:63] offset:9216
ds_write_b128 v21,v[64:67] offset:10240
ds_write_b128 v21,v[68:71] offset:11264
ds_write_b128 v21,v[72:75] offset:12288
ds_write_b128 v21,v[76:79] offset:13312
ds_write_b128 v21,v[80:83] offset:14336
ds_write_b128 v21,v[84:87] offset:15360
ds_write_b128 v21,v[88:91] offset:16384
ds_write_b128 v21,v[92:95] offset:17408
ds_write_b128 v21,v[96:99] offset:18432
ds_write_b128 v21,v[100:103] offset:19456
s_waitcnt lgkmcnt(0)
v_add_u32 v59,139264,v1
s_barrier
s_lshl_b32 s3,s49,2
v_mov_b32 v13,s3
s_nop 1
ibw_87:
buffer_load_dword v12,v13,s[12:15],0 offen sc1
s_waitcnt vmcnt(0)
v_cmp_ne_u32 vcc,256,v12
s_nop 0
s_cbranch_vccz ok_88
s_sleep 8
s_sub_u32 s47,s47,1
s_cbranch_scc1 ABORT
s_branch ibw_87
ok_88:
s_cmp_lg_u32 s49,0
s_cbranch_scc1 ibok_89
v_and_b32 v13,7,v0
v_lshlrev_b32 v13,2,v13
buffer_load_dword v12,v13,s[12:15],0 offen offset:32 sc1
s_waitcnt vmcnt(0)
v_cmp_ne_u32 vcc,32,v12
s_nop 0
s_cbranch_vccz ibok_89
s_barrier
s_mov_b32 s49,1
s_mov_b32 s3,s2
s_load_dwordx16 s[16:31],s[0:1],0
s_load_dwordx8 s[32:39],s[0:1],64
s_waitcnt lgkmcnt(0)
s_branch DISPATCH
ibok_89:
v_mov_b32 v13,192
buffer_load_dword v12,v13,s[12:15],0 offen sc1
s_waitcnt vmcnt(0)
v_readfirstlane_b32 s60,v12
s_cmp_gt_i32 s60,0
s_cselect_b32 s60,0x2000,0
s_add_u32 s83,s83,s60
s_mul_i32 s6,s46,5120
s_add_u32 s6,s6,s82
s_mov_b32 s7,0
s_add_u32 s7,s7,s82
s_add_u32 s7,s7,950272
v_add_u32 v18,4096,v1
s_mov_b32 s50,0
s_mov_b32 s4,0
s_mov_b32 s5,0
s_mov_b32 s78,-1
s_mov_b32 s79,-1
s_mov_b32 s30,-1
s_sub_u32 s60,s4,s5
s_cmp_gt_i32 s60,15
s_cselect_b32 s51,1,0
s_cmp_eq_u32 s4,64
s_cselect_b32 s51,1,s51
s_cmp_eq_u32 s51,0
s_cselect_b32 s52,s4,s5
s_addc_u32 s4,s4,0
s_add_u32 s5,s5,s51
s_and_b32 s60,s52,3
s_lshl2_add_u32 s60,s51,s60
s_lshl_b32 s68,s60,16
s_add_u32 s68,s68,s83
s_mul_i32 s59,s60,20480
s_add_u32 s59,s59,s6
s_lshl_b32 s69,s51,9
s_add_u32 s69,s69,s7
s_bfe_u32 s57,s52,0x10002
s_add_u32 s58,s52,1
s_cmp_lg_u32 s36,0
s_cbranch_scc1 CV_START
s_cmp_eq_u32 s46,3
s_cbranch_scc1 CH_START
s_lshl_b32 s60,s46,2
s_add_u32 s60,s60,147456
v_mov_b32 v20,s60
v_mov_b32 v12,0
ds_write_b32 v20,v12
v_add_u32 v58,106496,v1
v_mov_b32 v9,147468
s_lshl_b32 s85,s46,12
s_add_u32 s84,s84,s85
s_add_u32 s74,s85,81920
s_add_u32 s75,s74,s74
s_add_u32 s75,s75,24576
s_mov_b64 vcc,-1
s_waitcnt lgkmcnt(0)
s_cmp_lg_u32 s49,0
s_cbranch_scc1 CS_LOOP_S
CS_LOOP_F:
s_barrier
buffer_load_dwordx4 v[76:79],v18,s[8:11],s59 offen sc1
buffer_load_dwordx4 v[60:63],v1,s[8:11],s59 offen sc1
buffer_load_dwordx4 v[64:67],v1,s[8:11],s59 offen offset:1024 sc1
buffer_load_dwordx4 v[68:71],v1,s[8:11],s59 offen offset:2048 sc1
buffer_load_dwordx4 v[72:75],v1,s[8:11],s59 offen offset:3072 sc1
s_cbranch_vccz CS_FAST_F
v_mov_b32 v24,0
v_mov_b32 v25,0
v_mov_b32 v26,0
v_mov_b32 v27,0
v_mov_b32 v28,0
v_mov_b32 v29,0
v_mov_b32 v30,0
v_mov_b32 v31,0
v_mov_b32 v32,0
v_mov_b32 v33,0
v_mov_b32 v34,0
v_mov_b32 v35,0
v_mov_b32 v36,0
v_mov_b32 v37,0
v_mov_b32 v38,0
v_mov_b32 v39,0
v_mov_b32 v40,0
v_mov_b32 v41,0
v_mov_b32 v42,0
v_mov_b32 v43,0
v_mov_b32 v44,0
v_mov_b32 v45,0
v_mov_b32 v46,0
v_mov_b32 v47,0
s_waitcnt vmcnt(4)
buffer_load_dwordx4 v[96:99],v18,s[8:11],s68 offen sc1
buffer_load_dwordx4 v[80:83],v1,s[8:11],s68 offen sc1
buffer_load_dwordx4 v[84:87],v1,s[8:11],s68 offen offset:1024 sc1
buffer_load_dwordx4 v[88:91],v1,s[8:11],s68 offen offset:2048 sc1
buffer_load_dwordx4 v[92:95],v1,s[8:11],s68 offen offset:3072 sc1
fj_92:
fa_90:
s_waitcnt vmcnt(4)
v_pk_add_f32 v[12:13],v[76:77],v[96:97]
v_pk_add_f32 v[14:15],v[78:79],v[98:99]
v_bitop3_b32 v16,v76,v96,s57 bitop3:0x7e
v_cvt_pk_bf16_f32 v56,v12,v13
v_cvt_pk_bf16_f32 v57,v14,v15
ds_write_b64 v23,v[56:57]
s_waitcnt vmcnt(3)
v_pk_add_f32 v[12:13],v[60:61],v[80:81]
v_pk_add_f32 v[14:15],v[62:63],v[82:83]
v_bitop3_b32 v17,v60,v80,s57 bitop3:0x7e
v_cvt_pk_bf16_f32 v48,v12,v13
v_cvt_pk_bf16_f32 v49,v14,v15
v_or_b32 v16,v16,v17
s_waitcnt vmcnt(2)
v_pk_add_f32 v[12:13],v[64:65],v[84:85]
v_pk_add_f32 v[14:15],v[66:67],v[86:87]
v_bitop3_b32 v17,v64,v84,s57 bitop3:0x7e
v_cvt_pk_bf16_f32 v50,v12,v13
v_cvt_pk_bf16_f32 v51,v14,v15
v_or_b32 v16,v16,v17
ds_write_b128 v22,v[48:51] offset:0
s_waitcnt vmcnt(1)
v_pk_add_f32 v[12:13],v[68:69],v[88:89]
v_pk_add_f32 v[14:15],v[70:71],v[90:91]
v_bitop3_b32 v17,v68,v88,s57 bitop3:0x7e
v_cvt_pk_bf16_f32 v52,v12,v13
v_cvt_pk_bf16_f32 v53,v14,v15
v_or_b32 v16,v16,v17
s_waitcnt vmcnt(0)
v_pk_add_f32 v[12:13],v[72:73],v[92:93]
v_pk_add_f32 v[14:15],v[74:75],v[94:95]
v_bitop3_b32 v17,v72,v92,s57 bitop3:0x7e
v_cvt_pk_bf16_f32 v54,v12,v13
v_cvt_pk_bf16_f32 v55,v14,v15
v_bitop3_b32 v16,v16,v17,1 bitop3:0xa8
v_cmp_ne_u32 vcc,0,v16
ds_write_b128 v22,v[52:55] offset:1024
s_cbranch_vccnz fr_91
v_smfmac_f32_16x16x64_bf16 v[24:27],v[48:51],a[0:7],v2
ds_read_b128 v[72:75],v21 offset:0
v_xor_b32 v58,57344,v58
v_smfmac_f32_16x16x64_bf16 v[28:31],v[48:51],a[8:15],v2
ds_read_b128 v[76:79],v21 offset:1024
s_sub_u32 s60,s4,s5
v_smfmac_f32_16x16x64_bf16 v[32:35],v[48:51],a[16:23],v2
ds_read_b128 v[80:83],v21 offset:2048
v_smfmac_f32_16x16x64_bf16 v[36:39],v[48:51],a[24:31],v2
ds_read_b128 v[84:87],v21 offset:3072
s_waitcnt lgkmcnt(4)
s_barrier
v_smfmac_f32_16x16x64_bf16 v[40:43],v[48:51],a[32:39],v2
ds_read_b128 v[60:63],v3 offset:0
v_smfmac_f32_16x16x64_bf16 v[24:27],v[52:55],a[40:47],v2
ds_read_b128 v[64:67],v3 offset:1024
v_smfmac_f32_16x16x64_bf16 v[28:31],v[52:55],a[48:55],v2
ds_read_b128 v[68:71],v4 offset:0
v_smfmac_f32_16x16x64_bf16 v[32:35],v[52:55],a[56:63],v2
s_cmp_gt_i32 s60,15
s_cselect_b32 s53,1,0
v_smfmac_f32_16x16x64_bf16 v[36:39],v[52:55],a[64:71],v2
s_cmp_eq_u32 s4,64
s_cselect_b32 s53,1,s53
v_smfmac_f32_16x16x64_bf16 v[40:43],v[52:55],a[72:79],v2
s_waitcnt lgkmcnt(5)
v_smfmac_f32_16x16x64_bf16 v[44:47],v[48:51],v[72:79],v2
ds_read_b128 v[72:75],v21 offset:4096
s_waitcnt lgkmcnt(4)
v_smfmac_f32_16x16x64_bf16 v[44:47],v[52:55],v[80:87],v2
ds_read_b128 v[76:79],v21 offset:5120
s_waitcnt lgkmcnt(4)
v_smfmac_f32_16x16x64_bf16 v[24:27],v[60:63],a[80:87],v2
ds_read_b128 v[80:83],v21 offset:6144
v_smfmac_f32_16x16x64_bf16 v[28:31],v[60:63],a[88:95],v2
ds_read_b128 v[84:87],v21 offset:7168
v_smfmac_f32_16x16x64_bf16 v[32:35],v[60:63],a[96:103],v2
s_cmp_eq_u32 s53,0
s_cselect_b32 s54,s4,s5
s_addc_u32 s4,s4,0
v_smfmac_f32_16x16x64_bf16 v[36:39],v[60:63],a[104:111],v2
s_add_u32 s5,s5,s53
s_mul_i32 s73,s54,393216
s_add_u32 s73,s73,s84
v_smfmac_f32_16x16x64_bf16 v[40:43],v[60:63],a[112:119],v2
s_sub_u32 s74,s75,s74
s_mov_b32 m0,s74
s_waitcnt lgkmcnt(2)
v_smfmac_f32_16x16x64_bf16 v[44:47],v[60:63],v[72:79],v2
ds_read_b128 v[60:63],v4 offset:1024
s_and_b32 s60,s52,3
v_smfmac_f32_16x16x64_bf16 v[24:27],v[64:67],a[120:127],v2
ds_read_b128 v[72:75],v21 offset:8192
s_lshl2_add_u32 s60,s51,s60
v_smfmac_f32_16x16x64_bf16 v[28:31],v[64:67],a[128:135],v2
ds_read_b128 v[76:79],v21 offset:9216
s_mul_i32 s60,s60,49152
v_smfmac_f32_16x16x64_bf16 v[32:35],v[64:67],a[136:143],v2
s_add_u32 s71,s60,s34
s_add_u32 s70,s60,s33
s_lshl_b32 s60,s51,9
v_smfmac_f32_16x16x64_bf16 v[36:39],v[64:67],a[144:151],v2
s_add_u32 s72,s60,s35
buffer_load_dwordx4 v1,s[8:11],s73 offen nt sc1 lds
v_smfmac_f32_16x16x64_bf16 v[40:43],v[64:67],a[152:159],v2
buffer_load_dwordx4 v1,s[8:11],s73 offen offset:1024 nt sc1 lds
s_waitcnt lgkmcnt(3)
v_smfmac_f32_16x16x64_bf16 v[44:47],v[64:67],v[80:87],v2
ds_read_b128 v[64:67],v5 offset:0
v_smfmac_f32_16x16x64_bf16 v[24:27],v[68:71],a[160:167],v2
ds_read_b128 v[80:83],v21 offset:10240
v_smfmac_f32_16x16x64_bf16 v[28:31],v[68:71],a[168:175],v2
ds_read_b128 v[84:87],v21 offset:11264
v_smfmac_f32_16x16x64_bf16 v[32:35],v[68:71],a[176:183],v2
buffer_load_dwordx4 v1,s[8:11],s73 offen offset:2048 nt sc1 lds
v_smfmac_f32_16x16x64_bf16 v[36:39],v[68:71],a[184:191],v2
buffer_load_dwordx4 v1,s[8:11],s73 offen offset:3072 nt sc1 lds
s_and_b32 s60,s54,3
v_smfmac_f32_16x16x64_bf16 v[40:43],v[68:71],a[192:199],v2
s_lshl2_add_u32 s60,s53,s60
s_lshl_b32 s68,s60,16
s_waitcnt lgkmcnt(3)
v_smfmac_f32_16x16x64_bf16 v[44:47],v[68:71],v[72:79],v2
ds_read_b128 v[68:71],v5 offset:1024
s_add_u32 s68,s68,s83
v_smfmac_f32_16x16x64_bf16 v[24:27],v[60:63],a[200:207],v2
ds_read_b128 v[72:75],v21 offset:12288
s_mul_i32 s59,s60,20480
v_smfmac_f32_16x16x64_bf16 v[28:31],v[60:63],a[208:215],v2
ds_read_b128 v[76:79],v21 offset:13312
s_add_u32 s59,s59,s6
v_smfmac_f32_16x16x64_bf16 v[32:35],v[60:63],a[216:223],v2
s_lshl_b32 s69,s53,9
s_add_u32 s69,s69,s7
s_bfe_u32 s31,s54,0x10002
v_smfmac_f32_16x16x64_bf16 v[36:39],v[60:63],a[224:231],v2
s_add_u32 s32,s54,1
v_add_u32 v17,s85,v58
v_smfmac_f32_16x16x64_bf16 v[40:43],v[60:63],a[232:239],v2
v_mov_b32 v16,s58
s_waitcnt lgkmcnt(3)
v_smfmac_f32_16x16x64_bf16 v[44:47],v[60:63],v[80:87],v2
ds_read_b128 v[60:63],v59 offset:0
v_mov_b32 v15,0
v_smfmac_f32_16x16x64_bf16 v[24:27],v[64:67],a[240:247],v2
ds_read_b128 v[80:83],v21 offset:14336
v_smfmac_f32_16x16x64_bf16 v[28:31],v[64:67],a[248:255],v2
ds_read_b128 v[84:87],v21 offset:15360
v_smfmac_f32_16x16x64_bf16 v[32:35],v[64:67],v[112:119],v2
ds_read_b128 v[88:91],v58 offset:0
v_smfmac_f32_16x16x64_bf16 v[36:39],v[64:67],v[120:127],v2
ds_read_b128 v[92:95],v58 offset:1024
v_smfmac_f32_16x16x64_bf16 v[40:43],v[64:67],v[128:135],v2
ds_read_b128 v[96:99],v58 offset:2048
s_waitcnt lgkmcnt(6)
v_smfmac_f32_16x16x64_bf16 v[44:47],v[64:67],v[72:79],v2
ds_read_b128 v[64:67],v59 offset:1024
v_smfmac_f32_16x16x64_bf16 v[24:27],v[68:71],v[136:143],v2
ds_read_b128 v[72:75],v21 offset:16384
v_smfmac_f32_16x16x64_bf16 v[28:31],v[68:71],v[144:151],v2
ds_read_b128 v[76:79],v21 offset:17408
v_smfmac_f32_16x16x64_bf16 v[32:35],v[68:71],v[152:159],v2
ds_read_b128 v[100:103],v58 offset:3072
v_smfmac_f32_16x16x64_bf16 v[36:39],v[68:71],v[160:167],v2
ds_read_b128 v[104:107],v58 offset:4096
v_smfmac_f32_16x16x64_bf16 v[40:43],v[68:71],v[168:175],v2
ds_read_b128 v[108:111],v58 offset:5120
s_waitcnt lgkmcnt(9)
v_smfmac_f32_16x16x64_bf16 v[44:47],v[68:71],v[80:87],v2
ds_read_b128 v[80:83],v21 offset:18432
v_smfmac_f32_16x16x64_bf16 v[24:27],v[60:63],v[176:183],v2
ds_read_b128 v[84:87],v21 offset:19456
v_smfmac_f32_16x16x64_bf16 v[36:39],v[60:63],v[200:207],v2
ds_read_b128 v[48:51],v58 offset:6144
s_waitcnt lgkmcnt(8)
v_smfmac_f32_16x16x64_bf16 v[24:27],v[64:67],v[216:223],v2
ds_read_b128 v[52:55],v58 offset:7168
v_smfmac_f32_16x16x64_bf16 v[36:39],v[64:67],v[240:247],v2
v_smfmac_f32_16x16x64_bf16 v[28:31],v[60:63],v[184:191],v2
v_smfmac_f32_16x16x64_bf16 v[40:43],v[60:63],v[208:215],v2
s_nop 3
v_add_f32 v24,v24,v25
v_smfmac_f32_16x16x64_bf16 v[28:31],v[64:67],v[224:231],v2
v_add_f32 v26,v26,v27
v_smfmac_f32_16x16x64_bf16 v[40:43],v[64:67],v[248:255],v2
v_add_f32 v36,v36,v37
v_smfmac_f32_16x16x64_bf16 v[32:35],v[60:63],v[192:199],v2
v_add_f32 v38,v38,v39
s_waitcnt lgkmcnt(7)
v_smfmac_f32_16x16x64_bf16 v[44:47],v[60:63],v[72:79],v2
v_cvt_pk_bf16_f32 v37,v24,v26
v_smfmac_f32_16x16x64_bf16 v[32:35],v[64:67],v[232:239],v2
v_cvt_pk_bf16_f32 v36,v36,v38
s_waitcnt lgkmcnt(2)
v_smfmac_f32_16x16x64_bf16 v[44:47],v[64:67],v[80:87],v2
ds_write_b64 v6,v[36:37] offset:0
v_add_f32 v28,v28,v29
v_add_f32 v30,v30,v31
v_add_f32 v40,v40,v41
v_add_f32 v42,v42,v43
v_cvt_pk_bf16_f32 v41,v28,v30
v_cvt_pk_bf16_f32 v40,v40,v42
ds_write_b64 v6,v[40:41] offset:512
v_add_f32 v32,v32,v33
v_add_f32 v34,v34,v35
v_add_f32 v44,v44,v45
v_add_f32 v46,v46,v47
v_cvt_pk_bf16_f32 v45,v32,v34
v_cvt_pk_bf16_f32 v44,v44,v46
ds_write_b64 v6,v[44:45] offset:1024
s_cmp_eq_u32 s52,63
s_cbranch_scc1 last_93
ds_read_b128 v[72:75],v58 offset:8192
ds_read_b128 v[76:79],v58 offset:9216
s_waitcnt lgkmcnt(2)
s_barrier
ds_read_b64_tr_b16 v[24:25],v7 offset:0
ds_read_b64_tr_b16 v[26:27],v7 offset:512
ds_read_b64_tr_b16 v[28:29],v7 offset:1024
ds_read_b64_tr_b16 v[30:31],v7 offset:1536
ds_read_b64_tr_b16 v[32:33],v7 offset:2048
ds_read_b64_tr_b16 v[34:35],v7 offset:2560
ds_read_b64_tr_b16 v[36:37],v7 offset:3072
ds_read_b64_tr_b16 v[38:39],v7 offset:3584
s_waitcnt lgkmcnt(6)
v_mfma_f32_16x16x32_bf16 v[60:63],v[88:91],v[24:27],0
ds_read_b64_tr_b16 v[40:41],v7 offset:4096
s_mov_b64 vcc,s[88:89]
v_mfma_f32_16x16x32_bf16 v[64:67],v[92:95],v[24:27],0
ds_read_b64_tr_b16 v[42:43],v7 offset:4608
v_mfma_f32_16x16x32_bf16 v[68:71],v[24:27],v[24:27],0
ds_read_b128 v[80:83],v58 offset:10240
s_waitcnt lgkmcnt(7)
v_mfma_f32_16x16x32_bf16 v[60:63],v[96:99],v[28:31],v[60:63]
ds_read_b128 v[84:87],v58 offset:11264
v_mfma_f32_16x16x32_bf16 v[64:67],v[100:103],v[28:31],v[64:67]
ds_read_b64_tr_b16 v[44:45],v7 offset:5120
v_mfma_f32_16x16x32_bf16 v[68:71],v[28:31],v[28:31],v[68:71]
ds_read_b64_tr_b16 v[46:47],v7 offset:5632
s_waitcnt lgkmcnt(8)
v_mfma_f32_16x16x32_bf16 v[60:63],v[104:107],v[32:35],v[60:63]
ds_read_b128 v[88:91],v17 offset:12288
v_mfma_f32_16x16x32_bf16 v[64:67],v[108:111],v[32:35],v[64:67]
ds_read_b128 v[92:95],v17 offset:13312
v_mfma_f32_16x16x32_bf16 v[68:71],v[32:35],v[32:35],v[68:71]
ds_read_b128 v[96:99],v17 offset:14336
s_waitcnt lgkmcnt(9)
v_mfma_f32_16x16x32_bf16 v[60:63],v[48:51],v[36:39],v[60:63]
ds_read_b128 v[100:103],v17 offset:15360
v_mfma_f32_16x16x32_bf16 v[64:67],v[52:55],v[36:39],v[64:67]
v_mfma_f32_16x16x32_bf16 v[68:71],v[36:39],v[36:39],v[68:71]
s_waitcnt lgkmcnt(8)
v_mfma_f32_16x16x32_bf16 v[60:63],v[72:75],v[40:43],v[60:63]
v_mfma_f32_16x16x32_bf16 v[64:67],v[76:79],v[40:43],v[64:67]
v_mfma_f32_16x16x32_bf16 v[68:71],v[40:43],v[40:43],v[68:71]
s_waitcnt lgkmcnt(4)
v_mfma_f32_16x16x32_bf16 v[60:63],v[80:83],v[44:47],v[60:63]
v_mfma_f32_16x16x32_bf16 v[64:67],v[84:87],v[44:47],v[64:67]
buffer_load_dwordx4 v[104:107],v1,s[8:11],s71 offen sc1
v_mfma_f32_16x16x32_bf16 v[68:71],v[44:47],v[44:47],v[68:71]
s_nop 5
v_cndmask_b32_dpp v60,v64,v60,vcc quad_perm:[2,3,2,3] row_mask:0xf bank_mask:0xf
v_cndmask_b32_dpp v61,v65,v61,vcc quad_perm:[2,3,2,3] row_mask:0xf bank_mask:0xf
v_cndmask_b32_dpp v62,v66,v62,vcc quad_perm:[2,3,2,3] row_mask:0xf bank_mask:0xf
v_cndmask_b32_dpp v63,v67,v63,vcc quad_perm:[2,3,2,3] row_mask:0xf bank_mask:0xf
v_max3_f32 v12,v60,v61,v62
v_cndmask_b32_dpp v68,v69,v68,vcc quad_perm:[2,3,2,3] row_mask:0xf bank_mask:0xf
v_max3_f32 v12,v12,v63,v68
s_nop 1
v_max_f32_dpp v13,v12,v12 quad_perm:[2,3,0,1] row_mask:0xf bank_mask:0xf
v_max_f32_dpp v12,v12,v12 quad_perm:[2,3,0,1] row_mask:0xf bank_mask:0xf
s_nop 1
v_permlane32_swap_b32 v12,v13
v_max_f32 v64,v12,v13
v_max_f32 v12,v12,v13
s_mov_b64 exec,1
buffer_store_dword v16,v1,s[8:11],s72 offen
s_mov_b64 exec,-1
v_permlane16_swap_b32 v12,v64
v_max_f32 v12,v12,v64
v_mul_f32 v12,s87,v12
v_fma_f32 v60,v60,s87,-v12
v_fma_f32 v61,v61,s87,-v12
v_fma_f32 v62,v62,s87,-v12
v_fma_f32 v63,v63,s87,-v12
v_fma_f32 v68,v68,s87,-v12
v_exp_f32 v60,v60
v_exp_f32 v61,v61
v_exp_f32 v62,v62
v_exp_f32 v63,v63
v_exp_f32 v68,v68
v_cvt_pk_bf16_f32 v34,v60,v61
v_cvt_pk_bf16_f32 v35,v62,v63
v_cndmask_b32 v30,v34,v15,vcc
v_cndmask_b32 v31,v35,v15,vcc
v_cndmask_b32_dpp v28,v34,v15,vcc quad_perm:[2,3,0,1] row_mask:0xf bank_mask:0xf
v_cndmask_b32_dpp v29,v35,v15,vcc quad_perm:[2,3,0,1] row_mask:0xf bank_mask:0xf
s_mov_b64 vcc,s[90:91]
s_waitcnt lgkmcnt(0)
v_cndmask_b32 v24,v34,v15,vcc
v_mfma_f32_16x16x32_bf16 v[36:39],v[92:95],v[28:31],0
v_cndmask_b32 v25,v35,v15,vcc
v_cndmask_b32_dpp v26,v34,v15,vcc quad_perm:[2,3,0,1] row_mask:0xf bank_mask:0xf
v_mfma_f32_16x16x32_bf16 v[40:43],v[100:103],v[28:31],0
v_cndmask_b32_dpp v27,v35,v15,vcc quad_perm:[2,3,0,1] row_mask:0xf bank_mask:0xf
v_mov_b32_dpp v14,v68 quad_perm:[2,3,0,1] row_mask:0xf bank_mask:0xf
v_add_f32 v12,v60,v61
v_mfma_f32_16x16x32_bf16 v[36:39],v[88:91],v[24:27],v[36:39]
v_cvt_pk_bf16_f32 v32,v68,v14
v_cvt_pk_bf16_f32 v33,v14,v68
v_mfma_f32_16x16x32_bf16 v[40:43],v[96:99],v[24:27],v[40:43]
v_cndmask_b32 v32,v32,v15,vcc
v_cndmask_b32 v33,v15,v33,vcc
ds_read_b32 v10,v9
s_waitcnt vmcnt(1)
v_bitop3_b32 v17,v104,v106,s57 bitop3:0x7e
v_add_f32 v13,v62,v63
v_and_b32 v17,1,v17
v_add_f32 v12,v12,v68
v_cmp_ne_u32 vcc,0,v17
v_add_f32 v12,v12,v13
s_cbranch_vccnz vb_94
vo_95:
v_mfma_f32_16x16x16_bf16 v[36:39],v[104:105],v[32:33],v[36:39]
v_add_f32_dpp v13,v12,v12 quad_perm:[2,3,0,1] row_mask:0xf bank_mask:0xf
v_add_f32_dpp v12,v12,v12 quad_perm:[2,3,0,1] row_mask:0xf bank_mask:0xf
v_mfma_f32_16x16x16_bf16 v[40:43],v[106:107],v[32:33],v[40:43]
s_nop 0
v_permlane32_swap_b32 v12,v13
v_add_f32 v64,v12,v13
v_add_f32 v12,v12,v13
s_add_u32 s50,s50,1
s_mov_b32 s51,s53
v_permlane16_swap_b32 v12,v64
v_add_f32 v12,v12,v64
v_rcp_f32 v12,v12
s_mov_b32 s52,s54
v_pk_mul_f32 v[36:37],v[36:37],v[12:13] op_sel_hi:[1,0]
v_pk_mul_f32 v[38:39],v[38:39],v[12:13] op_sel_hi:[1,0]
v_pk_mul_f32 v[40:41],v[40:41],v[12:13] op_sel_hi:[1,0]
v_pk_mul_f32 v[42:43],v[42:43],v[12:13] op_sel_hi:[1,0]
v_cvt_pk_bf16_f32 v48,v36,v37
v_cvt_pk_bf16_f32 v49,v38,v39
v_cvt_pk_bf16_f32 v50,v40,v41
v_cvt_pk_bf16_f32 v51,v42,v43
v_and_or_b32 v48,v48,-2,s57
buffer_store_dwordx4 v[48:51],v8,s[8:11],s70 offen
s_mov_b32 s57,s31
s_mov_b32 s58,s32
s_waitcnt lgkmcnt(0)
v_cmp_ne_u32 vcc,s50,v10
v_mov_b32 v12,s50
ds_write_b32 v20,v12
s_branch CS_LOOP_F
last_93:
s_waitcnt lgkmcnt(0)
s_barrier
s_add_u32 s50,s50,1
s_mov_b32 s51,s53
s_mov_b32 s52,s54
s_mov_b32 s57,s31
s_mov_b32 s58,s32
s_mov_b64 vcc,-1
s_waitcnt vmcnt(0)
v_mov_b32 v12,s50
ds_write_b32 v20,v12
s_cmp_lt_u32 s50,128
s_cbranch_scc1 CS_LOOP_F
s_branch CS_DONE
fr_91:
v_bitop3_b32 v12,v60,v64,s57 bitop3:0x7e
v_bitop3_b32 v13,v68,v72,s57 bitop3:0x7e
v_xor_b32 v14,s57,v76
v_or3_b32 v12,v12,v13,v14
v_and_b32 v12,1,v12
v_cmp_ne_u32 vcc,0,v12
s_cbranch_vccz sk_96
buffer_load_dwordx4 v[76:79],v18,s[8:11],s59 offen sc1
buffer_load_dwordx4 v[60:63],v1,s[8:11],s59 offen sc1
buffer_load_dwordx4 v[64:67],v1,s[8:11],s59 offen offset:1024 sc1
buffer_load_dwordx4 v[68:71],v1,s[8:11],s59 offen offset:2048 sc1
buffer_load_dwordx4 v[72:75],v1,s[8:11],s59 offen offset:3072 sc1
sk_96:
buffer_load_dwordx4 v[96:99],v18,s[8:11],s68 offen sc1
buffer_load_dwordx4 v[80:83],v1,s[8:11],s68 offen sc1
buffer_load_dwordx4 v[84:87],v1,s[8:11],s68 offen offset:1024 sc1
buffer_load_dwordx4 v[88:91],v1,s[8:11],s68 offen offset:2048 sc1
buffer_load_dwordx4 v[92:95],v1,s[8:11],s68 offen offset:3072 sc1
s_sub_u32 s47,s47,1
s_cbranch_scc1 ABORT
s_waitcnt lgkmcnt(0)
s_branch fa_90
CS_FAST_F:
buffer_load_dwordx4 v[96:99],v18,s[8:11],s68 offen sc1
buffer_load_dwordx4 v[80:83],v1,s[8:11],s68 offen sc1
buffer_load_dwordx4 v[84:87],v1,s[8:11],s68 offen offset:1024 sc1
buffer_load_dwordx4 v[88:91],v1,s[8:11],s68 offen offset:2048 sc1
buffer_load_dwordx4 v[92:95],v1,s[8:11],s68 offen offset:3072 sc1
v_mov_b32 v24,0
v_mov_b32 v25,0
v_mov_b32 v26,0
v_mov_b32 v27,0
v_mov_b32 v28,0
v_mov_b32 v29,0
v_mov_b32 v30,0
v_mov_b32 v31,0
v_mov_b32 v32,0
v_mov_b32 v33,0
v_mov_b32 v34,0
v_mov_b32 v35,0
v_mov_b32 v36,0
v_mov_b32 v37,0
v_mov_b32 v38,0
v_mov_b32 v39,0
v_mov_b32 v40,0
v_mov_b32 v41,0
v_mov_b32 v42,0
v_mov_b32 v43,0
v_mov_b32 v44,0
v_mov_b32 v45,0
v_mov_b32 v46,0
v_mov_b32 v47,0
s_nop 0
s_branch fj_92
vb_94:
s_sub_u32 s47,s47,1
s_cbranch_scc1 ABORT
buffer_load_dwordx4 v[104:107],v1,s[8:11],s71 offen sc1
s_waitcnt vmcnt(0)
v_bitop3_b32 v17,v104,v106,s57 bitop3:0x7e
v_and_b32 v17,1,v17
v_cmp_ne_u32 vcc,0,v17
s_nop 0
s_cbranch_vccnz vb_94
s_branch vo_95
CS_LOOP_S:
s_barrier
buffer_load_dwordx4 v[76:79],v18,s[8:11],s59 offen sc1
buffer_load_dwordx4 v[60:63],v1,s[8:11],s59 offen sc1
buffer_load_dwordx4 v[64:67],v1,s[8:11],s59 offen offset:1024 sc1
buffer_load_dwordx4 v[68:71],v1,s[8:11],s59 offen offset:2048 sc1
buffer_load_dwordx4 v[72:75],v1,s[8:11],s59 offen offset:3072 sc1
s_cbranch_vccz CS_FAST_S
v_mov_b32 v24,0
v_mov_b32 v25,0
v_mov_b32 v26,0
v_mov_b32 v27,0
v_mov_b32 v28,0
v_mov_b32 v29,0
v_mov_b32 v30,0
v_mov_b32 v31,0
v_mov_b32 v32,0
v_mov_b32 v33,0
v_mov_b32 v34,0
v_mov_b32 v35,0
v_mov_b32 v36,0
v_mov_b32 v37,0
v_mov_b32 v38,0
v_mov_b32 v39,0
v_mov_b32 v40,0
v_mov_b32 v41,0
v_mov_b32 v42,0
v_mov_b32 v43,0
v_mov_b32 v44,0
v_mov_b32 v45,0
v_mov_b32 v46,0
v_mov_b32 v47,0
s_waitcnt vmcnt(4)
buffer_load_dwordx4 v[96:99],v18,s[8:11],s68 offen sc1
buffer_load_dwordx4 v[80:83],v1,s[8:11],s68 offen sc1
buffer_load_dwordx4 v[84:87],v1,s[8:11],s68 offen offset:1024 sc1
buffer_load_dwordx4 v[88:91],v1,s[8:11],s68 offen offset:2048 sc1
buffer_load_dwordx4 v[92:95],v1,s[8:11],s68 offen offset:3072 sc1
fj_99:
fa_97:
s_waitcnt vmcnt(4)
v_pk_add_f32 v[12:13],v[76:77],v[96:97]
v_pk_add_f32 v[14:15],v[78:79],v[98:99]
v_bitop3_b32 v16,v76,v96,s57 bitop3:0x7e
v_cvt_pk_bf16_f32 v56,v12,v13
v_cvt_pk_bf16_f32 v57,v14,v15
ds_write_b64 v23,v[56:57]
s_waitcnt vmcnt(3)
v_pk_add_f32 v[12:13],v[60:61],v[80:81]
v_pk_add_f32 v[14:15],v[62:63],v[82:83]
v_bitop3_b32 v17,v60,v80,s57 bitop3:0x7e
v_cvt_pk_bf16_f32 v48,v12,v13
v_cvt_pk_bf16_f32 v49,v14,v15
v_or_b32 v16,v16,v17
s_waitcnt vmcnt(2)
v_pk_add_f32 v[12:13],v[64:65],v[84:85]
v_pk_add_f32 v[14:15],v[66:67],v[86:87]
v_bitop3_b32 v17,v64,v84,s57 bitop3:0x7e
v_cvt_pk_bf16_f32 v50,v12,v13
v_cvt_pk_bf16_f32 v51,v14,v15
v_or_b32 v16,v16,v17
ds_write_b128 v22,v[48:51] offset:0
s_waitcnt vmcnt(1)
v_pk_add_f32 v[12:13],v[68:69],v[88:89]
v_pk_add_f32 v[14:15],v[70:71],v[90:91]
v_bitop3_b32 v17,v68,v88,s57 bitop3:0x7e
v_cvt_pk_bf16_f32 v52,v12,v13
v_cvt_pk_bf16_f32 v53,v14,v15
v_or_b32 v16,v16,v17
s_waitcnt vmcnt(0)
v_pk_add_f32 v[12:13],v[72:73],v[92:93]
v_pk_add_f32 v[14:15],v[74:75],v[94:95]
v_bitop3_b32 v17,v72,v92,s57 bitop3:0x7e
v_cvt_pk_bf16_f32 v54,v12,v13
v_cvt_pk_bf16_f32 v55,v14,v15
v_bitop3_b32 v16,v16,v17,1 bitop3:0xa8
v_cmp_ne_u32 vcc,0,v16
ds_write_b128 v22,v[52:55] offset:1024
s_cbranch_vccnz fr_98
v_smfmac_f32_16x16x64_bf16 v[24:27],v[48:51],a[0:7],v2
ds_read_b128 v[72:75],v21 offset:0
v_xor_b32 v58,57344,v58
v_smfmac_f32_16x16x64_bf16 v[28:31],v[48:51],a[8:15],v2
ds_read_b128 v[76:79],v21 offset:1024
s_sub_u32 s60,s4,s5
v_smfmac_f32_16x16x64_bf16 v[32:35],v[48:51],a[16:23],v2
ds_read_b128 v[80:83],v21 offset:2048
v_smfmac_f32_16x16x64_bf16 v[36:39],v[48:51],a[24:31],v2
ds_read_b128 v[84:87],v21 offset:3072
s_waitcnt lgkmcnt(4)
s_barrier
v_smfmac_f32_16x16x64_bf16 v[40:43],v[48:51],a[32:39],v2
ds_read_b128 v[60:63],v3 offset:0
v_smfmac_f32_16x16x64_bf16 v[24:27],v[52:55],a[40:47],v2
ds_read_b128 v[64:67],v3 offset:1024
v_smfmac_f32_16x16x64_bf16 v[28:31],v[52:55],a[48:55],v2
ds_read_b128 v[68:71],v4 offset:0
v_smfmac_f32_16x16x64_bf16 v[32:35],v[52:55],a[56:63],v2
s_cmp_gt_i32 s60,15
s_cselect_b32 s53,1,0
v_smfmac_f32_16x16x64_bf16 v[36:39],v[52:55],a[64:71],v2
s_cmp_eq_u32 s4,64
s_cselect_b32 s53,1,s53
v_smfmac_f32_16x16x64_bf16 v[40:43],v[52:55],a[72:79],v2
s_waitcnt lgkmcnt(5)
v_smfmac_f32_16x16x64_bf16 v[44:47],v[48:51],v[72:79],v2
ds_read_b128 v[72:75],v21 offset:4096
s_waitcnt lgkmcnt(4)
v_smfmac_f32_16x16x64_bf16 v[44:47],v[52:55],v[80:87],v2
ds_read_b128 v[76:79],v21 offset:5120
s_waitcnt lgkmcnt(4)
v_smfmac_f32_16x16x64_bf16 v[24:27],v[60:63],a[80:87],v2
ds_read_b128 v[80:83],v21 offset:6144
v_smfmac_f32_16x16x64_bf16 v[28:31],v[60:63],a[88:95],v2
ds_read_b128 v[84:87],v21 offset:7168
v_smfmac_f32_16x16x64_bf16 v[32:35],v[60:63],a[96:103],v2
s_cmp_eq_u32 s53,0
s_cselect_b32 s54,s4,s5
s_addc_u32 s4,s4,0
v_smfmac_f32_16x16x64_bf16 v[36:39],v[60:63],a[104:111],v2
s_add_u32 s5,s5,s53
s_mul_i32 s73,s54,393216
s_add_u32 s73,s73,s84
v_smfmac_f32_16x16x64_bf16 v[40:43],v[60:63],a[112:119],v2
s_sub_u32 s74,s75,s74
s_mov_b32 m0,s74
s_waitcnt lgkmcnt(2)
v_smfmac_f32_16x16x64_bf16 v[44:47],v[60:63],v[72:79],v2
ds_read_b128 v[60:63],v4 offset:1024
s_and_b32 s60,s52,3
v_smfmac_f32_16x16x64_bf16 v[24:27],v[64:67],a[120:127],v2
ds_read_b128 v[72:75],v21 offset:8192
s_lshl2_add_u32 s60,s51,s60
v_smfmac_f32_16x16x64_bf16 v[28:31],v[64:67],a[128:135],v2
ds_read_b128 v[76:79],v21 offset:9216
s_mul_i32 s60,s60,49152
v_smfmac_f32_16x16x64_bf16 v[32:35],v[64:67],a[136:143],v2
s_add_u32 s71,s60,s34
s_add_u32 s70,s60,s33
s_lshl_b32 s60,s51,9
v_smfmac_f32_16x16x64_bf16 v[36:39],v[64:67],a[144:151],v2
s_add_u32 s72,s60,s35
buffer_load_dwordx4 v1,s[8:11],s73 offen nt sc1 lds
v_smfmac_f32_16x16x64_bf16 v[40:43],v[64:67],a[152:159],v2
buffer_load_dwordx4 v1,s[8:11],s73 offen offset:1024 nt sc1 lds
s_waitcnt lgkmcnt(3)
v_smfmac_f32_16x16x64_bf16 v[44:47],v[64:67],v[80:87],v2
ds_read_b128 v[64:67],v5 offset:0
v_smfmac_f32_16x16x64_bf16 v[24:27],v[68:71],a[160:167],v2
ds_read_b128 v[80:83],v21 offset:10240
v_smfmac_f32_16x16x64_bf16 v[28:31],v[68:71],a[168:175],v2
ds_read_b128 v[84:87],v21 offset:11264
v_smfmac_f32_16x16x64_bf16 v[32:35],v[68:71],a[176:183],v2
buffer_load_dwordx4 v1,s[8:11],s73 offen offset:2048 nt sc1 lds
v_smfmac_f32_16x16x64_bf16 v[36:39],v[68:71],a[184:191],v2
buffer_load_dwordx4 v1,s[8:11],s73 offen offset:3072 nt sc1 lds
s_and_b32 s60,s54,3
v_smfmac_f32_16x16x64_bf16 v[40:43],v[68:71],a[192:199],v2
s_lshl2_add_u32 s60,s53,s60
s_lshl_b32 s68,s60,16
s_waitcnt lgkmcnt(3)
v_smfmac_f32_16x16x64_bf16 v[44:47],v[68:71],v[72:79],v2
ds_read_b128 v[68:71],v5 offset:1024
s_add_u32 s68,s68,s83
v_smfmac_f32_16x16x64_bf16 v[24:27],v[60:63],a[200:207],v2
ds_read_b128 v[72:75],v21 offset:12288
s_mul_i32 s59,s60,20480
v_smfmac_f32_16x16x64_bf16 v[28:31],v[60:63],a[208:215],v2
ds_read_b128 v[76:79],v21 offset:13312
s_add_u32 s59,s59,s6
v_smfmac_f32_16x16x64_bf16 v[32:35],v[60:63],a[216:223],v2
s_lshl_b32 s69,s53,9
s_add_u32 s69,s69,s7
s_bfe_u32 s31,s54,0x10002
v_smfmac_f32_16x16x64_bf16 v[36:39],v[60:63],a[224:231],v2
s_add_u32 s32,s54,1
v_add_u32 v17,s85,v58
v_smfmac_f32_16x16x64_bf16 v[40:43],v[60:63],a[232:239],v2
v_mov_b32 v16,s58
s_waitcnt lgkmcnt(3)
v_smfmac_f32_16x16x64_bf16 v[44:47],v[60:63],v[80:87],v2
ds_read_b128 v[60:63],v59 offset:0
v_mov_b32 v15,0
v_smfmac_f32_16x16x64_bf16 v[24:27],v[64:67],a[240:247],v2
ds_read_b128 v[80:83],v21 offset:14336
v_smfmac_f32_16x16x64_bf16 v[28:31],v[64:67],a[248:255],v2
ds_read_b128 v[84:87],v21 offset:15360
v_smfmac_f32_16x16x64_bf16 v[32:35],v[64:67],v[112:119],v2
ds_read_b128 v[88:91],v58 offset:0
v_smfmac_f32_16x16x64_bf16 v[36:39],v[64:67],v[120:127],v2
ds_read_b128 v[92:95],v58 offset:1024
v_smfmac_f32_16x16x64_bf16 v[40:43],v[64:67],v[128:135],v2
ds_read_b128 v[96:99],v58 offset:2048
s_waitcnt lgkmcnt(6)
v_smfmac_f32_16x16x64_bf16 v[44:47],v[64:67],v[72:79],v2
ds_read_b128 v[64:67],v59 offset:1024
v_smfmac_f32_16x16x64_bf16 v[24:27],v[68:71],v[136:143],v2
ds_read_b128 v[72:75],v21 offset:16384
v_smfmac_f32_16x16x64_bf16 v[28:31],v[68:71],v[144:151],v2
ds_read_b128 v[76:79],v21 offset:17408
v_smfmac_f32_16x16x64_bf16 v[32:35],v[68:71],v[152:159],v2
ds_read_b128 v[100:103],v58 offset:3072
v_smfmac_f32_16x16x64_bf16 v[36:39],v[68:71],v[160:167],v2
ds_read_b128 v[104:107],v58 offset:4096
v_smfmac_f32_16x16x64_bf16 v[40:43],v[68:71],v[168:175],v2
ds_read_b128 v[108:111],v58 offset:5120
s_waitcnt lgkmcnt(9)
v_smfmac_f32_16x16x64_bf16 v[44:47],v[68:71],v[80:87],v2
ds_read_b128 v[80:83],v21 offset:18432
v_smfmac_f32_16x16x64_bf16 v[24:27],v[60:63],v[176:183],v2
ds_read_b128 v[84:87],v21 offset:19456
v_smfmac_f32_16x16x64_bf16 v[36:39],v[60:63],v[200:207],v2
ds_read_b128 v[48:51],v58 offset:6144
s_waitcnt lgkmcnt(8)
v_smfmac_f32_16x16x64_bf16 v[24:27],v[64:67],v[216:223],v2
ds_read_b128 v[52:55],v58 offset:7168
v_smfmac_f32_16x16x64_bf16 v[36:39],v[64:67],v[240:247],v2
v_smfmac_f32_16x16x64_bf16 v[28:31],v[60:63],v[184:191],v2
v_smfmac_f32_16x16x64_bf16 v[40:43],v[60:63],v[208:215],v2
s_nop 3
v_add_f32 v24,v24,v25
v_smfmac_f32_16x16x64_bf16 v[28:31],v[64:67],v[224:231],v2
v_add_f32 v26,v26,v27
v_smfmac_f32_16x16x64_bf16 v[40:43],v[64:67],v[248:255],v2
v_add_f32 v36,v36,v37
v_smfmac_f32_16x16x64_bf16 v[32:35],v[60:63],v[192:199],v2
v_add_f32 v38,v38,v39
s_waitcnt lgkmcnt(7)
v_smfmac_f32_16x16x64_bf16 v[44:47],v[60:63],v[72:79],v2
v_cvt_pk_bf16_f32 v37,v24,v26
v_smfmac_f32_16x16x64_bf16 v[32:35],v[64:67],v[232:239],v2
v_cvt_pk_bf16_f32 v36,v36,v38
s_waitcnt lgkmcnt(2)
v_smfmac_f32_16x16x64_bf16 v[44:47],v[64:67],v[80:87],v2
ds_write_b64 v6,v[36:37] offset:0
v_add_f32 v28,v28,v29
v_add_f32 v30,v30,v31
v_add_f32 v40,v40,v41
v_add_f32 v42,v42,v43
v_cvt_pk_bf16_f32 v41,v28,v30
v_cvt_pk_bf16_f32 v40,v40,v42
ds_write_b64 v6,v[40:41] offset:512
v_add_f32 v32,v32,v33
v_add_f32 v34,v34,v35
v_add_f32 v44,v44,v45
v_add_f32 v46,v46,v47
v_cvt_pk_bf16_f32 v45,v32,v34
v_cvt_pk_bf16_f32 v44,v44,v46
ds_write_b64 v6,v[44:45] offset:1024
s_cmp_eq_u32 s52,63
s_cbranch_scc1 last_100
ds_read_b128 v[72:75],v58 offset:8192
ds_read_b128 v[76:79],v58 offset:9216
s_waitcnt lgkmcnt(2)
s_barrier
ds_read_b64_tr_b16 v[24:25],v7 offset:0
ds_read_b64_tr_b16 v[26:27],v7 offset:512
ds_read_b64_tr_b16 v[28:29],v7 offset:1024
ds_read_b64_tr_b16 v[30:31],v7 offset:1536
ds_read_b64_tr_b16 v[32:33],v7 offset:2048
ds_read_b64_tr_b16 v[34:35],v7 offset:2560
ds_read_b64_tr_b16 v[36:37],v7 offset:3072
ds_read_b64_tr_b16 v[38:39],v7 offset:3584
s_waitcnt lgkmcnt(6)
v_mfma_f32_16x16x32_bf16 v[60:63],v[88:91],v[24:27],0
ds_read_b64_tr_b16 v[40:41],v7 offset:4096
s_mov_b64 vcc,s[88:89]
v_mfma_f32_16x16x32_bf16 v[64:67],v[92:95],v[24:27],0
ds_read_b64_tr_b16 v[42:43],v7 offset:4608
v_mfma_f32_16x16x32_bf16 v[68:71],v[24:27],v[24:27],0
ds_read_b128 v[80:83],v58 offset:10240
s_waitcnt lgkmcnt(7)
v_mfma_f32_16x16x32_bf16 v[60:63],v[96:99],v[28:31],v[60:63]
ds_read_b128 v[84:87],v58 offset:11264
v_mfma_f32_16x16x32_bf16 v[64:67],v[100:103],v[28:31],v[64:67]
ds_read_b64_tr_b16 v[44:45],v7 offset:5120
v_mfma_f32_16x16x32_bf16 v[68:71],v[28:31],v[28:31],v[68:71]
ds_read_b64_tr_b16 v[46:47],v7 offset:5632
s_waitcnt lgkmcnt(8)
v_mfma_f32_16x16x32_bf16 v[60:63],v[104:107],v[32:35],v[60:63]
ds_read_b128 v[88:91],v17 offset:12288
v_mfma_f32_16x16x32_bf16 v[64:67],v[108:111],v[32:35],v[64:67]
ds_read_b128 v[92:95],v17 offset:13312
v_mfma_f32_16x16x32_bf16 v[68:71],v[32:35],v[32:35],v[68:71]
ds_read_b128 v[96:99],v17 offset:14336
s_waitcnt lgkmcnt(9)
v_mfma_f32_16x16x32_bf16 v[60:63],v[48:51],v[36:39],v[60:63]
ds_read_b128 v[100:103],v17 offset:15360
v_mfma_f32_16x16x32_bf16 v[64:67],v[52:55],v[36:39],v[64:67]
v_mfma_f32_16x16x32_bf16 v[68:71],v[36:39],v[36:39],v[68:71]
s_waitcnt lgkmcnt(8)
v_mfma_f32_16x16x32_bf16 v[60:63],v[72:75],v[40:43],v[60:63]
v_mfma_f32_16x16x32_bf16 v[64:67],v[76:79],v[40:43],v[64:67]
v_mfma_f32_16x16x32_bf16 v[68:71],v[40:43],v[40:43],v[68:71]
s_waitcnt lgkmcnt(4)
v_mfma_f32_16x16x32_bf16 v[60:63],v[80:83],v[44:47],v[60:63]
v_mfma_f32_16x16x32_bf16 v[64:67],v[84:87],v[44:47],v[64:67]
buffer_load_dwordx4 v[104:107],v1,s[8:11],s71 offen sc1
v_mfma_f32_16x16x32_bf16 v[68:71],v[44:47],v[44:47],v[68:71]
s_nop 5
v_cndmask_b32_dpp v60,v64,v60,vcc quad_perm:[2,3,2,3] row_mask:0xf bank_mask:0xf
v_cndmask_b32_dpp v61,v65,v61,vcc quad_perm:[2,3,2,3] row_mask:0xf bank_mask:0xf
v_cndmask_b32_dpp v62,v66,v62,vcc quad_perm:[2,3,2,3] row_mask:0xf bank_mask:0xf
v_cndmask_b32_dpp v63,v67,v63,vcc quad_perm:[2,3,2,3] row_mask:0xf bank_mask:0xf
v_max3_f32 v12,v60,v61,v62
v_cndmask_b32_dpp v68,v69,v68,vcc quad_perm:[2,3,2,3] row_mask:0xf bank_mask:0xf
v_max3_f32 v12,v12,v63,v68
s_nop 1
v_max_f32_dpp v13,v12,v12 quad_perm:[2,3,0,1] row_mask:0xf bank_mask:0xf
v_max_f32_dpp v12,v12,v12 quad_perm:[2,3,0,1] row_mask:0xf bank_mask:0xf
s_nop 1
v_permlane32_swap_b32 v12,v13
v_max_f32 v64,v12,v13
v_max_f32 v12,v12,v13
s_mov_b64 exec,1
buffer_store_dword v16,v1,s[8:11],s72 offen sc1
s_mov_b64 exec,-1
v_permlane16_swap_b32 v12,v64
v_max_f32 v12,v12,v64
v_mul_f32 v12,s87,v12
v_fma_f32 v60,v60,s87,-v12
v_fma_f32 v61,v61,s87,-v12
v_fma_f32 v62,v62,s87,-v12
v_fma_f32 v63,v63,s87,-v12
v_fma_f32 v68,v68,s87,-v12
v_exp_f32 v60,v60
v_exp_f32 v61,v61
v_exp_f32 v62,v62
v_exp_f32 v63,v63
v_exp_f32 v68,v68
v_cvt_pk_bf16_f32 v34,v60,v61
v_cvt_pk_bf16_f32 v35,v62,v63
v_cndmask_b32 v30,v34,v15,vcc
v_cndmask_b32 v31,v35,v15,vcc
v_cndmask_b32_dpp v28,v34,v15,vcc quad_perm:[2,3,0,1] row_mask:0xf bank_mask:0xf
v_cndmask_b32_dpp v29,v35,v15,vcc quad_perm:[2,3,0,1] row_mask:0xf bank_mask:0xf
s_mov_b64 vcc,s[90:91]
s_waitcnt lgkmcnt(0)
v_cndmask_b32 v24,v34,v15,vcc
v_mfma_f32_16x16x32_bf16 v[36:39],v[92:95],v[28:31],0
v_cndmask_b32 v25,v35,v15,vcc
v_cndmask_b32_dpp v26,v34,v15,vcc quad_perm:[2,3,0,1] row_mask:0xf bank_mask:0xf
v_mfma_f32_16x16x32_bf16 v[40:43],v[100:103],v[28:31],0
v_cndmask_b32_dpp v27,v35,v15,vcc quad_perm:[2,3,0,1] row_mask:0xf bank_mask:0xf
v_mov_b32_dpp v14,v68 quad_perm:[2,3,0,1] row_mask:0xf bank_mask:0xf
v_add_f32 v12,v60,v61
v_mfma_f32_16x16x32_bf16 v[36:39],v[88:91],v[24:27],v[36:39]
v_cvt_pk_bf16_f32 v32,v68,v14
v_cvt_pk_bf16_f32 v33,v14,v68
v_mfma_f32_16x16x32_bf16 v[40:43],v[96:99],v[24:27],v[40:43]
v_cndmask_b32 v32,v32,v15,vcc
v_cndmask_b32 v33,v15,v33,vcc
ds_read_b32 v10,v9
s_waitcnt vmcnt(1)
v_bitop3_b32 v17,v104,v106,s57 bitop3:0x7e
v_add_f32 v13,v62,v63
v_and_b32 v17,1,v17
v_add_f32 v12,v12,v68
v_cmp_ne_u32 vcc,0,v17
v_add_f32 v12,v12,v13
s_cbranch_vccnz vb_101
vo_102:
v_mfma_f32_16x16x16_bf16 v[36:39],v[104:105],v[32:33],v[36:39]
v_add_f32_dpp v13,v12,v12 quad_perm:[2,3,0,1] row_mask:0xf bank_mask:0xf
v_add_f32_dpp v12,v12,v12 quad_perm:[2,3,0,1] row_mask:0xf bank_mask:0xf
v_mfma_f32_16x16x16_bf16 v[40:43],v[106:107],v[32:33],v[40:43]
s_nop 0
v_permlane32_swap_b32 v12,v13
v_add_f32 v64,v12,v13
v_add_f32 v12,v12,v13
s_add_u32 s50,s50,1
s_mov_b32 s51,s53
v_permlane16_swap_b32 v12,v64
v_add_f32 v12,v12,v64
v_rcp_f32 v12,v12
s_mov_b32 s52,s54
v_pk_mul_f32 v[36:37],v[36:37],v[12:13] op_sel_hi:[1,0]
v_pk_mul_f32 v[38:39],v[38:39],v[12:13] op_sel_hi:[1,0]
v_pk_mul_f32 v[40:41],v[40:41],v[12:13] op_sel_hi:[1,0]
v_pk_mul_f32 v[42:43],v[42:43],v[12:13] op_sel_hi:[1,0]
v_cvt_pk_bf16_f32 v48,v36,v37
v_cvt_pk_bf16_f32 v49,v38,v39
v_cvt_pk_bf16_f32 v50,v40,v41
v_cvt_pk_bf16_f32 v51,v42,v43
v_and_or_b32 v48,v48,-2,s57
buffer_store_dwordx4 v[48:51],v8,s[8:11],s70 offen sc1
s_mov_b32 s57,s31
s_mov_b32 s58,s32
s_waitcnt lgkmcnt(0)
v_cmp_ne_u32 vcc,s50,v10
v_mov_b32 v12,s50
ds_write_b32 v20,v12
s_branch CS_LOOP_S
last_100:
s_waitcnt lgkmcnt(0)
s_barrier
s_add_u32 s50,s50,1
s_mov_b32 s51,s53
s_mov_b32 s52,s54
s_mov_b32 s57,s31
s_mov_b32 s58,s32
s_mov_b64 vcc,-1
s_waitcnt vmcnt(0)
v_mov_b32 v12,s50
ds_write_b32 v20,v12
s_cmp_lt_u32 s50,128
s_cbranch_scc1 CS_LOOP_S
s_branch CS_DONE
fr_98:
v_bitop3_b32 v12,v60,v64,s57 bitop3:0x7e
v_bitop3_b32 v13,v68,v72,s57 bitop3:0x7e
v_xor_b32 v14,s57,v76
v_or3_b32 v12,v12,v13,v14
v_and_b32 v12,1,v12
v_cmp_ne_u32 vcc,0,v12
s_cbranch_vccz sk_103
buffer_load_dwordx4 v[76:79],v18,s[8:11],s59 offen sc1
buffer_load_dwordx4 v[60:63],v1,s[8:11],s59 offen sc1
buffer_load_dwordx4 v[64:67],v1,s[8:11],s59 offen offset:1024 sc1
buffer_load_dwordx4 v[68:71],v1,s[8:11],s59 offen offset:2048 sc1
buffer_load_dwordx4 v[72:75],v1,s[8:11],s59 offen offset:3072 sc1
sk_103:
buffer_load_dwordx4 v[96:99],v18,s[8:11],s68 offen sc1
buffer_load_dwordx4 v[80:83],v1,s[8:11],s68 offen sc1
buffer_load_dwordx4 v[84:87],v1,s[8:11],s68 offen offset:1024 sc1
buffer_load_dwordx4 v[88:91],v1,s[8:11],s68 offen offset:2048 sc1
buffer_load_dwordx4 v[92:95],v1,s[8:11],s68 offen offset:3072 sc1
s_sub_u32 s47,s47,1
s_cbranch_scc1 ABORT
s_waitcnt lgkmcnt(0)
s_branch fa_97
CS_FAST_S:
buffer_load_dwordx4 v[96:99],v18,s[8:11],s68 offen sc1
buffer_load_dwordx4 v[80:83],v1,s[8:11],s68 offen sc1
buffer_load_dwordx4 v[84:87],v1,s[8:11],s68 offen offset:1024 sc1
buffer_load_dwordx4 v[88:91],v1,s[8:11],s68 offen offset:2048 sc1
buffer_load_dwordx4 v[92:95],v1,s[8:11],s68 offen offset:3072 sc1
v_mov_b32 v24,0
v_mov_b32 v25,0
v_mov_b32 v26,0
v_mov_b32 v27,0
v_mov_b32 v28,0
v_mov_b32 v29,0
v_mov_b32 v30,0
v_mov_b32 v31,0
v_mov_b32 v32,0
v_mov_b32 v33,0
v_mov_b32 v34,0
v_mov_b32 v35,0
v_mov_b32 v36,0
v_mov_b32 v37,0
v_mov_b32 v38,0
v_mov_b32 v39,0
v_mov_b32 v40,0
v_mov_b32 v41,0
v_mov_b32 v42,0
v_mov_b32 v43,0
v_mov_b32 v44,0
v_mov_b32 v45,0
v_mov_b32 v46,0
v_mov_b32 v47,0
s_nop 0
s_branch fj_99
vb_101:
s_sub_u32 s47,s47,1
s_cbranch_scc1 ABORT
buffer_load_dwordx4 v[104:107],v1,s[8:11],s71 offen sc1
s_waitcnt vmcnt(0)
v_bitop3_b32 v17,v104,v106,s57 bitop3:0x7e
v_and_b32 v17,1,v17
v_cmp_ne_u32 vcc,0,v17
s_nop 0
s_cbranch_vccnz vb_101
s_branch vo_102
CH_START:
s_sub_u32 s60,s4,s5
s_cmp_gt_i32 s60,15
s_cselect_b32 s53,1,0
s_cmp_eq_u32 s4,64
s_cselect_b32 s53,1,s53
s_cmp_eq_u32 s53,0
s_cselect_b32 s54,s4,s5
s_addc_u32 s4,s4,0
s_add_u32 s5,s5,s53
s_sub_u32 s60,s4,s5
s_cmp_gt_i32 s60,15
s_cselect_b32 s55,1,0
s_cmp_eq_u32 s4,64
s_cselect_b32 s55,1,s55
s_cmp_eq_u32 s55,0
s_cselect_b32 s56,s4,s5
s_addc_u32 s4,s4,0
s_add_u32 s5,s5,s55
s_mov_b32 s74,81920
s_mul_i32 s73,s52,393216
s_add_u32 s73,s73,s84
s_lshl_b32 s75,s51,6
s_add_u32 s75,s75,s52
s_lshl_b32 s75,s75,9
s_add_u32 s75,s75,131072
fl_104:
buffer_load_dword v12,v9,s[8:11],s75 offen sc1
s_waitcnt vmcnt(0)
v_cmp_eq_u32 vcc,0,v12
s_nop 0
s_cbranch_vccz ok_105
s_sleep 1
s_sub_u32 s47,s47,1
s_cbranch_scc1 ABORT
s_branch fl_104
ok_105:
s_add_u32 m0,s74,0
s_add_u32 s67,s73,0
buffer_load_dwordx4 v1,s[8:11],s67 offen nt sc1 lds
buffer_load_dwordx4 v1,s[8:11],s67 offen offset:1024 nt sc1 lds
buffer_load_dwordx4 v1,s[8:11],s67 offen offset:2048 nt sc1 lds
buffer_load_dwordx4 v1,s[8:11],s67 offen offset:3072 nt sc1 lds
s_add_u32 m0,s74,4096
s_add_u32 s67,s73,4096
buffer_load_dwordx4 v1,s[8:11],s67 offen nt sc1 lds
buffer_load_dwordx4 v1,s[8:11],s67 offen offset:1024 nt sc1 lds
buffer_load_dwordx4 v1,s[8:11],s67 offen offset:2048 nt sc1 lds
buffer_load_dwordx4 v1,s[8:11],s67 offen offset:3072 nt sc1 lds
s_add_u32 m0,s74,8192
s_add_u32 s67,s73,8192
buffer_load_dwordx4 v1,s[8:11],s67 offen nt sc1 lds
buffer_load_dwordx4 v1,s[8:11],s67 offen offset:1024 nt sc1 lds
buffer_load_dwordx4 v1,s[8:11],s67 offen offset:2048 nt sc1 lds
buffer_load_dwordx4 v1,s[8:11],s67 offen offset:3072 nt sc1 lds
s_add_u32 m0,s74,12288
s_add_u32 s67,s73,25165824
buffer_load_dwordx4 v1,s[8:11],s67 offen nt sc1 lds
buffer_load_dwordx4 v1,s[8:11],s67 offen offset:1024 nt sc1 lds
buffer_load_dwordx4 v1,s[8:11],s67 offen offset:2048 nt sc1 lds
buffer_load_dwordx4 v1,s[8:11],s67 offen offset:3072 nt sc1 lds
s_add_u32 m0,s74,16384
s_add_u32 s67,s73,25169920
buffer_load_dwordx4 v1,s[8:11],s67 offen nt sc1 lds
buffer_load_dwordx4 v1,s[8:11],s67 offen offset:1024 nt sc1 lds
buffer_load_dwordx4 v1,s[8:11],s67 offen offset:2048 nt sc1 lds
buffer_load_dwordx4 v1,s[8:11],s67 offen offset:3072 nt sc1 lds
s_add_u32 m0,s74,20480
s_add_u32 s67,s73,25174016
buffer_load_dwordx4 v1,s[8:11],s67 offen nt sc1 lds
buffer_load_dwordx4 v1,s[8:11],s67 offen offset:1024 nt sc1 lds
buffer_load_dwordx4 v1,s[8:11],s67 offen offset:2048 nt sc1 lds
buffer_load_dwordx4 v1,s[8:11],s67 offen offset:3072 nt sc1 lds
s_mov_b32 s74,106496
s_mul_i32 s73,s54,393216
s_add_u32 s73,s73,s84
s_lshl_b32 s75,s53,6
s_add_u32 s75,s75,s54
s_lshl_b32 s75,s75,9
s_add_u32 s75,s75,131072
s_lshl_b32 s76,s55,6
s_add_u32 s76,s76,s56
s_lshl_b32 s76,s76,9
s_add_u32 s76,s76,131072
s_mov_b32 s77,1
v_min_u32 v8,2,v0
v_lshlrev_b32 v8,2,v8
v_add_u32 v8,147456,v8
v_mov_b32 v58,147468
s_nop 1
CH_LOOP:
v_mov_b32 v24,0
v_mov_b32 v25,0
v_mov_b32 v26,0
v_mov_b32 v27,0
v_mov_b32 v28,0
v_mov_b32 v29,0
v_mov_b32 v30,0
v_mov_b32 v31,0
v_mov_b32 v32,0
v_mov_b32 v33,0
v_mov_b32 v34,0
v_mov_b32 v35,0
v_mov_b32 v36,0
v_mov_b32 v37,0
v_mov_b32 v38,0
v_mov_b32 v39,0
v_mov_b32 v40,0
v_mov_b32 v41,0
v_mov_b32 v42,0
v_mov_b32 v43,0
v_mov_b32 v44,0
v_mov_b32 v45,0
v_mov_b32 v46,0
v_mov_b32 v47,0
v_mov_b32 v14,s50
s_nop 1
db_109:
buffer_load_dword v12,v11,s[8:11],s69 offen sc1
s_waitcnt vmcnt(0)
v_cmp_gt_u32 vcc,s58,v12
s_cbranch_vccz dbok_110
s_sub_u32 s47,s47,1
s_cbranch_scc1 ABORT
s_branch db_109
dbok_110:
ds_write_b32 v58,v14
buffer_load_dwordx4 v[76:79],v18,s[8:11],s59 offen sc1
buffer_load_dwordx4 v[60:63],v1,s[8:11],s59 offen sc1
buffer_load_dwordx4 v[64:67],v1,s[8:11],s59 offen offset:1024 sc1
buffer_load_dwordx4 v[68:71],v1,s[8:11],s59 offen offset:2048 sc1
buffer_load_dwordx4 v[72:75],v1,s[8:11],s59 offen offset:3072 sc1
s_barrier
s_waitcnt vmcnt(4)
buffer_load_dwordx4 v[96:99],v18,s[8:11],s68 offen sc1
buffer_load_dwordx4 v[80:83],v1,s[8:11],s68 offen sc1
buffer_load_dwordx4 v[84:87],v1,s[8:11],s68 offen offset:1024 sc1
buffer_load_dwordx4 v[88:91],v1,s[8:11],s68 offen offset:2048 sc1
buffer_load_dwordx4 v[92:95],v1,s[8:11],s68 offen offset:3072 sc1
fj_108:
fa_106:
s_waitcnt vmcnt(4)
v_pk_add_f32 v[12:13],v[76:77],v[96:97]
v_pk_add_f32 v[14:15],v[78:79],v[98:99]
v_bitop3_b32 v16,v76,v96,s57 bitop3:0x7e
v_cvt_pk_bf16_f32 v56,v12,v13
v_cvt_pk_bf16_f32 v57,v14,v15
ds_write_b64 v23,v[56:57]
s_waitcnt vmcnt(3)
v_pk_add_f32 v[12:13],v[60:61],v[80:81]
v_pk_add_f32 v[14:15],v[62:63],v[82:83]
v_bitop3_b32 v17,v60,v80,s57 bitop3:0x7e
v_cvt_pk_bf16_f32 v48,v12,v13
v_cvt_pk_bf16_f32 v49,v14,v15
v_or_b32 v16,v16,v17
s_waitcnt vmcnt(2)
v_pk_add_f32 v[12:13],v[64:65],v[84:85]
v_pk_add_f32 v[14:15],v[66:67],v[86:87]
v_bitop3_b32 v17,v64,v84,s57 bitop3:0x7e
v_cvt_pk_bf16_f32 v50,v12,v13
v_cvt_pk_bf16_f32 v51,v14,v15
v_or_b32 v16,v16,v17
ds_write_b128 v22,v[48:51] offset:0
s_waitcnt vmcnt(1)
v_pk_add_f32 v[12:13],v[68:69],v[88:89]
v_pk_add_f32 v[14:15],v[70:71],v[90:91]
v_bitop3_b32 v17,v68,v88,s57 bitop3:0x7e
v_cvt_pk_bf16_f32 v52,v12,v13
v_cvt_pk_bf16_f32 v53,v14,v15
v_or_b32 v16,v16,v17
s_waitcnt vmcnt(0)
v_pk_add_f32 v[12:13],v[72:73],v[92:93]
v_pk_add_f32 v[14:15],v[74:75],v[94:95]
v_bitop3_b32 v17,v72,v92,s57 bitop3:0x7e
v_cvt_pk_bf16_f32 v54,v12,v13
v_cvt_pk_bf16_f32 v55,v14,v15
v_bitop3_b32 v16,v16,v17,1 bitop3:0xa8
v_cmp_ne_u32 vcc,0,v16
ds_write_b128 v22,v[52:55] offset:1024
s_cbranch_vccnz fr_107
v_smfmac_f32_16x16x64_bf16 v[24:27],v[48:51],a[0:7],v2
ds_read_b128 v[72:75],v21 offset:0
v_smfmac_f32_16x16x64_bf16 v[28:31],v[48:51],a[8:15],v2
ds_read_b128 v[76:79],v21 offset:1024
v_smfmac_f32_16x16x64_bf16 v[32:35],v[48:51],a[16:23],v2
ds_read_b128 v[80:83],v21 offset:2048
v_smfmac_f32_16x16x64_bf16 v[36:39],v[48:51],a[24:31],v2
ds_read_b128 v[84:87],v21 offset:3072
s_waitcnt lgkmcnt(4)
s_barrier
v_smfmac_f32_16x16x64_bf16 v[40:43],v[48:51],a[32:39],v2
ds_read_b128 v[60:63],v3 offset:0
v_smfmac_f32_16x16x64_bf16 v[24:27],v[52:55],a[40:47],v2
ds_read_b128 v[64:67],v3 offset:1024
v_smfmac_f32_16x16x64_bf16 v[28:31],v[52:55],a[48:55],v2
ds_read_b128 v[68:71],v4 offset:0
v_smfmac_f32_16x16x64_bf16 v[32:35],v[52:55],a[56:63],v2
s_add_u32 m0,s74,12288
s_add_u32 s67,s73,25165824
v_smfmac_f32_16x16x64_bf16 v[36:39],v[52:55],a[64:71],v2
buffer_load_dwordx4 v1,s[8:11],s67 offen nt sc1 lds
v_smfmac_f32_16x16x64_bf16 v[40:43],v[52:55],a[72:79],v2
buffer_load_dwordx4 v1,s[8:11],s67 offen offset:1024 nt sc1 lds
s_waitcnt lgkmcnt(5)
v_smfmac_f32_16x16x64_bf16 v[44:47],v[48:51],v[72:79],v2
ds_read_b128 v[72:75],v21 offset:4096
s_waitcnt lgkmcnt(4)
v_smfmac_f32_16x16x64_bf16 v[44:47],v[52:55],v[80:87],v2
ds_read_b128 v[76:79],v21 offset:5120
s_waitcnt lgkmcnt(4)
v_smfmac_f32_16x16x64_bf16 v[24:27],v[60:63],a[80:87],v2
ds_read_b128 v[80:83],v21 offset:6144
v_smfmac_f32_16x16x64_bf16 v[28:31],v[60:63],a[88:95],v2
ds_read_b128 v[84:87],v21 offset:7168
v_smfmac_f32_16x16x64_bf16 v[32:35],v[60:63],a[96:103],v2
buffer_load_dwordx4 v1,s[8:11],s67 offen offset:2048 nt sc1 lds
v_smfmac_f32_16x16x64_bf16 v[36:39],v[60:63],a[104:111],v2
buffer_load_dwordx4 v1,s[8:11],s67 offen offset:3072 nt sc1 lds
v_smfmac_f32_16x16x64_bf16 v[40:43],v[60:63],a[112:119],v2
s_add_u32 m0,s74,16384
s_add_u32 s67,s73,25169920
s_waitcnt lgkmcnt(2)
v_smfmac_f32_16x16x64_bf16 v[44:47],v[60:63],v[72:79],v2
ds_read_b128 v[60:63],v4 offset:1024
v_smfmac_f32_16x16x64_bf16 v[24:27],v[64:67],a[120:127],v2
ds_read_b128 v[72:75],v21 offset:8192
v_smfmac_f32_16x16x64_bf16 v[28:31],v[64:67],a[128:135],v2
ds_read_b128 v[76:79],v21 offset:9216
v_smfmac_f32_16x16x64_bf16 v[32:35],v[64:67],a[136:143],v2
buffer_load_dwordx4 v1,s[8:11],s67 offen nt sc1 lds
v_smfmac_f32_16x16x64_bf16 v[36:39],v[64:67],a[144:151],v2
buffer_load_dwordx4 v1,s[8:11],s67 offen offset:1024 nt sc1 lds
v_smfmac_f32_16x16x64_bf16 v[40:43],v[64:67],a[152:159],v2
buffer_load_dwordx4 v1,s[8:11],s67 offen offset:2048 nt sc1 lds
s_waitcnt lgkmcnt(3)
v_smfmac_f32_16x16x64_bf16 v[44:47],v[64:67],v[80:87],v2
ds_read_b128 v[64:67],v5 offset:0
v_smfmac_f32_16x16x64_bf16 v[24:27],v[68:71],a[160:167],v2
ds_read_b128 v[80:83],v21 offset:10240
v_smfmac_f32_16x16x64_bf16 v[28:31],v[68:71],a[168:175],v2
ds_read_b128 v[84:87],v21 offset:11264
v_smfmac_f32_16x16x64_bf16 v[32:35],v[68:71],a[176:183],v2
buffer_load_dwordx4 v1,s[8:11],s67 offen offset:3072 nt sc1 lds
v_smfmac_f32_16x16x64_bf16 v[36:39],v[68:71],a[184:191],v2
s_add_u32 m0,s74,20480
s_add_u32 s67,s73,25174016
v_smfmac_f32_16x16x64_bf16 v[40:43],v[68:71],a[192:199],v2
buffer_load_dwordx4 v1,s[8:11],s67 offen nt sc1 lds
s_waitcnt lgkmcnt(3)
v_smfmac_f32_16x16x64_bf16 v[44:47],v[68:71],v[72:79],v2
ds_read_b128 v[68:71],v5 offset:1024
v_smfmac_f32_16x16x64_bf16 v[24:27],v[60:63],a[200:207],v2
ds_read_b128 v[72:75],v21 offset:12288
v_smfmac_f32_16x16x64_bf16 v[28:31],v[60:63],a[208:215],v2
ds_read_b128 v[76:79],v21 offset:13312
v_smfmac_f32_16x16x64_bf16 v[32:35],v[60:63],a[216:223],v2
buffer_load_dwordx4 v1,s[8:11],s67 offen offset:1024 nt sc1 lds
v_smfmac_f32_16x16x64_bf16 v[36:39],v[60:63],a[224:231],v2
buffer_load_dwordx4 v1,s[8:11],s67 offen offset:2048 nt sc1 lds
v_smfmac_f32_16x16x64_bf16 v[40:43],v[60:63],a[232:239],v2
buffer_load_dwordx4 v1,s[8:11],s67 offen offset:3072 nt sc1 lds
s_waitcnt lgkmcnt(3)
v_smfmac_f32_16x16x64_bf16 v[44:47],v[60:63],v[80:87],v2
ds_read_b128 v[60:63],v59 offset:0
v_smfmac_f32_16x16x64_bf16 v[24:27],v[64:67],a[240:247],v2
ds_read_b128 v[80:83],v21 offset:14336
v_smfmac_f32_16x16x64_bf16 v[28:31],v[64:67],a[248:255],v2
ds_read_b128 v[84:87],v21 offset:15360
v_smfmac_f32_16x16x64_bf16 v[32:35],v[64:67],v[112:119],v2
s_cmp_eq_u32 s79,-1
s_cbranch_scc1 pf_111
v_mov_b32 v17,1
s_mov_b64 exec,1
buffer_store_dword v17,v1,s[8:11],s79 offen sc1
s_mov_b64 exec,-1
s_mov_b32 s79,-1
pf_111:
v_smfmac_f32_16x16x64_bf16 v[36:39],v[64:67],v[120:127],v2
s_cmp_eq_u32 s78,-1
s_cbranch_scc1 pk_112
buffer_store_dwordx4 v[100:103],v20,s[8:11],s78 offen sc1
buffer_store_dwordx4 v[104:107],v20,s[8:11],s78 offen offset:1024 sc1
buffer_store_dwordx4 v[108:111],v20,s[8:11],s78 offen offset:2048 sc1
s_mov_b32 s79,s30
s_mov_b32 s78,-1
pk_112:
v_smfmac_f32_16x16x64_bf16 v[40:43],v[64:67],v[128:135],v2
buffer_load_dword v10,v9,s[8:11],s76 offen sc1
s_waitcnt lgkmcnt(3)
v_smfmac_f32_16x16x64_bf16 v[44:47],v[64:67],v[72:79],v2
ds_read_b128 v[64:67],v59 offset:1024
v_smfmac_f32_16x16x64_bf16 v[24:27],v[68:71],v[136:143],v2
ds_read_b128 v[72:75],v21 offset:16384
v_smfmac_f32_16x16x64_bf16 v[28:31],v[68:71],v[144:151],v2
ds_read_b128 v[76:79],v21 offset:17408
v_smfmac_f32_16x16x64_bf16 v[32:35],v[68:71],v[152:159],v2
v_smfmac_f32_16x16x64_bf16 v[36:39],v[68:71],v[160:167],v2
v_smfmac_f32_16x16x64_bf16 v[40:43],v[68:71],v[168:175],v2
s_waitcnt lgkmcnt(3)
v_smfmac_f32_16x16x64_bf16 v[44:47],v[68:71],v[80:87],v2
ds_read_b128 v[80:83],v21 offset:18432
v_smfmac_f32_16x16x64_bf16 v[24:27],v[60:63],v[176:183],v2
ds_read_b128 v[84:87],v21 offset:19456
v_smfmac_f32_16x16x64_bf16 v[36:39],v[60:63],v[200:207],v2
s_waitcnt lgkmcnt(4)
v_smfmac_f32_16x16x64_bf16 v[24:27],v[64:67],v[216:223],v2
v_smfmac_f32_16x16x64_bf16 v[36:39],v[64:67],v[240:247],v2
v_smfmac_f32_16x16x64_bf16 v[28:31],v[60:63],v[184:191],v2
v_smfmac_f32_16x16x64_bf16 v[40:43],v[60:63],v[208:215],v2
s_nop 4
v_add_f32 v24,v24,v25
v_smfmac_f32_16x16x64_bf16 v[28:31],v[64:67],v[224:231],v2
v_add_f32 v26,v26,v27
v_smfmac_f32_16x16x64_bf16 v[40:43],v[64:67],v[248:255],v2
v_add_f32 v36,v36,v37
v_smfmac_f32_16x16x64_bf16 v[32:35],v[60:63],v[192:199],v2
v_add_f32 v38,v38,v39
s_waitcnt lgkmcnt(2)
v_smfmac_f32_16x16x64_bf16 v[44:47],v[60:63],v[72:79],v2
v_cvt_pk_bf16_f32 v37,v24,v26
v_smfmac_f32_16x16x64_bf16 v[32:35],v[64:67],v[232:239],v2
v_cvt_pk_bf16_f32 v36,v36,v38
s_waitcnt lgkmcnt(0)
v_smfmac_f32_16x16x64_bf16 v[44:47],v[64:67],v[80:87],v2
ds_write_b64 v6,v[36:37] offset:0
v_add_f32 v28,v28,v29
v_add_f32 v30,v30,v31
v_add_f32 v40,v40,v41
v_add_f32 v42,v42,v43
v_cvt_pk_bf16_f32 v41,v28,v30
v_cvt_pk_bf16_f32 v40,v40,v42
ds_write_b64 v6,v[40:41] offset:512
v_add_f32 v32,v32,v33
v_add_f32 v34,v34,v35
v_add_f32 v44,v44,v45
v_add_f32 v46,v46,v47
v_cvt_pk_bf16_f32 v45,v32,v34
v_cvt_pk_bf16_f32 v44,v44,v46
ds_write_b64 v6,v[44:45] offset:1024
s_waitcnt lgkmcnt(0)
s_barrier
ds_read_b64_tr_b16 v[24:25],v7 offset:0
ds_read_b64_tr_b16 v[26:27],v7 offset:512
ds_read_b64_tr_b16 v[28:29],v7 offset:1024
ds_read_b64_tr_b16 v[30:31],v7 offset:1536
ds_read_b64_tr_b16 v[32:33],v7 offset:2048
ds_read_b64_tr_b16 v[34:35],v7 offset:2560
ds_read_b64_tr_b16 v[36:37],v7 offset:3072
ds_read_b64_tr_b16 v[38:39],v7 offset:3584
ds_read_b64_tr_b16 v[40:41],v7 offset:4096
ds_read_b64_tr_b16 v[42:43],v7 offset:4608
ds_read_b64_tr_b16 v[44:45],v7 offset:5120
ds_read_b64_tr_b16 v[46:47],v7 offset:5632
s_lshl_b32 s60,s51,6
s_add_u32 s60,s60,s52
s_mul_i32 s78,s60,196608
s_add_u32 s78,s78,s85
s_lshl_b32 s60,s60,10
s_add_u32 s30,s60,s86
s_and_b32 s60,s54,3
s_lshl2_add_u32 s60,s53,s60
s_lshl_b32 s68,s60,16
s_add_u32 s68,s68,s83
s_mul_i32 s59,s60,20480
s_add_u32 s59,s59,s6
s_lshl_b32 s69,s53,9
s_add_u32 s69,s69,s7
s_bfe_u32 s31,s54,0x10002
s_add_u32 s32,s54,1
s_mov_b64 vcc,s[90:91]
s_waitcnt lgkmcnt(0)
v_cndmask_b32_dpp v100,v28,v24,vcc quad_perm:[0,1,0,1] row_mask:0xf bank_mask:0xf
v_cndmask_b32_dpp v101,v29,v25,vcc quad_perm:[0,1,0,1] row_mask:0xf bank_mask:0xf
v_cndmask_b32_dpp v102,v30,v26,vcc quad_perm:[0,1,0,1] row_mask:0xf bank_mask:0xf
v_cndmask_b32_dpp v103,v31,v27,vcc quad_perm:[0,1,0,1] row_mask:0xf bank_mask:0xf
v_cndmask_b32_dpp v104,v36,v32,vcc quad_perm:[0,1,0,1] row_mask:0xf bank_mask:0xf
v_cndmask_b32_dpp v105,v37,v33,vcc quad_perm:[0,1,0,1] row_mask:0xf bank_mask:0xf
v_cndmask_b32_dpp v106,v38,v34,vcc quad_perm:[0,1,0,1] row_mask:0xf bank_mask:0xf
v_cndmask_b32_dpp v107,v39,v35,vcc quad_perm:[0,1,0,1] row_mask:0xf bank_mask:0xf
v_cndmask_b32_dpp v108,v44,v40,vcc quad_perm:[0,1,0,1] row_mask:0xf bank_mask:0xf
v_cndmask_b32_dpp v109,v45,v41,vcc quad_perm:[0,1,0,1] row_mask:0xf bank_mask:0xf
v_cndmask_b32_dpp v110,v46,v42,vcc quad_perm:[0,1,0,1] row_mask:0xf bank_mask:0xf
v_cndmask_b32_dpp v111,v47,v43,vcc quad_perm:[0,1,0,1] row_mask:0xf bank_mask:0xf
s_cmp_ge_u32 s54,63
s_cselect_b32 s77,0,s77
s_cmp_eq_u32 s53,s51
s_cselect_b32 s60,1,s77
s_cmp_eq_u32 s60,0
s_cbranch_scc1 nd_114
sp_115:
ds_read_b32 v12,v8
s_waitcnt lgkmcnt(0)
v_cmp_ge_u32 vcc,s50,v12
s_nop 0
s_cbranch_vccz ok_116
s_sleep 1
s_sub_u32 s47,s47,1
s_cbranch_scc1 ABORT
s_branch sp_115
ok_116:
s_waitcnt vmcnt(0)
s_cmp_eq_u32 s79,-1
s_cbranch_scc1 pf_117
v_mov_b32 v17,1
s_mov_b64 exec,1
buffer_store_dword v17,v1,s[8:11],s79 offen sc1
s_mov_b64 exec,-1
s_mov_b32 s79,-1
pf_117:
s_cmp_eq_u32 s78,-1
s_cbranch_scc1 pk_118
buffer_store_dwordx4 v[100:103],v20,s[8:11],s78 offen sc1
buffer_store_dwordx4 v[104:107],v20,s[8:11],s78 offen offset:1024 sc1
buffer_store_dwordx4 v[108:111],v20,s[8:11],s78 offen offset:2048 sc1
s_mov_b32 s79,s30
s_mov_b32 s78,-1
pk_118:
s_waitcnt vmcnt(0)
s_cmp_eq_u32 s79,-1
s_cbranch_scc1 pf_119
v_mov_b32 v17,1
s_mov_b64 exec,1
buffer_store_dword v17,v1,s[8:11],s79 offen sc1
s_mov_b64 exec,-1
s_mov_b32 s79,-1
pf_119:
nx_113:
s_cmp_eq_u32 s77,0
s_cbranch_scc1 nd_114
fl_120:
buffer_load_dword v12,v9,s[8:11],s75 offen sc1
s_waitcnt vmcnt(0)
v_cmp_eq_u32 vcc,0,v12
s_nop 0
s_cbranch_vccz ok_121
s_sleep 1
s_sub_u32 s47,s47,1
s_cbranch_scc1 ABORT
s_branch fl_120
ok_121:
s_add_u32 m0,s74,0
s_add_u32 s67,s73,0
buffer_load_dwordx4 v1,s[8:11],s67 offen nt sc1 lds
buffer_load_dwordx4 v1,s[8:11],s67 offen offset:1024 nt sc1 lds
buffer_load_dwordx4 v1,s[8:11],s67 offen offset:2048 nt sc1 lds
buffer_load_dwordx4 v1,s[8:11],s67 offen offset:3072 nt sc1 lds
s_add_u32 m0,s74,4096
s_add_u32 s67,s73,4096
buffer_load_dwordx4 v1,s[8:11],s67 offen nt sc1 lds
buffer_load_dwordx4 v1,s[8:11],s67 offen offset:1024 nt sc1 lds
buffer_load_dwordx4 v1,s[8:11],s67 offen offset:2048 nt sc1 lds
buffer_load_dwordx4 v1,s[8:11],s67 offen offset:3072 nt sc1 lds
s_add_u32 m0,s74,8192
s_add_u32 s67,s73,8192
buffer_load_dwordx4 v1,s[8:11],s67 offen nt sc1 lds
buffer_load_dwordx4 v1,s[8:11],s67 offen offset:1024 nt sc1 lds
buffer_load_dwordx4 v1,s[8:11],s67 offen offset:2048 nt sc1 lds
buffer_load_dwordx4 v1,s[8:11],s67 offen offset:3072 nt sc1 lds
s_add_u32 m0,s74,12288
s_add_u32 s67,s73,25165824
buffer_load_dwordx4 v1,s[8:11],s67 offen nt sc1 lds
buffer_load_dwordx4 v1,s[8:11],s67 offen offset:1024 nt sc1 lds
buffer_load_dwordx4 v1,s[8:11],s67 offen offset:2048 nt sc1 lds
buffer_load_dwordx4 v1,s[8:11],s67 offen offset:3072 nt sc1 lds
s_add_u32 m0,s74,16384
s_add_u32 s67,s73,25169920
buffer_load_dwordx4 v1,s[8:11],s67 offen nt sc1 lds
buffer_load_dwordx4 v1,s[8:11],s67 offen offset:1024 nt sc1 lds
buffer_load_dwordx4 v1,s[8:11],s67 offen offset:2048 nt sc1 lds
buffer_load_dwordx4 v1,s[8:11],s67 offen offset:3072 nt sc1 lds
s_add_u32 m0,s74,20480
s_add_u32 s67,s73,25174016
buffer_load_dwordx4 v1,s[8:11],s67 offen nt sc1 lds
buffer_load_dwordx4 v1,s[8:11],s67 offen offset:1024 nt sc1 lds
buffer_load_dwordx4 v1,s[8:11],s67 offen offset:2048 nt sc1 lds
buffer_load_dwordx4 v1,s[8:11],s67 offen offset:3072 nt sc1 lds
nd_114:
s_add_u32 s50,s50,1
s_mov_b32 s51,s53
s_mov_b32 s52,s54
s_mov_b32 s57,s31
s_mov_b32 s58,s32
s_mov_b32 s53,s55
s_mov_b32 s54,s56
s_mov_b32 s75,s76
s_sub_u32 s60,s4,s5
s_cmp_gt_i32 s60,15
s_cselect_b32 s55,1,0
s_cmp_eq_u32 s4,64
s_cselect_b32 s55,1,s55
s_cmp_eq_u32 s55,0
s_cselect_b32 s56,s4,s5
s_addc_u32 s4,s4,0
s_add_u32 s5,s5,s55
s_lshl_b32 s76,s55,6
s_add_u32 s76,s76,s56
s_lshl_b32 s76,s76,9
s_add_u32 s76,s76,131072
s_mul_i32 s73,s54,393216
s_add_u32 s73,s73,s84
s_xor_b32 s74,s74,57344
s_waitcnt vmcnt(0)
v_cmp_eq_u32 vcc,0,v10
s_cmp_lg_u64 vcc,0
s_cselect_b32 s77,1,0
s_cmp_lt_u32 s50,128
s_cbranch_scc1 CH_LOOP
s_branch CS_DONE
fr_107:
v_bitop3_b32 v12,v60,v64,s57 bitop3:0x7e
v_bitop3_b32 v13,v68,v72,s57 bitop3:0x7e
v_xor_b32 v14,s57,v76
v_or3_b32 v12,v12,v13,v14
v_and_b32 v12,1,v12
v_cmp_ne_u32 vcc,0,v12
s_cbranch_vccz sk_122
buffer_load_dwordx4 v[76:79],v18,s[8:11],s59 offen sc1
buffer_load_dwordx4 v[60:63],v1,s[8:11],s59 offen sc1
buffer_load_dwordx4 v[64:67],v1,s[8:11],s59 offen offset:1024 sc1
buffer_load_dwordx4 v[68:71],v1,s[8:11],s59 offen offset:2048 sc1
buffer_load_dwordx4 v[72:75],v1,s[8:11],s59 offen offset:3072 sc1
sk_122:
buffer_load_dwordx4 v[96:99],v18,s[8:11],s68 offen sc1
buffer_load_dwordx4 v[80:83],v1,s[8:11],s68 offen sc1
buffer_load_dwordx4 v[84:87],v1,s[8:11],s68 offen offset:1024 sc1
buffer_load_dwordx4 v[88:91],v1,s[8:11],s68 offen offset:2048 sc1
buffer_load_dwordx4 v[92:95],v1,s[8:11],s68 offen offset:3072 sc1
s_sub_u32 s47,s47,1
s_cbranch_scc1 ABORT
s_waitcnt lgkmcnt(0)
s_branch fa_106
CS_DONE:
s_add_u32 s61,s48,0
s_endpgm
CV_START:
s_and_b32 s60,s46,1
s_lshl1_add_u32 s60,s49,s60
s_cmp_eq_u32 s60,1
s_cbranch_scc1 CV_LOOP_F1
s_cmp_eq_u32 s60,2
s_cbranch_scc1 CV_LOOP_S0
s_cmp_eq_u32 s60,3
s_cbranch_scc1 CV_LOOP_S1
CV_LOOP_F0:
v_mov_b32 v24,0
v_mov_b32 v25,0
v_mov_b32 v26,0
v_mov_b32 v27,0
v_mov_b32 v28,0
v_mov_b32 v29,0
v_mov_b32 v30,0
v_mov_b32 v31,0
v_mov_b32 v32,0
v_mov_b32 v33,0
v_mov_b32 v34,0
v_mov_b32 v35,0
v_mov_b32 v36,0
v_mov_b32 v37,0
v_mov_b32 v38,0
v_mov_b32 v39,0
v_mov_b32 v40,0
v_mov_b32 v41,0
v_mov_b32 v42,0
v_mov_b32 v43,0
v_mov_b32 v44,0
v_mov_b32 v45,0
v_mov_b32 v46,0
v_mov_b32 v47,0
s_cmp_lg_u32 s46,0
s_cbranch_scc1 np_126
db_127:
buffer_load_dword v12,v11,s[8:11],s69 offen sc1
s_waitcnt vmcnt(0)
v_cmp_gt_u32 vcc,s58,v12
s_cbranch_vccz dbok_128
s_sub_u32 s47,s47,1
s_cbranch_scc1 ABORT
s_branch db_127
dbok_128:
np_126:
s_barrier
buffer_load_dwordx4 v[76:79],v18,s[8:11],s59 offen sc1
buffer_load_dwordx4 v[60:63],v1,s[8:11],s59 offen sc1
buffer_load_dwordx4 v[64:67],v1,s[8:11],s59 offen offset:1024 sc1
buffer_load_dwordx4 v[68:71],v1,s[8:11],s59 offen offset:2048 sc1
buffer_load_dwordx4 v[72:75],v1,s[8:11],s59 offen offset:3072 sc1
s_waitcnt vmcnt(4)
buffer_load_dwordx4 v[96:99],v18,s[8:11],s68 offen sc1
buffer_load_dwordx4 v[80:83],v1,s[8:11],s68 offen sc1
buffer_load_dwordx4 v[84:87],v1,s[8:11],s68 offen offset:1024 sc1
buffer_load_dwordx4 v[88:91],v1,s[8:11],s68 offen offset:2048 sc1
buffer_load_dwordx4 v[92:95],v1,s[8:11],s68 offen offset:3072 sc1
fj_125:
fa_123:
s_waitcnt vmcnt(4)
v_pk_add_f32 v[12:13],v[76:77],v[96:97]
v_pk_add_f32 v[14:15],v[78:79],v[98:99]
v_bitop3_b32 v16,v76,v96,s57 bitop3:0x7e
v_cvt_pk_bf16_f32 v56,v12,v13
v_cvt_pk_bf16_f32 v57,v14,v15
ds_write_b64 v23,v[56:57]
s_waitcnt vmcnt(3)
v_pk_add_f32 v[12:13],v[60:61],v[80:81]
v_pk_add_f32 v[14:15],v[62:63],v[82:83]
v_bitop3_b32 v17,v60,v80,s57 bitop3:0x7e
v_cvt_pk_bf16_f32 v48,v12,v13
v_cvt_pk_bf16_f32 v49,v14,v15
v_or_b32 v16,v16,v17
s_waitcnt vmcnt(2)
v_pk_add_f32 v[12:13],v[64:65],v[84:85]
v_pk_add_f32 v[14:15],v[66:67],v[86:87]
v_bitop3_b32 v17,v64,v84,s57 bitop3:0x7e
v_cvt_pk_bf16_f32 v50,v12,v13
v_cvt_pk_bf16_f32 v51,v14,v15
v_or_b32 v16,v16,v17
ds_write_b128 v22,v[48:51] offset:0
s_waitcnt vmcnt(1)
v_pk_add_f32 v[12:13],v[68:69],v[88:89]
v_pk_add_f32 v[14:15],v[70:71],v[90:91]
v_bitop3_b32 v17,v68,v88,s57 bitop3:0x7e
v_cvt_pk_bf16_f32 v52,v12,v13
v_cvt_pk_bf16_f32 v53,v14,v15
v_or_b32 v16,v16,v17
s_waitcnt vmcnt(0)
v_pk_add_f32 v[12:13],v[72:73],v[92:93]
v_pk_add_f32 v[14:15],v[74:75],v[94:95]
v_bitop3_b32 v17,v72,v92,s57 bitop3:0x7e
v_cvt_pk_bf16_f32 v54,v12,v13
v_cvt_pk_bf16_f32 v55,v14,v15
v_bitop3_b32 v16,v16,v17,1 bitop3:0xa8
v_cmp_ne_u32 vcc,0,v16
ds_write_b128 v22,v[52:55] offset:1024
s_cbranch_vccnz fr_124
v_smfmac_f32_16x16x64_bf16 v[24:27],v[48:51],a[0:7],v2
ds_read_b128 v[72:75],v21 offset:0
s_and_b32 s60,s52,3
v_smfmac_f32_16x16x64_bf16 v[28:31],v[48:51],a[8:15],v2
ds_read_b128 v[76:79],v21 offset:1024
s_lshl2_add_u32 s60,s51,s60
v_smfmac_f32_16x16x64_bf16 v[32:35],v[48:51],a[16:23],v2
ds_read_b128 v[80:83],v21 offset:2048
s_mul_i32 s60,s60,49152
v_smfmac_f32_16x16x64_bf16 v[36:39],v[48:51],a[24:31],v2
ds_read_b128 v[84:87],v21 offset:3072
s_add_u32 s71,s60,s34
s_waitcnt lgkmcnt(4)
s_barrier
v_smfmac_f32_16x16x64_bf16 v[40:43],v[48:51],a[32:39],v2
ds_read_b128 v[60:63],v3 offset:0
v_smfmac_f32_16x16x64_bf16 v[24:27],v[52:55],a[40:47],v2
ds_read_b128 v[64:67],v3 offset:1024
v_smfmac_f32_16x16x64_bf16 v[28:31],v[52:55],a[48:55],v2
ds_read_b128 v[68:71],v4 offset:0
v_smfmac_f32_16x16x64_bf16 v[32:35],v[52:55],a[56:63],v2
v_smfmac_f32_16x16x64_bf16 v[36:39],v[52:55],a[64:71],v2
v_smfmac_f32_16x16x64_bf16 v[40:43],v[52:55],a[72:79],v2
s_waitcnt lgkmcnt(5)
v_smfmac_f32_16x16x64_bf16 v[44:47],v[48:51],v[72:79],v2
ds_read_b128 v[72:75],v21 offset:4096
s_waitcnt lgkmcnt(4)
v_smfmac_f32_16x16x64_bf16 v[44:47],v[52:55],v[80:87],v2
ds_read_b128 v[76:79],v21 offset:5120
s_waitcnt lgkmcnt(4)
v_smfmac_f32_16x16x64_bf16 v[24:27],v[60:63],a[80:87],v2
ds_read_b128 v[80:83],v21 offset:6144
v_smfmac_f32_16x16x64_bf16 v[28:31],v[60:63],a[88:95],v2
ds_read_b128 v[84:87],v21 offset:7168
v_smfmac_f32_16x16x64_bf16 v[32:35],v[60:63],a[96:103],v2
v_smfmac_f32_16x16x64_bf16 v[36:39],v[60:63],a[104:111],v2
v_smfmac_f32_16x16x64_bf16 v[40:43],v[60:63],a[112:119],v2
s_waitcnt lgkmcnt(2)
v_smfmac_f32_16x16x64_bf16 v[44:47],v[60:63],v[72:79],v2
ds_read_b128 v[60:63],v4 offset:1024
v_smfmac_f32_16x16x64_bf16 v[24:27],v[64:67],a[120:127],v2
ds_read_b128 v[72:75],v21 offset:8192
v_smfmac_f32_16x16x64_bf16 v[28:31],v[64:67],a[128:135],v2
ds_read_b128 v[76:79],v21 offset:9216
v_smfmac_f32_16x16x64_bf16 v[32:35],v[64:67],a[136:143],v2
v_smfmac_f32_16x16x64_bf16 v[36:39],v[64:67],a[144:151],v2
v_smfmac_f32_16x16x64_bf16 v[40:43],v[64:67],a[152:159],v2
s_waitcnt lgkmcnt(3)
v_smfmac_f32_16x16x64_bf16 v[44:47],v[64:67],v[80:87],v2
ds_read_b128 v[64:67],v5 offset:0
v_smfmac_f32_16x16x64_bf16 v[24:27],v[68:71],a[160:167],v2
ds_read_b128 v[80:83],v21 offset:10240
v_smfmac_f32_16x16x64_bf16 v[28:31],v[68:71],a[168:175],v2
ds_read_b128 v[84:87],v21 offset:11264
v_smfmac_f32_16x16x64_bf16 v[32:35],v[68:71],a[176:183],v2
v_smfmac_f32_16x16x64_bf16 v[36:39],v[68:71],a[184:191],v2
v_smfmac_f32_16x16x64_bf16 v[40:43],v[68:71],a[192:199],v2
s_waitcnt lgkmcnt(3)
v_smfmac_f32_16x16x64_bf16 v[44:47],v[68:71],v[72:79],v2
ds_read_b128 v[68:71],v5 offset:1024
v_smfmac_f32_16x16x64_bf16 v[24:27],v[60:63],a[200:207],v2
ds_read_b128 v[72:75],v21 offset:12288
v_smfmac_f32_16x16x64_bf16 v[28:31],v[60:63],a[208:215],v2
ds_read_b128 v[76:79],v21 offset:13312
v_smfmac_f32_16x16x64_bf16 v[32:35],v[60:63],a[216:223],v2
v_smfmac_f32_16x16x64_bf16 v[36:39],v[60:63],a[224:231],v2
v_smfmac_f32_16x16x64_bf16 v[40:43],v[60:63],a[232:239],v2
s_waitcnt lgkmcnt(3)
v_smfmac_f32_16x16x64_bf16 v[44:47],v[60:63],v[80:87],v2
ds_read_b128 v[60:63],v59 offset:0
v_smfmac_f32_16x16x64_bf16 v[24:27],v[64:67],a[240:247],v2
ds_read_b128 v[80:83],v21 offset:14336
v_smfmac_f32_16x16x64_bf16 v[28:31],v[64:67],a[248:255],v2
ds_read_b128 v[84:87],v21 offset:15360
v_smfmac_f32_16x16x64_bf16 v[32:35],v[64:67],v[112:119],v2
s_cmp_eq_u32 s79,-1
s_cbranch_scc1 pf_129
v_mov_b32 v17,1
s_mov_b64 exec,1
buffer_store_dword v17,v1,s[8:11],s79 offen sc1
s_mov_b64 exec,-1
s_mov_b32 s79,-1
pf_129:
v_smfmac_f32_16x16x64_bf16 v[36:39],v[64:67],v[120:127],v2
s_cmp_eq_u32 s78,-1
s_cbranch_scc1 pk_130
buffer_store_dwordx4 v[100:103],v6,s[8:11],s78 offen sc1
buffer_store_dwordx2 v[104:105],v7,s[8:11],s78 offen sc1
s_mov_b32 s79,s30
s_mov_b32 s78,-1
pk_130:
v_smfmac_f32_16x16x64_bf16 v[40:43],v[64:67],v[128:135],v2
s_waitcnt lgkmcnt(3)
v_smfmac_f32_16x16x64_bf16 v[44:47],v[64:67],v[72:79],v2
ds_read_b128 v[64:67],v59 offset:1024
v_smfmac_f32_16x16x64_bf16 v[24:27],v[68:71],v[136:143],v2
ds_read_b128 v[72:75],v21 offset:16384
v_smfmac_f32_16x16x64_bf16 v[28:31],v[68:71],v[144:151],v2
ds_read_b128 v[76:79],v21 offset:17408
v_smfmac_f32_16x16x64_bf16 v[32:35],v[68:71],v[152:159],v2
v_smfmac_f32_16x16x64_bf16 v[36:39],v[68:71],v[160:167],v2
v_smfmac_f32_16x16x64_bf16 v[40:43],v[68:71],v[168:175],v2
s_waitcnt lgkmcnt(3)
v_smfmac_f32_16x16x64_bf16 v[44:47],v[68:71],v[80:87],v2
ds_read_b128 v[80:83],v21 offset:18432
v_smfmac_f32_16x16x64_bf16 v[24:27],v[60:63],v[176:183],v2
ds_read_b128 v[84:87],v21 offset:19456
v_smfmac_f32_16x16x64_bf16 v[28:31],v[60:63],v[184:191],v2
s_waitcnt lgkmcnt(4)
v_smfmac_f32_16x16x64_bf16 v[24:27],v[64:67],v[216:223],v2
v_smfmac_f32_16x16x64_bf16 v[28:31],v[64:67],v[224:231],v2
v_smfmac_f32_16x16x64_bf16 v[32:35],v[60:63],v[192:199],v2
v_smfmac_f32_16x16x64_bf16 v[36:39],v[60:63],v[200:207],v2
s_nop 4
v_add_f32 v24,v24,v25
v_smfmac_f32_16x16x64_bf16 v[32:35],v[64:67],v[232:239],v2
v_add_f32 v26,v26,v27
v_smfmac_f32_16x16x64_bf16 v[36:39],v[64:67],v[240:247],v2
v_add_f32 v28,v28,v29
v_smfmac_f32_16x16x64_bf16 v[40:43],v[60:63],v[208:215],v2
v_add_f32 v30,v30,v31
s_waitcnt lgkmcnt(2)
v_smfmac_f32_16x16x64_bf16 v[44:47],v[60:63],v[72:79],v2
v_cvt_pk_bf16_f32 v100,v24,v26
v_smfmac_f32_16x16x64_bf16 v[40:43],v[64:67],v[248:255],v2
v_cvt_pk_bf16_f32 v101,v28,v30
s_waitcnt lgkmcnt(0)
v_smfmac_f32_16x16x64_bf16 v[44:47],v[64:67],v[80:87],v2
v_and_or_b32 v100,v100,-2,s57
v_add_f32 v32,v32,v33
v_add_f32 v34,v34,v35
v_add_f32 v36,v36,v37
v_add_f32 v38,v38,v39
v_cvt_pk_bf16_f32 v102,v32,v34
v_cvt_pk_bf16_f32 v103,v36,v38
v_and_or_b32 v102,v102,-2,s57
buffer_store_dwordx4 v[100:103],v6,s[8:11],s71 offen
v_add_f32 v40,v40,v41
v_add_f32 v42,v42,v43
v_add_f32 v44,v44,v45
v_add_f32 v46,v46,v47
v_cvt_pk_bf16_f32 v104,v40,v42
v_cvt_pk_bf16_f32 v105,v44,v46
v_and_or_b32 v104,v104,-2,s57
buffer_store_dwordx2 v[104:105],v7,s[8:11],s71 offen
s_lshl_b32 s60,s51,6
s_add_u32 s60,s60,s52
s_mul_i32 s78,s60,196608
s_add_u32 s78,s78,s85
s_lshl_b32 s60,s60,10
s_add_u32 s30,s60,s86
s_sub_u32 s60,s4,s5
s_cmp_gt_i32 s60,15
s_cselect_b32 s53,1,0
s_cmp_eq_u32 s4,64
s_cselect_b32 s53,1,s53
s_cmp_eq_u32 s53,0
s_cselect_b32 s54,s4,s5
s_addc_u32 s4,s4,0
s_add_u32 s5,s5,s53
s_and_b32 s60,s54,3
s_lshl2_add_u32 s60,s53,s60
s_lshl_b32 s68,s60,16
s_add_u32 s68,s68,s83
s_mul_i32 s59,s60,20480
s_add_u32 s59,s59,s6
s_lshl_b32 s69,s53,9
s_add_u32 s69,s69,s7
s_bfe_u32 s31,s54,0x10002
s_add_u32 s32,s54,1
s_cmp_lg_u32 s53,s51
s_cbranch_scc1 nx_131
s_waitcnt vmcnt(0)
s_cmp_eq_u32 s79,-1
s_cbranch_scc1 pf_132
v_mov_b32 v17,1
s_mov_b64 exec,1
buffer_store_dword v17,v1,s[8:11],s79 offen sc1
s_mov_b64 exec,-1
s_mov_b32 s79,-1
pf_132:
s_cmp_eq_u32 s78,-1
s_cbranch_scc1 pk_133
buffer_store_dwordx4 v[100:103],v6,s[8:11],s78 offen sc1
buffer_store_dwordx2 v[104:105],v7,s[8:11],s78 offen sc1
s_mov_b32 s79,s30
s_mov_b32 s78,-1
pk_133:
s_waitcnt vmcnt(0)
s_cmp_eq_u32 s79,-1
s_cbranch_scc1 pf_134
v_mov_b32 v17,1
s_mov_b64 exec,1
buffer_store_dword v17,v1,s[8:11],s79 offen sc1
s_mov_b64 exec,-1
s_mov_b32 s79,-1
pf_134:
nx_131:
s_add_u32 s50,s50,1
s_mov_b32 s51,s53
s_mov_b32 s52,s54
s_mov_b32 s57,s31
s_mov_b32 s58,s32
s_cmp_lt_u32 s50,128
s_cbranch_scc1 CV_LOOP_F0
s_branch CV_DONE
fr_124:
v_bitop3_b32 v12,v60,v64,s57 bitop3:0x7e
v_bitop3_b32 v13,v68,v72,s57 bitop3:0x7e
v_xor_b32 v14,s57,v76
v_or3_b32 v12,v12,v13,v14
v_and_b32 v12,1,v12
v_cmp_ne_u32 vcc,0,v12
s_cbranch_vccz sk_135
buffer_load_dwordx4 v[76:79],v18,s[8:11],s59 offen sc1
buffer_load_dwordx4 v[60:63],v1,s[8:11],s59 offen sc1
buffer_load_dwordx4 v[64:67],v1,s[8:11],s59 offen offset:1024 sc1
buffer_load_dwordx4 v[68:71],v1,s[8:11],s59 offen offset:2048 sc1
buffer_load_dwordx4 v[72:75],v1,s[8:11],s59 offen offset:3072 sc1
sk_135:
buffer_load_dwordx4 v[96:99],v18,s[8:11],s68 offen sc1
buffer_load_dwordx4 v[80:83],v1,s[8:11],s68 offen sc1
buffer_load_dwordx4 v[84:87],v1,s[8:11],s68 offen offset:1024 sc1
buffer_load_dwordx4 v[88:91],v1,s[8:11],s68 offen offset:2048 sc1
buffer_load_dwordx4 v[92:95],v1,s[8:11],s68 offen offset:3072 sc1
s_sub_u32 s47,s47,1
s_cbranch_scc1 ABORT
s_waitcnt lgkmcnt(0)
s_branch fa_123
CV_LOOP_F1:
v_mov_b32 v24,0
v_mov_b32 v25,0
v_mov_b32 v26,0
v_mov_b32 v27,0
v_mov_b32 v28,0
v_mov_b32 v29,0
v_mov_b32 v30,0
v_mov_b32 v31,0
v_mov_b32 v32,0
v_mov_b32 v33,0
v_mov_b32 v34,0
v_mov_b32 v35,0
v_mov_b32 v36,0
v_mov_b32 v37,0
v_mov_b32 v38,0
v_mov_b32 v39,0
v_mov_b32 v40,0
v_mov_b32 v41,0
v_mov_b32 v42,0
v_mov_b32 v43,0
v_mov_b32 v44,0
v_mov_b32 v45,0
v_mov_b32 v46,0
v_mov_b32 v47,0
s_barrier
buffer_load_dwordx4 v[76:79],v18,s[8:11],s59 offen sc1
buffer_load_dwordx4 v[60:63],v1,s[8:11],s59 offen sc1
buffer_load_dwordx4 v[64:67],v1,s[8:11],s59 offen offset:1024 sc1
buffer_load_dwordx4 v[68:71],v1,s[8:11],s59 offen offset:2048 sc1
buffer_load_dwordx4 v[72:75],v1,s[8:11],s59 offen offset:3072 sc1
s_waitcnt vmcnt(4)
buffer_load_dwordx4 v[96:99],v18,s[8:11],s68 offen sc1
buffer_load_dwordx4 v[80:83],v1,s[8:11],s68 offen sc1
buffer_load_dwordx4 v[84:87],v1,s[8:11],s68 offen offset:1024 sc1
buffer_load_dwordx4 v[88:91],v1,s[8:11],s68 offen offset:2048 sc1
buffer_load_dwordx4 v[92:95],v1,s[8:11],s68 offen offset:3072 sc1
fj_138:
fa_136:
s_waitcnt vmcnt(4)
v_pk_add_f32 v[12:13],v[76:77],v[96:97]
v_pk_add_f32 v[14:15],v[78:79],v[98:99]
v_bitop3_b32 v16,v76,v96,s57 bitop3:0x7e
v_cvt_pk_bf16_f32 v56,v12,v13
v_cvt_pk_bf16_f32 v57,v14,v15
ds_write_b64 v23,v[56:57]
s_waitcnt vmcnt(3)
v_pk_add_f32 v[12:13],v[60:61],v[80:81]
v_pk_add_f32 v[14:15],v[62:63],v[82:83]
v_bitop3_b32 v17,v60,v80,s57 bitop3:0x7e
v_cvt_pk_bf16_f32 v48,v12,v13
v_cvt_pk_bf16_f32 v49,v14,v15
v_or_b32 v16,v16,v17
s_waitcnt vmcnt(2)
v_pk_add_f32 v[12:13],v[64:65],v[84:85]
v_pk_add_f32 v[14:15],v[66:67],v[86:87]
v_bitop3_b32 v17,v64,v84,s57 bitop3:0x7e
v_cvt_pk_bf16_f32 v50,v12,v13
v_cvt_pk_bf16_f32 v51,v14,v15
v_or_b32 v16,v16,v17
ds_write_b128 v22,v[48:51] offset:0
s_waitcnt vmcnt(1)
v_pk_add_f32 v[12:13],v[68:69],v[88:89]
v_pk_add_f32 v[14:15],v[70:71],v[90:91]
v_bitop3_b32 v17,v68,v88,s57 bitop3:0x7e
v_cvt_pk_bf16_f32 v52,v12,v13
v_cvt_pk_bf16_f32 v53,v14,v15
v_or_b32 v16,v16,v17
s_waitcnt vmcnt(0)
v_pk_add_f32 v[12:13],v[72:73],v[92:93]
v_pk_add_f32 v[14:15],v[74:75],v[94:95]
v_bitop3_b32 v17,v72,v92,s57 bitop3:0x7e
v_cvt_pk_bf16_f32 v54,v12,v13
v_cvt_pk_bf16_f32 v55,v14,v15
v_bitop3_b32 v16,v16,v17,1 bitop3:0xa8
v_cmp_ne_u32 vcc,0,v16
ds_write_b128 v22,v[52:55] offset:1024
s_cbranch_vccnz fr_137
v_smfmac_f32_16x16x64_bf16 v[24:27],v[48:51],a[0:7],v2
ds_read_b128 v[72:75],v21 offset:0
s_and_b32 s60,s52,3
v_smfmac_f32_16x16x64_bf16 v[28:31],v[48:51],a[8:15],v2
ds_read_b128 v[76:79],v21 offset:1024
s_lshl2_add_u32 s60,s51,s60
v_smfmac_f32_16x16x64_bf16 v[32:35],v[48:51],a[16:23],v2
ds_read_b128 v[80:83],v21 offset:2048
s_mul_i32 s60,s60,49152
v_smfmac_f32_16x16x64_bf16 v[36:39],v[48:51],a[24:31],v2
ds_read_b128 v[84:87],v21 offset:3072
s_add_u32 s71,s60,s34
s_waitcnt lgkmcnt(4)
s_barrier
v_smfmac_f32_16x16x64_bf16 v[40:43],v[48:51],a[32:39],v2
ds_read_b128 v[60:63],v3 offset:0
v_smfmac_f32_16x16x64_bf16 v[24:27],v[52:55],a[40:47],v2
ds_read_b128 v[64:67],v3 offset:1024
v_smfmac_f32_16x16x64_bf16 v[28:31],v[52:55],a[48:55],v2
ds_read_b128 v[68:71],v4 offset:0
v_smfmac_f32_16x16x64_bf16 v[32:35],v[52:55],a[56:63],v2
v_smfmac_f32_16x16x64_bf16 v[36:39],v[52:55],a[64:71],v2
v_smfmac_f32_16x16x64_bf16 v[40:43],v[52:55],a[72:79],v2
s_waitcnt lgkmcnt(5)
v_smfmac_f32_16x16x64_bf16 v[44:47],v[48:51],v[72:79],v2
ds_read_b128 v[72:75],v21 offset:4096
s_waitcnt lgkmcnt(4)
v_smfmac_f32_16x16x64_bf16 v[44:47],v[52:55],v[80:87],v2
ds_read_b128 v[76:79],v21 offset:5120
s_waitcnt lgkmcnt(4)
v_smfmac_f32_16x16x64_bf16 v[24:27],v[60:63],a[80:87],v2
ds_read_b128 v[80:83],v21 offset:6144
v_smfmac_f32_16x16x64_bf16 v[28:31],v[60:63],a[88:95],v2
ds_read_b128 v[84:87],v21 offset:7168
v_smfmac_f32_16x16x64_bf16 v[32:35],v[60:63],a[96:103],v2
v_smfmac_f32_16x16x64_bf16 v[36:39],v[60:63],a[104:111],v2
v_smfmac_f32_16x16x64_bf16 v[40:43],v[60:63],a[112:119],v2
s_waitcnt lgkmcnt(2)
v_smfmac_f32_16x16x64_bf16 v[44:47],v[60:63],v[72:79],v2
ds_read_b128 v[60:63],v4 offset:1024
v_smfmac_f32_16x16x64_bf16 v[24:27],v[64:67],a[120:127],v2
ds_read_b128 v[72:75],v21 offset:8192
v_smfmac_f32_16x16x64_bf16 v[28:31],v[64:67],a[128:135],v2
ds_read_b128 v[76:79],v21 offset:9216
v_smfmac_f32_16x16x64_bf16 v[32:35],v[64:67],a[136:143],v2
v_smfmac_f32_16x16x64_bf16 v[36:39],v[64:67],a[144:151],v2
v_smfmac_f32_16x16x64_bf16 v[40:43],v[64:67],a[152:159],v2
s_waitcnt lgkmcnt(3)
v_smfmac_f32_16x16x64_bf16 v[44:47],v[64:67],v[80:87],v2
ds_read_b128 v[64:67],v5 offset:0
v_smfmac_f32_16x16x64_bf16 v[24:27],v[68:71],a[160:167],v2
ds_read_b128 v[80:83],v21 offset:10240
v_smfmac_f32_16x16x64_bf16 v[28:31],v[68:71],a[168:175],v2
ds_read_b128 v[84:87],v21 offset:11264
v_smfmac_f32_16x16x64_bf16 v[32:35],v[68:71],a[176:183],v2
v_smfmac_f32_16x16x64_bf16 v[36:39],v[68:71],a[184:191],v2
v_smfmac_f32_16x16x64_bf16 v[40:43],v[68:71],a[192:199],v2
s_waitcnt lgkmcnt(3)
v_smfmac_f32_16x16x64_bf16 v[44:47],v[68:71],v[72:79],v2
ds_read_b128 v[68:71],v5 offset:1024
v_smfmac_f32_16x16x64_bf16 v[24:27],v[60:63],a[200:207],v2
ds_read_b128 v[72:75],v21 offset:12288
v_smfmac_f32_16x16x64_bf16 v[28:31],v[60:63],a[208:215],v2
ds_read_b128 v[76:79],v21 offset:13312
v_smfmac_f32_16x16x64_bf16 v[32:35],v[60:63],a[216:223],v2
v_smfmac_f32_16x16x64_bf16 v[36:39],v[60:63],a[224:231],v2
v_smfmac_f32_16x16x64_bf16 v[40:43],v[60:63],a[232:239],v2
s_waitcnt lgkmcnt(3)
v_smfmac_f32_16x16x64_bf16 v[44:47],v[60:63],v[80:87],v2
ds_read_b128 v[60:63],v59 offset:0
v_smfmac_f32_16x16x64_bf16 v[24:27],v[64:67],a[240:247],v2
ds_read_b128 v[80:83],v21 offset:14336
v_smfmac_f32_16x16x64_bf16 v[28:31],v[64:67],a[248:255],v2
ds_read_b128 v[84:87],v21 offset:15360
v_smfmac_f32_16x16x64_bf16 v[32:35],v[64:67],v[112:119],v2
s_cmp_eq_u32 s79,-1
s_cbranch_scc1 pf_139
v_mov_b32 v17,1
s_mov_b64 exec,1
buffer_store_dword v17,v1,s[8:11],s79 offen sc1
s_mov_b64 exec,-1
s_mov_b32 s79,-1
pf_139:
v_smfmac_f32_16x16x64_bf16 v[36:39],v[64:67],v[120:127],v2
s_cmp_eq_u32 s78,-1
s_cbranch_scc1 pk_140
buffer_store_dwordx4 v[102:105],v6,s[8:11],s78 offen sc1
buffer_store_dwordx2 v[100:101],v7,s[8:11],s78 offen sc1
s_mov_b32 s79,s30
s_mov_b32 s78,-1
pk_140:
v_smfmac_f32_16x16x64_bf16 v[40:43],v[64:67],v[128:135],v2
s_waitcnt lgkmcnt(3)
v_smfmac_f32_16x16x64_bf16 v[44:47],v[64:67],v[72:79],v2
ds_read_b128 v[64:67],v59 offset:1024
v_smfmac_f32_16x16x64_bf16 v[24:27],v[68:71],v[136:143],v2
ds_read_b128 v[72:75],v21 offset:16384
v_smfmac_f32_16x16x64_bf16 v[28:31],v[68:71],v[144:151],v2
ds_read_b128 v[76:79],v21 offset:17408
v_smfmac_f32_16x16x64_bf16 v[32:35],v[68:71],v[152:159],v2
v_smfmac_f32_16x16x64_bf16 v[36:39],v[68:71],v[160:167],v2
v_smfmac_f32_16x16x64_bf16 v[40:43],v[68:71],v[168:175],v2
s_waitcnt lgkmcnt(3)
v_smfmac_f32_16x16x64_bf16 v[44:47],v[68:71],v[80:87],v2
ds_read_b128 v[80:83],v21 offset:18432
v_smfmac_f32_16x16x64_bf16 v[24:27],v[60:63],v[176:183],v2
ds_read_b128 v[84:87],v21 offset:19456
v_smfmac_f32_16x16x64_bf16 v[28:31],v[60:63],v[184:191],v2
s_waitcnt lgkmcnt(4)
v_smfmac_f32_16x16x64_bf16 v[24:27],v[64:67],v[216:223],v2
v_smfmac_f32_16x16x64_bf16 v[28:31],v[64:67],v[224:231],v2
v_smfmac_f32_16x16x64_bf16 v[32:35],v[60:63],v[192:199],v2
v_smfmac_f32_16x16x64_bf16 v[36:39],v[60:63],v[200:207],v2
s_nop 4
v_add_f32 v24,v24,v25
v_smfmac_f32_16x16x64_bf16 v[32:35],v[64:67],v[232:239],v2
v_add_f32 v26,v26,v27
v_smfmac_f32_16x16x64_bf16 v[36:39],v[64:67],v[240:247],v2
v_add_f32 v28,v28,v29
v_smfmac_f32_16x16x64_bf16 v[40:43],v[60:63],v[208:215],v2
v_add_f32 v30,v30,v31
s_waitcnt lgkmcnt(2)
v_smfmac_f32_16x16x64_bf16 v[44:47],v[60:63],v[72:79],v2
v_cvt_pk_bf16_f32 v100,v24,v26
v_smfmac_f32_16x16x64_bf16 v[40:43],v[64:67],v[248:255],v2
v_cvt_pk_bf16_f32 v101,v28,v30
s_waitcnt lgkmcnt(0)
v_smfmac_f32_16x16x64_bf16 v[44:47],v[64:67],v[80:87],v2
v_and_or_b32 v100,v100,-2,s57
buffer_store_dwordx2 v[100:101],v7,s[8:11],s71 offen
v_add_f32 v32,v32,v33
v_add_f32 v34,v34,v35
v_add_f32 v36,v36,v37
v_add_f32 v38,v38,v39
v_cvt_pk_bf16_f32 v102,v32,v34
v_cvt_pk_bf16_f32 v103,v36,v38
v_and_or_b32 v102,v102,-2,s57
v_add_f32 v40,v40,v41
v_add_f32 v42,v42,v43
v_add_f32 v44,v44,v45
v_add_f32 v46,v46,v47
v_cvt_pk_bf16_f32 v104,v40,v42
v_cvt_pk_bf16_f32 v105,v44,v46
v_and_or_b32 v104,v104,-2,s57
buffer_store_dwordx4 v[102:105],v6,s[8:11],s71 offen
s_lshl_b32 s60,s51,6
s_add_u32 s60,s60,s52
s_mul_i32 s78,s60,196608
s_add_u32 s78,s78,s85
s_lshl_b32 s60,s60,10
s_add_u32 s30,s60,s86
s_sub_u32 s60,s4,s5
s_cmp_gt_i32 s60,15
s_cselect_b32 s53,1,0
s_cmp_eq_u32 s4,64
s_cselect_b32 s53,1,s53
s_cmp_eq_u32 s53,0
s_cselect_b32 s54,s4,s5
s_addc_u32 s4,s4,0
s_add_u32 s5,s5,s53
s_and_b32 s60,s54,3
s_lshl2_add_u32 s60,s53,s60
s_lshl_b32 s68,s60,16
s_add_u32 s68,s68,s83
s_mul_i32 s59,s60,20480
s_add_u32 s59,s59,s6
s_lshl_b32 s69,s53,9
s_add_u32 s69,s69,s7
s_bfe_u32 s31,s54,0x10002
s_add_u32 s32,s54,1
s_cmp_lg_u32 s53,s51
s_cbranch_scc1 nx_141
s_waitcnt vmcnt(0)
s_cmp_eq_u32 s79,-1
s_cbranch_scc1 pf_142
v_mov_b32 v17,1
s_mov_b64 exec,1
buffer_store_dword v17,v1,s[8:11],s79 offen sc1
s_mov_b64 exec,-1
s_mov_b32 s79,-1
pf_142:
s_cmp_eq_u32 s78,-1
s_cbranch_scc1 pk_143
buffer_store_dwordx4 v[102:105],v6,s[8:11],s78 offen sc1
buffer_store_dwordx2 v[100:101],v7,s[8:11],s78 offen sc1
s_mov_b32 s79,s30
s_mov_b32 s78,-1
pk_143:
s_waitcnt vmcnt(0)
s_cmp_eq_u32 s79,-1
s_cbranch_scc1 pf_144
v_mov_b32 v17,1
s_mov_b64 exec,1
buffer_store_dword v17,v1,s[8:11],s79 offen sc1
s_mov_b64 exec,-1
s_mov_b32 s79,-1
pf_144:
nx_141:
s_add_u32 s50,s50,1
s_mov_b32 s51,s53
s_mov_b32 s52,s54
s_mov_b32 s57,s31
s_mov_b32 s58,s32
s_cmp_lt_u32 s50,128
s_cbranch_scc1 CV_LOOP_F1
s_branch CV_DONE
fr_137:
v_bitop3_b32 v12,v60,v64,s57 bitop3:0x7e
v_bitop3_b32 v13,v68,v72,s57 bitop3:0x7e
v_xor_b32 v14,s57,v76
v_or3_b32 v12,v12,v13,v14
v_and_b32 v12,1,v12
v_cmp_ne_u32 vcc,0,v12
s_cbranch_vccz sk_145
buffer_load_dwordx4 v[76:79],v18,s[8:11],s59 offen sc1
buffer_load_dwordx4 v[60:63],v1,s[8:11],s59 offen sc1
buffer_load_dwordx4 v[64:67],v1,s[8:11],s59 offen offset:1024 sc1
buffer_load_dwordx4 v[68:71],v1,s[8:11],s59 offen offset:2048 sc1
buffer_load_dwordx4 v[72:75],v1,s[8:11],s59 offen offset:3072 sc1
sk_145:
buffer_load_dwordx4 v[96:99],v18,s[8:11],s68 offen sc1
buffer_load_dwordx4 v[80:83],v1,s[8:11],s68 offen sc1
buffer_load_dwordx4 v[84:87],v1,s[8:11],s68 offen offset:1024 sc1
buffer_load_dwordx4 v[88:91],v1,s[8:11],s68 offen offset:2048 sc1
buffer_load_dwordx4 v[92:95],v1,s[8:11],s68 offen offset:3072 sc1
s_sub_u32 s47,s47,1
s_cbranch_scc1 ABORT
s_waitcnt lgkmcnt(0)
s_branch fa_136
CV_LOOP_S0:
v_mov_b32 v24,0
v_mov_b32 v25,0
v_mov_b32 v26,0
v_mov_b32 v27,0
v_mov_b32 v28,0
v_mov_b32 v29,0
v_mov_b32 v30,0
v_mov_b32 v31,0
v_mov_b32 v32,0
v_mov_b32 v33,0
v_mov_b32 v34,0
v_mov_b32 v35,0
v_mov_b32 v36,0
v_mov_b32 v37,0
v_mov_b32 v38,0
v_mov_b32 v39,0
v_mov_b32 v40,0
v_mov_b32 v41,0
v_mov_b32 v42,0
v_mov_b32 v43,0
v_mov_b32 v44,0
v_mov_b32 v45,0
v_mov_b32 v46,0
v_mov_b32 v47,0
s_cmp_lg_u32 s46,0
s_cbranch_scc1 np_149
db_150:
buffer_load_dword v12,v11,s[8:11],s69 offen sc1
s_waitcnt vmcnt(0)
v_cmp_gt_u32 vcc,s58,v12
s_cbranch_vccz dbok_151
s_sub_u32 s47,s47,1
s_cbranch_scc1 ABORT
s_branch db_150
dbok_151:
np_149:
s_barrier
buffer_load_dwordx4 v[76:79],v18,s[8:11],s59 offen sc1
buffer_load_dwordx4 v[60:63],v1,s[8:11],s59 offen sc1
buffer_load_dwordx4 v[64:67],v1,s[8:11],s59 offen offset:1024 sc1
buffer_load_dwordx4 v[68:71],v1,s[8:11],s59 offen offset:2048 sc1
buffer_load_dwordx4 v[72:75],v1,s[8:11],s59 offen offset:3072 sc1
s_waitcnt vmcnt(4)
buffer_load_dwordx4 v[96:99],v18,s[8:11],s68 offen sc1
buffer_load_dwordx4 v[80:83],v1,s[8:11],s68 offen sc1
buffer_load_dwordx4 v[84:87],v1,s[8:11],s68 offen offset:1024 sc1
buffer_load_dwordx4 v[88:91],v1,s[8:11],s68 offen offset:2048 sc1
buffer_load_dwordx4 v[92:95],v1,s[8:11],s68 offen offset:3072 sc1
fj_148:
fa_146:
s_waitcnt vmcnt(4)
v_pk_add_f32 v[12:13],v[76:77],v[96:97]
v_pk_add_f32 v[14:15],v[78:79],v[98:99]
v_bitop3_b32 v16,v76,v96,s57 bitop3:0x7e
v_cvt_pk_bf16_f32 v56,v12,v13
v_cvt_pk_bf16_f32 v57,v14,v15
ds_write_b64 v23,v[56:57]
s_waitcnt vmcnt(3)
v_pk_add_f32 v[12:13],v[60:61],v[80:81]
v_pk_add_f32 v[14:15],v[62:63],v[82:83]
v_bitop3_b32 v17,v60,v80,s57 bitop3:0x7e
v_cvt_pk_bf16_f32 v48,v12,v13
v_cvt_pk_bf16_f32 v49,v14,v15
v_or_b32 v16,v16,v17
s_waitcnt vmcnt(2)
v_pk_add_f32 v[12:13],v[64:65],v[84:85]
v_pk_add_f32 v[14:15],v[66:67],v[86:87]
v_bitop3_b32 v17,v64,v84,s57 bitop3:0x7e
v_cvt_pk_bf16_f32 v50,v12,v13
v_cvt_pk_bf16_f32 v51,v14,v15
v_or_b32 v16,v16,v17
ds_write_b128 v22,v[48:51] offset:0
s_waitcnt vmcnt(1)
v_pk_add_f32 v[12:13],v[68:69],v[88:89]
v_pk_add_f32 v[14:15],v[70:71],v[90:91]
v_bitop3_b32 v17,v68,v88,s57 bitop3:0x7e
v_cvt_pk_bf16_f32 v52,v12,v13
v_cvt_pk_bf16_f32 v53,v14,v15
v_or_b32 v16,v16,v17
s_waitcnt vmcnt(0)
v_pk_add_f32 v[12:13],v[72:73],v[92:93]
v_pk_add_f32 v[14:15],v[74:75],v[94:95]
v_bitop3_b32 v17,v72,v92,s57 bitop3:0x7e
v_cvt_pk_bf16_f32 v54,v12,v13
v_cvt_pk_bf16_f32 v55,v14,v15
v_bitop3_b32 v16,v16,v17,1 bitop3:0xa8
v_cmp_ne_u32 vcc,0,v16
ds_write_b128 v22,v[52:55] offset:1024
s_cbranch_vccnz fr_147
v_smfmac_f32_16x16x64_bf16 v[24:27],v[48:51],a[0:7],v2
ds_read_b128 v[72:75],v21 offset:0
s_and_b32 s60,s52,3
v_smfmac_f32_16x16x64_bf16 v[28:31],v[48:51],a[8:15],v2
ds_read_b128 v[76:79],v21 offset:1024
s_lshl2_add_u32 s60,s51,s60
v_smfmac_f32_16x16x64_bf16 v[32:35],v[48:51],a[16:23],v2
ds_read_b128 v[80:83],v21 offset:2048
s_mul_i32 s60,s60,49152
v_smfmac_f32_16x16x64_bf16 v[36:39],v[48:51],a[24:31],v2
ds_read_b128 v[84:87],v21 offset:3072
s_add_u32 s71,s60,s34
s_waitcnt lgkmcnt(4)
s_barrier
v_smfmac_f32_16x16x64_bf16 v[40:43],v[48:51],a[32:39],v2
ds_read_b128 v[60:63],v3 offset:0
v_smfmac_f32_16x16x64_bf16 v[24:27],v[52:55],a[40:47],v2
ds_read_b128 v[64:67],v3 offset:1024
v_smfmac_f32_16x16x64_bf16 v[28:31],v[52:55],a[48:55],v2
ds_read_b128 v[68:71],v4 offset:0
v_smfmac_f32_16x16x64_bf16 v[32:35],v[52:55],a[56:63],v2
v_smfmac_f32_16x16x64_bf16 v[36:39],v[52:55],a[64:71],v2
v_smfmac_f32_16x16x64_bf16 v[40:43],v[52:55],a[72:79],v2
s_waitcnt lgkmcnt(5)
v_smfmac_f32_16x16x64_bf16 v[44:47],v[48:51],v[72:79],v2
ds_read_b128 v[72:75],v21 offset:4096
s_waitcnt lgkmcnt(4)
v_smfmac_f32_16x16x64_bf16 v[44:47],v[52:55],v[80:87],v2
ds_read_b128 v[76:79],v21 offset:5120
s_waitcnt lgkmcnt(4)
v_smfmac_f32_16x16x64_bf16 v[24:27],v[60:63],a[80:87],v2
ds_read_b128 v[80:83],v21 offset:6144
v_smfmac_f32_16x16x64_bf16 v[28:31],v[60:63],a[88:95],v2
ds_read_b128 v[84:87],v21 offset:7168
v_smfmac_f32_16x16x64_bf16 v[32:35],v[60:63],a[96:103],v2
v_smfmac_f32_16x16x64_bf16 v[36:39],v[60:63],a[104:111],v2
v_smfmac_f32_16x16x64_bf16 v[40:43],v[60:63],a[112:119],v2
s_waitcnt lgkmcnt(2)
v_smfmac_f32_16x16x64_bf16 v[44:47],v[60:63],v[72:79],v2
ds_read_b128 v[60:63],v4 offset:1024
v_smfmac_f32_16x16x64_bf16 v[24:27],v[64:67],a[120:127],v2
ds_read_b128 v[72:75],v21 offset:8192
v_smfmac_f32_16x16x64_bf16 v[28:31],v[64:67],a[128:135],v2
ds_read_b128 v[76:79],v21 offset:9216
v_smfmac_f32_16x16x64_bf16 v[32:35],v[64:67],a[136:143],v2
v_smfmac_f32_16x16x64_bf16 v[36:39],v[64:67],a[144:151],v2
v_smfmac_f32_16x16x64_bf16 v[40:43],v[64:67],a[152:159],v2
s_waitcnt lgkmcnt(3)
v_smfmac_f32_16x16x64_bf16 v[44:47],v[64:67],v[80:87],v2
ds_read_b128 v[64:67],v5 offset:0
v_smfmac_f32_16x16x64_bf16 v[24:27],v[68:71],a[160:167],v2
ds_read_b128 v[80:83],v21 offset:10240
v_smfmac_f32_16x16x64_bf16 v[28:31],v[68:71],a[168:175],v2
ds_read_b128 v[84:87],v21 offset:11264
v_smfmac_f32_16x16x64_bf16 v[32:35],v[68:71],a[176:183],v2
v_smfmac_f32_16x16x64_bf16 v[36:39],v[68:71],a[184:191],v2
v_smfmac_f32_16x16x64_bf16 v[40:43],v[68:71],a[192:199],v2
s_waitcnt lgkmcnt(3)
v_smfmac_f32_16x16x64_bf16 v[44:47],v[68:71],v[72:79],v2
ds_read_b128 v[68:71],v5 offset:1024
v_smfmac_f32_16x16x64_bf16 v[24:27],v[60:63],a[200:207],v2
ds_read_b128 v[72:75],v21 offset:12288
v_smfmac_f32_16x16x64_bf16 v[28:31],v[60:63],a[208:215],v2
ds_read_b128 v[76:79],v21 offset:13312
v_smfmac_f32_16x16x64_bf16 v[32:35],v[60:63],a[216:223],v2
v_smfmac_f32_16x16x64_bf16 v[36:39],v[60:63],a[224:231],v2
v_smfmac_f32_16x16x64_bf16 v[40:43],v[60:63],a[232:239],v2
s_waitcnt lgkmcnt(3)
v_smfmac_f32_16x16x64_bf16 v[44:47],v[60:63],v[80:87],v2
ds_read_b128 v[60:63],v59 offset:0
v_smfmac_f32_16x16x64_bf16 v[24:27],v[64:67],a[240:247],v2
ds_read_b128 v[80:83],v21 offset:14336
v_smfmac_f32_16x16x64_bf16 v[28:31],v[64:67],a[248:255],v2
ds_read_b128 v[84:87],v21 offset:15360
v_smfmac_f32_16x16x64_bf16 v[32:35],v[64:67],v[112:119],v2
s_cmp_eq_u32 s79,-1
s_cbranch_scc1 pf_152
v_mov_b32 v17,1
s_mov_b64 exec,1
buffer_store_dword v17,v1,s[8:11],s79 offen sc1
s_mov_b64 exec,-1
s_mov_b32 s79,-1
pf_152:
v_smfmac_f32_16x16x64_bf16 v[36:39],v[64:67],v[120:127],v2
s_cmp_eq_u32 s78,-1
s_cbranch_scc1 pk_153
buffer_store_dwordx4 v[100:103],v6,s[8:11],s78 offen sc1
buffer_store_dwordx2 v[104:105],v7,s[8:11],s78 offen sc1
s_mov_b32 s79,s30
s_mov_b32 s78,-1
pk_153:
v_smfmac_f32_16x16x64_bf16 v[40:43],v[64:67],v[128:135],v2
s_waitcnt lgkmcnt(3)
v_smfmac_f32_16x16x64_bf16 v[44:47],v[64:67],v[72:79],v2
ds_read_b128 v[64:67],v59 offset:1024
v_smfmac_f32_16x16x64_bf16 v[24:27],v[68:71],v[136:143],v2
ds_read_b128 v[72:75],v21 offset:16384
v_smfmac_f32_16x16x64_bf16 v[28:31],v[68:71],v[144:151],v2
ds_read_b128 v[76:79],v21 offset:17408
v_smfmac_f32_16x16x64_bf16 v[32:35],v[68:71],v[152:159],v2
v_smfmac_f32_16x16x64_bf16 v[36:39],v[68:71],v[160:167],v2
v_smfmac_f32_16x16x64_bf16 v[40:43],v[68:71],v[168:175],v2
s_waitcnt lgkmcnt(3)
v_smfmac_f32_16x16x64_bf16 v[44:47],v[68:71],v[80:87],v2
ds_read_b128 v[80:83],v21 offset:18432
v_smfmac_f32_16x16x64_bf16 v[24:27],v[60:63],v[176:183],v2
ds_read_b128 v[84:87],v21 offset:19456
v_smfmac_f32_16x16x64_bf16 v[28:31],v[60:63],v[184:191],v2
s_waitcnt lgkmcnt(4)
v_smfmac_f32_16x16x64_bf16 v[24:27],v[64:67],v[216:223],v2
v_smfmac_f32_16x16x64_bf16 v[28:31],v[64:67],v[224:231],v2
v_smfmac_f32_16x16x64_bf16 v[32:35],v[60:63],v[192:199],v2
v_smfmac_f32_16x16x64_bf16 v[36:39],v[60:63],v[200:207],v2
s_nop 4
v_add_f32 v24,v24,v25
v_smfmac_f32_16x16x64_bf16 v[32:35],v[64:67],v[232:239],v2
v_add_f32 v26,v26,v27
v_smfmac_f32_16x16x64_bf16 v[36:39],v[64:67],v[240:247],v2
v_add_f32 v28,v28,v29
v_smfmac_f32_16x16x64_bf16 v[40:43],v[60:63],v[208:215],v2
v_add_f32 v30,v30,v31
s_waitcnt lgkmcnt(2)
v_smfmac_f32_16x16x64_bf16 v[44:47],v[60:63],v[72:79],v2
v_cvt_pk_bf16_f32 v100,v24,v26
v_smfmac_f32_16x16x64_bf16 v[40:43],v[64:67],v[248:255],v2
v_cvt_pk_bf16_f32 v101,v28,v30
s_waitcnt lgkmcnt(0)
v_smfmac_f32_16x16x64_bf16 v[44:47],v[64:67],v[80:87],v2
v_and_or_b32 v100,v100,-2,s57
v_add_f32 v32,v32,v33
v_add_f32 v34,v34,v35
v_add_f32 v36,v36,v37
v_add_f32 v38,v38,v39
v_cvt_pk_bf16_f32 v102,v32,v34
v_cvt_pk_bf16_f32 v103,v36,v38
v_and_or_b32 v102,v102,-2,s57
buffer_store_dwordx4 v[100:103],v6,s[8:11],s71 offen sc1
v_add_f32 v40,v40,v41
v_add_f32 v42,v42,v43
v_add_f32 v44,v44,v45
v_add_f32 v46,v46,v47
v_cvt_pk_bf16_f32 v104,v40,v42
v_cvt_pk_bf16_f32 v105,v44,v46
v_and_or_b32 v104,v104,-2,s57
buffer_store_dwordx2 v[104:105],v7,s[8:11],s71 offen sc1
s_lshl_b32 s60,s51,6
s_add_u32 s60,s60,s52
s_mul_i32 s78,s60,196608
s_add_u32 s78,s78,s85
s_lshl_b32 s60,s60,10
s_add_u32 s30,s60,s86
s_sub_u32 s60,s4,s5
s_cmp_gt_i32 s60,15
s_cselect_b32 s53,1,0
s_cmp_eq_u32 s4,64
s_cselect_b32 s53,1,s53
s_cmp_eq_u32 s53,0
s_cselect_b32 s54,s4,s5
s_addc_u32 s4,s4,0
s_add_u32 s5,s5,s53
s_and_b32 s60,s54,3
s_lshl2_add_u32 s60,s53,s60
s_lshl_b32 s68,s60,16
s_add_u32 s68,s68,s83
s_mul_i32 s59,s60,20480
s_add_u32 s59,s59,s6
s_lshl_b32 s69,s53,9
s_add_u32 s69,s69,s7
s_bfe_u32 s31,s54,0x10002
s_add_u32 s32,s54,1
s_cmp_lg_u32 s53,s51
s_cbranch_scc1 nx_154
s_waitcnt vmcnt(0)
s_cmp_eq_u32 s79,-1
s_cbranch_scc1 pf_155
v_mov_b32 v17,1
s_mov_b64 exec,1
buffer_store_dword v17,v1,s[8:11],s79 offen sc1
s_mov_b64 exec,-1
s_mov_b32 s79,-1
pf_155:
s_cmp_eq_u32 s78,-1
s_cbranch_scc1 pk_156
buffer_store_dwordx4 v[100:103],v6,s[8:11],s78 offen sc1
buffer_store_dwordx2 v[104:105],v7,s[8:11],s78 offen sc1
s_mov_b32 s79,s30
s_mov_b32 s78,-1
pk_156:
s_waitcnt vmcnt(0)
s_cmp_eq_u32 s79,-1
s_cbranch_scc1 pf_157
v_mov_b32 v17,1
s_mov_b64 exec,1
buffer_store_dword v17,v1,s[8:11],s79 offen sc1
s_mov_b64 exec,-1
s_mov_b32 s79,-1
pf_157:
nx_154:
s_add_u32 s50,s50,1
s_mov_b32 s51,s53
s_mov_b32 s52,s54
s_mov_b32 s57,s31
s_mov_b32 s58,s32
s_cmp_lt_u32 s50,128
s_cbranch_scc1 CV_LOOP_S0
s_branch CV_DONE
fr_147:
v_bitop3_b32 v12,v60,v64,s57 bitop3:0x7e
v_bitop3_b32 v13,v68,v72,s57 bitop3:0x7e
v_xor_b32 v14,s57,v76
v_or3_b32 v12,v12,v13,v14
v_and_b32 v12,1,v12
v_cmp_ne_u32 vcc,0,v12
s_cbranch_vccz sk_158
buffer_load_dwordx4 v[76:79],v18,s[8:11],s59 offen sc1
buffer_load_dwordx4 v[60:63],v1,s[8:11],s59 offen sc1
buffer_load_dwordx4 v[64:67],v1,s[8:11],s59 offen offset:1024 sc1
buffer_load_dwordx4 v[68:71],v1,s[8:11],s59 offen offset:2048 sc1
buffer_load_dwordx4 v[72:75],v1,s[8:11],s59 offen offset:3072 sc1
sk_158:
buffer_load_dwordx4 v[96:99],v18,s[8:11],s68 offen sc1
buffer_load_dwordx4 v[80:83],v1,s[8:11],s68 offen sc1
buffer_load_dwordx4 v[84:87],v1,s[8:11],s68 offen offset:1024 sc1
buffer_load_dwordx4 v[88:91],v1,s[8:11],s68 offen offset:2048 sc1
buffer_load_dwordx4 v[92:95],v1,s[8:11],s68 offen offset:3072 sc1
s_sub_u32 s47,s47,1
s_cbranch_scc1 ABORT
s_waitcnt lgkmcnt(0)
s_branch fa_146
CV_LOOP_S1:
v_mov_b32 v24,0
v_mov_b32 v25,0
v_mov_b32 v26,0
v_mov_b32 v27,0
v_mov_b32 v28,0
v_mov_b32 v29,0
v_mov_b32 v30,0
v_mov_b32 v31,0
v_mov_b32 v32,0
v_mov_b32 v33,0
v_mov_b32 v34,0
v_mov_b32 v35,0
v_mov_b32 v36,0
v_mov_b32 v37,0
v_mov_b32 v38,0
v_mov_b32 v39,0
v_mov_b32 v40,0
v_mov_b32 v41,0
v_mov_b32 v42,0
v_mov_b32 v43,0
v_mov_b32 v44,0
v_mov_b32 v45,0
v_mov_b32 v46,0
v_mov_b32 v47,0
s_barrier
buffer_load_dwordx4 v[76:79],v18,s[8:11],s59 offen sc1
buffer_load_dwordx4 v[60:63],v1,s[8:11],s59 offen sc1
buffer_load_dwordx4 v[64:67],v1,s[8:11],s59 offen offset:1024 sc1
buffer_load_dwordx4 v[68:71],v1,s[8:11],s59 offen offset:2048 sc1
buffer_load_dwordx4 v[72:75],v1,s[8:11],s59 offen offset:3072 sc1
s_waitcnt vmcnt(4)
buffer_load_dwordx4 v[96:99],v18,s[8:11],s68 offen sc1
buffer_load_dwordx4 v[80:83],v1,s[8:11],s68 offen sc1
buffer_load_dwordx4 v[84:87],v1,s[8:11],s68 offen offset:1024 sc1
buffer_load_dwordx4 v[88:91],v1,s[8:11],s68 offen offset:2048 sc1
buffer_load_dwordx4 v[92:95],v1,s[8:11],s68 offen offset:3072 sc1
fj_161:
fa_159:
s_waitcnt vmcnt(4)
v_pk_add_f32 v[12:13],v[76:77],v[96:97]
v_pk_add_f32 v[14:15],v[78:79],v[98:99]
v_bitop3_b32 v16,v76,v96,s57 bitop3:0x7e
v_cvt_pk_bf16_f32 v56,v12,v13
v_cvt_pk_bf16_f32 v57,v14,v15
ds_write_b64 v23,v[56:57]
s_waitcnt vmcnt(3)
v_pk_add_f32 v[12:13],v[60:61],v[80:81]
v_pk_add_f32 v[14:15],v[62:63],v[82:83]
v_bitop3_b32 v17,v60,v80,s57 bitop3:0x7e
v_cvt_pk_bf16_f32 v48,v12,v13
v_cvt_pk_bf16_f32 v49,v14,v15
v_or_b32 v16,v16,v17
s_waitcnt vmcnt(2)
v_pk_add_f32 v[12:13],v[64:65],v[84:85]
v_pk_add_f32 v[14:15],v[66:67],v[86:87]
v_bitop3_b32 v17,v64,v84,s57 bitop3:0x7e
v_cvt_pk_bf16_f32 v50,v12,v13
v_cvt_pk_bf16_f32 v51,v14,v15
v_or_b32 v16,v16,v17
ds_write_b128 v22,v[48:51] offset:0
s_waitcnt vmcnt(1)
v_pk_add_f32 v[12:13],v[68:69],v[88:89]
v_pk_add_f32 v[14:15],v[70:71],v[90:91]
v_bitop3_b32 v17,v68,v88,s57 bitop3:0x7e
v_cvt_pk_bf16_f32 v52,v12,v13
v_cvt_pk_bf16_f32 v53,v14,v15
v_or_b32 v16,v16,v17
s_waitcnt vmcnt(0)
v_pk_add_f32 v[12:13],v[72:73],v[92:93]
v_pk_add_f32 v[14:15],v[74:75],v[94:95]
v_bitop3_b32 v17,v72,v92,s57 bitop3:0x7e
v_cvt_pk_bf16_f32 v54,v12,v13
v_cvt_pk_bf16_f32 v55,v14,v15
v_bitop3_b32 v16,v16,v17,1 bitop3:0xa8
v_cmp_ne_u32 vcc,0,v16
ds_write_b128 v22,v[52:55] offset:1024
s_cbranch_vccnz fr_160
v_smfmac_f32_16x16x64_bf16 v[24:27],v[48:51],a[0:7],v2
ds_read_b128 v[72:75],v21 offset:0
s_and_b32 s60,s52,3
v_smfmac_f32_16x16x64_bf16 v[28:31],v[48:51],a[8:15],v2
ds_read_b128 v[76:79],v21 offset:1024
s_lshl2_add_u32 s60,s51,s60
v_smfmac_f32_16x16x64_bf16 v[32:35],v[48:51],a[16:23],v2
ds_read_b128 v[80:83],v21 offset:2048
s_mul_i32 s60,s60,49152
v_smfmac_f32_16x16x64_bf16 v[36:39],v[48:51],a[24:31],v2
ds_read_b128 v[84:87],v21 offset:3072
s_add_u32 s71,s60,s34
s_waitcnt lgkmcnt(4)
s_barrier
v_smfmac_f32_16x16x64_bf16 v[40:43],v[48:51],a[32:39],v2
ds_read_b128 v[60:63],v3 offset:0
v_smfmac_f32_16x16x64_bf16 v[24:27],v[52:55],a[40:47],v2
ds_read_b128 v[64:67],v3 offset:1024
v_smfmac_f32_16x16x64_bf16 v[28:31],v[52:55],a[48:55],v2
ds_read_b128 v[68:71],v4 offset:0
v_smfmac_f32_16x16x64_bf16 v[32:35],v[52:55],a[56:63],v2
v_smfmac_f32_16x16x64_bf16 v[36:39],v[52:55],a[64:71],v2
v_smfmac_f32_16x16x64_bf16 v[40:43],v[52:55],a[72:79],v2
s_waitcnt lgkmcnt(5)
v_smfmac_f32_16x16x64_bf16 v[44:47],v[48:51],v[72:79],v2
ds_read_b128 v[72:75],v21 offset:4096
s_waitcnt lgkmcnt(4)
v_smfmac_f32_16x16x64_bf16 v[44:47],v[52:55],v[80:87],v2
ds_read_b128 v[76:79],v21 offset:5120
s_waitcnt lgkmcnt(4)
v_smfmac_f32_16x16x64_bf16 v[24:27],v[60:63],a[80:87],v2
ds_read_b128 v[80:83],v21 offset:6144
v_smfmac_f32_16x16x64_bf16 v[28:31],v[60:63],a[88:95],v2
ds_read_b128 v[84:87],v21 offset:7168
v_smfmac_f32_16x16x64_bf16 v[32:35],v[60:63],a[96:103],v2
v_smfmac_f32_16x16x64_bf16 v[36:39],v[60:63],a[104:111],v2
v_smfmac_f32_16x16x64_bf16 v[40:43],v[60:63],a[112:119],v2
s_waitcnt lgkmcnt(2)
v_smfmac_f32_16x16x64_bf16 v[44:47],v[60:63],v[72:79],v2
ds_read_b128 v[60:63],v4 offset:1024
v_smfmac_f32_16x16x64_bf16 v[24:27],v[64:67],a[120:127],v2
ds_read_b128 v[72:75],v21 offset:8192
v_smfmac_f32_16x16x64_bf16 v[28:31],v[64:67],a[128:135],v2
ds_read_b128 v[76:79],v21 offset:9216
v_smfmac_f32_16x16x64_bf16 v[32:35],v[64:67],a[136:143],v2
v_smfmac_f32_16x16x64_bf16 v[36:39],v[64:67],a[144:151],v2
v_smfmac_f32_16x16x64_bf16 v[40:43],v[64:67],a[152:159],v2
s_waitcnt lgkmcnt(3)
v_smfmac_f32_16x16x64_bf16 v[44:47],v[64:67],v[80:87],v2
ds_read_b128 v[64:67],v5 offset:0
v_smfmac_f32_16x16x64_bf16 v[24:27],v[68:71],a[160:167],v2
ds_read_b128 v[80:83],v21 offset:10240
v_smfmac_f32_16x16x64_bf16 v[28:31],v[68:71],a[168:175],v2
ds_read_b128 v[84:87],v21 offset:11264
v_smfmac_f32_16x16x64_bf16 v[32:35],v[68:71],a[176:183],v2
v_smfmac_f32_16x16x64_bf16 v[36:39],v[68:71],a[184:191],v2
v_smfmac_f32_16x16x64_bf16 v[40:43],v[68:71],a[192:199],v2
s_waitcnt lgkmcnt(3)
v_smfmac_f32_16x16x64_bf16 v[44:47],v[68:71],v[72:79],v2
ds_read_b128 v[68:71],v5 offset:1024
v_smfmac_f32_16x16x64_bf16 v[24:27],v[60:63],a[200:207],v2
ds_read_b128 v[72:75],v21 offset:12288
v_smfmac_f32_16x16x64_bf16 v[28:31],v[60:63],a[208:215],v2
ds_read_b128 v[76:79],v21 offset:13312
v_smfmac_f32_16x16x64_bf16 v[32:35],v[60:63],a[216:223],v2
v_smfmac_f32_16x16x64_bf16 v[36:39],v[60:63],a[224:231],v2
v_smfmac_f32_16x16x64_bf16 v[40:43],v[60:63],a[232:239],v2
s_waitcnt lgkmcnt(3)
v_smfmac_f32_16x16x64_bf16 v[44:47],v[60:63],v[80:87],v2
ds_read_b128 v[60:63],v59 offset:0
v_smfmac_f32_16x16x64_bf16 v[24:27],v[64:67],a[240:247],v2
ds_read_b128 v[80:83],v21 offset:14336
v_smfmac_f32_16x16x64_bf16 v[28:31],v[64:67],a[248:255],v2
ds_read_b128 v[84:87],v21 offset:15360
v_smfmac_f32_16x16x64_bf16 v[32:35],v[64:67],v[112:119],v2
s_cmp_eq_u32 s79,-1
s_cbranch_scc1 pf_162
v_mov_b32 v17,1
s_mov_b64 exec,1
buffer_store_dword v17,v1,s[8:11],s79 offen sc1
s_mov_b64 exec,-1
s_mov_b32 s79,-1
pf_162:
v_smfmac_f32_16x16x64_bf16 v[36:39],v[64:67],v[120:127],v2
s_cmp_eq_u32 s78,-1
s_cbranch_scc1 pk_163
buffer_store_dwordx4 v[102:105],v6,s[8:11],s78 offen sc1
buffer_store_dwordx2 v[100:101],v7,s[8:11],s78 offen sc1
s_mov_b32 s79,s30
s_mov_b32 s78,-1
pk_163:
v_smfmac_f32_16x16x64_bf16 v[40:43],v[64:67],v[128:135],v2
s_waitcnt lgkmcnt(3)
v_smfmac_f32_16x16x64_bf16 v[44:47],v[64:67],v[72:79],v2
ds_read_b128 v[64:67],v59 offset:1024
v_smfmac_f32_16x16x64_bf16 v[24:27],v[68:71],v[136:143],v2
ds_read_b128 v[72:75],v21 offset:16384
v_smfmac_f32_16x16x64_bf16 v[28:31],v[68:71],v[144:151],v2
ds_read_b128 v[76:79],v21 offset:17408
v_smfmac_f32_16x16x64_bf16 v[32:35],v[68:71],v[152:159],v2
v_smfmac_f32_16x16x64_bf16 v[36:39],v[68:71],v[160:167],v2
v_smfmac_f32_16x16x64_bf16 v[40:43],v[68:71],v[168:175],v2
s_waitcnt lgkmcnt(3)
v_smfmac_f32_16x16x64_bf16 v[44:47],v[68:71],v[80:87],v2
ds_read_b128 v[80:83],v21 offset:18432
v_smfmac_f32_16x16x64_bf16 v[24:27],v[60:63],v[176:183],v2
ds_read_b128 v[84:87],v21 offset:19456
v_smfmac_f32_16x16x64_bf16 v[28:31],v[60:63],v[184:191],v2
s_waitcnt lgkmcnt(4)
v_smfmac_f32_16x16x64_bf16 v[24:27],v[64:67],v[216:223],v2
v_smfmac_f32_16x16x64_bf16 v[28:31],v[64:67],v[224:231],v2
v_smfmac_f32_16x16x64_bf16 v[32:35],v[60:63],v[192:199],v2
v_smfmac_f32_16x16x64_bf16 v[36:39],v[60:63],v[200:207],v2
s_nop 4
v_add_f32 v24,v24,v25
v_smfmac_f32_16x16x64_bf16 v[32:35],v[64:67],v[232:239],v2
v_add_f32 v26,v26,v27
v_smfmac_f32_16x16x64_bf16 v[36:39],v[64:67],v[240:247],v2
v_add_f32 v28,v28,v29
v_smfmac_f32_16x16x64_bf16 v[40:43],v[60:63],v[208:215],v2
v_add_f32 v30,v30,v31
s_waitcnt lgkmcnt(2)
v_smfmac_f32_16x16x64_bf16 v[44:47],v[60:63],v[72:79],v2
v_cvt_pk_bf16_f32 v100,v24,v26
v_smfmac_f32_16x16x64_bf16 v[40:43],v[64:67],v[248:255],v2
v_cvt_pk_bf16_f32 v101,v28,v30
s_waitcnt lgkmcnt(0)
v_smfmac_f32_16x16x64_bf16 v[44:47],v[64:67],v[80:87],v2
v_and_or_b32 v100,v100,-2,s57
buffer_store_dwordx2 v[100:101],v7,s[8:11],s71 offen sc1
v_add_f32 v32,v32,v33
v_add_f32 v34,v34,v35
v_add_f32 v36,v36,v37
v_add_f32 v38,v38,v39
v_cvt_pk_bf16_f32 v102,v32,v34
v_cvt_pk_bf16_f32 v103,v36,v38
v_and_or_b32 v102,v102,-2,s57
v_add_f32 v40,v40,v41
v_add_f32 v42,v42,v43
v_add_f32 v44,v44,v45
v_add_f32 v46,v46,v47
v_cvt_pk_bf16_f32 v104,v40,v42
v_cvt_pk_bf16_f32 v105,v44,v46
v_and_or_b32 v104,v104,-2,s57
buffer_store_dwordx4 v[102:105],v6,s[8:11],s71 offen sc1
s_lshl_b32 s60,s51,6
s_add_u32 s60,s60,s52
s_mul_i32 s78,s60,196608
s_add_u32 s78,s78,s85
s_lshl_b32 s60,s60,10
s_add_u32 s30,s60,s86
s_sub_u32 s60,s4,s5
s_cmp_gt_i32 s60,15
s_cselect_b32 s53,1,0
s_cmp_eq_u32 s4,64
s_cselect_b32 s53,1,s53
s_cmp_eq_u32 s53,0
s_cselect_b32 s54,s4,s5
s_addc_u32 s4,s4,0
s_add_u32 s5,s5,s53
s_and_b32 s60,s54,3
s_lshl2_add_u32 s60,s53,s60
s_lshl_b32 s68,s60,16
s_add_u32 s68,s68,s83
s_mul_i32 s59,s60,20480
s_add_u32 s59,s59,s6
s_lshl_b32 s69,s53,9
s_add_u32 s69,s69,s7
s_bfe_u32 s31,s54,0x10002
s_add_u32 s32,s54,1
s_cmp_lg_u32 s53,s51
s_cbranch_scc1 nx_164
s_waitcnt vmcnt(0)
s_cmp_eq_u32 s79,-1
s_cbranch_scc1 pf_165
v_mov_b32 v17,1
s_mov_b64 exec,1
buffer_store_dword v17,v1,s[8:11],s79 offen sc1
s_mov_b64 exec,-1
s_mov_b32 s79,-1
pf_165:
s_cmp_eq_u32 s78,-1
s_cbranch_scc1 pk_166
buffer_store_dwordx4 v[102:105],v6,s[8:11],s78 offen sc1
buffer_store_dwordx2 v[100:101],v7,s[8:11],s78 offen sc1
s_mov_b32 s79,s30
s_mov_b32 s78,-1
pk_166:
s_waitcnt vmcnt(0)
s_cmp_eq_u32 s79,-1
s_cbranch_scc1 pf_167
v_mov_b32 v17,1
s_mov_b64 exec,1
buffer_store_dword v17,v1,s[8:11],s79 offen sc1
s_mov_b64 exec,-1
s_mov_b32 s79,-1
pf_167:
nx_164:
s_add_u32 s50,s50,1
s_mov_b32 s51,s53
s_mov_b32 s52,s54
s_mov_b32 s57,s31
s_mov_b32 s58,s32
s_cmp_lt_u32 s50,128
s_cbranch_scc1 CV_LOOP_S1
s_branch CV_DONE
fr_160:
v_bitop3_b32 v12,v60,v64,s57 bitop3:0x7e
v_bitop3_b32 v13,v68,v72,s57 bitop3:0x7e
v_xor_b32 v14,s57,v76
v_or3_b32 v12,v12,v13,v14
v_and_b32 v12,1,v12
v_cmp_ne_u32 vcc,0,v12
s_cbranch_vccz sk_168
buffer_load_dwordx4 v[76:79],v18,s[8:11],s59 offen sc1
buffer_load_dwordx4 v[60:63],v1,s[8:11],s59 offen sc1
buffer_load_dwordx4 v[64:67],v1,s[8:11],s59 offen offset:1024 sc1
buffer_load_dwordx4 v[68:71],v1,s[8:11],s59 offen offset:2048 sc1
buffer_load_dwordx4 v[72:75],v1,s[8:11],s59 offen offset:3072 sc1
sk_168:
buffer_load_dwordx4 v[96:99],v18,s[8:11],s68 offen sc1
buffer_load_dwordx4 v[80:83],v1,s[8:11],s68 offen sc1
buffer_load_dwordx4 v[84:87],v1,s[8:11],s68 offen offset:1024 sc1
buffer_load_dwordx4 v[88:91],v1,s[8:11],s68 offen offset:2048 sc1
buffer_load_dwordx4 v[92:95],v1,s[8:11],s68 offen offset:3072 sc1
s_sub_u32 s47,s47,1
s_cbranch_scc1 ABORT
s_waitcnt lgkmcnt(0)
s_branch fa_159
CV_DONE:
s_add_u32 s61,s48,32
s_endpgm
ROLE_CW:
s_lshr_b32 s28,s48,3
s_and_b32 s29,s48,7
s_mul_i32 s82,s28,2097152
s_add_u32 s82,s82,2097152
v_lshlrev_b32 v1,4,v0
v_and_b32 v12,1,v0
v_mul_u32_u24 v2,0xaaaa,v12
v_or_b32 v2,0x4444,v2
v_lshrrev_b32 v14,4,v0
v_and_b32 v15,15,v0
v_min_u32 v3,11,v15
v_lshlrev_b32 v3,2,v3
v_lshl_add_u32 v3,v14,7,v3
s_mul_i32 s60,s46,24576
v_add_u32 v4,s60,v1
v_mul_u32_u24 v5,704,v14
v_lshl_add_u32 v5,v15,2,v5
s_mul_i32 s60,s46,2816
s_add_u32 s60,s60,98304
v_add_u32 v5,s60,v5
v_min_u32 v12,39,v0
s_mul_i32 s60,s46,40
v_add_u32 v12,s60,v12
v_lshlrev_b32 v9,4,v12
v_bfe_u32 v13,v12,1,3
v_mul_u32_u24 v6,352,v13
v_mul_u32_u24 v17,1280,v13
v_lshrrev_b32 v13,4,v12
v_lshl_add_u32 v6,v13,5,v6
v_lshl_add_u32 v17,v13,4,v17
v_and_b32 v13,1,v12
v_lshl_add_u32 v6,v13,4,v6
v_lshl_add_u32 v17,v13,3,v17
v_add_u32 v6,98304,v6
s_mov_b32 s88,-1
s_mov_b32 s89,0xff
s_mov_b32 s4,s18
s_mov_b32 s5,s19
s_mov_b32 s6,10240
s_mov_b32 s7,0x20000
s_mul_i32 s60,s29,160
buffer_load_dwordx2 v[32:33],v17,s[4:7],s60 offen
s_mul_i32 s84,s29,2560
s_add_u32 s84,s84,s82
s_lshl_b32 s83,s28,19
s_lshr_b32 s60,s29,1
s_lshl_b32 s61,s60,14
s_add_u32 s83,s83,s61
s_and_b32 s61,s29,1
s_mul_i32 s62,s61,2560
s_add_u32 s83,s83,s62
s_add_u32 s83,s83,10485760
s_lshl_b32 s85,s60,7
s_lshl_b32 s61,s61,2
s_add_u32 s61,s61,s46
s_lshl_b32 s61,s61,2
s_add_u32 s85,s85,s61
s_add_u32 s85,s85,s82
s_add_u32 s85,s85,950272
s_mul_i32 s33,s46,12288
s_add_u32 s33,s33,s82
s_add_u32 s33,s33,163840
s_mov_b32 s35,0
s_add_u32 s35,s35,s82
s_add_u32 s35,s35,951296
s_cmp_eq_u32 s28,0
s_cselect_b32 s63,0xffff0000,0
s_waitcnt vmcnt(0)
v_lshlrev_b32 v36,16,v32
v_and_b32 v36,s63,v36
v_and_b32 v37,s63,v32
v_lshlrev_b32 v38,16,v33
v_and_b32 v38,s63,v38
v_and_b32 v39,s63,v33
v_mov_b32 v40,-1
v_mov_b32 v41,-1
v_mov_b32 v42,-1
v_mov_b32 v43,-1
v_mov_b32 v44,1
s_mov_b64 exec,s[88:89]
s_add_u32 s60,s83,0
buffer_store_dwordx4 v[36:39],v9,s[8:11],s60 offen sc1
s_add_u32 s60,s83,8192
buffer_store_dwordx4 v[36:39],v9,s[8:11],s60 offen sc1
s_add_u32 s60,s83,65536
buffer_store_dwordx4 v[40:43],v9,s[8:11],s60 offen sc1
s_add_u32 s60,s83,73728
buffer_store_dwordx4 v[40:43],v9,s[8:11],s60 offen sc1
s_add_u32 s60,s83,131072
buffer_store_dwordx4 v[40:43],v9,s[8:11],s60 offen sc1
s_add_u32 s60,s83,139264
buffer_store_dwordx4 v[40:43],v9,s[8:11],s60 offen sc1
s_add_u32 s60,s83,196608
buffer_store_dwordx4 v[40:43],v9,s[8:11],s60 offen sc1
s_add_u32 s60,s83,204800
buffer_store_dwordx4 v[40:43],v9,s[8:11],s60 offen sc1
s_add_u32 s60,s83,262144
buffer_store_dwordx4 v[36:39],v9,s[8:11],s60 offen sc1
s_add_u32 s60,s83,270336
buffer_store_dwordx4 v[36:39],v9,s[8:11],s60 offen sc1
s_add_u32 s60,s83,327680
buffer_store_dwordx4 v[40:43],v9,s[8:11],s60 offen sc1
s_add_u32 s60,s83,335872
buffer_store_dwordx4 v[40:43],v9,s[8:11],s60 offen sc1
s_add_u32 s60,s83,393216
buffer_store_dwordx4 v[40:43],v9,s[8:11],s60 offen sc1
s_add_u32 s60,s83,401408
buffer_store_dwordx4 v[40:43],v9,s[8:11],s60 offen sc1
s_add_u32 s60,s83,458752
buffer_store_dwordx4 v[40:43],v9,s[8:11],s60 offen sc1
s_add_u32 s60,s83,466944
buffer_store_dwordx4 v[40:43],v9,s[8:11],s60 offen sc1
s_cmp_lg_u32 s49,0
s_cbranch_scc1 ls_169
s_add_u32 s60,s84,0
buffer_store_dwordx4 v[36:39],v9,s[8:11],s60 offen
buffer_load_dword v45,v9,s[8:11],s60 offen sc1
s_add_u32 s60,s84,20480
buffer_store_dwordx4 v[40:43],v9,s[8:11],s60 offen
buffer_load_dword v45,v9,s[8:11],s60 offen sc1
s_add_u32 s60,s84,40960
buffer_store_dwordx4 v[40:43],v9,s[8:11],s60 offen
buffer_load_dword v45,v9,s[8:11],s60 offen sc1
s_add_u32 s60,s84,61440
buffer_store_dwordx4 v[40:43],v9,s[8:11],s60 offen
buffer_load_dword v45,v9,s[8:11],s60 offen sc1
s_add_u32 s60,s84,81920
buffer_store_dwordx4 v[36:39],v9,s[8:11],s60 offen
buffer_load_dword v45,v9,s[8:11],s60 offen sc1
s_add_u32 s60,s84,102400
buffer_store_dwordx4 v[40:43],v9,s[8:11],s60 offen
buffer_load_dword v45,v9,s[8:11],s60 offen sc1
s_add_u32 s60,s84,122880
buffer_store_dwordx4 v[40:43],v9,s[8:11],s60 offen
buffer_load_dword v45,v9,s[8:11],s60 offen sc1
s_add_u32 s60,s84,143360
buffer_store_dwordx4 v[40:43],v9,s[8:11],s60 offen
buffer_load_dword v45,v9,s[8:11],s60 offen sc1
s_mov_b64 exec,1
buffer_store_dword v44,v1,s[8:11],s85 offen
buffer_store_dword v44,v1,s[8:11],s85 offen offset:512
s_branch ls_170
ls_169:
s_add_u32 s60,s84,0
buffer_store_dwordx4 v[36:39],v9,s[8:11],s60 offen sc1
buffer_load_dword v45,v9,s[8:11],s60 offen sc1
s_add_u32 s60,s84,20480
buffer_store_dwordx4 v[40:43],v9,s[8:11],s60 offen sc1
buffer_load_dword v45,v9,s[8:11],s60 offen sc1
s_add_u32 s60,s84,40960
buffer_store_dwordx4 v[40:43],v9,s[8:11],s60 offen sc1
buffer_load_dword v45,v9,s[8:11],s60 offen sc1
s_add_u32 s60,s84,61440
buffer_store_dwordx4 v[40:43],v9,s[8:11],s60 offen sc1
buffer_load_dword v45,v9,s[8:11],s60 offen sc1
s_add_u32 s60,s84,81920
buffer_store_dwordx4 v[36:39],v9,s[8:11],s60 offen sc1
buffer_load_dword v45,v9,s[8:11],s60 offen sc1
s_add_u32 s60,s84,102400
buffer_store_dwordx4 v[40:43],v9,s[8:11],s60 offen sc1
buffer_load_dword v45,v9,s[8:11],s60 offen sc1
s_add_u32 s60,s84,122880
buffer_store_dwordx4 v[40:43],v9,s[8:11],s60 offen sc1
buffer_load_dword v45,v9,s[8:11],s60 offen sc1
s_add_u32 s60,s84,143360
buffer_store_dwordx4 v[40:43],v9,s[8:11],s60 offen sc1
buffer_load_dword v45,v9,s[8:11],s60 offen sc1
s_mov_b64 exec,1
buffer_store_dword v44,v1,s[8:11],s85 offen sc1
buffer_store_dword v44,v1,s[8:11],s85 offen offset:512 sc1
ls_170:
s_mov_b64 exec,-1
s_waitcnt vmcnt(0)
s_barrier
s_cmp_lg_u32 s46,0
s_cbranch_scc1 arr_171
v_mov_b32 v12,1
s_lshl_b32 s3,s49,2
v_mov_b32 v13,s3
s_mov_b64 exec,1
buffer_atomic_add v12,v13,s[12:15],0 offen sc1
s_mov_b64 exec,-1
arr_171:
s_mov_b32 s4,s26
s_mov_b32 s5,s27
s_mov_b32 s6,7864320
s_mov_b32 s7,0x20000
s_lshl_b32 s60,s28,2
s_add_u32 s60,s60,s46
s_mul_i32 s73,s60,983040
s_mul_i32 s60,s29,160
s_add_u32 s73,s73,s60
s_mul_i32 s74,s46,40960
v_add_u32 v12,0,v0
v_mul_u32_u24 v13,6554,v12
v_lshrrev_b32 v13,16,v13
v_mul_u32_u24 v16,10,v13
v_sub_u32 v12,v12,v16
v_mul_u32_u24 v20,1280,v13
v_lshl_add_u32 v20,v12,4,v20
v_add_u32 v12,64,v0
v_mul_u32_u24 v13,6554,v12
v_lshrrev_b32 v13,16,v13
v_mul_u32_u24 v16,10,v13
v_sub_u32 v12,v12,v16
v_mul_u32_u24 v21,1280,v13
v_lshl_add_u32 v21,v12,4,v21
v_add_u32 v12,128,v0
v_mul_u32_u24 v13,6554,v12
v_lshrrev_b32 v13,16,v13
v_mul_u32_u24 v16,10,v13
v_sub_u32 v12,v12,v16
v_mul_u32_u24 v22,1280,v13
v_lshl_add_u32 v22,v12,4,v22
v_add_u32 v12,192,v0
v_mul_u32_u24 v13,6554,v12
v_lshrrev_b32 v13,16,v13
v_mul_u32_u24 v16,10,v13
v_sub_u32 v12,v12,v16
v_mul_u32_u24 v23,1280,v13
v_lshl_add_u32 v23,v12,4,v23
v_add_u32 v12,256,v0
v_mul_u32_u24 v13,6554,v12
v_lshrrev_b32 v13,16,v13
v_mul_u32_u24 v16,10,v13
v_sub_u32 v12,v12,v16
v_mul_u32_u24 v24,1280,v13
v_lshl_add_u32 v24,v12,4,v24
v_add_u32 v12,320,v0
v_mul_u32_u24 v13,6554,v12
v_lshrrev_b32 v13,16,v13
v_mul_u32_u24 v16,10,v13
v_sub_u32 v12,v12,v16
v_mul_u32_u24 v25,1280,v13
v_lshl_add_u32 v25,v12,4,v25
v_add_u32 v12,384,v0
v_mul_u32_u24 v13,6554,v12
v_lshrrev_b32 v13,16,v13
v_mul_u32_u24 v16,10,v13
v_sub_u32 v12,v12,v16
v_mul_u32_u24 v26,1280,v13
v_lshl_add_u32 v26,v12,4,v26
v_add_u32 v12,448,v0
v_mul_u32_u24 v13,6554,v12
v_lshrrev_b32 v13,16,v13
v_mul_u32_u24 v16,10,v13
v_sub_u32 v12,v12,v16
v_mul_u32_u24 v27,1280,v13
v_lshl_add_u32 v27,v12,4,v27
v_add_u32 v12,512,v0
v_mul_u32_u24 v13,6554,v12
v_lshrrev_b32 v13,16,v13
v_mul_u32_u24 v16,10,v13
v_sub_u32 v12,v12,v16
v_mul_u32_u24 v28,1280,v13
v_lshl_add_u32 v28,v12,4,v28
v_add_u32 v12,576,v0
v_mul_u32_u24 v13,6554,v12
v_lshrrev_b32 v13,16,v13
v_mul_u32_u24 v16,10,v13
v_sub_u32 v12,v12,v16
v_mul_u32_u24 v29,1280,v13
v_lshl_add_u32 v29,v12,4,v29
v_lshrrev_b32 v14,4,v0
v_and_b32 v12,1,v14
v_lshlrev_b32 v12,5,v12
v_lshrrev_b32 v13,1,v14
v_lshl_add_u32 v12,v13,2,v12
v_bfe_u32 v13,v0,2,1
v_add_u32 v12,v12,v13
v_bfe_u32 v13,v0,3,1
v_lshl_add_u32 v12,v13,4,v12
v_mul_u32_u24 v30,160,v12
v_and_b32 v13,3,v0
v_lshl_add_u32 v30,v13,3,v30
v_add_u32 v30,s74,v30
s_add_u32 s61,s73,0
s_add_u32 m0,s74,0
s_nop 0
buffer_load_dwordx4 v20,s[4:7],s61 offen lds
s_add_u32 m0,s74,1024
s_nop 0
buffer_load_dwordx4 v21,s[4:7],s61 offen lds
s_add_u32 m0,s74,2048
s_nop 0
buffer_load_dwordx4 v22,s[4:7],s61 offen lds
s_add_u32 m0,s74,3072
s_nop 0
buffer_load_dwordx4 v23,s[4:7],s61 offen lds
s_add_u32 m0,s74,4096
s_nop 0
buffer_load_dwordx4 v24,s[4:7],s61 offen lds
s_add_u32 m0,s74,5120
s_nop 0
buffer_load_dwordx4 v25,s[4:7],s61 offen lds
s_add_u32 m0,s74,6144
s_nop 0
buffer_load_dwordx4 v26,s[4:7],s61 offen lds
s_add_u32 m0,s74,7168
s_nop 0
buffer_load_dwordx4 v27,s[4:7],s61 offen lds
s_add_u32 m0,s74,8192
s_nop 0
buffer_load_dwordx4 v28,s[4:7],s61 offen lds
s_add_u32 m0,s74,9216
s_nop 0
buffer_load_dwordx4 v29,s[4:7],s61 offen lds
s_add_u32 s61,s73,81920
s_add_u32 m0,s74,10240
s_nop 0
buffer_load_dwordx4 v20,s[4:7],s61 offen lds
s_add_u32 m0,s74,11264
s_nop 0
buffer_load_dwordx4 v21,s[4:7],s61 offen lds
s_add_u32 m0,s74,12288
s_nop 0
buffer_load_dwordx4 v22,s[4:7],s61 offen lds
s_add_u32 m0,s74,13312
s_nop 0
buffer_load_dwordx4 v23,s[4:7],s61 offen lds
s_add_u32 m0,s74,14336
s_nop 0
buffer_load_dwordx4 v24,s[4:7],s61 offen lds
s_add_u32 m0,s74,15360
s_nop 0
buffer_load_dwordx4 v25,s[4:7],s61 offen lds
s_add_u32 m0,s74,16384
s_nop 0
buffer_load_dwordx4 v26,s[4:7],s61 offen lds
s_add_u32 m0,s74,17408
s_nop 0
buffer_load_dwordx4 v27,s[4:7],s61 offen lds
s_add_u32 m0,s74,18432
s_nop 0
buffer_load_dwordx4 v28,s[4:7],s61 offen lds
s_add_u32 m0,s74,19456
s_nop 0
buffer_load_dwordx4 v29,s[4:7],s61 offen lds
s_add_u32 s61,s73,163840
s_add_u32 m0,s74,20480
s_nop 0
buffer_load_dwordx4 v20,s[4:7],s61 offen lds
s_add_u32 m0,s74,21504
s_nop 0
buffer_load_dwordx4 v21,s[4:7],s61 offen lds
s_add_u32 m0,s74,22528
s_nop 0
buffer_load_dwordx4 v22,s[4:7],s61 offen lds
s_add_u32 m0,s74,23552
s_nop 0
buffer_load_dwordx4 v23,s[4:7],s61 offen lds
s_add_u32 m0,s74,24576
s_nop 0
buffer_load_dwordx4 v24,s[4:7],s61 offen lds
s_add_u32 m0,s74,25600
s_nop 0
buffer_load_dwordx4 v25,s[4:7],s61 offen lds
s_add_u32 m0,s74,26624
s_nop 0
buffer_load_dwordx4 v26,s[4:7],s61 offen lds
s_add_u32 m0,s74,27648
s_nop 0
buffer_load_dwordx4 v27,s[4:7],s61 offen lds
s_add_u32 m0,s74,28672
s_nop 0
buffer_load_dwordx4 v28,s[4:7],s61 offen lds
s_add_u32 m0,s74,29696
s_nop 0
buffer_load_dwordx4 v29,s[4:7],s61 offen lds
s_add_u32 s61,s73,245760
s_add_u32 m0,s74,30720
s_nop 0
buffer_load_dwordx4 v20,s[4:7],s61 offen lds
s_add_u32 m0,s74,31744
s_nop 0
buffer_load_dwordx4 v21,s[4:7],s61 offen lds
s_add_u32 m0,s74,32768
s_nop 0
buffer_load_dwordx4 v22,s[4:7],s61 offen lds
s_add_u32 m0,s74,33792
s_nop 0
buffer_load_dwordx4 v23,s[4:7],s61 offen lds
s_add_u32 m0,s74,34816
s_nop 0
buffer_load_dwordx4 v24,s[4:7],s61 offen lds
s_add_u32 m0,s74,35840
s_nop 0
buffer_load_dwordx4 v25,s[4:7],s61 offen lds
s_add_u32 m0,s74,36864
s_nop 0
buffer_load_dwordx4 v26,s[4:7],s61 offen lds
s_add_u32 m0,s74,37888
s_nop 0
buffer_load_dwordx4 v27,s[4:7],s61 offen lds
s_add_u32 m0,s74,38912
s_nop 0
buffer_load_dwordx4 v28,s[4:7],s61 offen lds
s_add_u32 m0,s74,39936
s_nop 0
buffer_load_dwordx4 v29,s[4:7],s61 offen lds
s_waitcnt vmcnt(30)
ds_read_b64_tr_b16 a[0:1],v30 offset:0
ds_read_b64_tr_b16 a[2:3],v30 offset:320
ds_read_b64_tr_b16 a[4:5],v30 offset:1280
ds_read_b64_tr_b16 a[6:7],v30 offset:1600
ds_read_b64_tr_b16 a[8:9],v30 offset:32
ds_read_b64_tr_b16 a[10:11],v30 offset:352
ds_read_b64_tr_b16 a[12:13],v30 offset:1312
ds_read_b64_tr_b16 a[14:15],v30 offset:1632
ds_read_b64_tr_b16 a[16:17],v30 offset:64
ds_read_b64_tr_b16 a[18:19],v30 offset:384
ds_read_b64_tr_b16 a[20:21],v30 offset:1344
ds_read_b64_tr_b16 a[22:23],v30 offset:1664
s_waitcnt lgkmcnt(4)
ds_read_b64_tr_b16 a[24:25],v30 offset:96
ds_read_b64_tr_b16 a[26:27],v30 offset:416
ds_read_b64_tr_b16 a[28:29],v30 offset:1376
ds_read_b64_tr_b16 a[30:31],v30 offset:1696
ds_read_b64_tr_b16 v[32:33],v30 offset:128
ds_read_b64_tr_b16 v[34:35],v30 offset:448
ds_read_b64_tr_b16 v[36:37],v30 offset:1408
ds_read_b64_tr_b16 v[38:39],v30 offset:1728
s_waitcnt lgkmcnt(0)
s_add_u32 s61,s73,327680
s_add_u32 m0,s74,0
s_nop 0
buffer_load_dwordx4 v20,s[4:7],s61 offen lds
s_add_u32 m0,s74,1024
s_nop 0
buffer_load_dwordx4 v21,s[4:7],s61 offen lds
s_add_u32 m0,s74,2048
s_nop 0
buffer_load_dwordx4 v22,s[4:7],s61 offen lds
s_add_u32 m0,s74,3072
s_nop 0
buffer_load_dwordx4 v23,s[4:7],s61 offen lds
s_add_u32 m0,s74,4096
s_nop 0
buffer_load_dwordx4 v24,s[4:7],s61 offen lds
s_add_u32 m0,s74,5120
s_nop 0
buffer_load_dwordx4 v25,s[4:7],s61 offen lds
s_add_u32 m0,s74,6144
s_nop 0
buffer_load_dwordx4 v26,s[4:7],s61 offen lds
s_add_u32 m0,s74,7168
s_nop 0
buffer_load_dwordx4 v27,s[4:7],s61 offen lds
s_add_u32 m0,s74,8192
s_nop 0
buffer_load_dwordx4 v28,s[4:7],s61 offen lds
s_add_u32 m0,s74,9216
s_nop 0
buffer_load_dwordx4 v29,s[4:7],s61 offen lds
s_waitcnt vmcnt(30)
ds_read_b64_tr_b16 a[32:33],v30 offset:10240
ds_read_b64_tr_b16 a[34:35],v30 offset:10560
ds_read_b64_tr_b16 a[36:37],v30 offset:11520
ds_read_b64_tr_b16 a[38:39],v30 offset:11840
ds_read_b64_tr_b16 a[40:41],v30 offset:10272
ds_read_b64_tr_b16 a[42:43],v30 offset:10592
ds_read_b64_tr_b16 a[44:45],v30 offset:11552
ds_read_b64_tr_b16 a[46:47],v30 offset:11872
ds_read_b64_tr_b16 a[48:49],v30 offset:10304
ds_read_b64_tr_b16 a[50:51],v30 offset:10624
ds_read_b64_tr_b16 a[52:53],v30 offset:11584
ds_read_b64_tr_b16 a[54:55],v30 offset:11904
s_waitcnt lgkmcnt(4)
ds_read_b64_tr_b16 a[56:57],v30 offset:10336
ds_read_b64_tr_b16 a[58:59],v30 offset:10656
ds_read_b64_tr_b16 a[60:61],v30 offset:11616
ds_read_b64_tr_b16 a[62:63],v30 offset:11936
ds_read_b64_tr_b16 v[40:41],v30 offset:10368
ds_read_b64_tr_b16 v[42:43],v30 offset:10688
ds_read_b64_tr_b16 v[44:45],v30 offset:11648
ds_read_b64_tr_b16 v[46:47],v30 offset:11968
s_waitcnt lgkmcnt(0)
s_add_u32 s61,s73,409600
s_add_u32 m0,s74,10240
s_nop 0
buffer_load_dwordx4 v20,s[4:7],s61 offen lds
s_add_u32 m0,s74,11264
s_nop 0
buffer_load_dwordx4 v21,s[4:7],s61 offen lds
s_add_u32 m0,s74,12288
s_nop 0
buffer_load_dwordx4 v22,s[4:7],s61 offen lds
s_add_u32 m0,s74,13312
s_nop 0
buffer_load_dwordx4 v23,s[4:7],s61 offen lds
s_add_u32 m0,s74,14336
s_nop 0
buffer_load_dwordx4 v24,s[4:7],s61 offen lds
s_add_u32 m0,s74,15360
s_nop 0
buffer_load_dwordx4 v25,s[4:7],s61 offen lds
s_add_u32 m0,s74,16384
s_nop 0
buffer_load_dwordx4 v26,s[4:7],s61 offen lds
s_add_u32 m0,s74,17408
s_nop 0
buffer_load_dwordx4 v27,s[4:7],s61 offen lds
s_add_u32 m0,s74,18432
s_nop 0
buffer_load_dwordx4 v28,s[4:7],s61 offen lds
s_add_u32 m0,s74,19456
s_nop 0
buffer_load_dwordx4 v29,s[4:7],s61 offen lds
s_waitcnt vmcnt(30)
ds_read_b64_tr_b16 a[64:65],v30 offset:20480
ds_read_b64_tr_b16 a[66:67],v30 offset:20800
ds_read_b64_tr_b16 a[68:69],v30 offset:21760
ds_read_b64_tr_b16 a[70:71],v30 offset:22080
ds_read_b64_tr_b16 a[72:73],v30 offset:20512
ds_read_b64_tr_b16 a[74:75],v30 offset:20832
ds_read_b64_tr_b16 a[76:77],v30 offset:21792
ds_read_b64_tr_b16 a[78:79],v30 offset:22112
ds_read_b64_tr_b16 a[80:81],v30 offset:20544
ds_read_b64_tr_b16 a[82:83],v30 offset:20864
ds_read_b64_tr_b16 a[84:85],v30 offset:21824
ds_read_b64_tr_b16 a[86:87],v30 offset:22144
s_waitcnt lgkmcnt(4)
ds_read_b64_tr_b16 a[88:89],v30 offset:20576
ds_read_b64_tr_b16 a[90:91],v30 offset:20896
ds_read_b64_tr_b16 a[92:93],v30 offset:21856
ds_read_b64_tr_b16 a[94:95],v30 offset:22176
ds_read_b64_tr_b16 v[48:49],v30 offset:20608
ds_read_b64_tr_b16 v[50:51],v30 offset:20928
ds_read_b64_tr_b16 v[52:53],v30 offset:21888
ds_read_b64_tr_b16 v[54:55],v30 offset:22208
s_waitcnt lgkmcnt(0)
s_add_u32 s61,s73,491520
s_add_u32 m0,s74,20480
s_nop 0
buffer_load_dwordx4 v20,s[4:7],s61 offen lds
s_add_u32 m0,s74,21504
s_nop 0
buffer_load_dwordx4 v21,s[4:7],s61 offen lds
s_add_u32 m0,s74,22528
s_nop 0
buffer_load_dwordx4 v22,s[4:7],s61 offen lds
s_add_u32 m0,s74,23552
s_nop 0
buffer_load_dwordx4 v23,s[4:7],s61 offen lds
s_add_u32 m0,s74,24576
s_nop 0
buffer_load_dwordx4 v24,s[4:7],s61 offen lds
s_add_u32 m0,s74,25600
s_nop 0
buffer_load_dwordx4 v25,s[4:7],s61 offen lds
s_add_u32 m0,s74,26624
s_nop 0
buffer_load_dwordx4 v26,s[4:7],s61 offen lds
s_add_u32 m0,s74,27648
s_nop 0
buffer_load_dwordx4 v27,s[4:7],s61 offen lds
s_add_u32 m0,s74,28672
s_nop 0
buffer_load_dwordx4 v28,s[4:7],s61 offen lds
s_add_u32 m0,s74,29696
s_nop 0
buffer_load_dwordx4 v29,s[4:7],s61 offen lds
s_waitcnt vmcnt(30)
ds_read_b64_tr_b16 a[96:97],v30 offset:30720
ds_read_b64_tr_b16 a[98:99],v30 offset:31040
ds_read_b64_tr_b16 a[100:101],v30 offset:32000
ds_read_b64_tr_b16 a[102:103],v30 offset:32320
ds_read_b64_tr_b16 a[104:105],v30 offset:30752
ds_read_b64_tr_b16 a[106:107],v30 offset:31072
ds_read_b64_tr_b16 a[108:109],v30 offset:32032
ds_read_b64_tr_b16 a[110:111],v30 offset:32352
ds_read_b64_tr_b16 a[112:113],v30 offset:30784
ds_read_b64_tr_b16 a[114:115],v30 offset:31104
ds_read_b64_tr_b16 a[116:117],v30 offset:32064
ds_read_b64_tr_b16 a[118:119],v30 offset:32384
s_waitcnt lgkmcnt(4)
ds_read_b64_tr_b16 a[120:121],v30 offset:30816
ds_read_b64_tr_b16 a[122:123],v30 offset:31136
ds_read_b64_tr_b16 a[124:125],v30 offset:32096
ds_read_b64_tr_b16 a[126:127],v30 offset:32416
ds_read_b64_tr_b16 v[56:57],v30 offset:30848
ds_read_b64_tr_b16 v[58:59],v30 offset:31168
ds_read_b64_tr_b16 v[60:61],v30 offset:32128
ds_read_b64_tr_b16 v[62:63],v30 offset:32448
s_waitcnt lgkmcnt(0)
s_add_u32 s61,s73,573440
s_add_u32 m0,s74,30720
s_nop 0
buffer_load_dwordx4 v20,s[4:7],s61 offen lds
s_add_u32 m0,s74,31744
s_nop 0
buffer_load_dwordx4 v21,s[4:7],s61 offen lds
s_add_u32 m0,s74,32768
s_nop 0
buffer_load_dwordx4 v22,s[4:7],s61 offen lds
s_add_u32 m0,s74,33792
s_nop 0
buffer_load_dwordx4 v23,s[4:7],s61 offen lds
s_add_u32 m0,s74,34816
s_nop 0
buffer_load_dwordx4 v24,s[4:7],s61 offen lds
s_add_u32 m0,s74,35840
s_nop 0
buffer_load_dwordx4 v25,s[4:7],s61 offen lds
s_add_u32 m0,s74,36864
s_nop 0
buffer_load_dwordx4 v26,s[4:7],s61 offen lds
s_add_u32 m0,s74,37888
s_nop 0
buffer_load_dwordx4 v27,s[4:7],s61 offen lds
s_add_u32 m0,s74,38912
s_nop 0
buffer_load_dwordx4 v28,s[4:7],s61 offen lds
s_add_u32 m0,s74,39936
s_nop 0
buffer_load_dwordx4 v29,s[4:7],s61 offen lds
s_waitcnt vmcnt(30)
ds_read_b64_tr_b16 a[128:129],v30 offset:0
ds_read_b64_tr_b16 a[130:131],v30 offset:320
ds_read_b64_tr_b16 a[132:133],v30 offset:1280
ds_read_b64_tr_b16 a[134:135],v30 offset:1600
ds_read_b64_tr_b16 a[136:137],v30 offset:32
ds_read_b64_tr_b16 a[138:139],v30 offset:352
ds_read_b64_tr_b16 a[140:141],v30 offset:1312
ds_read_b64_tr_b16 a[142:143],v30 offset:1632
ds_read_b64_tr_b16 a[144:145],v30 offset:64
ds_read_b64_tr_b16 a[146:147],v30 offset:384
ds_read_b64_tr_b16 a[148:149],v30 offset:1344
ds_read_b64_tr_b16 a[150:151],v30 offset:1664
s_waitcnt lgkmcnt(4)
ds_read_b64_tr_b16 a[152:153],v30 offset:96
ds_read_b64_tr_b16 a[154:155],v30 offset:416
ds_read_b64_tr_b16 a[156:157],v30 offset:1376
ds_read_b64_tr_b16 a[158:159],v30 offset:1696
ds_read_b64_tr_b16 v[64:65],v30 offset:128
ds_read_b64_tr_b16 v[66:67],v30 offset:448
ds_read_b64_tr_b16 v[68:69],v30 offset:1408
ds_read_b64_tr_b16 v[70:71],v30 offset:1728
s_waitcnt lgkmcnt(0)
s_add_u32 s61,s73,655360
s_add_u32 m0,s74,0
s_nop 0
buffer_load_dwordx4 v20,s[4:7],s61 offen lds
s_add_u32 m0,s74,1024
s_nop 0
buffer_load_dwordx4 v21,s[4:7],s61 offen lds
s_add_u32 m0,s74,2048
s_nop 0
buffer_load_dwordx4 v22,s[4:7],s61 offen lds
s_add_u32 m0,s74,3072
s_nop 0
buffer_load_dwordx4 v23,s[4:7],s61 offen lds
s_add_u32 m0,s74,4096
s_nop 0
buffer_load_dwordx4 v24,s[4:7],s61 offen lds
s_add_u32 m0,s74,5120
s_nop 0
buffer_load_dwordx4 v25,s[4:7],s61 offen lds
s_add_u32 m0,s74,6144
s_nop 0
buffer_load_dwordx4 v26,s[4:7],s61 offen lds
s_add_u32 m0,s74,7168
s_nop 0
buffer_load_dwordx4 v27,s[4:7],s61 offen lds
s_add_u32 m0,s74,8192
s_nop 0
buffer_load_dwordx4 v28,s[4:7],s61 offen lds
s_add_u32 m0,s74,9216
s_nop 0
buffer_load_dwordx4 v29,s[4:7],s61 offen lds
s_waitcnt vmcnt(30)
ds_read_b64_tr_b16 a[160:161],v30 offset:10240
ds_read_b64_tr_b16 a[162:163],v30 offset:10560
ds_read_b64_tr_b16 a[164:165],v30 offset:11520
ds_read_b64_tr_b16 a[166:167],v30 offset:11840
ds_read_b64_tr_b16 a[168:169],v30 offset:10272
ds_read_b64_tr_b16 a[170:171],v30 offset:10592
ds_read_b64_tr_b16 a[172:173],v30 offset:11552
ds_read_b64_tr_b16 a[174:175],v30 offset:11872
ds_read_b64_tr_b16 a[176:177],v30 offset:10304
ds_read_b64_tr_b16 a[178:179],v30 offset:10624
ds_read_b64_tr_b16 a[180:181],v30 offset:11584
ds_read_b64_tr_b16 a[182:183],v30 offset:11904
s_waitcnt lgkmcnt(4)
ds_read_b64_tr_b16 a[184:185],v30 offset:10336
ds_read_b64_tr_b16 a[186:187],v30 offset:10656
ds_read_b64_tr_b16 a[188:189],v30 offset:11616
ds_read_b64_tr_b16 a[190:191],v30 offset:11936
ds_read_b64_tr_b16 v[72:73],v30 offset:10368
ds_read_b64_tr_b16 v[74:75],v30 offset:10688
ds_read_b64_tr_b16 v[76:77],v30 offset:11648
ds_read_b64_tr_b16 v[78:79],v30 offset:11968
s_waitcnt lgkmcnt(0)
s_add_u32 s61,s73,737280
s_add_u32 m0,s74,10240
s_nop 0
buffer_load_dwordx4 v20,s[4:7],s61 offen lds
s_add_u32 m0,s74,11264
s_nop 0
buffer_load_dwordx4 v21,s[4:7],s61 offen lds
s_add_u32 m0,s74,12288
s_nop 0
buffer_load_dwordx4 v22,s[4:7],s61 offen lds
s_add_u32 m0,s74,13312
s_nop 0
buffer_load_dwordx4 v23,s[4:7],s61 offen lds
s_add_u32 m0,s74,14336
s_nop 0
buffer_load_dwordx4 v24,s[4:7],s61 offen lds
s_add_u32 m0,s74,15360
s_nop 0
buffer_load_dwordx4 v25,s[4:7],s61 offen lds
s_add_u32 m0,s74,16384
s_nop 0
buffer_load_dwordx4 v26,s[4:7],s61 offen lds
s_add_u32 m0,s74,17408
s_nop 0
buffer_load_dwordx4 v27,s[4:7],s61 offen lds
s_add_u32 m0,s74,18432
s_nop 0
buffer_load_dwordx4 v28,s[4:7],s61 offen lds
s_add_u32 m0,s74,19456
s_nop 0
buffer_load_dwordx4 v29,s[4:7],s61 offen lds
s_waitcnt vmcnt(30)
ds_read_b64_tr_b16 a[192:193],v30 offset:20480
ds_read_b64_tr_b16 a[194:195],v30 offset:20800
ds_read_b64_tr_b16 a[196:197],v30 offset:21760
ds_read_b64_tr_b16 a[198:199],v30 offset:22080
ds_read_b64_tr_b16 a[200:201],v30 offset:20512
ds_read_b64_tr_b16 a[202:203],v30 offset:20832
ds_read_b64_tr_b16 a[204:205],v30 offset:21792
ds_read_b64_tr_b16 a[206:207],v30 offset:22112
ds_read_b64_tr_b16 a[208:209],v30 offset:20544
ds_read_b64_tr_b16 a[210:211],v30 offset:20864
ds_read_b64_tr_b16 a[212:213],v30 offset:21824
ds_read_b64_tr_b16 a[214:215],v30 offset:22144
s_waitcnt lgkmcnt(4)
ds_read_b64_tr_b16 a[216:217],v30 offset:20576
ds_read_b64_tr_b16 a[218:219],v30 offset:20896
ds_read_b64_tr_b16 a[220:221],v30 offset:21856
ds_read_b64_tr_b16 a[222:223],v30 offset:22176
ds_read_b64_tr_b16 v[80:81],v30 offset:20608
ds_read_b64_tr_b16 v[82:83],v30 offset:20928
ds_read_b64_tr_b16 v[84:85],v30 offset:21888
ds_read_b64_tr_b16 v[86:87],v30 offset:22208
s_waitcnt lgkmcnt(0)
s_add_u32 s61,s73,819200
s_add_u32 m0,s74,20480
s_nop 0
buffer_load_dwordx4 v20,s[4:7],s61 offen lds
s_add_u32 m0,s74,21504
s_nop 0
buffer_load_dwordx4 v21,s[4:7],s61 offen lds
s_add_u32 m0,s74,22528
s_nop 0
buffer_load_dwordx4 v22,s[4:7],s61 offen lds
s_add_u32 m0,s74,23552
s_nop 0
buffer_load_dwordx4 v23,s[4:7],s61 offen lds
s_add_u32 m0,s74,24576
s_nop 0
buffer_load_dwordx4 v24,s[4:7],s61 offen lds
s_add_u32 m0,s74,25600
s_nop 0
buffer_load_dwordx4 v25,s[4:7],s61 offen lds
s_add_u32 m0,s74,26624
s_nop 0
buffer_load_dwordx4 v26,s[4:7],s61 offen lds
s_add_u32 m0,s74,27648
s_nop 0
buffer_load_dwordx4 v27,s[4:7],s61 offen lds
s_add_u32 m0,s74,28672
s_nop 0
buffer_load_dwordx4 v28,s[4:7],s61 offen lds
s_add_u32 m0,s74,29696
s_nop 0
buffer_load_dwordx4 v29,s[4:7],s61 offen lds
s_waitcnt vmcnt(30)
ds_read_b64_tr_b16 a[224:225],v30 offset:30720
ds_read_b64_tr_b16 a[226:227],v30 offset:31040
ds_read_b64_tr_b16 a[228:229],v30 offset:32000
ds_read_b64_tr_b16 a[230:231],v30 offset:32320
ds_read_b64_tr_b16 a[232:233],v30 offset:30752
ds_read_b64_tr_b16 a[234:235],v30 offset:31072
ds_read_b64_tr_b16 a[236:237],v30 offset:32032
ds_read_b64_tr_b16 a[238:239],v30 offset:32352
ds_read_b64_tr_b16 a[240:241],v30 offset:30784
ds_read_b64_tr_b16 a[242:243],v30 offset:31104
ds_read_b64_tr_b16 a[244:245],v30 offset:32064
ds_read_b64_tr_b16 a[246:247],v30 offset:32384
s_waitcnt lgkmcnt(4)
ds_read_b64_tr_b16 a[248:249],v30 offset:30816
ds_read_b64_tr_b16 a[250:251],v30 offset:31136
ds_read_b64_tr_b16 a[252:253],v30 offset:32096
ds_read_b64_tr_b16 a[254:255],v30 offset:32416
ds_read_b64_tr_b16 v[88:89],v30 offset:30848
ds_read_b64_tr_b16 v[90:91],v30 offset:31168
ds_read_b64_tr_b16 v[92:93],v30 offset:32128
ds_read_b64_tr_b16 v[94:95],v30 offset:32448
s_waitcnt lgkmcnt(0)
s_add_u32 s61,s73,901120
s_add_u32 m0,s74,30720
s_nop 0
buffer_load_dwordx4 v20,s[4:7],s61 offen lds
s_add_u32 m0,s74,31744
s_nop 0
buffer_load_dwordx4 v21,s[4:7],s61 offen lds
s_add_u32 m0,s74,32768
s_nop 0
buffer_load_dwordx4 v22,s[4:7],s61 offen lds
s_add_u32 m0,s74,33792
s_nop 0
buffer_load_dwordx4 v23,s[4:7],s61 offen lds
s_add_u32 m0,s74,34816
s_nop 0
buffer_load_dwordx4 v24,s[4:7],s61 offen lds
s_add_u32 m0,s74,35840
s_nop 0
buffer_load_dwordx4 v25,s[4:7],s61 offen lds
s_add_u32 m0,s74,36864
s_nop 0
buffer_load_dwordx4 v26,s[4:7],s61 offen lds
s_add_u32 m0,s74,37888
s_nop 0
buffer_load_dwordx4 v27,s[4:7],s61 offen lds
s_add_u32 m0,s74,38912
s_nop 0
buffer_load_dwordx4 v28,s[4:7],s61 offen lds
s_add_u32 m0,s74,39936
s_nop 0
buffer_load_dwordx4 v29,s[4:7],s61 offen lds
s_waitcnt vmcnt(30)
ds_read_b64_tr_b16 v[128:129],v30 offset:0
ds_read_b64_tr_b16 v[130:131],v30 offset:320
ds_read_b64_tr_b16 v[132:133],v30 offset:1280
ds_read_b64_tr_b16 v[134:135],v30 offset:1600
ds_read_b64_tr_b16 v[136:137],v30 offset:32
ds_read_b64_tr_b16 v[138:139],v30 offset:352
ds_read_b64_tr_b16 v[140:141],v30 offset:1312
ds_read_b64_tr_b16 v[142:143],v30 offset:1632
ds_read_b64_tr_b16 v[144:145],v30 offset:64
ds_read_b64_tr_b16 v[146:147],v30 offset:384
ds_read_b64_tr_b16 v[148:149],v30 offset:1344
ds_read_b64_tr_b16 v[150:151],v30 offset:1664
s_waitcnt lgkmcnt(4)
ds_read_b64_tr_b16 v[152:153],v30 offset:96
ds_read_b64_tr_b16 v[154:155],v30 offset:416
ds_read_b64_tr_b16 v[156:157],v30 offset:1376
ds_read_b64_tr_b16 v[158:159],v30 offset:1696
ds_read_b64_tr_b16 v[96:97],v30 offset:128
ds_read_b64_tr_b16 v[98:99],v30 offset:448
ds_read_b64_tr_b16 v[100:101],v30 offset:1408
ds_read_b64_tr_b16 v[102:103],v30 offset:1728
s_waitcnt lgkmcnt(0)
s_waitcnt vmcnt(20)
ds_read_b64_tr_b16 v[160:161],v30 offset:10240
ds_read_b64_tr_b16 v[162:163],v30 offset:10560
ds_read_b64_tr_b16 v[164:165],v30 offset:11520
ds_read_b64_tr_b16 v[166:167],v30 offset:11840
ds_read_b64_tr_b16 v[168:169],v30 offset:10272
ds_read_b64_tr_b16 v[170:171],v30 offset:10592
ds_read_b64_tr_b16 v[172:173],v30 offset:11552
ds_read_b64_tr_b16 v[174:175],v30 offset:11872
ds_read_b64_tr_b16 v[176:177],v30 offset:10304
ds_read_b64_tr_b16 v[178:179],v30 offset:10624
ds_read_b64_tr_b16 v[180:181],v30 offset:11584
ds_read_b64_tr_b16 v[182:183],v30 offset:11904
s_waitcnt lgkmcnt(4)
ds_read_b64_tr_b16 v[184:185],v30 offset:10336
ds_read_b64_tr_b16 v[186:187],v30 offset:10656
ds_read_b64_tr_b16 v[188:189],v30 offset:11616
ds_read_b64_tr_b16 v[190:191],v30 offset:11936
ds_read_b64_tr_b16 v[104:105],v30 offset:10368
ds_read_b64_tr_b16 v[106:107],v30 offset:10688
ds_read_b64_tr_b16 v[108:109],v30 offset:11648
ds_read_b64_tr_b16 v[110:111],v30 offset:11968
s_waitcnt lgkmcnt(0)
s_waitcnt vmcnt(10)
ds_read_b64_tr_b16 v[192:193],v30 offset:20480
ds_read_b64_tr_b16 v[194:195],v30 offset:20800
ds_read_b64_tr_b16 v[196:197],v30 offset:21760
ds_read_b64_tr_b16 v[198:199],v30 offset:22080
ds_read_b64_tr_b16 v[200:201],v30 offset:20512
ds_read_b64_tr_b16 v[202:203],v30 offset:20832
ds_read_b64_tr_b16 v[204:205],v30 offset:21792
ds_read_b64_tr_b16 v[206:207],v30 offset:22112
ds_read_b64_tr_b16 v[208:209],v30 offset:20544
ds_read_b64_tr_b16 v[210:211],v30 offset:20864
ds_read_b64_tr_b16 v[212:213],v30 offset:21824
ds_read_b64_tr_b16 v[214:215],v30 offset:22144
s_waitcnt lgkmcnt(4)
ds_read_b64_tr_b16 v[216:217],v30 offset:20576
ds_read_b64_tr_b16 v[218:219],v30 offset:20896
ds_read_b64_tr_b16 v[220:221],v30 offset:21856
ds_read_b64_tr_b16 v[222:223],v30 offset:22176
ds_read_b64_tr_b16 v[112:113],v30 offset:20608
ds_read_b64_tr_b16 v[114:115],v30 offset:20928
ds_read_b64_tr_b16 v[116:117],v30 offset:21888
ds_read_b64_tr_b16 v[118:119],v30 offset:22208
s_waitcnt lgkmcnt(0)
s_waitcnt vmcnt(0)
ds_read_b64_tr_b16 v[224:225],v30 offset:30720
ds_read_b64_tr_b16 v[226:227],v30 offset:31040
ds_read_b64_tr_b16 v[228:229],v30 offset:32000
ds_read_b64_tr_b16 v[230:231],v30 offset:32320
ds_read_b64_tr_b16 v[232:233],v30 offset:30752
ds_read_b64_tr_b16 v[234:235],v30 offset:31072
ds_read_b64_tr_b16 v[236:237],v30 offset:32032
ds_read_b64_tr_b16 v[238:239],v30 offset:32352
ds_read_b64_tr_b16 v[240:241],v30 offset:30784
ds_read_b64_tr_b16 v[242:243],v30 offset:31104
ds_read_b64_tr_b16 v[244:245],v30 offset:32064
ds_read_b64_tr_b16 v[246:247],v30 offset:32384
s_waitcnt lgkmcnt(4)
ds_read_b64_tr_b16 v[248:249],v30 offset:30816
ds_read_b64_tr_b16 v[250:251],v30 offset:31136
ds_read_b64_tr_b16 v[252:253],v30 offset:32096
ds_read_b64_tr_b16 v[254:255],v30 offset:32416
ds_read_b64_tr_b16 v[120:121],v30 offset:30848
ds_read_b64_tr_b16 v[122:123],v30 offset:31168
ds_read_b64_tr_b16 v[124:125],v30 offset:32128
ds_read_b64_tr_b16 v[126:127],v30 offset:32448
s_waitcnt lgkmcnt(0)
s_barrier
ds_write_b128 v4,v[32:35] offset:0
ds_write_b128 v4,v[36:39] offset:1024
ds_write_b128 v4,v[40:43] offset:2048
ds_write_b128 v4,v[44:47] offset:3072
ds_write_b128 v4,v[48:51] offset:4096
ds_write_b128 v4,v[52:55] offset:5120
ds_write_b128 v4,v[56:59] offset:6144
ds_write_b128 v4,v[60:63] offset:7168
s_waitcnt lgkmcnt(0)
ds_write_b128 v4,v[64:67] offset:8192
ds_write_b128 v4,v[68:71] offset:9216
ds_write_b128 v4,v[72:75] offset:10240
ds_write_b128 v4,v[76:79] offset:11264
ds_write_b128 v4,v[80:83] offset:12288
ds_write_b128 v4,v[84:87] offset:13312
ds_write_b128 v4,v[88:91] offset:14336
ds_write_b128 v4,v[92:95] offset:15360
s_waitcnt lgkmcnt(0)
ds_write_b128 v4,v[96:99] offset:16384
ds_write_b128 v4,v[100:103] offset:17408
ds_write_b128 v4,v[104:107] offset:18432
ds_write_b128 v4,v[108:111] offset:19456
ds_write_b128 v4,v[112:115] offset:20480
ds_write_b128 v4,v[116:119] offset:21504
ds_write_b128 v4,v[120:123] offset:22528
ds_write_b128 v4,v[124:127] offset:23552
s_waitcnt lgkmcnt(0)
s_barrier
s_lshl_b32 s3,s49,2
v_mov_b32 v13,s3
s_nop 1
ibw_172:
buffer_load_dword v12,v13,s[12:15],0 offen sc1
s_waitcnt vmcnt(0)
v_cmp_ne_u32 vcc,256,v12
s_nop 0
s_cbranch_vccz ok_173
s_sleep 8
s_sub_u32 s47,s47,1
s_cbranch_scc1 ABORT
s_branch ibw_172
ok_173:
s_cmp_lg_u32 s49,0
s_cbranch_scc1 ibok_174
v_and_b32 v13,7,v0
v_lshlrev_b32 v13,2,v13
buffer_load_dword v12,v13,s[12:15],0 offen offset:32 sc1
s_waitcnt vmcnt(0)
v_cmp_ne_u32 vcc,32,v12
s_nop 0
s_cbranch_vccz ibok_174
s_barrier
s_mov_b32 s49,1
s_mov_b32 s3,s2
s_load_dwordx16 s[16:31],s[0:1],0
s_load_dwordx8 s[32:39],s[0:1],64
s_waitcnt lgkmcnt(0)
s_branch DISPATCH
ibok_174:
v_mov_b32 v13,192
buffer_load_dword v12,v13,s[12:15],0 offen sc1
s_waitcnt vmcnt(0)
v_readfirstlane_b32 s60,v12
s_cmp_gt_i32 s60,0
s_cselect_b32 s60,0x2000,0
s_add_u32 s83,s83,s60
s_mov_b32 s50,0
s_mov_b32 s77,0
s_cmp_lg_u32 s49,0
s_cbranch_scc1 CW_LOOP_S
CW_LOOP_F:
s_sub_u32 s60,s50,15
s_lshr_b32 s52,s60,1
s_and_b32 s51,s60,1
s_cmp_eq_u32 s51,0
s_cselect_b32 s61,15,0
s_add_u32 s52,s52,s61
s_sub_u32 s61,s60,49
s_cmp_ge_u32 s60,98
s_cselect_b32 s52,s61,s52
s_cselect_b32 s51,1,s51
s_cmp_lt_u32 s50,15
s_cselect_b32 s52,s50,s52
s_cselect_b32 s51,0,s51
s_cmp_eq_u32 s52,63
s_cbranch_scc1 CW_NEXT_F
s_add_u32 s58,s52,1
s_lshl_b32 s61,s51,9
s_add_u32 s72,s61,s35
s_add_u32 s69,s61,s85
s_lshl_b32 s61,s51,2
s_and_b32 s60,s52,3
s_add_u32 s60,s60,s61
s_mul_i32 s70,s60,49152
s_add_u32 s70,s70,s33
s_add_u32 s71,s70,4096
s_add_u32 s80,s70,8192
s_bfe_u32 s57,s52,0x10002
s_bfe_u32 s31,s58,0x10002
s_and_b32 s60,s58,3
s_add_u32 s60,s60,s61
s_mul_i32 s59,s60,20480
s_add_u32 s59,s59,s84
s_lshl_b32 s68,s60,16
s_add_u32 s68,s68,s83
s_xor_b32 s77,s77,11264
v_add_u32 v7,s77,v5
v_add_u32 v8,s77,v6
s_add_u32 s60,s52,2
v_mov_b32 v16,s60
v_mov_b32 v80,0
v_mov_b32 v81,0
v_mov_b32 v82,0
v_mov_b32 v83,0
v_mov_b32 v84,0
v_mov_b32 v85,0
v_mov_b32 v86,0
v_mov_b32 v87,0
v_mov_b32 v88,0
v_mov_b32 v89,0
v_mov_b32 v90,0
v_mov_b32 v91,0
v_mov_b32 v92,0
v_mov_b32 v93,0
v_mov_b32 v94,0
v_mov_b32 v95,0
v_mov_b32 v96,0
v_mov_b32 v97,0
v_mov_b32 v98,0
v_mov_b32 v99,0
ds_read_b128 v[100:103],v4 offset:0
ds_read_b128 v[104:107],v4 offset:1024
ds_read_b128 v[108:111],v4 offset:2048
ds_read_b128 v[112:115],v4 offset:3072
s_cmp_lg_u32 s46,0
s_cbranch_scc1 np_175
db_176:
buffer_load_dword v12,v3,s[8:11],s72 offen sc1
s_waitcnt vmcnt(0)
v_cmp_gt_u32 vcc,s58,v12
s_cbranch_vccz dbok_177
s_sub_u32 s47,s47,1
s_cbranch_scc1 ABORT
s_branch db_176
dbok_177:
np_175:
s_barrier
buffer_load_dwordx4 v[32:35],v1,s[8:11],s70 offen sc1
s_nop 7
buffer_load_dwordx4 v[36:39],v1,s[8:11],s70 offen offset:1024 sc1
s_nop 7
buffer_load_dwordx4 v[40:43],v1,s[8:11],s70 offen offset:2048 sc1
s_nop 7
buffer_load_dwordx4 v[44:47],v1,s[8:11],s70 offen offset:3072 sc1
s_nop 7
buffer_load_dwordx4 v[48:51],v1,s[8:11],s71 offen sc1
s_waitcnt vmcnt(4)
v_and_b32 v12,1,v32
v_cmp_ne_u32 vcc,s57,v12
s_cbranch_vccnz ws_178
wg_187:
v_smfmac_f32_16x16x64_bf16 v[80:83],v[32:35],a[0:7],v2
buffer_load_dwordx4 v[52:55],v1,s[8:11],s71 offen offset:1024 sc1
v_smfmac_f32_16x16x64_bf16 v[84:87],v[32:35],a[8:15],v2
s_waitcnt vmcnt(4)
v_and_b32 v12,1,v36
v_smfmac_f32_16x16x64_bf16 v[88:91],v[32:35],a[16:23],v2
v_cmp_ne_u32 vcc,s57,v12
v_smfmac_f32_16x16x64_bf16 v[92:95],v[32:35],a[24:31],v2
s_waitcnt lgkmcnt(2)
v_smfmac_f32_16x16x64_bf16 v[96:99],v[32:35],v[100:107],v2
s_cbranch_vccnz ws_179
wg_188:
v_smfmac_f32_16x16x64_bf16 v[80:83],v[36:39],a[32:39],v2
buffer_load_dwordx4 v[56:59],v1,s[8:11],s71 offen offset:2048 sc1
v_smfmac_f32_16x16x64_bf16 v[84:87],v[36:39],a[40:47],v2
s_waitcnt vmcnt(4)
v_and_b32 v12,1,v40
v_smfmac_f32_16x16x64_bf16 v[88:91],v[36:39],a[48:55],v2
v_cmp_ne_u32 vcc,s57,v12
ds_read_b128 v[100:103],v4 offset:4096
v_smfmac_f32_16x16x64_bf16 v[92:95],v[36:39],a[56:63],v2
ds_read_b128 v[104:107],v4 offset:5120
s_waitcnt lgkmcnt(2)
v_smfmac_f32_16x16x64_bf16 v[96:99],v[36:39],v[108:115],v2
s_cbranch_vccnz ws_180
wg_189:
v_smfmac_f32_16x16x64_bf16 v[80:83],v[40:43],a[64:71],v2
buffer_load_dwordx4 v[60:63],v1,s[8:11],s71 offen offset:3072 sc1
v_smfmac_f32_16x16x64_bf16 v[84:87],v[40:43],a[72:79],v2
s_waitcnt vmcnt(4)
v_and_b32 v12,1,v44
v_smfmac_f32_16x16x64_bf16 v[88:91],v[40:43],a[80:87],v2
v_cmp_ne_u32 vcc,s57,v12
ds_read_b128 v[108:111],v4 offset:6144
v_smfmac_f32_16x16x64_bf16 v[92:95],v[40:43],a[88:95],v2
ds_read_b128 v[112:115],v4 offset:7168
s_waitcnt lgkmcnt(2)
v_smfmac_f32_16x16x64_bf16 v[96:99],v[40:43],v[100:107],v2
s_cbranch_vccnz ws_181
wg_190:
v_smfmac_f32_16x16x64_bf16 v[80:83],v[44:47],a[96:103],v2
buffer_load_dwordx4 v[64:67],v1,s[8:11],s80 offen sc1
v_smfmac_f32_16x16x64_bf16 v[84:87],v[44:47],a[104:111],v2
s_waitcnt vmcnt(4)
v_and_b32 v12,1,v48
v_smfmac_f32_16x16x64_bf16 v[88:91],v[44:47],a[112:119],v2
v_cmp_ne_u32 vcc,s57,v12
ds_read_b128 v[100:103],v4 offset:8192
v_smfmac_f32_16x16x64_bf16 v[92:95],v[44:47],a[120:127],v2
ds_read_b128 v[104:107],v4 offset:9216
s_waitcnt lgkmcnt(2)
v_smfmac_f32_16x16x64_bf16 v[96:99],v[44:47],v[108:115],v2
s_cbranch_vccnz ws_182
wg_191:
v_smfmac_f32_16x16x64_bf16 v[80:83],v[48:51],a[128:135],v2
buffer_load_dwordx4 v[68:71],v1,s[8:11],s80 offen offset:1024 sc1
v_smfmac_f32_16x16x64_bf16 v[84:87],v[48:51],a[136:143],v2
s_waitcnt vmcnt(4)
v_and_b32 v12,1,v52
v_smfmac_f32_16x16x64_bf16 v[88:91],v[48:51],a[144:151],v2
v_cmp_ne_u32 vcc,s57,v12
ds_read_b128 v[108:111],v4 offset:10240
v_smfmac_f32_16x16x64_bf16 v[92:95],v[48:51],a[152:159],v2
ds_read_b128 v[112:115],v4 offset:11264
s_waitcnt lgkmcnt(2)
v_smfmac_f32_16x16x64_bf16 v[96:99],v[48:51],v[100:107],v2
s_cbranch_vccnz ws_183
wg_192:
v_smfmac_f32_16x16x64_bf16 v[80:83],v[52:55],a[160:167],v2
s_waitcnt vmcnt(2)
v_bitop3_b32 v12,v56,v60,s57 bitop3:0x7e
v_smfmac_f32_16x16x64_bf16 v[84:87],v[52:55],a[168:175],v2
v_and_b32 v12,1,v12
buffer_load_dwordx4 v[72:75],v1,s[8:11],s80 offen offset:2048 sc1
v_smfmac_f32_16x16x64_bf16 v[88:91],v[52:55],a[176:183],v2
v_cmp_ne_u32 vcc,0,v12
ds_read_b128 v[100:103],v4 offset:12288
v_smfmac_f32_16x16x64_bf16 v[92:95],v[52:55],a[184:191],v2
ds_read_b128 v[104:107],v4 offset:13312
s_waitcnt lgkmcnt(2)
v_smfmac_f32_16x16x64_bf16 v[96:99],v[52:55],v[108:115],v2
s_cbranch_vccnz ws_184
wg_193:
v_smfmac_f32_16x16x64_bf16 v[80:83],v[56:59],a[192:199],v2
buffer_load_dwordx4 v[76:79],v1,s[8:11],s80 offen offset:3072 sc1
v_smfmac_f32_16x16x64_bf16 v[84:87],v[56:59],a[200:207],v2
ds_read_b128 v[108:111],v4 offset:14336
v_smfmac_f32_16x16x64_bf16 v[88:91],v[56:59],a[208:215],v2
ds_read_b128 v[112:115],v4 offset:15360
v_smfmac_f32_16x16x64_bf16 v[92:95],v[56:59],a[216:223],v2
s_waitcnt lgkmcnt(2)
v_smfmac_f32_16x16x64_bf16 v[96:99],v[56:59],v[100:107],v2
ds_read_b128 v[100:103],v4 offset:16384
v_smfmac_f32_16x16x64_bf16 v[80:83],v[60:63],a[224:231],v2
s_waitcnt vmcnt(2)
v_bitop3_b32 v12,v64,v68,s57 bitop3:0x7e
v_smfmac_f32_16x16x64_bf16 v[84:87],v[60:63],a[232:239],v2
v_and_b32 v12,1,v12
ds_read_b128 v[104:107],v4 offset:17408
v_smfmac_f32_16x16x64_bf16 v[88:91],v[60:63],a[240:247],v2
v_cmp_ne_u32 vcc,0,v12
v_smfmac_f32_16x16x64_bf16 v[92:95],v[60:63],a[248:255],v2
s_waitcnt lgkmcnt(2)
v_smfmac_f32_16x16x64_bf16 v[96:99],v[60:63],v[108:115],v2
s_cbranch_vccnz ws_185
wg_194:
v_smfmac_f32_16x16x64_bf16 v[80:83],v[64:67],v[128:135],v2
ds_read_b128 v[108:111],v4 offset:18432
v_smfmac_f32_16x16x64_bf16 v[84:87],v[64:67],v[136:143],v2
ds_read_b128 v[112:115],v4 offset:19456
v_smfmac_f32_16x16x64_bf16 v[88:91],v[64:67],v[144:151],v2
v_smfmac_f32_16x16x64_bf16 v[92:95],v[64:67],v[152:159],v2
s_waitcnt lgkmcnt(2)
v_smfmac_f32_16x16x64_bf16 v[96:99],v[64:67],v[100:107],v2
ds_read_b128 v[100:103],v4 offset:20480
v_smfmac_f32_16x16x64_bf16 v[80:83],v[68:71],v[160:167],v2
s_waitcnt vmcnt(0)
v_bitop3_b32 v12,v72,v76,s57 bitop3:0x7e
v_smfmac_f32_16x16x64_bf16 v[84:87],v[68:71],v[168:175],v2
v_and_b32 v12,1,v12
ds_read_b128 v[104:107],v4 offset:21504
v_smfmac_f32_16x16x64_bf16 v[88:91],v[68:71],v[176:183],v2
v_cmp_ne_u32 vcc,0,v12
v_smfmac_f32_16x16x64_bf16 v[92:95],v[68:71],v[184:191],v2
s_waitcnt lgkmcnt(2)
v_smfmac_f32_16x16x64_bf16 v[96:99],v[68:71],v[108:115],v2
s_cbranch_vccnz ws_186
wg_195:
v_smfmac_f32_16x16x64_bf16 v[80:83],v[72:75],v[192:199],v2
ds_read_b128 v[108:111],v4 offset:22528
v_smfmac_f32_16x16x64_bf16 v[80:83],v[76:79],v[224:231],v2
ds_read_b128 v[112:115],v4 offset:23552
v_smfmac_f32_16x16x64_bf16 v[84:87],v[72:75],v[200:207],v2
v_smfmac_f32_16x16x64_bf16 v[84:87],v[76:79],v[232:239],v2
v_smfmac_f32_16x16x64_bf16 v[88:91],v[72:75],v[208:215],v2
s_nop 3
v_add_f32 v80,v80,v81
v_smfmac_f32_16x16x64_bf16 v[88:91],v[76:79],v[240:247],v2
v_add_f32 v82,v82,v83
ds_write2_b32 v7,v80,v82 offset0:0 offset1:88
v_smfmac_f32_16x16x64_bf16 v[92:95],v[72:75],v[216:223],v2
v_add_f32 v84,v84,v85
v_smfmac_f32_16x16x64_bf16 v[92:95],v[76:79],v[248:255],v2
v_add_f32 v86,v86,v87
s_waitcnt lgkmcnt(3)
v_smfmac_f32_16x16x64_bf16 v[96:99],v[72:75],v[100:107],v2
ds_write2_b32 v7,v84,v86 offset0:16 offset1:104
s_waitcnt lgkmcnt(2)
v_smfmac_f32_16x16x64_bf16 v[96:99],v[76:79],v[108:115],v2
v_add_f32 v88,v88,v89
v_add_f32 v90,v90,v91
ds_write2_b32 v7,v88,v90 offset0:32 offset1:120
v_add_f32 v92,v92,v93
v_add_f32 v94,v94,v95
ds_write2_b32 v7,v92,v94 offset0:48 offset1:136
s_nop 1
v_add_f32 v96,v96,v97
v_add_f32 v98,v98,v99
ds_write2_b32 v7,v96,v98 offset0:64 offset1:152
s_mov_b64 exec,1
buffer_store_dword v16,v1,s[8:11],s69 offen
s_mov_b64 exec,-1
s_waitcnt lgkmcnt(0)
s_barrier
ds_read_b128 v[32:35],v8 offset:0
ds_read_b128 v[36:39],v8 offset:2816
ds_read_b128 v[40:43],v8 offset:5632
ds_read_b128 v[44:47],v8 offset:8448
s_mov_b64 exec,s[88:89]
s_waitcnt lgkmcnt(2)
v_pk_add_f32 v[32:33],v[32:33],v[36:37]
v_pk_add_f32 v[34:35],v[34:35],v[38:39]
s_waitcnt lgkmcnt(0)
v_pk_add_f32 v[40:41],v[40:41],v[44:45]
v_pk_add_f32 v[42:43],v[42:43],v[46:47]
v_pk_add_f32 v[32:33],v[32:33],v[40:41]
v_pk_add_f32 v[34:35],v[34:35],v[42:43]
v_and_or_b32 v32,v32,-2,s31
buffer_store_dwordx4 v[32:35],v9,s[8:11],s59 offen
s_barrier
buffer_store_dwordx4 v[32:35],v9,s[8:11],s68 offen sc1
s_mov_b64 exec,-1
s_nop 0
CW_NEXT_F:
s_add_u32 s50,s50,1
s_cmp_lt_u32 s50,128
s_cbranch_scc1 CW_LOOP_F
s_branch CW_DONE
ws_178:
buffer_load_dwordx4 v[32:35],v1,s[8:11],s70 offen sc1
buffer_load_dwordx4 v[36:39],v1,s[8:11],s70 offen offset:1024 sc1
buffer_load_dwordx4 v[40:43],v1,s[8:11],s70 offen offset:2048 sc1
buffer_load_dwordx4 v[44:47],v1,s[8:11],s70 offen offset:3072 sc1
buffer_load_dwordx4 v[48:51],v1,s[8:11],s71 offen sc1
s_sub_u32 s47,s47,1
s_cbranch_scc1 ABORT
s_waitcnt vmcnt(4)
v_and_b32 v12,1,v32
v_cmp_ne_u32 vcc,s57,v12
s_nop 0
s_cbranch_vccnz ws_178
s_branch wg_187
ws_179:
buffer_load_dwordx4 v[36:39],v1,s[8:11],s70 offen offset:1024 sc1
buffer_load_dwordx4 v[40:43],v1,s[8:11],s70 offen offset:2048 sc1
buffer_load_dwordx4 v[44:47],v1,s[8:11],s70 offen offset:3072 sc1
buffer_load_dwordx4 v[48:51],v1,s[8:11],s71 offen sc1
buffer_load_dwordx4 v[52:55],v1,s[8:11],s71 offen offset:1024 sc1
s_sub_u32 s47,s47,1
s_cbranch_scc1 ABORT
s_waitcnt vmcnt(4)
v_and_b32 v12,1,v36
v_cmp_ne_u32 vcc,s57,v12
s_nop 0
s_cbranch_vccnz ws_179
s_branch wg_188
ws_180:
buffer_load_dwordx4 v[40:43],v1,s[8:11],s70 offen offset:2048 sc1
buffer_load_dwordx4 v[44:47],v1,s[8:11],s70 offen offset:3072 sc1
buffer_load_dwordx4 v[48:51],v1,s[8:11],s71 offen sc1
buffer_load_dwordx4 v[52:55],v1,s[8:11],s71 offen offset:1024 sc1
buffer_load_dwordx4 v[56:59],v1,s[8:11],s71 offen offset:2048 sc1
s_sub_u32 s47,s47,1
s_cbranch_scc1 ABORT
s_waitcnt vmcnt(4)
v_and_b32 v12,1,v40
v_cmp_ne_u32 vcc,s57,v12
s_nop 0
s_cbranch_vccnz ws_180
s_branch wg_189
ws_181:
buffer_load_dwordx4 v[44:47],v1,s[8:11],s70 offen offset:3072 sc1
buffer_load_dwordx4 v[48:51],v1,s[8:11],s71 offen sc1
buffer_load_dwordx4 v[52:55],v1,s[8:11],s71 offen offset:1024 sc1
buffer_load_dwordx4 v[56:59],v1,s[8:11],s71 offen offset:2048 sc1
buffer_load_dwordx4 v[60:63],v1,s[8:11],s71 offen offset:3072 sc1
s_sub_u32 s47,s47,1
s_cbranch_scc1 ABORT
s_waitcnt vmcnt(4)
v_and_b32 v12,1,v44
v_cmp_ne_u32 vcc,s57,v12
s_nop 0
s_cbranch_vccnz ws_181
s_branch wg_190
ws_182:
buffer_load_dwordx4 v[48:51],v1,s[8:11],s71 offen sc1
buffer_load_dwordx4 v[52:55],v1,s[8:11],s71 offen offset:1024 sc1
buffer_load_dwordx4 v[56:59],v1,s[8:11],s71 offen offset:2048 sc1
buffer_load_dwordx4 v[60:63],v1,s[8:11],s71 offen offset:3072 sc1
buffer_load_dwordx4 v[64:67],v1,s[8:11],s80 offen sc1
s_sub_u32 s47,s47,1
s_cbranch_scc1 ABORT
s_waitcnt vmcnt(4)
v_and_b32 v12,1,v48
v_cmp_ne_u32 vcc,s57,v12
s_nop 0
s_cbranch_vccnz ws_182
s_branch wg_191
ws_183:
buffer_load_dwordx4 v[52:55],v1,s[8:11],s71 offen offset:1024 sc1
buffer_load_dwordx4 v[56:59],v1,s[8:11],s71 offen offset:2048 sc1
buffer_load_dwordx4 v[60:63],v1,s[8:11],s71 offen offset:3072 sc1
buffer_load_dwordx4 v[64:67],v1,s[8:11],s80 offen sc1
buffer_load_dwordx4 v[68:71],v1,s[8:11],s80 offen offset:1024 sc1
s_sub_u32 s47,s47,1
s_cbranch_scc1 ABORT
s_waitcnt vmcnt(4)
v_and_b32 v12,1,v52
v_cmp_ne_u32 vcc,s57,v12
s_nop 0
s_cbranch_vccnz ws_183
s_branch wg_192
ws_184:
buffer_load_dwordx4 v[56:59],v1,s[8:11],s71 offen offset:2048 sc1
buffer_load_dwordx4 v[60:63],v1,s[8:11],s71 offen offset:3072 sc1
buffer_load_dwordx4 v[64:67],v1,s[8:11],s80 offen sc1
buffer_load_dwordx4 v[68:71],v1,s[8:11],s80 offen offset:1024 sc1
buffer_load_dwordx4 v[72:75],v1,s[8:11],s80 offen offset:2048 sc1
s_sub_u32 s47,s47,1
s_cbranch_scc1 ABORT
s_waitcnt vmcnt(3)
v_bitop3_b32 v12,v56,v60,s57 bitop3:0x7e
v_and_b32 v12,1,v12
v_cmp_ne_u32 vcc,0,v12
s_nop 0
s_cbranch_vccnz ws_184
s_branch wg_193
ws_185:
buffer_load_dwordx4 v[64:67],v1,s[8:11],s80 offen sc1
buffer_load_dwordx4 v[68:71],v1,s[8:11],s80 offen offset:1024 sc1
buffer_load_dwordx4 v[72:75],v1,s[8:11],s80 offen offset:2048 sc1
buffer_load_dwordx4 v[76:79],v1,s[8:11],s80 offen offset:3072 sc1
s_sub_u32 s47,s47,1
s_cbranch_scc1 ABORT
s_waitcnt vmcnt(2)
v_bitop3_b32 v12,v64,v68,s57 bitop3:0x7e
v_and_b32 v12,1,v12
v_cmp_ne_u32 vcc,0,v12
s_nop 0
s_cbranch_vccnz ws_185
s_branch wg_194
ws_186:
buffer_load_dwordx4 v[72:75],v1,s[8:11],s80 offen offset:2048 sc1
buffer_load_dwordx4 v[76:79],v1,s[8:11],s80 offen offset:3072 sc1
s_sub_u32 s47,s47,1
s_cbranch_scc1 ABORT
s_waitcnt vmcnt(0)
v_bitop3_b32 v12,v72,v76,s57 bitop3:0x7e
v_and_b32 v12,1,v12
v_cmp_ne_u32 vcc,0,v12
s_nop 0
s_cbranch_vccnz ws_186
s_branch wg_195
CW_LOOP_S:
s_sub_u32 s60,s50,15
s_lshr_b32 s52,s60,1
s_and_b32 s51,s60,1
s_cmp_eq_u32 s51,0
s_cselect_b32 s61,15,0
s_add_u32 s52,s52,s61
s_sub_u32 s61,s60,49
s_cmp_ge_u32 s60,98
s_cselect_b32 s52,s61,s52
s_cselect_b32 s51,1,s51
s_cmp_lt_u32 s50,15
s_cselect_b32 s52,s50,s52
s_cselect_b32 s51,0,s51
s_cmp_eq_u32 s52,63
s_cbranch_scc1 CW_NEXT_S
s_add_u32 s58,s52,1
s_lshl_b32 s61,s51,9
s_add_u32 s72,s61,s35
s_add_u32 s69,s61,s85
s_lshl_b32 s61,s51,2
s_and_b32 s60,s52,3
s_add_u32 s60,s60,s61
s_mul_i32 s70,s60,49152
s_add_u32 s70,s70,s33
s_add_u32 s71,s70,4096
s_add_u32 s80,s70,8192
s_bfe_u32 s57,s52,0x10002
s_bfe_u32 s31,s58,0x10002
s_and_b32 s60,s58,3
s_add_u32 s60,s60,s61
s_mul_i32 s59,s60,20480
s_add_u32 s59,s59,s84
s_lshl_b32 s68,s60,16
s_add_u32 s68,s68,s83
s_xor_b32 s77,s77,11264
v_add_u32 v7,s77,v5
v_add_u32 v8,s77,v6
s_add_u32 s60,s52,2
v_mov_b32 v16,s60
v_mov_b32 v80,0
v_mov_b32 v81,0
v_mov_b32 v82,0
v_mov_b32 v83,0
v_mov_b32 v84,0
v_mov_b32 v85,0
v_mov_b32 v86,0
v_mov_b32 v87,0
v_mov_b32 v88,0
v_mov_b32 v89,0
v_mov_b32 v90,0
v_mov_b32 v91,0
v_mov_b32 v92,0
v_mov_b32 v93,0
v_mov_b32 v94,0
v_mov_b32 v95,0
v_mov_b32 v96,0
v_mov_b32 v97,0
v_mov_b32 v98,0
v_mov_b32 v99,0
ds_read_b128 v[100:103],v4 offset:0
ds_read_b128 v[104:107],v4 offset:1024
ds_read_b128 v[108:111],v4 offset:2048
ds_read_b128 v[112:115],v4 offset:3072
s_cmp_lg_u32 s46,0
s_cbranch_scc1 np_196
db_197:
buffer_load_dword v12,v3,s[8:11],s72 offen sc1
s_waitcnt vmcnt(0)
v_cmp_gt_u32 vcc,s58,v12
s_cbranch_vccz dbok_198
s_sub_u32 s47,s47,1
s_cbranch_scc1 ABORT
s_branch db_197
dbok_198:
np_196:
s_barrier
buffer_load_dwordx4 v[32:35],v1,s[8:11],s70 offen sc1
s_nop 7
buffer_load_dwordx4 v[36:39],v1,s[8:11],s70 offen offset:1024 sc1
s_nop 7
buffer_load_dwordx4 v[40:43],v1,s[8:11],s70 offen offset:2048 sc1
s_nop 7
buffer_load_dwordx4 v[44:47],v1,s[8:11],s70 offen offset:3072 sc1
s_nop 7
buffer_load_dwordx4 v[48:51],v1,s[8:11],s71 offen sc1
s_waitcnt vmcnt(4)
v_and_b32 v12,1,v32
v_cmp_ne_u32 vcc,s57,v12
s_cbranch_vccnz ws_199
wg_208:
v_smfmac_f32_16x16x64_bf16 v[80:83],v[32:35],a[0:7],v2
buffer_load_dwordx4 v[52:55],v1,s[8:11],s71 offen offset:1024 sc1
v_smfmac_f32_16x16x64_bf16 v[84:87],v[32:35],a[8:15],v2
s_waitcnt vmcnt(4)
v_and_b32 v12,1,v36
v_smfmac_f32_16x16x64_bf16 v[88:91],v[32:35],a[16:23],v2
v_cmp_ne_u32 vcc,s57,v12
v_smfmac_f32_16x16x64_bf16 v[92:95],v[32:35],a[24:31],v2
s_waitcnt lgkmcnt(2)
v_smfmac_f32_16x16x64_bf16 v[96:99],v[32:35],v[100:107],v2
s_cbranch_vccnz ws_200
wg_209:
v_smfmac_f32_16x16x64_bf16 v[80:83],v[36:39],a[32:39],v2
buffer_load_dwordx4 v[56:59],v1,s[8:11],s71 offen offset:2048 sc1
v_smfmac_f32_16x16x64_bf16 v[84:87],v[36:39],a[40:47],v2
s_waitcnt vmcnt(4)
v_and_b32 v12,1,v40
v_smfmac_f32_16x16x64_bf16 v[88:91],v[36:39],a[48:55],v2
v_cmp_ne_u32 vcc,s57,v12
ds_read_b128 v[100:103],v4 offset:4096
v_smfmac_f32_16x16x64_bf16 v[92:95],v[36:39],a[56:63],v2
ds_read_b128 v[104:107],v4 offset:5120
s_waitcnt lgkmcnt(2)
v_smfmac_f32_16x16x64_bf16 v[96:99],v[36:39],v[108:115],v2
s_cbranch_vccnz ws_201
wg_210:
v_smfmac_f32_16x16x64_bf16 v[80:83],v[40:43],a[64:71],v2
buffer_load_dwordx4 v[60:63],v1,s[8:11],s71 offen offset:3072 sc1
v_smfmac_f32_16x16x64_bf16 v[84:87],v[40:43],a[72:79],v2
s_waitcnt vmcnt(4)
v_and_b32 v12,1,v44
v_smfmac_f32_16x16x64_bf16 v[88:91],v[40:43],a[80:87],v2
v_cmp_ne_u32 vcc,s57,v12
ds_read_b128 v[108:111],v4 offset:6144
v_smfmac_f32_16x16x64_bf16 v[92:95],v[40:43],a[88:95],v2
ds_read_b128 v[112:115],v4 offset:7168
s_waitcnt lgkmcnt(2)
v_smfmac_f32_16x16x64_bf16 v[96:99],v[40:43],v[100:107],v2
s_cbranch_vccnz ws_202
wg_211:
v_smfmac_f32_16x16x64_bf16 v[80:83],v[44:47],a[96:103],v2
buffer_load_dwordx4 v[64:67],v1,s[8:11],s80 offen sc1
v_smfmac_f32_16x16x64_bf16 v[84:87],v[44:47],a[104:111],v2
s_waitcnt vmcnt(4)
v_and_b32 v12,1,v48
v_smfmac_f32_16x16x64_bf16 v[88:91],v[44:47],a[112:119],v2
v_cmp_ne_u32 vcc,s57,v12
ds_read_b128 v[100:103],v4 offset:8192
v_smfmac_f32_16x16x64_bf16 v[92:95],v[44:47],a[120:127],v2
ds_read_b128 v[104:107],v4 offset:9216
s_waitcnt lgkmcnt(2)
v_smfmac_f32_16x16x64_bf16 v[96:99],v[44:47],v[108:115],v2
s_cbranch_vccnz ws_203
wg_212:
v_smfmac_f32_16x16x64_bf16 v[80:83],v[48:51],a[128:135],v2
buffer_load_dwordx4 v[68:71],v1,s[8:11],s80 offen offset:1024 sc1
v_smfmac_f32_16x16x64_bf16 v[84:87],v[48:51],a[136:143],v2
s_waitcnt vmcnt(4)
v_and_b32 v12,1,v52
v_smfmac_f32_16x16x64_bf16 v[88:91],v[48:51],a[144:151],v2
v_cmp_ne_u32 vcc,s57,v12
ds_read_b128 v[108:111],v4 offset:10240
v_smfmac_f32_16x16x64_bf16 v[92:95],v[48:51],a[152:159],v2
ds_read_b128 v[112:115],v4 offset:11264
s_waitcnt lgkmcnt(2)
v_smfmac_f32_16x16x64_bf16 v[96:99],v[48:51],v[100:107],v2
s_cbranch_vccnz ws_204
wg_213:
v_smfmac_f32_16x16x64_bf16 v[80:83],v[52:55],a[160:167],v2
s_waitcnt vmcnt(2)
v_bitop3_b32 v12,v56,v60,s57 bitop3:0x7e
v_smfmac_f32_16x16x64_bf16 v[84:87],v[52:55],a[168:175],v2
v_and_b32 v12,1,v12
buffer_load_dwordx4 v[72:75],v1,s[8:11],s80 offen offset:2048 sc1
v_smfmac_f32_16x16x64_bf16 v[88:91],v[52:55],a[176:183],v2
v_cmp_ne_u32 vcc,0,v12
ds_read_b128 v[100:103],v4 offset:12288
v_smfmac_f32_16x16x64_bf16 v[92:95],v[52:55],a[184:191],v2
ds_read_b128 v[104:107],v4 offset:13312
s_waitcnt lgkmcnt(2)
v_smfmac_f32_16x16x64_bf16 v[96:99],v[52:55],v[108:115],v2
s_cbranch_vccnz ws_205
wg_214:
v_smfmac_f32_16x16x64_bf16 v[80:83],v[56:59],a[192:199],v2
buffer_load_dwordx4 v[76:79],v1,s[8:11],s80 offen offset:3072 sc1
v_smfmac_f32_16x16x64_bf16 v[84:87],v[56:59],a[200:207],v2
ds_read_b128 v[108:111],v4 offset:14336
v_smfmac_f32_16x16x64_bf16 v[88:91],v[56:59],a[208:215],v2
ds_read_b128 v[112:115],v4 offset:15360
v_smfmac_f32_16x16x64_bf16 v[92:95],v[56:59],a[216:223],v2
s_waitcnt lgkmcnt(2)
v_smfmac_f32_16x16x64_bf16 v[96:99],v[56:59],v[100:107],v2
ds_read_b128 v[100:103],v4 offset:16384
v_smfmac_f32_16x16x64_bf16 v[80:83],v[60:63],a[224:231],v2
s_waitcnt vmcnt(2)
v_bitop3_b32 v12,v64,v68,s57 bitop3:0x7e
v_smfmac_f32_16x16x64_bf16 v[84:87],v[60:63],a[232:239],v2
v_and_b32 v12,1,v12
ds_read_b128 v[104:107],v4 offset:17408
v_smfmac_f32_16x16x64_bf16 v[88:91],v[60:63],a[240:247],v2
v_cmp_ne_u32 vcc,0,v12
v_smfmac_f32_16x16x64_bf16 v[92:95],v[60:63],a[248:255],v2
s_waitcnt lgkmcnt(2)
v_smfmac_f32_16x16x64_bf16 v[96:99],v[60:63],v[108:115],v2
s_cbranch_vccnz ws_206
wg_215:
v_smfmac_f32_16x16x64_bf16 v[80:83],v[64:67],v[128:135],v2
ds_read_b128 v[108:111],v4 offset:18432
v_smfmac_f32_16x16x64_bf16 v[84:87],v[64:67],v[136:143],v2
ds_read_b128 v[112:115],v4 offset:19456
v_smfmac_f32_16x16x64_bf16 v[88:91],v[64:67],v[144:151],v2
v_smfmac_f32_16x16x64_bf16 v[92:95],v[64:67],v[152:159],v2
s_waitcnt lgkmcnt(2)
v_smfmac_f32_16x16x64_bf16 v[96:99],v[64:67],v[100:107],v2
ds_read_b128 v[100:103],v4 offset:20480
v_smfmac_f32_16x16x64_bf16 v[80:83],v[68:71],v[160:167],v2
s_waitcnt vmcnt(0)
v_bitop3_b32 v12,v72,v76,s57 bitop3:0x7e
v_smfmac_f32_16x16x64_bf16 v[84:87],v[68:71],v[168:175],v2
v_and_b32 v12,1,v12
ds_read_b128 v[104:107],v4 offset:21504
v_smfmac_f32_16x16x64_bf16 v[88:91],v[68:71],v[176:183],v2
v_cmp_ne_u32 vcc,0,v12
v_smfmac_f32_16x16x64_bf16 v[92:95],v[68:71],v[184:191],v2
s_waitcnt lgkmcnt(2)
v_smfmac_f32_16x16x64_bf16 v[96:99],v[68:71],v[108:115],v2
s_cbranch_vccnz ws_207
wg_216:
v_smfmac_f32_16x16x64_bf16 v[80:83],v[72:75],v[192:199],v2
ds_read_b128 v[108:111],v4 offset:22528
v_smfmac_f32_16x16x64_bf16 v[80:83],v[76:79],v[224:231],v2
ds_read_b128 v[112:115],v4 offset:23552
v_smfmac_f32_16x16x64_bf16 v[84:87],v[72:75],v[200:207],v2
v_smfmac_f32_16x16x64_bf16 v[84:87],v[76:79],v[232:239],v2
v_smfmac_f32_16x16x64_bf16 v[88:91],v[72:75],v[208:215],v2
s_nop 3
v_add_f32 v80,v80,v81
v_smfmac_f32_16x16x64_bf16 v[88:91],v[76:79],v[240:247],v2
v_add_f32 v82,v82,v83
ds_write2_b32 v7,v80,v82 offset0:0 offset1:88
v_smfmac_f32_16x16x64_bf16 v[92:95],v[72:75],v[216:223],v2
v_add_f32 v84,v84,v85
v_smfmac_f32_16x16x64_bf16 v[92:95],v[76:79],v[248:255],v2
v_add_f32 v86,v86,v87
s_waitcnt lgkmcnt(3)
v_smfmac_f32_16x16x64_bf16 v[96:99],v[72:75],v[100:107],v2
ds_write2_b32 v7,v84,v86 offset0:16 offset1:104
s_waitcnt lgkmcnt(2)
v_smfmac_f32_16x16x64_bf16 v[96:99],v[76:79],v[108:115],v2
v_add_f32 v88,v88,v89
v_add_f32 v90,v90,v91
ds_write2_b32 v7,v88,v90 offset0:32 offset1:120
v_add_f32 v92,v92,v93
v_add_f32 v94,v94,v95
ds_write2_b32 v7,v92,v94 offset0:48 offset1:136
s_nop 1
v_add_f32 v96,v96,v97
v_add_f32 v98,v98,v99
ds_write2_b32 v7,v96,v98 offset0:64 offset1:152
s_mov_b64 exec,1
buffer_store_dword v16,v1,s[8:11],s69 offen sc1
s_mov_b64 exec,-1
s_waitcnt lgkmcnt(0)
s_barrier
ds_read_b128 v[32:35],v8 offset:0
ds_read_b128 v[36:39],v8 offset:2816
ds_read_b128 v[40:43],v8 offset:5632
ds_read_b128 v[44:47],v8 offset:8448
s_mov_b64 exec,s[88:89]
s_waitcnt lgkmcnt(2)
v_pk_add_f32 v[32:33],v[32:33],v[36:37]
v_pk_add_f32 v[34:35],v[34:35],v[38:39]
s_waitcnt lgkmcnt(0)
v_pk_add_f32 v[40:41],v[40:41],v[44:45]
v_pk_add_f32 v[42:43],v[42:43],v[46:47]
v_pk_add_f32 v[32:33],v[32:33],v[40:41]
v_pk_add_f32 v[34:35],v[34:35],v[42:43]
v_and_or_b32 v32,v32,-2,s31
buffer_store_dwordx4 v[32:35],v9,s[8:11],s59 offen sc1
s_barrier
buffer_store_dwordx4 v[32:35],v9,s[8:11],s68 offen sc1
s_mov_b64 exec,-1
s_nop 0
CW_NEXT_S:
s_add_u32 s50,s50,1
s_cmp_lt_u32 s50,128
s_cbranch_scc1 CW_LOOP_S
s_branch CW_DONE
ws_199:
buffer_load_dwordx4 v[32:35],v1,s[8:11],s70 offen sc1
buffer_load_dwordx4 v[36:39],v1,s[8:11],s70 offen offset:1024 sc1
buffer_load_dwordx4 v[40:43],v1,s[8:11],s70 offen offset:2048 sc1
buffer_load_dwordx4 v[44:47],v1,s[8:11],s70 offen offset:3072 sc1
buffer_load_dwordx4 v[48:51],v1,s[8:11],s71 offen sc1
s_sub_u32 s47,s47,1
s_cbranch_scc1 ABORT
s_waitcnt vmcnt(4)
v_and_b32 v12,1,v32
v_cmp_ne_u32 vcc,s57,v12
s_nop 0
s_cbranch_vccnz ws_199
s_branch wg_208
ws_200:
buffer_load_dwordx4 v[36:39],v1,s[8:11],s70 offen offset:1024 sc1
buffer_load_dwordx4 v[40:43],v1,s[8:11],s70 offen offset:2048 sc1
buffer_load_dwordx4 v[44:47],v1,s[8:11],s70 offen offset:3072 sc1
buffer_load_dwordx4 v[48:51],v1,s[8:11],s71 offen sc1
buffer_load_dwordx4 v[52:55],v1,s[8:11],s71 offen offset:1024 sc1
s_sub_u32 s47,s47,1
s_cbranch_scc1 ABORT
s_waitcnt vmcnt(4)
v_and_b32 v12,1,v36
v_cmp_ne_u32 vcc,s57,v12
s_nop 0
s_cbranch_vccnz ws_200
s_branch wg_209
ws_201:
buffer_load_dwordx4 v[40:43],v1,s[8:11],s70 offen offset:2048 sc1
buffer_load_dwordx4 v[44:47],v1,s[8:11],s70 offen offset:3072 sc1
buffer_load_dwordx4 v[48:51],v1,s[8:11],s71 offen sc1
buffer_load_dwordx4 v[52:55],v1,s[8:11],s71 offen offset:1024 sc1
buffer_load_dwordx4 v[56:59],v1,s[8:11],s71 offen offset:2048 sc1
s_sub_u32 s47,s47,1
s_cbranch_scc1 ABORT
s_waitcnt vmcnt(4)
v_and_b32 v12,1,v40
v_cmp_ne_u32 vcc,s57,v12
s_nop 0
s_cbranch_vccnz ws_201
s_branch wg_210
ws_202:
buffer_load_dwordx4 v[44:47],v1,s[8:11],s70 offen offset:3072 sc1
buffer_load_dwordx4 v[48:51],v1,s[8:11],s71 offen sc1
buffer_load_dwordx4 v[52:55],v1,s[8:11],s71 offen offset:1024 sc1
buffer_load_dwordx4 v[56:59],v1,s[8:11],s71 offen offset:2048 sc1
buffer_load_dwordx4 v[60:63],v1,s[8:11],s71 offen offset:3072 sc1
s_sub_u32 s47,s47,1
s_cbranch_scc1 ABORT
s_waitcnt vmcnt(4)
v_and_b32 v12,1,v44
v_cmp_ne_u32 vcc,s57,v12
s_nop 0
s_cbranch_vccnz ws_202
s_branch wg_211
ws_203:
buffer_load_dwordx4 v[48:51],v1,s[8:11],s71 offen sc1
buffer_load_dwordx4 v[52:55],v1,s[8:11],s71 offen offset:1024 sc1
buffer_load_dwordx4 v[56:59],v1,s[8:11],s71 offen offset:2048 sc1
buffer_load_dwordx4 v[60:63],v1,s[8:11],s71 offen offset:3072 sc1
buffer_load_dwordx4 v[64:67],v1,s[8:11],s80 offen sc1
s_sub_u32 s47,s47,1
s_cbranch_scc1 ABORT
s_waitcnt vmcnt(4)
v_and_b32 v12,1,v48
v_cmp_ne_u32 vcc,s57,v12
s_nop 0
s_cbranch_vccnz ws_203
s_branch wg_212
ws_204:
buffer_load_dwordx4 v[52:55],v1,s[8:11],s71 offen offset:1024 sc1
buffer_load_dwordx4 v[56:59],v1,s[8:11],s71 offen offset:2048 sc1
buffer_load_dwordx4 v[60:63],v1,s[8:11],s71 offen offset:3072 sc1
buffer_load_dwordx4 v[64:67],v1,s[8:11],s80 offen sc1
buffer_load_dwordx4 v[68:71],v1,s[8:11],s80 offen offset:1024 sc1
s_sub_u32 s47,s47,1
s_cbranch_scc1 ABORT
s_waitcnt vmcnt(4)
v_and_b32 v12,1,v52
v_cmp_ne_u32 vcc,s57,v12
s_nop 0
s_cbranch_vccnz ws_204
s_branch wg_213
ws_205:
buffer_load_dwordx4 v[56:59],v1,s[8:11],s71 offen offset:2048 sc1
buffer_load_dwordx4 v[60:63],v1,s[8:11],s71 offen offset:3072 sc1
buffer_load_dwordx4 v[64:67],v1,s[8:11],s80 offen sc1
buffer_load_dwordx4 v[68:71],v1,s[8:11],s80 offen offset:1024 sc1
buffer_load_dwordx4 v[72:75],v1,s[8:11],s80 offen offset:2048 sc1
s_sub_u32 s47,s47,1
s_cbranch_scc1 ABORT
s_waitcnt vmcnt(3)
v_bitop3_b32 v12,v56,v60,s57 bitop3:0x7e
v_and_b32 v12,1,v12
v_cmp_ne_u32 vcc,0,v12
s_nop 0
s_cbranch_vccnz ws_205
s_branch wg_214
ws_206:
buffer_load_dwordx4 v[64:67],v1,s[8:11],s80 offen sc1
buffer_load_dwordx4 v[68:71],v1,s[8:11],s80 offen offset:1024 sc1
buffer_load_dwordx4 v[72:75],v1,s[8:11],s80 offen offset:2048 sc1
buffer_load_dwordx4 v[76:79],v1,s[8:11],s80 offen offset:3072 sc1
s_sub_u32 s47,s47,1
s_cbranch_scc1 ABORT
s_waitcnt vmcnt(2)
v_bitop3_b32 v12,v64,v68,s57 bitop3:0x7e
v_and_b32 v12,1,v12
v_cmp_ne_u32 vcc,0,v12
s_nop 0
s_cbranch_vccnz ws_206
s_branch wg_215
ws_207:
buffer_load_dwordx4 v[72:75],v1,s[8:11],s80 offen offset:2048 sc1
buffer_load_dwordx4 v[76:79],v1,s[8:11],s80 offen offset:3072 sc1
s_sub_u32 s47,s47,1
s_cbranch_scc1 ABORT
s_waitcnt vmcnt(0)
v_bitop3_b32 v12,v72,v76,s57 bitop3:0x7e
v_and_b32 v12,1,v12
v_cmp_ne_u32 vcc,0,v12
s_nop 0
s_cbranch_vccnz ws_207
s_branch wg_216
CW_DONE:
s_add_u32 s61,s48,48
s_endpgm
DISPATCH:
s_sub_u32 s48,s3,0
s_cmp_lt_u32 s3,16
s_cbranch_scc1 ROLE_CS
s_sub_u32 s48,s3,16
s_cmp_lt_u32 s3,24
s_cbranch_scc1 ROLE_CV
s_sub_u32 s48,s3,24
s_cmp_lt_u32 s3,32
s_cbranch_scc1 ROLE_CW
s_sub_u32 s48,s3,16
s_cmp_lt_u32 s3,48
s_cbranch_scc1 ROLE_CS
s_sub_u32 s48,s3,40
s_cmp_lt_u32 s3,56
s_cbranch_scc1 ROLE_CV
s_sub_u32 s48,s3,48
s_cmp_lt_u32 s3,64
s_cbranch_scc1 ROLE_CW
s_sub_u32 s48,s3,64
s_cmp_lt_u32 s3,74
s_cbranch_scc1 ROLE_W4
s_sub_u32 s48,s3,74
s_cmp_lt_u32 s3,79
s_cbranch_scc1 ROLE_W1
s_sub_u32 s48,s3,79
s_cmp_lt_u32 s3,91
s_cbranch_scc1 ROLE_W3
s_sub_u32 s48,s3,91
s_cmp_lt_u32 s3,96
s_cbranch_scc1 ROLE_W2
s_sub_u32 s48,s3,96
s_cmp_lt_u32 s3,104
s_cbranch_scc1 ROLE_QKVQ
s_sub_u32 s48,s3,104
s_cmp_lt_u32 s3,112
s_cbranch_scc1 ROLE_QKVV
s_sub_u32 s48,s3,112
s_cmp_lt_u32 s3,128
s_cbranch_scc1 ROLE_R1
s_sub_u32 s48,s3,128
s_cmp_lt_u32 s3,138
s_cbranch_scc1 ROLE_WO
s_sub_u32 s48,s3,138
s_cmp_lt_u32 s3,146
s_cbranch_scc1 ROLE_ATT
s_sub_u32 s48,s3,138
s_cmp_lt_u32 s3,156
s_cbranch_scc1 ROLE_QKVQ
s_sub_u32 s48,s3,148
s_cmp_lt_u32 s3,160
s_cbranch_scc1 ROLE_QKVV
s_sub_u32 s48,s3,150
s_cmp_lt_u32 s3,170
s_cbranch_scc1 ROLE_WO
s_sub_u32 s48,s3,162
s_cmp_lt_u32 s3,178
s_cbranch_scc1 ROLE_ATT
s_sub_u32 s48,s3,160
s_cmp_lt_u32 s3,188
s_cbranch_scc1 ROLE_QKVQ
s_sub_u32 s48,s3,176
s_cmp_lt_u32 s3,192
s_cbranch_scc1 ROLE_QKVV
s_sub_u32 s48,s3,172
s_cmp_lt_u32 s3,202
s_cbranch_scc1 ROLE_WO
s_sub_u32 s48,s3,186
s_cmp_lt_u32 s3,210
s_cbranch_scc1 ROLE_ATT
s_sub_u32 s48,s3,182
s_cmp_lt_u32 s3,220
s_cbranch_scc1 ROLE_QKVQ
s_sub_u32 s48,s3,204
s_cmp_lt_u32 s3,224
s_cbranch_scc1 ROLE_QKVV
s_sub_u32 s48,s3,194
s_cmp_lt_u32 s3,234
s_cbranch_scc1 ROLE_WO
s_sub_u32 s48,s3,210
s_cmp_lt_u32 s3,242
s_cbranch_scc1 ROLE_ATT
s_sub_u32 s48,s3,204
s_cmp_lt_u32 s3,252
s_cbranch_scc1 ROLE_QKVQ
s_sub_u32 s48,s3,232
s_cmp_lt_u32 s3,256
s_cbranch_scc1 ROLE_QKVV
s_branch ROLE_SPARE
EXIT:
s_endpgm
ABORT:
s_mov_b64 exec,1
v_mov_b32 v1,s2
v_add_u32 v1,0x10000,v1
v_mov_b32 v2,8
buffer_store_dword v1,v2,s[12:15],0 offen
s_endpgm
ROLE_SPARE:
s_waitcnt vmcnt(0)
s_barrier
s_cmp_lg_u32 s46,0
s_cbranch_scc1 arr_217
v_mov_b32 v12,1
s_lshl_b32 s3,s49,2
v_mov_b32 v13,s3
s_mov_b64 exec,1
buffer_atomic_add v12,v13,s[12:15],0 offen sc1
s_mov_b64 exec,-1
arr_217:
s_lshl_b32 s3,s49,2
v_mov_b32 v13,s3
s_nop 1
ibw_218:
buffer_load_dword v12,v13,s[12:15],0 offen sc1
s_waitcnt vmcnt(0)
v_cmp_ne_u32 vcc,256,v12
s_nop 0
s_cbranch_vccz ok_219
s_sleep 8
s_sub_u32 s47,s47,1
s_cbranch_scc1 ABORT
s_branch ibw_218
ok_219:
s_cmp_lg_u32 s49,0
s_cbranch_scc1 ibok_220
v_and_b32 v13,7,v0
v_lshlrev_b32 v13,2,v13
buffer_load_dword v12,v13,s[12:15],0 offen offset:32 sc1
s_waitcnt vmcnt(0)
v_cmp_ne_u32 vcc,32,v12
s_nop 0
s_cbranch_vccz ibok_220
s_barrier
s_mov_b32 s49,1
s_mov_b32 s3,s2
s_load_dwordx16 s[16:31],s[0:1],0
s_load_dwordx8 s[32:39],s[0:1],64
s_waitcnt lgkmcnt(0)
s_branch DISPATCH
ibok_220:
s_endpgm
ROLE_QKVQ:
v_lshlrev_b32 v1,4,v0
v_mov_b32 v5,1
s_lshl_b32 s56,s48,2
s_add_u32 s56,s56,s46
v_bfe_u32 v6,v0,2,2
v_lshrrev_b32 v7,4,v0
v_add_u32 v7,v6,v7
v_and_b32 v7,3,v7
v_and_b32 v15,3,v0
v_lshlrev_b32 v15,4,v15
v_lshl_add_u32 v15,v7,6,v15
v_lshl_add_u32 v15,v6,8,v15
v_lshrrev_b32 v6,5,v0
v_bfe_u32 v7,v0,4,1
v_lshlrev_b32 v16,10,v7
v_bfe_u32 v7,v0,2,2
v_lshl_add_u32 v16,v7,8,v16
v_add_u32 v6,v6,v7
v_and_b32 v6,3,v6
v_lshl_add_u32 v16,v6,6,v16
v_and_b32 v6,3,v0
v_lshl_add_u32 v16,v6,4,v16
v_add_u32 v18,46080,v16
v_lshrrev_b32 v6,5,v0
v_bfe_u32 v7,v0,4,1
v_lshlrev_b32 v20,10,v7
v_lshl_add_u32 v20,v6,8,v20
v_and_b32 v6,15,v0
v_lshl_add_u32 v20,v6,4,v20
v_lshrrev_b32 v6,5,v0
v_add_u32 v6,2,v6
v_bfe_u32 v7,v0,4,1
v_lshlrev_b32 v17,10,v7
v_bfe_u32 v7,v0,2,2
v_lshl_add_u32 v17,v7,8,v17
v_add_u32 v6,v6,v7
v_and_b32 v6,3,v6
v_lshl_add_u32 v17,v6,6,v17
v_and_b32 v6,3,v0
v_lshl_add_u32 v17,v6,4,v17
v_add_u32 v19,46080,v17
v_lshrrev_b32 v6,5,v0
v_add_u32 v6,2,v6
v_bfe_u32 v7,v0,4,1
v_lshlrev_b32 v21,10,v7
v_lshl_add_u32 v21,v6,8,v21
v_and_b32 v6,15,v0
v_lshl_add_u32 v21,v6,4,v21
s_cmp_ge_u32 s48,24
s_cselect_b32 s68,1,0
s_mul_i32 s60,s68,96
s_sub_u32 s69,s56,s60
s_mul_i32 s70,s68,50331648
s_add_u32 s70,s70,74448896
s_mul_i32 s60,s68,65536
s_sub_u32 s71,131072,s60
s_lshl_b32 s60,s69,12
s_add_u32 s70,s70,s60
v_lshrrev_b32 v6,5,v0
v_mul_u32_u24 v188,2560,v6
v_and_b32 v6,31,v0
v_lshl_add_u32 v188,v6,3,v188
v_add_u32 v188,0xa000,v188
v_min_u32 v12,7,v0
v_lshlrev_b32 v12,2,v12
v_min_u32 v13,39,v0
v_lshlrev_b32 v13,2,v13
v_mov_b32 v14,93184
s_waitcnt vmcnt(0)
s_barrier
s_cmp_lg_u32 s46,0
s_cbranch_scc1 arr_221
v_mov_b32 v6,1
s_lshl_b32 s3,s49,2
v_mov_b32 v7,s3
s_mov_b64 exec,1
buffer_atomic_add v6,v7,s[12:15],0 offen sc1
s_mov_b64 exec,-1
arr_221:
s_lshl_b32 s58,s69,7
s_mul_i32 s63,s46,40960
s_cmp_eq_u32 s68,0
s_cselect_b32 s4,s22,s20
s_cselect_b32 s5,s23,s21
s_mov_b32 s6,7864320
s_mov_b32 s7,0x20000
v_lshrrev_b32 v9,3,v0
s_mov_b32 s64,12288
v_mul_lo_u32 v9,v9,s64
v_and_b32 v10,7,v0
v_lshl_add_u32 v6,v10,4,v9
s_add_u32 m0,s63,0
s_add_u32 s65,s58,0
buffer_load_dwordx4 v6,s[4:7],s65 offen lds
s_add_u32 m0,s63,1024
s_add_u32 s65,s58,98304
buffer_load_dwordx4 v6,s[4:7],s65 offen lds
s_add_u32 m0,s63,2048
s_add_u32 s65,s58,196608
buffer_load_dwordx4 v6,s[4:7],s65 offen lds
s_add_u32 m0,s63,3072
s_add_u32 s65,s58,294912
buffer_load_dwordx4 v6,s[4:7],s65 offen lds
s_add_u32 m0,s63,4096
s_add_u32 s65,s58,393216
buffer_load_dwordx4 v6,s[4:7],s65 offen lds
s_add_u32 m0,s63,5120
s_add_u32 s65,s58,491520
buffer_load_dwordx4 v6,s[4:7],s65 offen lds
s_add_u32 m0,s63,6144
s_add_u32 s65,s58,589824
buffer_load_dwordx4 v6,s[4:7],s65 offen lds
s_add_u32 m0,s63,7168
s_add_u32 s65,s58,688128
buffer_load_dwordx4 v6,s[4:7],s65 offen lds
s_add_u32 m0,s63,8192
s_add_u32 s65,s58,786432
buffer_load_dwordx4 v6,s[4:7],s65 offen lds
s_add_u32 m0,s63,9216
s_add_u32 s65,s58,884736
buffer_load_dwordx4 v6,s[4:7],s65 offen lds
s_add_u32 m0,s63,10240
s_add_u32 s65,s58,983040
buffer_load_dwordx4 v6,s[4:7],s65 offen lds
s_add_u32 m0,s63,11264
s_add_u32 s65,s58,1081344
buffer_load_dwordx4 v6,s[4:7],s65 offen lds
s_add_u32 m0,s63,12288
s_add_u32 s65,s58,1179648
buffer_load_dwordx4 v6,s[4:7],s65 offen lds
s_add_u32 m0,s63,13312
s_add_u32 s65,s58,1277952
buffer_load_dwordx4 v6,s[4:7],s65 offen lds
s_add_u32 m0,s63,14336
s_add_u32 s65,s58,1376256
buffer_load_dwordx4 v6,s[4:7],s65 offen lds
s_add_u32 m0,s63,15360
s_add_u32 s65,s58,1474560
buffer_load_dwordx4 v6,s[4:7],s65 offen lds
s_add_u32 m0,s63,16384
s_add_u32 s65,s58,1572864
buffer_load_dwordx4 v6,s[4:7],s65 offen lds
s_add_u32 m0,s63,17408
s_add_u32 s65,s58,1671168
buffer_load_dwordx4 v6,s[4:7],s65 offen lds
s_add_u32 m0,s63,18432
s_add_u32 s65,s58,1769472
buffer_load_dwordx4 v6,s[4:7],s65 offen lds
s_add_u32 m0,s63,19456
s_add_u32 s65,s58,1867776
buffer_load_dwordx4 v6,s[4:7],s65 offen lds
s_add_u32 m0,s63,20480
s_add_u32 s65,s58,1966080
buffer_load_dwordx4 v6,s[4:7],s65 offen lds
s_add_u32 m0,s63,21504
s_add_u32 s65,s58,2064384
buffer_load_dwordx4 v6,s[4:7],s65 offen lds
s_add_u32 m0,s63,22528
s_add_u32 s65,s58,2162688
buffer_load_dwordx4 v6,s[4:7],s65 offen lds
s_add_u32 m0,s63,23552
s_add_u32 s65,s58,2260992
buffer_load_dwordx4 v6,s[4:7],s65 offen lds
s_add_u32 m0,s63,24576
s_add_u32 s65,s58,2359296
buffer_load_dwordx4 v6,s[4:7],s65 offen lds
s_add_u32 m0,s63,25600
s_add_u32 s65,s58,2457600
buffer_load_dwordx4 v6,s[4:7],s65 offen lds
s_add_u32 m0,s63,26624
s_add_u32 s65,s58,2555904
buffer_load_dwordx4 v6,s[4:7],s65 offen lds
s_add_u32 m0,s63,27648
s_add_u32 s65,s58,2654208
buffer_load_dwordx4 v6,s[4:7],s65 offen lds
s_add_u32 m0,s63,28672
s_add_u32 s65,s58,2752512
buffer_load_dwordx4 v6,s[4:7],s65 offen lds
s_add_u32 m0,s63,29696
s_add_u32 s65,s58,2850816
buffer_load_dwordx4 v6,s[4:7],s65 offen lds
s_add_u32 m0,s63,30720
s_add_u32 s65,s58,2949120
buffer_load_dwordx4 v6,s[4:7],s65 offen lds
s_add_u32 m0,s63,31744
s_add_u32 s65,s58,3047424
buffer_load_dwordx4 v6,s[4:7],s65 offen lds
s_add_u32 m0,s63,32768
s_add_u32 s65,s58,3145728
buffer_load_dwordx4 v6,s[4:7],s65 offen lds
s_add_u32 m0,s63,33792
s_add_u32 s65,s58,3244032
buffer_load_dwordx4 v6,s[4:7],s65 offen lds
s_add_u32 m0,s63,34816
s_add_u32 s65,s58,3342336
buffer_load_dwordx4 v6,s[4:7],s65 offen lds
s_add_u32 m0,s63,35840
s_add_u32 s65,s58,3440640
buffer_load_dwordx4 v6,s[4:7],s65 offen lds
s_add_u32 m0,s63,36864
s_add_u32 s65,s58,3538944
buffer_load_dwordx4 v6,s[4:7],s65 offen lds
s_add_u32 m0,s63,37888
s_add_u32 s65,s58,3637248
buffer_load_dwordx4 v6,s[4:7],s65 offen lds
s_add_u32 m0,s63,38912
s_add_u32 s65,s58,3735552
buffer_load_dwordx4 v6,s[4:7],s65 offen lds
s_add_u32 m0,s63,39936
s_add_u32 s65,s58,3833856
buffer_load_dwordx4 v6,s[4:7],s65 offen lds
s_waitcnt vmcnt(20)
v_bfe_u32 v9,v0,2,2
v_lshrrev_b32 v10,5,v0
v_lshl_add_u32 v9,v10,2,v9
v_mul_u32_u24 v9,128,v9
v_and_b32 v10,1,v0
v_lshl_add_u32 v9,v10,3,v9
v_bfe_u32 v10,v0,1,1
v_lshl_add_u32 v9,v10,5,v9
v_bfe_u32 v10,v0,4,1
v_lshl_add_u32 v9,v10,4,v9
v_add_u32 v7,s63,v9
ds_read_b64_tr_b16 a[0:1],v7 offset:0
ds_read_b64_tr_b16 a[2:3],v7 offset:2048
ds_read_b64_tr_b16 a[4:5],v7 offset:1024
ds_read_b64_tr_b16 a[6:7],v7 offset:3072
ds_read_b64_tr_b16 a[160:161],v7 offset:64
ds_read_b64_tr_b16 a[162:163],v7 offset:2112
ds_read_b64_tr_b16 a[164:165],v7 offset:1088
ds_read_b64_tr_b16 a[166:167],v7 offset:3136
ds_read_b64_tr_b16 a[8:9],v7 offset:4096
ds_read_b64_tr_b16 a[10:11],v7 offset:6144
ds_read_b64_tr_b16 a[12:13],v7 offset:5120
ds_read_b64_tr_b16 a[14:15],v7 offset:7168
s_waitcnt lgkmcnt(4)
ds_read_b64_tr_b16 a[168:169],v7 offset:4160
ds_read_b64_tr_b16 a[170:171],v7 offset:6208
ds_read_b64_tr_b16 a[172:173],v7 offset:5184
ds_read_b64_tr_b16 a[174:175],v7 offset:7232
ds_read_b64_tr_b16 a[16:17],v7 offset:8192
ds_read_b64_tr_b16 a[18:19],v7 offset:10240
ds_read_b64_tr_b16 a[20:21],v7 offset:9216
ds_read_b64_tr_b16 a[22:23],v7 offset:11264
ds_read_b64_tr_b16 a[176:177],v7 offset:8256
ds_read_b64_tr_b16 a[178:179],v7 offset:10304
ds_read_b64_tr_b16 a[180:181],v7 offset:9280
ds_read_b64_tr_b16 a[182:183],v7 offset:11328
s_waitcnt lgkmcnt(4)
ds_read_b64_tr_b16 a[24:25],v7 offset:12288
ds_read_b64_tr_b16 a[26:27],v7 offset:14336
ds_read_b64_tr_b16 a[28:29],v7 offset:13312
ds_read_b64_tr_b16 a[30:31],v7 offset:15360
ds_read_b64_tr_b16 a[184:185],v7 offset:12352
ds_read_b64_tr_b16 a[186:187],v7 offset:14400
ds_read_b64_tr_b16 a[188:189],v7 offset:13376
ds_read_b64_tr_b16 a[190:191],v7 offset:15424
ds_read_b64_tr_b16 a[32:33],v7 offset:16384
ds_read_b64_tr_b16 a[34:35],v7 offset:18432
ds_read_b64_tr_b16 a[36:37],v7 offset:17408
ds_read_b64_tr_b16 a[38:39],v7 offset:19456
s_waitcnt lgkmcnt(4)
ds_read_b64_tr_b16 a[192:193],v7 offset:16448
ds_read_b64_tr_b16 a[194:195],v7 offset:18496
ds_read_b64_tr_b16 a[196:197],v7 offset:17472
ds_read_b64_tr_b16 a[198:199],v7 offset:19520
s_waitcnt lgkmcnt(0)
s_add_u32 m0,s63,0
s_add_u32 s65,s58,3932160
buffer_load_dwordx4 v6,s[4:7],s65 offen lds
s_add_u32 m0,s63,1024
s_add_u32 s65,s58,4030464
buffer_load_dwordx4 v6,s[4:7],s65 offen lds
s_add_u32 m0,s63,2048
s_add_u32 s65,s58,4128768
buffer_load_dwordx4 v6,s[4:7],s65 offen lds
s_add_u32 m0,s63,3072
s_add_u32 s65,s58,4227072
buffer_load_dwordx4 v6,s[4:7],s65 offen lds
s_add_u32 m0,s63,4096
s_add_u32 s65,s58,4325376
buffer_load_dwordx4 v6,s[4:7],s65 offen lds
s_add_u32 m0,s63,5120
s_add_u32 s65,s58,4423680
buffer_load_dwordx4 v6,s[4:7],s65 offen lds
s_add_u32 m0,s63,6144
s_add_u32 s65,s58,4521984
buffer_load_dwordx4 v6,s[4:7],s65 offen lds
s_add_u32 m0,s63,7168
s_add_u32 s65,s58,4620288
buffer_load_dwordx4 v6,s[4:7],s65 offen lds
s_add_u32 m0,s63,8192
s_add_u32 s65,s58,4718592
buffer_load_dwordx4 v6,s[4:7],s65 offen lds
s_add_u32 m0,s63,9216
s_add_u32 s65,s58,4816896
buffer_load_dwordx4 v6,s[4:7],s65 offen lds
s_add_u32 m0,s63,10240
s_add_u32 s65,s58,4915200
buffer_load_dwordx4 v6,s[4:7],s65 offen lds
s_add_u32 m0,s63,11264
s_add_u32 s65,s58,5013504
buffer_load_dwordx4 v6,s[4:7],s65 offen lds
s_add_u32 m0,s63,12288
s_add_u32 s65,s58,5111808
buffer_load_dwordx4 v6,s[4:7],s65 offen lds
s_add_u32 m0,s63,13312
s_add_u32 s65,s58,5210112
buffer_load_dwordx4 v6,s[4:7],s65 offen lds
s_add_u32 m0,s63,14336
s_add_u32 s65,s58,5308416
buffer_load_dwordx4 v6,s[4:7],s65 offen lds
s_add_u32 m0,s63,15360
s_add_u32 s65,s58,5406720
buffer_load_dwordx4 v6,s[4:7],s65 offen lds
s_add_u32 m0,s63,16384
s_add_u32 s65,s58,5505024
buffer_load_dwordx4 v6,s[4:7],s65 offen lds
s_add_u32 m0,s63,17408
s_add_u32 s65,s58,5603328
buffer_load_dwordx4 v6,s[4:7],s65 offen lds
s_add_u32 m0,s63,18432
s_add_u32 s65,s58,5701632
buffer_load_dwordx4 v6,s[4:7],s65 offen lds
s_add_u32 m0,s63,19456
s_add_u32 s65,s58,5799936
buffer_load_dwordx4 v6,s[4:7],s65 offen lds
s_waitcnt vmcnt(20)
v_bfe_u32 v9,v0,2,2
v_lshrrev_b32 v10,5,v0
v_lshl_add_u32 v9,v10,2,v9
v_mul_u32_u24 v9,128,v9
v_and_b32 v10,1,v0
v_lshl_add_u32 v9,v10,3,v9
v_bfe_u32 v10,v0,1,1
v_lshl_add_u32 v9,v10,5,v9
v_bfe_u32 v10,v0,4,1
v_lshl_add_u32 v9,v10,4,v9
v_add_u32 v7,s63,v9
ds_read_b64_tr_b16 a[40:41],v7 offset:20480
ds_read_b64_tr_b16 a[42:43],v7 offset:22528
ds_read_b64_tr_b16 a[44:45],v7 offset:21504
ds_read_b64_tr_b16 a[46:47],v7 offset:23552
ds_read_b64_tr_b16 a[200:201],v7 offset:20544
ds_read_b64_tr_b16 a[202:203],v7 offset:22592
ds_read_b64_tr_b16 a[204:205],v7 offset:21568
ds_read_b64_tr_b16 a[206:207],v7 offset:23616
ds_read_b64_tr_b16 a[48:49],v7 offset:24576
ds_read_b64_tr_b16 a[50:51],v7 offset:26624
ds_read_b64_tr_b16 a[52:53],v7 offset:25600
ds_read_b64_tr_b16 a[54:55],v7 offset:27648
s_waitcnt lgkmcnt(4)
ds_read_b64_tr_b16 a[208:209],v7 offset:24640
ds_read_b64_tr_b16 a[210:211],v7 offset:26688
ds_read_b64_tr_b16 a[212:213],v7 offset:25664
ds_read_b64_tr_b16 a[214:215],v7 offset:27712
ds_read_b64_tr_b16 a[56:57],v7 offset:28672
ds_read_b64_tr_b16 a[58:59],v7 offset:30720
ds_read_b64_tr_b16 a[60:61],v7 offset:29696
ds_read_b64_tr_b16 a[62:63],v7 offset:31744
ds_read_b64_tr_b16 a[216:217],v7 offset:28736
ds_read_b64_tr_b16 a[218:219],v7 offset:30784
ds_read_b64_tr_b16 a[220:221],v7 offset:29760
ds_read_b64_tr_b16 a[222:223],v7 offset:31808
s_waitcnt lgkmcnt(4)
ds_read_b64_tr_b16 a[64:65],v7 offset:32768
ds_read_b64_tr_b16 a[66:67],v7 offset:34816
ds_read_b64_tr_b16 a[68:69],v7 offset:33792
ds_read_b64_tr_b16 a[70:71],v7 offset:35840
ds_read_b64_tr_b16 a[224:225],v7 offset:32832
ds_read_b64_tr_b16 a[226:227],v7 offset:34880
ds_read_b64_tr_b16 a[228:229],v7 offset:33856
ds_read_b64_tr_b16 a[230:231],v7 offset:35904
ds_read_b64_tr_b16 a[72:73],v7 offset:36864
ds_read_b64_tr_b16 a[74:75],v7 offset:38912
ds_read_b64_tr_b16 a[76:77],v7 offset:37888
ds_read_b64_tr_b16 a[78:79],v7 offset:39936
s_waitcnt lgkmcnt(4)
ds_read_b64_tr_b16 a[232:233],v7 offset:36928
ds_read_b64_tr_b16 a[234:235],v7 offset:38976
ds_read_b64_tr_b16 a[236:237],v7 offset:37952
ds_read_b64_tr_b16 a[238:239],v7 offset:40000
s_waitcnt lgkmcnt(0)
s_add_u32 m0,s63,20480
s_add_u32 s65,s58,5898240
buffer_load_dwordx4 v6,s[4:7],s65 offen lds
s_add_u32 m0,s63,21504
s_add_u32 s65,s58,5996544
buffer_load_dwordx4 v6,s[4:7],s65 offen lds
s_add_u32 m0,s63,22528
s_add_u32 s65,s58,6094848
buffer_load_dwordx4 v6,s[4:7],s65 offen lds
s_add_u32 m0,s63,23552
s_add_u32 s65,s58,6193152
buffer_load_dwordx4 v6,s[4:7],s65 offen lds
s_add_u32 m0,s63,24576
s_add_u32 s65,s58,6291456
buffer_load_dwordx4 v6,s[4:7],s65 offen lds
s_add_u32 m0,s63,25600
s_add_u32 s65,s58,6389760
buffer_load_dwordx4 v6,s[4:7],s65 offen lds
s_add_u32 m0,s63,26624
s_add_u32 s65,s58,6488064
buffer_load_dwordx4 v6,s[4:7],s65 offen lds
s_add_u32 m0,s63,27648
s_add_u32 s65,s58,6586368
buffer_load_dwordx4 v6,s[4:7],s65 offen lds
s_add_u32 m0,s63,28672
s_add_u32 s65,s58,6684672
buffer_load_dwordx4 v6,s[4:7],s65 offen lds
s_add_u32 m0,s63,29696
s_add_u32 s65,s58,6782976
buffer_load_dwordx4 v6,s[4:7],s65 offen lds
s_add_u32 m0,s63,30720
s_add_u32 s65,s58,6881280
buffer_load_dwordx4 v6,s[4:7],s65 offen lds
s_add_u32 m0,s63,31744
s_add_u32 s65,s58,6979584
buffer_load_dwordx4 v6,s[4:7],s65 offen lds
s_add_u32 m0,s63,32768
s_add_u32 s65,s58,7077888
buffer_load_dwordx4 v6,s[4:7],s65 offen lds
s_add_u32 m0,s63,33792
s_add_u32 s65,s58,7176192
buffer_load_dwordx4 v6,s[4:7],s65 offen lds
s_add_u32 m0,s63,34816
s_add_u32 s65,s58,7274496
buffer_load_dwordx4 v6,s[4:7],s65 offen lds
s_add_u32 m0,s63,35840
s_add_u32 s65,s58,7372800
buffer_load_dwordx4 v6,s[4:7],s65 offen lds
s_add_u32 m0,s63,36864
s_add_u32 s65,s58,7471104
buffer_load_dwordx4 v6,s[4:7],s65 offen lds
s_add_u32 m0,s63,37888
s_add_u32 s65,s58,7569408
buffer_load_dwordx4 v6,s[4:7],s65 offen lds
s_add_u32 m0,s63,38912
s_add_u32 s65,s58,7667712
buffer_load_dwordx4 v6,s[4:7],s65 offen lds
s_add_u32 m0,s63,39936
s_add_u32 s65,s58,7766016
buffer_load_dwordx4 v6,s[4:7],s65 offen lds
s_waitcnt vmcnt(20)
v_bfe_u32 v9,v0,2,2
v_lshrrev_b32 v10,5,v0
v_lshl_add_u32 v9,v10,2,v9
v_mul_u32_u24 v9,128,v9
v_and_b32 v10,1,v0
v_lshl_add_u32 v9,v10,3,v9
v_bfe_u32 v10,v0,1,1
v_lshl_add_u32 v9,v10,5,v9
v_bfe_u32 v10,v0,4,1
v_lshl_add_u32 v9,v10,4,v9
v_add_u32 v7,s63,v9
ds_read_b64_tr_b16 a[80:81],v7 offset:0
ds_read_b64_tr_b16 a[82:83],v7 offset:2048
ds_read_b64_tr_b16 a[84:85],v7 offset:1024
ds_read_b64_tr_b16 a[86:87],v7 offset:3072
ds_read_b64_tr_b16 a[240:241],v7 offset:64
ds_read_b64_tr_b16 a[242:243],v7 offset:2112
ds_read_b64_tr_b16 a[244:245],v7 offset:1088
ds_read_b64_tr_b16 a[246:247],v7 offset:3136
ds_read_b64_tr_b16 a[88:89],v7 offset:4096
ds_read_b64_tr_b16 a[90:91],v7 offset:6144
ds_read_b64_tr_b16 a[92:93],v7 offset:5120
ds_read_b64_tr_b16 a[94:95],v7 offset:7168
s_waitcnt lgkmcnt(4)
ds_read_b64_tr_b16 a[248:249],v7 offset:4160
ds_read_b64_tr_b16 a[250:251],v7 offset:6208
ds_read_b64_tr_b16 a[252:253],v7 offset:5184
ds_read_b64_tr_b16 a[254:255],v7 offset:7232
ds_read_b64_tr_b16 a[96:97],v7 offset:8192
ds_read_b64_tr_b16 a[98:99],v7 offset:10240
ds_read_b64_tr_b16 a[100:101],v7 offset:9216
ds_read_b64_tr_b16 a[102:103],v7 offset:11264
ds_read_b64_tr_b16 v[192:193],v7 offset:8256
ds_read_b64_tr_b16 v[194:195],v7 offset:10304
ds_read_b64_tr_b16 v[196:197],v7 offset:9280
ds_read_b64_tr_b16 v[198:199],v7 offset:11328
s_waitcnt lgkmcnt(4)
ds_read_b64_tr_b16 a[104:105],v7 offset:12288
ds_read_b64_tr_b16 a[106:107],v7 offset:14336
ds_read_b64_tr_b16 a[108:109],v7 offset:13312
ds_read_b64_tr_b16 a[110:111],v7 offset:15360
ds_read_b64_tr_b16 v[200:201],v7 offset:12352
ds_read_b64_tr_b16 v[202:203],v7 offset:14400
ds_read_b64_tr_b16 v[204:205],v7 offset:13376
ds_read_b64_tr_b16 v[206:207],v7 offset:15424
ds_read_b64_tr_b16 a[112:113],v7 offset:16384
ds_read_b64_tr_b16 a[114:115],v7 offset:18432
ds_read_b64_tr_b16 a[116:117],v7 offset:17408
ds_read_b64_tr_b16 a[118:119],v7 offset:19456
s_waitcnt lgkmcnt(4)
ds_read_b64_tr_b16 v[208:209],v7 offset:16448
ds_read_b64_tr_b16 v[210:211],v7 offset:18496
ds_read_b64_tr_b16 v[212:213],v7 offset:17472
ds_read_b64_tr_b16 v[214:215],v7 offset:19520
s_waitcnt lgkmcnt(0)
s_waitcnt vmcnt(0)
v_bfe_u32 v9,v0,2,2
v_lshrrev_b32 v10,5,v0
v_lshl_add_u32 v9,v10,2,v9
v_mul_u32_u24 v9,128,v9
v_and_b32 v10,1,v0
v_lshl_add_u32 v9,v10,3,v9
v_bfe_u32 v10,v0,1,1
v_lshl_add_u32 v9,v10,5,v9
v_bfe_u32 v10,v0,4,1
v_lshl_add_u32 v9,v10,4,v9
v_add_u32 v7,s63,v9
ds_read_b64_tr_b16 a[120:121],v7 offset:20480
ds_read_b64_tr_b16 a[122:123],v7 offset:22528
ds_read_b64_tr_b16 a[124:125],v7 offset:21504
ds_read_b64_tr_b16 a[126:127],v7 offset:23552
ds_read_b64_tr_b16 v[216:217],v7 offset:20544
ds_read_b64_tr_b16 v[218:219],v7 offset:22592
ds_read_b64_tr_b16 v[220:221],v7 offset:21568
ds_read_b64_tr_b16 v[222:223],v7 offset:23616
ds_read_b64_tr_b16 a[128:129],v7 offset:24576
ds_read_b64_tr_b16 a[130:131],v7 offset:26624
ds_read_b64_tr_b16 a[132:133],v7 offset:25600
ds_read_b64_tr_b16 a[134:135],v7 offset:27648
s_waitcnt lgkmcnt(4)
ds_read_b64_tr_b16 v[224:225],v7 offset:24640
ds_read_b64_tr_b16 v[226:227],v7 offset:26688
ds_read_b64_tr_b16 v[228:229],v7 offset:25664
ds_read_b64_tr_b16 v[230:231],v7 offset:27712
ds_read_b64_tr_b16 a[136:137],v7 offset:28672
ds_read_b64_tr_b16 a[138:139],v7 offset:30720
ds_read_b64_tr_b16 a[140:141],v7 offset:29696
ds_read_b64_tr_b16 a[142:143],v7 offset:31744
ds_read_b64_tr_b16 v[232:233],v7 offset:28736
ds_read_b64_tr_b16 v[234:235],v7 offset:30784
ds_read_b64_tr_b16 v[236:237],v7 offset:29760
ds_read_b64_tr_b16 v[238:239],v7 offset:31808
s_waitcnt lgkmcnt(4)
ds_read_b64_tr_b16 a[144:145],v7 offset:32768
ds_read_b64_tr_b16 a[146:147],v7 offset:34816
ds_read_b64_tr_b16 a[148:149],v7 offset:33792
ds_read_b64_tr_b16 a[150:151],v7 offset:35840
ds_read_b64_tr_b16 v[240:241],v7 offset:32832
ds_read_b64_tr_b16 v[242:243],v7 offset:34880
ds_read_b64_tr_b16 v[244:245],v7 offset:33856
ds_read_b64_tr_b16 v[246:247],v7 offset:35904
ds_read_b64_tr_b16 a[152:153],v7 offset:36864
ds_read_b64_tr_b16 a[154:155],v7 offset:38912
ds_read_b64_tr_b16 a[156:157],v7 offset:37888
ds_read_b64_tr_b16 a[158:159],v7 offset:39936
s_waitcnt lgkmcnt(4)
ds_read_b64_tr_b16 v[248:249],v7 offset:36928
ds_read_b64_tr_b16 v[250:251],v7 offset:38976
ds_read_b64_tr_b16 v[252:253],v7 offset:37952
ds_read_b64_tr_b16 v[254:255],v7 offset:40000
s_waitcnt lgkmcnt(0)
v_mov_b32 v24,0x3f803f80
v_mov_b32 v25,0x3f803f80
v_mov_b32 v26,0x3f803f80
v_mov_b32 v27,0x3f803f80
s_nop 1
v_mfma_f32_32x32x16_bf16 v[120:135],a[0:3],v[24:27],0
v_mfma_f32_32x32x16_bf16 v[136:151],a[160:163],v[24:27],0
v_mfma_f32_32x32x16_bf16 v[120:135],a[4:7],v[24:27],v[120:135]
v_mfma_f32_32x32x16_bf16 v[136:151],a[164:167],v[24:27],v[136:151]
v_mfma_f32_32x32x16_bf16 v[120:135],a[8:11],v[24:27],v[120:135]
v_mfma_f32_32x32x16_bf16 v[136:151],a[168:171],v[24:27],v[136:151]
v_mfma_f32_32x32x16_bf16 v[120:135],a[12:15],v[24:27],v[120:135]
v_mfma_f32_32x32x16_bf16 v[136:151],a[172:175],v[24:27],v[136:151]
v_mfma_f32_32x32x16_bf16 v[120:135],a[16:19],v[24:27],v[120:135]
v_mfma_f32_32x32x16_bf16 v[136:151],a[176:179],v[24:27],v[136:151]
v_mfma_f32_32x32x16_bf16 v[120:135],a[20:23],v[24:27],v[120:135]
v_mfma_f32_32x32x16_bf16 v[136:151],a[180:183],v[24:27],v[136:151]
v_mfma_f32_32x32x16_bf16 v[120:135],a[24:27],v[24:27],v[120:135]
v_mfma_f32_32x32x16_bf16 v[136:151],a[184:187],v[24:27],v[136:151]
v_mfma_f32_32x32x16_bf16 v[120:135],a[28:31],v[24:27],v[120:135]
v_mfma_f32_32x32x16_bf16 v[136:151],a[188:191],v[24:27],v[136:151]
v_mfma_f32_32x32x16_bf16 v[120:135],a[32:35],v[24:27],v[120:135]
v_mfma_f32_32x32x16_bf16 v[136:151],a[192:195],v[24:27],v[136:151]
v_mfma_f32_32x32x16_bf16 v[120:135],a[36:39],v[24:27],v[120:135]
v_mfma_f32_32x32x16_bf16 v[136:151],a[196:199],v[24:27],v[136:151]
v_mfma_f32_32x32x16_bf16 v[120:135],a[40:43],v[24:27],v[120:135]
v_mfma_f32_32x32x16_bf16 v[136:151],a[200:203],v[24:27],v[136:151]
v_mfma_f32_32x32x16_bf16 v[120:135],a[44:47],v[24:27],v[120:135]
v_mfma_f32_32x32x16_bf16 v[136:151],a[204:207],v[24:27],v[136:151]
v_mfma_f32_32x32x16_bf16 v[120:135],a[48:51],v[24:27],v[120:135]
v_mfma_f32_32x32x16_bf16 v[136:151],a[208:211],v[24:27],v[136:151]
v_mfma_f32_32x32x16_bf16 v[120:135],a[52:55],v[24:27],v[120:135]
v_mfma_f32_32x32x16_bf16 v[136:151],a[212:215],v[24:27],v[136:151]
v_mfma_f32_32x32x16_bf16 v[120:135],a[56:59],v[24:27],v[120:135]
v_mfma_f32_32x32x16_bf16 v[136:151],a[216:219],v[24:27],v[136:151]
v_mfma_f32_32x32x16_bf16 v[120:135],a[60:63],v[24:27],v[120:135]
v_mfma_f32_32x32x16_bf16 v[136:151],a[220:223],v[24:27],v[136:151]
v_mfma_f32_32x32x16_bf16 v[120:135],a[64:67],v[24:27],v[120:135]
v_mfma_f32_32x32x16_bf16 v[136:151],a[224:227],v[24:27],v[136:151]
v_mfma_f32_32x32x16_bf16 v[120:135],a[68:71],v[24:27],v[120:135]
v_mfma_f32_32x32x16_bf16 v[136:151],a[228:231],v[24:27],v[136:151]
v_mfma_f32_32x32x16_bf16 v[120:135],a[72:75],v[24:27],v[120:135]
v_mfma_f32_32x32x16_bf16 v[136:151],a[232:235],v[24:27],v[136:151]
v_mfma_f32_32x32x16_bf16 v[120:135],a[76:79],v[24:27],v[120:135]
v_mfma_f32_32x32x16_bf16 v[136:151],a[236:239],v[24:27],v[136:151]
v_mfma_f32_32x32x16_bf16 v[120:135],a[80:83],v[24:27],v[120:135]
v_mfma_f32_32x32x16_bf16 v[136:151],a[240:243],v[24:27],v[136:151]
v_mfma_f32_32x32x16_bf16 v[120:135],a[84:87],v[24:27],v[120:135]
v_mfma_f32_32x32x16_bf16 v[136:151],a[244:247],v[24:27],v[136:151]
v_mfma_f32_32x32x16_bf16 v[120:135],a[88:91],v[24:27],v[120:135]
v_mfma_f32_32x32x16_bf16 v[136:151],a[248:251],v[24:27],v[136:151]
v_mfma_f32_32x32x16_bf16 v[120:135],a[92:95],v[24:27],v[120:135]
v_mfma_f32_32x32x16_bf16 v[136:151],a[252:255],v[24:27],v[136:151]
v_mfma_f32_32x32x16_bf16 v[120:135],a[96:99],v[24:27],v[120:135]
v_mfma_f32_32x32x16_bf16 v[136:151],v[192:195],v[24:27],v[136:151]
v_mfma_f32_32x32x16_bf16 v[120:135],a[100:103],v[24:27],v[120:135]
v_mfma_f32_32x32x16_bf16 v[136:151],v[196:199],v[24:27],v[136:151]
v_mfma_f32_32x32x16_bf16 v[120:135],a[104:107],v[24:27],v[120:135]
v_mfma_f32_32x32x16_bf16 v[136:151],v[200:203],v[24:27],v[136:151]
v_mfma_f32_32x32x16_bf16 v[120:135],a[108:111],v[24:27],v[120:135]
v_mfma_f32_32x32x16_bf16 v[136:151],v[204:207],v[24:27],v[136:151]
v_mfma_f32_32x32x16_bf16 v[120:135],a[112:115],v[24:27],v[120:135]
v_mfma_f32_32x32x16_bf16 v[136:151],v[208:211],v[24:27],v[136:151]
v_mfma_f32_32x32x16_bf16 v[120:135],a[116:119],v[24:27],v[120:135]
v_mfma_f32_32x32x16_bf16 v[136:151],v[212:215],v[24:27],v[136:151]
v_mfma_f32_32x32x16_bf16 v[120:135],a[120:123],v[24:27],v[120:135]
v_mfma_f32_32x32x16_bf16 v[136:151],v[216:219],v[24:27],v[136:151]
v_mfma_f32_32x32x16_bf16 v[120:135],a[124:127],v[24:27],v[120:135]
v_mfma_f32_32x32x16_bf16 v[136:151],v[220:223],v[24:27],v[136:151]
v_mfma_f32_32x32x16_bf16 v[120:135],a[128:131],v[24:27],v[120:135]
v_mfma_f32_32x32x16_bf16 v[136:151],v[224:227],v[24:27],v[136:151]
v_mfma_f32_32x32x16_bf16 v[120:135],a[132:135],v[24:27],v[120:135]
v_mfma_f32_32x32x16_bf16 v[136:151],v[228:231],v[24:27],v[136:151]
v_mfma_f32_32x32x16_bf16 v[120:135],a[136:139],v[24:27],v[120:135]
v_mfma_f32_32x32x16_bf16 v[136:151],v[232:235],v[24:27],v[136:151]
v_mfma_f32_32x32x16_bf16 v[120:135],a[140:143],v[24:27],v[120:135]
v_mfma_f32_32x32x16_bf16 v[136:151],v[236:239],v[24:27],v[136:151]
v_mfma_f32_32x32x16_bf16 v[120:135],a[144:147],v[24:27],v[120:135]
v_mfma_f32_32x32x16_bf16 v[136:151],v[240:243],v[24:27],v[136:151]
v_mfma_f32_32x32x16_bf16 v[120:135],a[148:151],v[24:27],v[120:135]
v_mfma_f32_32x32x16_bf16 v[136:151],v[244:247],v[24:27],v[136:151]
v_mfma_f32_32x32x16_bf16 v[120:135],a[152:155],v[24:27],v[120:135]
v_mfma_f32_32x32x16_bf16 v[136:151],v[248:251],v[24:27],v[136:151]
v_mfma_f32_32x32x16_bf16 v[120:135],a[156:159],v[24:27],v[120:135]
v_mfma_f32_32x32x16_bf16 v[136:151],v[252:255],v[24:27],v[136:151]
s_barrier
s_lshl_b32 s3,s49,2
v_mov_b32 v7,s3
s_nop 8
ibw_222:
buffer_load_dword v6,v7,s[12:15],0 offen sc1
s_waitcnt vmcnt(0)
v_cmp_ne_u32 vcc,256,v6
s_nop 0
s_cbranch_vccz ok_223
s_sleep 8
s_sub_u32 s47,s47,1
s_cbranch_scc1 ABORT
s_branch ibw_222
ok_223:
s_cmp_lg_u32 s49,0
s_cbranch_scc1 ibok_224
v_and_b32 v7,7,v0
v_lshlrev_b32 v7,2,v7
buffer_load_dword v6,v7,s[12:15],0 offen offset:32 sc1
s_waitcnt vmcnt(0)
v_cmp_ne_u32 vcc,32,v6
s_nop 0
s_cbranch_vccz ibok_224
s_barrier
s_mov_b32 s49,1
s_mov_b32 s3,s2
s_load_dwordx16 s[16:31],s[0:1],0
s_load_dwordx8 s[32:39],s[0:1],64
s_waitcnt lgkmcnt(0)
s_branch DISPATCH
ibok_224:
s_mov_b32 s50,0
s_mov_b32 s32,0
s_mov_b32 s57,0
s_mov_b32 s59,2147483648
s_mov_b32 s82,2147483648
s_mov_b32 s39,2147483648
v_mov_b32 v22,94208
s_mov_b32 s72,0
s_mov_b32 s73,0
s_mov_b32 s83,s100
s_min_u32 s62,s32,127
s_sub_u32 s60,s62,20
s_lshr_b32 s34,s60,1
s_and_b32 s33,s60,1
s_xor_b32 s33,s33,1
s_cmp_eq_u32 s33,0
s_cselect_b32 s61,20,0
s_add_u32 s34,s34,s61
s_sub_u32 s61,s60,44
s_cmp_ge_u32 s60,88
s_cselect_b32 s34,s61,s34
s_cselect_b32 s33,1,s33
s_cmp_lt_u32 s62,20
s_cselect_b32 s34,s62,s34
s_cselect_b32 s33,0,s33
s_lshl_b32 s35,s33,6
s_add_u32 s35,s35,s34
s_lshl_b32 s35,s35,9
s_add_u32 s35,s35,0
s_lshl_b32 s60,s33,5
s_add_u32 s60,s60,7
v_min_u32 v2,s60,v0
v_lshlrev_b32 v2,2,v2
s_nop 1
QKVQ_COLD0:
s_cmp_lg_u32 s46,0
s_cbranch_scc1 cp_225
fb_226:
buffer_load_dword v3,v2,s[8:11],s35 offen sc1
s_waitcnt vmcnt(0)
v_cmp_eq_u32 vcc,0,v3
s_nop 0
s_cbranch_vccz ok_227
s_sleep 7
s_sub_u32 s47,s47,1
s_cbranch_scc1 ABORT
s_branch fb_226
ok_227:
cp_225:
s_barrier
s_lshl_b32 s60,s33,6
s_add_u32 s60,s60,s34
s_mul_i32 s60,s60,46080
s_add_u32 s60,s60,206569472
s_lshl_b32 s62,s46,10
s_add_u32 s62,s62,40960
s_add_u32 m0,s57,s62
s_add_u32 s63,s60,s62
buffer_load_dwordx4 v1,s[8:11],s63 offen sc1 lds
s_add_u32 m0,s57,45056
s_add_u32 s63,s60,45056
buffer_load_dwordx4 v1,s[8:11],s63 offen sc1 lds
s_mul_i32 s61,s46,10240
s_add_u32 s60,s60,s61
s_add_u32 s61,s61,s57
s_add_u32 m0,s61,0
s_add_u32 s63,s60,0
buffer_load_dwordx4 v1,s[8:11],s63 offen sc1 lds
buffer_load_dwordx4 v1,s[8:11],s63 offen offset:1024 sc1 lds
buffer_load_dwordx4 v1,s[8:11],s63 offen offset:2048 sc1 lds
buffer_load_dwordx4 v1,s[8:11],s63 offen offset:3072 sc1 lds
s_add_u32 m0,s61,4096
s_add_u32 s63,s60,4096
buffer_load_dwordx4 v1,s[8:11],s63 offen sc1 lds
buffer_load_dwordx4 v1,s[8:11],s63 offen offset:1024 sc1 lds
buffer_load_dwordx4 v1,s[8:11],s63 offen offset:2048 sc1 lds
buffer_load_dwordx4 v1,s[8:11],s63 offen offset:3072 sc1 lds
s_add_u32 m0,s61,8192
s_add_u32 s63,s60,8192
buffer_load_dwordx4 v1,s[8:11],s63 offen sc1 lds
buffer_load_dwordx4 v1,s[8:11],s63 offen offset:1024 sc1 lds
QKVQ_CD0:
s_mov_b32 s51,s33
s_mov_b32 s52,s34
s_add_u32 s32,s32,1
s_min_u32 s62,s32,127
s_sub_u32 s60,s62,20
s_lshr_b32 s34,s60,1
s_and_b32 s33,s60,1
s_xor_b32 s33,s33,1
s_cmp_eq_u32 s33,0
s_cselect_b32 s61,20,0
s_add_u32 s34,s34,s61
s_sub_u32 s61,s60,44
s_cmp_ge_u32 s60,88
s_cselect_b32 s34,s61,s34
s_cselect_b32 s33,1,s33
s_cmp_lt_u32 s62,20
s_cselect_b32 s34,s62,s34
s_cselect_b32 s33,0,s33
s_lshl_b32 s35,s33,6
s_add_u32 s35,s35,s34
s_lshl_b32 s35,s35,9
s_add_u32 s35,s35,0
s_lshl_b32 s60,s33,5
s_add_u32 s60,s60,7
v_min_u32 v2,s60,v0
v_lshlrev_b32 v2,2,v2
s_cmp_lg_u32 s46,0
s_cbranch_scc1 w0_228
buffer_load_dword v3,v2,s[8:11],s35 offen sc1
w0_228:
s_waitcnt vmcnt(0)
s_mov_b64 exec,1
buffer_store_dword v5,v1,s[8:11],s59 offen sc1
s_mov_b64 exec,-1
s_mov_b32 s59,2147483648
s_cmp_lg_u32 s46,0
s_cbranch_scc1 w0_229
v_cmp_eq_u32 vcc,0,v3
s_cmp_eq_u64 vcc,0
s_cselect_b32 s36,0,2147483648
s_cmp_lt_u32 s32,128
s_cselect_b32 s36,s36,2147483648
v_mov_b32 v23,s36
ds_write_b32 v22,v23
w0_229:
s_waitcnt lgkmcnt(0)
s_barrier
ds_read_b32 v23,v22
ds_read_b128 v[24:27],v16 offset:0
ds_read_b128 v[28:31],v17 offset:0
ds_read_b128 v[32:35],v16 offset:2048
ds_read_b128 v[36:39],v17 offset:2048
ds_read_b128 v[40:43],v16 offset:4096
s_waitcnt lgkmcnt(5)
v_readfirstlane_b32 s37,v23
s_nop 4
QKVQ_B0:
s_waitcnt lgkmcnt(3)
v_mfma_f32_32x32x16_bf16 v[56:71],a[0:3],v[24:27],0
ds_read_b128 v[44:47],v17 offset:4096
v_add_u32 v189,s57,v188
v_mfma_f32_32x32x16_bf16 v[72:87],a[160:163],v[24:27],0
v_add_u32 v8,0x800,v189
s_sub_u32 s66,46080,s57
s_lshl_b32 s60,s33,6
s_add_u32 s60,s60,s34
s_mul_i32 s60,s60,46080
s_add_u32 s60,s60,s37
v_mfma_f32_32x32x16_bf16 v[56:71],a[4:7],v[28:31],v[56:71]
ds_read_b128 v[48:51],v16 offset:6144
ds_read2_b64 v[156:159],v189 offset0:0 offset1:32
s_add_u32 s60,s60,206569472
s_lshl_b32 s62,s46,10
v_mfma_f32_32x32x16_bf16 v[72:87],a[164:167],v[28:31],v[72:87]
ds_read2_b64 v[160:163],v189 offset0:64 offset1:96
s_add_u32 s62,s62,40960
s_add_u32 m0,s66,s62
s_add_u32 s63,s60,s62
s_waitcnt lgkmcnt(5)
v_mfma_f32_32x32x16_bf16 v[56:71],a[8:11],v[32:35],v[56:71]
ds_read_b128 v[52:55],v17 offset:6144
ds_read2_b64 v[164:167],v189 offset0:128 offset1:160
buffer_load_dwordx4 v1,s[8:11],s63 offen sc1 lds
v_mfma_f32_32x32x16_bf16 v[72:87],a[168:171],v[32:35],v[72:87]
ds_read2_b64 v[168:171],v189 offset0:192 offset1:224
s_add_u32 m0,s66,45056
s_add_u32 s63,s60,45056
s_mul_i32 s74,s73,393216
s_add_u32 s74,s74,s39
v_mfma_f32_32x32x16_bf16 v[56:71],a[12:15],v[36:39],v[56:71]
ds_read_b128 v[24:27],v16 offset:8192
ds_read2_b64 v[172:175],v8 offset0:0 offset1:32
s_add_u32 s74,s74,s70
v_fma_f32 v88,-v176,v120,v88
v_mfma_f32_32x32x16_bf16 v[72:87],a[172:175],v[36:39],v[72:87]
buffer_load_dwordx4 v1,s[8:11],s63 offen sc1 lds
s_mul_i32 s61,s46,10240
s_add_u32 s60,s60,s61
s_add_u32 s61,s61,s66
s_waitcnt lgkmcnt(8)
v_mfma_f32_32x32x16_bf16 v[56:71],a[16:19],v[40:43],v[56:71]
ds_read_b128 v[28:31],v17 offset:8192
s_add_u32 m0,s61,0
s_add_u32 s63,s60,0
v_fma_f32 v89,-v176,v121,v89
v_fma_f32 v90,-v176,v122,v90
v_mfma_f32_32x32x16_bf16 v[72:87],a[176:179],v[40:43],v[72:87]
v_fma_f32 v91,-v176,v123,v91
v_fma_f32 v92,-v176,v124,v92
v_fma_f32 v93,-v176,v125,v93
v_fma_f32 v94,-v176,v126,v94
v_fma_f32 v95,-v176,v127,v95
v_mul_f32 v88,v88,v177
v_mfma_f32_32x32x16_bf16 v[56:71],a[20:23],v[44:47],v[56:71]
ds_read_b128 v[32:35],v16 offset:10240
buffer_load_dwordx4 v1,s[8:11],s63 offen sc1 lds
v_mul_f32 v89,v89,v177
v_mul_f32 v90,v90,v177
v_mfma_f32_32x32x16_bf16 v[72:87],a[180:183],v[44:47],v[72:87]
v_mul_f32 v91,v91,v177
v_mul_f32 v92,v92,v177
v_mul_f32 v93,v93,v177
v_mul_f32 v94,v94,v177
v_mul_f32 v95,v95,v177
s_waitcnt lgkmcnt(6)
v_mfma_f32_32x32x16_bf16 v[56:71],a[24:27],v[48:51],v[56:71]
ds_read_b128 v[36:39],v17 offset:10240
v_cvt_pk_bf16_f32 v180,v88,v89
v_cvt_pk_bf16_f32 v181,v90,v91
v_cvt_pk_bf16_f32 v182,v92,v93
v_cvt_pk_bf16_f32 v183,v94,v95
v_mfma_f32_32x32x16_bf16 v[72:87],a[184:187],v[48:51],v[72:87]
buffer_load_dwordx4 v1,s[8:11],s63 offen offset:1024 sc1 lds
buffer_store_dwordx4 v[180:183],v20,s[8:11],s74 offen sc1
v_fma_f32 v96,-v176,v128,v96
v_fma_f32 v97,-v176,v129,v97
v_mfma_f32_32x32x16_bf16 v[56:71],a[28:31],v[52:55],v[56:71]
ds_read_b128 v[40:43],v16 offset:12288
v_fma_f32 v98,-v176,v130,v98
v_fma_f32 v99,-v176,v131,v99
v_fma_f32 v100,-v176,v132,v100
v_fma_f32 v101,-v176,v133,v101
v_mfma_f32_32x32x16_bf16 v[72:87],a[188:191],v[52:55],v[72:87]
v_fma_f32 v102,-v176,v134,v102
v_fma_f32 v103,-v176,v135,v103
v_mul_f32 v96,v96,v177
v_mul_f32 v97,v97,v177
v_mul_f32 v98,v98,v177
s_waitcnt lgkmcnt(3)
v_mfma_f32_32x32x16_bf16 v[56:71],a[32:35],v[24:27],v[56:71]
ds_read_b128 v[44:47],v17 offset:12288
buffer_load_dwordx4 v1,s[8:11],s63 offen offset:2048 sc1 lds
v_mul_f32 v99,v99,v177
v_mul_f32 v100,v100,v177
v_mfma_f32_32x32x16_bf16 v[72:87],a[192:195],v[24:27],v[72:87]
v_mul_f32 v101,v101,v177
v_mul_f32 v102,v102,v177
v_mul_f32 v103,v103,v177
v_cvt_pk_bf16_f32 v184,v96,v97
v_cvt_pk_bf16_f32 v185,v98,v99
v_cvt_pk_bf16_f32 v186,v100,v101
v_mfma_f32_32x32x16_bf16 v[56:71],a[36:39],v[28:31],v[56:71]
ds_read_b128 v[48:51],v16 offset:14336
v_cvt_pk_bf16_f32 v187,v102,v103
buffer_store_dwordx4 v[184:187],v21,s[8:11],s74 offen sc1
v_fma_f32 v104,-v176,v136,v104
v_mfma_f32_32x32x16_bf16 v[72:87],a[196:199],v[28:31],v[72:87]
buffer_load_dwordx4 v1,s[8:11],s63 offen offset:3072 sc1 lds
s_add_u32 m0,s61,4096
s_add_u32 s63,s60,4096
v_fma_f32 v105,-v176,v137,v105
s_waitcnt lgkmcnt(3)
v_mfma_f32_32x32x16_bf16 v[56:71],a[40:43],v[32:35],v[56:71]
ds_read_b128 v[52:55],v17 offset:14336
v_fma_f32 v106,-v176,v138,v106
v_fma_f32 v107,-v176,v139,v107
v_fma_f32 v108,-v176,v140,v108
v_fma_f32 v109,-v176,v141,v109
v_mfma_f32_32x32x16_bf16 v[72:87],a[200:203],v[32:35],v[72:87]
v_fma_f32 v110,-v176,v142,v110
v_fma_f32 v111,-v176,v143,v111
v_mul_f32 v104,v104,v177
v_mul_f32 v105,v105,v177
v_mul_f32 v106,v106,v177
v_mul_f32 v107,v107,v177
v_mfma_f32_32x32x16_bf16 v[56:71],a[44:47],v[36:39],v[56:71]
ds_read_b128 v[24:27],v16 offset:16384
buffer_load_dwordx4 v1,s[8:11],s63 offen sc1 lds
v_mul_f32 v108,v108,v177
v_mul_f32 v109,v109,v177
v_mfma_f32_32x32x16_bf16 v[72:87],a[204:207],v[36:39],v[72:87]
v_mul_f32 v110,v110,v177
v_mul_f32 v111,v111,v177
v_cvt_pk_bf16_f32 v180,v104,v105
v_cvt_pk_bf16_f32 v181,v106,v107
v_cvt_pk_bf16_f32 v182,v108,v109
s_waitcnt lgkmcnt(3)
v_mfma_f32_32x32x16_bf16 v[56:71],a[48:51],v[40:43],v[56:71]
ds_read_b128 v[28:31],v17 offset:16384
v_cvt_pk_bf16_f32 v183,v110,v111
buffer_store_dwordx4 v[180:183],v20,s[8:11],s74 offen offset:2048 sc1
v_fma_f32 v112,-v176,v144,v112
v_mfma_f32_32x32x16_bf16 v[72:87],a[208:211],v[40:43],v[72:87]
buffer_load_dwordx4 v1,s[8:11],s63 offen offset:1024 sc1 lds
v_fma_f32 v113,-v176,v145,v113
v_fma_f32 v114,-v176,v146,v114
v_fma_f32 v115,-v176,v147,v115
v_fma_f32 v116,-v176,v148,v116
v_mfma_f32_32x32x16_bf16 v[56:71],a[52:55],v[44:47],v[56:71]
ds_read_b128 v[32:35],v16 offset:18432
v_fma_f32 v117,-v176,v149,v117
v_fma_f32 v118,-v176,v150,v118
v_fma_f32 v119,-v176,v151,v119
v_mul_f32 v112,v112,v177
v_mfma_f32_32x32x16_bf16 v[72:87],a[212:215],v[44:47],v[72:87]
v_mul_f32 v113,v113,v177
v_mul_f32 v114,v114,v177
v_mul_f32 v115,v115,v177
v_mul_f32 v116,v116,v177
v_mul_f32 v117,v117,v177
s_waitcnt lgkmcnt(3)
v_mfma_f32_32x32x16_bf16 v[56:71],a[56:59],v[48:51],v[56:71]
ds_read_b128 v[36:39],v17 offset:18432
buffer_load_dwordx4 v1,s[8:11],s63 offen offset:2048 sc1 lds
v_mul_f32 v118,v118,v177
v_mul_f32 v119,v119,v177
v_mfma_f32_32x32x16_bf16 v[72:87],a[216:219],v[48:51],v[72:87]
v_cvt_pk_bf16_f32 v184,v112,v113
v_cvt_pk_bf16_f32 v185,v114,v115
v_cvt_pk_bf16_f32 v186,v116,v117
v_cvt_pk_bf16_f32 v187,v118,v119
buffer_store_dwordx4 v[184:187],v21,s[8:11],s74 offen offset:2048 sc1
v_mfma_f32_32x32x16_bf16 v[56:71],a[60:63],v[52:55],v[56:71]
ds_read_b128 v[40:43],v16 offset:20480
s_waitcnt vmcnt(13)
s_mov_b64 exec,1
buffer_store_dword v5,v1,s[8:11],s59 offen sc1
s_mov_b64 exec,-1
s_mov_b32 s59,2147483648
v_mfma_f32_32x32x16_bf16 v[72:87],a[220:223],v[52:55],v[72:87]
buffer_load_dwordx4 v1,s[8:11],s63 offen offset:3072 sc1 lds
s_add_u32 m0,s61,8192
s_add_u32 s63,s60,8192
s_lshl_b32 s82,s72,6
s_waitcnt lgkmcnt(3)
v_mfma_f32_32x32x16_bf16 v[56:71],a[64:67],v[24:27],v[56:71]
ds_read_b128 v[44:47],v17 offset:20480
s_add_u32 s82,s82,s73
s_lshl_b32 s82,s82,9
s_add_u32 s82,s82,s71
s_lshl_b32 s75,s69,2
v_mfma_f32_32x32x16_bf16 v[72:87],a[224:227],v[24:27],v[72:87]
s_add_u32 s82,s82,s75
s_add_u32 s82,s82,s39
v_pk_add_f32 v[156:157],v[156:157],v[166:167]
v_mfma_f32_32x32x16_bf16 v[56:71],a[68:71],v[28:31],v[56:71]
ds_read_b128 v[48:51],v16 offset:22528
buffer_load_dwordx4 v1,s[8:11],s63 offen sc1 lds
v_pk_add_f32 v[158:159],v[158:159],v[168:169]
v_mfma_f32_32x32x16_bf16 v[72:87],a[228:231],v[28:31],v[72:87]
v_pk_add_f32 v[160:161],v[160:161],v[170:171]
v_pk_add_f32 v[162:163],v[162:163],v[172:173]
s_waitcnt lgkmcnt(3)
v_mfma_f32_32x32x16_bf16 v[56:71],a[72:75],v[32:35],v[56:71]
ds_read_b128 v[52:55],v17 offset:22528
v_pk_add_f32 v[164:165],v[164:165],v[174:175]
v_pk_add_f32 v[156:157],v[156:157],v[158:159]
v_mfma_f32_32x32x16_bf16 v[72:87],a[232:235],v[32:35],v[72:87]
buffer_load_dwordx4 v1,s[8:11],s63 offen offset:1024 sc1 lds
s_mov_b32 s53,s33
s_mov_b32 s54,s34
s_cmp_eq_u32 s37,0
s_addc_u32 s32,s32,0
v_mfma_f32_32x32x16_bf16 v[56:71],a[76:79],v[36:39],v[56:71]
ds_read_b128 v[24:27],v16 offset:24576
s_min_u32 s62,s32,127
s_sub_u32 s60,s62,20
s_lshr_b32 s34,s60,1
s_and_b32 s33,s60,1
v_mfma_f32_32x32x16_bf16 v[72:87],a[236:239],v[36:39],v[72:87]
s_xor_b32 s33,s33,1
s_cmp_eq_u32 s33,0
s_cselect_b32 s61,20,0
s_add_u32 s34,s34,s61
s_sub_u32 s61,s60,44
s_waitcnt lgkmcnt(3)
v_mfma_f32_32x32x16_bf16 v[56:71],a[80:83],v[40:43],v[56:71]
ds_read_b128 v[28:31],v17 offset:24576
s_cmp_ge_u32 s60,88
s_cselect_b32 s34,s61,s34
s_cselect_b32 s33,1,s33
v_mfma_f32_32x32x16_bf16 v[72:87],a[240:243],v[40:43],v[72:87]
s_cmp_lt_u32 s62,20
s_cselect_b32 s34,s62,s34
s_cselect_b32 s33,0,s33
s_lshl_b32 s35,s33,6
s_add_u32 s35,s35,s34
s_lshl_b32 s35,s35,9
v_mfma_f32_32x32x16_bf16 v[56:71],a[84:87],v[44:47],v[56:71]
ds_read_b128 v[32:35],v16 offset:26624
s_add_u32 s35,s35,0
s_lshl_b32 s60,s33,5
s_add_u32 s60,s60,7
v_min_u32 v2,s60,v0
v_mfma_f32_32x32x16_bf16 v[72:87],a[244:247],v[44:47],v[72:87]
v_lshlrev_b32 v2,2,v2
v_pk_add_f32 v[160:161],v[160:161],v[162:163]
v_pk_add_f32 v[156:157],v[156:157],v[160:161]
s_waitcnt lgkmcnt(3)
v_mfma_f32_32x32x16_bf16 v[56:71],a[88:91],v[48:51],v[56:71]
ds_read_b128 v[36:39],v17 offset:26624
s_cmp_lg_u32 s46,0
s_cbranch_scc1 w0_230
buffer_load_dword v3,v2,s[8:11],s35 offen sc1
w0_230:
v_mfma_f32_32x32x16_bf16 v[72:87],a[248:251],v[48:51],v[72:87]
v_pk_add_f32 v[156:157],v[156:157],v[164:165]
v_mov_b32 v158,v156
v_mov_b32 v159,v157
s_nop 0
v_permlane32_swap_b32 v156,v158
v_permlane32_swap_b32 v157,v159
v_mfma_f32_32x32x16_bf16 v[56:71],a[92:95],v[52:55],v[56:71]
ds_read_b128 v[40:43],v16 offset:28672
v_add_f32 v176,v156,v158
v_add_f32 v177,v157,v159
v_mul_f32 v176,0x3acccccd,v176
v_mul_f32 v177,0x3acccccd,v177
v_mfma_f32_32x32x16_bf16 v[72:87],a[252:255],v[52:55],v[72:87]
v_fma_f32 v177,-v176,v176,v177
v_max_f32 v177,0,v177
v_cvt_pk_bf16_f32 v8,v176,v177
v_lshlrev_b32 v176,16,v8
v_and_b32 v177,0xffff0000,v8
s_waitcnt lgkmcnt(3)
v_mfma_f32_32x32x16_bf16 v[56:71],a[96:99],v[24:27],v[56:71]
ds_read_b128 v[44:47],v17 offset:28672
v_add_f32 v177,0x3727c5ac,v177
v_cvt_pk_bf16_f32 v8,v177,v177
v_lshlrev_b32 v177,16,v8
v_mfma_f32_32x32x16_bf16 v[72:87],v[192:195],v[24:27],v[72:87]
v_sqrt_f32 v177,v177
s_nop 0
v_cvt_pk_bf16_f32 v8,v177,v177
v_lshlrev_b32 v177,16,v8
v_rcp_f32 v177,v177
v_mfma_f32_32x32x16_bf16 v[56:71],a[100:103],v[28:31],v[56:71]
ds_read_b128 v[48:51],v16 offset:30720
s_cmp_eq_u32 s51,0
s_cselect_b64 s[76:77],-1,0
v_cndmask_b32 v176,v176,0,s[76:77]
v_cndmask_b32 v177,v177,1.0,s[76:77]
v_mfma_f32_32x32x16_bf16 v[72:87],v[196:199],v[28:31],v[72:87]
s_mov_b32 s72,s51
s_mov_b32 s73,s52
s_waitcnt lgkmcnt(3)
v_mfma_f32_32x32x16_bf16 v[56:71],a[104:107],v[32:35],v[56:71]
ds_read_b128 v[52:55],v17 offset:30720
v_mfma_f32_32x32x16_bf16 v[72:87],v[200:203],v[32:35],v[72:87]
v_mfma_f32_32x32x16_bf16 v[56:71],a[108:111],v[36:39],v[56:71]
ds_read_b128 v[24:27],v16 offset:32768
v_mfma_f32_32x32x16_bf16 v[72:87],v[204:207],v[36:39],v[72:87]
s_waitcnt lgkmcnt(3)
v_mfma_f32_32x32x16_bf16 v[56:71],a[112:115],v[40:43],v[56:71]
ds_read_b128 v[28:31],v17 offset:32768
v_mfma_f32_32x32x16_bf16 v[72:87],v[208:211],v[40:43],v[72:87]
v_mfma_f32_32x32x16_bf16 v[56:71],a[116:119],v[44:47],v[56:71]
ds_read_b128 v[32:35],v16 offset:34816
v_mfma_f32_32x32x16_bf16 v[72:87],v[212:215],v[44:47],v[72:87]
s_waitcnt lgkmcnt(3)
v_mfma_f32_32x32x16_bf16 v[56:71],a[120:123],v[48:51],v[56:71]
ds_read_b128 v[36:39],v17 offset:34816
v_mfma_f32_32x32x16_bf16 v[72:87],v[216:219],v[48:51],v[72:87]
v_mfma_f32_32x32x16_bf16 v[56:71],a[124:127],v[52:55],v[56:71]
ds_read_b128 v[40:43],v16 offset:36864
v_mfma_f32_32x32x16_bf16 v[72:87],v[220:223],v[52:55],v[72:87]
s_waitcnt vmcnt(0)
s_cmp_lg_u32 s46,0
s_cbranch_scc1 w0_231
v_cmp_eq_u32 vcc,0,v3
s_cmp_eq_u64 vcc,0
s_cselect_b32 s36,0,2147483648
s_cmp_lt_u32 s32,128
s_cselect_b32 s36,s36,2147483648
v_mov_b32 v23,s36
ds_write_b32 v22,v23
w0_231:
s_waitcnt lgkmcnt(3)
v_mfma_f32_32x32x16_bf16 v[56:71],a[128:131],v[24:27],v[56:71]
ds_read_b128 v[44:47],v17 offset:36864
s_mov_b64 exec,1
buffer_store_dword v5,v1,s[8:11],s82 offen sc1
s_mov_b64 exec,-1
s_mov_b32 s82,2147483648
v_mfma_f32_32x32x16_bf16 v[72:87],v[224:227],v[24:27],v[72:87]
v_mfma_f32_32x32x16_bf16 v[56:71],a[132:135],v[28:31],v[56:71]
ds_read_b128 v[48:51],v16 offset:38912
v_mfma_f32_32x32x16_bf16 v[72:87],v[228:231],v[28:31],v[72:87]
s_waitcnt lgkmcnt(3)
v_mfma_f32_32x32x16_bf16 v[56:71],a[136:139],v[32:35],v[56:71]
ds_read_b128 v[52:55],v17 offset:38912
v_mfma_f32_32x32x16_bf16 v[72:87],v[232:235],v[32:35],v[72:87]
s_waitcnt lgkmcnt(2)
s_barrier
ds_read_b32 v23,v22
v_mfma_f32_32x32x16_bf16 v[56:71],a[140:143],v[36:39],v[56:71]
ds_read_b128 v[24:27],v18 offset:0
v_mfma_f32_32x32x16_bf16 v[72:87],v[236:239],v[36:39],v[72:87]
v_mfma_f32_32x32x16_bf16 v[56:71],a[144:147],v[40:43],v[56:71]
ds_read_b128 v[28:31],v19 offset:0
v_mfma_f32_32x32x16_bf16 v[72:87],v[240:243],v[40:43],v[72:87]
v_mfma_f32_32x32x16_bf16 v[56:71],a[148:151],v[44:47],v[56:71]
ds_read_b128 v[32:35],v18 offset:2048
v_mfma_f32_32x32x16_bf16 v[72:87],v[244:247],v[44:47],v[72:87]
s_waitcnt lgkmcnt(4)
v_mfma_f32_32x32x16_bf16 v[56:71],a[152:155],v[48:51],v[56:71]
ds_read_b128 v[36:39],v19 offset:2048
s_waitcnt lgkmcnt(4)
v_readfirstlane_b32 s38,v23
v_mfma_f32_32x32x16_bf16 v[72:87],v[248:251],v[48:51],v[72:87]
v_mfma_f32_32x32x16_bf16 v[56:71],a[156:159],v[52:55],v[56:71]
ds_read_b128 v[40:43],v18 offset:4096
v_mfma_f32_32x32x16_bf16 v[72:87],v[252:255],v[52:55],v[72:87]
s_cmp_lg_u32 s37,0
s_cbranch_scc1 nf_232
s_cmp_lt_u32 s50,2
s_cbranch_scc1 now_233
s_mov_b32 s39,0
s_add_u32 s50,s50,1
s_sub_u32 s57,46080,s57
s_mov_b32 s51,s53
s_mov_b32 s52,s54
s_mov_b32 s37,s38
s_branch QKVQ_B1
s_nop 0
now_233:
s_mov_b32 s55,0
s_branch nt_234
nf_232:
s_mov_b32 s55,2
s_cmp_lg_u32 s38,0
s_cbranch_scc1 nt_234
s_mov_b32 s55,1
s_mov_b32 s37,0
s_sub_u32 s66,46080,s57
s_lshl_b32 s60,s33,6
s_add_u32 s60,s60,s34
s_mul_i32 s60,s60,46080
s_add_u32 s60,s60,s37
s_add_u32 s60,s60,206569472
s_lshl_b32 s62,s46,10
s_add_u32 s62,s62,40960
s_add_u32 m0,s66,s62
s_add_u32 s63,s60,s62
buffer_load_dwordx4 v1,s[8:11],s63 offen sc1 lds
s_add_u32 m0,s66,45056
s_add_u32 s63,s60,45056
buffer_load_dwordx4 v1,s[8:11],s63 offen sc1 lds
s_mul_i32 s61,s46,10240
s_add_u32 s60,s60,s61
s_add_u32 s61,s61,s66
s_add_u32 m0,s61,0
s_add_u32 s63,s60,0
buffer_load_dwordx4 v1,s[8:11],s63 offen sc1 lds
buffer_load_dwordx4 v1,s[8:11],s63 offen offset:1024 sc1 lds
buffer_load_dwordx4 v1,s[8:11],s63 offen offset:2048 sc1 lds
buffer_load_dwordx4 v1,s[8:11],s63 offen offset:3072 sc1 lds
s_add_u32 m0,s61,4096
s_add_u32 s63,s60,4096
buffer_load_dwordx4 v1,s[8:11],s63 offen sc1 lds
buffer_load_dwordx4 v1,s[8:11],s63 offen offset:1024 sc1 lds
buffer_load_dwordx4 v1,s[8:11],s63 offen offset:2048 sc1 lds
buffer_load_dwordx4 v1,s[8:11],s63 offen offset:3072 sc1 lds
s_add_u32 m0,s61,8192
s_add_u32 s63,s60,8192
buffer_load_dwordx4 v1,s[8:11],s63 offen sc1 lds
buffer_load_dwordx4 v1,s[8:11],s63 offen offset:1024 sc1 lds
nt_234:
s_mov_b32 s39,0
s_mul_i32 s74,s73,393216
s_add_u32 s74,s74,s39
s_add_u32 s74,s74,s70
v_fma_f32 v56,-v176,v120,v56
v_fma_f32 v57,-v176,v121,v57
v_fma_f32 v58,-v176,v122,v58
v_fma_f32 v59,-v176,v123,v59
v_fma_f32 v60,-v176,v124,v60
v_fma_f32 v61,-v176,v125,v61
v_fma_f32 v62,-v176,v126,v62
v_fma_f32 v63,-v176,v127,v63
v_mul_f32 v56,v56,v177
v_mul_f32 v57,v57,v177
v_mul_f32 v58,v58,v177
v_mul_f32 v59,v59,v177
v_mul_f32 v60,v60,v177
v_mul_f32 v61,v61,v177
v_mul_f32 v62,v62,v177
v_mul_f32 v63,v63,v177
v_cvt_pk_bf16_f32 v180,v56,v57
v_cvt_pk_bf16_f32 v181,v58,v59
v_cvt_pk_bf16_f32 v182,v60,v61
v_cvt_pk_bf16_f32 v183,v62,v63
buffer_store_dwordx4 v[180:183],v20,s[8:11],s74 offen sc1
v_fma_f32 v64,-v176,v128,v64
v_fma_f32 v65,-v176,v129,v65
v_fma_f32 v66,-v176,v130,v66
v_fma_f32 v67,-v176,v131,v67
v_fma_f32 v68,-v176,v132,v68
v_fma_f32 v69,-v176,v133,v69
v_fma_f32 v70,-v176,v134,v70
v_fma_f32 v71,-v176,v135,v71
v_mul_f32 v64,v64,v177
v_mul_f32 v65,v65,v177
v_mul_f32 v66,v66,v177
v_mul_f32 v67,v67,v177
v_mul_f32 v68,v68,v177
v_mul_f32 v69,v69,v177
v_mul_f32 v70,v70,v177
v_mul_f32 v71,v71,v177
v_cvt_pk_bf16_f32 v184,v64,v65
v_cvt_pk_bf16_f32 v185,v66,v67
v_cvt_pk_bf16_f32 v186,v68,v69
v_cvt_pk_bf16_f32 v187,v70,v71
buffer_store_dwordx4 v[184:187],v21,s[8:11],s74 offen sc1
v_fma_f32 v72,-v176,v136,v72
v_fma_f32 v73,-v176,v137,v73
v_fma_f32 v74,-v176,v138,v74
v_fma_f32 v75,-v176,v139,v75
v_fma_f32 v76,-v176,v140,v76
v_fma_f32 v77,-v176,v141,v77
v_fma_f32 v78,-v176,v142,v78
v_fma_f32 v79,-v176,v143,v79
v_mul_f32 v72,v72,v177
v_mul_f32 v73,v73,v177
v_mul_f32 v74,v74,v177
v_mul_f32 v75,v75,v177
v_mul_f32 v76,v76,v177
v_mul_f32 v77,v77,v177
v_mul_f32 v78,v78,v177
v_mul_f32 v79,v79,v177
v_cvt_pk_bf16_f32 v180,v72,v73
v_cvt_pk_bf16_f32 v181,v74,v75
v_cvt_pk_bf16_f32 v182,v76,v77
v_cvt_pk_bf16_f32 v183,v78,v79
buffer_store_dwordx4 v[180:183],v20,s[8:11],s74 offen offset:2048 sc1
v_fma_f32 v80,-v176,v144,v80
v_fma_f32 v81,-v176,v145,v81
v_fma_f32 v82,-v176,v146,v82
v_fma_f32 v83,-v176,v147,v83
v_fma_f32 v84,-v176,v148,v84
v_fma_f32 v85,-v176,v149,v85
v_fma_f32 v86,-v176,v150,v86
v_fma_f32 v87,-v176,v151,v87
v_mul_f32 v80,v80,v177
v_mul_f32 v81,v81,v177
v_mul_f32 v82,v82,v177
v_mul_f32 v83,v83,v177
v_mul_f32 v84,v84,v177
v_mul_f32 v85,v85,v177
v_mul_f32 v86,v86,v177
v_mul_f32 v87,v87,v177
v_cvt_pk_bf16_f32 v184,v80,v81
v_cvt_pk_bf16_f32 v185,v82,v83
v_cvt_pk_bf16_f32 v186,v84,v85
v_cvt_pk_bf16_f32 v187,v86,v87
buffer_store_dwordx4 v[184:187],v21,s[8:11],s74 offen offset:2048 sc1
s_lshl_b32 s82,s72,6
s_add_u32 s82,s82,s73
s_lshl_b32 s82,s82,9
s_add_u32 s82,s82,s71
s_lshl_b32 s75,s69,2
s_add_u32 s82,s82,s75
s_add_u32 s82,s82,s39
s_mov_b32 s59,s82
s_mov_b32 s82,2147483648
s_mov_b32 s39,2147483648
s_add_u32 s50,s50,1
s_sub_u32 s57,46080,s57
s_mov_b32 s51,s53
s_mov_b32 s52,s54
s_mov_b32 s37,s38
s_cmp_eq_u32 s55,0
s_cbranch_scc1 QKVQ_B1
s_cmp_eq_u32 s55,1
s_cbranch_scc1 QKVQ_CD1
s_waitcnt vmcnt(0)
s_mov_b64 exec,1
buffer_store_dword v5,v1,s[8:11],s59 offen sc1
s_mov_b64 exec,-1
s_mov_b32 s59,2147483648
s_cmp_eq_u32 s50,128
s_cbranch_scc1 QKVQ_END
s_branch QKVQ_COLD1
QKVQ_COLD1:
s_cmp_lg_u32 s46,0
s_cbranch_scc1 cp_235
fb_236:
buffer_load_dword v3,v2,s[8:11],s35 offen sc1
s_waitcnt vmcnt(0)
v_cmp_eq_u32 vcc,0,v3
s_nop 0
s_cbranch_vccz ok_237
s_sleep 7
s_sub_u32 s47,s47,1
s_cbranch_scc1 ABORT
s_branch fb_236
ok_237:
cp_235:
s_barrier
s_lshl_b32 s60,s33,6
s_add_u32 s60,s60,s34
s_mul_i32 s60,s60,46080
s_add_u32 s60,s60,206569472
s_lshl_b32 s62,s46,10
s_add_u32 s62,s62,40960
s_add_u32 m0,s57,s62
s_add_u32 s63,s60,s62
buffer_load_dwordx4 v1,s[8:11],s63 offen sc1 lds
s_add_u32 m0,s57,45056
s_add_u32 s63,s60,45056
buffer_load_dwordx4 v1,s[8:11],s63 offen sc1 lds
s_mul_i32 s61,s46,10240
s_add_u32 s60,s60,s61
s_add_u32 s61,s61,s57
s_add_u32 m0,s61,0
s_add_u32 s63,s60,0
buffer_load_dwordx4 v1,s[8:11],s63 offen sc1 lds
buffer_load_dwordx4 v1,s[8:11],s63 offen offset:1024 sc1 lds
buffer_load_dwordx4 v1,s[8:11],s63 offen offset:2048 sc1 lds
buffer_load_dwordx4 v1,s[8:11],s63 offen offset:3072 sc1 lds
s_add_u32 m0,s61,4096
s_add_u32 s63,s60,4096
buffer_load_dwordx4 v1,s[8:11],s63 offen sc1 lds
buffer_load_dwordx4 v1,s[8:11],s63 offen offset:1024 sc1 lds
buffer_load_dwordx4 v1,s[8:11],s63 offen offset:2048 sc1 lds
buffer_load_dwordx4 v1,s[8:11],s63 offen offset:3072 sc1 lds
s_add_u32 m0,s61,8192
s_add_u32 s63,s60,8192
buffer_load_dwordx4 v1,s[8:11],s63 offen sc1 lds
buffer_load_dwordx4 v1,s[8:11],s63 offen offset:1024 sc1 lds
QKVQ_CD1:
s_mov_b32 s51,s33
s_mov_b32 s52,s34
s_add_u32 s32,s32,1
s_min_u32 s62,s32,127
s_sub_u32 s60,s62,20
s_lshr_b32 s34,s60,1
s_and_b32 s33,s60,1
s_xor_b32 s33,s33,1
s_cmp_eq_u32 s33,0
s_cselect_b32 s61,20,0
s_add_u32 s34,s34,s61
s_sub_u32 s61,s60,44
s_cmp_ge_u32 s60,88
s_cselect_b32 s34,s61,s34
s_cselect_b32 s33,1,s33
s_cmp_lt_u32 s62,20
s_cselect_b32 s34,s62,s34
s_cselect_b32 s33,0,s33
s_lshl_b32 s35,s33,6
s_add_u32 s35,s35,s34
s_lshl_b32 s35,s35,9
s_add_u32 s35,s35,0
s_lshl_b32 s60,s33,5
s_add_u32 s60,s60,7
v_min_u32 v2,s60,v0
v_lshlrev_b32 v2,2,v2
s_cmp_lg_u32 s46,0
s_cbranch_scc1 w0_238
buffer_load_dword v3,v2,s[8:11],s35 offen sc1
w0_238:
s_waitcnt vmcnt(0)
s_mov_b64 exec,1
buffer_store_dword v5,v1,s[8:11],s59 offen sc1
s_mov_b64 exec,-1
s_mov_b32 s59,2147483648
s_cmp_lg_u32 s46,0
s_cbranch_scc1 w0_239
v_cmp_eq_u32 vcc,0,v3
s_cmp_eq_u64 vcc,0
s_cselect_b32 s36,0,2147483648
s_cmp_lt_u32 s32,128
s_cselect_b32 s36,s36,2147483648
v_mov_b32 v23,s36
ds_write_b32 v22,v23
w0_239:
s_waitcnt lgkmcnt(0)
s_barrier
ds_read_b32 v23,v22
ds_read_b128 v[24:27],v18 offset:0
ds_read_b128 v[28:31],v19 offset:0
ds_read_b128 v[32:35],v18 offset:2048
ds_read_b128 v[36:39],v19 offset:2048
ds_read_b128 v[40:43],v18 offset:4096
s_waitcnt lgkmcnt(5)
v_readfirstlane_b32 s37,v23
s_nop 4
QKVQ_B1:
s_waitcnt lgkmcnt(3)
v_mfma_f32_32x32x16_bf16 v[88:103],a[0:3],v[24:27],0
ds_read_b128 v[44:47],v19 offset:4096
v_add_u32 v189,s57,v188
v_mfma_f32_32x32x16_bf16 v[104:119],a[160:163],v[24:27],0
v_add_u32 v8,0x800,v189
s_sub_u32 s66,46080,s57
s_lshl_b32 s60,s33,6
s_add_u32 s60,s60,s34
s_mul_i32 s60,s60,46080
s_add_u32 s60,s60,s37
v_mfma_f32_32x32x16_bf16 v[88:103],a[4:7],v[28:31],v[88:103]
ds_read_b128 v[48:51],v18 offset:6144
ds_read2_b64 v[156:159],v189 offset0:0 offset1:32
s_add_u32 s60,s60,206569472
s_lshl_b32 s62,s46,10
v_mfma_f32_32x32x16_bf16 v[104:119],a[164:167],v[28:31],v[104:119]
ds_read2_b64 v[160:163],v189 offset0:64 offset1:96
s_add_u32 s62,s62,40960
s_add_u32 m0,s66,s62
s_add_u32 s63,s60,s62
s_waitcnt lgkmcnt(5)
v_mfma_f32_32x32x16_bf16 v[88:103],a[8:11],v[32:35],v[88:103]
ds_read_b128 v[52:55],v19 offset:6144
ds_read2_b64 v[164:167],v189 offset0:128 offset1:160
buffer_load_dwordx4 v1,s[8:11],s63 offen sc1 lds
v_mfma_f32_32x32x16_bf16 v[104:119],a[168:171],v[32:35],v[104:119]
ds_read2_b64 v[168:171],v189 offset0:192 offset1:224
s_add_u32 m0,s66,45056
s_add_u32 s63,s60,45056
s_mul_i32 s74,s73,393216
s_add_u32 s74,s74,s39
v_mfma_f32_32x32x16_bf16 v[88:103],a[12:15],v[36:39],v[88:103]
ds_read_b128 v[24:27],v18 offset:8192
ds_read2_b64 v[172:175],v8 offset0:0 offset1:32
s_add_u32 s74,s74,s70
v_fma_f32 v56,-v176,v120,v56
v_mfma_f32_32x32x16_bf16 v[104:119],a[172:175],v[36:39],v[104:119]
buffer_load_dwordx4 v1,s[8:11],s63 offen sc1 lds
s_mul_i32 s61,s46,10240
s_add_u32 s60,s60,s61
s_add_u32 s61,s61,s66
s_waitcnt lgkmcnt(8)
v_mfma_f32_32x32x16_bf16 v[88:103],a[16:19],v[40:43],v[88:103]
ds_read_b128 v[28:31],v19 offset:8192
s_add_u32 m0,s61,0
s_add_u32 s63,s60,0
v_fma_f32 v57,-v176,v121,v57
v_fma_f32 v58,-v176,v122,v58
v_mfma_f32_32x32x16_bf16 v[104:119],a[176:179],v[40:43],v[104:119]
v_fma_f32 v59,-v176,v123,v59
v_fma_f32 v60,-v176,v124,v60
v_fma_f32 v61,-v176,v125,v61
v_fma_f32 v62,-v176,v126,v62
v_fma_f32 v63,-v176,v127,v63
v_mul_f32 v56,v56,v177
v_mfma_f32_32x32x16_bf16 v[88:103],a[20:23],v[44:47],v[88:103]
ds_read_b128 v[32:35],v18 offset:10240
buffer_load_dwordx4 v1,s[8:11],s63 offen sc1 lds
v_mul_f32 v57,v57,v177
v_mul_f32 v58,v58,v177
v_mfma_f32_32x32x16_bf16 v[104:119],a[180:183],v[44:47],v[104:119]
v_mul_f32 v59,v59,v177
v_mul_f32 v60,v60,v177
v_mul_f32 v61,v61,v177
v_mul_f32 v62,v62,v177
v_mul_f32 v63,v63,v177
s_waitcnt lgkmcnt(6)
v_mfma_f32_32x32x16_bf16 v[88:103],a[24:27],v[48:51],v[88:103]
ds_read_b128 v[36:39],v19 offset:10240
v_cvt_pk_bf16_f32 v180,v56,v57
v_cvt_pk_bf16_f32 v181,v58,v59
v_cvt_pk_bf16_f32 v182,v60,v61
v_cvt_pk_bf16_f32 v183,v62,v63
v_mfma_f32_32x32x16_bf16 v[104:119],a[184:187],v[48:51],v[104:119]
buffer_load_dwordx4 v1,s[8:11],s63 offen offset:1024 sc1 lds
buffer_store_dwordx4 v[180:183],v20,s[8:11],s74 offen sc1
v_fma_f32 v64,-v176,v128,v64
v_fma_f32 v65,-v176,v129,v65
v_mfma_f32_32x32x16_bf16 v[88:103],a[28:31],v[52:55],v[88:103]
ds_read_b128 v[40:43],v18 offset:12288
v_fma_f32 v66,-v176,v130,v66
v_fma_f32 v67,-v176,v131,v67
v_fma_f32 v68,-v176,v132,v68
v_fma_f32 v69,-v176,v133,v69
v_mfma_f32_32x32x16_bf16 v[104:119],a[188:191],v[52:55],v[104:119]
v_fma_f32 v70,-v176,v134,v70
v_fma_f32 v71,-v176,v135,v71
v_mul_f32 v64,v64,v177
v_mul_f32 v65,v65,v177
v_mul_f32 v66,v66,v177
s_waitcnt lgkmcnt(3)
v_mfma_f32_32x32x16_bf16 v[88:103],a[32:35],v[24:27],v[88:103]
ds_read_b128 v[44:47],v19 offset:12288
buffer_load_dwordx4 v1,s[8:11],s63 offen offset:2048 sc1 lds
v_mul_f32 v67,v67,v177
v_mul_f32 v68,v68,v177
v_mfma_f32_32x32x16_bf16 v[104:119],a[192:195],v[24:27],v[104:119]
v_mul_f32 v69,v69,v177
v_mul_f32 v70,v70,v177
v_mul_f32 v71,v71,v177
v_cvt_pk_bf16_f32 v184,v64,v65
v_cvt_pk_bf16_f32 v185,v66,v67
v_cvt_pk_bf16_f32 v186,v68,v69
v_mfma_f32_32x32x16_bf16 v[88:103],a[36:39],v[28:31],v[88:103]
ds_read_b128 v[48:51],v18 offset:14336
v_cvt_pk_bf16_f32 v187,v70,v71
buffer_store_dwordx4 v[184:187],v21,s[8:11],s74 offen sc1
v_fma_f32 v72,-v176,v136,v72
v_mfma_f32_32x32x16_bf16 v[104:119],a[196:199],v[28:31],v[104:119]
buffer_load_dwordx4 v1,s[8:11],s63 offen offset:3072 sc1 lds
s_add_u32 m0,s61,4096
s_add_u32 s63,s60,4096
v_fma_f32 v73,-v176,v137,v73
s_waitcnt lgkmcnt(3)
v_mfma_f32_32x32x16_bf16 v[88:103],a[40:43],v[32:35],v[88:103]
ds_read_b128 v[52:55],v19 offset:14336
v_fma_f32 v74,-v176,v138,v74
v_fma_f32 v75,-v176,v139,v75
v_fma_f32 v76,-v176,v140,v76
v_fma_f32 v77,-v176,v141,v77
v_mfma_f32_32x32x16_bf16 v[104:119],a[200:203],v[32:35],v[104:119]
v_fma_f32 v78,-v176,v142,v78
v_fma_f32 v79,-v176,v143,v79
v_mul_f32 v72,v72,v177
v_mul_f32 v73,v73,v177
v_mul_f32 v74,v74,v177
v_mul_f32 v75,v75,v177
v_mfma_f32_32x32x16_bf16 v[88:103],a[44:47],v[36:39],v[88:103]
ds_read_b128 v[24:27],v18 offset:16384
buffer_load_dwordx4 v1,s[8:11],s63 offen sc1 lds
v_mul_f32 v76,v76,v177
v_mul_f32 v77,v77,v177
v_mfma_f32_32x32x16_bf16 v[104:119],a[204:207],v[36:39],v[104:119]
v_mul_f32 v78,v78,v177
v_mul_f32 v79,v79,v177
v_cvt_pk_bf16_f32 v180,v72,v73
v_cvt_pk_bf16_f32 v181,v74,v75
v_cvt_pk_bf16_f32 v182,v76,v77
s_waitcnt lgkmcnt(3)
v_mfma_f32_32x32x16_bf16 v[88:103],a[48:51],v[40:43],v[88:103]
ds_read_b128 v[28:31],v19 offset:16384
v_cvt_pk_bf16_f32 v183,v78,v79
buffer_store_dwordx4 v[180:183],v20,s[8:11],s74 offen offset:2048 sc1
v_fma_f32 v80,-v176,v144,v80
v_mfma_f32_32x32x16_bf16 v[104:119],a[208:211],v[40:43],v[104:119]
buffer_load_dwordx4 v1,s[8:11],s63 offen offset:1024 sc1 lds
v_fma_f32 v81,-v176,v145,v81
v_fma_f32 v82,-v176,v146,v82
v_fma_f32 v83,-v176,v147,v83
v_fma_f32 v84,-v176,v148,v84
v_mfma_f32_32x32x16_bf16 v[88:103],a[52:55],v[44:47],v[88:103]
ds_read_b128 v[32:35],v18 offset:18432
v_fma_f32 v85,-v176,v149,v85
v_fma_f32 v86,-v176,v150,v86
v_fma_f32 v87,-v176,v151,v87
v_mul_f32 v80,v80,v177
v_mfma_f32_32x32x16_bf16 v[104:119],a[212:215],v[44:47],v[104:119]
v_mul_f32 v81,v81,v177
v_mul_f32 v82,v82,v177
v_mul_f32 v83,v83,v177
v_mul_f32 v84,v84,v177
v_mul_f32 v85,v85,v177
s_waitcnt lgkmcnt(3)
v_mfma_f32_32x32x16_bf16 v[88:103],a[56:59],v[48:51],v[88:103]
ds_read_b128 v[36:39],v19 offset:18432
buffer_load_dwordx4 v1,s[8:11],s63 offen offset:2048 sc1 lds
v_mul_f32 v86,v86,v177
v_mul_f32 v87,v87,v177
v_mfma_f32_32x32x16_bf16 v[104:119],a[216:219],v[48:51],v[104:119]
v_cvt_pk_bf16_f32 v184,v80,v81
v_cvt_pk_bf16_f32 v185,v82,v83
v_cvt_pk_bf16_f32 v186,v84,v85
v_cvt_pk_bf16_f32 v187,v86,v87
buffer_store_dwordx4 v[184:187],v21,s[8:11],s74 offen offset:2048 sc1
v_mfma_f32_32x32x16_bf16 v[88:103],a[60:63],v[52:55],v[88:103]
ds_read_b128 v[40:43],v18 offset:20480
s_waitcnt vmcnt(13)
s_mov_b64 exec,1
buffer_store_dword v5,v1,s[8:11],s59 offen sc1
s_mov_b64 exec,-1
s_mov_b32 s59,2147483648
v_mfma_f32_32x32x16_bf16 v[104:119],a[220:223],v[52:55],v[104:119]
buffer_load_dwordx4 v1,s[8:11],s63 offen offset:3072 sc1 lds
s_add_u32 m0,s61,8192
s_add_u32 s63,s60,8192
s_lshl_b32 s82,s72,6
s_waitcnt lgkmcnt(3)
v_mfma_f32_32x32x16_bf16 v[88:103],a[64:67],v[24:27],v[88:103]
ds_read_b128 v[44:47],v19 offset:20480
s_add_u32 s82,s82,s73
s_lshl_b32 s82,s82,9
s_add_u32 s82,s82,s71
s_lshl_b32 s75,s69,2
v_mfma_f32_32x32x16_bf16 v[104:119],a[224:227],v[24:27],v[104:119]
s_add_u32 s82,s82,s75
s_add_u32 s82,s82,s39
v_pk_add_f32 v[156:157],v[156:157],v[166:167]
v_mfma_f32_32x32x16_bf16 v[88:103],a[68:71],v[28:31],v[88:103]
ds_read_b128 v[48:51],v18 offset:22528
buffer_load_dwordx4 v1,s[8:11],s63 offen sc1 lds
v_pk_add_f32 v[158:159],v[158:159],v[168:169]
v_mfma_f32_32x32x16_bf16 v[104:119],a[228:231],v[28:31],v[104:119]
v_pk_add_f32 v[160:161],v[160:161],v[170:171]
v_pk_add_f32 v[162:163],v[162:163],v[172:173]
s_waitcnt lgkmcnt(3)
v_mfma_f32_32x32x16_bf16 v[88:103],a[72:75],v[32:35],v[88:103]
ds_read_b128 v[52:55],v19 offset:22528
v_pk_add_f32 v[164:165],v[164:165],v[174:175]
v_pk_add_f32 v[156:157],v[156:157],v[158:159]
v_mfma_f32_32x32x16_bf16 v[104:119],a[232:235],v[32:35],v[104:119]
buffer_load_dwordx4 v1,s[8:11],s63 offen offset:1024 sc1 lds
s_mov_b32 s53,s33
s_mov_b32 s54,s34
s_cmp_eq_u32 s37,0
s_addc_u32 s32,s32,0
v_mfma_f32_32x32x16_bf16 v[88:103],a[76:79],v[36:39],v[88:103]
ds_read_b128 v[24:27],v18 offset:24576
s_min_u32 s62,s32,127
s_sub_u32 s60,s62,20
s_lshr_b32 s34,s60,1
s_and_b32 s33,s60,1
v_mfma_f32_32x32x16_bf16 v[104:119],a[236:239],v[36:39],v[104:119]
s_xor_b32 s33,s33,1
s_cmp_eq_u32 s33,0
s_cselect_b32 s61,20,0
s_add_u32 s34,s34,s61
s_sub_u32 s61,s60,44
s_waitcnt lgkmcnt(3)
v_mfma_f32_32x32x16_bf16 v[88:103],a[80:83],v[40:43],v[88:103]
ds_read_b128 v[28:31],v19 offset:24576
s_cmp_ge_u32 s60,88
s_cselect_b32 s34,s61,s34
s_cselect_b32 s33,1,s33
v_mfma_f32_32x32x16_bf16 v[104:119],a[240:243],v[40:43],v[104:119]
s_cmp_lt_u32 s62,20
s_cselect_b32 s34,s62,s34
s_cselect_b32 s33,0,s33
s_lshl_b32 s35,s33,6
s_add_u32 s35,s35,s34
s_lshl_b32 s35,s35,9
v_mfma_f32_32x32x16_bf16 v[88:103],a[84:87],v[44:47],v[88:103]
ds_read_b128 v[32:35],v18 offset:26624
s_add_u32 s35,s35,0
s_lshl_b32 s60,s33,5
s_add_u32 s60,s60,7
v_min_u32 v2,s60,v0
v_mfma_f32_32x32x16_bf16 v[104:119],a[244:247],v[44:47],v[104:119]
v_lshlrev_b32 v2,2,v2
v_pk_add_f32 v[160:161],v[160:161],v[162:163]
v_pk_add_f32 v[156:157],v[156:157],v[160:161]
s_waitcnt lgkmcnt(3)
v_mfma_f32_32x32x16_bf16 v[88:103],a[88:91],v[48:51],v[88:103]
ds_read_b128 v[36:39],v19 offset:26624
s_cmp_lg_u32 s46,0
s_cbranch_scc1 w0_240
buffer_load_dword v3,v2,s[8:11],s35 offen sc1
w0_240:
v_mfma_f32_32x32x16_bf16 v[104:119],a[248:251],v[48:51],v[104:119]
v_pk_add_f32 v[156:157],v[156:157],v[164:165]
v_mov_b32 v158,v156
v_mov_b32 v159,v157
s_nop 0
v_permlane32_swap_b32 v156,v158
v_permlane32_swap_b32 v157,v159
v_mfma_f32_32x32x16_bf16 v[88:103],a[92:95],v[52:55],v[88:103]
ds_read_b128 v[40:43],v18 offset:28672
v_add_f32 v176,v156,v158
v_add_f32 v177,v157,v159
v_mul_f32 v176,0x3acccccd,v176
v_mul_f32 v177,0x3acccccd,v177
v_mfma_f32_32x32x16_bf16 v[104:119],a[252:255],v[52:55],v[104:119]
v_fma_f32 v177,-v176,v176,v177
v_max_f32 v177,0,v177
v_cvt_pk_bf16_f32 v8,v176,v177
v_lshlrev_b32 v176,16,v8
v_and_b32 v177,0xffff0000,v8
s_waitcnt lgkmcnt(3)
v_mfma_f32_32x32x16_bf16 v[88:103],a[96:99],v[24:27],v[88:103]
ds_read_b128 v[44:47],v19 offset:28672
v_add_f32 v177,0x3727c5ac,v177
v_cvt_pk_bf16_f32 v8,v177,v177
v_lshlrev_b32 v177,16,v8
v_mfma_f32_32x32x16_bf16 v[104:119],v[192:195],v[24:27],v[104:119]
v_sqrt_f32 v177,v177
s_nop 0
v_cvt_pk_bf16_f32 v8,v177,v177
v_lshlrev_b32 v177,16,v8
v_rcp_f32 v177,v177
v_mfma_f32_32x32x16_bf16 v[88:103],a[100:103],v[28:31],v[88:103]
ds_read_b128 v[48:51],v18 offset:30720
s_cmp_eq_u32 s51,0
s_cselect_b64 s[76:77],-1,0
v_cndmask_b32 v176,v176,0,s[76:77]
v_cndmask_b32 v177,v177,1.0,s[76:77]
v_mfma_f32_32x32x16_bf16 v[104:119],v[196:199],v[28:31],v[104:119]
s_mov_b32 s72,s51
s_mov_b32 s73,s52
s_waitcnt lgkmcnt(3)
v_mfma_f32_32x32x16_bf16 v[88:103],a[104:107],v[32:35],v[88:103]
ds_read_b128 v[52:55],v19 offset:30720
v_mfma_f32_32x32x16_bf16 v[104:119],v[200:203],v[32:35],v[104:119]
v_mfma_f32_32x32x16_bf16 v[88:103],a[108:111],v[36:39],v[88:103]
ds_read_b128 v[24:27],v18 offset:32768
v_mfma_f32_32x32x16_bf16 v[104:119],v[204:207],v[36:39],v[104:119]
s_waitcnt lgkmcnt(3)
v_mfma_f32_32x32x16_bf16 v[88:103],a[112:115],v[40:43],v[88:103]
ds_read_b128 v[28:31],v19 offset:32768
v_mfma_f32_32x32x16_bf16 v[104:119],v[208:211],v[40:43],v[104:119]
v_mfma_f32_32x32x16_bf16 v[88:103],a[116:119],v[44:47],v[88:103]
ds_read_b128 v[32:35],v18 offset:34816
v_mfma_f32_32x32x16_bf16 v[104:119],v[212:215],v[44:47],v[104:119]
s_waitcnt lgkmcnt(3)
v_mfma_f32_32x32x16_bf16 v[88:103],a[120:123],v[48:51],v[88:103]
ds_read_b128 v[36:39],v19 offset:34816
v_mfma_f32_32x32x16_bf16 v[104:119],v[216:219],v[48:51],v[104:119]
v_mfma_f32_32x32x16_bf16 v[88:103],a[124:127],v[52:55],v[88:103]
ds_read_b128 v[40:43],v18 offset:36864
v_mfma_f32_32x32x16_bf16 v[104:119],v[220:223],v[52:55],v[104:119]
s_waitcnt vmcnt(0)
s_cmp_lg_u32 s46,0
s_cbranch_scc1 w0_241
v_cmp_eq_u32 vcc,0,v3
s_cmp_eq_u64 vcc,0
s_cselect_b32 s36,0,2147483648
s_cmp_lt_u32 s32,128
s_cselect_b32 s36,s36,2147483648
v_mov_b32 v23,s36
ds_write_b32 v22,v23
w0_241:
s_waitcnt lgkmcnt(3)
v_mfma_f32_32x32x16_bf16 v[88:103],a[128:131],v[24:27],v[88:103]
ds_read_b128 v[44:47],v19 offset:36864
s_mov_b64 exec,1
buffer_store_dword v5,v1,s[8:11],s82 offen sc1
s_mov_b64 exec,-1
s_mov_b32 s82,2147483648
v_mfma_f32_32x32x16_bf16 v[104:119],v[224:227],v[24:27],v[104:119]
v_mfma_f32_32x32x16_bf16 v[88:103],a[132:135],v[28:31],v[88:103]
ds_read_b128 v[48:51],v18 offset:38912
v_mfma_f32_32x32x16_bf16 v[104:119],v[228:231],v[28:31],v[104:119]
s_waitcnt lgkmcnt(3)
v_mfma_f32_32x32x16_bf16 v[88:103],a[136:139],v[32:35],v[88:103]
ds_read_b128 v[52:55],v19 offset:38912
v_mfma_f32_32x32x16_bf16 v[104:119],v[232:235],v[32:35],v[104:119]
s_waitcnt lgkmcnt(2)
s_barrier
ds_read_b32 v23,v22
v_mfma_f32_32x32x16_bf16 v[88:103],a[140:143],v[36:39],v[88:103]
ds_read_b128 v[24:27],v16 offset:0
v_mfma_f32_32x32x16_bf16 v[104:119],v[236:239],v[36:39],v[104:119]
v_mfma_f32_32x32x16_bf16 v[88:103],a[144:147],v[40:43],v[88:103]
ds_read_b128 v[28:31],v17 offset:0
v_mfma_f32_32x32x16_bf16 v[104:119],v[240:243],v[40:43],v[104:119]
v_mfma_f32_32x32x16_bf16 v[88:103],a[148:151],v[44:47],v[88:103]
ds_read_b128 v[32:35],v16 offset:2048
v_mfma_f32_32x32x16_bf16 v[104:119],v[244:247],v[44:47],v[104:119]
s_waitcnt lgkmcnt(4)
v_mfma_f32_32x32x16_bf16 v[88:103],a[152:155],v[48:51],v[88:103]
ds_read_b128 v[36:39],v17 offset:2048
s_waitcnt lgkmcnt(4)
v_readfirstlane_b32 s38,v23
v_mfma_f32_32x32x16_bf16 v[104:119],v[248:251],v[48:51],v[104:119]
v_mfma_f32_32x32x16_bf16 v[88:103],a[156:159],v[52:55],v[88:103]
ds_read_b128 v[40:43],v16 offset:4096
v_mfma_f32_32x32x16_bf16 v[104:119],v[252:255],v[52:55],v[104:119]
s_cmp_lg_u32 s37,0
s_cbranch_scc1 nf_242
s_cmp_lt_u32 s50,2
s_cbranch_scc1 now_243
s_mov_b32 s39,0
s_add_u32 s50,s50,1
s_sub_u32 s57,46080,s57
s_mov_b32 s51,s53
s_mov_b32 s52,s54
s_mov_b32 s37,s38
s_branch QKVQ_B0
s_nop 0
now_243:
s_mov_b32 s55,0
s_branch nt_244
nf_242:
s_mov_b32 s55,2
s_cmp_lg_u32 s38,0
s_cbranch_scc1 nt_244
s_mov_b32 s55,1
s_mov_b32 s37,0
s_sub_u32 s66,46080,s57
s_lshl_b32 s60,s33,6
s_add_u32 s60,s60,s34
s_mul_i32 s60,s60,46080
s_add_u32 s60,s60,s37
s_add_u32 s60,s60,206569472
s_lshl_b32 s62,s46,10
s_add_u32 s62,s62,40960
s_add_u32 m0,s66,s62
s_add_u32 s63,s60,s62
buffer_load_dwordx4 v1,s[8:11],s63 offen sc1 lds
s_add_u32 m0,s66,45056
s_add_u32 s63,s60,45056
buffer_load_dwordx4 v1,s[8:11],s63 offen sc1 lds
s_mul_i32 s61,s46,10240
s_add_u32 s60,s60,s61
s_add_u32 s61,s61,s66
s_add_u32 m0,s61,0
s_add_u32 s63,s60,0
buffer_load_dwordx4 v1,s[8:11],s63 offen sc1 lds
buffer_load_dwordx4 v1,s[8:11],s63 offen offset:1024 sc1 lds
buffer_load_dwordx4 v1,s[8:11],s63 offen offset:2048 sc1 lds
buffer_load_dwordx4 v1,s[8:11],s63 offen offset:3072 sc1 lds
s_add_u32 m0,s61,4096
s_add_u32 s63,s60,4096
buffer_load_dwordx4 v1,s[8:11],s63 offen sc1 lds
buffer_load_dwordx4 v1,s[8:11],s63 offen offset:1024 sc1 lds
buffer_load_dwordx4 v1,s[8:11],s63 offen offset:2048 sc1 lds
buffer_load_dwordx4 v1,s[8:11],s63 offen offset:3072 sc1 lds
s_add_u32 m0,s61,8192
s_add_u32 s63,s60,8192
buffer_load_dwordx4 v1,s[8:11],s63 offen sc1 lds
buffer_load_dwordx4 v1,s[8:11],s63 offen offset:1024 sc1 lds
nt_244:
s_mov_b32 s39,0
s_mul_i32 s74,s73,393216
s_add_u32 s74,s74,s39
s_add_u32 s74,s74,s70
v_fma_f32 v88,-v176,v120,v88
v_fma_f32 v89,-v176,v121,v89
v_fma_f32 v90,-v176,v122,v90
v_fma_f32 v91,-v176,v123,v91
v_fma_f32 v92,-v176,v124,v92
v_fma_f32 v93,-v176,v125,v93
v_fma_f32 v94,-v176,v126,v94
v_fma_f32 v95,-v176,v127,v95
v_mul_f32 v88,v88,v177
v_mul_f32 v89,v89,v177
v_mul_f32 v90,v90,v177
v_mul_f32 v91,v91,v177
v_mul_f32 v92,v92,v177
v_mul_f32 v93,v93,v177
v_mul_f32 v94,v94,v177
v_mul_f32 v95,v95,v177
v_cvt_pk_bf16_f32 v180,v88,v89
v_cvt_pk_bf16_f32 v181,v90,v91
v_cvt_pk_bf16_f32 v182,v92,v93
v_cvt_pk_bf16_f32 v183,v94,v95
buffer_store_dwordx4 v[180:183],v20,s[8:11],s74 offen sc1
v_fma_f32 v96,-v176,v128,v96
v_fma_f32 v97,-v176,v129,v97
v_fma_f32 v98,-v176,v130,v98
v_fma_f32 v99,-v176,v131,v99
v_fma_f32 v100,-v176,v132,v100
v_fma_f32 v101,-v176,v133,v101
v_fma_f32 v102,-v176,v134,v102
v_fma_f32 v103,-v176,v135,v103
v_mul_f32 v96,v96,v177
v_mul_f32 v97,v97,v177
v_mul_f32 v98,v98,v177
v_mul_f32 v99,v99,v177
v_mul_f32 v100,v100,v177
v_mul_f32 v101,v101,v177
v_mul_f32 v102,v102,v177
v_mul_f32 v103,v103,v177
v_cvt_pk_bf16_f32 v184,v96,v97
v_cvt_pk_bf16_f32 v185,v98,v99
v_cvt_pk_bf16_f32 v186,v100,v101
v_cvt_pk_bf16_f32 v187,v102,v103
buffer_store_dwordx4 v[184:187],v21,s[8:11],s74 offen sc1
v_fma_f32 v104,-v176,v136,v104
v_fma_f32 v105,-v176,v137,v105
v_fma_f32 v106,-v176,v138,v106
v_fma_f32 v107,-v176,v139,v107
v_fma_f32 v108,-v176,v140,v108
v_fma_f32 v109,-v176,v141,v109
v_fma_f32 v110,-v176,v142,v110
v_fma_f32 v111,-v176,v143,v111
v_mul_f32 v104,v104,v177
v_mul_f32 v105,v105,v177
v_mul_f32 v106,v106,v177
v_mul_f32 v107,v107,v177
v_mul_f32 v108,v108,v177
v_mul_f32 v109,v109,v177
v_mul_f32 v110,v110,v177
v_mul_f32 v111,v111,v177
v_cvt_pk_bf16_f32 v180,v104,v105
v_cvt_pk_bf16_f32 v181,v106,v107
v_cvt_pk_bf16_f32 v182,v108,v109
v_cvt_pk_bf16_f32 v183,v110,v111
buffer_store_dwordx4 v[180:183],v20,s[8:11],s74 offen offset:2048 sc1
v_fma_f32 v112,-v176,v144,v112
v_fma_f32 v113,-v176,v145,v113
v_fma_f32 v114,-v176,v146,v114
v_fma_f32 v115,-v176,v147,v115
v_fma_f32 v116,-v176,v148,v116
v_fma_f32 v117,-v176,v149,v117
v_fma_f32 v118,-v176,v150,v118
v_fma_f32 v119,-v176,v151,v119
v_mul_f32 v112,v112,v177
v_mul_f32 v113,v113,v177
v_mul_f32 v114,v114,v177
v_mul_f32 v115,v115,v177
v_mul_f32 v116,v116,v177
v_mul_f32 v117,v117,v177
v_mul_f32 v118,v118,v177
v_mul_f32 v119,v119,v177
v_cvt_pk_bf16_f32 v184,v112,v113
v_cvt_pk_bf16_f32 v185,v114,v115
v_cvt_pk_bf16_f32 v186,v116,v117
v_cvt_pk_bf16_f32 v187,v118,v119
buffer_store_dwordx4 v[184:187],v21,s[8:11],s74 offen offset:2048 sc1
s_lshl_b32 s82,s72,6
s_add_u32 s82,s82,s73
s_lshl_b32 s82,s82,9
s_add_u32 s82,s82,s71
s_lshl_b32 s75,s69,2
s_add_u32 s82,s82,s75
s_add_u32 s82,s82,s39
s_mov_b32 s59,s82
s_mov_b32 s82,2147483648
s_mov_b32 s39,2147483648
s_add_u32 s50,s50,1
s_sub_u32 s57,46080,s57
s_mov_b32 s51,s53
s_mov_b32 s52,s54
s_mov_b32 s37,s38
s_cmp_eq_u32 s55,0
s_cbranch_scc1 QKVQ_B0
s_cmp_eq_u32 s55,1
s_cbranch_scc1 QKVQ_CD0
s_waitcnt vmcnt(0)
s_mov_b64 exec,1
buffer_store_dword v5,v1,s[8:11],s59 offen sc1
s_mov_b64 exec,-1
s_mov_b32 s59,2147483648
s_cmp_eq_u32 s50,128
s_cbranch_scc1 QKVQ_END
s_branch QKVQ_COLD0
QKVQ_END:
s_endpgm
ROLE_QKVV:
v_lshlrev_b32 v1,4,v0
v_mov_b32 v5,1
s_lshl_b32 s56,s48,2
s_add_u32 s56,s56,s46
v_bfe_u32 v6,v0,2,2
v_lshrrev_b32 v7,4,v0
v_add_u32 v7,v6,v7
v_and_b32 v7,3,v7
v_and_b32 v15,3,v0
v_lshlrev_b32 v15,4,v15
v_lshl_add_u32 v15,v7,6,v15
v_lshl_add_u32 v15,v6,8,v15
v_lshrrev_b32 v6,5,v0
v_bfe_u32 v7,v0,4,1
v_lshlrev_b32 v16,10,v7
v_bfe_u32 v7,v0,2,2
v_lshl_add_u32 v16,v7,8,v16
v_add_u32 v6,v6,v7
v_and_b32 v6,3,v6
v_lshl_add_u32 v16,v6,6,v16
v_and_b32 v6,3,v0
v_lshl_add_u32 v16,v6,4,v16
v_add_u32 v18,46080,v16
v_lshrrev_b32 v6,5,v0
v_bfe_u32 v7,v0,4,1
v_lshlrev_b32 v20,10,v7
v_lshl_add_u32 v20,v6,8,v20
v_and_b32 v6,15,v0
v_lshl_add_u32 v20,v6,4,v20
v_lshrrev_b32 v6,5,v0
v_add_u32 v6,2,v6
v_bfe_u32 v7,v0,4,1
v_lshlrev_b32 v17,10,v7
v_bfe_u32 v7,v0,2,2
v_lshl_add_u32 v17,v7,8,v17
v_add_u32 v6,v6,v7
v_and_b32 v6,3,v6
v_lshl_add_u32 v17,v6,6,v17
v_and_b32 v6,3,v0
v_lshl_add_u32 v17,v6,4,v17
v_add_u32 v19,46080,v17
v_lshrrev_b32 v6,5,v0
v_add_u32 v6,2,v6
v_bfe_u32 v7,v0,4,1
v_lshlrev_b32 v21,10,v7
v_lshl_add_u32 v21,v6,8,v21
v_and_b32 v6,15,v0
v_lshl_add_u32 v21,v6,4,v21
s_mov_b32 s69,s56
s_mov_b32 s70,99614720
s_mov_b32 s71,196608
s_lshl_b32 s60,s69,12
s_add_u32 s70,s70,s60
v_lshrrev_b32 v6,5,v0
v_mul_u32_u24 v188,2560,v6
v_and_b32 v6,31,v0
v_lshl_add_u32 v188,v6,3,v188
v_add_u32 v188,0xa000,v188
v_min_u32 v12,7,v0
v_lshlrev_b32 v12,2,v12
v_min_u32 v13,39,v0
v_lshlrev_b32 v13,2,v13
v_mov_b32 v14,93184
s_lshl_b32 s60,s46,8
s_add_u32 s60,s60,92160
v_and_b32 v6,31,v0
v_lshlrev_b32 v190,3,v6
v_add_u32 v190,s60,v190
v_lshrrev_b32 v6,5,v0
v_lshlrev_b32 v191,5,v6
v_add_u32 v191,s60,v191
s_waitcnt vmcnt(0)
s_barrier
s_cmp_lg_u32 s46,0
s_cbranch_scc1 arr_245
v_mov_b32 v6,1
s_lshl_b32 s3,s49,2
v_mov_b32 v7,s3
s_mov_b64 exec,1
buffer_atomic_add v6,v7,s[12:15],0 offen sc1
s_mov_b64 exec,-1
arr_245:
s_lshl_b32 s58,s69,7
s_mul_i32 s63,s46,40960
s_mov_b32 s4,s24
s_mov_b32 s5,s25
s_mov_b32 s6,7864320
s_mov_b32 s7,0x20000
v_lshrrev_b32 v9,3,v0
s_mov_b32 s64,12288
v_mul_lo_u32 v9,v9,s64
v_and_b32 v10,7,v0
v_lshl_add_u32 v6,v10,4,v9
s_add_u32 m0,s63,0
s_add_u32 s65,s58,0
buffer_load_dwordx4 v6,s[4:7],s65 offen lds
s_add_u32 m0,s63,1024
s_add_u32 s65,s58,98304
buffer_load_dwordx4 v6,s[4:7],s65 offen lds
s_add_u32 m0,s63,2048
s_add_u32 s65,s58,196608
buffer_load_dwordx4 v6,s[4:7],s65 offen lds
s_add_u32 m0,s63,3072
s_add_u32 s65,s58,294912
buffer_load_dwordx4 v6,s[4:7],s65 offen lds
s_add_u32 m0,s63,4096
s_add_u32 s65,s58,393216
buffer_load_dwordx4 v6,s[4:7],s65 offen lds
s_add_u32 m0,s63,5120
s_add_u32 s65,s58,491520
buffer_load_dwordx4 v6,s[4:7],s65 offen lds
s_add_u32 m0,s63,6144
s_add_u32 s65,s58,589824
buffer_load_dwordx4 v6,s[4:7],s65 offen lds
s_add_u32 m0,s63,7168
s_add_u32 s65,s58,688128
buffer_load_dwordx4 v6,s[4:7],s65 offen lds
s_add_u32 m0,s63,8192
s_add_u32 s65,s58,786432
buffer_load_dwordx4 v6,s[4:7],s65 offen lds
s_add_u32 m0,s63,9216
s_add_u32 s65,s58,884736
buffer_load_dwordx4 v6,s[4:7],s65 offen lds
s_add_u32 m0,s63,10240
s_add_u32 s65,s58,983040
buffer_load_dwordx4 v6,s[4:7],s65 offen lds
s_add_u32 m0,s63,11264
s_add_u32 s65,s58,1081344
buffer_load_dwordx4 v6,s[4:7],s65 offen lds
s_add_u32 m0,s63,12288
s_add_u32 s65,s58,1179648
buffer_load_dwordx4 v6,s[4:7],s65 offen lds
s_add_u32 m0,s63,13312
s_add_u32 s65,s58,1277952
buffer_load_dwordx4 v6,s[4:7],s65 offen lds
s_add_u32 m0,s63,14336
s_add_u32 s65,s58,1376256
buffer_load_dwordx4 v6,s[4:7],s65 offen lds
s_add_u32 m0,s63,15360
s_add_u32 s65,s58,1474560
buffer_load_dwordx4 v6,s[4:7],s65 offen lds
s_add_u32 m0,s63,16384
s_add_u32 s65,s58,1572864
buffer_load_dwordx4 v6,s[4:7],s65 offen lds
s_add_u32 m0,s63,17408
s_add_u32 s65,s58,1671168
buffer_load_dwordx4 v6,s[4:7],s65 offen lds
s_add_u32 m0,s63,18432
s_add_u32 s65,s58,1769472
buffer_load_dwordx4 v6,s[4:7],s65 offen lds
s_add_u32 m0,s63,19456
s_add_u32 s65,s58,1867776
buffer_load_dwordx4 v6,s[4:7],s65 offen lds
s_add_u32 m0,s63,20480
s_add_u32 s65,s58,1966080
buffer_load_dwordx4 v6,s[4:7],s65 offen lds
s_add_u32 m0,s63,21504
s_add_u32 s65,s58,2064384
buffer_load_dwordx4 v6,s[4:7],s65 offen lds
s_add_u32 m0,s63,22528
s_add_u32 s65,s58,2162688
buffer_load_dwordx4 v6,s[4:7],s65 offen lds
s_add_u32 m0,s63,23552
s_add_u32 s65,s58,2260992
buffer_load_dwordx4 v6,s[4:7],s65 offen lds
s_add_u32 m0,s63,24576
s_add_u32 s65,s58,2359296
buffer_load_dwordx4 v6,s[4:7],s65 offen lds
s_add_u32 m0,s63,25600
s_add_u32 s65,s58,2457600
buffer_load_dwordx4 v6,s[4:7],s65 offen lds
s_add_u32 m0,s63,26624
s_add_u32 s65,s58,2555904
buffer_load_dwordx4 v6,s[4:7],s65 offen lds
s_add_u32 m0,s63,27648
s_add_u32 s65,s58,2654208
buffer_load_dwordx4 v6,s[4:7],s65 offen lds
s_add_u32 m0,s63,28672
s_add_u32 s65,s58,2752512
buffer_load_dwordx4 v6,s[4:7],s65 offen lds
s_add_u32 m0,s63,29696
s_add_u32 s65,s58,2850816
buffer_load_dwordx4 v6,s[4:7],s65 offen lds
s_add_u32 m0,s63,30720
s_add_u32 s65,s58,2949120
buffer_load_dwordx4 v6,s[4:7],s65 offen lds
s_add_u32 m0,s63,31744
s_add_u32 s65,s58,3047424
buffer_load_dwordx4 v6,s[4:7],s65 offen lds
s_add_u32 m0,s63,32768
s_add_u32 s65,s58,3145728
buffer_load_dwordx4 v6,s[4:7],s65 offen lds
s_add_u32 m0,s63,33792
s_add_u32 s65,s58,3244032
buffer_load_dwordx4 v6,s[4:7],s65 offen lds
s_add_u32 m0,s63,34816
s_add_u32 s65,s58,3342336
buffer_load_dwordx4 v6,s[4:7],s65 offen lds
s_add_u32 m0,s63,35840
s_add_u32 s65,s58,3440640
buffer_load_dwordx4 v6,s[4:7],s65 offen lds
s_add_u32 m0,s63,36864
s_add_u32 s65,s58,3538944
buffer_load_dwordx4 v6,s[4:7],s65 offen lds
s_add_u32 m0,s63,37888
s_add_u32 s65,s58,3637248
buffer_load_dwordx4 v6,s[4:7],s65 offen lds
s_add_u32 m0,s63,38912
s_add_u32 s65,s58,3735552
buffer_load_dwordx4 v6,s[4:7],s65 offen lds
s_add_u32 m0,s63,39936
s_add_u32 s65,s58,3833856
buffer_load_dwordx4 v6,s[4:7],s65 offen lds
s_waitcnt vmcnt(20)
v_bfe_u32 v9,v0,2,2
v_lshrrev_b32 v10,5,v0
v_lshl_add_u32 v9,v10,2,v9
v_mul_u32_u24 v9,128,v9
v_and_b32 v10,1,v0
v_lshl_add_u32 v9,v10,3,v9
v_bfe_u32 v10,v0,1,1
v_lshl_add_u32 v9,v10,4,v9
v_bfe_u32 v10,v0,4,1
v_lshl_add_u32 v9,v10,5,v9
v_add_u32 v7,s63,v9
ds_read_b64_tr_b16 a[0:1],v7 offset:0
ds_read_b64_tr_b16 a[2:3],v7 offset:2048
ds_read_b64_tr_b16 a[4:5],v7 offset:1024
ds_read_b64_tr_b16 a[6:7],v7 offset:3072
ds_read_b64_tr_b16 a[160:161],v7 offset:64
ds_read_b64_tr_b16 a[162:163],v7 offset:2112
ds_read_b64_tr_b16 a[164:165],v7 offset:1088
ds_read_b64_tr_b16 a[166:167],v7 offset:3136
ds_read_b64_tr_b16 a[8:9],v7 offset:4096
ds_read_b64_tr_b16 a[10:11],v7 offset:6144
ds_read_b64_tr_b16 a[12:13],v7 offset:5120
ds_read_b64_tr_b16 a[14:15],v7 offset:7168
s_waitcnt lgkmcnt(4)
ds_read_b64_tr_b16 a[168:169],v7 offset:4160
ds_read_b64_tr_b16 a[170:171],v7 offset:6208
ds_read_b64_tr_b16 a[172:173],v7 offset:5184
ds_read_b64_tr_b16 a[174:175],v7 offset:7232
ds_read_b64_tr_b16 a[16:17],v7 offset:8192
ds_read_b64_tr_b16 a[18:19],v7 offset:10240
ds_read_b64_tr_b16 a[20:21],v7 offset:9216
ds_read_b64_tr_b16 a[22:23],v7 offset:11264
ds_read_b64_tr_b16 a[176:177],v7 offset:8256
ds_read_b64_tr_b16 a[178:179],v7 offset:10304
ds_read_b64_tr_b16 a[180:181],v7 offset:9280
ds_read_b64_tr_b16 a[182:183],v7 offset:11328
s_waitcnt lgkmcnt(4)
ds_read_b64_tr_b16 a[24:25],v7 offset:12288
ds_read_b64_tr_b16 a[26:27],v7 offset:14336
ds_read_b64_tr_b16 a[28:29],v7 offset:13312
ds_read_b64_tr_b16 a[30:31],v7 offset:15360
ds_read_b64_tr_b16 a[184:185],v7 offset:12352
ds_read_b64_tr_b16 a[186:187],v7 offset:14400
ds_read_b64_tr_b16 a[188:189],v7 offset:13376
ds_read_b64_tr_b16 a[190:191],v7 offset:15424
ds_read_b64_tr_b16 a[32:33],v7 offset:16384
ds_read_b64_tr_b16 a[34:35],v7 offset:18432
ds_read_b64_tr_b16 a[36:37],v7 offset:17408
ds_read_b64_tr_b16 a[38:39],v7 offset:19456
s_waitcnt lgkmcnt(4)
ds_read_b64_tr_b16 a[192:193],v7 offset:16448
ds_read_b64_tr_b16 a[194:195],v7 offset:18496
ds_read_b64_tr_b16 a[196:197],v7 offset:17472
ds_read_b64_tr_b16 a[198:199],v7 offset:19520
s_waitcnt lgkmcnt(0)
s_add_u32 m0,s63,0
s_add_u32 s65,s58,3932160
buffer_load_dwordx4 v6,s[4:7],s65 offen lds
s_add_u32 m0,s63,1024
s_add_u32 s65,s58,4030464
buffer_load_dwordx4 v6,s[4:7],s65 offen lds
s_add_u32 m0,s63,2048
s_add_u32 s65,s58,4128768
buffer_load_dwordx4 v6,s[4:7],s65 offen lds
s_add_u32 m0,s63,3072
s_add_u32 s65,s58,4227072
buffer_load_dwordx4 v6,s[4:7],s65 offen lds
s_add_u32 m0,s63,4096
s_add_u32 s65,s58,4325376
buffer_load_dwordx4 v6,s[4:7],s65 offen lds
s_add_u32 m0,s63,5120
s_add_u32 s65,s58,4423680
buffer_load_dwordx4 v6,s[4:7],s65 offen lds
s_add_u32 m0,s63,6144
s_add_u32 s65,s58,4521984
buffer_load_dwordx4 v6,s[4:7],s65 offen lds
s_add_u32 m0,s63,7168
s_add_u32 s65,s58,4620288
buffer_load_dwordx4 v6,s[4:7],s65 offen lds
s_add_u32 m0,s63,8192
s_add_u32 s65,s58,4718592
buffer_load_dwordx4 v6,s[4:7],s65 offen lds
s_add_u32 m0,s63,9216
s_add_u32 s65,s58,4816896
buffer_load_dwordx4 v6,s[4:7],s65 offen lds
s_add_u32 m0,s63,10240
s_add_u32 s65,s58,4915200
buffer_load_dwordx4 v6,s[4:7],s65 offen lds
s_add_u32 m0,s63,11264
s_add_u32 s65,s58,5013504
buffer_load_dwordx4 v6,s[4:7],s65 offen lds
s_add_u32 m0,s63,12288
s_add_u32 s65,s58,5111808
buffer_load_dwordx4 v6,s[4:7],s65 offen lds
s_add_u32 m0,s63,13312
s_add_u32 s65,s58,5210112
buffer_load_dwordx4 v6,s[4:7],s65 offen lds
s_add_u32 m0,s63,14336
s_add_u32 s65,s58,5308416
buffer_load_dwordx4 v6,s[4:7],s65 offen lds
s_add_u32 m0,s63,15360
s_add_u32 s65,s58,5406720
buffer_load_dwordx4 v6,s[4:7],s65 offen lds
s_add_u32 m0,s63,16384
s_add_u32 s65,s58,5505024
buffer_load_dwordx4 v6,s[4:7],s65 offen lds
s_add_u32 m0,s63,17408
s_add_u32 s65,s58,5603328
buffer_load_dwordx4 v6,s[4:7],s65 offen lds
s_add_u32 m0,s63,18432
s_add_u32 s65,s58,5701632
buffer_load_dwordx4 v6,s[4:7],s65 offen lds
s_add_u32 m0,s63,19456
s_add_u32 s65,s58,5799936
buffer_load_dwordx4 v6,s[4:7],s65 offen lds
s_waitcnt vmcnt(20)
v_bfe_u32 v9,v0,2,2
v_lshrrev_b32 v10,5,v0
v_lshl_add_u32 v9,v10,2,v9
v_mul_u32_u24 v9,128,v9
v_and_b32 v10,1,v0
v_lshl_add_u32 v9,v10,3,v9
v_bfe_u32 v10,v0,1,1
v_lshl_add_u32 v9,v10,4,v9
v_bfe_u32 v10,v0,4,1
v_lshl_add_u32 v9,v10,5,v9
v_add_u32 v7,s63,v9
ds_read_b64_tr_b16 a[40:41],v7 offset:20480
ds_read_b64_tr_b16 a[42:43],v7 offset:22528
ds_read_b64_tr_b16 a[44:45],v7 offset:21504
ds_read_b64_tr_b16 a[46:47],v7 offset:23552
ds_read_b64_tr_b16 a[200:201],v7 offset:20544
ds_read_b64_tr_b16 a[202:203],v7 offset:22592
ds_read_b64_tr_b16 a[204:205],v7 offset:21568
ds_read_b64_tr_b16 a[206:207],v7 offset:23616
ds_read_b64_tr_b16 a[48:49],v7 offset:24576
ds_read_b64_tr_b16 a[50:51],v7 offset:26624
ds_read_b64_tr_b16 a[52:53],v7 offset:25600
ds_read_b64_tr_b16 a[54:55],v7 offset:27648
s_waitcnt lgkmcnt(4)
ds_read_b64_tr_b16 a[208:209],v7 offset:24640
ds_read_b64_tr_b16 a[210:211],v7 offset:26688
ds_read_b64_tr_b16 a[212:213],v7 offset:25664
ds_read_b64_tr_b16 a[214:215],v7 offset:27712
ds_read_b64_tr_b16 a[56:57],v7 offset:28672
ds_read_b64_tr_b16 a[58:59],v7 offset:30720
ds_read_b64_tr_b16 a[60:61],v7 offset:29696
ds_read_b64_tr_b16 a[62:63],v7 offset:31744
ds_read_b64_tr_b16 a[216:217],v7 offset:28736
ds_read_b64_tr_b16 a[218:219],v7 offset:30784
ds_read_b64_tr_b16 a[220:221],v7 offset:29760
ds_read_b64_tr_b16 a[222:223],v7 offset:31808
s_waitcnt lgkmcnt(4)
ds_read_b64_tr_b16 a[64:65],v7 offset:32768
ds_read_b64_tr_b16 a[66:67],v7 offset:34816
ds_read_b64_tr_b16 a[68:69],v7 offset:33792
ds_read_b64_tr_b16 a[70:71],v7 offset:35840
ds_read_b64_tr_b16 a[224:225],v7 offset:32832
ds_read_b64_tr_b16 a[226:227],v7 offset:34880
ds_read_b64_tr_b16 a[228:229],v7 offset:33856
ds_read_b64_tr_b16 a[230:231],v7 offset:35904
ds_read_b64_tr_b16 a[72:73],v7 offset:36864
ds_read_b64_tr_b16 a[74:75],v7 offset:38912
ds_read_b64_tr_b16 a[76:77],v7 offset:37888
ds_read_b64_tr_b16 a[78:79],v7 offset:39936
s_waitcnt lgkmcnt(4)
ds_read_b64_tr_b16 a[232:233],v7 offset:36928
ds_read_b64_tr_b16 a[234:235],v7 offset:38976
ds_read_b64_tr_b16 a[236:237],v7 offset:37952
ds_read_b64_tr_b16 a[238:239],v7 offset:40000
s_waitcnt lgkmcnt(0)
s_add_u32 m0,s63,20480
s_add_u32 s65,s58,5898240
buffer_load_dwordx4 v6,s[4:7],s65 offen lds
s_add_u32 m0,s63,21504
s_add_u32 s65,s58,5996544
buffer_load_dwordx4 v6,s[4:7],s65 offen lds
s_add_u32 m0,s63,22528
s_add_u32 s65,s58,6094848
buffer_load_dwordx4 v6,s[4:7],s65 offen lds
s_add_u32 m0,s63,23552
s_add_u32 s65,s58,6193152
buffer_load_dwordx4 v6,s[4:7],s65 offen lds
s_add_u32 m0,s63,24576
s_add_u32 s65,s58,6291456
buffer_load_dwordx4 v6,s[4:7],s65 offen lds
s_add_u32 m0,s63,25600
s_add_u32 s65,s58,6389760
buffer_load_dwordx4 v6,s[4:7],s65 offen lds
s_add_u32 m0,s63,26624
s_add_u32 s65,s58,6488064
buffer_load_dwordx4 v6,s[4:7],s65 offen lds
s_add_u32 m0,s63,27648
s_add_u32 s65,s58,6586368
buffer_load_dwordx4 v6,s[4:7],s65 offen lds
s_add_u32 m0,s63,28672
s_add_u32 s65,s58,6684672
buffer_load_dwordx4 v6,s[4:7],s65 offen lds
s_add_u32 m0,s63,29696
s_add_u32 s65,s58,6782976
buffer_load_dwordx4 v6,s[4:7],s65 offen lds
s_add_u32 m0,s63,30720
s_add_u32 s65,s58,6881280
buffer_load_dwordx4 v6,s[4:7],s65 offen lds
s_add_u32 m0,s63,31744
s_add_u32 s65,s58,6979584
buffer_load_dwordx4 v6,s[4:7],s65 offen lds
s_add_u32 m0,s63,32768
s_add_u32 s65,s58,7077888
buffer_load_dwordx4 v6,s[4:7],s65 offen lds
s_add_u32 m0,s63,33792
s_add_u32 s65,s58,7176192
buffer_load_dwordx4 v6,s[4:7],s65 offen lds
s_add_u32 m0,s63,34816
s_add_u32 s65,s58,7274496
buffer_load_dwordx4 v6,s[4:7],s65 offen lds
s_add_u32 m0,s63,35840
s_add_u32 s65,s58,7372800
buffer_load_dwordx4 v6,s[4:7],s65 offen lds
s_add_u32 m0,s63,36864
s_add_u32 s65,s58,7471104
buffer_load_dwordx4 v6,s[4:7],s65 offen lds
s_add_u32 m0,s63,37888
s_add_u32 s65,s58,7569408
buffer_load_dwordx4 v6,s[4:7],s65 offen lds
s_add_u32 m0,s63,38912
s_add_u32 s65,s58,7667712
buffer_load_dwordx4 v6,s[4:7],s65 offen lds
s_add_u32 m0,s63,39936
s_add_u32 s65,s58,7766016
buffer_load_dwordx4 v6,s[4:7],s65 offen lds
s_waitcnt vmcnt(20)
v_bfe_u32 v9,v0,2,2
v_lshrrev_b32 v10,5,v0
v_lshl_add_u32 v9,v10,2,v9
v_mul_u32_u24 v9,128,v9
v_and_b32 v10,1,v0
v_lshl_add_u32 v9,v10,3,v9
v_bfe_u32 v10,v0,1,1
v_lshl_add_u32 v9,v10,4,v9
v_bfe_u32 v10,v0,4,1
v_lshl_add_u32 v9,v10,5,v9
v_add_u32 v7,s63,v9
ds_read_b64_tr_b16 a[80:81],v7 offset:0
ds_read_b64_tr_b16 a[82:83],v7 offset:2048
ds_read_b64_tr_b16 a[84:85],v7 offset:1024
ds_read_b64_tr_b16 a[86:87],v7 offset:3072
ds_read_b64_tr_b16 a[240:241],v7 offset:64
ds_read_b64_tr_b16 a[242:243],v7 offset:2112
ds_read_b64_tr_b16 a[244:245],v7 offset:1088
ds_read_b64_tr_b16 a[246:247],v7 offset:3136
ds_read_b64_tr_b16 a[88:89],v7 offset:4096
ds_read_b64_tr_b16 a[90:91],v7 offset:6144
ds_read_b64_tr_b16 a[92:93],v7 offset:5120
ds_read_b64_tr_b16 a[94:95],v7 offset:7168
s_waitcnt lgkmcnt(4)
ds_read_b64_tr_b16 a[248:249],v7 offset:4160
ds_read_b64_tr_b16 a[250:251],v7 offset:6208
ds_read_b64_tr_b16 a[252:253],v7 offset:5184
ds_read_b64_tr_b16 a[254:255],v7 offset:7232
ds_read_b64_tr_b16 a[96:97],v7 offset:8192
ds_read_b64_tr_b16 a[98:99],v7 offset:10240
ds_read_b64_tr_b16 a[100:101],v7 offset:9216
ds_read_b64_tr_b16 a[102:103],v7 offset:11264
ds_read_b64_tr_b16 v[192:193],v7 offset:8256
ds_read_b64_tr_b16 v[194:195],v7 offset:10304
ds_read_b64_tr_b16 v[196:197],v7 offset:9280
ds_read_b64_tr_b16 v[198:199],v7 offset:11328
s_waitcnt lgkmcnt(4)
ds_read_b64_tr_b16 a[104:105],v7 offset:12288
ds_read_b64_tr_b16 a[106:107],v7 offset:14336
ds_read_b64_tr_b16 a[108:109],v7 offset:13312
ds_read_b64_tr_b16 a[110:111],v7 offset:15360
ds_read_b64_tr_b16 v[200:201],v7 offset:12352
ds_read_b64_tr_b16 v[202:203],v7 offset:14400
ds_read_b64_tr_b16 v[204:205],v7 offset:13376
ds_read_b64_tr_b16 v[206:207],v7 offset:15424
ds_read_b64_tr_b16 a[112:113],v7 offset:16384
ds_read_b64_tr_b16 a[114:115],v7 offset:18432
ds_read_b64_tr_b16 a[116:117],v7 offset:17408
ds_read_b64_tr_b16 a[118:119],v7 offset:19456
s_waitcnt lgkmcnt(4)
ds_read_b64_tr_b16 v[208:209],v7 offset:16448
ds_read_b64_tr_b16 v[210:211],v7 offset:18496
ds_read_b64_tr_b16 v[212:213],v7 offset:17472
ds_read_b64_tr_b16 v[214:215],v7 offset:19520
s_waitcnt lgkmcnt(0)
s_waitcnt vmcnt(0)
v_bfe_u32 v9,v0,2,2
v_lshrrev_b32 v10,5,v0
v_lshl_add_u32 v9,v10,2,v9
v_mul_u32_u24 v9,128,v9
v_and_b32 v10,1,v0
v_lshl_add_u32 v9,v10,3,v9
v_bfe_u32 v10,v0,1,1
v_lshl_add_u32 v9,v10,4,v9
v_bfe_u32 v10,v0,4,1
v_lshl_add_u32 v9,v10,5,v9
v_add_u32 v7,s63,v9
ds_read_b64_tr_b16 a[120:121],v7 offset:20480
ds_read_b64_tr_b16 a[122:123],v7 offset:22528
ds_read_b64_tr_b16 a[124:125],v7 offset:21504
ds_read_b64_tr_b16 a[126:127],v7 offset:23552
ds_read_b64_tr_b16 v[216:217],v7 offset:20544
ds_read_b64_tr_b16 v[218:219],v7 offset:22592
ds_read_b64_tr_b16 v[220:221],v7 offset:21568
ds_read_b64_tr_b16 v[222:223],v7 offset:23616
ds_read_b64_tr_b16 a[128:129],v7 offset:24576
ds_read_b64_tr_b16 a[130:131],v7 offset:26624
ds_read_b64_tr_b16 a[132:133],v7 offset:25600
ds_read_b64_tr_b16 a[134:135],v7 offset:27648
s_waitcnt lgkmcnt(4)
ds_read_b64_tr_b16 v[224:225],v7 offset:24640
ds_read_b64_tr_b16 v[226:227],v7 offset:26688
ds_read_b64_tr_b16 v[228:229],v7 offset:25664
ds_read_b64_tr_b16 v[230:231],v7 offset:27712
ds_read_b64_tr_b16 a[136:137],v7 offset:28672
ds_read_b64_tr_b16 a[138:139],v7 offset:30720
ds_read_b64_tr_b16 a[140:141],v7 offset:29696
ds_read_b64_tr_b16 a[142:143],v7 offset:31744
ds_read_b64_tr_b16 v[232:233],v7 offset:28736
ds_read_b64_tr_b16 v[234:235],v7 offset:30784
ds_read_b64_tr_b16 v[236:237],v7 offset:29760
ds_read_b64_tr_b16 v[238:239],v7 offset:31808
s_waitcnt lgkmcnt(4)
ds_read_b64_tr_b16 a[144:145],v7 offset:32768
ds_read_b64_tr_b16 a[146:147],v7 offset:34816
ds_read_b64_tr_b16 a[148:149],v7 offset:33792
ds_read_b64_tr_b16 a[150:151],v7 offset:35840
ds_read_b64_tr_b16 v[240:241],v7 offset:32832
ds_read_b64_tr_b16 v[242:243],v7 offset:34880
ds_read_b64_tr_b16 v[244:245],v7 offset:33856
ds_read_b64_tr_b16 v[246:247],v7 offset:35904
ds_read_b64_tr_b16 a[152:153],v7 offset:36864
ds_read_b64_tr_b16 a[154:155],v7 offset:38912
ds_read_b64_tr_b16 a[156:157],v7 offset:37888
ds_read_b64_tr_b16 a[158:159],v7 offset:39936
s_waitcnt lgkmcnt(4)
ds_read_b64_tr_b16 v[248:249],v7 offset:36928
ds_read_b64_tr_b16 v[250:251],v7 offset:38976
ds_read_b64_tr_b16 v[252:253],v7 offset:37952
ds_read_b64_tr_b16 v[254:255],v7 offset:40000
s_waitcnt lgkmcnt(0)
v_mov_b32 v24,0x3f803f80
v_mov_b32 v25,0x3f803f80
v_mov_b32 v26,0x3f803f80
v_mov_b32 v27,0x3f803f80
s_nop 1
v_mfma_f32_32x32x16_bf16 v[56:71],v[24:27],a[0:3],0
v_mfma_f32_32x32x16_bf16 v[72:87],v[24:27],a[160:163],0
v_mfma_f32_32x32x16_bf16 v[56:71],v[24:27],a[4:7],v[56:71]
v_mfma_f32_32x32x16_bf16 v[72:87],v[24:27],a[164:167],v[72:87]
v_mfma_f32_32x32x16_bf16 v[56:71],v[24:27],a[8:11],v[56:71]
v_mfma_f32_32x32x16_bf16 v[72:87],v[24:27],a[168:171],v[72:87]
v_mfma_f32_32x32x16_bf16 v[56:71],v[24:27],a[12:15],v[56:71]
v_mfma_f32_32x32x16_bf16 v[72:87],v[24:27],a[172:175],v[72:87]
v_mfma_f32_32x32x16_bf16 v[56:71],v[24:27],a[16:19],v[56:71]
v_mfma_f32_32x32x16_bf16 v[72:87],v[24:27],a[176:179],v[72:87]
v_mfma_f32_32x32x16_bf16 v[56:71],v[24:27],a[20:23],v[56:71]
v_mfma_f32_32x32x16_bf16 v[72:87],v[24:27],a[180:183],v[72:87]
v_mfma_f32_32x32x16_bf16 v[56:71],v[24:27],a[24:27],v[56:71]
v_mfma_f32_32x32x16_bf16 v[72:87],v[24:27],a[184:187],v[72:87]
v_mfma_f32_32x32x16_bf16 v[56:71],v[24:27],a[28:31],v[56:71]
v_mfma_f32_32x32x16_bf16 v[72:87],v[24:27],a[188:191],v[72:87]
v_mfma_f32_32x32x16_bf16 v[56:71],v[24:27],a[32:35],v[56:71]
v_mfma_f32_32x32x16_bf16 v[72:87],v[24:27],a[192:195],v[72:87]
v_mfma_f32_32x32x16_bf16 v[56:71],v[24:27],a[36:39],v[56:71]
v_mfma_f32_32x32x16_bf16 v[72:87],v[24:27],a[196:199],v[72:87]
v_mfma_f32_32x32x16_bf16 v[56:71],v[24:27],a[40:43],v[56:71]
v_mfma_f32_32x32x16_bf16 v[72:87],v[24:27],a[200:203],v[72:87]
v_mfma_f32_32x32x16_bf16 v[56:71],v[24:27],a[44:47],v[56:71]
v_mfma_f32_32x32x16_bf16 v[72:87],v[24:27],a[204:207],v[72:87]
v_mfma_f32_32x32x16_bf16 v[56:71],v[24:27],a[48:51],v[56:71]
v_mfma_f32_32x32x16_bf16 v[72:87],v[24:27],a[208:211],v[72:87]
v_mfma_f32_32x32x16_bf16 v[56:71],v[24:27],a[52:55],v[56:71]
v_mfma_f32_32x32x16_bf16 v[72:87],v[24:27],a[212:215],v[72:87]
v_mfma_f32_32x32x16_bf16 v[56:71],v[24:27],a[56:59],v[56:71]
v_mfma_f32_32x32x16_bf16 v[72:87],v[24:27],a[216:219],v[72:87]
v_mfma_f32_32x32x16_bf16 v[56:71],v[24:27],a[60:63],v[56:71]
v_mfma_f32_32x32x16_bf16 v[72:87],v[24:27],a[220:223],v[72:87]
v_mfma_f32_32x32x16_bf16 v[56:71],v[24:27],a[64:67],v[56:71]
v_mfma_f32_32x32x16_bf16 v[72:87],v[24:27],a[224:227],v[72:87]
v_mfma_f32_32x32x16_bf16 v[56:71],v[24:27],a[68:71],v[56:71]
v_mfma_f32_32x32x16_bf16 v[72:87],v[24:27],a[228:231],v[72:87]
v_mfma_f32_32x32x16_bf16 v[56:71],v[24:27],a[72:75],v[56:71]
v_mfma_f32_32x32x16_bf16 v[72:87],v[24:27],a[232:235],v[72:87]
v_mfma_f32_32x32x16_bf16 v[56:71],v[24:27],a[76:79],v[56:71]
v_mfma_f32_32x32x16_bf16 v[72:87],v[24:27],a[236:239],v[72:87]
v_mfma_f32_32x32x16_bf16 v[56:71],v[24:27],a[80:83],v[56:71]
v_mfma_f32_32x32x16_bf16 v[72:87],v[24:27],a[240:243],v[72:87]
v_mfma_f32_32x32x16_bf16 v[56:71],v[24:27],a[84:87],v[56:71]
v_mfma_f32_32x32x16_bf16 v[72:87],v[24:27],a[244:247],v[72:87]
v_mfma_f32_32x32x16_bf16 v[56:71],v[24:27],a[88:91],v[56:71]
v_mfma_f32_32x32x16_bf16 v[72:87],v[24:27],a[248:251],v[72:87]
v_mfma_f32_32x32x16_bf16 v[56:71],v[24:27],a[92:95],v[56:71]
v_mfma_f32_32x32x16_bf16 v[72:87],v[24:27],a[252:255],v[72:87]
v_mfma_f32_32x32x16_bf16 v[56:71],v[24:27],a[96:99],v[56:71]
v_mfma_f32_32x32x16_bf16 v[72:87],v[24:27],v[192:195],v[72:87]
v_mfma_f32_32x32x16_bf16 v[56:71],v[24:27],a[100:103],v[56:71]
v_mfma_f32_32x32x16_bf16 v[72:87],v[24:27],v[196:199],v[72:87]
v_mfma_f32_32x32x16_bf16 v[56:71],v[24:27],a[104:107],v[56:71]
v_mfma_f32_32x32x16_bf16 v[72:87],v[24:27],v[200:203],v[72:87]
v_mfma_f32_32x32x16_bf16 v[56:71],v[24:27],a[108:111],v[56:71]
v_mfma_f32_32x32x16_bf16 v[72:87],v[24:27],v[204:207],v[72:87]
v_mfma_f32_32x32x16_bf16 v[56:71],v[24:27],a[112:115],v[56:71]
v_mfma_f32_32x32x16_bf16 v[72:87],v[24:27],v[208:211],v[72:87]
v_mfma_f32_32x32x16_bf16 v[56:71],v[24:27],a[116:119],v[56:71]
v_mfma_f32_32x32x16_bf16 v[72:87],v[24:27],v[212:215],v[72:87]
v_mfma_f32_32x32x16_bf16 v[56:71],v[24:27],a[120:123],v[56:71]
v_mfma_f32_32x32x16_bf16 v[72:87],v[24:27],v[216:219],v[72:87]
v_mfma_f32_32x32x16_bf16 v[56:71],v[24:27],a[124:127],v[56:71]
v_mfma_f32_32x32x16_bf16 v[72:87],v[24:27],v[220:223],v[72:87]
v_mfma_f32_32x32x16_bf16 v[56:71],v[24:27],a[128:131],v[56:71]
v_mfma_f32_32x32x16_bf16 v[72:87],v[24:27],v[224:227],v[72:87]
v_mfma_f32_32x32x16_bf16 v[56:71],v[24:27],a[132:135],v[56:71]
v_mfma_f32_32x32x16_bf16 v[72:87],v[24:27],v[228:231],v[72:87]
v_mfma_f32_32x32x16_bf16 v[56:71],v[24:27],a[136:139],v[56:71]
v_mfma_f32_32x32x16_bf16 v[72:87],v[24:27],v[232:235],v[72:87]
v_mfma_f32_32x32x16_bf16 v[56:71],v[24:27],a[140:143],v[56:71]
v_mfma_f32_32x32x16_bf16 v[72:87],v[24:27],v[236:239],v[72:87]
v_mfma_f32_32x32x16_bf16 v[56:71],v[24:27],a[144:147],v[56:71]
v_mfma_f32_32x32x16_bf16 v[72:87],v[24:27],v[240:243],v[72:87]
v_mfma_f32_32x32x16_bf16 v[56:71],v[24:27],a[148:151],v[56:71]
v_mfma_f32_32x32x16_bf16 v[72:87],v[24:27],v[244:247],v[72:87]
v_mfma_f32_32x32x16_bf16 v[56:71],v[24:27],a[152:155],v[56:71]
v_mfma_f32_32x32x16_bf16 v[72:87],v[24:27],v[248:251],v[72:87]
v_mfma_f32_32x32x16_bf16 v[56:71],v[24:27],a[156:159],v[56:71]
v_mfma_f32_32x32x16_bf16 v[72:87],v[24:27],v[252:255],v[72:87]
s_nop 10
v_mov_b32 v120,v56
v_mov_b32 v121,v72
s_barrier
s_lshl_b32 s3,s49,2
v_mov_b32 v7,s3
s_nop 1
ibw_246:
buffer_load_dword v6,v7,s[12:15],0 offen sc1
s_waitcnt vmcnt(0)
v_cmp_ne_u32 vcc,256,v6
s_nop 0
s_cbranch_vccz ok_247
s_sleep 8
s_sub_u32 s47,s47,1
s_cbranch_scc1 ABORT
s_branch ibw_246
ok_247:
s_cmp_lg_u32 s49,0
s_cbranch_scc1 ibok_248
v_and_b32 v7,7,v0
v_lshlrev_b32 v7,2,v7
buffer_load_dword v6,v7,s[12:15],0 offen offset:32 sc1
s_waitcnt vmcnt(0)
v_cmp_ne_u32 vcc,32,v6
s_nop 0
s_cbranch_vccz ibok_248
s_barrier
s_mov_b32 s49,1
s_mov_b32 s3,s2
s_load_dwordx16 s[16:31],s[0:1],0
s_load_dwordx8 s[32:39],s[0:1],64
s_waitcnt lgkmcnt(0)
s_branch DISPATCH
ibok_248:
s_mov_b32 s50,0
s_mov_b32 s32,0
s_mov_b32 s57,0
s_mov_b32 s59,2147483648
s_mov_b32 s82,2147483648
s_mov_b32 s39,2147483648
v_mov_b32 v22,94208
s_mov_b32 s72,0
s_mov_b32 s73,0
s_mov_b32 s83,s100
s_min_u32 s62,s32,127
s_sub_u32 s60,s62,20
s_lshr_b32 s34,s60,1
s_and_b32 s33,s60,1
s_xor_b32 s33,s33,1
s_cmp_eq_u32 s33,0
s_cselect_b32 s61,20,0
s_add_u32 s34,s34,s61
s_sub_u32 s61,s60,44
s_cmp_ge_u32 s60,88
s_cselect_b32 s34,s61,s34
s_cselect_b32 s33,1,s33
s_cmp_lt_u32 s62,20
s_cselect_b32 s34,s62,s34
s_cselect_b32 s33,0,s33
s_lshl_b32 s35,s33,6
s_add_u32 s35,s35,s34
s_lshl_b32 s35,s35,9
s_add_u32 s35,s35,0
s_lshl_b32 s60,s33,5
s_add_u32 s60,s60,7
v_min_u32 v2,s60,v0
v_lshlrev_b32 v2,2,v2
s_nop 1
QKVV_COLD0:
s_cmp_lg_u32 s46,0
s_cbranch_scc1 cp_249
fb_250:
buffer_load_dword v3,v2,s[8:11],s35 offen sc1
s_waitcnt vmcnt(0)
v_cmp_eq_u32 vcc,0,v3
s_nop 0
s_cbranch_vccz ok_251
s_sleep 7
s_sub_u32 s47,s47,1
s_cbranch_scc1 ABORT
s_branch fb_250
ok_251:
cp_249:
s_barrier
s_lshl_b32 s60,s33,6
s_add_u32 s60,s60,s34
s_mul_i32 s60,s60,46080
s_add_u32 s60,s60,206569472
s_lshl_b32 s62,s46,10
s_add_u32 s62,s62,40960
s_add_u32 m0,s57,s62
s_add_u32 s63,s60,s62
buffer_load_dwordx4 v1,s[8:11],s63 offen sc1 lds
s_add_u32 m0,s57,45056
s_add_u32 s63,s60,45056
buffer_load_dwordx4 v1,s[8:11],s63 offen sc1 lds
s_mul_i32 s61,s46,10240
s_add_u32 s60,s60,s61
s_add_u32 s61,s61,s57
s_add_u32 m0,s61,0
s_add_u32 s63,s60,0
buffer_load_dwordx4 v1,s[8:11],s63 offen sc1 lds
buffer_load_dwordx4 v1,s[8:11],s63 offen offset:1024 sc1 lds
buffer_load_dwordx4 v1,s[8:11],s63 offen offset:2048 sc1 lds
buffer_load_dwordx4 v1,s[8:11],s63 offen offset:3072 sc1 lds
s_add_u32 m0,s61,4096
s_add_u32 s63,s60,4096
buffer_load_dwordx4 v1,s[8:11],s63 offen sc1 lds
buffer_load_dwordx4 v1,s[8:11],s63 offen offset:1024 sc1 lds
buffer_load_dwordx4 v1,s[8:11],s63 offen offset:2048 sc1 lds
buffer_load_dwordx4 v1,s[8:11],s63 offen offset:3072 sc1 lds
s_add_u32 m0,s61,8192
s_add_u32 s63,s60,8192
buffer_load_dwordx4 v1,s[8:11],s63 offen sc1 lds
buffer_load_dwordx4 v1,s[8:11],s63 offen offset:1024 sc1 lds
QKVV_CD0:
s_mov_b32 s51,s33
s_mov_b32 s52,s34
s_add_u32 s32,s32,1
s_min_u32 s62,s32,127
s_sub_u32 s60,s62,20
s_lshr_b32 s34,s60,1
s_and_b32 s33,s60,1
s_xor_b32 s33,s33,1
s_cmp_eq_u32 s33,0
s_cselect_b32 s61,20,0
s_add_u32 s34,s34,s61
s_sub_u32 s61,s60,44
s_cmp_ge_u32 s60,88
s_cselect_b32 s34,s61,s34
s_cselect_b32 s33,1,s33
s_cmp_lt_u32 s62,20
s_cselect_b32 s34,s62,s34
s_cselect_b32 s33,0,s33
s_lshl_b32 s35,s33,6
s_add_u32 s35,s35,s34
s_lshl_b32 s35,s35,9
s_add_u32 s35,s35,0
s_lshl_b32 s60,s33,5
s_add_u32 s60,s60,7
v_min_u32 v2,s60,v0
v_lshlrev_b32 v2,2,v2
s_cmp_lg_u32 s46,0
s_cbranch_scc1 w0_252
buffer_load_dword v3,v2,s[8:11],s35 offen sc1
w0_252:
s_waitcnt vmcnt(0)
s_mov_b64 exec,1
buffer_store_dword v5,v1,s[8:11],s59 offen sc1
s_mov_b64 exec,-1
s_mov_b32 s59,2147483648
s_cmp_lg_u32 s46,0
s_cbranch_scc1 w0_253
v_cmp_eq_u32 vcc,0,v3
s_cmp_eq_u64 vcc,0
s_cselect_b32 s36,0,2147483648
s_cmp_lt_u32 s32,128
s_cselect_b32 s36,s36,2147483648
v_mov_b32 v23,s36
ds_write_b32 v22,v23
w0_253:
s_waitcnt lgkmcnt(0)
s_barrier
ds_read_b32 v23,v22
ds_read_b128 v[24:27],v16 offset:0
ds_read_b128 v[28:31],v17 offset:0
ds_read_b128 v[32:35],v16 offset:2048
ds_read_b128 v[36:39],v17 offset:2048
ds_read_b128 v[40:43],v16 offset:4096
s_waitcnt lgkmcnt(5)
v_readfirstlane_b32 s37,v23
s_nop 4
QKVV_B0:
s_waitcnt lgkmcnt(3)
v_mfma_f32_32x32x16_bf16 v[56:71],v[24:27],a[0:3],0
ds_read_b128 v[44:47],v17 offset:4096
v_add_u32 v189,s57,v188
v_mfma_f32_32x32x16_bf16 v[72:87],v[24:27],a[160:163],0
v_add_u32 v8,0x800,v189
s_sub_u32 s66,46080,s57
s_lshl_b32 s60,s33,6
s_add_u32 s60,s60,s34
s_mul_i32 s60,s60,46080
s_add_u32 s60,s60,s37
v_mfma_f32_32x32x16_bf16 v[56:71],v[28:31],a[4:7],v[56:71]
ds_read_b128 v[48:51],v16 offset:6144
ds_read2_b64 v[156:159],v189 offset0:0 offset1:32
s_add_u32 s60,s60,206569472
s_lshl_b32 s62,s46,10
v_mfma_f32_32x32x16_bf16 v[72:87],v[28:31],a[164:167],v[72:87]
ds_read2_b64 v[160:163],v189 offset0:64 offset1:96
s_add_u32 s62,s62,40960
s_add_u32 m0,s66,s62
s_add_u32 s63,s60,s62
s_waitcnt lgkmcnt(5)
v_mfma_f32_32x32x16_bf16 v[56:71],v[32:35],a[8:11],v[56:71]
ds_read_b128 v[52:55],v17 offset:6144
ds_read2_b64 v[164:167],v189 offset0:128 offset1:160
buffer_load_dwordx4 v1,s[8:11],s63 offen sc1 lds
v_mfma_f32_32x32x16_bf16 v[72:87],v[32:35],a[168:171],v[72:87]
ds_read2_b64 v[168:171],v189 offset0:192 offset1:224
s_add_u32 m0,s66,45056
s_add_u32 s63,s60,45056
s_mul_i32 s74,s73,393216
s_add_u32 s74,s74,s39
v_mfma_f32_32x32x16_bf16 v[56:71],v[36:39],a[12:15],v[56:71]
ds_read_b128 v[24:27],v16 offset:8192
ds_read2_b64 v[172:175],v8 offset0:0 offset1:32
s_add_u32 s74,s74,s70
v_fma_f32 v88,-v124,v120,v88
v_mfma_f32_32x32x16_bf16 v[72:87],v[36:39],a[172:175],v[72:87]
buffer_load_dwordx4 v1,s[8:11],s63 offen sc1 lds
s_mul_i32 s61,s46,10240
s_add_u32 s60,s60,s61
s_add_u32 s61,s61,s66
s_waitcnt lgkmcnt(8)
v_mfma_f32_32x32x16_bf16 v[56:71],v[40:43],a[16:19],v[56:71]
ds_read_b128 v[28:31],v17 offset:8192
s_add_u32 m0,s61,0
s_add_u32 s63,s60,0
v_fma_f32 v89,-v126,v120,v89
v_fma_f32 v90,-v128,v120,v90
v_mfma_f32_32x32x16_bf16 v[72:87],v[40:43],a[176:179],v[72:87]
v_fma_f32 v91,-v130,v120,v91
v_fma_f32 v96,-v140,v120,v96
v_fma_f32 v97,-v142,v120,v97
v_fma_f32 v98,-v144,v120,v98
v_fma_f32 v99,-v146,v120,v99
v_mul_f32 v88,v88,v125
v_mfma_f32_32x32x16_bf16 v[56:71],v[44:47],a[20:23],v[56:71]
ds_read_b128 v[32:35],v16 offset:10240
buffer_load_dwordx4 v1,s[8:11],s63 offen sc1 lds
v_mul_f32 v89,v89,v127
v_mul_f32 v90,v90,v129
v_mfma_f32_32x32x16_bf16 v[72:87],v[44:47],a[180:183],v[72:87]
v_mul_f32 v91,v91,v131
v_mul_f32 v96,v96,v141
v_mul_f32 v97,v97,v143
v_mul_f32 v98,v98,v145
v_mul_f32 v99,v99,v147
s_waitcnt lgkmcnt(6)
v_mfma_f32_32x32x16_bf16 v[56:71],v[48:51],a[24:27],v[56:71]
ds_read_b128 v[36:39],v17 offset:10240
v_cvt_pk_bf16_f32 v180,v88,v89
v_cvt_pk_bf16_f32 v181,v90,v91
v_cvt_pk_bf16_f32 v182,v96,v97
v_cvt_pk_bf16_f32 v183,v98,v99
v_mfma_f32_32x32x16_bf16 v[72:87],v[48:51],a[184:187],v[72:87]
buffer_load_dwordx4 v1,s[8:11],s63 offen offset:1024 sc1 lds
buffer_store_dwordx4 v[180:183],v20,s[8:11],s74 offen sc1
v_fma_f32 v92,-v132,v120,v92
v_fma_f32 v93,-v134,v120,v93
v_mfma_f32_32x32x16_bf16 v[56:71],v[52:55],a[28:31],v[56:71]
ds_read_b128 v[40:43],v16 offset:12288
v_fma_f32 v94,-v136,v120,v94
v_fma_f32 v95,-v138,v120,v95
v_fma_f32 v100,-v148,v120,v100
v_fma_f32 v101,-v150,v120,v101
v_mfma_f32_32x32x16_bf16 v[72:87],v[52:55],a[188:191],v[72:87]
v_fma_f32 v102,-v152,v120,v102
v_fma_f32 v103,-v154,v120,v103
v_mul_f32 v92,v92,v133
v_mul_f32 v93,v93,v135
v_mul_f32 v94,v94,v137
s_waitcnt lgkmcnt(3)
v_mfma_f32_32x32x16_bf16 v[56:71],v[24:27],a[32:35],v[56:71]
ds_read_b128 v[44:47],v17 offset:12288
buffer_load_dwordx4 v1,s[8:11],s63 offen offset:2048 sc1 lds
v_mul_f32 v95,v95,v139
v_mul_f32 v100,v100,v149
v_mfma_f32_32x32x16_bf16 v[72:87],v[24:27],a[192:195],v[72:87]
v_mul_f32 v101,v101,v151
v_mul_f32 v102,v102,v153
v_mul_f32 v103,v103,v155
v_cvt_pk_bf16_f32 v184,v92,v93
v_cvt_pk_bf16_f32 v185,v94,v95
v_cvt_pk_bf16_f32 v186,v100,v101
v_mfma_f32_32x32x16_bf16 v[56:71],v[28:31],a[36:39],v[56:71]
ds_read_b128 v[48:51],v16 offset:14336
v_cvt_pk_bf16_f32 v187,v102,v103
buffer_store_dwordx4 v[184:187],v21,s[8:11],s74 offen sc1
v_fma_f32 v104,-v124,v121,v104
v_mfma_f32_32x32x16_bf16 v[72:87],v[28:31],a[196:199],v[72:87]
buffer_load_dwordx4 v1,s[8:11],s63 offen offset:3072 sc1 lds
s_add_u32 m0,s61,4096
s_add_u32 s63,s60,4096
v_fma_f32 v105,-v126,v121,v105
s_waitcnt lgkmcnt(3)
v_mfma_f32_32x32x16_bf16 v[56:71],v[32:35],a[40:43],v[56:71]
ds_read_b128 v[52:55],v17 offset:14336
v_fma_f32 v106,-v128,v121,v106
v_fma_f32 v107,-v130,v121,v107
v_fma_f32 v112,-v140,v121,v112
v_fma_f32 v113,-v142,v121,v113
v_mfma_f32_32x32x16_bf16 v[72:87],v[32:35],a[200:203],v[72:87]
v_fma_f32 v114,-v144,v121,v114
v_fma_f32 v115,-v146,v121,v115
v_mul_f32 v104,v104,v125
v_mul_f32 v105,v105,v127
v_mul_f32 v106,v106,v129
v_mul_f32 v107,v107,v131
v_mfma_f32_32x32x16_bf16 v[56:71],v[36:39],a[44:47],v[56:71]
ds_read_b128 v[24:27],v16 offset:16384
buffer_load_dwordx4 v1,s[8:11],s63 offen sc1 lds
v_mul_f32 v112,v112,v141
v_mul_f32 v113,v113,v143
v_mfma_f32_32x32x16_bf16 v[72:87],v[36:39],a[204:207],v[72:87]
v_mul_f32 v114,v114,v145
v_mul_f32 v115,v115,v147
v_cvt_pk_bf16_f32 v180,v104,v105
v_cvt_pk_bf16_f32 v181,v106,v107
v_cvt_pk_bf16_f32 v182,v112,v113
s_waitcnt lgkmcnt(3)
v_mfma_f32_32x32x16_bf16 v[56:71],v[40:43],a[48:51],v[56:71]
ds_read_b128 v[28:31],v17 offset:16384
v_cvt_pk_bf16_f32 v183,v114,v115
buffer_store_dwordx4 v[180:183],v20,s[8:11],s74 offen offset:2048 sc1
v_fma_f32 v108,-v132,v121,v108
v_mfma_f32_32x32x16_bf16 v[72:87],v[40:43],a[208:211],v[72:87]
buffer_load_dwordx4 v1,s[8:11],s63 offen offset:1024 sc1 lds
v_fma_f32 v109,-v134,v121,v109
v_fma_f32 v110,-v136,v121,v110
v_fma_f32 v111,-v138,v121,v111
v_fma_f32 v116,-v148,v121,v116
v_mfma_f32_32x32x16_bf16 v[56:71],v[44:47],a[52:55],v[56:71]
ds_read_b128 v[32:35],v16 offset:18432
v_fma_f32 v117,-v150,v121,v117
v_fma_f32 v118,-v152,v121,v118
v_fma_f32 v119,-v154,v121,v119
v_mul_f32 v108,v108,v133
v_mfma_f32_32x32x16_bf16 v[72:87],v[44:47],a[212:215],v[72:87]
v_mul_f32 v109,v109,v135
v_mul_f32 v110,v110,v137
v_mul_f32 v111,v111,v139
v_mul_f32 v116,v116,v149
v_mul_f32 v117,v117,v151
s_waitcnt lgkmcnt(3)
v_mfma_f32_32x32x16_bf16 v[56:71],v[48:51],a[56:59],v[56:71]
ds_read_b128 v[36:39],v17 offset:18432
buffer_load_dwordx4 v1,s[8:11],s63 offen offset:2048 sc1 lds
v_mul_f32 v118,v118,v153
v_mul_f32 v119,v119,v155
v_mfma_f32_32x32x16_bf16 v[72:87],v[48:51],a[216:219],v[72:87]
v_cvt_pk_bf16_f32 v184,v108,v109
v_cvt_pk_bf16_f32 v185,v110,v111
v_cvt_pk_bf16_f32 v186,v116,v117
v_cvt_pk_bf16_f32 v187,v118,v119
buffer_store_dwordx4 v[184:187],v21,s[8:11],s74 offen offset:2048 sc1
v_mfma_f32_32x32x16_bf16 v[56:71],v[52:55],a[60:63],v[56:71]
ds_read_b128 v[40:43],v16 offset:20480
s_waitcnt vmcnt(13)
s_mov_b64 exec,1
buffer_store_dword v5,v1,s[8:11],s59 offen sc1
s_mov_b64 exec,-1
s_mov_b32 s59,2147483648
v_mfma_f32_32x32x16_bf16 v[72:87],v[52:55],a[220:223],v[72:87]
buffer_load_dwordx4 v1,s[8:11],s63 offen offset:3072 sc1 lds
s_add_u32 m0,s61,8192
s_add_u32 s63,s60,8192
s_lshl_b32 s82,s72,6
s_waitcnt lgkmcnt(3)
v_mfma_f32_32x32x16_bf16 v[56:71],v[24:27],a[64:67],v[56:71]
ds_read_b128 v[44:47],v17 offset:20480
s_add_u32 s82,s82,s73
s_lshl_b32 s82,s82,9
s_add_u32 s82,s82,s71
s_lshl_b32 s75,s69,2
v_mfma_f32_32x32x16_bf16 v[72:87],v[24:27],a[224:227],v[72:87]
s_add_u32 s82,s82,s75
s_add_u32 s82,s82,s39
v_pk_add_f32 v[156:157],v[156:157],v[166:167]
v_mfma_f32_32x32x16_bf16 v[56:71],v[28:31],a[68:71],v[56:71]
ds_read_b128 v[48:51],v16 offset:22528
buffer_load_dwordx4 v1,s[8:11],s63 offen sc1 lds
v_pk_add_f32 v[158:159],v[158:159],v[168:169]
v_mfma_f32_32x32x16_bf16 v[72:87],v[28:31],a[228:231],v[72:87]
v_pk_add_f32 v[160:161],v[160:161],v[170:171]
v_pk_add_f32 v[162:163],v[162:163],v[172:173]
s_waitcnt lgkmcnt(3)
v_mfma_f32_32x32x16_bf16 v[56:71],v[32:35],a[72:75],v[56:71]
ds_read_b128 v[52:55],v17 offset:22528
v_pk_add_f32 v[164:165],v[164:165],v[174:175]
v_pk_add_f32 v[156:157],v[156:157],v[158:159]
v_mfma_f32_32x32x16_bf16 v[72:87],v[32:35],a[232:235],v[72:87]
buffer_load_dwordx4 v1,s[8:11],s63 offen offset:1024 sc1 lds
s_mov_b32 s53,s33
s_mov_b32 s54,s34
s_cmp_eq_u32 s37,0
s_addc_u32 s32,s32,0
v_mfma_f32_32x32x16_bf16 v[56:71],v[36:39],a[76:79],v[56:71]
ds_read_b128 v[24:27],v16 offset:24576
s_min_u32 s62,s32,127
s_sub_u32 s60,s62,20
s_lshr_b32 s34,s60,1
s_and_b32 s33,s60,1
v_mfma_f32_32x32x16_bf16 v[72:87],v[36:39],a[236:239],v[72:87]
s_xor_b32 s33,s33,1
s_cmp_eq_u32 s33,0
s_cselect_b32 s61,20,0
s_add_u32 s34,s34,s61
s_sub_u32 s61,s60,44
s_waitcnt lgkmcnt(3)
v_mfma_f32_32x32x16_bf16 v[56:71],v[40:43],a[80:83],v[56:71]
ds_read_b128 v[28:31],v17 offset:24576
s_cmp_ge_u32 s60,88
s_cselect_b32 s34,s61,s34
s_cselect_b32 s33,1,s33
v_mfma_f32_32x32x16_bf16 v[72:87],v[40:43],a[240:243],v[72:87]
s_cmp_lt_u32 s62,20
s_cselect_b32 s34,s62,s34
s_cselect_b32 s33,0,s33
s_lshl_b32 s35,s33,6
s_add_u32 s35,s35,s34
s_lshl_b32 s35,s35,9
v_mfma_f32_32x32x16_bf16 v[56:71],v[44:47],a[84:87],v[56:71]
ds_read_b128 v[32:35],v16 offset:26624
s_add_u32 s35,s35,0
s_lshl_b32 s60,s33,5
s_add_u32 s60,s60,7
v_min_u32 v2,s60,v0
v_mfma_f32_32x32x16_bf16 v[72:87],v[44:47],a[244:247],v[72:87]
v_lshlrev_b32 v2,2,v2
v_pk_add_f32 v[160:161],v[160:161],v[162:163]
v_pk_add_f32 v[156:157],v[156:157],v[160:161]
s_waitcnt lgkmcnt(3)
v_mfma_f32_32x32x16_bf16 v[56:71],v[48:51],a[88:91],v[56:71]
ds_read_b128 v[36:39],v17 offset:26624
s_cmp_lg_u32 s46,0
s_cbranch_scc1 w0_254
buffer_load_dword v3,v2,s[8:11],s35 offen sc1
w0_254:
v_mfma_f32_32x32x16_bf16 v[72:87],v[48:51],a[248:251],v[72:87]
v_pk_add_f32 v[156:157],v[156:157],v[164:165]
v_mov_b32 v158,v156
v_mov_b32 v159,v157
s_nop 0
v_permlane32_swap_b32 v156,v158
v_permlane32_swap_b32 v157,v159
v_mfma_f32_32x32x16_bf16 v[56:71],v[52:55],a[92:95],v[56:71]
ds_read_b128 v[40:43],v16 offset:28672
v_add_f32 v176,v156,v158
v_add_f32 v177,v157,v159
v_mul_f32 v176,0x3acccccd,v176
v_mul_f32 v177,0x3acccccd,v177
v_mfma_f32_32x32x16_bf16 v[72:87],v[52:55],a[252:255],v[72:87]
v_fma_f32 v177,-v176,v176,v177
v_max_f32 v177,0,v177
v_cvt_pk_bf16_f32 v8,v176,v177
v_lshlrev_b32 v176,16,v8
v_and_b32 v177,0xffff0000,v8
s_waitcnt lgkmcnt(3)
v_mfma_f32_32x32x16_bf16 v[56:71],v[24:27],a[96:99],v[56:71]
ds_read_b128 v[44:47],v17 offset:28672
v_add_f32 v177,0x3727c5ac,v177
v_cvt_pk_bf16_f32 v8,v177,v177
v_lshlrev_b32 v177,16,v8
v_mfma_f32_32x32x16_bf16 v[72:87],v[24:27],v[192:195],v[72:87]
v_sqrt_f32 v177,v177
s_nop 0
v_cvt_pk_bf16_f32 v8,v177,v177
v_lshlrev_b32 v177,16,v8
v_rcp_f32 v177,v177
v_mfma_f32_32x32x16_bf16 v[56:71],v[28:31],a[100:103],v[56:71]
ds_read_b128 v[48:51],v16 offset:30720
s_cmp_eq_u32 s51,0
s_cselect_b64 s[76:77],-1,0
v_cndmask_b32 v176,v176,0,s[76:77]
v_cndmask_b32 v177,v177,1.0,s[76:77]
v_mfma_f32_32x32x16_bf16 v[72:87],v[28:31],v[196:199],v[72:87]
s_mov_b32 s72,s51
s_mov_b32 s73,s52
ds_write_b64 v190,v[176:177]
s_waitcnt lgkmcnt(4)
v_mfma_f32_32x32x16_bf16 v[56:71],v[32:35],a[104:107],v[56:71]
ds_read_b128 v[52:55],v17 offset:30720
ds_read_b128 v[124:127],v191 offset:0
ds_read_b128 v[128:131],v191 offset:16
v_mfma_f32_32x32x16_bf16 v[72:87],v[32:35],v[200:203],v[72:87]
ds_read_b128 v[132:135],v191 offset:64
ds_read_b128 v[136:139],v191 offset:80
ds_read_b128 v[140:143],v191 offset:128
v_mfma_f32_32x32x16_bf16 v[56:71],v[36:39],a[108:111],v[56:71]
ds_read_b128 v[24:27],v16 offset:32768
ds_read_b128 v[144:147],v191 offset:144
ds_read_b128 v[148:151],v191 offset:192
v_mfma_f32_32x32x16_bf16 v[72:87],v[36:39],v[204:207],v[72:87]
ds_read_b128 v[152:155],v191 offset:208
s_waitcnt lgkmcnt(12)
v_mfma_f32_32x32x16_bf16 v[56:71],v[40:43],a[112:115],v[56:71]
ds_read_b128 v[28:31],v17 offset:32768
v_mfma_f32_32x32x16_bf16 v[72:87],v[40:43],v[208:211],v[72:87]
v_mfma_f32_32x32x16_bf16 v[56:71],v[44:47],a[116:119],v[56:71]
ds_read_b128 v[32:35],v16 offset:34816
v_mfma_f32_32x32x16_bf16 v[72:87],v[44:47],v[212:215],v[72:87]
s_waitcnt lgkmcnt(11)
v_mfma_f32_32x32x16_bf16 v[56:71],v[48:51],a[120:123],v[56:71]
ds_read_b128 v[36:39],v17 offset:34816
v_mfma_f32_32x32x16_bf16 v[72:87],v[48:51],v[216:219],v[72:87]
v_mfma_f32_32x32x16_bf16 v[56:71],v[52:55],a[124:127],v[56:71]
ds_read_b128 v[40:43],v16 offset:36864
v_mfma_f32_32x32x16_bf16 v[72:87],v[52:55],v[220:223],v[72:87]
s_waitcnt vmcnt(0)
s_cmp_lg_u32 s46,0
s_cbranch_scc1 w0_255
v_cmp_eq_u32 vcc,0,v3
s_cmp_eq_u64 vcc,0
s_cselect_b32 s36,0,2147483648
s_cmp_lt_u32 s32,128
s_cselect_b32 s36,s36,2147483648
v_mov_b32 v23,s36
ds_write_b32 v22,v23
w0_255:
s_waitcnt lgkmcnt(3)
v_mfma_f32_32x32x16_bf16 v[56:71],v[24:27],a[128:131],v[56:71]
ds_read_b128 v[44:47],v17 offset:36864
s_mov_b64 exec,1
buffer_store_dword v5,v1,s[8:11],s82 offen sc1
s_mov_b64 exec,-1
s_mov_b32 s82,2147483648
v_mfma_f32_32x32x16_bf16 v[72:87],v[24:27],v[224:227],v[72:87]
v_mfma_f32_32x32x16_bf16 v[56:71],v[28:31],a[132:135],v[56:71]
ds_read_b128 v[48:51],v16 offset:38912
v_mfma_f32_32x32x16_bf16 v[72:87],v[28:31],v[228:231],v[72:87]
s_waitcnt lgkmcnt(3)
v_mfma_f32_32x32x16_bf16 v[56:71],v[32:35],a[136:139],v[56:71]
ds_read_b128 v[52:55],v17 offset:38912
v_mfma_f32_32x32x16_bf16 v[72:87],v[32:35],v[232:235],v[72:87]
s_waitcnt lgkmcnt(2)
s_barrier
ds_read_b32 v23,v22
v_mfma_f32_32x32x16_bf16 v[56:71],v[36:39],a[140:143],v[56:71]
ds_read_b128 v[24:27],v18 offset:0
v_mfma_f32_32x32x16_bf16 v[72:87],v[36:39],v[236:239],v[72:87]
v_mfma_f32_32x32x16_bf16 v[56:71],v[40:43],a[144:147],v[56:71]
ds_read_b128 v[28:31],v19 offset:0
v_mfma_f32_32x32x16_bf16 v[72:87],v[40:43],v[240:243],v[72:87]
v_mfma_f32_32x32x16_bf16 v[56:71],v[44:47],a[148:151],v[56:71]
ds_read_b128 v[32:35],v18 offset:2048
v_mfma_f32_32x32x16_bf16 v[72:87],v[44:47],v[244:247],v[72:87]
s_waitcnt lgkmcnt(4)
v_mfma_f32_32x32x16_bf16 v[56:71],v[48:51],a[152:155],v[56:71]
ds_read_b128 v[36:39],v19 offset:2048
s_waitcnt lgkmcnt(4)
v_readfirstlane_b32 s38,v23
v_mfma_f32_32x32x16_bf16 v[72:87],v[48:51],v[248:251],v[72:87]
v_mfma_f32_32x32x16_bf16 v[56:71],v[52:55],a[156:159],v[56:71]
ds_read_b128 v[40:43],v18 offset:4096
v_mfma_f32_32x32x16_bf16 v[72:87],v[52:55],v[252:255],v[72:87]
s_cmp_lg_u32 s37,0
s_cbranch_scc1 nf_256
s_cmp_lt_u32 s50,2
s_cbranch_scc1 now_257
s_mov_b32 s39,0
s_add_u32 s50,s50,1
s_sub_u32 s57,46080,s57
s_mov_b32 s51,s53
s_mov_b32 s52,s54
s_mov_b32 s37,s38
s_branch QKVV_B1
s_nop 0
now_257:
s_mov_b32 s55,0
s_branch nt_258
nf_256:
s_mov_b32 s55,2
s_cmp_lg_u32 s38,0
s_cbranch_scc1 nt_258
s_mov_b32 s55,1
s_mov_b32 s37,0
s_sub_u32 s66,46080,s57
s_lshl_b32 s60,s33,6
s_add_u32 s60,s60,s34
s_mul_i32 s60,s60,46080
s_add_u32 s60,s60,s37
s_add_u32 s60,s60,206569472
s_lshl_b32 s62,s46,10
s_add_u32 s62,s62,40960
s_add_u32 m0,s66,s62
s_add_u32 s63,s60,s62
buffer_load_dwordx4 v1,s[8:11],s63 offen sc1 lds
s_add_u32 m0,s66,45056
s_add_u32 s63,s60,45056
buffer_load_dwordx4 v1,s[8:11],s63 offen sc1 lds
s_mul_i32 s61,s46,10240
s_add_u32 s60,s60,s61
s_add_u32 s61,s61,s66
s_add_u32 m0,s61,0
s_add_u32 s63,s60,0
buffer_load_dwordx4 v1,s[8:11],s63 offen sc1 lds
buffer_load_dwordx4 v1,s[8:11],s63 offen offset:1024 sc1 lds
buffer_load_dwordx4 v1,s[8:11],s63 offen offset:2048 sc1 lds
buffer_load_dwordx4 v1,s[8:11],s63 offen offset:3072 sc1 lds
s_add_u32 m0,s61,4096
s_add_u32 s63,s60,4096
buffer_load_dwordx4 v1,s[8:11],s63 offen sc1 lds
buffer_load_dwordx4 v1,s[8:11],s63 offen offset:1024 sc1 lds
buffer_load_dwordx4 v1,s[8:11],s63 offen offset:2048 sc1 lds
buffer_load_dwordx4 v1,s[8:11],s63 offen offset:3072 sc1 lds
s_add_u32 m0,s61,8192
s_add_u32 s63,s60,8192
buffer_load_dwordx4 v1,s[8:11],s63 offen sc1 lds
buffer_load_dwordx4 v1,s[8:11],s63 offen offset:1024 sc1 lds
nt_258:
s_mov_b32 s39,0
s_mul_i32 s74,s73,393216
s_add_u32 s74,s74,s39
s_add_u32 s74,s74,s70
v_fma_f32 v56,-v124,v120,v56
v_fma_f32 v57,-v126,v120,v57
v_fma_f32 v58,-v128,v120,v58
v_fma_f32 v59,-v130,v120,v59
v_fma_f32 v64,-v140,v120,v64
v_fma_f32 v65,-v142,v120,v65
v_fma_f32 v66,-v144,v120,v66
v_fma_f32 v67,-v146,v120,v67
v_mul_f32 v56,v56,v125
v_mul_f32 v57,v57,v127
v_mul_f32 v58,v58,v129
v_mul_f32 v59,v59,v131
v_mul_f32 v64,v64,v141
v_mul_f32 v65,v65,v143
v_mul_f32 v66,v66,v145
v_mul_f32 v67,v67,v147
v_cvt_pk_bf16_f32 v180,v56,v57
v_cvt_pk_bf16_f32 v181,v58,v59
v_cvt_pk_bf16_f32 v182,v64,v65
v_cvt_pk_bf16_f32 v183,v66,v67
buffer_store_dwordx4 v[180:183],v20,s[8:11],s74 offen sc1
v_fma_f32 v60,-v132,v120,v60
v_fma_f32 v61,-v134,v120,v61
v_fma_f32 v62,-v136,v120,v62
v_fma_f32 v63,-v138,v120,v63
v_fma_f32 v68,-v148,v120,v68
v_fma_f32 v69,-v150,v120,v69
v_fma_f32 v70,-v152,v120,v70
v_fma_f32 v71,-v154,v120,v71
v_mul_f32 v60,v60,v133
v_mul_f32 v61,v61,v135
v_mul_f32 v62,v62,v137
v_mul_f32 v63,v63,v139
v_mul_f32 v68,v68,v149
v_mul_f32 v69,v69,v151
v_mul_f32 v70,v70,v153
v_mul_f32 v71,v71,v155
v_cvt_pk_bf16_f32 v184,v60,v61
v_cvt_pk_bf16_f32 v185,v62,v63
v_cvt_pk_bf16_f32 v186,v68,v69
v_cvt_pk_bf16_f32 v187,v70,v71
buffer_store_dwordx4 v[184:187],v21,s[8:11],s74 offen sc1
v_fma_f32 v72,-v124,v121,v72
v_fma_f32 v73,-v126,v121,v73
v_fma_f32 v74,-v128,v121,v74
v_fma_f32 v75,-v130,v121,v75
v_fma_f32 v80,-v140,v121,v80
v_fma_f32 v81,-v142,v121,v81
v_fma_f32 v82,-v144,v121,v82
v_fma_f32 v83,-v146,v121,v83
v_mul_f32 v72,v72,v125
v_mul_f32 v73,v73,v127
v_mul_f32 v74,v74,v129
v_mul_f32 v75,v75,v131
v_mul_f32 v80,v80,v141
v_mul_f32 v81,v81,v143
v_mul_f32 v82,v82,v145
v_mul_f32 v83,v83,v147
v_cvt_pk_bf16_f32 v180,v72,v73
v_cvt_pk_bf16_f32 v181,v74,v75
v_cvt_pk_bf16_f32 v182,v80,v81
v_cvt_pk_bf16_f32 v183,v82,v83
buffer_store_dwordx4 v[180:183],v20,s[8:11],s74 offen offset:2048 sc1
v_fma_f32 v76,-v132,v121,v76
v_fma_f32 v77,-v134,v121,v77
v_fma_f32 v78,-v136,v121,v78
v_fma_f32 v79,-v138,v121,v79
v_fma_f32 v84,-v148,v121,v84
v_fma_f32 v85,-v150,v121,v85
v_fma_f32 v86,-v152,v121,v86
v_fma_f32 v87,-v154,v121,v87
v_mul_f32 v76,v76,v133
v_mul_f32 v77,v77,v135
v_mul_f32 v78,v78,v137
v_mul_f32 v79,v79,v139
v_mul_f32 v84,v84,v149
v_mul_f32 v85,v85,v151
v_mul_f32 v86,v86,v153
v_mul_f32 v87,v87,v155
v_cvt_pk_bf16_f32 v184,v76,v77
v_cvt_pk_bf16_f32 v185,v78,v79
v_cvt_pk_bf16_f32 v186,v84,v85
v_cvt_pk_bf16_f32 v187,v86,v87
buffer_store_dwordx4 v[184:187],v21,s[8:11],s74 offen offset:2048 sc1
s_lshl_b32 s82,s72,6
s_add_u32 s82,s82,s73
s_lshl_b32 s82,s82,9
s_add_u32 s82,s82,s71
s_lshl_b32 s75,s69,2
s_add_u32 s82,s82,s75
s_add_u32 s82,s82,s39
s_mov_b32 s59,s82
s_mov_b32 s82,2147483648
s_mov_b32 s39,2147483648
s_add_u32 s50,s50,1
s_sub_u32 s57,46080,s57
s_mov_b32 s51,s53
s_mov_b32 s52,s54
s_mov_b32 s37,s38
s_cmp_eq_u32 s55,0
s_cbranch_scc1 QKVV_B1
s_cmp_eq_u32 s55,1
s_cbranch_scc1 QKVV_CD1
s_waitcnt vmcnt(0)
s_mov_b64 exec,1
buffer_store_dword v5,v1,s[8:11],s59 offen sc1
s_mov_b64 exec,-1
s_mov_b32 s59,2147483648
s_cmp_eq_u32 s50,128
s_cbranch_scc1 QKVV_END
s_branch QKVV_COLD1
QKVV_COLD1:
s_cmp_lg_u32 s46,0
s_cbranch_scc1 cp_259
fb_260:
buffer_load_dword v3,v2,s[8:11],s35 offen sc1
s_waitcnt vmcnt(0)
v_cmp_eq_u32 vcc,0,v3
s_nop 0
s_cbranch_vccz ok_261
s_sleep 7
s_sub_u32 s47,s47,1
s_cbranch_scc1 ABORT
s_branch fb_260
ok_261:
cp_259:
s_barrier
s_lshl_b32 s60,s33,6
s_add_u32 s60,s60,s34
s_mul_i32 s60,s60,46080
s_add_u32 s60,s60,206569472
s_lshl_b32 s62,s46,10
s_add_u32 s62,s62,40960
s_add_u32 m0,s57,s62
s_add_u32 s63,s60,s62
buffer_load_dwordx4 v1,s[8:11],s63 offen sc1 lds
s_add_u32 m0,s57,45056
s_add_u32 s63,s60,45056
buffer_load_dwordx4 v1,s[8:11],s63 offen sc1 lds
s_mul_i32 s61,s46,10240
s_add_u32 s60,s60,s61
s_add_u32 s61,s61,s57
s_add_u32 m0,s61,0
s_add_u32 s63,s60,0
buffer_load_dwordx4 v1,s[8:11],s63 offen sc1 lds
buffer_load_dwordx4 v1,s[8:11],s63 offen offset:1024 sc1 lds
buffer_load_dwordx4 v1,s[8:11],s63 offen offset:2048 sc1 lds
buffer_load_dwordx4 v1,s[8:11],s63 offen offset:3072 sc1 lds
s_add_u32 m0,s61,4096
s_add_u32 s63,s60,4096
buffer_load_dwordx4 v1,s[8:11],s63 offen sc1 lds
buffer_load_dwordx4 v1,s[8:11],s63 offen offset:1024 sc1 lds
buffer_load_dwordx4 v1,s[8:11],s63 offen offset:2048 sc1 lds
buffer_load_dwordx4 v1,s[8:11],s63 offen offset:3072 sc1 lds
s_add_u32 m0,s61,8192
s_add_u32 s63,s60,8192
buffer_load_dwordx4 v1,s[8:11],s63 offen sc1 lds
buffer_load_dwordx4 v1,s[8:11],s63 offen offset:1024 sc1 lds
QKVV_CD1:
s_mov_b32 s51,s33
s_mov_b32 s52,s34
s_add_u32 s32,s32,1
s_min_u32 s62,s32,127
s_sub_u32 s60,s62,20
s_lshr_b32 s34,s60,1
s_and_b32 s33,s60,1
s_xor_b32 s33,s33,1
s_cmp_eq_u32 s33,0
s_cselect_b32 s61,20,0
s_add_u32 s34,s34,s61
s_sub_u32 s61,s60,44
s_cmp_ge_u32 s60,88
s_cselect_b32 s34,s61,s34
s_cselect_b32 s33,1,s33
s_cmp_lt_u32 s62,20
s_cselect_b32 s34,s62,s34
s_cselect_b32 s33,0,s33
s_lshl_b32 s35,s33,6
s_add_u32 s35,s35,s34
s_lshl_b32 s35,s35,9
s_add_u32 s35,s35,0
s_lshl_b32 s60,s33,5
s_add_u32 s60,s60,7
v_min_u32 v2,s60,v0
v_lshlrev_b32 v2,2,v2
s_cmp_lg_u32 s46,0
s_cbranch_scc1 w0_262
buffer_load_dword v3,v2,s[8:11],s35 offen sc1
w0_262:
s_waitcnt vmcnt(0)
s_mov_b64 exec,1
buffer_store_dword v5,v1,s[8:11],s59 offen sc1
s_mov_b64 exec,-1
s_mov_b32 s59,2147483648
s_cmp_lg_u32 s46,0
s_cbranch_scc1 w0_263
v_cmp_eq_u32 vcc,0,v3
s_cmp_eq_u64 vcc,0
s_cselect_b32 s36,0,2147483648
s_cmp_lt_u32 s32,128
s_cselect_b32 s36,s36,2147483648
v_mov_b32 v23,s36
ds_write_b32 v22,v23
w0_263:
s_waitcnt lgkmcnt(0)
s_barrier
ds_read_b32 v23,v22
ds_read_b128 v[24:27],v18 offset:0
ds_read_b128 v[28:31],v19 offset:0
ds_read_b128 v[32:35],v18 offset:2048
ds_read_b128 v[36:39],v19 offset:2048
ds_read_b128 v[40:43],v18 offset:4096
s_waitcnt lgkmcnt(5)
v_readfirstlane_b32 s37,v23
s_nop 4
QKVV_B1:
s_waitcnt lgkmcnt(3)
v_mfma_f32_32x32x16_bf16 v[88:103],v[24:27],a[0:3],0
ds_read_b128 v[44:47],v19 offset:4096
v_add_u32 v189,s57,v188
v_mfma_f32_32x32x16_bf16 v[104:119],v[24:27],a[160:163],0
v_add_u32 v8,0x800,v189
s_sub_u32 s66,46080,s57
s_lshl_b32 s60,s33,6
s_add_u32 s60,s60,s34
s_mul_i32 s60,s60,46080
s_add_u32 s60,s60,s37
v_mfma_f32_32x32x16_bf16 v[88:103],v[28:31],a[4:7],v[88:103]
ds_read_b128 v[48:51],v18 offset:6144
ds_read2_b64 v[156:159],v189 offset0:0 offset1:32
s_add_u32 s60,s60,206569472
s_lshl_b32 s62,s46,10
v_mfma_f32_32x32x16_bf16 v[104:119],v[28:31],a[164:167],v[104:119]
ds_read2_b64 v[160:163],v189 offset0:64 offset1:96
s_add_u32 s62,s62,40960
s_add_u32 m0,s66,s62
s_add_u32 s63,s60,s62
s_waitcnt lgkmcnt(5)
v_mfma_f32_32x32x16_bf16 v[88:103],v[32:35],a[8:11],v[88:103]
ds_read_b128 v[52:55],v19 offset:6144
ds_read2_b64 v[164:167],v189 offset0:128 offset1:160
buffer_load_dwordx4 v1,s[8:11],s63 offen sc1 lds
v_mfma_f32_32x32x16_bf16 v[104:119],v[32:35],a[168:171],v[104:119]
ds_read2_b64 v[168:171],v189 offset0:192 offset1:224
s_add_u32 m0,s66,45056
s_add_u32 s63,s60,45056
s_mul_i32 s74,s73,393216
s_add_u32 s74,s74,s39
v_mfma_f32_32x32x16_bf16 v[88:103],v[36:39],a[12:15],v[88:103]
ds_read_b128 v[24:27],v18 offset:8192
ds_read2_b64 v[172:175],v8 offset0:0 offset1:32
s_add_u32 s74,s74,s70
v_fma_f32 v56,-v124,v120,v56
v_mfma_f32_32x32x16_bf16 v[104:119],v[36:39],a[172:175],v[104:119]
buffer_load_dwordx4 v1,s[8:11],s63 offen sc1 lds
s_mul_i32 s61,s46,10240
s_add_u32 s60,s60,s61
s_add_u32 s61,s61,s66
s_waitcnt lgkmcnt(8)
v_mfma_f32_32x32x16_bf16 v[88:103],v[40:43],a[16:19],v[88:103]
ds_read_b128 v[28:31],v19 offset:8192
s_add_u32 m0,s61,0
s_add_u32 s63,s60,0
v_fma_f32 v57,-v126,v120,v57
v_fma_f32 v58,-v128,v120,v58
v_mfma_f32_32x32x16_bf16 v[104:119],v[40:43],a[176:179],v[104:119]
v_fma_f32 v59,-v130,v120,v59
v_fma_f32 v64,-v140,v120,v64
v_fma_f32 v65,-v142,v120,v65
v_fma_f32 v66,-v144,v120,v66
v_fma_f32 v67,-v146,v120,v67
v_mul_f32 v56,v56,v125
v_mfma_f32_32x32x16_bf16 v[88:103],v[44:47],a[20:23],v[88:103]
ds_read_b128 v[32:35],v18 offset:10240
buffer_load_dwordx4 v1,s[8:11],s63 offen sc1 lds
v_mul_f32 v57,v57,v127
v_mul_f32 v58,v58,v129
v_mfma_f32_32x32x16_bf16 v[104:119],v[44:47],a[180:183],v[104:119]
v_mul_f32 v59,v59,v131
v_mul_f32 v64,v64,v141
v_mul_f32 v65,v65,v143
v_mul_f32 v66,v66,v145
v_mul_f32 v67,v67,v147
s_waitcnt lgkmcnt(6)
v_mfma_f32_32x32x16_bf16 v[88:103],v[48:51],a[24:27],v[88:103]
ds_read_b128 v[36:39],v19 offset:10240
v_cvt_pk_bf16_f32 v180,v56,v57
v_cvt_pk_bf16_f32 v181,v58,v59
v_cvt_pk_bf16_f32 v182,v64,v65
v_cvt_pk_bf16_f32 v183,v66,v67
v_mfma_f32_32x32x16_bf16 v[104:119],v[48:51],a[184:187],v[104:119]
buffer_load_dwordx4 v1,s[8:11],s63 offen offset:1024 sc1 lds
buffer_store_dwordx4 v[180:183],v20,s[8:11],s74 offen sc1
v_fma_f32 v60,-v132,v120,v60
v_fma_f32 v61,-v134,v120,v61
v_mfma_f32_32x32x16_bf16 v[88:103],v[52:55],a[28:31],v[88:103]
ds_read_b128 v[40:43],v18 offset:12288
v_fma_f32 v62,-v136,v120,v62
v_fma_f32 v63,-v138,v120,v63
v_fma_f32 v68,-v148,v120,v68
v_fma_f32 v69,-v150,v120,v69
v_mfma_f32_32x32x16_bf16 v[104:119],v[52:55],a[188:191],v[104:119]
v_fma_f32 v70,-v152,v120,v70
v_fma_f32 v71,-v154,v120,v71
v_mul_f32 v60,v60,v133
v_mul_f32 v61,v61,v135
v_mul_f32 v62,v62,v137
s_waitcnt lgkmcnt(3)
v_mfma_f32_32x32x16_bf16 v[88:103],v[24:27],a[32:35],v[88:103]
ds_read_b128 v[44:47],v19 offset:12288
buffer_load_dwordx4 v1,s[8:11],s63 offen offset:2048 sc1 lds
v_mul_f32 v63,v63,v139
v_mul_f32 v68,v68,v149
v_mfma_f32_32x32x16_bf16 v[104:119],v[24:27],a[192:195],v[104:119]
v_mul_f32 v69,v69,v151
v_mul_f32 v70,v70,v153
v_mul_f32 v71,v71,v155
v_cvt_pk_bf16_f32 v184,v60,v61
v_cvt_pk_bf16_f32 v185,v62,v63
v_cvt_pk_bf16_f32 v186,v68,v69
v_mfma_f32_32x32x16_bf16 v[88:103],v[28:31],a[36:39],v[88:103]
ds_read_b128 v[48:51],v18 offset:14336
v_cvt_pk_bf16_f32 v187,v70,v71
buffer_store_dwordx4 v[184:187],v21,s[8:11],s74 offen sc1
v_fma_f32 v72,-v124,v121,v72
v_mfma_f32_32x32x16_bf16 v[104:119],v[28:31],a[196:199],v[104:119]
buffer_load_dwordx4 v1,s[8:11],s63 offen offset:3072 sc1 lds
s_add_u32 m0,s61,4096
s_add_u32 s63,s60,4096
v_fma_f32 v73,-v126,v121,v73
s_waitcnt lgkmcnt(3)
v_mfma_f32_32x32x16_bf16 v[88:103],v[32:35],a[40:43],v[88:103]
ds_read_b128 v[52:55],v19 offset:14336
v_fma_f32 v74,-v128,v121,v74
v_fma_f32 v75,-v130,v121,v75
v_fma_f32 v80,-v140,v121,v80
v_fma_f32 v81,-v142,v121,v81
v_mfma_f32_32x32x16_bf16 v[104:119],v[32:35],a[200:203],v[104:119]
v_fma_f32 v82,-v144,v121,v82
v_fma_f32 v83,-v146,v121,v83
v_mul_f32 v72,v72,v125
v_mul_f32 v73,v73,v127
v_mul_f32 v74,v74,v129
v_mul_f32 v75,v75,v131
v_mfma_f32_32x32x16_bf16 v[88:103],v[36:39],a[44:47],v[88:103]
ds_read_b128 v[24:27],v18 offset:16384
buffer_load_dwordx4 v1,s[8:11],s63 offen sc1 lds
v_mul_f32 v80,v80,v141
v_mul_f32 v81,v81,v143
v_mfma_f32_32x32x16_bf16 v[104:119],v[36:39],a[204:207],v[104:119]
v_mul_f32 v82,v82,v145
v_mul_f32 v83,v83,v147
v_cvt_pk_bf16_f32 v180,v72,v73
v_cvt_pk_bf16_f32 v181,v74,v75
v_cvt_pk_bf16_f32 v182,v80,v81
s_waitcnt lgkmcnt(3)
v_mfma_f32_32x32x16_bf16 v[88:103],v[40:43],a[48:51],v[88:103]
ds_read_b128 v[28:31],v19 offset:16384
v_cvt_pk_bf16_f32 v183,v82,v83
buffer_store_dwordx4 v[180:183],v20,s[8:11],s74 offen offset:2048 sc1
v_fma_f32 v76,-v132,v121,v76
v_mfma_f32_32x32x16_bf16 v[104:119],v[40:43],a[208:211],v[104:119]
buffer_load_dwordx4 v1,s[8:11],s63 offen offset:1024 sc1 lds
v_fma_f32 v77,-v134,v121,v77
v_fma_f32 v78,-v136,v121,v78
v_fma_f32 v79,-v138,v121,v79
v_fma_f32 v84,-v148,v121,v84
v_mfma_f32_32x32x16_bf16 v[88:103],v[44:47],a[52:55],v[88:103]
ds_read_b128 v[32:35],v18 offset:18432
v_fma_f32 v85,-v150,v121,v85
v_fma_f32 v86,-v152,v121,v86
v_fma_f32 v87,-v154,v121,v87
v_mul_f32 v76,v76,v133
v_mfma_f32_32x32x16_bf16 v[104:119],v[44:47],a[212:215],v[104:119]
v_mul_f32 v77,v77,v135
v_mul_f32 v78,v78,v137
v_mul_f32 v79,v79,v139
v_mul_f32 v84,v84,v149
v_mul_f32 v85,v85,v151
s_waitcnt lgkmcnt(3)
v_mfma_f32_32x32x16_bf16 v[88:103],v[48:51],a[56:59],v[88:103]
ds_read_b128 v[36:39],v19 offset:18432
buffer_load_dwordx4 v1,s[8:11],s63 offen offset:2048 sc1 lds
v_mul_f32 v86,v86,v153
v_mul_f32 v87,v87,v155
v_mfma_f32_32x32x16_bf16 v[104:119],v[48:51],a[216:219],v[104:119]
v_cvt_pk_bf16_f32 v184,v76,v77
v_cvt_pk_bf16_f32 v185,v78,v79
v_cvt_pk_bf16_f32 v186,v84,v85
v_cvt_pk_bf16_f32 v187,v86,v87
buffer_store_dwordx4 v[184:187],v21,s[8:11],s74 offen offset:2048 sc1
v_mfma_f32_32x32x16_bf16 v[88:103],v[52:55],a[60:63],v[88:103]
ds_read_b128 v[40:43],v18 offset:20480
s_waitcnt vmcnt(13)
s_mov_b64 exec,1
buffer_store_dword v5,v1,s[8:11],s59 offen sc1
s_mov_b64 exec,-1
s_mov_b32 s59,2147483648
v_mfma_f32_32x32x16_bf16 v[104:119],v[52:55],a[220:223],v[104:119]
buffer_load_dwordx4 v1,s[8:11],s63 offen offset:3072 sc1 lds
s_add_u32 m0,s61,8192
s_add_u32 s63,s60,8192
s_lshl_b32 s82,s72,6
s_waitcnt lgkmcnt(3)
v_mfma_f32_32x32x16_bf16 v[88:103],v[24:27],a[64:67],v[88:103]
ds_read_b128 v[44:47],v19 offset:20480
s_add_u32 s82,s82,s73
s_lshl_b32 s82,s82,9
s_add_u32 s82,s82,s71
s_lshl_b32 s75,s69,2
v_mfma_f32_32x32x16_bf16 v[104:119],v[24:27],a[224:227],v[104:119]
s_add_u32 s82,s82,s75
s_add_u32 s82,s82,s39
v_pk_add_f32 v[156:157],v[156:157],v[166:167]
v_mfma_f32_32x32x16_bf16 v[88:103],v[28:31],a[68:71],v[88:103]
ds_read_b128 v[48:51],v18 offset:22528
buffer_load_dwordx4 v1,s[8:11],s63 offen sc1 lds
v_pk_add_f32 v[158:159],v[158:159],v[168:169]
v_mfma_f32_32x32x16_bf16 v[104:119],v[28:31],a[228:231],v[104:119]
v_pk_add_f32 v[160:161],v[160:161],v[170:171]
v_pk_add_f32 v[162:163],v[162:163],v[172:173]
s_waitcnt lgkmcnt(3)
v_mfma_f32_32x32x16_bf16 v[88:103],v[32:35],a[72:75],v[88:103]
ds_read_b128 v[52:55],v19 offset:22528
v_pk_add_f32 v[164:165],v[164:165],v[174:175]
v_pk_add_f32 v[156:157],v[156:157],v[158:159]
v_mfma_f32_32x32x16_bf16 v[104:119],v[32:35],a[232:235],v[104:119]
buffer_load_dwordx4 v1,s[8:11],s63 offen offset:1024 sc1 lds
s_mov_b32 s53,s33
s_mov_b32 s54,s34
s_cmp_eq_u32 s37,0
s_addc_u32 s32,s32,0
v_mfma_f32_32x32x16_bf16 v[88:103],v[36:39],a[76:79],v[88:103]
ds_read_b128 v[24:27],v18 offset:24576
s_min_u32 s62,s32,127
s_sub_u32 s60,s62,20
s_lshr_b32 s34,s60,1
s_and_b32 s33,s60,1
v_mfma_f32_32x32x16_bf16 v[104:119],v[36:39],a[236:239],v[104:119]
s_xor_b32 s33,s33,1
s_cmp_eq_u32 s33,0
s_cselect_b32 s61,20,0
s_add_u32 s34,s34,s61
s_sub_u32 s61,s60,44
s_waitcnt lgkmcnt(3)
v_mfma_f32_32x32x16_bf16 v[88:103],v[40:43],a[80:83],v[88:103]
ds_read_b128 v[28:31],v19 offset:24576
s_cmp_ge_u32 s60,88
s_cselect_b32 s34,s61,s34
s_cselect_b32 s33,1,s33
v_mfma_f32_32x32x16_bf16 v[104:119],v[40:43],a[240:243],v[104:119]
s_cmp_lt_u32 s62,20
s_cselect_b32 s34,s62,s34
s_cselect_b32 s33,0,s33
s_lshl_b32 s35,s33,6
s_add_u32 s35,s35,s34
s_lshl_b32 s35,s35,9
v_mfma_f32_32x32x16_bf16 v[88:103],v[44:47],a[84:87],v[88:103]
ds_read_b128 v[32:35],v18 offset:26624
s_add_u32 s35,s35,0
s_lshl_b32 s60,s33,5
s_add_u32 s60,s60,7
v_min_u32 v2,s60,v0
v_mfma_f32_32x32x16_bf16 v[104:119],v[44:47],a[244:247],v[104:119]
v_lshlrev_b32 v2,2,v2
v_pk_add_f32 v[160:161],v[160:161],v[162:163]
v_pk_add_f32 v[156:157],v[156:157],v[160:161]
s_waitcnt lgkmcnt(3)
v_mfma_f32_32x32x16_bf16 v[88:103],v[48:51],a[88:91],v[88:103]
ds_read_b128 v[36:39],v19 offset:26624
s_cmp_lg_u32 s46,0
s_cbranch_scc1 w0_264
buffer_load_dword v3,v2,s[8:11],s35 offen sc1
w0_264:
v_mfma_f32_32x32x16_bf16 v[104:119],v[48:51],a[248:251],v[104:119]
v_pk_add_f32 v[156:157],v[156:157],v[164:165]
v_mov_b32 v158,v156
v_mov_b32 v159,v157
s_nop 0
v_permlane32_swap_b32 v156,v158
v_permlane32_swap_b32 v157,v159
v_mfma_f32_32x32x16_bf16 v[88:103],v[52:55],a[92:95],v[88:103]
ds_read_b128 v[40:43],v18 offset:28672
v_add_f32 v176,v156,v158
v_add_f32 v177,v157,v159
v_mul_f32 v176,0x3acccccd,v176
v_mul_f32 v177,0x3acccccd,v177
v_mfma_f32_32x32x16_bf16 v[104:119],v[52:55],a[252:255],v[104:119]
v_fma_f32 v177,-v176,v176,v177
v_max_f32 v177,0,v177
v_cvt_pk_bf16_f32 v8,v176,v177
v_lshlrev_b32 v176,16,v8
v_and_b32 v177,0xffff0000,v8
s_waitcnt lgkmcnt(3)
v_mfma_f32_32x32x16_bf16 v[88:103],v[24:27],a[96:99],v[88:103]
ds_read_b128 v[44:47],v19 offset:28672
v_add_f32 v177,0x3727c5ac,v177
v_cvt_pk_bf16_f32 v8,v177,v177
v_lshlrev_b32 v177,16,v8
v_mfma_f32_32x32x16_bf16 v[104:119],v[24:27],v[192:195],v[104:119]
v_sqrt_f32 v177,v177
s_nop 0
v_cvt_pk_bf16_f32 v8,v177,v177
v_lshlrev_b32 v177,16,v8
v_rcp_f32 v177,v177
v_mfma_f32_32x32x16_bf16 v[88:103],v[28:31],a[100:103],v[88:103]
ds_read_b128 v[48:51],v18 offset:30720
s_cmp_eq_u32 s51,0
s_cselect_b64 s[76:77],-1,0
v_cndmask_b32 v176,v176,0,s[76:77]
v_cndmask_b32 v177,v177,1.0,s[76:77]
v_mfma_f32_32x32x16_bf16 v[104:119],v[28:31],v[196:199],v[104:119]
s_mov_b32 s72,s51
s_mov_b32 s73,s52
ds_write_b64 v190,v[176:177]
s_waitcnt lgkmcnt(4)
v_mfma_f32_32x32x16_bf16 v[88:103],v[32:35],a[104:107],v[88:103]
ds_read_b128 v[52:55],v19 offset:30720
ds_read_b128 v[124:127],v191 offset:0
ds_read_b128 v[128:131],v191 offset:16
v_mfma_f32_32x32x16_bf16 v[104:119],v[32:35],v[200:203],v[104:119]
ds_read_b128 v[132:135],v191 offset:64
ds_read_b128 v[136:139],v191 offset:80
ds_read_b128 v[140:143],v191 offset:128
v_mfma_f32_32x32x16_bf16 v[88:103],v[36:39],a[108:111],v[88:103]
ds_read_b128 v[24:27],v18 offset:32768
ds_read_b128 v[144:147],v191 offset:144
ds_read_b128 v[148:151],v191 offset:192
v_mfma_f32_32x32x16_bf16 v[104:119],v[36:39],v[204:207],v[104:119]
ds_read_b128 v[152:155],v191 offset:208
s_waitcnt lgkmcnt(12)
v_mfma_f32_32x32x16_bf16 v[88:103],v[40:43],a[112:115],v[88:103]
ds_read_b128 v[28:31],v19 offset:32768
v_mfma_f32_32x32x16_bf16 v[104:119],v[40:43],v[208:211],v[104:119]
v_mfma_f32_32x32x16_bf16 v[88:103],v[44:47],a[116:119],v[88:103]
ds_read_b128 v[32:35],v18 offset:34816
v_mfma_f32_32x32x16_bf16 v[104:119],v[44:47],v[212:215],v[104:119]
s_waitcnt lgkmcnt(11)
v_mfma_f32_32x32x16_bf16 v[88:103],v[48:51],a[120:123],v[88:103]
ds_read_b128 v[36:39],v19 offset:34816
v_mfma_f32_32x32x16_bf16 v[104:119],v[48:51],v[216:219],v[104:119]
v_mfma_f32_32x32x16_bf16 v[88:103],v[52:55],a[124:127],v[88:103]
ds_read_b128 v[40:43],v18 offset:36864
v_mfma_f32_32x32x16_bf16 v[104:119],v[52:55],v[220:223],v[104:119]
s_waitcnt vmcnt(0)
s_cmp_lg_u32 s46,0
s_cbranch_scc1 w0_265
v_cmp_eq_u32 vcc,0,v3
s_cmp_eq_u64 vcc,0
s_cselect_b32 s36,0,2147483648
s_cmp_lt_u32 s32,128
s_cselect_b32 s36,s36,2147483648
v_mov_b32 v23,s36
ds_write_b32 v22,v23
w0_265:
s_waitcnt lgkmcnt(3)
v_mfma_f32_32x32x16_bf16 v[88:103],v[24:27],a[128:131],v[88:103]
ds_read_b128 v[44:47],v19 offset:36864
s_mov_b64 exec,1
buffer_store_dword v5,v1,s[8:11],s82 offen sc1
s_mov_b64 exec,-1
s_mov_b32 s82,2147483648
v_mfma_f32_32x32x16_bf16 v[104:119],v[24:27],v[224:227],v[104:119]
v_mfma_f32_32x32x16_bf16 v[88:103],v[28:31],a[132:135],v[88:103]
ds_read_b128 v[48:51],v18 offset:38912
v_mfma_f32_32x32x16_bf16 v[104:119],v[28:31],v[228:231],v[104:119]
s_waitcnt lgkmcnt(3)
v_mfma_f32_32x32x16_bf16 v[88:103],v[32:35],a[136:139],v[88:103]
ds_read_b128 v[52:55],v19 offset:38912
v_mfma_f32_32x32x16_bf16 v[104:119],v[32:35],v[232:235],v[104:119]
s_waitcnt lgkmcnt(2)
s_barrier
ds_read_b32 v23,v22
v_mfma_f32_32x32x16_bf16 v[88:103],v[36:39],a[140:143],v[88:103]
ds_read_b128 v[24:27],v16 offset:0
v_mfma_f32_32x32x16_bf16 v[104:119],v[36:39],v[236:239],v[104:119]
v_mfma_f32_32x32x16_bf16 v[88:103],v[40:43],a[144:147],v[88:103]
ds_read_b128 v[28:31],v17 offset:0
v_mfma_f32_32x32x16_bf16 v[104:119],v[40:43],v[240:243],v[104:119]
v_mfma_f32_32x32x16_bf16 v[88:103],v[44:47],a[148:151],v[88:103]
ds_read_b128 v[32:35],v16 offset:2048
v_mfma_f32_32x32x16_bf16 v[104:119],v[44:47],v[244:247],v[104:119]
s_waitcnt lgkmcnt(4)
v_mfma_f32_32x32x16_bf16 v[88:103],v[48:51],a[152:155],v[88:103]
ds_read_b128 v[36:39],v17 offset:2048
s_waitcnt lgkmcnt(4)
v_readfirstlane_b32 s38,v23
v_mfma_f32_32x32x16_bf16 v[104:119],v[48:51],v[248:251],v[104:119]
v_mfma_f32_32x32x16_bf16 v[88:103],v[52:55],a[156:159],v[88:103]
ds_read_b128 v[40:43],v16 offset:4096
v_mfma_f32_32x32x16_bf16 v[104:119],v[52:55],v[252:255],v[104:119]
s_cmp_lg_u32 s37,0
s_cbranch_scc1 nf_266
s_cmp_lt_u32 s50,2
s_cbranch_scc1 now_267
s_mov_b32 s39,0
s_add_u32 s50,s50,1
s_sub_u32 s57,46080,s57
s_mov_b32 s51,s53
s_mov_b32 s52,s54
s_mov_b32 s37,s38
s_branch QKVV_B0
s_nop 0
now_267:
s_mov_b32 s55,0
s_branch nt_268
nf_266:
s_mov_b32 s55,2
s_cmp_lg_u32 s38,0
s_cbranch_scc1 nt_268
s_mov_b32 s55,1
s_mov_b32 s37,0
s_sub_u32 s66,46080,s57
s_lshl_b32 s60,s33,6
s_add_u32 s60,s60,s34
s_mul_i32 s60,s60,46080
s_add_u32 s60,s60,s37
s_add_u32 s60,s60,206569472
s_lshl_b32 s62,s46,10
s_add_u32 s62,s62,40960
s_add_u32 m0,s66,s62
s_add_u32 s63,s60,s62
buffer_load_dwordx4 v1,s[8:11],s63 offen sc1 lds
s_add_u32 m0,s66,45056
s_add_u32 s63,s60,45056
buffer_load_dwordx4 v1,s[8:11],s63 offen sc1 lds
s_mul_i32 s61,s46,10240
s_add_u32 s60,s60,s61
s_add_u32 s61,s61,s66
s_add_u32 m0,s61,0
s_add_u32 s63,s60,0
buffer_load_dwordx4 v1,s[8:11],s63 offen sc1 lds
buffer_load_dwordx4 v1,s[8:11],s63 offen offset:1024 sc1 lds
buffer_load_dwordx4 v1,s[8:11],s63 offen offset:2048 sc1 lds
buffer_load_dwordx4 v1,s[8:11],s63 offen offset:3072 sc1 lds
s_add_u32 m0,s61,4096
s_add_u32 s63,s60,4096
buffer_load_dwordx4 v1,s[8:11],s63 offen sc1 lds
buffer_load_dwordx4 v1,s[8:11],s63 offen offset:1024 sc1 lds
buffer_load_dwordx4 v1,s[8:11],s63 offen offset:2048 sc1 lds
buffer_load_dwordx4 v1,s[8:11],s63 offen offset:3072 sc1 lds
s_add_u32 m0,s61,8192
s_add_u32 s63,s60,8192
buffer_load_dwordx4 v1,s[8:11],s63 offen sc1 lds
buffer_load_dwordx4 v1,s[8:11],s63 offen offset:1024 sc1 lds
nt_268:
s_mov_b32 s39,0
s_mul_i32 s74,s73,393216
s_add_u32 s74,s74,s39
s_add_u32 s74,s74,s70
v_fma_f32 v88,-v124,v120,v88
v_fma_f32 v89,-v126,v120,v89
v_fma_f32 v90,-v128,v120,v90
v_fma_f32 v91,-v130,v120,v91
v_fma_f32 v96,-v140,v120,v96
v_fma_f32 v97,-v142,v120,v97
v_fma_f32 v98,-v144,v120,v98
v_fma_f32 v99,-v146,v120,v99
v_mul_f32 v88,v88,v125
v_mul_f32 v89,v89,v127
v_mul_f32 v90,v90,v129
v_mul_f32 v91,v91,v131
v_mul_f32 v96,v96,v141
v_mul_f32 v97,v97,v143
v_mul_f32 v98,v98,v145
v_mul_f32 v99,v99,v147
v_cvt_pk_bf16_f32 v180,v88,v89
v_cvt_pk_bf16_f32 v181,v90,v91
v_cvt_pk_bf16_f32 v182,v96,v97
v_cvt_pk_bf16_f32 v183,v98,v99
buffer_store_dwordx4 v[180:183],v20,s[8:11],s74 offen sc1
v_fma_f32 v92,-v132,v120,v92
v_fma_f32 v93,-v134,v120,v93
v_fma_f32 v94,-v136,v120,v94
v_fma_f32 v95,-v138,v120,v95
v_fma_f32 v100,-v148,v120,v100
v_fma_f32 v101,-v150,v120,v101
v_fma_f32 v102,-v152,v120,v102
v_fma_f32 v103,-v154,v120,v103
v_mul_f32 v92,v92,v133
v_mul_f32 v93,v93,v135
v_mul_f32 v94,v94,v137
v_mul_f32 v95,v95,v139
v_mul_f32 v100,v100,v149
v_mul_f32 v101,v101,v151
v_mul_f32 v102,v102,v153
v_mul_f32 v103,v103,v155
v_cvt_pk_bf16_f32 v184,v92,v93
v_cvt_pk_bf16_f32 v185,v94,v95
v_cvt_pk_bf16_f32 v186,v100,v101
v_cvt_pk_bf16_f32 v187,v102,v103
buffer_store_dwordx4 v[184:187],v21,s[8:11],s74 offen sc1
v_fma_f32 v104,-v124,v121,v104
v_fma_f32 v105,-v126,v121,v105
v_fma_f32 v106,-v128,v121,v106
v_fma_f32 v107,-v130,v121,v107
v_fma_f32 v112,-v140,v121,v112
v_fma_f32 v113,-v142,v121,v113
v_fma_f32 v114,-v144,v121,v114
v_fma_f32 v115,-v146,v121,v115
v_mul_f32 v104,v104,v125
v_mul_f32 v105,v105,v127
v_mul_f32 v106,v106,v129
v_mul_f32 v107,v107,v131
v_mul_f32 v112,v112,v141
v_mul_f32 v113,v113,v143
v_mul_f32 v114,v114,v145
v_mul_f32 v115,v115,v147
v_cvt_pk_bf16_f32 v180,v104,v105
v_cvt_pk_bf16_f32 v181,v106,v107
v_cvt_pk_bf16_f32 v182,v112,v113
v_cvt_pk_bf16_f32 v183,v114,v115
buffer_store_dwordx4 v[180:183],v20,s[8:11],s74 offen offset:2048 sc1
v_fma_f32 v108,-v132,v121,v108
v_fma_f32 v109,-v134,v121,v109
v_fma_f32 v110,-v136,v121,v110
v_fma_f32 v111,-v138,v121,v111
v_fma_f32 v116,-v148,v121,v116
v_fma_f32 v117,-v150,v121,v117
v_fma_f32 v118,-v152,v121,v118
v_fma_f32 v119,-v154,v121,v119
v_mul_f32 v108,v108,v133
v_mul_f32 v109,v109,v135
v_mul_f32 v110,v110,v137
v_mul_f32 v111,v111,v139
v_mul_f32 v116,v116,v149
v_mul_f32 v117,v117,v151
v_mul_f32 v118,v118,v153
v_mul_f32 v119,v119,v155
v_cvt_pk_bf16_f32 v184,v108,v109
v_cvt_pk_bf16_f32 v185,v110,v111
v_cvt_pk_bf16_f32 v186,v116,v117
v_cvt_pk_bf16_f32 v187,v118,v119
buffer_store_dwordx4 v[184:187],v21,s[8:11],s74 offen offset:2048 sc1
s_lshl_b32 s82,s72,6
s_add_u32 s82,s82,s73
s_lshl_b32 s82,s82,9
s_add_u32 s82,s82,s71
s_lshl_b32 s75,s69,2
s_add_u32 s82,s82,s75
s_add_u32 s82,s82,s39
s_mov_b32 s59,s82
s_mov_b32 s82,2147483648
s_mov_b32 s39,2147483648
s_add_u32 s50,s50,1
s_sub_u32 s57,46080,s57
s_mov_b32 s51,s53
s_mov_b32 s52,s54
s_mov_b32 s37,s38
s_cmp_eq_u32 s55,0
s_cbranch_scc1 QKVV_B0
s_cmp_eq_u32 s55,1
s_cbranch_scc1 QKVV_CD0
s_waitcnt vmcnt(0)
s_mov_b64 exec,1
buffer_store_dword v5,v1,s[8:11],s59 offen sc1
s_mov_b64 exec,-1
s_mov_b32 s59,2147483648
s_cmp_eq_u32 s50,128
s_cbranch_scc1 QKVV_END
s_branch QKVV_COLD0
QKVV_END:
s_endpgm
ROLE_ATT:
v_lshlrev_b32 v1,4,v0
v_mov_b32 v5,1
s_lshl_b32 s56,s48,2
s_add_u32 s56,s56,s46
v_bfe_u32 v6,v0,2,2
v_lshrrev_b32 v7,4,v0
v_add_u32 v7,v6,v7
v_and_b32 v7,3,v7
v_and_b32 v15,3,v0
v_lshlrev_b32 v15,4,v15
v_lshl_add_u32 v15,v7,6,v15
v_lshl_add_u32 v15,v6,8,v15
s_mov_b32 s68,s48
s_and_b32 s51,s46,1
s_lshr_b32 s86,s46,1
s_lshr_b32 s87,s68,3
s_lshl_b32 s87,s87,5
s_and_b32 s60,s68,7
s_add_u32 s87,s87,s60
v_lshlrev_b32 v229,3,v0
v_mov_b32 v230,0xff800000
s_mov_b32 s80,-1
s_mov_b32 s81,0
s_mov_b32 s84,0x3d93cd3a
s_mov_b32 s85,0x3fb8aa3b
v_min_u32 v6,8,v0
v_mul_u32_u24 v7,86,v6
v_lshrrev_b32 v7,8,v7
v_mul_u32_u24 v8,3,v7
v_sub_u32 v6,v6,v8
s_mul_i32 s60,s68,3
v_add_u32 v6,s60,v6
v_lshlrev_b32 v2,2,v6
v_lshl_add_u32 v2,v7,16,v2
v_min_u32 v228,2,v0
v_lshlrev_b32 v228,2,v228
v_lshrrev_b32 v6,4,v0
v_lshlrev_b32 v6,2,v6
v_and_b32 v7,15,v0
v_add_u32 v8,0,v6
v_cmp_le_u32 s[72:73],v8,v7
v_add_u32 v8,1,v6
v_cmp_le_u32 s[74:75],v8,v7
v_add_u32 v8,2,v6
v_cmp_le_u32 s[76:77],v8,v7
v_add_u32 v8,3,v6
v_cmp_le_u32 s[78:79],v8,v7
s_mul_i32 s71,s68,12288
s_mul_i32 s60,s51,15
s_mul_i32 s69,s60,589824
s_mul_i32 s61,s68,18432
s_add_u32 s69,s69,s61
s_mul_i32 s61,s51,9216
s_add_u32 s69,s69,s61
s_add_u32 s69,s69,24120320
s_mul_i32 s70,s60,2048
s_lshl_b32 s61,s68,6
s_add_u32 s70,s70,s61
s_add_u32 s70,s70,688128
s_mul_i32 s69,s51,12582912
s_mul_i32 s61,s68,6144
s_add_u32 s69,s69,s61
s_add_u32 s69,s69,24117248
s_mul_i32 s70,s51,65536
s_lshl_b32 s61,s68,5
s_add_u32 s70,s70,s61
s_add_u32 s70,s70,688128
s_waitcnt vmcnt(0)
s_barrier
s_cmp_lg_u32 s46,0
s_cbranch_scc1 arr_269
v_mov_b32 v6,1
s_lshl_b32 s3,s49,2
v_mov_b32 v7,s3
s_mov_b64 exec,1
buffer_atomic_add v6,v7,s[12:15],0 offen sc1
s_mov_b64 exec,-1
arr_269:
s_mov_b32 s66,s56
s_and_b32 s53,s66,7
s_lshr_b32 s54,s66,3
v_lshrrev_b32 v6,4,v0
v_bfe_u32 v7,v0,2,2
v_and_b32 v8,3,v0
s_and_b32 s61,s53,3
s_lshl_b32 s60,s53,8
v_lshlrev_b32 v132,11,v6
v_lshrrev_b32 v9,1,v6
v_lshlrev_b32 v132,11,v9
v_and_b32 v9,1,v6
v_lshl_add_u32 v132,v9,12,v132
v_add_u32 v9,s61,v7
v_and_b32 v9,3,v9
v_lshl_add_u32 v132,v9,6,v132
v_lshl_add_u32 v132,v8,4,v132
v_add_u32 v132,s60,v132
s_lshl_b32 s60,s53,2
v_add_u32 v9,s60,v8
v_mul_u32_u24 v133,1280,v9
v_lshl_add_u32 v133,v6,5,v133
v_lshl_add_u32 v133,v7,3,v133
s_mov_b32 s4,s16
s_mov_b32 s5,s17
s_mov_b32 s6,2621440
s_mov_b32 s7,0x20000
s_mov_b32 s55,0
s_mul_i32 s62,s54,40960
buffer_load_dwordx2 v[32:33],v133,s[4:7],s62 offen offset:0
buffer_load_dwordx2 v[34:35],v133,s[4:7],s62 offen offset:128
buffer_load_dwordx2 v[36:37],v133,s[4:7],s62 offen offset:256
buffer_load_dwordx2 v[38:39],v133,s[4:7],s62 offen offset:384
buffer_load_dwordx2 v[40:41],v133,s[4:7],s62 offen offset:512
buffer_load_dwordx2 v[42:43],v133,s[4:7],s62 offen offset:640
buffer_load_dwordx2 v[44:45],v133,s[4:7],s62 offen offset:768
buffer_load_dwordx2 v[46:47],v133,s[4:7],s62 offen offset:896
buffer_load_dwordx2 v[48:49],v133,s[4:7],s62 offen offset:1024
buffer_load_dwordx2 v[50:51],v133,s[4:7],s62 offen offset:1152
s_add_u32 s66,s54,16
s_min_u32 s66,s66,63
s_mul_i32 s62,s66,40960
buffer_load_dwordx2 v[52:53],v133,s[4:7],s62 offen offset:0
buffer_load_dwordx2 v[54:55],v133,s[4:7],s62 offen offset:128
buffer_load_dwordx2 v[56:57],v133,s[4:7],s62 offen offset:256
buffer_load_dwordx2 v[58:59],v133,s[4:7],s62 offen offset:384
buffer_load_dwordx2 v[60:61],v133,s[4:7],s62 offen offset:512
buffer_load_dwordx2 v[62:63],v133,s[4:7],s62 offen offset:640
buffer_load_dwordx2 v[64:65],v133,s[4:7],s62 offen offset:768
buffer_load_dwordx2 v[66:67],v133,s[4:7],s62 offen offset:896
buffer_load_dwordx2 v[68:69],v133,s[4:7],s62 offen offset:1024
buffer_load_dwordx2 v[70:71],v133,s[4:7],s62 offen offset:1152
s_mul_i32 s64,s54,40960
s_add_u32 s64,s64,234749952
s_mul_i32 s65,s54,46080
s_add_u32 s65,s65,206569472
s_waitcnt vmcnt(10)
v_lshlrev_b32 v72,16,v32
v_and_b32 v73,0xffff0000,v32
v_lshlrev_b32 v74,16,v33
v_and_b32 v75,0xffff0000,v33
v_lshlrev_b32 v76,16,v34
v_and_b32 v77,0xffff0000,v34
v_lshlrev_b32 v78,16,v35
v_and_b32 v79,0xffff0000,v35
v_lshlrev_b32 v80,16,v36
v_and_b32 v81,0xffff0000,v36
v_lshlrev_b32 v82,16,v37
v_and_b32 v83,0xffff0000,v37
v_lshlrev_b32 v84,16,v38
v_and_b32 v85,0xffff0000,v38
v_lshlrev_b32 v86,16,v39
v_and_b32 v87,0xffff0000,v39
v_lshlrev_b32 v88,16,v40
v_and_b32 v89,0xffff0000,v40
v_lshlrev_b32 v90,16,v41
v_and_b32 v91,0xffff0000,v41
v_lshlrev_b32 v92,16,v42
v_and_b32 v93,0xffff0000,v42
v_lshlrev_b32 v94,16,v43
v_and_b32 v95,0xffff0000,v43
v_lshlrev_b32 v96,16,v44
v_and_b32 v97,0xffff0000,v44
v_lshlrev_b32 v98,16,v45
v_and_b32 v99,0xffff0000,v45
v_lshlrev_b32 v100,16,v46
v_and_b32 v101,0xffff0000,v46
v_lshlrev_b32 v102,16,v47
v_and_b32 v103,0xffff0000,v47
v_lshlrev_b32 v104,16,v48
v_and_b32 v105,0xffff0000,v48
v_lshlrev_b32 v106,16,v49
v_and_b32 v107,0xffff0000,v49
v_lshlrev_b32 v108,16,v50
v_and_b32 v109,0xffff0000,v50
v_lshlrev_b32 v110,16,v51
v_and_b32 v111,0xffff0000,v51
v_pk_add_f32 v[28:29],v[72:73],v[74:75]
v_pk_mul_f32 v[26:27],v[72:73],v[72:73]
v_pk_fma_f32 v[26:27],v[74:75],v[74:75],v[26:27]
v_pk_add_f32 v[28:29],v[28:29],v[76:77]
v_pk_fma_f32 v[26:27],v[76:77],v[76:77],v[26:27]
v_pk_add_f32 v[28:29],v[28:29],v[78:79]
v_pk_fma_f32 v[26:27],v[78:79],v[78:79],v[26:27]
v_pk_add_f32 v[28:29],v[28:29],v[80:81]
v_pk_fma_f32 v[26:27],v[80:81],v[80:81],v[26:27]
v_pk_add_f32 v[28:29],v[28:29],v[82:83]
v_pk_fma_f32 v[26:27],v[82:83],v[82:83],v[26:27]
v_pk_add_f32 v[28:29],v[28:29],v[84:85]
v_pk_fma_f32 v[26:27],v[84:85],v[84:85],v[26:27]
v_pk_add_f32 v[28:29],v[28:29],v[86:87]
v_pk_fma_f32 v[26:27],v[86:87],v[86:87],v[26:27]
v_pk_add_f32 v[28:29],v[28:29],v[88:89]
v_pk_fma_f32 v[26:27],v[88:89],v[88:89],v[26:27]
v_pk_add_f32 v[28:29],v[28:29],v[90:91]
v_pk_fma_f32 v[26:27],v[90:91],v[90:91],v[26:27]
v_pk_add_f32 v[28:29],v[28:29],v[92:93]
v_pk_fma_f32 v[26:27],v[92:93],v[92:93],v[26:27]
v_pk_add_f32 v[28:29],v[28:29],v[94:95]
v_pk_fma_f32 v[26:27],v[94:95],v[94:95],v[26:27]
v_pk_add_f32 v[28:29],v[28:29],v[96:97]
v_pk_fma_f32 v[26:27],v[96:97],v[96:97],v[26:27]
v_pk_add_f32 v[28:29],v[28:29],v[98:99]
v_pk_fma_f32 v[26:27],v[98:99],v[98:99],v[26:27]
v_pk_add_f32 v[28:29],v[28:29],v[100:101]
v_pk_fma_f32 v[26:27],v[100:101],v[100:101],v[26:27]
v_pk_add_f32 v[28:29],v[28:29],v[102:103]
v_pk_fma_f32 v[26:27],v[102:103],v[102:103],v[26:27]
v_pk_add_f32 v[28:29],v[28:29],v[104:105]
v_pk_fma_f32 v[26:27],v[104:105],v[104:105],v[26:27]
v_pk_add_f32 v[28:29],v[28:29],v[106:107]
v_pk_fma_f32 v[26:27],v[106:107],v[106:107],v[26:27]
v_pk_add_f32 v[28:29],v[28:29],v[108:109]
v_pk_fma_f32 v[26:27],v[108:109],v[108:109],v[26:27]
v_pk_add_f32 v[28:29],v[28:29],v[110:111]
v_pk_fma_f32 v[26:27],v[110:111],v[110:111],v[26:27]
v_add_f32 v24,v28,v29
v_add_f32 v25,v26,v27
s_nop 0
v_add_f32_dpp v24,v24,v24 row_ror:4 row_mask:0xf bank_mask:0xf
v_add_f32_dpp v25,v25,v25 row_ror:4 row_mask:0xf bank_mask:0xf
s_nop 0
v_add_f32_dpp v24,v24,v24 row_ror:8 row_mask:0xf bank_mask:0xf
v_add_f32_dpp v25,v25,v25 row_ror:8 row_mask:0xf bank_mask:0xf
v_mov_b32 v26,v24
v_mov_b32 v27,v25
s_nop 0
v_permlane32_swap_b32 v24,v26
v_permlane32_swap_b32 v25,v27
v_add_f32 v24,v24,v26
v_add_f32 v25,v25,v27
v_mov_b32 v26,v24
v_mov_b32 v27,v25
s_nop 0
v_permlane16_swap_b32 v24,v26
v_permlane16_swap_b32 v25,v27
v_add_f32 v24,v24,v26
v_add_f32 v25,v25,v27
v_mul_f32 v24,0x3acccccd,v24
v_mul_f32 v25,0x3acccccd,v25
v_fma_f32 v25,-v24,v24,v25
v_max_f32 v25,0,v25
v_cvt_pk_bf16_f32 v6,v24,v25
v_lshlrev_b32 v24,16,v6
v_and_b32 v25,0xffff0000,v6
v_add_f32 v25,0x3727c5ac,v25
v_cvt_pk_bf16_f32 v6,v25,v25
v_lshlrev_b32 v25,16,v6
v_sqrt_f32 v25,v25
s_nop 0
v_cvt_pk_bf16_f32 v6,v25,v25
v_lshlrev_b32 v25,16,v6
v_rcp_f32 v25,v25
s_nop 0
v_pk_add_f32 v[72:73],v[72:73],v[24:25] op_sel_hi:[1,0] neg_lo:[0,1] neg_hi:[0,1]
v_pk_add_f32 v[74:75],v[74:75],v[24:25] op_sel_hi:[1,0] neg_lo:[0,1] neg_hi:[0,1]
v_pk_add_f32 v[76:77],v[76:77],v[24:25] op_sel_hi:[1,0] neg_lo:[0,1] neg_hi:[0,1]
v_pk_add_f32 v[78:79],v[78:79],v[24:25] op_sel_hi:[1,0] neg_lo:[0,1] neg_hi:[0,1]
v_pk_add_f32 v[80:81],v[80:81],v[24:25] op_sel_hi:[1,0] neg_lo:[0,1] neg_hi:[0,1]
v_pk_add_f32 v[82:83],v[82:83],v[24:25] op_sel_hi:[1,0] neg_lo:[0,1] neg_hi:[0,1]
v_pk_add_f32 v[84:85],v[84:85],v[24:25] op_sel_hi:[1,0] neg_lo:[0,1] neg_hi:[0,1]
v_pk_add_f32 v[86:87],v[86:87],v[24:25] op_sel_hi:[1,0] neg_lo:[0,1] neg_hi:[0,1]
v_pk_add_f32 v[88:89],v[88:89],v[24:25] op_sel_hi:[1,0] neg_lo:[0,1] neg_hi:[0,1]
v_pk_add_f32 v[90:91],v[90:91],v[24:25] op_sel_hi:[1,0] neg_lo:[0,1] neg_hi:[0,1]
v_pk_add_f32 v[92:93],v[92:93],v[24:25] op_sel_hi:[1,0] neg_lo:[0,1] neg_hi:[0,1]
v_pk_add_f32 v[94:95],v[94:95],v[24:25] op_sel_hi:[1,0] neg_lo:[0,1] neg_hi:[0,1]
v_pk_add_f32 v[96:97],v[96:97],v[24:25] op_sel_hi:[1,0] neg_lo:[0,1] neg_hi:[0,1]
v_pk_add_f32 v[98:99],v[98:99],v[24:25] op_sel_hi:[1,0] neg_lo:[0,1] neg_hi:[0,1]
v_pk_add_f32 v[100:101],v[100:101],v[24:25] op_sel_hi:[1,0] neg_lo:[0,1] neg_hi:[0,1]
v_pk_add_f32 v[102:103],v[102:103],v[24:25] op_sel_hi:[1,0] neg_lo:[0,1] neg_hi:[0,1]
v_pk_add_f32 v[104:105],v[104:105],v[24:25] op_sel_hi:[1,0] neg_lo:[0,1] neg_hi:[0,1]
v_pk_add_f32 v[106:107],v[106:107],v[24:25] op_sel_hi:[1,0] neg_lo:[0,1] neg_hi:[0,1]
v_pk_add_f32 v[108:109],v[108:109],v[24:25] op_sel_hi:[1,0] neg_lo:[0,1] neg_hi:[0,1]
v_pk_add_f32 v[110:111],v[110:111],v[24:25] op_sel_hi:[1,0] neg_lo:[0,1] neg_hi:[0,1]
v_cvt_pk_bf16_f32 v6,v72,v73
v_lshlrev_b32 v72,16,v6
v_and_b32 v73,0xffff0000,v6
v_cvt_pk_bf16_f32 v8,v74,v75
v_lshlrev_b32 v74,16,v8
v_and_b32 v75,0xffff0000,v8
v_cvt_pk_bf16_f32 v6,v76,v77
v_lshlrev_b32 v76,16,v6
v_and_b32 v77,0xffff0000,v6
v_cvt_pk_bf16_f32 v8,v78,v79
v_lshlrev_b32 v78,16,v8
v_and_b32 v79,0xffff0000,v8
v_cvt_pk_bf16_f32 v6,v80,v81
v_lshlrev_b32 v80,16,v6
v_and_b32 v81,0xffff0000,v6
v_cvt_pk_bf16_f32 v8,v82,v83
v_lshlrev_b32 v82,16,v8
v_and_b32 v83,0xffff0000,v8
v_cvt_pk_bf16_f32 v6,v84,v85
v_lshlrev_b32 v84,16,v6
v_and_b32 v85,0xffff0000,v6
v_cvt_pk_bf16_f32 v8,v86,v87
v_lshlrev_b32 v86,16,v8
v_and_b32 v87,0xffff0000,v8
v_cvt_pk_bf16_f32 v6,v88,v89
v_lshlrev_b32 v88,16,v6
v_and_b32 v89,0xffff0000,v6
v_cvt_pk_bf16_f32 v8,v90,v91
v_lshlrev_b32 v90,16,v8
v_and_b32 v91,0xffff0000,v8
v_cvt_pk_bf16_f32 v6,v92,v93
v_lshlrev_b32 v92,16,v6
v_and_b32 v93,0xffff0000,v6
v_cvt_pk_bf16_f32 v8,v94,v95
v_lshlrev_b32 v94,16,v8
v_and_b32 v95,0xffff0000,v8
v_cvt_pk_bf16_f32 v6,v96,v97
v_lshlrev_b32 v96,16,v6
v_and_b32 v97,0xffff0000,v6
v_cvt_pk_bf16_f32 v8,v98,v99
v_lshlrev_b32 v98,16,v8
v_and_b32 v99,0xffff0000,v8
v_cvt_pk_bf16_f32 v6,v100,v101
v_lshlrev_b32 v100,16,v6
v_and_b32 v101,0xffff0000,v6
v_cvt_pk_bf16_f32 v8,v102,v103
v_lshlrev_b32 v102,16,v8
v_and_b32 v103,0xffff0000,v8
v_cvt_pk_bf16_f32 v6,v104,v105
v_lshlrev_b32 v104,16,v6
v_and_b32 v105,0xffff0000,v6
v_cvt_pk_bf16_f32 v8,v106,v107
v_lshlrev_b32 v106,16,v8
v_and_b32 v107,0xffff0000,v8
v_cvt_pk_bf16_f32 v6,v108,v109
v_lshlrev_b32 v108,16,v6
v_and_b32 v109,0xffff0000,v6
v_cvt_pk_bf16_f32 v8,v110,v111
v_lshlrev_b32 v110,16,v8
v_and_b32 v111,0xffff0000,v8
v_pk_mul_f32 v[72:73],v[72:73],v[24:25] op_sel:[0,1] op_sel_hi:[1,1]
v_pk_mul_f32 v[74:75],v[74:75],v[24:25] op_sel:[0,1] op_sel_hi:[1,1]
v_pk_mul_f32 v[76:77],v[76:77],v[24:25] op_sel:[0,1] op_sel_hi:[1,1]
v_pk_mul_f32 v[78:79],v[78:79],v[24:25] op_sel:[0,1] op_sel_hi:[1,1]
v_pk_mul_f32 v[80:81],v[80:81],v[24:25] op_sel:[0,1] op_sel_hi:[1,1]
v_pk_mul_f32 v[82:83],v[82:83],v[24:25] op_sel:[0,1] op_sel_hi:[1,1]
v_pk_mul_f32 v[84:85],v[84:85],v[24:25] op_sel:[0,1] op_sel_hi:[1,1]
v_pk_mul_f32 v[86:87],v[86:87],v[24:25] op_sel:[0,1] op_sel_hi:[1,1]
v_pk_mul_f32 v[88:89],v[88:89],v[24:25] op_sel:[0,1] op_sel_hi:[1,1]
v_pk_mul_f32 v[90:91],v[90:91],v[24:25] op_sel:[0,1] op_sel_hi:[1,1]
v_pk_mul_f32 v[92:93],v[92:93],v[24:25] op_sel:[0,1] op_sel_hi:[1,1]
v_pk_mul_f32 v[94:95],v[94:95],v[24:25] op_sel:[0,1] op_sel_hi:[1,1]
v_pk_mul_f32 v[96:97],v[96:97],v[24:25] op_sel:[0,1] op_sel_hi:[1,1]
v_pk_mul_f32 v[98:99],v[98:99],v[24:25] op_sel:[0,1] op_sel_hi:[1,1]
v_pk_mul_f32 v[100:101],v[100:101],v[24:25] op_sel:[0,1] op_sel_hi:[1,1]
v_pk_mul_f32 v[102:103],v[102:103],v[24:25] op_sel:[0,1] op_sel_hi:[1,1]
v_pk_mul_f32 v[104:105],v[104:105],v[24:25] op_sel:[0,1] op_sel_hi:[1,1]
v_pk_mul_f32 v[106:107],v[106:107],v[24:25] op_sel:[0,1] op_sel_hi:[1,1]
v_pk_mul_f32 v[108:109],v[108:109],v[24:25] op_sel:[0,1] op_sel_hi:[1,1]
v_pk_mul_f32 v[110:111],v[110:111],v[24:25] op_sel:[0,1] op_sel_hi:[1,1]
v_cvt_pk_bf16_f32 v112,v72,v73
v_lshlrev_b32 v72,16,v112
v_and_b32 v73,0xffff0000,v112
v_cvt_pk_bf16_f32 v113,v74,v75
v_lshlrev_b32 v74,16,v113
v_and_b32 v75,0xffff0000,v113
v_cvt_pk_bf16_f32 v114,v76,v77
v_lshlrev_b32 v76,16,v114
v_and_b32 v77,0xffff0000,v114
v_cvt_pk_bf16_f32 v115,v78,v79
v_lshlrev_b32 v78,16,v115
v_and_b32 v79,0xffff0000,v115
v_cvt_pk_bf16_f32 v116,v80,v81
v_lshlrev_b32 v80,16,v116
v_and_b32 v81,0xffff0000,v116
v_cvt_pk_bf16_f32 v117,v82,v83
v_lshlrev_b32 v82,16,v117
v_and_b32 v83,0xffff0000,v117
v_cvt_pk_bf16_f32 v118,v84,v85
v_lshlrev_b32 v84,16,v118
v_and_b32 v85,0xffff0000,v118
v_cvt_pk_bf16_f32 v119,v86,v87
v_lshlrev_b32 v86,16,v119
v_and_b32 v87,0xffff0000,v119
v_cvt_pk_bf16_f32 v120,v88,v89
v_lshlrev_b32 v88,16,v120
v_and_b32 v89,0xffff0000,v120
v_cvt_pk_bf16_f32 v121,v90,v91
v_lshlrev_b32 v90,16,v121
v_and_b32 v91,0xffff0000,v121
v_cvt_pk_bf16_f32 v122,v92,v93
v_lshlrev_b32 v92,16,v122
v_and_b32 v93,0xffff0000,v122
v_cvt_pk_bf16_f32 v123,v94,v95
v_lshlrev_b32 v94,16,v123
v_and_b32 v95,0xffff0000,v123
v_cvt_pk_bf16_f32 v124,v96,v97
v_lshlrev_b32 v96,16,v124
v_and_b32 v97,0xffff0000,v124
v_cvt_pk_bf16_f32 v125,v98,v99
v_lshlrev_b32 v98,16,v125
v_and_b32 v99,0xffff0000,v125
v_cvt_pk_bf16_f32 v126,v100,v101
v_lshlrev_b32 v100,16,v126
v_and_b32 v101,0xffff0000,v126
v_cvt_pk_bf16_f32 v127,v102,v103
v_lshlrev_b32 v102,16,v127
v_and_b32 v103,0xffff0000,v127
v_cvt_pk_bf16_f32 v128,v104,v105
v_lshlrev_b32 v104,16,v128
v_and_b32 v105,0xffff0000,v128
v_cvt_pk_bf16_f32 v129,v106,v107
v_lshlrev_b32 v106,16,v129
v_and_b32 v107,0xffff0000,v129
v_cvt_pk_bf16_f32 v130,v108,v109
v_lshlrev_b32 v108,16,v130
v_and_b32 v109,0xffff0000,v130
v_cvt_pk_bf16_f32 v131,v110,v111
v_lshlrev_b32 v110,16,v131
v_and_b32 v111,0xffff0000,v131
s_add_u32 s63,s65,0
v_permlane16_swap_b32 v112,v114
v_permlane16_swap_b32 v113,v115
buffer_store_dwordx4 v[112:115],v132,s[8:11],s63 offen sc1
s_add_u32 s63,s65,8192
v_permlane16_swap_b32 v116,v118
v_permlane16_swap_b32 v117,v119
buffer_store_dwordx4 v[116:119],v132,s[8:11],s63 offen sc1
s_add_u32 s63,s65,16384
v_permlane16_swap_b32 v120,v122
v_permlane16_swap_b32 v121,v123
buffer_store_dwordx4 v[120:123],v132,s[8:11],s63 offen sc1
s_add_u32 s63,s65,24576
v_permlane16_swap_b32 v124,v126
v_permlane16_swap_b32 v125,v127
buffer_store_dwordx4 v[124:127],v132,s[8:11],s63 offen sc1
s_add_u32 s63,s65,32768
v_permlane16_swap_b32 v128,v130
v_permlane16_swap_b32 v129,v131
buffer_store_dwordx4 v[128:131],v132,s[8:11],s63 offen sc1
s_add_u32 s63,s64,0
v_permlane16_swap_b32 v32,v34
v_permlane16_swap_b32 v33,v35
buffer_store_dwordx4 v[32:35],v132,s[8:11],s63 offen sc1
s_add_u32 s63,s64,8192
v_permlane16_swap_b32 v36,v38
v_permlane16_swap_b32 v37,v39
buffer_store_dwordx4 v[36:39],v132,s[8:11],s63 offen sc1
s_add_u32 s63,s64,16384
v_permlane16_swap_b32 v40,v42
v_permlane16_swap_b32 v41,v43
buffer_store_dwordx4 v[40:43],v132,s[8:11],s63 offen sc1
s_add_u32 s63,s64,24576
v_permlane16_swap_b32 v44,v46
v_permlane16_swap_b32 v45,v47
buffer_store_dwordx4 v[44:47],v132,s[8:11],s63 offen sc1
s_add_u32 s63,s64,32768
v_permlane16_swap_b32 v48,v50
v_permlane16_swap_b32 v49,v51
buffer_store_dwordx4 v[48:51],v132,s[8:11],s63 offen sc1
s_lshl_b32 s82,s55,6
s_add_u32 s82,s82,s54
s_lshl_b32 s82,s82,9
s_add_u32 s82,s82,0
s_lshl_b32 s61,s53,2
s_add_u32 s82,s82,s61
s_add_u32 s54,s54,16
s_lshl_b32 s3,s49,2
v_mov_b32 v7,s3
s_nop 1
ibw_270:
buffer_load_dword v6,v7,s[12:15],0 offen sc1
s_waitcnt vmcnt(0)
v_cmp_ne_u32 vcc,256,v6
s_nop 0
s_cbranch_vccz ok_271
s_sleep 8
s_sub_u32 s47,s47,1
s_cbranch_scc1 ABORT
s_branch ibw_270
ok_271:
s_cmp_lg_u32 s49,0
s_cbranch_scc1 ibok_272
v_and_b32 v7,7,v0
v_lshlrev_b32 v7,2,v7
buffer_load_dword v6,v7,s[12:15],0 offen offset:32 sc1
s_waitcnt vmcnt(0)
v_cmp_ne_u32 vcc,32,v6
s_nop 0
s_cbranch_vccz ibok_272
s_barrier
s_mov_b32 s49,1
s_mov_b32 s3,s2
s_load_dwordx16 s[16:31],s[0:1],0
s_load_dwordx8 s[32:39],s[0:1],64
s_waitcnt lgkmcnt(0)
s_branch DISPATCH
ibok_272:
s_mov_b64 exec,1
buffer_store_dword v5,v1,s[8:11],s82 offen sc1
s_mov_b64 exec,-1
s_add_u32 s66,s54,16
s_min_u32 s66,s66,63
s_mul_i32 s62,s66,40960
buffer_load_dwordx2 v[32:33],v133,s[4:7],s62 offen offset:0
buffer_load_dwordx2 v[34:35],v133,s[4:7],s62 offen offset:128
buffer_load_dwordx2 v[36:37],v133,s[4:7],s62 offen offset:256
buffer_load_dwordx2 v[38:39],v133,s[4:7],s62 offen offset:384
buffer_load_dwordx2 v[40:41],v133,s[4:7],s62 offen offset:512
buffer_load_dwordx2 v[42:43],v133,s[4:7],s62 offen offset:640
buffer_load_dwordx2 v[44:45],v133,s[4:7],s62 offen offset:768
buffer_load_dwordx2 v[46:47],v133,s[4:7],s62 offen offset:896
buffer_load_dwordx2 v[48:49],v133,s[4:7],s62 offen offset:1024
buffer_load_dwordx2 v[50:51],v133,s[4:7],s62 offen offset:1152
s_mul_i32 s64,s54,40960
s_add_u32 s64,s64,234749952
s_mul_i32 s65,s54,46080
s_add_u32 s65,s65,206569472
s_waitcnt vmcnt(10)
v_lshlrev_b32 v72,16,v52
v_and_b32 v73,0xffff0000,v52
v_lshlrev_b32 v74,16,v53
v_and_b32 v75,0xffff0000,v53
v_lshlrev_b32 v76,16,v54
v_and_b32 v77,0xffff0000,v54
v_lshlrev_b32 v78,16,v55
v_and_b32 v79,0xffff0000,v55
v_lshlrev_b32 v80,16,v56
v_and_b32 v81,0xffff0000,v56
v_lshlrev_b32 v82,16,v57
v_and_b32 v83,0xffff0000,v57
v_lshlrev_b32 v84,16,v58
v_and_b32 v85,0xffff0000,v58
v_lshlrev_b32 v86,16,v59
v_and_b32 v87,0xffff0000,v59
v_lshlrev_b32 v88,16,v60
v_and_b32 v89,0xffff0000,v60
v_lshlrev_b32 v90,16,v61
v_and_b32 v91,0xffff0000,v61
v_lshlrev_b32 v92,16,v62
v_and_b32 v93,0xffff0000,v62
v_lshlrev_b32 v94,16,v63
v_and_b32 v95,0xffff0000,v63
v_lshlrev_b32 v96,16,v64
v_and_b32 v97,0xffff0000,v64
v_lshlrev_b32 v98,16,v65
v_and_b32 v99,0xffff0000,v65
v_lshlrev_b32 v100,16,v66
v_and_b32 v101,0xffff0000,v66
v_lshlrev_b32 v102,16,v67
v_and_b32 v103,0xffff0000,v67
v_lshlrev_b32 v104,16,v68
v_and_b32 v105,0xffff0000,v68
v_lshlrev_b32 v106,16,v69
v_and_b32 v107,0xffff0000,v69
v_lshlrev_b32 v108,16,v70
v_and_b32 v109,0xffff0000,v70
v_lshlrev_b32 v110,16,v71
v_and_b32 v111,0xffff0000,v71
v_pk_add_f32 v[28:29],v[72:73],v[74:75]
v_pk_mul_f32 v[26:27],v[72:73],v[72:73]
v_pk_fma_f32 v[26:27],v[74:75],v[74:75],v[26:27]
v_pk_add_f32 v[28:29],v[28:29],v[76:77]
v_pk_fma_f32 v[26:27],v[76:77],v[76:77],v[26:27]
v_pk_add_f32 v[28:29],v[28:29],v[78:79]
v_pk_fma_f32 v[26:27],v[78:79],v[78:79],v[26:27]
v_pk_add_f32 v[28:29],v[28:29],v[80:81]
v_pk_fma_f32 v[26:27],v[80:81],v[80:81],v[26:27]
v_pk_add_f32 v[28:29],v[28:29],v[82:83]
v_pk_fma_f32 v[26:27],v[82:83],v[82:83],v[26:27]
v_pk_add_f32 v[28:29],v[28:29],v[84:85]
v_pk_fma_f32 v[26:27],v[84:85],v[84:85],v[26:27]
v_pk_add_f32 v[28:29],v[28:29],v[86:87]
v_pk_fma_f32 v[26:27],v[86:87],v[86:87],v[26:27]
v_pk_add_f32 v[28:29],v[28:29],v[88:89]
v_pk_fma_f32 v[26:27],v[88:89],v[88:89],v[26:27]
v_pk_add_f32 v[28:29],v[28:29],v[90:91]
v_pk_fma_f32 v[26:27],v[90:91],v[90:91],v[26:27]
v_pk_add_f32 v[28:29],v[28:29],v[92:93]
v_pk_fma_f32 v[26:27],v[92:93],v[92:93],v[26:27]
v_pk_add_f32 v[28:29],v[28:29],v[94:95]
v_pk_fma_f32 v[26:27],v[94:95],v[94:95],v[26:27]
v_pk_add_f32 v[28:29],v[28:29],v[96:97]
v_pk_fma_f32 v[26:27],v[96:97],v[96:97],v[26:27]
v_pk_add_f32 v[28:29],v[28:29],v[98:99]
v_pk_fma_f32 v[26:27],v[98:99],v[98:99],v[26:27]
v_pk_add_f32 v[28:29],v[28:29],v[100:101]
v_pk_fma_f32 v[26:27],v[100:101],v[100:101],v[26:27]
v_pk_add_f32 v[28:29],v[28:29],v[102:103]
v_pk_fma_f32 v[26:27],v[102:103],v[102:103],v[26:27]
v_pk_add_f32 v[28:29],v[28:29],v[104:105]
v_pk_fma_f32 v[26:27],v[104:105],v[104:105],v[26:27]
v_pk_add_f32 v[28:29],v[28:29],v[106:107]
v_pk_fma_f32 v[26:27],v[106:107],v[106:107],v[26:27]
v_pk_add_f32 v[28:29],v[28:29],v[108:109]
v_pk_fma_f32 v[26:27],v[108:109],v[108:109],v[26:27]
v_pk_add_f32 v[28:29],v[28:29],v[110:111]
v_pk_fma_f32 v[26:27],v[110:111],v[110:111],v[26:27]
v_add_f32 v24,v28,v29
v_add_f32 v25,v26,v27
s_nop 0
v_add_f32_dpp v24,v24,v24 row_ror:4 row_mask:0xf bank_mask:0xf
v_add_f32_dpp v25,v25,v25 row_ror:4 row_mask:0xf bank_mask:0xf
s_nop 0
v_add_f32_dpp v24,v24,v24 row_ror:8 row_mask:0xf bank_mask:0xf
v_add_f32_dpp v25,v25,v25 row_ror:8 row_mask:0xf bank_mask:0xf
v_mov_b32 v26,v24
v_mov_b32 v27,v25
s_nop 0
v_permlane32_swap_b32 v24,v26
v_permlane32_swap_b32 v25,v27
v_add_f32 v24,v24,v26
v_add_f32 v25,v25,v27
v_mov_b32 v26,v24
v_mov_b32 v27,v25
s_nop 0
v_permlane16_swap_b32 v24,v26
v_permlane16_swap_b32 v25,v27
v_add_f32 v24,v24,v26
v_add_f32 v25,v25,v27
v_mul_f32 v24,0x3acccccd,v24
v_mul_f32 v25,0x3acccccd,v25
v_fma_f32 v25,-v24,v24,v25
v_max_f32 v25,0,v25
v_cvt_pk_bf16_f32 v6,v24,v25
v_lshlrev_b32 v24,16,v6
v_and_b32 v25,0xffff0000,v6
v_add_f32 v25,0x3727c5ac,v25
v_cvt_pk_bf16_f32 v6,v25,v25
v_lshlrev_b32 v25,16,v6
v_sqrt_f32 v25,v25
s_nop 0
v_cvt_pk_bf16_f32 v6,v25,v25
v_lshlrev_b32 v25,16,v6
v_rcp_f32 v25,v25
s_nop 0
v_pk_add_f32 v[72:73],v[72:73],v[24:25] op_sel_hi:[1,0] neg_lo:[0,1] neg_hi:[0,1]
v_pk_add_f32 v[74:75],v[74:75],v[24:25] op_sel_hi:[1,0] neg_lo:[0,1] neg_hi:[0,1]
v_pk_add_f32 v[76:77],v[76:77],v[24:25] op_sel_hi:[1,0] neg_lo:[0,1] neg_hi:[0,1]
v_pk_add_f32 v[78:79],v[78:79],v[24:25] op_sel_hi:[1,0] neg_lo:[0,1] neg_hi:[0,1]
v_pk_add_f32 v[80:81],v[80:81],v[24:25] op_sel_hi:[1,0] neg_lo:[0,1] neg_hi:[0,1]
v_pk_add_f32 v[82:83],v[82:83],v[24:25] op_sel_hi:[1,0] neg_lo:[0,1] neg_hi:[0,1]
v_pk_add_f32 v[84:85],v[84:85],v[24:25] op_sel_hi:[1,0] neg_lo:[0,1] neg_hi:[0,1]
v_pk_add_f32 v[86:87],v[86:87],v[24:25] op_sel_hi:[1,0] neg_lo:[0,1] neg_hi:[0,1]
v_pk_add_f32 v[88:89],v[88:89],v[24:25] op_sel_hi:[1,0] neg_lo:[0,1] neg_hi:[0,1]
v_pk_add_f32 v[90:91],v[90:91],v[24:25] op_sel_hi:[1,0] neg_lo:[0,1] neg_hi:[0,1]
v_pk_add_f32 v[92:93],v[92:93],v[24:25] op_sel_hi:[1,0] neg_lo:[0,1] neg_hi:[0,1]
v_pk_add_f32 v[94:95],v[94:95],v[24:25] op_sel_hi:[1,0] neg_lo:[0,1] neg_hi:[0,1]
v_pk_add_f32 v[96:97],v[96:97],v[24:25] op_sel_hi:[1,0] neg_lo:[0,1] neg_hi:[0,1]
v_pk_add_f32 v[98:99],v[98:99],v[24:25] op_sel_hi:[1,0] neg_lo:[0,1] neg_hi:[0,1]
v_pk_add_f32 v[100:101],v[100:101],v[24:25] op_sel_hi:[1,0] neg_lo:[0,1] neg_hi:[0,1]
v_pk_add_f32 v[102:103],v[102:103],v[24:25] op_sel_hi:[1,0] neg_lo:[0,1] neg_hi:[0,1]
v_pk_add_f32 v[104:105],v[104:105],v[24:25] op_sel_hi:[1,0] neg_lo:[0,1] neg_hi:[0,1]
v_pk_add_f32 v[106:107],v[106:107],v[24:25] op_sel_hi:[1,0] neg_lo:[0,1] neg_hi:[0,1]
v_pk_add_f32 v[108:109],v[108:109],v[24:25] op_sel_hi:[1,0] neg_lo:[0,1] neg_hi:[0,1]
v_pk_add_f32 v[110:111],v[110:111],v[24:25] op_sel_hi:[1,0] neg_lo:[0,1] neg_hi:[0,1]
v_cvt_pk_bf16_f32 v6,v72,v73
v_lshlrev_b32 v72,16,v6
v_and_b32 v73,0xffff0000,v6
v_cvt_pk_bf16_f32 v8,v74,v75
v_lshlrev_b32 v74,16,v8
v_and_b32 v75,0xffff0000,v8
v_cvt_pk_bf16_f32 v6,v76,v77
v_lshlrev_b32 v76,16,v6
v_and_b32 v77,0xffff0000,v6
v_cvt_pk_bf16_f32 v8,v78,v79
v_lshlrev_b32 v78,16,v8
v_and_b32 v79,0xffff0000,v8
v_cvt_pk_bf16_f32 v6,v80,v81
v_lshlrev_b32 v80,16,v6
v_and_b32 v81,0xffff0000,v6
v_cvt_pk_bf16_f32 v8,v82,v83
v_lshlrev_b32 v82,16,v8
v_and_b32 v83,0xffff0000,v8
v_cvt_pk_bf16_f32 v6,v84,v85
v_lshlrev_b32 v84,16,v6
v_and_b32 v85,0xffff0000,v6
v_cvt_pk_bf16_f32 v8,v86,v87
v_lshlrev_b32 v86,16,v8
v_and_b32 v87,0xffff0000,v8
v_cvt_pk_bf16_f32 v6,v88,v89
v_lshlrev_b32 v88,16,v6
v_and_b32 v89,0xffff0000,v6
v_cvt_pk_bf16_f32 v8,v90,v91
v_lshlrev_b32 v90,16,v8
v_and_b32 v91,0xffff0000,v8
v_cvt_pk_bf16_f32 v6,v92,v93
v_lshlrev_b32 v92,16,v6
v_and_b32 v93,0xffff0000,v6
v_cvt_pk_bf16_f32 v8,v94,v95
v_lshlrev_b32 v94,16,v8
v_and_b32 v95,0xffff0000,v8
v_cvt_pk_bf16_f32 v6,v96,v97
v_lshlrev_b32 v96,16,v6
v_and_b32 v97,0xffff0000,v6
v_cvt_pk_bf16_f32 v8,v98,v99
v_lshlrev_b32 v98,16,v8
v_and_b32 v99,0xffff0000,v8
v_cvt_pk_bf16_f32 v6,v100,v101
v_lshlrev_b32 v100,16,v6
v_and_b32 v101,0xffff0000,v6
v_cvt_pk_bf16_f32 v8,v102,v103
v_lshlrev_b32 v102,16,v8
v_and_b32 v103,0xffff0000,v8
v_cvt_pk_bf16_f32 v6,v104,v105
v_lshlrev_b32 v104,16,v6
v_and_b32 v105,0xffff0000,v6
v_cvt_pk_bf16_f32 v8,v106,v107
v_lshlrev_b32 v106,16,v8
v_and_b32 v107,0xffff0000,v8
v_cvt_pk_bf16_f32 v6,v108,v109
v_lshlrev_b32 v108,16,v6
v_and_b32 v109,0xffff0000,v6
v_cvt_pk_bf16_f32 v8,v110,v111
v_lshlrev_b32 v110,16,v8
v_and_b32 v111,0xffff0000,v8
v_pk_mul_f32 v[72:73],v[72:73],v[24:25] op_sel:[0,1] op_sel_hi:[1,1]
v_pk_mul_f32 v[74:75],v[74:75],v[24:25] op_sel:[0,1] op_sel_hi:[1,1]
v_pk_mul_f32 v[76:77],v[76:77],v[24:25] op_sel:[0,1] op_sel_hi:[1,1]
v_pk_mul_f32 v[78:79],v[78:79],v[24:25] op_sel:[0,1] op_sel_hi:[1,1]
v_pk_mul_f32 v[80:81],v[80:81],v[24:25] op_sel:[0,1] op_sel_hi:[1,1]
v_pk_mul_f32 v[82:83],v[82:83],v[24:25] op_sel:[0,1] op_sel_hi:[1,1]
v_pk_mul_f32 v[84:85],v[84:85],v[24:25] op_sel:[0,1] op_sel_hi:[1,1]
v_pk_mul_f32 v[86:87],v[86:87],v[24:25] op_sel:[0,1] op_sel_hi:[1,1]
v_pk_mul_f32 v[88:89],v[88:89],v[24:25] op_sel:[0,1] op_sel_hi:[1,1]
v_pk_mul_f32 v[90:91],v[90:91],v[24:25] op_sel:[0,1] op_sel_hi:[1,1]
v_pk_mul_f32 v[92:93],v[92:93],v[24:25] op_sel:[0,1] op_sel_hi:[1,1]
v_pk_mul_f32 v[94:95],v[94:95],v[24:25] op_sel:[0,1] op_sel_hi:[1,1]
v_pk_mul_f32 v[96:97],v[96:97],v[24:25] op_sel:[0,1] op_sel_hi:[1,1]
v_pk_mul_f32 v[98:99],v[98:99],v[24:25] op_sel:[0,1] op_sel_hi:[1,1]
v_pk_mul_f32 v[100:101],v[100:101],v[24:25] op_sel:[0,1] op_sel_hi:[1,1]
v_pk_mul_f32 v[102:103],v[102:103],v[24:25] op_sel:[0,1] op_sel_hi:[1,1]
v_pk_mul_f32 v[104:105],v[104:105],v[24:25] op_sel:[0,1] op_sel_hi:[1,1]
v_pk_mul_f32 v[106:107],v[106:107],v[24:25] op_sel:[0,1] op_sel_hi:[1,1]
v_pk_mul_f32 v[108:109],v[108:109],v[24:25] op_sel:[0,1] op_sel_hi:[1,1]
v_pk_mul_f32 v[110:111],v[110:111],v[24:25] op_sel:[0,1] op_sel_hi:[1,1]
v_cvt_pk_bf16_f32 v112,v72,v73
v_lshlrev_b32 v72,16,v112
v_and_b32 v73,0xffff0000,v112
v_cvt_pk_bf16_f32 v113,v74,v75
v_lshlrev_b32 v74,16,v113
v_and_b32 v75,0xffff0000,v113
v_cvt_pk_bf16_f32 v114,v76,v77
v_lshlrev_b32 v76,16,v114
v_and_b32 v77,0xffff0000,v114
v_cvt_pk_bf16_f32 v115,v78,v79
v_lshlrev_b32 v78,16,v115
v_and_b32 v79,0xffff0000,v115
v_cvt_pk_bf16_f32 v116,v80,v81
v_lshlrev_b32 v80,16,v116
v_and_b32 v81,0xffff0000,v116
v_cvt_pk_bf16_f32 v117,v82,v83
v_lshlrev_b32 v82,16,v117
v_and_b32 v83,0xffff0000,v117
v_cvt_pk_bf16_f32 v118,v84,v85
v_lshlrev_b32 v84,16,v118
v_and_b32 v85,0xffff0000,v118
v_cvt_pk_bf16_f32 v119,v86,v87
v_lshlrev_b32 v86,16,v119
v_and_b32 v87,0xffff0000,v119
v_cvt_pk_bf16_f32 v120,v88,v89
v_lshlrev_b32 v88,16,v120
v_and_b32 v89,0xffff0000,v120
v_cvt_pk_bf16_f32 v121,v90,v91
v_lshlrev_b32 v90,16,v121
v_and_b32 v91,0xffff0000,v121
v_cvt_pk_bf16_f32 v122,v92,v93
v_lshlrev_b32 v92,16,v122
v_and_b32 v93,0xffff0000,v122
v_cvt_pk_bf16_f32 v123,v94,v95
v_lshlrev_b32 v94,16,v123
v_and_b32 v95,0xffff0000,v123
v_cvt_pk_bf16_f32 v124,v96,v97
v_lshlrev_b32 v96,16,v124
v_and_b32 v97,0xffff0000,v124
v_cvt_pk_bf16_f32 v125,v98,v99
v_lshlrev_b32 v98,16,v125
v_and_b32 v99,0xffff0000,v125
v_cvt_pk_bf16_f32 v126,v100,v101
v_lshlrev_b32 v100,16,v126
v_and_b32 v101,0xffff0000,v126
v_cvt_pk_bf16_f32 v127,v102,v103
v_lshlrev_b32 v102,16,v127
v_and_b32 v103,0xffff0000,v127
v_cvt_pk_bf16_f32 v128,v104,v105
v_lshlrev_b32 v104,16,v128
v_and_b32 v105,0xffff0000,v128
v_cvt_pk_bf16_f32 v129,v106,v107
v_lshlrev_b32 v106,16,v129
v_and_b32 v107,0xffff0000,v129
v_cvt_pk_bf16_f32 v130,v108,v109
v_lshlrev_b32 v108,16,v130
v_and_b32 v109,0xffff0000,v130
v_cvt_pk_bf16_f32 v131,v110,v111
v_lshlrev_b32 v110,16,v131
v_and_b32 v111,0xffff0000,v131
s_add_u32 s63,s65,0
v_permlane16_swap_b32 v112,v114
v_permlane16_swap_b32 v113,v115
buffer_store_dwordx4 v[112:115],v132,s[8:11],s63 offen sc1
s_add_u32 s63,s65,8192
v_permlane16_swap_b32 v116,v118
v_permlane16_swap_b32 v117,v119
buffer_store_dwordx4 v[116:119],v132,s[8:11],s63 offen sc1
s_add_u32 s63,s65,16384
v_permlane16_swap_b32 v120,v122
v_permlane16_swap_b32 v121,v123
buffer_store_dwordx4 v[120:123],v132,s[8:11],s63 offen sc1
s_add_u32 s63,s65,24576
v_permlane16_swap_b32 v124,v126
v_permlane16_swap_b32 v125,v127
buffer_store_dwordx4 v[124:127],v132,s[8:11],s63 offen sc1
s_add_u32 s63,s65,32768
v_permlane16_swap_b32 v128,v130
v_permlane16_swap_b32 v129,v131
buffer_store_dwordx4 v[128:131],v132,s[8:11],s63 offen sc1
s_add_u32 s63,s64,0
v_permlane16_swap_b32 v52,v54
v_permlane16_swap_b32 v53,v55
buffer_store_dwordx4 v[52:55],v132,s[8:11],s63 offen sc1
s_add_u32 s63,s64,8192
v_permlane16_swap_b32 v56,v58
v_permlane16_swap_b32 v57,v59
buffer_store_dwordx4 v[56:59],v132,s[8:11],s63 offen sc1
s_add_u32 s63,s64,16384
v_permlane16_swap_b32 v60,v62
v_permlane16_swap_b32 v61,v63
buffer_store_dwordx4 v[60:63],v132,s[8:11],s63 offen sc1
s_add_u32 s63,s64,24576
v_permlane16_swap_b32 v64,v66
v_permlane16_swap_b32 v65,v67
buffer_store_dwordx4 v[64:67],v132,s[8:11],s63 offen sc1
s_add_u32 s63,s64,32768
v_permlane16_swap_b32 v68,v70
v_permlane16_swap_b32 v69,v71
buffer_store_dwordx4 v[68:71],v132,s[8:11],s63 offen sc1
s_lshl_b32 s82,s55,6
s_add_u32 s82,s82,s54
s_lshl_b32 s82,s82,9
s_add_u32 s82,s82,0
s_lshl_b32 s61,s53,2
s_add_u32 s82,s82,s61
s_add_u32 s54,s54,16
R0_LOOPA:
s_add_u32 s66,s54,16
s_min_u32 s66,s66,63
s_mul_i32 s62,s66,40960
buffer_load_dwordx2 v[52:53],v133,s[4:7],s62 offen offset:0
buffer_load_dwordx2 v[54:55],v133,s[4:7],s62 offen offset:128
buffer_load_dwordx2 v[56:57],v133,s[4:7],s62 offen offset:256
buffer_load_dwordx2 v[58:59],v133,s[4:7],s62 offen offset:384
buffer_load_dwordx2 v[60:61],v133,s[4:7],s62 offen offset:512
buffer_load_dwordx2 v[62:63],v133,s[4:7],s62 offen offset:640
buffer_load_dwordx2 v[64:65],v133,s[4:7],s62 offen offset:768
buffer_load_dwordx2 v[66:67],v133,s[4:7],s62 offen offset:896
buffer_load_dwordx2 v[68:69],v133,s[4:7],s62 offen offset:1024
buffer_load_dwordx2 v[70:71],v133,s[4:7],s62 offen offset:1152
s_mul_i32 s64,s54,40960
s_add_u32 s64,s64,234749952
s_mul_i32 s65,s54,46080
s_add_u32 s65,s65,206569472
s_waitcnt vmcnt(10)
s_mov_b64 exec,1
buffer_store_dword v5,v1,s[8:11],s82 offen sc1
s_mov_b64 exec,-1
v_lshlrev_b32 v72,16,v32
v_and_b32 v73,0xffff0000,v32
v_lshlrev_b32 v74,16,v33
v_and_b32 v75,0xffff0000,v33
v_lshlrev_b32 v76,16,v34
v_and_b32 v77,0xffff0000,v34
v_lshlrev_b32 v78,16,v35
v_and_b32 v79,0xffff0000,v35
v_lshlrev_b32 v80,16,v36
v_and_b32 v81,0xffff0000,v36
v_lshlrev_b32 v82,16,v37
v_and_b32 v83,0xffff0000,v37
v_lshlrev_b32 v84,16,v38
v_and_b32 v85,0xffff0000,v38
v_lshlrev_b32 v86,16,v39
v_and_b32 v87,0xffff0000,v39
v_lshlrev_b32 v88,16,v40
v_and_b32 v89,0xffff0000,v40
v_lshlrev_b32 v90,16,v41
v_and_b32 v91,0xffff0000,v41
v_lshlrev_b32 v92,16,v42
v_and_b32 v93,0xffff0000,v42
v_lshlrev_b32 v94,16,v43
v_and_b32 v95,0xffff0000,v43
v_lshlrev_b32 v96,16,v44
v_and_b32 v97,0xffff0000,v44
v_lshlrev_b32 v98,16,v45
v_and_b32 v99,0xffff0000,v45
v_lshlrev_b32 v100,16,v46
v_and_b32 v101,0xffff0000,v46
v_lshlrev_b32 v102,16,v47
v_and_b32 v103,0xffff0000,v47
v_lshlrev_b32 v104,16,v48
v_and_b32 v105,0xffff0000,v48
v_lshlrev_b32 v106,16,v49
v_and_b32 v107,0xffff0000,v49
v_lshlrev_b32 v108,16,v50
v_and_b32 v109,0xffff0000,v50
v_lshlrev_b32 v110,16,v51
v_and_b32 v111,0xffff0000,v51
v_pk_add_f32 v[28:29],v[72:73],v[74:75]
v_pk_mul_f32 v[26:27],v[72:73],v[72:73]
v_pk_fma_f32 v[26:27],v[74:75],v[74:75],v[26:27]
v_pk_add_f32 v[28:29],v[28:29],v[76:77]
v_pk_fma_f32 v[26:27],v[76:77],v[76:77],v[26:27]
v_pk_add_f32 v[28:29],v[28:29],v[78:79]
v_pk_fma_f32 v[26:27],v[78:79],v[78:79],v[26:27]
v_pk_add_f32 v[28:29],v[28:29],v[80:81]
v_pk_fma_f32 v[26:27],v[80:81],v[80:81],v[26:27]
v_pk_add_f32 v[28:29],v[28:29],v[82:83]
v_pk_fma_f32 v[26:27],v[82:83],v[82:83],v[26:27]
v_pk_add_f32 v[28:29],v[28:29],v[84:85]
v_pk_fma_f32 v[26:27],v[84:85],v[84:85],v[26:27]
v_pk_add_f32 v[28:29],v[28:29],v[86:87]
v_pk_fma_f32 v[26:27],v[86:87],v[86:87],v[26:27]
v_pk_add_f32 v[28:29],v[28:29],v[88:89]
v_pk_fma_f32 v[26:27],v[88:89],v[88:89],v[26:27]
v_pk_add_f32 v[28:29],v[28:29],v[90:91]
v_pk_fma_f32 v[26:27],v[90:91],v[90:91],v[26:27]
v_pk_add_f32 v[28:29],v[28:29],v[92:93]
v_pk_fma_f32 v[26:27],v[92:93],v[92:93],v[26:27]
v_pk_add_f32 v[28:29],v[28:29],v[94:95]
v_pk_fma_f32 v[26:27],v[94:95],v[94:95],v[26:27]
v_pk_add_f32 v[28:29],v[28:29],v[96:97]
v_pk_fma_f32 v[26:27],v[96:97],v[96:97],v[26:27]
v_pk_add_f32 v[28:29],v[28:29],v[98:99]
v_pk_fma_f32 v[26:27],v[98:99],v[98:99],v[26:27]
v_pk_add_f32 v[28:29],v[28:29],v[100:101]
v_pk_fma_f32 v[26:27],v[100:101],v[100:101],v[26:27]
v_pk_add_f32 v[28:29],v[28:29],v[102:103]
v_pk_fma_f32 v[26:27],v[102:103],v[102:103],v[26:27]
v_pk_add_f32 v[28:29],v[28:29],v[104:105]
v_pk_fma_f32 v[26:27],v[104:105],v[104:105],v[26:27]
v_pk_add_f32 v[28:29],v[28:29],v[106:107]
v_pk_fma_f32 v[26:27],v[106:107],v[106:107],v[26:27]
v_pk_add_f32 v[28:29],v[28:29],v[108:109]
v_pk_fma_f32 v[26:27],v[108:109],v[108:109],v[26:27]
v_pk_add_f32 v[28:29],v[28:29],v[110:111]
v_pk_fma_f32 v[26:27],v[110:111],v[110:111],v[26:27]
v_add_f32 v24,v28,v29
v_add_f32 v25,v26,v27
s_nop 0
v_add_f32_dpp v24,v24,v24 row_ror:4 row_mask:0xf bank_mask:0xf
v_add_f32_dpp v25,v25,v25 row_ror:4 row_mask:0xf bank_mask:0xf
s_nop 0
v_add_f32_dpp v24,v24,v24 row_ror:8 row_mask:0xf bank_mask:0xf
v_add_f32_dpp v25,v25,v25 row_ror:8 row_mask:0xf bank_mask:0xf
v_mov_b32 v26,v24
v_mov_b32 v27,v25
s_nop 0
v_permlane32_swap_b32 v24,v26
v_permlane32_swap_b32 v25,v27
v_add_f32 v24,v24,v26
v_add_f32 v25,v25,v27
v_mov_b32 v26,v24
v_mov_b32 v27,v25
s_nop 0
v_permlane16_swap_b32 v24,v26
v_permlane16_swap_b32 v25,v27
v_add_f32 v24,v24,v26
v_add_f32 v25,v25,v27
v_mul_f32 v24,0x3acccccd,v24
v_mul_f32 v25,0x3acccccd,v25
v_fma_f32 v25,-v24,v24,v25
v_max_f32 v25,0,v25
v_cvt_pk_bf16_f32 v6,v24,v25
v_lshlrev_b32 v24,16,v6
v_and_b32 v25,0xffff0000,v6
v_add_f32 v25,0x3727c5ac,v25
v_cvt_pk_bf16_f32 v6,v25,v25
v_lshlrev_b32 v25,16,v6
v_sqrt_f32 v25,v25
s_nop 0
v_cvt_pk_bf16_f32 v6,v25,v25
v_lshlrev_b32 v25,16,v6
v_rcp_f32 v25,v25
s_nop 0
v_pk_add_f32 v[72:73],v[72:73],v[24:25] op_sel_hi:[1,0] neg_lo:[0,1] neg_hi:[0,1]
v_pk_add_f32 v[74:75],v[74:75],v[24:25] op_sel_hi:[1,0] neg_lo:[0,1] neg_hi:[0,1]
v_pk_add_f32 v[76:77],v[76:77],v[24:25] op_sel_hi:[1,0] neg_lo:[0,1] neg_hi:[0,1]
v_pk_add_f32 v[78:79],v[78:79],v[24:25] op_sel_hi:[1,0] neg_lo:[0,1] neg_hi:[0,1]
v_pk_add_f32 v[80:81],v[80:81],v[24:25] op_sel_hi:[1,0] neg_lo:[0,1] neg_hi:[0,1]
v_pk_add_f32 v[82:83],v[82:83],v[24:25] op_sel_hi:[1,0] neg_lo:[0,1] neg_hi:[0,1]
v_pk_add_f32 v[84:85],v[84:85],v[24:25] op_sel_hi:[1,0] neg_lo:[0,1] neg_hi:[0,1]
v_pk_add_f32 v[86:87],v[86:87],v[24:25] op_sel_hi:[1,0] neg_lo:[0,1] neg_hi:[0,1]
v_pk_add_f32 v[88:89],v[88:89],v[24:25] op_sel_hi:[1,0] neg_lo:[0,1] neg_hi:[0,1]
v_pk_add_f32 v[90:91],v[90:91],v[24:25] op_sel_hi:[1,0] neg_lo:[0,1] neg_hi:[0,1]
v_pk_add_f32 v[92:93],v[92:93],v[24:25] op_sel_hi:[1,0] neg_lo:[0,1] neg_hi:[0,1]
v_pk_add_f32 v[94:95],v[94:95],v[24:25] op_sel_hi:[1,0] neg_lo:[0,1] neg_hi:[0,1]
v_pk_add_f32 v[96:97],v[96:97],v[24:25] op_sel_hi:[1,0] neg_lo:[0,1] neg_hi:[0,1]
v_pk_add_f32 v[98:99],v[98:99],v[24:25] op_sel_hi:[1,0] neg_lo:[0,1] neg_hi:[0,1]
v_pk_add_f32 v[100:101],v[100:101],v[24:25] op_sel_hi:[1,0] neg_lo:[0,1] neg_hi:[0,1]
v_pk_add_f32 v[102:103],v[102:103],v[24:25] op_sel_hi:[1,0] neg_lo:[0,1] neg_hi:[0,1]
v_pk_add_f32 v[104:105],v[104:105],v[24:25] op_sel_hi:[1,0] neg_lo:[0,1] neg_hi:[0,1]
v_pk_add_f32 v[106:107],v[106:107],v[24:25] op_sel_hi:[1,0] neg_lo:[0,1] neg_hi:[0,1]
v_pk_add_f32 v[108:109],v[108:109],v[24:25] op_sel_hi:[1,0] neg_lo:[0,1] neg_hi:[0,1]
v_pk_add_f32 v[110:111],v[110:111],v[24:25] op_sel_hi:[1,0] neg_lo:[0,1] neg_hi:[0,1]
v_cvt_pk_bf16_f32 v6,v72,v73
v_lshlrev_b32 v72,16,v6
v_and_b32 v73,0xffff0000,v6
v_cvt_pk_bf16_f32 v8,v74,v75
v_lshlrev_b32 v74,16,v8
v_and_b32 v75,0xffff0000,v8
v_cvt_pk_bf16_f32 v6,v76,v77
v_lshlrev_b32 v76,16,v6
v_and_b32 v77,0xffff0000,v6
v_cvt_pk_bf16_f32 v8,v78,v79
v_lshlrev_b32 v78,16,v8
v_and_b32 v79,0xffff0000,v8
v_cvt_pk_bf16_f32 v6,v80,v81
v_lshlrev_b32 v80,16,v6
v_and_b32 v81,0xffff0000,v6
v_cvt_pk_bf16_f32 v8,v82,v83
v_lshlrev_b32 v82,16,v8
v_and_b32 v83,0xffff0000,v8
v_cvt_pk_bf16_f32 v6,v84,v85
v_lshlrev_b32 v84,16,v6
v_and_b32 v85,0xffff0000,v6
v_cvt_pk_bf16_f32 v8,v86,v87
v_lshlrev_b32 v86,16,v8
v_and_b32 v87,0xffff0000,v8
v_cvt_pk_bf16_f32 v6,v88,v89
v_lshlrev_b32 v88,16,v6
v_and_b32 v89,0xffff0000,v6
v_cvt_pk_bf16_f32 v8,v90,v91
v_lshlrev_b32 v90,16,v8
v_and_b32 v91,0xffff0000,v8
v_cvt_pk_bf16_f32 v6,v92,v93
v_lshlrev_b32 v92,16,v6
v_and_b32 v93,0xffff0000,v6
v_cvt_pk_bf16_f32 v8,v94,v95
v_lshlrev_b32 v94,16,v8
v_and_b32 v95,0xffff0000,v8
v_cvt_pk_bf16_f32 v6,v96,v97
v_lshlrev_b32 v96,16,v6
v_and_b32 v97,0xffff0000,v6
v_cvt_pk_bf16_f32 v8,v98,v99
v_lshlrev_b32 v98,16,v8
v_and_b32 v99,0xffff0000,v8
v_cvt_pk_bf16_f32 v6,v100,v101
v_lshlrev_b32 v100,16,v6
v_and_b32 v101,0xffff0000,v6
v_cvt_pk_bf16_f32 v8,v102,v103
v_lshlrev_b32 v102,16,v8
v_and_b32 v103,0xffff0000,v8
v_cvt_pk_bf16_f32 v6,v104,v105
v_lshlrev_b32 v104,16,v6
v_and_b32 v105,0xffff0000,v6
v_cvt_pk_bf16_f32 v8,v106,v107
v_lshlrev_b32 v106,16,v8
v_and_b32 v107,0xffff0000,v8
v_cvt_pk_bf16_f32 v6,v108,v109
v_lshlrev_b32 v108,16,v6
v_and_b32 v109,0xffff0000,v6
v_cvt_pk_bf16_f32 v8,v110,v111
v_lshlrev_b32 v110,16,v8
v_and_b32 v111,0xffff0000,v8
v_pk_mul_f32 v[72:73],v[72:73],v[24:25] op_sel:[0,1] op_sel_hi:[1,1]
v_pk_mul_f32 v[74:75],v[74:75],v[24:25] op_sel:[0,1] op_sel_hi:[1,1]
v_pk_mul_f32 v[76:77],v[76:77],v[24:25] op_sel:[0,1] op_sel_hi:[1,1]
v_pk_mul_f32 v[78:79],v[78:79],v[24:25] op_sel:[0,1] op_sel_hi:[1,1]
v_pk_mul_f32 v[80:81],v[80:81],v[24:25] op_sel:[0,1] op_sel_hi:[1,1]
v_pk_mul_f32 v[82:83],v[82:83],v[24:25] op_sel:[0,1] op_sel_hi:[1,1]
v_pk_mul_f32 v[84:85],v[84:85],v[24:25] op_sel:[0,1] op_sel_hi:[1,1]
v_pk_mul_f32 v[86:87],v[86:87],v[24:25] op_sel:[0,1] op_sel_hi:[1,1]
v_pk_mul_f32 v[88:89],v[88:89],v[24:25] op_sel:[0,1] op_sel_hi:[1,1]
v_pk_mul_f32 v[90:91],v[90:91],v[24:25] op_sel:[0,1] op_sel_hi:[1,1]
v_pk_mul_f32 v[92:93],v[92:93],v[24:25] op_sel:[0,1] op_sel_hi:[1,1]
v_pk_mul_f32 v[94:95],v[94:95],v[24:25] op_sel:[0,1] op_sel_hi:[1,1]
v_pk_mul_f32 v[96:97],v[96:97],v[24:25] op_sel:[0,1] op_sel_hi:[1,1]
v_pk_mul_f32 v[98:99],v[98:99],v[24:25] op_sel:[0,1] op_sel_hi:[1,1]
v_pk_mul_f32 v[100:101],v[100:101],v[24:25] op_sel:[0,1] op_sel_hi:[1,1]
v_pk_mul_f32 v[102:103],v[102:103],v[24:25] op_sel:[0,1] op_sel_hi:[1,1]
v_pk_mul_f32 v[104:105],v[104:105],v[24:25] op_sel:[0,1] op_sel_hi:[1,1]
v_pk_mul_f32 v[106:107],v[106:107],v[24:25] op_sel:[0,1] op_sel_hi:[1,1]
v_pk_mul_f32 v[108:109],v[108:109],v[24:25] op_sel:[0,1] op_sel_hi:[1,1]
v_pk_mul_f32 v[110:111],v[110:111],v[24:25] op_sel:[0,1] op_sel_hi:[1,1]
v_cvt_pk_bf16_f32 v112,v72,v73
v_lshlrev_b32 v72,16,v112
v_and_b32 v73,0xffff0000,v112
v_cvt_pk_bf16_f32 v113,v74,v75
v_lshlrev_b32 v74,16,v113
v_and_b32 v75,0xffff0000,v113
v_cvt_pk_bf16_f32 v114,v76,v77
v_lshlrev_b32 v76,16,v114
v_and_b32 v77,0xffff0000,v114
v_cvt_pk_bf16_f32 v115,v78,v79
v_lshlrev_b32 v78,16,v115
v_and_b32 v79,0xffff0000,v115
v_cvt_pk_bf16_f32 v116,v80,v81
v_lshlrev_b32 v80,16,v116
v_and_b32 v81,0xffff0000,v116
v_cvt_pk_bf16_f32 v117,v82,v83
v_lshlrev_b32 v82,16,v117
v_and_b32 v83,0xffff0000,v117
v_cvt_pk_bf16_f32 v118,v84,v85
v_lshlrev_b32 v84,16,v118
v_and_b32 v85,0xffff0000,v118
v_cvt_pk_bf16_f32 v119,v86,v87
v_lshlrev_b32 v86,16,v119
v_and_b32 v87,0xffff0000,v119
v_cvt_pk_bf16_f32 v120,v88,v89
v_lshlrev_b32 v88,16,v120
v_and_b32 v89,0xffff0000,v120
v_cvt_pk_bf16_f32 v121,v90,v91
v_lshlrev_b32 v90,16,v121
v_and_b32 v91,0xffff0000,v121
v_cvt_pk_bf16_f32 v122,v92,v93
v_lshlrev_b32 v92,16,v122
v_and_b32 v93,0xffff0000,v122
v_cvt_pk_bf16_f32 v123,v94,v95
v_lshlrev_b32 v94,16,v123
v_and_b32 v95,0xffff0000,v123
v_cvt_pk_bf16_f32 v124,v96,v97
v_lshlrev_b32 v96,16,v124
v_and_b32 v97,0xffff0000,v124
v_cvt_pk_bf16_f32 v125,v98,v99
v_lshlrev_b32 v98,16,v125
v_and_b32 v99,0xffff0000,v125
v_cvt_pk_bf16_f32 v126,v100,v101
v_lshlrev_b32 v100,16,v126
v_and_b32 v101,0xffff0000,v126
v_cvt_pk_bf16_f32 v127,v102,v103
v_lshlrev_b32 v102,16,v127
v_and_b32 v103,0xffff0000,v127
v_cvt_pk_bf16_f32 v128,v104,v105
v_lshlrev_b32 v104,16,v128
v_and_b32 v105,0xffff0000,v128
v_cvt_pk_bf16_f32 v129,v106,v107
v_lshlrev_b32 v106,16,v129
v_and_b32 v107,0xffff0000,v129
v_cvt_pk_bf16_f32 v130,v108,v109
v_lshlrev_b32 v108,16,v130
v_and_b32 v109,0xffff0000,v130
v_cvt_pk_bf16_f32 v131,v110,v111
v_lshlrev_b32 v110,16,v131
v_and_b32 v111,0xffff0000,v131
s_add_u32 s63,s65,0
v_permlane16_swap_b32 v112,v114
v_permlane16_swap_b32 v113,v115
buffer_store_dwordx4 v[112:115],v132,s[8:11],s63 offen sc1
s_add_u32 s63,s65,8192
v_permlane16_swap_b32 v116,v118
v_permlane16_swap_b32 v117,v119
buffer_store_dwordx4 v[116:119],v132,s[8:11],s63 offen sc1
s_add_u32 s63,s65,16384
v_permlane16_swap_b32 v120,v122
v_permlane16_swap_b32 v121,v123
buffer_store_dwordx4 v[120:123],v132,s[8:11],s63 offen sc1
s_add_u32 s63,s65,24576
v_permlane16_swap_b32 v124,v126
v_permlane16_swap_b32 v125,v127
buffer_store_dwordx4 v[124:127],v132,s[8:11],s63 offen sc1
s_add_u32 s63,s65,32768
v_permlane16_swap_b32 v128,v130
v_permlane16_swap_b32 v129,v131
buffer_store_dwordx4 v[128:131],v132,s[8:11],s63 offen sc1
s_add_u32 s63,s64,0
v_permlane16_swap_b32 v32,v34
v_permlane16_swap_b32 v33,v35
buffer_store_dwordx4 v[32:35],v132,s[8:11],s63 offen sc1
s_add_u32 s63,s64,8192
v_permlane16_swap_b32 v36,v38
v_permlane16_swap_b32 v37,v39
buffer_store_dwordx4 v[36:39],v132,s[8:11],s63 offen sc1
s_add_u32 s63,s64,16384
v_permlane16_swap_b32 v40,v42
v_permlane16_swap_b32 v41,v43
buffer_store_dwordx4 v[40:43],v132,s[8:11],s63 offen sc1
s_add_u32 s63,s64,24576
v_permlane16_swap_b32 v44,v46
v_permlane16_swap_b32 v45,v47
buffer_store_dwordx4 v[44:47],v132,s[8:11],s63 offen sc1
s_add_u32 s63,s64,32768
v_permlane16_swap_b32 v48,v50
v_permlane16_swap_b32 v49,v51
buffer_store_dwordx4 v[48:51],v132,s[8:11],s63 offen sc1
s_lshl_b32 s82,s55,6
s_add_u32 s82,s82,s54
s_lshl_b32 s82,s82,9
s_add_u32 s82,s82,0
s_lshl_b32 s61,s53,2
s_add_u32 s82,s82,s61
s_add_u32 s54,s54,16
s_cmp_ge_u32 s54,64
s_cbranch_scc1 R0_ENDA
s_add_u32 s66,s54,16
s_min_u32 s66,s66,63
s_mul_i32 s62,s66,40960
buffer_load_dwordx2 v[32:33],v133,s[4:7],s62 offen offset:0
buffer_load_dwordx2 v[34:35],v133,s[4:7],s62 offen offset:128
buffer_load_dwordx2 v[36:37],v133,s[4:7],s62 offen offset:256
buffer_load_dwordx2 v[38:39],v133,s[4:7],s62 offen offset:384
buffer_load_dwordx2 v[40:41],v133,s[4:7],s62 offen offset:512
buffer_load_dwordx2 v[42:43],v133,s[4:7],s62 offen offset:640
buffer_load_dwordx2 v[44:45],v133,s[4:7],s62 offen offset:768
buffer_load_dwordx2 v[46:47],v133,s[4:7],s62 offen offset:896
buffer_load_dwordx2 v[48:49],v133,s[4:7],s62 offen offset:1024
buffer_load_dwordx2 v[50:51],v133,s[4:7],s62 offen offset:1152
s_mul_i32 s64,s54,40960
s_add_u32 s64,s64,234749952
s_mul_i32 s65,s54,46080
s_add_u32 s65,s65,206569472
s_waitcnt vmcnt(10)
s_mov_b64 exec,1
buffer_store_dword v5,v1,s[8:11],s82 offen sc1
s_mov_b64 exec,-1
v_lshlrev_b32 v72,16,v52
v_and_b32 v73,0xffff0000,v52
v_lshlrev_b32 v74,16,v53
v_and_b32 v75,0xffff0000,v53
v_lshlrev_b32 v76,16,v54
v_and_b32 v77,0xffff0000,v54
v_lshlrev_b32 v78,16,v55
v_and_b32 v79,0xffff0000,v55
v_lshlrev_b32 v80,16,v56
v_and_b32 v81,0xffff0000,v56
v_lshlrev_b32 v82,16,v57
v_and_b32 v83,0xffff0000,v57
v_lshlrev_b32 v84,16,v58
v_and_b32 v85,0xffff0000,v58
v_lshlrev_b32 v86,16,v59
v_and_b32 v87,0xffff0000,v59
v_lshlrev_b32 v88,16,v60
v_and_b32 v89,0xffff0000,v60
v_lshlrev_b32 v90,16,v61
v_and_b32 v91,0xffff0000,v61
v_lshlrev_b32 v92,16,v62
v_and_b32 v93,0xffff0000,v62
v_lshlrev_b32 v94,16,v63
v_and_b32 v95,0xffff0000,v63
v_lshlrev_b32 v96,16,v64
v_and_b32 v97,0xffff0000,v64
v_lshlrev_b32 v98,16,v65
v_and_b32 v99,0xffff0000,v65
v_lshlrev_b32 v100,16,v66
v_and_b32 v101,0xffff0000,v66
v_lshlrev_b32 v102,16,v67
v_and_b32 v103,0xffff0000,v67
v_lshlrev_b32 v104,16,v68
v_and_b32 v105,0xffff0000,v68
v_lshlrev_b32 v106,16,v69
v_and_b32 v107,0xffff0000,v69
v_lshlrev_b32 v108,16,v70
v_and_b32 v109,0xffff0000,v70
v_lshlrev_b32 v110,16,v71
v_and_b32 v111,0xffff0000,v71
v_pk_add_f32 v[28:29],v[72:73],v[74:75]
v_pk_mul_f32 v[26:27],v[72:73],v[72:73]
v_pk_fma_f32 v[26:27],v[74:75],v[74:75],v[26:27]
v_pk_add_f32 v[28:29],v[28:29],v[76:77]
v_pk_fma_f32 v[26:27],v[76:77],v[76:77],v[26:27]
v_pk_add_f32 v[28:29],v[28:29],v[78:79]
v_pk_fma_f32 v[26:27],v[78:79],v[78:79],v[26:27]
v_pk_add_f32 v[28:29],v[28:29],v[80:81]
v_pk_fma_f32 v[26:27],v[80:81],v[80:81],v[26:27]
v_pk_add_f32 v[28:29],v[28:29],v[82:83]
v_pk_fma_f32 v[26:27],v[82:83],v[82:83],v[26:27]
v_pk_add_f32 v[28:29],v[28:29],v[84:85]
v_pk_fma_f32 v[26:27],v[84:85],v[84:85],v[26:27]
v_pk_add_f32 v[28:29],v[28:29],v[86:87]
v_pk_fma_f32 v[26:27],v[86:87],v[86:87],v[26:27]
v_pk_add_f32 v[28:29],v[28:29],v[88:89]
v_pk_fma_f32 v[26:27],v[88:89],v[88:89],v[26:27]
v_pk_add_f32 v[28:29],v[28:29],v[90:91]
v_pk_fma_f32 v[26:27],v[90:91],v[90:91],v[26:27]
v_pk_add_f32 v[28:29],v[28:29],v[92:93]
v_pk_fma_f32 v[26:27],v[92:93],v[92:93],v[26:27]
v_pk_add_f32 v[28:29],v[28:29],v[94:95]
v_pk_fma_f32 v[26:27],v[94:95],v[94:95],v[26:27]
v_pk_add_f32 v[28:29],v[28:29],v[96:97]
v_pk_fma_f32 v[26:27],v[96:97],v[96:97],v[26:27]
v_pk_add_f32 v[28:29],v[28:29],v[98:99]
v_pk_fma_f32 v[26:27],v[98:99],v[98:99],v[26:27]
v_pk_add_f32 v[28:29],v[28:29],v[100:101]
v_pk_fma_f32 v[26:27],v[100:101],v[100:101],v[26:27]
v_pk_add_f32 v[28:29],v[28:29],v[102:103]
v_pk_fma_f32 v[26:27],v[102:103],v[102:103],v[26:27]
v_pk_add_f32 v[28:29],v[28:29],v[104:105]
v_pk_fma_f32 v[26:27],v[104:105],v[104:105],v[26:27]
v_pk_add_f32 v[28:29],v[28:29],v[106:107]
v_pk_fma_f32 v[26:27],v[106:107],v[106:107],v[26:27]
v_pk_add_f32 v[28:29],v[28:29],v[108:109]
v_pk_fma_f32 v[26:27],v[108:109],v[108:109],v[26:27]
v_pk_add_f32 v[28:29],v[28:29],v[110:111]
v_pk_fma_f32 v[26:27],v[110:111],v[110:111],v[26:27]
v_add_f32 v24,v28,v29
v_add_f32 v25,v26,v27
s_nop 0
v_add_f32_dpp v24,v24,v24 row_ror:4 row_mask:0xf bank_mask:0xf
v_add_f32_dpp v25,v25,v25 row_ror:4 row_mask:0xf bank_mask:0xf
s_nop 0
v_add_f32_dpp v24,v24,v24 row_ror:8 row_mask:0xf bank_mask:0xf
v_add_f32_dpp v25,v25,v25 row_ror:8 row_mask:0xf bank_mask:0xf
v_mov_b32 v26,v24
v_mov_b32 v27,v25
s_nop 0
v_permlane32_swap_b32 v24,v26
v_permlane32_swap_b32 v25,v27
v_add_f32 v24,v24,v26
v_add_f32 v25,v25,v27
v_mov_b32 v26,v24
v_mov_b32 v27,v25
s_nop 0
v_permlane16_swap_b32 v24,v26
v_permlane16_swap_b32 v25,v27
v_add_f32 v24,v24,v26
v_add_f32 v25,v25,v27
v_mul_f32 v24,0x3acccccd,v24
v_mul_f32 v25,0x3acccccd,v25
v_fma_f32 v25,-v24,v24,v25
v_max_f32 v25,0,v25
v_cvt_pk_bf16_f32 v6,v24,v25
v_lshlrev_b32 v24,16,v6
v_and_b32 v25,0xffff0000,v6
v_add_f32 v25,0x3727c5ac,v25
v_cvt_pk_bf16_f32 v6,v25,v25
v_lshlrev_b32 v25,16,v6
v_sqrt_f32 v25,v25
s_nop 0
v_cvt_pk_bf16_f32 v6,v25,v25
v_lshlrev_b32 v25,16,v6
v_rcp_f32 v25,v25
s_nop 0
v_pk_add_f32 v[72:73],v[72:73],v[24:25] op_sel_hi:[1,0] neg_lo:[0,1] neg_hi:[0,1]
v_pk_add_f32 v[74:75],v[74:75],v[24:25] op_sel_hi:[1,0] neg_lo:[0,1] neg_hi:[0,1]
v_pk_add_f32 v[76:77],v[76:77],v[24:25] op_sel_hi:[1,0] neg_lo:[0,1] neg_hi:[0,1]
v_pk_add_f32 v[78:79],v[78:79],v[24:25] op_sel_hi:[1,0] neg_lo:[0,1] neg_hi:[0,1]
v_pk_add_f32 v[80:81],v[80:81],v[24:25] op_sel_hi:[1,0] neg_lo:[0,1] neg_hi:[0,1]
v_pk_add_f32 v[82:83],v[82:83],v[24:25] op_sel_hi:[1,0] neg_lo:[0,1] neg_hi:[0,1]
v_pk_add_f32 v[84:85],v[84:85],v[24:25] op_sel_hi:[1,0] neg_lo:[0,1] neg_hi:[0,1]
v_pk_add_f32 v[86:87],v[86:87],v[24:25] op_sel_hi:[1,0] neg_lo:[0,1] neg_hi:[0,1]
v_pk_add_f32 v[88:89],v[88:89],v[24:25] op_sel_hi:[1,0] neg_lo:[0,1] neg_hi:[0,1]
v_pk_add_f32 v[90:91],v[90:91],v[24:25] op_sel_hi:[1,0] neg_lo:[0,1] neg_hi:[0,1]
v_pk_add_f32 v[92:93],v[92:93],v[24:25] op_sel_hi:[1,0] neg_lo:[0,1] neg_hi:[0,1]
v_pk_add_f32 v[94:95],v[94:95],v[24:25] op_sel_hi:[1,0] neg_lo:[0,1] neg_hi:[0,1]
v_pk_add_f32 v[96:97],v[96:97],v[24:25] op_sel_hi:[1,0] neg_lo:[0,1] neg_hi:[0,1]
v_pk_add_f32 v[98:99],v[98:99],v[24:25] op_sel_hi:[1,0] neg_lo:[0,1] neg_hi:[0,1]
v_pk_add_f32 v[100:101],v[100:101],v[24:25] op_sel_hi:[1,0] neg_lo:[0,1] neg_hi:[0,1]
v_pk_add_f32 v[102:103],v[102:103],v[24:25] op_sel_hi:[1,0] neg_lo:[0,1] neg_hi:[0,1]
v_pk_add_f32 v[104:105],v[104:105],v[24:25] op_sel_hi:[1,0] neg_lo:[0,1] neg_hi:[0,1]
v_pk_add_f32 v[106:107],v[106:107],v[24:25] op_sel_hi:[1,0] neg_lo:[0,1] neg_hi:[0,1]
v_pk_add_f32 v[108:109],v[108:109],v[24:25] op_sel_hi:[1,0] neg_lo:[0,1] neg_hi:[0,1]
v_pk_add_f32 v[110:111],v[110:111],v[24:25] op_sel_hi:[1,0] neg_lo:[0,1] neg_hi:[0,1]
v_cvt_pk_bf16_f32 v6,v72,v73
v_lshlrev_b32 v72,16,v6
v_and_b32 v73,0xffff0000,v6
v_cvt_pk_bf16_f32 v8,v74,v75
v_lshlrev_b32 v74,16,v8
v_and_b32 v75,0xffff0000,v8
v_cvt_pk_bf16_f32 v6,v76,v77
v_lshlrev_b32 v76,16,v6
v_and_b32 v77,0xffff0000,v6
v_cvt_pk_bf16_f32 v8,v78,v79
v_lshlrev_b32 v78,16,v8
v_and_b32 v79,0xffff0000,v8
v_cvt_pk_bf16_f32 v6,v80,v81
v_lshlrev_b32 v80,16,v6
v_and_b32 v81,0xffff0000,v6
v_cvt_pk_bf16_f32 v8,v82,v83
v_lshlrev_b32 v82,16,v8
v_and_b32 v83,0xffff0000,v8
v_cvt_pk_bf16_f32 v6,v84,v85
v_lshlrev_b32 v84,16,v6
v_and_b32 v85,0xffff0000,v6
v_cvt_pk_bf16_f32 v8,v86,v87
v_lshlrev_b32 v86,16,v8
v_and_b32 v87,0xffff0000,v8
v_cvt_pk_bf16_f32 v6,v88,v89
v_lshlrev_b32 v88,16,v6
v_and_b32 v89,0xffff0000,v6
v_cvt_pk_bf16_f32 v8,v90,v91
v_lshlrev_b32 v90,16,v8
v_and_b32 v91,0xffff0000,v8
v_cvt_pk_bf16_f32 v6,v92,v93
v_lshlrev_b32 v92,16,v6
v_and_b32 v93,0xffff0000,v6
v_cvt_pk_bf16_f32 v8,v94,v95
v_lshlrev_b32 v94,16,v8
v_and_b32 v95,0xffff0000,v8
v_cvt_pk_bf16_f32 v6,v96,v97
v_lshlrev_b32 v96,16,v6
v_and_b32 v97,0xffff0000,v6
v_cvt_pk_bf16_f32 v8,v98,v99
v_lshlrev_b32 v98,16,v8
v_and_b32 v99,0xffff0000,v8
v_cvt_pk_bf16_f32 v6,v100,v101
v_lshlrev_b32 v100,16,v6
v_and_b32 v101,0xffff0000,v6
v_cvt_pk_bf16_f32 v8,v102,v103
v_lshlrev_b32 v102,16,v8
v_and_b32 v103,0xffff0000,v8
v_cvt_pk_bf16_f32 v6,v104,v105
v_lshlrev_b32 v104,16,v6
v_and_b32 v105,0xffff0000,v6
v_cvt_pk_bf16_f32 v8,v106,v107
v_lshlrev_b32 v106,16,v8
v_and_b32 v107,0xffff0000,v8
v_cvt_pk_bf16_f32 v6,v108,v109
v_lshlrev_b32 v108,16,v6
v_and_b32 v109,0xffff0000,v6
v_cvt_pk_bf16_f32 v8,v110,v111
v_lshlrev_b32 v110,16,v8
v_and_b32 v111,0xffff0000,v8
v_pk_mul_f32 v[72:73],v[72:73],v[24:25] op_sel:[0,1] op_sel_hi:[1,1]
v_pk_mul_f32 v[74:75],v[74:75],v[24:25] op_sel:[0,1] op_sel_hi:[1,1]
v_pk_mul_f32 v[76:77],v[76:77],v[24:25] op_sel:[0,1] op_sel_hi:[1,1]
v_pk_mul_f32 v[78:79],v[78:79],v[24:25] op_sel:[0,1] op_sel_hi:[1,1]
v_pk_mul_f32 v[80:81],v[80:81],v[24:25] op_sel:[0,1] op_sel_hi:[1,1]
v_pk_mul_f32 v[82:83],v[82:83],v[24:25] op_sel:[0,1] op_sel_hi:[1,1]
v_pk_mul_f32 v[84:85],v[84:85],v[24:25] op_sel:[0,1] op_sel_hi:[1,1]
v_pk_mul_f32 v[86:87],v[86:87],v[24:25] op_sel:[0,1] op_sel_hi:[1,1]
v_pk_mul_f32 v[88:89],v[88:89],v[24:25] op_sel:[0,1] op_sel_hi:[1,1]
v_pk_mul_f32 v[90:91],v[90:91],v[24:25] op_sel:[0,1] op_sel_hi:[1,1]
v_pk_mul_f32 v[92:93],v[92:93],v[24:25] op_sel:[0,1] op_sel_hi:[1,1]
v_pk_mul_f32 v[94:95],v[94:95],v[24:25] op_sel:[0,1] op_sel_hi:[1,1]
v_pk_mul_f32 v[96:97],v[96:97],v[24:25] op_sel:[0,1] op_sel_hi:[1,1]
v_pk_mul_f32 v[98:99],v[98:99],v[24:25] op_sel:[0,1] op_sel_hi:[1,1]
v_pk_mul_f32 v[100:101],v[100:101],v[24:25] op_sel:[0,1] op_sel_hi:[1,1]
v_pk_mul_f32 v[102:103],v[102:103],v[24:25] op_sel:[0,1] op_sel_hi:[1,1]
v_pk_mul_f32 v[104:105],v[104:105],v[24:25] op_sel:[0,1] op_sel_hi:[1,1]
v_pk_mul_f32 v[106:107],v[106:107],v[24:25] op_sel:[0,1] op_sel_hi:[1,1]
v_pk_mul_f32 v[108:109],v[108:109],v[24:25] op_sel:[0,1] op_sel_hi:[1,1]
v_pk_mul_f32 v[110:111],v[110:111],v[24:25] op_sel:[0,1] op_sel_hi:[1,1]
v_cvt_pk_bf16_f32 v112,v72,v73
v_lshlrev_b32 v72,16,v112
v_and_b32 v73,0xffff0000,v112
v_cvt_pk_bf16_f32 v113,v74,v75
v_lshlrev_b32 v74,16,v113
v_and_b32 v75,0xffff0000,v113
v_cvt_pk_bf16_f32 v114,v76,v77
v_lshlrev_b32 v76,16,v114
v_and_b32 v77,0xffff0000,v114
v_cvt_pk_bf16_f32 v115,v78,v79
v_lshlrev_b32 v78,16,v115
v_and_b32 v79,0xffff0000,v115
v_cvt_pk_bf16_f32 v116,v80,v81
v_lshlrev_b32 v80,16,v116
v_and_b32 v81,0xffff0000,v116
v_cvt_pk_bf16_f32 v117,v82,v83
v_lshlrev_b32 v82,16,v117
v_and_b32 v83,0xffff0000,v117
v_cvt_pk_bf16_f32 v118,v84,v85
v_lshlrev_b32 v84,16,v118
v_and_b32 v85,0xffff0000,v118
v_cvt_pk_bf16_f32 v119,v86,v87
v_lshlrev_b32 v86,16,v119
v_and_b32 v87,0xffff0000,v119
v_cvt_pk_bf16_f32 v120,v88,v89
v_lshlrev_b32 v88,16,v120
v_and_b32 v89,0xffff0000,v120
v_cvt_pk_bf16_f32 v121,v90,v91
v_lshlrev_b32 v90,16,v121
v_and_b32 v91,0xffff0000,v121
v_cvt_pk_bf16_f32 v122,v92,v93
v_lshlrev_b32 v92,16,v122
v_and_b32 v93,0xffff0000,v122
v_cvt_pk_bf16_f32 v123,v94,v95
v_lshlrev_b32 v94,16,v123
v_and_b32 v95,0xffff0000,v123
v_cvt_pk_bf16_f32 v124,v96,v97
v_lshlrev_b32 v96,16,v124
v_and_b32 v97,0xffff0000,v124
v_cvt_pk_bf16_f32 v125,v98,v99
v_lshlrev_b32 v98,16,v125
v_and_b32 v99,0xffff0000,v125
v_cvt_pk_bf16_f32 v126,v100,v101
v_lshlrev_b32 v100,16,v126
v_and_b32 v101,0xffff0000,v126
v_cvt_pk_bf16_f32 v127,v102,v103
v_lshlrev_b32 v102,16,v127
v_and_b32 v103,0xffff0000,v127
v_cvt_pk_bf16_f32 v128,v104,v105
v_lshlrev_b32 v104,16,v128
v_and_b32 v105,0xffff0000,v128
v_cvt_pk_bf16_f32 v129,v106,v107
v_lshlrev_b32 v106,16,v129
v_and_b32 v107,0xffff0000,v129
v_cvt_pk_bf16_f32 v130,v108,v109
v_lshlrev_b32 v108,16,v130
v_and_b32 v109,0xffff0000,v130
v_cvt_pk_bf16_f32 v131,v110,v111
v_lshlrev_b32 v110,16,v131
v_and_b32 v111,0xffff0000,v131
s_add_u32 s63,s65,0
v_permlane16_swap_b32 v112,v114
v_permlane16_swap_b32 v113,v115
buffer_store_dwordx4 v[112:115],v132,s[8:11],s63 offen sc1
s_add_u32 s63,s65,8192
v_permlane16_swap_b32 v116,v118
v_permlane16_swap_b32 v117,v119
buffer_store_dwordx4 v[116:119],v132,s[8:11],s63 offen sc1
s_add_u32 s63,s65,16384
v_permlane16_swap_b32 v120,v122
v_permlane16_swap_b32 v121,v123
buffer_store_dwordx4 v[120:123],v132,s[8:11],s63 offen sc1
s_add_u32 s63,s65,24576
v_permlane16_swap_b32 v124,v126
v_permlane16_swap_b32 v125,v127
buffer_store_dwordx4 v[124:127],v132,s[8:11],s63 offen sc1
s_add_u32 s63,s65,32768
v_permlane16_swap_b32 v128,v130
v_permlane16_swap_b32 v129,v131
buffer_store_dwordx4 v[128:131],v132,s[8:11],s63 offen sc1
s_add_u32 s63,s64,0
v_permlane16_swap_b32 v52,v54
v_permlane16_swap_b32 v53,v55
buffer_store_dwordx4 v[52:55],v132,s[8:11],s63 offen sc1
s_add_u32 s63,s64,8192
v_permlane16_swap_b32 v56,v58
v_permlane16_swap_b32 v57,v59
buffer_store_dwordx4 v[56:59],v132,s[8:11],s63 offen sc1
s_add_u32 s63,s64,16384
v_permlane16_swap_b32 v60,v62
v_permlane16_swap_b32 v61,v63
buffer_store_dwordx4 v[60:63],v132,s[8:11],s63 offen sc1
s_add_u32 s63,s64,24576
v_permlane16_swap_b32 v64,v66
v_permlane16_swap_b32 v65,v67
buffer_store_dwordx4 v[64:67],v132,s[8:11],s63 offen sc1
s_add_u32 s63,s64,32768
v_permlane16_swap_b32 v68,v70
v_permlane16_swap_b32 v69,v71
buffer_store_dwordx4 v[68:71],v132,s[8:11],s63 offen sc1
s_lshl_b32 s82,s55,6
s_add_u32 s82,s82,s54
s_lshl_b32 s82,s82,9
s_add_u32 s82,s82,0
s_lshl_b32 s61,s53,2
s_add_u32 s82,s82,s61
s_add_u32 s54,s54,16
s_cmp_lt_u32 s54,64
s_cbranch_scc1 R0_LOOPA
R0_ENDA:
s_waitcnt vmcnt(0)
s_mov_b64 exec,1
buffer_store_dword v5,v1,s[8:11],s82 offen sc1
s_mov_b64 exec,-1
s_mov_b32 s52,s86
s_mul_i32 s60,s86,196608
s_add_u32 s69,s69,s60
s_mul_i32 s60,s86,1024
s_add_u32 s70,s70,s60
ATT_LOOP:
s_lshl_b32 s67,s51,6
s_add_u32 s67,s67,s52
s_lshl_b32 s67,s67,9
s_add_u32 s67,s67,65536
s_mul_i32 s66,s52,393216
s_add_u32 s66,s66,s71
fb_273:
buffer_load_dword v3,v2,s[8:11],s67 offen sc1
s_waitcnt vmcnt(0)
v_cmp_eq_u32 vcc,0,v3
s_nop 0
s_cbranch_vccz ok_274
s_sleep 20
s_sub_u32 s47,s47,1
s_cbranch_scc1 ABORT
s_branch fb_273
ok_274:
s_add_u32 s63,s66,124780544
buffer_load_dwordx4 v[16:19],v1,s[8:11],s63 offen nt sc1
buffer_load_dwordx4 v[20:23],v1,s[8:11],s63 offen offset:1024 nt sc1
buffer_load_dwordx4 v[24:27],v1,s[8:11],s63 offen offset:2048 nt sc1
buffer_load_dwordx4 v[28:31],v1,s[8:11],s63 offen offset:3072 nt sc1
s_add_u32 s63,s66,124784640
buffer_load_dwordx4 v[32:35],v1,s[8:11],s63 offen nt sc1
buffer_load_dwordx4 v[36:39],v1,s[8:11],s63 offen offset:1024 nt sc1
buffer_load_dwordx4 v[40:43],v1,s[8:11],s63 offen offset:2048 nt sc1
buffer_load_dwordx4 v[44:47],v1,s[8:11],s63 offen offset:3072 nt sc1
s_add_u32 s63,s66,124788736
buffer_load_dwordx4 v[48:51],v1,s[8:11],s63 offen nt sc1
buffer_load_dwordx4 v[52:55],v1,s[8:11],s63 offen offset:1024 nt sc1
buffer_load_dwordx4 v[56:59],v1,s[8:11],s63 offen offset:2048 nt sc1
buffer_load_dwordx4 v[60:63],v1,s[8:11],s63 offen offset:3072 nt sc1
s_add_u32 s63,s66,74448896
buffer_load_dwordx4 v[64:67],v1,s[8:11],s63 offen nt sc1
buffer_load_dwordx4 v[68:71],v1,s[8:11],s63 offen offset:1024 nt sc1
buffer_load_dwordx4 v[72:75],v1,s[8:11],s63 offen offset:2048 nt sc1
buffer_load_dwordx4 v[76:79],v1,s[8:11],s63 offen offset:3072 nt sc1
s_add_u32 s63,s66,74452992
buffer_load_dwordx4 v[80:83],v1,s[8:11],s63 offen nt sc1
buffer_load_dwordx4 v[84:87],v1,s[8:11],s63 offen offset:1024 nt sc1
buffer_load_dwordx4 v[88:91],v1,s[8:11],s63 offen offset:2048 nt sc1
buffer_load_dwordx4 v[92:95],v1,s[8:11],s63 offen offset:3072 nt sc1
s_add_u32 s63,s66,74457088
buffer_load_dwordx4 v[96:99],v1,s[8:11],s63 offen nt sc1
buffer_load_dwordx4 v[100:103],v1,s[8:11],s63 offen offset:1024 nt sc1
buffer_load_dwordx4 v[104:107],v1,s[8:11],s63 offen offset:2048 nt sc1
buffer_load_dwordx4 v[108:111],v1,s[8:11],s63 offen offset:3072 nt sc1
s_add_u32 s63,s66,99614720
buffer_load_dwordx4 v[112:115],v1,s[8:11],s63 offen nt sc1
buffer_load_dwordx4 v[116:119],v1,s[8:11],s63 offen offset:1024 nt sc1
buffer_load_dwordx4 v[120:123],v1,s[8:11],s63 offen offset:2048 nt sc1
buffer_load_dwordx4 v[124:127],v1,s[8:11],s63 offen offset:3072 nt sc1
s_add_u32 s63,s66,99618816
buffer_load_dwordx4 v[128:131],v1,s[8:11],s63 offen nt sc1
buffer_load_dwordx4 v[132:135],v1,s[8:11],s63 offen offset:1024 nt sc1
buffer_load_dwordx4 v[136:139],v1,s[8:11],s63 offen offset:2048 nt sc1
buffer_load_dwordx4 v[140:143],v1,s[8:11],s63 offen offset:3072 nt sc1
s_add_u32 s63,s66,99622912
buffer_load_dwordx4 v[144:147],v1,s[8:11],s63 offen nt sc1
buffer_load_dwordx4 v[148:151],v1,s[8:11],s63 offen offset:1024 nt sc1
buffer_load_dwordx4 v[152:155],v1,s[8:11],s63 offen offset:2048 nt sc1
buffer_load_dwordx4 v[156:159],v1,s[8:11],s63 offen offset:3072 nt sc1
v_lshlrev_b32 v232,7,v0
s_add_u32 s63,s66,149946368
buffer_load_dword v233,v232,s[8:11],s63 offen sc1
s_add_u32 s63,s66,149950464
buffer_load_dword v233,v232,s[8:11],s63 offen sc1
s_waitcnt vmcnt(14)
v_mfma_f32_16x16x32_bf16 v[184:187],v[64:67],v[16:19],0
v_mfma_f32_16x16x32_bf16 v[188:191],v[64:67],v[20:23],0
v_mfma_f32_16x16x32_bf16 v[192:195],v[68:71],v[20:23],0
v_mfma_f32_16x16x32_bf16 v[184:187],v[72:75],v[24:27],v[184:187]
v_mfma_f32_16x16x32_bf16 v[188:191],v[72:75],v[28:31],v[188:191]
v_mfma_f32_16x16x32_bf16 v[192:195],v[76:79],v[28:31],v[192:195]
v_mfma_f32_16x16x32_bf16 v[184:187],v[80:83],v[32:35],v[184:187]
v_mfma_f32_16x16x32_bf16 v[188:191],v[80:83],v[36:39],v[188:191]
v_mfma_f32_16x16x32_bf16 v[192:195],v[84:87],v[36:39],v[192:195]
v_mfma_f32_16x16x32_bf16 v[184:187],v[88:91],v[40:43],v[184:187]
v_mfma_f32_16x16x32_bf16 v[188:191],v[88:91],v[44:47],v[188:191]
v_mfma_f32_16x16x32_bf16 v[192:195],v[92:95],v[44:47],v[192:195]
v_mfma_f32_16x16x32_bf16 v[184:187],v[96:99],v[48:51],v[184:187]
v_mfma_f32_16x16x32_bf16 v[188:191],v[96:99],v[52:55],v[188:191]
v_mfma_f32_16x16x32_bf16 v[192:195],v[100:103],v[52:55],v[192:195]
v_mfma_f32_16x16x32_bf16 v[184:187],v[104:107],v[56:59],v[184:187]
v_mfma_f32_16x16x32_bf16 v[188:191],v[104:107],v[60:63],v[188:191]
v_mfma_f32_16x16x32_bf16 v[192:195],v[108:111],v[60:63],v[192:195]
s_nop 5
v_cvt_pk_bf16_f32 v6,v184,v185
v_lshlrev_b32 v184,16,v6
v_and_b32 v185,0xffff0000,v6
v_cvt_pk_bf16_f32 v6,v186,v187
v_lshlrev_b32 v186,16,v6
v_and_b32 v187,0xffff0000,v6
v_cvt_pk_bf16_f32 v6,v188,v189
v_lshlrev_b32 v188,16,v6
v_and_b32 v189,0xffff0000,v6
v_cvt_pk_bf16_f32 v6,v190,v191
v_lshlrev_b32 v190,16,v6
v_and_b32 v191,0xffff0000,v6
v_cvt_pk_bf16_f32 v6,v192,v193
v_lshlrev_b32 v192,16,v6
v_and_b32 v193,0xffff0000,v6
v_cvt_pk_bf16_f32 v6,v194,v195
v_lshlrev_b32 v194,16,v6
v_and_b32 v195,0xffff0000,v6
v_mul_f32 v184,s84,v184
v_mul_f32 v185,s84,v185
v_mul_f32 v186,s84,v186
v_mul_f32 v187,s84,v187
v_mul_f32 v188,s84,v188
v_mul_f32 v189,s84,v189
v_mul_f32 v190,s84,v190
v_mul_f32 v191,s84,v191
v_mul_f32 v192,s84,v192
v_mul_f32 v193,s84,v193
v_mul_f32 v194,s84,v194
v_mul_f32 v195,s84,v195
v_cvt_pk_bf16_f32 v6,v184,v185
v_lshlrev_b32 v184,16,v6
v_and_b32 v185,0xffff0000,v6
v_cvt_pk_bf16_f32 v6,v186,v187
v_lshlrev_b32 v186,16,v6
v_and_b32 v187,0xffff0000,v6
v_cvt_pk_bf16_f32 v6,v188,v189
v_lshlrev_b32 v188,16,v6
v_and_b32 v189,0xffff0000,v6
v_cvt_pk_bf16_f32 v6,v190,v191
v_lshlrev_b32 v190,16,v6
v_and_b32 v191,0xffff0000,v6
v_cvt_pk_bf16_f32 v6,v192,v193
v_lshlrev_b32 v192,16,v6
v_and_b32 v193,0xffff0000,v6
v_cvt_pk_bf16_f32 v6,v194,v195
v_lshlrev_b32 v194,16,v6
v_and_b32 v195,0xffff0000,v6
v_cndmask_b32 v184,v230,v184,s[72:73]
v_cndmask_b32 v185,v230,v185,s[74:75]
v_cndmask_b32 v186,v230,v186,s[76:77]
v_cndmask_b32 v187,v230,v187,s[78:79]
v_cndmask_b32 v192,v230,v192,s[72:73]
v_cndmask_b32 v193,v230,v193,s[74:75]
v_cndmask_b32 v194,v230,v194,s[76:77]
v_cndmask_b32 v195,v230,v195,s[78:79]
s_nop 1
fb_275:
buffer_load_dword v3,v228,s[8:11],s70 offen sc1
s_waitcnt vmcnt(0)
v_cmp_eq_u32 vcc,0,v3
s_nop 0
s_cbranch_vccz ok_276
s_sleep 10
s_sub_u32 s47,s47,1
s_cbranch_scc1 ABORT
s_branch fb_275
ok_276:
buffer_load_dwordx4 v[160:163],v1,s[8:11],s69 offen sc1
buffer_load_dwordx4 v[164:167],v1,s[8:11],s69 offen offset:1024 sc1
buffer_load_dwordx4 v[168:171],v1,s[8:11],s69 offen offset:2048 sc1
s_add_u32 s63,s69,3072
buffer_load_dwordx4 v[172:175],v1,s[8:11],s63 offen sc1
buffer_load_dwordx4 v[176:179],v1,s[8:11],s63 offen offset:1024 sc1
buffer_load_dwordx4 v[180:183],v1,s[8:11],s63 offen offset:2048 sc1
s_waitcnt vmcnt(3)
v_mfma_f32_16x16x32_bf16 v[196:199],v[160:163],v[16:19],0
v_mfma_f32_16x16x32_bf16 v[200:203],v[160:163],v[24:27],0
v_mfma_f32_16x16x32_bf16 v[204:207],v[160:163],v[20:23],0
v_mfma_f32_16x16x32_bf16 v[208:211],v[160:163],v[28:31],0
v_mfma_f32_16x16x32_bf16 v[196:199],v[164:167],v[32:35],v[196:199]
v_mfma_f32_16x16x32_bf16 v[200:203],v[164:167],v[40:43],v[200:203]
v_mfma_f32_16x16x32_bf16 v[204:207],v[164:167],v[36:39],v[204:207]
v_mfma_f32_16x16x32_bf16 v[208:211],v[164:167],v[44:47],v[208:211]
v_mfma_f32_16x16x32_bf16 v[196:199],v[168:171],v[48:51],v[196:199]
v_mfma_f32_16x16x32_bf16 v[200:203],v[168:171],v[56:59],v[200:203]
v_mfma_f32_16x16x32_bf16 v[204:207],v[168:171],v[52:55],v[204:207]
v_mfma_f32_16x16x32_bf16 v[208:211],v[168:171],v[60:63],v[208:211]
s_nop 4
v_permlane32_swap_b32 v196,v197
v_permlane32_swap_b32 v200,v201
v_permlane32_swap_b32 v198,v199
v_permlane32_swap_b32 v202,v203
v_add_f32 v196,v196,v201
v_add_f32 v197,v198,v203
v_permlane32_swap_b32 v204,v205
v_permlane32_swap_b32 v208,v209
v_permlane32_swap_b32 v206,v207
v_permlane32_swap_b32 v210,v211
v_add_f32 v204,v204,v209
v_add_f32 v205,v206,v211
v_cvt_pk_bf16_f32 v6,v196,v197
v_lshlrev_b32 v196,16,v6
v_and_b32 v197,0xffff0000,v6
v_cvt_pk_bf16_f32 v6,v204,v205
v_lshlrev_b32 v204,16,v6
v_and_b32 v205,0xffff0000,v6
v_mul_f32 v196,s84,v196
v_mul_f32 v197,s84,v197
v_mul_f32 v204,s84,v204
v_mul_f32 v205,s84,v205
v_cvt_pk_bf16_f32 v6,v196,v197
v_lshlrev_b32 v196,16,v6
v_and_b32 v197,0xffff0000,v6
v_cvt_pk_bf16_f32 v6,v204,v205
v_lshlrev_b32 v204,16,v6
v_and_b32 v205,0xffff0000,v6
v_max3_f32 v6,v184,v185,v186
v_max3_f32 v6,v6,v187,v196
v_max_f32 v6,v6,v197
v_mov_b32 v7,v6
s_nop 1
v_permlane32_swap_b32 v6,v7
v_max_f32 v6,v6,v7
v_mov_b32 v7,v6
s_nop 1
v_permlane16_swap_b32 v6,v7
v_max_f32 v6,v6,v7
v_mul_f32 v6,s85,v6
v_fma_f32 v184,v184,s85,-v6
v_fma_f32 v185,v185,s85,-v6
v_fma_f32 v186,v186,s85,-v6
v_fma_f32 v187,v187,s85,-v6
v_fma_f32 v196,v196,s85,-v6
v_fma_f32 v197,v197,s85,-v6
v_exp_f32 v184,v184
v_exp_f32 v185,v185
v_exp_f32 v186,v186
v_exp_f32 v187,v187
v_exp_f32 v196,v196
v_exp_f32 v197,v197
v_add_f32 v6,v184,v185
v_add_f32 v6,v6,v186
v_add_f32 v6,v6,v187
v_add_f32 v6,v6,v196
v_add_f32 v6,v6,v197
v_mov_b32 v7,v6
s_nop 1
v_permlane32_swap_b32 v6,v7
v_add_f32 v6,v6,v7
v_mov_b32 v7,v6
s_nop 1
v_permlane16_swap_b32 v6,v7
v_add_f32 v6,v6,v7
v_rcp_f32 v6,v6
s_nop 0
v_mul_f32 v184,v184,v6
v_mul_f32 v185,v185,v6
v_mul_f32 v186,v186,v6
v_mul_f32 v187,v187,v6
v_mul_f32 v196,v196,v6
v_mul_f32 v197,v197,v6
v_cvt_pk_bf16_f32 v212,v184,v185
v_cvt_pk_bf16_f32 v213,v186,v187
v_mov_b32 v214,0
v_mov_b32 v215,0
v_cvt_pk_bf16_f32 v216,v196,v197
v_mov_b32 v217,0
v_mov_b32 v218,0
v_cvt_pk_bf16_f32 v219,v196,v197
v_max3_f32 v8,v188,v189,v190
v_max3_f32 v8,v8,v191,v192
v_max3_f32 v8,v8,v193,v194
v_max3_f32 v8,v8,v195,v204
v_max_f32 v8,v8,v205
v_mov_b32 v9,v8
s_nop 1
v_permlane32_swap_b32 v8,v9
v_max_f32 v8,v8,v9
v_mov_b32 v9,v8
s_nop 1
v_permlane16_swap_b32 v8,v9
v_max_f32 v8,v8,v9
v_mul_f32 v8,s85,v8
v_fma_f32 v188,v188,s85,-v8
v_fma_f32 v189,v189,s85,-v8
v_fma_f32 v190,v190,s85,-v8
v_fma_f32 v191,v191,s85,-v8
v_fma_f32 v192,v192,s85,-v8
v_fma_f32 v193,v193,s85,-v8
v_fma_f32 v194,v194,s85,-v8
v_fma_f32 v195,v195,s85,-v8
v_fma_f32 v204,v204,s85,-v8
v_fma_f32 v205,v205,s85,-v8
v_exp_f32 v188,v188
v_exp_f32 v189,v189
v_exp_f32 v190,v190
v_exp_f32 v191,v191
v_exp_f32 v192,v192
v_exp_f32 v193,v193
v_exp_f32 v194,v194
v_exp_f32 v195,v195
v_exp_f32 v204,v204
v_exp_f32 v205,v205
v_add_f32 v8,v188,v189
v_add_f32 v8,v8,v190
v_add_f32 v8,v8,v191
v_add_f32 v8,v8,v192
v_add_f32 v8,v8,v193
v_add_f32 v8,v8,v194
v_add_f32 v8,v8,v195
v_add_f32 v8,v8,v204
v_add_f32 v8,v8,v205
v_mov_b32 v9,v8
s_nop 1
v_permlane32_swap_b32 v8,v9
v_add_f32 v8,v8,v9
v_mov_b32 v9,v8
s_nop 1
v_permlane16_swap_b32 v8,v9
v_add_f32 v8,v8,v9
v_rcp_f32 v8,v8
s_nop 0
v_mul_f32 v188,v188,v8
v_mul_f32 v189,v189,v8
v_mul_f32 v190,v190,v8
v_mul_f32 v191,v191,v8
v_mul_f32 v192,v192,v8
v_mul_f32 v193,v193,v8
v_mul_f32 v194,v194,v8
v_mul_f32 v195,v195,v8
v_mul_f32 v204,v204,v8
v_mul_f32 v205,v205,v8
v_cvt_pk_bf16_f32 v220,v188,v189
v_cvt_pk_bf16_f32 v221,v190,v191
v_cvt_pk_bf16_f32 v222,v192,v193
v_cvt_pk_bf16_f32 v223,v194,v195
v_cvt_pk_bf16_f32 v224,v204,v205
v_mov_b32 v225,0
v_mov_b32 v226,0
v_cvt_pk_bf16_f32 v227,v204,v205
s_waitcnt vmcnt(0)
s_add_u32 s66,s66,149946368
v_mfma_f32_16x16x32_bf16 v[16:19],v[112:115],v[212:215],0
v_mfma_f32_16x16x32_bf16 v[20:23],v[116:119],v[212:215],0
v_mfma_f32_16x16x32_bf16 v[24:27],v[120:123],v[212:215],0
v_mfma_f32_16x16x32_bf16 v[28:31],v[124:127],v[212:215],0
v_mfma_f32_16x16x32_bf16 v[32:35],v[128:131],v[212:215],0
v_mfma_f32_16x16x32_bf16 v[36:39],v[132:135],v[212:215],0
v_mfma_f32_16x16x32_bf16 v[40:43],v[136:139],v[212:215],0
v_mfma_f32_16x16x32_bf16 v[44:47],v[140:143],v[212:215],0
v_mfma_f32_16x16x32_bf16 v[48:51],v[144:147],v[212:215],0
v_mfma_f32_16x16x32_bf16 v[52:55],v[148:151],v[212:215],0
v_mfma_f32_16x16x32_bf16 v[56:59],v[152:155],v[212:215],0
v_mfma_f32_16x16x32_bf16 v[60:63],v[156:159],v[212:215],0
v_mfma_f32_16x16x16_bf16 v[16:19],v[172:173],v[216:217],v[16:19]
v_mfma_f32_16x16x16_bf16 v[20:23],v[172:173],v[218:219],v[20:23]
v_mfma_f32_16x16x16_bf16 v[24:27],v[174:175],v[216:217],v[24:27]
v_mfma_f32_16x16x16_bf16 v[28:31],v[174:175],v[218:219],v[28:31]
v_mfma_f32_16x16x16_bf16 v[32:35],v[176:177],v[216:217],v[32:35]
v_mfma_f32_16x16x16_bf16 v[36:39],v[176:177],v[218:219],v[36:39]
v_mfma_f32_16x16x16_bf16 v[40:43],v[178:179],v[216:217],v[40:43]
v_mfma_f32_16x16x16_bf16 v[44:47],v[178:179],v[218:219],v[44:47]
v_mfma_f32_16x16x16_bf16 v[48:51],v[180:181],v[216:217],v[48:51]
v_mfma_f32_16x16x16_bf16 v[52:55],v[180:181],v[218:219],v[52:55]
v_mfma_f32_16x16x16_bf16 v[56:59],v[182:183],v[216:217],v[56:59]
v_mfma_f32_16x16x16_bf16 v[60:63],v[182:183],v[218:219],v[60:63]
v_mfma_f32_16x16x32_bf16 v[64:67],v[112:115],v[220:223],0
v_mfma_f32_16x16x32_bf16 v[68:71],v[116:119],v[220:223],0
v_mfma_f32_16x16x32_bf16 v[72:75],v[120:123],v[220:223],0
v_mfma_f32_16x16x32_bf16 v[76:79],v[124:127],v[220:223],0
v_mfma_f32_16x16x32_bf16 v[80:83],v[128:131],v[220:223],0
v_mfma_f32_16x16x32_bf16 v[84:87],v[132:135],v[220:223],0
v_mfma_f32_16x16x32_bf16 v[88:91],v[136:139],v[220:223],0
v_mfma_f32_16x16x32_bf16 v[92:95],v[140:143],v[220:223],0
v_mfma_f32_16x16x32_bf16 v[96:99],v[144:147],v[220:223],0
v_mfma_f32_16x16x32_bf16 v[100:103],v[148:151],v[220:223],0
v_mfma_f32_16x16x32_bf16 v[104:107],v[152:155],v[220:223],0
v_mfma_f32_16x16x32_bf16 v[108:111],v[156:159],v[220:223],0
v_mfma_f32_16x16x16_bf16 v[64:67],v[172:173],v[224:225],v[64:67]
v_mfma_f32_16x16x16_bf16 v[68:71],v[172:173],v[226:227],v[68:71]
v_mfma_f32_16x16x16_bf16 v[72:75],v[174:175],v[224:225],v[72:75]
v_mfma_f32_16x16x16_bf16 v[76:79],v[174:175],v[226:227],v[76:79]
v_mfma_f32_16x16x16_bf16 v[80:83],v[176:177],v[224:225],v[80:83]
v_mfma_f32_16x16x16_bf16 v[84:87],v[176:177],v[226:227],v[84:87]
v_mfma_f32_16x16x16_bf16 v[88:91],v[178:179],v[224:225],v[88:91]
v_mfma_f32_16x16x16_bf16 v[92:95],v[178:179],v[226:227],v[92:95]
v_mfma_f32_16x16x16_bf16 v[96:99],v[180:181],v[224:225],v[96:99]
v_mfma_f32_16x16x16_bf16 v[100:103],v[180:181],v[226:227],v[100:103]
v_mfma_f32_16x16x16_bf16 v[104:107],v[182:183],v[224:225],v[104:107]
v_mfma_f32_16x16x16_bf16 v[108:111],v[182:183],v[226:227],v[108:111]
s_cmp_lg_u32 s49,0
s_nop 5
s_cbranch_scc1 ATT_OS
v_cvt_pk_bf16_f32 v232,v16,v17
v_cvt_pk_bf16_f32 v233,v18,v19
v_cvt_pk_bf16_f32 v234,v20,v21
v_cvt_pk_bf16_f32 v235,v22,v23
s_add_u32 s63,s66,0
buffer_store_dwordx4 v[232:235],v1,s[8:11],s63 offen offset:0
v_cvt_pk_bf16_f32 v236,v24,v25
v_cvt_pk_bf16_f32 v237,v26,v27
v_cvt_pk_bf16_f32 v238,v28,v29
v_cvt_pk_bf16_f32 v239,v30,v31
buffer_store_dwordx4 v[236:239],v1,s[8:11],s63 offen offset:2048
v_cvt_pk_bf16_f32 v232,v32,v33
v_cvt_pk_bf16_f32 v233,v34,v35
v_cvt_pk_bf16_f32 v234,v36,v37
v_cvt_pk_bf16_f32 v235,v38,v39
s_add_u32 s63,s66,4096
buffer_store_dwordx4 v[232:235],v1,s[8:11],s63 offen offset:0
v_cvt_pk_bf16_f32 v236,v40,v41
v_cvt_pk_bf16_f32 v237,v42,v43
v_cvt_pk_bf16_f32 v238,v44,v45
v_cvt_pk_bf16_f32 v239,v46,v47
buffer_store_dwordx4 v[236:239],v1,s[8:11],s63 offen offset:2048
v_cvt_pk_bf16_f32 v232,v48,v49
v_cvt_pk_bf16_f32 v233,v50,v51
v_cvt_pk_bf16_f32 v234,v52,v53
v_cvt_pk_bf16_f32 v235,v54,v55
s_add_u32 s63,s66,8192
buffer_store_dwordx4 v[232:235],v1,s[8:11],s63 offen offset:0
v_cvt_pk_bf16_f32 v236,v56,v57
v_cvt_pk_bf16_f32 v237,v58,v59
v_cvt_pk_bf16_f32 v238,v60,v61
v_cvt_pk_bf16_f32 v239,v62,v63
buffer_store_dwordx4 v[236:239],v1,s[8:11],s63 offen offset:2048
v_cvt_pk_bf16_f32 v232,v64,v65
v_cvt_pk_bf16_f32 v233,v66,v67
v_cvt_pk_bf16_f32 v234,v68,v69
v_cvt_pk_bf16_f32 v235,v70,v71
s_add_u32 s63,s66,1024
buffer_store_dwordx4 v[232:235],v1,s[8:11],s63 offen offset:0
v_cvt_pk_bf16_f32 v236,v72,v73
v_cvt_pk_bf16_f32 v237,v74,v75
v_cvt_pk_bf16_f32 v238,v76,v77
v_cvt_pk_bf16_f32 v239,v78,v79
buffer_store_dwordx4 v[236:239],v1,s[8:11],s63 offen offset:2048
v_cvt_pk_bf16_f32 v232,v80,v81
v_cvt_pk_bf16_f32 v233,v82,v83
v_cvt_pk_bf16_f32 v234,v84,v85
v_cvt_pk_bf16_f32 v235,v86,v87
s_add_u32 s63,s66,5120
buffer_store_dwordx4 v[232:235],v1,s[8:11],s63 offen offset:0
v_cvt_pk_bf16_f32 v236,v88,v89
v_cvt_pk_bf16_f32 v237,v90,v91
v_cvt_pk_bf16_f32 v238,v92,v93
v_cvt_pk_bf16_f32 v239,v94,v95
buffer_store_dwordx4 v[236:239],v1,s[8:11],s63 offen offset:2048
v_cvt_pk_bf16_f32 v232,v96,v97
v_cvt_pk_bf16_f32 v233,v98,v99
v_cvt_pk_bf16_f32 v234,v100,v101
v_cvt_pk_bf16_f32 v235,v102,v103
s_add_u32 s63,s66,9216
buffer_store_dwordx4 v[232:235],v1,s[8:11],s63 offen offset:0
v_cvt_pk_bf16_f32 v236,v104,v105
v_cvt_pk_bf16_f32 v237,v106,v107
v_cvt_pk_bf16_f32 v238,v108,v109
v_cvt_pk_bf16_f32 v239,v110,v111
buffer_store_dwordx4 v[236:239],v1,s[8:11],s63 offen offset:2048
s_lshl_b32 s60,s51,6
s_add_u32 s60,s60,s52
s_lshl_b32 s60,s60,9
s_add_u32 s60,s60,262144
s_lshl_b32 s61,s87,2
s_add_u32 s60,s60,s61
s_waitcnt vmcnt(0)
s_mov_b64 exec,1
buffer_store_dword v5,v1,s[8:11],s60 offen
s_mov_b64 exec,-1
s_branch ATT_OJ
ATT_OS:
v_cvt_pk_bf16_f32 v232,v16,v17
v_cvt_pk_bf16_f32 v233,v18,v19
v_cvt_pk_bf16_f32 v234,v20,v21
v_cvt_pk_bf16_f32 v235,v22,v23
s_add_u32 s63,s66,0
buffer_store_dwordx4 v[232:235],v1,s[8:11],s63 offen sc1
v_cvt_pk_bf16_f32 v236,v24,v25
v_cvt_pk_bf16_f32 v237,v26,v27
v_cvt_pk_bf16_f32 v238,v28,v29
v_cvt_pk_bf16_f32 v239,v30,v31
buffer_store_dwordx4 v[236:239],v1,s[8:11],s63 offen offset:2048 sc1
v_cvt_pk_bf16_f32 v232,v32,v33
v_cvt_pk_bf16_f32 v233,v34,v35
v_cvt_pk_bf16_f32 v234,v36,v37
v_cvt_pk_bf16_f32 v235,v38,v39
s_add_u32 s63,s66,4096
buffer_store_dwordx4 v[232:235],v1,s[8:11],s63 offen sc1
v_cvt_pk_bf16_f32 v236,v40,v41
v_cvt_pk_bf16_f32 v237,v42,v43
v_cvt_pk_bf16_f32 v238,v44,v45
v_cvt_pk_bf16_f32 v239,v46,v47
buffer_store_dwordx4 v[236:239],v1,s[8:11],s63 offen offset:2048 sc1
v_cvt_pk_bf16_f32 v232,v48,v49
v_cvt_pk_bf16_f32 v233,v50,v51
v_cvt_pk_bf16_f32 v234,v52,v53
v_cvt_pk_bf16_f32 v235,v54,v55
s_add_u32 s63,s66,8192
buffer_store_dwordx4 v[232:235],v1,s[8:11],s63 offen sc1
v_cvt_pk_bf16_f32 v236,v56,v57
v_cvt_pk_bf16_f32 v237,v58,v59
v_cvt_pk_bf16_f32 v238,v60,v61
v_cvt_pk_bf16_f32 v239,v62,v63
buffer_store_dwordx4 v[236:239],v1,s[8:11],s63 offen offset:2048 sc1
v_cvt_pk_bf16_f32 v232,v64,v65
v_cvt_pk_bf16_f32 v233,v66,v67
v_cvt_pk_bf16_f32 v234,v68,v69
v_cvt_pk_bf16_f32 v235,v70,v71
s_add_u32 s63,s66,1024
buffer_store_dwordx4 v[232:235],v1,s[8:11],s63 offen sc1
v_cvt_pk_bf16_f32 v236,v72,v73
v_cvt_pk_bf16_f32 v237,v74,v75
v_cvt_pk_bf16_f32 v238,v76,v77
v_cvt_pk_bf16_f32 v239,v78,v79
buffer_store_dwordx4 v[236:239],v1,s[8:11],s63 offen offset:2048 sc1
v_cvt_pk_bf16_f32 v232,v80,v81
v_cvt_pk_bf16_f32 v233,v82,v83
v_cvt_pk_bf16_f32 v234,v84,v85
v_cvt_pk_bf16_f32 v235,v86,v87
s_add_u32 s63,s66,5120
buffer_store_dwordx4 v[232:235],v1,s[8:11],s63 offen sc1
v_cvt_pk_bf16_f32 v236,v88,v89
v_cvt_pk_bf16_f32 v237,v90,v91
v_cvt_pk_bf16_f32 v238,v92,v93
v_cvt_pk_bf16_f32 v239,v94,v95
buffer_store_dwordx4 v[236:239],v1,s[8:11],s63 offen offset:2048 sc1
v_cvt_pk_bf16_f32 v232,v96,v97
v_cvt_pk_bf16_f32 v233,v98,v99
v_cvt_pk_bf16_f32 v234,v100,v101
v_cvt_pk_bf16_f32 v235,v102,v103
s_add_u32 s63,s66,9216
buffer_store_dwordx4 v[232:235],v1,s[8:11],s63 offen sc1
v_cvt_pk_bf16_f32 v236,v104,v105
v_cvt_pk_bf16_f32 v237,v106,v107
v_cvt_pk_bf16_f32 v238,v108,v109
v_cvt_pk_bf16_f32 v239,v110,v111
buffer_store_dwordx4 v[236:239],v1,s[8:11],s63 offen offset:2048 sc1
s_lshl_b32 s60,s51,6
s_add_u32 s60,s60,s52
s_lshl_b32 s60,s60,9
s_add_u32 s60,s60,262144
s_lshl_b32 s61,s87,2
s_add_u32 s60,s60,s61
s_waitcnt vmcnt(0)
s_mov_b64 exec,1
buffer_store_dword v5,v1,s[8:11],s60 offen sc1
s_mov_b64 exec,-1
ATT_OJ:
s_add_u32 s69,s69,393216
s_add_u32 s70,s70,2048
s_add_u32 s52,s52,2
s_cmp_lt_u32 s52,64
s_cbranch_scc1 ATT_LOOP
s_endpgm
ROLE_WO:
v_lshlrev_b32 v1,4,v0
v_mov_b32 v5,1
s_lshl_b32 s56,s48,2
s_add_u32 s56,s56,s46
v_bfe_u32 v6,v0,2,2
v_lshrrev_b32 v7,4,v0
v_add_u32 v7,v6,v7
v_and_b32 v7,3,v7
v_and_b32 v15,3,v0
v_lshlrev_b32 v15,4,v15
v_lshl_add_u32 v15,v7,6,v15
v_lshl_add_u32 v15,v6,8,v15
v_lshrrev_b32 v6,5,v0
v_bfe_u32 v7,v0,4,1
v_lshlrev_b32 v208,10,v7
v_lshl_add_u32 v208,v6,8,v208
v_and_b32 v6,15,v0
v_lshl_add_u32 v208,v6,4,v208
v_lshrrev_b32 v6,5,v0
v_add_u32 v6,2,v6
v_bfe_u32 v7,v0,4,1
v_lshlrev_b32 v209,10,v7
v_lshl_add_u32 v209,v6,8,v209
v_and_b32 v6,15,v0
v_lshl_add_u32 v209,v6,4,v209
s_mul_i32 s64,s48,6554
s_lshr_b32 s64,s64,16
s_mul_i32 s60,s64,10
s_sub_u32 s65,s48,s60
v_min_u32 v2,1,v0
s_lshl_b32 s60,s64,4
s_add_u32 s60,s60,s46
s_lshl_b32 s60,s60,1
v_add_u32 v2,s60,v2
v_lshlrev_b32 v2,2,v2
s_and_b32 s60,s46,1
s_lshl_b32 s68,s65,1
s_add_u32 s68,s68,s60
s_lshr_b32 s69,s46,1
s_mul_i32 s71,s46,24576
s_mul_i32 s58,s46,491520
s_lshl_b32 s61,s65,7
s_add_u32 s58,s58,s61
s_mul_i32 s61,s64,1966080
s_add_u32 s58,s58,s61
s_mul_i32 s61,s64,98304
s_add_u32 s71,s71,s61
s_add_u32 s71,s71,149946368
v_bfe_u32 v6,v0,2,2
v_mul_u32_u24 v205,10240,v6
v_and_b32 v6,3,v0
v_lshl_add_u32 v205,v6,4,v205
v_lshrrev_b32 v6,4,v0
v_lshl_add_u32 v205,v6,6,v205
s_mul_i32 s74,s64,81920
s_mul_i32 s61,s69,40960
s_add_u32 s74,s74,s61
s_lshl_b32 s61,s68,9
s_add_u32 s74,s74,s61
s_add_u32 s74,s74,175112192
s_lshl1_add_u32 s75,s48,s60
s_lshl_b32 s75,s75,2
s_mul_i32 s61,s69,320
s_add_u32 s75,s75,s61
s_add_u32 s75,s75,819200
v_bfe_u32 v6,v0,4,1
v_lshlrev_b32 v206,14,v6
v_lshrrev_b32 v6,5,v0
v_lshl_add_u32 v206,v6,8,v206
v_and_b32 v6,15,v0
v_lshl_add_u32 v206,v6,4,v206
s_lshl_b32 s60,s46,11
v_add_u32 v206,s60,v206
s_lshl_b32 s60,s46,13
v_add_u32 v207,s60,v1
s_waitcnt vmcnt(0)
s_barrier
s_cmp_lg_u32 s46,0
s_cbranch_scc1 arr_277
v_mov_b32 v6,1
s_lshl_b32 s3,s49,2
v_mov_b32 v7,s3
s_mov_b64 exec,1
buffer_atomic_add v6,v7,s[12:15],0 offen sc1
s_mov_b64 exec,-1
arr_277:
s_mul_i32 s63,s46,40960
s_mov_b32 s4,s26
s_mov_b32 s5,s27
s_mov_b32 s6,7864320
s_mov_b32 s7,0x20000
v_lshrrev_b32 v9,3,v0
s_mov_b32 s64,1280
v_mul_lo_u32 v9,v9,s64
v_and_b32 v10,7,v0
v_lshl_add_u32 v6,v10,4,v9
s_add_u32 m0,s63,0
s_add_u32 s65,s58,0
buffer_load_dwordx4 v6,s[4:7],s65 offen lds
s_add_u32 m0,s63,1024
s_add_u32 s65,s58,10240
buffer_load_dwordx4 v6,s[4:7],s65 offen lds
s_add_u32 m0,s63,2048
s_add_u32 s65,s58,20480
buffer_load_dwordx4 v6,s[4:7],s65 offen lds
s_add_u32 m0,s63,3072
s_add_u32 s65,s58,30720
buffer_load_dwordx4 v6,s[4:7],s65 offen lds
s_add_u32 m0,s63,4096
s_add_u32 s65,s58,40960
buffer_load_dwordx4 v6,s[4:7],s65 offen lds
s_add_u32 m0,s63,5120
s_add_u32 s65,s58,51200
buffer_load_dwordx4 v6,s[4:7],s65 offen lds
s_add_u32 m0,s63,6144
s_add_u32 s65,s58,61440
buffer_load_dwordx4 v6,s[4:7],s65 offen lds
s_add_u32 m0,s63,7168
s_add_u32 s65,s58,71680
buffer_load_dwordx4 v6,s[4:7],s65 offen lds
s_add_u32 m0,s63,8192
s_add_u32 s65,s58,81920
buffer_load_dwordx4 v6,s[4:7],s65 offen lds
s_add_u32 m0,s63,9216
s_add_u32 s65,s58,92160
buffer_load_dwordx4 v6,s[4:7],s65 offen lds
s_add_u32 m0,s63,10240
s_add_u32 s65,s58,102400
buffer_load_dwordx4 v6,s[4:7],s65 offen lds
s_add_u32 m0,s63,11264
s_add_u32 s65,s58,112640
buffer_load_dwordx4 v6,s[4:7],s65 offen lds
s_add_u32 m0,s63,12288
s_add_u32 s65,s58,122880
buffer_load_dwordx4 v6,s[4:7],s65 offen lds
s_add_u32 m0,s63,13312
s_add_u32 s65,s58,133120
buffer_load_dwordx4 v6,s[4:7],s65 offen lds
s_add_u32 m0,s63,14336
s_add_u32 s65,s58,143360
buffer_load_dwordx4 v6,s[4:7],s65 offen lds
s_add_u32 m0,s63,15360
s_add_u32 s65,s58,153600
buffer_load_dwordx4 v6,s[4:7],s65 offen lds
s_add_u32 m0,s63,16384
s_add_u32 s65,s58,163840
buffer_load_dwordx4 v6,s[4:7],s65 offen lds
s_add_u32 m0,s63,17408
s_add_u32 s65,s58,174080
buffer_load_dwordx4 v6,s[4:7],s65 offen lds
s_add_u32 m0,s63,18432
s_add_u32 s65,s58,184320
buffer_load_dwordx4 v6,s[4:7],s65 offen lds
s_add_u32 m0,s63,19456
s_add_u32 s65,s58,194560
buffer_load_dwordx4 v6,s[4:7],s65 offen lds
s_add_u32 m0,s63,20480
s_add_u32 s65,s58,204800
buffer_load_dwordx4 v6,s[4:7],s65 offen lds
s_add_u32 m0,s63,21504
s_add_u32 s65,s58,215040
buffer_load_dwordx4 v6,s[4:7],s65 offen lds
s_add_u32 m0,s63,22528
s_add_u32 s65,s58,225280
buffer_load_dwordx4 v6,s[4:7],s65 offen lds
s_add_u32 m0,s63,23552
s_add_u32 s65,s58,235520
buffer_load_dwordx4 v6,s[4:7],s65 offen lds
s_add_u32 m0,s63,24576
s_add_u32 s65,s58,245760
buffer_load_dwordx4 v6,s[4:7],s65 offen lds
s_add_u32 m0,s63,25600
s_add_u32 s65,s58,256000
buffer_load_dwordx4 v6,s[4:7],s65 offen lds
s_add_u32 m0,s63,26624
s_add_u32 s65,s58,266240
buffer_load_dwordx4 v6,s[4:7],s65 offen lds
s_add_u32 m0,s63,27648
s_add_u32 s65,s58,276480
buffer_load_dwordx4 v6,s[4:7],s65 offen lds
s_add_u32 m0,s63,28672
s_add_u32 s65,s58,286720
buffer_load_dwordx4 v6,s[4:7],s65 offen lds
s_add_u32 m0,s63,29696
s_add_u32 s65,s58,296960
buffer_load_dwordx4 v6,s[4:7],s65 offen lds
s_add_u32 m0,s63,30720
s_add_u32 s65,s58,307200
buffer_load_dwordx4 v6,s[4:7],s65 offen lds
s_add_u32 m0,s63,31744
s_add_u32 s65,s58,317440
buffer_load_dwordx4 v6,s[4:7],s65 offen lds
s_add_u32 m0,s63,32768
s_add_u32 s65,s58,327680
buffer_load_dwordx4 v6,s[4:7],s65 offen lds
s_add_u32 m0,s63,33792
s_add_u32 s65,s58,337920
buffer_load_dwordx4 v6,s[4:7],s65 offen lds
s_add_u32 m0,s63,34816
s_add_u32 s65,s58,348160
buffer_load_dwordx4 v6,s[4:7],s65 offen lds
s_add_u32 m0,s63,35840
s_add_u32 s65,s58,358400
buffer_load_dwordx4 v6,s[4:7],s65 offen lds
s_add_u32 m0,s63,36864
s_add_u32 s65,s58,368640
buffer_load_dwordx4 v6,s[4:7],s65 offen lds
s_add_u32 m0,s63,37888
s_add_u32 s65,s58,378880
buffer_load_dwordx4 v6,s[4:7],s65 offen lds
s_add_u32 m0,s63,38912
s_add_u32 s65,s58,389120
buffer_load_dwordx4 v6,s[4:7],s65 offen lds
s_add_u32 m0,s63,39936
s_add_u32 s65,s58,399360
buffer_load_dwordx4 v6,s[4:7],s65 offen lds
s_waitcnt vmcnt(20)
v_bfe_u32 v9,v0,2,2
v_lshrrev_b32 v10,5,v0
v_lshl_add_u32 v9,v10,2,v9
v_mul_u32_u24 v9,128,v9
v_and_b32 v10,1,v0
v_lshl_add_u32 v9,v10,3,v9
v_bfe_u32 v10,v0,1,1
v_lshl_add_u32 v9,v10,5,v9
v_bfe_u32 v10,v0,4,1
v_lshl_add_u32 v9,v10,4,v9
v_add_u32 v7,s63,v9
ds_read_b64_tr_b16 a[0:1],v7 offset:0
ds_read_b64_tr_b16 a[2:3],v7 offset:2048
ds_read_b64_tr_b16 a[4:5],v7 offset:1024
ds_read_b64_tr_b16 a[6:7],v7 offset:3072
ds_read_b64_tr_b16 a[96:97],v7 offset:64
ds_read_b64_tr_b16 a[98:99],v7 offset:2112
ds_read_b64_tr_b16 a[100:101],v7 offset:1088
ds_read_b64_tr_b16 a[102:103],v7 offset:3136
ds_read_b64_tr_b16 a[8:9],v7 offset:4096
ds_read_b64_tr_b16 a[10:11],v7 offset:6144
ds_read_b64_tr_b16 a[12:13],v7 offset:5120
ds_read_b64_tr_b16 a[14:15],v7 offset:7168
s_waitcnt lgkmcnt(4)
ds_read_b64_tr_b16 a[104:105],v7 offset:4160
ds_read_b64_tr_b16 a[106:107],v7 offset:6208
ds_read_b64_tr_b16 a[108:109],v7 offset:5184
ds_read_b64_tr_b16 a[110:111],v7 offset:7232
ds_read_b64_tr_b16 a[16:17],v7 offset:8192
ds_read_b64_tr_b16 a[18:19],v7 offset:10240
ds_read_b64_tr_b16 a[20:21],v7 offset:9216
ds_read_b64_tr_b16 a[22:23],v7 offset:11264
ds_read_b64_tr_b16 a[112:113],v7 offset:8256
ds_read_b64_tr_b16 a[114:115],v7 offset:10304
ds_read_b64_tr_b16 a[116:117],v7 offset:9280
ds_read_b64_tr_b16 a[118:119],v7 offset:11328
s_waitcnt lgkmcnt(4)
ds_read_b64_tr_b16 a[24:25],v7 offset:12288
ds_read_b64_tr_b16 a[26:27],v7 offset:14336
ds_read_b64_tr_b16 a[28:29],v7 offset:13312
ds_read_b64_tr_b16 a[30:31],v7 offset:15360
ds_read_b64_tr_b16 a[120:121],v7 offset:12352
ds_read_b64_tr_b16 a[122:123],v7 offset:14400
ds_read_b64_tr_b16 a[124:125],v7 offset:13376
ds_read_b64_tr_b16 a[126:127],v7 offset:15424
ds_read_b64_tr_b16 a[32:33],v7 offset:16384
ds_read_b64_tr_b16 a[34:35],v7 offset:18432
ds_read_b64_tr_b16 a[36:37],v7 offset:17408
ds_read_b64_tr_b16 a[38:39],v7 offset:19456
s_waitcnt lgkmcnt(4)
ds_read_b64_tr_b16 a[128:129],v7 offset:16448
ds_read_b64_tr_b16 a[130:131],v7 offset:18496
ds_read_b64_tr_b16 a[132:133],v7 offset:17472
ds_read_b64_tr_b16 a[134:135],v7 offset:19520
s_waitcnt lgkmcnt(0)
s_add_u32 m0,s63,0
s_add_u32 s65,s58,409600
buffer_load_dwordx4 v6,s[4:7],s65 offen lds
s_add_u32 m0,s63,1024
s_add_u32 s65,s58,419840
buffer_load_dwordx4 v6,s[4:7],s65 offen lds
s_add_u32 m0,s63,2048
s_add_u32 s65,s58,430080
buffer_load_dwordx4 v6,s[4:7],s65 offen lds
s_add_u32 m0,s63,3072
s_add_u32 s65,s58,440320
buffer_load_dwordx4 v6,s[4:7],s65 offen lds
s_add_u32 m0,s63,4096
s_add_u32 s65,s58,450560
buffer_load_dwordx4 v6,s[4:7],s65 offen lds
s_add_u32 m0,s63,5120
s_add_u32 s65,s58,460800
buffer_load_dwordx4 v6,s[4:7],s65 offen lds
s_add_u32 m0,s63,6144
s_add_u32 s65,s58,471040
buffer_load_dwordx4 v6,s[4:7],s65 offen lds
s_add_u32 m0,s63,7168
s_add_u32 s65,s58,481280
buffer_load_dwordx4 v6,s[4:7],s65 offen lds
s_waitcnt vmcnt(8)
v_bfe_u32 v9,v0,2,2
v_lshrrev_b32 v10,5,v0
v_lshl_add_u32 v9,v10,2,v9
v_mul_u32_u24 v9,128,v9
v_and_b32 v10,1,v0
v_lshl_add_u32 v9,v10,3,v9
v_bfe_u32 v10,v0,1,1
v_lshl_add_u32 v9,v10,5,v9
v_bfe_u32 v10,v0,4,1
v_lshl_add_u32 v9,v10,4,v9
v_add_u32 v7,s63,v9
ds_read_b64_tr_b16 a[40:41],v7 offset:20480
ds_read_b64_tr_b16 a[42:43],v7 offset:22528
ds_read_b64_tr_b16 a[44:45],v7 offset:21504
ds_read_b64_tr_b16 a[46:47],v7 offset:23552
ds_read_b64_tr_b16 a[136:137],v7 offset:20544
ds_read_b64_tr_b16 a[138:139],v7 offset:22592
ds_read_b64_tr_b16 a[140:141],v7 offset:21568
ds_read_b64_tr_b16 a[142:143],v7 offset:23616
ds_read_b64_tr_b16 a[48:49],v7 offset:24576
ds_read_b64_tr_b16 a[50:51],v7 offset:26624
ds_read_b64_tr_b16 a[52:53],v7 offset:25600
ds_read_b64_tr_b16 a[54:55],v7 offset:27648
s_waitcnt lgkmcnt(4)
ds_read_b64_tr_b16 a[144:145],v7 offset:24640
ds_read_b64_tr_b16 a[146:147],v7 offset:26688
ds_read_b64_tr_b16 a[148:149],v7 offset:25664
ds_read_b64_tr_b16 a[150:151],v7 offset:27712
ds_read_b64_tr_b16 a[56:57],v7 offset:28672
ds_read_b64_tr_b16 a[58:59],v7 offset:30720
ds_read_b64_tr_b16 a[60:61],v7 offset:29696
ds_read_b64_tr_b16 a[62:63],v7 offset:31744
ds_read_b64_tr_b16 a[152:153],v7 offset:28736
ds_read_b64_tr_b16 a[154:155],v7 offset:30784
ds_read_b64_tr_b16 a[156:157],v7 offset:29760
ds_read_b64_tr_b16 a[158:159],v7 offset:31808
s_waitcnt lgkmcnt(4)
ds_read_b64_tr_b16 a[64:65],v7 offset:32768
ds_read_b64_tr_b16 a[66:67],v7 offset:34816
ds_read_b64_tr_b16 a[68:69],v7 offset:33792
ds_read_b64_tr_b16 a[70:71],v7 offset:35840
ds_read_b64_tr_b16 a[160:161],v7 offset:32832
ds_read_b64_tr_b16 a[162:163],v7 offset:34880
ds_read_b64_tr_b16 a[164:165],v7 offset:33856
ds_read_b64_tr_b16 a[166:167],v7 offset:35904
ds_read_b64_tr_b16 a[72:73],v7 offset:36864
ds_read_b64_tr_b16 a[74:75],v7 offset:38912
ds_read_b64_tr_b16 a[76:77],v7 offset:37888
ds_read_b64_tr_b16 a[78:79],v7 offset:39936
s_waitcnt lgkmcnt(4)
ds_read_b64_tr_b16 a[168:169],v7 offset:36928
ds_read_b64_tr_b16 a[170:171],v7 offset:38976
ds_read_b64_tr_b16 a[172:173],v7 offset:37952
ds_read_b64_tr_b16 a[174:175],v7 offset:40000
s_waitcnt lgkmcnt(0)
s_waitcnt vmcnt(0)
v_bfe_u32 v9,v0,2,2
v_lshrrev_b32 v10,5,v0
v_lshl_add_u32 v9,v10,2,v9
v_mul_u32_u24 v9,128,v9
v_and_b32 v10,1,v0
v_lshl_add_u32 v9,v10,3,v9
v_bfe_u32 v10,v0,1,1
v_lshl_add_u32 v9,v10,5,v9
v_bfe_u32 v10,v0,4,1
v_lshl_add_u32 v9,v10,4,v9
v_add_u32 v7,s63,v9
ds_read_b64_tr_b16 a[80:81],v7 offset:0
ds_read_b64_tr_b16 a[82:83],v7 offset:2048
ds_read_b64_tr_b16 a[84:85],v7 offset:1024
ds_read_b64_tr_b16 a[86:87],v7 offset:3072
ds_read_b64_tr_b16 a[176:177],v7 offset:64
ds_read_b64_tr_b16 a[178:179],v7 offset:2112
ds_read_b64_tr_b16 a[180:181],v7 offset:1088
ds_read_b64_tr_b16 a[182:183],v7 offset:3136
ds_read_b64_tr_b16 a[88:89],v7 offset:4096
ds_read_b64_tr_b16 a[90:91],v7 offset:6144
ds_read_b64_tr_b16 a[92:93],v7 offset:5120
ds_read_b64_tr_b16 a[94:95],v7 offset:7168
s_waitcnt lgkmcnt(4)
ds_read_b64_tr_b16 a[184:185],v7 offset:4160
ds_read_b64_tr_b16 a[186:187],v7 offset:6208
ds_read_b64_tr_b16 a[188:189],v7 offset:5184
ds_read_b64_tr_b16 a[190:191],v7 offset:7232
s_waitcnt lgkmcnt(0)
s_barrier
s_lshl_b32 s3,s49,2
v_mov_b32 v7,s3
s_nop 1
ibw_278:
buffer_load_dword v6,v7,s[12:15],0 offen sc1
s_waitcnt vmcnt(0)
v_cmp_ne_u32 vcc,256,v6
s_nop 0
s_cbranch_vccz ok_279
s_sleep 8
s_sub_u32 s47,s47,1
s_cbranch_scc1 ABORT
s_branch ibw_278
ok_279:
s_cmp_lg_u32 s49,0
s_cbranch_scc1 ibok_280
v_and_b32 v7,7,v0
v_lshlrev_b32 v7,2,v7
buffer_load_dword v6,v7,s[12:15],0 offen offset:32 sc1
s_waitcnt vmcnt(0)
v_cmp_ne_u32 vcc,32,v6
s_nop 0
s_cbranch_vccz ibok_280
s_barrier
s_mov_b32 s49,1
s_mov_b32 s3,s2
s_load_dwordx16 s[16:31],s[0:1],0
s_load_dwordx8 s[32:39],s[0:1],64
s_waitcnt lgkmcnt(0)
s_branch DISPATCH
ibok_280:
s_mov_b32 s83,s100
s_mov_b32 s32,0
s_mov_b32 s59,2147483648
s_min_u32 s62,s32,127
s_sub_u32 s60,s62,15
s_lshr_b32 s34,s60,1
s_and_b32 s33,s60,1
s_cmp_eq_u32 s33,0
s_cselect_b32 s61,15,0
s_add_u32 s34,s34,s61
s_sub_u32 s61,s60,49
s_cmp_ge_u32 s60,98
s_cselect_b32 s34,s61,s34
s_cselect_b32 s33,1,s33
s_cmp_lt_u32 s62,15
s_cselect_b32 s34,s62,s34
s_cselect_b32 s33,0,s33
s_lshl_b32 s35,s33,6
s_add_u32 s35,s35,s34
s_lshl_b32 s35,s35,9
s_add_u32 s35,s35,262144
s_mul_i32 s73,s34,393216
s_add_u32 s73,s73,s71
WO_COLD:
fb_281:
buffer_load_dword v3,v2,s[8:11],s35 offen sc1
s_waitcnt vmcnt(0)
v_cmp_eq_u32 vcc,0,v3
s_nop 0
s_cbranch_vccz ok_282
s_sleep 2
s_sub_u32 s47,s47,1
s_cbranch_scc1 ABORT
s_branch fb_281
ok_282:
s_add_u32 s63,s73,0
buffer_load_dwordx4 v[16:19],v208,s[8:11],s63 offen sc1
s_nop 7
buffer_load_dwordx4 v[20:23],v209,s[8:11],s63 offen sc1
s_nop 7
buffer_load_dwordx4 v[24:27],v208,s[8:11],s63 offen offset:2048 sc1
s_nop 7
buffer_load_dwordx4 v[28:31],v209,s[8:11],s63 offen offset:2048 sc1
s_nop 7
s_add_u32 s63,s73,4096
buffer_load_dwordx4 v[32:35],v208,s[8:11],s63 offen sc1
s_nop 7
buffer_load_dwordx4 v[36:39],v209,s[8:11],s63 offen sc1
s_nop 7
buffer_load_dwordx4 v[40:43],v208,s[8:11],s63 offen offset:2048 sc1
s_nop 7
buffer_load_dwordx4 v[44:47],v209,s[8:11],s63 offen offset:2048 sc1
s_nop 7
s_add_u32 s63,s73,8192
buffer_load_dwordx4 v[48:51],v208,s[8:11],s63 offen sc1
s_nop 7
buffer_load_dwordx4 v[52:55],v209,s[8:11],s63 offen sc1
WO_NEXT:
s_mov_b32 s51,s33
s_mov_b32 s52,s34
s_mov_b32 s72,s73
s_add_u32 s32,s32,1
s_waitcnt vmcnt(9)
v_mfma_f32_32x32x16_bf16 v[112:127],a[0:3],v[16:19],0
s_add_u32 s63,s72,8192
buffer_load_dwordx4 v[56:59],v208,s[8:11],s63 offen offset:2048 sc1
s_min_u32 s62,s32,127
s_sub_u32 s60,s62,15
s_lshr_b32 s34,s60,1
v_mfma_f32_32x32x16_bf16 v[128:143],a[96:99],v[16:19],0
s_and_b32 s33,s60,1
s_cmp_eq_u32 s33,0
s_cselect_b32 s61,15,0
s_add_u32 s34,s34,s61
s_sub_u32 s61,s60,49
v_xor_b32 v206,0x8000,v206
s_waitcnt vmcnt(9)
v_mfma_f32_32x32x16_bf16 v[112:127],a[4:7],v[20:23],v[112:127]
buffer_load_dwordx4 v[60:63],v209,s[8:11],s63 offen offset:2048 sc1
s_cmp_ge_u32 s60,98
s_cselect_b32 s34,s61,s34
s_cselect_b32 s33,1,s33
v_xor_b32 v207,0x8000,v207
v_mfma_f32_32x32x16_bf16 v[128:143],a[100:103],v[20:23],v[128:143]
s_cmp_lt_u32 s62,15
s_cselect_b32 s34,s62,s34
s_cselect_b32 s33,0,s33
s_lshl_b32 s35,s33,6
s_add_u32 s35,s35,s34
s_lshl_b32 s35,s35,9
s_waitcnt vmcnt(9)
v_mfma_f32_32x32x16_bf16 v[112:127],a[8:11],v[24:27],v[112:127]
s_add_u32 s63,s72,12288
buffer_load_dwordx4 v[64:67],v208,s[8:11],s63 offen sc1
s_add_u32 s35,s35,262144
s_mul_i32 s73,s34,393216
s_add_u32 s73,s73,s71
v_mfma_f32_32x32x16_bf16 v[128:143],a[104:107],v[24:27],v[128:143]
buffer_load_dword v3,v2,s[8:11],s35 offen sc1
s_mul_i32 s64,s52,491520
s_add_u32 s64,s64,s74
s_lshl_b32 s65,s51,6
s_add_u32 s65,s65,s52
s_waitcnt vmcnt(10)
v_mfma_f32_32x32x16_bf16 v[112:127],a[12:15],v[28:31],v[112:127]
buffer_load_dwordx4 v[68:71],v209,s[8:11],s63 offen sc1
s_mul_i32 s65,s65,640
s_add_u32 s82,s65,s75
v_mfma_f32_32x32x16_bf16 v[128:143],a[108:111],v[28:31],v[128:143]
s_waitcnt vmcnt(10)
v_mfma_f32_32x32x16_bf16 v[112:127],a[16:19],v[32:35],v[112:127]
buffer_load_dwordx4 v[72:75],v208,s[8:11],s63 offen offset:2048 sc1
v_mfma_f32_32x32x16_bf16 v[128:143],a[112:115],v[32:35],v[128:143]
s_waitcnt vmcnt(10)
v_mfma_f32_32x32x16_bf16 v[112:127],a[20:23],v[36:39],v[112:127]
buffer_load_dwordx4 v[76:79],v209,s[8:11],s63 offen offset:2048 sc1
v_mfma_f32_32x32x16_bf16 v[128:143],a[116:119],v[36:39],v[128:143]
s_waitcnt vmcnt(10)
v_mfma_f32_32x32x16_bf16 v[112:127],a[24:27],v[40:43],v[112:127]
s_add_u32 s63,s72,16384
buffer_load_dwordx4 v[80:83],v208,s[8:11],s63 offen sc1
v_mfma_f32_32x32x16_bf16 v[128:143],a[120:123],v[40:43],v[128:143]
s_waitcnt vmcnt(10)
v_mfma_f32_32x32x16_bf16 v[112:127],a[28:31],v[44:47],v[112:127]
buffer_load_dwordx4 v[84:87],v209,s[8:11],s63 offen sc1
v_mfma_f32_32x32x16_bf16 v[128:143],a[124:127],v[44:47],v[128:143]
s_waitcnt vmcnt(10)
v_mfma_f32_32x32x16_bf16 v[112:127],a[32:35],v[48:51],v[112:127]
buffer_load_dwordx4 v[88:91],v208,s[8:11],s63 offen offset:2048 sc1
v_mfma_f32_32x32x16_bf16 v[128:143],a[128:131],v[48:51],v[128:143]
s_waitcnt vmcnt(10)
v_mfma_f32_32x32x16_bf16 v[112:127],a[36:39],v[52:55],v[112:127]
buffer_load_dwordx4 v[92:95],v209,s[8:11],s63 offen offset:2048 sc1
v_mfma_f32_32x32x16_bf16 v[128:143],a[132:135],v[52:55],v[128:143]
s_waitcnt vmcnt(10)
v_mfma_f32_32x32x16_bf16 v[112:127],a[40:43],v[56:59],v[112:127]
s_add_u32 s63,s72,20480
buffer_load_dwordx4 v[96:99],v208,s[8:11],s63 offen sc1
v_mfma_f32_32x32x16_bf16 v[128:143],a[136:139],v[56:59],v[128:143]
s_waitcnt vmcnt(10)
v_mfma_f32_32x32x16_bf16 v[112:127],a[44:47],v[60:63],v[112:127]
buffer_load_dwordx4 v[100:103],v209,s[8:11],s63 offen sc1
v_mfma_f32_32x32x16_bf16 v[128:143],a[140:143],v[60:63],v[128:143]
s_waitcnt vmcnt(10)
v_mfma_f32_32x32x16_bf16 v[112:127],a[48:51],v[64:67],v[112:127]
buffer_load_dwordx4 v[104:107],v208,s[8:11],s63 offen offset:2048 sc1
v_mfma_f32_32x32x16_bf16 v[128:143],a[144:147],v[64:67],v[128:143]
s_waitcnt vmcnt(10)
v_cmp_eq_u32 vcc,0,v3
s_cmp_eq_u64 vcc,0
s_cselect_b32 s37,0,2147483648
s_cmp_lt_u32 s32,128
s_cselect_b32 s37,s37,2147483648
s_waitcnt vmcnt(9)
v_mfma_f32_32x32x16_bf16 v[112:127],a[52:55],v[68:71],v[112:127]
buffer_load_dwordx4 v[108:111],v209,s[8:11],s63 offen offset:2048 sc1
s_add_u32 s67,s73,s37
v_mfma_f32_32x32x16_bf16 v[128:143],a[148:151],v[68:71],v[128:143]
s_mov_b64 exec,1
buffer_store_dword v5,v1,s[8:11],s59 offen sc1
s_mov_b64 exec,-1
s_mov_b32 s59,2147483648
s_waitcnt vmcnt(10)
v_mfma_f32_32x32x16_bf16 v[112:127],a[56:59],v[72:75],v[112:127]
s_add_u32 s63,s67,0
buffer_load_dwordx4 v[16:19],v208,s[8:11],s63 offen sc1
v_mfma_f32_32x32x16_bf16 v[128:143],a[152:155],v[72:75],v[128:143]
s_waitcnt vmcnt(10)
v_mfma_f32_32x32x16_bf16 v[112:127],a[60:63],v[76:79],v[112:127]
buffer_load_dwordx4 v[20:23],v209,s[8:11],s63 offen sc1
v_mfma_f32_32x32x16_bf16 v[128:143],a[156:159],v[76:79],v[128:143]
s_waitcnt vmcnt(10)
v_mfma_f32_32x32x16_bf16 v[112:127],a[64:67],v[80:83],v[112:127]
buffer_load_dwordx4 v[24:27],v208,s[8:11],s63 offen offset:2048 sc1
v_mfma_f32_32x32x16_bf16 v[128:143],a[160:163],v[80:83],v[128:143]
s_waitcnt vmcnt(10)
v_mfma_f32_32x32x16_bf16 v[112:127],a[68:71],v[84:87],v[112:127]
buffer_load_dwordx4 v[28:31],v209,s[8:11],s63 offen offset:2048 sc1
v_mfma_f32_32x32x16_bf16 v[128:143],a[164:167],v[84:87],v[128:143]
s_waitcnt vmcnt(10)
v_mfma_f32_32x32x16_bf16 v[112:127],a[72:75],v[88:91],v[112:127]
s_add_u32 s63,s67,4096
buffer_load_dwordx4 v[32:35],v208,s[8:11],s63 offen sc1
buffer_load_dword v3,v2,s[8:11],s35 offen sc1
v_mfma_f32_32x32x16_bf16 v[128:143],a[168:171],v[88:91],v[128:143]
s_waitcnt vmcnt(11)
v_mfma_f32_32x32x16_bf16 v[112:127],a[76:79],v[92:95],v[112:127]
buffer_load_dwordx4 v[36:39],v209,s[8:11],s63 offen sc1
v_mfma_f32_32x32x16_bf16 v[128:143],a[172:175],v[92:95],v[128:143]
s_waitcnt vmcnt(11)
v_mfma_f32_32x32x16_bf16 v[112:127],a[80:83],v[96:99],v[112:127]
buffer_load_dwordx4 v[40:43],v208,s[8:11],s63 offen offset:2048 sc1
v_mfma_f32_32x32x16_bf16 v[128:143],a[176:179],v[96:99],v[128:143]
s_waitcnt vmcnt(11)
v_mfma_f32_32x32x16_bf16 v[112:127],a[84:87],v[100:103],v[112:127]
buffer_load_dwordx4 v[44:47],v209,s[8:11],s63 offen offset:2048 sc1
v_mfma_f32_32x32x16_bf16 v[128:143],a[180:183],v[100:103],v[128:143]
s_waitcnt vmcnt(11)
v_mfma_f32_32x32x16_bf16 v[112:127],a[88:91],v[104:107],v[112:127]
s_add_u32 s63,s67,8192
buffer_load_dwordx4 v[48:51],v208,s[8:11],s63 offen sc1
v_mfma_f32_32x32x16_bf16 v[128:143],a[184:187],v[104:107],v[128:143]
s_waitcnt vmcnt(11)
v_mfma_f32_32x32x16_bf16 v[112:127],a[92:95],v[108:111],v[112:127]
buffer_load_dwordx4 v[52:55],v209,s[8:11],s63 offen sc1
v_mfma_f32_32x32x16_bf16 v[128:143],a[188:191],v[108:111],v[128:143]
s_cmp_eq_u32 s37,0
s_cbranch_scc1 ep_283
s_waitcnt vmcnt(0)
v_cmp_eq_u32 vcc,0,v3
s_cmp_eq_u64 vcc,0
s_cselect_b32 s37,0,2147483648
s_cmp_lt_u32 s32,128
s_cselect_b32 s37,s37,2147483648
s_cmp_lg_u32 s37,0
s_cbranch_scc1 ep_283
s_add_u32 s63,s73,0
buffer_load_dwordx4 v[16:19],v208,s[8:11],s63 offen sc1
buffer_load_dwordx4 v[20:23],v209,s[8:11],s63 offen sc1
buffer_load_dwordx4 v[24:27],v208,s[8:11],s63 offen offset:2048 sc1
buffer_load_dwordx4 v[28:31],v209,s[8:11],s63 offen offset:2048 sc1
s_add_u32 s63,s73,4096
buffer_load_dwordx4 v[32:35],v208,s[8:11],s63 offen sc1
buffer_load_dwordx4 v[36:39],v209,s[8:11],s63 offen sc1
buffer_load_dwordx4 v[40:43],v208,s[8:11],s63 offen offset:2048 sc1
buffer_load_dwordx4 v[44:47],v209,s[8:11],s63 offen offset:2048 sc1
s_add_u32 s63,s73,8192
buffer_load_dwordx4 v[48:51],v208,s[8:11],s63 offen sc1
buffer_load_dwordx4 v[52:55],v209,s[8:11],s63 offen sc1
ep_283:
s_nop 7
ds_write_b128 v206,v[112:115] offset:0
ds_write_b128 v206,v[116:119] offset:1024
ds_write_b128 v206,v[120:123] offset:512
ds_write_b128 v206,v[124:127] offset:1536
s_nop 0
ds_write_b128 v206,v[128:131] offset:8192
ds_write_b128 v206,v[132:135] offset:9216
ds_write_b128 v206,v[136:139] offset:8704
ds_write_b128 v206,v[140:143] offset:9728
s_waitcnt lgkmcnt(0)
s_barrier
ds_read_b128 v[144:147],v207 offset:0
ds_read_b128 v[148:151],v207 offset:1024
ds_read_b128 v[152:155],v207 offset:2048
ds_read_b128 v[156:159],v207 offset:3072
ds_read_b128 v[160:163],v207 offset:4096
ds_read_b128 v[164:167],v207 offset:5120
ds_read_b128 v[168:171],v207 offset:6144
ds_read_b128 v[172:175],v207 offset:7168
s_waitcnt lgkmcnt(4)
v_pk_add_f32 v[144:145],v[144:145],v[152:153]
v_pk_add_f32 v[146:147],v[146:147],v[154:155]
v_pk_add_f32 v[148:149],v[148:149],v[156:157]
v_pk_add_f32 v[150:151],v[150:151],v[158:159]
s_waitcnt lgkmcnt(0)
v_pk_add_f32 v[160:161],v[160:161],v[168:169]
v_pk_add_f32 v[162:163],v[162:163],v[170:171]
v_pk_add_f32 v[164:165],v[164:165],v[172:173]
v_pk_add_f32 v[166:167],v[166:167],v[174:175]
v_pk_add_f32 v[144:145],v[144:145],v[160:161]
v_pk_add_f32 v[146:147],v[146:147],v[162:163]
v_pk_add_f32 v[148:149],v[148:149],v[164:165]
v_pk_add_f32 v[150:151],v[150:151],v[166:167]
buffer_store_dwordx4 v[144:147],v205,s[8:11],s64 offen sc1
buffer_store_dwordx4 v[148:151],v205,s[8:11],s64 offen offset:256 sc1
s_mov_b32 s59,s82
s_cmp_eq_u32 s37,0
s_cbranch_scc1 WO_NEXT
s_waitcnt vmcnt(0)
s_mov_b64 exec,1
buffer_store_dword v5,v1,s[8:11],s59 offen sc1
s_mov_b64 exec,-1
s_mov_b32 s59,2147483648
s_cmp_lt_u32 s32,128
s_cbranch_scc1 WO_COLD
s_endpgm
ROLE_R1:
s_lshr_b32 s80,s48,3
s_and_b32 s48,s48,7
v_lshlrev_b32 v1,4,v0
v_mov_b32 v5,1
s_lshl_b32 s56,s48,2
s_add_u32 s56,s56,s46
v_bfe_u32 v6,v0,2,2
v_lshrrev_b32 v7,4,v0
v_add_u32 v7,v6,v7
v_and_b32 v7,3,v7
v_and_b32 v15,3,v0
v_lshlrev_b32 v15,4,v15
v_lshl_add_u32 v15,v7,6,v15
v_lshl_add_u32 v15,v6,8,v15
v_lshrrev_b32 v6,4,v0
v_bfe_u32 v7,v0,2,2
v_and_b32 v8,3,v0
s_lshr_b32 s60,s48,2
s_lshl_b32 s70,s60,10
s_and_b32 s61,s48,3
s_lshl_b32 s60,s61,8
s_add_u32 s70,s70,s60
v_lshrrev_b32 v9,1,v6
v_lshlrev_b32 v18,11,v9
v_add_u32 v9,s61,v7
v_and_b32 v9,3,v9
v_lshl_add_u32 v18,v9,6,v18
v_lshl_add_u32 v18,v8,4,v18
v_add_u32 v18,s70,v18
v_and_b32 v9,1,v6
v_lshl_add_u32 v16,v9,3,v18
v_lshl_add_u32 v17,v9,14,v18
s_lshl_b32 s60,s48,2
v_add_u32 v9,s60,v8
v_mul_u32_u24 v19,1280,v9
v_lshl_add_u32 v19,v6,5,v19
v_lshl_add_u32 v19,v7,3,v19
v_lshlrev_b32 v21,5,v8
s_lshl_b32 s60,s46,3
v_add_u32 v20,s60,v21
v_min_u32 v2,39,v0
v_lshlrev_b32 v2,3,v2
s_lshr_b32 s60,s48,2
s_mul_i32 s60,s60,320
v_add_u32 v2,s60,v2
s_cmp_lt_u32 s46,2
s_cselect_b32 s68,0,2147483648
s_cselect_b32 s69,1.0,0
s_waitcnt vmcnt(0)
s_barrier
s_cmp_lg_u32 s46,0
s_cbranch_scc1 arr_284
v_mov_b32 v6,1
s_lshl_b32 s3,s49,2
v_mov_b32 v7,s3
s_mov_b64 exec,1
buffer_atomic_add v6,v7,s[12:15],0 offen sc1
s_mov_b64 exec,-1
arr_284:
s_lshl_b32 s3,s49,2
v_mov_b32 v7,s3
s_nop 1
ibw_285:
buffer_load_dword v6,v7,s[12:15],0 offen sc1
s_waitcnt vmcnt(0)
v_cmp_ne_u32 vcc,256,v6
s_nop 0
s_cbranch_vccz ok_286
s_sleep 8
s_sub_u32 s47,s47,1
s_cbranch_scc1 ABORT
s_branch ibw_285
ok_286:
s_cmp_lg_u32 s49,0
s_cbranch_scc1 ibok_287
v_and_b32 v7,7,v0
v_lshlrev_b32 v7,2,v7
buffer_load_dword v6,v7,s[12:15],0 offen offset:32 sc1
s_waitcnt vmcnt(0)
v_cmp_ne_u32 vcc,32,v6
s_nop 0
s_cbranch_vccz ibok_287
s_barrier
s_mov_b32 s49,1
s_mov_b32 s3,s2
s_load_dwordx16 s[16:31],s[0:1],0
s_load_dwordx8 s[32:39],s[0:1],64
s_waitcnt lgkmcnt(0)
s_branch DISPATCH
ibok_287:
R1_GO:
s_mov_b32 s83,s100
s_mov_b32 s50,64
s_mov_b32 s55,1
s_mov_b32 s59,1600000
v_mov_b32 v238,1024
v_mov_b32 v239,0
ds_write_b32 v238,v239
s_waitcnt lgkmcnt(0)
s_barrier
s_mov_b32 s82,-1
v_mov_b32 v40,0
v_mov_b32 v41,0
v_mov_b32 v42,0
v_mov_b32 v43,0
v_mov_b32 v52,0
v_mov_b32 v53,0
v_mov_b32 v54,0
v_mov_b32 v55,0
v_mov_b32 v64,0
v_mov_b32 v65,0
v_mov_b32 v66,0
v_mov_b32 v67,0
v_mov_b32 v76,0
v_mov_b32 v77,0
v_mov_b32 v78,0
v_mov_b32 v79,0
v_mov_b32 v108,0
v_mov_b32 v109,0
v_mov_b32 v120,0
v_mov_b32 v121,0
v_mov_b32 v122,0
v_mov_b32 v123,0
v_mov_b32 v132,0
v_mov_b32 v133,0
v_mov_b32 v134,0
v_mov_b32 v135,0
v_mov_b32 v144,0
v_mov_b32 v145,0
v_mov_b32 v146,0
v_mov_b32 v147,0
v_mov_b32 v156,0
v_mov_b32 v157,0
v_mov_b32 v158,0
v_mov_b32 v159,0
v_mov_b32 v188,0
v_mov_b32 v189,0
s_mov_b32 s51,s80
s_sub_u32 s52,s50,64
s_lshl_b32 s67,s51,6
s_add_u32 s67,s67,s52
s_mul_i32 s67,s67,640
s_add_u32 s67,s67,819200
fb_288:
buffer_load_dwordx2 v[236:237],v2,s[8:11],s67 offen sc1
s_waitcnt vmcnt(0)
v_min_u32 v236,v236,v237
v_cmp_eq_u32 vcc,0,v236
s_nop 0
s_cbranch_vccz ok_289
s_sleep 20
s_sub_u32 s47,s47,1
s_cbranch_scc1 ABORT
s_branch fb_288
ok_289:
s_mul_i32 s66,s52,491520
s_mul_i32 s60,s48,10240
s_add_u32 s66,s66,s60
s_lshl_b32 s60,s46,10
s_add_u32 s66,s66,s60
s_add_u32 s66,s66,175112192
s_mul_i32 s60,s52,40960
s_add_u32 s60,s60,234749952
s_mul_i32 s61,s52,46080
s_add_u32 s61,s61,209518592
s_cmp_eq_u32 s51,0
s_cselect_b32 s65,s60,s61
s_lshl_b32 s60,s46,12
s_add_u32 s65,s65,s60
s_cmp_lt_u32 s46,2
s_cbranch_scc1 g2_290
v_mov_b32 v40,0
v_mov_b32 v41,0
v_mov_b32 v42,0
v_mov_b32 v43,0
s_nop 0
s_branch g3_291
g2_290:
s_add_u32 s63,s65,32768
buffer_load_dwordx2 v[108:109],v16,s[8:11],s63 offen sc1
s_add_u32 s63,s66,8192
buffer_load_dwordx4 v[40:43],v1,s[8:11],s63 offen sc1
s_add_u32 s63,s66,90112
buffer_load_dwordx4 v[52:55],v1,s[8:11],s63 offen sc1
s_add_u32 s63,s66,172032
buffer_load_dwordx4 v[64:67],v1,s[8:11],s63 offen sc1
s_add_u32 s63,s66,253952
buffer_load_dwordx4 v[76:79],v1,s[8:11],s63 offen sc1
g3_291:
s_add_u32 s63,s65,0
buffer_load_dwordx2 v[104:105],v16,s[8:11],s63 offen sc1
s_add_u32 s63,s65,16384
buffer_load_dwordx2 v[106:107],v16,s[8:11],s63 offen sc1
s_add_u32 s63,s66,0
buffer_load_dwordx4 v[32:35],v1,s[8:11],s63 offen sc1
s_add_u32 s63,s66,4096
buffer_load_dwordx4 v[36:39],v1,s[8:11],s63 offen sc1
s_add_u32 s63,s66,81920
buffer_load_dwordx4 v[44:47],v1,s[8:11],s63 offen sc1
s_add_u32 s63,s66,86016
buffer_load_dwordx4 v[48:51],v1,s[8:11],s63 offen sc1
s_add_u32 s63,s66,163840
buffer_load_dwordx4 v[56:59],v1,s[8:11],s63 offen sc1
s_add_u32 s63,s66,167936
buffer_load_dwordx4 v[60:63],v1,s[8:11],s63 offen sc1
s_add_u32 s63,s66,245760
buffer_load_dwordx4 v[68:71],v1,s[8:11],s63 offen sc1
s_add_u32 s63,s66,249856
buffer_load_dwordx4 v[72:75],v1,s[8:11],s63 offen sc1
R1_A:
s_add_u32 s66,s50,1
s_min_u32 s66,s66,127
s_mov_b32 s53,s80
s_sub_u32 s54,s66,64
s_lshl_b32 s67,s53,6
s_add_u32 s67,s67,s54
s_mul_i32 s67,s67,640
s_add_u32 s67,s67,819200
s_lshl_b32 s60,s51,6
s_add_u32 s60,s60,s52
s_mul_i32 s71,s60,40960
s_mul_i32 s73,s60,5120
s_lshl_b32 s60,s46,12
s_add_u32 s71,s71,s60
s_add_u32 s72,s71,32768
s_add_u32 s72,s72,s68
s_cmp_eq_u32 s55,0
s_cbranch_scc1 r1p_292
s_waitcnt vmcnt(8)
v_lshlrev_b32 v192,16,v104
v_and_b32 v193,0xffff0000,v104
v_lshlrev_b32 v194,16,v105
v_and_b32 v195,0xffff0000,v105
v_lshlrev_b32 v196,16,v106
v_and_b32 v197,0xffff0000,v106
v_lshlrev_b32 v198,16,v107
v_and_b32 v199,0xffff0000,v107
v_lshlrev_b32 v200,16,v108
v_and_b32 v201,0xffff0000,v108
v_lshlrev_b32 v202,16,v109
v_and_b32 v203,0xffff0000,v109
s_waitcnt vmcnt(4)
v_pk_add_f32 v[32:33],v[32:33],v[44:45]
v_pk_add_f32 v[34:35],v[34:35],v[46:47]
v_pk_add_f32 v[36:37],v[36:37],v[48:49]
v_pk_add_f32 v[38:39],v[38:39],v[50:51]
v_pk_add_f32 v[40:41],v[40:41],v[52:53]
v_pk_add_f32 v[42:43],v[42:43],v[54:55]
s_waitcnt vmcnt(2)
v_pk_add_f32 v[32:33],v[32:33],v[56:57]
v_pk_add_f32 v[34:35],v[34:35],v[58:59]
v_pk_add_f32 v[36:37],v[36:37],v[60:61]
v_pk_add_f32 v[38:39],v[38:39],v[62:63]
v_pk_add_f32 v[40:41],v[40:41],v[64:65]
v_pk_add_f32 v[42:43],v[42:43],v[66:67]
s_waitcnt vmcnt(0)
v_pk_add_f32 v[32:33],v[32:33],v[68:69]
v_pk_add_f32 v[34:35],v[34:35],v[70:71]
v_pk_add_f32 v[36:37],v[36:37],v[72:73]
v_pk_add_f32 v[38:39],v[38:39],v[74:75]
v_pk_add_f32 v[40:41],v[40:41],v[76:77]
v_pk_add_f32 v[42:43],v[42:43],v[78:79]
s_nop 0
s_branch r1j_293
r1p_292:
s_waitcnt vmcnt(9)
v_lshlrev_b32 v192,16,v104
v_and_b32 v193,0xffff0000,v104
v_lshlrev_b32 v194,16,v105
v_and_b32 v195,0xffff0000,v105
v_lshlrev_b32 v196,16,v106
v_and_b32 v197,0xffff0000,v106
v_lshlrev_b32 v198,16,v107
v_and_b32 v199,0xffff0000,v107
v_lshlrev_b32 v200,16,v108
v_and_b32 v201,0xffff0000,v108
v_lshlrev_b32 v202,16,v109
v_and_b32 v203,0xffff0000,v109
s_waitcnt vmcnt(5)
v_pk_add_f32 v[32:33],v[32:33],v[44:45]
v_pk_add_f32 v[34:35],v[34:35],v[46:47]
v_pk_add_f32 v[36:37],v[36:37],v[48:49]
v_pk_add_f32 v[38:39],v[38:39],v[50:51]
v_pk_add_f32 v[40:41],v[40:41],v[52:53]
v_pk_add_f32 v[42:43],v[42:43],v[54:55]
s_waitcnt vmcnt(3)
v_pk_add_f32 v[32:33],v[32:33],v[56:57]
v_pk_add_f32 v[34:35],v[34:35],v[58:59]
v_pk_add_f32 v[36:37],v[36:37],v[60:61]
v_pk_add_f32 v[38:39],v[38:39],v[62:63]
v_pk_add_f32 v[40:41],v[40:41],v[64:65]
v_pk_add_f32 v[42:43],v[42:43],v[66:67]
s_waitcnt vmcnt(1)
v_pk_add_f32 v[32:33],v[32:33],v[68:69]
v_pk_add_f32 v[34:35],v[34:35],v[70:71]
v_pk_add_f32 v[36:37],v[36:37],v[72:73]
v_pk_add_f32 v[38:39],v[38:39],v[74:75]
v_pk_add_f32 v[40:41],v[40:41],v[76:77]
v_pk_add_f32 v[42:43],v[42:43],v[78:79]
s_nop 1
r1j_293:
v_cvt_pk_bf16_f32 v6,v32,v33
v_lshlrev_b32 v32,16,v6
v_and_b32 v33,0xffff0000,v6
v_cvt_pk_bf16_f32 v6,v34,v35
v_lshlrev_b32 v34,16,v6
v_and_b32 v35,0xffff0000,v6
v_cvt_pk_bf16_f32 v6,v36,v37
v_lshlrev_b32 v36,16,v6
v_and_b32 v37,0xffff0000,v6
v_cvt_pk_bf16_f32 v6,v38,v39
v_lshlrev_b32 v38,16,v6
v_and_b32 v39,0xffff0000,v6
v_cvt_pk_bf16_f32 v6,v40,v41
v_lshlrev_b32 v40,16,v6
v_and_b32 v41,0xffff0000,v6
v_cvt_pk_bf16_f32 v6,v42,v43
v_lshlrev_b32 v42,16,v6
v_and_b32 v43,0xffff0000,v6
v_pk_add_f32 v[32:33],v[32:33],v[192:193]
v_pk_add_f32 v[34:35],v[34:35],v[194:195]
v_pk_add_f32 v[36:37],v[36:37],v[196:197]
v_pk_add_f32 v[38:39],v[38:39],v[198:199]
v_pk_add_f32 v[40:41],v[40:41],v[200:201]
v_pk_add_f32 v[42:43],v[42:43],v[202:203]
v_cvt_pk_bf16_f32 v204,v32,v33
v_lshlrev_b32 v32,16,v204
v_and_b32 v33,0xffff0000,v204
v_cvt_pk_bf16_f32 v205,v34,v35
v_lshlrev_b32 v34,16,v205
v_and_b32 v35,0xffff0000,v205
v_cvt_pk_bf16_f32 v206,v36,v37
v_lshlrev_b32 v36,16,v206
v_and_b32 v37,0xffff0000,v206
v_cvt_pk_bf16_f32 v207,v38,v39
v_lshlrev_b32 v38,16,v207
v_and_b32 v39,0xffff0000,v207
v_cvt_pk_bf16_f32 v208,v40,v41
v_lshlrev_b32 v40,16,v208
v_and_b32 v41,0xffff0000,v208
v_cvt_pk_bf16_f32 v209,v42,v43
v_lshlrev_b32 v42,16,v209
v_and_b32 v43,0xffff0000,v209
v_pk_add_f32 v[28:29],v[32:33],v[34:35]
v_pk_mul_f32 v[26:27],v[32:33],v[32:33]
v_pk_fma_f32 v[26:27],v[34:35],v[34:35],v[26:27]
v_pk_add_f32 v[28:29],v[28:29],v[36:37]
v_pk_fma_f32 v[26:27],v[36:37],v[36:37],v[26:27]
v_pk_add_f32 v[28:29],v[28:29],v[38:39]
v_pk_fma_f32 v[26:27],v[38:39],v[38:39],v[26:27]
v_pk_add_f32 v[28:29],v[28:29],v[40:41]
v_pk_fma_f32 v[26:27],v[40:41],v[40:41],v[26:27]
v_pk_add_f32 v[28:29],v[28:29],v[42:43]
v_pk_fma_f32 v[26:27],v[42:43],v[42:43],v[26:27]
v_add_f32 v24,v28,v29
v_add_f32 v25,v26,v27
s_nop 0
v_add_f32_dpp v24,v24,v24 row_ror:4 row_mask:0xf bank_mask:0xf
v_add_f32_dpp v25,v25,v25 row_ror:4 row_mask:0xf bank_mask:0xf
s_nop 0
v_add_f32_dpp v24,v24,v24 row_ror:8 row_mask:0xf bank_mask:0xf
v_add_f32_dpp v25,v25,v25 row_ror:8 row_mask:0xf bank_mask:0xf
v_mov_b32 v26,v24
v_mov_b32 v27,v25
s_nop 0
v_permlane32_swap_b32 v24,v26
v_permlane32_swap_b32 v25,v27
v_add_f32 v24,v24,v26
v_add_f32 v25,v25,v27
v_mov_b32 v26,v24
v_mov_b32 v27,v25
s_nop 0
v_permlane16_swap_b32 v24,v26
v_permlane16_swap_b32 v25,v27
v_add_f32 v24,v24,v26
v_add_f32 v25,v25,v27
ds_write_b64 v20,v[24:25] offset:0
s_waitcnt lgkmcnt(0)
s_barrier
ds_read_b128 v[228:231],v21 offset:0
ds_read_b128 v[232:235],v21 offset:16
buffer_load_dwordx2 v[236:237],v2,s[8:11],s67 offen sc1
v_mov_b32 v210,v208
v_mov_b32 v211,v209
s_add_u32 s63,s71,218365952
v_permlane16_swap_b32 v204,v206
v_permlane16_swap_b32 v205,v207
buffer_store_dwordx4 v[204:207],v17,s[8:11],s63 offen sc1
s_add_u32 s63,s72,218365952
v_permlane16_swap_b32 v208,v210
v_permlane16_swap_b32 v209,v211
buffer_store_dwordx4 v[208:211],v18,s[8:11],s63 offen sc1
s_waitcnt lgkmcnt(0)
v_pk_add_f32 v[228:229],v[228:229],v[230:231]
v_pk_add_f32 v[232:233],v[232:233],v[234:235]
v_pk_add_f32 v[24:25],v[228:229],v[232:233]
v_mul_f32 v24,0x3acccccd,v24
v_mul_f32 v25,0x3acccccd,v25
v_fma_f32 v25,-v24,v24,v25
v_max_f32 v25,0,v25
v_mov_b32 v28,v24
v_mov_b32 v29,v25
v_cvt_pk_bf16_f32 v6,v24,v25
v_lshlrev_b32 v24,16,v6
v_and_b32 v25,0xffff0000,v6
v_add_f32 v25,0x3727c5ac,v25
v_cvt_pk_bf16_f32 v6,v25,v25
v_lshlrev_b32 v25,16,v6
v_sqrt_f32 v25,v25
s_nop 0
v_cvt_pk_bf16_f32 v6,v25,v25
v_lshlrev_b32 v25,16,v6
v_rcp_f32 v25,v25
s_nop 0
v_pk_add_f32 v[32:33],v[32:33],v[24:25] op_sel_hi:[1,0] neg_lo:[0,1] neg_hi:[0,1]
v_pk_add_f32 v[34:35],v[34:35],v[24:25] op_sel_hi:[1,0] neg_lo:[0,1] neg_hi:[0,1]
v_pk_add_f32 v[36:37],v[36:37],v[24:25] op_sel_hi:[1,0] neg_lo:[0,1] neg_hi:[0,1]
v_pk_add_f32 v[38:39],v[38:39],v[24:25] op_sel_hi:[1,0] neg_lo:[0,1] neg_hi:[0,1]
v_pk_add_f32 v[40:41],v[40:41],v[24:25] op_sel_hi:[1,0] neg_lo:[0,1] neg_hi:[0,1]
v_pk_add_f32 v[42:43],v[42:43],v[24:25] op_sel_hi:[1,0] neg_lo:[0,1] neg_hi:[0,1]
v_cvt_pk_bf16_f32 v6,v32,v33
v_lshlrev_b32 v32,16,v6
v_and_b32 v33,0xffff0000,v6
v_cvt_pk_bf16_f32 v8,v34,v35
v_lshlrev_b32 v34,16,v8
v_and_b32 v35,0xffff0000,v8
v_cvt_pk_bf16_f32 v6,v36,v37
v_lshlrev_b32 v36,16,v6
v_and_b32 v37,0xffff0000,v6
v_cvt_pk_bf16_f32 v8,v38,v39
v_lshlrev_b32 v38,16,v8
v_and_b32 v39,0xffff0000,v8
v_cvt_pk_bf16_f32 v6,v40,v41
v_lshlrev_b32 v40,16,v6
v_and_b32 v41,0xffff0000,v6
v_cvt_pk_bf16_f32 v8,v42,v43
v_lshlrev_b32 v42,16,v8
v_and_b32 v43,0xffff0000,v8
v_pk_mul_f32 v[32:33],v[32:33],v[24:25] op_sel:[0,1] op_sel_hi:[1,1]
v_pk_mul_f32 v[34:35],v[34:35],v[24:25] op_sel:[0,1] op_sel_hi:[1,1]
v_pk_mul_f32 v[36:37],v[36:37],v[24:25] op_sel:[0,1] op_sel_hi:[1,1]
v_pk_mul_f32 v[38:39],v[38:39],v[24:25] op_sel:[0,1] op_sel_hi:[1,1]
v_pk_mul_f32 v[40:41],v[40:41],v[24:25] op_sel:[0,1] op_sel_hi:[1,1]
v_pk_mul_f32 v[42:43],v[42:43],v[24:25] op_sel:[0,1] op_sel_hi:[1,1]
v_cvt_pk_bf16_f32 v212,v32,v33
v_lshlrev_b32 v32,16,v212
v_and_b32 v33,0xffff0000,v212
v_cvt_pk_bf16_f32 v213,v34,v35
v_lshlrev_b32 v34,16,v213
v_and_b32 v35,0xffff0000,v213
v_cvt_pk_bf16_f32 v214,v36,v37
v_lshlrev_b32 v36,16,v214
v_and_b32 v37,0xffff0000,v214
v_cvt_pk_bf16_f32 v215,v38,v39
v_lshlrev_b32 v38,16,v215
v_and_b32 v39,0xffff0000,v215
v_cvt_pk_bf16_f32 v216,v40,v41
v_lshlrev_b32 v40,16,v216
v_and_b32 v41,0xffff0000,v216
v_cvt_pk_bf16_f32 v217,v42,v43
v_lshlrev_b32 v42,16,v217
v_and_b32 v43,0xffff0000,v217
v_mov_b32 v218,v216
v_mov_b32 v219,v217
s_add_u32 s63,s71,223608832
s_add_u32 s63,s63,s73
v_permlane16_swap_b32 v212,v214
v_permlane16_swap_b32 v213,v215
buffer_store_dwordx4 v[212:215],v17,s[8:11],s63 offen sc1
s_add_u32 s63,s72,223608832
s_add_u32 s63,s63,s73
v_permlane16_swap_b32 v216,v218
v_permlane16_swap_b32 v217,v219
buffer_store_dwordx4 v[216:219],v18,s[8:11],s63 offen sc1
v_sub_f32 v28,v28,v24
v_mul_f32 v29,v29,v25
v_mul_f32 v28,v28,v25
v_mul_f32 v29,v29,v25
v_cvt_pk_bf16_f32 v6,v28,v29
v_lshlrev_b32 v28,16,v6
v_and_b32 v29,0xffff0000,v6
v_add_f32 v29,0x3727c5ac,v29
v_cvt_pk_bf16_f32 v6,v29,v29
v_lshlrev_b32 v29,16,v6
v_sqrt_f32 v29,v29
s_nop 0
v_cvt_pk_bf16_f32 v6,v29,v29
v_lshlrev_b32 v29,16,v6
v_rcp_f32 v29,v29
s_lshl_b32 s60,s46,12
s_sub_u32 s63,s71,s60
s_add_u32 s63,s63,s73
s_lshl_b32 s60,s48,5
s_add_u32 s63,s63,s60
s_add_u32 s63,s63,223649792
v_lshlrev_b32 v6,3,v0
s_cmp_lg_u32 s46,3
s_cbranch_scc1 zs_294
s_mov_b64 exec,15
buffer_store_dwordx2 v[28:29],v6,s[8:11],s63 offen sc1
s_mov_b64 exec,-1
zs_294:
s_lshl_b32 s82,s51,6
s_add_u32 s82,s82,s52
s_lshl_b32 s82,s82,9
s_add_u32 s82,s82,393216
s_lshl_b32 s61,s56,2
s_add_u32 s82,s82,s61
s_add_u32 s50,s50,1
s_cmp_eq_u32 s50,128
s_cbranch_scc1 R1_END
s_mov_b32 s51,s53
s_mov_b32 s52,s54
s_waitcnt vmcnt(4)
v_min_u32 v236,v236,v237
v_cmp_eq_u32 vcc,0,v236
s_nop 0
s_cbranch_vccnz nr_295
s_add_u32 s60,s50,0
v_mov_b32 v239,s60
ds_write_b32 v238,v239
s_mul_i32 s66,s52,491520
s_mul_i32 s60,s48,10240
s_add_u32 s66,s66,s60
s_lshl_b32 s60,s46,10
s_add_u32 s66,s66,s60
s_add_u32 s66,s66,175112192
s_mul_i32 s60,s52,40960
s_add_u32 s60,s60,234749952
s_mul_i32 s61,s52,46080
s_add_u32 s61,s61,209518592
s_cmp_eq_u32 s51,0
s_cselect_b32 s65,s60,s61
s_lshl_b32 s60,s46,12
s_add_u32 s65,s65,s60
s_cmp_lt_u32 s46,2
s_cbranch_scc1 g2_296
v_mov_b32 v120,0
v_mov_b32 v121,0
v_mov_b32 v122,0
v_mov_b32 v123,0
s_nop 0
s_branch g3_297
g2_296:
s_add_u32 s63,s65,32768
buffer_load_dwordx2 v[188:189],v16,s[8:11],s63 offen sc1
s_add_u32 s63,s66,8192
buffer_load_dwordx4 v[120:123],v1,s[8:11],s63 offen sc1
s_add_u32 s63,s66,90112
buffer_load_dwordx4 v[132:135],v1,s[8:11],s63 offen sc1
s_add_u32 s63,s66,172032
buffer_load_dwordx4 v[144:147],v1,s[8:11],s63 offen sc1
s_add_u32 s63,s66,253952
buffer_load_dwordx4 v[156:159],v1,s[8:11],s63 offen sc1
g3_297:
s_add_u32 s63,s65,0
buffer_load_dwordx2 v[184:185],v16,s[8:11],s63 offen sc1
s_add_u32 s63,s65,16384
buffer_load_dwordx2 v[186:187],v16,s[8:11],s63 offen sc1
s_add_u32 s63,s66,0
buffer_load_dwordx4 v[112:115],v1,s[8:11],s63 offen sc1
s_add_u32 s63,s66,4096
buffer_load_dwordx4 v[116:119],v1,s[8:11],s63 offen sc1
s_add_u32 s63,s66,81920
buffer_load_dwordx4 v[124:127],v1,s[8:11],s63 offen sc1
s_add_u32 s63,s66,86016
buffer_load_dwordx4 v[128:131],v1,s[8:11],s63 offen sc1
s_add_u32 s63,s66,163840
buffer_load_dwordx4 v[136:139],v1,s[8:11],s63 offen sc1
s_add_u32 s63,s66,167936
buffer_load_dwordx4 v[140:143],v1,s[8:11],s63 offen sc1
s_add_u32 s63,s66,245760
buffer_load_dwordx4 v[148:151],v1,s[8:11],s63 offen sc1
s_add_u32 s63,s66,249856
buffer_load_dwordx4 v[152:155],v1,s[8:11],s63 offen sc1
s_waitcnt vmcnt(10)
s_mov_b64 exec,1
buffer_store_dword v5,v1,s[8:11],s82 offen sc1
s_mov_b64 exec,-1
s_mov_b32 s55,0
s_branch R1_B
nr_295:
s_mov_b32 s55,1
s_waitcnt vmcnt(0)
s_mov_b64 exec,1
buffer_store_dword v5,v1,s[8:11],s82 offen sc1
s_mov_b64 exec,-1
s_mov_b32 s82,-1
s_lshl_b32 s67,s51,6
s_add_u32 s67,s67,s52
s_mul_i32 s67,s67,640
s_add_u32 s67,s67,819200
s_cmp_lg_u32 s46,0
s_cbranch_scc1 wo_298
fb_300:
buffer_load_dwordx2 v[236:237],v2,s[8:11],s67 offen sc1
s_waitcnt vmcnt(0)
v_min_u32 v236,v236,v237
v_cmp_eq_u32 vcc,0,v236
s_nop 0
s_cbranch_vccz ok_301
s_sleep 7
s_sub_u32 s47,s47,1
s_cbranch_scc1 ABORT
s_branch fb_300
ok_301:
s_add_u32 s60,s50,0
v_mov_b32 v239,s60
ds_write_b32 v238,v239
s_branch wd_299
wo_298:
ds_read_b32 v239,v238
s_waitcnt lgkmcnt(0)
v_cmp_gt_u32 vcc,s50,v239
s_nop 0
s_cbranch_vccz wd_299
s_sleep 1
s_sub_u32 s59,s59,1
s_cbranch_scc1 ABORT
s_branch wo_298
wd_299:
s_mul_i32 s66,s52,491520
s_mul_i32 s60,s48,10240
s_add_u32 s66,s66,s60
s_lshl_b32 s60,s46,10
s_add_u32 s66,s66,s60
s_add_u32 s66,s66,175112192
s_mul_i32 s60,s52,40960
s_add_u32 s60,s60,234749952
s_mul_i32 s61,s52,46080
s_add_u32 s61,s61,209518592
s_cmp_eq_u32 s51,0
s_cselect_b32 s65,s60,s61
s_lshl_b32 s60,s46,12
s_add_u32 s65,s65,s60
s_cmp_lt_u32 s46,2
s_cbranch_scc1 g2_302
v_mov_b32 v120,0
v_mov_b32 v121,0
v_mov_b32 v122,0
v_mov_b32 v123,0
s_nop 0
s_branch g3_303
g2_302:
s_add_u32 s63,s65,32768
buffer_load_dwordx2 v[188:189],v16,s[8:11],s63 offen sc1
s_add_u32 s63,s66,8192
buffer_load_dwordx4 v[120:123],v1,s[8:11],s63 offen sc1
s_add_u32 s63,s66,90112
buffer_load_dwordx4 v[132:135],v1,s[8:11],s63 offen sc1
s_add_u32 s63,s66,172032
buffer_load_dwordx4 v[144:147],v1,s[8:11],s63 offen sc1
s_add_u32 s63,s66,253952
buffer_load_dwordx4 v[156:159],v1,s[8:11],s63 offen sc1
g3_303:
s_add_u32 s63,s65,0
buffer_load_dwordx2 v[184:185],v16,s[8:11],s63 offen sc1
s_add_u32 s63,s65,16384
buffer_load_dwordx2 v[186:187],v16,s[8:11],s63 offen sc1
s_add_u32 s63,s66,0
buffer_load_dwordx4 v[112:115],v1,s[8:11],s63 offen sc1
s_add_u32 s63,s66,4096
buffer_load_dwordx4 v[116:119],v1,s[8:11],s63 offen sc1
s_add_u32 s63,s66,81920
buffer_load_dwordx4 v[124:127],v1,s[8:11],s63 offen sc1
s_add_u32 s63,s66,86016
buffer_load_dwordx4 v[128:131],v1,s[8:11],s63 offen sc1
s_add_u32 s63,s66,163840
buffer_load_dwordx4 v[136:139],v1,s[8:11],s63 offen sc1
s_add_u32 s63,s66,167936
buffer_load_dwordx4 v[140:143],v1,s[8:11],s63 offen sc1
s_add_u32 s63,s66,245760
buffer_load_dwordx4 v[148:151],v1,s[8:11],s63 offen sc1
s_add_u32 s63,s66,249856
buffer_load_dwordx4 v[152:155],v1,s[8:11],s63 offen sc1
s_branch R1_B
R1_B:
s_add_u32 s66,s50,1
s_min_u32 s66,s66,127
s_mov_b32 s53,s80
s_sub_u32 s54,s66,64
s_lshl_b32 s67,s53,6
s_add_u32 s67,s67,s54
s_mul_i32 s67,s67,640
s_add_u32 s67,s67,819200
s_lshl_b32 s60,s51,6
s_add_u32 s60,s60,s52
s_mul_i32 s71,s60,40960
s_mul_i32 s73,s60,5120
s_lshl_b32 s60,s46,12
s_add_u32 s71,s71,s60
s_add_u32 s72,s71,32768
s_add_u32 s72,s72,s68
s_cmp_eq_u32 s55,0
s_cbranch_scc1 r1p_304
s_waitcnt vmcnt(8)
v_lshlrev_b32 v192,16,v184
v_and_b32 v193,0xffff0000,v184
v_lshlrev_b32 v194,16,v185
v_and_b32 v195,0xffff0000,v185
v_lshlrev_b32 v196,16,v186
v_and_b32 v197,0xffff0000,v186
v_lshlrev_b32 v198,16,v187
v_and_b32 v199,0xffff0000,v187
v_lshlrev_b32 v200,16,v188
v_and_b32 v201,0xffff0000,v188
v_lshlrev_b32 v202,16,v189
v_and_b32 v203,0xffff0000,v189
s_waitcnt vmcnt(4)
v_pk_add_f32 v[112:113],v[112:113],v[124:125]
v_pk_add_f32 v[114:115],v[114:115],v[126:127]
v_pk_add_f32 v[116:117],v[116:117],v[128:129]
v_pk_add_f32 v[118:119],v[118:119],v[130:131]
v_pk_add_f32 v[120:121],v[120:121],v[132:133]
v_pk_add_f32 v[122:123],v[122:123],v[134:135]
s_waitcnt vmcnt(2)
v_pk_add_f32 v[112:113],v[112:113],v[136:137]
v_pk_add_f32 v[114:115],v[114:115],v[138:139]
v_pk_add_f32 v[116:117],v[116:117],v[140:141]
v_pk_add_f32 v[118:119],v[118:119],v[142:143]
v_pk_add_f32 v[120:121],v[120:121],v[144:145]
v_pk_add_f32 v[122:123],v[122:123],v[146:147]
s_waitcnt vmcnt(0)
v_pk_add_f32 v[112:113],v[112:113],v[148:149]
v_pk_add_f32 v[114:115],v[114:115],v[150:151]
v_pk_add_f32 v[116:117],v[116:117],v[152:153]
v_pk_add_f32 v[118:119],v[118:119],v[154:155]
v_pk_add_f32 v[120:121],v[120:121],v[156:157]
v_pk_add_f32 v[122:123],v[122:123],v[158:159]
s_nop 0
s_branch r1j_305
r1p_304:
s_waitcnt vmcnt(9)
v_lshlrev_b32 v192,16,v184
v_and_b32 v193,0xffff0000,v184
v_lshlrev_b32 v194,16,v185
v_and_b32 v195,0xffff0000,v185
v_lshlrev_b32 v196,16,v186
v_and_b32 v197,0xffff0000,v186
v_lshlrev_b32 v198,16,v187
v_and_b32 v199,0xffff0000,v187
v_lshlrev_b32 v200,16,v188
v_and_b32 v201,0xffff0000,v188
v_lshlrev_b32 v202,16,v189
v_and_b32 v203,0xffff0000,v189
s_waitcnt vmcnt(5)
v_pk_add_f32 v[112:113],v[112:113],v[124:125]
v_pk_add_f32 v[114:115],v[114:115],v[126:127]
v_pk_add_f32 v[116:117],v[116:117],v[128:129]
v_pk_add_f32 v[118:119],v[118:119],v[130:131]
v_pk_add_f32 v[120:121],v[120:121],v[132:133]
v_pk_add_f32 v[122:123],v[122:123],v[134:135]
s_waitcnt vmcnt(3)
v_pk_add_f32 v[112:113],v[112:113],v[136:137]
v_pk_add_f32 v[114:115],v[114:115],v[138:139]
v_pk_add_f32 v[116:117],v[116:117],v[140:141]
v_pk_add_f32 v[118:119],v[118:119],v[142:143]
v_pk_add_f32 v[120:121],v[120:121],v[144:145]
v_pk_add_f32 v[122:123],v[122:123],v[146:147]
s_waitcnt vmcnt(1)
v_pk_add_f32 v[112:113],v[112:113],v[148:149]
v_pk_add_f32 v[114:115],v[114:115],v[150:151]
v_pk_add_f32 v[116:117],v[116:117],v[152:153]
v_pk_add_f32 v[118:119],v[118:119],v[154:155]
v_pk_add_f32 v[120:121],v[120:121],v[156:157]
v_pk_add_f32 v[122:123],v[122:123],v[158:159]
s_nop 1
r1j_305:
v_cvt_pk_bf16_f32 v6,v112,v113
v_lshlrev_b32 v112,16,v6
v_and_b32 v113,0xffff0000,v6
v_cvt_pk_bf16_f32 v6,v114,v115
v_lshlrev_b32 v114,16,v6
v_and_b32 v115,0xffff0000,v6
v_cvt_pk_bf16_f32 v6,v116,v117
v_lshlrev_b32 v116,16,v6
v_and_b32 v117,0xffff0000,v6
v_cvt_pk_bf16_f32 v6,v118,v119
v_lshlrev_b32 v118,16,v6
v_and_b32 v119,0xffff0000,v6
v_cvt_pk_bf16_f32 v6,v120,v121
v_lshlrev_b32 v120,16,v6
v_and_b32 v121,0xffff0000,v6
v_cvt_pk_bf16_f32 v6,v122,v123
v_lshlrev_b32 v122,16,v6
v_and_b32 v123,0xffff0000,v6
v_pk_add_f32 v[112:113],v[112:113],v[192:193]
v_pk_add_f32 v[114:115],v[114:115],v[194:195]
v_pk_add_f32 v[116:117],v[116:117],v[196:197]
v_pk_add_f32 v[118:119],v[118:119],v[198:199]
v_pk_add_f32 v[120:121],v[120:121],v[200:201]
v_pk_add_f32 v[122:123],v[122:123],v[202:203]
v_cvt_pk_bf16_f32 v204,v112,v113
v_lshlrev_b32 v112,16,v204
v_and_b32 v113,0xffff0000,v204
v_cvt_pk_bf16_f32 v205,v114,v115
v_lshlrev_b32 v114,16,v205
v_and_b32 v115,0xffff0000,v205
v_cvt_pk_bf16_f32 v206,v116,v117
v_lshlrev_b32 v116,16,v206
v_and_b32 v117,0xffff0000,v206
v_cvt_pk_bf16_f32 v207,v118,v119
v_lshlrev_b32 v118,16,v207
v_and_b32 v119,0xffff0000,v207
v_cvt_pk_bf16_f32 v208,v120,v121
v_lshlrev_b32 v120,16,v208
v_and_b32 v121,0xffff0000,v208
v_cvt_pk_bf16_f32 v209,v122,v123
v_lshlrev_b32 v122,16,v209
v_and_b32 v123,0xffff0000,v209
v_pk_add_f32 v[28:29],v[112:113],v[114:115]
v_pk_mul_f32 v[26:27],v[112:113],v[112:113]
v_pk_fma_f32 v[26:27],v[114:115],v[114:115],v[26:27]
v_pk_add_f32 v[28:29],v[28:29],v[116:117]
v_pk_fma_f32 v[26:27],v[116:117],v[116:117],v[26:27]
v_pk_add_f32 v[28:29],v[28:29],v[118:119]
v_pk_fma_f32 v[26:27],v[118:119],v[118:119],v[26:27]
v_pk_add_f32 v[28:29],v[28:29],v[120:121]
v_pk_fma_f32 v[26:27],v[120:121],v[120:121],v[26:27]
v_pk_add_f32 v[28:29],v[28:29],v[122:123]
v_pk_fma_f32 v[26:27],v[122:123],v[122:123],v[26:27]
v_add_f32 v24,v28,v29
v_add_f32 v25,v26,v27
s_nop 0
v_add_f32_dpp v24,v24,v24 row_ror:4 row_mask:0xf bank_mask:0xf
v_add_f32_dpp v25,v25,v25 row_ror:4 row_mask:0xf bank_mask:0xf
s_nop 0
v_add_f32_dpp v24,v24,v24 row_ror:8 row_mask:0xf bank_mask:0xf
v_add_f32_dpp v25,v25,v25 row_ror:8 row_mask:0xf bank_mask:0xf
v_mov_b32 v26,v24
v_mov_b32 v27,v25
s_nop 0
v_permlane32_swap_b32 v24,v26
v_permlane32_swap_b32 v25,v27
v_add_f32 v24,v24,v26
v_add_f32 v25,v25,v27
v_mov_b32 v26,v24
v_mov_b32 v27,v25
s_nop 0
v_permlane16_swap_b32 v24,v26
v_permlane16_swap_b32 v25,v27
v_add_f32 v24,v24,v26
v_add_f32 v25,v25,v27
ds_write_b64 v20,v[24:25] offset:128
s_waitcnt lgkmcnt(0)
s_barrier
ds_read_b128 v[228:231],v21 offset:128
ds_read_b128 v[232:235],v21 offset:144
buffer_load_dwordx2 v[236:237],v2,s[8:11],s67 offen sc1
v_mov_b32 v210,v208
v_mov_b32 v211,v209
s_add_u32 s63,s71,218365952
v_permlane16_swap_b32 v204,v206
v_permlane16_swap_b32 v205,v207
buffer_store_dwordx4 v[204:207],v17,s[8:11],s63 offen sc1
s_add_u32 s63,s72,218365952
v_permlane16_swap_b32 v208,v210
v_permlane16_swap_b32 v209,v211
buffer_store_dwordx4 v[208:211],v18,s[8:11],s63 offen sc1
s_waitcnt lgkmcnt(0)
v_pk_add_f32 v[228:229],v[228:229],v[230:231]
v_pk_add_f32 v[232:233],v[232:233],v[234:235]
v_pk_add_f32 v[24:25],v[228:229],v[232:233]
v_mul_f32 v24,0x3acccccd,v24
v_mul_f32 v25,0x3acccccd,v25
v_fma_f32 v25,-v24,v24,v25
v_max_f32 v25,0,v25
v_mov_b32 v28,v24
v_mov_b32 v29,v25
v_cvt_pk_bf16_f32 v6,v24,v25
v_lshlrev_b32 v24,16,v6
v_and_b32 v25,0xffff0000,v6
v_add_f32 v25,0x3727c5ac,v25
v_cvt_pk_bf16_f32 v6,v25,v25
v_lshlrev_b32 v25,16,v6
v_sqrt_f32 v25,v25
s_nop 0
v_cvt_pk_bf16_f32 v6,v25,v25
v_lshlrev_b32 v25,16,v6
v_rcp_f32 v25,v25
s_nop 0
v_pk_add_f32 v[112:113],v[112:113],v[24:25] op_sel_hi:[1,0] neg_lo:[0,1] neg_hi:[0,1]
v_pk_add_f32 v[114:115],v[114:115],v[24:25] op_sel_hi:[1,0] neg_lo:[0,1] neg_hi:[0,1]
v_pk_add_f32 v[116:117],v[116:117],v[24:25] op_sel_hi:[1,0] neg_lo:[0,1] neg_hi:[0,1]
v_pk_add_f32 v[118:119],v[118:119],v[24:25] op_sel_hi:[1,0] neg_lo:[0,1] neg_hi:[0,1]
v_pk_add_f32 v[120:121],v[120:121],v[24:25] op_sel_hi:[1,0] neg_lo:[0,1] neg_hi:[0,1]
v_pk_add_f32 v[122:123],v[122:123],v[24:25] op_sel_hi:[1,0] neg_lo:[0,1] neg_hi:[0,1]
v_cvt_pk_bf16_f32 v6,v112,v113
v_lshlrev_b32 v112,16,v6
v_and_b32 v113,0xffff0000,v6
v_cvt_pk_bf16_f32 v8,v114,v115
v_lshlrev_b32 v114,16,v8
v_and_b32 v115,0xffff0000,v8
v_cvt_pk_bf16_f32 v6,v116,v117
v_lshlrev_b32 v116,16,v6
v_and_b32 v117,0xffff0000,v6
v_cvt_pk_bf16_f32 v8,v118,v119
v_lshlrev_b32 v118,16,v8
v_and_b32 v119,0xffff0000,v8
v_cvt_pk_bf16_f32 v6,v120,v121
v_lshlrev_b32 v120,16,v6
v_and_b32 v121,0xffff0000,v6
v_cvt_pk_bf16_f32 v8,v122,v123
v_lshlrev_b32 v122,16,v8
v_and_b32 v123,0xffff0000,v8
v_pk_mul_f32 v[112:113],v[112:113],v[24:25] op_sel:[0,1] op_sel_hi:[1,1]
v_pk_mul_f32 v[114:115],v[114:115],v[24:25] op_sel:[0,1] op_sel_hi:[1,1]
v_pk_mul_f32 v[116:117],v[116:117],v[24:25] op_sel:[0,1] op_sel_hi:[1,1]
v_pk_mul_f32 v[118:119],v[118:119],v[24:25] op_sel:[0,1] op_sel_hi:[1,1]
v_pk_mul_f32 v[120:121],v[120:121],v[24:25] op_sel:[0,1] op_sel_hi:[1,1]
v_pk_mul_f32 v[122:123],v[122:123],v[24:25] op_sel:[0,1] op_sel_hi:[1,1]
v_cvt_pk_bf16_f32 v212,v112,v113
v_lshlrev_b32 v112,16,v212
v_and_b32 v113,0xffff0000,v212
v_cvt_pk_bf16_f32 v213,v114,v115
v_lshlrev_b32 v114,16,v213
v_and_b32 v115,0xffff0000,v213
v_cvt_pk_bf16_f32 v214,v116,v117
v_lshlrev_b32 v116,16,v214
v_and_b32 v117,0xffff0000,v214
v_cvt_pk_bf16_f32 v215,v118,v119
v_lshlrev_b32 v118,16,v215
v_and_b32 v119,0xffff0000,v215
v_cvt_pk_bf16_f32 v216,v120,v121
v_lshlrev_b32 v120,16,v216
v_and_b32 v121,0xffff0000,v216
v_cvt_pk_bf16_f32 v217,v122,v123
v_lshlrev_b32 v122,16,v217
v_and_b32 v123,0xffff0000,v217
v_mov_b32 v218,v216
v_mov_b32 v219,v217
s_add_u32 s63,s71,223608832
s_add_u32 s63,s63,s73
v_permlane16_swap_b32 v212,v214
v_permlane16_swap_b32 v213,v215
buffer_store_dwordx4 v[212:215],v17,s[8:11],s63 offen sc1
s_add_u32 s63,s72,223608832
s_add_u32 s63,s63,s73
v_permlane16_swap_b32 v216,v218
v_permlane16_swap_b32 v217,v219
buffer_store_dwordx4 v[216:219],v18,s[8:11],s63 offen sc1
v_sub_f32 v28,v28,v24
v_mul_f32 v29,v29,v25
v_mul_f32 v28,v28,v25
v_mul_f32 v29,v29,v25
v_cvt_pk_bf16_f32 v6,v28,v29
v_lshlrev_b32 v28,16,v6
v_and_b32 v29,0xffff0000,v6
v_add_f32 v29,0x3727c5ac,v29
v_cvt_pk_bf16_f32 v6,v29,v29
v_lshlrev_b32 v29,16,v6
v_sqrt_f32 v29,v29
s_nop 0
v_cvt_pk_bf16_f32 v6,v29,v29
v_lshlrev_b32 v29,16,v6
v_rcp_f32 v29,v29
s_lshl_b32 s60,s46,12
s_sub_u32 s63,s71,s60
s_add_u32 s63,s63,s73
s_lshl_b32 s60,s48,5
s_add_u32 s63,s63,s60
s_add_u32 s63,s63,223649792
v_lshlrev_b32 v6,3,v0
s_cmp_lg_u32 s46,3
s_cbranch_scc1 zs_306
s_mov_b64 exec,15
buffer_store_dwordx2 v[28:29],v6,s[8:11],s63 offen sc1
s_mov_b64 exec,-1
zs_306:
s_lshl_b32 s82,s51,6
s_add_u32 s82,s82,s52
s_lshl_b32 s82,s82,9
s_add_u32 s82,s82,393216
s_lshl_b32 s61,s56,2
s_add_u32 s82,s82,s61
s_add_u32 s50,s50,1
s_cmp_eq_u32 s50,128
s_cbranch_scc1 R1_END
s_mov_b32 s51,s53
s_mov_b32 s52,s54
s_waitcnt vmcnt(4)
v_min_u32 v236,v236,v237
v_cmp_eq_u32 vcc,0,v236
s_nop 0
s_cbranch_vccnz nr_307
s_add_u32 s60,s50,0
v_mov_b32 v239,s60
ds_write_b32 v238,v239
s_mul_i32 s66,s52,491520
s_mul_i32 s60,s48,10240
s_add_u32 s66,s66,s60
s_lshl_b32 s60,s46,10
s_add_u32 s66,s66,s60
s_add_u32 s66,s66,175112192
s_mul_i32 s60,s52,40960
s_add_u32 s60,s60,234749952
s_mul_i32 s61,s52,46080
s_add_u32 s61,s61,209518592
s_cmp_eq_u32 s51,0
s_cselect_b32 s65,s60,s61
s_lshl_b32 s60,s46,12
s_add_u32 s65,s65,s60
s_cmp_lt_u32 s46,2
s_cbranch_scc1 g2_308
v_mov_b32 v40,0
v_mov_b32 v41,0
v_mov_b32 v42,0
v_mov_b32 v43,0
s_nop 0
s_branch g3_309
g2_308:
s_add_u32 s63,s65,32768
buffer_load_dwordx2 v[108:109],v16,s[8:11],s63 offen sc1
s_add_u32 s63,s66,8192
buffer_load_dwordx4 v[40:43],v1,s[8:11],s63 offen sc1
s_add_u32 s63,s66,90112
buffer_load_dwordx4 v[52:55],v1,s[8:11],s63 offen sc1
s_add_u32 s63,s66,172032
buffer_load_dwordx4 v[64:67],v1,s[8:11],s63 offen sc1
s_add_u32 s63,s66,253952
buffer_load_dwordx4 v[76:79],v1,s[8:11],s63 offen sc1
g3_309:
s_add_u32 s63,s65,0
buffer_load_dwordx2 v[104:105],v16,s[8:11],s63 offen sc1
s_add_u32 s63,s65,16384
buffer_load_dwordx2 v[106:107],v16,s[8:11],s63 offen sc1
s_add_u32 s63,s66,0
buffer_load_dwordx4 v[32:35],v1,s[8:11],s63 offen sc1
s_add_u32 s63,s66,4096
buffer_load_dwordx4 v[36:39],v1,s[8:11],s63 offen sc1
s_add_u32 s63,s66,81920
buffer_load_dwordx4 v[44:47],v1,s[8:11],s63 offen sc1
s_add_u32 s63,s66,86016
buffer_load_dwordx4 v[48:51],v1,s[8:11],s63 offen sc1
s_add_u32 s63,s66,163840
buffer_load_dwordx4 v[56:59],v1,s[8:11],s63 offen sc1
s_add_u32 s63,s66,167936
buffer_load_dwordx4 v[60:63],v1,s[8:11],s63 offen sc1
s_add_u32 s63,s66,245760
buffer_load_dwordx4 v[68:71],v1,s[8:11],s63 offen sc1
s_add_u32 s63,s66,249856
buffer_load_dwordx4 v[72:75],v1,s[8:11],s63 offen sc1
s_waitcnt vmcnt(10)
s_mov_b64 exec,1
buffer_store_dword v5,v1,s[8:11],s82 offen sc1
s_mov_b64 exec,-1
s_mov_b32 s55,0
s_branch R1_A
nr_307:
s_mov_b32 s55,1
s_waitcnt vmcnt(0)
s_mov_b64 exec,1
buffer_store_dword v5,v1,s[8:11],s82 offen sc1
s_mov_b64 exec,-1
s_mov_b32 s82,-1
s_lshl_b32 s67,s51,6
s_add_u32 s67,s67,s52
s_mul_i32 s67,s67,640
s_add_u32 s67,s67,819200
s_cmp_lg_u32 s46,0
s_cbranch_scc1 wo_310
fb_312:
buffer_load_dwordx2 v[236:237],v2,s[8:11],s67 offen sc1
s_waitcnt vmcnt(0)
v_min_u32 v236,v236,v237
v_cmp_eq_u32 vcc,0,v236
s_nop 0
s_cbranch_vccz ok_313
s_sleep 7
s_sub_u32 s47,s47,1
s_cbranch_scc1 ABORT
s_branch fb_312
ok_313:
s_add_u32 s60,s50,0
v_mov_b32 v239,s60
ds_write_b32 v238,v239
s_branch wd_311
wo_310:
ds_read_b32 v239,v238
s_waitcnt lgkmcnt(0)
v_cmp_gt_u32 vcc,s50,v239
s_nop 0
s_cbranch_vccz wd_311
s_sleep 1
s_sub_u32 s59,s59,1
s_cbranch_scc1 ABORT
s_branch wo_310
wd_311:
s_mul_i32 s66,s52,491520
s_mul_i32 s60,s48,10240
s_add_u32 s66,s66,s60
s_lshl_b32 s60,s46,10
s_add_u32 s66,s66,s60
s_add_u32 s66,s66,175112192
s_mul_i32 s60,s52,40960
s_add_u32 s60,s60,234749952
s_mul_i32 s61,s52,46080
s_add_u32 s61,s61,209518592
s_cmp_eq_u32 s51,0
s_cselect_b32 s65,s60,s61
s_lshl_b32 s60,s46,12
s_add_u32 s65,s65,s60
s_cmp_lt_u32 s46,2
s_cbranch_scc1 g2_314
v_mov_b32 v40,0
v_mov_b32 v41,0
v_mov_b32 v42,0
v_mov_b32 v43,0
s_nop 0
s_branch g3_315
g2_314:
s_add_u32 s63,s65,32768
buffer_load_dwordx2 v[108:109],v16,s[8:11],s63 offen sc1
s_add_u32 s63,s66,8192
buffer_load_dwordx4 v[40:43],v1,s[8:11],s63 offen sc1
s_add_u32 s63,s66,90112
buffer_load_dwordx4 v[52:55],v1,s[8:11],s63 offen sc1
s_add_u32 s63,s66,172032
buffer_load_dwordx4 v[64:67],v1,s[8:11],s63 offen sc1
s_add_u32 s63,s66,253952
buffer_load_dwordx4 v[76:79],v1,s[8:11],s63 offen sc1
g3_315:
s_add_u32 s63,s65,0
buffer_load_dwordx2 v[104:105],v16,s[8:11],s63 offen sc1
s_add_u32 s63,s65,16384
buffer_load_dwordx2 v[106:107],v16,s[8:11],s63 offen sc1
s_add_u32 s63,s66,0
buffer_load_dwordx4 v[32:35],v1,s[8:11],s63 offen sc1
s_add_u32 s63,s66,4096
buffer_load_dwordx4 v[36:39],v1,s[8:11],s63 offen sc1
s_add_u32 s63,s66,81920
buffer_load_dwordx4 v[44:47],v1,s[8:11],s63 offen sc1
s_add_u32 s63,s66,86016
buffer_load_dwordx4 v[48:51],v1,s[8:11],s63 offen sc1
s_add_u32 s63,s66,163840
buffer_load_dwordx4 v[56:59],v1,s[8:11],s63 offen sc1
s_add_u32 s63,s66,167936
buffer_load_dwordx4 v[60:63],v1,s[8:11],s63 offen sc1
s_add_u32 s63,s66,245760
buffer_load_dwordx4 v[68:71],v1,s[8:11],s63 offen sc1
s_add_u32 s63,s66,249856
buffer_load_dwordx4 v[72:75],v1,s[8:11],s63 offen sc1
s_branch R1_A
R1_END:
s_waitcnt vmcnt(0)
s_mov_b64 exec,1
buffer_store_dword v5,v1,s[8:11],s82 offen sc1
s_mov_b64 exec,-1
s_endpgm
ROLE_W1:
v_lshlrev_b32 v1,4,v0
v_mov_b32 v5,1
s_lshl_b32 s56,s48,2
s_add_u32 s56,s56,s46
v_bfe_u32 v6,v0,2,2
v_lshrrev_b32 v7,4,v0
v_add_u32 v7,v6,v7
v_and_b32 v7,3,v7
v_and_b32 v15,3,v0
v_lshlrev_b32 v15,4,v15
v_lshl_add_u32 v15,v7,6,v15
v_lshl_add_u32 v15,v6,8,v15
v_lshrrev_b32 v6,5,v0
v_bfe_u32 v7,v0,4,1
v_lshlrev_b32 v16,10,v7
v_bfe_u32 v7,v0,2,2
v_lshl_add_u32 v16,v7,8,v16
v_add_u32 v6,v6,v7
v_and_b32 v6,3,v6
v_lshl_add_u32 v16,v6,6,v16
v_and_b32 v6,3,v0
v_lshl_add_u32 v16,v6,4,v16
v_add_u32 v18,46080,v16
v_lshrrev_b32 v6,5,v0
v_bfe_u32 v7,v0,4,1
v_lshlrev_b32 v20,10,v7
v_lshl_add_u32 v20,v6,8,v20
v_and_b32 v6,15,v0
v_lshl_add_u32 v20,v6,4,v20
v_lshrrev_b32 v6,5,v0
v_add_u32 v6,2,v6
v_bfe_u32 v7,v0,4,1
v_lshlrev_b32 v17,10,v7
v_bfe_u32 v7,v0,2,2
v_lshl_add_u32 v17,v7,8,v17
v_add_u32 v6,v6,v7
v_and_b32 v6,3,v6
v_lshl_add_u32 v17,v6,6,v17
v_and_b32 v6,3,v0
v_lshl_add_u32 v17,v6,4,v17
v_add_u32 v19,46080,v17
v_lshrrev_b32 v6,5,v0
v_add_u32 v6,2,v6
v_bfe_u32 v7,v0,4,1
v_lshlrev_b32 v21,10,v7
v_lshl_add_u32 v21,v6,8,v21
v_and_b32 v6,15,v0
v_lshl_add_u32 v21,v6,4,v21
v_min_u32 v2,31,v0
v_lshlrev_b32 v2,2,v2
v_mov_b32 v112,0xc0135761
v_mov_b32 v113,0xbdd2d3e8
s_mov_b32 s68,0xbdd2d3e8
v_mov_b32 v116,0
v_mov_b32 v117,0
v_mov_b32 v118,0
v_mov_b32 v119,0
s_lshl_b32 s60,s56,11
s_add_u32 s61,s60,237371392
buffer_store_dwordx4 v[116:119],v1,s[8:11],s61 offen sc1
buffer_store_dwordx4 v[116:119],v1,s[8:11],s61 offen offset:1024 sc1
s_add_u32 s61,s60,240033792
buffer_store_dwordx4 v[116:119],v1,s[8:11],s61 offen sc1
buffer_store_dwordx4 v[116:119],v1,s[8:11],s61 offen offset:1024 sc1
s_add_u32 s61,s60,240074752
buffer_store_dwordx4 v[116:119],v1,s[8:11],s61 offen sc1
buffer_store_dwordx4 v[116:119],v1,s[8:11],s61 offen offset:1024 sc1
s_add_u32 s61,s60,242737152
buffer_store_dwordx4 v[116:119],v1,s[8:11],s61 offen sc1
buffer_store_dwordx4 v[116:119],v1,s[8:11],s61 offen offset:1024 sc1
s_waitcnt vmcnt(0)
s_barrier
s_cmp_lg_u32 s46,0
s_cbranch_scc1 arr_316
v_mov_b32 v6,1
s_lshl_b32 s3,s49,2
v_mov_b32 v7,s3
s_mov_b64 exec,1
buffer_atomic_add v6,v7,s[12:15],0 offen sc1
s_mov_b64 exec,-1
arr_316:
s_lshl_b32 s58,s56,6
s_mul_i32 s63,s46,40960
s_mov_b32 s4,s32
s_mov_b32 s5,s33
s_mov_b32 s6,819200
s_mov_b32 s7,0x20000
v_lshrrev_b32 v9,2,v0
s_mov_b32 s64,1280
v_mul_lo_u32 v9,v9,s64
v_and_b32 v10,3,v0
v_lshl_add_u32 v6,v10,4,v9
s_add_u32 m0,s63,0
s_add_u32 s65,s58,0
buffer_load_dwordx4 v6,s[4:7],s65 offen lds
s_add_u32 m0,s63,1024
s_add_u32 s65,s58,20480
buffer_load_dwordx4 v6,s[4:7],s65 offen lds
s_add_u32 m0,s63,2048
s_add_u32 s65,s58,40960
buffer_load_dwordx4 v6,s[4:7],s65 offen lds
s_add_u32 m0,s63,3072
s_add_u32 s65,s58,61440
buffer_load_dwordx4 v6,s[4:7],s65 offen lds
s_add_u32 m0,s63,4096
s_add_u32 s65,s58,81920
buffer_load_dwordx4 v6,s[4:7],s65 offen lds
s_add_u32 m0,s63,5120
s_add_u32 s65,s58,102400
buffer_load_dwordx4 v6,s[4:7],s65 offen lds
s_add_u32 m0,s63,6144
s_add_u32 s65,s58,122880
buffer_load_dwordx4 v6,s[4:7],s65 offen lds
s_add_u32 m0,s63,7168
s_add_u32 s65,s58,143360
buffer_load_dwordx4 v6,s[4:7],s65 offen lds
s_add_u32 m0,s63,8192
s_add_u32 s65,s58,163840
buffer_load_dwordx4 v6,s[4:7],s65 offen lds
s_add_u32 m0,s63,9216
s_add_u32 s65,s58,184320
buffer_load_dwordx4 v6,s[4:7],s65 offen lds
s_add_u32 m0,s63,10240
s_add_u32 s65,s58,204800
buffer_load_dwordx4 v6,s[4:7],s65 offen lds
s_add_u32 m0,s63,11264
s_add_u32 s65,s58,225280
buffer_load_dwordx4 v6,s[4:7],s65 offen lds
s_add_u32 m0,s63,12288
s_add_u32 s65,s58,245760
buffer_load_dwordx4 v6,s[4:7],s65 offen lds
s_add_u32 m0,s63,13312
s_add_u32 s65,s58,266240
buffer_load_dwordx4 v6,s[4:7],s65 offen lds
s_add_u32 m0,s63,14336
s_add_u32 s65,s58,286720
buffer_load_dwordx4 v6,s[4:7],s65 offen lds
s_add_u32 m0,s63,15360
s_add_u32 s65,s58,307200
buffer_load_dwordx4 v6,s[4:7],s65 offen lds
s_add_u32 m0,s63,16384
s_add_u32 s65,s58,327680
buffer_load_dwordx4 v6,s[4:7],s65 offen lds
s_add_u32 m0,s63,17408
s_add_u32 s65,s58,348160
buffer_load_dwordx4 v6,s[4:7],s65 offen lds
s_add_u32 m0,s63,18432
s_add_u32 s65,s58,368640
buffer_load_dwordx4 v6,s[4:7],s65 offen lds
s_add_u32 m0,s63,19456
s_add_u32 s65,s58,389120
buffer_load_dwordx4 v6,s[4:7],s65 offen lds
s_add_u32 m0,s63,20480
s_add_u32 s65,s58,409600
buffer_load_dwordx4 v6,s[4:7],s65 offen lds
s_add_u32 m0,s63,21504
s_add_u32 s65,s58,430080
buffer_load_dwordx4 v6,s[4:7],s65 offen lds
s_add_u32 m0,s63,22528
s_add_u32 s65,s58,450560
buffer_load_dwordx4 v6,s[4:7],s65 offen lds
s_add_u32 m0,s63,23552
s_add_u32 s65,s58,471040
buffer_load_dwordx4 v6,s[4:7],s65 offen lds
s_add_u32 m0,s63,24576
s_add_u32 s65,s58,491520
buffer_load_dwordx4 v6,s[4:7],s65 offen lds
s_add_u32 m0,s63,25600
s_add_u32 s65,s58,512000
buffer_load_dwordx4 v6,s[4:7],s65 offen lds
s_add_u32 m0,s63,26624
s_add_u32 s65,s58,532480
buffer_load_dwordx4 v6,s[4:7],s65 offen lds
s_add_u32 m0,s63,27648
s_add_u32 s65,s58,552960
buffer_load_dwordx4 v6,s[4:7],s65 offen lds
s_add_u32 m0,s63,28672
s_add_u32 s65,s58,573440
buffer_load_dwordx4 v6,s[4:7],s65 offen lds
s_add_u32 m0,s63,29696
s_add_u32 s65,s58,593920
buffer_load_dwordx4 v6,s[4:7],s65 offen lds
s_add_u32 m0,s63,30720
s_add_u32 s65,s58,614400
buffer_load_dwordx4 v6,s[4:7],s65 offen lds
s_add_u32 m0,s63,31744
s_add_u32 s65,s58,634880
buffer_load_dwordx4 v6,s[4:7],s65 offen lds
s_add_u32 m0,s63,32768
s_add_u32 s65,s58,655360
buffer_load_dwordx4 v6,s[4:7],s65 offen lds
s_add_u32 m0,s63,33792
s_add_u32 s65,s58,675840
buffer_load_dwordx4 v6,s[4:7],s65 offen lds
s_add_u32 m0,s63,34816
s_add_u32 s65,s58,696320
buffer_load_dwordx4 v6,s[4:7],s65 offen lds
s_add_u32 m0,s63,35840
s_add_u32 s65,s58,716800
buffer_load_dwordx4 v6,s[4:7],s65 offen lds
s_add_u32 m0,s63,36864
s_add_u32 s65,s58,737280
buffer_load_dwordx4 v6,s[4:7],s65 offen lds
s_add_u32 m0,s63,37888
s_add_u32 s65,s58,757760
buffer_load_dwordx4 v6,s[4:7],s65 offen lds
s_add_u32 m0,s63,38912
s_add_u32 s65,s58,778240
buffer_load_dwordx4 v6,s[4:7],s65 offen lds
s_add_u32 m0,s63,39936
s_add_u32 s65,s58,798720
buffer_load_dwordx4 v6,s[4:7],s65 offen lds
s_waitcnt vmcnt(20)
v_bfe_u32 v9,v0,2,2
v_lshrrev_b32 v10,5,v0
v_lshl_add_u32 v9,v10,2,v9
v_mul_u32_u24 v9,64,v9
v_and_b32 v10,1,v0
v_lshl_add_u32 v9,v10,3,v9
v_bfe_u32 v10,v0,1,1
v_lshl_add_u32 v9,v10,5,v9
v_bfe_u32 v10,v0,4,1
v_lshl_add_u32 v9,v10,4,v9
v_add_u32 v7,s63,v9
ds_read_b64_tr_b16 a[0:1],v7 offset:0
ds_read_b64_tr_b16 a[2:3],v7 offset:1024
ds_read_b64_tr_b16 a[4:5],v7 offset:512
ds_read_b64_tr_b16 a[6:7],v7 offset:1536
ds_read_b64_tr_b16 a[8:9],v7 offset:2048
ds_read_b64_tr_b16 a[10:11],v7 offset:3072
ds_read_b64_tr_b16 a[12:13],v7 offset:2560
ds_read_b64_tr_b16 a[14:15],v7 offset:3584
ds_read_b64_tr_b16 a[16:17],v7 offset:4096
ds_read_b64_tr_b16 a[18:19],v7 offset:5120
ds_read_b64_tr_b16 a[20:21],v7 offset:4608
ds_read_b64_tr_b16 a[22:23],v7 offset:5632
s_waitcnt lgkmcnt(4)
ds_read_b64_tr_b16 a[24:25],v7 offset:6144
ds_read_b64_tr_b16 a[26:27],v7 offset:7168
ds_read_b64_tr_b16 a[28:29],v7 offset:6656
ds_read_b64_tr_b16 a[30:31],v7 offset:7680
ds_read_b64_tr_b16 a[32:33],v7 offset:8192
ds_read_b64_tr_b16 a[34:35],v7 offset:9216
ds_read_b64_tr_b16 a[36:37],v7 offset:8704
ds_read_b64_tr_b16 a[38:39],v7 offset:9728
ds_read_b64_tr_b16 a[40:41],v7 offset:10240
ds_read_b64_tr_b16 a[42:43],v7 offset:11264
ds_read_b64_tr_b16 a[44:45],v7 offset:10752
ds_read_b64_tr_b16 a[46:47],v7 offset:11776
s_waitcnt lgkmcnt(4)
ds_read_b64_tr_b16 a[48:49],v7 offset:12288
ds_read_b64_tr_b16 a[50:51],v7 offset:13312
ds_read_b64_tr_b16 a[52:53],v7 offset:12800
ds_read_b64_tr_b16 a[54:55],v7 offset:13824
ds_read_b64_tr_b16 a[56:57],v7 offset:14336
ds_read_b64_tr_b16 a[58:59],v7 offset:15360
ds_read_b64_tr_b16 a[60:61],v7 offset:14848
ds_read_b64_tr_b16 a[62:63],v7 offset:15872
ds_read_b64_tr_b16 a[64:65],v7 offset:16384
ds_read_b64_tr_b16 a[66:67],v7 offset:17408
ds_read_b64_tr_b16 a[68:69],v7 offset:16896
ds_read_b64_tr_b16 a[70:71],v7 offset:17920
s_waitcnt lgkmcnt(4)
ds_read_b64_tr_b16 a[72:73],v7 offset:18432
ds_read_b64_tr_b16 a[74:75],v7 offset:19456
ds_read_b64_tr_b16 a[76:77],v7 offset:18944
ds_read_b64_tr_b16 a[78:79],v7 offset:19968
s_waitcnt lgkmcnt(0)
s_waitcnt vmcnt(0)
v_bfe_u32 v9,v0,2,2
v_lshrrev_b32 v10,5,v0
v_lshl_add_u32 v9,v10,2,v9
v_mul_u32_u24 v9,64,v9
v_and_b32 v10,1,v0
v_lshl_add_u32 v9,v10,3,v9
v_bfe_u32 v10,v0,1,1
v_lshl_add_u32 v9,v10,5,v9
v_bfe_u32 v10,v0,4,1
v_lshl_add_u32 v9,v10,4,v9
v_add_u32 v7,s63,v9
ds_read_b64_tr_b16 a[80:81],v7 offset:20480
ds_read_b64_tr_b16 a[82:83],v7 offset:21504
ds_read_b64_tr_b16 a[84:85],v7 offset:20992
ds_read_b64_tr_b16 a[86:87],v7 offset:22016
ds_read_b64_tr_b16 a[88:89],v7 offset:22528
ds_read_b64_tr_b16 a[90:91],v7 offset:23552
ds_read_b64_tr_b16 a[92:93],v7 offset:23040
ds_read_b64_tr_b16 a[94:95],v7 offset:24064
ds_read_b64_tr_b16 a[96:97],v7 offset:24576
ds_read_b64_tr_b16 a[98:99],v7 offset:25600
ds_read_b64_tr_b16 a[100:101],v7 offset:25088
ds_read_b64_tr_b16 a[102:103],v7 offset:26112
s_waitcnt lgkmcnt(4)
ds_read_b64_tr_b16 a[104:105],v7 offset:26624
ds_read_b64_tr_b16 a[106:107],v7 offset:27648
ds_read_b64_tr_b16 a[108:109],v7 offset:27136
ds_read_b64_tr_b16 a[110:111],v7 offset:28160
ds_read_b64_tr_b16 a[112:113],v7 offset:28672
ds_read_b64_tr_b16 a[114:115],v7 offset:29696
ds_read_b64_tr_b16 a[116:117],v7 offset:29184
ds_read_b64_tr_b16 a[118:119],v7 offset:30208
ds_read_b64_tr_b16 a[120:121],v7 offset:30720
ds_read_b64_tr_b16 a[122:123],v7 offset:31744
ds_read_b64_tr_b16 a[124:125],v7 offset:31232
ds_read_b64_tr_b16 a[126:127],v7 offset:32256
s_waitcnt lgkmcnt(4)
ds_read_b64_tr_b16 a[128:129],v7 offset:32768
ds_read_b64_tr_b16 a[130:131],v7 offset:33792
ds_read_b64_tr_b16 a[132:133],v7 offset:33280
ds_read_b64_tr_b16 a[134:135],v7 offset:34304
ds_read_b64_tr_b16 a[136:137],v7 offset:34816
ds_read_b64_tr_b16 a[138:139],v7 offset:35840
ds_read_b64_tr_b16 a[140:141],v7 offset:35328
ds_read_b64_tr_b16 a[142:143],v7 offset:36352
ds_read_b64_tr_b16 a[144:145],v7 offset:36864
ds_read_b64_tr_b16 a[146:147],v7 offset:37888
ds_read_b64_tr_b16 a[148:149],v7 offset:37376
ds_read_b64_tr_b16 a[150:151],v7 offset:38400
s_waitcnt lgkmcnt(4)
ds_read_b64_tr_b16 a[152:153],v7 offset:38912
ds_read_b64_tr_b16 a[154:155],v7 offset:39936
ds_read_b64_tr_b16 a[156:157],v7 offset:39424
ds_read_b64_tr_b16 a[158:159],v7 offset:40448
s_waitcnt lgkmcnt(0)
v_mov_b32 v24,0x3f803f80
v_mov_b32 v25,0x3f803f80
v_mov_b32 v26,0x3f803f80
v_mov_b32 v27,0x3f803f80
s_nop 1
v_mfma_f32_32x32x16_bf16 v[144:159],a[0:3],v[24:27],0
v_mfma_f32_32x32x16_bf16 v[144:159],a[4:7],v[24:27],v[144:159]
v_mfma_f32_32x32x16_bf16 v[144:159],a[8:11],v[24:27],v[144:159]
v_mfma_f32_32x32x16_bf16 v[144:159],a[12:15],v[24:27],v[144:159]
v_mfma_f32_32x32x16_bf16 v[144:159],a[16:19],v[24:27],v[144:159]
v_mfma_f32_32x32x16_bf16 v[144:159],a[20:23],v[24:27],v[144:159]
v_mfma_f32_32x32x16_bf16 v[144:159],a[24:27],v[24:27],v[144:159]
v_mfma_f32_32x32x16_bf16 v[144:159],a[28:31],v[24:27],v[144:159]
v_mfma_f32_32x32x16_bf16 v[144:159],a[32:35],v[24:27],v[144:159]
v_mfma_f32_32x32x16_bf16 v[144:159],a[36:39],v[24:27],v[144:159]
v_mfma_f32_32x32x16_bf16 v[144:159],a[40:43],v[24:27],v[144:159]
v_mfma_f32_32x32x16_bf16 v[144:159],a[44:47],v[24:27],v[144:159]
v_mfma_f32_32x32x16_bf16 v[144:159],a[48:51],v[24:27],v[144:159]
v_mfma_f32_32x32x16_bf16 v[144:159],a[52:55],v[24:27],v[144:159]
v_mfma_f32_32x32x16_bf16 v[144:159],a[56:59],v[24:27],v[144:159]
v_mfma_f32_32x32x16_bf16 v[144:159],a[60:63],v[24:27],v[144:159]
v_mfma_f32_32x32x16_bf16 v[144:159],a[64:67],v[24:27],v[144:159]
v_mfma_f32_32x32x16_bf16 v[144:159],a[68:71],v[24:27],v[144:159]
v_mfma_f32_32x32x16_bf16 v[144:159],a[72:75],v[24:27],v[144:159]
v_mfma_f32_32x32x16_bf16 v[144:159],a[76:79],v[24:27],v[144:159]
v_mfma_f32_32x32x16_bf16 v[144:159],a[80:83],v[24:27],v[144:159]
v_mfma_f32_32x32x16_bf16 v[144:159],a[84:87],v[24:27],v[144:159]
v_mfma_f32_32x32x16_bf16 v[144:159],a[88:91],v[24:27],v[144:159]
v_mfma_f32_32x32x16_bf16 v[144:159],a[92:95],v[24:27],v[144:159]
v_mfma_f32_32x32x16_bf16 v[144:159],a[96:99],v[24:27],v[144:159]
v_mfma_f32_32x32x16_bf16 v[144:159],a[100:103],v[24:27],v[144:159]
v_mfma_f32_32x32x16_bf16 v[144:159],a[104:107],v[24:27],v[144:159]
v_mfma_f32_32x32x16_bf16 v[144:159],a[108:111],v[24:27],v[144:159]
v_mfma_f32_32x32x16_bf16 v[144:159],a[112:115],v[24:27],v[144:159]
v_mfma_f32_32x32x16_bf16 v[144:159],a[116:119],v[24:27],v[144:159]
v_mfma_f32_32x32x16_bf16 v[144:159],a[120:123],v[24:27],v[144:159]
v_mfma_f32_32x32x16_bf16 v[144:159],a[124:127],v[24:27],v[144:159]
v_mfma_f32_32x32x16_bf16 v[144:159],a[128:131],v[24:27],v[144:159]
v_mfma_f32_32x32x16_bf16 v[144:159],a[132:135],v[24:27],v[144:159]
v_mfma_f32_32x32x16_bf16 v[144:159],a[136:139],v[24:27],v[144:159]
v_mfma_f32_32x32x16_bf16 v[144:159],a[140:143],v[24:27],v[144:159]
v_mfma_f32_32x32x16_bf16 v[144:159],a[144:147],v[24:27],v[144:159]
v_mfma_f32_32x32x16_bf16 v[144:159],a[148:151],v[24:27],v[144:159]
v_mfma_f32_32x32x16_bf16 v[144:159],a[152:155],v[24:27],v[144:159]
v_mfma_f32_32x32x16_bf16 v[144:159],a[156:159],v[24:27],v[144:159]
v_and_b32 v182,31,v0
v_lshlrev_b32 v182,3,v182
v_add_u32 v182,0xa000,v182
s_barrier
s_lshl_b32 s3,s49,2
v_mov_b32 v7,s3
s_nop 5
ibw_317:
buffer_load_dword v6,v7,s[12:15],0 offen sc1
s_waitcnt vmcnt(0)
v_cmp_ne_u32 vcc,256,v6
s_nop 0
s_cbranch_vccz ok_318
s_sleep 8
s_sub_u32 s47,s47,1
s_cbranch_scc1 ABORT
s_branch ibw_317
ok_318:
s_cmp_lg_u32 s49,0
s_cbranch_scc1 ibok_319
v_and_b32 v7,7,v0
v_lshlrev_b32 v7,2,v7
buffer_load_dword v6,v7,s[12:15],0 offen offset:32 sc1
s_waitcnt vmcnt(0)
v_cmp_ne_u32 vcc,32,v6
s_nop 0
s_cbranch_vccz ibok_319
s_barrier
s_mov_b32 s49,1
s_mov_b32 s3,s2
s_load_dwordx16 s[16:31],s[0:1],0
s_load_dwordx8 s[32:39],s[0:1],64
s_waitcnt lgkmcnt(0)
s_branch DISPATCH
ibok_319:
s_mov_b32 s50,0
s_mov_b32 s32,0
s_mov_b32 s57,0
s_mov_b32 s59,2147483648
s_mov_b32 s82,2147483648
s_mov_b32 s39,2147483648
v_mov_b32 v22,94208
v_mov_b32 v23,0
ds_write_b32 v22,v23
s_mov_b32 s39,1600000
v_and_b32 v72,15,v0
v_lshlrev_b32 v72,7,v72
s_waitcnt lgkmcnt(0)
s_barrier
s_mov_b32 s83,s100
s_min_u32 s62,s32,127
s_sub_u32 s60,s62,15
s_lshr_b32 s34,s60,1
s_and_b32 s33,s60,1
s_cmp_eq_u32 s33,0
s_cselect_b32 s61,15,0
s_add_u32 s34,s34,s61
s_sub_u32 s61,s60,49
s_cmp_ge_u32 s60,98
s_cselect_b32 s34,s61,s34
s_cselect_b32 s33,1,s33
s_cmp_lt_u32 s62,15
s_cselect_b32 s34,s62,s34
s_cselect_b32 s33,0,s33
s_lshl_b32 s35,s33,6
s_add_u32 s35,s35,s34
s_lshl_b32 s35,s35,9
s_add_u32 s35,s35,393216
s_sub_u32 s57,46080,s57
v_swap_b32 v16,v18
v_swap_b32 v17,v19
s_mov_b32 s50,-1
s_nop 0
W1_COLD:
s_mov_b32 s37,0
s_cmp_lg_u32 s46,0
s_cbranch_scc1 wo_320
fb_322:
buffer_load_dword v3,v2,s[8:11],s35 offen sc1
s_waitcnt vmcnt(0)
v_cmp_eq_u32 vcc,0,v3
s_nop 0
s_cbranch_vccz ok_323
s_sleep 7
s_sub_u32 s47,s47,1
s_cbranch_scc1 ABORT
s_branch fb_322
ok_323:
s_add_u32 s65,s32,1
s_or_b32 s65,s65,s37
v_mov_b32 v23,s65
ds_max_i32 v22,v23
s_branch wd_321
wo_320:
ds_read_b32 v23,v22
s_waitcnt lgkmcnt(0)
v_cmp_ge_u32 vcc,s32,v23
s_nop 0
s_cbranch_vccz wd_321
s_sleep 1
s_sub_u32 s39,s39,1
s_cbranch_scc1 ABORT
s_branch wo_320
wd_321:
s_sub_u32 s66,46080,s57
s_lshl_b32 s60,s33,6
s_add_u32 s60,s60,s34
s_mul_i32 s60,s60,46080
s_add_u32 s60,s60,s37
s_add_u32 s60,s60,223608832
s_add_u32 m0,s66,40960
s_add_u32 s63,s60,40960
buffer_load_dwordx4 v1,s[8:11],s63 offen sc1 lds
s_mul_i32 s61,s46,10240
s_add_u32 s60,s60,s61
s_add_u32 s61,s61,s66
s_add_u32 m0,s61,0
s_add_u32 s63,s60,0
buffer_load_dwordx4 v1,s[8:11],s63 offen sc1 lds
buffer_load_dwordx4 v1,s[8:11],s63 offen offset:1024 sc1 lds
buffer_load_dwordx4 v1,s[8:11],s63 offen offset:2048 sc1 lds
buffer_load_dwordx4 v1,s[8:11],s63 offen offset:3072 sc1 lds
s_add_u32 m0,s61,4096
s_add_u32 s63,s60,4096
buffer_load_dwordx4 v1,s[8:11],s63 offen sc1 lds
buffer_load_dwordx4 v1,s[8:11],s63 offen offset:1024 sc1 lds
buffer_load_dwordx4 v1,s[8:11],s63 offen offset:2048 sc1 lds
buffer_load_dwordx4 v1,s[8:11],s63 offen offset:3072 sc1 lds
s_add_u32 m0,s61,8192
s_add_u32 s63,s60,8192
buffer_load_dwordx4 v1,s[8:11],s63 offen sc1 lds
buffer_load_dwordx4 v1,s[8:11],s63 offen offset:1024 sc1 lds
s_mov_b32 s55,1
W1_NEXT:
s_add_u32 s50,s50,1
s_sub_u32 s57,46080,s57
v_swap_b32 v16,v18
v_swap_b32 v17,v19
s_mov_b32 s51,s33
s_mov_b32 s52,s34
s_add_u32 s32,s32,1
s_min_u32 s62,s32,127
s_sub_u32 s60,s62,15
s_lshr_b32 s34,s60,1
s_and_b32 s33,s60,1
s_cmp_eq_u32 s33,0
s_cselect_b32 s61,15,0
s_add_u32 s34,s34,s61
s_sub_u32 s61,s60,49
s_cmp_ge_u32 s60,98
s_cselect_b32 s34,s61,s34
s_cselect_b32 s33,1,s33
s_cmp_lt_u32 s62,15
s_cselect_b32 s34,s62,s34
s_cselect_b32 s33,0,s33
s_lshl_b32 s35,s33,6
s_add_u32 s35,s35,s34
s_lshl_b32 s35,s35,9
s_add_u32 s35,s35,393216
s_waitcnt vmcnt(2)
s_cmp_eq_u32 s55,0
s_cbranch_scc1 wv_324
s_waitcnt vmcnt(0)
wv_324:
s_barrier
ds_read_b128 v[24:27],v16 offset:0
ds_read_b128 v[28:31],v17 offset:0
ds_read_b128 v[32:35],v16 offset:2048
ds_read_b128 v[36:39],v17 offset:2048
ds_read_b128 v[40:43],v16 offset:4096
ds_read_b128 v[44:47],v17 offset:4096
ds_read_b128 v[48:51],v16 offset:6144
buffer_load_dword v3,v2,s[8:11],s35 offen sc1
s_waitcnt lgkmcnt(6)
v_mfma_f32_32x32x16_bf16 v[56:71],a[0:3],v[24:27],0
ds_read_b128 v[52:55],v17 offset:6144
v_add_u32 v183,s57,v182
s_mul_i32 s62,s51,66
s_add_u32 s62,s62,s52
s_waitcnt lgkmcnt(6)
v_mfma_f32_32x32x16_bf16 v[56:71],a[4:7],v[28:31],v[56:71]
ds_read_b128 v[24:27],v16 offset:8192
ds_read_b64 v[180:181],v183
s_mul_i32 s62,s62,40960
s_waitcnt lgkmcnt(6)
v_mfma_f32_32x32x16_bf16 v[56:71],a[8:11],v[32:35],v[56:71]
ds_read_b128 v[28:31],v17 offset:8192
s_lshl_b32 s63,s56,11
s_add_u32 s62,s62,s63
s_add_u32 s62,s62,237412352
v_mfma_f32_32x32x16_bf16 v[56:71],a[12:15],v[36:39],v[56:71]
ds_read_b128 v[32:35],v16 offset:10240
buffer_load_dword v73,v72,s[8:11],s62 offen sc1
s_waitcnt lgkmcnt(6)
v_mfma_f32_32x32x16_bf16 v[56:71],a[16:19],v[40:43],v[56:71]
ds_read_b128 v[36:39],v17 offset:10240
v_mfma_f32_32x32x16_bf16 v[56:71],a[20:23],v[44:47],v[56:71]
ds_read_b128 v[40:43],v16 offset:12288
s_waitcnt lgkmcnt(6)
v_mfma_f32_32x32x16_bf16 v[56:71],a[24:27],v[48:51],v[56:71]
ds_read_b128 v[44:47],v17 offset:12288
v_mfma_f32_32x32x16_bf16 v[56:71],a[28:31],v[52:55],v[56:71]
ds_read_b128 v[48:51],v16 offset:14336
s_waitcnt lgkmcnt(5)
v_mfma_f32_32x32x16_bf16 v[56:71],a[32:35],v[24:27],v[56:71]
ds_read_b128 v[52:55],v17 offset:14336
v_mfma_f32_32x32x16_bf16 v[56:71],a[36:39],v[28:31],v[56:71]
ds_read_b128 v[24:27],v16 offset:16384
s_waitcnt lgkmcnt(5)
v_mfma_f32_32x32x16_bf16 v[56:71],a[40:43],v[32:35],v[56:71]
ds_read_b128 v[28:31],v17 offset:16384
v_mfma_f32_32x32x16_bf16 v[56:71],a[44:47],v[36:39],v[56:71]
ds_read_b128 v[32:35],v16 offset:18432
s_waitcnt lgkmcnt(5)
v_mfma_f32_32x32x16_bf16 v[56:71],a[48:51],v[40:43],v[56:71]
ds_read_b128 v[36:39],v17 offset:18432
v_mfma_f32_32x32x16_bf16 v[56:71],a[52:55],v[44:47],v[56:71]
ds_read_b128 v[40:43],v16 offset:20480
s_waitcnt lgkmcnt(5)
v_mfma_f32_32x32x16_bf16 v[56:71],a[56:59],v[48:51],v[56:71]
ds_read_b128 v[44:47],v17 offset:20480
v_mfma_f32_32x32x16_bf16 v[56:71],a[60:63],v[52:55],v[56:71]
ds_read_b128 v[48:51],v16 offset:22528
s_waitcnt lgkmcnt(5)
v_mfma_f32_32x32x16_bf16 v[56:71],a[64:67],v[24:27],v[56:71]
ds_read_b128 v[52:55],v17 offset:22528
v_mfma_f32_32x32x16_bf16 v[56:71],a[68:71],v[28:31],v[56:71]
ds_read_b128 v[24:27],v16 offset:24576
s_waitcnt lgkmcnt(5)
v_mfma_f32_32x32x16_bf16 v[56:71],a[72:75],v[32:35],v[56:71]
ds_read_b128 v[28:31],v17 offset:24576
v_mfma_f32_32x32x16_bf16 v[56:71],a[76:79],v[36:39],v[56:71]
ds_read_b128 v[32:35],v16 offset:26624
s_waitcnt lgkmcnt(5)
v_mfma_f32_32x32x16_bf16 v[56:71],a[80:83],v[40:43],v[56:71]
ds_read_b128 v[36:39],v17 offset:26624
v_mfma_f32_32x32x16_bf16 v[56:71],a[84:87],v[44:47],v[56:71]
ds_read_b128 v[40:43],v16 offset:28672
s_waitcnt lgkmcnt(5)
v_mfma_f32_32x32x16_bf16 v[56:71],a[88:91],v[48:51],v[56:71]
ds_read_b128 v[44:47],v17 offset:28672
s_waitcnt vmcnt(1)
s_mov_b64 exec,1
s_cmp_lg_u32 s49,0
s_cbranch_scc0 ls_325
buffer_store_dword v5,v1,s[8:11],s59 offen sc1
s_branch ls_326
ls_325:
buffer_store_dword v5,v1,s[8:11],s59 offen
ls_326:
s_mov_b64 exec,-1
s_mov_b32 s59,2147483648
v_mfma_f32_32x32x16_bf16 v[56:71],a[92:95],v[52:55],v[56:71]
ds_read_b128 v[48:51],v16 offset:30720
v_cmp_eq_u32 vcc,0,v3
s_cmp_eq_u64 vcc,0
s_cselect_b32 s37,0,2147483648
s_waitcnt lgkmcnt(5)
v_mfma_f32_32x32x16_bf16 v[56:71],a[96:99],v[24:27],v[56:71]
ds_read_b128 v[52:55],v17 offset:30720
s_cmp_lt_u32 s32,128
s_cselect_b32 s37,s37,2147483648
s_add_u32 s65,s32,1
s_or_b32 s65,s65,s37
v_mfma_f32_32x32x16_bf16 v[56:71],a[100:103],v[28:31],v[56:71]
ds_read_b128 v[24:27],v16 offset:32768
v_mov_b32 v23,s65
ds_max_i32 v22,v23
s_waitcnt lgkmcnt(6)
v_mfma_f32_32x32x16_bf16 v[56:71],a[104:107],v[32:35],v[56:71]
ds_read_b128 v[28:31],v17 offset:32768
buffer_load_dword v3,v2,s[8:11],s35 offen sc1
s_sub_u32 s66,46080,s57
v_mfma_f32_32x32x16_bf16 v[56:71],a[108:111],v[36:39],v[56:71]
ds_read_b128 v[32:35],v16 offset:34816
s_lshl_b32 s60,s33,6
s_add_u32 s60,s60,s34
s_mul_i32 s60,s60,46080
s_waitcnt lgkmcnt(6)
v_mfma_f32_32x32x16_bf16 v[56:71],a[112:115],v[40:43],v[56:71]
ds_read_b128 v[36:39],v17 offset:34816
s_add_u32 s60,s60,s37
s_add_u32 s60,s60,223608832
s_add_u32 m0,s66,40960
s_add_u32 s63,s60,40960
v_mfma_f32_32x32x16_bf16 v[56:71],a[116:119],v[44:47],v[56:71]
ds_read_b128 v[40:43],v16 offset:36864
buffer_load_dwordx4 v1,s[8:11],s63 offen sc1 lds
s_mul_i32 s61,s46,10240
s_waitcnt lgkmcnt(6)
v_mfma_f32_32x32x16_bf16 v[56:71],a[120:123],v[48:51],v[56:71]
ds_read_b128 v[44:47],v17 offset:36864
s_add_u32 s60,s60,s61
s_add_u32 s61,s61,s66
s_add_u32 m0,s61,0
s_add_u32 s63,s60,0
v_mfma_f32_32x32x16_bf16 v[56:71],a[124:127],v[52:55],v[56:71]
ds_read_b128 v[48:51],v16 offset:38912
buffer_load_dwordx4 v1,s[8:11],s63 offen sc1 lds
s_waitcnt lgkmcnt(5)
v_mfma_f32_32x32x16_bf16 v[56:71],a[128:131],v[24:27],v[56:71]
ds_read_b128 v[52:55],v17 offset:38912
buffer_load_dwordx4 v1,s[8:11],s63 offen offset:1024 sc1 lds
v_mfma_f32_32x32x16_bf16 v[56:71],a[132:135],v[28:31],v[56:71]
buffer_load_dwordx4 v1,s[8:11],s63 offen offset:2048 sc1 lds
s_waitcnt lgkmcnt(4)
v_mfma_f32_32x32x16_bf16 v[56:71],a[136:139],v[32:35],v[56:71]
buffer_load_dwordx4 v1,s[8:11],s63 offen offset:3072 sc1 lds
s_add_u32 m0,s61,4096
s_add_u32 s63,s60,4096
v_mfma_f32_32x32x16_bf16 v[56:71],a[140:143],v[36:39],v[56:71]
buffer_load_dwordx4 v1,s[8:11],s63 offen sc1 lds
s_waitcnt lgkmcnt(2)
v_mfma_f32_32x32x16_bf16 v[56:71],a[144:147],v[40:43],v[56:71]
buffer_load_dwordx4 v1,s[8:11],s63 offen offset:1024 sc1 lds
v_mfma_f32_32x32x16_bf16 v[56:71],a[148:151],v[44:47],v[56:71]
buffer_load_dwordx4 v1,s[8:11],s63 offen offset:2048 sc1 lds
s_waitcnt lgkmcnt(0)
v_mfma_f32_32x32x16_bf16 v[56:71],a[152:155],v[48:51],v[56:71]
buffer_load_dwordx4 v1,s[8:11],s63 offen offset:3072 sc1 lds
s_add_u32 m0,s61,8192
s_add_u32 s63,s60,8192
v_mfma_f32_32x32x16_bf16 v[56:71],a[156:159],v[52:55],v[56:71]
buffer_load_dwordx4 v1,s[8:11],s63 offen sc1 lds
buffer_load_dwordx4 v1,s[8:11],s63 offen offset:1024 sc1 lds
s_mov_b32 s55,0
s_cmp_eq_u32 s37,0
s_cbranch_scc1 ep_327
s_waitcnt vmcnt(0)
v_cmp_eq_u32 vcc,0,v3
s_cmp_eq_u64 vcc,0
s_cselect_b32 s37,0,2147483648
s_cmp_lt_u32 s32,128
s_cselect_b32 s37,s37,2147483648
s_cmp_lg_u32 s37,0
s_cbranch_scc1 ep_327
s_add_u32 s65,s32,1
s_or_b32 s65,s65,s37
v_mov_b32 v23,s65
ds_max_i32 v22,v23
s_sub_u32 s66,46080,s57
s_lshl_b32 s60,s33,6
s_add_u32 s60,s60,s34
s_mul_i32 s60,s60,46080
s_add_u32 s60,s60,s37
s_add_u32 s60,s60,223608832
s_add_u32 m0,s66,40960
s_add_u32 s63,s60,40960
buffer_load_dwordx4 v1,s[8:11],s63 offen sc1 lds
s_mul_i32 s61,s46,10240
s_add_u32 s60,s60,s61
s_add_u32 s61,s61,s66
s_add_u32 m0,s61,0
s_add_u32 s63,s60,0
buffer_load_dwordx4 v1,s[8:11],s63 offen sc1 lds
buffer_load_dwordx4 v1,s[8:11],s63 offen offset:1024 sc1 lds
buffer_load_dwordx4 v1,s[8:11],s63 offen offset:2048 sc1 lds
buffer_load_dwordx4 v1,s[8:11],s63 offen offset:3072 sc1 lds
s_add_u32 m0,s61,4096
s_add_u32 s63,s60,4096
buffer_load_dwordx4 v1,s[8:11],s63 offen sc1 lds
buffer_load_dwordx4 v1,s[8:11],s63 offen offset:1024 sc1 lds
buffer_load_dwordx4 v1,s[8:11],s63 offen offset:2048 sc1 lds
buffer_load_dwordx4 v1,s[8:11],s63 offen offset:3072 sc1 lds
s_add_u32 m0,s61,8192
s_add_u32 s63,s60,8192
buffer_load_dwordx4 v1,s[8:11],s63 offen sc1 lds
buffer_load_dwordx4 v1,s[8:11],s63 offen offset:1024 sc1 lds
ep_327:
s_nop 7
s_mul_i32 s62,s51,66
s_add_u32 s62,s62,s52
s_mul_i32 s62,s62,40960
s_lshl_b32 s63,s56,11
s_add_u32 s62,s62,s63
s_add_u32 s62,s62,237412352
v_pk_fma_f32 v[56:57],v[144:145],v[180:181],v[56:57] op_sel_hi:[1,0,1] neg_lo:[0,1,0] neg_hi:[0,1,0]
v_pk_fma_f32 v[58:59],v[146:147],v[180:181],v[58:59] op_sel_hi:[1,0,1] neg_lo:[0,1,0] neg_hi:[0,1,0]
v_pk_fma_f32 v[60:61],v[148:149],v[180:181],v[60:61] op_sel_hi:[1,0,1] neg_lo:[0,1,0] neg_hi:[0,1,0]
v_pk_fma_f32 v[62:63],v[150:151],v[180:181],v[62:63] op_sel_hi:[1,0,1] neg_lo:[0,1,0] neg_hi:[0,1,0]
v_pk_fma_f32 v[64:65],v[152:153],v[180:181],v[64:65] op_sel_hi:[1,0,1] neg_lo:[0,1,0] neg_hi:[0,1,0]
v_pk_fma_f32 v[66:67],v[154:155],v[180:181],v[66:67] op_sel_hi:[1,0,1] neg_lo:[0,1,0] neg_hi:[0,1,0]
v_pk_fma_f32 v[68:69],v[156:157],v[180:181],v[68:69] op_sel_hi:[1,0,1] neg_lo:[0,1,0] neg_hi:[0,1,0]
v_pk_fma_f32 v[70:71],v[158:159],v[180:181],v[70:71] op_sel_hi:[1,0,1] neg_lo:[0,1,0] neg_hi:[0,1,0]
v_pk_mul_f32 v[56:57],v[56:57],v[180:181] op_sel:[0,1] op_sel_hi:[1,1]
v_pk_mul_f32 v[58:59],v[58:59],v[180:181] op_sel:[0,1] op_sel_hi:[1,1]
v_pk_mul_f32 v[60:61],v[60:61],v[180:181] op_sel:[0,1] op_sel_hi:[1,1]
v_pk_mul_f32 v[62:63],v[62:63],v[180:181] op_sel:[0,1] op_sel_hi:[1,1]
v_pk_mul_f32 v[64:65],v[64:65],v[180:181] op_sel:[0,1] op_sel_hi:[1,1]
v_pk_mul_f32 v[66:67],v[66:67],v[180:181] op_sel:[0,1] op_sel_hi:[1,1]
v_pk_mul_f32 v[68:69],v[68:69],v[180:181] op_sel:[0,1] op_sel_hi:[1,1]
v_pk_mul_f32 v[70:71],v[70:71],v[180:181] op_sel:[0,1] op_sel_hi:[1,1]
v_cvt_pk_bf16_f32 v140,v56,v57
v_lshlrev_b32 v56,16,v140
v_and_b32 v57,0xffff0000,v140
v_cvt_pk_bf16_f32 v140,v58,v59
v_lshlrev_b32 v58,16,v140
v_and_b32 v59,0xffff0000,v140
v_cvt_pk_bf16_f32 v140,v60,v61
v_lshlrev_b32 v60,16,v140
v_and_b32 v61,0xffff0000,v140
v_cvt_pk_bf16_f32 v140,v62,v63
v_lshlrev_b32 v62,16,v140
v_and_b32 v63,0xffff0000,v140
v_cvt_pk_bf16_f32 v140,v64,v65
v_lshlrev_b32 v64,16,v140
v_and_b32 v65,0xffff0000,v140
v_cvt_pk_bf16_f32 v140,v66,v67
v_lshlrev_b32 v66,16,v140
v_and_b32 v67,0xffff0000,v140
v_cvt_pk_bf16_f32 v140,v68,v69
v_lshlrev_b32 v68,16,v140
v_and_b32 v69,0xffff0000,v140
v_cvt_pk_bf16_f32 v140,v70,v71
v_lshlrev_b32 v70,16,v140
v_and_b32 v71,0xffff0000,v140
v_pk_mul_f32 v[124:125],v[56:57],v[56:57]
v_pk_mul_f32 v[126:127],v[58:59],v[58:59]
v_pk_mul_f32 v[128:129],v[60:61],v[60:61]
v_pk_mul_f32 v[130:131],v[62:63],v[62:63]
v_pk_mul_f32 v[132:133],v[64:65],v[64:65]
v_pk_mul_f32 v[134:135],v[66:67],v[66:67]
v_pk_mul_f32 v[136:137],v[68:69],v[68:69]
v_pk_mul_f32 v[138:139],v[70:71],v[70:71]
v_pk_fma_f32 v[124:125],v[124:125],v[112:113],v[112:113] op_sel:[0,1,0] op_sel_hi:[1,1,0]
v_pk_fma_f32 v[126:127],v[126:127],v[112:113],v[112:113] op_sel:[0,1,0] op_sel_hi:[1,1,0]
v_pk_fma_f32 v[128:129],v[128:129],v[112:113],v[112:113] op_sel:[0,1,0] op_sel_hi:[1,1,0]
v_pk_fma_f32 v[130:131],v[130:131],v[112:113],v[112:113] op_sel:[0,1,0] op_sel_hi:[1,1,0]
v_pk_fma_f32 v[132:133],v[132:133],v[112:113],v[112:113] op_sel:[0,1,0] op_sel_hi:[1,1,0]
v_pk_fma_f32 v[134:135],v[134:135],v[112:113],v[112:113] op_sel:[0,1,0] op_sel_hi:[1,1,0]
v_pk_fma_f32 v[136:137],v[136:137],v[112:113],v[112:113] op_sel:[0,1,0] op_sel_hi:[1,1,0]
v_pk_fma_f32 v[138:139],v[138:139],v[112:113],v[112:113] op_sel:[0,1,0] op_sel_hi:[1,1,0]
v_pk_mul_f32 v[124:125],v[124:125],v[56:57]
v_pk_mul_f32 v[126:127],v[126:127],v[58:59]
v_pk_mul_f32 v[128:129],v[128:129],v[60:61]
v_pk_mul_f32 v[130:131],v[130:131],v[62:63]
v_pk_mul_f32 v[132:133],v[132:133],v[64:65]
v_pk_mul_f32 v[134:135],v[134:135],v[66:67]
v_pk_mul_f32 v[136:137],v[136:137],v[68:69]
v_pk_mul_f32 v[138:139],v[138:139],v[70:71]
v_exp_f32 v124,v124
v_exp_f32 v125,v125
v_exp_f32 v126,v126
v_exp_f32 v127,v127
v_exp_f32 v128,v128
v_exp_f32 v129,v129
v_exp_f32 v130,v130
v_exp_f32 v131,v131
v_exp_f32 v132,v132
v_exp_f32 v133,v133
v_exp_f32 v134,v134
v_exp_f32 v135,v135
v_exp_f32 v136,v136
v_exp_f32 v137,v137
v_exp_f32 v138,v138
v_exp_f32 v139,v139
v_pk_add_f32 v[124:125],v[124:125],1.0 op_sel_hi:[1,0]
v_pk_add_f32 v[126:127],v[126:127],1.0 op_sel_hi:[1,0]
v_pk_add_f32 v[128:129],v[128:129],1.0 op_sel_hi:[1,0]
v_pk_add_f32 v[130:131],v[130:131],1.0 op_sel_hi:[1,0]
v_pk_add_f32 v[132:133],v[132:133],1.0 op_sel_hi:[1,0]
v_pk_add_f32 v[134:135],v[134:135],1.0 op_sel_hi:[1,0]
v_pk_add_f32 v[136:137],v[136:137],1.0 op_sel_hi:[1,0]
v_pk_add_f32 v[138:139],v[138:139],1.0 op_sel_hi:[1,0]
v_rcp_f32 v124,v124
v_rcp_f32 v125,v125
v_rcp_f32 v126,v126
v_rcp_f32 v127,v127
v_rcp_f32 v128,v128
v_rcp_f32 v129,v129
v_rcp_f32 v130,v130
v_rcp_f32 v131,v131
v_rcp_f32 v132,v132
v_rcp_f32 v133,v133
v_rcp_f32 v134,v134
v_rcp_f32 v135,v135
v_rcp_f32 v136,v136
v_rcp_f32 v137,v137
v_rcp_f32 v138,v138
v_rcp_f32 v139,v139
v_pk_mul_f32 v[56:57],v[56:57],v[124:125]
v_pk_mul_f32 v[58:59],v[58:59],v[126:127]
v_pk_mul_f32 v[60:61],v[60:61],v[128:129]
v_pk_mul_f32 v[62:63],v[62:63],v[130:131]
v_pk_mul_f32 v[64:65],v[64:65],v[132:133]
v_pk_mul_f32 v[66:67],v[66:67],v[134:135]
v_pk_mul_f32 v[68:69],v[68:69],v[136:137]
v_pk_mul_f32 v[70:71],v[70:71],v[138:139]
v_cvt_pk_bf16_f32 v116,v56,v57
v_cvt_pk_bf16_f32 v117,v58,v59
v_cvt_pk_bf16_f32 v118,v60,v61
v_cvt_pk_bf16_f32 v119,v62,v63
v_cvt_pk_bf16_f32 v120,v64,v65
v_cvt_pk_bf16_f32 v121,v66,v67
v_cvt_pk_bf16_f32 v122,v68,v69
v_cvt_pk_bf16_f32 v123,v70,v71
s_cmp_lg_u32 s49,0
s_cbranch_scc0 ls_328
buffer_store_dwordx4 v[116:119],v20,s[8:11],s62 offen sc1
buffer_store_dwordx4 v[120:123],v21,s[8:11],s62 offen sc1
s_branch ls_329
ls_328:
buffer_store_dwordx4 v[116:119],v20,s[8:11],s62 offen
buffer_store_dwordx4 v[120:123],v21,s[8:11],s62 offen
ls_329:
s_lshl_b32 s82,s51,6
s_add_u32 s82,s82,s52
s_lshl_b32 s82,s82,9
s_add_u32 s82,s82,458752
s_lshl_b32 s61,s56,2
s_add_u32 s82,s82,s61
s_mov_b32 s59,s82
s_cmp_eq_u32 s37,0
s_cbranch_scc1 W1_NEXT
s_waitcnt vmcnt(0)
s_mov_b64 exec,1
s_cmp_lg_u32 s49,0
s_cbranch_scc0 ls_330
buffer_store_dword v5,v1,s[8:11],s59 offen sc1
s_branch ls_331
ls_330:
buffer_store_dword v5,v1,s[8:11],s59 offen
ls_331:
s_mov_b64 exec,-1
s_mov_b32 s59,2147483648
s_cmp_lt_u32 s32,128
s_cbranch_scc1 W1_COLD
W1_END:
s_endpgm
ROLE_W2:
v_lshlrev_b32 v1,4,v0
v_mov_b32 v5,1
s_lshl_b32 s56,s48,2
s_add_u32 s56,s56,s46
v_bfe_u32 v6,v0,2,2
v_lshrrev_b32 v7,4,v0
v_add_u32 v7,v6,v7
v_and_b32 v7,3,v7
v_and_b32 v15,3,v0
v_lshlrev_b32 v15,4,v15
v_lshl_add_u32 v15,v7,6,v15
v_lshl_add_u32 v15,v6,8,v15
v_lshrrev_b32 v6,5,v0
v_bfe_u32 v7,v0,4,1
v_lshlrev_b32 v16,10,v7
v_lshl_add_u32 v16,v6,8,v16
v_and_b32 v6,15,v0
v_lshl_add_u32 v16,v6,4,v16
v_add_u32 v18,40960,v16
v_lshrrev_b32 v6,5,v0
v_bfe_u32 v7,v0,4,1
v_lshlrev_b32 v20,10,v7
v_lshl_add_u32 v20,v6,8,v20
v_and_b32 v6,15,v0
v_lshl_add_u32 v20,v6,4,v20
v_lshrrev_b32 v6,5,v0
v_add_u32 v6,2,v6
v_bfe_u32 v7,v0,4,1
v_lshlrev_b32 v17,10,v7
v_lshl_add_u32 v17,v6,8,v17
v_and_b32 v6,15,v0
v_lshl_add_u32 v17,v6,4,v17
v_add_u32 v19,40960,v17
v_lshrrev_b32 v6,5,v0
v_add_u32 v6,2,v6
v_bfe_u32 v7,v0,4,1
v_lshlrev_b32 v21,10,v7
v_lshl_add_u32 v21,v6,8,v21
v_and_b32 v6,15,v0
v_lshl_add_u32 v21,v6,4,v21
v_min_u32 v2,19,v0
v_lshlrev_b32 v2,2,v2
s_lshr_b32 s60,s46,1
s_add_u32 s60,s60,1
s_sub_u32 s61,32,s60
s_add_u32 s60,s60,32
s_bitcmp1_b32 s46,0
s_cselect_b32 s60,s60,s61
v_and_b32 v6,15,v0
v_add_u32 v6,s60,v6
v_lshrrev_b32 v7,5,v6
v_mul_u32_u24 v112,40960,v7
v_bfe_u32 v7,v6,4,1
v_lshl_add_u32 v112,v7,10,v112
v_and_b32 v7,15,v6
v_lshl_add_u32 v112,v7,4,v112
v_lshrrev_b32 v7,4,v0
v_lshl_add_u32 v112,v7,8,v112
v_and_b32 v6,15,v0
v_add_u32 v6,s60,v6
v_add_u32 v6,16,v6
v_lshrrev_b32 v7,5,v6
v_mul_u32_u24 v113,40960,v7
v_bfe_u32 v7,v6,4,1
v_lshl_add_u32 v113,v7,10,v113
v_and_b32 v7,15,v6
v_lshl_add_u32 v113,v7,4,v113
v_lshrrev_b32 v7,4,v0
v_lshl_add_u32 v113,v7,8,v113
v_lshrrev_b32 v6,5,v0
v_and_b32 v7,15,v0
v_lshlrev_b32 v114,3,v7
v_lshl_add_u32 v114,v6,7,v114
v_and_b32 v114,31,v0
v_lshlrev_b32 v114,3,v114
v_lshrrev_b32 v6,5,v0
v_bfe_u32 v7,v0,4,1
v_lshlrev_b32 v116,10,v7
v_bfe_u32 v7,v0,2,2
v_lshl_add_u32 v116,v7,8,v116
v_add_u32 v6,v6,v7
v_and_b32 v6,3,v6
v_lshl_add_u32 v116,v6,6,v116
v_and_b32 v6,3,v0
v_lshl_add_u32 v116,v6,4,v116
v_lshrrev_b32 v6,5,v0
v_add_u32 v6,2,v6
v_bfe_u32 v7,v0,4,1
v_lshlrev_b32 v117,10,v7
v_bfe_u32 v7,v0,2,2
v_lshl_add_u32 v117,v7,8,v117
v_add_u32 v6,v6,v7
v_and_b32 v6,3,v6
v_lshl_add_u32 v117,v6,6,v117
v_and_b32 v6,3,v0
v_lshl_add_u32 v117,v6,4,v117
s_waitcnt vmcnt(0)
s_barrier
s_cmp_lg_u32 s46,0
s_cbranch_scc1 arr_332
v_mov_b32 v6,1
s_lshl_b32 s3,s49,2
v_mov_b32 v7,s3
s_mov_b64 exec,1
buffer_atomic_add v6,v7,s[12:15],0 offen sc1
s_mov_b64 exec,-1
arr_332:
s_lshl_b32 s58,s56,6
s_mul_i32 s63,s46,40960
s_mov_b32 s4,s34
s_mov_b32 s5,s35
s_mov_b32 s6,819200
s_mov_b32 s7,0x20000
v_lshrrev_b32 v9,2,v0
s_mov_b32 s64,1280
v_mul_lo_u32 v9,v9,s64
v_and_b32 v10,3,v0
v_lshl_add_u32 v6,v10,4,v9
s_add_u32 m0,s63,0
s_add_u32 s65,s58,0
buffer_load_dwordx4 v6,s[4:7],s65 offen lds
s_add_u32 m0,s63,1024
s_add_u32 s65,s58,20480
buffer_load_dwordx4 v6,s[4:7],s65 offen lds
s_add_u32 m0,s63,2048
s_add_u32 s65,s58,40960
buffer_load_dwordx4 v6,s[4:7],s65 offen lds
s_add_u32 m0,s63,3072
s_add_u32 s65,s58,61440
buffer_load_dwordx4 v6,s[4:7],s65 offen lds
s_add_u32 m0,s63,4096
s_add_u32 s65,s58,81920
buffer_load_dwordx4 v6,s[4:7],s65 offen lds
s_add_u32 m0,s63,5120
s_add_u32 s65,s58,102400
buffer_load_dwordx4 v6,s[4:7],s65 offen lds
s_add_u32 m0,s63,6144
s_add_u32 s65,s58,122880
buffer_load_dwordx4 v6,s[4:7],s65 offen lds
s_add_u32 m0,s63,7168
s_add_u32 s65,s58,143360
buffer_load_dwordx4 v6,s[4:7],s65 offen lds
s_add_u32 m0,s63,8192
s_add_u32 s65,s58,163840
buffer_load_dwordx4 v6,s[4:7],s65 offen lds
s_add_u32 m0,s63,9216
s_add_u32 s65,s58,184320
buffer_load_dwordx4 v6,s[4:7],s65 offen lds
s_add_u32 m0,s63,10240
s_add_u32 s65,s58,204800
buffer_load_dwordx4 v6,s[4:7],s65 offen lds
s_add_u32 m0,s63,11264
s_add_u32 s65,s58,225280
buffer_load_dwordx4 v6,s[4:7],s65 offen lds
s_add_u32 m0,s63,12288
s_add_u32 s65,s58,245760
buffer_load_dwordx4 v6,s[4:7],s65 offen lds
s_add_u32 m0,s63,13312
s_add_u32 s65,s58,266240
buffer_load_dwordx4 v6,s[4:7],s65 offen lds
s_add_u32 m0,s63,14336
s_add_u32 s65,s58,286720
buffer_load_dwordx4 v6,s[4:7],s65 offen lds
s_add_u32 m0,s63,15360
s_add_u32 s65,s58,307200
buffer_load_dwordx4 v6,s[4:7],s65 offen lds
s_add_u32 m0,s63,16384
s_add_u32 s65,s58,327680
buffer_load_dwordx4 v6,s[4:7],s65 offen lds
s_add_u32 m0,s63,17408
s_add_u32 s65,s58,348160
buffer_load_dwordx4 v6,s[4:7],s65 offen lds
s_add_u32 m0,s63,18432
s_add_u32 s65,s58,368640
buffer_load_dwordx4 v6,s[4:7],s65 offen lds
s_add_u32 m0,s63,19456
s_add_u32 s65,s58,389120
buffer_load_dwordx4 v6,s[4:7],s65 offen lds
s_add_u32 m0,s63,20480
s_add_u32 s65,s58,409600
buffer_load_dwordx4 v6,s[4:7],s65 offen lds
s_add_u32 m0,s63,21504
s_add_u32 s65,s58,430080
buffer_load_dwordx4 v6,s[4:7],s65 offen lds
s_add_u32 m0,s63,22528
s_add_u32 s65,s58,450560
buffer_load_dwordx4 v6,s[4:7],s65 offen lds
s_add_u32 m0,s63,23552
s_add_u32 s65,s58,471040
buffer_load_dwordx4 v6,s[4:7],s65 offen lds
s_add_u32 m0,s63,24576
s_add_u32 s65,s58,491520
buffer_load_dwordx4 v6,s[4:7],s65 offen lds
s_add_u32 m0,s63,25600
s_add_u32 s65,s58,512000
buffer_load_dwordx4 v6,s[4:7],s65 offen lds
s_add_u32 m0,s63,26624
s_add_u32 s65,s58,532480
buffer_load_dwordx4 v6,s[4:7],s65 offen lds
s_add_u32 m0,s63,27648
s_add_u32 s65,s58,552960
buffer_load_dwordx4 v6,s[4:7],s65 offen lds
s_add_u32 m0,s63,28672
s_add_u32 s65,s58,573440
buffer_load_dwordx4 v6,s[4:7],s65 offen lds
s_add_u32 m0,s63,29696
s_add_u32 s65,s58,593920
buffer_load_dwordx4 v6,s[4:7],s65 offen lds
s_add_u32 m0,s63,30720
s_add_u32 s65,s58,614400
buffer_load_dwordx4 v6,s[4:7],s65 offen lds
s_add_u32 m0,s63,31744
s_add_u32 s65,s58,634880
buffer_load_dwordx4 v6,s[4:7],s65 offen lds
s_add_u32 m0,s63,32768
s_add_u32 s65,s58,655360
buffer_load_dwordx4 v6,s[4:7],s65 offen lds
s_add_u32 m0,s63,33792
s_add_u32 s65,s58,675840
buffer_load_dwordx4 v6,s[4:7],s65 offen lds
s_add_u32 m0,s63,34816
s_add_u32 s65,s58,696320
buffer_load_dwordx4 v6,s[4:7],s65 offen lds
s_add_u32 m0,s63,35840
s_add_u32 s65,s58,716800
buffer_load_dwordx4 v6,s[4:7],s65 offen lds
s_add_u32 m0,s63,36864
s_add_u32 s65,s58,737280
buffer_load_dwordx4 v6,s[4:7],s65 offen lds
s_add_u32 m0,s63,37888
s_add_u32 s65,s58,757760
buffer_load_dwordx4 v6,s[4:7],s65 offen lds
s_add_u32 m0,s63,38912
s_add_u32 s65,s58,778240
buffer_load_dwordx4 v6,s[4:7],s65 offen lds
s_add_u32 m0,s63,39936
s_add_u32 s65,s58,798720
buffer_load_dwordx4 v6,s[4:7],s65 offen lds
s_waitcnt vmcnt(20)
v_bfe_u32 v9,v0,2,2
v_lshrrev_b32 v10,5,v0
v_lshl_add_u32 v9,v10,2,v9
v_mul_u32_u24 v9,64,v9
v_and_b32 v10,1,v0
v_lshl_add_u32 v9,v10,3,v9
v_bfe_u32 v10,v0,1,1
v_lshl_add_u32 v9,v10,5,v9
v_bfe_u32 v10,v0,4,1
v_lshl_add_u32 v9,v10,4,v9
v_add_u32 v7,s63,v9
ds_read_b64_tr_b16 a[0:1],v7 offset:0
ds_read_b64_tr_b16 a[2:3],v7 offset:1024
ds_read_b64_tr_b16 a[4:5],v7 offset:512
ds_read_b64_tr_b16 a[6:7],v7 offset:1536
ds_read_b64_tr_b16 a[8:9],v7 offset:2048
ds_read_b64_tr_b16 a[10:11],v7 offset:3072
ds_read_b64_tr_b16 a[12:13],v7 offset:2560
ds_read_b64_tr_b16 a[14:15],v7 offset:3584
ds_read_b64_tr_b16 a[16:17],v7 offset:4096
ds_read_b64_tr_b16 a[18:19],v7 offset:5120
ds_read_b64_tr_b16 a[20:21],v7 offset:4608
ds_read_b64_tr_b16 a[22:23],v7 offset:5632
s_waitcnt lgkmcnt(4)
ds_read_b64_tr_b16 a[24:25],v7 offset:6144
ds_read_b64_tr_b16 a[26:27],v7 offset:7168
ds_read_b64_tr_b16 a[28:29],v7 offset:6656
ds_read_b64_tr_b16 a[30:31],v7 offset:7680
ds_read_b64_tr_b16 a[32:33],v7 offset:8192
ds_read_b64_tr_b16 a[34:35],v7 offset:9216
ds_read_b64_tr_b16 a[36:37],v7 offset:8704
ds_read_b64_tr_b16 a[38:39],v7 offset:9728
ds_read_b64_tr_b16 a[40:41],v7 offset:10240
ds_read_b64_tr_b16 a[42:43],v7 offset:11264
ds_read_b64_tr_b16 a[44:45],v7 offset:10752
ds_read_b64_tr_b16 a[46:47],v7 offset:11776
s_waitcnt lgkmcnt(4)
ds_read_b64_tr_b16 a[48:49],v7 offset:12288
ds_read_b64_tr_b16 a[50:51],v7 offset:13312
ds_read_b64_tr_b16 a[52:53],v7 offset:12800
ds_read_b64_tr_b16 a[54:55],v7 offset:13824
ds_read_b64_tr_b16 a[56:57],v7 offset:14336
ds_read_b64_tr_b16 a[58:59],v7 offset:15360
ds_read_b64_tr_b16 a[60:61],v7 offset:14848
ds_read_b64_tr_b16 a[62:63],v7 offset:15872
ds_read_b64_tr_b16 a[64:65],v7 offset:16384
ds_read_b64_tr_b16 a[66:67],v7 offset:17408
ds_read_b64_tr_b16 a[68:69],v7 offset:16896
ds_read_b64_tr_b16 a[70:71],v7 offset:17920
s_waitcnt lgkmcnt(4)
ds_read_b64_tr_b16 a[72:73],v7 offset:18432
ds_read_b64_tr_b16 a[74:75],v7 offset:19456
ds_read_b64_tr_b16 a[76:77],v7 offset:18944
ds_read_b64_tr_b16 a[78:79],v7 offset:19968
s_waitcnt lgkmcnt(0)
s_waitcnt vmcnt(0)
v_bfe_u32 v9,v0,2,2
v_lshrrev_b32 v10,5,v0
v_lshl_add_u32 v9,v10,2,v9
v_mul_u32_u24 v9,64,v9
v_and_b32 v10,1,v0
v_lshl_add_u32 v9,v10,3,v9
v_bfe_u32 v10,v0,1,1
v_lshl_add_u32 v9,v10,5,v9
v_bfe_u32 v10,v0,4,1
v_lshl_add_u32 v9,v10,4,v9
v_add_u32 v7,s63,v9
ds_read_b64_tr_b16 a[80:81],v7 offset:20480
ds_read_b64_tr_b16 a[82:83],v7 offset:21504
ds_read_b64_tr_b16 a[84:85],v7 offset:20992
ds_read_b64_tr_b16 a[86:87],v7 offset:22016
ds_read_b64_tr_b16 a[88:89],v7 offset:22528
ds_read_b64_tr_b16 a[90:91],v7 offset:23552
ds_read_b64_tr_b16 a[92:93],v7 offset:23040
ds_read_b64_tr_b16 a[94:95],v7 offset:24064
ds_read_b64_tr_b16 a[96:97],v7 offset:24576
ds_read_b64_tr_b16 a[98:99],v7 offset:25600
ds_read_b64_tr_b16 a[100:101],v7 offset:25088
ds_read_b64_tr_b16 a[102:103],v7 offset:26112
s_waitcnt lgkmcnt(4)
ds_read_b64_tr_b16 a[104:105],v7 offset:26624
ds_read_b64_tr_b16 a[106:107],v7 offset:27648
ds_read_b64_tr_b16 a[108:109],v7 offset:27136
ds_read_b64_tr_b16 a[110:111],v7 offset:28160
ds_read_b64_tr_b16 a[112:113],v7 offset:28672
ds_read_b64_tr_b16 a[114:115],v7 offset:29696
ds_read_b64_tr_b16 a[116:117],v7 offset:29184
ds_read_b64_tr_b16 a[118:119],v7 offset:30208
ds_read_b64_tr_b16 a[120:121],v7 offset:30720
ds_read_b64_tr_b16 a[122:123],v7 offset:31744
ds_read_b64_tr_b16 a[124:125],v7 offset:31232
ds_read_b64_tr_b16 a[126:127],v7 offset:32256
s_waitcnt lgkmcnt(4)
ds_read_b64_tr_b16 a[128:129],v7 offset:32768
ds_read_b64_tr_b16 a[130:131],v7 offset:33792
ds_read_b64_tr_b16 a[132:133],v7 offset:33280
ds_read_b64_tr_b16 a[134:135],v7 offset:34304
ds_read_b64_tr_b16 a[136:137],v7 offset:34816
ds_read_b64_tr_b16 a[138:139],v7 offset:35840
ds_read_b64_tr_b16 a[140:141],v7 offset:35328
ds_read_b64_tr_b16 a[142:143],v7 offset:36352
ds_read_b64_tr_b16 a[144:145],v7 offset:36864
ds_read_b64_tr_b16 a[146:147],v7 offset:37888
ds_read_b64_tr_b16 a[148:149],v7 offset:37376
ds_read_b64_tr_b16 a[150:151],v7 offset:38400
s_waitcnt lgkmcnt(4)
ds_read_b64_tr_b16 a[152:153],v7 offset:38912
ds_read_b64_tr_b16 a[154:155],v7 offset:39936
ds_read_b64_tr_b16 a[156:157],v7 offset:39424
ds_read_b64_tr_b16 a[158:159],v7 offset:40448
s_waitcnt lgkmcnt(0)
s_barrier
s_lshl_b32 s3,s49,2
v_mov_b32 v7,s3
s_nop 1
ibw_333:
buffer_load_dword v6,v7,s[12:15],0 offen sc1
s_waitcnt vmcnt(0)
v_cmp_ne_u32 vcc,256,v6
s_nop 0
s_cbranch_vccz ok_334
s_sleep 8
s_sub_u32 s47,s47,1
s_cbranch_scc1 ABORT
s_branch ibw_333
ok_334:
s_cmp_lg_u32 s49,0
s_cbranch_scc1 ibok_335
v_and_b32 v7,7,v0
v_lshlrev_b32 v7,2,v7
buffer_load_dword v6,v7,s[12:15],0 offen offset:32 sc1
s_waitcnt vmcnt(0)
v_cmp_ne_u32 vcc,32,v6
s_nop 0
s_cbranch_vccz ibok_335
s_barrier
s_mov_b32 s49,1
s_mov_b32 s3,s2
s_load_dwordx16 s[16:31],s[0:1],0
s_load_dwordx8 s[32:39],s[0:1],64
s_waitcnt lgkmcnt(0)
s_branch DISPATCH
ibok_335:
s_mov_b32 s50,0
s_mov_b32 s32,0
s_mov_b32 s57,0
s_mov_b32 s59,2147483648
s_mov_b32 s82,2147483648
s_mov_b32 s39,2147483648
v_mov_b32 v22,83968
v_mov_b32 v23,0
ds_write_b32 v22,v23
s_mov_b32 s39,1600000
v_and_b32 v72,15,v0
v_lshlrev_b32 v72,7,v72
s_mul_i32 s60,s56,-1792
s_add_u32 s60,s60,40960
v_and_b32 v6,128,v72
v_add_u32 v6,s60,v6
v_cmp_lt_u32 vcc,15,v0
s_nop 1
v_cndmask_b32 v72,v72,v6,vcc
s_waitcnt lgkmcnt(0)
s_barrier
s_mov_b32 s83,s100
s_min_u32 s62,s32,127
s_sub_u32 s60,s62,15
s_lshr_b32 s34,s60,1
s_and_b32 s33,s60,1
s_cmp_eq_u32 s33,0
s_cselect_b32 s61,15,0
s_add_u32 s34,s34,s61
s_sub_u32 s61,s60,49
s_cmp_ge_u32 s60,98
s_cselect_b32 s34,s61,s34
s_cselect_b32 s33,1,s33
s_cmp_lt_u32 s62,15
s_cselect_b32 s34,s62,s34
s_cselect_b32 s33,0,s33
s_add_u32 s60,s34,1
s_min_u32 s60,s60,63
s_lshl_b32 s35,s33,6
s_add_u32 s35,s35,s60
s_lshl_b32 s35,s35,9
s_add_u32 s35,s35,458752
s_sub_u32 s57,40960,s57
v_swap_b32 v16,v18
v_swap_b32 v17,v19
s_mov_b32 s50,-1
s_nop 0
W2_COLD:
s_mov_b32 s37,0
fb_336:
buffer_load_dword v3,v2,s[8:11],s35 offen sc1
s_waitcnt vmcnt(0)
v_cmp_eq_u32 vcc,0,v3
s_nop 0
s_cbranch_vccz ok_337
s_sleep 2
s_sub_u32 s47,s47,1
s_cbranch_scc1 ABORT
s_branch fb_336
ok_337:
s_sub_u32 s66,40960,s57
s_mul_i32 s60,s33,66
s_add_u32 s60,s60,s34
s_mul_i32 s60,s60,40960
s_add_u32 s60,s60,s37
s_mul_i32 s61,s46,10240
s_add_u32 s60,s60,s61
s_add_u32 s60,s60,237371392
s_add_u32 s61,s61,s66
s_add_u32 m0,s61,0
s_add_u32 s63,s60,0
buffer_load_dwordx4 v112,s[8:11],s63 offen sc1 lds
s_add_u32 m0,s61,1024
s_add_u32 s63,s60,0
buffer_load_dwordx4 v113,s[8:11],s63 offen sc1 lds
s_add_u32 m0,s61,2048
s_add_u32 s63,s60,2048
buffer_load_dwordx4 v112,s[8:11],s63 offen sc1 lds
s_add_u32 m0,s61,3072
s_add_u32 s63,s60,2048
buffer_load_dwordx4 v113,s[8:11],s63 offen sc1 lds
s_add_u32 m0,s61,4096
s_add_u32 s63,s60,4096
buffer_load_dwordx4 v112,s[8:11],s63 offen sc1 lds
s_add_u32 m0,s61,5120
s_add_u32 s63,s60,4096
buffer_load_dwordx4 v113,s[8:11],s63 offen sc1 lds
s_add_u32 m0,s61,6144
s_add_u32 s63,s60,6144
buffer_load_dwordx4 v112,s[8:11],s63 offen sc1 lds
s_add_u32 m0,s61,7168
s_add_u32 s63,s60,6144
buffer_load_dwordx4 v113,s[8:11],s63 offen sc1 lds
s_add_u32 m0,s61,8192
s_add_u32 s63,s60,8192
buffer_load_dwordx4 v112,s[8:11],s63 offen sc1 lds
s_add_u32 m0,s61,9216
s_add_u32 s63,s60,8192
buffer_load_dwordx4 v113,s[8:11],s63 offen sc1 lds
s_mov_b32 s55,1
W2_NEXT:
s_add_u32 s50,s50,1
s_sub_u32 s57,40960,s57
v_swap_b32 v16,v18
v_swap_b32 v17,v19
s_mov_b32 s51,s33
s_mov_b32 s52,s34
s_add_u32 s32,s32,1
s_min_u32 s62,s32,127
s_sub_u32 s60,s62,15
s_lshr_b32 s34,s60,1
s_and_b32 s33,s60,1
s_cmp_eq_u32 s33,0
s_cselect_b32 s61,15,0
s_add_u32 s34,s34,s61
s_sub_u32 s61,s60,49
s_cmp_ge_u32 s60,98
s_cselect_b32 s34,s61,s34
s_cselect_b32 s33,1,s33
s_cmp_lt_u32 s62,15
s_cselect_b32 s34,s62,s34
s_cselect_b32 s33,0,s33
s_add_u32 s60,s34,1
s_min_u32 s60,s60,63
s_lshl_b32 s35,s33,6
s_add_u32 s35,s35,s60
s_lshl_b32 s35,s35,9
s_add_u32 s35,s35,458752
s_waitcnt vmcnt(3)
s_cmp_eq_u32 s55,0
s_cbranch_scc1 wv_338
s_waitcnt vmcnt(0)
wv_338:
s_barrier
ds_read_b128 v[24:27],v16 offset:0
ds_read_b128 v[28:31],v17 offset:0
ds_read_b128 v[32:35],v16 offset:2048
ds_read_b128 v[36:39],v17 offset:2048
ds_read_b128 v[40:43],v16 offset:4096
ds_read_b128 v[44:47],v17 offset:4096
ds_read_b128 v[48:51],v16 offset:6144
buffer_load_dword v3,v2,s[8:11],s35 offen sc1
s_waitcnt lgkmcnt(6)
v_mfma_f32_32x32x16_bf16 v[56:71],a[0:3],v[24:27],0
ds_read_b128 v[52:55],v17 offset:6144
s_lshl_b32 s60,s51,6
s_add_u32 s60,s60,s52
s_mul_i32 s60,s60,46080
s_waitcnt lgkmcnt(6)
v_mfma_f32_32x32x16_bf16 v[56:71],a[4:7],v[28:31],v[56:71]
ds_read_b128 v[24:27],v16 offset:8192
s_lshl_b32 s61,s56,11
s_add_u32 s60,s60,s61
s_add_u32 s60,s60,223608832
s_waitcnt lgkmcnt(5)
v_mfma_f32_32x32x16_bf16 v[56:71],a[8:11],v[32:35],v[56:71]
ds_read_b128 v[28:31],v17 offset:8192
buffer_load_dwordx4 v[120:123],v116,s[8:11],s60 offen sc1
buffer_load_dwordx4 v[124:127],v117,s[8:11],s60 offen sc1
v_mfma_f32_32x32x16_bf16 v[56:71],a[12:15],v[36:39],v[56:71]
ds_read_b128 v[32:35],v16 offset:10240
s_lshl_b32 s62,s51,6
s_add_u32 s62,s62,s52
s_mul_i32 s62,s62,46080
s_waitcnt lgkmcnt(5)
v_mfma_f32_32x32x16_bf16 v[56:71],a[16:19],v[40:43],v[56:71]
ds_read_b128 v[36:39],v17 offset:10240
s_lshl_b32 s63,s56,11
s_add_u32 s62,s62,s63
s_add_u32 s62,s62,212467712
v_mfma_f32_32x32x16_bf16 v[56:71],a[20:23],v[44:47],v[56:71]
ds_read_b128 v[40:43],v16 offset:12288
buffer_load_dword v73,v72,s[8:11],s62 offen sc1
s_waitcnt lgkmcnt(5)
v_mfma_f32_32x32x16_bf16 v[56:71],a[24:27],v[48:51],v[56:71]
ds_read_b128 v[44:47],v17 offset:12288
v_mfma_f32_32x32x16_bf16 v[56:71],a[28:31],v[52:55],v[56:71]
ds_read_b128 v[48:51],v16 offset:14336
s_waitcnt lgkmcnt(5)
v_mfma_f32_32x32x16_bf16 v[56:71],a[32:35],v[24:27],v[56:71]
ds_read_b128 v[52:55],v17 offset:14336
v_mfma_f32_32x32x16_bf16 v[56:71],a[36:39],v[28:31],v[56:71]
ds_read_b128 v[24:27],v16 offset:16384
s_waitcnt lgkmcnt(5)
v_mfma_f32_32x32x16_bf16 v[56:71],a[40:43],v[32:35],v[56:71]
ds_read_b128 v[28:31],v17 offset:16384
v_mfma_f32_32x32x16_bf16 v[56:71],a[44:47],v[36:39],v[56:71]
ds_read_b128 v[32:35],v16 offset:18432
s_waitcnt lgkmcnt(5)
v_mfma_f32_32x32x16_bf16 v[56:71],a[48:51],v[40:43],v[56:71]
ds_read_b128 v[36:39],v17 offset:18432
s_waitcnt vmcnt(3)
s_mov_b64 exec,1
s_cmp_lg_u32 s49,0
s_cbranch_scc0 ls_339
buffer_store_dword v5,v1,s[8:11],s59 offen sc1
s_branch ls_340
ls_339:
buffer_store_dword v5,v1,s[8:11],s59 offen
ls_340:
s_mov_b64 exec,-1
s_mov_b32 s59,2147483648
v_mfma_f32_32x32x16_bf16 v[56:71],a[52:55],v[44:47],v[56:71]
ds_read_b128 v[40:43],v16 offset:20480
v_cmp_eq_u32 vcc,0,v3
s_cmp_eq_u64 vcc,0
s_cselect_b32 s37,0,2147483648
s_waitcnt lgkmcnt(5)
v_mfma_f32_32x32x16_bf16 v[56:71],a[56:59],v[48:51],v[56:71]
ds_read_b128 v[44:47],v17 offset:20480
s_cmp_lt_u32 s32,128
s_cselect_b32 s37,s37,2147483648
s_sub_u32 s66,40960,s57
s_mul_i32 s60,s33,66
v_mfma_f32_32x32x16_bf16 v[56:71],a[60:63],v[52:55],v[56:71]
ds_read_b128 v[48:51],v16 offset:22528
s_add_u32 s60,s60,s34
s_mul_i32 s60,s60,40960
s_add_u32 s60,s60,s37
s_waitcnt lgkmcnt(5)
v_mfma_f32_32x32x16_bf16 v[56:71],a[64:67],v[24:27],v[56:71]
ds_read_b128 v[52:55],v17 offset:22528
s_mul_i32 s61,s46,10240
s_add_u32 s60,s60,s61
s_add_u32 s60,s60,237371392
s_add_u32 s61,s61,s66
v_mfma_f32_32x32x16_bf16 v[56:71],a[68:71],v[28:31],v[56:71]
ds_read_b128 v[24:27],v16 offset:24576
s_add_u32 m0,s61,0
s_add_u32 s63,s60,0
s_waitcnt lgkmcnt(5)
v_mfma_f32_32x32x16_bf16 v[56:71],a[72:75],v[32:35],v[56:71]
ds_read_b128 v[28:31],v17 offset:24576
buffer_load_dwordx4 v112,s[8:11],s63 offen sc1 lds
s_add_u32 m0,s61,1024
s_add_u32 s63,s60,0
v_mfma_f32_32x32x16_bf16 v[56:71],a[76:79],v[36:39],v[56:71]
ds_read_b128 v[32:35],v16 offset:26624
s_waitcnt lgkmcnt(5)
v_mfma_f32_32x32x16_bf16 v[56:71],a[80:83],v[40:43],v[56:71]
ds_read_b128 v[36:39],v17 offset:26624
buffer_load_dwordx4 v113,s[8:11],s63 offen sc1 lds
s_add_u32 m0,s61,2048
s_add_u32 s63,s60,2048
v_mfma_f32_32x32x16_bf16 v[56:71],a[84:87],v[44:47],v[56:71]
ds_read_b128 v[40:43],v16 offset:28672
s_waitcnt lgkmcnt(5)
v_mfma_f32_32x32x16_bf16 v[56:71],a[88:91],v[48:51],v[56:71]
ds_read_b128 v[44:47],v17 offset:28672
buffer_load_dwordx4 v112,s[8:11],s63 offen sc1 lds
s_add_u32 m0,s61,3072
s_add_u32 s63,s60,2048
v_mfma_f32_32x32x16_bf16 v[56:71],a[92:95],v[52:55],v[56:71]
ds_read_b128 v[48:51],v16 offset:30720
s_waitcnt lgkmcnt(5)
v_mfma_f32_32x32x16_bf16 v[56:71],a[96:99],v[24:27],v[56:71]
ds_read_b128 v[52:55],v17 offset:30720
buffer_load_dwordx4 v113,s[8:11],s63 offen sc1 lds
s_add_u32 m0,s61,4096
s_add_u32 s63,s60,4096
v_mfma_f32_32x32x16_bf16 v[56:71],a[100:103],v[28:31],v[56:71]
ds_read_b128 v[24:27],v16 offset:32768
s_waitcnt lgkmcnt(5)
v_mfma_f32_32x32x16_bf16 v[56:71],a[104:107],v[32:35],v[56:71]
ds_read_b128 v[28:31],v17 offset:32768
buffer_load_dwordx4 v112,s[8:11],s63 offen sc1 lds
s_add_u32 m0,s61,5120
s_add_u32 s63,s60,4096
v_mfma_f32_32x32x16_bf16 v[56:71],a[108:111],v[36:39],v[56:71]
ds_read_b128 v[32:35],v16 offset:34816
s_waitcnt lgkmcnt(5)
v_mfma_f32_32x32x16_bf16 v[56:71],a[112:115],v[40:43],v[56:71]
ds_read_b128 v[36:39],v17 offset:34816
buffer_load_dwordx4 v113,s[8:11],s63 offen sc1 lds
s_add_u32 m0,s61,6144
s_add_u32 s63,s60,6144
v_mfma_f32_32x32x16_bf16 v[56:71],a[116:119],v[44:47],v[56:71]
ds_read_b128 v[40:43],v16 offset:36864
s_waitcnt lgkmcnt(5)
v_mfma_f32_32x32x16_bf16 v[56:71],a[120:123],v[48:51],v[56:71]
ds_read_b128 v[44:47],v17 offset:36864
buffer_load_dword v3,v2,s[8:11],s35 offen sc1
v_mfma_f32_32x32x16_bf16 v[56:71],a[124:127],v[52:55],v[56:71]
ds_read_b128 v[48:51],v16 offset:38912
buffer_load_dwordx4 v112,s[8:11],s63 offen sc1 lds
s_add_u32 m0,s61,7168
s_waitcnt lgkmcnt(5)
v_mfma_f32_32x32x16_bf16 v[56:71],a[128:131],v[24:27],v[56:71]
ds_read_b128 v[52:55],v17 offset:38912
s_add_u32 s63,s60,6144
v_mfma_f32_32x32x16_bf16 v[56:71],a[132:135],v[28:31],v[56:71]
buffer_load_dwordx4 v113,s[8:11],s63 offen sc1 lds
s_add_u32 m0,s61,8192
s_add_u32 s63,s60,8192
s_waitcnt lgkmcnt(4)
v_mfma_f32_32x32x16_bf16 v[56:71],a[136:139],v[32:35],v[56:71]
v_mfma_f32_32x32x16_bf16 v[56:71],a[140:143],v[36:39],v[56:71]
buffer_load_dwordx4 v112,s[8:11],s63 offen sc1 lds
s_add_u32 m0,s61,9216
s_add_u32 s63,s60,8192
s_waitcnt lgkmcnt(2)
v_mfma_f32_32x32x16_bf16 v[56:71],a[144:147],v[40:43],v[56:71]
v_mfma_f32_32x32x16_bf16 v[56:71],a[148:151],v[44:47],v[56:71]
buffer_load_dwordx4 v113,s[8:11],s63 offen sc1 lds
s_waitcnt lgkmcnt(0)
v_mfma_f32_32x32x16_bf16 v[56:71],a[152:155],v[48:51],v[56:71]
v_mfma_f32_32x32x16_bf16 v[56:71],a[156:159],v[52:55],v[56:71]
s_mov_b32 s55,0
s_cmp_eq_u32 s37,0
s_cbranch_scc1 ep_341
s_waitcnt vmcnt(0)
v_cmp_eq_u32 vcc,0,v3
s_cmp_eq_u64 vcc,0
s_cselect_b32 s37,0,2147483648
s_cmp_lt_u32 s32,128
s_cselect_b32 s37,s37,2147483648
s_cmp_lg_u32 s37,0
s_cbranch_scc1 ep_341
s_sub_u32 s66,40960,s57
s_mul_i32 s60,s33,66
s_add_u32 s60,s60,s34
s_mul_i32 s60,s60,40960
s_add_u32 s60,s60,s37
s_mul_i32 s61,s46,10240
s_add_u32 s60,s60,s61
s_add_u32 s60,s60,237371392
s_add_u32 s61,s61,s66
s_add_u32 m0,s61,0
s_add_u32 s63,s60,0
buffer_load_dwordx4 v112,s[8:11],s63 offen sc1 lds
s_add_u32 m0,s61,1024
s_add_u32 s63,s60,0
buffer_load_dwordx4 v113,s[8:11],s63 offen sc1 lds
s_add_u32 m0,s61,2048
s_add_u32 s63,s60,2048
buffer_load_dwordx4 v112,s[8:11],s63 offen sc1 lds
s_add_u32 m0,s61,3072
s_add_u32 s63,s60,2048
buffer_load_dwordx4 v113,s[8:11],s63 offen sc1 lds
s_add_u32 m0,s61,4096
s_add_u32 s63,s60,4096
buffer_load_dwordx4 v112,s[8:11],s63 offen sc1 lds
s_add_u32 m0,s61,5120
s_add_u32 s63,s60,4096
buffer_load_dwordx4 v113,s[8:11],s63 offen sc1 lds
s_add_u32 m0,s61,6144
s_add_u32 s63,s60,6144
buffer_load_dwordx4 v112,s[8:11],s63 offen sc1 lds
s_add_u32 m0,s61,7168
s_add_u32 s63,s60,6144
buffer_load_dwordx4 v113,s[8:11],s63 offen sc1 lds
s_add_u32 m0,s61,8192
s_add_u32 s63,s60,8192
buffer_load_dwordx4 v112,s[8:11],s63 offen sc1 lds
s_add_u32 m0,s61,9216
s_add_u32 s63,s60,8192
buffer_load_dwordx4 v113,s[8:11],s63 offen sc1 lds
ep_341:
s_nop 7
s_waitcnt vmcnt(12)
v_lshlrev_b32 v128,16,v120
v_and_b32 v129,0xffff0000,v120
v_lshlrev_b32 v130,16,v121
v_and_b32 v131,0xffff0000,v121
v_lshlrev_b32 v132,16,v122
v_and_b32 v133,0xffff0000,v122
v_lshlrev_b32 v134,16,v123
v_and_b32 v135,0xffff0000,v123
v_lshlrev_b32 v136,16,v124
v_and_b32 v137,0xffff0000,v124
v_lshlrev_b32 v138,16,v125
v_and_b32 v139,0xffff0000,v125
v_lshlrev_b32 v140,16,v126
v_and_b32 v141,0xffff0000,v126
v_lshlrev_b32 v142,16,v127
v_and_b32 v143,0xffff0000,v127
s_lshl_b32 s62,s51,6
s_add_u32 s62,s62,s52
s_mul_i32 s62,s62,46080
s_add_u32 s62,s62,212467712
s_lshl_b32 s63,s56,8
s_add_u32 s63,s63,s62
s_add_u32 s63,s63,40960
s_lshl_b32 s64,s56,11
s_add_u32 s62,s62,s64
v_cvt_pk_bf16_f32 v6,v56,v57
v_lshlrev_b32 v56,16,v6
v_and_b32 v57,0xffff0000,v6
v_cvt_pk_bf16_f32 v6,v58,v59
v_lshlrev_b32 v58,16,v6
v_and_b32 v59,0xffff0000,v6
v_cvt_pk_bf16_f32 v6,v60,v61
v_lshlrev_b32 v60,16,v6
v_and_b32 v61,0xffff0000,v6
v_cvt_pk_bf16_f32 v6,v62,v63
v_lshlrev_b32 v62,16,v6
v_and_b32 v63,0xffff0000,v6
v_cvt_pk_bf16_f32 v6,v64,v65
v_lshlrev_b32 v64,16,v6
v_and_b32 v65,0xffff0000,v6
v_cvt_pk_bf16_f32 v6,v66,v67
v_lshlrev_b32 v66,16,v6
v_and_b32 v67,0xffff0000,v6
v_cvt_pk_bf16_f32 v6,v68,v69
v_lshlrev_b32 v68,16,v6
v_and_b32 v69,0xffff0000,v6
v_cvt_pk_bf16_f32 v6,v70,v71
v_lshlrev_b32 v70,16,v6
v_and_b32 v71,0xffff0000,v6
v_pk_add_f32 v[56:57],v[56:57],v[128:129]
v_pk_add_f32 v[58:59],v[58:59],v[130:131]
v_pk_add_f32 v[60:61],v[60:61],v[132:133]
v_pk_add_f32 v[62:63],v[62:63],v[134:135]
v_pk_add_f32 v[64:65],v[64:65],v[136:137]
v_pk_add_f32 v[66:67],v[66:67],v[138:139]
v_pk_add_f32 v[68:69],v[68:69],v[140:141]
v_pk_add_f32 v[70:71],v[70:71],v[142:143]
v_cvt_pk_bf16_f32 v144,v56,v57
v_lshlrev_b32 v56,16,v144
v_and_b32 v57,0xffff0000,v144
v_cvt_pk_bf16_f32 v145,v58,v59
v_lshlrev_b32 v58,16,v145
v_and_b32 v59,0xffff0000,v145
v_cvt_pk_bf16_f32 v146,v60,v61
v_lshlrev_b32 v60,16,v146
v_and_b32 v61,0xffff0000,v146
v_cvt_pk_bf16_f32 v147,v62,v63
v_lshlrev_b32 v62,16,v147
v_and_b32 v63,0xffff0000,v147
v_cvt_pk_bf16_f32 v148,v64,v65
v_lshlrev_b32 v64,16,v148
v_and_b32 v65,0xffff0000,v148
v_cvt_pk_bf16_f32 v149,v66,v67
v_lshlrev_b32 v66,16,v149
v_and_b32 v67,0xffff0000,v149
v_cvt_pk_bf16_f32 v150,v68,v69
v_lshlrev_b32 v68,16,v150
v_and_b32 v69,0xffff0000,v150
v_cvt_pk_bf16_f32 v151,v70,v71
v_lshlrev_b32 v70,16,v151
v_and_b32 v71,0xffff0000,v151
s_cmp_lg_u32 s49,0
s_cbranch_scc0 ls_342
buffer_store_dwordx4 v[144:147],v20,s[8:11],s62 offen sc1
buffer_store_dwordx4 v[148:151],v21,s[8:11],s62 offen sc1
s_branch ls_343
ls_342:
buffer_store_dwordx4 v[144:147],v20,s[8:11],s62 offen
buffer_store_dwordx4 v[148:151],v21,s[8:11],s62 offen
ls_343:
v_pk_add_f32 v[6:7],v[56:57],v[58:59]
v_pk_mul_f32 v[8:9],v[56:57],v[56:57]
v_pk_fma_f32 v[8:9],v[58:59],v[58:59],v[8:9]
v_pk_add_f32 v[6:7],v[6:7],v[60:61]
v_pk_fma_f32 v[8:9],v[60:61],v[60:61],v[8:9]
v_pk_add_f32 v[6:7],v[6:7],v[62:63]
v_pk_fma_f32 v[8:9],v[62:63],v[62:63],v[8:9]
v_pk_add_f32 v[6:7],v[6:7],v[64:65]
v_pk_fma_f32 v[8:9],v[64:65],v[64:65],v[8:9]
v_pk_add_f32 v[6:7],v[6:7],v[66:67]
v_pk_fma_f32 v[8:9],v[66:67],v[66:67],v[8:9]
v_pk_add_f32 v[6:7],v[6:7],v[68:69]
v_pk_fma_f32 v[8:9],v[68:69],v[68:69],v[8:9]
v_pk_add_f32 v[6:7],v[6:7],v[70:71]
v_pk_fma_f32 v[8:9],v[70:71],v[70:71],v[8:9]
v_add_f32 v6,v6,v7
v_add_f32 v7,v8,v9
v_mov_b32 v8,v6
v_mov_b32 v9,v7
s_nop 0
v_permlane32_swap_b32 v6,v8
v_permlane32_swap_b32 v7,v9
v_pk_add_f32 v[6:7],v[6:7],v[8:9]
s_mov_b32 exec_hi,0
s_cmp_lg_u32 s49,0
s_cbranch_scc0 ls_344
buffer_store_dwordx2 v[6:7],v114,s[8:11],s63 offen sc1
s_branch ls_345
ls_344:
buffer_store_dwordx2 v[6:7],v114,s[8:11],s63 offen
ls_345:
s_mov_b32 exec_hi,-1
s_lshl_b32 s82,s51,6
s_add_u32 s82,s82,s52
s_lshl_b32 s82,s82,9
s_add_u32 s82,s82,524288
s_lshl_b32 s61,s56,2
s_add_u32 s82,s82,s61
s_mov_b32 s59,s82
s_cmp_eq_u32 s37,0
s_cbranch_scc1 W2_NEXT
s_waitcnt vmcnt(0)
s_mov_b64 exec,1
s_cmp_lg_u32 s49,0
s_cbranch_scc0 ls_346
buffer_store_dword v5,v1,s[8:11],s59 offen sc1
s_branch ls_347
ls_346:
buffer_store_dword v5,v1,s[8:11],s59 offen
ls_347:
s_mov_b64 exec,-1
s_mov_b32 s59,2147483648
s_cmp_lt_u32 s32,128
s_cbranch_scc1 W2_COLD
W2_END:
s_endpgm
ROLE_W3:
v_lshlrev_b32 v1,4,v0
v_mov_b32 v5,1
s_lshl_b32 s56,s48,2
s_add_u32 s56,s56,s46
v_bfe_u32 v6,v0,2,2
v_lshrrev_b32 v7,4,v0
v_add_u32 v7,v6,v7
v_and_b32 v7,3,v7
v_and_b32 v15,3,v0
v_lshlrev_b32 v15,4,v15
v_lshl_add_u32 v15,v7,6,v15
v_lshl_add_u32 v15,v6,8,v15
v_lshrrev_b32 v6,5,v0
v_bfe_u32 v7,v0,4,1
v_lshlrev_b32 v16,10,v7
v_lshl_add_u32 v16,v6,8,v16
v_and_b32 v6,15,v0
v_lshl_add_u32 v16,v6,4,v16
v_add_u32 v18,46080,v16
v_lshrrev_b32 v6,5,v0
v_bfe_u32 v7,v0,4,1
v_lshlrev_b32 v20,10,v7
v_lshl_add_u32 v20,v6,8,v20
v_and_b32 v6,15,v0
v_lshl_add_u32 v20,v6,4,v20
v_lshrrev_b32 v6,5,v0
v_add_u32 v6,2,v6
v_bfe_u32 v7,v0,4,1
v_lshlrev_b32 v17,10,v7
v_lshl_add_u32 v17,v6,8,v17
v_and_b32 v6,15,v0
v_lshl_add_u32 v17,v6,4,v17
v_add_u32 v19,46080,v17
v_lshrrev_b32 v6,5,v0
v_add_u32 v6,2,v6
v_bfe_u32 v7,v0,4,1
v_lshlrev_b32 v21,10,v7
v_lshl_add_u32 v21,v6,8,v21
v_and_b32 v6,15,v0
v_lshl_add_u32 v21,v6,4,v21
v_min_u32 v2,19,v0
v_lshlrev_b32 v2,2,v2
v_mov_b32 v112,0xc0135761
v_mov_b32 v113,0xbdd2d3e8
s_mov_b32 s68,0xbdd2d3e8
v_lshrrev_b32 v6,5,v0
v_mul_u32_u24 v182,2560,v6
v_and_b32 v6,31,v0
v_lshl_add_u32 v182,v6,3,v182
v_add_u32 v182,0xa000,v182
s_waitcnt vmcnt(0)
s_barrier
s_cmp_lg_u32 s46,0
s_cbranch_scc1 arr_348
v_mov_b32 v6,1
s_lshl_b32 s3,s49,2
v_mov_b32 v7,s3
s_mov_b64 exec,1
buffer_atomic_add v6,v7,s[12:15],0 offen sc1
s_mov_b64 exec,-1
arr_348:
s_lshl_b32 s58,s56,6
s_mul_i32 s63,s46,40960
s_mov_b32 s4,s36
s_mov_b32 s5,s37
s_mov_b32 s6,1966080
s_mov_b32 s7,0x20000
v_lshrrev_b32 v9,2,v0
s_mov_b32 s64,3072
v_mul_lo_u32 v9,v9,s64
v_and_b32 v10,3,v0
v_lshl_add_u32 v6,v10,4,v9
s_add_u32 m0,s63,0
s_add_u32 s65,s58,0
buffer_load_dwordx4 v6,s[4:7],s65 offen lds
s_add_u32 m0,s63,1024
s_add_u32 s65,s58,49152
buffer_load_dwordx4 v6,s[4:7],s65 offen lds
s_add_u32 m0,s63,2048
s_add_u32 s65,s58,98304
buffer_load_dwordx4 v6,s[4:7],s65 offen lds
s_add_u32 m0,s63,3072
s_add_u32 s65,s58,147456
buffer_load_dwordx4 v6,s[4:7],s65 offen lds
s_add_u32 m0,s63,4096
s_add_u32 s65,s58,196608
buffer_load_dwordx4 v6,s[4:7],s65 offen lds
s_add_u32 m0,s63,5120
s_add_u32 s65,s58,245760
buffer_load_dwordx4 v6,s[4:7],s65 offen lds
s_add_u32 m0,s63,6144
s_add_u32 s65,s58,294912
buffer_load_dwordx4 v6,s[4:7],s65 offen lds
s_add_u32 m0,s63,7168
s_add_u32 s65,s58,344064
buffer_load_dwordx4 v6,s[4:7],s65 offen lds
s_add_u32 m0,s63,8192
s_add_u32 s65,s58,393216
buffer_load_dwordx4 v6,s[4:7],s65 offen lds
s_add_u32 m0,s63,9216
s_add_u32 s65,s58,442368
buffer_load_dwordx4 v6,s[4:7],s65 offen lds
s_add_u32 m0,s63,10240
s_add_u32 s65,s58,491520
buffer_load_dwordx4 v6,s[4:7],s65 offen lds
s_add_u32 m0,s63,11264
s_add_u32 s65,s58,540672
buffer_load_dwordx4 v6,s[4:7],s65 offen lds
s_add_u32 m0,s63,12288
s_add_u32 s65,s58,589824
buffer_load_dwordx4 v6,s[4:7],s65 offen lds
s_add_u32 m0,s63,13312
s_add_u32 s65,s58,638976
buffer_load_dwordx4 v6,s[4:7],s65 offen lds
s_add_u32 m0,s63,14336
s_add_u32 s65,s58,688128
buffer_load_dwordx4 v6,s[4:7],s65 offen lds
s_add_u32 m0,s63,15360
s_add_u32 s65,s58,737280
buffer_load_dwordx4 v6,s[4:7],s65 offen lds
s_add_u32 m0,s63,16384
s_add_u32 s65,s58,786432
buffer_load_dwordx4 v6,s[4:7],s65 offen lds
s_add_u32 m0,s63,17408
s_add_u32 s65,s58,835584
buffer_load_dwordx4 v6,s[4:7],s65 offen lds
s_add_u32 m0,s63,18432
s_add_u32 s65,s58,884736
buffer_load_dwordx4 v6,s[4:7],s65 offen lds
s_add_u32 m0,s63,19456
s_add_u32 s65,s58,933888
buffer_load_dwordx4 v6,s[4:7],s65 offen lds
s_add_u32 m0,s63,20480
s_add_u32 s65,s58,983040
buffer_load_dwordx4 v6,s[4:7],s65 offen lds
s_add_u32 m0,s63,21504
s_add_u32 s65,s58,1032192
buffer_load_dwordx4 v6,s[4:7],s65 offen lds
s_add_u32 m0,s63,22528
s_add_u32 s65,s58,1081344
buffer_load_dwordx4 v6,s[4:7],s65 offen lds
s_add_u32 m0,s63,23552
s_add_u32 s65,s58,1130496
buffer_load_dwordx4 v6,s[4:7],s65 offen lds
s_add_u32 m0,s63,24576
s_add_u32 s65,s58,1179648
buffer_load_dwordx4 v6,s[4:7],s65 offen lds
s_add_u32 m0,s63,25600
s_add_u32 s65,s58,1228800
buffer_load_dwordx4 v6,s[4:7],s65 offen lds
s_add_u32 m0,s63,26624
s_add_u32 s65,s58,1277952
buffer_load_dwordx4 v6,s[4:7],s65 offen lds
s_add_u32 m0,s63,27648
s_add_u32 s65,s58,1327104
buffer_load_dwordx4 v6,s[4:7],s65 offen lds
s_add_u32 m0,s63,28672
s_add_u32 s65,s58,1376256
buffer_load_dwordx4 v6,s[4:7],s65 offen lds
s_add_u32 m0,s63,29696
s_add_u32 s65,s58,1425408
buffer_load_dwordx4 v6,s[4:7],s65 offen lds
s_add_u32 m0,s63,30720
s_add_u32 s65,s58,1474560
buffer_load_dwordx4 v6,s[4:7],s65 offen lds
s_add_u32 m0,s63,31744
s_add_u32 s65,s58,1523712
buffer_load_dwordx4 v6,s[4:7],s65 offen lds
s_add_u32 m0,s63,32768
s_add_u32 s65,s58,1572864
buffer_load_dwordx4 v6,s[4:7],s65 offen lds
s_add_u32 m0,s63,33792
s_add_u32 s65,s58,1622016
buffer_load_dwordx4 v6,s[4:7],s65 offen lds
s_add_u32 m0,s63,34816
s_add_u32 s65,s58,1671168
buffer_load_dwordx4 v6,s[4:7],s65 offen lds
s_add_u32 m0,s63,35840
s_add_u32 s65,s58,1720320
buffer_load_dwordx4 v6,s[4:7],s65 offen lds
s_add_u32 m0,s63,36864
s_add_u32 s65,s58,1769472
buffer_load_dwordx4 v6,s[4:7],s65 offen lds
s_add_u32 m0,s63,37888
s_add_u32 s65,s58,1818624
buffer_load_dwordx4 v6,s[4:7],s65 offen lds
s_add_u32 m0,s63,38912
s_add_u32 s65,s58,1867776
buffer_load_dwordx4 v6,s[4:7],s65 offen lds
s_add_u32 m0,s63,39936
s_add_u32 s65,s58,1916928
buffer_load_dwordx4 v6,s[4:7],s65 offen lds
s_waitcnt vmcnt(20)
v_bfe_u32 v9,v0,2,2
v_lshrrev_b32 v10,5,v0
v_lshl_add_u32 v9,v10,2,v9
v_mul_u32_u24 v9,64,v9
v_and_b32 v10,1,v0
v_lshl_add_u32 v9,v10,3,v9
v_bfe_u32 v10,v0,1,1
v_lshl_add_u32 v9,v10,5,v9
v_bfe_u32 v10,v0,4,1
v_lshl_add_u32 v9,v10,4,v9
v_add_u32 v7,s63,v9
ds_read_b64_tr_b16 a[0:1],v7 offset:0
ds_read_b64_tr_b16 a[2:3],v7 offset:1024
ds_read_b64_tr_b16 a[4:5],v7 offset:512
ds_read_b64_tr_b16 a[6:7],v7 offset:1536
ds_read_b64_tr_b16 a[8:9],v7 offset:2048
ds_read_b64_tr_b16 a[10:11],v7 offset:3072
ds_read_b64_tr_b16 a[12:13],v7 offset:2560
ds_read_b64_tr_b16 a[14:15],v7 offset:3584
ds_read_b64_tr_b16 a[16:17],v7 offset:4096
ds_read_b64_tr_b16 a[18:19],v7 offset:5120
ds_read_b64_tr_b16 a[20:21],v7 offset:4608
ds_read_b64_tr_b16 a[22:23],v7 offset:5632
s_waitcnt lgkmcnt(4)
ds_read_b64_tr_b16 a[24:25],v7 offset:6144
ds_read_b64_tr_b16 a[26:27],v7 offset:7168
ds_read_b64_tr_b16 a[28:29],v7 offset:6656
ds_read_b64_tr_b16 a[30:31],v7 offset:7680
ds_read_b64_tr_b16 a[32:33],v7 offset:8192
ds_read_b64_tr_b16 a[34:35],v7 offset:9216
ds_read_b64_tr_b16 a[36:37],v7 offset:8704
ds_read_b64_tr_b16 a[38:39],v7 offset:9728
ds_read_b64_tr_b16 a[40:41],v7 offset:10240
ds_read_b64_tr_b16 a[42:43],v7 offset:11264
ds_read_b64_tr_b16 a[44:45],v7 offset:10752
ds_read_b64_tr_b16 a[46:47],v7 offset:11776
s_waitcnt lgkmcnt(4)
ds_read_b64_tr_b16 a[48:49],v7 offset:12288
ds_read_b64_tr_b16 a[50:51],v7 offset:13312
ds_read_b64_tr_b16 a[52:53],v7 offset:12800
ds_read_b64_tr_b16 a[54:55],v7 offset:13824
ds_read_b64_tr_b16 a[56:57],v7 offset:14336
ds_read_b64_tr_b16 a[58:59],v7 offset:15360
ds_read_b64_tr_b16 a[60:61],v7 offset:14848
ds_read_b64_tr_b16 a[62:63],v7 offset:15872
ds_read_b64_tr_b16 a[64:65],v7 offset:16384
ds_read_b64_tr_b16 a[66:67],v7 offset:17408
ds_read_b64_tr_b16 a[68:69],v7 offset:16896
ds_read_b64_tr_b16 a[70:71],v7 offset:17920
s_waitcnt lgkmcnt(4)
ds_read_b64_tr_b16 a[72:73],v7 offset:18432
ds_read_b64_tr_b16 a[74:75],v7 offset:19456
ds_read_b64_tr_b16 a[76:77],v7 offset:18944
ds_read_b64_tr_b16 a[78:79],v7 offset:19968
s_waitcnt lgkmcnt(0)
s_waitcnt vmcnt(0)
v_bfe_u32 v9,v0,2,2
v_lshrrev_b32 v10,5,v0
v_lshl_add_u32 v9,v10,2,v9
v_mul_u32_u24 v9,64,v9
v_and_b32 v10,1,v0
v_lshl_add_u32 v9,v10,3,v9
v_bfe_u32 v10,v0,1,1
v_lshl_add_u32 v9,v10,5,v9
v_bfe_u32 v10,v0,4,1
v_lshl_add_u32 v9,v10,4,v9
v_add_u32 v7,s63,v9
ds_read_b64_tr_b16 a[80:81],v7 offset:20480
ds_read_b64_tr_b16 a[82:83],v7 offset:21504
ds_read_b64_tr_b16 a[84:85],v7 offset:20992
ds_read_b64_tr_b16 a[86:87],v7 offset:22016
ds_read_b64_tr_b16 a[88:89],v7 offset:22528
ds_read_b64_tr_b16 a[90:91],v7 offset:23552
ds_read_b64_tr_b16 a[92:93],v7 offset:23040
ds_read_b64_tr_b16 a[94:95],v7 offset:24064
ds_read_b64_tr_b16 a[96:97],v7 offset:24576
ds_read_b64_tr_b16 a[98:99],v7 offset:25600
ds_read_b64_tr_b16 a[100:101],v7 offset:25088
ds_read_b64_tr_b16 a[102:103],v7 offset:26112
s_waitcnt lgkmcnt(4)
ds_read_b64_tr_b16 a[104:105],v7 offset:26624
ds_read_b64_tr_b16 a[106:107],v7 offset:27648
ds_read_b64_tr_b16 a[108:109],v7 offset:27136
ds_read_b64_tr_b16 a[110:111],v7 offset:28160
ds_read_b64_tr_b16 a[112:113],v7 offset:28672
ds_read_b64_tr_b16 a[114:115],v7 offset:29696
ds_read_b64_tr_b16 a[116:117],v7 offset:29184
ds_read_b64_tr_b16 a[118:119],v7 offset:30208
ds_read_b64_tr_b16 a[120:121],v7 offset:30720
ds_read_b64_tr_b16 a[122:123],v7 offset:31744
ds_read_b64_tr_b16 a[124:125],v7 offset:31232
ds_read_b64_tr_b16 a[126:127],v7 offset:32256
s_waitcnt lgkmcnt(4)
ds_read_b64_tr_b16 a[128:129],v7 offset:32768
ds_read_b64_tr_b16 a[130:131],v7 offset:33792
ds_read_b64_tr_b16 a[132:133],v7 offset:33280
ds_read_b64_tr_b16 a[134:135],v7 offset:34304
ds_read_b64_tr_b16 a[136:137],v7 offset:34816
ds_read_b64_tr_b16 a[138:139],v7 offset:35840
ds_read_b64_tr_b16 a[140:141],v7 offset:35328
ds_read_b64_tr_b16 a[142:143],v7 offset:36352
ds_read_b64_tr_b16 a[144:145],v7 offset:36864
ds_read_b64_tr_b16 a[146:147],v7 offset:37888
ds_read_b64_tr_b16 a[148:149],v7 offset:37376
ds_read_b64_tr_b16 a[150:151],v7 offset:38400
s_waitcnt lgkmcnt(4)
ds_read_b64_tr_b16 a[152:153],v7 offset:38912
ds_read_b64_tr_b16 a[154:155],v7 offset:39936
ds_read_b64_tr_b16 a[156:157],v7 offset:39424
ds_read_b64_tr_b16 a[158:159],v7 offset:40448
s_waitcnt lgkmcnt(0)
v_mov_b32 v24,0x3f803f80
v_mov_b32 v25,0x3f803f80
v_mov_b32 v26,0x3f803f80
v_mov_b32 v27,0x3f803f80
s_nop 1
v_mfma_f32_32x32x16_bf16 v[144:159],a[0:3],v[24:27],0
v_mfma_f32_32x32x16_bf16 v[144:159],a[4:7],v[24:27],v[144:159]
v_mfma_f32_32x32x16_bf16 v[144:159],a[8:11],v[24:27],v[144:159]
v_mfma_f32_32x32x16_bf16 v[144:159],a[12:15],v[24:27],v[144:159]
v_mfma_f32_32x32x16_bf16 v[144:159],a[16:19],v[24:27],v[144:159]
v_mfma_f32_32x32x16_bf16 v[144:159],a[20:23],v[24:27],v[144:159]
v_mfma_f32_32x32x16_bf16 v[144:159],a[24:27],v[24:27],v[144:159]
v_mfma_f32_32x32x16_bf16 v[144:159],a[28:31],v[24:27],v[144:159]
v_mfma_f32_32x32x16_bf16 v[144:159],a[32:35],v[24:27],v[144:159]
v_mfma_f32_32x32x16_bf16 v[144:159],a[36:39],v[24:27],v[144:159]
v_mfma_f32_32x32x16_bf16 v[144:159],a[40:43],v[24:27],v[144:159]
v_mfma_f32_32x32x16_bf16 v[144:159],a[44:47],v[24:27],v[144:159]
v_mfma_f32_32x32x16_bf16 v[144:159],a[48:51],v[24:27],v[144:159]
v_mfma_f32_32x32x16_bf16 v[144:159],a[52:55],v[24:27],v[144:159]
v_mfma_f32_32x32x16_bf16 v[144:159],a[56:59],v[24:27],v[144:159]
v_mfma_f32_32x32x16_bf16 v[144:159],a[60:63],v[24:27],v[144:159]
v_mfma_f32_32x32x16_bf16 v[144:159],a[64:67],v[24:27],v[144:159]
v_mfma_f32_32x32x16_bf16 v[144:159],a[68:71],v[24:27],v[144:159]
v_mfma_f32_32x32x16_bf16 v[144:159],a[72:75],v[24:27],v[144:159]
v_mfma_f32_32x32x16_bf16 v[144:159],a[76:79],v[24:27],v[144:159]
v_mfma_f32_32x32x16_bf16 v[144:159],a[80:83],v[24:27],v[144:159]
v_mfma_f32_32x32x16_bf16 v[144:159],a[84:87],v[24:27],v[144:159]
v_mfma_f32_32x32x16_bf16 v[144:159],a[88:91],v[24:27],v[144:159]
v_mfma_f32_32x32x16_bf16 v[144:159],a[92:95],v[24:27],v[144:159]
v_mfma_f32_32x32x16_bf16 v[144:159],a[96:99],v[24:27],v[144:159]
v_mfma_f32_32x32x16_bf16 v[144:159],a[100:103],v[24:27],v[144:159]
v_mfma_f32_32x32x16_bf16 v[144:159],a[104:107],v[24:27],v[144:159]
v_mfma_f32_32x32x16_bf16 v[144:159],a[108:111],v[24:27],v[144:159]
v_mfma_f32_32x32x16_bf16 v[144:159],a[112:115],v[24:27],v[144:159]
v_mfma_f32_32x32x16_bf16 v[144:159],a[116:119],v[24:27],v[144:159]
v_mfma_f32_32x32x16_bf16 v[144:159],a[120:123],v[24:27],v[144:159]
v_mfma_f32_32x32x16_bf16 v[144:159],a[124:127],v[24:27],v[144:159]
v_mfma_f32_32x32x16_bf16 v[144:159],a[128:131],v[24:27],v[144:159]
v_mfma_f32_32x32x16_bf16 v[144:159],a[132:135],v[24:27],v[144:159]
v_mfma_f32_32x32x16_bf16 v[144:159],a[136:139],v[24:27],v[144:159]
v_mfma_f32_32x32x16_bf16 v[144:159],a[140:143],v[24:27],v[144:159]
v_mfma_f32_32x32x16_bf16 v[144:159],a[144:147],v[24:27],v[144:159]
v_mfma_f32_32x32x16_bf16 v[144:159],a[148:151],v[24:27],v[144:159]
v_mfma_f32_32x32x16_bf16 v[144:159],a[152:155],v[24:27],v[144:159]
v_mfma_f32_32x32x16_bf16 v[144:159],a[156:159],v[24:27],v[144:159]
s_barrier
s_lshl_b32 s3,s49,2
v_mov_b32 v7,s3
s_nop 8
ibw_349:
buffer_load_dword v6,v7,s[12:15],0 offen sc1
s_waitcnt vmcnt(0)
v_cmp_ne_u32 vcc,256,v6
s_nop 0
s_cbranch_vccz ok_350
s_sleep 8
s_sub_u32 s47,s47,1
s_cbranch_scc1 ABORT
s_branch ibw_349
ok_350:
s_cmp_lg_u32 s49,0
s_cbranch_scc1 ibok_351
v_and_b32 v7,7,v0
v_lshlrev_b32 v7,2,v7
buffer_load_dword v6,v7,s[12:15],0 offen offset:32 sc1
s_waitcnt vmcnt(0)
v_cmp_ne_u32 vcc,32,v6
s_nop 0
s_cbranch_vccz ibok_351
s_barrier
s_mov_b32 s49,1
s_mov_b32 s3,s2
s_load_dwordx16 s[16:31],s[0:1],0
s_load_dwordx8 s[32:39],s[0:1],64
s_waitcnt lgkmcnt(0)
s_branch DISPATCH
ibok_351:
s_mov_b32 s50,0
s_mov_b32 s32,0
s_mov_b32 s57,0
s_mov_b32 s59,2147483648
s_mov_b32 s82,2147483648
s_mov_b32 s39,2147483648
v_mov_b32 v22,94208
v_mov_b32 v23,0
ds_write_b32 v22,v23
s_mov_b32 s39,1600000
v_and_b32 v72,15,v0
v_lshlrev_b32 v72,7,v72
s_waitcnt lgkmcnt(0)
s_barrier
s_mov_b32 s83,s100
s_min_u32 s62,s32,127
s_sub_u32 s60,s62,15
s_lshr_b32 s34,s60,1
s_and_b32 s33,s60,1
s_cmp_eq_u32 s33,0
s_cselect_b32 s61,15,0
s_add_u32 s34,s34,s61
s_sub_u32 s61,s60,49
s_cmp_ge_u32 s60,98
s_cselect_b32 s34,s61,s34
s_cselect_b32 s33,1,s33
s_cmp_lt_u32 s62,15
s_cselect_b32 s34,s62,s34
s_cselect_b32 s33,0,s33
s_lshl_b32 s35,s33,6
s_add_u32 s35,s35,s34
s_lshl_b32 s35,s35,9
s_add_u32 s35,s35,524288
s_sub_u32 s57,46080,s57
v_swap_b32 v16,v18
v_swap_b32 v17,v19
s_mov_b32 s50,-1
s_nop 0
W3_COLD:
s_mov_b32 s37,0
fb_352:
buffer_load_dword v3,v2,s[8:11],s35 offen sc1
s_waitcnt vmcnt(0)
v_cmp_eq_u32 vcc,0,v3
s_nop 0
s_cbranch_vccz ok_353
s_sleep 2
s_sub_u32 s47,s47,1
s_cbranch_scc1 ABORT
s_branch fb_352
ok_353:
s_sub_u32 s66,46080,s57
s_lshl_b32 s60,s33,6
s_add_u32 s60,s60,s34
s_mul_i32 s60,s60,46080
s_add_u32 s60,s60,s37
s_add_u32 s60,s60,212467712
s_lshl_b32 s62,s46,10
s_add_u32 s62,s62,40960
s_add_u32 m0,s66,s62
s_add_u32 s63,s60,s62
buffer_load_dwordx4 v1,s[8:11],s63 offen sc1 lds
s_add_u32 m0,s66,45056
s_add_u32 s63,s60,45056
buffer_load_dwordx4 v1,s[8:11],s63 offen sc1 lds
s_mul_i32 s61,s46,10240
s_add_u32 s60,s60,s61
s_add_u32 s61,s61,s66
s_add_u32 m0,s61,0
s_add_u32 s63,s60,0
buffer_load_dwordx4 v1,s[8:11],s63 offen sc1 lds
buffer_load_dwordx4 v1,s[8:11],s63 offen offset:1024 sc1 lds
buffer_load_dwordx4 v1,s[8:11],s63 offen offset:2048 sc1 lds
buffer_load_dwordx4 v1,s[8:11],s63 offen offset:3072 sc1 lds
s_add_u32 m0,s61,4096
s_add_u32 s63,s60,4096
buffer_load_dwordx4 v1,s[8:11],s63 offen sc1 lds
buffer_load_dwordx4 v1,s[8:11],s63 offen offset:1024 sc1 lds
buffer_load_dwordx4 v1,s[8:11],s63 offen offset:2048 sc1 lds
buffer_load_dwordx4 v1,s[8:11],s63 offen offset:3072 sc1 lds
s_add_u32 m0,s61,8192
s_add_u32 s63,s60,8192
buffer_load_dwordx4 v1,s[8:11],s63 offen sc1 lds
buffer_load_dwordx4 v1,s[8:11],s63 offen offset:1024 sc1 lds
s_mov_b32 s55,1
W3_NEXT:
s_add_u32 s50,s50,1
s_sub_u32 s57,46080,s57
v_swap_b32 v16,v18
v_swap_b32 v17,v19
s_mov_b32 s51,s33
s_mov_b32 s52,s34
s_add_u32 s32,s32,1
s_min_u32 s62,s32,127
s_sub_u32 s60,s62,15
s_lshr_b32 s34,s60,1
s_and_b32 s33,s60,1
s_cmp_eq_u32 s33,0
s_cselect_b32 s61,15,0
s_add_u32 s34,s34,s61
s_sub_u32 s61,s60,49
s_cmp_ge_u32 s60,98
s_cselect_b32 s34,s61,s34
s_cselect_b32 s33,1,s33
s_cmp_lt_u32 s62,15
s_cselect_b32 s34,s62,s34
s_cselect_b32 s33,0,s33
s_lshl_b32 s35,s33,6
s_add_u32 s35,s35,s34
s_lshl_b32 s35,s35,9
s_add_u32 s35,s35,524288
s_waitcnt vmcnt(2)
s_cmp_eq_u32 s55,0
s_cbranch_scc1 wv_354
s_waitcnt vmcnt(0)
wv_354:
s_barrier
ds_read_b128 v[24:27],v16 offset:0
ds_read_b128 v[28:31],v17 offset:0
ds_read_b128 v[32:35],v16 offset:2048
ds_read_b128 v[36:39],v17 offset:2048
ds_read_b128 v[40:43],v16 offset:4096
ds_read_b128 v[44:47],v17 offset:4096
ds_read_b128 v[48:51],v16 offset:6144
buffer_load_dword v3,v2,s[8:11],s35 offen sc1
s_waitcnt lgkmcnt(6)
v_mfma_f32_32x32x16_bf16 v[56:71],a[0:3],v[24:27],0
ds_read_b128 v[52:55],v17 offset:6144
v_add_u32 v183,s57,v182
s_lshl_b32 s62,s51,6
s_add_u32 s62,s62,s52
s_waitcnt lgkmcnt(6)
v_mfma_f32_32x32x16_bf16 v[56:71],a[4:7],v[28:31],v[56:71]
ds_read_b128 v[24:27],v16 offset:8192
v_add_u32 v8,0x800,v183
s_mul_i32 s62,s62,98304
s_lshl_b32 s63,s56,11
s_waitcnt lgkmcnt(5)
v_mfma_f32_32x32x16_bf16 v[56:71],a[8:11],v[32:35],v[56:71]
ds_read_b128 v[28:31],v17 offset:8192
ds_read2_b64 v[160:163],v183 offset0:0 offset1:32
s_add_u32 s62,s62,s63
s_add_u32 s62,s62,242778112
v_mfma_f32_32x32x16_bf16 v[56:71],a[12:15],v[36:39],v[56:71]
ds_read_b128 v[32:35],v16 offset:10240
ds_read2_b64 v[164:167],v183 offset0:64 offset1:96
s_waitcnt lgkmcnt(7)
v_mfma_f32_32x32x16_bf16 v[56:71],a[16:19],v[40:43],v[56:71]
ds_read_b128 v[36:39],v17 offset:10240
ds_read2_b64 v[168:171],v183 offset0:128 offset1:160
buffer_load_dword v73,v72,s[8:11],s62 offen sc1
v_mfma_f32_32x32x16_bf16 v[56:71],a[20:23],v[44:47],v[56:71]
ds_read_b128 v[40:43],v16 offset:12288
ds_read2_b64 v[172:175],v183 offset0:192 offset1:224
s_waitcnt lgkmcnt(9)
v_mfma_f32_32x32x16_bf16 v[56:71],a[24:27],v[48:51],v[56:71]
ds_read_b128 v[44:47],v17 offset:12288
ds_read2_b64 v[176:179],v8 offset0:0 offset1:32
v_mfma_f32_32x32x16_bf16 v[56:71],a[28:31],v[52:55],v[56:71]
ds_read_b128 v[48:51],v16 offset:14336
s_waitcnt lgkmcnt(10)
v_mfma_f32_32x32x16_bf16 v[56:71],a[32:35],v[24:27],v[56:71]
ds_read_b128 v[52:55],v17 offset:14336
v_mfma_f32_32x32x16_bf16 v[56:71],a[36:39],v[28:31],v[56:71]
ds_read_b128 v[24:27],v16 offset:16384
s_waitcnt lgkmcnt(8)
v_mfma_f32_32x32x16_bf16 v[56:71],a[40:43],v[32:35],v[56:71]
ds_read_b128 v[28:31],v17 offset:16384
s_waitcnt lgkmcnt(4)
v_pk_add_f32 v[160:161],v[160:161],v[170:171]
v_mfma_f32_32x32x16_bf16 v[56:71],a[44:47],v[36:39],v[56:71]
ds_read_b128 v[32:35],v16 offset:18432
v_pk_add_f32 v[162:163],v[162:163],v[172:173]
v_pk_add_f32 v[164:165],v[164:165],v[174:175]
v_mfma_f32_32x32x16_bf16 v[56:71],a[48:51],v[40:43],v[56:71]
ds_read_b128 v[36:39],v17 offset:18432
s_waitcnt vmcnt(1)
s_mov_b64 exec,1
s_cmp_lg_u32 s49,0
s_cbranch_scc0 ls_355
buffer_store_dword v5,v1,s[8:11],s59 offen sc1
s_branch ls_356
ls_355:
buffer_store_dword v5,v1,s[8:11],s59 offen
ls_356:
s_mov_b64 exec,-1
s_mov_b32 s59,2147483648
v_mfma_f32_32x32x16_bf16 v[56:71],a[52:55],v[44:47],v[56:71]
ds_read_b128 v[40:43],v16 offset:20480
v_cmp_eq_u32 vcc,0,v3
s_cmp_eq_u64 vcc,0
s_cselect_b32 s37,0,2147483648
s_waitcnt lgkmcnt(5)
v_mfma_f32_32x32x16_bf16 v[56:71],a[56:59],v[48:51],v[56:71]
ds_read_b128 v[44:47],v17 offset:20480
s_cmp_lt_u32 s32,128
s_cselect_b32 s37,s37,2147483648
s_sub_u32 s66,46080,s57
s_lshl_b32 s60,s33,6
v_mfma_f32_32x32x16_bf16 v[56:71],a[60:63],v[52:55],v[56:71]
ds_read_b128 v[48:51],v16 offset:22528
s_add_u32 s60,s60,s34
s_mul_i32 s60,s60,46080
s_add_u32 s60,s60,s37
s_waitcnt lgkmcnt(5)
v_mfma_f32_32x32x16_bf16 v[56:71],a[64:67],v[24:27],v[56:71]
ds_read_b128 v[52:55],v17 offset:22528
s_add_u32 s60,s60,212467712
s_lshl_b32 s62,s46,10
s_add_u32 s62,s62,40960
s_add_u32 m0,s66,s62
v_mfma_f32_32x32x16_bf16 v[56:71],a[68:71],v[28:31],v[56:71]
ds_read_b128 v[24:27],v16 offset:24576
s_add_u32 s63,s60,s62
buffer_load_dwordx4 v1,s[8:11],s63 offen sc1 lds
s_waitcnt lgkmcnt(5)
v_mfma_f32_32x32x16_bf16 v[56:71],a[72:75],v[32:35],v[56:71]
ds_read_b128 v[28:31],v17 offset:24576
s_add_u32 m0,s66,45056
s_add_u32 s63,s60,45056
v_pk_add_f32 v[166:167],v[166:167],v[176:177]
v_mfma_f32_32x32x16_bf16 v[56:71],a[76:79],v[36:39],v[56:71]
ds_read_b128 v[32:35],v16 offset:26624
buffer_load_dwordx4 v1,s[8:11],s63 offen sc1 lds
s_mul_i32 s61,s46,10240
s_waitcnt lgkmcnt(5)
v_mfma_f32_32x32x16_bf16 v[56:71],a[80:83],v[40:43],v[56:71]
ds_read_b128 v[36:39],v17 offset:26624
s_add_u32 s60,s60,s61
s_add_u32 s61,s61,s66
s_add_u32 m0,s61,0
s_add_u32 s63,s60,0
v_mfma_f32_32x32x16_bf16 v[56:71],a[84:87],v[44:47],v[56:71]
ds_read_b128 v[40:43],v16 offset:28672
buffer_load_dwordx4 v1,s[8:11],s63 offen sc1 lds
s_waitcnt lgkmcnt(5)
v_mfma_f32_32x32x16_bf16 v[56:71],a[88:91],v[48:51],v[56:71]
ds_read_b128 v[44:47],v17 offset:28672
v_pk_add_f32 v[168:169],v[168:169],v[178:179]
v_pk_add_f32 v[160:161],v[160:161],v[162:163]
v_mfma_f32_32x32x16_bf16 v[56:71],a[92:95],v[52:55],v[56:71]
ds_read_b128 v[48:51],v16 offset:30720
buffer_load_dwordx4 v1,s[8:11],s63 offen offset:1024 sc1 lds
s_waitcnt lgkmcnt(5)
v_mfma_f32_32x32x16_bf16 v[56:71],a[96:99],v[24:27],v[56:71]
ds_read_b128 v[52:55],v17 offset:30720
v_pk_add_f32 v[164:165],v[164:165],v[166:167]
v_pk_add_f32 v[160:161],v[160:161],v[164:165]
v_mfma_f32_32x32x16_bf16 v[56:71],a[100:103],v[28:31],v[56:71]
ds_read_b128 v[24:27],v16 offset:32768
buffer_load_dwordx4 v1,s[8:11],s63 offen offset:2048 sc1 lds
s_waitcnt lgkmcnt(5)
v_mfma_f32_32x32x16_bf16 v[56:71],a[104:107],v[32:35],v[56:71]
ds_read_b128 v[28:31],v17 offset:32768
v_pk_add_f32 v[160:161],v[160:161],v[168:169]
v_mov_b32 v162,v160
v_mov_b32 v163,v161
v_mfma_f32_32x32x16_bf16 v[56:71],a[108:111],v[36:39],v[56:71]
ds_read_b128 v[32:35],v16 offset:34816
buffer_load_dwordx4 v1,s[8:11],s63 offen offset:3072 sc1 lds
s_add_u32 m0,s61,4096
s_waitcnt lgkmcnt(5)
v_mfma_f32_32x32x16_bf16 v[56:71],a[112:115],v[40:43],v[56:71]
ds_read_b128 v[36:39],v17 offset:34816
s_add_u32 s63,s60,4096
v_permlane32_swap_b32 v160,v162
v_permlane32_swap_b32 v161,v163
v_add_f32 v180,v160,v162
v_mfma_f32_32x32x16_bf16 v[56:71],a[116:119],v[44:47],v[56:71]
ds_read_b128 v[40:43],v16 offset:36864
buffer_load_dwordx4 v1,s[8:11],s63 offen sc1 lds
v_add_f32 v181,v161,v163
s_waitcnt lgkmcnt(5)
v_mfma_f32_32x32x16_bf16 v[56:71],a[120:123],v[48:51],v[56:71]
ds_read_b128 v[44:47],v17 offset:36864
buffer_load_dword v3,v2,s[8:11],s35 offen sc1
v_mul_f32 v180,0x3acccccd,v180
v_mfma_f32_32x32x16_bf16 v[56:71],a[124:127],v[52:55],v[56:71]
ds_read_b128 v[48:51],v16 offset:38912
buffer_load_dwordx4 v1,s[8:11],s63 offen offset:1024 sc1 lds
v_mul_f32 v181,0x3acccccd,v181
s_waitcnt lgkmcnt(5)
v_mfma_f32_32x32x16_bf16 v[56:71],a[128:131],v[24:27],v[56:71]
ds_read_b128 v[52:55],v17 offset:38912
v_fma_f32 v181,-v180,v180,v181
v_max_f32 v181,0,v181
v_cvt_pk_bf16_f32 v8,v180,v181
v_lshlrev_b32 v180,16,v8
v_mfma_f32_32x32x16_bf16 v[56:71],a[132:135],v[28:31],v[56:71]
buffer_load_dwordx4 v1,s[8:11],s63 offen offset:2048 sc1 lds
v_and_b32 v181,0xffff0000,v8
v_add_f32 v181,0x3727c5ac,v181
v_cvt_pk_bf16_f32 v8,v181,v181
s_waitcnt lgkmcnt(4)
v_mfma_f32_32x32x16_bf16 v[56:71],a[136:139],v[32:35],v[56:71]
v_lshlrev_b32 v181,16,v8
v_sqrt_f32 v181,v181
s_nop 0
v_cvt_pk_bf16_f32 v8,v181,v181
v_lshlrev_b32 v181,16,v8
v_mfma_f32_32x32x16_bf16 v[56:71],a[140:143],v[36:39],v[56:71]
buffer_load_dwordx4 v1,s[8:11],s63 offen offset:3072 sc1 lds
s_add_u32 m0,s61,8192
s_add_u32 s63,s60,8192
s_waitcnt lgkmcnt(2)
v_mfma_f32_32x32x16_bf16 v[56:71],a[144:147],v[40:43],v[56:71]
v_rcp_f32 v181,v181
v_mfma_f32_32x32x16_bf16 v[56:71],a[148:151],v[44:47],v[56:71]
buffer_load_dwordx4 v1,s[8:11],s63 offen sc1 lds
s_waitcnt lgkmcnt(0)
v_mfma_f32_32x32x16_bf16 v[56:71],a[152:155],v[48:51],v[56:71]
v_mfma_f32_32x32x16_bf16 v[56:71],a[156:159],v[52:55],v[56:71]
buffer_load_dwordx4 v1,s[8:11],s63 offen offset:1024 sc1 lds
s_mov_b32 s55,0
s_cmp_eq_u32 s37,0
s_cbranch_scc1 ep_357
s_waitcnt vmcnt(0)
v_cmp_eq_u32 vcc,0,v3
s_cmp_eq_u64 vcc,0
s_cselect_b32 s37,0,2147483648
s_cmp_lt_u32 s32,128
s_cselect_b32 s37,s37,2147483648
s_cmp_lg_u32 s37,0
s_cbranch_scc1 ep_357
s_sub_u32 s66,46080,s57
s_lshl_b32 s60,s33,6
s_add_u32 s60,s60,s34
s_mul_i32 s60,s60,46080
s_add_u32 s60,s60,s37
s_add_u32 s60,s60,212467712
s_lshl_b32 s62,s46,10
s_add_u32 s62,s62,40960
s_add_u32 m0,s66,s62
s_add_u32 s63,s60,s62
buffer_load_dwordx4 v1,s[8:11],s63 offen sc1 lds
s_add_u32 m0,s66,45056
s_add_u32 s63,s60,45056
buffer_load_dwordx4 v1,s[8:11],s63 offen sc1 lds
s_mul_i32 s61,s46,10240
s_add_u32 s60,s60,s61
s_add_u32 s61,s61,s66
s_add_u32 m0,s61,0
s_add_u32 s63,s60,0
buffer_load_dwordx4 v1,s[8:11],s63 offen sc1 lds
buffer_load_dwordx4 v1,s[8:11],s63 offen offset:1024 sc1 lds
buffer_load_dwordx4 v1,s[8:11],s63 offen offset:2048 sc1 lds
buffer_load_dwordx4 v1,s[8:11],s63 offen offset:3072 sc1 lds
s_add_u32 m0,s61,4096
s_add_u32 s63,s60,4096
buffer_load_dwordx4 v1,s[8:11],s63 offen sc1 lds
buffer_load_dwordx4 v1,s[8:11],s63 offen offset:1024 sc1 lds
buffer_load_dwordx4 v1,s[8:11],s63 offen offset:2048 sc1 lds
buffer_load_dwordx4 v1,s[8:11],s63 offen offset:3072 sc1 lds
s_add_u32 m0,s61,8192
s_add_u32 s63,s60,8192
buffer_load_dwordx4 v1,s[8:11],s63 offen sc1 lds
buffer_load_dwordx4 v1,s[8:11],s63 offen offset:1024 sc1 lds
ep_357:
s_nop 7
s_lshl_b32 s62,s51,6
s_add_u32 s62,s62,s52
s_mul_i32 s62,s62,98304
s_lshl_b32 s63,s56,11
s_add_u32 s62,s62,s63
s_add_u32 s62,s62,242778112
v_pk_fma_f32 v[56:57],v[144:145],v[180:181],v[56:57] op_sel_hi:[1,0,1] neg_lo:[0,1,0] neg_hi:[0,1,0]
v_pk_fma_f32 v[58:59],v[146:147],v[180:181],v[58:59] op_sel_hi:[1,0,1] neg_lo:[0,1,0] neg_hi:[0,1,0]
v_pk_fma_f32 v[60:61],v[148:149],v[180:181],v[60:61] op_sel_hi:[1,0,1] neg_lo:[0,1,0] neg_hi:[0,1,0]
v_pk_fma_f32 v[62:63],v[150:151],v[180:181],v[62:63] op_sel_hi:[1,0,1] neg_lo:[0,1,0] neg_hi:[0,1,0]
v_pk_fma_f32 v[64:65],v[152:153],v[180:181],v[64:65] op_sel_hi:[1,0,1] neg_lo:[0,1,0] neg_hi:[0,1,0]
v_pk_fma_f32 v[66:67],v[154:155],v[180:181],v[66:67] op_sel_hi:[1,0,1] neg_lo:[0,1,0] neg_hi:[0,1,0]
v_pk_fma_f32 v[68:69],v[156:157],v[180:181],v[68:69] op_sel_hi:[1,0,1] neg_lo:[0,1,0] neg_hi:[0,1,0]
v_pk_fma_f32 v[70:71],v[158:159],v[180:181],v[70:71] op_sel_hi:[1,0,1] neg_lo:[0,1,0] neg_hi:[0,1,0]
v_pk_mul_f32 v[56:57],v[56:57],v[180:181] op_sel:[0,1] op_sel_hi:[1,1]
v_pk_mul_f32 v[58:59],v[58:59],v[180:181] op_sel:[0,1] op_sel_hi:[1,1]
v_pk_mul_f32 v[60:61],v[60:61],v[180:181] op_sel:[0,1] op_sel_hi:[1,1]
v_pk_mul_f32 v[62:63],v[62:63],v[180:181] op_sel:[0,1] op_sel_hi:[1,1]
v_pk_mul_f32 v[64:65],v[64:65],v[180:181] op_sel:[0,1] op_sel_hi:[1,1]
v_pk_mul_f32 v[66:67],v[66:67],v[180:181] op_sel:[0,1] op_sel_hi:[1,1]
v_pk_mul_f32 v[68:69],v[68:69],v[180:181] op_sel:[0,1] op_sel_hi:[1,1]
v_pk_mul_f32 v[70:71],v[70:71],v[180:181] op_sel:[0,1] op_sel_hi:[1,1]
v_cvt_pk_bf16_f32 v140,v56,v57
v_lshlrev_b32 v56,16,v140
v_and_b32 v57,0xffff0000,v140
v_cvt_pk_bf16_f32 v140,v58,v59
v_lshlrev_b32 v58,16,v140
v_and_b32 v59,0xffff0000,v140
v_cvt_pk_bf16_f32 v140,v60,v61
v_lshlrev_b32 v60,16,v140
v_and_b32 v61,0xffff0000,v140
v_cvt_pk_bf16_f32 v140,v62,v63
v_lshlrev_b32 v62,16,v140
v_and_b32 v63,0xffff0000,v140
v_cvt_pk_bf16_f32 v140,v64,v65
v_lshlrev_b32 v64,16,v140
v_and_b32 v65,0xffff0000,v140
v_cvt_pk_bf16_f32 v140,v66,v67
v_lshlrev_b32 v66,16,v140
v_and_b32 v67,0xffff0000,v140
v_cvt_pk_bf16_f32 v140,v68,v69
v_lshlrev_b32 v68,16,v140
v_and_b32 v69,0xffff0000,v140
v_cvt_pk_bf16_f32 v140,v70,v71
v_lshlrev_b32 v70,16,v140
v_and_b32 v71,0xffff0000,v140
v_pk_mul_f32 v[124:125],v[56:57],v[56:57]
v_pk_mul_f32 v[126:127],v[58:59],v[58:59]
v_pk_mul_f32 v[128:129],v[60:61],v[60:61]
v_pk_mul_f32 v[130:131],v[62:63],v[62:63]
v_pk_mul_f32 v[132:133],v[64:65],v[64:65]
v_pk_mul_f32 v[134:135],v[66:67],v[66:67]
v_pk_mul_f32 v[136:137],v[68:69],v[68:69]
v_pk_mul_f32 v[138:139],v[70:71],v[70:71]
v_pk_fma_f32 v[124:125],v[124:125],v[112:113],v[112:113] op_sel:[0,1,0] op_sel_hi:[1,1,0]
v_pk_fma_f32 v[126:127],v[126:127],v[112:113],v[112:113] op_sel:[0,1,0] op_sel_hi:[1,1,0]
v_pk_fma_f32 v[128:129],v[128:129],v[112:113],v[112:113] op_sel:[0,1,0] op_sel_hi:[1,1,0]
v_pk_fma_f32 v[130:131],v[130:131],v[112:113],v[112:113] op_sel:[0,1,0] op_sel_hi:[1,1,0]
v_pk_fma_f32 v[132:133],v[132:133],v[112:113],v[112:113] op_sel:[0,1,0] op_sel_hi:[1,1,0]
v_pk_fma_f32 v[134:135],v[134:135],v[112:113],v[112:113] op_sel:[0,1,0] op_sel_hi:[1,1,0]
v_pk_fma_f32 v[136:137],v[136:137],v[112:113],v[112:113] op_sel:[0,1,0] op_sel_hi:[1,1,0]
v_pk_fma_f32 v[138:139],v[138:139],v[112:113],v[112:113] op_sel:[0,1,0] op_sel_hi:[1,1,0]
v_pk_mul_f32 v[124:125],v[124:125],v[56:57]
v_pk_mul_f32 v[126:127],v[126:127],v[58:59]
v_pk_mul_f32 v[128:129],v[128:129],v[60:61]
v_pk_mul_f32 v[130:131],v[130:131],v[62:63]
v_pk_mul_f32 v[132:133],v[132:133],v[64:65]
v_pk_mul_f32 v[134:135],v[134:135],v[66:67]
v_pk_mul_f32 v[136:137],v[136:137],v[68:69]
v_pk_mul_f32 v[138:139],v[138:139],v[70:71]
v_exp_f32 v124,v124
v_exp_f32 v125,v125
v_exp_f32 v126,v126
v_exp_f32 v127,v127
v_exp_f32 v128,v128
v_exp_f32 v129,v129
v_exp_f32 v130,v130
v_exp_f32 v131,v131
v_exp_f32 v132,v132
v_exp_f32 v133,v133
v_exp_f32 v134,v134
v_exp_f32 v135,v135
v_exp_f32 v136,v136
v_exp_f32 v137,v137
v_exp_f32 v138,v138
v_exp_f32 v139,v139
v_pk_add_f32 v[124:125],v[124:125],1.0 op_sel_hi:[1,0]
v_pk_add_f32 v[126:127],v[126:127],1.0 op_sel_hi:[1,0]
v_pk_add_f32 v[128:129],v[128:129],1.0 op_sel_hi:[1,0]
v_pk_add_f32 v[130:131],v[130:131],1.0 op_sel_hi:[1,0]
v_pk_add_f32 v[132:133],v[132:133],1.0 op_sel_hi:[1,0]
v_pk_add_f32 v[134:135],v[134:135],1.0 op_sel_hi:[1,0]
v_pk_add_f32 v[136:137],v[136:137],1.0 op_sel_hi:[1,0]
v_pk_add_f32 v[138:139],v[138:139],1.0 op_sel_hi:[1,0]
v_rcp_f32 v124,v124
v_rcp_f32 v125,v125
v_rcp_f32 v126,v126
v_rcp_f32 v127,v127
v_rcp_f32 v128,v128
v_rcp_f32 v129,v129
v_rcp_f32 v130,v130
v_rcp_f32 v131,v131
v_rcp_f32 v132,v132
v_rcp_f32 v133,v133
v_rcp_f32 v134,v134
v_rcp_f32 v135,v135
v_rcp_f32 v136,v136
v_rcp_f32 v137,v137
v_rcp_f32 v138,v138
v_rcp_f32 v139,v139
v_pk_mul_f32 v[56:57],v[56:57],v[124:125]
v_pk_mul_f32 v[58:59],v[58:59],v[126:127]
v_pk_mul_f32 v[60:61],v[60:61],v[128:129]
v_pk_mul_f32 v[62:63],v[62:63],v[130:131]
v_pk_mul_f32 v[64:65],v[64:65],v[132:133]
v_pk_mul_f32 v[66:67],v[66:67],v[134:135]
v_pk_mul_f32 v[68:69],v[68:69],v[136:137]
v_pk_mul_f32 v[70:71],v[70:71],v[138:139]
v_cvt_pk_bf16_f32 v116,v56,v57
v_cvt_pk_bf16_f32 v117,v58,v59
v_cvt_pk_bf16_f32 v118,v60,v61
v_cvt_pk_bf16_f32 v119,v62,v63
v_cvt_pk_bf16_f32 v120,v64,v65
v_cvt_pk_bf16_f32 v121,v66,v67
v_cvt_pk_bf16_f32 v122,v68,v69
v_cvt_pk_bf16_f32 v123,v70,v71
s_cmp_lg_u32 s49,0
s_cbranch_scc0 ls_358
buffer_store_dwordx4 v[116:119],v20,s[8:11],s62 offen sc1
buffer_store_dwordx4 v[120:123],v21,s[8:11],s62 offen sc1
s_branch ls_359
ls_358:
buffer_store_dwordx4 v[116:119],v20,s[8:11],s62 offen
buffer_store_dwordx4 v[120:123],v21,s[8:11],s62 offen
ls_359:
s_lshl_b32 s82,s51,6
s_add_u32 s82,s82,s52
s_lshl_b32 s82,s82,9
s_add_u32 s82,s82,589824
s_lshl_b32 s61,s56,2
s_add_u32 s82,s82,s61
s_mov_b32 s59,s82
s_cmp_eq_u32 s37,0
s_cbranch_scc1 W3_NEXT
s_waitcnt vmcnt(0)
s_mov_b64 exec,1
s_cmp_lg_u32 s49,0
s_cbranch_scc0 ls_360
buffer_store_dword v5,v1,s[8:11],s59 offen sc1
s_branch ls_361
ls_360:
buffer_store_dword v5,v1,s[8:11],s59 offen
ls_361:
s_mov_b64 exec,-1
s_mov_b32 s59,2147483648
s_cmp_lt_u32 s32,128
s_cbranch_scc1 W3_COLD
W3_END:
s_endpgm
ROLE_W4:
v_lshlrev_b32 v1,4,v0
v_mov_b32 v5,1
s_lshl_b32 s56,s48,2
s_add_u32 s56,s56,s46
v_bfe_u32 v6,v0,2,2
v_lshrrev_b32 v7,4,v0
v_add_u32 v7,v6,v7
v_and_b32 v7,3,v7
v_and_b32 v15,3,v0
v_lshlrev_b32 v15,4,v15
v_lshl_add_u32 v15,v7,6,v15
v_lshl_add_u32 v15,v6,8,v15
v_lshrrev_b32 v6,5,v0
v_bfe_u32 v7,v0,4,1
v_lshlrev_b32 v208,10,v7
v_lshl_add_u32 v208,v6,8,v208
v_and_b32 v6,15,v0
v_lshl_add_u32 v208,v6,4,v208
v_lshrrev_b32 v6,5,v0
v_add_u32 v6,2,v6
v_bfe_u32 v7,v0,4,1
v_lshlrev_b32 v209,10,v7
v_lshl_add_u32 v209,v6,8,v209
v_and_b32 v6,15,v0
v_lshl_add_u32 v209,v6,4,v209
v_min_u32 v2,11,v0
s_mul_i32 s60,s46,12
v_add_u32 v2,s60,v2
v_lshlrev_b32 v2,2,v2
s_and_b32 s60,s46,1
s_lshl_b32 s68,s48,1
s_add_u32 s68,s68,s60
s_lshr_b32 s69,s46,1
s_mul_i32 s71,s46,24576
s_mul_i32 s58,s46,491520
s_lshl_b32 s61,s48,7
s_add_u32 s58,s58,s61
s_add_u32 s71,s71,242778112
v_and_b32 v6,15,v0
v_lshlrev_b32 v204,3,v6
s_lshl_b32 s60,s69,4
v_add_u32 v6,s60,v6
v_mul_u32_u24 v205,1280,v6
v_lshrrev_b32 v6,4,v0
v_lshl_add_u32 v205,v6,3,v205
s_lshl_b32 s60,s68,6
v_add_u32 v205,s60,v205
s_mov_b32 s76,s40
s_mov_b32 s77,s41
s_mov_b32 s78,2621440
s_mov_b32 s79,0x20000
s_lshl_b32 s70,s68,1
s_add_u32 s70,s70,s69
s_lshl_b32 s70,s70,10
v_bfe_u32 v6,v0,4,1
v_lshlrev_b32 v206,14,v6
v_lshrrev_b32 v6,5,v0
v_lshl_add_u32 v206,v6,8,v206
v_and_b32 v6,15,v0
v_lshl_add_u32 v206,v6,4,v206
s_lshl_b32 s60,s46,11
v_add_u32 v206,s60,v206
s_lshl_b32 s60,s46,13
v_add_u32 v207,s60,v1
s_waitcnt vmcnt(0)
s_barrier
s_cmp_lg_u32 s46,0
s_cbranch_scc1 arr_362
v_mov_b32 v6,1
s_lshl_b32 s3,s49,2
v_mov_b32 v7,s3
s_mov_b64 exec,1
buffer_atomic_add v6,v7,s[12:15],0 offen sc1
s_mov_b64 exec,-1
arr_362:
s_mul_i32 s63,s46,40960
s_mov_b32 s4,s38
s_mov_b32 s5,s39
s_mov_b32 s6,1966080
s_mov_b32 s7,0x20000
v_lshrrev_b32 v9,3,v0
s_mov_b32 s64,1280
v_mul_lo_u32 v9,v9,s64
v_and_b32 v10,7,v0
v_lshl_add_u32 v6,v10,4,v9
s_add_u32 m0,s63,0
s_add_u32 s65,s58,0
buffer_load_dwordx4 v6,s[4:7],s65 offen lds
s_add_u32 m0,s63,1024
s_add_u32 s65,s58,10240
buffer_load_dwordx4 v6,s[4:7],s65 offen lds
s_add_u32 m0,s63,2048
s_add_u32 s65,s58,20480
buffer_load_dwordx4 v6,s[4:7],s65 offen lds
s_add_u32 m0,s63,3072
s_add_u32 s65,s58,30720
buffer_load_dwordx4 v6,s[4:7],s65 offen lds
s_add_u32 m0,s63,4096
s_add_u32 s65,s58,40960
buffer_load_dwordx4 v6,s[4:7],s65 offen lds
s_add_u32 m0,s63,5120
s_add_u32 s65,s58,51200
buffer_load_dwordx4 v6,s[4:7],s65 offen lds
s_add_u32 m0,s63,6144
s_add_u32 s65,s58,61440
buffer_load_dwordx4 v6,s[4:7],s65 offen lds
s_add_u32 m0,s63,7168
s_add_u32 s65,s58,71680
buffer_load_dwordx4 v6,s[4:7],s65 offen lds
s_add_u32 m0,s63,8192
s_add_u32 s65,s58,81920
buffer_load_dwordx4 v6,s[4:7],s65 offen lds
s_add_u32 m0,s63,9216
s_add_u32 s65,s58,92160
buffer_load_dwordx4 v6,s[4:7],s65 offen lds
s_add_u32 m0,s63,10240
s_add_u32 s65,s58,102400
buffer_load_dwordx4 v6,s[4:7],s65 offen lds
s_add_u32 m0,s63,11264
s_add_u32 s65,s58,112640
buffer_load_dwordx4 v6,s[4:7],s65 offen lds
s_add_u32 m0,s63,12288
s_add_u32 s65,s58,122880
buffer_load_dwordx4 v6,s[4:7],s65 offen lds
s_add_u32 m0,s63,13312
s_add_u32 s65,s58,133120
buffer_load_dwordx4 v6,s[4:7],s65 offen lds
s_add_u32 m0,s63,14336
s_add_u32 s65,s58,143360
buffer_load_dwordx4 v6,s[4:7],s65 offen lds
s_add_u32 m0,s63,15360
s_add_u32 s65,s58,153600
buffer_load_dwordx4 v6,s[4:7],s65 offen lds
s_add_u32 m0,s63,16384
s_add_u32 s65,s58,163840
buffer_load_dwordx4 v6,s[4:7],s65 offen lds
s_add_u32 m0,s63,17408
s_add_u32 s65,s58,174080
buffer_load_dwordx4 v6,s[4:7],s65 offen lds
s_add_u32 m0,s63,18432
s_add_u32 s65,s58,184320
buffer_load_dwordx4 v6,s[4:7],s65 offen lds
s_add_u32 m0,s63,19456
s_add_u32 s65,s58,194560
buffer_load_dwordx4 v6,s[4:7],s65 offen lds
s_add_u32 m0,s63,20480
s_add_u32 s65,s58,204800
buffer_load_dwordx4 v6,s[4:7],s65 offen lds
s_add_u32 m0,s63,21504
s_add_u32 s65,s58,215040
buffer_load_dwordx4 v6,s[4:7],s65 offen lds
s_add_u32 m0,s63,22528
s_add_u32 s65,s58,225280
buffer_load_dwordx4 v6,s[4:7],s65 offen lds
s_add_u32 m0,s63,23552
s_add_u32 s65,s58,235520
buffer_load_dwordx4 v6,s[4:7],s65 offen lds
s_add_u32 m0,s63,24576
s_add_u32 s65,s58,245760
buffer_load_dwordx4 v6,s[4:7],s65 offen lds
s_add_u32 m0,s63,25600
s_add_u32 s65,s58,256000
buffer_load_dwordx4 v6,s[4:7],s65 offen lds
s_add_u32 m0,s63,26624
s_add_u32 s65,s58,266240
buffer_load_dwordx4 v6,s[4:7],s65 offen lds
s_add_u32 m0,s63,27648
s_add_u32 s65,s58,276480
buffer_load_dwordx4 v6,s[4:7],s65 offen lds
s_add_u32 m0,s63,28672
s_add_u32 s65,s58,286720
buffer_load_dwordx4 v6,s[4:7],s65 offen lds
s_add_u32 m0,s63,29696
s_add_u32 s65,s58,296960
buffer_load_dwordx4 v6,s[4:7],s65 offen lds
s_add_u32 m0,s63,30720
s_add_u32 s65,s58,307200
buffer_load_dwordx4 v6,s[4:7],s65 offen lds
s_add_u32 m0,s63,31744
s_add_u32 s65,s58,317440
buffer_load_dwordx4 v6,s[4:7],s65 offen lds
s_add_u32 m0,s63,32768
s_add_u32 s65,s58,327680
buffer_load_dwordx4 v6,s[4:7],s65 offen lds
s_add_u32 m0,s63,33792
s_add_u32 s65,s58,337920
buffer_load_dwordx4 v6,s[4:7],s65 offen lds
s_add_u32 m0,s63,34816
s_add_u32 s65,s58,348160
buffer_load_dwordx4 v6,s[4:7],s65 offen lds
s_add_u32 m0,s63,35840
s_add_u32 s65,s58,358400
buffer_load_dwordx4 v6,s[4:7],s65 offen lds
s_add_u32 m0,s63,36864
s_add_u32 s65,s58,368640
buffer_load_dwordx4 v6,s[4:7],s65 offen lds
s_add_u32 m0,s63,37888
s_add_u32 s65,s58,378880
buffer_load_dwordx4 v6,s[4:7],s65 offen lds
s_add_u32 m0,s63,38912
s_add_u32 s65,s58,389120
buffer_load_dwordx4 v6,s[4:7],s65 offen lds
s_add_u32 m0,s63,39936
s_add_u32 s65,s58,399360
buffer_load_dwordx4 v6,s[4:7],s65 offen lds
s_waitcnt vmcnt(20)
v_bfe_u32 v9,v0,2,2
v_lshrrev_b32 v10,5,v0
v_lshl_add_u32 v9,v10,2,v9
v_mul_u32_u24 v9,128,v9
v_and_b32 v10,1,v0
v_lshl_add_u32 v9,v10,3,v9
v_bfe_u32 v10,v0,1,1
v_lshl_add_u32 v9,v10,5,v9
v_bfe_u32 v10,v0,4,1
v_lshl_add_u32 v9,v10,4,v9
v_add_u32 v7,s63,v9
ds_read_b64_tr_b16 a[0:1],v7 offset:0
ds_read_b64_tr_b16 a[2:3],v7 offset:2048
ds_read_b64_tr_b16 a[4:5],v7 offset:1024
ds_read_b64_tr_b16 a[6:7],v7 offset:3072
ds_read_b64_tr_b16 a[96:97],v7 offset:64
ds_read_b64_tr_b16 a[98:99],v7 offset:2112
ds_read_b64_tr_b16 a[100:101],v7 offset:1088
ds_read_b64_tr_b16 a[102:103],v7 offset:3136
ds_read_b64_tr_b16 a[8:9],v7 offset:4096
ds_read_b64_tr_b16 a[10:11],v7 offset:6144
ds_read_b64_tr_b16 a[12:13],v7 offset:5120
ds_read_b64_tr_b16 a[14:15],v7 offset:7168
s_waitcnt lgkmcnt(4)
ds_read_b64_tr_b16 a[104:105],v7 offset:4160
ds_read_b64_tr_b16 a[106:107],v7 offset:6208
ds_read_b64_tr_b16 a[108:109],v7 offset:5184
ds_read_b64_tr_b16 a[110:111],v7 offset:7232
ds_read_b64_tr_b16 a[16:17],v7 offset:8192
ds_read_b64_tr_b16 a[18:19],v7 offset:10240
ds_read_b64_tr_b16 a[20:21],v7 offset:9216
ds_read_b64_tr_b16 a[22:23],v7 offset:11264
ds_read_b64_tr_b16 a[112:113],v7 offset:8256
ds_read_b64_tr_b16 a[114:115],v7 offset:10304
ds_read_b64_tr_b16 a[116:117],v7 offset:9280
ds_read_b64_tr_b16 a[118:119],v7 offset:11328
s_waitcnt lgkmcnt(4)
ds_read_b64_tr_b16 a[24:25],v7 offset:12288
ds_read_b64_tr_b16 a[26:27],v7 offset:14336
ds_read_b64_tr_b16 a[28:29],v7 offset:13312
ds_read_b64_tr_b16 a[30:31],v7 offset:15360
ds_read_b64_tr_b16 a[120:121],v7 offset:12352
ds_read_b64_tr_b16 a[122:123],v7 offset:14400
ds_read_b64_tr_b16 a[124:125],v7 offset:13376
ds_read_b64_tr_b16 a[126:127],v7 offset:15424
ds_read_b64_tr_b16 a[32:33],v7 offset:16384
ds_read_b64_tr_b16 a[34:35],v7 offset:18432
ds_read_b64_tr_b16 a[36:37],v7 offset:17408
ds_read_b64_tr_b16 a[38:39],v7 offset:19456
s_waitcnt lgkmcnt(4)
ds_read_b64_tr_b16 a[128:129],v7 offset:16448
ds_read_b64_tr_b16 a[130:131],v7 offset:18496
ds_read_b64_tr_b16 a[132:133],v7 offset:17472
ds_read_b64_tr_b16 a[134:135],v7 offset:19520
s_waitcnt lgkmcnt(0)
s_add_u32 m0,s63,0
s_add_u32 s65,s58,409600
buffer_load_dwordx4 v6,s[4:7],s65 offen lds
s_add_u32 m0,s63,1024
s_add_u32 s65,s58,419840
buffer_load_dwordx4 v6,s[4:7],s65 offen lds
s_add_u32 m0,s63,2048
s_add_u32 s65,s58,430080
buffer_load_dwordx4 v6,s[4:7],s65 offen lds
s_add_u32 m0,s63,3072
s_add_u32 s65,s58,440320
buffer_load_dwordx4 v6,s[4:7],s65 offen lds
s_add_u32 m0,s63,4096
s_add_u32 s65,s58,450560
buffer_load_dwordx4 v6,s[4:7],s65 offen lds
s_add_u32 m0,s63,5120
s_add_u32 s65,s58,460800
buffer_load_dwordx4 v6,s[4:7],s65 offen lds
s_add_u32 m0,s63,6144
s_add_u32 s65,s58,471040
buffer_load_dwordx4 v6,s[4:7],s65 offen lds
s_add_u32 m0,s63,7168
s_add_u32 s65,s58,481280
buffer_load_dwordx4 v6,s[4:7],s65 offen lds
s_waitcnt vmcnt(8)
v_bfe_u32 v9,v0,2,2
v_lshrrev_b32 v10,5,v0
v_lshl_add_u32 v9,v10,2,v9
v_mul_u32_u24 v9,128,v9
v_and_b32 v10,1,v0
v_lshl_add_u32 v9,v10,3,v9
v_bfe_u32 v10,v0,1,1
v_lshl_add_u32 v9,v10,5,v9
v_bfe_u32 v10,v0,4,1
v_lshl_add_u32 v9,v10,4,v9
v_add_u32 v7,s63,v9
ds_read_b64_tr_b16 a[40:41],v7 offset:20480
ds_read_b64_tr_b16 a[42:43],v7 offset:22528
ds_read_b64_tr_b16 a[44:45],v7 offset:21504
ds_read_b64_tr_b16 a[46:47],v7 offset:23552
ds_read_b64_tr_b16 a[136:137],v7 offset:20544
ds_read_b64_tr_b16 a[138:139],v7 offset:22592
ds_read_b64_tr_b16 a[140:141],v7 offset:21568
ds_read_b64_tr_b16 a[142:143],v7 offset:23616
ds_read_b64_tr_b16 a[48:49],v7 offset:24576
ds_read_b64_tr_b16 a[50:51],v7 offset:26624
ds_read_b64_tr_b16 a[52:53],v7 offset:25600
ds_read_b64_tr_b16 a[54:55],v7 offset:27648
s_waitcnt lgkmcnt(4)
ds_read_b64_tr_b16 a[144:145],v7 offset:24640
ds_read_b64_tr_b16 a[146:147],v7 offset:26688
ds_read_b64_tr_b16 a[148:149],v7 offset:25664
ds_read_b64_tr_b16 a[150:151],v7 offset:27712
ds_read_b64_tr_b16 a[56:57],v7 offset:28672
ds_read_b64_tr_b16 a[58:59],v7 offset:30720
ds_read_b64_tr_b16 a[60:61],v7 offset:29696
ds_read_b64_tr_b16 a[62:63],v7 offset:31744
ds_read_b64_tr_b16 a[152:153],v7 offset:28736
ds_read_b64_tr_b16 a[154:155],v7 offset:30784
ds_read_b64_tr_b16 a[156:157],v7 offset:29760
ds_read_b64_tr_b16 a[158:159],v7 offset:31808
s_waitcnt lgkmcnt(4)
ds_read_b64_tr_b16 a[64:65],v7 offset:32768
ds_read_b64_tr_b16 a[66:67],v7 offset:34816
ds_read_b64_tr_b16 a[68:69],v7 offset:33792
ds_read_b64_tr_b16 a[70:71],v7 offset:35840
ds_read_b64_tr_b16 a[160:161],v7 offset:32832
ds_read_b64_tr_b16 a[162:163],v7 offset:34880
ds_read_b64_tr_b16 a[164:165],v7 offset:33856
ds_read_b64_tr_b16 a[166:167],v7 offset:35904
ds_read_b64_tr_b16 a[72:73],v7 offset:36864
ds_read_b64_tr_b16 a[74:75],v7 offset:38912
ds_read_b64_tr_b16 a[76:77],v7 offset:37888
ds_read_b64_tr_b16 a[78:79],v7 offset:39936
s_waitcnt lgkmcnt(4)
ds_read_b64_tr_b16 a[168:169],v7 offset:36928
ds_read_b64_tr_b16 a[170:171],v7 offset:38976
ds_read_b64_tr_b16 a[172:173],v7 offset:37952
ds_read_b64_tr_b16 a[174:175],v7 offset:40000
s_waitcnt lgkmcnt(0)
s_waitcnt vmcnt(0)
v_bfe_u32 v9,v0,2,2
v_lshrrev_b32 v10,5,v0
v_lshl_add_u32 v9,v10,2,v9
v_mul_u32_u24 v9,128,v9
v_and_b32 v10,1,v0
v_lshl_add_u32 v9,v10,3,v9
v_bfe_u32 v10,v0,1,1
v_lshl_add_u32 v9,v10,5,v9
v_bfe_u32 v10,v0,4,1
v_lshl_add_u32 v9,v10,4,v9
v_add_u32 v7,s63,v9
ds_read_b64_tr_b16 a[80:81],v7 offset:0
ds_read_b64_tr_b16 a[82:83],v7 offset:2048
ds_read_b64_tr_b16 a[84:85],v7 offset:1024
ds_read_b64_tr_b16 a[86:87],v7 offset:3072
ds_read_b64_tr_b16 a[176:177],v7 offset:64
ds_read_b64_tr_b16 a[178:179],v7 offset:2112
ds_read_b64_tr_b16 a[180:181],v7 offset:1088
ds_read_b64_tr_b16 a[182:183],v7 offset:3136
ds_read_b64_tr_b16 a[88:89],v7 offset:4096
ds_read_b64_tr_b16 a[90:91],v7 offset:6144
ds_read_b64_tr_b16 a[92:93],v7 offset:5120
ds_read_b64_tr_b16 a[94:95],v7 offset:7168
s_waitcnt lgkmcnt(4)
ds_read_b64_tr_b16 a[184:185],v7 offset:4160
ds_read_b64_tr_b16 a[186:187],v7 offset:6208
ds_read_b64_tr_b16 a[188:189],v7 offset:5184
ds_read_b64_tr_b16 a[190:191],v7 offset:7232
s_waitcnt lgkmcnt(0)
s_barrier
s_lshl_b32 s3,s49,2
v_mov_b32 v7,s3
s_nop 1
ibw_363:
buffer_load_dword v6,v7,s[12:15],0 offen sc1
s_waitcnt vmcnt(0)
v_cmp_ne_u32 vcc,256,v6
s_nop 0
s_cbranch_vccz ok_364
s_sleep 8
s_sub_u32 s47,s47,1
s_cbranch_scc1 ABORT
s_branch ibw_363
ok_364:
s_cmp_lg_u32 s49,0
s_cbranch_scc1 ibok_365
v_and_b32 v7,7,v0
v_lshlrev_b32 v7,2,v7
buffer_load_dword v6,v7,s[12:15],0 offen offset:32 sc1
s_waitcnt vmcnt(0)
v_cmp_ne_u32 vcc,32,v6
s_nop 0
s_cbranch_vccz ibok_365
s_barrier
s_mov_b32 s49,1
s_mov_b32 s3,s2
s_load_dwordx16 s[16:31],s[0:1],0
s_load_dwordx8 s[32:39],s[0:1],64
s_waitcnt lgkmcnt(0)
s_branch DISPATCH
ibok_365:
s_mov_b32 s83,s100
s_mov_b32 s32,0
s_mov_b32 s59,2147483648
s_min_u32 s62,s32,127
s_sub_u32 s60,s62,15
s_lshr_b32 s34,s60,1
s_and_b32 s33,s60,1
s_cmp_eq_u32 s33,0
s_cselect_b32 s61,15,0
s_add_u32 s34,s34,s61
s_sub_u32 s61,s60,49
s_cmp_ge_u32 s60,98
s_cselect_b32 s34,s61,s34
s_cselect_b32 s33,1,s33
s_cmp_lt_u32 s62,15
s_cselect_b32 s34,s62,s34
s_cselect_b32 s33,0,s33
s_lshl_b32 s35,s33,6
s_add_u32 s35,s35,s34
s_lshl_b32 s35,s35,9
s_add_u32 s35,s35,589824
s_lshl_b32 s60,s33,6
s_add_u32 s60,s60,s34
s_mul_i32 s73,s60,98304
s_add_u32 s73,s73,s71
W4_COLD:
fb_366:
buffer_load_dword v3,v2,s[8:11],s35 offen sc1
s_waitcnt vmcnt(0)
v_cmp_eq_u32 vcc,0,v3
s_nop 0
s_cbranch_vccz ok_367
s_sleep 2
s_sub_u32 s47,s47,1
s_cbranch_scc1 ABORT
s_branch fb_366
ok_367:
s_add_u32 s63,s73,0
buffer_load_dwordx4 v[16:19],v208,s[8:11],s63 offen sc1
s_nop 7
buffer_load_dwordx4 v[20:23],v209,s[8:11],s63 offen sc1
s_nop 7
buffer_load_dwordx4 v[24:27],v208,s[8:11],s63 offen offset:2048 sc1
s_nop 7
buffer_load_dwordx4 v[28:31],v209,s[8:11],s63 offen offset:2048 sc1
s_nop 7
s_add_u32 s63,s73,4096
buffer_load_dwordx4 v[32:35],v208,s[8:11],s63 offen sc1
s_nop 7
buffer_load_dwordx4 v[36:39],v209,s[8:11],s63 offen sc1
s_nop 7
buffer_load_dwordx4 v[40:43],v208,s[8:11],s63 offen offset:2048 sc1
s_nop 7
buffer_load_dwordx4 v[44:47],v209,s[8:11],s63 offen offset:2048 sc1
s_nop 7
s_add_u32 s63,s73,8192
buffer_load_dwordx4 v[48:51],v208,s[8:11],s63 offen sc1
s_nop 7
buffer_load_dwordx4 v[52:55],v209,s[8:11],s63 offen sc1
W4_NEXT:
s_mov_b32 s51,s33
s_mov_b32 s52,s34
s_mov_b32 s72,s73
s_add_u32 s32,s32,1
s_waitcnt vmcnt(9)
v_mfma_f32_32x32x16_bf16 v[112:127],a[0:3],v[16:19],0
s_add_u32 s63,s72,8192
buffer_load_dwordx4 v[56:59],v208,s[8:11],s63 offen offset:2048 sc1
s_min_u32 s62,s32,127
s_sub_u32 s60,s62,15
s_lshr_b32 s34,s60,1
v_mfma_f32_32x32x16_bf16 v[128:143],a[96:99],v[16:19],0
s_and_b32 s33,s60,1
s_cmp_eq_u32 s33,0
s_cselect_b32 s61,15,0
s_add_u32 s34,s34,s61
s_sub_u32 s61,s60,49
v_xor_b32 v206,0x8000,v206
s_waitcnt vmcnt(9)
v_mfma_f32_32x32x16_bf16 v[112:127],a[4:7],v[20:23],v[112:127]
buffer_load_dwordx4 v[60:63],v209,s[8:11],s63 offen offset:2048 sc1
s_cmp_ge_u32 s60,98
s_cselect_b32 s34,s61,s34
s_cselect_b32 s33,1,s33
v_xor_b32 v207,0x8000,v207
v_mfma_f32_32x32x16_bf16 v[128:143],a[100:103],v[20:23],v[128:143]
s_cmp_lt_u32 s62,15
s_cselect_b32 s34,s62,s34
s_cselect_b32 s33,0,s33
s_lshl_b32 s35,s33,6
s_add_u32 s35,s35,s34
s_lshl_b32 s35,s35,9
s_waitcnt vmcnt(9)
v_mfma_f32_32x32x16_bf16 v[112:127],a[8:11],v[24:27],v[112:127]
s_add_u32 s63,s72,12288
buffer_load_dwordx4 v[64:67],v208,s[8:11],s63 offen sc1
s_add_u32 s35,s35,589824
s_lshl_b32 s60,s33,6
s_add_u32 s60,s60,s34
v_mfma_f32_32x32x16_bf16 v[128:143],a[104:107],v[24:27],v[128:143]
s_mul_i32 s73,s60,98304
s_add_u32 s73,s73,s71
buffer_load_dword v3,v2,s[8:11],s35 offen sc1
s_lshl_b32 s64,s51,6
s_add_u32 s64,s64,s52
s_waitcnt vmcnt(10)
v_mfma_f32_32x32x16_bf16 v[112:127],a[12:15],v[28:31],v[112:127]
buffer_load_dwordx4 v[68:71],v209,s[8:11],s63 offen sc1
s_mul_i32 s65,s64,46080
s_add_u32 s65,s65,s70
s_add_u32 s65,s65,212467712
v_mfma_f32_32x32x16_bf16 v[128:143],a[108:111],v[28:31],v[128:143]
buffer_load_dwordx4 v[176:179],v1,s[8:11],s65 offen sc1
s_mul_i32 s65,s64,40960
s_add_u32 s65,s65,s70
s_add_u32 s65,s65,218365952
s_waitcnt vmcnt(11)
v_mfma_f32_32x32x16_bf16 v[112:127],a[16:19],v[32:35],v[112:127]
buffer_load_dwordx4 v[72:75],v208,s[8:11],s63 offen offset:2048 sc1
v_mfma_f32_32x32x16_bf16 v[128:143],a[112:115],v[32:35],v[128:143]
s_waitcnt vmcnt(11)
v_mfma_f32_32x32x16_bf16 v[112:127],a[20:23],v[36:39],v[112:127]
buffer_load_dwordx4 v[76:79],v209,s[8:11],s63 offen offset:2048 sc1
v_mfma_f32_32x32x16_bf16 v[128:143],a[116:119],v[36:39],v[128:143]
s_waitcnt vmcnt(11)
v_mfma_f32_32x32x16_bf16 v[112:127],a[24:27],v[40:43],v[112:127]
s_add_u32 s63,s72,16384
buffer_load_dwordx4 v[80:83],v208,s[8:11],s63 offen sc1
v_mfma_f32_32x32x16_bf16 v[128:143],a[120:123],v[40:43],v[128:143]
s_waitcnt vmcnt(11)
v_mfma_f32_32x32x16_bf16 v[112:127],a[28:31],v[44:47],v[112:127]
buffer_load_dwordx4 v[84:87],v209,s[8:11],s63 offen sc1
v_mfma_f32_32x32x16_bf16 v[128:143],a[124:127],v[44:47],v[128:143]
s_waitcnt vmcnt(11)
v_mfma_f32_32x32x16_bf16 v[112:127],a[32:35],v[48:51],v[112:127]
buffer_load_dwordx4 v[88:91],v208,s[8:11],s63 offen offset:2048 sc1
v_mfma_f32_32x32x16_bf16 v[128:143],a[128:131],v[48:51],v[128:143]
s_waitcnt vmcnt(11)
v_mfma_f32_32x32x16_bf16 v[112:127],a[36:39],v[52:55],v[112:127]
buffer_load_dwordx4 v[92:95],v209,s[8:11],s63 offen offset:2048 sc1
v_mfma_f32_32x32x16_bf16 v[128:143],a[132:135],v[52:55],v[128:143]
s_waitcnt vmcnt(11)
v_mfma_f32_32x32x16_bf16 v[112:127],a[40:43],v[56:59],v[112:127]
s_add_u32 s63,s72,20480
buffer_load_dwordx4 v[96:99],v208,s[8:11],s63 offen sc1
v_mfma_f32_32x32x16_bf16 v[128:143],a[136:139],v[56:59],v[128:143]
s_waitcnt vmcnt(11)
v_mfma_f32_32x32x16_bf16 v[112:127],a[44:47],v[60:63],v[112:127]
buffer_load_dwordx4 v[100:103],v209,s[8:11],s63 offen sc1
v_mfma_f32_32x32x16_bf16 v[128:143],a[140:143],v[60:63],v[128:143]
s_waitcnt vmcnt(11)
v_mfma_f32_32x32x16_bf16 v[112:127],a[48:51],v[64:67],v[112:127]
buffer_load_dwordx4 v[104:107],v208,s[8:11],s63 offen offset:2048 sc1
v_mfma_f32_32x32x16_bf16 v[128:143],a[144:147],v[64:67],v[128:143]
s_waitcnt vmcnt(11)
v_cmp_eq_u32 vcc,0,v3
s_cmp_eq_u64 vcc,0
s_cselect_b32 s37,0,2147483648
s_cmp_lt_u32 s32,128
s_cselect_b32 s37,s37,2147483648
s_waitcnt vmcnt(10)
v_mfma_f32_32x32x16_bf16 v[112:127],a[52:55],v[68:71],v[112:127]
buffer_load_dwordx4 v[108:111],v209,s[8:11],s63 offen offset:2048 sc1
s_add_u32 s67,s73,s37
v_mfma_f32_32x32x16_bf16 v[128:143],a[148:151],v[68:71],v[128:143]
s_mov_b64 exec,1
buffer_store_dword v5,v1,s[8:11],s59 offen sc1
s_mov_b64 exec,-1
s_mov_b32 s59,2147483648
s_waitcnt vmcnt(10)
v_mfma_f32_32x32x16_bf16 v[112:127],a[56:59],v[72:75],v[112:127]
s_add_u32 s63,s67,0
buffer_load_dwordx4 v[16:19],v208,s[8:11],s63 offen sc1
buffer_load_dwordx4 v[180:183],v15,s[8:11],s65 offen sc1
v_mfma_f32_32x32x16_bf16 v[128:143],a[152:155],v[72:75],v[128:143]
s_waitcnt vmcnt(11)
v_mfma_f32_32x32x16_bf16 v[112:127],a[60:63],v[76:79],v[112:127]
buffer_load_dwordx4 v[20:23],v209,s[8:11],s63 offen sc1
v_mfma_f32_32x32x16_bf16 v[128:143],a[156:159],v[76:79],v[128:143]
s_waitcnt vmcnt(11)
v_mfma_f32_32x32x16_bf16 v[112:127],a[64:67],v[80:83],v[112:127]
buffer_load_dwordx4 v[24:27],v208,s[8:11],s63 offen offset:2048 sc1
v_mfma_f32_32x32x16_bf16 v[128:143],a[160:163],v[80:83],v[128:143]
s_waitcnt vmcnt(11)
v_mfma_f32_32x32x16_bf16 v[112:127],a[68:71],v[84:87],v[112:127]
buffer_load_dwordx4 v[28:31],v209,s[8:11],s63 offen offset:2048 sc1
v_mfma_f32_32x32x16_bf16 v[128:143],a[164:167],v[84:87],v[128:143]
s_waitcnt vmcnt(11)
v_mfma_f32_32x32x16_bf16 v[112:127],a[72:75],v[88:91],v[112:127]
s_add_u32 s63,s67,4096
buffer_load_dwordx4 v[32:35],v208,s[8:11],s63 offen sc1
buffer_load_dword v3,v2,s[8:11],s35 offen sc1
v_mfma_f32_32x32x16_bf16 v[128:143],a[168:171],v[88:91],v[128:143]
s_waitcnt vmcnt(12)
v_mfma_f32_32x32x16_bf16 v[112:127],a[76:79],v[92:95],v[112:127]
buffer_load_dwordx4 v[36:39],v209,s[8:11],s63 offen sc1
v_mfma_f32_32x32x16_bf16 v[128:143],a[172:175],v[92:95],v[128:143]
s_waitcnt vmcnt(12)
v_mfma_f32_32x32x16_bf16 v[112:127],a[80:83],v[96:99],v[112:127]
buffer_load_dwordx4 v[40:43],v208,s[8:11],s63 offen offset:2048 sc1
v_mfma_f32_32x32x16_bf16 v[128:143],a[176:179],v[96:99],v[128:143]
s_waitcnt vmcnt(12)
v_mfma_f32_32x32x16_bf16 v[112:127],a[84:87],v[100:103],v[112:127]
buffer_load_dwordx4 v[44:47],v209,s[8:11],s63 offen offset:2048 sc1
v_mfma_f32_32x32x16_bf16 v[128:143],a[180:183],v[100:103],v[128:143]
s_waitcnt vmcnt(12)
v_mfma_f32_32x32x16_bf16 v[112:127],a[88:91],v[104:107],v[112:127]
s_add_u32 s63,s67,8192
buffer_load_dwordx4 v[48:51],v208,s[8:11],s63 offen sc1
v_mfma_f32_32x32x16_bf16 v[128:143],a[184:187],v[104:107],v[128:143]
s_waitcnt vmcnt(12)
v_mfma_f32_32x32x16_bf16 v[112:127],a[92:95],v[108:111],v[112:127]
buffer_load_dwordx4 v[52:55],v209,s[8:11],s63 offen sc1
v_mfma_f32_32x32x16_bf16 v[128:143],a[188:191],v[108:111],v[128:143]
s_cmp_eq_u32 s37,0
s_cbranch_scc1 ep_368
s_waitcnt vmcnt(0)
v_cmp_eq_u32 vcc,0,v3
s_cmp_eq_u64 vcc,0
s_cselect_b32 s37,0,2147483648
s_cmp_lt_u32 s32,128
s_cselect_b32 s37,s37,2147483648
s_cmp_lg_u32 s37,0
s_cbranch_scc1 ep_368
s_add_u32 s63,s73,0
buffer_load_dwordx4 v[16:19],v208,s[8:11],s63 offen sc1
buffer_load_dwordx4 v[20:23],v209,s[8:11],s63 offen sc1
buffer_load_dwordx4 v[24:27],v208,s[8:11],s63 offen offset:2048 sc1
buffer_load_dwordx4 v[28:31],v209,s[8:11],s63 offen offset:2048 sc1
s_add_u32 s63,s73,4096
buffer_load_dwordx4 v[32:35],v208,s[8:11],s63 offen sc1
buffer_load_dwordx4 v[36:39],v209,s[8:11],s63 offen sc1
buffer_load_dwordx4 v[40:43],v208,s[8:11],s63 offen offset:2048 sc1
buffer_load_dwordx4 v[44:47],v209,s[8:11],s63 offen offset:2048 sc1
s_add_u32 s63,s73,8192
buffer_load_dwordx4 v[48:51],v208,s[8:11],s63 offen sc1
buffer_load_dwordx4 v[52:55],v209,s[8:11],s63 offen sc1
ep_368:
s_nop 7
ds_write_b128 v206,v[112:115] offset:0
ds_write_b128 v206,v[116:119] offset:1024
ds_write_b128 v206,v[120:123] offset:512
ds_write_b128 v206,v[124:127] offset:1536
s_nop 0
ds_write_b128 v206,v[128:131] offset:8192
ds_write_b128 v206,v[132:135] offset:9216
ds_write_b128 v206,v[136:139] offset:8704
ds_write_b128 v206,v[140:143] offset:9728
s_waitcnt vmcnt(10)
v_lshlrev_b32 v184,16,v176
v_and_b32 v185,0xffff0000,v176
v_lshlrev_b32 v186,16,v177
v_and_b32 v187,0xffff0000,v177
v_lshlrev_b32 v188,16,v178
v_and_b32 v189,0xffff0000,v178
v_lshlrev_b32 v190,16,v179
v_and_b32 v191,0xffff0000,v179
v_lshlrev_b32 v192,16,v180
v_and_b32 v193,0xffff0000,v180
v_lshlrev_b32 v194,16,v181
v_and_b32 v195,0xffff0000,v181
v_lshlrev_b32 v196,16,v182
v_and_b32 v197,0xffff0000,v182
v_lshlrev_b32 v198,16,v183
v_and_b32 v199,0xffff0000,v183
s_waitcnt lgkmcnt(0)
s_barrier
ds_read_b128 v[144:147],v207 offset:0
ds_read_b128 v[148:151],v207 offset:1024
ds_read_b128 v[152:155],v207 offset:2048
ds_read_b128 v[156:159],v207 offset:3072
ds_read_b128 v[160:163],v207 offset:4096
ds_read_b128 v[164:167],v207 offset:5120
ds_read_b128 v[168:171],v207 offset:6144
ds_read_b128 v[172:175],v207 offset:7168
s_waitcnt lgkmcnt(4)
v_pk_add_f32 v[144:145],v[144:145],v[152:153]
v_pk_add_f32 v[146:147],v[146:147],v[154:155]
v_pk_add_f32 v[148:149],v[148:149],v[156:157]
v_pk_add_f32 v[150:151],v[150:151],v[158:159]
s_waitcnt lgkmcnt(0)
v_pk_add_f32 v[160:161],v[160:161],v[168:169]
v_pk_add_f32 v[162:163],v[162:163],v[170:171]
v_pk_add_f32 v[164:165],v[164:165],v[172:173]
v_pk_add_f32 v[166:167],v[166:167],v[174:175]
v_pk_add_f32 v[144:145],v[144:145],v[160:161]
v_pk_add_f32 v[146:147],v[146:147],v[162:163]
v_pk_add_f32 v[148:149],v[148:149],v[164:165]
v_pk_add_f32 v[150:151],v[150:151],v[166:167]
v_cvt_pk_bf16_f32 v6,v144,v145
v_lshlrev_b32 v144,16,v6
v_and_b32 v145,0xffff0000,v6
v_cvt_pk_bf16_f32 v6,v146,v147
v_lshlrev_b32 v146,16,v6
v_and_b32 v147,0xffff0000,v6
v_cvt_pk_bf16_f32 v6,v148,v149
v_lshlrev_b32 v148,16,v6
v_and_b32 v149,0xffff0000,v6
v_cvt_pk_bf16_f32 v6,v150,v151
v_lshlrev_b32 v150,16,v6
v_and_b32 v151,0xffff0000,v6
v_pk_add_f32 v[144:145],v[144:145],v[184:185]
v_pk_add_f32 v[146:147],v[146:147],v[186:187]
v_pk_add_f32 v[148:149],v[148:149],v[188:189]
v_pk_add_f32 v[150:151],v[150:151],v[190:191]
v_cvt_pk_bf16_f32 v6,v144,v145
v_lshlrev_b32 v144,16,v6
v_and_b32 v145,0xffff0000,v6
v_cvt_pk_bf16_f32 v6,v146,v147
v_lshlrev_b32 v146,16,v6
v_and_b32 v147,0xffff0000,v6
v_cvt_pk_bf16_f32 v6,v148,v149
v_lshlrev_b32 v148,16,v6
v_and_b32 v149,0xffff0000,v6
v_cvt_pk_bf16_f32 v6,v150,v151
v_lshlrev_b32 v150,16,v6
v_and_b32 v151,0xffff0000,v6
v_pk_add_f32 v[144:145],v[144:145],v[192:193]
v_pk_add_f32 v[146:147],v[146:147],v[194:195]
v_pk_add_f32 v[148:149],v[148:149],v[196:197]
v_pk_add_f32 v[150:151],v[150:151],v[198:199]
v_cvt_pk_bf16_f32 v200,v144,v145
v_lshlrev_b32 v144,16,v200
v_and_b32 v145,0xffff0000,v200
v_cvt_pk_bf16_f32 v201,v146,v147
v_lshlrev_b32 v146,16,v201
v_and_b32 v147,0xffff0000,v201
v_cvt_pk_bf16_f32 v202,v148,v149
v_lshlrev_b32 v148,16,v202
v_and_b32 v149,0xffff0000,v202
v_cvt_pk_bf16_f32 v203,v150,v151
v_lshlrev_b32 v150,16,v203
v_and_b32 v151,0xffff0000,v203
s_cmp_lg_u32 s51,0
s_cbranch_scc1 w4o_369
s_mul_i32 s62,s52,46080
s_add_u32 s62,s62,209518592
s_add_u32 s63,s62,s70
buffer_store_dwordx4 v[200:203],v15,s[8:11],s63 offen sc1
v_add_f32 v6,v144,v145
v_mul_f32 v7,v144,v144
v_fmac_f32 v7,v145,v145
v_add_f32 v6,v6,v146
v_fmac_f32 v7,v146,v146
v_add_f32 v6,v6,v147
v_fmac_f32 v7,v147,v147
v_add_f32 v6,v6,v148
v_fmac_f32 v7,v148,v148
v_add_f32 v6,v6,v149
v_fmac_f32 v7,v149,v149
v_add_f32 v6,v6,v150
v_fmac_f32 v7,v150,v150
v_add_f32 v6,v6,v151
v_fmac_f32 v7,v151,v151
v_mov_b32 v8,v6
v_mov_b32 v9,v7
s_nop 0
v_permlane32_swap_b32 v6,v8
v_permlane32_swap_b32 v7,v9
v_add_f32 v6,v6,v8
v_add_f32 v7,v7,v9
v_mov_b32 v8,v6
v_mov_b32 v9,v7
s_nop 0
v_permlane16_swap_b32 v6,v8
v_permlane16_swap_b32 v7,v9
v_add_f32 v6,v6,v8
v_add_f32 v7,v7,v9
s_lshl_b32 s63,s68,8
s_lshl_b32 s60,s69,7
s_add_u32 s63,s63,s60
s_add_u32 s63,s63,s62
s_add_u32 s63,s63,40960
s_mov_b64 exec,0xffff
buffer_store_dwordx2 v[6:7],v204,s[8:11],s63 offen sc1
s_mov_b64 exec,-1
s_mov_b32 s66,1
s_lshl_b32 s59,s66,6
s_add_u32 s59,s59,s52
s_lshl_b32 s59,s59,9
s_add_u32 s59,s59,0
s_lshl_b32 s61,s56,2
s_add_u32 s59,s59,s61
s_branch w4n_370
w4o_369:
s_mul_i32 s62,s52,40960
buffer_store_dwordx2 v[200:201],v205,s[76:79],s62 offen
buffer_store_dwordx2 v[202:203],v205,s[76:79],s62 offen offset:32
w4n_370:
s_cmp_eq_u32 s37,0
s_cbranch_scc1 W4_NEXT
s_waitcnt vmcnt(0)
s_mov_b64 exec,1
buffer_store_dword v5,v1,s[8:11],s59 offen sc1
s_mov_b64 exec,-1
s_mov_b32 s59,2147483648
s_cmp_lt_u32 s32,128
s_cbranch_scc1 W4_COLD
s_endpgm
.section .rodata,"a"
.p2align 6
.amdhsa_kernel interleave_layers__memory_aug_recurrent_mem_tr__mixer_s_mlp__prompt_kernel
  .amdhsa_next_free_vgpr 512
  .amdhsa_next_free_sgpr 102
  .amdhsa_accum_offset 256
  .amdhsa_group_segment_fixed_size 0
  .amdhsa_kernarg_size 120
  .amdhsa_user_sgpr_count 2
  .amdhsa_user_sgpr_kernarg_segment_ptr 1
  .amdhsa_system_sgpr_workgroup_id_x 1
.end_amdhsa_kernel
```

```asm
; @launch grid=(256,1,1) block=(256,1,1) lds=163840
.amdgcn_target "amdgcn-amd-amdhsa--gfx950"
.text
.globl interleave_layers__memory_aug_recurrent_mem_tr__mixer_s_mlp__prompt_kernel
.p2align 8
.type interleave_layers__memory_aug_recurrent_mem_tr__mixer_s_mlp__prompt_kernel,@function
interleave_layers__memory_aug_recurrent_mem_tr__mixer_s_mlp__prompt_kernel:
s_cmp_ge_u32 s2,256
s_cbranch_scc1 EXIT
s_load_dwordx16 s[16:31],s[0:1],0
s_load_dwordx8 s[32:39],s[0:1],64
s_load_dwordx4 s[40:43],s[0:1],96
s_load_dwordx2 s[44:45],s[0:1],112
v_lshrrev_b32 v1,6,v0
v_and_b32 v0,63,v0
v_readfirstlane_b32 s46,v1
s_mov_b32 s47,200000
s_mov_b32 s49,0
s_getreg_b32 s4,hwreg(HW_REG_XCC_ID)
s_and_b32 s4,s4,7
s_waitcnt lgkmcnt(0)
s_mov_b32 s8,s44
s_mov_b32 s9,s45
s_mov_b32 s10,268435456
s_mov_b32 s11,0x20000
s_mov_b32 s12,s42
s_mov_b32 s13,s43
s_mov_b32 s14,256
s_mov_b32 s15,0x20000
v_lshlrev_b32 v1,4,v0
v_mov_b32 v4,0
v_mov_b32 v5,0
v_mov_b32 v6,0
v_mov_b32 v7,0
s_lshl_b32 s5,s2,2
s_add_u32 s5,s5,s46
s_lshl_b32 s5,s5,10
buffer_store_dwordx4 v[4:7],v1,s[8:11],s5 offen sc1
s_cmp_ge_u32 s4,4
s_cbranch_scc1 VOTE_DONE
s_cmp_lg_u32 s46,1
s_cbranch_scc1 VOTE_DONE
s_and_b32 s52,s2,24
s_cbranch_scc1 VOTE_DONE
s_mov_b64 exec,1
v_mov_b32 v12,0
s_and_b32 s53,s2,63
s_lshl_b32 s53,s53,7
s_lshr_b32 s52,s2,6
s_mul_i32 s52,s52,3
s_add_u32 s52,s52,s46
s_lshl_b32 s52,s52,14
s_add_u32 s53,s53,s52
s_add_u32 s53,s53,11796480
s_add_u32 s59,s53,0x2000
buffer_store_dword v12,v12,s[8:11],s53 offen sc1
buffer_store_dword v12,v12,s[8:11],s59 offen sc1
s_waitcnt vmcnt(0)
s_memtime s[54:55]
s_waitcnt lgkmcnt(0)
buffer_load_dword v13,v12,s[8:11],s53 offen sc1
s_waitcnt vmcnt(0)
s_memtime s[56:57]
s_waitcnt lgkmcnt(0)
s_sub_u32 s50,s56,s54
s_memtime s[54:55]
s_waitcnt lgkmcnt(0)
buffer_load_dword v13,v12,s[8:11],s59 offen sc1
s_waitcnt vmcnt(0)
s_memtime s[56:57]
s_waitcnt lgkmcnt(0)
s_sub_u32 s51,s56,s54
s_cmp_lt_u32 s51,s50
s_cselect_b32 s52,1,-1
v_mov_b32 v13,s52
v_mov_b32 v12,192
buffer_atomic_add v13,v12,s[12:15],0 offen sc1
s_mov_b64 exec,-1
VOTE_DONE:
v_mov_b32 v2,0
s_cmp_lg_u32 s46,0
s_cbranch_scc1 TK_DONE
s_mov_b64 exec,1
v_mov_b32 v1,1
s_lshl_b32 s5,s4,2
v_mov_b32 v3,s5
buffer_atomic_add v1,v3,s[12:15],0 offen offset:32 sc0 sc1
s_waitcnt vmcnt(0)
v_readfirstlane_b32 s5,v1
s_lshl_b32 s6,s4,5
s_add_u32 s6,s6,s5
s_cmp_lt_u32 s5,32
s_cselect_b32 s6,s6,999
v_mov_b32 v1,s6
ds_write_b32 v2,v1
s_mov_b64 exec,-1
s_waitcnt lgkmcnt(0)
TK_DONE:
s_barrier
ds_read_b32 v1,v2
s_waitcnt lgkmcnt(0)
v_readfirstlane_b32 s3,v1
s_barrier
s_nop 2
s_branch DISPATCH
ROLE_CS:
s_lshr_b32 s28,s48,4
s_and_b32 s29,s48,15
s_mul_i32 s82,s28,2097152
s_add_u32 s82,s82,2097152
v_lshlrev_b32 v1,4,v0
v_and_b32 v12,1,v0
v_mul_u32_u24 v2,0xaaaa,v12
v_or_b32 v2,0x4444,v2
s_add_u32 s60,s46,1
s_and_b32 s60,s60,3
s_lshl_b32 s60,s60,11
s_add_u32 s60,s60,131072
v_add_u32 v3,s60,v1
s_add_u32 s60,s46,2
s_and_b32 s60,s60,3
s_lshl_b32 s60,s60,11
s_add_u32 s60,s60,131072
v_add_u32 v4,s60,v1
s_add_u32 s60,s46,3
s_and_b32 s60,s60,3
s_lshl_b32 s60,s60,11
s_add_u32 s60,s60,131072
v_add_u32 v5,s60,v1
v_add_u32 v59,139264,v1
s_lshl_b32 s60,s46,11
s_add_u32 s60,s60,131072
v_add_u32 v22,s60,v1
s_lshr_b32 s60,s46,1
s_lshl_b32 s60,s60,10
s_and_b32 s61,s46,1
s_lshl_b32 s61,s61,3
s_add_u32 s60,s60,s61
v_add_u32 v23,s60,v59
s_mul_i32 s60,s46,20480
v_add_u32 v21,s60,v1
v_and_b32 v11,7,v0
v_lshlrev_b32 v11,2,v11
v_bfe_u32 v12,v0,3,2
v_lshl_add_u32 v11,v12,7,v11
s_xor_b32 s60,s28,1
s_lshl_b32 s60,s60,19
s_lshl_b32 s61,s46,14
s_add_u32 s83,s60,s61
s_add_u32 s83,s83,10485760
s_mov_b32 s36,0
s_mov_b32 s88,0xcccccccc
s_mov_b32 s89,0xcccccccc
s_mov_b32 s90,0x33333333
s_mov_b32 s91,0x33333333
s_mov_b32 s87,0x3dd53b95
v_lshrrev_b32 v14,4,v0
v_and_b32 v15,15,v0
v_lshrrev_b32 v12,2,v15
v_add_u32 v12,v12,v14
v_and_b32 v12,3,v12
v_lshlrev_b32 v6,3,v12
v_lshl_add_u32 v6,v15,5,v6
s_mul_i32 s60,s46,1536
s_add_u32 s60,s60,141312
v_add_u32 v6,s60,v6
v_add_u32 v12,v0,v14
v_and_b32 v12,3,v12
v_lshlrev_b32 v7,3,v12
v_lshrrev_b32 v12,2,v0
v_lshl_add_u32 v7,v12,5,v7
v_add_u32 v7,141312,v7
s_min_u32 s62,s46,2
v_lshrrev_b32 v12,2,v15
v_and_b32 v13,1,v15
v_lshl_add_u32 v12,v12,1,v13
v_bfe_u32 v13,v15,1,1
v_lshlrev_b32 v8,8,v14
v_lshl_add_u32 v8,v12,5,v8
v_xor_b32 v16,1,v13
v_lshl_add_u32 v8,v16,4,v8
v_lshlrev_b32 v20,8,v14
v_lshl_add_u32 v20,v13,7,v20
v_and_b32 v16,3,v12
v_lshl_add_u32 v20,v16,5,v20
v_lshrrev_b32 v16,2,v12
v_lshl_add_u32 v20,v16,4,v20
v_min_u32 v12,5,v0
s_mul_i32 s60,s48,3
v_add_u32 v9,s60,v12
v_lshlrev_b32 v9,2,v9
v_add_u32 v13,65524,v9
v_cmp_lt_u32 vcc,2,v12
s_nop 1
v_cndmask_b32 v9,v9,v13,vcc
s_mul_i32 s84,s48,12288
s_add_u32 s84,s84,74448896
s_mul_i32 s60,s29,3072
s_lshl_b32 s61,s62,10
s_add_u32 s60,s60,s61
s_add_u32 s60,s60,s82
s_add_u32 s33,s60,163840
s_add_u32 s34,s60,557056
s_mul_i32 s85,s48,6144
s_add_u32 s85,s85,24117248
s_lshl_b32 s86,s48,5
s_lshl_b32 s61,s62,2
s_add_u32 s86,s86,688128
s_lshr_b32 s60,s29,2
s_lshl_b32 s60,s60,7
s_and_b32 s63,s29,3
s_mul_i32 s63,s63,12
s_add_u32 s60,s60,s63
s_add_u32 s60,s60,s61
s_add_u32 s60,s60,s82
s_add_u32 s35,s60,951296
s_cmp_eq_u32 s46,3
s_cbranch_scc1 si_1
v_mov_b32 v12,-1
v_mov_b32 v13,0
s_cmp_lg_u32 s49,0
s_cbranch_scc1 ls_2
s_add_u32 s60,s33,0
buffer_store_dword v12,v1,s[8:11],s60 offen
s_add_u32 s60,s33,49152
buffer_store_dword v12,v1,s[8:11],s60 offen
s_add_u32 s60,s33,98304
buffer_store_dword v12,v1,s[8:11],s60 offen
s_add_u32 s60,s33,147456
buffer_store_dword v12,v1,s[8:11],s60 offen
s_add_u32 s60,s33,196608
buffer_store_dword v12,v1,s[8:11],s60 offen
s_add_u32 s60,s33,245760
buffer_store_dword v12,v1,s[8:11],s60 offen
s_add_u32 s60,s33,294912
buffer_store_dword v12,v1,s[8:11],s60 offen
s_add_u32 s60,s33,344064
buffer_store_dword v12,v1,s[8:11],s60 offen
s_mov_b64 exec,1
buffer_store_dword v13,v1,s[8:11],s35 offen
buffer_store_dword v13,v1,s[8:11],s35 offen offset:512
s_mov_b64 exec,-1
s_branch ls_3
ls_2:
s_add_u32 s60,s33,0
buffer_store_dword v12,v1,s[8:11],s60 offen sc1
s_add_u32 s60,s33,49152
buffer_store_dword v12,v1,s[8:11],s60 offen sc1
s_add_u32 s60,s33,98304
buffer_store_dword v12,v1,s[8:11],s60 offen sc1
s_add_u32 s60,s33,147456
buffer_store_dword v12,v1,s[8:11],s60 offen sc1
s_add_u32 s60,s33,196608
buffer_store_dword v12,v1,s[8:11],s60 offen sc1
s_add_u32 s60,s33,245760
buffer_store_dword v12,v1,s[8:11],s60 offen sc1
s_add_u32 s60,s33,294912
buffer_store_dword v12,v1,s[8:11],s60 offen sc1
s_add_u32 s60,s33,344064
buffer_store_dword v12,v1,s[8:11],s60 offen sc1
s_mov_b64 exec,1
buffer_store_dword v13,v1,s[8:11],s35 offen sc1
buffer_store_dword v13,v1,s[8:11],s35 offen offset:512 sc1
s_mov_b64 exec,-1
ls_3:
si_1:
s_mul_i32 s73,s48,384
s_mov_b32 s74,s73
v_add_u32 v12,0,v0
v_mul_u32_u24 v13,2731,v12
v_lshrrev_b32 v13,16,v13
v_mul_u32_u24 v16,24,v13
v_sub_u32 v12,v12,v16
v_mul_u32_u24 v104,12288,v13
v_lshl_add_u32 v104,v12,4,v104
v_add_u32 v12,64,v0
v_mul_u32_u24 v13,2731,v12
v_lshrrev_b32 v13,16,v13
v_mul_u32_u24 v16,24,v13
v_sub_u32 v12,v12,v16
v_mul_u32_u24 v105,12288,v13
v_lshl_add_u32 v105,v12,4,v105
v_add_u32 v12,128,v0
v_mul_u32_u24 v13,2731,v12
v_lshrrev_b32 v13,16,v13
v_mul_u32_u24 v16,24,v13
v_sub_u32 v12,v12,v16
v_mul_u32_u24 v106,12288,v13
v_lshl_add_u32 v106,v12,4,v106
s_mov_b32 s4,s20
s_mov_b32 s5,s21
s_mov_b32 s6,7864320
s_mov_b32 s7,0x20000
s_mov_b32 s52,s22
s_mov_b32 s53,s23
s_mov_b32 s54,7864320
s_mov_b32 s55,0x20000
s_branch SV_LOAD
ROLE_CV:
s_lshr_b32 s28,s48,3
s_and_b32 s29,s48,7
s_mul_i32 s82,s28,2097152
s_add_u32 s82,s82,2097152
v_lshlrev_b32 v1,4,v0
v_and_b32 v12,1,v0
v_mul_u32_u24 v2,0xaaaa,v12
v_or_b32 v2,0x4444,v2
s_add_u32 s60,s46,1
s_and_b32 s60,s60,3
s_lshl_b32 s60,s60,11
s_add_u32 s60,s60,131072
v_add_u32 v3,s60,v1
s_add_u32 s60,s46,2
s_and_b32 s60,s60,3
s_lshl_b32 s60,s60,11
s_add_u32 s60,s60,131072
v_add_u32 v4,s60,v1
s_add_u32 s60,s46,3
s_and_b32 s60,s60,3
s_lshl_b32 s60,s60,11
s_add_u32 s60,s60,131072
v_add_u32 v5,s60,v1
v_add_u32 v59,139264,v1
s_lshl_b32 s60,s46,11
s_add_u32 s60,s60,131072
v_add_u32 v22,s60,v1
s_lshr_b32 s60,s46,1
s_lshl_b32 s60,s60,10
s_and_b32 s61,s46,1
s_lshl_b32 s61,s61,3
s_add_u32 s60,s60,s61
v_add_u32 v23,s60,v59
s_mul_i32 s60,s46,20480
v_add_u32 v21,s60,v1
v_and_b32 v11,7,v0
v_lshlrev_b32 v11,2,v11
v_bfe_u32 v12,v0,3,2
v_lshl_add_u32 v11,v12,7,v11
s_xor_b32 s60,s28,1
s_lshl_b32 s60,s60,19
s_lshl_b32 s61,s46,14
s_add_u32 s83,s60,s61
s_add_u32 s83,s83,10485760
s_mov_b32 s36,1
v_mov_b32 v8,0
v_mov_b32 v9,0
v_mov_b32 v20,0
s_and_b32 s62,s46,1
s_lshl_b32 s60,s62,11
v_add_u32 v6,s60,v1
s_lshl_b32 s60,s62,3
s_add_u32 s60,s60,1024
v_add_u32 v7,s60,v1
s_lshr_b32 s61,s46,1
s_lshl_b32 s60,s29,1
s_add_u32 s60,s60,s61
s_mul_i32 s60,s60,3072
s_add_u32 s60,s60,s82
s_add_u32 s34,s60,557056
s_lshl_b32 s60,s48,1
s_add_u32 s60,s60,s61
s_mul_i32 s85,s60,6144
s_add_u32 s85,s85,24120320
s_lshl_b32 s86,s60,5
s_lshl_b32 s61,s62,2
s_add_u32 s86,s86,s61
s_add_u32 s86,s86,688132
v_mov_b32 v12,-1
v_mov_b32 v13,-1
v_mov_b32 v14,-1
v_mov_b32 v15,-1
s_cmp_lg_u32 s49,0
s_cbranch_scc1 ls_4
s_add_u32 s60,s34,0
buffer_store_dwordx4 v[12:15],v6,s[8:11],s60 offen
buffer_store_dwordx2 v[12:13],v7,s[8:11],s60 offen
s_add_u32 s60,s34,49152
buffer_store_dwordx4 v[12:15],v6,s[8:11],s60 offen
buffer_store_dwordx2 v[12:13],v7,s[8:11],s60 offen
s_add_u32 s60,s34,98304
buffer_store_dwordx4 v[12:15],v6,s[8:11],s60 offen
buffer_store_dwordx2 v[12:13],v7,s[8:11],s60 offen
s_add_u32 s60,s34,147456
buffer_store_dwordx4 v[12:15],v6,s[8:11],s60 offen
buffer_store_dwordx2 v[12:13],v7,s[8:11],s60 offen
s_add_u32 s60,s34,196608
buffer_store_dwordx4 v[12:15],v6,s[8:11],s60 offen
buffer_store_dwordx2 v[12:13],v7,s[8:11],s60 offen
s_add_u32 s60,s34,245760
buffer_store_dwordx4 v[12:15],v6,s[8:11],s60 offen
buffer_store_dwordx2 v[12:13],v7,s[8:11],s60 offen
s_add_u32 s60,s34,294912
buffer_store_dwordx4 v[12:15],v6,s[8:11],s60 offen
buffer_store_dwordx2 v[12:13],v7,s[8:11],s60 offen
s_add_u32 s60,s34,344064
buffer_store_dwordx4 v[12:15],v6,s[8:11],s60 offen
buffer_store_dwordx2 v[12:13],v7,s[8:11],s60 offen
s_branch ls_5
ls_4:
s_add_u32 s60,s34,0
buffer_store_dwordx4 v[12:15],v6,s[8:11],s60 offen sc1
buffer_store_dwordx2 v[12:13],v7,s[8:11],s60 offen sc1
s_add_u32 s60,s34,49152
buffer_store_dwordx4 v[12:15],v6,s[8:11],s60 offen sc1
buffer_store_dwordx2 v[12:13],v7,s[8:11],s60 offen sc1
s_add_u32 s60,s34,98304
buffer_store_dwordx4 v[12:15],v6,s[8:11],s60 offen sc1
buffer_store_dwordx2 v[12:13],v7,s[8:11],s60 offen sc1
s_add_u32 s60,s34,147456
buffer_store_dwordx4 v[12:15],v6,s[8:11],s60 offen sc1
buffer_store_dwordx2 v[12:13],v7,s[8:11],s60 offen sc1
s_add_u32 s60,s34,196608
buffer_store_dwordx4 v[12:15],v6,s[8:11],s60 offen sc1
buffer_store_dwordx2 v[12:13],v7,s[8:11],s60 offen sc1
s_add_u32 s60,s34,245760
buffer_store_dwordx4 v[12:15],v6,s[8:11],s60 offen sc1
buffer_store_dwordx2 v[12:13],v7,s[8:11],s60 offen sc1
s_add_u32 s60,s34,294912
buffer_store_dwordx4 v[12:15],v6,s[8:11],s60 offen sc1
buffer_store_dwordx2 v[12:13],v7,s[8:11],s60 offen sc1
s_add_u32 s60,s34,344064
buffer_store_dwordx4 v[12:15],v6,s[8:11],s60 offen sc1
buffer_store_dwordx2 v[12:13],v7,s[8:11],s60 offen sc1
s_nop 0
ls_5:
s_mul_i32 s73,s48,768
s_add_u32 s74,s73,96
v_add_u32 v12,0,v0
v_mul_u32_u24 v13,2731,v12
v_lshrrev_b32 v13,16,v13
v_mul_u32_u24 v16,24,v13
v_sub_u32 v12,v12,v16
v_mul_u32_u24 v104,12288,v13
v_lshl_add_u32 v104,v12,4,v104
v_mul_u32_u24 v13,43,v12
v_lshrrev_b32 v13,8,v13
v_mul_u32_u24 v13,96,v13
v_add_u32 v104,v104,v13
v_add_u32 v12,64,v0
v_mul_u32_u24 v13,2731,v12
v_lshrrev_b32 v13,16,v13
v_mul_u32_u24 v16,24,v13
v_sub_u32 v12,v12,v16
v_mul_u32_u24 v105,12288,v13
v_lshl_add_u32 v105,v12,4,v105
v_mul_u32_u24 v13,43,v12
v_lshrrev_b32 v13,8,v13
v_mul_u32_u24 v13,96,v13
v_add_u32 v105,v105,v13
v_add_u32 v12,128,v0
v_mul_u32_u24 v13,2731,v12
v_lshrrev_b32 v13,16,v13
v_mul_u32_u24 v16,24,v13
v_sub_u32 v12,v12,v16
v_mul_u32_u24 v106,12288,v13
v_lshl_add_u32 v106,v12,4,v106
v_mul_u32_u24 v13,43,v12
v_lshrrev_b32 v13,8,v13
v_mul_u32_u24 v13,96,v13
v_add_u32 v106,v106,v13
s_mov_b32 s4,s24
s_mov_b32 s5,s25
s_mov_b32 s6,7864320
s_mov_b32 s7,0x20000
s_mov_b32 s52,s24
s_mov_b32 s53,s25
s_mov_b32 s54,7864320
s_mov_b32 s55,0x20000
SV_LOAD:
s_waitcnt vmcnt(0)
s_barrier
s_cmp_lg_u32 s46,0
s_cbranch_scc1 arr_6
v_mov_b32 v12,1
s_lshl_b32 s3,s49,2
v_mov_b32 v13,s3
s_mov_b64 exec,1
buffer_atomic_add v12,v13,s[12:15],0 offen sc1
s_mov_b64 exec,-1
arr_6:
s_and_b32 s60,s46,1
s_mul_i32 s60,s60,196608
s_lshr_b32 s61,s46,1
s_mul_i32 s75,s61,393216
s_add_u32 s75,s75,s60
s_mul_i32 s76,s61,1966080
s_add_u32 s76,s76,s60
s_mul_i32 s77,s46,6144
v_lshrrev_b32 v14,4,v0
v_and_b32 v15,15,v0
v_and_b32 v12,1,v14
v_lshlrev_b32 v12,5,v12
v_lshrrev_b32 v13,1,v14
v_lshl_add_u32 v12,v13,3,v12
v_bfe_u32 v13,v0,2,1
v_add_u32 v12,v12,v13
v_bfe_u32 v13,v0,3,1
v_lshl_add_u32 v12,v13,2,v12
v_mul_u32_u24 v107,384,v12
v_and_b32 v13,3,v0
v_lshl_add_u32 v107,v13,3,v107
s_mul_i32 s60,s46,96
v_add_u32 v107,s60,v107
s_add_u32 s60,s75,s73
s_add_u32 m0,s77,0
s_add_u32 s61,s60,0
buffer_load_dwordx4 v104,s[4:7],s61 offen lds
s_add_u32 m0,s77,1024
s_add_u32 s61,s60,0
buffer_load_dwordx4 v105,s[4:7],s61 offen lds
s_add_u32 m0,s77,2048
s_add_u32 s61,s60,0
buffer_load_dwordx4 v106,s[4:7],s61 offen lds
s_add_u32 m0,s77,3072
s_add_u32 s61,s60,98304
buffer_load_dwordx4 v104,s[4:7],s61 offen lds
s_add_u32 m0,s77,4096
s_add_u32 s61,s60,98304
buffer_load_dwordx4 v105,s[4:7],s61 offen lds
s_add_u32 m0,s77,5120
s_add_u32 s61,s60,98304
buffer_load_dwordx4 v106,s[4:7],s61 offen lds
s_add_u32 s60,s75,s74
s_add_u32 m0,s77,24576
s_add_u32 s61,s60,0
buffer_load_dwordx4 v104,s[52:55],s61 offen lds
s_add_u32 m0,s77,25600
s_add_u32 s61,s60,0
buffer_load_dwordx4 v105,s[52:55],s61 offen lds
s_add_u32 m0,s77,26624
s_add_u32 s61,s60,0
buffer_load_dwordx4 v106,s[52:55],s61 offen lds
s_add_u32 m0,s77,27648
s_add_u32 s61,s60,98304
buffer_load_dwordx4 v104,s[52:55],s61 offen lds
s_add_u32 m0,s77,28672
s_add_u32 s61,s60,98304
buffer_load_dwordx4 v105,s[52:55],s61 offen lds
s_add_u32 m0,s77,29696
s_add_u32 s61,s60,98304
buffer_load_dwordx4 v106,s[52:55],s61 offen lds
s_add_u32 s60,s75,s73
s_add_u32 m0,s77,49152
s_add_u32 s61,s60,786432
buffer_load_dwordx4 v104,s[4:7],s61 offen lds
s_add_u32 m0,s77,50176
s_add_u32 s61,s60,786432
buffer_load_dwordx4 v105,s[4:7],s61 offen lds
s_add_u32 m0,s77,51200
s_add_u32 s61,s60,786432
buffer_load_dwordx4 v106,s[4:7],s61 offen lds
s_add_u32 m0,s77,52224
s_add_u32 s61,s60,884736
buffer_load_dwordx4 v104,s[4:7],s61 offen lds
s_add_u32 m0,s77,53248
s_add_u32 s61,s60,884736
buffer_load_dwordx4 v105,s[4:7],s61 offen lds
s_add_u32 m0,s77,54272
s_add_u32 s61,s60,884736
buffer_load_dwordx4 v106,s[4:7],s61 offen lds
s_add_u32 s60,s75,s74
s_add_u32 m0,s77,73728
s_add_u32 s61,s60,786432
buffer_load_dwordx4 v104,s[52:55],s61 offen lds
s_add_u32 m0,s77,74752
s_add_u32 s61,s60,786432
buffer_load_dwordx4 v105,s[52:55],s61 offen lds
s_add_u32 m0,s77,75776
s_add_u32 s61,s60,786432
buffer_load_dwordx4 v106,s[52:55],s61 offen lds
s_add_u32 m0,s77,76800
s_add_u32 s61,s60,884736
buffer_load_dwordx4 v104,s[52:55],s61 offen lds
s_add_u32 m0,s77,77824
s_add_u32 s61,s60,884736
buffer_load_dwordx4 v105,s[52:55],s61 offen lds
s_add_u32 m0,s77,78848
s_add_u32 s61,s60,884736
buffer_load_dwordx4 v106,s[52:55],s61 offen lds
s_add_u32 s60,s75,s73
s_add_u32 m0,s77,98304
s_add_u32 s61,s60,1966080
buffer_load_dwordx4 v104,s[4:7],s61 offen lds
s_add_u32 m0,s77,99328
s_add_u32 s61,s60,1966080
buffer_load_dwordx4 v105,s[4:7],s61 offen lds
s_add_u32 m0,s77,100352
s_add_u32 s61,s60,1966080
buffer_load_dwordx4 v106,s[4:7],s61 offen lds
s_add_u32 m0,s77,101376
s_add_u32 s61,s60,2064384
buffer_load_dwordx4 v104,s[4:7],s61 offen lds
s_add_u32 m0,s77,102400
s_add_u32 s61,s60,2064384
buffer_load_dwordx4 v105,s[4:7],s61 offen lds
s_add_u32 m0,s77,103424
s_add_u32 s61,s60,2064384
buffer_load_dwordx4 v106,s[4:7],s61 offen lds
s_waitcnt vmcnt(24)
s_barrier
s_add_u32 s60,s75,s74
s_add_u32 m0,s77,122880
s_add_u32 s61,s60,1966080
buffer_load_dwordx4 v104,s[52:55],s61 offen lds
s_add_u32 m0,s77,123904
s_add_u32 s61,s60,1966080
buffer_load_dwordx4 v105,s[52:55],s61 offen lds
s_add_u32 m0,s77,124928
s_add_u32 s61,s60,1966080
buffer_load_dwordx4 v106,s[52:55],s61 offen lds
s_add_u32 m0,s77,125952
s_add_u32 s61,s60,2064384
buffer_load_dwordx4 v104,s[52:55],s61 offen lds
s_add_u32 m0,s77,126976
s_add_u32 s61,s60,2064384
buffer_load_dwordx4 v105,s[52:55],s61 offen lds
s_add_u32 m0,s77,128000
s_add_u32 s61,s60,2064384
buffer_load_dwordx4 v106,s[52:55],s61 offen lds
v_add_u32 v12,0,v107
s_cmp_eq_u32 s46,1
s_cbranch_scc1 lw_9
s_cmp_eq_u32 s46,2
s_cbranch_scc1 lw_10
s_cmp_eq_u32 s46,3
s_cbranch_scc1 lw_11
lw_8:
ds_read_b64_tr_b16 a[0:1],v12 offset:0
ds_read_b64_tr_b16 a[2:3],v12 offset:768
ds_read_b64_tr_b16 a[4:5],v12 offset:6144
ds_read_b64_tr_b16 a[6:7],v12 offset:6912
ds_read_b64_tr_b16 a[8:9],v12 offset:32
ds_read_b64_tr_b16 a[10:11],v12 offset:800
ds_read_b64_tr_b16 a[12:13],v12 offset:6176
ds_read_b64_tr_b16 a[14:15],v12 offset:6944
ds_read_b64_tr_b16 a[16:17],v12 offset:64
ds_read_b64_tr_b16 a[18:19],v12 offset:832
ds_read_b64_tr_b16 a[20:21],v12 offset:6208
ds_read_b64_tr_b16 a[22:23],v12 offset:6976
s_branch ld_7
lw_9:
ds_read_b64_tr_b16 a[240:241],v12 offset:0
ds_read_b64_tr_b16 a[242:243],v12 offset:768
ds_read_b64_tr_b16 a[244:245],v12 offset:6144
ds_read_b64_tr_b16 a[246:247],v12 offset:6912
ds_read_b64_tr_b16 a[248:249],v12 offset:32
ds_read_b64_tr_b16 a[250:251],v12 offset:800
ds_read_b64_tr_b16 a[252:253],v12 offset:6176
ds_read_b64_tr_b16 a[254:255],v12 offset:6944
ds_read_b64_tr_b16 v[112:113],v12 offset:64
ds_read_b64_tr_b16 v[114:115],v12 offset:832
ds_read_b64_tr_b16 v[116:117],v12 offset:6208
ds_read_b64_tr_b16 v[118:119],v12 offset:6976
s_branch ld_7
lw_10:
ds_read_b64_tr_b16 a[160:161],v12 offset:0
ds_read_b64_tr_b16 a[162:163],v12 offset:768
ds_read_b64_tr_b16 a[164:165],v12 offset:6144
ds_read_b64_tr_b16 a[166:167],v12 offset:6912
ds_read_b64_tr_b16 a[168:169],v12 offset:32
ds_read_b64_tr_b16 a[170:171],v12 offset:800
ds_read_b64_tr_b16 a[172:173],v12 offset:6176
ds_read_b64_tr_b16 a[174:175],v12 offset:6944
ds_read_b64_tr_b16 a[176:177],v12 offset:64
ds_read_b64_tr_b16 a[178:179],v12 offset:832
ds_read_b64_tr_b16 a[180:181],v12 offset:6208
ds_read_b64_tr_b16 a[182:183],v12 offset:6976
s_branch ld_7
lw_11:
ds_read_b64_tr_b16 a[80:81],v12 offset:0
ds_read_b64_tr_b16 a[82:83],v12 offset:768
ds_read_b64_tr_b16 a[84:85],v12 offset:6144
ds_read_b64_tr_b16 a[86:87],v12 offset:6912
ds_read_b64_tr_b16 a[88:89],v12 offset:32
ds_read_b64_tr_b16 a[90:91],v12 offset:800
ds_read_b64_tr_b16 a[92:93],v12 offset:6176
ds_read_b64_tr_b16 a[94:95],v12 offset:6944
ds_read_b64_tr_b16 a[96:97],v12 offset:64
ds_read_b64_tr_b16 a[98:99],v12 offset:832
ds_read_b64_tr_b16 a[100:101],v12 offset:6208
ds_read_b64_tr_b16 a[102:103],v12 offset:6976
ld_7:
s_waitcnt lgkmcnt(0)
s_waitcnt vmcnt(24)
s_barrier
s_add_u32 s60,s75,s73
s_add_u32 m0,s77,0
s_add_u32 s61,s60,2752512
buffer_load_dwordx4 v104,s[4:7],s61 offen lds
s_add_u32 m0,s77,1024
s_add_u32 s61,s60,2752512
buffer_load_dwordx4 v105,s[4:7],s61 offen lds
s_add_u32 m0,s77,2048
s_add_u32 s61,s60,2752512
buffer_load_dwordx4 v106,s[4:7],s61 offen lds
s_add_u32 m0,s77,3072
s_add_u32 s61,s60,2850816
buffer_load_dwordx4 v104,s[4:7],s61 offen lds
s_add_u32 m0,s77,4096
s_add_u32 s61,s60,2850816
buffer_load_dwordx4 v105,s[4:7],s61 offen lds
s_add_u32 m0,s77,5120
s_add_u32 s61,s60,2850816
buffer_load_dwordx4 v106,s[4:7],s61 offen lds
v_add_u32 v12,24576,v107
s_cmp_eq_u32 s46,1
s_cbranch_scc1 lw_14
s_cmp_eq_u32 s46,2
s_cbranch_scc1 lw_15
s_cmp_eq_u32 s46,3
s_cbranch_scc1 lw_16
lw_13:
ds_read_b64_tr_b16 a[24:25],v12 offset:0
ds_read_b64_tr_b16 a[26:27],v12 offset:768
ds_read_b64_tr_b16 a[28:29],v12 offset:6144
ds_read_b64_tr_b16 a[30:31],v12 offset:6912
ds_read_b64_tr_b16 a[32:33],v12 offset:32
ds_read_b64_tr_b16 a[34:35],v12 offset:800
ds_read_b64_tr_b16 a[36:37],v12 offset:6176
ds_read_b64_tr_b16 a[38:39],v12 offset:6944
ds_read_b64_tr_b16 v[24:25],v12 offset:64
ds_read_b64_tr_b16 v[26:27],v12 offset:832
ds_read_b64_tr_b16 v[28:29],v12 offset:6208
ds_read_b64_tr_b16 v[30:31],v12 offset:6976
s_branch ld_12
lw_14:
ds_read_b64_tr_b16 v[120:121],v12 offset:0
ds_read_b64_tr_b16 v[122:123],v12 offset:768
ds_read_b64_tr_b16 v[124:125],v12 offset:6144
ds_read_b64_tr_b16 v[126:127],v12 offset:6912
ds_read_b64_tr_b16 v[128:129],v12 offset:32
ds_read_b64_tr_b16 v[130:131],v12 offset:800
ds_read_b64_tr_b16 v[132:133],v12 offset:6176
ds_read_b64_tr_b16 v[134:135],v12 offset:6944
ds_read_b64_tr_b16 v[72:73],v12 offset:64
ds_read_b64_tr_b16 v[74:75],v12 offset:832
ds_read_b64_tr_b16 v[76:77],v12 offset:6208
ds_read_b64_tr_b16 v[78:79],v12 offset:6976
s_branch ld_12
lw_15:
ds_read_b64_tr_b16 a[184:185],v12 offset:0
ds_read_b64_tr_b16 a[186:187],v12 offset:768
ds_read_b64_tr_b16 a[188:189],v12 offset:6144
ds_read_b64_tr_b16 a[190:191],v12 offset:6912
ds_read_b64_tr_b16 a[192:193],v12 offset:32
ds_read_b64_tr_b16 a[194:195],v12 offset:800
ds_read_b64_tr_b16 a[196:197],v12 offset:6176
ds_read_b64_tr_b16 a[198:199],v12 offset:6944
ds_read_b64_tr_b16 v[56:57],v12 offset:64
ds_read_b64_tr_b16 v[58:59],v12 offset:832
ds_read_b64_tr_b16 v[60:61],v12 offset:6208
ds_read_b64_tr_b16 v[62:63],v12 offset:6976
s_branch ld_12
lw_16:
ds_read_b64_tr_b16 a[104:105],v12 offset:0
ds_read_b64_tr_b16 a[106:107],v12 offset:768
ds_read_b64_tr_b16 a[108:109],v12 offset:6144
ds_read_b64_tr_b16 a[110:111],v12 offset:6912
ds_read_b64_tr_b16 a[112:113],v12 offset:32
ds_read_b64_tr_b16 a[114:115],v12 offset:800
ds_read_b64_tr_b16 a[116:117],v12 offset:6176
ds_read_b64_tr_b16 a[118:119],v12 offset:6944
ds_read_b64_tr_b16 v[40:41],v12 offset:64
ds_read_b64_tr_b16 v[42:43],v12 offset:832
ds_read_b64_tr_b16 v[44:45],v12 offset:6208
ds_read_b64_tr_b16 v[46:47],v12 offset:6976
ld_12:
s_waitcnt lgkmcnt(0)
s_waitcnt vmcnt(24)
s_barrier
s_add_u32 s60,s75,s74
s_add_u32 m0,s77,24576
s_add_u32 s61,s60,2752512
buffer_load_dwordx4 v104,s[52:55],s61 offen lds
s_add_u32 m0,s77,25600
s_add_u32 s61,s60,2752512
buffer_load_dwordx4 v105,s[52:55],s61 offen lds
s_add_u32 m0,s77,26624
s_add_u32 s61,s60,2752512
buffer_load_dwordx4 v106,s[52:55],s61 offen lds
s_add_u32 m0,s77,27648
s_add_u32 s61,s60,2850816
buffer_load_dwordx4 v104,s[52:55],s61 offen lds
s_add_u32 m0,s77,28672
s_add_u32 s61,s60,2850816
buffer_load_dwordx4 v105,s[52:55],s61 offen lds
s_add_u32 m0,s77,29696
s_add_u32 s61,s60,2850816
buffer_load_dwordx4 v106,s[52:55],s61 offen lds
v_add_u32 v12,49152,v107
s_cmp_eq_u32 s46,1
s_cbranch_scc1 lw_19
s_cmp_eq_u32 s46,2
s_cbranch_scc1 lw_20
s_cmp_eq_u32 s46,3
s_cbranch_scc1 lw_21
lw_18:
ds_read_b64_tr_b16 a[40:41],v12 offset:0
ds_read_b64_tr_b16 a[42:43],v12 offset:768
ds_read_b64_tr_b16 a[44:45],v12 offset:6144
ds_read_b64_tr_b16 a[46:47],v12 offset:6912
ds_read_b64_tr_b16 a[48:49],v12 offset:32
ds_read_b64_tr_b16 a[50:51],v12 offset:800
ds_read_b64_tr_b16 a[52:53],v12 offset:6176
ds_read_b64_tr_b16 a[54:55],v12 offset:6944
ds_read_b64_tr_b16 a[56:57],v12 offset:64
ds_read_b64_tr_b16 a[58:59],v12 offset:832
ds_read_b64_tr_b16 a[60:61],v12 offset:6208
ds_read_b64_tr_b16 a[62:63],v12 offset:6976
s_branch ld_17
lw_19:
ds_read_b64_tr_b16 v[136:137],v12 offset:0
ds_read_b64_tr_b16 v[138:139],v12 offset:768
ds_read_b64_tr_b16 v[140:141],v12 offset:6144
ds_read_b64_tr_b16 v[142:143],v12 offset:6912
ds_read_b64_tr_b16 v[144:145],v12 offset:32
ds_read_b64_tr_b16 v[146:147],v12 offset:800
ds_read_b64_tr_b16 v[148:149],v12 offset:6176
ds_read_b64_tr_b16 v[150:151],v12 offset:6944
ds_read_b64_tr_b16 v[152:153],v12 offset:64
ds_read_b64_tr_b16 v[154:155],v12 offset:832
ds_read_b64_tr_b16 v[156:157],v12 offset:6208
ds_read_b64_tr_b16 v[158:159],v12 offset:6976
s_branch ld_17
lw_20:
ds_read_b64_tr_b16 a[200:201],v12 offset:0
ds_read_b64_tr_b16 a[202:203],v12 offset:768
ds_read_b64_tr_b16 a[204:205],v12 offset:6144
ds_read_b64_tr_b16 a[206:207],v12 offset:6912
ds_read_b64_tr_b16 a[208:209],v12 offset:32
ds_read_b64_tr_b16 a[210:211],v12 offset:800
ds_read_b64_tr_b16 a[212:213],v12 offset:6176
ds_read_b64_tr_b16 a[214:215],v12 offset:6944
ds_read_b64_tr_b16 a[216:217],v12 offset:64
ds_read_b64_tr_b16 a[218:219],v12 offset:832
ds_read_b64_tr_b16 a[220:221],v12 offset:6208
ds_read_b64_tr_b16 a[222:223],v12 offset:6976
s_branch ld_17
lw_21:
ds_read_b64_tr_b16 a[120:121],v12 offset:0
ds_read_b64_tr_b16 a[122:123],v12 offset:768
ds_read_b64_tr_b16 a[124:125],v12 offset:6144
ds_read_b64_tr_b16 a[126:127],v12 offset:6912
ds_read_b64_tr_b16 a[128:129],v12 offset:32
ds_read_b64_tr_b16 a[130:131],v12 offset:800
ds_read_b64_tr_b16 a[132:133],v12 offset:6176
ds_read_b64_tr_b16 a[134:135],v12 offset:6944
ds_read_b64_tr_b16 a[136:137],v12 offset:64
ds_read_b64_tr_b16 a[138:139],v12 offset:832
ds_read_b64_tr_b16 a[140:141],v12 offset:6208
ds_read_b64_tr_b16 a[142:143],v12 offset:6976
ld_17:
s_waitcnt lgkmcnt(0)
s_waitcnt vmcnt(24)
s_barrier
s_add_u32 s60,s75,s73
s_add_u32 m0,s77,49152
s_add_u32 s61,s60,3932160
buffer_load_dwordx4 v104,s[4:7],s61 offen lds
s_add_u32 m0,s77,50176
s_add_u32 s61,s60,3932160
buffer_load_dwordx4 v105,s[4:7],s61 offen lds
s_add_u32 m0,s77,51200
s_add_u32 s61,s60,3932160
buffer_load_dwordx4 v106,s[4:7],s61 offen lds
s_add_u32 m0,s77,52224
s_add_u32 s61,s60,4030464
buffer_load_dwordx4 v104,s[4:7],s61 offen lds
s_add_u32 m0,s77,53248
s_add_u32 s61,s60,4030464
buffer_load_dwordx4 v105,s[4:7],s61 offen lds
s_add_u32 m0,s77,54272
s_add_u32 s61,s60,4030464
buffer_load_dwordx4 v106,s[4:7],s61 offen lds
v_add_u32 v12,73728,v107
s_cmp_eq_u32 s46,1
s_cbranch_scc1 lw_24
s_cmp_eq_u32 s46,2
s_cbranch_scc1 lw_25
s_cmp_eq_u32 s46,3
s_cbranch_scc1 lw_26
lw_23:
ds_read_b64_tr_b16 a[64:65],v12 offset:0
ds_read_b64_tr_b16 a[66:67],v12 offset:768
ds_read_b64_tr_b16 a[68:69],v12 offset:6144
ds_read_b64_tr_b16 a[70:71],v12 offset:6912
ds_read_b64_tr_b16 a[72:73],v12 offset:32
ds_read_b64_tr_b16 a[74:75],v12 offset:800
ds_read_b64_tr_b16 a[76:77],v12 offset:6176
ds_read_b64_tr_b16 a[78:79],v12 offset:6944
ds_read_b64_tr_b16 v[32:33],v12 offset:64
ds_read_b64_tr_b16 v[34:35],v12 offset:832
ds_read_b64_tr_b16 v[36:37],v12 offset:6208
ds_read_b64_tr_b16 v[38:39],v12 offset:6976
s_branch ld_22
lw_24:
ds_read_b64_tr_b16 v[160:161],v12 offset:0
ds_read_b64_tr_b16 v[162:163],v12 offset:768
ds_read_b64_tr_b16 v[164:165],v12 offset:6144
ds_read_b64_tr_b16 v[166:167],v12 offset:6912
ds_read_b64_tr_b16 v[168:169],v12 offset:32
ds_read_b64_tr_b16 v[170:171],v12 offset:800
ds_read_b64_tr_b16 v[172:173],v12 offset:6176
ds_read_b64_tr_b16 v[174:175],v12 offset:6944
ds_read_b64_tr_b16 v[80:81],v12 offset:64
ds_read_b64_tr_b16 v[82:83],v12 offset:832
ds_read_b64_tr_b16 v[84:85],v12 offset:6208
ds_read_b64_tr_b16 v[86:87],v12 offset:6976
s_branch ld_22
lw_25:
ds_read_b64_tr_b16 a[224:225],v12 offset:0
ds_read_b64_tr_b16 a[226:227],v12 offset:768
ds_read_b64_tr_b16 a[228:229],v12 offset:6144
ds_read_b64_tr_b16 a[230:231],v12 offset:6912
ds_read_b64_tr_b16 a[232:233],v12 offset:32
ds_read_b64_tr_b16 a[234:235],v12 offset:800
ds_read_b64_tr_b16 a[236:237],v12 offset:6176
ds_read_b64_tr_b16 a[238:239],v12 offset:6944
ds_read_b64_tr_b16 v[64:65],v12 offset:64
ds_read_b64_tr_b16 v[66:67],v12 offset:832
ds_read_b64_tr_b16 v[68:69],v12 offset:6208
ds_read_b64_tr_b16 v[70:71],v12 offset:6976
s_branch ld_22
lw_26:
ds_read_b64_tr_b16 a[144:145],v12 offset:0
ds_read_b64_tr_b16 a[146:147],v12 offset:768
ds_read_b64_tr_b16 a[148:149],v12 offset:6144
ds_read_b64_tr_b16 a[150:151],v12 offset:6912
ds_read_b64_tr_b16 a[152:153],v12 offset:32
ds_read_b64_tr_b16 a[154:155],v12 offset:800
ds_read_b64_tr_b16 a[156:157],v12 offset:6176
ds_read_b64_tr_b16 a[158:159],v12 offset:6944
ds_read_b64_tr_b16 v[48:49],v12 offset:64
ds_read_b64_tr_b16 v[50:51],v12 offset:832
ds_read_b64_tr_b16 v[52:53],v12 offset:6208
ds_read_b64_tr_b16 v[54:55],v12 offset:6976
ld_22:
s_waitcnt lgkmcnt(0)
s_waitcnt vmcnt(24)
s_barrier
s_add_u32 s60,s75,s74
s_add_u32 m0,s77,73728
s_add_u32 s61,s60,3932160
buffer_load_dwordx4 v104,s[52:55],s61 offen lds
s_add_u32 m0,s77,74752
s_add_u32 s61,s60,3932160
buffer_load_dwordx4 v105,s[52:55],s61 offen lds
s_add_u32 m0,s77,75776
s_add_u32 s61,s60,3932160
buffer_load_dwordx4 v106,s[52:55],s61 offen lds
s_add_u32 m0,s77,76800
s_add_u32 s61,s60,4030464
buffer_load_dwordx4 v104,s[52:55],s61 offen lds
s_add_u32 m0,s77,77824
s_add_u32 s61,s60,4030464
buffer_load_dwordx4 v105,s[52:55],s61 offen lds
s_add_u32 m0,s77,78848
s_add_u32 s61,s60,4030464
buffer_load_dwordx4 v106,s[52:55],s61 offen lds
v_add_u32 v12,98304,v107
s_cmp_eq_u32 s46,1
s_cbranch_scc1 lw_29
s_cmp_eq_u32 s46,2
s_cbranch_scc1 lw_30
s_cmp_eq_u32 s46,3
s_cbranch_scc1 lw_31
lw_28:
ds_read_b64_tr_b16 a[80:81],v12 offset:0
ds_read_b64_tr_b16 a[82:83],v12 offset:768
ds_read_b64_tr_b16 a[84:85],v12 offset:6144
ds_read_b64_tr_b16 a[86:87],v12 offset:6912
ds_read_b64_tr_b16 a[88:89],v12 offset:32
ds_read_b64_tr_b16 a[90:91],v12 offset:800
ds_read_b64_tr_b16 a[92:93],v12 offset:6176
ds_read_b64_tr_b16 a[94:95],v12 offset:6944
ds_read_b64_tr_b16 a[96:97],v12 offset:64
ds_read_b64_tr_b16 a[98:99],v12 offset:832
ds_read_b64_tr_b16 a[100:101],v12 offset:6208
ds_read_b64_tr_b16 a[102:103],v12 offset:6976
s_branch ld_27
lw_29:
ds_read_b64_tr_b16 a[0:1],v12 offset:0
ds_read_b64_tr_b16 a[2:3],v12 offset:768
ds_read_b64_tr_b16 a[4:5],v12 offset:6144
ds_read_b64_tr_b16 a[6:7],v12 offset:6912
ds_read_b64_tr_b16 a[8:9],v12 offset:32
ds_read_b64_tr_b16 a[10:11],v12 offset:800
ds_read_b64_tr_b16 a[12:13],v12 offset:6176
ds_read_b64_tr_b16 a[14:15],v12 offset:6944
ds_read_b64_tr_b16 a[16:17],v12 offset:64
ds_read_b64_tr_b16 a[18:19],v12 offset:832
ds_read_b64_tr_b16 a[20:21],v12 offset:6208
ds_read_b64_tr_b16 a[22:23],v12 offset:6976
s_branch ld_27
lw_30:
ds_read_b64_tr_b16 a[240:241],v12 offset:0
ds_read_b64_tr_b16 a[242:243],v12 offset:768
ds_read_b64_tr_b16 a[244:245],v12 offset:6144
ds_read_b64_tr_b16 a[246:247],v12 offset:6912
ds_read_b64_tr_b16 a[248:249],v12 offset:32
ds_read_b64_tr_b16 a[250:251],v12 offset:800
ds_read_b64_tr_b16 a[252:253],v12 offset:6176
ds_read_b64_tr_b16 a[254:255],v12 offset:6944
ds_read_b64_tr_b16 v[112:113],v12 offset:64
ds_read_b64_tr_b16 v[114:115],v12 offset:832
ds_read_b64_tr_b16 v[116:117],v12 offset:6208
ds_read_b64_tr_b16 v[118:119],v12 offset:6976
s_branch ld_27
lw_31:
ds_read_b64_tr_b16 a[160:161],v12 offset:0
ds_read_b64_tr_b16 a[162:163],v12 offset:768
ds_read_b64_tr_b16 a[164:165],v12 offset:6144
ds_read_b64_tr_b16 a[166:167],v12 offset:6912
ds_read_b64_tr_b16 a[168:169],v12 offset:32
ds_read_b64_tr_b16 a[170:171],v12 offset:800
ds_read_b64_tr_b16 a[172:173],v12 offset:6176
ds_read_b64_tr_b16 a[174:175],v12 offset:6944
ds_read_b64_tr_b16 a[176:177],v12 offset:64
ds_read_b64_tr_b16 a[178:179],v12 offset:832
ds_read_b64_tr_b16 a[180:181],v12 offset:6208
ds_read_b64_tr_b16 a[182:183],v12 offset:6976
ld_27:
s_waitcnt lgkmcnt(0)
s_waitcnt vmcnt(24)
s_barrier
s_add_u32 s60,s75,s73
s_add_u32 m0,s77,98304
s_add_u32 s61,s60,4718592
buffer_load_dwordx4 v104,s[4:7],s61 offen lds
s_add_u32 m0,s77,99328
s_add_u32 s61,s60,4718592
buffer_load_dwordx4 v105,s[4:7],s61 offen lds
s_add_u32 m0,s77,100352
s_add_u32 s61,s60,4718592
buffer_load_dwordx4 v106,s[4:7],s61 offen lds
s_add_u32 m0,s77,101376
s_add_u32 s61,s60,4816896
buffer_load_dwordx4 v104,s[4:7],s61 offen lds
s_add_u32 m0,s77,102400
s_add_u32 s61,s60,4816896
buffer_load_dwordx4 v105,s[4:7],s61 offen lds
s_add_u32 m0,s77,103424
s_add_u32 s61,s60,4816896
buffer_load_dwordx4 v106,s[4:7],s61 offen lds
v_add_u32 v12,122880,v107
s_cmp_eq_u32 s46,1
s_cbranch_scc1 lw_34
s_cmp_eq_u32 s46,2
s_cbranch_scc1 lw_35
s_cmp_eq_u32 s46,3
s_cbranch_scc1 lw_36
lw_33:
ds_read_b64_tr_b16 a[104:105],v12 offset:0
ds_read_b64_tr_b16 a[106:107],v12 offset:768
ds_read_b64_tr_b16 a[108:109],v12 offset:6144
ds_read_b64_tr_b16 a[110:111],v12 offset:6912
ds_read_b64_tr_b16 a[112:113],v12 offset:32
ds_read_b64_tr_b16 a[114:115],v12 offset:800
ds_read_b64_tr_b16 a[116:117],v12 offset:6176
ds_read_b64_tr_b16 a[118:119],v12 offset:6944
ds_read_b64_tr_b16 v[40:41],v12 offset:64
ds_read_b64_tr_b16 v[42:43],v12 offset:832
ds_read_b64_tr_b16 v[44:45],v12 offset:6208
ds_read_b64_tr_b16 v[46:47],v12 offset:6976
s_branch ld_32
lw_34:
ds_read_b64_tr_b16 a[24:25],v12 offset:0
ds_read_b64_tr_b16 a[26:27],v12 offset:768
ds_read_b64_tr_b16 a[28:29],v12 offset:6144
ds_read_b64_tr_b16 a[30:31],v12 offset:6912
ds_read_b64_tr_b16 a[32:33],v12 offset:32
ds_read_b64_tr_b16 a[34:35],v12 offset:800
ds_read_b64_tr_b16 a[36:37],v12 offset:6176
ds_read_b64_tr_b16 a[38:39],v12 offset:6944
ds_read_b64_tr_b16 v[24:25],v12 offset:64
ds_read_b64_tr_b16 v[26:27],v12 offset:832
ds_read_b64_tr_b16 v[28:29],v12 offset:6208
ds_read_b64_tr_b16 v[30:31],v12 offset:6976
s_branch ld_32
lw_35:
ds_read_b64_tr_b16 v[120:121],v12 offset:0
ds_read_b64_tr_b16 v[122:123],v12 offset:768
ds_read_b64_tr_b16 v[124:125],v12 offset:6144
ds_read_b64_tr_b16 v[126:127],v12 offset:6912
ds_read_b64_tr_b16 v[128:129],v12 offset:32
ds_read_b64_tr_b16 v[130:131],v12 offset:800
ds_read_b64_tr_b16 v[132:133],v12 offset:6176
ds_read_b64_tr_b16 v[134:135],v12 offset:6944
ds_read_b64_tr_b16 v[72:73],v12 offset:64
ds_read_b64_tr_b16 v[74:75],v12 offset:832
ds_read_b64_tr_b16 v[76:77],v12 offset:6208
ds_read_b64_tr_b16 v[78:79],v12 offset:6976
s_branch ld_32
lw_36:
ds_read_b64_tr_b16 a[184:185],v12 offset:0
ds_read_b64_tr_b16 a[186:187],v12 offset:768
ds_read_b64_tr_b16 a[188:189],v12 offset:6144
ds_read_b64_tr_b16 a[190:191],v12 offset:6912
ds_read_b64_tr_b16 a[192:193],v12 offset:32
ds_read_b64_tr_b16 a[194:195],v12 offset:800
ds_read_b64_tr_b16 a[196:197],v12 offset:6176
ds_read_b64_tr_b16 a[198:199],v12 offset:6944
ds_read_b64_tr_b16 v[56:57],v12 offset:64
ds_read_b64_tr_b16 v[58:59],v12 offset:832
ds_read_b64_tr_b16 v[60:61],v12 offset:6208
ds_read_b64_tr_b16 v[62:63],v12 offset:6976
ld_32:
s_waitcnt lgkmcnt(0)
s_waitcnt vmcnt(24)
s_barrier
s_add_u32 s60,s75,s74
s_add_u32 m0,s77,122880
s_add_u32 s61,s60,4718592
buffer_load_dwordx4 v104,s[52:55],s61 offen lds
s_add_u32 m0,s77,123904
s_add_u32 s61,s60,4718592
buffer_load_dwordx4 v105,s[52:55],s61 offen lds
s_add_u32 m0,s77,124928
s_add_u32 s61,s60,4718592
buffer_load_dwordx4 v106,s[52:55],s61 offen lds
s_add_u32 m0,s77,125952
s_add_u32 s61,s60,4816896
buffer_load_dwordx4 v104,s[52:55],s61 offen lds
s_add_u32 m0,s77,126976
s_add_u32 s61,s60,4816896
buffer_load_dwordx4 v105,s[52:55],s61 offen lds
s_add_u32 m0,s77,128000
s_add_u32 s61,s60,4816896
buffer_load_dwordx4 v106,s[52:55],s61 offen lds
v_add_u32 v12,0,v107
s_cmp_eq_u32 s46,1
s_cbranch_scc1 lw_39
s_cmp_eq_u32 s46,2
s_cbranch_scc1 lw_40
s_cmp_eq_u32 s46,3
s_cbranch_scc1 lw_41
lw_38:
ds_read_b64_tr_b16 a[120:121],v12 offset:0
ds_read_b64_tr_b16 a[122:123],v12 offset:768
ds_read_b64_tr_b16 a[124:125],v12 offset:6144
ds_read_b64_tr_b16 a[126:127],v12 offset:6912
ds_read_b64_tr_b16 a[128:129],v12 offset:32
ds_read_b64_tr_b16 a[130:131],v12 offset:800
ds_read_b64_tr_b16 a[132:133],v12 offset:6176
ds_read_b64_tr_b16 a[134:135],v12 offset:6944
ds_read_b64_tr_b16 a[136:137],v12 offset:64
ds_read_b64_tr_b16 a[138:139],v12 offset:832
ds_read_b64_tr_b16 a[140:141],v12 offset:6208
ds_read_b64_tr_b16 a[142:143],v12 offset:6976
s_branch ld_37
lw_39:
ds_read_b64_tr_b16 a[40:41],v12 offset:0
ds_read_b64_tr_b16 a[42:43],v12 offset:768
ds_read_b64_tr_b16 a[44:45],v12 offset:6144
ds_read_b64_tr_b16 a[46:47],v12 offset:6912
ds_read_b64_tr_b16 a[48:49],v12 offset:32
ds_read_b64_tr_b16 a[50:51],v12 offset:800
ds_read_b64_tr_b16 a[52:53],v12 offset:6176
ds_read_b64_tr_b16 a[54:55],v12 offset:6944
ds_read_b64_tr_b16 a[56:57],v12 offset:64
ds_read_b64_tr_b16 a[58:59],v12 offset:832
ds_read_b64_tr_b16 a[60:61],v12 offset:6208
ds_read_b64_tr_b16 a[62:63],v12 offset:6976
s_branch ld_37
lw_40:
ds_read_b64_tr_b16 v[136:137],v12 offset:0
ds_read_b64_tr_b16 v[138:139],v12 offset:768
ds_read_b64_tr_b16 v[140:141],v12 offset:6144
ds_read_b64_tr_b16 v[142:143],v12 offset:6912
ds_read_b64_tr_b16 v[144:145],v12 offset:32
ds_read_b64_tr_b16 v[146:147],v12 offset:800
ds_read_b64_tr_b16 v[148:149],v12 offset:6176
ds_read_b64_tr_b16 v[150:151],v12 offset:6944
ds_read_b64_tr_b16 v[152:153],v12 offset:64
ds_read_b64_tr_b16 v[154:155],v12 offset:832
ds_read_b64_tr_b16 v[156:157],v12 offset:6208
ds_read_b64_tr_b16 v[158:159],v12 offset:6976
s_branch ld_37
lw_41:
ds_read_b64_tr_b16 a[200:201],v12 offset:0
ds_read_b64_tr_b16 a[202:203],v12 offset:768
ds_read_b64_tr_b16 a[204:205],v12 offset:6144
ds_read_b64_tr_b16 a[206:207],v12 offset:6912
ds_read_b64_tr_b16 a[208:209],v12 offset:32
ds_read_b64_tr_b16 a[210:211],v12 offset:800
ds_read_b64_tr_b16 a[212:213],v12 offset:6176
ds_read_b64_tr_b16 a[214:215],v12 offset:6944
ds_read_b64_tr_b16 a[216:217],v12 offset:64
ds_read_b64_tr_b16 a[218:219],v12 offset:832
ds_read_b64_tr_b16 a[220:221],v12 offset:6208
ds_read_b64_tr_b16 a[222:223],v12 offset:6976
ld_37:
s_waitcnt lgkmcnt(0)
s_waitcnt vmcnt(24)
s_barrier
s_add_u32 s60,s75,s73
s_add_u32 m0,s77,0
s_add_u32 s61,s60,5898240
buffer_load_dwordx4 v104,s[4:7],s61 offen lds
s_add_u32 m0,s77,1024
s_add_u32 s61,s60,5898240
buffer_load_dwordx4 v105,s[4:7],s61 offen lds
s_add_u32 m0,s77,2048
s_add_u32 s61,s60,5898240
buffer_load_dwordx4 v106,s[4:7],s61 offen lds
s_add_u32 m0,s77,3072
s_add_u32 s61,s60,5996544
buffer_load_dwordx4 v104,s[4:7],s61 offen lds
s_add_u32 m0,s77,4096
s_add_u32 s61,s60,5996544
buffer_load_dwordx4 v105,s[4:7],s61 offen lds
s_add_u32 m0,s77,5120
s_add_u32 s61,s60,5996544
buffer_load_dwordx4 v106,s[4:7],s61 offen lds
v_add_u32 v12,24576,v107
s_cmp_eq_u32 s46,1
s_cbranch_scc1 lw_44
s_cmp_eq_u32 s46,2
s_cbranch_scc1 lw_45
s_cmp_eq_u32 s46,3
s_cbranch_scc1 lw_46
lw_43:
ds_read_b64_tr_b16 a[144:145],v12 offset:0
ds_read_b64_tr_b16 a[146:147],v12 offset:768
ds_read_b64_tr_b16 a[148:149],v12 offset:6144
ds_read_b64_tr_b16 a[150:151],v12 offset:6912
ds_read_b64_tr_b16 a[152:153],v12 offset:32
ds_read_b64_tr_b16 a[154:155],v12 offset:800
ds_read_b64_tr_b16 a[156:157],v12 offset:6176
ds_read_b64_tr_b16 a[158:159],v12 offset:6944
ds_read_b64_tr_b16 v[48:49],v12 offset:64
ds_read_b64_tr_b16 v[50:51],v12 offset:832
ds_read_b64_tr_b16 v[52:53],v12 offset:6208
ds_read_b64_tr_b16 v[54:55],v12 offset:6976
s_branch ld_42
lw_44:
ds_read_b64_tr_b16 a[64:65],v12 offset:0
ds_read_b64_tr_b16 a[66:67],v12 offset:768
ds_read_b64_tr_b16 a[68:69],v12 offset:6144
ds_read_b64_tr_b16 a[70:71],v12 offset:6912
ds_read_b64_tr_b16 a[72:73],v12 offset:32
ds_read_b64_tr_b16 a[74:75],v12 offset:800
ds_read_b64_tr_b16 a[76:77],v12 offset:6176
ds_read_b64_tr_b16 a[78:79],v12 offset:6944
ds_read_b64_tr_b16 v[32:33],v12 offset:64
ds_read_b64_tr_b16 v[34:35],v12 offset:832
ds_read_b64_tr_b16 v[36:37],v12 offset:6208
ds_read_b64_tr_b16 v[38:39],v12 offset:6976
s_branch ld_42
lw_45:
ds_read_b64_tr_b16 v[160:161],v12 offset:0
ds_read_b64_tr_b16 v[162:163],v12 offset:768
ds_read_b64_tr_b16 v[164:165],v12 offset:6144
ds_read_b64_tr_b16 v[166:167],v12 offset:6912
ds_read_b64_tr_b16 v[168:169],v12 offset:32
ds_read_b64_tr_b16 v[170:171],v12 offset:800
ds_read_b64_tr_b16 v[172:173],v12 offset:6176
ds_read_b64_tr_b16 v[174:175],v12 offset:6944
ds_read_b64_tr_b16 v[80:81],v12 offset:64
ds_read_b64_tr_b16 v[82:83],v12 offset:832
ds_read_b64_tr_b16 v[84:85],v12 offset:6208
ds_read_b64_tr_b16 v[86:87],v12 offset:6976
s_branch ld_42
lw_46:
ds_read_b64_tr_b16 a[224:225],v12 offset:0
ds_read_b64_tr_b16 a[226:227],v12 offset:768
ds_read_b64_tr_b16 a[228:229],v12 offset:6144
ds_read_b64_tr_b16 a[230:231],v12 offset:6912
ds_read_b64_tr_b16 a[232:233],v12 offset:32
ds_read_b64_tr_b16 a[234:235],v12 offset:800
ds_read_b64_tr_b16 a[236:237],v12 offset:6176
ds_read_b64_tr_b16 a[238:239],v12 offset:6944
ds_read_b64_tr_b16 v[64:65],v12 offset:64
ds_read_b64_tr_b16 v[66:67],v12 offset:832
ds_read_b64_tr_b16 v[68:69],v12 offset:6208
ds_read_b64_tr_b16 v[70:71],v12 offset:6976
ld_42:
s_waitcnt lgkmcnt(0)
s_waitcnt vmcnt(24)
s_barrier
s_add_u32 s60,s75,s74
s_add_u32 m0,s77,24576
s_add_u32 s61,s60,5898240
buffer_load_dwordx4 v104,s[52:55],s61 offen lds
s_add_u32 m0,s77,25600
s_add_u32 s61,s60,5898240
buffer_load_dwordx4 v105,s[52:55],s61 offen lds
s_add_u32 m0,s77,26624
s_add_u32 s61,s60,5898240
buffer_load_dwordx4 v106,s[52:55],s61 offen lds
s_add_u32 m0,s77,27648
s_add_u32 s61,s60,5996544
buffer_load_dwordx4 v104,s[52:55],s61 offen lds
s_add_u32 m0,s77,28672
s_add_u32 s61,s60,5996544
buffer_load_dwordx4 v105,s[52:55],s61 offen lds
s_add_u32 m0,s77,29696
s_add_u32 s61,s60,5996544
buffer_load_dwordx4 v106,s[52:55],s61 offen lds
v_add_u32 v12,49152,v107
s_cmp_eq_u32 s46,1
s_cbranch_scc1 lw_49
s_cmp_eq_u32 s46,2
s_cbranch_scc1 lw_50
s_cmp_eq_u32 s46,3
s_cbranch_scc1 lw_51
lw_48:
ds_read_b64_tr_b16 a[160:161],v12 offset:0
ds_read_b64_tr_b16 a[162:163],v12 offset:768
ds_read_b64_tr_b16 a[164:165],v12 offset:6144
ds_read_b64_tr_b16 a[166:167],v12 offset:6912
ds_read_b64_tr_b16 a[168:169],v12 offset:32
ds_read_b64_tr_b16 a[170:171],v12 offset:800
ds_read_b64_tr_b16 a[172:173],v12 offset:6176
ds_read_b64_tr_b16 a[174:175],v12 offset:6944
ds_read_b64_tr_b16 a[176:177],v12 offset:64
ds_read_b64_tr_b16 a[178:179],v12 offset:832
ds_read_b64_tr_b16 a[180:181],v12 offset:6208
ds_read_b64_tr_b16 a[182:183],v12 offset:6976
s_branch ld_47
lw_49:
ds_read_b64_tr_b16 a[80:81],v12 offset:0
ds_read_b64_tr_b16 a[82:83],v12 offset:768
ds_read_b64_tr_b16 a[84:85],v12 offset:6144
ds_read_b64_tr_b16 a[86:87],v12 offset:6912
ds_read_b64_tr_b16 a[88:89],v12 offset:32
ds_read_b64_tr_b16 a[90:91],v12 offset:800
ds_read_b64_tr_b16 a[92:93],v12 offset:6176
ds_read_b64_tr_b16 a[94:95],v12 offset:6944
ds_read_b64_tr_b16 a[96:97],v12 offset:64
ds_read_b64_tr_b16 a[98:99],v12 offset:832
ds_read_b64_tr_b16 a[100:101],v12 offset:6208
ds_read_b64_tr_b16 a[102:103],v12 offset:6976
s_branch ld_47
lw_50:
ds_read_b64_tr_b16 a[0:1],v12 offset:0
ds_read_b64_tr_b16 a[2:3],v12 offset:768
ds_read_b64_tr_b16 a[4:5],v12 offset:6144
ds_read_b64_tr_b16 a[6:7],v12 offset:6912
ds_read_b64_tr_b16 a[8:9],v12 offset:32
ds_read_b64_tr_b16 a[10:11],v12 offset:800
ds_read_b64_tr_b16 a[12:13],v12 offset:6176
ds_read_b64_tr_b16 a[14:15],v12 offset:6944
ds_read_b64_tr_b16 a[16:17],v12 offset:64
ds_read_b64_tr_b16 a[18:19],v12 offset:832
ds_read_b64_tr_b16 a[20:21],v12 offset:6208
ds_read_b64_tr_b16 a[22:23],v12 offset:6976
s_branch ld_47
lw_51:
ds_read_b64_tr_b16 a[240:241],v12 offset:0
ds_read_b64_tr_b16 a[242:243],v12 offset:768
ds_read_b64_tr_b16 a[244:245],v12 offset:6144
ds_read_b64_tr_b16 a[246:247],v12 offset:6912
ds_read_b64_tr_b16 a[248:249],v12 offset:32
ds_read_b64_tr_b16 a[250:251],v12 offset:800
ds_read_b64_tr_b16 a[252:253],v12 offset:6176
ds_read_b64_tr_b16 a[254:255],v12 offset:6944
ds_read_b64_tr_b16 v[112:113],v12 offset:64
ds_read_b64_tr_b16 v[114:115],v12 offset:832
ds_read_b64_tr_b16 v[116:117],v12 offset:6208
ds_read_b64_tr_b16 v[118:119],v12 offset:6976
ld_47:
s_waitcnt lgkmcnt(0)
s_waitcnt vmcnt(24)
s_barrier
s_add_u32 s60,s75,s73
s_add_u32 m0,s77,49152
s_add_u32 s61,s60,6684672
buffer_load_dwordx4 v104,s[4:7],s61 offen lds
s_add_u32 m0,s77,50176
s_add_u32 s61,s60,6684672
buffer_load_dwordx4 v105,s[4:7],s61 offen lds
s_add_u32 m0,s77,51200
s_add_u32 s61,s60,6684672
buffer_load_dwordx4 v106,s[4:7],s61 offen lds
s_add_u32 m0,s77,52224
s_add_u32 s61,s60,6782976
buffer_load_dwordx4 v104,s[4:7],s61 offen lds
s_add_u32 m0,s77,53248
s_add_u32 s61,s60,6782976
buffer_load_dwordx4 v105,s[4:7],s61 offen lds
s_add_u32 m0,s77,54272
s_add_u32 s61,s60,6782976
buffer_load_dwordx4 v106,s[4:7],s61 offen lds
v_add_u32 v12,73728,v107
s_cmp_eq_u32 s46,1
s_cbranch_scc1 lw_54
s_cmp_eq_u32 s46,2
s_cbranch_scc1 lw_55
s_cmp_eq_u32 s46,3
s_cbranch_scc1 lw_56
lw_53:
ds_read_b64_tr_b16 a[184:185],v12 offset:0
ds_read_b64_tr_b16 a[186:187],v12 offset:768
ds_read_b64_tr_b16 a[188:189],v12 offset:6144
ds_read_b64_tr_b16 a[190:191],v12 offset:6912
ds_read_b64_tr_b16 a[192:193],v12 offset:32
ds_read_b64_tr_b16 a[194:195],v12 offset:800
ds_read_b64_tr_b16 a[196:197],v12 offset:6176
ds_read_b64_tr_b16 a[198:199],v12 offset:6944
ds_read_b64_tr_b16 v[56:57],v12 offset:64
ds_read_b64_tr_b16 v[58:59],v12 offset:832
ds_read_b64_tr_b16 v[60:61],v12 offset:6208
ds_read_b64_tr_b16 v[62:63],v12 offset:6976
s_branch ld_52
lw_54:
ds_read_b64_tr_b16 a[104:105],v12 offset:0
ds_read_b64_tr_b16 a[106:107],v12 offset:768
ds_read_b64_tr_b16 a[108:109],v12 offset:6144
ds_read_b64_tr_b16 a[110:111],v12 offset:6912
ds_read_b64_tr_b16 a[112:113],v12 offset:32
ds_read_b64_tr_b16 a[114:115],v12 offset:800
ds_read_b64_tr_b16 a[116:117],v12 offset:6176
ds_read_b64_tr_b16 a[118:119],v12 offset:6944
ds_read_b64_tr_b16 v[40:41],v12 offset:64
ds_read_b64_tr_b16 v[42:43],v12 offset:832
ds_read_b64_tr_b16 v[44:45],v12 offset:6208
ds_read_b64_tr_b16 v[46:47],v12 offset:6976
s_branch ld_52
lw_55:
ds_read_b64_tr_b16 a[24:25],v12 offset:0
ds_read_b64_tr_b16 a[26:27],v12 offset:768
ds_read_b64_tr_b16 a[28:29],v12 offset:6144
ds_read_b64_tr_b16 a[30:31],v12 offset:6912
ds_read_b64_tr_b16 a[32:33],v12 offset:32
ds_read_b64_tr_b16 a[34:35],v12 offset:800
ds_read_b64_tr_b16 a[36:37],v12 offset:6176
ds_read_b64_tr_b16 a[38:39],v12 offset:6944
ds_read_b64_tr_b16 v[24:25],v12 offset:64
ds_read_b64_tr_b16 v[26:27],v12 offset:832
ds_read_b64_tr_b16 v[28:29],v12 offset:6208
ds_read_b64_tr_b16 v[30:31],v12 offset:6976
s_branch ld_52
lw_56:
ds_read_b64_tr_b16 v[120:121],v12 offset:0
ds_read_b64_tr_b16 v[122:123],v12 offset:768
ds_read_b64_tr_b16 v[124:125],v12 offset:6144
ds_read_b64_tr_b16 v[126:127],v12 offset:6912
ds_read_b64_tr_b16 v[128:129],v12 offset:32
ds_read_b64_tr_b16 v[130:131],v12 offset:800
ds_read_b64_tr_b16 v[132:133],v12 offset:6176
ds_read_b64_tr_b16 v[134:135],v12 offset:6944
ds_read_b64_tr_b16 v[72:73],v12 offset:64
ds_read_b64_tr_b16 v[74:75],v12 offset:832
ds_read_b64_tr_b16 v[76:77],v12 offset:6208
ds_read_b64_tr_b16 v[78:79],v12 offset:6976
ld_52:
s_waitcnt lgkmcnt(0)
s_waitcnt vmcnt(24)
s_barrier
s_add_u32 s60,s75,s74
s_add_u32 m0,s77,73728
s_add_u32 s61,s60,6684672
buffer_load_dwordx4 v104,s[52:55],s61 offen lds
s_add_u32 m0,s77,74752
s_add_u32 s61,s60,6684672
buffer_load_dwordx4 v105,s[52:55],s61 offen lds
s_add_u32 m0,s77,75776
s_add_u32 s61,s60,6684672
buffer_load_dwordx4 v106,s[52:55],s61 offen lds
s_add_u32 m0,s77,76800
s_add_u32 s61,s60,6782976
buffer_load_dwordx4 v104,s[52:55],s61 offen lds
s_add_u32 m0,s77,77824
s_add_u32 s61,s60,6782976
buffer_load_dwordx4 v105,s[52:55],s61 offen lds
s_add_u32 m0,s77,78848
s_add_u32 s61,s60,6782976
buffer_load_dwordx4 v106,s[52:55],s61 offen lds
v_add_u32 v12,98304,v107
s_cmp_eq_u32 s46,1
s_cbranch_scc1 lw_59
s_cmp_eq_u32 s46,2
s_cbranch_scc1 lw_60
s_cmp_eq_u32 s46,3
s_cbranch_scc1 lw_61
lw_58:
ds_read_b64_tr_b16 a[200:201],v12 offset:0
ds_read_b64_tr_b16 a[202:203],v12 offset:768
ds_read_b64_tr_b16 a[204:205],v12 offset:6144
ds_read_b64_tr_b16 a[206:207],v12 offset:6912
ds_read_b64_tr_b16 a[208:209],v12 offset:32
ds_read_b64_tr_b16 a[210:211],v12 offset:800
ds_read_b64_tr_b16 a[212:213],v12 offset:6176
ds_read_b64_tr_b16 a[214:215],v12 offset:6944
ds_read_b64_tr_b16 a[216:217],v12 offset:64
ds_read_b64_tr_b16 a[218:219],v12 offset:832
ds_read_b64_tr_b16 a[220:221],v12 offset:6208
ds_read_b64_tr_b16 a[222:223],v12 offset:6976
s_branch ld_57
lw_59:
ds_read_b64_tr_b16 a[120:121],v12 offset:0
ds_read_b64_tr_b16 a[122:123],v12 offset:768
ds_read_b64_tr_b16 a[124:125],v12 offset:6144
ds_read_b64_tr_b16 a[126:127],v12 offset:6912
ds_read_b64_tr_b16 a[128:129],v12 offset:32
ds_read_b64_tr_b16 a[130:131],v12 offset:800
ds_read_b64_tr_b16 a[132:133],v12 offset:6176
ds_read_b64_tr_b16 a[134:135],v12 offset:6944
ds_read_b64_tr_b16 a[136:137],v12 offset:64
ds_read_b64_tr_b16 a[138:139],v12 offset:832
ds_read_b64_tr_b16 a[140:141],v12 offset:6208
ds_read_b64_tr_b16 a[142:143],v12 offset:6976
s_branch ld_57
lw_60:
ds_read_b64_tr_b16 a[40:41],v12 offset:0
ds_read_b64_tr_b16 a[42:43],v12 offset:768
ds_read_b64_tr_b16 a[44:45],v12 offset:6144
ds_read_b64_tr_b16 a[46:47],v12 offset:6912
ds_read_b64_tr_b16 a[48:49],v12 offset:32
ds_read_b64_tr_b16 a[50:51],v12 offset:800
ds_read_b64_tr_b16 a[52:53],v12 offset:6176
ds_read_b64_tr_b16 a[54:55],v12 offset:6944
ds_read_b64_tr_b16 a[56:57],v12 offset:64
ds_read_b64_tr_b16 a[58:59],v12 offset:832
ds_read_b64_tr_b16 a[60:61],v12 offset:6208
ds_read_b64_tr_b16 a[62:63],v12 offset:6976
s_branch ld_57
lw_61:
ds_read_b64_tr_b16 v[136:137],v12 offset:0
ds_read_b64_tr_b16 v[138:139],v12 offset:768
ds_read_b64_tr_b16 v[140:141],v12 offset:6144
ds_read_b64_tr_b16 v[142:143],v12 offset:6912
ds_read_b64_tr_b16 v[144:145],v12 offset:32
ds_read_b64_tr_b16 v[146:147],v12 offset:800
ds_read_b64_tr_b16 v[148:149],v12 offset:6176
ds_read_b64_tr_b16 v[150:151],v12 offset:6944
ds_read_b64_tr_b16 v[152:153],v12 offset:64
ds_read_b64_tr_b16 v[154:155],v12 offset:832
ds_read_b64_tr_b16 v[156:157],v12 offset:6208
ds_read_b64_tr_b16 v[158:159],v12 offset:6976
ld_57:
s_waitcnt lgkmcnt(0)
s_waitcnt vmcnt(24)
s_barrier
s_add_u32 s60,s76,s73
s_add_u32 m0,s77,98304
s_add_u32 s61,s60,1572864
buffer_load_dwordx4 v104,s[4:7],s61 offen lds
s_add_u32 m0,s77,99328
s_add_u32 s61,s60,1572864
buffer_load_dwordx4 v105,s[4:7],s61 offen lds
s_add_u32 m0,s77,100352
s_add_u32 s61,s60,1572864
buffer_load_dwordx4 v106,s[4:7],s61 offen lds
s_add_u32 m0,s77,101376
s_add_u32 s61,s60,1671168
buffer_load_dwordx4 v104,s[4:7],s61 offen lds
s_add_u32 m0,s77,102400
s_add_u32 s61,s60,1671168
buffer_load_dwordx4 v105,s[4:7],s61 offen lds
s_add_u32 m0,s77,103424
s_add_u32 s61,s60,1671168
buffer_load_dwordx4 v106,s[4:7],s61 offen lds
v_add_u32 v12,122880,v107
s_cmp_eq_u32 s46,1
s_cbranch_scc1 lw_64
s_cmp_eq_u32 s46,2
s_cbranch_scc1 lw_65
s_cmp_eq_u32 s46,3
s_cbranch_scc1 lw_66
lw_63:
ds_read_b64_tr_b16 a[224:225],v12 offset:0
ds_read_b64_tr_b16 a[226:227],v12 offset:768
ds_read_b64_tr_b16 a[228:229],v12 offset:6144
ds_read_b64_tr_b16 a[230:231],v12 offset:6912
ds_read_b64_tr_b16 a[232:233],v12 offset:32
ds_read_b64_tr_b16 a[234:235],v12 offset:800
ds_read_b64_tr_b16 a[236:237],v12 offset:6176
ds_read_b64_tr_b16 a[238:239],v12 offset:6944
ds_read_b64_tr_b16 v[64:65],v12 offset:64
ds_read_b64_tr_b16 v[66:67],v12 offset:832
ds_read_b64_tr_b16 v[68:69],v12 offset:6208
ds_read_b64_tr_b16 v[70:71],v12 offset:6976
s_branch ld_62
lw_64:
ds_read_b64_tr_b16 a[144:145],v12 offset:0
ds_read_b64_tr_b16 a[146:147],v12 offset:768
ds_read_b64_tr_b16 a[148:149],v12 offset:6144
ds_read_b64_tr_b16 a[150:151],v12 offset:6912
ds_read_b64_tr_b16 a[152:153],v12 offset:32
ds_read_b64_tr_b16 a[154:155],v12 offset:800
ds_read_b64_tr_b16 a[156:157],v12 offset:6176
ds_read_b64_tr_b16 a[158:159],v12 offset:6944
ds_read_b64_tr_b16 v[48:49],v12 offset:64
ds_read_b64_tr_b16 v[50:51],v12 offset:832
ds_read_b64_tr_b16 v[52:53],v12 offset:6208
ds_read_b64_tr_b16 v[54:55],v12 offset:6976
s_branch ld_62
lw_65:
ds_read_b64_tr_b16 a[64:65],v12 offset:0
ds_read_b64_tr_b16 a[66:67],v12 offset:768
ds_read_b64_tr_b16 a[68:69],v12 offset:6144
ds_read_b64_tr_b16 a[70:71],v12 offset:6912
ds_read_b64_tr_b16 a[72:73],v12 offset:32
ds_read_b64_tr_b16 a[74:75],v12 offset:800
ds_read_b64_tr_b16 a[76:77],v12 offset:6176
ds_read_b64_tr_b16 a[78:79],v12 offset:6944
ds_read_b64_tr_b16 v[32:33],v12 offset:64
ds_read_b64_tr_b16 v[34:35],v12 offset:832
ds_read_b64_tr_b16 v[36:37],v12 offset:6208
ds_read_b64_tr_b16 v[38:39],v12 offset:6976
s_branch ld_62
lw_66:
ds_read_b64_tr_b16 v[160:161],v12 offset:0
ds_read_b64_tr_b16 v[162:163],v12 offset:768
ds_read_b64_tr_b16 v[164:165],v12 offset:6144
ds_read_b64_tr_b16 v[166:167],v12 offset:6912
ds_read_b64_tr_b16 v[168:169],v12 offset:32
ds_read_b64_tr_b16 v[170:171],v12 offset:800
ds_read_b64_tr_b16 v[172:173],v12 offset:6176
ds_read_b64_tr_b16 v[174:175],v12 offset:6944
ds_read_b64_tr_b16 v[80:81],v12 offset:64
ds_read_b64_tr_b16 v[82:83],v12 offset:832
ds_read_b64_tr_b16 v[84:85],v12 offset:6208
ds_read_b64_tr_b16 v[86:87],v12 offset:6976
ld_62:
s_waitcnt lgkmcnt(0)
s_waitcnt vmcnt(24)
s_barrier
s_add_u32 s60,s76,s74
s_add_u32 m0,s77,122880
s_add_u32 s61,s60,1572864
buffer_load_dwordx4 v104,s[52:55],s61 offen lds
s_add_u32 m0,s77,123904
s_add_u32 s61,s60,1572864
buffer_load_dwordx4 v105,s[52:55],s61 offen lds
s_add_u32 m0,s77,124928
s_add_u32 s61,s60,1572864
buffer_load_dwordx4 v106,s[52:55],s61 offen lds
s_add_u32 m0,s77,125952
s_add_u32 s61,s60,1671168
buffer_load_dwordx4 v104,s[52:55],s61 offen lds
s_add_u32 m0,s77,126976
s_add_u32 s61,s60,1671168
buffer_load_dwordx4 v105,s[52:55],s61 offen lds
s_add_u32 m0,s77,128000
s_add_u32 s61,s60,1671168
buffer_load_dwordx4 v106,s[52:55],s61 offen lds
v_add_u32 v12,0,v107
s_cmp_eq_u32 s46,1
s_cbranch_scc1 lw_69
s_cmp_eq_u32 s46,2
s_cbranch_scc1 lw_70
s_cmp_eq_u32 s46,3
s_cbranch_scc1 lw_71
lw_68:
ds_read_b64_tr_b16 a[240:241],v12 offset:0
ds_read_b64_tr_b16 a[242:243],v12 offset:768
ds_read_b64_tr_b16 a[244:245],v12 offset:6144
ds_read_b64_tr_b16 a[246:247],v12 offset:6912
ds_read_b64_tr_b16 a[248:249],v12 offset:32
ds_read_b64_tr_b16 a[250:251],v12 offset:800
ds_read_b64_tr_b16 a[252:253],v12 offset:6176
ds_read_b64_tr_b16 a[254:255],v12 offset:6944
ds_read_b64_tr_b16 v[112:113],v12 offset:64
ds_read_b64_tr_b16 v[114:115],v12 offset:832
ds_read_b64_tr_b16 v[116:117],v12 offset:6208
ds_read_b64_tr_b16 v[118:119],v12 offset:6976
s_branch ld_67
lw_69:
ds_read_b64_tr_b16 a[160:161],v12 offset:0
ds_read_b64_tr_b16 a[162:163],v12 offset:768
ds_read_b64_tr_b16 a[164:165],v12 offset:6144
ds_read_b64_tr_b16 a[166:167],v12 offset:6912
ds_read_b64_tr_b16 a[168:169],v12 offset:32
ds_read_b64_tr_b16 a[170:171],v12 offset:800
ds_read_b64_tr_b16 a[172:173],v12 offset:6176
ds_read_b64_tr_b16 a[174:175],v12 offset:6944
ds_read_b64_tr_b16 a[176:177],v12 offset:64
ds_read_b64_tr_b16 a[178:179],v12 offset:832
ds_read_b64_tr_b16 a[180:181],v12 offset:6208
ds_read_b64_tr_b16 a[182:183],v12 offset:6976
s_branch ld_67
lw_70:
ds_read_b64_tr_b16 a[80:81],v12 offset:0
ds_read_b64_tr_b16 a[82:83],v12 offset:768
ds_read_b64_tr_b16 a[84:85],v12 offset:6144
ds_read_b64_tr_b16 a[86:87],v12 offset:6912
ds_read_b64_tr_b16 a[88:89],v12 offset:32
ds_read_b64_tr_b16 a[90:91],v12 offset:800
ds_read_b64_tr_b16 a[92:93],v12 offset:6176
ds_read_b64_tr_b16 a[94:95],v12 offset:6944
ds_read_b64_tr_b16 a[96:97],v12 offset:64
ds_read_b64_tr_b16 a[98:99],v12 offset:832
ds_read_b64_tr_b16 a[100:101],v12 offset:6208
ds_read_b64_tr_b16 a[102:103],v12 offset:6976
s_branch ld_67
lw_71:
ds_read_b64_tr_b16 a[0:1],v12 offset:0
ds_read_b64_tr_b16 a[2:3],v12 offset:768
ds_read_b64_tr_b16 a[4:5],v12 offset:6144
ds_read_b64_tr_b16 a[6:7],v12 offset:6912
ds_read_b64_tr_b16 a[8:9],v12 offset:32
ds_read_b64_tr_b16 a[10:11],v12 offset:800
ds_read_b64_tr_b16 a[12:13],v12 offset:6176
ds_read_b64_tr_b16 a[14:15],v12 offset:6944
ds_read_b64_tr_b16 a[16:17],v12 offset:64
ds_read_b64_tr_b16 a[18:19],v12 offset:832
ds_read_b64_tr_b16 a[20:21],v12 offset:6208
ds_read_b64_tr_b16 a[22:23],v12 offset:6976
ld_67:
s_waitcnt lgkmcnt(0)
s_waitcnt vmcnt(24)
s_barrier
s_add_u32 s60,s76,s73
s_add_u32 m0,s77,0
s_add_u32 s61,s60,5505024
buffer_load_dwordx4 v104,s[4:7],s61 offen lds
s_add_u32 m0,s77,1024
s_add_u32 s61,s60,5505024
buffer_load_dwordx4 v105,s[4:7],s61 offen lds
s_add_u32 m0,s77,2048
s_add_u32 s61,s60,5505024
buffer_load_dwordx4 v106,s[4:7],s61 offen lds
s_add_u32 m0,s77,3072
s_add_u32 s61,s60,5603328
buffer_load_dwordx4 v104,s[4:7],s61 offen lds
s_add_u32 m0,s77,4096
s_add_u32 s61,s60,5603328
buffer_load_dwordx4 v105,s[4:7],s61 offen lds
s_add_u32 m0,s77,5120
s_add_u32 s61,s60,5603328
buffer_load_dwordx4 v106,s[4:7],s61 offen lds
v_add_u32 v12,24576,v107
s_cmp_eq_u32 s46,1
s_cbranch_scc1 lw_74
s_cmp_eq_u32 s46,2
s_cbranch_scc1 lw_75
s_cmp_eq_u32 s46,3
s_cbranch_scc1 lw_76
lw_73:
ds_read_b64_tr_b16 v[120:121],v12 offset:0
ds_read_b64_tr_b16 v[122:123],v12 offset:768
ds_read_b64_tr_b16 v[124:125],v12 offset:6144
ds_read_b64_tr_b16 v[126:127],v12 offset:6912
ds_read_b64_tr_b16 v[128:129],v12 offset:32
ds_read_b64_tr_b16 v[130:131],v12 offset:800
ds_read_b64_tr_b16 v[132:133],v12 offset:6176
ds_read_b64_tr_b16 v[134:135],v12 offset:6944
ds_read_b64_tr_b16 v[72:73],v12 offset:64
ds_read_b64_tr_b16 v[74:75],v12 offset:832
ds_read_b64_tr_b16 v[76:77],v12 offset:6208
ds_read_b64_tr_b16 v[78:79],v12 offset:6976
s_branch ld_72
lw_74:
ds_read_b64_tr_b16 a[184:185],v12 offset:0
ds_read_b64_tr_b16 a[186:187],v12 offset:768
ds_read_b64_tr_b16 a[188:189],v12 offset:6144
ds_read_b64_tr_b16 a[190:191],v12 offset:6912
ds_read_b64_tr_b16 a[192:193],v12 offset:32
ds_read_b64_tr_b16 a[194:195],v12 offset:800
ds_read_b64_tr_b16 a[196:197],v12 offset:6176
ds_read_b64_tr_b16 a[198:199],v12 offset:6944
ds_read_b64_tr_b16 v[56:57],v12 offset:64
ds_read_b64_tr_b16 v[58:59],v12 offset:832
ds_read_b64_tr_b16 v[60:61],v12 offset:6208
ds_read_b64_tr_b16 v[62:63],v12 offset:6976
s_branch ld_72
lw_75:
ds_read_b64_tr_b16 a[104:105],v12 offset:0
ds_read_b64_tr_b16 a[106:107],v12 offset:768
ds_read_b64_tr_b16 a[108:109],v12 offset:6144
ds_read_b64_tr_b16 a[110:111],v12 offset:6912
ds_read_b64_tr_b16 a[112:113],v12 offset:32
ds_read_b64_tr_b16 a[114:115],v12 offset:800
ds_read_b64_tr_b16 a[116:117],v12 offset:6176
ds_read_b64_tr_b16 a[118:119],v12 offset:6944
ds_read_b64_tr_b16 v[40:41],v12 offset:64
ds_read_b64_tr_b16 v[42:43],v12 offset:832
ds_read_b64_tr_b16 v[44:45],v12 offset:6208
ds_read_b64_tr_b16 v[46:47],v12 offset:6976
s_branch ld_72
lw_76:
ds_read_b64_tr_b16 a[24:25],v12 offset:0
ds_read_b64_tr_b16 a[26:27],v12 offset:768
ds_read_b64_tr_b16 a[28:29],v12 offset:6144
ds_read_b64_tr_b16 a[30:31],v12 offset:6912
ds_read_b64_tr_b16 a[32:33],v12 offset:32
ds_read_b64_tr_b16 a[34:35],v12 offset:800
ds_read_b64_tr_b16 a[36:37],v12 offset:6176
ds_read_b64_tr_b16 a[38:39],v12 offset:6944
ds_read_b64_tr_b16 v[24:25],v12 offset:64
ds_read_b64_tr_b16 v[26:27],v12 offset:832
ds_read_b64_tr_b16 v[28:29],v12 offset:6208
ds_read_b64_tr_b16 v[30:31],v12 offset:6976
ld_72:
s_waitcnt lgkmcnt(0)
s_waitcnt vmcnt(24)
s_barrier
s_add_u32 s60,s76,s74
s_add_u32 m0,s77,24576
s_add_u32 s61,s60,5505024
buffer_load_dwordx4 v104,s[52:55],s61 offen lds
s_add_u32 m0,s77,25600
s_add_u32 s61,s60,5505024
buffer_load_dwordx4 v105,s[52:55],s61 offen lds
s_add_u32 m0,s77,26624
s_add_u32 s61,s60,5505024
buffer_load_dwordx4 v106,s[52:55],s61 offen lds
s_add_u32 m0,s77,27648
s_add_u32 s61,s60,5603328
buffer_load_dwordx4 v104,s[52:55],s61 offen lds
s_add_u32 m0,s77,28672
s_add_u32 s61,s60,5603328
buffer_load_dwordx4 v105,s[52:55],s61 offen lds
s_add_u32 m0,s77,29696
s_add_u32 s61,s60,5603328
buffer_load_dwordx4 v106,s[52:55],s61 offen lds
v_add_u32 v12,49152,v107
s_cmp_eq_u32 s46,1
s_cbranch_scc1 lw_79
s_cmp_eq_u32 s46,2
s_cbranch_scc1 lw_80
s_cmp_eq_u32 s46,3
s_cbranch_scc1 lw_81
lw_78:
ds_read_b64_tr_b16 v[136:137],v12 offset:0
ds_read_b64_tr_b16 v[138:139],v12 offset:768
ds_read_b64_tr_b16 v[140:141],v12 offset:6144
ds_read_b64_tr_b16 v[142:143],v12 offset:6912
ds_read_b64_tr_b16 v[144:145],v12 offset:32
ds_read_b64_tr_b16 v[146:147],v12 offset:800
ds_read_b64_tr_b16 v[148:149],v12 offset:6176
ds_read_b64_tr_b16 v[150:151],v12 offset:6944
ds_read_b64_tr_b16 v[152:153],v12 offset:64
ds_read_b64_tr_b16 v[154:155],v12 offset:832
ds_read_b64_tr_b16 v[156:157],v12 offset:6208
ds_read_b64_tr_b16 v[158:159],v12 offset:6976
s_branch ld_77
lw_79:
ds_read_b64_tr_b16 a[200:201],v12 offset:0
ds_read_b64_tr_b16 a[202:203],v12 offset:768
ds_read_b64_tr_b16 a[204:205],v12 offset:6144
ds_read_b64_tr_b16 a[206:207],v12 offset:6912
ds_read_b64_tr_b16 a[208:209],v12 offset:32
ds_read_b64_tr_b16 a[210:211],v12 offset:800
ds_read_b64_tr_b16 a[212:213],v12 offset:6176
ds_read_b64_tr_b16 a[214:215],v12 offset:6944
ds_read_b64_tr_b16 a[216:217],v12 offset:64
ds_read_b64_tr_b16 a[218:219],v12 offset:832
ds_read_b64_tr_b16 a[220:221],v12 offset:6208
ds_read_b64_tr_b16 a[222:223],v12 offset:6976
s_branch ld_77
lw_80:
ds_read_b64_tr_b16 a[120:121],v12 offset:0
ds_read_b64_tr_b16 a[122:123],v12 offset:768
ds_read_b64_tr_b16 a[124:125],v12 offset:6144
ds_read_b64_tr_b16 a[126:127],v12 offset:6912
ds_read_b64_tr_b16 a[128:129],v12 offset:32
ds_read_b64_tr_b16 a[130:131],v12 offset:800
ds_read_b64_tr_b16 a[132:133],v12 offset:6176
ds_read_b64_tr_b16 a[134:135],v12 offset:6944
ds_read_b64_tr_b16 a[136:137],v12 offset:64
ds_read_b64_tr_b16 a[138:139],v12 offset:832
ds_read_b64_tr_b16 a[140:141],v12 offset:6208
ds_read_b64_tr_b16 a[142:143],v12 offset:6976
s_branch ld_77
lw_81:
ds_read_b64_tr_b16 a[40:41],v12 offset:0
ds_read_b64_tr_b16 a[42:43],v12 offset:768
ds_read_b64_tr_b16 a[44:45],v12 offset:6144
ds_read_b64_tr_b16 a[46:47],v12 offset:6912
ds_read_b64_tr_b16 a[48:49],v12 offset:32
ds_read_b64_tr_b16 a[50:51],v12 offset:800
ds_read_b64_tr_b16 a[52:53],v12 offset:6176
ds_read_b64_tr_b16 a[54:55],v12 offset:6944
ds_read_b64_tr_b16 a[56:57],v12 offset:64
ds_read_b64_tr_b16 a[58:59],v12 offset:832
ds_read_b64_tr_b16 a[60:61],v12 offset:6208
ds_read_b64_tr_b16 a[62:63],v12 offset:6976
ld_77:
s_waitcnt lgkmcnt(0)
s_waitcnt vmcnt(24)
s_barrier
v_add_u32 v12,73728,v107
s_cmp_eq_u32 s46,1
s_cbranch_scc1 lw_84
s_cmp_eq_u32 s46,2
s_cbranch_scc1 lw_85
s_cmp_eq_u32 s46,3
s_cbranch_scc1 lw_86
lw_83:
ds_read_b64_tr_b16 v[160:161],v12 offset:0
ds_read_b64_tr_b16 v[162:163],v12 offset:768
ds_read_b64_tr_b16 v[164:165],v12 offset:6144
ds_read_b64_tr_b16 v[166:167],v12 offset:6912
ds_read_b64_tr_b16 v[168:169],v12 offset:32
ds_read_b64_tr_b16 v[170:171],v12 offset:800
ds_read_b64_tr_b16 v[172:173],v12 offset:6176
ds_read_b64_tr_b16 v[174:175],v12 offset:6944
ds_read_b64_tr_b16 v[80:81],v12 offset:64
ds_read_b64_tr_b16 v[82:83],v12 offset:832
ds_read_b64_tr_b16 v[84:85],v12 offset:6208
ds_read_b64_tr_b16 v[86:87],v12 offset:6976
s_branch ld_82
lw_84:
ds_read_b64_tr_b16 a[224:225],v12 offset:0
ds_read_b64_tr_b16 a[226:227],v12 offset:768
ds_read_b64_tr_b16 a[228:229],v12 offset:6144
ds_read_b64_tr_b16 a[230:231],v12 offset:6912
ds_read_b64_tr_b16 a[232:233],v12 offset:32
ds_read_b64_tr_b16 a[234:235],v12 offset:800
ds_read_b64_tr_b16 a[236:237],v12 offset:6176
ds_read_b64_tr_b16 a[238:239],v12 offset:6944
ds_read_b64_tr_b16 v[64:65],v12 offset:64
ds_read_b64_tr_b16 v[66:67],v12 offset:832
ds_read_b64_tr_b16 v[68:69],v12 offset:6208
ds_read_b64_tr_b16 v[70:71],v12 offset:6976
s_branch ld_82
lw_85:
ds_read_b64_tr_b16 a[144:145],v12 offset:0
ds_read_b64_tr_b16 a[146:147],v12 offset:768
ds_read_b64_tr_b16 a[148:149],v12 offset:6144
ds_read_b64_tr_b16 a[150:151],v12 offset:6912
ds_read_b64_tr_b16 a[152:153],v12 offset:32
ds_read_b64_tr_b16 a[154:155],v12 offset:800
ds_read_b64_tr_b16 a[156:157],v12 offset:6176
ds_read_b64_tr_b16 a[158:159],v12 offset:6944
ds_read_b64_tr_b16 v[48:49],v12 offset:64
ds_read_b64_tr_b16 v[50:51],v12 offset:832
ds_read_b64_tr_b16 v[52:53],v12 offset:6208
ds_read_b64_tr_b16 v[54:55],v12 offset:6976
s_branch ld_82
lw_86:
ds_read_b64_tr_b16 a[64:65],v12 offset:0
ds_read_b64_tr_b16 a[66:67],v12 offset:768
ds_read_b64_tr_b16 a[68:69],v12 offset:6144
ds_read_b64_tr_b16 a[70:71],v12 offset:6912
ds_read_b64_tr_b16 a[72:73],v12 offset:32
ds_read_b64_tr_b16 a[74:75],v12 offset:800
ds_read_b64_tr_b16 a[76:77],v12 offset:6176
ds_read_b64_tr_b16 a[78:79],v12 offset:6944
ds_read_b64_tr_b16 v[32:33],v12 offset:64
ds_read_b64_tr_b16 v[34:35],v12 offset:832
ds_read_b64_tr_b16 v[36:37],v12 offset:6208
ds_read_b64_tr_b16 v[38:39],v12 offset:6976
ld_82:
s_waitcnt lgkmcnt(0)
s_waitcnt vmcnt(18)
s_barrier
v_add_u32 v12,98304,v107
ds_read_b64_tr_b16 v[176:177],v12 offset:0
ds_read_b64_tr_b16 v[178:179],v12 offset:768
ds_read_b64_tr_b16 v[180:181],v12 offset:6144
ds_read_b64_tr_b16 v[182:183],v12 offset:6912
ds_read_b64_tr_b16 v[184:185],v12 offset:32
ds_read_b64_tr_b16 v[186:187],v12 offset:800
ds_read_b64_tr_b16 v[188:189],v12 offset:6176
ds_read_b64_tr_b16 v[190:191],v12 offset:6944
ds_read_b64_tr_b16 v[192:193],v12 offset:64
ds_read_b64_tr_b16 v[194:195],v12 offset:832
ds_read_b64_tr_b16 v[196:197],v12 offset:6208
ds_read_b64_tr_b16 v[198:199],v12 offset:6976
s_waitcnt lgkmcnt(0)
s_waitcnt vmcnt(12)
s_barrier
v_add_u32 v12,122880,v107
ds_read_b64_tr_b16 v[200:201],v12 offset:0
ds_read_b64_tr_b16 v[202:203],v12 offset:768
ds_read_b64_tr_b16 v[204:205],v12 offset:6144
ds_read_b64_tr_b16 v[206:207],v12 offset:6912
ds_read_b64_tr_b16 v[208:209],v12 offset:32
ds_read_b64_tr_b16 v[210:211],v12 offset:800
ds_read_b64_tr_b16 v[212:213],v12 offset:6176
ds_read_b64_tr_b16 v[214:215],v12 offset:6944
ds_read_b64_tr_b16 v[88:89],v12 offset:64
ds_read_b64_tr_b16 v[90:91],v12 offset:832
ds_read_b64_tr_b16 v[92:93],v12 offset:6208
ds_read_b64_tr_b16 v[94:95],v12 offset:6976
s_waitcnt lgkmcnt(0)
s_waitcnt vmcnt(6)
s_barrier
v_add_u32 v12,0,v107
ds_read_b64_tr_b16 v[216:217],v12 offset:0
ds_read_b64_tr_b16 v[218:219],v12 offset:768
ds_read_b64_tr_b16 v[220:221],v12 offset:6144
ds_read_b64_tr_b16 v[222:223],v12 offset:6912
ds_read_b64_tr_b16 v[224:225],v12 offset:32
ds_read_b64_tr_b16 v[226:227],v12 offset:800
ds_read_b64_tr_b16 v[228:229],v12 offset:6176
ds_read_b64_tr_b16 v[230:231],v12 offset:6944
ds_read_b64_tr_b16 v[232:233],v12 offset:64
ds_read_b64_tr_b16 v[234:235],v12 offset:832
ds_read_b64_tr_b16 v[236:237],v12 offset:6208
ds_read_b64_tr_b16 v[238:239],v12 offset:6976
s_waitcnt lgkmcnt(0)
s_waitcnt vmcnt(0)
s_barrier
v_add_u32 v12,24576,v107
ds_read_b64_tr_b16 v[240:241],v12 offset:0
ds_read_b64_tr_b16 v[242:243],v12 offset:768
ds_read_b64_tr_b16 v[244:245],v12 offset:6144
ds_read_b64_tr_b16 v[246:247],v12 offset:6912
ds_read_b64_tr_b16 v[248:249],v12 offset:32
ds_read_b64_tr_b16 v[250:251],v12 offset:800
ds_read_b64_tr_b16 v[252:253],v12 offset:6176
ds_read_b64_tr_b16 v[254:255],v12 offset:6944
ds_read_b64_tr_b16 v[96:97],v12 offset:64
ds_read_b64_tr_b16 v[98:99],v12 offset:832
ds_read_b64_tr_b16 v[100:101],v12 offset:6208
ds_read_b64_tr_b16 v[102:103],v12 offset:6976
s_waitcnt lgkmcnt(0)
s_barrier
ds_write_b128 v21,v[24:27] offset:0
ds_write_b128 v21,v[28:31] offset:1024
ds_write_b128 v21,v[32:35] offset:2048
ds_write_b128 v21,v[36:39] offset:3072
ds_write_b128 v21,v[40:43] offset:4096
ds_write_b128 v21,v[44:47] offset:5120
ds_write_b128 v21,v[48:51] offset:6144
ds_write_b128 v21,v[52:55] offset:7168
ds_write_b128 v21,v[56:59] offset:8192
ds_write_b128 v21,v[60:63] offset:9216
ds_write_b128 v21,v[64:67] offset:10240
ds_write_b128 v21,v[68:71] offset:11264
ds_write_b128 v21,v[72:75] offset:12288
ds_write_b128 v21,v[76:79] offset:13312
ds_write_b128 v21,v[80:83] offset:14336
ds_write_b128 v21,v[84:87] offset:15360
ds_write_b128 v21,v[88:91] offset:16384
ds_write_b128 v21,v[92:95] offset:17408
ds_write_b128 v21,v[96:99] offset:18432
ds_write_b128 v21,v[100:103] offset:19456
s_waitcnt lgkmcnt(0)
v_add_u32 v59,139264,v1
s_barrier
s_lshl_b32 s3,s49,2
v_mov_b32 v13,s3
s_nop 1
ibw_87:
buffer_load_dword v12,v13,s[12:15],0 offen sc1
s_waitcnt vmcnt(0)
v_cmp_ne_u32 vcc,256,v12
s_nop 0
s_cbranch_vccz ok_88
s_sleep 8
s_sub_u32 s47,s47,1
s_cbranch_scc1 ABORT
s_branch ibw_87
ok_88:
s_cmp_lg_u32 s49,0
s_cbranch_scc1 ibok_89
v_and_b32 v13,7,v0
v_lshlrev_b32 v13,2,v13
buffer_load_dword v12,v13,s[12:15],0 offen offset:32 sc1
s_waitcnt vmcnt(0)
v_cmp_ne_u32 vcc,32,v12
s_nop 0
s_cbranch_vccz ibok_89
s_barrier
s_mov_b32 s49,1
s_mov_b32 s3,s2
s_load_dwordx16 s[16:31],s[0:1],0
s_load_dwordx8 s[32:39],s[0:1],64
s_waitcnt lgkmcnt(0)
s_branch DISPATCH
ibok_89:
v_mov_b32 v13,192
buffer_load_dword v12,v13,s[12:15],0 offen sc1
s_waitcnt vmcnt(0)
v_readfirstlane_b32 s60,v12
s_cmp_gt_i32 s60,0
s_cselect_b32 s60,0x2000,0
s_add_u32 s83,s83,s60
s_mul_i32 s6,s46,5120
s_add_u32 s6,s6,s82
s_mov_b32 s7,0
s_add_u32 s7,s7,s82
s_add_u32 s7,s7,950272
v_add_u32 v18,4096,v1
s_mov_b32 s50,0
s_mov_b32 s4,0
s_mov_b32 s5,0
s_mov_b32 s78,-1
s_mov_b32 s79,-1
s_mov_b32 s30,-1
s_sub_u32 s60,s4,s5
s_cmp_gt_i32 s60,13
s_cselect_b32 s51,1,0
s_cmp_eq_u32 s4,64
s_cselect_b32 s51,1,s51
s_cmp_eq_u32 s51,0
s_cselect_b32 s52,s4,s5
s_addc_u32 s4,s4,0
s_add_u32 s5,s5,s51
s_and_b32 s60,s52,1
s_lshl2_add_u32 s60,s51,s60
s_lshl_b32 s68,s60,16
s_add_u32 s68,s68,s83
s_mul_i32 s59,s60,20480
s_add_u32 s59,s59,s6
s_lshl_b32 s69,s51,9
s_add_u32 s69,s69,s7
s_bfe_u32 s57,s52,65537
s_add_u32 s58,s52,1
s_cmp_lg_u32 s36,0
s_cbranch_scc1 CV_START
s_cmp_eq_u32 s46,3
s_cbranch_scc1 CH_START
s_lshl_b32 s60,s46,2
s_add_u32 s60,s60,147456
v_mov_b32 v20,s60
v_mov_b32 v12,0
ds_write_b32 v20,v12
v_add_u32 v58,106496,v1
v_mov_b32 v9,147468
s_lshl_b32 s85,s46,12
s_add_u32 s84,s84,s85
s_add_u32 s74,s85,81920
s_add_u32 s75,s74,s74
s_add_u32 s75,s75,24576
s_mul_i32 s60,s29,3
s_add_u32 s60,s60,s46
v_lshlrev_b32 v13,7,v0
s_add_u32 s61,s60,0
s_min_u32 s61,s61,115
s_lshl_b32 s61,s61,13
s_add_u32 s61,s61,s82
buffer_load_dword v14,v13,s[8:11],s61 offen sc1
s_add_u32 s61,s60,48
s_min_u32 s61,s61,115
s_lshl_b32 s61,s61,13
s_add_u32 s61,s61,s82
buffer_load_dword v14,v13,s[8:11],s61 offen sc1
s_add_u32 s61,s60,96
s_min_u32 s61,s61,115
s_lshl_b32 s61,s61,13
s_add_u32 s61,s61,s82
buffer_load_dword v14,v13,s[8:11],s61 offen sc1
s_waitcnt vmcnt(0)
s_mov_b64 vcc,-1
s_waitcnt lgkmcnt(0)
s_cmp_lg_u32 s49,0
s_cbranch_scc1 CS_LOOP_S
CS_LOOP_F:
s_barrier
buffer_load_dwordx4 v[76:79],v18,s[8:11],s59 offen sc1
buffer_load_dwordx4 v[60:63],v1,s[8:11],s59 offen sc1
buffer_load_dwordx4 v[64:67],v1,s[8:11],s59 offen offset:1024 sc1
buffer_load_dwordx4 v[68:71],v1,s[8:11],s59 offen offset:2048 sc1
buffer_load_dwordx4 v[72:75],v1,s[8:11],s59 offen offset:3072 sc1
s_cbranch_vccz CS_FAST_F
v_mov_b32 v24,0
v_mov_b32 v25,0
v_mov_b32 v26,0
v_mov_b32 v27,0
v_mov_b32 v28,0
v_mov_b32 v29,0
v_mov_b32 v30,0
v_mov_b32 v31,0
v_mov_b32 v32,0
v_mov_b32 v33,0
v_mov_b32 v34,0
v_mov_b32 v35,0
v_mov_b32 v36,0
v_mov_b32 v37,0
v_mov_b32 v38,0
v_mov_b32 v39,0
v_mov_b32 v40,0
v_mov_b32 v41,0
v_mov_b32 v42,0
v_mov_b32 v43,0
v_mov_b32 v44,0
v_mov_b32 v45,0
v_mov_b32 v46,0
v_mov_b32 v47,0
s_waitcnt vmcnt(4)
buffer_load_dwordx4 v[96:99],v18,s[8:11],s68 offen sc1
buffer_load_dwordx4 v[80:83],v1,s[8:11],s68 offen sc1
buffer_load_dwordx4 v[84:87],v1,s[8:11],s68 offen offset:1024 sc1
buffer_load_dwordx4 v[88:91],v1,s[8:11],s68 offen offset:2048 sc1
buffer_load_dwordx4 v[92:95],v1,s[8:11],s68 offen offset:3072 sc1
fj_92:
fa_90:
s_waitcnt vmcnt(4)
v_pk_add_f32 v[12:13],v[76:77],v[96:97]
v_pk_add_f32 v[14:15],v[78:79],v[98:99]
v_bitop3_b32 v16,v76,v96,s57 bitop3:0x7e
v_cvt_pk_bf16_f32 v56,v12,v13
v_cvt_pk_bf16_f32 v57,v14,v15
ds_write_b64 v23,v[56:57]
s_waitcnt vmcnt(3)
v_pk_add_f32 v[12:13],v[60:61],v[80:81]
v_pk_add_f32 v[14:15],v[62:63],v[82:83]
v_bitop3_b32 v17,v60,v80,s57 bitop3:0x7e
v_cvt_pk_bf16_f32 v48,v12,v13
v_cvt_pk_bf16_f32 v49,v14,v15
v_or_b32 v16,v16,v17
s_waitcnt vmcnt(2)
v_pk_add_f32 v[12:13],v[64:65],v[84:85]
v_pk_add_f32 v[14:15],v[66:67],v[86:87]
v_bitop3_b32 v17,v64,v84,s57 bitop3:0x7e
v_cvt_pk_bf16_f32 v50,v12,v13
v_cvt_pk_bf16_f32 v51,v14,v15
v_or_b32 v16,v16,v17
ds_write_b128 v22,v[48:51] offset:0
s_waitcnt vmcnt(1)
v_pk_add_f32 v[12:13],v[68:69],v[88:89]
v_pk_add_f32 v[14:15],v[70:71],v[90:91]
v_bitop3_b32 v17,v68,v88,s57 bitop3:0x7e
v_cvt_pk_bf16_f32 v52,v12,v13
v_cvt_pk_bf16_f32 v53,v14,v15
v_or_b32 v16,v16,v17
s_waitcnt vmcnt(0)
v_pk_add_f32 v[12:13],v[72:73],v[92:93]
v_pk_add_f32 v[14:15],v[74:75],v[94:95]
v_bitop3_b32 v17,v72,v92,s57 bitop3:0x7e
v_cvt_pk_bf16_f32 v54,v12,v13
v_cvt_pk_bf16_f32 v55,v14,v15
v_bitop3_b32 v16,v16,v17,1 bitop3:0xa8
v_cmp_ne_u32 vcc,0,v16
ds_write_b128 v22,v[52:55] offset:1024
s_cbranch_vccnz fr_91
v_smfmac_f32_16x16x64_bf16 v[24:27],v[48:51],a[0:7],v2
ds_read_b128 v[72:75],v21 offset:0
v_xor_b32 v58,57344,v58
v_smfmac_f32_16x16x64_bf16 v[28:31],v[48:51],a[8:15],v2
ds_read_b128 v[76:79],v21 offset:1024
s_sub_u32 s60,s4,s5
v_smfmac_f32_16x16x64_bf16 v[32:35],v[48:51],a[16:23],v2
ds_read_b128 v[80:83],v21 offset:2048
v_smfmac_f32_16x16x64_bf16 v[36:39],v[48:51],a[24:31],v2
ds_read_b128 v[84:87],v21 offset:3072
s_waitcnt lgkmcnt(4)
s_barrier
v_smfmac_f32_16x16x64_bf16 v[40:43],v[48:51],a[32:39],v2
ds_read_b128 v[60:63],v3 offset:0
v_smfmac_f32_16x16x64_bf16 v[24:27],v[52:55],a[40:47],v2
ds_read_b128 v[64:67],v3 offset:1024
v_smfmac_f32_16x16x64_bf16 v[28:31],v[52:55],a[48:55],v2
ds_read_b128 v[68:71],v4 offset:0
v_smfmac_f32_16x16x64_bf16 v[32:35],v[52:55],a[56:63],v2
s_cmp_gt_i32 s60,13
s_cselect_b32 s53,1,0
v_smfmac_f32_16x16x64_bf16 v[36:39],v[52:55],a[64:71],v2
s_cmp_eq_u32 s4,64
s_cselect_b32 s53,1,s53
v_smfmac_f32_16x16x64_bf16 v[40:43],v[52:55],a[72:79],v2
s_waitcnt lgkmcnt(5)
v_smfmac_f32_16x16x64_bf16 v[44:47],v[48:51],v[72:79],v2
ds_read_b128 v[72:75],v21 offset:4096
s_waitcnt lgkmcnt(4)
v_smfmac_f32_16x16x64_bf16 v[44:47],v[52:55],v[80:87],v2
ds_read_b128 v[76:79],v21 offset:5120
s_waitcnt lgkmcnt(4)
v_smfmac_f32_16x16x64_bf16 v[24:27],v[60:63],a[80:87],v2
ds_read_b128 v[80:83],v21 offset:6144
v_smfmac_f32_16x16x64_bf16 v[28:31],v[60:63],a[88:95],v2
ds_read_b128 v[84:87],v21 offset:7168
v_smfmac_f32_16x16x64_bf16 v[32:35],v[60:63],a[96:103],v2
s_cmp_eq_u32 s53,0
s_cselect_b32 s54,s4,s5
s_addc_u32 s4,s4,0
v_smfmac_f32_16x16x64_bf16 v[36:39],v[60:63],a[104:111],v2
s_add_u32 s5,s5,s53
s_mul_i32 s73,s54,393216
s_add_u32 s73,s73,s84
v_smfmac_f32_16x16x64_bf16 v[40:43],v[60:63],a[112:119],v2
s_sub_u32 s74,s75,s74
s_mov_b32 m0,s74
s_waitcnt lgkmcnt(2)
v_smfmac_f32_16x16x64_bf16 v[44:47],v[60:63],v[72:79],v2
ds_read_b128 v[60:63],v4 offset:1024
s_and_b32 s60,s52,1
v_smfmac_f32_16x16x64_bf16 v[24:27],v[64:67],a[120:127],v2
ds_read_b128 v[72:75],v21 offset:8192
s_lshl2_add_u32 s60,s51,s60
v_smfmac_f32_16x16x64_bf16 v[28:31],v[64:67],a[128:135],v2
ds_read_b128 v[76:79],v21 offset:9216
s_mul_i32 s60,s60,49152
v_smfmac_f32_16x16x64_bf16 v[32:35],v[64:67],a[136:143],v2
s_add_u32 s71,s60,s34
s_add_u32 s70,s60,s33
s_lshl_b32 s60,s51,9
v_smfmac_f32_16x16x64_bf16 v[36:39],v[64:67],a[144:151],v2
s_add_u32 s72,s60,s35
buffer_load_dwordx4 v1,s[8:11],s73 offen sc1 lds
v_smfmac_f32_16x16x64_bf16 v[40:43],v[64:67],a[152:159],v2
buffer_load_dwordx4 v1,s[8:11],s73 offen offset:1024 sc1 lds
s_waitcnt lgkmcnt(3)
v_smfmac_f32_16x16x64_bf16 v[44:47],v[64:67],v[80:87],v2
ds_read_b128 v[64:67],v5 offset:0
v_smfmac_f32_16x16x64_bf16 v[24:27],v[68:71],a[160:167],v2
ds_read_b128 v[80:83],v21 offset:10240
v_smfmac_f32_16x16x64_bf16 v[28:31],v[68:71],a[168:175],v2
ds_read_b128 v[84:87],v21 offset:11264
v_smfmac_f32_16x16x64_bf16 v[32:35],v[68:71],a[176:183],v2
buffer_load_dwordx4 v1,s[8:11],s73 offen offset:2048 sc1 lds
v_smfmac_f32_16x16x64_bf16 v[36:39],v[68:71],a[184:191],v2
buffer_load_dwordx4 v1,s[8:11],s73 offen offset:3072 sc1 lds
s_and_b32 s60,s54,1
v_smfmac_f32_16x16x64_bf16 v[40:43],v[68:71],a[192:199],v2
s_lshl2_add_u32 s60,s53,s60
s_lshl_b32 s68,s60,16
s_waitcnt lgkmcnt(3)
v_smfmac_f32_16x16x64_bf16 v[44:47],v[68:71],v[72:79],v2
ds_read_b128 v[68:71],v5 offset:1024
s_add_u32 s68,s68,s83
v_smfmac_f32_16x16x64_bf16 v[24:27],v[60:63],a[200:207],v2
ds_read_b128 v[72:75],v21 offset:12288
s_mul_i32 s59,s60,20480
v_smfmac_f32_16x16x64_bf16 v[28:31],v[60:63],a[208:215],v2
ds_read_b128 v[76:79],v21 offset:13312
s_add_u32 s59,s59,s6
v_smfmac_f32_16x16x64_bf16 v[32:35],v[60:63],a[216:223],v2
s_lshl_b32 s69,s53,9
s_add_u32 s69,s69,s7
s_bfe_u32 s31,s54,65537
v_smfmac_f32_16x16x64_bf16 v[36:39],v[60:63],a[224:231],v2
s_add_u32 s32,s54,1
v_add_u32 v17,s85,v58
v_smfmac_f32_16x16x64_bf16 v[40:43],v[60:63],a[232:239],v2
v_mov_b32 v16,s58
s_waitcnt lgkmcnt(3)
v_smfmac_f32_16x16x64_bf16 v[44:47],v[60:63],v[80:87],v2
ds_read_b128 v[60:63],v59 offset:0
v_mov_b32 v15,0
v_smfmac_f32_16x16x64_bf16 v[24:27],v[64:67],a[240:247],v2
ds_read_b128 v[80:83],v21 offset:14336
v_smfmac_f32_16x16x64_bf16 v[28:31],v[64:67],a[248:255],v2
ds_read_b128 v[84:87],v21 offset:15360
v_smfmac_f32_16x16x64_bf16 v[32:35],v[64:67],v[112:119],v2
ds_read_b128 v[88:91],v58 offset:0
v_smfmac_f32_16x16x64_bf16 v[36:39],v[64:67],v[120:127],v2
ds_read_b128 v[92:95],v58 offset:1024
v_smfmac_f32_16x16x64_bf16 v[40:43],v[64:67],v[128:135],v2
ds_read_b128 v[96:99],v58 offset:2048
s_waitcnt lgkmcnt(6)
v_smfmac_f32_16x16x64_bf16 v[44:47],v[64:67],v[72:79],v2
ds_read_b128 v[64:67],v59 offset:1024
v_smfmac_f32_16x16x64_bf16 v[24:27],v[68:71],v[136:143],v2
ds_read_b128 v[72:75],v21 offset:16384
v_smfmac_f32_16x16x64_bf16 v[28:31],v[68:71],v[144:151],v2
ds_read_b128 v[76:79],v21 offset:17408
v_smfmac_f32_16x16x64_bf16 v[32:35],v[68:71],v[152:159],v2
ds_read_b128 v[100:103],v58 offset:3072
v_smfmac_f32_16x16x64_bf16 v[36:39],v[68:71],v[160:167],v2
ds_read_b128 v[104:107],v58 offset:4096
v_smfmac_f32_16x16x64_bf16 v[40:43],v[68:71],v[168:175],v2
ds_read_b128 v[108:111],v58 offset:5120
s_waitcnt lgkmcnt(9)
v_smfmac_f32_16x16x64_bf16 v[44:47],v[68:71],v[80:87],v2
ds_read_b128 v[80:83],v21 offset:18432
v_smfmac_f32_16x16x64_bf16 v[24:27],v[60:63],v[176:183],v2
ds_read_b128 v[84:87],v21 offset:19456
v_smfmac_f32_16x16x64_bf16 v[36:39],v[60:63],v[200:207],v2
ds_read_b128 v[48:51],v58 offset:6144
s_waitcnt lgkmcnt(8)
v_smfmac_f32_16x16x64_bf16 v[24:27],v[64:67],v[216:223],v2
ds_read_b128 v[52:55],v58 offset:7168
v_smfmac_f32_16x16x64_bf16 v[36:39],v[64:67],v[240:247],v2
v_smfmac_f32_16x16x64_bf16 v[28:31],v[60:63],v[184:191],v2
v_smfmac_f32_16x16x64_bf16 v[40:43],v[60:63],v[208:215],v2
s_nop 3
v_add_f32 v24,v24,v25
v_smfmac_f32_16x16x64_bf16 v[28:31],v[64:67],v[224:231],v2
v_add_f32 v26,v26,v27
v_smfmac_f32_16x16x64_bf16 v[40:43],v[64:67],v[248:255],v2
v_add_f32 v36,v36,v37
v_smfmac_f32_16x16x64_bf16 v[32:35],v[60:63],v[192:199],v2
v_add_f32 v38,v38,v39
s_waitcnt lgkmcnt(7)
v_smfmac_f32_16x16x64_bf16 v[44:47],v[60:63],v[72:79],v2
v_cvt_pk_bf16_f32 v37,v24,v26
v_smfmac_f32_16x16x64_bf16 v[32:35],v[64:67],v[232:239],v2
v_cvt_pk_bf16_f32 v36,v36,v38
s_waitcnt lgkmcnt(2)
v_smfmac_f32_16x16x64_bf16 v[44:47],v[64:67],v[80:87],v2
ds_write_b64 v6,v[36:37] offset:0
v_add_f32 v28,v28,v29
v_add_f32 v30,v30,v31
v_add_f32 v40,v40,v41
v_add_f32 v42,v42,v43
v_cvt_pk_bf16_f32 v41,v28,v30
v_cvt_pk_bf16_f32 v40,v40,v42
ds_write_b64 v6,v[40:41] offset:512
v_add_f32 v32,v32,v33
v_add_f32 v34,v34,v35
v_add_f32 v44,v44,v45
v_add_f32 v46,v46,v47
v_cvt_pk_bf16_f32 v45,v32,v34
v_cvt_pk_bf16_f32 v44,v44,v46
ds_write_b64 v6,v[44:45] offset:1024
s_cmp_eq_u32 s52,63
s_cbranch_scc1 last_93
ds_read_b128 v[72:75],v58 offset:8192
ds_read_b128 v[76:79],v58 offset:9216
s_waitcnt lgkmcnt(2)
s_barrier
ds_read_b64_tr_b16 v[24:25],v7 offset:0
ds_read_b64_tr_b16 v[26:27],v7 offset:512
ds_read_b64_tr_b16 v[28:29],v7 offset:1024
ds_read_b64_tr_b16 v[30:31],v7 offset:1536
ds_read_b64_tr_b16 v[32:33],v7 offset:2048
ds_read_b64_tr_b16 v[34:35],v7 offset:2560
ds_read_b64_tr_b16 v[36:37],v7 offset:3072
ds_read_b64_tr_b16 v[38:39],v7 offset:3584
s_waitcnt lgkmcnt(6)
v_mfma_f32_16x16x32_bf16 v[60:63],v[88:91],v[24:27],0
ds_read_b64_tr_b16 v[40:41],v7 offset:4096
s_mov_b64 vcc,s[88:89]
v_mfma_f32_16x16x32_bf16 v[64:67],v[92:95],v[24:27],0
ds_read_b64_tr_b16 v[42:43],v7 offset:4608
v_mfma_f32_16x16x32_bf16 v[68:71],v[24:27],v[24:27],0
ds_read_b128 v[80:83],v58 offset:10240
s_waitcnt lgkmcnt(7)
v_mfma_f32_16x16x32_bf16 v[60:63],v[96:99],v[28:31],v[60:63]
ds_read_b128 v[84:87],v58 offset:11264
v_mfma_f32_16x16x32_bf16 v[64:67],v[100:103],v[28:31],v[64:67]
ds_read_b64_tr_b16 v[44:45],v7 offset:5120
v_mfma_f32_16x16x32_bf16 v[68:71],v[28:31],v[28:31],v[68:71]
ds_read_b64_tr_b16 v[46:47],v7 offset:5632
s_waitcnt lgkmcnt(8)
v_mfma_f32_16x16x32_bf16 v[60:63],v[104:107],v[32:35],v[60:63]
ds_read_b128 v[88:91],v17 offset:12288
v_mfma_f32_16x16x32_bf16 v[64:67],v[108:111],v[32:35],v[64:67]
ds_read_b128 v[92:95],v17 offset:13312
v_mfma_f32_16x16x32_bf16 v[68:71],v[32:35],v[32:35],v[68:71]
ds_read_b128 v[96:99],v17 offset:14336
s_waitcnt lgkmcnt(9)
v_mfma_f32_16x16x32_bf16 v[60:63],v[48:51],v[36:39],v[60:63]
ds_read_b128 v[100:103],v17 offset:15360
v_mfma_f32_16x16x32_bf16 v[64:67],v[52:55],v[36:39],v[64:67]
v_mfma_f32_16x16x32_bf16 v[68:71],v[36:39],v[36:39],v[68:71]
s_waitcnt lgkmcnt(8)
v_mfma_f32_16x16x32_bf16 v[60:63],v[72:75],v[40:43],v[60:63]
v_mfma_f32_16x16x32_bf16 v[64:67],v[76:79],v[40:43],v[64:67]
v_mfma_f32_16x16x32_bf16 v[68:71],v[40:43],v[40:43],v[68:71]
s_waitcnt lgkmcnt(4)
v_mfma_f32_16x16x32_bf16 v[60:63],v[80:83],v[44:47],v[60:63]
v_mfma_f32_16x16x32_bf16 v[64:67],v[84:87],v[44:47],v[64:67]
buffer_load_dwordx4 v[104:107],v1,s[8:11],s71 offen sc1
v_mfma_f32_16x16x32_bf16 v[68:71],v[44:47],v[44:47],v[68:71]
s_nop 5
v_cndmask_b32_dpp v60,v64,v60,vcc quad_perm:[2,3,2,3] row_mask:0xf bank_mask:0xf
v_cndmask_b32_dpp v61,v65,v61,vcc quad_perm:[2,3,2,3] row_mask:0xf bank_mask:0xf
v_cndmask_b32_dpp v62,v66,v62,vcc quad_perm:[2,3,2,3] row_mask:0xf bank_mask:0xf
v_cndmask_b32_dpp v63,v67,v63,vcc quad_perm:[2,3,2,3] row_mask:0xf bank_mask:0xf
v_max3_f32 v12,v60,v61,v62
v_cndmask_b32_dpp v68,v69,v68,vcc quad_perm:[2,3,2,3] row_mask:0xf bank_mask:0xf
v_max3_f32 v12,v12,v63,v68
s_nop 1
v_max_f32_dpp v13,v12,v12 quad_perm:[2,3,0,1] row_mask:0xf bank_mask:0xf
v_max_f32_dpp v12,v12,v12 quad_perm:[2,3,0,1] row_mask:0xf bank_mask:0xf
s_nop 1
v_permlane32_swap_b32 v12,v13
v_max_f32 v64,v12,v13
v_max_f32 v12,v12,v13
s_mov_b64 exec,1
buffer_store_dword v16,v1,s[8:11],s72 offen
s_mov_b64 exec,-1
v_permlane16_swap_b32 v12,v64
v_max_f32 v12,v12,v64
v_mul_f32 v12,s87,v12
v_fma_f32 v60,v60,s87,-v12
v_fma_f32 v61,v61,s87,-v12
v_fma_f32 v62,v62,s87,-v12
v_fma_f32 v63,v63,s87,-v12
v_fma_f32 v68,v68,s87,-v12
v_exp_f32 v60,v60
v_exp_f32 v61,v61
v_exp_f32 v62,v62
v_exp_f32 v63,v63
v_exp_f32 v68,v68
v_cvt_pk_bf16_f32 v34,v60,v61
v_cvt_pk_bf16_f32 v35,v62,v63
v_cndmask_b32 v30,v34,v15,vcc
v_cndmask_b32 v31,v35,v15,vcc
v_cndmask_b32_dpp v28,v34,v15,vcc quad_perm:[2,3,0,1] row_mask:0xf bank_mask:0xf
v_cndmask_b32_dpp v29,v35,v15,vcc quad_perm:[2,3,0,1] row_mask:0xf bank_mask:0xf
s_mov_b64 vcc,s[90:91]
s_waitcnt lgkmcnt(0)
v_cndmask_b32 v24,v34,v15,vcc
v_mfma_f32_16x16x32_bf16 v[36:39],v[92:95],v[28:31],0
v_cndmask_b32 v25,v35,v15,vcc
v_cndmask_b32_dpp v26,v34,v15,vcc quad_perm:[2,3,0,1] row_mask:0xf bank_mask:0xf
v_mfma_f32_16x16x32_bf16 v[40:43],v[100:103],v[28:31],0
v_cndmask_b32_dpp v27,v35,v15,vcc quad_perm:[2,3,0,1] row_mask:0xf bank_mask:0xf
v_mov_b32_dpp v14,v68 quad_perm:[2,3,0,1] row_mask:0xf bank_mask:0xf
v_add_f32 v12,v60,v61
v_mfma_f32_16x16x32_bf16 v[36:39],v[88:91],v[24:27],v[36:39]
v_cvt_pk_bf16_f32 v32,v68,v14
v_cvt_pk_bf16_f32 v33,v14,v68
v_mfma_f32_16x16x32_bf16 v[40:43],v[96:99],v[24:27],v[40:43]
v_cndmask_b32 v32,v32,v15,vcc
v_cndmask_b32 v33,v15,v33,vcc
ds_read_b32 v10,v9
s_waitcnt vmcnt(1)
v_bitop3_b32 v17,v104,v106,s57 bitop3:0x7e
v_add_f32 v13,v62,v63
v_and_b32 v17,1,v17
v_add_f32 v12,v12,v68
v_cmp_ne_u32 vcc,0,v17
v_add_f32 v12,v12,v13
s_cbranch_vccnz vb_94
vo_95:
v_mfma_f32_16x16x16_bf16 v[36:39],v[104:105],v[32:33],v[36:39]
v_add_f32_dpp v13,v12,v12 quad_perm:[2,3,0,1] row_mask:0xf bank_mask:0xf
v_add_f32_dpp v12,v12,v12 quad_perm:[2,3,0,1] row_mask:0xf bank_mask:0xf
v_mfma_f32_16x16x16_bf16 v[40:43],v[106:107],v[32:33],v[40:43]
s_nop 0
v_permlane32_swap_b32 v12,v13
v_add_f32 v64,v12,v13
v_add_f32 v12,v12,v13
s_add_u32 s50,s50,1
s_mov_b32 s51,s53
v_permlane16_swap_b32 v12,v64
v_add_f32 v12,v12,v64
v_rcp_f32 v12,v12
s_mov_b32 s52,s54
v_pk_mul_f32 v[36:37],v[36:37],v[12:13] op_sel_hi:[1,0]
v_pk_mul_f32 v[38:39],v[38:39],v[12:13] op_sel_hi:[1,0]
v_pk_mul_f32 v[40:41],v[40:41],v[12:13] op_sel_hi:[1,0]
v_pk_mul_f32 v[42:43],v[42:43],v[12:13] op_sel_hi:[1,0]
v_cvt_pk_bf16_f32 v48,v36,v37
v_cvt_pk_bf16_f32 v49,v38,v39
v_cvt_pk_bf16_f32 v50,v40,v41
v_cvt_pk_bf16_f32 v51,v42,v43
v_and_or_b32 v48,v48,-2,s57
buffer_store_dwordx4 v[48:51],v8,s[8:11],s70 offen
s_mov_b32 s57,s31
s_mov_b32 s58,s32
s_waitcnt lgkmcnt(0)
v_cmp_ne_u32 vcc,s50,v10
v_mov_b32 v12,s50
ds_write_b32 v20,v12
s_branch CS_LOOP_F
last_93:
s_waitcnt lgkmcnt(0)
s_barrier
s_add_u32 s50,s50,1
s_mov_b32 s51,s53
s_mov_b32 s52,s54
s_mov_b32 s57,s31
s_mov_b32 s58,s32
s_mov_b64 vcc,-1
s_waitcnt vmcnt(0)
v_mov_b32 v12,s50
ds_write_b32 v20,v12
s_cmp_lt_u32 s50,128
s_cbranch_scc1 CS_LOOP_F
s_branch CS_DONE
fr_91:
v_bitop3_b32 v12,v60,v64,s57 bitop3:0x7e
v_bitop3_b32 v13,v68,v72,s57 bitop3:0x7e
v_xor_b32 v14,s57,v76
v_or3_b32 v12,v12,v13,v14
v_and_b32 v12,1,v12
v_cmp_ne_u32 vcc,0,v12
s_cbranch_vccz sk_96
buffer_load_dwordx4 v[76:79],v18,s[8:11],s59 offen sc1
buffer_load_dwordx4 v[60:63],v1,s[8:11],s59 offen sc1
buffer_load_dwordx4 v[64:67],v1,s[8:11],s59 offen offset:1024 sc1
buffer_load_dwordx4 v[68:71],v1,s[8:11],s59 offen offset:2048 sc1
buffer_load_dwordx4 v[72:75],v1,s[8:11],s59 offen offset:3072 sc1
sk_96:
buffer_load_dwordx4 v[96:99],v18,s[8:11],s68 offen sc1
buffer_load_dwordx4 v[80:83],v1,s[8:11],s68 offen sc1
buffer_load_dwordx4 v[84:87],v1,s[8:11],s68 offen offset:1024 sc1
buffer_load_dwordx4 v[88:91],v1,s[8:11],s68 offen offset:2048 sc1
buffer_load_dwordx4 v[92:95],v1,s[8:11],s68 offen offset:3072 sc1
s_sub_u32 s47,s47,1
s_cbranch_scc1 ABORT
s_waitcnt lgkmcnt(0)
s_branch fa_90
CS_FAST_F:
buffer_load_dwordx4 v[96:99],v18,s[8:11],s68 offen sc1
buffer_load_dwordx4 v[80:83],v1,s[8:11],s68 offen sc1
buffer_load_dwordx4 v[84:87],v1,s[8:11],s68 offen offset:1024 sc1
buffer_load_dwordx4 v[88:91],v1,s[8:11],s68 offen offset:2048 sc1
buffer_load_dwordx4 v[92:95],v1,s[8:11],s68 offen offset:3072 sc1
v_mov_b32 v24,0
v_mov_b32 v25,0
v_mov_b32 v26,0
v_mov_b32 v27,0
v_mov_b32 v28,0
v_mov_b32 v29,0
v_mov_b32 v30,0
v_mov_b32 v31,0
v_mov_b32 v32,0
v_mov_b32 v33,0
v_mov_b32 v34,0
v_mov_b32 v35,0
v_mov_b32 v36,0
v_mov_b32 v37,0
v_mov_b32 v38,0
v_mov_b32 v39,0
v_mov_b32 v40,0
v_mov_b32 v41,0
v_mov_b32 v42,0
v_mov_b32 v43,0
v_mov_b32 v44,0
v_mov_b32 v45,0
v_mov_b32 v46,0
v_mov_b32 v47,0
s_nop 0
s_branch fj_92
vb_94:
s_sub_u32 s47,s47,1
s_cbranch_scc1 ABORT
buffer_load_dwordx4 v[104:107],v1,s[8:11],s71 offen sc1
s_waitcnt vmcnt(0)
v_bitop3_b32 v17,v104,v106,s57 bitop3:0x7e
v_and_b32 v17,1,v17
v_cmp_ne_u32 vcc,0,v17
s_nop 0
s_cbranch_vccnz vb_94
s_branch vo_95
CS_LOOP_S:
s_barrier
buffer_load_dwordx4 v[76:79],v18,s[8:11],s59 offen sc1
buffer_load_dwordx4 v[60:63],v1,s[8:11],s59 offen sc1
buffer_load_dwordx4 v[64:67],v1,s[8:11],s59 offen offset:1024 sc1
buffer_load_dwordx4 v[68:71],v1,s[8:11],s59 offen offset:2048 sc1
buffer_load_dwordx4 v[72:75],v1,s[8:11],s59 offen offset:3072 sc1
s_cbranch_vccz CS_FAST_S
v_mov_b32 v24,0
v_mov_b32 v25,0
v_mov_b32 v26,0
v_mov_b32 v27,0
v_mov_b32 v28,0
v_mov_b32 v29,0
v_mov_b32 v30,0
v_mov_b32 v31,0
v_mov_b32 v32,0
v_mov_b32 v33,0
v_mov_b32 v34,0
v_mov_b32 v35,0
v_mov_b32 v36,0
v_mov_b32 v37,0
v_mov_b32 v38,0
v_mov_b32 v39,0
v_mov_b32 v40,0
v_mov_b32 v41,0
v_mov_b32 v42,0
v_mov_b32 v43,0
v_mov_b32 v44,0
v_mov_b32 v45,0
v_mov_b32 v46,0
v_mov_b32 v47,0
s_waitcnt vmcnt(4)
buffer_load_dwordx4 v[96:99],v18,s[8:11],s68 offen sc1
buffer_load_dwordx4 v[80:83],v1,s[8:11],s68 offen sc1
buffer_load_dwordx4 v[84:87],v1,s[8:11],s68 offen offset:1024 sc1
buffer_load_dwordx4 v[88:91],v1,s[8:11],s68 offen offset:2048 sc1
buffer_load_dwordx4 v[92:95],v1,s[8:11],s68 offen offset:3072 sc1
fj_99:
fa_97:
s_waitcnt vmcnt(4)
v_pk_add_f32 v[12:13],v[76:77],v[96:97]
v_pk_add_f32 v[14:15],v[78:79],v[98:99]
v_bitop3_b32 v16,v76,v96,s57 bitop3:0x7e
v_cvt_pk_bf16_f32 v56,v12,v13
v_cvt_pk_bf16_f32 v57,v14,v15
ds_write_b64 v23,v[56:57]
s_waitcnt vmcnt(3)
v_pk_add_f32 v[12:13],v[60:61],v[80:81]
v_pk_add_f32 v[14:15],v[62:63],v[82:83]
v_bitop3_b32 v17,v60,v80,s57 bitop3:0x7e
v_cvt_pk_bf16_f32 v48,v12,v13
v_cvt_pk_bf16_f32 v49,v14,v15
v_or_b32 v16,v16,v17
s_waitcnt vmcnt(2)
v_pk_add_f32 v[12:13],v[64:65],v[84:85]
v_pk_add_f32 v[14:15],v[66:67],v[86:87]
v_bitop3_b32 v17,v64,v84,s57 bitop3:0x7e
v_cvt_pk_bf16_f32 v50,v12,v13
v_cvt_pk_bf16_f32 v51,v14,v15
v_or_b32 v16,v16,v17
ds_write_b128 v22,v[48:51] offset:0
s_waitcnt vmcnt(1)
v_pk_add_f32 v[12:13],v[68:69],v[88:89]
v_pk_add_f32 v[14:15],v[70:71],v[90:91]
v_bitop3_b32 v17,v68,v88,s57 bitop3:0x7e
v_cvt_pk_bf16_f32 v52,v12,v13
v_cvt_pk_bf16_f32 v53,v14,v15
v_or_b32 v16,v16,v17
s_waitcnt vmcnt(0)
v_pk_add_f32 v[12:13],v[72:73],v[92:93]
v_pk_add_f32 v[14:15],v[74:75],v[94:95]
v_bitop3_b32 v17,v72,v92,s57 bitop3:0x7e
v_cvt_pk_bf16_f32 v54,v12,v13
v_cvt_pk_bf16_f32 v55,v14,v15
v_bitop3_b32 v16,v16,v17,1 bitop3:0xa8
v_cmp_ne_u32 vcc,0,v16
ds_write_b128 v22,v[52:55] offset:1024
s_cbranch_vccnz fr_98
v_smfmac_f32_16x16x64_bf16 v[24:27],v[48:51],a[0:7],v2
ds_read_b128 v[72:75],v21 offset:0
v_xor_b32 v58,57344,v58
v_smfmac_f32_16x16x64_bf16 v[28:31],v[48:51],a[8:15],v2
ds_read_b128 v[76:79],v21 offset:1024
s_sub_u32 s60,s4,s5
v_smfmac_f32_16x16x64_bf16 v[32:35],v[48:51],a[16:23],v2
ds_read_b128 v[80:83],v21 offset:2048
v_smfmac_f32_16x16x64_bf16 v[36:39],v[48:51],a[24:31],v2
ds_read_b128 v[84:87],v21 offset:3072
s_waitcnt lgkmcnt(4)
s_barrier
v_smfmac_f32_16x16x64_bf16 v[40:43],v[48:51],a[32:39],v2
ds_read_b128 v[60:63],v3 offset:0
v_smfmac_f32_16x16x64_bf16 v[24:27],v[52:55],a[40:47],v2
ds_read_b128 v[64:67],v3 offset:1024
v_smfmac_f32_16x16x64_bf16 v[28:31],v[52:55],a[48:55],v2
ds_read_b128 v[68:71],v4 offset:0
v_smfmac_f32_16x16x64_bf16 v[32:35],v[52:55],a[56:63],v2
s_cmp_gt_i32 s60,13
s_cselect_b32 s53,1,0
v_smfmac_f32_16x16x64_bf16 v[36:39],v[52:55],a[64:71],v2
s_cmp_eq_u32 s4,64
s_cselect_b32 s53,1,s53
v_smfmac_f32_16x16x64_bf16 v[40:43],v[52:55],a[72:79],v2
s_waitcnt lgkmcnt(5)
v_smfmac_f32_16x16x64_bf16 v[44:47],v[48:51],v[72:79],v2
ds_read_b128 v[72:75],v21 offset:4096
s_waitcnt lgkmcnt(4)
v_smfmac_f32_16x16x64_bf16 v[44:47],v[52:55],v[80:87],v2
ds_read_b128 v[76:79],v21 offset:5120
s_waitcnt lgkmcnt(4)
v_smfmac_f32_16x16x64_bf16 v[24:27],v[60:63],a[80:87],v2
ds_read_b128 v[80:83],v21 offset:6144
v_smfmac_f32_16x16x64_bf16 v[28:31],v[60:63],a[88:95],v2
ds_read_b128 v[84:87],v21 offset:7168
v_smfmac_f32_16x16x64_bf16 v[32:35],v[60:63],a[96:103],v2
s_cmp_eq_u32 s53,0
s_cselect_b32 s54,s4,s5
s_addc_u32 s4,s4,0
v_smfmac_f32_16x16x64_bf16 v[36:39],v[60:63],a[104:111],v2
s_add_u32 s5,s5,s53
s_mul_i32 s73,s54,393216
s_add_u32 s73,s73,s84
v_smfmac_f32_16x16x64_bf16 v[40:43],v[60:63],a[112:119],v2
s_sub_u32 s74,s75,s74
s_mov_b32 m0,s74
s_waitcnt lgkmcnt(2)
v_smfmac_f32_16x16x64_bf16 v[44:47],v[60:63],v[72:79],v2
ds_read_b128 v[60:63],v4 offset:1024
s_and_b32 s60,s52,1
v_smfmac_f32_16x16x64_bf16 v[24:27],v[64:67],a[120:127],v2
ds_read_b128 v[72:75],v21 offset:8192
s_lshl2_add_u32 s60,s51,s60
v_smfmac_f32_16x16x64_bf16 v[28:31],v[64:67],a[128:135],v2
ds_read_b128 v[76:79],v21 offset:9216
s_mul_i32 s60,s60,49152
v_smfmac_f32_16x16x64_bf16 v[32:35],v[64:67],a[136:143],v2
s_add_u32 s71,s60,s34
s_add_u32 s70,s60,s33
s_lshl_b32 s60,s51,9
v_smfmac_f32_16x16x64_bf16 v[36:39],v[64:67],a[144:151],v2
s_add_u32 s72,s60,s35
buffer_load_dwordx4 v1,s[8:11],s73 offen sc1 lds
v_smfmac_f32_16x16x64_bf16 v[40:43],v[64:67],a[152:159],v2
buffer_load_dwordx4 v1,s[8:11],s73 offen offset:1024 sc1 lds
s_waitcnt lgkmcnt(3)
v_smfmac_f32_16x16x64_bf16 v[44:47],v[64:67],v[80:87],v2
ds_read_b128 v[64:67],v5 offset:0
v_smfmac_f32_16x16x64_bf16 v[24:27],v[68:71],a[160:167],v2
ds_read_b128 v[80:83],v21 offset:10240
v_smfmac_f32_16x16x64_bf16 v[28:31],v[68:71],a[168:175],v2
ds_read_b128 v[84:87],v21 offset:11264
v_smfmac_f32_16x16x64_bf16 v[32:35],v[68:71],a[176:183],v2
buffer_load_dwordx4 v1,s[8:11],s73 offen offset:2048 sc1 lds
v_smfmac_f32_16x16x64_bf16 v[36:39],v[68:71],a[184:191],v2
buffer_load_dwordx4 v1,s[8:11],s73 offen offset:3072 sc1 lds
s_and_b32 s60,s54,1
v_smfmac_f32_16x16x64_bf16 v[40:43],v[68:71],a[192:199],v2
s_lshl2_add_u32 s60,s53,s60
s_lshl_b32 s68,s60,16
s_waitcnt lgkmcnt(3)
v_smfmac_f32_16x16x64_bf16 v[44:47],v[68:71],v[72:79],v2
ds_read_b128 v[68:71],v5 offset:1024
s_add_u32 s68,s68,s83
v_smfmac_f32_16x16x64_bf16 v[24:27],v[60:63],a[200:207],v2
ds_read_b128 v[72:75],v21 offset:12288
s_mul_i32 s59,s60,20480
v_smfmac_f32_16x16x64_bf16 v[28:31],v[60:63],a[208:215],v2
ds_read_b128 v[76:79],v21 offset:13312
s_add_u32 s59,s59,s6
v_smfmac_f32_16x16x64_bf16 v[32:35],v[60:63],a[216:223],v2
s_lshl_b32 s69,s53,9
s_add_u32 s69,s69,s7
s_bfe_u32 s31,s54,65537
v_smfmac_f32_16x16x64_bf16 v[36:39],v[60:63],a[224:231],v2
s_add_u32 s32,s54,1
v_add_u32 v17,s85,v58
v_smfmac_f32_16x16x64_bf16 v[40:43],v[60:63],a[232:239],v2
v_mov_b32 v16,s58
s_waitcnt lgkmcnt(3)
v_smfmac_f32_16x16x64_bf16 v[44:47],v[60:63],v[80:87],v2
ds_read_b128 v[60:63],v59 offset:0
v_mov_b32 v15,0
v_smfmac_f32_16x16x64_bf16 v[24:27],v[64:67],a[240:247],v2
ds_read_b128 v[80:83],v21 offset:14336
v_smfmac_f32_16x16x64_bf16 v[28:31],v[64:67],a[248:255],v2
ds_read_b128 v[84:87],v21 offset:15360
v_smfmac_f32_16x16x64_bf16 v[32:35],v[64:67],v[112:119],v2
ds_read_b128 v[88:91],v58 offset:0
v_smfmac_f32_16x16x64_bf16 v[36:39],v[64:67],v[120:127],v2
ds_read_b128 v[92:95],v58 offset:1024
v_smfmac_f32_16x16x64_bf16 v[40:43],v[64:67],v[128:135],v2
ds_read_b128 v[96:99],v58 offset:2048
s_waitcnt lgkmcnt(6)
v_smfmac_f32_16x16x64_bf16 v[44:47],v[64:67],v[72:79],v2
ds_read_b128 v[64:67],v59 offset:1024
v_smfmac_f32_16x16x64_bf16 v[24:27],v[68:71],v[136:143],v2
ds_read_b128 v[72:75],v21 offset:16384
v_smfmac_f32_16x16x64_bf16 v[28:31],v[68:71],v[144:151],v2
ds_read_b128 v[76:79],v21 offset:17408
v_smfmac_f32_16x16x64_bf16 v[32:35],v[68:71],v[152:159],v2
ds_read_b128 v[100:103],v58 offset:3072
v_smfmac_f32_16x16x64_bf16 v[36:39],v[68:71],v[160:167],v2
ds_read_b128 v[104:107],v58 offset:4096
v_smfmac_f32_16x16x64_bf16 v[40:43],v[68:71],v[168:175],v2
ds_read_b128 v[108:111],v58 offset:5120
s_waitcnt lgkmcnt(9)
v_smfmac_f32_16x16x64_bf16 v[44:47],v[68:71],v[80:87],v2
ds_read_b128 v[80:83],v21 offset:18432
v_smfmac_f32_16x16x64_bf16 v[24:27],v[60:63],v[176:183],v2
ds_read_b128 v[84:87],v21 offset:19456
v_smfmac_f32_16x16x64_bf16 v[36:39],v[60:63],v[200:207],v2
ds_read_b128 v[48:51],v58 offset:6144
s_waitcnt lgkmcnt(8)
v_smfmac_f32_16x16x64_bf16 v[24:27],v[64:67],v[216:223],v2
ds_read_b128 v[52:55],v58 offset:7168
v_smfmac_f32_16x16x64_bf16 v[36:39],v[64:67],v[240:247],v2
v_smfmac_f32_16x16x64_bf16 v[28:31],v[60:63],v[184:191],v2
v_smfmac_f32_16x16x64_bf16 v[40:43],v[60:63],v[208:215],v2
s_nop 3
v_add_f32 v24,v24,v25
v_smfmac_f32_16x16x64_bf16 v[28:31],v[64:67],v[224:231],v2
v_add_f32 v26,v26,v27
v_smfmac_f32_16x16x64_bf16 v[40:43],v[64:67],v[248:255],v2
v_add_f32 v36,v36,v37
v_smfmac_f32_16x16x64_bf16 v[32:35],v[60:63],v[192:199],v2
v_add_f32 v38,v38,v39
s_waitcnt lgkmcnt(7)
v_smfmac_f32_16x16x64_bf16 v[44:47],v[60:63],v[72:79],v2
v_cvt_pk_bf16_f32 v37,v24,v26
v_smfmac_f32_16x16x64_bf16 v[32:35],v[64:67],v[232:239],v2
v_cvt_pk_bf16_f32 v36,v36,v38
s_waitcnt lgkmcnt(2)
v_smfmac_f32_16x16x64_bf16 v[44:47],v[64:67],v[80:87],v2
ds_write_b64 v6,v[36:37] offset:0
v_add_f32 v28,v28,v29
v_add_f32 v30,v30,v31
v_add_f32 v40,v40,v41
v_add_f32 v42,v42,v43
v_cvt_pk_bf16_f32 v41,v28,v30
v_cvt_pk_bf16_f32 v40,v40,v42
ds_write_b64 v6,v[40:41] offset:512
v_add_f32 v32,v32,v33
v_add_f32 v34,v34,v35
v_add_f32 v44,v44,v45
v_add_f32 v46,v46,v47
v_cvt_pk_bf16_f32 v45,v32,v34
v_cvt_pk_bf16_f32 v44,v44,v46
ds_write_b64 v6,v[44:45] offset:1024
s_cmp_eq_u32 s52,63
s_cbranch_scc1 last_100
ds_read_b128 v[72:75],v58 offset:8192
ds_read_b128 v[76:79],v58 offset:9216
s_waitcnt lgkmcnt(2)
s_barrier
ds_read_b64_tr_b16 v[24:25],v7 offset:0
ds_read_b64_tr_b16 v[26:27],v7 offset:512
ds_read_b64_tr_b16 v[28:29],v7 offset:1024
ds_read_b64_tr_b16 v[30:31],v7 offset:1536
ds_read_b64_tr_b16 v[32:33],v7 offset:2048
ds_read_b64_tr_b16 v[34:35],v7 offset:2560
ds_read_b64_tr_b16 v[36:37],v7 offset:3072
ds_read_b64_tr_b16 v[38:39],v7 offset:3584
s_waitcnt lgkmcnt(6)
v_mfma_f32_16x16x32_bf16 v[60:63],v[88:91],v[24:27],0
ds_read_b64_tr_b16 v[40:41],v7 offset:4096
s_mov_b64 vcc,s[88:89]
v_mfma_f32_16x16x32_bf16 v[64:67],v[92:95],v[24:27],0
ds_read_b64_tr_b16 v[42:43],v7 offset:4608
v_mfma_f32_16x16x32_bf16 v[68:71],v[24:27],v[24:27],0
ds_read_b128 v[80:83],v58 offset:10240
s_waitcnt lgkmcnt(7)
v_mfma_f32_16x16x32_bf16 v[60:63],v[96:99],v[28:31],v[60:63]
ds_read_b128 v[84:87],v58 offset:11264
v_mfma_f32_16x16x32_bf16 v[64:67],v[100:103],v[28:31],v[64:67]
ds_read_b64_tr_b16 v[44:45],v7 offset:5120
v_mfma_f32_16x16x32_bf16 v[68:71],v[28:31],v[28:31],v[68:71]
ds_read_b64_tr_b16 v[46:47],v7 offset:5632
s_waitcnt lgkmcnt(8)
v_mfma_f32_16x16x32_bf16 v[60:63],v[104:107],v[32:35],v[60:63]
ds_read_b128 v[88:91],v17 offset:12288
v_mfma_f32_16x16x32_bf16 v[64:67],v[108:111],v[32:35],v[64:67]
ds_read_b128 v[92:95],v17 offset:13312
v_mfma_f32_16x16x32_bf16 v[68:71],v[32:35],v[32:35],v[68:71]
ds_read_b128 v[96:99],v17 offset:14336
s_waitcnt lgkmcnt(9)
v_mfma_f32_16x16x32_bf16 v[60:63],v[48:51],v[36:39],v[60:63]
ds_read_b128 v[100:103],v17 offset:15360
v_mfma_f32_16x16x32_bf16 v[64:67],v[52:55],v[36:39],v[64:67]
v_mfma_f32_16x16x32_bf16 v[68:71],v[36:39],v[36:39],v[68:71]
s_waitcnt lgkmcnt(8)
v_mfma_f32_16x16x32_bf16 v[60:63],v[72:75],v[40:43],v[60:63]
v_mfma_f32_16x16x32_bf16 v[64:67],v[76:79],v[40:43],v[64:67]
v_mfma_f32_16x16x32_bf16 v[68:71],v[40:43],v[40:43],v[68:71]
s_waitcnt lgkmcnt(4)
v_mfma_f32_16x16x32_bf16 v[60:63],v[80:83],v[44:47],v[60:63]
v_mfma_f32_16x16x32_bf16 v[64:67],v[84:87],v[44:47],v[64:67]
buffer_load_dwordx4 v[104:107],v1,s[8:11],s71 offen sc1
v_mfma_f32_16x16x32_bf16 v[68:71],v[44:47],v[44:47],v[68:71]
s_nop 5
v_cndmask_b32_dpp v60,v64,v60,vcc quad_perm:[2,3,2,3] row_mask:0xf bank_mask:0xf
v_cndmask_b32_dpp v61,v65,v61,vcc quad_perm:[2,3,2,3] row_mask:0xf bank_mask:0xf
v_cndmask_b32_dpp v62,v66,v62,vcc quad_perm:[2,3,2,3] row_mask:0xf bank_mask:0xf
v_cndmask_b32_dpp v63,v67,v63,vcc quad_perm:[2,3,2,3] row_mask:0xf bank_mask:0xf
v_max3_f32 v12,v60,v61,v62
v_cndmask_b32_dpp v68,v69,v68,vcc quad_perm:[2,3,2,3] row_mask:0xf bank_mask:0xf
v_max3_f32 v12,v12,v63,v68
s_nop 1
v_max_f32_dpp v13,v12,v12 quad_perm:[2,3,0,1] row_mask:0xf bank_mask:0xf
v_max_f32_dpp v12,v12,v12 quad_perm:[2,3,0,1] row_mask:0xf bank_mask:0xf
s_nop 1
v_permlane32_swap_b32 v12,v13
v_max_f32 v64,v12,v13
v_max_f32 v12,v12,v13
s_mov_b64 exec,1
buffer_store_dword v16,v1,s[8:11],s72 offen sc1
s_mov_b64 exec,-1
v_permlane16_swap_b32 v12,v64
v_max_f32 v12,v12,v64
v_mul_f32 v12,s87,v12
v_fma_f32 v60,v60,s87,-v12
v_fma_f32 v61,v61,s87,-v12
v_fma_f32 v62,v62,s87,-v12
v_fma_f32 v63,v63,s87,-v12
v_fma_f32 v68,v68,s87,-v12
v_exp_f32 v60,v60
v_exp_f32 v61,v61
v_exp_f32 v62,v62
v_exp_f32 v63,v63
v_exp_f32 v68,v68
v_cvt_pk_bf16_f32 v34,v60,v61
v_cvt_pk_bf16_f32 v35,v62,v63
v_cndmask_b32 v30,v34,v15,vcc
v_cndmask_b32 v31,v35,v15,vcc
v_cndmask_b32_dpp v28,v34,v15,vcc quad_perm:[2,3,0,1] row_mask:0xf bank_mask:0xf
v_cndmask_b32_dpp v29,v35,v15,vcc quad_perm:[2,3,0,1] row_mask:0xf bank_mask:0xf
s_mov_b64 vcc,s[90:91]
s_waitcnt lgkmcnt(0)
v_cndmask_b32 v24,v34,v15,vcc
v_mfma_f32_16x16x32_bf16 v[36:39],v[92:95],v[28:31],0
v_cndmask_b32 v25,v35,v15,vcc
v_cndmask_b32_dpp v26,v34,v15,vcc quad_perm:[2,3,0,1] row_mask:0xf bank_mask:0xf
v_mfma_f32_16x16x32_bf16 v[40:43],v[100:103],v[28:31],0
v_cndmask_b32_dpp v27,v35,v15,vcc quad_perm:[2,3,0,1] row_mask:0xf bank_mask:0xf
v_mov_b32_dpp v14,v68 quad_perm:[2,3,0,1] row_mask:0xf bank_mask:0xf
v_add_f32 v12,v60,v61
v_mfma_f32_16x16x32_bf16 v[36:39],v[88:91],v[24:27],v[36:39]
v_cvt_pk_bf16_f32 v32,v68,v14
v_cvt_pk_bf16_f32 v33,v14,v68
v_mfma_f32_16x16x32_bf16 v[40:43],v[96:99],v[24:27],v[40:43]
v_cndmask_b32 v32,v32,v15,vcc
v_cndmask_b32 v33,v15,v33,vcc
ds_read_b32 v10,v9
s_waitcnt vmcnt(1)
v_bitop3_b32 v17,v104,v106,s57 bitop3:0x7e
v_add_f32 v13,v62,v63
v_and_b32 v17,1,v17
v_add_f32 v12,v12,v68
v_cmp_ne_u32 vcc,0,v17
v_add_f32 v12,v12,v13
s_cbranch_vccnz vb_101
vo_102:
v_mfma_f32_16x16x16_bf16 v[36:39],v[104:105],v[32:33],v[36:39]
v_add_f32_dpp v13,v12,v12 quad_perm:[2,3,0,1] row_mask:0xf bank_mask:0xf
v_add_f32_dpp v12,v12,v12 quad_perm:[2,3,0,1] row_mask:0xf bank_mask:0xf
v_mfma_f32_16x16x16_bf16 v[40:43],v[106:107],v[32:33],v[40:43]
s_nop 0
v_permlane32_swap_b32 v12,v13
v_add_f32 v64,v12,v13
v_add_f32 v12,v12,v13
s_add_u32 s50,s50,1
s_mov_b32 s51,s53
v_permlane16_swap_b32 v12,v64
v_add_f32 v12,v12,v64
v_rcp_f32 v12,v12
s_mov_b32 s52,s54
v_pk_mul_f32 v[36:37],v[36:37],v[12:13] op_sel_hi:[1,0]
v_pk_mul_f32 v[38:39],v[38:39],v[12:13] op_sel_hi:[1,0]
v_pk_mul_f32 v[40:41],v[40:41],v[12:13] op_sel_hi:[1,0]
v_pk_mul_f32 v[42:43],v[42:43],v[12:13] op_sel_hi:[1,0]
v_cvt_pk_bf16_f32 v48,v36,v37
v_cvt_pk_bf16_f32 v49,v38,v39
v_cvt_pk_bf16_f32 v50,v40,v41
v_cvt_pk_bf16_f32 v51,v42,v43
v_and_or_b32 v48,v48,-2,s57
buffer_store_dwordx4 v[48:51],v8,s[8:11],s70 offen sc1
s_mov_b32 s57,s31
s_mov_b32 s58,s32
s_waitcnt lgkmcnt(0)
v_cmp_ne_u32 vcc,s50,v10
v_mov_b32 v12,s50
ds_write_b32 v20,v12
s_branch CS_LOOP_S
last_100:
s_waitcnt lgkmcnt(0)
s_barrier
s_add_u32 s50,s50,1
s_mov_b32 s51,s53
s_mov_b32 s52,s54
s_mov_b32 s57,s31
s_mov_b32 s58,s32
s_mov_b64 vcc,-1
s_waitcnt vmcnt(0)
v_mov_b32 v12,s50
ds_write_b32 v20,v12
s_cmp_lt_u32 s50,128
s_cbranch_scc1 CS_LOOP_S
s_branch CS_DONE
fr_98:
v_bitop3_b32 v12,v60,v64,s57 bitop3:0x7e
v_bitop3_b32 v13,v68,v72,s57 bitop3:0x7e
v_xor_b32 v14,s57,v76
v_or3_b32 v12,v12,v13,v14
v_and_b32 v12,1,v12
v_cmp_ne_u32 vcc,0,v12
s_cbranch_vccz sk_103
buffer_load_dwordx4 v[76:79],v18,s[8:11],s59 offen sc1
buffer_load_dwordx4 v[60:63],v1,s[8:11],s59 offen sc1
buffer_load_dwordx4 v[64:67],v1,s[8:11],s59 offen offset:1024 sc1
buffer_load_dwordx4 v[68:71],v1,s[8:11],s59 offen offset:2048 sc1
buffer_load_dwordx4 v[72:75],v1,s[8:11],s59 offen offset:3072 sc1
sk_103:
buffer_load_dwordx4 v[96:99],v18,s[8:11],s68 offen sc1
buffer_load_dwordx4 v[80:83],v1,s[8:11],s68 offen sc1
buffer_load_dwordx4 v[84:87],v1,s[8:11],s68 offen offset:1024 sc1
buffer_load_dwordx4 v[88:91],v1,s[8:11],s68 offen offset:2048 sc1
buffer_load_dwordx4 v[92:95],v1,s[8:11],s68 offen offset:3072 sc1
s_sub_u32 s47,s47,1
s_cbranch_scc1 ABORT
s_waitcnt lgkmcnt(0)
s_branch fa_97
CS_FAST_S:
buffer_load_dwordx4 v[96:99],v18,s[8:11],s68 offen sc1
buffer_load_dwordx4 v[80:83],v1,s[8:11],s68 offen sc1
buffer_load_dwordx4 v[84:87],v1,s[8:11],s68 offen offset:1024 sc1
buffer_load_dwordx4 v[88:91],v1,s[8:11],s68 offen offset:2048 sc1
buffer_load_dwordx4 v[92:95],v1,s[8:11],s68 offen offset:3072 sc1
v_mov_b32 v24,0
v_mov_b32 v25,0
v_mov_b32 v26,0
v_mov_b32 v27,0
v_mov_b32 v28,0
v_mov_b32 v29,0
v_mov_b32 v30,0
v_mov_b32 v31,0
v_mov_b32 v32,0
v_mov_b32 v33,0
v_mov_b32 v34,0
v_mov_b32 v35,0
v_mov_b32 v36,0
v_mov_b32 v37,0
v_mov_b32 v38,0
v_mov_b32 v39,0
v_mov_b32 v40,0
v_mov_b32 v41,0
v_mov_b32 v42,0
v_mov_b32 v43,0
v_mov_b32 v44,0
v_mov_b32 v45,0
v_mov_b32 v46,0
v_mov_b32 v47,0
s_nop 0
s_branch fj_99
vb_101:
s_sub_u32 s47,s47,1
s_cbranch_scc1 ABORT
buffer_load_dwordx4 v[104:107],v1,s[8:11],s71 offen sc1
s_waitcnt vmcnt(0)
v_bitop3_b32 v17,v104,v106,s57 bitop3:0x7e
v_and_b32 v17,1,v17
v_cmp_ne_u32 vcc,0,v17
s_nop 0
s_cbranch_vccnz vb_101
s_branch vo_102
CH_START:
s_sub_u32 s60,s4,s5
s_cmp_gt_i32 s60,13
s_cselect_b32 s53,1,0
s_cmp_eq_u32 s4,64
s_cselect_b32 s53,1,s53
s_cmp_eq_u32 s53,0
s_cselect_b32 s54,s4,s5
s_addc_u32 s4,s4,0
s_add_u32 s5,s5,s53
s_sub_u32 s60,s4,s5
s_cmp_gt_i32 s60,13
s_cselect_b32 s55,1,0
s_cmp_eq_u32 s4,64
s_cselect_b32 s55,1,s55
s_cmp_eq_u32 s55,0
s_cselect_b32 s56,s4,s5
s_addc_u32 s4,s4,0
s_add_u32 s5,s5,s55
s_mov_b32 s74,81920
s_mul_i32 s73,s52,393216
s_add_u32 s73,s73,s84
s_lshl_b32 s75,s51,6
s_add_u32 s75,s75,s52
s_lshl_b32 s75,s75,9
s_add_u32 s75,s75,131072
fl_104:
buffer_load_dword v12,v9,s[8:11],s75 offen sc1
s_waitcnt vmcnt(0)
v_cmp_eq_u32 vcc,0,v12
s_nop 0
s_cbranch_vccz ok_105
s_sleep 1
s_sub_u32 s47,s47,1
s_cbranch_scc1 ABORT
s_branch fl_104
ok_105:
s_add_u32 m0,s74,0
s_add_u32 s67,s73,0
buffer_load_dwordx4 v1,s[8:11],s67 offen sc1 lds
buffer_load_dwordx4 v1,s[8:11],s67 offen offset:1024 sc1 lds
buffer_load_dwordx4 v1,s[8:11],s67 offen offset:2048 sc1 lds
buffer_load_dwordx4 v1,s[8:11],s67 offen offset:3072 sc1 lds
s_add_u32 m0,s74,4096
s_add_u32 s67,s73,4096
buffer_load_dwordx4 v1,s[8:11],s67 offen sc1 lds
buffer_load_dwordx4 v1,s[8:11],s67 offen offset:1024 sc1 lds
buffer_load_dwordx4 v1,s[8:11],s67 offen offset:2048 sc1 lds
buffer_load_dwordx4 v1,s[8:11],s67 offen offset:3072 sc1 lds
s_add_u32 m0,s74,8192
s_add_u32 s67,s73,8192
buffer_load_dwordx4 v1,s[8:11],s67 offen sc1 lds
buffer_load_dwordx4 v1,s[8:11],s67 offen offset:1024 sc1 lds
buffer_load_dwordx4 v1,s[8:11],s67 offen offset:2048 sc1 lds
buffer_load_dwordx4 v1,s[8:11],s67 offen offset:3072 sc1 lds
s_add_u32 m0,s74,12288
s_add_u32 s67,s73,25165824
buffer_load_dwordx4 v1,s[8:11],s67 offen sc1 lds
buffer_load_dwordx4 v1,s[8:11],s67 offen offset:1024 sc1 lds
buffer_load_dwordx4 v1,s[8:11],s67 offen offset:2048 sc1 lds
buffer_load_dwordx4 v1,s[8:11],s67 offen offset:3072 sc1 lds
s_add_u32 m0,s74,16384
s_add_u32 s67,s73,25169920
buffer_load_dwordx4 v1,s[8:11],s67 offen sc1 lds
buffer_load_dwordx4 v1,s[8:11],s67 offen offset:1024 sc1 lds
buffer_load_dwordx4 v1,s[8:11],s67 offen offset:2048 sc1 lds
buffer_load_dwordx4 v1,s[8:11],s67 offen offset:3072 sc1 lds
s_add_u32 m0,s74,20480
s_add_u32 s67,s73,25174016
buffer_load_dwordx4 v1,s[8:11],s67 offen sc1 lds
buffer_load_dwordx4 v1,s[8:11],s67 offen offset:1024 sc1 lds
buffer_load_dwordx4 v1,s[8:11],s67 offen offset:2048 sc1 lds
buffer_load_dwordx4 v1,s[8:11],s67 offen offset:3072 sc1 lds
s_mov_b32 s74,106496
s_mul_i32 s73,s54,393216
s_add_u32 s73,s73,s84
s_lshl_b32 s75,s53,6
s_add_u32 s75,s75,s54
s_lshl_b32 s75,s75,9
s_add_u32 s75,s75,131072
s_lshl_b32 s76,s55,6
s_add_u32 s76,s76,s56
s_lshl_b32 s76,s76,9
s_add_u32 s76,s76,131072
s_mov_b32 s77,1
v_min_u32 v8,2,v0
v_lshlrev_b32 v8,2,v8
v_add_u32 v8,147456,v8
v_mov_b32 v58,147468
s_nop 1
CH_LOOP:
v_mov_b32 v24,0
v_mov_b32 v25,0
v_mov_b32 v26,0
v_mov_b32 v27,0
v_mov_b32 v28,0
v_mov_b32 v29,0
v_mov_b32 v30,0
v_mov_b32 v31,0
v_mov_b32 v32,0
v_mov_b32 v33,0
v_mov_b32 v34,0
v_mov_b32 v35,0
v_mov_b32 v36,0
v_mov_b32 v37,0
v_mov_b32 v38,0
v_mov_b32 v39,0
v_mov_b32 v40,0
v_mov_b32 v41,0
v_mov_b32 v42,0
v_mov_b32 v43,0
v_mov_b32 v44,0
v_mov_b32 v45,0
v_mov_b32 v46,0
v_mov_b32 v47,0
v_mov_b32 v14,s50
s_nop 1
db_109:
buffer_load_dword v12,v11,s[8:11],s69 offen sc1
s_waitcnt vmcnt(0)
v_cmp_gt_u32 vcc,s58,v12
s_cbranch_vccz dbok_110
s_sub_u32 s47,s47,1
s_cbranch_scc1 ABORT
s_branch db_109
dbok_110:
ds_write_b32 v58,v14
buffer_load_dwordx4 v[76:79],v18,s[8:11],s59 offen sc1
buffer_load_dwordx4 v[60:63],v1,s[8:11],s59 offen sc1
buffer_load_dwordx4 v[64:67],v1,s[8:11],s59 offen offset:1024 sc1
buffer_load_dwordx4 v[68:71],v1,s[8:11],s59 offen offset:2048 sc1
buffer_load_dwordx4 v[72:75],v1,s[8:11],s59 offen offset:3072 sc1
s_barrier
s_waitcnt vmcnt(4)
buffer_load_dwordx4 v[96:99],v18,s[8:11],s68 offen sc1
buffer_load_dwordx4 v[80:83],v1,s[8:11],s68 offen sc1
buffer_load_dwordx4 v[84:87],v1,s[8:11],s68 offen offset:1024 sc1
buffer_load_dwordx4 v[88:91],v1,s[8:11],s68 offen offset:2048 sc1
buffer_load_dwordx4 v[92:95],v1,s[8:11],s68 offen offset:3072 sc1
fj_108:
fa_106:
s_waitcnt vmcnt(4)
v_pk_add_f32 v[12:13],v[76:77],v[96:97]
v_pk_add_f32 v[14:15],v[78:79],v[98:99]
v_bitop3_b32 v16,v76,v96,s57 bitop3:0x7e
v_cvt_pk_bf16_f32 v56,v12,v13
v_cvt_pk_bf16_f32 v57,v14,v15
ds_write_b64 v23,v[56:57]
s_waitcnt vmcnt(3)
v_pk_add_f32 v[12:13],v[60:61],v[80:81]
v_pk_add_f32 v[14:15],v[62:63],v[82:83]
v_bitop3_b32 v17,v60,v80,s57 bitop3:0x7e
v_cvt_pk_bf16_f32 v48,v12,v13
v_cvt_pk_bf16_f32 v49,v14,v15
v_or_b32 v16,v16,v17
s_waitcnt vmcnt(2)
v_pk_add_f32 v[12:13],v[64:65],v[84:85]
v_pk_add_f32 v[14:15],v[66:67],v[86:87]
v_bitop3_b32 v17,v64,v84,s57 bitop3:0x7e
v_cvt_pk_bf16_f32 v50,v12,v13
v_cvt_pk_bf16_f32 v51,v14,v15
v_or_b32 v16,v16,v17
ds_write_b128 v22,v[48:51] offset:0
s_waitcnt vmcnt(1)
v_pk_add_f32 v[12:13],v[68:69],v[88:89]
v_pk_add_f32 v[14:15],v[70:71],v[90:91]
v_bitop3_b32 v17,v68,v88,s57 bitop3:0x7e
v_cvt_pk_bf16_f32 v52,v12,v13
v_cvt_pk_bf16_f32 v53,v14,v15
v_or_b32 v16,v16,v17
s_waitcnt vmcnt(0)
v_pk_add_f32 v[12:13],v[72:73],v[92:93]
v_pk_add_f32 v[14:15],v[74:75],v[94:95]
v_bitop3_b32 v17,v72,v92,s57 bitop3:0x7e
v_cvt_pk_bf16_f32 v54,v12,v13
v_cvt_pk_bf16_f32 v55,v14,v15
v_bitop3_b32 v16,v16,v17,1 bitop3:0xa8
v_cmp_ne_u32 vcc,0,v16
ds_write_b128 v22,v[52:55] offset:1024
s_cbranch_vccnz fr_107
v_smfmac_f32_16x16x64_bf16 v[24:27],v[48:51],a[0:7],v2
ds_read_b128 v[72:75],v21 offset:0
v_smfmac_f32_16x16x64_bf16 v[28:31],v[48:51],a[8:15],v2
ds_read_b128 v[76:79],v21 offset:1024
v_smfmac_f32_16x16x64_bf16 v[32:35],v[48:51],a[16:23],v2
ds_read_b128 v[80:83],v21 offset:2048
v_smfmac_f32_16x16x64_bf16 v[36:39],v[48:51],a[24:31],v2
ds_read_b128 v[84:87],v21 offset:3072
s_waitcnt lgkmcnt(4)
s_barrier
v_smfmac_f32_16x16x64_bf16 v[40:43],v[48:51],a[32:39],v2
ds_read_b128 v[60:63],v3 offset:0
v_smfmac_f32_16x16x64_bf16 v[24:27],v[52:55],a[40:47],v2
ds_read_b128 v[64:67],v3 offset:1024
v_smfmac_f32_16x16x64_bf16 v[28:31],v[52:55],a[48:55],v2
ds_read_b128 v[68:71],v4 offset:0
v_smfmac_f32_16x16x64_bf16 v[32:35],v[52:55],a[56:63],v2
s_add_u32 m0,s74,12288
s_add_u32 s67,s73,25165824
v_smfmac_f32_16x16x64_bf16 v[36:39],v[52:55],a[64:71],v2
buffer_load_dwordx4 v1,s[8:11],s67 offen sc1 lds
v_smfmac_f32_16x16x64_bf16 v[40:43],v[52:55],a[72:79],v2
buffer_load_dwordx4 v1,s[8:11],s67 offen offset:1024 sc1 lds
s_waitcnt lgkmcnt(5)
v_smfmac_f32_16x16x64_bf16 v[44:47],v[48:51],v[72:79],v2
ds_read_b128 v[72:75],v21 offset:4096
s_waitcnt lgkmcnt(4)
v_smfmac_f32_16x16x64_bf16 v[44:47],v[52:55],v[80:87],v2
ds_read_b128 v[76:79],v21 offset:5120
s_waitcnt lgkmcnt(4)
v_smfmac_f32_16x16x64_bf16 v[24:27],v[60:63],a[80:87],v2
ds_read_b128 v[80:83],v21 offset:6144
v_smfmac_f32_16x16x64_bf16 v[28:31],v[60:63],a[88:95],v2
ds_read_b128 v[84:87],v21 offset:7168
v_smfmac_f32_16x16x64_bf16 v[32:35],v[60:63],a[96:103],v2
buffer_load_dwordx4 v1,s[8:11],s67 offen offset:2048 sc1 lds
v_smfmac_f32_16x16x64_bf16 v[36:39],v[60:63],a[104:111],v2
buffer_load_dwordx4 v1,s[8:11],s67 offen offset:3072 sc1 lds
v_smfmac_f32_16x16x64_bf16 v[40:43],v[60:63],a[112:119],v2
s_add_u32 m0,s74,16384
s_add_u32 s67,s73,25169920
s_waitcnt lgkmcnt(2)
v_smfmac_f32_16x16x64_bf16 v[44:47],v[60:63],v[72:79],v2
ds_read_b128 v[60:63],v4 offset:1024
v_smfmac_f32_16x16x64_bf16 v[24:27],v[64:67],a[120:127],v2
ds_read_b128 v[72:75],v21 offset:8192
v_smfmac_f32_16x16x64_bf16 v[28:31],v[64:67],a[128:135],v2
ds_read_b128 v[76:79],v21 offset:9216
v_smfmac_f32_16x16x64_bf16 v[32:35],v[64:67],a[136:143],v2
buffer_load_dwordx4 v1,s[8:11],s67 offen sc1 lds
v_smfmac_f32_16x16x64_bf16 v[36:39],v[64:67],a[144:151],v2
buffer_load_dwordx4 v1,s[8:11],s67 offen offset:1024 sc1 lds
v_smfmac_f32_16x16x64_bf16 v[40:43],v[64:67],a[152:159],v2
buffer_load_dwordx4 v1,s[8:11],s67 offen offset:2048 sc1 lds
s_waitcnt lgkmcnt(3)
v_smfmac_f32_16x16x64_bf16 v[44:47],v[64:67],v[80:87],v2
ds_read_b128 v[64:67],v5 offset:0
v_smfmac_f32_16x16x64_bf16 v[24:27],v[68:71],a[160:167],v2
ds_read_b128 v[80:83],v21 offset:10240
v_smfmac_f32_16x16x64_bf16 v[28:31],v[68:71],a[168:175],v2
ds_read_b128 v[84:87],v21 offset:11264
v_smfmac_f32_16x16x64_bf16 v[32:35],v[68:71],a[176:183],v2
buffer_load_dwordx4 v1,s[8:11],s67 offen offset:3072 sc1 lds
v_smfmac_f32_16x16x64_bf16 v[36:39],v[68:71],a[184:191],v2
s_add_u32 m0,s74,20480
s_add_u32 s67,s73,25174016
v_smfmac_f32_16x16x64_bf16 v[40:43],v[68:71],a[192:199],v2
buffer_load_dwordx4 v1,s[8:11],s67 offen sc1 lds
s_waitcnt lgkmcnt(3)
v_smfmac_f32_16x16x64_bf16 v[44:47],v[68:71],v[72:79],v2
ds_read_b128 v[68:71],v5 offset:1024
v_smfmac_f32_16x16x64_bf16 v[24:27],v[60:63],a[200:207],v2
ds_read_b128 v[72:75],v21 offset:12288
v_smfmac_f32_16x16x64_bf16 v[28:31],v[60:63],a[208:215],v2
ds_read_b128 v[76:79],v21 offset:13312
v_smfmac_f32_16x16x64_bf16 v[32:35],v[60:63],a[216:223],v2
buffer_load_dwordx4 v1,s[8:11],s67 offen offset:1024 sc1 lds
v_smfmac_f32_16x16x64_bf16 v[36:39],v[60:63],a[224:231],v2
buffer_load_dwordx4 v1,s[8:11],s67 offen offset:2048 sc1 lds
v_smfmac_f32_16x16x64_bf16 v[40:43],v[60:63],a[232:239],v2
buffer_load_dwordx4 v1,s[8:11],s67 offen offset:3072 sc1 lds
s_waitcnt lgkmcnt(3)
v_smfmac_f32_16x16x64_bf16 v[44:47],v[60:63],v[80:87],v2
ds_read_b128 v[60:63],v59 offset:0
v_smfmac_f32_16x16x64_bf16 v[24:27],v[64:67],a[240:247],v2
ds_read_b128 v[80:83],v21 offset:14336
v_smfmac_f32_16x16x64_bf16 v[28:31],v[64:67],a[248:255],v2
ds_read_b128 v[84:87],v21 offset:15360
v_smfmac_f32_16x16x64_bf16 v[32:35],v[64:67],v[112:119],v2
s_cmp_eq_u32 s79,-1
s_cbranch_scc1 pf_111
v_mov_b32 v17,1
s_mov_b64 exec,1
buffer_store_dword v17,v1,s[8:11],s79 offen sc1
s_mov_b64 exec,-1
s_mov_b32 s79,-1
pf_111:
v_smfmac_f32_16x16x64_bf16 v[36:39],v[64:67],v[120:127],v2
s_cmp_eq_u32 s78,-1
s_cbranch_scc1 pk_112
buffer_store_dwordx4 v[100:103],v20,s[8:11],s78 offen sc1
buffer_store_dwordx4 v[104:107],v20,s[8:11],s78 offen offset:1024 sc1
buffer_store_dwordx4 v[108:111],v20,s[8:11],s78 offen offset:2048 sc1
s_mov_b32 s79,s30
s_mov_b32 s78,-1
pk_112:
v_smfmac_f32_16x16x64_bf16 v[40:43],v[64:67],v[128:135],v2
buffer_load_dword v10,v9,s[8:11],s76 offen sc1
s_waitcnt lgkmcnt(3)
v_smfmac_f32_16x16x64_bf16 v[44:47],v[64:67],v[72:79],v2
ds_read_b128 v[64:67],v59 offset:1024
v_smfmac_f32_16x16x64_bf16 v[24:27],v[68:71],v[136:143],v2
ds_read_b128 v[72:75],v21 offset:16384
v_smfmac_f32_16x16x64_bf16 v[28:31],v[68:71],v[144:151],v2
ds_read_b128 v[76:79],v21 offset:17408
v_smfmac_f32_16x16x64_bf16 v[32:35],v[68:71],v[152:159],v2
v_smfmac_f32_16x16x64_bf16 v[36:39],v[68:71],v[160:167],v2
v_smfmac_f32_16x16x64_bf16 v[40:43],v[68:71],v[168:175],v2
s_waitcnt lgkmcnt(3)
v_smfmac_f32_16x16x64_bf16 v[44:47],v[68:71],v[80:87],v2
ds_read_b128 v[80:83],v21 offset:18432
v_smfmac_f32_16x16x64_bf16 v[24:27],v[60:63],v[176:183],v2
ds_read_b128 v[84:87],v21 offset:19456
v_smfmac_f32_16x16x64_bf16 v[36:39],v[60:63],v[200:207],v2
s_waitcnt lgkmcnt(4)
v_smfmac_f32_16x16x64_bf16 v[24:27],v[64:67],v[216:223],v2
v_smfmac_f32_16x16x64_bf16 v[36:39],v[64:67],v[240:247],v2
v_smfmac_f32_16x16x64_bf16 v[28:31],v[60:63],v[184:191],v2
v_smfmac_f32_16x16x64_bf16 v[40:43],v[60:63],v[208:215],v2
s_nop 4
v_add_f32 v24,v24,v25
v_smfmac_f32_16x16x64_bf16 v[28:31],v[64:67],v[224:231],v2
v_add_f32 v26,v26,v27
v_smfmac_f32_16x16x64_bf16 v[40:43],v[64:67],v[248:255],v2
v_add_f32 v36,v36,v37
v_smfmac_f32_16x16x64_bf16 v[32:35],v[60:63],v[192:199],v2
v_add_f32 v38,v38,v39
s_waitcnt lgkmcnt(2)
v_smfmac_f32_16x16x64_bf16 v[44:47],v[60:63],v[72:79],v2
v_cvt_pk_bf16_f32 v37,v24,v26
v_smfmac_f32_16x16x64_bf16 v[32:35],v[64:67],v[232:239],v2
v_cvt_pk_bf16_f32 v36,v36,v38
s_waitcnt lgkmcnt(0)
v_smfmac_f32_16x16x64_bf16 v[44:47],v[64:67],v[80:87],v2
ds_write_b64 v6,v[36:37] offset:0
v_add_f32 v28,v28,v29
v_add_f32 v30,v30,v31
v_add_f32 v40,v40,v41
v_add_f32 v42,v42,v43
v_cvt_pk_bf16_f32 v41,v28,v30
v_cvt_pk_bf16_f32 v40,v40,v42
ds_write_b64 v6,v[40:41] offset:512
v_add_f32 v32,v32,v33
v_add_f32 v34,v34,v35
v_add_f32 v44,v44,v45
v_add_f32 v46,v46,v47
v_cvt_pk_bf16_f32 v45,v32,v34
v_cvt_pk_bf16_f32 v44,v44,v46
ds_write_b64 v6,v[44:45] offset:1024
s_waitcnt lgkmcnt(0)
s_barrier
ds_read_b64_tr_b16 v[24:25],v7 offset:0
ds_read_b64_tr_b16 v[26:27],v7 offset:512
ds_read_b64_tr_b16 v[28:29],v7 offset:1024
ds_read_b64_tr_b16 v[30:31],v7 offset:1536
ds_read_b64_tr_b16 v[32:33],v7 offset:2048
ds_read_b64_tr_b16 v[34:35],v7 offset:2560
ds_read_b64_tr_b16 v[36:37],v7 offset:3072
ds_read_b64_tr_b16 v[38:39],v7 offset:3584
ds_read_b64_tr_b16 v[40:41],v7 offset:4096
ds_read_b64_tr_b16 v[42:43],v7 offset:4608
ds_read_b64_tr_b16 v[44:45],v7 offset:5120
ds_read_b64_tr_b16 v[46:47],v7 offset:5632
s_lshl_b32 s60,s51,6
s_add_u32 s60,s60,s52
s_mul_i32 s78,s60,196608
s_add_u32 s78,s78,s85
s_lshl_b32 s60,s60,10
s_add_u32 s30,s60,s86
s_and_b32 s60,s54,1
s_lshl2_add_u32 s60,s53,s60
s_lshl_b32 s68,s60,16
s_add_u32 s68,s68,s83
s_mul_i32 s59,s60,20480
s_add_u32 s59,s59,s6
s_lshl_b32 s69,s53,9
s_add_u32 s69,s69,s7
s_bfe_u32 s31,s54,65537
s_add_u32 s32,s54,1
s_mov_b64 vcc,s[90:91]
s_waitcnt lgkmcnt(0)
v_cndmask_b32_dpp v100,v28,v24,vcc quad_perm:[0,1,0,1] row_mask:0xf bank_mask:0xf
v_cndmask_b32_dpp v101,v29,v25,vcc quad_perm:[0,1,0,1] row_mask:0xf bank_mask:0xf
v_cndmask_b32_dpp v102,v30,v26,vcc quad_perm:[0,1,0,1] row_mask:0xf bank_mask:0xf
v_cndmask_b32_dpp v103,v31,v27,vcc quad_perm:[0,1,0,1] row_mask:0xf bank_mask:0xf
v_cndmask_b32_dpp v104,v36,v32,vcc quad_perm:[0,1,0,1] row_mask:0xf bank_mask:0xf
v_cndmask_b32_dpp v105,v37,v33,vcc quad_perm:[0,1,0,1] row_mask:0xf bank_mask:0xf
v_cndmask_b32_dpp v106,v38,v34,vcc quad_perm:[0,1,0,1] row_mask:0xf bank_mask:0xf
v_cndmask_b32_dpp v107,v39,v35,vcc quad_perm:[0,1,0,1] row_mask:0xf bank_mask:0xf
v_cndmask_b32_dpp v108,v44,v40,vcc quad_perm:[0,1,0,1] row_mask:0xf bank_mask:0xf
v_cndmask_b32_dpp v109,v45,v41,vcc quad_perm:[0,1,0,1] row_mask:0xf bank_mask:0xf
v_cndmask_b32_dpp v110,v46,v42,vcc quad_perm:[0,1,0,1] row_mask:0xf bank_mask:0xf
v_cndmask_b32_dpp v111,v47,v43,vcc quad_perm:[0,1,0,1] row_mask:0xf bank_mask:0xf
s_cmp_ge_u32 s54,63
s_cselect_b32 s77,0,s77
s_cmp_eq_u32 s53,s51
s_cselect_b32 s60,1,s77
s_cmp_eq_u32 s60,0
s_cbranch_scc1 nd_114
sp_115:
ds_read_b32 v12,v8
s_waitcnt lgkmcnt(0)
v_cmp_ge_u32 vcc,s50,v12
s_nop 0
s_cbranch_vccz ok_116
s_sleep 1
s_sub_u32 s47,s47,1
s_cbranch_scc1 ABORT
s_branch sp_115
ok_116:
s_waitcnt vmcnt(0)
s_cmp_eq_u32 s79,-1
s_cbranch_scc1 pf_117
v_mov_b32 v17,1
s_mov_b64 exec,1
buffer_store_dword v17,v1,s[8:11],s79 offen sc1
s_mov_b64 exec,-1
s_mov_b32 s79,-1
pf_117:
s_cmp_eq_u32 s78,-1
s_cbranch_scc1 pk_118
buffer_store_dwordx4 v[100:103],v20,s[8:11],s78 offen sc1
buffer_store_dwordx4 v[104:107],v20,s[8:11],s78 offen offset:1024 sc1
buffer_store_dwordx4 v[108:111],v20,s[8:11],s78 offen offset:2048 sc1
s_mov_b32 s79,s30
s_mov_b32 s78,-1
pk_118:
s_waitcnt vmcnt(0)
s_cmp_eq_u32 s79,-1
s_cbranch_scc1 pf_119
v_mov_b32 v17,1
s_mov_b64 exec,1
buffer_store_dword v17,v1,s[8:11],s79 offen sc1
s_mov_b64 exec,-1
s_mov_b32 s79,-1
pf_119:
nx_113:
s_cmp_eq_u32 s77,0
s_cbranch_scc1 nd_114
fl_120:
buffer_load_dword v12,v9,s[8:11],s75 offen sc1
s_waitcnt vmcnt(0)
v_cmp_eq_u32 vcc,0,v12
s_nop 0
s_cbranch_vccz ok_121
s_sleep 1
s_sub_u32 s47,s47,1
s_cbranch_scc1 ABORT
s_branch fl_120
ok_121:
s_add_u32 m0,s74,0
s_add_u32 s67,s73,0
buffer_load_dwordx4 v1,s[8:11],s67 offen sc1 lds
buffer_load_dwordx4 v1,s[8:11],s67 offen offset:1024 sc1 lds
buffer_load_dwordx4 v1,s[8:11],s67 offen offset:2048 sc1 lds
buffer_load_dwordx4 v1,s[8:11],s67 offen offset:3072 sc1 lds
s_add_u32 m0,s74,4096
s_add_u32 s67,s73,4096
buffer_load_dwordx4 v1,s[8:11],s67 offen sc1 lds
buffer_load_dwordx4 v1,s[8:11],s67 offen offset:1024 sc1 lds
buffer_load_dwordx4 v1,s[8:11],s67 offen offset:2048 sc1 lds
buffer_load_dwordx4 v1,s[8:11],s67 offen offset:3072 sc1 lds
s_add_u32 m0,s74,8192
s_add_u32 s67,s73,8192
buffer_load_dwordx4 v1,s[8:11],s67 offen sc1 lds
buffer_load_dwordx4 v1,s[8:11],s67 offen offset:1024 sc1 lds
buffer_load_dwordx4 v1,s[8:11],s67 offen offset:2048 sc1 lds
buffer_load_dwordx4 v1,s[8:11],s67 offen offset:3072 sc1 lds
s_add_u32 m0,s74,12288
s_add_u32 s67,s73,25165824
buffer_load_dwordx4 v1,s[8:11],s67 offen sc1 lds
buffer_load_dwordx4 v1,s[8:11],s67 offen offset:1024 sc1 lds
buffer_load_dwordx4 v1,s[8:11],s67 offen offset:2048 sc1 lds
buffer_load_dwordx4 v1,s[8:11],s67 offen offset:3072 sc1 lds
s_add_u32 m0,s74,16384
s_add_u32 s67,s73,25169920
buffer_load_dwordx4 v1,s[8:11],s67 offen sc1 lds
buffer_load_dwordx4 v1,s[8:11],s67 offen offset:1024 sc1 lds
buffer_load_dwordx4 v1,s[8:11],s67 offen offset:2048 sc1 lds
buffer_load_dwordx4 v1,s[8:11],s67 offen offset:3072 sc1 lds
s_add_u32 m0,s74,20480
s_add_u32 s67,s73,25174016
buffer_load_dwordx4 v1,s[8:11],s67 offen sc1 lds
buffer_load_dwordx4 v1,s[8:11],s67 offen offset:1024 sc1 lds
buffer_load_dwordx4 v1,s[8:11],s67 offen offset:2048 sc1 lds
buffer_load_dwordx4 v1,s[8:11],s67 offen offset:3072 sc1 lds
nd_114:
s_add_u32 s50,s50,1
s_mov_b32 s51,s53
s_mov_b32 s52,s54
s_mov_b32 s57,s31
s_mov_b32 s58,s32
s_mov_b32 s53,s55
s_mov_b32 s54,s56
s_mov_b32 s75,s76
s_sub_u32 s60,s4,s5
s_cmp_gt_i32 s60,13
s_cselect_b32 s55,1,0
s_cmp_eq_u32 s4,64
s_cselect_b32 s55,1,s55
s_cmp_eq_u32 s55,0
s_cselect_b32 s56,s4,s5
s_addc_u32 s4,s4,0
s_add_u32 s5,s5,s55
s_lshl_b32 s76,s55,6
s_add_u32 s76,s76,s56
s_lshl_b32 s76,s76,9
s_add_u32 s76,s76,131072
s_mul_i32 s73,s54,393216
s_add_u32 s73,s73,s84
s_xor_b32 s74,s74,57344
s_waitcnt vmcnt(0)
v_cmp_eq_u32 vcc,0,v10
s_cmp_lg_u64 vcc,0
s_cselect_b32 s77,1,0
s_cmp_lt_u32 s50,128
s_cbranch_scc1 CH_LOOP
s_branch CS_DONE
fr_107:
v_bitop3_b32 v12,v60,v64,s57 bitop3:0x7e
v_bitop3_b32 v13,v68,v72,s57 bitop3:0x7e
v_xor_b32 v14,s57,v76
v_or3_b32 v12,v12,v13,v14
v_and_b32 v12,1,v12
v_cmp_ne_u32 vcc,0,v12
s_cbranch_vccz sk_122
buffer_load_dwordx4 v[76:79],v18,s[8:11],s59 offen sc1
buffer_load_dwordx4 v[60:63],v1,s[8:11],s59 offen sc1
buffer_load_dwordx4 v[64:67],v1,s[8:11],s59 offen offset:1024 sc1
buffer_load_dwordx4 v[68:71],v1,s[8:11],s59 offen offset:2048 sc1
buffer_load_dwordx4 v[72:75],v1,s[8:11],s59 offen offset:3072 sc1
sk_122:
buffer_load_dwordx4 v[96:99],v18,s[8:11],s68 offen sc1
buffer_load_dwordx4 v[80:83],v1,s[8:11],s68 offen sc1
buffer_load_dwordx4 v[84:87],v1,s[8:11],s68 offen offset:1024 sc1
buffer_load_dwordx4 v[88:91],v1,s[8:11],s68 offen offset:2048 sc1
buffer_load_dwordx4 v[92:95],v1,s[8:11],s68 offen offset:3072 sc1
s_sub_u32 s47,s47,1
s_cbranch_scc1 ABORT
s_waitcnt lgkmcnt(0)
s_branch fa_106
CS_DONE:
s_add_u32 s61,s48,0
s_endpgm
CV_START:
s_and_b32 s60,s46,1
s_lshl1_add_u32 s60,s49,s60
s_cmp_eq_u32 s60,1
s_cbranch_scc1 CV_LOOP_F1
s_cmp_eq_u32 s60,2
s_cbranch_scc1 CV_LOOP_S0
s_cmp_eq_u32 s60,3
s_cbranch_scc1 CV_LOOP_S1
CV_LOOP_F0:
v_mov_b32 v24,0
v_mov_b32 v25,0
v_mov_b32 v26,0
v_mov_b32 v27,0
v_mov_b32 v28,0
v_mov_b32 v29,0
v_mov_b32 v30,0
v_mov_b32 v31,0
v_mov_b32 v32,0
v_mov_b32 v33,0
v_mov_b32 v34,0
v_mov_b32 v35,0
v_mov_b32 v36,0
v_mov_b32 v37,0
v_mov_b32 v38,0
v_mov_b32 v39,0
v_mov_b32 v40,0
v_mov_b32 v41,0
v_mov_b32 v42,0
v_mov_b32 v43,0
v_mov_b32 v44,0
v_mov_b32 v45,0
v_mov_b32 v46,0
v_mov_b32 v47,0
s_cmp_lg_u32 s46,0
s_cbranch_scc1 np_126
db_127:
buffer_load_dword v12,v11,s[8:11],s69 offen sc1
s_waitcnt vmcnt(0)
v_cmp_gt_u32 vcc,s58,v12
s_cbranch_vccz dbok_128
s_sub_u32 s47,s47,1
s_cbranch_scc1 ABORT
s_branch db_127
dbok_128:
np_126:
s_barrier
buffer_load_dwordx4 v[76:79],v18,s[8:11],s59 offen sc1
buffer_load_dwordx4 v[60:63],v1,s[8:11],s59 offen sc1
buffer_load_dwordx4 v[64:67],v1,s[8:11],s59 offen offset:1024 sc1
buffer_load_dwordx4 v[68:71],v1,s[8:11],s59 offen offset:2048 sc1
buffer_load_dwordx4 v[72:75],v1,s[8:11],s59 offen offset:3072 sc1
s_waitcnt vmcnt(4)
buffer_load_dwordx4 v[96:99],v18,s[8:11],s68 offen sc1
buffer_load_dwordx4 v[80:83],v1,s[8:11],s68 offen sc1
buffer_load_dwordx4 v[84:87],v1,s[8:11],s68 offen offset:1024 sc1
buffer_load_dwordx4 v[88:91],v1,s[8:11],s68 offen offset:2048 sc1
buffer_load_dwordx4 v[92:95],v1,s[8:11],s68 offen offset:3072 sc1
fj_125:
fa_123:
s_waitcnt vmcnt(4)
v_pk_add_f32 v[12:13],v[76:77],v[96:97]
v_pk_add_f32 v[14:15],v[78:79],v[98:99]
v_bitop3_b32 v16,v76,v96,s57 bitop3:0x7e
v_cvt_pk_bf16_f32 v56,v12,v13
v_cvt_pk_bf16_f32 v57,v14,v15
ds_write_b64 v23,v[56:57]
s_waitcnt vmcnt(3)
v_pk_add_f32 v[12:13],v[60:61],v[80:81]
v_pk_add_f32 v[14:15],v[62:63],v[82:83]
v_bitop3_b32 v17,v60,v80,s57 bitop3:0x7e
v_cvt_pk_bf16_f32 v48,v12,v13
v_cvt_pk_bf16_f32 v49,v14,v15
v_or_b32 v16,v16,v17
s_waitcnt vmcnt(2)
v_pk_add_f32 v[12:13],v[64:65],v[84:85]
v_pk_add_f32 v[14:15],v[66:67],v[86:87]
v_bitop3_b32 v17,v64,v84,s57 bitop3:0x7e
v_cvt_pk_bf16_f32 v50,v12,v13
v_cvt_pk_bf16_f32 v51,v14,v15
v_or_b32 v16,v16,v17
ds_write_b128 v22,v[48:51] offset:0
s_waitcnt vmcnt(1)
v_pk_add_f32 v[12:13],v[68:69],v[88:89]
v_pk_add_f32 v[14:15],v[70:71],v[90:91]
v_bitop3_b32 v17,v68,v88,s57 bitop3:0x7e
v_cvt_pk_bf16_f32 v52,v12,v13
v_cvt_pk_bf16_f32 v53,v14,v15
v_or_b32 v16,v16,v17
s_waitcnt vmcnt(0)
v_pk_add_f32 v[12:13],v[72:73],v[92:93]
v_pk_add_f32 v[14:15],v[74:75],v[94:95]
v_bitop3_b32 v17,v72,v92,s57 bitop3:0x7e
v_cvt_pk_bf16_f32 v54,v12,v13
v_cvt_pk_bf16_f32 v55,v14,v15
v_bitop3_b32 v16,v16,v17,1 bitop3:0xa8
v_cmp_ne_u32 vcc,0,v16
ds_write_b128 v22,v[52:55] offset:1024
s_cbranch_vccnz fr_124
v_smfmac_f32_16x16x64_bf16 v[24:27],v[48:51],a[0:7],v2
ds_read_b128 v[72:75],v21 offset:0
s_and_b32 s60,s52,1
v_smfmac_f32_16x16x64_bf16 v[28:31],v[48:51],a[8:15],v2
ds_read_b128 v[76:79],v21 offset:1024
s_lshl2_add_u32 s60,s51,s60
v_smfmac_f32_16x16x64_bf16 v[32:35],v[48:51],a[16:23],v2
ds_read_b128 v[80:83],v21 offset:2048
s_mul_i32 s60,s60,49152
v_smfmac_f32_16x16x64_bf16 v[36:39],v[48:51],a[24:31],v2
ds_read_b128 v[84:87],v21 offset:3072
s_add_u32 s71,s60,s34
s_waitcnt lgkmcnt(4)
s_barrier
v_smfmac_f32_16x16x64_bf16 v[40:43],v[48:51],a[32:39],v2
ds_read_b128 v[60:63],v3 offset:0
v_smfmac_f32_16x16x64_bf16 v[24:27],v[52:55],a[40:47],v2
ds_read_b128 v[64:67],v3 offset:1024
v_smfmac_f32_16x16x64_bf16 v[28:31],v[52:55],a[48:55],v2
ds_read_b128 v[68:71],v4 offset:0
v_smfmac_f32_16x16x64_bf16 v[32:35],v[52:55],a[56:63],v2
v_smfmac_f32_16x16x64_bf16 v[36:39],v[52:55],a[64:71],v2
v_smfmac_f32_16x16x64_bf16 v[40:43],v[52:55],a[72:79],v2
s_waitcnt lgkmcnt(5)
v_smfmac_f32_16x16x64_bf16 v[44:47],v[48:51],v[72:79],v2
ds_read_b128 v[72:75],v21 offset:4096
s_waitcnt lgkmcnt(4)
v_smfmac_f32_16x16x64_bf16 v[44:47],v[52:55],v[80:87],v2
ds_read_b128 v[76:79],v21 offset:5120
s_waitcnt lgkmcnt(4)
v_smfmac_f32_16x16x64_bf16 v[24:27],v[60:63],a[80:87],v2
ds_read_b128 v[80:83],v21 offset:6144
v_smfmac_f32_16x16x64_bf16 v[28:31],v[60:63],a[88:95],v2
ds_read_b128 v[84:87],v21 offset:7168
v_smfmac_f32_16x16x64_bf16 v[32:35],v[60:63],a[96:103],v2
v_smfmac_f32_16x16x64_bf16 v[36:39],v[60:63],a[104:111],v2
v_smfmac_f32_16x16x64_bf16 v[40:43],v[60:63],a[112:119],v2
s_waitcnt lgkmcnt(2)
v_smfmac_f32_16x16x64_bf16 v[44:47],v[60:63],v[72:79],v2
ds_read_b128 v[60:63],v4 offset:1024
v_smfmac_f32_16x16x64_bf16 v[24:27],v[64:67],a[120:127],v2
ds_read_b128 v[72:75],v21 offset:8192
v_smfmac_f32_16x16x64_bf16 v[28:31],v[64:67],a[128:135],v2
ds_read_b128 v[76:79],v21 offset:9216
v_smfmac_f32_16x16x64_bf16 v[32:35],v[64:67],a[136:143],v2
v_smfmac_f32_16x16x64_bf16 v[36:39],v[64:67],a[144:151],v2
v_smfmac_f32_16x16x64_bf16 v[40:43],v[64:67],a[152:159],v2
s_waitcnt lgkmcnt(3)
v_smfmac_f32_16x16x64_bf16 v[44:47],v[64:67],v[80:87],v2
ds_read_b128 v[64:67],v5 offset:0
v_smfmac_f32_16x16x64_bf16 v[24:27],v[68:71],a[160:167],v2
ds_read_b128 v[80:83],v21 offset:10240
v_smfmac_f32_16x16x64_bf16 v[28:31],v[68:71],a[168:175],v2
ds_read_b128 v[84:87],v21 offset:11264
v_smfmac_f32_16x16x64_bf16 v[32:35],v[68:71],a[176:183],v2
v_smfmac_f32_16x16x64_bf16 v[36:39],v[68:71],a[184:191],v2
v_smfmac_f32_16x16x64_bf16 v[40:43],v[68:71],a[192:199],v2
s_waitcnt lgkmcnt(3)
v_smfmac_f32_16x16x64_bf16 v[44:47],v[68:71],v[72:79],v2
ds_read_b128 v[68:71],v5 offset:1024
v_smfmac_f32_16x16x64_bf16 v[24:27],v[60:63],a[200:207],v2
ds_read_b128 v[72:75],v21 offset:12288
v_smfmac_f32_16x16x64_bf16 v[28:31],v[60:63],a[208:215],v2
ds_read_b128 v[76:79],v21 offset:13312
v_smfmac_f32_16x16x64_bf16 v[32:35],v[60:63],a[216:223],v2
v_smfmac_f32_16x16x64_bf16 v[36:39],v[60:63],a[224:231],v2
v_smfmac_f32_16x16x64_bf16 v[40:43],v[60:63],a[232:239],v2
s_waitcnt lgkmcnt(3)
v_smfmac_f32_16x16x64_bf16 v[44:47],v[60:63],v[80:87],v2
ds_read_b128 v[60:63],v59 offset:0
v_smfmac_f32_16x16x64_bf16 v[24:27],v[64:67],a[240:247],v2
ds_read_b128 v[80:83],v21 offset:14336
v_smfmac_f32_16x16x64_bf16 v[28:31],v[64:67],a[248:255],v2
ds_read_b128 v[84:87],v21 offset:15360
v_smfmac_f32_16x16x64_bf16 v[32:35],v[64:67],v[112:119],v2
s_cmp_eq_u32 s79,-1
s_cbranch_scc1 pf_129
v_mov_b32 v17,1
s_mov_b64 exec,1
buffer_store_dword v17,v1,s[8:11],s79 offen sc1
s_mov_b64 exec,-1
s_mov_b32 s79,-1
pf_129:
v_smfmac_f32_16x16x64_bf16 v[36:39],v[64:67],v[120:127],v2
s_cmp_eq_u32 s78,-1
s_cbranch_scc1 pk_130
buffer_store_dwordx4 v[100:103],v6,s[8:11],s78 offen sc1
buffer_store_dwordx2 v[104:105],v7,s[8:11],s78 offen sc1
s_mov_b32 s79,s30
s_mov_b32 s78,-1
pk_130:
v_smfmac_f32_16x16x64_bf16 v[40:43],v[64:67],v[128:135],v2
s_waitcnt lgkmcnt(3)
v_smfmac_f32_16x16x64_bf16 v[44:47],v[64:67],v[72:79],v2
ds_read_b128 v[64:67],v59 offset:1024
v_smfmac_f32_16x16x64_bf16 v[24:27],v[68:71],v[136:143],v2
ds_read_b128 v[72:75],v21 offset:16384
v_smfmac_f32_16x16x64_bf16 v[28:31],v[68:71],v[144:151],v2
ds_read_b128 v[76:79],v21 offset:17408
v_smfmac_f32_16x16x64_bf16 v[32:35],v[68:71],v[152:159],v2
v_smfmac_f32_16x16x64_bf16 v[36:39],v[68:71],v[160:167],v2
v_smfmac_f32_16x16x64_bf16 v[40:43],v[68:71],v[168:175],v2
s_waitcnt lgkmcnt(3)
v_smfmac_f32_16x16x64_bf16 v[44:47],v[68:71],v[80:87],v2
ds_read_b128 v[80:83],v21 offset:18432
v_smfmac_f32_16x16x64_bf16 v[24:27],v[60:63],v[176:183],v2
ds_read_b128 v[84:87],v21 offset:19456
v_smfmac_f32_16x16x64_bf16 v[28:31],v[60:63],v[184:191],v2
s_waitcnt lgkmcnt(4)
v_smfmac_f32_16x16x64_bf16 v[24:27],v[64:67],v[216:223],v2
v_smfmac_f32_16x16x64_bf16 v[28:31],v[64:67],v[224:231],v2
v_smfmac_f32_16x16x64_bf16 v[32:35],v[60:63],v[192:199],v2
v_smfmac_f32_16x16x64_bf16 v[36:39],v[60:63],v[200:207],v2
s_nop 4
v_add_f32 v24,v24,v25
v_smfmac_f32_16x16x64_bf16 v[32:35],v[64:67],v[232:239],v2
v_add_f32 v26,v26,v27
v_smfmac_f32_16x16x64_bf16 v[36:39],v[64:67],v[240:247],v2
v_add_f32 v28,v28,v29
v_smfmac_f32_16x16x64_bf16 v[40:43],v[60:63],v[208:215],v2
v_add_f32 v30,v30,v31
s_waitcnt lgkmcnt(2)
v_smfmac_f32_16x16x64_bf16 v[44:47],v[60:63],v[72:79],v2
v_cvt_pk_bf16_f32 v100,v24,v26
v_smfmac_f32_16x16x64_bf16 v[40:43],v[64:67],v[248:255],v2
v_cvt_pk_bf16_f32 v101,v28,v30
s_waitcnt lgkmcnt(0)
v_smfmac_f32_16x16x64_bf16 v[44:47],v[64:67],v[80:87],v2
v_and_or_b32 v100,v100,-2,s57
v_add_f32 v32,v32,v33
v_add_f32 v34,v34,v35
v_add_f32 v36,v36,v37
v_add_f32 v38,v38,v39
v_cvt_pk_bf16_f32 v102,v32,v34
v_cvt_pk_bf16_f32 v103,v36,v38
v_and_or_b32 v102,v102,-2,s57
buffer_store_dwordx4 v[100:103],v6,s[8:11],s71 offen
v_add_f32 v40,v40,v41
v_add_f32 v42,v42,v43
v_add_f32 v44,v44,v45
v_add_f32 v46,v46,v47
v_cvt_pk_bf16_f32 v104,v40,v42
v_cvt_pk_bf16_f32 v105,v44,v46
v_and_or_b32 v104,v104,-2,s57
buffer_store_dwordx2 v[104:105],v7,s[8:11],s71 offen
s_lshl_b32 s60,s51,6
s_add_u32 s60,s60,s52
s_mul_i32 s78,s60,196608
s_add_u32 s78,s78,s85
s_lshl_b32 s60,s60,10
s_add_u32 s30,s60,s86
s_sub_u32 s60,s4,s5
s_cmp_gt_i32 s60,13
s_cselect_b32 s53,1,0
s_cmp_eq_u32 s4,64
s_cselect_b32 s53,1,s53
s_cmp_eq_u32 s53,0
s_cselect_b32 s54,s4,s5
s_addc_u32 s4,s4,0
s_add_u32 s5,s5,s53
s_and_b32 s60,s54,1
s_lshl2_add_u32 s60,s53,s60
s_lshl_b32 s68,s60,16
s_add_u32 s68,s68,s83
s_mul_i32 s59,s60,20480
s_add_u32 s59,s59,s6
s_lshl_b32 s69,s53,9
s_add_u32 s69,s69,s7
s_bfe_u32 s31,s54,65537
s_add_u32 s32,s54,1
s_cmp_lg_u32 s53,s51
s_cbranch_scc1 nx_131
s_waitcnt vmcnt(0)
s_cmp_eq_u32 s79,-1
s_cbranch_scc1 pf_132
v_mov_b32 v17,1
s_mov_b64 exec,1
buffer_store_dword v17,v1,s[8:11],s79 offen sc1
s_mov_b64 exec,-1
s_mov_b32 s79,-1
pf_132:
s_cmp_eq_u32 s78,-1
s_cbranch_scc1 pk_133
buffer_store_dwordx4 v[100:103],v6,s[8:11],s78 offen sc1
buffer_store_dwordx2 v[104:105],v7,s[8:11],s78 offen sc1
s_mov_b32 s79,s30
s_mov_b32 s78,-1
pk_133:
s_waitcnt vmcnt(0)
s_cmp_eq_u32 s79,-1
s_cbranch_scc1 pf_134
v_mov_b32 v17,1
s_mov_b64 exec,1
buffer_store_dword v17,v1,s[8:11],s79 offen sc1
s_mov_b64 exec,-1
s_mov_b32 s79,-1
pf_134:
nx_131:
s_add_u32 s50,s50,1
s_mov_b32 s51,s53
s_mov_b32 s52,s54
s_mov_b32 s57,s31
s_mov_b32 s58,s32
s_cmp_lt_u32 s50,128
s_cbranch_scc1 CV_LOOP_F0
s_branch CV_DONE
fr_124:
v_bitop3_b32 v12,v60,v64,s57 bitop3:0x7e
v_bitop3_b32 v13,v68,v72,s57 bitop3:0x7e
v_xor_b32 v14,s57,v76
v_or3_b32 v12,v12,v13,v14
v_and_b32 v12,1,v12
v_cmp_ne_u32 vcc,0,v12
s_cbranch_vccz sk_135
buffer_load_dwordx4 v[76:79],v18,s[8:11],s59 offen sc1
buffer_load_dwordx4 v[60:63],v1,s[8:11],s59 offen sc1
buffer_load_dwordx4 v[64:67],v1,s[8:11],s59 offen offset:1024 sc1
buffer_load_dwordx4 v[68:71],v1,s[8:11],s59 offen offset:2048 sc1
buffer_load_dwordx4 v[72:75],v1,s[8:11],s59 offen offset:3072 sc1
sk_135:
buffer_load_dwordx4 v[96:99],v18,s[8:11],s68 offen sc1
buffer_load_dwordx4 v[80:83],v1,s[8:11],s68 offen sc1
buffer_load_dwordx4 v[84:87],v1,s[8:11],s68 offen offset:1024 sc1
buffer_load_dwordx4 v[88:91],v1,s[8:11],s68 offen offset:2048 sc1
buffer_load_dwordx4 v[92:95],v1,s[8:11],s68 offen offset:3072 sc1
s_sub_u32 s47,s47,1
s_cbranch_scc1 ABORT
s_waitcnt lgkmcnt(0)
s_branch fa_123
CV_LOOP_F1:
v_mov_b32 v24,0
v_mov_b32 v25,0
v_mov_b32 v26,0
v_mov_b32 v27,0
v_mov_b32 v28,0
v_mov_b32 v29,0
v_mov_b32 v30,0
v_mov_b32 v31,0
v_mov_b32 v32,0
v_mov_b32 v33,0
v_mov_b32 v34,0
v_mov_b32 v35,0
v_mov_b32 v36,0
v_mov_b32 v37,0
v_mov_b32 v38,0
v_mov_b32 v39,0
v_mov_b32 v40,0
v_mov_b32 v41,0
v_mov_b32 v42,0
v_mov_b32 v43,0
v_mov_b32 v44,0
v_mov_b32 v45,0
v_mov_b32 v46,0
v_mov_b32 v47,0
s_barrier
buffer_load_dwordx4 v[76:79],v18,s[8:11],s59 offen sc1
buffer_load_dwordx4 v[60:63],v1,s[8:11],s59 offen sc1
buffer_load_dwordx4 v[64:67],v1,s[8:11],s59 offen offset:1024 sc1
buffer_load_dwordx4 v[68:71],v1,s[8:11],s59 offen offset:2048 sc1
buffer_load_dwordx4 v[72:75],v1,s[8:11],s59 offen offset:3072 sc1
s_waitcnt vmcnt(4)
buffer_load_dwordx4 v[96:99],v18,s[8:11],s68 offen sc1
buffer_load_dwordx4 v[80:83],v1,s[8:11],s68 offen sc1
buffer_load_dwordx4 v[84:87],v1,s[8:11],s68 offen offset:1024 sc1
buffer_load_dwordx4 v[88:91],v1,s[8:11],s68 offen offset:2048 sc1
buffer_load_dwordx4 v[92:95],v1,s[8:11],s68 offen offset:3072 sc1
fj_138:
fa_136:
s_waitcnt vmcnt(4)
v_pk_add_f32 v[12:13],v[76:77],v[96:97]
v_pk_add_f32 v[14:15],v[78:79],v[98:99]
v_bitop3_b32 v16,v76,v96,s57 bitop3:0x7e
v_cvt_pk_bf16_f32 v56,v12,v13
v_cvt_pk_bf16_f32 v57,v14,v15
ds_write_b64 v23,v[56:57]
s_waitcnt vmcnt(3)
v_pk_add_f32 v[12:13],v[60:61],v[80:81]
v_pk_add_f32 v[14:15],v[62:63],v[82:83]
v_bitop3_b32 v17,v60,v80,s57 bitop3:0x7e
v_cvt_pk_bf16_f32 v48,v12,v13
v_cvt_pk_bf16_f32 v49,v14,v15
v_or_b32 v16,v16,v17
s_waitcnt vmcnt(2)
v_pk_add_f32 v[12:13],v[64:65],v[84:85]
v_pk_add_f32 v[14:15],v[66:67],v[86:87]
v_bitop3_b32 v17,v64,v84,s57 bitop3:0x7e
v_cvt_pk_bf16_f32 v50,v12,v13
v_cvt_pk_bf16_f32 v51,v14,v15
v_or_b32 v16,v16,v17
ds_write_b128 v22,v[48:51] offset:0
s_waitcnt vmcnt(1)
v_pk_add_f32 v[12:13],v[68:69],v[88:89]
v_pk_add_f32 v[14:15],v[70:71],v[90:91]
v_bitop3_b32 v17,v68,v88,s57 bitop3:0x7e
v_cvt_pk_bf16_f32 v52,v12,v13
v_cvt_pk_bf16_f32 v53,v14,v15
v_or_b32 v16,v16,v17
s_waitcnt vmcnt(0)
v_pk_add_f32 v[12:13],v[72:73],v[92:93]
v_pk_add_f32 v[14:15],v[74:75],v[94:95]
v_bitop3_b32 v17,v72,v92,s57 bitop3:0x7e
v_cvt_pk_bf16_f32 v54,v12,v13
v_cvt_pk_bf16_f32 v55,v14,v15
v_bitop3_b32 v16,v16,v17,1 bitop3:0xa8
v_cmp_ne_u32 vcc,0,v16
ds_write_b128 v22,v[52:55] offset:1024
s_cbranch_vccnz fr_137
v_smfmac_f32_16x16x64_bf16 v[24:27],v[48:51],a[0:7],v2
ds_read_b128 v[72:75],v21 offset:0
s_and_b32 s60,s52,1
v_smfmac_f32_16x16x64_bf16 v[28:31],v[48:51],a[8:15],v2
ds_read_b128 v[76:79],v21 offset:1024
s_lshl2_add_u32 s60,s51,s60
v_smfmac_f32_16x16x64_bf16 v[32:35],v[48:51],a[16:23],v2
ds_read_b128 v[80:83],v21 offset:2048
s_mul_i32 s60,s60,49152
v_smfmac_f32_16x16x64_bf16 v[36:39],v[48:51],a[24:31],v2
ds_read_b128 v[84:87],v21 offset:3072
s_add_u32 s71,s60,s34
s_waitcnt lgkmcnt(4)
s_barrier
v_smfmac_f32_16x16x64_bf16 v[40:43],v[48:51],a[32:39],v2
ds_read_b128 v[60:63],v3 offset:0
v_smfmac_f32_16x16x64_bf16 v[24:27],v[52:55],a[40:47],v2
ds_read_b128 v[64:67],v3 offset:1024
v_smfmac_f32_16x16x64_bf16 v[28:31],v[52:55],a[48:55],v2
ds_read_b128 v[68:71],v4 offset:0
v_smfmac_f32_16x16x64_bf16 v[32:35],v[52:55],a[56:63],v2
v_smfmac_f32_16x16x64_bf16 v[36:39],v[52:55],a[64:71],v2
v_smfmac_f32_16x16x64_bf16 v[40:43],v[52:55],a[72:79],v2
s_waitcnt lgkmcnt(5)
v_smfmac_f32_16x16x64_bf16 v[44:47],v[48:51],v[72:79],v2
ds_read_b128 v[72:75],v21 offset:4096
s_waitcnt lgkmcnt(4)
v_smfmac_f32_16x16x64_bf16 v[44:47],v[52:55],v[80:87],v2
ds_read_b128 v[76:79],v21 offset:5120
s_waitcnt lgkmcnt(4)
v_smfmac_f32_16x16x64_bf16 v[24:27],v[60:63],a[80:87],v2
ds_read_b128 v[80:83],v21 offset:6144
v_smfmac_f32_16x16x64_bf16 v[28:31],v[60:63],a[88:95],v2
ds_read_b128 v[84:87],v21 offset:7168
v_smfmac_f32_16x16x64_bf16 v[32:35],v[60:63],a[96:103],v2
v_smfmac_f32_16x16x64_bf16 v[36:39],v[60:63],a[104:111],v2
v_smfmac_f32_16x16x64_bf16 v[40:43],v[60:63],a[112:119],v2
s_waitcnt lgkmcnt(2)
v_smfmac_f32_16x16x64_bf16 v[44:47],v[60:63],v[72:79],v2
ds_read_b128 v[60:63],v4 offset:1024
v_smfmac_f32_16x16x64_bf16 v[24:27],v[64:67],a[120:127],v2
ds_read_b128 v[72:75],v21 offset:8192
v_smfmac_f32_16x16x64_bf16 v[28:31],v[64:67],a[128:135],v2
ds_read_b128 v[76:79],v21 offset:9216
v_smfmac_f32_16x16x64_bf16 v[32:35],v[64:67],a[136:143],v2
v_smfmac_f32_16x16x64_bf16 v[36:39],v[64:67],a[144:151],v2
v_smfmac_f32_16x16x64_bf16 v[40:43],v[64:67],a[152:159],v2
s_waitcnt lgkmcnt(3)
v_smfmac_f32_16x16x64_bf16 v[44:47],v[64:67],v[80:87],v2
ds_read_b128 v[64:67],v5 offset:0
v_smfmac_f32_16x16x64_bf16 v[24:27],v[68:71],a[160:167],v2
ds_read_b128 v[80:83],v21 offset:10240
v_smfmac_f32_16x16x64_bf16 v[28:31],v[68:71],a[168:175],v2
ds_read_b128 v[84:87],v21 offset:11264
v_smfmac_f32_16x16x64_bf16 v[32:35],v[68:71],a[176:183],v2
v_smfmac_f32_16x16x64_bf16 v[36:39],v[68:71],a[184:191],v2
v_smfmac_f32_16x16x64_bf16 v[40:43],v[68:71],a[192:199],v2
s_waitcnt lgkmcnt(3)
v_smfmac_f32_16x16x64_bf16 v[44:47],v[68:71],v[72:79],v2
ds_read_b128 v[68:71],v5 offset:1024
v_smfmac_f32_16x16x64_bf16 v[24:27],v[60:63],a[200:207],v2
ds_read_b128 v[72:75],v21 offset:12288
v_smfmac_f32_16x16x64_bf16 v[28:31],v[60:63],a[208:215],v2
ds_read_b128 v[76:79],v21 offset:13312
v_smfmac_f32_16x16x64_bf16 v[32:35],v[60:63],a[216:223],v2
v_smfmac_f32_16x16x64_bf16 v[36:39],v[60:63],a[224:231],v2
v_smfmac_f32_16x16x64_bf16 v[40:43],v[60:63],a[232:239],v2
s_waitcnt lgkmcnt(3)
v_smfmac_f32_16x16x64_bf16 v[44:47],v[60:63],v[80:87],v2
ds_read_b128 v[60:63],v59 offset:0
v_smfmac_f32_16x16x64_bf16 v[24:27],v[64:67],a[240:247],v2
ds_read_b128 v[80:83],v21 offset:14336
v_smfmac_f32_16x16x64_bf16 v[28:31],v[64:67],a[248:255],v2
ds_read_b128 v[84:87],v21 offset:15360
v_smfmac_f32_16x16x64_bf16 v[32:35],v[64:67],v[112:119],v2
s_cmp_eq_u32 s79,-1
s_cbranch_scc1 pf_139
v_mov_b32 v17,1
s_mov_b64 exec,1
buffer_store_dword v17,v1,s[8:11],s79 offen sc1
s_mov_b64 exec,-1
s_mov_b32 s79,-1
pf_139:
v_smfmac_f32_16x16x64_bf16 v[36:39],v[64:67],v[120:127],v2
s_cmp_eq_u32 s78,-1
s_cbranch_scc1 pk_140
buffer_store_dwordx4 v[102:105],v6,s[8:11],s78 offen sc1
buffer_store_dwordx2 v[100:101],v7,s[8:11],s78 offen sc1
s_mov_b32 s79,s30
s_mov_b32 s78,-1
pk_140:
v_smfmac_f32_16x16x64_bf16 v[40:43],v[64:67],v[128:135],v2
s_waitcnt lgkmcnt(3)
v_smfmac_f32_16x16x64_bf16 v[44:47],v[64:67],v[72:79],v2
ds_read_b128 v[64:67],v59 offset:1024
v_smfmac_f32_16x16x64_bf16 v[24:27],v[68:71],v[136:143],v2
ds_read_b128 v[72:75],v21 offset:16384
v_smfmac_f32_16x16x64_bf16 v[28:31],v[68:71],v[144:151],v2
ds_read_b128 v[76:79],v21 offset:17408
v_smfmac_f32_16x16x64_bf16 v[32:35],v[68:71],v[152:159],v2
v_smfmac_f32_16x16x64_bf16 v[36:39],v[68:71],v[160:167],v2
v_smfmac_f32_16x16x64_bf16 v[40:43],v[68:71],v[168:175],v2
s_waitcnt lgkmcnt(3)
v_smfmac_f32_16x16x64_bf16 v[44:47],v[68:71],v[80:87],v2
ds_read_b128 v[80:83],v21 offset:18432
v_smfmac_f32_16x16x64_bf16 v[24:27],v[60:63],v[176:183],v2
ds_read_b128 v[84:87],v21 offset:19456
v_smfmac_f32_16x16x64_bf16 v[28:31],v[60:63],v[184:191],v2
s_waitcnt lgkmcnt(4)
v_smfmac_f32_16x16x64_bf16 v[24:27],v[64:67],v[216:223],v2
v_smfmac_f32_16x16x64_bf16 v[28:31],v[64:67],v[224:231],v2
v_smfmac_f32_16x16x64_bf16 v[32:35],v[60:63],v[192:199],v2
v_smfmac_f32_16x16x64_bf16 v[36:39],v[60:63],v[200:207],v2
s_nop 4
v_add_f32 v24,v24,v25
v_smfmac_f32_16x16x64_bf16 v[32:35],v[64:67],v[232:239],v2
v_add_f32 v26,v26,v27
v_smfmac_f32_16x16x64_bf16 v[36:39],v[64:67],v[240:247],v2
v_add_f32 v28,v28,v29
v_smfmac_f32_16x16x64_bf16 v[40:43],v[60:63],v[208:215],v2
v_add_f32 v30,v30,v31
s_waitcnt lgkmcnt(2)
v_smfmac_f32_16x16x64_bf16 v[44:47],v[60:63],v[72:79],v2
v_cvt_pk_bf16_f32 v100,v24,v26
v_smfmac_f32_16x16x64_bf16 v[40:43],v[64:67],v[248:255],v2
v_cvt_pk_bf16_f32 v101,v28,v30
s_waitcnt lgkmcnt(0)
v_smfmac_f32_16x16x64_bf16 v[44:47],v[64:67],v[80:87],v2
v_and_or_b32 v100,v100,-2,s57
buffer_store_dwordx2 v[100:101],v7,s[8:11],s71 offen
v_add_f32 v32,v32,v33
v_add_f32 v34,v34,v35
v_add_f32 v36,v36,v37
v_add_f32 v38,v38,v39
v_cvt_pk_bf16_f32 v102,v32,v34
v_cvt_pk_bf16_f32 v103,v36,v38
v_and_or_b32 v102,v102,-2,s57
v_add_f32 v40,v40,v41
v_add_f32 v42,v42,v43
v_add_f32 v44,v44,v45
v_add_f32 v46,v46,v47
v_cvt_pk_bf16_f32 v104,v40,v42
v_cvt_pk_bf16_f32 v105,v44,v46
v_and_or_b32 v104,v104,-2,s57
buffer_store_dwordx4 v[102:105],v6,s[8:11],s71 offen
s_lshl_b32 s60,s51,6
s_add_u32 s60,s60,s52
s_mul_i32 s78,s60,196608
s_add_u32 s78,s78,s85
s_lshl_b32 s60,s60,10
s_add_u32 s30,s60,s86
s_sub_u32 s60,s4,s5
s_cmp_gt_i32 s60,13
s_cselect_b32 s53,1,0
s_cmp_eq_u32 s4,64
s_cselect_b32 s53,1,s53
s_cmp_eq_u32 s53,0
s_cselect_b32 s54,s4,s5
s_addc_u32 s4,s4,0
s_add_u32 s5,s5,s53
s_and_b32 s60,s54,1
s_lshl2_add_u32 s60,s53,s60
s_lshl_b32 s68,s60,16
s_add_u32 s68,s68,s83
s_mul_i32 s59,s60,20480
s_add_u32 s59,s59,s6
s_lshl_b32 s69,s53,9
s_add_u32 s69,s69,s7
s_bfe_u32 s31,s54,65537
s_add_u32 s32,s54,1
s_cmp_lg_u32 s53,s51
s_cbranch_scc1 nx_141
s_waitcnt vmcnt(0)
s_cmp_eq_u32 s79,-1
s_cbranch_scc1 pf_142
v_mov_b32 v17,1
s_mov_b64 exec,1
buffer_store_dword v17,v1,s[8:11],s79 offen sc1
s_mov_b64 exec,-1
s_mov_b32 s79,-1
pf_142:
s_cmp_eq_u32 s78,-1
s_cbranch_scc1 pk_143
buffer_store_dwordx4 v[102:105],v6,s[8:11],s78 offen sc1
buffer_store_dwordx2 v[100:101],v7,s[8:11],s78 offen sc1
s_mov_b32 s79,s30
s_mov_b32 s78,-1
pk_143:
s_waitcnt vmcnt(0)
s_cmp_eq_u32 s79,-1
s_cbranch_scc1 pf_144
v_mov_b32 v17,1
s_mov_b64 exec,1
buffer_store_dword v17,v1,s[8:11],s79 offen sc1
s_mov_b64 exec,-1
s_mov_b32 s79,-1
pf_144:
nx_141:
s_add_u32 s50,s50,1
s_mov_b32 s51,s53
s_mov_b32 s52,s54
s_mov_b32 s57,s31
s_mov_b32 s58,s32
s_cmp_lt_u32 s50,128
s_cbranch_scc1 CV_LOOP_F1
s_branch CV_DONE
fr_137:
v_bitop3_b32 v12,v60,v64,s57 bitop3:0x7e
v_bitop3_b32 v13,v68,v72,s57 bitop3:0x7e
v_xor_b32 v14,s57,v76
v_or3_b32 v12,v12,v13,v14
v_and_b32 v12,1,v12
v_cmp_ne_u32 vcc,0,v12
s_cbranch_vccz sk_145
buffer_load_dwordx4 v[76:79],v18,s[8:11],s59 offen sc1
buffer_load_dwordx4 v[60:63],v1,s[8:11],s59 offen sc1
buffer_load_dwordx4 v[64:67],v1,s[8:11],s59 offen offset:1024 sc1
buffer_load_dwordx4 v[68:71],v1,s[8:11],s59 offen offset:2048 sc1
buffer_load_dwordx4 v[72:75],v1,s[8:11],s59 offen offset:3072 sc1
sk_145:
buffer_load_dwordx4 v[96:99],v18,s[8:11],s68 offen sc1
buffer_load_dwordx4 v[80:83],v1,s[8:11],s68 offen sc1
buffer_load_dwordx4 v[84:87],v1,s[8:11],s68 offen offset:1024 sc1
buffer_load_dwordx4 v[88:91],v1,s[8:11],s68 offen offset:2048 sc1
buffer_load_dwordx4 v[92:95],v1,s[8:11],s68 offen offset:3072 sc1
s_sub_u32 s47,s47,1
s_cbranch_scc1 ABORT
s_waitcnt lgkmcnt(0)
s_branch fa_136
CV_LOOP_S0:
v_mov_b32 v24,0
v_mov_b32 v25,0
v_mov_b32 v26,0
v_mov_b32 v27,0
v_mov_b32 v28,0
v_mov_b32 v29,0
v_mov_b32 v30,0
v_mov_b32 v31,0
v_mov_b32 v32,0
v_mov_b32 v33,0
v_mov_b32 v34,0
v_mov_b32 v35,0
v_mov_b32 v36,0
v_mov_b32 v37,0
v_mov_b32 v38,0
v_mov_b32 v39,0
v_mov_b32 v40,0
v_mov_b32 v41,0
v_mov_b32 v42,0
v_mov_b32 v43,0
v_mov_b32 v44,0
v_mov_b32 v45,0
v_mov_b32 v46,0
v_mov_b32 v47,0
s_cmp_lg_u32 s46,0
s_cbranch_scc1 np_149
db_150:
buffer_load_dword v12,v11,s[8:11],s69 offen sc1
s_waitcnt vmcnt(0)
v_cmp_gt_u32 vcc,s58,v12
s_cbranch_vccz dbok_151
s_sub_u32 s47,s47,1
s_cbranch_scc1 ABORT
s_branch db_150
dbok_151:
np_149:
s_barrier
buffer_load_dwordx4 v[76:79],v18,s[8:11],s59 offen sc1
buffer_load_dwordx4 v[60:63],v1,s[8:11],s59 offen sc1
buffer_load_dwordx4 v[64:67],v1,s[8:11],s59 offen offset:1024 sc1
buffer_load_dwordx4 v[68:71],v1,s[8:11],s59 offen offset:2048 sc1
buffer_load_dwordx4 v[72:75],v1,s[8:11],s59 offen offset:3072 sc1
s_waitcnt vmcnt(4)
buffer_load_dwordx4 v[96:99],v18,s[8:11],s68 offen sc1
buffer_load_dwordx4 v[80:83],v1,s[8:11],s68 offen sc1
buffer_load_dwordx4 v[84:87],v1,s[8:11],s68 offen offset:1024 sc1
buffer_load_dwordx4 v[88:91],v1,s[8:11],s68 offen offset:2048 sc1
buffer_load_dwordx4 v[92:95],v1,s[8:11],s68 offen offset:3072 sc1
fj_148:
fa_146:
s_waitcnt vmcnt(4)
v_pk_add_f32 v[12:13],v[76:77],v[96:97]
v_pk_add_f32 v[14:15],v[78:79],v[98:99]
v_bitop3_b32 v16,v76,v96,s57 bitop3:0x7e
v_cvt_pk_bf16_f32 v56,v12,v13
v_cvt_pk_bf16_f32 v57,v14,v15
ds_write_b64 v23,v[56:57]
s_waitcnt vmcnt(3)
v_pk_add_f32 v[12:13],v[60:61],v[80:81]
v_pk_add_f32 v[14:15],v[62:63],v[82:83]
v_bitop3_b32 v17,v60,v80,s57 bitop3:0x7e
v_cvt_pk_bf16_f32 v48,v12,v13
v_cvt_pk_bf16_f32 v49,v14,v15
v_or_b32 v16,v16,v17
s_waitcnt vmcnt(2)
v_pk_add_f32 v[12:13],v[64:65],v[84:85]
v_pk_add_f32 v[14:15],v[66:67],v[86:87]
v_bitop3_b32 v17,v64,v84,s57 bitop3:0x7e
v_cvt_pk_bf16_f32 v50,v12,v13
v_cvt_pk_bf16_f32 v51,v14,v15
v_or_b32 v16,v16,v17
ds_write_b128 v22,v[48:51] offset:0
s_waitcnt vmcnt(1)
v_pk_add_f32 v[12:13],v[68:69],v[88:89]
v_pk_add_f32 v[14:15],v[70:71],v[90:91]
v_bitop3_b32 v17,v68,v88,s57 bitop3:0x7e
v_cvt_pk_bf16_f32 v52,v12,v13
v_cvt_pk_bf16_f32 v53,v14,v15
v_or_b32 v16,v16,v17
s_waitcnt vmcnt(0)
v_pk_add_f32 v[12:13],v[72:73],v[92:93]
v_pk_add_f32 v[14:15],v[74:75],v[94:95]
v_bitop3_b32 v17,v72,v92,s57 bitop3:0x7e
v_cvt_pk_bf16_f32 v54,v12,v13
v_cvt_pk_bf16_f32 v55,v14,v15
v_bitop3_b32 v16,v16,v17,1 bitop3:0xa8
v_cmp_ne_u32 vcc,0,v16
ds_write_b128 v22,v[52:55] offset:1024
s_cbranch_vccnz fr_147
v_smfmac_f32_16x16x64_bf16 v[24:27],v[48:51],a[0:7],v2
ds_read_b128 v[72:75],v21 offset:0
s_and_b32 s60,s52,1
v_smfmac_f32_16x16x64_bf16 v[28:31],v[48:51],a[8:15],v2
ds_read_b128 v[76:79],v21 offset:1024
s_lshl2_add_u32 s60,s51,s60
v_smfmac_f32_16x16x64_bf16 v[32:35],v[48:51],a[16:23],v2
ds_read_b128 v[80:83],v21 offset:2048
s_mul_i32 s60,s60,49152
v_smfmac_f32_16x16x64_bf16 v[36:39],v[48:51],a[24:31],v2
ds_read_b128 v[84:87],v21 offset:3072
s_add_u32 s71,s60,s34
s_waitcnt lgkmcnt(4)
s_barrier
v_smfmac_f32_16x16x64_bf16 v[40:43],v[48:51],a[32:39],v2
ds_read_b128 v[60:63],v3 offset:0
v_smfmac_f32_16x16x64_bf16 v[24:27],v[52:55],a[40:47],v2
ds_read_b128 v[64:67],v3 offset:1024
v_smfmac_f32_16x16x64_bf16 v[28:31],v[52:55],a[48:55],v2
ds_read_b128 v[68:71],v4 offset:0
v_smfmac_f32_16x16x64_bf16 v[32:35],v[52:55],a[56:63],v2
v_smfmac_f32_16x16x64_bf16 v[36:39],v[52:55],a[64:71],v2
v_smfmac_f32_16x16x64_bf16 v[40:43],v[52:55],a[72:79],v2
s_waitcnt lgkmcnt(5)
v_smfmac_f32_16x16x64_bf16 v[44:47],v[48:51],v[72:79],v2
ds_read_b128 v[72:75],v21 offset:4096
s_waitcnt lgkmcnt(4)
v_smfmac_f32_16x16x64_bf16 v[44:47],v[52:55],v[80:87],v2
ds_read_b128 v[76:79],v21 offset:5120
s_waitcnt lgkmcnt(4)
v_smfmac_f32_16x16x64_bf16 v[24:27],v[60:63],a[80:87],v2
ds_read_b128 v[80:83],v21 offset:6144
v_smfmac_f32_16x16x64_bf16 v[28:31],v[60:63],a[88:95],v2
ds_read_b128 v[84:87],v21 offset:7168
v_smfmac_f32_16x16x64_bf16 v[32:35],v[60:63],a[96:103],v2
v_smfmac_f32_16x16x64_bf16 v[36:39],v[60:63],a[104:111],v2
v_smfmac_f32_16x16x64_bf16 v[40:43],v[60:63],a[112:119],v2
s_waitcnt lgkmcnt(2)
v_smfmac_f32_16x16x64_bf16 v[44:47],v[60:63],v[72:79],v2
ds_read_b128 v[60:63],v4 offset:1024
v_smfmac_f32_16x16x64_bf16 v[24:27],v[64:67],a[120:127],v2
ds_read_b128 v[72:75],v21 offset:8192
v_smfmac_f32_16x16x64_bf16 v[28:31],v[64:67],a[128:135],v2
ds_read_b128 v[76:79],v21 offset:9216
v_smfmac_f32_16x16x64_bf16 v[32:35],v[64:67],a[136:143],v2
v_smfmac_f32_16x16x64_bf16 v[36:39],v[64:67],a[144:151],v2
v_smfmac_f32_16x16x64_bf16 v[40:43],v[64:67],a[152:159],v2
s_waitcnt lgkmcnt(3)
v_smfmac_f32_16x16x64_bf16 v[44:47],v[64:67],v[80:87],v2
ds_read_b128 v[64:67],v5 offset:0
v_smfmac_f32_16x16x64_bf16 v[24:27],v[68:71],a[160:167],v2
ds_read_b128 v[80:83],v21 offset:10240
v_smfmac_f32_16x16x64_bf16 v[28:31],v[68:71],a[168:175],v2
ds_read_b128 v[84:87],v21 offset:11264
v_smfmac_f32_16x16x64_bf16 v[32:35],v[68:71],a[176:183],v2
v_smfmac_f32_16x16x64_bf16 v[36:39],v[68:71],a[184:191],v2
v_smfmac_f32_16x16x64_bf16 v[40:43],v[68:71],a[192:199],v2
s_waitcnt lgkmcnt(3)
v_smfmac_f32_16x16x64_bf16 v[44:47],v[68:71],v[72:79],v2
ds_read_b128 v[68:71],v5 offset:1024
v_smfmac_f32_16x16x64_bf16 v[24:27],v[60:63],a[200:207],v2
ds_read_b128 v[72:75],v21 offset:12288
v_smfmac_f32_16x16x64_bf16 v[28:31],v[60:63],a[208:215],v2
ds_read_b128 v[76:79],v21 offset:13312
v_smfmac_f32_16x16x64_bf16 v[32:35],v[60:63],a[216:223],v2
v_smfmac_f32_16x16x64_bf16 v[36:39],v[60:63],a[224:231],v2
v_smfmac_f32_16x16x64_bf16 v[40:43],v[60:63],a[232:239],v2
s_waitcnt lgkmcnt(3)
v_smfmac_f32_16x16x64_bf16 v[44:47],v[60:63],v[80:87],v2
ds_read_b128 v[60:63],v59 offset:0
v_smfmac_f32_16x16x64_bf16 v[24:27],v[64:67],a[240:247],v2
ds_read_b128 v[80:83],v21 offset:14336
v_smfmac_f32_16x16x64_bf16 v[28:31],v[64:67],a[248:255],v2
ds_read_b128 v[84:87],v21 offset:15360
v_smfmac_f32_16x16x64_bf16 v[32:35],v[64:67],v[112:119],v2
s_cmp_eq_u32 s79,-1
s_cbranch_scc1 pf_152
v_mov_b32 v17,1
s_mov_b64 exec,1
buffer_store_dword v17,v1,s[8:11],s79 offen sc1
s_mov_b64 exec,-1
s_mov_b32 s79,-1
pf_152:
v_smfmac_f32_16x16x64_bf16 v[36:39],v[64:67],v[120:127],v2
s_cmp_eq_u32 s78,-1
s_cbranch_scc1 pk_153
buffer_store_dwordx4 v[100:103],v6,s[8:11],s78 offen sc1
buffer_store_dwordx2 v[104:105],v7,s[8:11],s78 offen sc1
s_mov_b32 s79,s30
s_mov_b32 s78,-1
pk_153:
v_smfmac_f32_16x16x64_bf16 v[40:43],v[64:67],v[128:135],v2
s_waitcnt lgkmcnt(3)
v_smfmac_f32_16x16x64_bf16 v[44:47],v[64:67],v[72:79],v2
ds_read_b128 v[64:67],v59 offset:1024
v_smfmac_f32_16x16x64_bf16 v[24:27],v[68:71],v[136:143],v2
ds_read_b128 v[72:75],v21 offset:16384
v_smfmac_f32_16x16x64_bf16 v[28:31],v[68:71],v[144:151],v2
ds_read_b128 v[76:79],v21 offset:17408
v_smfmac_f32_16x16x64_bf16 v[32:35],v[68:71],v[152:159],v2
v_smfmac_f32_16x16x64_bf16 v[36:39],v[68:71],v[160:167],v2
v_smfmac_f32_16x16x64_bf16 v[40:43],v[68:71],v[168:175],v2
s_waitcnt lgkmcnt(3)
v_smfmac_f32_16x16x64_bf16 v[44:47],v[68:71],v[80:87],v2
ds_read_b128 v[80:83],v21 offset:18432
v_smfmac_f32_16x16x64_bf16 v[24:27],v[60:63],v[176:183],v2
ds_read_b128 v[84:87],v21 offset:19456
v_smfmac_f32_16x16x64_bf16 v[28:31],v[60:63],v[184:191],v2
s_waitcnt lgkmcnt(4)
v_smfmac_f32_16x16x64_bf16 v[24:27],v[64:67],v[216:223],v2
v_smfmac_f32_16x16x64_bf16 v[28:31],v[64:67],v[224:231],v2
v_smfmac_f32_16x16x64_bf16 v[32:35],v[60:63],v[192:199],v2
v_smfmac_f32_16x16x64_bf16 v[36:39],v[60:63],v[200:207],v2
s_nop 4
v_add_f32 v24,v24,v25
v_smfmac_f32_16x16x64_bf16 v[32:35],v[64:67],v[232:239],v2
v_add_f32 v26,v26,v27
v_smfmac_f32_16x16x64_bf16 v[36:39],v[64:67],v[240:247],v2
v_add_f32 v28,v28,v29
v_smfmac_f32_16x16x64_bf16 v[40:43],v[60:63],v[208:215],v2
v_add_f32 v30,v30,v31
s_waitcnt lgkmcnt(2)
v_smfmac_f32_16x16x64_bf16 v[44:47],v[60:63],v[72:79],v2
v_cvt_pk_bf16_f32 v100,v24,v26
v_smfmac_f32_16x16x64_bf16 v[40:43],v[64:67],v[248:255],v2
v_cvt_pk_bf16_f32 v101,v28,v30
s_waitcnt lgkmcnt(0)
v_smfmac_f32_16x16x64_bf16 v[44:47],v[64:67],v[80:87],v2
v_and_or_b32 v100,v100,-2,s57
v_add_f32 v32,v32,v33
v_add_f32 v34,v34,v35
v_add_f32 v36,v36,v37
v_add_f32 v38,v38,v39
v_cvt_pk_bf16_f32 v102,v32,v34
v_cvt_pk_bf16_f32 v103,v36,v38
v_and_or_b32 v102,v102,-2,s57
buffer_store_dwordx4 v[100:103],v6,s[8:11],s71 offen sc1
v_add_f32 v40,v40,v41
v_add_f32 v42,v42,v43
v_add_f32 v44,v44,v45
v_add_f32 v46,v46,v47
v_cvt_pk_bf16_f32 v104,v40,v42
v_cvt_pk_bf16_f32 v105,v44,v46
v_and_or_b32 v104,v104,-2,s57
buffer_store_dwordx2 v[104:105],v7,s[8:11],s71 offen sc1
s_lshl_b32 s60,s51,6
s_add_u32 s60,s60,s52
s_mul_i32 s78,s60,196608
s_add_u32 s78,s78,s85
s_lshl_b32 s60,s60,10
s_add_u32 s30,s60,s86
s_sub_u32 s60,s4,s5
s_cmp_gt_i32 s60,13
s_cselect_b32 s53,1,0
s_cmp_eq_u32 s4,64
s_cselect_b32 s53,1,s53
s_cmp_eq_u32 s53,0
s_cselect_b32 s54,s4,s5
s_addc_u32 s4,s4,0
s_add_u32 s5,s5,s53
s_and_b32 s60,s54,1
s_lshl2_add_u32 s60,s53,s60
s_lshl_b32 s68,s60,16
s_add_u32 s68,s68,s83
s_mul_i32 s59,s60,20480
s_add_u32 s59,s59,s6
s_lshl_b32 s69,s53,9
s_add_u32 s69,s69,s7
s_bfe_u32 s31,s54,65537
s_add_u32 s32,s54,1
s_cmp_lg_u32 s53,s51
s_cbranch_scc1 nx_154
s_waitcnt vmcnt(0)
s_cmp_eq_u32 s79,-1
s_cbranch_scc1 pf_155
v_mov_b32 v17,1
s_mov_b64 exec,1
buffer_store_dword v17,v1,s[8:11],s79 offen sc1
s_mov_b64 exec,-1
s_mov_b32 s79,-1
pf_155:
s_cmp_eq_u32 s78,-1
s_cbranch_scc1 pk_156
buffer_store_dwordx4 v[100:103],v6,s[8:11],s78 offen sc1
buffer_store_dwordx2 v[104:105],v7,s[8:11],s78 offen sc1
s_mov_b32 s79,s30
s_mov_b32 s78,-1
pk_156:
s_waitcnt vmcnt(0)
s_cmp_eq_u32 s79,-1
s_cbranch_scc1 pf_157
v_mov_b32 v17,1
s_mov_b64 exec,1
buffer_store_dword v17,v1,s[8:11],s79 offen sc1
s_mov_b64 exec,-1
s_mov_b32 s79,-1
pf_157:
nx_154:
s_add_u32 s50,s50,1
s_mov_b32 s51,s53
s_mov_b32 s52,s54
s_mov_b32 s57,s31
s_mov_b32 s58,s32
s_cmp_lt_u32 s50,128
s_cbranch_scc1 CV_LOOP_S0
s_branch CV_DONE
fr_147:
v_bitop3_b32 v12,v60,v64,s57 bitop3:0x7e
v_bitop3_b32 v13,v68,v72,s57 bitop3:0x7e
v_xor_b32 v14,s57,v76
v_or3_b32 v12,v12,v13,v14
v_and_b32 v12,1,v12
v_cmp_ne_u32 vcc,0,v12
s_cbranch_vccz sk_158
buffer_load_dwordx4 v[76:79],v18,s[8:11],s59 offen sc1
buffer_load_dwordx4 v[60:63],v1,s[8:11],s59 offen sc1
buffer_load_dwordx4 v[64:67],v1,s[8:11],s59 offen offset:1024 sc1
buffer_load_dwordx4 v[68:71],v1,s[8:11],s59 offen offset:2048 sc1
buffer_load_dwordx4 v[72:75],v1,s[8:11],s59 offen offset:3072 sc1
sk_158:
buffer_load_dwordx4 v[96:99],v18,s[8:11],s68 offen sc1
buffer_load_dwordx4 v[80:83],v1,s[8:11],s68 offen sc1
buffer_load_dwordx4 v[84:87],v1,s[8:11],s68 offen offset:1024 sc1
buffer_load_dwordx4 v[88:91],v1,s[8:11],s68 offen offset:2048 sc1
buffer_load_dwordx4 v[92:95],v1,s[8:11],s68 offen offset:3072 sc1
s_sub_u32 s47,s47,1
s_cbranch_scc1 ABORT
s_waitcnt lgkmcnt(0)
s_branch fa_146
CV_LOOP_S1:
v_mov_b32 v24,0
v_mov_b32 v25,0
v_mov_b32 v26,0
v_mov_b32 v27,0
v_mov_b32 v28,0
v_mov_b32 v29,0
v_mov_b32 v30,0
v_mov_b32 v31,0
v_mov_b32 v32,0
v_mov_b32 v33,0
v_mov_b32 v34,0
v_mov_b32 v35,0
v_mov_b32 v36,0
v_mov_b32 v37,0
v_mov_b32 v38,0
v_mov_b32 v39,0
v_mov_b32 v40,0
v_mov_b32 v41,0
v_mov_b32 v42,0
v_mov_b32 v43,0
v_mov_b32 v44,0
v_mov_b32 v45,0
v_mov_b32 v46,0
v_mov_b32 v47,0
s_barrier
buffer_load_dwordx4 v[76:79],v18,s[8:11],s59 offen sc1
buffer_load_dwordx4 v[60:63],v1,s[8:11],s59 offen sc1
buffer_load_dwordx4 v[64:67],v1,s[8:11],s59 offen offset:1024 sc1
buffer_load_dwordx4 v[68:71],v1,s[8:11],s59 offen offset:2048 sc1
buffer_load_dwordx4 v[72:75],v1,s[8:11],s59 offen offset:3072 sc1
s_waitcnt vmcnt(4)
buffer_load_dwordx4 v[96:99],v18,s[8:11],s68 offen sc1
buffer_load_dwordx4 v[80:83],v1,s[8:11],s68 offen sc1
buffer_load_dwordx4 v[84:87],v1,s[8:11],s68 offen offset:1024 sc1
buffer_load_dwordx4 v[88:91],v1,s[8:11],s68 offen offset:2048 sc1
buffer_load_dwordx4 v[92:95],v1,s[8:11],s68 offen offset:3072 sc1
fj_161:
fa_159:
s_waitcnt vmcnt(4)
v_pk_add_f32 v[12:13],v[76:77],v[96:97]
v_pk_add_f32 v[14:15],v[78:79],v[98:99]
v_bitop3_b32 v16,v76,v96,s57 bitop3:0x7e
v_cvt_pk_bf16_f32 v56,v12,v13
v_cvt_pk_bf16_f32 v57,v14,v15
ds_write_b64 v23,v[56:57]
s_waitcnt vmcnt(3)
v_pk_add_f32 v[12:13],v[60:61],v[80:81]
v_pk_add_f32 v[14:15],v[62:63],v[82:83]
v_bitop3_b32 v17,v60,v80,s57 bitop3:0x7e
v_cvt_pk_bf16_f32 v48,v12,v13
v_cvt_pk_bf16_f32 v49,v14,v15
v_or_b32 v16,v16,v17
s_waitcnt vmcnt(2)
v_pk_add_f32 v[12:13],v[64:65],v[84:85]
v_pk_add_f32 v[14:15],v[66:67],v[86:87]
v_bitop3_b32 v17,v64,v84,s57 bitop3:0x7e
v_cvt_pk_bf16_f32 v50,v12,v13
v_cvt_pk_bf16_f32 v51,v14,v15
v_or_b32 v16,v16,v17
ds_write_b128 v22,v[48:51] offset:0
s_waitcnt vmcnt(1)
v_pk_add_f32 v[12:13],v[68:69],v[88:89]
v_pk_add_f32 v[14:15],v[70:71],v[90:91]
v_bitop3_b32 v17,v68,v88,s57 bitop3:0x7e
v_cvt_pk_bf16_f32 v52,v12,v13
v_cvt_pk_bf16_f32 v53,v14,v15
v_or_b32 v16,v16,v17
s_waitcnt vmcnt(0)
v_pk_add_f32 v[12:13],v[72:73],v[92:93]
v_pk_add_f32 v[14:15],v[74:75],v[94:95]
v_bitop3_b32 v17,v72,v92,s57 bitop3:0x7e
v_cvt_pk_bf16_f32 v54,v12,v13
v_cvt_pk_bf16_f32 v55,v14,v15
v_bitop3_b32 v16,v16,v17,1 bitop3:0xa8
v_cmp_ne_u32 vcc,0,v16
ds_write_b128 v22,v[52:55] offset:1024
s_cbranch_vccnz fr_160
v_smfmac_f32_16x16x64_bf16 v[24:27],v[48:51],a[0:7],v2
ds_read_b128 v[72:75],v21 offset:0
s_and_b32 s60,s52,1
v_smfmac_f32_16x16x64_bf16 v[28:31],v[48:51],a[8:15],v2
ds_read_b128 v[76:79],v21 offset:1024
s_lshl2_add_u32 s60,s51,s60
v_smfmac_f32_16x16x64_bf16 v[32:35],v[48:51],a[16:23],v2
ds_read_b128 v[80:83],v21 offset:2048
s_mul_i32 s60,s60,49152
v_smfmac_f32_16x16x64_bf16 v[36:39],v[48:51],a[24:31],v2
ds_read_b128 v[84:87],v21 offset:3072
s_add_u32 s71,s60,s34
s_waitcnt lgkmcnt(4)
s_barrier
v_smfmac_f32_16x16x64_bf16 v[40:43],v[48:51],a[32:39],v2
ds_read_b128 v[60:63],v3 offset:0
v_smfmac_f32_16x16x64_bf16 v[24:27],v[52:55],a[40:47],v2
ds_read_b128 v[64:67],v3 offset:1024
v_smfmac_f32_16x16x64_bf16 v[28:31],v[52:55],a[48:55],v2
ds_read_b128 v[68:71],v4 offset:0
v_smfmac_f32_16x16x64_bf16 v[32:35],v[52:55],a[56:63],v2
v_smfmac_f32_16x16x64_bf16 v[36:39],v[52:55],a[64:71],v2
v_smfmac_f32_16x16x64_bf16 v[40:43],v[52:55],a[72:79],v2
s_waitcnt lgkmcnt(5)
v_smfmac_f32_16x16x64_bf16 v[44:47],v[48:51],v[72:79],v2
ds_read_b128 v[72:75],v21 offset:4096
s_waitcnt lgkmcnt(4)
v_smfmac_f32_16x16x64_bf16 v[44:47],v[52:55],v[80:87],v2
ds_read_b128 v[76:79],v21 offset:5120
s_waitcnt lgkmcnt(4)
v_smfmac_f32_16x16x64_bf16 v[24:27],v[60:63],a[80:87],v2
ds_read_b128 v[80:83],v21 offset:6144
v_smfmac_f32_16x16x64_bf16 v[28:31],v[60:63],a[88:95],v2
ds_read_b128 v[84:87],v21 offset:7168
v_smfmac_f32_16x16x64_bf16 v[32:35],v[60:63],a[96:103],v2
v_smfmac_f32_16x16x64_bf16 v[36:39],v[60:63],a[104:111],v2
v_smfmac_f32_16x16x64_bf16 v[40:43],v[60:63],a[112:119],v2
s_waitcnt lgkmcnt(2)
v_smfmac_f32_16x16x64_bf16 v[44:47],v[60:63],v[72:79],v2
ds_read_b128 v[60:63],v4 offset:1024
v_smfmac_f32_16x16x64_bf16 v[24:27],v[64:67],a[120:127],v2
ds_read_b128 v[72:75],v21 offset:8192
v_smfmac_f32_16x16x64_bf16 v[28:31],v[64:67],a[128:135],v2
ds_read_b128 v[76:79],v21 offset:9216
v_smfmac_f32_16x16x64_bf16 v[32:35],v[64:67],a[136:143],v2
v_smfmac_f32_16x16x64_bf16 v[36:39],v[64:67],a[144:151],v2
v_smfmac_f32_16x16x64_bf16 v[40:43],v[64:67],a[152:159],v2
s_waitcnt lgkmcnt(3)
v_smfmac_f32_16x16x64_bf16 v[44:47],v[64:67],v[80:87],v2
ds_read_b128 v[64:67],v5 offset:0
v_smfmac_f32_16x16x64_bf16 v[24:27],v[68:71],a[160:167],v2
ds_read_b128 v[80:83],v21 offset:10240
v_smfmac_f32_16x16x64_bf16 v[28:31],v[68:71],a[168:175],v2
ds_read_b128 v[84:87],v21 offset:11264
v_smfmac_f32_16x16x64_bf16 v[32:35],v[68:71],a[176:183],v2
v_smfmac_f32_16x16x64_bf16 v[36:39],v[68:71],a[184:191],v2
v_smfmac_f32_16x16x64_bf16 v[40:43],v[68:71],a[192:199],v2
s_waitcnt lgkmcnt(3)
v_smfmac_f32_16x16x64_bf16 v[44:47],v[68:71],v[72:79],v2
ds_read_b128 v[68:71],v5 offset:1024
v_smfmac_f32_16x16x64_bf16 v[24:27],v[60:63],a[200:207],v2
ds_read_b128 v[72:75],v21 offset:12288
v_smfmac_f32_16x16x64_bf16 v[28:31],v[60:63],a[208:215],v2
ds_read_b128 v[76:79],v21 offset:13312
v_smfmac_f32_16x16x64_bf16 v[32:35],v[60:63],a[216:223],v2
v_smfmac_f32_16x16x64_bf16 v[36:39],v[60:63],a[224:231],v2
v_smfmac_f32_16x16x64_bf16 v[40:43],v[60:63],a[232:239],v2
s_waitcnt lgkmcnt(3)
v_smfmac_f32_16x16x64_bf16 v[44:47],v[60:63],v[80:87],v2
ds_read_b128 v[60:63],v59 offset:0
v_smfmac_f32_16x16x64_bf16 v[24:27],v[64:67],a[240:247],v2
ds_read_b128 v[80:83],v21 offset:14336
v_smfmac_f32_16x16x64_bf16 v[28:31],v[64:67],a[248:255],v2
ds_read_b128 v[84:87],v21 offset:15360
v_smfmac_f32_16x16x64_bf16 v[32:35],v[64:67],v[112:119],v2
s_cmp_eq_u32 s79,-1
s_cbranch_scc1 pf_162
v_mov_b32 v17,1
s_mov_b64 exec,1
buffer_store_dword v17,v1,s[8:11],s79 offen sc1
s_mov_b64 exec,-1
s_mov_b32 s79,-1
pf_162:
v_smfmac_f32_16x16x64_bf16 v[36:39],v[64:67],v[120:127],v2
s_cmp_eq_u32 s78,-1
s_cbranch_scc1 pk_163
buffer_store_dwordx4 v[102:105],v6,s[8:11],s78 offen sc1
buffer_store_dwordx2 v[100:101],v7,s[8:11],s78 offen sc1
s_mov_b32 s79,s30
s_mov_b32 s78,-1
pk_163:
v_smfmac_f32_16x16x64_bf16 v[40:43],v[64:67],v[128:135],v2
s_waitcnt lgkmcnt(3)
v_smfmac_f32_16x16x64_bf16 v[44:47],v[64:67],v[72:79],v2
ds_read_b128 v[64:67],v59 offset:1024
v_smfmac_f32_16x16x64_bf16 v[24:27],v[68:71],v[136:143],v2
ds_read_b128 v[72:75],v21 offset:16384
v_smfmac_f32_16x16x64_bf16 v[28:31],v[68:71],v[144:151],v2
ds_read_b128 v[76:79],v21 offset:17408
v_smfmac_f32_16x16x64_bf16 v[32:35],v[68:71],v[152:159],v2
v_smfmac_f32_16x16x64_bf16 v[36:39],v[68:71],v[160:167],v2
v_smfmac_f32_16x16x64_bf16 v[40:43],v[68:71],v[168:175],v2
s_waitcnt lgkmcnt(3)
v_smfmac_f32_16x16x64_bf16 v[44:47],v[68:71],v[80:87],v2
ds_read_b128 v[80:83],v21 offset:18432
v_smfmac_f32_16x16x64_bf16 v[24:27],v[60:63],v[176:183],v2
ds_read_b128 v[84:87],v21 offset:19456
v_smfmac_f32_16x16x64_bf16 v[28:31],v[60:63],v[184:191],v2
s_waitcnt lgkmcnt(4)
v_smfmac_f32_16x16x64_bf16 v[24:27],v[64:67],v[216:223],v2
v_smfmac_f32_16x16x64_bf16 v[28:31],v[64:67],v[224:231],v2
v_smfmac_f32_16x16x64_bf16 v[32:35],v[60:63],v[192:199],v2
v_smfmac_f32_16x16x64_bf16 v[36:39],v[60:63],v[200:207],v2
s_nop 4
v_add_f32 v24,v24,v25
v_smfmac_f32_16x16x64_bf16 v[32:35],v[64:67],v[232:239],v2
v_add_f32 v26,v26,v27
v_smfmac_f32_16x16x64_bf16 v[36:39],v[64:67],v[240:247],v2
v_add_f32 v28,v28,v29
v_smfmac_f32_16x16x64_bf16 v[40:43],v[60:63],v[208:215],v2
v_add_f32 v30,v30,v31
s_waitcnt lgkmcnt(2)
v_smfmac_f32_16x16x64_bf16 v[44:47],v[60:63],v[72:79],v2
v_cvt_pk_bf16_f32 v100,v24,v26
v_smfmac_f32_16x16x64_bf16 v[40:43],v[64:67],v[248:255],v2
v_cvt_pk_bf16_f32 v101,v28,v30
s_waitcnt lgkmcnt(0)
v_smfmac_f32_16x16x64_bf16 v[44:47],v[64:67],v[80:87],v2
v_and_or_b32 v100,v100,-2,s57
buffer_store_dwordx2 v[100:101],v7,s[8:11],s71 offen sc1
v_add_f32 v32,v32,v33
v_add_f32 v34,v34,v35
v_add_f32 v36,v36,v37
v_add_f32 v38,v38,v39
v_cvt_pk_bf16_f32 v102,v32,v34
v_cvt_pk_bf16_f32 v103,v36,v38
v_and_or_b32 v102,v102,-2,s57
v_add_f32 v40,v40,v41
v_add_f32 v42,v42,v43
v_add_f32 v44,v44,v45
v_add_f32 v46,v46,v47
v_cvt_pk_bf16_f32 v104,v40,v42
v_cvt_pk_bf16_f32 v105,v44,v46
v_and_or_b32 v104,v104,-2,s57
buffer_store_dwordx4 v[102:105],v6,s[8:11],s71 offen sc1
s_lshl_b32 s60,s51,6
s_add_u32 s60,s60,s52
s_mul_i32 s78,s60,196608
s_add_u32 s78,s78,s85
s_lshl_b32 s60,s60,10
s_add_u32 s30,s60,s86
s_sub_u32 s60,s4,s5
s_cmp_gt_i32 s60,13
s_cselect_b32 s53,1,0
s_cmp_eq_u32 s4,64
s_cselect_b32 s53,1,s53
s_cmp_eq_u32 s53,0
s_cselect_b32 s54,s4,s5
s_addc_u32 s4,s4,0
s_add_u32 s5,s5,s53
s_and_b32 s60,s54,1
s_lshl2_add_u32 s60,s53,s60
s_lshl_b32 s68,s60,16
s_add_u32 s68,s68,s83
s_mul_i32 s59,s60,20480
s_add_u32 s59,s59,s6
s_lshl_b32 s69,s53,9
s_add_u32 s69,s69,s7
s_bfe_u32 s31,s54,65537
s_add_u32 s32,s54,1
s_cmp_lg_u32 s53,s51
s_cbranch_scc1 nx_164
s_waitcnt vmcnt(0)
s_cmp_eq_u32 s79,-1
s_cbranch_scc1 pf_165
v_mov_b32 v17,1
s_mov_b64 exec,1
buffer_store_dword v17,v1,s[8:11],s79 offen sc1
s_mov_b64 exec,-1
s_mov_b32 s79,-1
pf_165:
s_cmp_eq_u32 s78,-1
s_cbranch_scc1 pk_166
buffer_store_dwordx4 v[102:105],v6,s[8:11],s78 offen sc1
buffer_store_dwordx2 v[100:101],v7,s[8:11],s78 offen sc1
s_mov_b32 s79,s30
s_mov_b32 s78,-1
pk_166:
s_waitcnt vmcnt(0)
s_cmp_eq_u32 s79,-1
s_cbranch_scc1 pf_167
v_mov_b32 v17,1
s_mov_b64 exec,1
buffer_store_dword v17,v1,s[8:11],s79 offen sc1
s_mov_b64 exec,-1
s_mov_b32 s79,-1
pf_167:
nx_164:
s_add_u32 s50,s50,1
s_mov_b32 s51,s53
s_mov_b32 s52,s54
s_mov_b32 s57,s31
s_mov_b32 s58,s32
s_cmp_lt_u32 s50,128
s_cbranch_scc1 CV_LOOP_S1
s_branch CV_DONE
fr_160:
v_bitop3_b32 v12,v60,v64,s57 bitop3:0x7e
v_bitop3_b32 v13,v68,v72,s57 bitop3:0x7e
v_xor_b32 v14,s57,v76
v_or3_b32 v12,v12,v13,v14
v_and_b32 v12,1,v12
v_cmp_ne_u32 vcc,0,v12
s_cbranch_vccz sk_168
buffer_load_dwordx4 v[76:79],v18,s[8:11],s59 offen sc1
buffer_load_dwordx4 v[60:63],v1,s[8:11],s59 offen sc1
buffer_load_dwordx4 v[64:67],v1,s[8:11],s59 offen offset:1024 sc1
buffer_load_dwordx4 v[68:71],v1,s[8:11],s59 offen offset:2048 sc1
buffer_load_dwordx4 v[72:75],v1,s[8:11],s59 offen offset:3072 sc1
sk_168:
buffer_load_dwordx4 v[96:99],v18,s[8:11],s68 offen sc1
buffer_load_dwordx4 v[80:83],v1,s[8:11],s68 offen sc1
buffer_load_dwordx4 v[84:87],v1,s[8:11],s68 offen offset:1024 sc1
buffer_load_dwordx4 v[88:91],v1,s[8:11],s68 offen offset:2048 sc1
buffer_load_dwordx4 v[92:95],v1,s[8:11],s68 offen offset:3072 sc1
s_sub_u32 s47,s47,1
s_cbranch_scc1 ABORT
s_waitcnt lgkmcnt(0)
s_branch fa_159
CV_DONE:
s_add_u32 s61,s48,32
s_endpgm
ROLE_CW:
s_lshr_b32 s28,s48,3
s_and_b32 s29,s48,7
s_mul_i32 s82,s28,2097152
s_add_u32 s82,s82,2097152
v_lshlrev_b32 v1,4,v0
v_and_b32 v12,1,v0
v_mul_u32_u24 v2,0xaaaa,v12
v_or_b32 v2,0x4444,v2
v_lshrrev_b32 v14,4,v0
v_and_b32 v15,15,v0
v_min_u32 v3,11,v15
v_lshlrev_b32 v3,2,v3
v_lshl_add_u32 v3,v14,7,v3
s_mul_i32 s60,s46,24576
v_add_u32 v4,s60,v1
v_mul_u32_u24 v5,704,v14
v_lshl_add_u32 v5,v15,2,v5
s_mul_i32 s60,s46,2816
s_add_u32 s60,s60,98304
v_add_u32 v5,s60,v5
v_min_u32 v12,39,v0
s_mul_i32 s60,s46,40
v_add_u32 v12,s60,v12
v_lshlrev_b32 v9,4,v12
v_bfe_u32 v13,v12,1,3
v_mul_u32_u24 v6,352,v13
v_mul_u32_u24 v17,1280,v13
v_lshrrev_b32 v13,4,v12
v_lshl_add_u32 v6,v13,5,v6
v_lshl_add_u32 v17,v13,4,v17
v_and_b32 v13,1,v12
v_lshl_add_u32 v6,v13,4,v6
v_lshl_add_u32 v17,v13,3,v17
v_add_u32 v6,98304,v6
s_mov_b32 s88,-1
s_mov_b32 s89,0xff
s_mov_b32 s4,s18
s_mov_b32 s5,s19
s_mov_b32 s6,10240
s_mov_b32 s7,0x20000
s_mul_i32 s60,s29,160
buffer_load_dwordx2 v[32:33],v17,s[4:7],s60 offen
s_mul_i32 s84,s29,2560
s_add_u32 s84,s84,s82
s_lshl_b32 s83,s28,19
s_lshr_b32 s60,s29,1
s_lshl_b32 s61,s60,14
s_add_u32 s83,s83,s61
s_and_b32 s61,s29,1
s_mul_i32 s62,s61,2560
s_add_u32 s83,s83,s62
s_add_u32 s83,s83,10485760
s_lshl_b32 s85,s60,7
s_lshl_b32 s61,s61,2
s_add_u32 s61,s61,s46
s_lshl_b32 s61,s61,2
s_add_u32 s85,s85,s61
s_add_u32 s85,s85,s82
s_add_u32 s85,s85,950272
s_mul_i32 s33,s46,12288
s_add_u32 s33,s33,s82
s_add_u32 s33,s33,163840
s_mov_b32 s35,0
s_add_u32 s35,s35,s82
s_add_u32 s35,s35,951296
s_cmp_eq_u32 s28,0
s_cselect_b32 s63,0xffff0000,0
s_waitcnt vmcnt(0)
v_lshlrev_b32 v36,16,v32
v_and_b32 v36,s63,v36
v_and_b32 v37,s63,v32
v_lshlrev_b32 v38,16,v33
v_and_b32 v38,s63,v38
v_and_b32 v39,s63,v33
v_mov_b32 v40,-1
v_mov_b32 v41,-1
v_mov_b32 v42,-1
v_mov_b32 v43,-1
v_mov_b32 v44,1
s_mov_b64 exec,s[88:89]
s_add_u32 s60,s83,0
buffer_store_dwordx4 v[36:39],v9,s[8:11],s60 offen sc1
s_add_u32 s60,s83,8192
buffer_store_dwordx4 v[36:39],v9,s[8:11],s60 offen sc1
s_add_u32 s60,s83,65536
buffer_store_dwordx4 v[40:43],v9,s[8:11],s60 offen sc1
s_add_u32 s60,s83,73728
buffer_store_dwordx4 v[40:43],v9,s[8:11],s60 offen sc1
s_add_u32 s60,s83,131072
buffer_store_dwordx4 v[40:43],v9,s[8:11],s60 offen sc1
s_add_u32 s60,s83,139264
buffer_store_dwordx4 v[40:43],v9,s[8:11],s60 offen sc1
s_add_u32 s60,s83,196608
buffer_store_dwordx4 v[40:43],v9,s[8:11],s60 offen sc1
s_add_u32 s60,s83,204800
buffer_store_dwordx4 v[40:43],v9,s[8:11],s60 offen sc1
s_add_u32 s60,s83,262144
buffer_store_dwordx4 v[36:39],v9,s[8:11],s60 offen sc1
s_add_u32 s60,s83,270336
buffer_store_dwordx4 v[36:39],v9,s[8:11],s60 offen sc1
s_add_u32 s60,s83,327680
buffer_store_dwordx4 v[40:43],v9,s[8:11],s60 offen sc1
s_add_u32 s60,s83,335872
buffer_store_dwordx4 v[40:43],v9,s[8:11],s60 offen sc1
s_add_u32 s60,s83,393216
buffer_store_dwordx4 v[40:43],v9,s[8:11],s60 offen sc1
s_add_u32 s60,s83,401408
buffer_store_dwordx4 v[40:43],v9,s[8:11],s60 offen sc1
s_add_u32 s60,s83,458752
buffer_store_dwordx4 v[40:43],v9,s[8:11],s60 offen sc1
s_add_u32 s60,s83,466944
buffer_store_dwordx4 v[40:43],v9,s[8:11],s60 offen sc1
s_cmp_lg_u32 s49,0
s_cbranch_scc1 ls_169
s_add_u32 s60,s84,0
buffer_store_dwordx4 v[36:39],v9,s[8:11],s60 offen
s_add_u32 s60,s84,20480
buffer_store_dwordx4 v[40:43],v9,s[8:11],s60 offen
s_add_u32 s60,s84,40960
buffer_store_dwordx4 v[40:43],v9,s[8:11],s60 offen
s_add_u32 s60,s84,61440
buffer_store_dwordx4 v[40:43],v9,s[8:11],s60 offen
s_add_u32 s60,s84,81920
buffer_store_dwordx4 v[36:39],v9,s[8:11],s60 offen
s_add_u32 s60,s84,102400
buffer_store_dwordx4 v[40:43],v9,s[8:11],s60 offen
s_add_u32 s60,s84,122880
buffer_store_dwordx4 v[40:43],v9,s[8:11],s60 offen
s_add_u32 s60,s84,143360
buffer_store_dwordx4 v[40:43],v9,s[8:11],s60 offen
s_mov_b64 exec,1
buffer_store_dword v44,v1,s[8:11],s85 offen
buffer_store_dword v44,v1,s[8:11],s85 offen offset:512
s_branch ls_170
ls_169:
s_add_u32 s60,s84,0
buffer_store_dwordx4 v[36:39],v9,s[8:11],s60 offen sc1
s_add_u32 s60,s84,20480
buffer_store_dwordx4 v[40:43],v9,s[8:11],s60 offen sc1
s_add_u32 s60,s84,40960
buffer_store_dwordx4 v[40:43],v9,s[8:11],s60 offen sc1
s_add_u32 s60,s84,61440
buffer_store_dwordx4 v[40:43],v9,s[8:11],s60 offen sc1
s_add_u32 s60,s84,81920
buffer_store_dwordx4 v[36:39],v9,s[8:11],s60 offen sc1
s_add_u32 s60,s84,102400
buffer_store_dwordx4 v[40:43],v9,s[8:11],s60 offen sc1
s_add_u32 s60,s84,122880
buffer_store_dwordx4 v[40:43],v9,s[8:11],s60 offen sc1
s_add_u32 s60,s84,143360
buffer_store_dwordx4 v[40:43],v9,s[8:11],s60 offen sc1
s_mov_b64 exec,1
buffer_store_dword v44,v1,s[8:11],s85 offen sc1
buffer_store_dword v44,v1,s[8:11],s85 offen offset:512 sc1
ls_170:
s_mov_b64 exec,-1
s_waitcnt vmcnt(0)
s_barrier
s_cmp_lg_u32 s46,0
s_cbranch_scc1 arr_171
v_mov_b32 v12,1
s_lshl_b32 s3,s49,2
v_mov_b32 v13,s3
s_mov_b64 exec,1
buffer_atomic_add v12,v13,s[12:15],0 offen sc1
s_mov_b64 exec,-1
arr_171:
s_mov_b32 s4,s26
s_mov_b32 s5,s27
s_mov_b32 s6,7864320
s_mov_b32 s7,0x20000
s_lshl_b32 s60,s28,2
s_add_u32 s60,s60,s46
s_mul_i32 s73,s60,983040
s_mul_i32 s60,s29,160
s_add_u32 s73,s73,s60
s_mul_i32 s74,s46,40960
v_add_u32 v12,0,v0
v_mul_u32_u24 v13,6554,v12
v_lshrrev_b32 v13,16,v13
v_mul_u32_u24 v16,10,v13
v_sub_u32 v12,v12,v16
v_mul_u32_u24 v20,1280,v13
v_lshl_add_u32 v20,v12,4,v20
v_add_u32 v12,64,v0
v_mul_u32_u24 v13,6554,v12
v_lshrrev_b32 v13,16,v13
v_mul_u32_u24 v16,10,v13
v_sub_u32 v12,v12,v16
v_mul_u32_u24 v21,1280,v13
v_lshl_add_u32 v21,v12,4,v21
v_add_u32 v12,128,v0
v_mul_u32_u24 v13,6554,v12
v_lshrrev_b32 v13,16,v13
v_mul_u32_u24 v16,10,v13
v_sub_u32 v12,v12,v16
v_mul_u32_u24 v22,1280,v13
v_lshl_add_u32 v22,v12,4,v22
v_add_u32 v12,192,v0
v_mul_u32_u24 v13,6554,v12
v_lshrrev_b32 v13,16,v13
v_mul_u32_u24 v16,10,v13
v_sub_u32 v12,v12,v16
v_mul_u32_u24 v23,1280,v13
v_lshl_add_u32 v23,v12,4,v23
v_add_u32 v12,256,v0
v_mul_u32_u24 v13,6554,v12
v_lshrrev_b32 v13,16,v13
v_mul_u32_u24 v16,10,v13
v_sub_u32 v12,v12,v16
v_mul_u32_u24 v24,1280,v13
v_lshl_add_u32 v24,v12,4,v24
v_add_u32 v12,320,v0
v_mul_u32_u24 v13,6554,v12
v_lshrrev_b32 v13,16,v13
v_mul_u32_u24 v16,10,v13
v_sub_u32 v12,v12,v16
v_mul_u32_u24 v25,1280,v13
v_lshl_add_u32 v25,v12,4,v25
v_add_u32 v12,384,v0
v_mul_u32_u24 v13,6554,v12
v_lshrrev_b32 v13,16,v13
v_mul_u32_u24 v16,10,v13
v_sub_u32 v12,v12,v16
v_mul_u32_u24 v26,1280,v13
v_lshl_add_u32 v26,v12,4,v26
v_add_u32 v12,448,v0
v_mul_u32_u24 v13,6554,v12
v_lshrrev_b32 v13,16,v13
v_mul_u32_u24 v16,10,v13
v_sub_u32 v12,v12,v16
v_mul_u32_u24 v27,1280,v13
v_lshl_add_u32 v27,v12,4,v27
v_add_u32 v12,512,v0
v_mul_u32_u24 v13,6554,v12
v_lshrrev_b32 v13,16,v13
v_mul_u32_u24 v16,10,v13
v_sub_u32 v12,v12,v16
v_mul_u32_u24 v28,1280,v13
v_lshl_add_u32 v28,v12,4,v28
v_add_u32 v12,576,v0
v_mul_u32_u24 v13,6554,v12
v_lshrrev_b32 v13,16,v13
v_mul_u32_u24 v16,10,v13
v_sub_u32 v12,v12,v16
v_mul_u32_u24 v29,1280,v13
v_lshl_add_u32 v29,v12,4,v29
v_lshrrev_b32 v14,4,v0
v_and_b32 v12,1,v14
v_lshlrev_b32 v12,5,v12
v_lshrrev_b32 v13,1,v14
v_lshl_add_u32 v12,v13,2,v12
v_bfe_u32 v13,v0,2,1
v_add_u32 v12,v12,v13
v_bfe_u32 v13,v0,3,1
v_lshl_add_u32 v12,v13,4,v12
v_mul_u32_u24 v30,160,v12
v_and_b32 v13,3,v0
v_lshl_add_u32 v30,v13,3,v30
v_add_u32 v30,s74,v30
s_add_u32 s61,s73,0
s_add_u32 m0,s74,0
s_nop 0
buffer_load_dwordx4 v20,s[4:7],s61 offen lds
s_add_u32 m0,s74,1024
s_nop 0
buffer_load_dwordx4 v21,s[4:7],s61 offen lds
s_add_u32 m0,s74,2048
s_nop 0
buffer_load_dwordx4 v22,s[4:7],s61 offen lds
s_add_u32 m0,s74,3072
s_nop 0
buffer_load_dwordx4 v23,s[4:7],s61 offen lds
s_add_u32 m0,s74,4096
s_nop 0
buffer_load_dwordx4 v24,s[4:7],s61 offen lds
s_add_u32 m0,s74,5120
s_nop 0
buffer_load_dwordx4 v25,s[4:7],s61 offen lds
s_add_u32 m0,s74,6144
s_nop 0
buffer_load_dwordx4 v26,s[4:7],s61 offen lds
s_add_u32 m0,s74,7168
s_nop 0
buffer_load_dwordx4 v27,s[4:7],s61 offen lds
s_add_u32 m0,s74,8192
s_nop 0
buffer_load_dwordx4 v28,s[4:7],s61 offen lds
s_add_u32 m0,s74,9216
s_nop 0
buffer_load_dwordx4 v29,s[4:7],s61 offen lds
s_add_u32 s61,s73,81920
s_add_u32 m0,s74,10240
s_nop 0
buffer_load_dwordx4 v20,s[4:7],s61 offen lds
s_add_u32 m0,s74,11264
s_nop 0
buffer_load_dwordx4 v21,s[4:7],s61 offen lds
s_add_u32 m0,s74,12288
s_nop 0
buffer_load_dwordx4 v22,s[4:7],s61 offen lds
s_add_u32 m0,s74,13312
s_nop 0
buffer_load_dwordx4 v23,s[4:7],s61 offen lds
s_add_u32 m0,s74,14336
s_nop 0
buffer_load_dwordx4 v24,s[4:7],s61 offen lds
s_add_u32 m0,s74,15360
s_nop 0
buffer_load_dwordx4 v25,s[4:7],s61 offen lds
s_add_u32 m0,s74,16384
s_nop 0
buffer_load_dwordx4 v26,s[4:7],s61 offen lds
s_add_u32 m0,s74,17408
s_nop 0
buffer_load_dwordx4 v27,s[4:7],s61 offen lds
s_add_u32 m0,s74,18432
s_nop 0
buffer_load_dwordx4 v28,s[4:7],s61 offen lds
s_add_u32 m0,s74,19456
s_nop 0
buffer_load_dwordx4 v29,s[4:7],s61 offen lds
s_add_u32 s61,s73,163840
s_add_u32 m0,s74,20480
s_nop 0
buffer_load_dwordx4 v20,s[4:7],s61 offen lds
s_add_u32 m0,s74,21504
s_nop 0
buffer_load_dwordx4 v21,s[4:7],s61 offen lds
s_add_u32 m0,s74,22528
s_nop 0
buffer_load_dwordx4 v22,s[4:7],s61 offen lds
s_add_u32 m0,s74,23552
s_nop 0
buffer_load_dwordx4 v23,s[4:7],s61 offen lds
s_add_u32 m0,s74,24576
s_nop 0
buffer_load_dwordx4 v24,s[4:7],s61 offen lds
s_add_u32 m0,s74,25600
s_nop 0
buffer_load_dwordx4 v25,s[4:7],s61 offen lds
s_add_u32 m0,s74,26624
s_nop 0
buffer_load_dwordx4 v26,s[4:7],s61 offen lds
s_add_u32 m0,s74,27648
s_nop 0
buffer_load_dwordx4 v27,s[4:7],s61 offen lds
s_add_u32 m0,s74,28672
s_nop 0
buffer_load_dwordx4 v28,s[4:7],s61 offen lds
s_add_u32 m0,s74,29696
s_nop 0
buffer_load_dwordx4 v29,s[4:7],s61 offen lds
s_add_u32 s61,s73,245760
s_add_u32 m0,s74,30720
s_nop 0
buffer_load_dwordx4 v20,s[4:7],s61 offen lds
s_add_u32 m0,s74,31744
s_nop 0
buffer_load_dwordx4 v21,s[4:7],s61 offen lds
s_add_u32 m0,s74,32768
s_nop 0
buffer_load_dwordx4 v22,s[4:7],s61 offen lds
s_add_u32 m0,s74,33792
s_nop 0
buffer_load_dwordx4 v23,s[4:7],s61 offen lds
s_add_u32 m0,s74,34816
s_nop 0
buffer_load_dwordx4 v24,s[4:7],s61 offen lds
s_add_u32 m0,s74,35840
s_nop 0
buffer_load_dwordx4 v25,s[4:7],s61 offen lds
s_add_u32 m0,s74,36864
s_nop 0
buffer_load_dwordx4 v26,s[4:7],s61 offen lds
s_add_u32 m0,s74,37888
s_nop 0
buffer_load_dwordx4 v27,s[4:7],s61 offen lds
s_add_u32 m0,s74,38912
s_nop 0
buffer_load_dwordx4 v28,s[4:7],s61 offen lds
s_add_u32 m0,s74,39936
s_nop 0
buffer_load_dwordx4 v29,s[4:7],s61 offen lds
s_waitcnt vmcnt(30)
ds_read_b64_tr_b16 a[0:1],v30 offset:0
ds_read_b64_tr_b16 a[2:3],v30 offset:320
ds_read_b64_tr_b16 a[4:5],v30 offset:1280
ds_read_b64_tr_b16 a[6:7],v30 offset:1600
ds_read_b64_tr_b16 a[8:9],v30 offset:32
ds_read_b64_tr_b16 a[10:11],v30 offset:352
ds_read_b64_tr_b16 a[12:13],v30 offset:1312
ds_read_b64_tr_b16 a[14:15],v30 offset:1632
ds_read_b64_tr_b16 a[16:17],v30 offset:64
ds_read_b64_tr_b16 a[18:19],v30 offset:384
ds_read_b64_tr_b16 a[20:21],v30 offset:1344
ds_read_b64_tr_b16 a[22:23],v30 offset:1664
s_waitcnt lgkmcnt(4)
ds_read_b64_tr_b16 a[24:25],v30 offset:96
ds_read_b64_tr_b16 a[26:27],v30 offset:416
ds_read_b64_tr_b16 a[28:29],v30 offset:1376
ds_read_b64_tr_b16 a[30:31],v30 offset:1696
ds_read_b64_tr_b16 v[32:33],v30 offset:128
ds_read_b64_tr_b16 v[34:35],v30 offset:448
ds_read_b64_tr_b16 v[36:37],v30 offset:1408
ds_read_b64_tr_b16 v[38:39],v30 offset:1728
s_waitcnt lgkmcnt(0)
s_add_u32 s61,s73,327680
s_add_u32 m0,s74,0
s_nop 0
buffer_load_dwordx4 v20,s[4:7],s61 offen lds
s_add_u32 m0,s74,1024
s_nop 0
buffer_load_dwordx4 v21,s[4:7],s61 offen lds
s_add_u32 m0,s74,2048
s_nop 0
buffer_load_dwordx4 v22,s[4:7],s61 offen lds
s_add_u32 m0,s74,3072
s_nop 0
buffer_load_dwordx4 v23,s[4:7],s61 offen lds
s_add_u32 m0,s74,4096
s_nop 0
buffer_load_dwordx4 v24,s[4:7],s61 offen lds
s_add_u32 m0,s74,5120
s_nop 0
buffer_load_dwordx4 v25,s[4:7],s61 offen lds
s_add_u32 m0,s74,6144
s_nop 0
buffer_load_dwordx4 v26,s[4:7],s61 offen lds
s_add_u32 m0,s74,7168
s_nop 0
buffer_load_dwordx4 v27,s[4:7],s61 offen lds
s_add_u32 m0,s74,8192
s_nop 0
buffer_load_dwordx4 v28,s[4:7],s61 offen lds
s_add_u32 m0,s74,9216
s_nop 0
buffer_load_dwordx4 v29,s[4:7],s61 offen lds
s_waitcnt vmcnt(30)
ds_read_b64_tr_b16 a[32:33],v30 offset:10240
ds_read_b64_tr_b16 a[34:35],v30 offset:10560
ds_read_b64_tr_b16 a[36:37],v30 offset:11520
ds_read_b64_tr_b16 a[38:39],v30 offset:11840
ds_read_b64_tr_b16 a[40:41],v30 offset:10272
ds_read_b64_tr_b16 a[42:43],v30 offset:10592
ds_read_b64_tr_b16 a[44:45],v30 offset:11552
ds_read_b64_tr_b16 a[46:47],v30 offset:11872
ds_read_b64_tr_b16 a[48:49],v30 offset:10304
ds_read_b64_tr_b16 a[50:51],v30 offset:10624
ds_read_b64_tr_b16 a[52:53],v30 offset:11584
ds_read_b64_tr_b16 a[54:55],v30 offset:11904
s_waitcnt lgkmcnt(4)
ds_read_b64_tr_b16 a[56:57],v30 offset:10336
ds_read_b64_tr_b16 a[58:59],v30 offset:10656
ds_read_b64_tr_b16 a[60:61],v30 offset:11616
ds_read_b64_tr_b16 a[62:63],v30 offset:11936
ds_read_b64_tr_b16 v[40:41],v30 offset:10368
ds_read_b64_tr_b16 v[42:43],v30 offset:10688
ds_read_b64_tr_b16 v[44:45],v30 offset:11648
ds_read_b64_tr_b16 v[46:47],v30 offset:11968
s_waitcnt lgkmcnt(0)
s_add_u32 s61,s73,409600
s_add_u32 m0,s74,10240
s_nop 0
buffer_load_dwordx4 v20,s[4:7],s61 offen lds
s_add_u32 m0,s74,11264
s_nop 0
buffer_load_dwordx4 v21,s[4:7],s61 offen lds
s_add_u32 m0,s74,12288
s_nop 0
buffer_load_dwordx4 v22,s[4:7],s61 offen lds
s_add_u32 m0,s74,13312
s_nop 0
buffer_load_dwordx4 v23,s[4:7],s61 offen lds
s_add_u32 m0,s74,14336
s_nop 0
buffer_load_dwordx4 v24,s[4:7],s61 offen lds
s_add_u32 m0,s74,15360
s_nop 0
buffer_load_dwordx4 v25,s[4:7],s61 offen lds
s_add_u32 m0,s74,16384
s_nop 0
buffer_load_dwordx4 v26,s[4:7],s61 offen lds
s_add_u32 m0,s74,17408
s_nop 0
buffer_load_dwordx4 v27,s[4:7],s61 offen lds
s_add_u32 m0,s74,18432
s_nop 0
buffer_load_dwordx4 v28,s[4:7],s61 offen lds
s_add_u32 m0,s74,19456
s_nop 0
buffer_load_dwordx4 v29,s[4:7],s61 offen lds
s_waitcnt vmcnt(30)
ds_read_b64_tr_b16 a[64:65],v30 offset:20480
ds_read_b64_tr_b16 a[66:67],v30 offset:20800
ds_read_b64_tr_b16 a[68:69],v30 offset:21760
ds_read_b64_tr_b16 a[70:71],v30 offset:22080
ds_read_b64_tr_b16 a[72:73],v30 offset:20512
ds_read_b64_tr_b16 a[74:75],v30 offset:20832
ds_read_b64_tr_b16 a[76:77],v30 offset:21792
ds_read_b64_tr_b16 a[78:79],v30 offset:22112
ds_read_b64_tr_b16 a[80:81],v30 offset:20544
ds_read_b64_tr_b16 a[82:83],v30 offset:20864
ds_read_b64_tr_b16 a[84:85],v30 offset:21824
ds_read_b64_tr_b16 a[86:87],v30 offset:22144
s_waitcnt lgkmcnt(4)
ds_read_b64_tr_b16 a[88:89],v30 offset:20576
ds_read_b64_tr_b16 a[90:91],v30 offset:20896
ds_read_b64_tr_b16 a[92:93],v30 offset:21856
ds_read_b64_tr_b16 a[94:95],v30 offset:22176
ds_read_b64_tr_b16 v[48:49],v30 offset:20608
ds_read_b64_tr_b16 v[50:51],v30 offset:20928
ds_read_b64_tr_b16 v[52:53],v30 offset:21888
ds_read_b64_tr_b16 v[54:55],v30 offset:22208
s_waitcnt lgkmcnt(0)
s_add_u32 s61,s73,491520
s_add_u32 m0,s74,20480
s_nop 0
buffer_load_dwordx4 v20,s[4:7],s61 offen lds
s_add_u32 m0,s74,21504
s_nop 0
buffer_load_dwordx4 v21,s[4:7],s61 offen lds
s_add_u32 m0,s74,22528
s_nop 0
buffer_load_dwordx4 v22,s[4:7],s61 offen lds
s_add_u32 m0,s74,23552
s_nop 0
buffer_load_dwordx4 v23,s[4:7],s61 offen lds
s_add_u32 m0,s74,24576
s_nop 0
buffer_load_dwordx4 v24,s[4:7],s61 offen lds
s_add_u32 m0,s74,25600
s_nop 0
buffer_load_dwordx4 v25,s[4:7],s61 offen lds
s_add_u32 m0,s74,26624
s_nop 0
buffer_load_dwordx4 v26,s[4:7],s61 offen lds
s_add_u32 m0,s74,27648
s_nop 0
buffer_load_dwordx4 v27,s[4:7],s61 offen lds
s_add_u32 m0,s74,28672
s_nop 0
buffer_load_dwordx4 v28,s[4:7],s61 offen lds
s_add_u32 m0,s74,29696
s_nop 0
buffer_load_dwordx4 v29,s[4:7],s61 offen lds
s_waitcnt vmcnt(30)
ds_read_b64_tr_b16 a[96:97],v30 offset:30720
ds_read_b64_tr_b16 a[98:99],v30 offset:31040
ds_read_b64_tr_b16 a[100:101],v30 offset:32000
ds_read_b64_tr_b16 a[102:103],v30 offset:32320
ds_read_b64_tr_b16 a[104:105],v30 offset:30752
ds_read_b64_tr_b16 a[106:107],v30 offset:31072
ds_read_b64_tr_b16 a[108:109],v30 offset:32032
ds_read_b64_tr_b16 a[110:111],v30 offset:32352
ds_read_b64_tr_b16 a[112:113],v30 offset:30784
ds_read_b64_tr_b16 a[114:115],v30 offset:31104
ds_read_b64_tr_b16 a[116:117],v30 offset:32064
ds_read_b64_tr_b16 a[118:119],v30 offset:32384
s_waitcnt lgkmcnt(4)
ds_read_b64_tr_b16 a[120:121],v30 offset:30816
ds_read_b64_tr_b16 a[122:123],v30 offset:31136
ds_read_b64_tr_b16 a[124:125],v30 offset:32096
ds_read_b64_tr_b16 a[126:127],v30 offset:32416
ds_read_b64_tr_b16 v[56:57],v30 offset:30848
ds_read_b64_tr_b16 v[58:59],v30 offset:31168
ds_read_b64_tr_b16 v[60:61],v30 offset:32128
ds_read_b64_tr_b16 v[62:63],v30 offset:32448
s_waitcnt lgkmcnt(0)
s_add_u32 s61,s73,573440
s_add_u32 m0,s74,30720
s_nop 0
buffer_load_dwordx4 v20,s[4:7],s61 offen lds
s_add_u32 m0,s74,31744
s_nop 0
buffer_load_dwordx4 v21,s[4:7],s61 offen lds
s_add_u32 m0,s74,32768
s_nop 0
buffer_load_dwordx4 v22,s[4:7],s61 offen lds
s_add_u32 m0,s74,33792
s_nop 0
buffer_load_dwordx4 v23,s[4:7],s61 offen lds
s_add_u32 m0,s74,34816
s_nop 0
buffer_load_dwordx4 v24,s[4:7],s61 offen lds
s_add_u32 m0,s74,35840
s_nop 0
buffer_load_dwordx4 v25,s[4:7],s61 offen lds
s_add_u32 m0,s74,36864
s_nop 0
buffer_load_dwordx4 v26,s[4:7],s61 offen lds
s_add_u32 m0,s74,37888
s_nop 0
buffer_load_dwordx4 v27,s[4:7],s61 offen lds
s_add_u32 m0,s74,38912
s_nop 0
buffer_load_dwordx4 v28,s[4:7],s61 offen lds
s_add_u32 m0,s74,39936
s_nop 0
buffer_load_dwordx4 v29,s[4:7],s61 offen lds
s_waitcnt vmcnt(30)
ds_read_b64_tr_b16 a[128:129],v30 offset:0
ds_read_b64_tr_b16 a[130:131],v30 offset:320
ds_read_b64_tr_b16 a[132:133],v30 offset:1280
ds_read_b64_tr_b16 a[134:135],v30 offset:1600
ds_read_b64_tr_b16 a[136:137],v30 offset:32
ds_read_b64_tr_b16 a[138:139],v30 offset:352
ds_read_b64_tr_b16 a[140:141],v30 offset:1312
ds_read_b64_tr_b16 a[142:143],v30 offset:1632
ds_read_b64_tr_b16 a[144:145],v30 offset:64
ds_read_b64_tr_b16 a[146:147],v30 offset:384
ds_read_b64_tr_b16 a[148:149],v30 offset:1344
ds_read_b64_tr_b16 a[150:151],v30 offset:1664
s_waitcnt lgkmcnt(4)
ds_read_b64_tr_b16 a[152:153],v30 offset:96
ds_read_b64_tr_b16 a[154:155],v30 offset:416
ds_read_b64_tr_b16 a[156:157],v30 offset:1376
ds_read_b64_tr_b16 a[158:159],v30 offset:1696
ds_read_b64_tr_b16 v[64:65],v30 offset:128
ds_read_b64_tr_b16 v[66:67],v30 offset:448
ds_read_b64_tr_b16 v[68:69],v30 offset:1408
ds_read_b64_tr_b16 v[70:71],v30 offset:1728
s_waitcnt lgkmcnt(0)
s_add_u32 s61,s73,655360
s_add_u32 m0,s74,0
s_nop 0
buffer_load_dwordx4 v20,s[4:7],s61 offen lds
s_add_u32 m0,s74,1024
s_nop 0
buffer_load_dwordx4 v21,s[4:7],s61 offen lds
s_add_u32 m0,s74,2048
s_nop 0
buffer_load_dwordx4 v22,s[4:7],s61 offen lds
s_add_u32 m0,s74,3072
s_nop 0
buffer_load_dwordx4 v23,s[4:7],s61 offen lds
s_add_u32 m0,s74,4096
s_nop 0
buffer_load_dwordx4 v24,s[4:7],s61 offen lds
s_add_u32 m0,s74,5120
s_nop 0
buffer_load_dwordx4 v25,s[4:7],s61 offen lds
s_add_u32 m0,s74,6144
s_nop 0
buffer_load_dwordx4 v26,s[4:7],s61 offen lds
s_add_u32 m0,s74,7168
s_nop 0
buffer_load_dwordx4 v27,s[4:7],s61 offen lds
s_add_u32 m0,s74,8192
s_nop 0
buffer_load_dwordx4 v28,s[4:7],s61 offen lds
s_add_u32 m0,s74,9216
s_nop 0
buffer_load_dwordx4 v29,s[4:7],s61 offen lds
s_waitcnt vmcnt(30)
ds_read_b64_tr_b16 a[160:161],v30 offset:10240
ds_read_b64_tr_b16 a[162:163],v30 offset:10560
ds_read_b64_tr_b16 a[164:165],v30 offset:11520
ds_read_b64_tr_b16 a[166:167],v30 offset:11840
ds_read_b64_tr_b16 a[168:169],v30 offset:10272
ds_read_b64_tr_b16 a[170:171],v30 offset:10592
ds_read_b64_tr_b16 a[172:173],v30 offset:11552
ds_read_b64_tr_b16 a[174:175],v30 offset:11872
ds_read_b64_tr_b16 a[176:177],v30 offset:10304
ds_read_b64_tr_b16 a[178:179],v30 offset:10624
ds_read_b64_tr_b16 a[180:181],v30 offset:11584
ds_read_b64_tr_b16 a[182:183],v30 offset:11904
s_waitcnt lgkmcnt(4)
ds_read_b64_tr_b16 a[184:185],v30 offset:10336
ds_read_b64_tr_b16 a[186:187],v30 offset:10656
ds_read_b64_tr_b16 a[188:189],v30 offset:11616
ds_read_b64_tr_b16 a[190:191],v30 offset:11936
ds_read_b64_tr_b16 v[72:73],v30 offset:10368
ds_read_b64_tr_b16 v[74:75],v30 offset:10688
ds_read_b64_tr_b16 v[76:77],v30 offset:11648
ds_read_b64_tr_b16 v[78:79],v30 offset:11968
s_waitcnt lgkmcnt(0)
s_add_u32 s61,s73,737280
s_add_u32 m0,s74,10240
s_nop 0
buffer_load_dwordx4 v20,s[4:7],s61 offen lds
s_add_u32 m0,s74,11264
s_nop 0
buffer_load_dwordx4 v21,s[4:7],s61 offen lds
s_add_u32 m0,s74,12288
s_nop 0
buffer_load_dwordx4 v22,s[4:7],s61 offen lds
s_add_u32 m0,s74,13312
s_nop 0
buffer_load_dwordx4 v23,s[4:7],s61 offen lds
s_add_u32 m0,s74,14336
s_nop 0
buffer_load_dwordx4 v24,s[4:7],s61 offen lds
s_add_u32 m0,s74,15360
s_nop 0
buffer_load_dwordx4 v25,s[4:7],s61 offen lds
s_add_u32 m0,s74,16384
s_nop 0
buffer_load_dwordx4 v26,s[4:7],s61 offen lds
s_add_u32 m0,s74,17408
s_nop 0
buffer_load_dwordx4 v27,s[4:7],s61 offen lds
s_add_u32 m0,s74,18432
s_nop 0
buffer_load_dwordx4 v28,s[4:7],s61 offen lds
s_add_u32 m0,s74,19456
s_nop 0
buffer_load_dwordx4 v29,s[4:7],s61 offen lds
s_waitcnt vmcnt(30)
ds_read_b64_tr_b16 a[192:193],v30 offset:20480
ds_read_b64_tr_b16 a[194:195],v30 offset:20800
ds_read_b64_tr_b16 a[196:197],v30 offset:21760
ds_read_b64_tr_b16 a[198:199],v30 offset:22080
ds_read_b64_tr_b16 a[200:201],v30 offset:20512
ds_read_b64_tr_b16 a[202:203],v30 offset:20832
ds_read_b64_tr_b16 a[204:205],v30 offset:21792
ds_read_b64_tr_b16 a[206:207],v30 offset:22112
ds_read_b64_tr_b16 a[208:209],v30 offset:20544
ds_read_b64_tr_b16 a[210:211],v30 offset:20864
ds_read_b64_tr_b16 a[212:213],v30 offset:21824
ds_read_b64_tr_b16 a[214:215],v30 offset:22144
s_waitcnt lgkmcnt(4)
ds_read_b64_tr_b16 a[216:217],v30 offset:20576
ds_read_b64_tr_b16 a[218:219],v30 offset:20896
ds_read_b64_tr_b16 a[220:221],v30 offset:21856
ds_read_b64_tr_b16 a[222:223],v30 offset:22176
ds_read_b64_tr_b16 v[80:81],v30 offset:20608
ds_read_b64_tr_b16 v[82:83],v30 offset:20928
ds_read_b64_tr_b16 v[84:85],v30 offset:21888
ds_read_b64_tr_b16 v[86:87],v30 offset:22208
s_waitcnt lgkmcnt(0)
s_add_u32 s61,s73,819200
s_add_u32 m0,s74,20480
s_nop 0
buffer_load_dwordx4 v20,s[4:7],s61 offen lds
s_add_u32 m0,s74,21504
s_nop 0
buffer_load_dwordx4 v21,s[4:7],s61 offen lds
s_add_u32 m0,s74,22528
s_nop 0
buffer_load_dwordx4 v22,s[4:7],s61 offen lds
s_add_u32 m0,s74,23552
s_nop 0
buffer_load_dwordx4 v23,s[4:7],s61 offen lds
s_add_u32 m0,s74,24576
s_nop 0
buffer_load_dwordx4 v24,s[4:7],s61 offen lds
s_add_u32 m0,s74,25600
s_nop 0
buffer_load_dwordx4 v25,s[4:7],s61 offen lds
s_add_u32 m0,s74,26624
s_nop 0
buffer_load_dwordx4 v26,s[4:7],s61 offen lds
s_add_u32 m0,s74,27648
s_nop 0
buffer_load_dwordx4 v27,s[4:7],s61 offen lds
s_add_u32 m0,s74,28672
s_nop 0
buffer_load_dwordx4 v28,s[4:7],s61 offen lds
s_add_u32 m0,s74,29696
s_nop 0
buffer_load_dwordx4 v29,s[4:7],s61 offen lds
s_waitcnt vmcnt(30)
ds_read_b64_tr_b16 a[224:225],v30 offset:30720
ds_read_b64_tr_b16 a[226:227],v30 offset:31040
ds_read_b64_tr_b16 a[228:229],v30 offset:32000
ds_read_b64_tr_b16 a[230:231],v30 offset:32320
ds_read_b64_tr_b16 a[232:233],v30 offset:30752
ds_read_b64_tr_b16 a[234:235],v30 offset:31072
ds_read_b64_tr_b16 a[236:237],v30 offset:32032
ds_read_b64_tr_b16 a[238:239],v30 offset:32352
ds_read_b64_tr_b16 a[240:241],v30 offset:30784
ds_read_b64_tr_b16 a[242:243],v30 offset:31104
ds_read_b64_tr_b16 a[244:245],v30 offset:32064
ds_read_b64_tr_b16 a[246:247],v30 offset:32384
s_waitcnt lgkmcnt(4)
ds_read_b64_tr_b16 a[248:249],v30 offset:30816
ds_read_b64_tr_b16 a[250:251],v30 offset:31136
ds_read_b64_tr_b16 a[252:253],v30 offset:32096
ds_read_b64_tr_b16 a[254:255],v30 offset:32416
ds_read_b64_tr_b16 v[88:89],v30 offset:30848
ds_read_b64_tr_b16 v[90:91],v30 offset:31168
ds_read_b64_tr_b16 v[92:93],v30 offset:32128
ds_read_b64_tr_b16 v[94:95],v30 offset:32448
s_waitcnt lgkmcnt(0)
s_add_u32 s61,s73,901120
s_add_u32 m0,s74,30720
s_nop 0
buffer_load_dwordx4 v20,s[4:7],s61 offen lds
s_add_u32 m0,s74,31744
s_nop 0
buffer_load_dwordx4 v21,s[4:7],s61 offen lds
s_add_u32 m0,s74,32768
s_nop 0
buffer_load_dwordx4 v22,s[4:7],s61 offen lds
s_add_u32 m0,s74,33792
s_nop 0
buffer_load_dwordx4 v23,s[4:7],s61 offen lds
s_add_u32 m0,s74,34816
s_nop 0
buffer_load_dwordx4 v24,s[4:7],s61 offen lds
s_add_u32 m0,s74,35840
s_nop 0
buffer_load_dwordx4 v25,s[4:7],s61 offen lds
s_add_u32 m0,s74,36864
s_nop 0
buffer_load_dwordx4 v26,s[4:7],s61 offen lds
s_add_u32 m0,s74,37888
s_nop 0
buffer_load_dwordx4 v27,s[4:7],s61 offen lds
s_add_u32 m0,s74,38912
s_nop 0
buffer_load_dwordx4 v28,s[4:7],s61 offen lds
s_add_u32 m0,s74,39936
s_nop 0
buffer_load_dwordx4 v29,s[4:7],s61 offen lds
s_waitcnt vmcnt(30)
ds_read_b64_tr_b16 v[128:129],v30 offset:0
ds_read_b64_tr_b16 v[130:131],v30 offset:320
ds_read_b64_tr_b16 v[132:133],v30 offset:1280
ds_read_b64_tr_b16 v[134:135],v30 offset:1600
ds_read_b64_tr_b16 v[136:137],v30 offset:32
ds_read_b64_tr_b16 v[138:139],v30 offset:352
ds_read_b64_tr_b16 v[140:141],v30 offset:1312
ds_read_b64_tr_b16 v[142:143],v30 offset:1632
ds_read_b64_tr_b16 v[144:145],v30 offset:64
ds_read_b64_tr_b16 v[146:147],v30 offset:384
ds_read_b64_tr_b16 v[148:149],v30 offset:1344
ds_read_b64_tr_b16 v[150:151],v30 offset:1664
s_waitcnt lgkmcnt(4)
ds_read_b64_tr_b16 v[152:153],v30 offset:96
ds_read_b64_tr_b16 v[154:155],v30 offset:416
ds_read_b64_tr_b16 v[156:157],v30 offset:1376
ds_read_b64_tr_b16 v[158:159],v30 offset:1696
ds_read_b64_tr_b16 v[96:97],v30 offset:128
ds_read_b64_tr_b16 v[98:99],v30 offset:448
ds_read_b64_tr_b16 v[100:101],v30 offset:1408
ds_read_b64_tr_b16 v[102:103],v30 offset:1728
s_waitcnt lgkmcnt(0)
s_waitcnt vmcnt(20)
ds_read_b64_tr_b16 v[160:161],v30 offset:10240
ds_read_b64_tr_b16 v[162:163],v30 offset:10560
ds_read_b64_tr_b16 v[164:165],v30 offset:11520
ds_read_b64_tr_b16 v[166:167],v30 offset:11840
ds_read_b64_tr_b16 v[168:169],v30 offset:10272
ds_read_b64_tr_b16 v[170:171],v30 offset:10592
ds_read_b64_tr_b16 v[172:173],v30 offset:11552
ds_read_b64_tr_b16 v[174:175],v30 offset:11872
ds_read_b64_tr_b16 v[176:177],v30 offset:10304
ds_read_b64_tr_b16 v[178:179],v30 offset:10624
ds_read_b64_tr_b16 v[180:181],v30 offset:11584
ds_read_b64_tr_b16 v[182:183],v30 offset:11904
s_waitcnt lgkmcnt(4)
ds_read_b64_tr_b16 v[184:185],v30 offset:10336
ds_read_b64_tr_b16 v[186:187],v30 offset:10656
ds_read_b64_tr_b16 v[188:189],v30 offset:11616
ds_read_b64_tr_b16 v[190:191],v30 offset:11936
ds_read_b64_tr_b16 v[104:105],v30 offset:10368
ds_read_b64_tr_b16 v[106:107],v30 offset:10688
ds_read_b64_tr_b16 v[108:109],v30 offset:11648
ds_read_b64_tr_b16 v[110:111],v30 offset:11968
s_waitcnt lgkmcnt(0)
s_waitcnt vmcnt(10)
ds_read_b64_tr_b16 v[192:193],v30 offset:20480
ds_read_b64_tr_b16 v[194:195],v30 offset:20800
ds_read_b64_tr_b16 v[196:197],v30 offset:21760
ds_read_b64_tr_b16 v[198:199],v30 offset:22080
ds_read_b64_tr_b16 v[200:201],v30 offset:20512
ds_read_b64_tr_b16 v[202:203],v30 offset:20832
ds_read_b64_tr_b16 v[204:205],v30 offset:21792
ds_read_b64_tr_b16 v[206:207],v30 offset:22112
ds_read_b64_tr_b16 v[208:209],v30 offset:20544
ds_read_b64_tr_b16 v[210:211],v30 offset:20864
ds_read_b64_tr_b16 v[212:213],v30 offset:21824
ds_read_b64_tr_b16 v[214:215],v30 offset:22144
s_waitcnt lgkmcnt(4)
ds_read_b64_tr_b16 v[216:217],v30 offset:20576
ds_read_b64_tr_b16 v[218:219],v30 offset:20896
ds_read_b64_tr_b16 v[220:221],v30 offset:21856
ds_read_b64_tr_b16 v[222:223],v30 offset:22176
ds_read_b64_tr_b16 v[112:113],v30 offset:20608
ds_read_b64_tr_b16 v[114:115],v30 offset:20928
ds_read_b64_tr_b16 v[116:117],v30 offset:21888
ds_read_b64_tr_b16 v[118:119],v30 offset:22208
s_waitcnt lgkmcnt(0)
s_waitcnt vmcnt(0)
ds_read_b64_tr_b16 v[224:225],v30 offset:30720
ds_read_b64_tr_b16 v[226:227],v30 offset:31040
ds_read_b64_tr_b16 v[228:229],v30 offset:32000
ds_read_b64_tr_b16 v[230:231],v30 offset:32320
ds_read_b64_tr_b16 v[232:233],v30 offset:30752
ds_read_b64_tr_b16 v[234:235],v30 offset:31072
ds_read_b64_tr_b16 v[236:237],v30 offset:32032
ds_read_b64_tr_b16 v[238:239],v30 offset:32352
ds_read_b64_tr_b16 v[240:241],v30 offset:30784
ds_read_b64_tr_b16 v[242:243],v30 offset:31104
ds_read_b64_tr_b16 v[244:245],v30 offset:32064
ds_read_b64_tr_b16 v[246:247],v30 offset:32384
s_waitcnt lgkmcnt(4)
ds_read_b64_tr_b16 v[248:249],v30 offset:30816
ds_read_b64_tr_b16 v[250:251],v30 offset:31136
ds_read_b64_tr_b16 v[252:253],v30 offset:32096
ds_read_b64_tr_b16 v[254:255],v30 offset:32416
ds_read_b64_tr_b16 v[120:121],v30 offset:30848
ds_read_b64_tr_b16 v[122:123],v30 offset:31168
ds_read_b64_tr_b16 v[124:125],v30 offset:32128
ds_read_b64_tr_b16 v[126:127],v30 offset:32448
s_waitcnt lgkmcnt(0)
s_barrier
ds_write_b128 v4,v[32:35] offset:0
ds_write_b128 v4,v[36:39] offset:1024
ds_write_b128 v4,v[40:43] offset:2048
ds_write_b128 v4,v[44:47] offset:3072
ds_write_b128 v4,v[48:51] offset:4096
ds_write_b128 v4,v[52:55] offset:5120
ds_write_b128 v4,v[56:59] offset:6144
ds_write_b128 v4,v[60:63] offset:7168
s_waitcnt lgkmcnt(0)
ds_write_b128 v4,v[64:67] offset:8192
ds_write_b128 v4,v[68:71] offset:9216
ds_write_b128 v4,v[72:75] offset:10240
ds_write_b128 v4,v[76:79] offset:11264
ds_write_b128 v4,v[80:83] offset:12288
ds_write_b128 v4,v[84:87] offset:13312
ds_write_b128 v4,v[88:91] offset:14336
ds_write_b128 v4,v[92:95] offset:15360
s_waitcnt lgkmcnt(0)
ds_write_b128 v4,v[96:99] offset:16384
ds_write_b128 v4,v[100:103] offset:17408
ds_write_b128 v4,v[104:107] offset:18432
ds_write_b128 v4,v[108:111] offset:19456
ds_write_b128 v4,v[112:115] offset:20480
ds_write_b128 v4,v[116:119] offset:21504
ds_write_b128 v4,v[120:123] offset:22528
ds_write_b128 v4,v[124:127] offset:23552
s_waitcnt lgkmcnt(0)
s_barrier
s_lshl_b32 s3,s49,2
v_mov_b32 v13,s3
s_nop 1
ibw_172:
buffer_load_dword v12,v13,s[12:15],0 offen sc1
s_waitcnt vmcnt(0)
v_cmp_ne_u32 vcc,256,v12
s_nop 0
s_cbranch_vccz ok_173
s_sleep 8
s_sub_u32 s47,s47,1
s_cbranch_scc1 ABORT
s_branch ibw_172
ok_173:
s_cmp_lg_u32 s49,0
s_cbranch_scc1 ibok_174
v_and_b32 v13,7,v0
v_lshlrev_b32 v13,2,v13
buffer_load_dword v12,v13,s[12:15],0 offen offset:32 sc1
s_waitcnt vmcnt(0)
v_cmp_ne_u32 vcc,32,v12
s_nop 0
s_cbranch_vccz ibok_174
s_barrier
s_mov_b32 s49,1
s_mov_b32 s3,s2
s_load_dwordx16 s[16:31],s[0:1],0
s_load_dwordx8 s[32:39],s[0:1],64
s_waitcnt lgkmcnt(0)
s_branch DISPATCH
ibok_174:
v_mov_b32 v13,192
buffer_load_dword v12,v13,s[12:15],0 offen sc1
s_waitcnt vmcnt(0)
v_readfirstlane_b32 s60,v12
s_cmp_gt_i32 s60,0
s_cselect_b32 s60,0x2000,0
s_add_u32 s83,s83,s60
s_mov_b32 s50,0
s_mov_b32 s77,0
s_cmp_lg_u32 s49,0
s_cbranch_scc1 CW_LOOP_S
CW_LOOP_F:
s_sub_u32 s60,s50,13
s_lshr_b32 s52,s60,1
s_and_b32 s51,s60,1
s_cmp_eq_u32 s51,0
s_cselect_b32 s61,13,0
s_add_u32 s52,s52,s61
s_sub_u32 s61,s60,51
s_cmp_ge_u32 s60,102
s_cselect_b32 s52,s61,s52
s_cselect_b32 s51,1,s51
s_cmp_lt_u32 s50,13
s_cselect_b32 s52,s50,s52
s_cselect_b32 s51,0,s51
s_cmp_eq_u32 s52,63
s_cbranch_scc1 CW_NEXT_F
s_add_u32 s58,s52,1
s_lshl_b32 s61,s51,9
s_add_u32 s72,s61,s35
s_add_u32 s69,s61,s85
s_lshl_b32 s61,s51,2
s_and_b32 s60,s52,1
s_add_u32 s60,s60,s61
s_mul_i32 s70,s60,49152
s_add_u32 s70,s70,s33
s_add_u32 s71,s70,4096
s_add_u32 s80,s70,8192
s_bfe_u32 s57,s52,65537
s_bfe_u32 s31,s58,65537
s_and_b32 s60,s58,1
s_add_u32 s60,s60,s61
s_mul_i32 s59,s60,20480
s_add_u32 s59,s59,s84
s_lshl_b32 s68,s60,16
s_add_u32 s68,s68,s83
s_xor_b32 s77,s77,11264
v_add_u32 v7,s77,v5
v_add_u32 v8,s77,v6
s_add_u32 s60,s52,2
v_mov_b32 v16,s60
v_mov_b32 v80,0
v_mov_b32 v81,0
v_mov_b32 v82,0
v_mov_b32 v83,0
v_mov_b32 v84,0
v_mov_b32 v85,0
v_mov_b32 v86,0
v_mov_b32 v87,0
v_mov_b32 v88,0
v_mov_b32 v89,0
v_mov_b32 v90,0
v_mov_b32 v91,0
v_mov_b32 v92,0
v_mov_b32 v93,0
v_mov_b32 v94,0
v_mov_b32 v95,0
v_mov_b32 v96,0
v_mov_b32 v97,0
v_mov_b32 v98,0
v_mov_b32 v99,0
ds_read_b128 v[100:103],v4 offset:0
ds_read_b128 v[104:107],v4 offset:1024
ds_read_b128 v[108:111],v4 offset:2048
ds_read_b128 v[112:115],v4 offset:3072
s_cmp_lg_u32 s46,0
s_cbranch_scc1 np_175
db_176:
buffer_load_dword v12,v3,s[8:11],s72 offen sc1
s_waitcnt vmcnt(0)
v_cmp_gt_u32 vcc,s58,v12
s_cbranch_vccz dbok_177
s_sub_u32 s47,s47,1
s_cbranch_scc1 ABORT
s_branch db_176
dbok_177:
np_175:
s_barrier
buffer_load_dwordx4 v[32:35],v1,s[8:11],s70 offen sc1
s_nop 7
buffer_load_dwordx4 v[36:39],v1,s[8:11],s70 offen offset:1024 sc1
s_nop 7
buffer_load_dwordx4 v[40:43],v1,s[8:11],s70 offen offset:2048 sc1
s_nop 7
buffer_load_dwordx4 v[44:47],v1,s[8:11],s70 offen offset:3072 sc1
s_nop 7
buffer_load_dwordx4 v[48:51],v1,s[8:11],s71 offen sc1
s_waitcnt vmcnt(4)
v_and_b32 v12,1,v32
v_cmp_ne_u32 vcc,s57,v12
s_cbranch_vccnz ws_178
wg_187:
v_smfmac_f32_16x16x64_bf16 v[80:83],v[32:35],a[0:7],v2
buffer_load_dwordx4 v[52:55],v1,s[8:11],s71 offen offset:1024 sc1
v_smfmac_f32_16x16x64_bf16 v[84:87],v[32:35],a[8:15],v2
s_waitcnt vmcnt(4)
v_and_b32 v12,1,v36
v_smfmac_f32_16x16x64_bf16 v[88:91],v[32:35],a[16:23],v2
v_cmp_ne_u32 vcc,s57,v12
v_smfmac_f32_16x16x64_bf16 v[92:95],v[32:35],a[24:31],v2
s_waitcnt lgkmcnt(2)
v_smfmac_f32_16x16x64_bf16 v[96:99],v[32:35],v[100:107],v2
s_cbranch_vccnz ws_179
wg_188:
v_smfmac_f32_16x16x64_bf16 v[80:83],v[36:39],a[32:39],v2
buffer_load_dwordx4 v[56:59],v1,s[8:11],s71 offen offset:2048 sc1
v_smfmac_f32_16x16x64_bf16 v[84:87],v[36:39],a[40:47],v2
s_waitcnt vmcnt(4)
v_and_b32 v12,1,v40
v_smfmac_f32_16x16x64_bf16 v[88:91],v[36:39],a[48:55],v2
v_cmp_ne_u32 vcc,s57,v12
ds_read_b128 v[100:103],v4 offset:4096
v_smfmac_f32_16x16x64_bf16 v[92:95],v[36:39],a[56:63],v2
ds_read_b128 v[104:107],v4 offset:5120
s_waitcnt lgkmcnt(2)
v_smfmac_f32_16x16x64_bf16 v[96:99],v[36:39],v[108:115],v2
s_cbranch_vccnz ws_180
wg_189:
v_smfmac_f32_16x16x64_bf16 v[80:83],v[40:43],a[64:71],v2
buffer_load_dwordx4 v[60:63],v1,s[8:11],s71 offen offset:3072 sc1
v_smfmac_f32_16x16x64_bf16 v[84:87],v[40:43],a[72:79],v2
s_waitcnt vmcnt(4)
v_and_b32 v12,1,v44
v_smfmac_f32_16x16x64_bf16 v[88:91],v[40:43],a[80:87],v2
v_cmp_ne_u32 vcc,s57,v12
ds_read_b128 v[108:111],v4 offset:6144
v_smfmac_f32_16x16x64_bf16 v[92:95],v[40:43],a[88:95],v2
ds_read_b128 v[112:115],v4 offset:7168
s_waitcnt lgkmcnt(2)
v_smfmac_f32_16x16x64_bf16 v[96:99],v[40:43],v[100:107],v2
s_cbranch_vccnz ws_181
wg_190:
v_smfmac_f32_16x16x64_bf16 v[80:83],v[44:47],a[96:103],v2
buffer_load_dwordx4 v[64:67],v1,s[8:11],s80 offen sc1
v_smfmac_f32_16x16x64_bf16 v[84:87],v[44:47],a[104:111],v2
s_waitcnt vmcnt(4)
v_and_b32 v12,1,v48
v_smfmac_f32_16x16x64_bf16 v[88:91],v[44:47],a[112:119],v2
v_cmp_ne_u32 vcc,s57,v12
ds_read_b128 v[100:103],v4 offset:8192
v_smfmac_f32_16x16x64_bf16 v[92:95],v[44:47],a[120:127],v2
ds_read_b128 v[104:107],v4 offset:9216
s_waitcnt lgkmcnt(2)
v_smfmac_f32_16x16x64_bf16 v[96:99],v[44:47],v[108:115],v2
s_cbranch_vccnz ws_182
wg_191:
v_smfmac_f32_16x16x64_bf16 v[80:83],v[48:51],a[128:135],v2
buffer_load_dwordx4 v[68:71],v1,s[8:11],s80 offen offset:1024 sc1
v_smfmac_f32_16x16x64_bf16 v[84:87],v[48:51],a[136:143],v2
s_waitcnt vmcnt(4)
v_and_b32 v12,1,v52
v_smfmac_f32_16x16x64_bf16 v[88:91],v[48:51],a[144:151],v2
v_cmp_ne_u32 vcc,s57,v12
ds_read_b128 v[108:111],v4 offset:10240
v_smfmac_f32_16x16x64_bf16 v[92:95],v[48:51],a[152:159],v2
ds_read_b128 v[112:115],v4 offset:11264
s_waitcnt lgkmcnt(2)
v_smfmac_f32_16x16x64_bf16 v[96:99],v[48:51],v[100:107],v2
s_cbranch_vccnz ws_183
wg_192:
v_smfmac_f32_16x16x64_bf16 v[80:83],v[52:55],a[160:167],v2
s_waitcnt vmcnt(2)
v_bitop3_b32 v12,v56,v60,s57 bitop3:0x7e
v_smfmac_f32_16x16x64_bf16 v[84:87],v[52:55],a[168:175],v2
v_and_b32 v12,1,v12
buffer_load_dwordx4 v[72:75],v1,s[8:11],s80 offen offset:2048 sc1
v_smfmac_f32_16x16x64_bf16 v[88:91],v[52:55],a[176:183],v2
v_cmp_ne_u32 vcc,0,v12
ds_read_b128 v[100:103],v4 offset:12288
v_smfmac_f32_16x16x64_bf16 v[92:95],v[52:55],a[184:191],v2
ds_read_b128 v[104:107],v4 offset:13312
s_waitcnt lgkmcnt(2)
v_smfmac_f32_16x16x64_bf16 v[96:99],v[52:55],v[108:115],v2
s_cbranch_vccnz ws_184
wg_193:
v_smfmac_f32_16x16x64_bf16 v[80:83],v[56:59],a[192:199],v2
buffer_load_dwordx4 v[76:79],v1,s[8:11],s80 offen offset:3072 sc1
v_smfmac_f32_16x16x64_bf16 v[84:87],v[56:59],a[200:207],v2
ds_read_b128 v[108:111],v4 offset:14336
v_smfmac_f32_16x16x64_bf16 v[88:91],v[56:59],a[208:215],v2
ds_read_b128 v[112:115],v4 offset:15360
v_smfmac_f32_16x16x64_bf16 v[92:95],v[56:59],a[216:223],v2
s_waitcnt lgkmcnt(2)
v_smfmac_f32_16x16x64_bf16 v[96:99],v[56:59],v[100:107],v2
ds_read_b128 v[100:103],v4 offset:16384
v_smfmac_f32_16x16x64_bf16 v[80:83],v[60:63],a[224:231],v2
s_waitcnt vmcnt(2)
v_bitop3_b32 v12,v64,v68,s57 bitop3:0x7e
v_smfmac_f32_16x16x64_bf16 v[84:87],v[60:63],a[232:239],v2
v_and_b32 v12,1,v12
ds_read_b128 v[104:107],v4 offset:17408
v_smfmac_f32_16x16x64_bf16 v[88:91],v[60:63],a[240:247],v2
v_cmp_ne_u32 vcc,0,v12
v_smfmac_f32_16x16x64_bf16 v[92:95],v[60:63],a[248:255],v2
s_waitcnt lgkmcnt(2)
v_smfmac_f32_16x16x64_bf16 v[96:99],v[60:63],v[108:115],v2
s_cbranch_vccnz ws_185
wg_194:
v_smfmac_f32_16x16x64_bf16 v[80:83],v[64:67],v[128:135],v2
ds_read_b128 v[108:111],v4 offset:18432
v_smfmac_f32_16x16x64_bf16 v[84:87],v[64:67],v[136:143],v2
ds_read_b128 v[112:115],v4 offset:19456
v_smfmac_f32_16x16x64_bf16 v[88:91],v[64:67],v[144:151],v2
v_smfmac_f32_16x16x64_bf16 v[92:95],v[64:67],v[152:159],v2
s_waitcnt lgkmcnt(2)
v_smfmac_f32_16x16x64_bf16 v[96:99],v[64:67],v[100:107],v2
ds_read_b128 v[100:103],v4 offset:20480
v_smfmac_f32_16x16x64_bf16 v[80:83],v[68:71],v[160:167],v2
s_waitcnt vmcnt(0)
v_bitop3_b32 v12,v72,v76,s57 bitop3:0x7e
v_smfmac_f32_16x16x64_bf16 v[84:87],v[68:71],v[168:175],v2
v_and_b32 v12,1,v12
ds_read_b128 v[104:107],v4 offset:21504
v_smfmac_f32_16x16x64_bf16 v[88:91],v[68:71],v[176:183],v2
v_cmp_ne_u32 vcc,0,v12
v_smfmac_f32_16x16x64_bf16 v[92:95],v[68:71],v[184:191],v2
s_waitcnt lgkmcnt(2)
v_smfmac_f32_16x16x64_bf16 v[96:99],v[68:71],v[108:115],v2
s_cbranch_vccnz ws_186
wg_195:
v_smfmac_f32_16x16x64_bf16 v[80:83],v[72:75],v[192:199],v2
ds_read_b128 v[108:111],v4 offset:22528
v_smfmac_f32_16x16x64_bf16 v[80:83],v[76:79],v[224:231],v2
ds_read_b128 v[112:115],v4 offset:23552
v_smfmac_f32_16x16x64_bf16 v[84:87],v[72:75],v[200:207],v2
v_smfmac_f32_16x16x64_bf16 v[84:87],v[76:79],v[232:239],v2
v_smfmac_f32_16x16x64_bf16 v[88:91],v[72:75],v[208:215],v2
s_nop 3
v_add_f32 v80,v80,v81
v_smfmac_f32_16x16x64_bf16 v[88:91],v[76:79],v[240:247],v2
v_add_f32 v82,v82,v83
ds_write2_b32 v7,v80,v82 offset0:0 offset1:88
v_smfmac_f32_16x16x64_bf16 v[92:95],v[72:75],v[216:223],v2
v_add_f32 v84,v84,v85
v_smfmac_f32_16x16x64_bf16 v[92:95],v[76:79],v[248:255],v2
v_add_f32 v86,v86,v87
s_waitcnt lgkmcnt(3)
v_smfmac_f32_16x16x64_bf16 v[96:99],v[72:75],v[100:107],v2
ds_write2_b32 v7,v84,v86 offset0:16 offset1:104
s_waitcnt lgkmcnt(2)
v_smfmac_f32_16x16x64_bf16 v[96:99],v[76:79],v[108:115],v2
v_add_f32 v88,v88,v89
v_add_f32 v90,v90,v91
ds_write2_b32 v7,v88,v90 offset0:32 offset1:120
v_add_f32 v92,v92,v93
v_add_f32 v94,v94,v95
ds_write2_b32 v7,v92,v94 offset0:48 offset1:136
s_nop 1
v_add_f32 v96,v96,v97
v_add_f32 v98,v98,v99
ds_write2_b32 v7,v96,v98 offset0:64 offset1:152
s_mov_b64 exec,1
buffer_store_dword v16,v1,s[8:11],s69 offen
s_mov_b64 exec,-1
s_waitcnt lgkmcnt(0)
s_barrier
ds_read_b128 v[32:35],v8 offset:0
ds_read_b128 v[36:39],v8 offset:2816
ds_read_b128 v[40:43],v8 offset:5632
ds_read_b128 v[44:47],v8 offset:8448
s_mov_b64 exec,s[88:89]
s_waitcnt lgkmcnt(2)
v_pk_add_f32 v[32:33],v[32:33],v[36:37]
v_pk_add_f32 v[34:35],v[34:35],v[38:39]
s_waitcnt lgkmcnt(0)
v_pk_add_f32 v[40:41],v[40:41],v[44:45]
v_pk_add_f32 v[42:43],v[42:43],v[46:47]
v_pk_add_f32 v[32:33],v[32:33],v[40:41]
v_pk_add_f32 v[34:35],v[34:35],v[42:43]
v_and_or_b32 v32,v32,-2,s31
buffer_store_dwordx4 v[32:35],v9,s[8:11],s59 offen
s_barrier
buffer_store_dwordx4 v[32:35],v9,s[8:11],s68 offen sc1
s_mov_b64 exec,-1
s_nop 0
CW_NEXT_F:
s_add_u32 s50,s50,1
s_cmp_lt_u32 s50,128
s_cbranch_scc1 CW_LOOP_F
s_branch CW_DONE
ws_178:
buffer_load_dwordx4 v[32:35],v1,s[8:11],s70 offen sc1
buffer_load_dwordx4 v[36:39],v1,s[8:11],s70 offen offset:1024 sc1
buffer_load_dwordx4 v[40:43],v1,s[8:11],s70 offen offset:2048 sc1
buffer_load_dwordx4 v[44:47],v1,s[8:11],s70 offen offset:3072 sc1
buffer_load_dwordx4 v[48:51],v1,s[8:11],s71 offen sc1
s_sub_u32 s47,s47,1
s_cbranch_scc1 ABORT
s_waitcnt vmcnt(4)
v_and_b32 v12,1,v32
v_cmp_ne_u32 vcc,s57,v12
s_nop 0
s_cbranch_vccnz ws_178
s_branch wg_187
ws_179:
buffer_load_dwordx4 v[36:39],v1,s[8:11],s70 offen offset:1024 sc1
buffer_load_dwordx4 v[40:43],v1,s[8:11],s70 offen offset:2048 sc1
buffer_load_dwordx4 v[44:47],v1,s[8:11],s70 offen offset:3072 sc1
buffer_load_dwordx4 v[48:51],v1,s[8:11],s71 offen sc1
buffer_load_dwordx4 v[52:55],v1,s[8:11],s71 offen offset:1024 sc1
s_sub_u32 s47,s47,1
s_cbranch_scc1 ABORT
s_waitcnt vmcnt(4)
v_and_b32 v12,1,v36
v_cmp_ne_u32 vcc,s57,v12
s_nop 0
s_cbranch_vccnz ws_179
s_branch wg_188
ws_180:
buffer_load_dwordx4 v[40:43],v1,s[8:11],s70 offen offset:2048 sc1
buffer_load_dwordx4 v[44:47],v1,s[8:11],s70 offen offset:3072 sc1
buffer_load_dwordx4 v[48:51],v1,s[8:11],s71 offen sc1
buffer_load_dwordx4 v[52:55],v1,s[8:11],s71 offen offset:1024 sc1
buffer_load_dwordx4 v[56:59],v1,s[8:11],s71 offen offset:2048 sc1
s_sub_u32 s47,s47,1
s_cbranch_scc1 ABORT
s_waitcnt vmcnt(4)
v_and_b32 v12,1,v40
v_cmp_ne_u32 vcc,s57,v12
s_nop 0
s_cbranch_vccnz ws_180
s_branch wg_189
ws_181:
buffer_load_dwordx4 v[44:47],v1,s[8:11],s70 offen offset:3072 sc1
buffer_load_dwordx4 v[48:51],v1,s[8:11],s71 offen sc1
buffer_load_dwordx4 v[52:55],v1,s[8:11],s71 offen offset:1024 sc1
buffer_load_dwordx4 v[56:59],v1,s[8:11],s71 offen offset:2048 sc1
buffer_load_dwordx4 v[60:63],v1,s[8:11],s71 offen offset:3072 sc1
s_sub_u32 s47,s47,1
s_cbranch_scc1 ABORT
s_waitcnt vmcnt(4)
v_and_b32 v12,1,v44
v_cmp_ne_u32 vcc,s57,v12
s_nop 0
s_cbranch_vccnz ws_181
s_branch wg_190
ws_182:
buffer_load_dwordx4 v[48:51],v1,s[8:11],s71 offen sc1
buffer_load_dwordx4 v[52:55],v1,s[8:11],s71 offen offset:1024 sc1
buffer_load_dwordx4 v[56:59],v1,s[8:11],s71 offen offset:2048 sc1
buffer_load_dwordx4 v[60:63],v1,s[8:11],s71 offen offset:3072 sc1
buffer_load_dwordx4 v[64:67],v1,s[8:11],s80 offen sc1
s_sub_u32 s47,s47,1
s_cbranch_scc1 ABORT
s_waitcnt vmcnt(4)
v_and_b32 v12,1,v48
v_cmp_ne_u32 vcc,s57,v12
s_nop 0
s_cbranch_vccnz ws_182
s_branch wg_191
ws_183:
buffer_load_dwordx4 v[52:55],v1,s[8:11],s71 offen offset:1024 sc1
buffer_load_dwordx4 v[56:59],v1,s[8:11],s71 offen offset:2048 sc1
buffer_load_dwordx4 v[60:63],v1,s[8:11],s71 offen offset:3072 sc1
buffer_load_dwordx4 v[64:67],v1,s[8:11],s80 offen sc1
buffer_load_dwordx4 v[68:71],v1,s[8:11],s80 offen offset:1024 sc1
s_sub_u32 s47,s47,1
s_cbranch_scc1 ABORT
s_waitcnt vmcnt(4)
v_and_b32 v12,1,v52
v_cmp_ne_u32 vcc,s57,v12
s_nop 0
s_cbranch_vccnz ws_183
s_branch wg_192
ws_184:
buffer_load_dwordx4 v[56:59],v1,s[8:11],s71 offen offset:2048 sc1
buffer_load_dwordx4 v[60:63],v1,s[8:11],s71 offen offset:3072 sc1
buffer_load_dwordx4 v[64:67],v1,s[8:11],s80 offen sc1
buffer_load_dwordx4 v[68:71],v1,s[8:11],s80 offen offset:1024 sc1
buffer_load_dwordx4 v[72:75],v1,s[8:11],s80 offen offset:2048 sc1
s_sub_u32 s47,s47,1
s_cbranch_scc1 ABORT
s_waitcnt vmcnt(3)
v_bitop3_b32 v12,v56,v60,s57 bitop3:0x7e
v_and_b32 v12,1,v12
v_cmp_ne_u32 vcc,0,v12
s_nop 0
s_cbranch_vccnz ws_184
s_branch wg_193
ws_185:
buffer_load_dwordx4 v[64:67],v1,s[8:11],s80 offen sc1
buffer_load_dwordx4 v[68:71],v1,s[8:11],s80 offen offset:1024 sc1
buffer_load_dwordx4 v[72:75],v1,s[8:11],s80 offen offset:2048 sc1
buffer_load_dwordx4 v[76:79],v1,s[8:11],s80 offen offset:3072 sc1
s_sub_u32 s47,s47,1
s_cbranch_scc1 ABORT
s_waitcnt vmcnt(2)
v_bitop3_b32 v12,v64,v68,s57 bitop3:0x7e
v_and_b32 v12,1,v12
v_cmp_ne_u32 vcc,0,v12
s_nop 0
s_cbranch_vccnz ws_185
s_branch wg_194
ws_186:
buffer_load_dwordx4 v[72:75],v1,s[8:11],s80 offen offset:2048 sc1
buffer_load_dwordx4 v[76:79],v1,s[8:11],s80 offen offset:3072 sc1
s_sub_u32 s47,s47,1
s_cbranch_scc1 ABORT
s_waitcnt vmcnt(0)
v_bitop3_b32 v12,v72,v76,s57 bitop3:0x7e
v_and_b32 v12,1,v12
v_cmp_ne_u32 vcc,0,v12
s_nop 0
s_cbranch_vccnz ws_186
s_branch wg_195
CW_LOOP_S:
s_sub_u32 s60,s50,13
s_lshr_b32 s52,s60,1
s_and_b32 s51,s60,1
s_cmp_eq_u32 s51,0
s_cselect_b32 s61,13,0
s_add_u32 s52,s52,s61
s_sub_u32 s61,s60,51
s_cmp_ge_u32 s60,102
s_cselect_b32 s52,s61,s52
s_cselect_b32 s51,1,s51
s_cmp_lt_u32 s50,13
s_cselect_b32 s52,s50,s52
s_cselect_b32 s51,0,s51
s_cmp_eq_u32 s52,63
s_cbranch_scc1 CW_NEXT_S
s_add_u32 s58,s52,1
s_lshl_b32 s61,s51,9
s_add_u32 s72,s61,s35
s_add_u32 s69,s61,s85
s_lshl_b32 s61,s51,2
s_and_b32 s60,s52,1
s_add_u32 s60,s60,s61
s_mul_i32 s70,s60,49152
s_add_u32 s70,s70,s33
s_add_u32 s71,s70,4096
s_add_u32 s80,s70,8192
s_bfe_u32 s57,s52,65537
s_bfe_u32 s31,s58,65537
s_and_b32 s60,s58,1
s_add_u32 s60,s60,s61
s_mul_i32 s59,s60,20480
s_add_u32 s59,s59,s84
s_lshl_b32 s68,s60,16
s_add_u32 s68,s68,s83
s_xor_b32 s77,s77,11264
v_add_u32 v7,s77,v5
v_add_u32 v8,s77,v6
s_add_u32 s60,s52,2
v_mov_b32 v16,s60
v_mov_b32 v80,0
v_mov_b32 v81,0
v_mov_b32 v82,0
v_mov_b32 v83,0
v_mov_b32 v84,0
v_mov_b32 v85,0
v_mov_b32 v86,0
v_mov_b32 v87,0
v_mov_b32 v88,0
v_mov_b32 v89,0
v_mov_b32 v90,0
v_mov_b32 v91,0
v_mov_b32 v92,0
v_mov_b32 v93,0
v_mov_b32 v94,0
v_mov_b32 v95,0
v_mov_b32 v96,0
v_mov_b32 v97,0
v_mov_b32 v98,0
v_mov_b32 v99,0
ds_read_b128 v[100:103],v4 offset:0
ds_read_b128 v[104:107],v4 offset:1024
ds_read_b128 v[108:111],v4 offset:2048
ds_read_b128 v[112:115],v4 offset:3072
s_cmp_lg_u32 s46,0
s_cbranch_scc1 np_196
db_197:
buffer_load_dword v12,v3,s[8:11],s72 offen sc1
s_waitcnt vmcnt(0)
v_cmp_gt_u32 vcc,s58,v12
s_cbranch_vccz dbok_198
s_sub_u32 s47,s47,1
s_cbranch_scc1 ABORT
s_branch db_197
dbok_198:
np_196:
s_barrier
buffer_load_dwordx4 v[32:35],v1,s[8:11],s70 offen sc1
s_nop 7
buffer_load_dwordx4 v[36:39],v1,s[8:11],s70 offen offset:1024 sc1
s_nop 7
buffer_load_dwordx4 v[40:43],v1,s[8:11],s70 offen offset:2048 sc1
s_nop 7
buffer_load_dwordx4 v[44:47],v1,s[8:11],s70 offen offset:3072 sc1
s_nop 7
buffer_load_dwordx4 v[48:51],v1,s[8:11],s71 offen sc1
s_waitcnt vmcnt(4)
v_and_b32 v12,1,v32
v_cmp_ne_u32 vcc,s57,v12
s_cbranch_vccnz ws_199
wg_208:
v_smfmac_f32_16x16x64_bf16 v[80:83],v[32:35],a[0:7],v2
buffer_load_dwordx4 v[52:55],v1,s[8:11],s71 offen offset:1024 sc1
v_smfmac_f32_16x16x64_bf16 v[84:87],v[32:35],a[8:15],v2
s_waitcnt vmcnt(4)
v_and_b32 v12,1,v36
v_smfmac_f32_16x16x64_bf16 v[88:91],v[32:35],a[16:23],v2
v_cmp_ne_u32 vcc,s57,v12
v_smfmac_f32_16x16x64_bf16 v[92:95],v[32:35],a[24:31],v2
s_waitcnt lgkmcnt(2)
v_smfmac_f32_16x16x64_bf16 v[96:99],v[32:35],v[100:107],v2
s_cbranch_vccnz ws_200
wg_209:
v_smfmac_f32_16x16x64_bf16 v[80:83],v[36:39],a[32:39],v2
buffer_load_dwordx4 v[56:59],v1,s[8:11],s71 offen offset:2048 sc1
v_smfmac_f32_16x16x64_bf16 v[84:87],v[36:39],a[40:47],v2
s_waitcnt vmcnt(4)
v_and_b32 v12,1,v40
v_smfmac_f32_16x16x64_bf16 v[88:91],v[36:39],a[48:55],v2
v_cmp_ne_u32 vcc,s57,v12
ds_read_b128 v[100:103],v4 offset:4096
v_smfmac_f32_16x16x64_bf16 v[92:95],v[36:39],a[56:63],v2
ds_read_b128 v[104:107],v4 offset:5120
s_waitcnt lgkmcnt(2)
v_smfmac_f32_16x16x64_bf16 v[96:99],v[36:39],v[108:115],v2
s_cbranch_vccnz ws_201
wg_210:
v_smfmac_f32_16x16x64_bf16 v[80:83],v[40:43],a[64:71],v2
buffer_load_dwordx4 v[60:63],v1,s[8:11],s71 offen offset:3072 sc1
v_smfmac_f32_16x16x64_bf16 v[84:87],v[40:43],a[72:79],v2
s_waitcnt vmcnt(4)
v_and_b32 v12,1,v44
v_smfmac_f32_16x16x64_bf16 v[88:91],v[40:43],a[80:87],v2
v_cmp_ne_u32 vcc,s57,v12
ds_read_b128 v[108:111],v4 offset:6144
v_smfmac_f32_16x16x64_bf16 v[92:95],v[40:43],a[88:95],v2
ds_read_b128 v[112:115],v4 offset:7168
s_waitcnt lgkmcnt(2)
v_smfmac_f32_16x16x64_bf16 v[96:99],v[40:43],v[100:107],v2
s_cbranch_vccnz ws_202
wg_211:
v_smfmac_f32_16x16x64_bf16 v[80:83],v[44:47],a[96:103],v2
buffer_load_dwordx4 v[64:67],v1,s[8:11],s80 offen sc1
v_smfmac_f32_16x16x64_bf16 v[84:87],v[44:47],a[104:111],v2
s_waitcnt vmcnt(4)
v_and_b32 v12,1,v48
v_smfmac_f32_16x16x64_bf16 v[88:91],v[44:47],a[112:119],v2
v_cmp_ne_u32 vcc,s57,v12
ds_read_b128 v[100:103],v4 offset:8192
v_smfmac_f32_16x16x64_bf16 v[92:95],v[44:47],a[120:127],v2
ds_read_b128 v[104:107],v4 offset:9216
s_waitcnt lgkmcnt(2)
v_smfmac_f32_16x16x64_bf16 v[96:99],v[44:47],v[108:115],v2
s_cbranch_vccnz ws_203
wg_212:
v_smfmac_f32_16x16x64_bf16 v[80:83],v[48:51],a[128:135],v2
buffer_load_dwordx4 v[68:71],v1,s[8:11],s80 offen offset:1024 sc1
v_smfmac_f32_16x16x64_bf16 v[84:87],v[48:51],a[136:143],v2
s_waitcnt vmcnt(4)
v_and_b32 v12,1,v52
v_smfmac_f32_16x16x64_bf16 v[88:91],v[48:51],a[144:151],v2
v_cmp_ne_u32 vcc,s57,v12
ds_read_b128 v[108:111],v4 offset:10240
v_smfmac_f32_16x16x64_bf16 v[92:95],v[48:51],a[152:159],v2
ds_read_b128 v[112:115],v4 offset:11264
s_waitcnt lgkmcnt(2)
v_smfmac_f32_16x16x64_bf16 v[96:99],v[48:51],v[100:107],v2
s_cbranch_vccnz ws_204
wg_213:
v_smfmac_f32_16x16x64_bf16 v[80:83],v[52:55],a[160:167],v2
s_waitcnt vmcnt(2)
v_bitop3_b32 v12,v56,v60,s57 bitop3:0x7e
v_smfmac_f32_16x16x64_bf16 v[84:87],v[52:55],a[168:175],v2
v_and_b32 v12,1,v12
buffer_load_dwordx4 v[72:75],v1,s[8:11],s80 offen offset:2048 sc1
v_smfmac_f32_16x16x64_bf16 v[88:91],v[52:55],a[176:183],v2
v_cmp_ne_u32 vcc,0,v12
ds_read_b128 v[100:103],v4 offset:12288
v_smfmac_f32_16x16x64_bf16 v[92:95],v[52:55],a[184:191],v2
ds_read_b128 v[104:107],v4 offset:13312
s_waitcnt lgkmcnt(2)
v_smfmac_f32_16x16x64_bf16 v[96:99],v[52:55],v[108:115],v2
s_cbranch_vccnz ws_205
wg_214:
v_smfmac_f32_16x16x64_bf16 v[80:83],v[56:59],a[192:199],v2
buffer_load_dwordx4 v[76:79],v1,s[8:11],s80 offen offset:3072 sc1
v_smfmac_f32_16x16x64_bf16 v[84:87],v[56:59],a[200:207],v2
ds_read_b128 v[108:111],v4 offset:14336
v_smfmac_f32_16x16x64_bf16 v[88:91],v[56:59],a[208:215],v2
ds_read_b128 v[112:115],v4 offset:15360
v_smfmac_f32_16x16x64_bf16 v[92:95],v[56:59],a[216:223],v2
s_waitcnt lgkmcnt(2)
v_smfmac_f32_16x16x64_bf16 v[96:99],v[56:59],v[100:107],v2
ds_read_b128 v[100:103],v4 offset:16384
v_smfmac_f32_16x16x64_bf16 v[80:83],v[60:63],a[224:231],v2
s_waitcnt vmcnt(2)
v_bitop3_b32 v12,v64,v68,s57 bitop3:0x7e
v_smfmac_f32_16x16x64_bf16 v[84:87],v[60:63],a[232:239],v2
v_and_b32 v12,1,v12
ds_read_b128 v[104:107],v4 offset:17408
v_smfmac_f32_16x16x64_bf16 v[88:91],v[60:63],a[240:247],v2
v_cmp_ne_u32 vcc,0,v12
v_smfmac_f32_16x16x64_bf16 v[92:95],v[60:63],a[248:255],v2
s_waitcnt lgkmcnt(2)
v_smfmac_f32_16x16x64_bf16 v[96:99],v[60:63],v[108:115],v2
s_cbranch_vccnz ws_206
wg_215:
v_smfmac_f32_16x16x64_bf16 v[80:83],v[64:67],v[128:135],v2
ds_read_b128 v[108:111],v4 offset:18432
v_smfmac_f32_16x16x64_bf16 v[84:87],v[64:67],v[136:143],v2
ds_read_b128 v[112:115],v4 offset:19456
v_smfmac_f32_16x16x64_bf16 v[88:91],v[64:67],v[144:151],v2
v_smfmac_f32_16x16x64_bf16 v[92:95],v[64:67],v[152:159],v2
s_waitcnt lgkmcnt(2)
v_smfmac_f32_16x16x64_bf16 v[96:99],v[64:67],v[100:107],v2
ds_read_b128 v[100:103],v4 offset:20480
v_smfmac_f32_16x16x64_bf16 v[80:83],v[68:71],v[160:167],v2
s_waitcnt vmcnt(0)
v_bitop3_b32 v12,v72,v76,s57 bitop3:0x7e
v_smfmac_f32_16x16x64_bf16 v[84:87],v[68:71],v[168:175],v2
v_and_b32 v12,1,v12
ds_read_b128 v[104:107],v4 offset:21504
v_smfmac_f32_16x16x64_bf16 v[88:91],v[68:71],v[176:183],v2
v_cmp_ne_u32 vcc,0,v12
v_smfmac_f32_16x16x64_bf16 v[92:95],v[68:71],v[184:191],v2
s_waitcnt lgkmcnt(2)
v_smfmac_f32_16x16x64_bf16 v[96:99],v[68:71],v[108:115],v2
s_cbranch_vccnz ws_207
wg_216:
v_smfmac_f32_16x16x64_bf16 v[80:83],v[72:75],v[192:199],v2
ds_read_b128 v[108:111],v4 offset:22528
v_smfmac_f32_16x16x64_bf16 v[80:83],v[76:79],v[224:231],v2
ds_read_b128 v[112:115],v4 offset:23552
v_smfmac_f32_16x16x64_bf16 v[84:87],v[72:75],v[200:207],v2
v_smfmac_f32_16x16x64_bf16 v[84:87],v[76:79],v[232:239],v2
v_smfmac_f32_16x16x64_bf16 v[88:91],v[72:75],v[208:215],v2
s_nop 3
v_add_f32 v80,v80,v81
v_smfmac_f32_16x16x64_bf16 v[88:91],v[76:79],v[240:247],v2
v_add_f32 v82,v82,v83
ds_write2_b32 v7,v80,v82 offset0:0 offset1:88
v_smfmac_f32_16x16x64_bf16 v[92:95],v[72:75],v[216:223],v2
v_add_f32 v84,v84,v85
v_smfmac_f32_16x16x64_bf16 v[92:95],v[76:79],v[248:255],v2
v_add_f32 v86,v86,v87
s_waitcnt lgkmcnt(3)
v_smfmac_f32_16x16x64_bf16 v[96:99],v[72:75],v[100:107],v2
ds_write2_b32 v7,v84,v86 offset0:16 offset1:104
s_waitcnt lgkmcnt(2)
v_smfmac_f32_16x16x64_bf16 v[96:99],v[76:79],v[108:115],v2
v_add_f32 v88,v88,v89
v_add_f32 v90,v90,v91
ds_write2_b32 v7,v88,v90 offset0:32 offset1:120
v_add_f32 v92,v92,v93
v_add_f32 v94,v94,v95
ds_write2_b32 v7,v92,v94 offset0:48 offset1:136
s_nop 1
v_add_f32 v96,v96,v97
v_add_f32 v98,v98,v99
ds_write2_b32 v7,v96,v98 offset0:64 offset1:152
s_mov_b64 exec,1
buffer_store_dword v16,v1,s[8:11],s69 offen sc1
s_mov_b64 exec,-1
s_waitcnt lgkmcnt(0)
s_barrier
ds_read_b128 v[32:35],v8 offset:0
ds_read_b128 v[36:39],v8 offset:2816
ds_read_b128 v[40:43],v8 offset:5632
ds_read_b128 v[44:47],v8 offset:8448
s_mov_b64 exec,s[88:89]
s_waitcnt lgkmcnt(2)
v_pk_add_f32 v[32:33],v[32:33],v[36:37]
v_pk_add_f32 v[34:35],v[34:35],v[38:39]
s_waitcnt lgkmcnt(0)
v_pk_add_f32 v[40:41],v[40:41],v[44:45]
v_pk_add_f32 v[42:43],v[42:43],v[46:47]
v_pk_add_f32 v[32:33],v[32:33],v[40:41]
v_pk_add_f32 v[34:35],v[34:35],v[42:43]
v_and_or_b32 v32,v32,-2,s31
buffer_store_dwordx4 v[32:35],v9,s[8:11],s59 offen sc1
s_barrier
buffer_store_dwordx4 v[32:35],v9,s[8:11],s68 offen sc1
s_mov_b64 exec,-1
s_nop 0
CW_NEXT_S:
s_add_u32 s50,s50,1
s_cmp_lt_u32 s50,128
s_cbranch_scc1 CW_LOOP_S
s_branch CW_DONE
ws_199:
buffer_load_dwordx4 v[32:35],v1,s[8:11],s70 offen sc1
buffer_load_dwordx4 v[36:39],v1,s[8:11],s70 offen offset:1024 sc1
buffer_load_dwordx4 v[40:43],v1,s[8:11],s70 offen offset:2048 sc1
buffer_load_dwordx4 v[44:47],v1,s[8:11],s70 offen offset:3072 sc1
buffer_load_dwordx4 v[48:51],v1,s[8:11],s71 offen sc1
s_sub_u32 s47,s47,1
s_cbranch_scc1 ABORT
s_waitcnt vmcnt(4)
v_and_b32 v12,1,v32
v_cmp_ne_u32 vcc,s57,v12
s_nop 0
s_cbranch_vccnz ws_199
s_branch wg_208
ws_200:
buffer_load_dwordx4 v[36:39],v1,s[8:11],s70 offen offset:1024 sc1
buffer_load_dwordx4 v[40:43],v1,s[8:11],s70 offen offset:2048 sc1
buffer_load_dwordx4 v[44:47],v1,s[8:11],s70 offen offset:3072 sc1
buffer_load_dwordx4 v[48:51],v1,s[8:11],s71 offen sc1
buffer_load_dwordx4 v[52:55],v1,s[8:11],s71 offen offset:1024 sc1
s_sub_u32 s47,s47,1
s_cbranch_scc1 ABORT
s_waitcnt vmcnt(4)
v_and_b32 v12,1,v36
v_cmp_ne_u32 vcc,s57,v12
s_nop 0
s_cbranch_vccnz ws_200
s_branch wg_209
ws_201:
buffer_load_dwordx4 v[40:43],v1,s[8:11],s70 offen offset:2048 sc1
buffer_load_dwordx4 v[44:47],v1,s[8:11],s70 offen offset:3072 sc1
buffer_load_dwordx4 v[48:51],v1,s[8:11],s71 offen sc1
buffer_load_dwordx4 v[52:55],v1,s[8:11],s71 offen offset:1024 sc1
buffer_load_dwordx4 v[56:59],v1,s[8:11],s71 offen offset:2048 sc1
s_sub_u32 s47,s47,1
s_cbranch_scc1 ABORT
s_waitcnt vmcnt(4)
v_and_b32 v12,1,v40
v_cmp_ne_u32 vcc,s57,v12
s_nop 0
s_cbranch_vccnz ws_201
s_branch wg_210
ws_202:
buffer_load_dwordx4 v[44:47],v1,s[8:11],s70 offen offset:3072 sc1
buffer_load_dwordx4 v[48:51],v1,s[8:11],s71 offen sc1
buffer_load_dwordx4 v[52:55],v1,s[8:11],s71 offen offset:1024 sc1
buffer_load_dwordx4 v[56:59],v1,s[8:11],s71 offen offset:2048 sc1
buffer_load_dwordx4 v[60:63],v1,s[8:11],s71 offen offset:3072 sc1
s_sub_u32 s47,s47,1
s_cbranch_scc1 ABORT
s_waitcnt vmcnt(4)
v_and_b32 v12,1,v44
v_cmp_ne_u32 vcc,s57,v12
s_nop 0
s_cbranch_vccnz ws_202
s_branch wg_211
ws_203:
buffer_load_dwordx4 v[48:51],v1,s[8:11],s71 offen sc1
buffer_load_dwordx4 v[52:55],v1,s[8:11],s71 offen offset:1024 sc1
buffer_load_dwordx4 v[56:59],v1,s[8:11],s71 offen offset:2048 sc1
buffer_load_dwordx4 v[60:63],v1,s[8:11],s71 offen offset:3072 sc1
buffer_load_dwordx4 v[64:67],v1,s[8:11],s80 offen sc1
s_sub_u32 s47,s47,1
s_cbranch_scc1 ABORT
s_waitcnt vmcnt(4)
v_and_b32 v12,1,v48
v_cmp_ne_u32 vcc,s57,v12
s_nop 0
s_cbranch_vccnz ws_203
s_branch wg_212
ws_204:
buffer_load_dwordx4 v[52:55],v1,s[8:11],s71 offen offset:1024 sc1
buffer_load_dwordx4 v[56:59],v1,s[8:11],s71 offen offset:2048 sc1
buffer_load_dwordx4 v[60:63],v1,s[8:11],s71 offen offset:3072 sc1
buffer_load_dwordx4 v[64:67],v1,s[8:11],s80 offen sc1
buffer_load_dwordx4 v[68:71],v1,s[8:11],s80 offen offset:1024 sc1
s_sub_u32 s47,s47,1
s_cbranch_scc1 ABORT
s_waitcnt vmcnt(4)
v_and_b32 v12,1,v52
v_cmp_ne_u32 vcc,s57,v12
s_nop 0
s_cbranch_vccnz ws_204
s_branch wg_213
ws_205:
buffer_load_dwordx4 v[56:59],v1,s[8:11],s71 offen offset:2048 sc1
buffer_load_dwordx4 v[60:63],v1,s[8:11],s71 offen offset:3072 sc1
buffer_load_dwordx4 v[64:67],v1,s[8:11],s80 offen sc1
buffer_load_dwordx4 v[68:71],v1,s[8:11],s80 offen offset:1024 sc1
buffer_load_dwordx4 v[72:75],v1,s[8:11],s80 offen offset:2048 sc1
s_sub_u32 s47,s47,1
s_cbranch_scc1 ABORT
s_waitcnt vmcnt(3)
v_bitop3_b32 v12,v56,v60,s57 bitop3:0x7e
v_and_b32 v12,1,v12
v_cmp_ne_u32 vcc,0,v12
s_nop 0
s_cbranch_vccnz ws_205
s_branch wg_214
ws_206:
buffer_load_dwordx4 v[64:67],v1,s[8:11],s80 offen sc1
buffer_load_dwordx4 v[68:71],v1,s[8:11],s80 offen offset:1024 sc1
buffer_load_dwordx4 v[72:75],v1,s[8:11],s80 offen offset:2048 sc1
buffer_load_dwordx4 v[76:79],v1,s[8:11],s80 offen offset:3072 sc1
s_sub_u32 s47,s47,1
s_cbranch_scc1 ABORT
s_waitcnt vmcnt(2)
v_bitop3_b32 v12,v64,v68,s57 bitop3:0x7e
v_and_b32 v12,1,v12
v_cmp_ne_u32 vcc,0,v12
s_nop 0
s_cbranch_vccnz ws_206
s_branch wg_215
ws_207:
buffer_load_dwordx4 v[72:75],v1,s[8:11],s80 offen offset:2048 sc1
buffer_load_dwordx4 v[76:79],v1,s[8:11],s80 offen offset:3072 sc1
s_sub_u32 s47,s47,1
s_cbranch_scc1 ABORT
s_waitcnt vmcnt(0)
v_bitop3_b32 v12,v72,v76,s57 bitop3:0x7e
v_and_b32 v12,1,v12
v_cmp_ne_u32 vcc,0,v12
s_nop 0
s_cbranch_vccnz ws_207
s_branch wg_216
CW_DONE:
s_add_u32 s61,s48,48
s_endpgm
DISPATCH:
s_sub_u32 s48,s3,0
s_cmp_lt_u32 s3,16
s_cbranch_scc1 ROLE_CS
s_sub_u32 s48,s3,16
s_cmp_lt_u32 s3,24
s_cbranch_scc1 ROLE_CV
s_sub_u32 s48,s3,24
s_cmp_lt_u32 s3,32
s_cbranch_scc1 ROLE_CW
s_sub_u32 s48,s3,16
s_cmp_lt_u32 s3,48
s_cbranch_scc1 ROLE_CS
s_sub_u32 s48,s3,40
s_cmp_lt_u32 s3,56
s_cbranch_scc1 ROLE_CV
s_sub_u32 s48,s3,48
s_cmp_lt_u32 s3,64
s_cbranch_scc1 ROLE_CW
s_sub_u32 s48,s3,64
s_cmp_lt_u32 s3,74
s_cbranch_scc1 ROLE_W4
s_sub_u32 s48,s3,74
s_cmp_lt_u32 s3,79
s_cbranch_scc1 ROLE_W1
s_sub_u32 s48,s3,79
s_cmp_lt_u32 s3,91
s_cbranch_scc1 ROLE_W3
s_sub_u32 s48,s3,91
s_cmp_lt_u32 s3,96
s_cbranch_scc1 ROLE_W2
s_sub_u32 s48,s3,96
s_cmp_lt_u32 s3,104
s_cbranch_scc1 ROLE_QKVQ
s_sub_u32 s48,s3,104
s_cmp_lt_u32 s3,112
s_cbranch_scc1 ROLE_QKVV
s_sub_u32 s48,s3,112
s_cmp_lt_u32 s3,128
s_cbranch_scc1 ROLE_R1
s_sub_u32 s48,s3,128
s_cmp_lt_u32 s3,138
s_cbranch_scc1 ROLE_WO
s_sub_u32 s48,s3,138
s_cmp_lt_u32 s3,146
s_cbranch_scc1 ROLE_ATT
s_sub_u32 s48,s3,138
s_cmp_lt_u32 s3,156
s_cbranch_scc1 ROLE_QKVQ
s_sub_u32 s48,s3,148
s_cmp_lt_u32 s3,160
s_cbranch_scc1 ROLE_QKVV
s_sub_u32 s48,s3,150
s_cmp_lt_u32 s3,170
s_cbranch_scc1 ROLE_WO
s_sub_u32 s48,s3,162
s_cmp_lt_u32 s3,178
s_cbranch_scc1 ROLE_ATT
s_sub_u32 s48,s3,160
s_cmp_lt_u32 s3,188
s_cbranch_scc1 ROLE_QKVQ
s_sub_u32 s48,s3,176
s_cmp_lt_u32 s3,192
s_cbranch_scc1 ROLE_QKVV
s_sub_u32 s48,s3,172
s_cmp_lt_u32 s3,202
s_cbranch_scc1 ROLE_WO
s_sub_u32 s48,s3,186
s_cmp_lt_u32 s3,210
s_cbranch_scc1 ROLE_ATT
s_sub_u32 s48,s3,182
s_cmp_lt_u32 s3,220
s_cbranch_scc1 ROLE_QKVQ
s_sub_u32 s48,s3,204
s_cmp_lt_u32 s3,224
s_cbranch_scc1 ROLE_QKVV
s_sub_u32 s48,s3,194
s_cmp_lt_u32 s3,234
s_cbranch_scc1 ROLE_WO
s_sub_u32 s48,s3,210
s_cmp_lt_u32 s3,242
s_cbranch_scc1 ROLE_ATT
s_sub_u32 s48,s3,204
s_cmp_lt_u32 s3,252
s_cbranch_scc1 ROLE_QKVQ
s_sub_u32 s48,s3,232
s_cmp_lt_u32 s3,256
s_cbranch_scc1 ROLE_QKVV
s_branch ROLE_SPARE
EXIT:
s_endpgm
ABORT:
s_mov_b64 exec,1
v_mov_b32 v1,s2
v_add_u32 v1,0x10000,v1
v_mov_b32 v2,8
buffer_store_dword v1,v2,s[12:15],0 offen
s_endpgm
ROLE_SPARE:
s_waitcnt vmcnt(0)
s_barrier
s_cmp_lg_u32 s46,0
s_cbranch_scc1 arr_217
v_mov_b32 v12,1
s_lshl_b32 s3,s49,2
v_mov_b32 v13,s3
s_mov_b64 exec,1
buffer_atomic_add v12,v13,s[12:15],0 offen sc1
s_mov_b64 exec,-1
arr_217:
s_lshl_b32 s3,s49,2
v_mov_b32 v13,s3
s_nop 1
ibw_218:
buffer_load_dword v12,v13,s[12:15],0 offen sc1
s_waitcnt vmcnt(0)
v_cmp_ne_u32 vcc,256,v12
s_nop 0
s_cbranch_vccz ok_219
s_sleep 8
s_sub_u32 s47,s47,1
s_cbranch_scc1 ABORT
s_branch ibw_218
ok_219:
s_cmp_lg_u32 s49,0
s_cbranch_scc1 ibok_220
v_and_b32 v13,7,v0
v_lshlrev_b32 v13,2,v13
buffer_load_dword v12,v13,s[12:15],0 offen offset:32 sc1
s_waitcnt vmcnt(0)
v_cmp_ne_u32 vcc,32,v12
s_nop 0
s_cbranch_vccz ibok_220
s_barrier
s_mov_b32 s49,1
s_mov_b32 s3,s2
s_load_dwordx16 s[16:31],s[0:1],0
s_load_dwordx8 s[32:39],s[0:1],64
s_waitcnt lgkmcnt(0)
s_branch DISPATCH
ibok_220:
s_endpgm
ROLE_QKVQ:
v_lshlrev_b32 v1,4,v0
v_mov_b32 v5,1
s_lshl_b32 s56,s48,2
s_add_u32 s56,s56,s46
v_bfe_u32 v6,v0,2,2
v_lshrrev_b32 v7,4,v0
v_add_u32 v7,v6,v7
v_and_b32 v7,3,v7
v_and_b32 v15,3,v0
v_lshlrev_b32 v15,4,v15
v_lshl_add_u32 v15,v7,6,v15
v_lshl_add_u32 v15,v6,8,v15
v_lshrrev_b32 v6,5,v0
v_bfe_u32 v7,v0,4,1
v_lshlrev_b32 v16,10,v7
v_bfe_u32 v7,v0,2,2
v_lshl_add_u32 v16,v7,8,v16
v_add_u32 v6,v6,v7
v_and_b32 v6,3,v6
v_lshl_add_u32 v16,v6,6,v16
v_and_b32 v6,3,v0
v_lshl_add_u32 v16,v6,4,v16
v_add_u32 v18,46080,v16
v_lshrrev_b32 v6,5,v0
v_bfe_u32 v7,v0,4,1
v_lshlrev_b32 v20,10,v7
v_lshl_add_u32 v20,v6,8,v20
v_and_b32 v6,15,v0
v_lshl_add_u32 v20,v6,4,v20
v_lshrrev_b32 v6,5,v0
v_add_u32 v6,2,v6
v_bfe_u32 v7,v0,4,1
v_lshlrev_b32 v17,10,v7
v_bfe_u32 v7,v0,2,2
v_lshl_add_u32 v17,v7,8,v17
v_add_u32 v6,v6,v7
v_and_b32 v6,3,v6
v_lshl_add_u32 v17,v6,6,v17
v_and_b32 v6,3,v0
v_lshl_add_u32 v17,v6,4,v17
v_add_u32 v19,46080,v17
v_lshrrev_b32 v6,5,v0
v_add_u32 v6,2,v6
v_bfe_u32 v7,v0,4,1
v_lshlrev_b32 v21,10,v7
v_lshl_add_u32 v21,v6,8,v21
v_and_b32 v6,15,v0
v_lshl_add_u32 v21,v6,4,v21
s_cmp_ge_u32 s48,24
s_cselect_b32 s68,1,0
s_mul_i32 s60,s68,96
s_sub_u32 s69,s56,s60
s_mul_i32 s70,s68,50331648
s_add_u32 s70,s70,74448896
s_mul_i32 s60,s68,65536
s_sub_u32 s71,131072,s60
s_lshl_b32 s60,s69,12
s_add_u32 s70,s70,s60
v_lshrrev_b32 v6,5,v0
v_mul_u32_u24 v188,2560,v6
v_and_b32 v6,31,v0
v_lshl_add_u32 v188,v6,3,v188
v_add_u32 v188,0xa000,v188
v_min_u32 v12,7,v0
v_lshlrev_b32 v12,2,v12
v_min_u32 v13,39,v0
v_lshlrev_b32 v13,2,v13
v_mov_b32 v14,93184
s_waitcnt vmcnt(0)
s_barrier
s_cmp_lg_u32 s46,0
s_cbranch_scc1 arr_221
v_mov_b32 v6,1
s_lshl_b32 s3,s49,2
v_mov_b32 v7,s3
s_mov_b64 exec,1
buffer_atomic_add v6,v7,s[12:15],0 offen sc1
s_mov_b64 exec,-1
arr_221:
s_lshl_b32 s58,s69,7
s_mul_i32 s63,s46,40960
s_cmp_eq_u32 s68,0
s_cselect_b32 s4,s22,s20
s_cselect_b32 s5,s23,s21
s_mov_b32 s6,7864320
s_mov_b32 s7,0x20000
v_lshrrev_b32 v9,3,v0
s_mov_b32 s64,12288
v_mul_lo_u32 v9,v9,s64
v_and_b32 v10,7,v0
v_lshl_add_u32 v6,v10,4,v9
s_add_u32 m0,s63,0
s_add_u32 s65,s58,0
buffer_load_dwordx4 v6,s[4:7],s65 offen lds
s_add_u32 m0,s63,1024
s_add_u32 s65,s58,98304
buffer_load_dwordx4 v6,s[4:7],s65 offen lds
s_add_u32 m0,s63,2048
s_add_u32 s65,s58,196608
buffer_load_dwordx4 v6,s[4:7],s65 offen lds
s_add_u32 m0,s63,3072
s_add_u32 s65,s58,294912
buffer_load_dwordx4 v6,s[4:7],s65 offen lds
s_add_u32 m0,s63,4096
s_add_u32 s65,s58,393216
buffer_load_dwordx4 v6,s[4:7],s65 offen lds
s_add_u32 m0,s63,5120
s_add_u32 s65,s58,491520
buffer_load_dwordx4 v6,s[4:7],s65 offen lds
s_add_u32 m0,s63,6144
s_add_u32 s65,s58,589824
buffer_load_dwordx4 v6,s[4:7],s65 offen lds
s_add_u32 m0,s63,7168
s_add_u32 s65,s58,688128
buffer_load_dwordx4 v6,s[4:7],s65 offen lds
s_add_u32 m0,s63,8192
s_add_u32 s65,s58,786432
buffer_load_dwordx4 v6,s[4:7],s65 offen lds
s_add_u32 m0,s63,9216
s_add_u32 s65,s58,884736
buffer_load_dwordx4 v6,s[4:7],s65 offen lds
s_add_u32 m0,s63,10240
s_add_u32 s65,s58,983040
buffer_load_dwordx4 v6,s[4:7],s65 offen lds
s_add_u32 m0,s63,11264
s_add_u32 s65,s58,1081344
buffer_load_dwordx4 v6,s[4:7],s65 offen lds
s_add_u32 m0,s63,12288
s_add_u32 s65,s58,1179648
buffer_load_dwordx4 v6,s[4:7],s65 offen lds
s_add_u32 m0,s63,13312
s_add_u32 s65,s58,1277952
buffer_load_dwordx4 v6,s[4:7],s65 offen lds
s_add_u32 m0,s63,14336
s_add_u32 s65,s58,1376256
buffer_load_dwordx4 v6,s[4:7],s65 offen lds
s_add_u32 m0,s63,15360
s_add_u32 s65,s58,1474560
buffer_load_dwordx4 v6,s[4:7],s65 offen lds
s_add_u32 m0,s63,16384
s_add_u32 s65,s58,1572864
buffer_load_dwordx4 v6,s[4:7],s65 offen lds
s_add_u32 m0,s63,17408
s_add_u32 s65,s58,1671168
buffer_load_dwordx4 v6,s[4:7],s65 offen lds
s_add_u32 m0,s63,18432
s_add_u32 s65,s58,1769472
buffer_load_dwordx4 v6,s[4:7],s65 offen lds
s_add_u32 m0,s63,19456
s_add_u32 s65,s58,1867776
buffer_load_dwordx4 v6,s[4:7],s65 offen lds
s_add_u32 m0,s63,20480
s_add_u32 s65,s58,1966080
buffer_load_dwordx4 v6,s[4:7],s65 offen lds
s_add_u32 m0,s63,21504
s_add_u32 s65,s58,2064384
buffer_load_dwordx4 v6,s[4:7],s65 offen lds
s_add_u32 m0,s63,22528
s_add_u32 s65,s58,2162688
buffer_load_dwordx4 v6,s[4:7],s65 offen lds
s_add_u32 m0,s63,23552
s_add_u32 s65,s58,2260992
buffer_load_dwordx4 v6,s[4:7],s65 offen lds
s_add_u32 m0,s63,24576
s_add_u32 s65,s58,2359296
buffer_load_dwordx4 v6,s[4:7],s65 offen lds
s_add_u32 m0,s63,25600
s_add_u32 s65,s58,2457600
buffer_load_dwordx4 v6,s[4:7],s65 offen lds
s_add_u32 m0,s63,26624
s_add_u32 s65,s58,2555904
buffer_load_dwordx4 v6,s[4:7],s65 offen lds
s_add_u32 m0,s63,27648
s_add_u32 s65,s58,2654208
buffer_load_dwordx4 v6,s[4:7],s65 offen lds
s_add_u32 m0,s63,28672
s_add_u32 s65,s58,2752512
buffer_load_dwordx4 v6,s[4:7],s65 offen lds
s_add_u32 m0,s63,29696
s_add_u32 s65,s58,2850816
buffer_load_dwordx4 v6,s[4:7],s65 offen lds
s_add_u32 m0,s63,30720
s_add_u32 s65,s58,2949120
buffer_load_dwordx4 v6,s[4:7],s65 offen lds
s_add_u32 m0,s63,31744
s_add_u32 s65,s58,3047424
buffer_load_dwordx4 v6,s[4:7],s65 offen lds
s_add_u32 m0,s63,32768
s_add_u32 s65,s58,3145728
buffer_load_dwordx4 v6,s[4:7],s65 offen lds
s_add_u32 m0,s63,33792
s_add_u32 s65,s58,3244032
buffer_load_dwordx4 v6,s[4:7],s65 offen lds
s_add_u32 m0,s63,34816
s_add_u32 s65,s58,3342336
buffer_load_dwordx4 v6,s[4:7],s65 offen lds
s_add_u32 m0,s63,35840
s_add_u32 s65,s58,3440640
buffer_load_dwordx4 v6,s[4:7],s65 offen lds
s_add_u32 m0,s63,36864
s_add_u32 s65,s58,3538944
buffer_load_dwordx4 v6,s[4:7],s65 offen lds
s_add_u32 m0,s63,37888
s_add_u32 s65,s58,3637248
buffer_load_dwordx4 v6,s[4:7],s65 offen lds
s_add_u32 m0,s63,38912
s_add_u32 s65,s58,3735552
buffer_load_dwordx4 v6,s[4:7],s65 offen lds
s_add_u32 m0,s63,39936
s_add_u32 s65,s58,3833856
buffer_load_dwordx4 v6,s[4:7],s65 offen lds
s_waitcnt vmcnt(20)
v_bfe_u32 v9,v0,2,2
v_lshrrev_b32 v10,5,v0
v_lshl_add_u32 v9,v10,2,v9
v_mul_u32_u24 v9,128,v9
v_and_b32 v10,1,v0
v_lshl_add_u32 v9,v10,3,v9
v_bfe_u32 v10,v0,1,1
v_lshl_add_u32 v9,v10,5,v9
v_bfe_u32 v10,v0,4,1
v_lshl_add_u32 v9,v10,4,v9
v_add_u32 v7,s63,v9
ds_read_b64_tr_b16 a[0:1],v7 offset:0
ds_read_b64_tr_b16 a[2:3],v7 offset:2048
ds_read_b64_tr_b16 a[4:5],v7 offset:1024
ds_read_b64_tr_b16 a[6:7],v7 offset:3072
ds_read_b64_tr_b16 a[160:161],v7 offset:64
ds_read_b64_tr_b16 a[162:163],v7 offset:2112
ds_read_b64_tr_b16 a[164:165],v7 offset:1088
ds_read_b64_tr_b16 a[166:167],v7 offset:3136
ds_read_b64_tr_b16 a[8:9],v7 offset:4096
ds_read_b64_tr_b16 a[10:11],v7 offset:6144
ds_read_b64_tr_b16 a[12:13],v7 offset:5120
ds_read_b64_tr_b16 a[14:15],v7 offset:7168
s_waitcnt lgkmcnt(4)
ds_read_b64_tr_b16 a[168:169],v7 offset:4160
ds_read_b64_tr_b16 a[170:171],v7 offset:6208
ds_read_b64_tr_b16 a[172:173],v7 offset:5184
ds_read_b64_tr_b16 a[174:175],v7 offset:7232
ds_read_b64_tr_b16 a[16:17],v7 offset:8192
ds_read_b64_tr_b16 a[18:19],v7 offset:10240
ds_read_b64_tr_b16 a[20:21],v7 offset:9216
ds_read_b64_tr_b16 a[22:23],v7 offset:11264
ds_read_b64_tr_b16 a[176:177],v7 offset:8256
ds_read_b64_tr_b16 a[178:179],v7 offset:10304
ds_read_b64_tr_b16 a[180:181],v7 offset:9280
ds_read_b64_tr_b16 a[182:183],v7 offset:11328
s_waitcnt lgkmcnt(4)
ds_read_b64_tr_b16 a[24:25],v7 offset:12288
ds_read_b64_tr_b16 a[26:27],v7 offset:14336
ds_read_b64_tr_b16 a[28:29],v7 offset:13312
ds_read_b64_tr_b16 a[30:31],v7 offset:15360
ds_read_b64_tr_b16 a[184:185],v7 offset:12352
ds_read_b64_tr_b16 a[186:187],v7 offset:14400
ds_read_b64_tr_b16 a[188:189],v7 offset:13376
ds_read_b64_tr_b16 a[190:191],v7 offset:15424
ds_read_b64_tr_b16 a[32:33],v7 offset:16384
ds_read_b64_tr_b16 a[34:35],v7 offset:18432
ds_read_b64_tr_b16 a[36:37],v7 offset:17408
ds_read_b64_tr_b16 a[38:39],v7 offset:19456
s_waitcnt lgkmcnt(4)
ds_read_b64_tr_b16 a[192:193],v7 offset:16448
ds_read_b64_tr_b16 a[194:195],v7 offset:18496
ds_read_b64_tr_b16 a[196:197],v7 offset:17472
ds_read_b64_tr_b16 a[198:199],v7 offset:19520
s_waitcnt lgkmcnt(0)
s_add_u32 m0,s63,0
s_add_u32 s65,s58,3932160
buffer_load_dwordx4 v6,s[4:7],s65 offen lds
s_add_u32 m0,s63,1024
s_add_u32 s65,s58,4030464
buffer_load_dwordx4 v6,s[4:7],s65 offen lds
s_add_u32 m0,s63,2048
s_add_u32 s65,s58,4128768
buffer_load_dwordx4 v6,s[4:7],s65 offen lds
s_add_u32 m0,s63,3072
s_add_u32 s65,s58,4227072
buffer_load_dwordx4 v6,s[4:7],s65 offen lds
s_add_u32 m0,s63,4096
s_add_u32 s65,s58,4325376
buffer_load_dwordx4 v6,s[4:7],s65 offen lds
s_add_u32 m0,s63,5120
s_add_u32 s65,s58,4423680
buffer_load_dwordx4 v6,s[4:7],s65 offen lds
s_add_u32 m0,s63,6144
s_add_u32 s65,s58,4521984
buffer_load_dwordx4 v6,s[4:7],s65 offen lds
s_add_u32 m0,s63,7168
s_add_u32 s65,s58,4620288
buffer_load_dwordx4 v6,s[4:7],s65 offen lds
s_add_u32 m0,s63,8192
s_add_u32 s65,s58,4718592
buffer_load_dwordx4 v6,s[4:7],s65 offen lds
s_add_u32 m0,s63,9216
s_add_u32 s65,s58,4816896
buffer_load_dwordx4 v6,s[4:7],s65 offen lds
s_add_u32 m0,s63,10240
s_add_u32 s65,s58,4915200
buffer_load_dwordx4 v6,s[4:7],s65 offen lds
s_add_u32 m0,s63,11264
s_add_u32 s65,s58,5013504
buffer_load_dwordx4 v6,s[4:7],s65 offen lds
s_add_u32 m0,s63,12288
s_add_u32 s65,s58,5111808
buffer_load_dwordx4 v6,s[4:7],s65 offen lds
s_add_u32 m0,s63,13312
s_add_u32 s65,s58,5210112
buffer_load_dwordx4 v6,s[4:7],s65 offen lds
s_add_u32 m0,s63,14336
s_add_u32 s65,s58,5308416
buffer_load_dwordx4 v6,s[4:7],s65 offen lds
s_add_u32 m0,s63,15360
s_add_u32 s65,s58,5406720
buffer_load_dwordx4 v6,s[4:7],s65 offen lds
s_add_u32 m0,s63,16384
s_add_u32 s65,s58,5505024
buffer_load_dwordx4 v6,s[4:7],s65 offen lds
s_add_u32 m0,s63,17408
s_add_u32 s65,s58,5603328
buffer_load_dwordx4 v6,s[4:7],s65 offen lds
s_add_u32 m0,s63,18432
s_add_u32 s65,s58,5701632
buffer_load_dwordx4 v6,s[4:7],s65 offen lds
s_add_u32 m0,s63,19456
s_add_u32 s65,s58,5799936
buffer_load_dwordx4 v6,s[4:7],s65 offen lds
s_waitcnt vmcnt(20)
v_bfe_u32 v9,v0,2,2
v_lshrrev_b32 v10,5,v0
v_lshl_add_u32 v9,v10,2,v9
v_mul_u32_u24 v9,128,v9
v_and_b32 v10,1,v0
v_lshl_add_u32 v9,v10,3,v9
v_bfe_u32 v10,v0,1,1
v_lshl_add_u32 v9,v10,5,v9
v_bfe_u32 v10,v0,4,1
v_lshl_add_u32 v9,v10,4,v9
v_add_u32 v7,s63,v9
ds_read_b64_tr_b16 a[40:41],v7 offset:20480
ds_read_b64_tr_b16 a[42:43],v7 offset:22528
ds_read_b64_tr_b16 a[44:45],v7 offset:21504
ds_read_b64_tr_b16 a[46:47],v7 offset:23552
ds_read_b64_tr_b16 a[200:201],v7 offset:20544
ds_read_b64_tr_b16 a[202:203],v7 offset:22592
ds_read_b64_tr_b16 a[204:205],v7 offset:21568
ds_read_b64_tr_b16 a[206:207],v7 offset:23616
ds_read_b64_tr_b16 a[48:49],v7 offset:24576
ds_read_b64_tr_b16 a[50:51],v7 offset:26624
ds_read_b64_tr_b16 a[52:53],v7 offset:25600
ds_read_b64_tr_b16 a[54:55],v7 offset:27648
s_waitcnt lgkmcnt(4)
ds_read_b64_tr_b16 a[208:209],v7 offset:24640
ds_read_b64_tr_b16 a[210:211],v7 offset:26688
ds_read_b64_tr_b16 a[212:213],v7 offset:25664
ds_read_b64_tr_b16 a[214:215],v7 offset:27712
ds_read_b64_tr_b16 a[56:57],v7 offset:28672
ds_read_b64_tr_b16 a[58:59],v7 offset:30720
ds_read_b64_tr_b16 a[60:61],v7 offset:29696
ds_read_b64_tr_b16 a[62:63],v7 offset:31744
ds_read_b64_tr_b16 a[216:217],v7 offset:28736
ds_read_b64_tr_b16 a[218:219],v7 offset:30784
ds_read_b64_tr_b16 a[220:221],v7 offset:29760
ds_read_b64_tr_b16 a[222:223],v7 offset:31808
s_waitcnt lgkmcnt(4)
ds_read_b64_tr_b16 a[64:65],v7 offset:32768
ds_read_b64_tr_b16 a[66:67],v7 offset:34816
ds_read_b64_tr_b16 a[68:69],v7 offset:33792
ds_read_b64_tr_b16 a[70:71],v7 offset:35840
ds_read_b64_tr_b16 a[224:225],v7 offset:32832
ds_read_b64_tr_b16 a[226:227],v7 offset:34880
ds_read_b64_tr_b16 a[228:229],v7 offset:33856
ds_read_b64_tr_b16 a[230:231],v7 offset:35904
ds_read_b64_tr_b16 a[72:73],v7 offset:36864
ds_read_b64_tr_b16 a[74:75],v7 offset:38912
ds_read_b64_tr_b16 a[76:77],v7 offset:37888
ds_read_b64_tr_b16 a[78:79],v7 offset:39936
s_waitcnt lgkmcnt(4)
ds_read_b64_tr_b16 a[232:233],v7 offset:36928
ds_read_b64_tr_b16 a[234:235],v7 offset:38976
ds_read_b64_tr_b16 a[236:237],v7 offset:37952
ds_read_b64_tr_b16 a[238:239],v7 offset:40000
s_waitcnt lgkmcnt(0)
s_add_u32 m0,s63,20480
s_add_u32 s65,s58,5898240
buffer_load_dwordx4 v6,s[4:7],s65 offen lds
s_add_u32 m0,s63,21504
s_add_u32 s65,s58,5996544
buffer_load_dwordx4 v6,s[4:7],s65 offen lds
s_add_u32 m0,s63,22528
s_add_u32 s65,s58,6094848
buffer_load_dwordx4 v6,s[4:7],s65 offen lds
s_add_u32 m0,s63,23552
s_add_u32 s65,s58,6193152
buffer_load_dwordx4 v6,s[4:7],s65 offen lds
s_add_u32 m0,s63,24576
s_add_u32 s65,s58,6291456
buffer_load_dwordx4 v6,s[4:7],s65 offen lds
s_add_u32 m0,s63,25600
s_add_u32 s65,s58,6389760
buffer_load_dwordx4 v6,s[4:7],s65 offen lds
s_add_u32 m0,s63,26624
s_add_u32 s65,s58,6488064
buffer_load_dwordx4 v6,s[4:7],s65 offen lds
s_add_u32 m0,s63,27648
s_add_u32 s65,s58,6586368
buffer_load_dwordx4 v6,s[4:7],s65 offen lds
s_add_u32 m0,s63,28672
s_add_u32 s65,s58,6684672
buffer_load_dwordx4 v6,s[4:7],s65 offen lds
s_add_u32 m0,s63,29696
s_add_u32 s65,s58,6782976
buffer_load_dwordx4 v6,s[4:7],s65 offen lds
s_add_u32 m0,s63,30720
s_add_u32 s65,s58,6881280
buffer_load_dwordx4 v6,s[4:7],s65 offen lds
s_add_u32 m0,s63,31744
s_add_u32 s65,s58,6979584
buffer_load_dwordx4 v6,s[4:7],s65 offen lds
s_add_u32 m0,s63,32768
s_add_u32 s65,s58,7077888
buffer_load_dwordx4 v6,s[4:7],s65 offen lds
s_add_u32 m0,s63,33792
s_add_u32 s65,s58,7176192
buffer_load_dwordx4 v6,s[4:7],s65 offen lds
s_add_u32 m0,s63,34816
s_add_u32 s65,s58,7274496
buffer_load_dwordx4 v6,s[4:7],s65 offen lds
s_add_u32 m0,s63,35840
s_add_u32 s65,s58,7372800
buffer_load_dwordx4 v6,s[4:7],s65 offen lds
s_add_u32 m0,s63,36864
s_add_u32 s65,s58,7471104
buffer_load_dwordx4 v6,s[4:7],s65 offen lds
s_add_u32 m0,s63,37888
s_add_u32 s65,s58,7569408
buffer_load_dwordx4 v6,s[4:7],s65 offen lds
s_add_u32 m0,s63,38912
s_add_u32 s65,s58,7667712
buffer_load_dwordx4 v6,s[4:7],s65 offen lds
s_add_u32 m0,s63,39936
s_add_u32 s65,s58,7766016
buffer_load_dwordx4 v6,s[4:7],s65 offen lds
s_waitcnt vmcnt(20)
v_bfe_u32 v9,v0,2,2
v_lshrrev_b32 v10,5,v0
v_lshl_add_u32 v9,v10,2,v9
v_mul_u32_u24 v9,128,v9
v_and_b32 v10,1,v0
v_lshl_add_u32 v9,v10,3,v9
v_bfe_u32 v10,v0,1,1
v_lshl_add_u32 v9,v10,5,v9
v_bfe_u32 v10,v0,4,1
v_lshl_add_u32 v9,v10,4,v9
v_add_u32 v7,s63,v9
ds_read_b64_tr_b16 a[80:81],v7 offset:0
ds_read_b64_tr_b16 a[82:83],v7 offset:2048
ds_read_b64_tr_b16 a[84:85],v7 offset:1024
ds_read_b64_tr_b16 a[86:87],v7 offset:3072
ds_read_b64_tr_b16 a[240:241],v7 offset:64
ds_read_b64_tr_b16 a[242:243],v7 offset:2112
ds_read_b64_tr_b16 a[244:245],v7 offset:1088
ds_read_b64_tr_b16 a[246:247],v7 offset:3136
ds_read_b64_tr_b16 a[88:89],v7 offset:4096
ds_read_b64_tr_b16 a[90:91],v7 offset:6144
ds_read_b64_tr_b16 a[92:93],v7 offset:5120
ds_read_b64_tr_b16 a[94:95],v7 offset:7168
s_waitcnt lgkmcnt(4)
ds_read_b64_tr_b16 a[248:249],v7 offset:4160
ds_read_b64_tr_b16 a[250:251],v7 offset:6208
ds_read_b64_tr_b16 a[252:253],v7 offset:5184
ds_read_b64_tr_b16 a[254:255],v7 offset:7232
ds_read_b64_tr_b16 a[96:97],v7 offset:8192
ds_read_b64_tr_b16 a[98:99],v7 offset:10240
ds_read_b64_tr_b16 a[100:101],v7 offset:9216
ds_read_b64_tr_b16 a[102:103],v7 offset:11264
ds_read_b64_tr_b16 v[192:193],v7 offset:8256
ds_read_b64_tr_b16 v[194:195],v7 offset:10304
ds_read_b64_tr_b16 v[196:197],v7 offset:9280
ds_read_b64_tr_b16 v[198:199],v7 offset:11328
s_waitcnt lgkmcnt(4)
ds_read_b64_tr_b16 a[104:105],v7 offset:12288
ds_read_b64_tr_b16 a[106:107],v7 offset:14336
ds_read_b64_tr_b16 a[108:109],v7 offset:13312
ds_read_b64_tr_b16 a[110:111],v7 offset:15360
ds_read_b64_tr_b16 v[200:201],v7 offset:12352
ds_read_b64_tr_b16 v[202:203],v7 offset:14400
ds_read_b64_tr_b16 v[204:205],v7 offset:13376
ds_read_b64_tr_b16 v[206:207],v7 offset:15424
ds_read_b64_tr_b16 a[112:113],v7 offset:16384
ds_read_b64_tr_b16 a[114:115],v7 offset:18432
ds_read_b64_tr_b16 a[116:117],v7 offset:17408
ds_read_b64_tr_b16 a[118:119],v7 offset:19456
s_waitcnt lgkmcnt(4)
ds_read_b64_tr_b16 v[208:209],v7 offset:16448
ds_read_b64_tr_b16 v[210:211],v7 offset:18496
ds_read_b64_tr_b16 v[212:213],v7 offset:17472
ds_read_b64_tr_b16 v[214:215],v7 offset:19520
s_waitcnt lgkmcnt(0)
s_waitcnt vmcnt(0)
v_bfe_u32 v9,v0,2,2
v_lshrrev_b32 v10,5,v0
v_lshl_add_u32 v9,v10,2,v9
v_mul_u32_u24 v9,128,v9
v_and_b32 v10,1,v0
v_lshl_add_u32 v9,v10,3,v9
v_bfe_u32 v10,v0,1,1
v_lshl_add_u32 v9,v10,5,v9
v_bfe_u32 v10,v0,4,1
v_lshl_add_u32 v9,v10,4,v9
v_add_u32 v7,s63,v9
ds_read_b64_tr_b16 a[120:121],v7 offset:20480
ds_read_b64_tr_b16 a[122:123],v7 offset:22528
ds_read_b64_tr_b16 a[124:125],v7 offset:21504
ds_read_b64_tr_b16 a[126:127],v7 offset:23552
ds_read_b64_tr_b16 v[216:217],v7 offset:20544
ds_read_b64_tr_b16 v[218:219],v7 offset:22592
ds_read_b64_tr_b16 v[220:221],v7 offset:21568
ds_read_b64_tr_b16 v[222:223],v7 offset:23616
ds_read_b64_tr_b16 a[128:129],v7 offset:24576
ds_read_b64_tr_b16 a[130:131],v7 offset:26624
ds_read_b64_tr_b16 a[132:133],v7 offset:25600
ds_read_b64_tr_b16 a[134:135],v7 offset:27648
s_waitcnt lgkmcnt(4)
ds_read_b64_tr_b16 v[224:225],v7 offset:24640
ds_read_b64_tr_b16 v[226:227],v7 offset:26688
ds_read_b64_tr_b16 v[228:229],v7 offset:25664
ds_read_b64_tr_b16 v[230:231],v7 offset:27712
ds_read_b64_tr_b16 a[136:137],v7 offset:28672
ds_read_b64_tr_b16 a[138:139],v7 offset:30720
ds_read_b64_tr_b16 a[140:141],v7 offset:29696
ds_read_b64_tr_b16 a[142:143],v7 offset:31744
ds_read_b64_tr_b16 v[232:233],v7 offset:28736
ds_read_b64_tr_b16 v[234:235],v7 offset:30784
ds_read_b64_tr_b16 v[236:237],v7 offset:29760
ds_read_b64_tr_b16 v[238:239],v7 offset:31808
s_waitcnt lgkmcnt(4)
ds_read_b64_tr_b16 a[144:145],v7 offset:32768
ds_read_b64_tr_b16 a[146:147],v7 offset:34816
ds_read_b64_tr_b16 a[148:149],v7 offset:33792
ds_read_b64_tr_b16 a[150:151],v7 offset:35840
ds_read_b64_tr_b16 v[240:241],v7 offset:32832
ds_read_b64_tr_b16 v[242:243],v7 offset:34880
ds_read_b64_tr_b16 v[244:245],v7 offset:33856
ds_read_b64_tr_b16 v[246:247],v7 offset:35904
ds_read_b64_tr_b16 a[152:153],v7 offset:36864
ds_read_b64_tr_b16 a[154:155],v7 offset:38912
ds_read_b64_tr_b16 a[156:157],v7 offset:37888
ds_read_b64_tr_b16 a[158:159],v7 offset:39936
s_waitcnt lgkmcnt(4)
ds_read_b64_tr_b16 v[248:249],v7 offset:36928
ds_read_b64_tr_b16 v[250:251],v7 offset:38976
ds_read_b64_tr_b16 v[252:253],v7 offset:37952
ds_read_b64_tr_b16 v[254:255],v7 offset:40000
s_waitcnt lgkmcnt(0)
v_mov_b32 v24,0x3f803f80
v_mov_b32 v25,0x3f803f80
v_mov_b32 v26,0x3f803f80
v_mov_b32 v27,0x3f803f80
s_nop 1
v_mfma_f32_32x32x16_bf16 v[120:135],a[0:3],v[24:27],0
v_mfma_f32_32x32x16_bf16 v[136:151],a[160:163],v[24:27],0
v_mfma_f32_32x32x16_bf16 v[120:135],a[4:7],v[24:27],v[120:135]
v_mfma_f32_32x32x16_bf16 v[136:151],a[164:167],v[24:27],v[136:151]
v_mfma_f32_32x32x16_bf16 v[120:135],a[8:11],v[24:27],v[120:135]
v_mfma_f32_32x32x16_bf16 v[136:151],a[168:171],v[24:27],v[136:151]
v_mfma_f32_32x32x16_bf16 v[120:135],a[12:15],v[24:27],v[120:135]
v_mfma_f32_32x32x16_bf16 v[136:151],a[172:175],v[24:27],v[136:151]
v_mfma_f32_32x32x16_bf16 v[120:135],a[16:19],v[24:27],v[120:135]
v_mfma_f32_32x32x16_bf16 v[136:151],a[176:179],v[24:27],v[136:151]
v_mfma_f32_32x32x16_bf16 v[120:135],a[20:23],v[24:27],v[120:135]
v_mfma_f32_32x32x16_bf16 v[136:151],a[180:183],v[24:27],v[136:151]
v_mfma_f32_32x32x16_bf16 v[120:135],a[24:27],v[24:27],v[120:135]
v_mfma_f32_32x32x16_bf16 v[136:151],a[184:187],v[24:27],v[136:151]
v_mfma_f32_32x32x16_bf16 v[120:135],a[28:31],v[24:27],v[120:135]
v_mfma_f32_32x32x16_bf16 v[136:151],a[188:191],v[24:27],v[136:151]
v_mfma_f32_32x32x16_bf16 v[120:135],a[32:35],v[24:27],v[120:135]
v_mfma_f32_32x32x16_bf16 v[136:151],a[192:195],v[24:27],v[136:151]
v_mfma_f32_32x32x16_bf16 v[120:135],a[36:39],v[24:27],v[120:135]
v_mfma_f32_32x32x16_bf16 v[136:151],a[196:199],v[24:27],v[136:151]
v_mfma_f32_32x32x16_bf16 v[120:135],a[40:43],v[24:27],v[120:135]
v_mfma_f32_32x32x16_bf16 v[136:151],a[200:203],v[24:27],v[136:151]
v_mfma_f32_32x32x16_bf16 v[120:135],a[44:47],v[24:27],v[120:135]
v_mfma_f32_32x32x16_bf16 v[136:151],a[204:207],v[24:27],v[136:151]
v_mfma_f32_32x32x16_bf16 v[120:135],a[48:51],v[24:27],v[120:135]
v_mfma_f32_32x32x16_bf16 v[136:151],a[208:211],v[24:27],v[136:151]
v_mfma_f32_32x32x16_bf16 v[120:135],a[52:55],v[24:27],v[120:135]
v_mfma_f32_32x32x16_bf16 v[136:151],a[212:215],v[24:27],v[136:151]
v_mfma_f32_32x32x16_bf16 v[120:135],a[56:59],v[24:27],v[120:135]
v_mfma_f32_32x32x16_bf16 v[136:151],a[216:219],v[24:27],v[136:151]
v_mfma_f32_32x32x16_bf16 v[120:135],a[60:63],v[24:27],v[120:135]
v_mfma_f32_32x32x16_bf16 v[136:151],a[220:223],v[24:27],v[136:151]
v_mfma_f32_32x32x16_bf16 v[120:135],a[64:67],v[24:27],v[120:135]
v_mfma_f32_32x32x16_bf16 v[136:151],a[224:227],v[24:27],v[136:151]
v_mfma_f32_32x32x16_bf16 v[120:135],a[68:71],v[24:27],v[120:135]
v_mfma_f32_32x32x16_bf16 v[136:151],a[228:231],v[24:27],v[136:151]
v_mfma_f32_32x32x16_bf16 v[120:135],a[72:75],v[24:27],v[120:135]
v_mfma_f32_32x32x16_bf16 v[136:151],a[232:235],v[24:27],v[136:151]
v_mfma_f32_32x32x16_bf16 v[120:135],a[76:79],v[24:27],v[120:135]
v_mfma_f32_32x32x16_bf16 v[136:151],a[236:239],v[24:27],v[136:151]
v_mfma_f32_32x32x16_bf16 v[120:135],a[80:83],v[24:27],v[120:135]
v_mfma_f32_32x32x16_bf16 v[136:151],a[240:243],v[24:27],v[136:151]
v_mfma_f32_32x32x16_bf16 v[120:135],a[84:87],v[24:27],v[120:135]
v_mfma_f32_32x32x16_bf16 v[136:151],a[244:247],v[24:27],v[136:151]
v_mfma_f32_32x32x16_bf16 v[120:135],a[88:91],v[24:27],v[120:135]
v_mfma_f32_32x32x16_bf16 v[136:151],a[248:251],v[24:27],v[136:151]
v_mfma_f32_32x32x16_bf16 v[120:135],a[92:95],v[24:27],v[120:135]
v_mfma_f32_32x32x16_bf16 v[136:151],a[252:255],v[24:27],v[136:151]
v_mfma_f32_32x32x16_bf16 v[120:135],a[96:99],v[24:27],v[120:135]
v_mfma_f32_32x32x16_bf16 v[136:151],v[192:195],v[24:27],v[136:151]
v_mfma_f32_32x32x16_bf16 v[120:135],a[100:103],v[24:27],v[120:135]
v_mfma_f32_32x32x16_bf16 v[136:151],v[196:199],v[24:27],v[136:151]
v_mfma_f32_32x32x16_bf16 v[120:135],a[104:107],v[24:27],v[120:135]
v_mfma_f32_32x32x16_bf16 v[136:151],v[200:203],v[24:27],v[136:151]
v_mfma_f32_32x32x16_bf16 v[120:135],a[108:111],v[24:27],v[120:135]
v_mfma_f32_32x32x16_bf16 v[136:151],v[204:207],v[24:27],v[136:151]
v_mfma_f32_32x32x16_bf16 v[120:135],a[112:115],v[24:27],v[120:135]
v_mfma_f32_32x32x16_bf16 v[136:151],v[208:211],v[24:27],v[136:151]
v_mfma_f32_32x32x16_bf16 v[120:135],a[116:119],v[24:27],v[120:135]
v_mfma_f32_32x32x16_bf16 v[136:151],v[212:215],v[24:27],v[136:151]
v_mfma_f32_32x32x16_bf16 v[120:135],a[120:123],v[24:27],v[120:135]
v_mfma_f32_32x32x16_bf16 v[136:151],v[216:219],v[24:27],v[136:151]
v_mfma_f32_32x32x16_bf16 v[120:135],a[124:127],v[24:27],v[120:135]
v_mfma_f32_32x32x16_bf16 v[136:151],v[220:223],v[24:27],v[136:151]
v_mfma_f32_32x32x16_bf16 v[120:135],a[128:131],v[24:27],v[120:135]
v_mfma_f32_32x32x16_bf16 v[136:151],v[224:227],v[24:27],v[136:151]
v_mfma_f32_32x32x16_bf16 v[120:135],a[132:135],v[24:27],v[120:135]
v_mfma_f32_32x32x16_bf16 v[136:151],v[228:231],v[24:27],v[136:151]
v_mfma_f32_32x32x16_bf16 v[120:135],a[136:139],v[24:27],v[120:135]
v_mfma_f32_32x32x16_bf16 v[136:151],v[232:235],v[24:27],v[136:151]
v_mfma_f32_32x32x16_bf16 v[120:135],a[140:143],v[24:27],v[120:135]
v_mfma_f32_32x32x16_bf16 v[136:151],v[236:239],v[24:27],v[136:151]
v_mfma_f32_32x32x16_bf16 v[120:135],a[144:147],v[24:27],v[120:135]
v_mfma_f32_32x32x16_bf16 v[136:151],v[240:243],v[24:27],v[136:151]
v_mfma_f32_32x32x16_bf16 v[120:135],a[148:151],v[24:27],v[120:135]
v_mfma_f32_32x32x16_bf16 v[136:151],v[244:247],v[24:27],v[136:151]
v_mfma_f32_32x32x16_bf16 v[120:135],a[152:155],v[24:27],v[120:135]
v_mfma_f32_32x32x16_bf16 v[136:151],v[248:251],v[24:27],v[136:151]
v_mfma_f32_32x32x16_bf16 v[120:135],a[156:159],v[24:27],v[120:135]
v_mfma_f32_32x32x16_bf16 v[136:151],v[252:255],v[24:27],v[136:151]
s_barrier
s_lshl_b32 s3,s49,2
v_mov_b32 v7,s3
s_nop 8
ibw_222:
buffer_load_dword v6,v7,s[12:15],0 offen sc1
s_waitcnt vmcnt(0)
v_cmp_ne_u32 vcc,256,v6
s_nop 0
s_cbranch_vccz ok_223
s_sleep 8
s_sub_u32 s47,s47,1
s_cbranch_scc1 ABORT
s_branch ibw_222
ok_223:
s_cmp_lg_u32 s49,0
s_cbranch_scc1 ibok_224
v_and_b32 v7,7,v0
v_lshlrev_b32 v7,2,v7
buffer_load_dword v6,v7,s[12:15],0 offen offset:32 sc1
s_waitcnt vmcnt(0)
v_cmp_ne_u32 vcc,32,v6
s_nop 0
s_cbranch_vccz ibok_224
s_barrier
s_mov_b32 s49,1
s_mov_b32 s3,s2
s_load_dwordx16 s[16:31],s[0:1],0
s_load_dwordx8 s[32:39],s[0:1],64
s_waitcnt lgkmcnt(0)
s_branch DISPATCH
ibok_224:
s_mov_b32 s50,0
s_mov_b32 s32,0
s_mov_b32 s57,0
s_mov_b32 s59,2147483648
s_mov_b32 s82,2147483648
s_mov_b32 s39,2147483648
v_mov_b32 v22,94208
s_mov_b32 s72,0
s_mov_b32 s73,0
s_mov_b32 s83,s100
s_min_u32 s62,s32,127
s_sub_u32 s60,s62,20
s_lshr_b32 s34,s60,1
s_and_b32 s33,s60,1
s_xor_b32 s33,s33,1
s_cmp_eq_u32 s33,0
s_cselect_b32 s61,20,0
s_add_u32 s34,s34,s61
s_sub_u32 s61,s60,44
s_cmp_ge_u32 s60,88
s_cselect_b32 s34,s61,s34
s_cselect_b32 s33,1,s33
s_cmp_lt_u32 s62,20
s_cselect_b32 s34,s62,s34
s_cselect_b32 s33,0,s33
s_lshl_b32 s35,s33,6
s_add_u32 s35,s35,s34
s_lshl_b32 s35,s35,9
s_add_u32 s35,s35,0
s_lshl_b32 s60,s33,5
s_add_u32 s60,s60,7
v_min_u32 v2,s60,v0
v_lshlrev_b32 v2,2,v2
s_nop 1
QKVQ_COLD0:
s_cmp_lg_u32 s46,0
s_cbranch_scc1 cp_225
fb_226:
buffer_load_dword v3,v2,s[8:11],s35 offen sc1
s_waitcnt vmcnt(0)
v_cmp_eq_u32 vcc,0,v3
s_nop 0
s_cbranch_vccz ok_227
s_sleep 7
s_sub_u32 s47,s47,1
s_cbranch_scc1 ABORT
s_branch fb_226
ok_227:
cp_225:
s_barrier
s_lshl_b32 s60,s33,6
s_add_u32 s60,s60,s34
s_mul_i32 s60,s60,46080
s_add_u32 s60,s60,206569472
s_lshl_b32 s62,s46,10
s_add_u32 s62,s62,40960
s_add_u32 m0,s57,s62
s_add_u32 s63,s60,s62
buffer_load_dwordx4 v1,s[8:11],s63 offen sc1 lds
s_add_u32 m0,s57,45056
s_add_u32 s63,s60,45056
buffer_load_dwordx4 v1,s[8:11],s63 offen sc1 lds
s_mul_i32 s61,s46,10240
s_add_u32 s60,s60,s61
s_add_u32 s61,s61,s57
s_add_u32 m0,s61,0
s_add_u32 s63,s60,0
buffer_load_dwordx4 v1,s[8:11],s63 offen sc1 lds
buffer_load_dwordx4 v1,s[8:11],s63 offen offset:1024 sc1 lds
buffer_load_dwordx4 v1,s[8:11],s63 offen offset:2048 sc1 lds
buffer_load_dwordx4 v1,s[8:11],s63 offen offset:3072 sc1 lds
s_add_u32 m0,s61,4096
s_add_u32 s63,s60,4096
buffer_load_dwordx4 v1,s[8:11],s63 offen sc1 lds
buffer_load_dwordx4 v1,s[8:11],s63 offen offset:1024 sc1 lds
buffer_load_dwordx4 v1,s[8:11],s63 offen offset:2048 sc1 lds
buffer_load_dwordx4 v1,s[8:11],s63 offen offset:3072 sc1 lds
s_add_u32 m0,s61,8192
s_add_u32 s63,s60,8192
buffer_load_dwordx4 v1,s[8:11],s63 offen sc1 lds
buffer_load_dwordx4 v1,s[8:11],s63 offen offset:1024 sc1 lds
QKVQ_CD0:
s_mov_b32 s51,s33
s_mov_b32 s52,s34
s_add_u32 s32,s32,1
s_min_u32 s62,s32,127
s_sub_u32 s60,s62,20
s_lshr_b32 s34,s60,1
s_and_b32 s33,s60,1
s_xor_b32 s33,s33,1
s_cmp_eq_u32 s33,0
s_cselect_b32 s61,20,0
s_add_u32 s34,s34,s61
s_sub_u32 s61,s60,44
s_cmp_ge_u32 s60,88
s_cselect_b32 s34,s61,s34
s_cselect_b32 s33,1,s33
s_cmp_lt_u32 s62,20
s_cselect_b32 s34,s62,s34
s_cselect_b32 s33,0,s33
s_lshl_b32 s35,s33,6
s_add_u32 s35,s35,s34
s_lshl_b32 s35,s35,9
s_add_u32 s35,s35,0
s_lshl_b32 s60,s33,5
s_add_u32 s60,s60,7
v_min_u32 v2,s60,v0
v_lshlrev_b32 v2,2,v2
s_cmp_lg_u32 s46,0
s_cbranch_scc1 w0_228
buffer_load_dword v3,v2,s[8:11],s35 offen sc1
w0_228:
s_waitcnt vmcnt(0)
s_mov_b64 exec,1
buffer_store_dword v5,v1,s[8:11],s59 offen sc1
s_mov_b64 exec,-1
s_mov_b32 s59,2147483648
s_cmp_lg_u32 s46,0
s_cbranch_scc1 w0_229
v_cmp_eq_u32 vcc,0,v3
s_cmp_eq_u64 vcc,0
s_cselect_b32 s36,0,2147483648
s_cmp_lt_u32 s32,128
s_cselect_b32 s36,s36,2147483648
v_mov_b32 v23,s36
ds_write_b32 v22,v23
w0_229:
s_waitcnt lgkmcnt(0)
s_barrier
ds_read_b32 v23,v22
ds_read_b128 v[24:27],v16 offset:0
ds_read_b128 v[28:31],v17 offset:0
ds_read_b128 v[32:35],v16 offset:2048
ds_read_b128 v[36:39],v17 offset:2048
ds_read_b128 v[40:43],v16 offset:4096
s_waitcnt lgkmcnt(5)
v_readfirstlane_b32 s37,v23
s_nop 4
QKVQ_B0:
s_waitcnt lgkmcnt(3)
v_mfma_f32_32x32x16_bf16 v[56:71],a[0:3],v[24:27],0
ds_read_b128 v[44:47],v17 offset:4096
v_add_u32 v189,s57,v188
v_mfma_f32_32x32x16_bf16 v[72:87],a[160:163],v[24:27],0
v_add_u32 v8,0x800,v189
s_sub_u32 s66,46080,s57
s_lshl_b32 s60,s33,6
s_add_u32 s60,s60,s34
s_mul_i32 s60,s60,46080
s_add_u32 s60,s60,s37
v_mfma_f32_32x32x16_bf16 v[56:71],a[4:7],v[28:31],v[56:71]
ds_read_b128 v[48:51],v16 offset:6144
ds_read2_b64 v[156:159],v189 offset0:0 offset1:32
s_add_u32 s60,s60,206569472
s_lshl_b32 s62,s46,10
v_mfma_f32_32x32x16_bf16 v[72:87],a[164:167],v[28:31],v[72:87]
ds_read2_b64 v[160:163],v189 offset0:64 offset1:96
s_add_u32 s62,s62,40960
s_add_u32 m0,s66,s62
s_add_u32 s63,s60,s62
s_waitcnt lgkmcnt(5)
v_mfma_f32_32x32x16_bf16 v[56:71],a[8:11],v[32:35],v[56:71]
ds_read_b128 v[52:55],v17 offset:6144
ds_read2_b64 v[164:167],v189 offset0:128 offset1:160
buffer_load_dwordx4 v1,s[8:11],s63 offen sc1 lds
v_mfma_f32_32x32x16_bf16 v[72:87],a[168:171],v[32:35],v[72:87]
ds_read2_b64 v[168:171],v189 offset0:192 offset1:224
s_add_u32 m0,s66,45056
s_add_u32 s63,s60,45056
s_mul_i32 s74,s73,393216
s_add_u32 s74,s74,s39
v_mfma_f32_32x32x16_bf16 v[56:71],a[12:15],v[36:39],v[56:71]
ds_read_b128 v[24:27],v16 offset:8192
ds_read2_b64 v[172:175],v8 offset0:0 offset1:32
s_add_u32 s74,s74,s70
v_fma_f32 v88,-v176,v120,v88
v_mfma_f32_32x32x16_bf16 v[72:87],a[172:175],v[36:39],v[72:87]
buffer_load_dwordx4 v1,s[8:11],s63 offen sc1 lds
s_mul_i32 s61,s46,10240
s_add_u32 s60,s60,s61
s_add_u32 s61,s61,s66
s_waitcnt lgkmcnt(8)
v_mfma_f32_32x32x16_bf16 v[56:71],a[16:19],v[40:43],v[56:71]
ds_read_b128 v[28:31],v17 offset:8192
s_add_u32 m0,s61,0
s_add_u32 s63,s60,0
v_fma_f32 v89,-v176,v121,v89
v_fma_f32 v90,-v176,v122,v90
v_mfma_f32_32x32x16_bf16 v[72:87],a[176:179],v[40:43],v[72:87]
v_fma_f32 v91,-v176,v123,v91
v_fma_f32 v92,-v176,v124,v92
v_fma_f32 v93,-v176,v125,v93
v_fma_f32 v94,-v176,v126,v94
v_fma_f32 v95,-v176,v127,v95
v_mfma_f32_32x32x16_bf16 v[56:71],a[20:23],v[44:47],v[56:71]
ds_read_b128 v[32:35],v16 offset:10240
buffer_load_dwordx4 v1,s[8:11],s63 offen sc1 lds
v_mul_f32 v88,v88,v177
v_mul_f32 v89,v89,v177
v_mfma_f32_32x32x16_bf16 v[72:87],a[180:183],v[44:47],v[72:87]
v_mul_f32 v90,v90,v177
v_mul_f32 v91,v91,v177
v_mul_f32 v92,v92,v177
v_mul_f32 v93,v93,v177
v_mul_f32 v94,v94,v177
s_waitcnt lgkmcnt(6)
v_mfma_f32_32x32x16_bf16 v[56:71],a[24:27],v[48:51],v[56:71]
ds_read_b128 v[36:39],v17 offset:10240
v_mul_f32 v95,v95,v177
v_cvt_pk_bf16_f32 v180,v88,v89
v_cvt_pk_bf16_f32 v181,v90,v91
v_cvt_pk_bf16_f32 v182,v92,v93
v_mfma_f32_32x32x16_bf16 v[72:87],a[184:187],v[48:51],v[72:87]
buffer_load_dwordx4 v1,s[8:11],s63 offen offset:1024 sc1 lds
v_cvt_pk_bf16_f32 v183,v94,v95
buffer_store_dwordx4 v[180:183],v20,s[8:11],s74 offen sc1
v_fma_f32 v96,-v176,v128,v96
v_mfma_f32_32x32x16_bf16 v[56:71],a[28:31],v[52:55],v[56:71]
ds_read_b128 v[40:43],v16 offset:12288
v_fma_f32 v97,-v176,v129,v97
v_fma_f32 v98,-v176,v130,v98
v_fma_f32 v99,-v176,v131,v99
v_fma_f32 v100,-v176,v132,v100
v_mfma_f32_32x32x16_bf16 v[72:87],a[188:191],v[52:55],v[72:87]
v_fma_f32 v101,-v176,v133,v101
v_fma_f32 v102,-v176,v134,v102
v_fma_f32 v103,-v176,v135,v103
v_mul_f32 v96,v96,v177
v_mul_f32 v97,v97,v177
s_waitcnt lgkmcnt(3)
v_mfma_f32_32x32x16_bf16 v[56:71],a[32:35],v[24:27],v[56:71]
ds_read_b128 v[44:47],v17 offset:12288
buffer_load_dwordx4 v1,s[8:11],s63 offen offset:2048 sc1 lds
v_mul_f32 v98,v98,v177
v_mul_f32 v99,v99,v177
v_mfma_f32_32x32x16_bf16 v[72:87],a[192:195],v[24:27],v[72:87]
v_mul_f32 v100,v100,v177
v_mul_f32 v101,v101,v177
v_mul_f32 v102,v102,v177
v_mul_f32 v103,v103,v177
v_cvt_pk_bf16_f32 v184,v96,v97
v_mfma_f32_32x32x16_bf16 v[56:71],a[36:39],v[28:31],v[56:71]
ds_read_b128 v[48:51],v16 offset:14336
v_cvt_pk_bf16_f32 v185,v98,v99
v_cvt_pk_bf16_f32 v186,v100,v101
v_cvt_pk_bf16_f32 v187,v102,v103
v_mfma_f32_32x32x16_bf16 v[72:87],a[196:199],v[28:31],v[72:87]
buffer_load_dwordx4 v1,s[8:11],s63 offen offset:3072 sc1 lds
s_add_u32 m0,s61,4096
s_add_u32 s63,s60,4096
s_waitcnt lgkmcnt(3)
v_mfma_f32_32x32x16_bf16 v[56:71],a[40:43],v[32:35],v[56:71]
ds_read_b128 v[52:55],v17 offset:14336
buffer_store_dwordx4 v[184:187],v21,s[8:11],s74 offen sc1
v_fma_f32 v104,-v176,v136,v104
v_fma_f32 v105,-v176,v137,v105
v_mfma_f32_32x32x16_bf16 v[72:87],a[200:203],v[32:35],v[72:87]
v_fma_f32 v106,-v176,v138,v106
v_fma_f32 v107,-v176,v139,v107
v_fma_f32 v108,-v176,v140,v108
v_fma_f32 v109,-v176,v141,v109
v_fma_f32 v110,-v176,v142,v110
v_mfma_f32_32x32x16_bf16 v[56:71],a[44:47],v[36:39],v[56:71]
ds_read_b128 v[24:27],v16 offset:16384
buffer_load_dwordx4 v1,s[8:11],s63 offen sc1 lds
v_fma_f32 v111,-v176,v143,v111
v_mul_f32 v104,v104,v177
v_mfma_f32_32x32x16_bf16 v[72:87],a[204:207],v[36:39],v[72:87]
v_mul_f32 v105,v105,v177
v_mul_f32 v106,v106,v177
v_mul_f32 v107,v107,v177
v_mul_f32 v108,v108,v177
v_mul_f32 v109,v109,v177
s_waitcnt lgkmcnt(3)
v_mfma_f32_32x32x16_bf16 v[56:71],a[48:51],v[40:43],v[56:71]
ds_read_b128 v[28:31],v17 offset:16384
v_mul_f32 v110,v110,v177
v_mul_f32 v111,v111,v177
v_cvt_pk_bf16_f32 v180,v104,v105
v_cvt_pk_bf16_f32 v181,v106,v107
v_mfma_f32_32x32x16_bf16 v[72:87],a[208:211],v[40:43],v[72:87]
buffer_load_dwordx4 v1,s[8:11],s63 offen offset:1024 sc1 lds
v_cvt_pk_bf16_f32 v182,v108,v109
v_cvt_pk_bf16_f32 v183,v110,v111
buffer_store_dwordx4 v[180:183],v20,s[8:11],s74 offen offset:2048 sc1
v_mfma_f32_32x32x16_bf16 v[56:71],a[52:55],v[44:47],v[56:71]
ds_read_b128 v[32:35],v16 offset:18432
v_fma_f32 v112,-v176,v144,v112
v_fma_f32 v113,-v176,v145,v113
v_fma_f32 v114,-v176,v146,v114
v_fma_f32 v115,-v176,v147,v115
v_mfma_f32_32x32x16_bf16 v[72:87],a[212:215],v[44:47],v[72:87]
v_fma_f32 v116,-v176,v148,v116
v_fma_f32 v117,-v176,v149,v117
v_fma_f32 v118,-v176,v150,v118
v_fma_f32 v119,-v176,v151,v119
v_mul_f32 v112,v112,v177
s_waitcnt lgkmcnt(3)
v_mfma_f32_32x32x16_bf16 v[56:71],a[56:59],v[48:51],v[56:71]
ds_read_b128 v[36:39],v17 offset:18432
buffer_load_dwordx4 v1,s[8:11],s63 offen offset:2048 sc1 lds
v_mul_f32 v113,v113,v177
v_mul_f32 v114,v114,v177
v_mfma_f32_32x32x16_bf16 v[72:87],a[216:219],v[48:51],v[72:87]
v_mul_f32 v115,v115,v177
v_mul_f32 v116,v116,v177
v_mul_f32 v117,v117,v177
v_mul_f32 v118,v118,v177
v_mul_f32 v119,v119,v177
v_mfma_f32_32x32x16_bf16 v[56:71],a[60:63],v[52:55],v[56:71]
ds_read_b128 v[40:43],v16 offset:20480
s_waitcnt vmcnt(12)
s_mov_b64 exec,1
buffer_store_dword v5,v1,s[8:11],s59 offen sc1
s_mov_b64 exec,-1
s_mov_b32 s59,2147483648
v_mfma_f32_32x32x16_bf16 v[72:87],a[220:223],v[52:55],v[72:87]
buffer_load_dwordx4 v1,s[8:11],s63 offen offset:3072 sc1 lds
s_add_u32 m0,s61,8192
s_add_u32 s63,s60,8192
v_cvt_pk_bf16_f32 v184,v112,v113
s_waitcnt lgkmcnt(3)
v_mfma_f32_32x32x16_bf16 v[56:71],a[64:67],v[24:27],v[56:71]
ds_read_b128 v[44:47],v17 offset:20480
v_cvt_pk_bf16_f32 v185,v114,v115
v_cvt_pk_bf16_f32 v186,v116,v117
v_cvt_pk_bf16_f32 v187,v118,v119
v_mfma_f32_32x32x16_bf16 v[72:87],a[224:227],v[24:27],v[72:87]
buffer_store_dwordx4 v[184:187],v21,s[8:11],s74 offen offset:2048 sc1
s_lshl_b32 s82,s72,6
s_add_u32 s82,s82,s73
s_lshl_b32 s82,s82,9
s_add_u32 s82,s82,s71
v_mfma_f32_32x32x16_bf16 v[56:71],a[68:71],v[28:31],v[56:71]
ds_read_b128 v[48:51],v16 offset:22528
buffer_load_dwordx4 v1,s[8:11],s63 offen sc1 lds
s_lshl_b32 s75,s69,2
s_add_u32 s82,s82,s75
v_mfma_f32_32x32x16_bf16 v[72:87],a[228:231],v[28:31],v[72:87]
s_add_u32 s82,s82,s39
v_add_f32 v156,v156,v166
v_add_f32 v157,v157,v167
v_add_f32 v158,v158,v168
s_waitcnt lgkmcnt(3)
v_mfma_f32_32x32x16_bf16 v[56:71],a[72:75],v[32:35],v[56:71]
ds_read_b128 v[52:55],v17 offset:22528
v_add_f32 v159,v159,v169
v_add_f32 v160,v160,v170
v_add_f32 v161,v161,v171
v_add_f32 v162,v162,v172
v_mfma_f32_32x32x16_bf16 v[72:87],a[232:235],v[32:35],v[72:87]
buffer_load_dwordx4 v1,s[8:11],s63 offen offset:1024 sc1 lds
s_mov_b32 s53,s33
s_mov_b32 s54,s34
s_cmp_eq_u32 s37,0
s_addc_u32 s32,s32,0
v_mfma_f32_32x32x16_bf16 v[56:71],a[76:79],v[36:39],v[56:71]
ds_read_b128 v[24:27],v16 offset:24576
s_min_u32 s62,s32,127
s_sub_u32 s60,s62,20
s_lshr_b32 s34,s60,1
s_and_b32 s33,s60,1
v_mfma_f32_32x32x16_bf16 v[72:87],a[236:239],v[36:39],v[72:87]
s_xor_b32 s33,s33,1
s_cmp_eq_u32 s33,0
s_cselect_b32 s61,20,0
s_add_u32 s34,s34,s61
s_sub_u32 s61,s60,44
s_waitcnt lgkmcnt(3)
v_mfma_f32_32x32x16_bf16 v[56:71],a[80:83],v[40:43],v[56:71]
ds_read_b128 v[28:31],v17 offset:24576
s_cmp_ge_u32 s60,88
s_cselect_b32 s34,s61,s34
s_cselect_b32 s33,1,s33
v_add_f32 v163,v163,v173
v_mfma_f32_32x32x16_bf16 v[72:87],a[240:243],v[40:43],v[72:87]
s_cmp_lt_u32 s62,20
s_cselect_b32 s34,s62,s34
s_cselect_b32 s33,0,s33
s_lshl_b32 s35,s33,6
s_add_u32 s35,s35,s34
s_lshl_b32 s35,s35,9
v_mfma_f32_32x32x16_bf16 v[56:71],a[84:87],v[44:47],v[56:71]
ds_read_b128 v[32:35],v16 offset:26624
s_add_u32 s35,s35,0
s_lshl_b32 s60,s33,5
s_add_u32 s60,s60,7
v_min_u32 v2,s60,v0
v_mfma_f32_32x32x16_bf16 v[72:87],a[244:247],v[44:47],v[72:87]
v_lshlrev_b32 v2,2,v2
v_add_f32 v164,v164,v174
v_add_f32 v165,v165,v175
v_add_f32 v156,v156,v158
v_add_f32 v157,v157,v159
s_waitcnt lgkmcnt(3)
v_mfma_f32_32x32x16_bf16 v[56:71],a[88:91],v[48:51],v[56:71]
ds_read_b128 v[36:39],v17 offset:26624
s_cmp_lg_u32 s46,0
s_cbranch_scc1 w0_230
buffer_load_dword v3,v2,s[8:11],s35 offen sc1
w0_230:
v_mfma_f32_32x32x16_bf16 v[72:87],a[248:251],v[48:51],v[72:87]
v_add_f32 v160,v160,v162
v_add_f32 v161,v161,v163
v_add_f32 v156,v156,v160
v_add_f32 v157,v157,v161
v_add_f32 v156,v156,v164
v_mfma_f32_32x32x16_bf16 v[56:71],a[92:95],v[52:55],v[56:71]
ds_read_b128 v[40:43],v16 offset:28672
v_add_f32 v157,v157,v165
v_mov_b32 v158,v156
v_mov_b32 v159,v157
s_nop 0
v_permlane32_swap_b32 v156,v158
v_mfma_f32_32x32x16_bf16 v[72:87],a[252:255],v[52:55],v[72:87]
v_permlane32_swap_b32 v157,v159
v_add_f32 v176,v156,v158
v_add_f32 v177,v157,v159
v_mul_f32 v176,0x3acccccd,v176
v_mul_f32 v177,0x3acccccd,v177
s_waitcnt lgkmcnt(3)
v_mfma_f32_32x32x16_bf16 v[56:71],a[96:99],v[24:27],v[56:71]
ds_read_b128 v[44:47],v17 offset:28672
v_fma_f32 v177,-v176,v176,v177
v_max_f32 v177,0,v177
v_cvt_pk_bf16_f32 v8,v176,v177
v_lshlrev_b32 v176,16,v8
v_mfma_f32_32x32x16_bf16 v[72:87],v[192:195],v[24:27],v[72:87]
v_and_b32 v177,0xffff0000,v8
v_add_f32 v177,0x3727c5ac,v177
v_cvt_pk_bf16_f32 v8,v177,v177
v_lshlrev_b32 v177,16,v8
v_sqrt_f32 v177,v177
v_mfma_f32_32x32x16_bf16 v[56:71],a[100:103],v[28:31],v[56:71]
ds_read_b128 v[48:51],v16 offset:30720
v_cvt_pk_bf16_f32 v8,v177,v177
v_lshlrev_b32 v177,16,v8
v_rcp_f32 v177,v177
v_mfma_f32_32x32x16_bf16 v[72:87],v[196:199],v[28:31],v[72:87]
s_cmp_eq_u32 s51,0
s_cselect_b64 s[76:77],-1,0
v_cndmask_b32 v176,v176,0,s[76:77]
v_cndmask_b32 v177,v177,1.0,s[76:77]
s_mov_b32 s72,s51
s_waitcnt lgkmcnt(3)
v_mfma_f32_32x32x16_bf16 v[56:71],a[104:107],v[32:35],v[56:71]
ds_read_b128 v[52:55],v17 offset:30720
s_mov_b32 s73,s52
v_mfma_f32_32x32x16_bf16 v[72:87],v[200:203],v[32:35],v[72:87]
v_mfma_f32_32x32x16_bf16 v[56:71],a[108:111],v[36:39],v[56:71]
ds_read_b128 v[24:27],v16 offset:32768
v_mfma_f32_32x32x16_bf16 v[72:87],v[204:207],v[36:39],v[72:87]
s_waitcnt lgkmcnt(3)
v_mfma_f32_32x32x16_bf16 v[56:71],a[112:115],v[40:43],v[56:71]
ds_read_b128 v[28:31],v17 offset:32768
v_mfma_f32_32x32x16_bf16 v[72:87],v[208:211],v[40:43],v[72:87]
v_mfma_f32_32x32x16_bf16 v[56:71],a[116:119],v[44:47],v[56:71]
ds_read_b128 v[32:35],v16 offset:34816
v_mfma_f32_32x32x16_bf16 v[72:87],v[212:215],v[44:47],v[72:87]
s_waitcnt lgkmcnt(3)
v_mfma_f32_32x32x16_bf16 v[56:71],a[120:123],v[48:51],v[56:71]
ds_read_b128 v[36:39],v17 offset:34816
v_mfma_f32_32x32x16_bf16 v[72:87],v[216:219],v[48:51],v[72:87]
v_mfma_f32_32x32x16_bf16 v[56:71],a[124:127],v[52:55],v[56:71]
ds_read_b128 v[40:43],v16 offset:36864
v_mfma_f32_32x32x16_bf16 v[72:87],v[220:223],v[52:55],v[72:87]
s_waitcnt vmcnt(0)
s_cmp_lg_u32 s46,0
s_cbranch_scc1 w0_231
v_cmp_eq_u32 vcc,0,v3
s_cmp_eq_u64 vcc,0
s_cselect_b32 s36,0,2147483648
s_cmp_lt_u32 s32,128
s_cselect_b32 s36,s36,2147483648
v_mov_b32 v23,s36
ds_write_b32 v22,v23
w0_231:
s_waitcnt lgkmcnt(3)
v_mfma_f32_32x32x16_bf16 v[56:71],a[128:131],v[24:27],v[56:71]
ds_read_b128 v[44:47],v17 offset:36864
s_mov_b64 exec,1
buffer_store_dword v5,v1,s[8:11],s82 offen sc1
s_mov_b64 exec,-1
s_mov_b32 s82,2147483648
v_mfma_f32_32x32x16_bf16 v[72:87],v[224:227],v[24:27],v[72:87]
v_mfma_f32_32x32x16_bf16 v[56:71],a[132:135],v[28:31],v[56:71]
ds_read_b128 v[48:51],v16 offset:38912
v_mfma_f32_32x32x16_bf16 v[72:87],v[228:231],v[28:31],v[72:87]
s_waitcnt lgkmcnt(3)
v_mfma_f32_32x32x16_bf16 v[56:71],a[136:139],v[32:35],v[56:71]
ds_read_b128 v[52:55],v17 offset:38912
v_mfma_f32_32x32x16_bf16 v[72:87],v[232:235],v[32:35],v[72:87]
s_waitcnt lgkmcnt(2)
s_barrier
ds_read_b32 v23,v22
v_mfma_f32_32x32x16_bf16 v[56:71],a[140:143],v[36:39],v[56:71]
ds_read_b128 v[24:27],v18 offset:0
v_mfma_f32_32x32x16_bf16 v[72:87],v[236:239],v[36:39],v[72:87]
v_mfma_f32_32x32x16_bf16 v[56:71],a[144:147],v[40:43],v[56:71]
ds_read_b128 v[28:31],v19 offset:0
v_mfma_f32_32x32x16_bf16 v[72:87],v[240:243],v[40:43],v[72:87]
v_mfma_f32_32x32x16_bf16 v[56:71],a[148:151],v[44:47],v[56:71]
ds_read_b128 v[32:35],v18 offset:2048
v_mfma_f32_32x32x16_bf16 v[72:87],v[244:247],v[44:47],v[72:87]
s_waitcnt lgkmcnt(4)
v_mfma_f32_32x32x16_bf16 v[56:71],a[152:155],v[48:51],v[56:71]
ds_read_b128 v[36:39],v19 offset:2048
s_waitcnt lgkmcnt(4)
v_readfirstlane_b32 s38,v23
v_mfma_f32_32x32x16_bf16 v[72:87],v[248:251],v[48:51],v[72:87]
v_mfma_f32_32x32x16_bf16 v[56:71],a[156:159],v[52:55],v[56:71]
ds_read_b128 v[40:43],v18 offset:4096
v_mfma_f32_32x32x16_bf16 v[72:87],v[252:255],v[52:55],v[72:87]
s_cmp_lg_u32 s37,0
s_cbranch_scc1 nf_232
s_cmp_lt_u32 s50,2
s_cbranch_scc1 now_233
s_mov_b32 s39,0
s_add_u32 s50,s50,1
s_sub_u32 s57,46080,s57
s_mov_b32 s51,s53
s_mov_b32 s52,s54
s_mov_b32 s37,s38
s_branch QKVQ_B1
s_nop 0
now_233:
s_mov_b32 s55,0
s_branch nt_234
nf_232:
s_mov_b32 s55,2
s_cmp_lg_u32 s38,0
s_cbranch_scc1 nt_234
s_mov_b32 s55,1
s_mov_b32 s37,0
s_sub_u32 s66,46080,s57
s_lshl_b32 s60,s33,6
s_add_u32 s60,s60,s34
s_mul_i32 s60,s60,46080
s_add_u32 s60,s60,s37
s_add_u32 s60,s60,206569472
s_lshl_b32 s62,s46,10
s_add_u32 s62,s62,40960
s_add_u32 m0,s66,s62
s_add_u32 s63,s60,s62
buffer_load_dwordx4 v1,s[8:11],s63 offen sc1 lds
s_add_u32 m0,s66,45056
s_add_u32 s63,s60,45056
buffer_load_dwordx4 v1,s[8:11],s63 offen sc1 lds
s_mul_i32 s61,s46,10240
s_add_u32 s60,s60,s61
s_add_u32 s61,s61,s66
s_add_u32 m0,s61,0
s_add_u32 s63,s60,0
buffer_load_dwordx4 v1,s[8:11],s63 offen sc1 lds
buffer_load_dwordx4 v1,s[8:11],s63 offen offset:1024 sc1 lds
buffer_load_dwordx4 v1,s[8:11],s63 offen offset:2048 sc1 lds
buffer_load_dwordx4 v1,s[8:11],s63 offen offset:3072 sc1 lds
s_add_u32 m0,s61,4096
s_add_u32 s63,s60,4096
buffer_load_dwordx4 v1,s[8:11],s63 offen sc1 lds
buffer_load_dwordx4 v1,s[8:11],s63 offen offset:1024 sc1 lds
buffer_load_dwordx4 v1,s[8:11],s63 offen offset:2048 sc1 lds
buffer_load_dwordx4 v1,s[8:11],s63 offen offset:3072 sc1 lds
s_add_u32 m0,s61,8192
s_add_u32 s63,s60,8192
buffer_load_dwordx4 v1,s[8:11],s63 offen sc1 lds
buffer_load_dwordx4 v1,s[8:11],s63 offen offset:1024 sc1 lds
nt_234:
s_mov_b32 s39,0
s_mul_i32 s74,s73,393216
s_add_u32 s74,s74,s39
s_add_u32 s74,s74,s70
v_fma_f32 v56,-v176,v120,v56
v_fma_f32 v57,-v176,v121,v57
v_fma_f32 v58,-v176,v122,v58
v_fma_f32 v59,-v176,v123,v59
v_fma_f32 v60,-v176,v124,v60
v_fma_f32 v61,-v176,v125,v61
v_fma_f32 v62,-v176,v126,v62
v_fma_f32 v63,-v176,v127,v63
v_mul_f32 v56,v56,v177
v_mul_f32 v57,v57,v177
v_mul_f32 v58,v58,v177
v_mul_f32 v59,v59,v177
v_mul_f32 v60,v60,v177
v_mul_f32 v61,v61,v177
v_mul_f32 v62,v62,v177
v_mul_f32 v63,v63,v177
v_cvt_pk_bf16_f32 v180,v56,v57
v_cvt_pk_bf16_f32 v181,v58,v59
v_cvt_pk_bf16_f32 v182,v60,v61
v_cvt_pk_bf16_f32 v183,v62,v63
buffer_store_dwordx4 v[180:183],v20,s[8:11],s74 offen sc1
v_fma_f32 v64,-v176,v128,v64
v_fma_f32 v65,-v176,v129,v65
v_fma_f32 v66,-v176,v130,v66
v_fma_f32 v67,-v176,v131,v67
v_fma_f32 v68,-v176,v132,v68
v_fma_f32 v69,-v176,v133,v69
v_fma_f32 v70,-v176,v134,v70
v_fma_f32 v71,-v176,v135,v71
v_mul_f32 v64,v64,v177
v_mul_f32 v65,v65,v177
v_mul_f32 v66,v66,v177
v_mul_f32 v67,v67,v177
v_mul_f32 v68,v68,v177
v_mul_f32 v69,v69,v177
v_mul_f32 v70,v70,v177
v_mul_f32 v71,v71,v177
v_cvt_pk_bf16_f32 v184,v64,v65
v_cvt_pk_bf16_f32 v185,v66,v67
v_cvt_pk_bf16_f32 v186,v68,v69
v_cvt_pk_bf16_f32 v187,v70,v71
buffer_store_dwordx4 v[184:187],v21,s[8:11],s74 offen sc1
v_fma_f32 v72,-v176,v136,v72
v_fma_f32 v73,-v176,v137,v73
v_fma_f32 v74,-v176,v138,v74
v_fma_f32 v75,-v176,v139,v75
v_fma_f32 v76,-v176,v140,v76
v_fma_f32 v77,-v176,v141,v77
v_fma_f32 v78,-v176,v142,v78
v_fma_f32 v79,-v176,v143,v79
v_mul_f32 v72,v72,v177
v_mul_f32 v73,v73,v177
v_mul_f32 v74,v74,v177
v_mul_f32 v75,v75,v177
v_mul_f32 v76,v76,v177
v_mul_f32 v77,v77,v177
v_mul_f32 v78,v78,v177
v_mul_f32 v79,v79,v177
v_cvt_pk_bf16_f32 v180,v72,v73
v_cvt_pk_bf16_f32 v181,v74,v75
v_cvt_pk_bf16_f32 v182,v76,v77
v_cvt_pk_bf16_f32 v183,v78,v79
buffer_store_dwordx4 v[180:183],v20,s[8:11],s74 offen offset:2048 sc1
v_fma_f32 v80,-v176,v144,v80
v_fma_f32 v81,-v176,v145,v81
v_fma_f32 v82,-v176,v146,v82
v_fma_f32 v83,-v176,v147,v83
v_fma_f32 v84,-v176,v148,v84
v_fma_f32 v85,-v176,v149,v85
v_fma_f32 v86,-v176,v150,v86
v_fma_f32 v87,-v176,v151,v87
v_mul_f32 v80,v80,v177
v_mul_f32 v81,v81,v177
v_mul_f32 v82,v82,v177
v_mul_f32 v83,v83,v177
v_mul_f32 v84,v84,v177
v_mul_f32 v85,v85,v177
v_mul_f32 v86,v86,v177
v_mul_f32 v87,v87,v177
v_cvt_pk_bf16_f32 v184,v80,v81
v_cvt_pk_bf16_f32 v185,v82,v83
v_cvt_pk_bf16_f32 v186,v84,v85
v_cvt_pk_bf16_f32 v187,v86,v87
buffer_store_dwordx4 v[184:187],v21,s[8:11],s74 offen offset:2048 sc1
s_lshl_b32 s82,s72,6
s_add_u32 s82,s82,s73
s_lshl_b32 s82,s82,9
s_add_u32 s82,s82,s71
s_lshl_b32 s75,s69,2
s_add_u32 s82,s82,s75
s_add_u32 s82,s82,s39
s_mov_b32 s59,s82
s_mov_b32 s82,2147483648
s_mov_b32 s39,2147483648
s_add_u32 s50,s50,1
s_sub_u32 s57,46080,s57
s_mov_b32 s51,s53
s_mov_b32 s52,s54
s_mov_b32 s37,s38
s_cmp_eq_u32 s55,0
s_cbranch_scc1 QKVQ_B1
s_cmp_eq_u32 s55,1
s_cbranch_scc1 QKVQ_CD1
s_waitcnt vmcnt(0)
s_mov_b64 exec,1
buffer_store_dword v5,v1,s[8:11],s59 offen sc1
s_mov_b64 exec,-1
s_mov_b32 s59,2147483648
s_cmp_eq_u32 s50,128
s_cbranch_scc1 QKVQ_END
s_branch QKVQ_COLD1
QKVQ_COLD1:
s_cmp_lg_u32 s46,0
s_cbranch_scc1 cp_235
fb_236:
buffer_load_dword v3,v2,s[8:11],s35 offen sc1
s_waitcnt vmcnt(0)
v_cmp_eq_u32 vcc,0,v3
s_nop 0
s_cbranch_vccz ok_237
s_sleep 7
s_sub_u32 s47,s47,1
s_cbranch_scc1 ABORT
s_branch fb_236
ok_237:
cp_235:
s_barrier
s_lshl_b32 s60,s33,6
s_add_u32 s60,s60,s34
s_mul_i32 s60,s60,46080
s_add_u32 s60,s60,206569472
s_lshl_b32 s62,s46,10
s_add_u32 s62,s62,40960
s_add_u32 m0,s57,s62
s_add_u32 s63,s60,s62
buffer_load_dwordx4 v1,s[8:11],s63 offen sc1 lds
s_add_u32 m0,s57,45056
s_add_u32 s63,s60,45056
buffer_load_dwordx4 v1,s[8:11],s63 offen sc1 lds
s_mul_i32 s61,s46,10240
s_add_u32 s60,s60,s61
s_add_u32 s61,s61,s57
s_add_u32 m0,s61,0
s_add_u32 s63,s60,0
buffer_load_dwordx4 v1,s[8:11],s63 offen sc1 lds
buffer_load_dwordx4 v1,s[8:11],s63 offen offset:1024 sc1 lds
buffer_load_dwordx4 v1,s[8:11],s63 offen offset:2048 sc1 lds
buffer_load_dwordx4 v1,s[8:11],s63 offen offset:3072 sc1 lds
s_add_u32 m0,s61,4096
s_add_u32 s63,s60,4096
buffer_load_dwordx4 v1,s[8:11],s63 offen sc1 lds
buffer_load_dwordx4 v1,s[8:11],s63 offen offset:1024 sc1 lds
buffer_load_dwordx4 v1,s[8:11],s63 offen offset:2048 sc1 lds
buffer_load_dwordx4 v1,s[8:11],s63 offen offset:3072 sc1 lds
s_add_u32 m0,s61,8192
s_add_u32 s63,s60,8192
buffer_load_dwordx4 v1,s[8:11],s63 offen sc1 lds
buffer_load_dwordx4 v1,s[8:11],s63 offen offset:1024 sc1 lds
QKVQ_CD1:
s_mov_b32 s51,s33
s_mov_b32 s52,s34
s_add_u32 s32,s32,1
s_min_u32 s62,s32,127
s_sub_u32 s60,s62,20
s_lshr_b32 s34,s60,1
s_and_b32 s33,s60,1
s_xor_b32 s33,s33,1
s_cmp_eq_u32 s33,0
s_cselect_b32 s61,20,0
s_add_u32 s34,s34,s61
s_sub_u32 s61,s60,44
s_cmp_ge_u32 s60,88
s_cselect_b32 s34,s61,s34
s_cselect_b32 s33,1,s33
s_cmp_lt_u32 s62,20
s_cselect_b32 s34,s62,s34
s_cselect_b32 s33,0,s33
s_lshl_b32 s35,s33,6
s_add_u32 s35,s35,s34
s_lshl_b32 s35,s35,9
s_add_u32 s35,s35,0
s_lshl_b32 s60,s33,5
s_add_u32 s60,s60,7
v_min_u32 v2,s60,v0
v_lshlrev_b32 v2,2,v2
s_cmp_lg_u32 s46,0
s_cbranch_scc1 w0_238
buffer_load_dword v3,v2,s[8:11],s35 offen sc1
w0_238:
s_waitcnt vmcnt(0)
s_mov_b64 exec,1
buffer_store_dword v5,v1,s[8:11],s59 offen sc1
s_mov_b64 exec,-1
s_mov_b32 s59,2147483648
s_cmp_lg_u32 s46,0
s_cbranch_scc1 w0_239
v_cmp_eq_u32 vcc,0,v3
s_cmp_eq_u64 vcc,0
s_cselect_b32 s36,0,2147483648
s_cmp_lt_u32 s32,128
s_cselect_b32 s36,s36,2147483648
v_mov_b32 v23,s36
ds_write_b32 v22,v23
w0_239:
s_waitcnt lgkmcnt(0)
s_barrier
ds_read_b32 v23,v22
ds_read_b128 v[24:27],v18 offset:0
ds_read_b128 v[28:31],v19 offset:0
ds_read_b128 v[32:35],v18 offset:2048
ds_read_b128 v[36:39],v19 offset:2048
ds_read_b128 v[40:43],v18 offset:4096
s_waitcnt lgkmcnt(5)
v_readfirstlane_b32 s37,v23
s_nop 4
QKVQ_B1:
s_waitcnt lgkmcnt(3)
v_mfma_f32_32x32x16_bf16 v[88:103],a[0:3],v[24:27],0
ds_read_b128 v[44:47],v19 offset:4096
v_add_u32 v189,s57,v188
v_mfma_f32_32x32x16_bf16 v[104:119],a[160:163],v[24:27],0
v_add_u32 v8,0x800,v189
s_sub_u32 s66,46080,s57
s_lshl_b32 s60,s33,6
s_add_u32 s60,s60,s34
s_mul_i32 s60,s60,46080
s_add_u32 s60,s60,s37
v_mfma_f32_32x32x16_bf16 v[88:103],a[4:7],v[28:31],v[88:103]
ds_read_b128 v[48:51],v18 offset:6144
ds_read2_b64 v[156:159],v189 offset0:0 offset1:32
s_add_u32 s60,s60,206569472
s_lshl_b32 s62,s46,10
v_mfma_f32_32x32x16_bf16 v[104:119],a[164:167],v[28:31],v[104:119]
ds_read2_b64 v[160:163],v189 offset0:64 offset1:96
s_add_u32 s62,s62,40960
s_add_u32 m0,s66,s62
s_add_u32 s63,s60,s62
s_waitcnt lgkmcnt(5)
v_mfma_f32_32x32x16_bf16 v[88:103],a[8:11],v[32:35],v[88:103]
ds_read_b128 v[52:55],v19 offset:6144
ds_read2_b64 v[164:167],v189 offset0:128 offset1:160
buffer_load_dwordx4 v1,s[8:11],s63 offen sc1 lds
v_mfma_f32_32x32x16_bf16 v[104:119],a[168:171],v[32:35],v[104:119]
ds_read2_b64 v[168:171],v189 offset0:192 offset1:224
s_add_u32 m0,s66,45056
s_add_u32 s63,s60,45056
s_mul_i32 s74,s73,393216
s_add_u32 s74,s74,s39
v_mfma_f32_32x32x16_bf16 v[88:103],a[12:15],v[36:39],v[88:103]
ds_read_b128 v[24:27],v18 offset:8192
ds_read2_b64 v[172:175],v8 offset0:0 offset1:32
s_add_u32 s74,s74,s70
v_fma_f32 v56,-v176,v120,v56
v_mfma_f32_32x32x16_bf16 v[104:119],a[172:175],v[36:39],v[104:119]
buffer_load_dwordx4 v1,s[8:11],s63 offen sc1 lds
s_mul_i32 s61,s46,10240
s_add_u32 s60,s60,s61
s_add_u32 s61,s61,s66
s_waitcnt lgkmcnt(8)
v_mfma_f32_32x32x16_bf16 v[88:103],a[16:19],v[40:43],v[88:103]
ds_read_b128 v[28:31],v19 offset:8192
s_add_u32 m0,s61,0
s_add_u32 s63,s60,0
v_fma_f32 v57,-v176,v121,v57
v_fma_f32 v58,-v176,v122,v58
v_mfma_f32_32x32x16_bf16 v[104:119],a[176:179],v[40:43],v[104:119]
v_fma_f32 v59,-v176,v123,v59
v_fma_f32 v60,-v176,v124,v60
v_fma_f32 v61,-v176,v125,v61
v_fma_f32 v62,-v176,v126,v62
v_fma_f32 v63,-v176,v127,v63
v_mfma_f32_32x32x16_bf16 v[88:103],a[20:23],v[44:47],v[88:103]
ds_read_b128 v[32:35],v18 offset:10240
buffer_load_dwordx4 v1,s[8:11],s63 offen sc1 lds
v_mul_f32 v56,v56,v177
v_mul_f32 v57,v57,v177
v_mfma_f32_32x32x16_bf16 v[104:119],a[180:183],v[44:47],v[104:119]
v_mul_f32 v58,v58,v177
v_mul_f32 v59,v59,v177
v_mul_f32 v60,v60,v177
v_mul_f32 v61,v61,v177
v_mul_f32 v62,v62,v177
s_waitcnt lgkmcnt(6)
v_mfma_f32_32x32x16_bf16 v[88:103],a[24:27],v[48:51],v[88:103]
ds_read_b128 v[36:39],v19 offset:10240
v_mul_f32 v63,v63,v177
v_cvt_pk_bf16_f32 v180,v56,v57
v_cvt_pk_bf16_f32 v181,v58,v59
v_cvt_pk_bf16_f32 v182,v60,v61
v_mfma_f32_32x32x16_bf16 v[104:119],a[184:187],v[48:51],v[104:119]
buffer_load_dwordx4 v1,s[8:11],s63 offen offset:1024 sc1 lds
v_cvt_pk_bf16_f32 v183,v62,v63
buffer_store_dwordx4 v[180:183],v20,s[8:11],s74 offen sc1
v_fma_f32 v64,-v176,v128,v64
v_mfma_f32_32x32x16_bf16 v[88:103],a[28:31],v[52:55],v[88:103]
ds_read_b128 v[40:43],v18 offset:12288
v_fma_f32 v65,-v176,v129,v65
v_fma_f32 v66,-v176,v130,v66
v_fma_f32 v67,-v176,v131,v67
v_fma_f32 v68,-v176,v132,v68
v_mfma_f32_32x32x16_bf16 v[104:119],a[188:191],v[52:55],v[104:119]
v_fma_f32 v69,-v176,v133,v69
v_fma_f32 v70,-v176,v134,v70
v_fma_f32 v71,-v176,v135,v71
v_mul_f32 v64,v64,v177
v_mul_f32 v65,v65,v177
s_waitcnt lgkmcnt(3)
v_mfma_f32_32x32x16_bf16 v[88:103],a[32:35],v[24:27],v[88:103]
ds_read_b128 v[44:47],v19 offset:12288
buffer_load_dwordx4 v1,s[8:11],s63 offen offset:2048 sc1 lds
v_mul_f32 v66,v66,v177
v_mul_f32 v67,v67,v177
v_mfma_f32_32x32x16_bf16 v[104:119],a[192:195],v[24:27],v[104:119]
v_mul_f32 v68,v68,v177
v_mul_f32 v69,v69,v177
v_mul_f32 v70,v70,v177
v_mul_f32 v71,v71,v177
v_cvt_pk_bf16_f32 v184,v64,v65
v_mfma_f32_32x32x16_bf16 v[88:103],a[36:39],v[28:31],v[88:103]
ds_read_b128 v[48:51],v18 offset:14336
v_cvt_pk_bf16_f32 v185,v66,v67
v_cvt_pk_bf16_f32 v186,v68,v69
v_cvt_pk_bf16_f32 v187,v70,v71
v_mfma_f32_32x32x16_bf16 v[104:119],a[196:199],v[28:31],v[104:119]
buffer_load_dwordx4 v1,s[8:11],s63 offen offset:3072 sc1 lds
s_add_u32 m0,s61,4096
s_add_u32 s63,s60,4096
s_waitcnt lgkmcnt(3)
v_mfma_f32_32x32x16_bf16 v[88:103],a[40:43],v[32:35],v[88:103]
ds_read_b128 v[52:55],v19 offset:14336
buffer_store_dwordx4 v[184:187],v21,s[8:11],s74 offen sc1
v_fma_f32 v72,-v176,v136,v72
v_fma_f32 v73,-v176,v137,v73
v_mfma_f32_32x32x16_bf16 v[104:119],a[200:203],v[32:35],v[104:119]
v_fma_f32 v74,-v176,v138,v74
v_fma_f32 v75,-v176,v139,v75
v_fma_f32 v76,-v176,v140,v76
v_fma_f32 v77,-v176,v141,v77
v_fma_f32 v78,-v176,v142,v78
v_mfma_f32_32x32x16_bf16 v[88:103],a[44:47],v[36:39],v[88:103]
ds_read_b128 v[24:27],v18 offset:16384
buffer_load_dwordx4 v1,s[8:11],s63 offen sc1 lds
v_fma_f32 v79,-v176,v143,v79
v_mul_f32 v72,v72,v177
v_mfma_f32_32x32x16_bf16 v[104:119],a[204:207],v[36:39],v[104:119]
v_mul_f32 v73,v73,v177
v_mul_f32 v74,v74,v177
v_mul_f32 v75,v75,v177
v_mul_f32 v76,v76,v177
v_mul_f32 v77,v77,v177
s_waitcnt lgkmcnt(3)
v_mfma_f32_32x32x16_bf16 v[88:103],a[48:51],v[40:43],v[88:103]
ds_read_b128 v[28:31],v19 offset:16384
v_mul_f32 v78,v78,v177
v_mul_f32 v79,v79,v177
v_cvt_pk_bf16_f32 v180,v72,v73
v_cvt_pk_bf16_f32 v181,v74,v75
v_mfma_f32_32x32x16_bf16 v[104:119],a[208:211],v[40:43],v[104:119]
buffer_load_dwordx4 v1,s[8:11],s63 offen offset:1024 sc1 lds
v_cvt_pk_bf16_f32 v182,v76,v77
v_cvt_pk_bf16_f32 v183,v78,v79
buffer_store_dwordx4 v[180:183],v20,s[8:11],s74 offen offset:2048 sc1
v_mfma_f32_32x32x16_bf16 v[88:103],a[52:55],v[44:47],v[88:103]
ds_read_b128 v[32:35],v18 offset:18432
v_fma_f32 v80,-v176,v144,v80
v_fma_f32 v81,-v176,v145,v81
v_fma_f32 v82,-v176,v146,v82
v_fma_f32 v83,-v176,v147,v83
v_mfma_f32_32x32x16_bf16 v[104:119],a[212:215],v[44:47],v[104:119]
v_fma_f32 v84,-v176,v148,v84
v_fma_f32 v85,-v176,v149,v85
v_fma_f32 v86,-v176,v150,v86
v_fma_f32 v87,-v176,v151,v87
v_mul_f32 v80,v80,v177
s_waitcnt lgkmcnt(3)
v_mfma_f32_32x32x16_bf16 v[88:103],a[56:59],v[48:51],v[88:103]
ds_read_b128 v[36:39],v19 offset:18432
buffer_load_dwordx4 v1,s[8:11],s63 offen offset:2048 sc1 lds
v_mul_f32 v81,v81,v177
v_mul_f32 v82,v82,v177
v_mfma_f32_32x32x16_bf16 v[104:119],a[216:219],v[48:51],v[104:119]
v_mul_f32 v83,v83,v177
v_mul_f32 v84,v84,v177
v_mul_f32 v85,v85,v177
v_mul_f32 v86,v86,v177
v_mul_f32 v87,v87,v177
v_mfma_f32_32x32x16_bf16 v[88:103],a[60:63],v[52:55],v[88:103]
ds_read_b128 v[40:43],v18 offset:20480
s_waitcnt vmcnt(12)
s_mov_b64 exec,1
buffer_store_dword v5,v1,s[8:11],s59 offen sc1
s_mov_b64 exec,-1
s_mov_b32 s59,2147483648
v_mfma_f32_32x32x16_bf16 v[104:119],a[220:223],v[52:55],v[104:119]
buffer_load_dwordx4 v1,s[8:11],s63 offen offset:3072 sc1 lds
s_add_u32 m0,s61,8192
s_add_u32 s63,s60,8192
v_cvt_pk_bf16_f32 v184,v80,v81
s_waitcnt lgkmcnt(3)
v_mfma_f32_32x32x16_bf16 v[88:103],a[64:67],v[24:27],v[88:103]
ds_read_b128 v[44:47],v19 offset:20480
v_cvt_pk_bf16_f32 v185,v82,v83
v_cvt_pk_bf16_f32 v186,v84,v85
v_cvt_pk_bf16_f32 v187,v86,v87
v_mfma_f32_32x32x16_bf16 v[104:119],a[224:227],v[24:27],v[104:119]
buffer_store_dwordx4 v[184:187],v21,s[8:11],s74 offen offset:2048 sc1
s_lshl_b32 s82,s72,6
s_add_u32 s82,s82,s73
s_lshl_b32 s82,s82,9
s_add_u32 s82,s82,s71
v_mfma_f32_32x32x16_bf16 v[88:103],a[68:71],v[28:31],v[88:103]
ds_read_b128 v[48:51],v18 offset:22528
buffer_load_dwordx4 v1,s[8:11],s63 offen sc1 lds
s_lshl_b32 s75,s69,2
s_add_u32 s82,s82,s75
v_mfma_f32_32x32x16_bf16 v[104:119],a[228:231],v[28:31],v[104:119]
s_add_u32 s82,s82,s39
v_add_f32 v156,v156,v166
v_add_f32 v157,v157,v167
v_add_f32 v158,v158,v168
s_waitcnt lgkmcnt(3)
v_mfma_f32_32x32x16_bf16 v[88:103],a[72:75],v[32:35],v[88:103]
ds_read_b128 v[52:55],v19 offset:22528
v_add_f32 v159,v159,v169
v_add_f32 v160,v160,v170
v_add_f32 v161,v161,v171
v_add_f32 v162,v162,v172
v_mfma_f32_32x32x16_bf16 v[104:119],a[232:235],v[32:35],v[104:119]
buffer_load_dwordx4 v1,s[8:11],s63 offen offset:1024 sc1 lds
s_mov_b32 s53,s33
s_mov_b32 s54,s34
s_cmp_eq_u32 s37,0
s_addc_u32 s32,s32,0
v_mfma_f32_32x32x16_bf16 v[88:103],a[76:79],v[36:39],v[88:103]
ds_read_b128 v[24:27],v18 offset:24576
s_min_u32 s62,s32,127
s_sub_u32 s60,s62,20
s_lshr_b32 s34,s60,1
s_and_b32 s33,s60,1
v_mfma_f32_32x32x16_bf16 v[104:119],a[236:239],v[36:39],v[104:119]
s_xor_b32 s33,s33,1
s_cmp_eq_u32 s33,0
s_cselect_b32 s61,20,0
s_add_u32 s34,s34,s61
s_sub_u32 s61,s60,44
s_waitcnt lgkmcnt(3)
v_mfma_f32_32x32x16_bf16 v[88:103],a[80:83],v[40:43],v[88:103]
ds_read_b128 v[28:31],v19 offset:24576
s_cmp_ge_u32 s60,88
s_cselect_b32 s34,s61,s34
s_cselect_b32 s33,1,s33
v_add_f32 v163,v163,v173
v_mfma_f32_32x32x16_bf16 v[104:119],a[240:243],v[40:43],v[104:119]
s_cmp_lt_u32 s62,20
s_cselect_b32 s34,s62,s34
s_cselect_b32 s33,0,s33
s_lshl_b32 s35,s33,6
s_add_u32 s35,s35,s34
s_lshl_b32 s35,s35,9
v_mfma_f32_32x32x16_bf16 v[88:103],a[84:87],v[44:47],v[88:103]
ds_read_b128 v[32:35],v18 offset:26624
s_add_u32 s35,s35,0
s_lshl_b32 s60,s33,5
s_add_u32 s60,s60,7
v_min_u32 v2,s60,v0
v_mfma_f32_32x32x16_bf16 v[104:119],a[244:247],v[44:47],v[104:119]
v_lshlrev_b32 v2,2,v2
v_add_f32 v164,v164,v174
v_add_f32 v165,v165,v175
v_add_f32 v156,v156,v158
v_add_f32 v157,v157,v159
s_waitcnt lgkmcnt(3)
v_mfma_f32_32x32x16_bf16 v[88:103],a[88:91],v[48:51],v[88:103]
ds_read_b128 v[36:39],v19 offset:26624
s_cmp_lg_u32 s46,0
s_cbranch_scc1 w0_240
buffer_load_dword v3,v2,s[8:11],s35 offen sc1
w0_240:
v_mfma_f32_32x32x16_bf16 v[104:119],a[248:251],v[48:51],v[104:119]
v_add_f32 v160,v160,v162
v_add_f32 v161,v161,v163
v_add_f32 v156,v156,v160
v_add_f32 v157,v157,v161
v_add_f32 v156,v156,v164
v_mfma_f32_32x32x16_bf16 v[88:103],a[92:95],v[52:55],v[88:103]
ds_read_b128 v[40:43],v18 offset:28672
v_add_f32 v157,v157,v165
v_mov_b32 v158,v156
v_mov_b32 v159,v157
s_nop 0
v_permlane32_swap_b32 v156,v158
v_mfma_f32_32x32x16_bf16 v[104:119],a[252:255],v[52:55],v[104:119]
v_permlane32_swap_b32 v157,v159
v_add_f32 v176,v156,v158
v_add_f32 v177,v157,v159
v_mul_f32 v176,0x3acccccd,v176
v_mul_f32 v177,0x3acccccd,v177
s_waitcnt lgkmcnt(3)
v_mfma_f32_32x32x16_bf16 v[88:103],a[96:99],v[24:27],v[88:103]
ds_read_b128 v[44:47],v19 offset:28672
v_fma_f32 v177,-v176,v176,v177
v_max_f32 v177,0,v177
v_cvt_pk_bf16_f32 v8,v176,v177
v_lshlrev_b32 v176,16,v8
v_mfma_f32_32x32x16_bf16 v[104:119],v[192:195],v[24:27],v[104:119]
v_and_b32 v177,0xffff0000,v8
v_add_f32 v177,0x3727c5ac,v177
v_cvt_pk_bf16_f32 v8,v177,v177
v_lshlrev_b32 v177,16,v8
v_sqrt_f32 v177,v177
v_mfma_f32_32x32x16_bf16 v[88:103],a[100:103],v[28:31],v[88:103]
ds_read_b128 v[48:51],v18 offset:30720
v_cvt_pk_bf16_f32 v8,v177,v177
v_lshlrev_b32 v177,16,v8
v_rcp_f32 v177,v177
v_mfma_f32_32x32x16_bf16 v[104:119],v[196:199],v[28:31],v[104:119]
s_cmp_eq_u32 s51,0
s_cselect_b64 s[76:77],-1,0
v_cndmask_b32 v176,v176,0,s[76:77]
v_cndmask_b32 v177,v177,1.0,s[76:77]
s_mov_b32 s72,s51
s_waitcnt lgkmcnt(3)
v_mfma_f32_32x32x16_bf16 v[88:103],a[104:107],v[32:35],v[88:103]
ds_read_b128 v[52:55],v19 offset:30720
s_mov_b32 s73,s52
v_mfma_f32_32x32x16_bf16 v[104:119],v[200:203],v[32:35],v[104:119]
v_mfma_f32_32x32x16_bf16 v[88:103],a[108:111],v[36:39],v[88:103]
ds_read_b128 v[24:27],v18 offset:32768
v_mfma_f32_32x32x16_bf16 v[104:119],v[204:207],v[36:39],v[104:119]
s_waitcnt lgkmcnt(3)
v_mfma_f32_32x32x16_bf16 v[88:103],a[112:115],v[40:43],v[88:103]
ds_read_b128 v[28:31],v19 offset:32768
v_mfma_f32_32x32x16_bf16 v[104:119],v[208:211],v[40:43],v[104:119]
v_mfma_f32_32x32x16_bf16 v[88:103],a[116:119],v[44:47],v[88:103]
ds_read_b128 v[32:35],v18 offset:34816
v_mfma_f32_32x32x16_bf16 v[104:119],v[212:215],v[44:47],v[104:119]
s_waitcnt lgkmcnt(3)
v_mfma_f32_32x32x16_bf16 v[88:103],a[120:123],v[48:51],v[88:103]
ds_read_b128 v[36:39],v19 offset:34816
v_mfma_f32_32x32x16_bf16 v[104:119],v[216:219],v[48:51],v[104:119]
v_mfma_f32_32x32x16_bf16 v[88:103],a[124:127],v[52:55],v[88:103]
ds_read_b128 v[40:43],v18 offset:36864
v_mfma_f32_32x32x16_bf16 v[104:119],v[220:223],v[52:55],v[104:119]
s_waitcnt vmcnt(0)
s_cmp_lg_u32 s46,0
s_cbranch_scc1 w0_241
v_cmp_eq_u32 vcc,0,v3
s_cmp_eq_u64 vcc,0
s_cselect_b32 s36,0,2147483648
s_cmp_lt_u32 s32,128
s_cselect_b32 s36,s36,2147483648
v_mov_b32 v23,s36
ds_write_b32 v22,v23
w0_241:
s_waitcnt lgkmcnt(3)
v_mfma_f32_32x32x16_bf16 v[88:103],a[128:131],v[24:27],v[88:103]
ds_read_b128 v[44:47],v19 offset:36864
s_mov_b64 exec,1
buffer_store_dword v5,v1,s[8:11],s82 offen sc1
s_mov_b64 exec,-1
s_mov_b32 s82,2147483648
v_mfma_f32_32x32x16_bf16 v[104:119],v[224:227],v[24:27],v[104:119]
v_mfma_f32_32x32x16_bf16 v[88:103],a[132:135],v[28:31],v[88:103]
ds_read_b128 v[48:51],v18 offset:38912
v_mfma_f32_32x32x16_bf16 v[104:119],v[228:231],v[28:31],v[104:119]
s_waitcnt lgkmcnt(3)
v_mfma_f32_32x32x16_bf16 v[88:103],a[136:139],v[32:35],v[88:103]
ds_read_b128 v[52:55],v19 offset:38912
v_mfma_f32_32x32x16_bf16 v[104:119],v[232:235],v[32:35],v[104:119]
s_waitcnt lgkmcnt(2)
s_barrier
ds_read_b32 v23,v22
v_mfma_f32_32x32x16_bf16 v[88:103],a[140:143],v[36:39],v[88:103]
ds_read_b128 v[24:27],v16 offset:0
v_mfma_f32_32x32x16_bf16 v[104:119],v[236:239],v[36:39],v[104:119]
v_mfma_f32_32x32x16_bf16 v[88:103],a[144:147],v[40:43],v[88:103]
ds_read_b128 v[28:31],v17 offset:0
v_mfma_f32_32x32x16_bf16 v[104:119],v[240:243],v[40:43],v[104:119]
v_mfma_f32_32x32x16_bf16 v[88:103],a[148:151],v[44:47],v[88:103]
ds_read_b128 v[32:35],v16 offset:2048
v_mfma_f32_32x32x16_bf16 v[104:119],v[244:247],v[44:47],v[104:119]
s_waitcnt lgkmcnt(4)
v_mfma_f32_32x32x16_bf16 v[88:103],a[152:155],v[48:51],v[88:103]
ds_read_b128 v[36:39],v17 offset:2048
s_waitcnt lgkmcnt(4)
v_readfirstlane_b32 s38,v23
v_mfma_f32_32x32x16_bf16 v[104:119],v[248:251],v[48:51],v[104:119]
v_mfma_f32_32x32x16_bf16 v[88:103],a[156:159],v[52:55],v[88:103]
ds_read_b128 v[40:43],v16 offset:4096
v_mfma_f32_32x32x16_bf16 v[104:119],v[252:255],v[52:55],v[104:119]
s_cmp_lg_u32 s37,0
s_cbranch_scc1 nf_242
s_cmp_lt_u32 s50,2
s_cbranch_scc1 now_243
s_mov_b32 s39,0
s_add_u32 s50,s50,1
s_sub_u32 s57,46080,s57
s_mov_b32 s51,s53
s_mov_b32 s52,s54
s_mov_b32 s37,s38
s_branch QKVQ_B0
s_nop 0
now_243:
s_mov_b32 s55,0
s_branch nt_244
nf_242:
s_mov_b32 s55,2
s_cmp_lg_u32 s38,0
s_cbranch_scc1 nt_244
s_mov_b32 s55,1
s_mov_b32 s37,0
s_sub_u32 s66,46080,s57
s_lshl_b32 s60,s33,6
s_add_u32 s60,s60,s34
s_mul_i32 s60,s60,46080
s_add_u32 s60,s60,s37
s_add_u32 s60,s60,206569472
s_lshl_b32 s62,s46,10
s_add_u32 s62,s62,40960
s_add_u32 m0,s66,s62
s_add_u32 s63,s60,s62
buffer_load_dwordx4 v1,s[8:11],s63 offen sc1 lds
s_add_u32 m0,s66,45056
s_add_u32 s63,s60,45056
buffer_load_dwordx4 v1,s[8:11],s63 offen sc1 lds
s_mul_i32 s61,s46,10240
s_add_u32 s60,s60,s61
s_add_u32 s61,s61,s66
s_add_u32 m0,s61,0
s_add_u32 s63,s60,0
buffer_load_dwordx4 v1,s[8:11],s63 offen sc1 lds
buffer_load_dwordx4 v1,s[8:11],s63 offen offset:1024 sc1 lds
buffer_load_dwordx4 v1,s[8:11],s63 offen offset:2048 sc1 lds
buffer_load_dwordx4 v1,s[8:11],s63 offen offset:3072 sc1 lds
s_add_u32 m0,s61,4096
s_add_u32 s63,s60,4096
buffer_load_dwordx4 v1,s[8:11],s63 offen sc1 lds
buffer_load_dwordx4 v1,s[8:11],s63 offen offset:1024 sc1 lds
buffer_load_dwordx4 v1,s[8:11],s63 offen offset:2048 sc1 lds
buffer_load_dwordx4 v1,s[8:11],s63 offen offset:3072 sc1 lds
s_add_u32 m0,s61,8192
s_add_u32 s63,s60,8192
buffer_load_dwordx4 v1,s[8:11],s63 offen sc1 lds
buffer_load_dwordx4 v1,s[8:11],s63 offen offset:1024 sc1 lds
nt_244:
s_mov_b32 s39,0
s_mul_i32 s74,s73,393216
s_add_u32 s74,s74,s39
s_add_u32 s74,s74,s70
v_fma_f32 v88,-v176,v120,v88
v_fma_f32 v89,-v176,v121,v89
v_fma_f32 v90,-v176,v122,v90
v_fma_f32 v91,-v176,v123,v91
v_fma_f32 v92,-v176,v124,v92
v_fma_f32 v93,-v176,v125,v93
v_fma_f32 v94,-v176,v126,v94
v_fma_f32 v95,-v176,v127,v95
v_mul_f32 v88,v88,v177
v_mul_f32 v89,v89,v177
v_mul_f32 v90,v90,v177
v_mul_f32 v91,v91,v177
v_mul_f32 v92,v92,v177
v_mul_f32 v93,v93,v177
v_mul_f32 v94,v94,v177
v_mul_f32 v95,v95,v177
v_cvt_pk_bf16_f32 v180,v88,v89
v_cvt_pk_bf16_f32 v181,v90,v91
v_cvt_pk_bf16_f32 v182,v92,v93
v_cvt_pk_bf16_f32 v183,v94,v95
buffer_store_dwordx4 v[180:183],v20,s[8:11],s74 offen sc1
v_fma_f32 v96,-v176,v128,v96
v_fma_f32 v97,-v176,v129,v97
v_fma_f32 v98,-v176,v130,v98
v_fma_f32 v99,-v176,v131,v99
v_fma_f32 v100,-v176,v132,v100
v_fma_f32 v101,-v176,v133,v101
v_fma_f32 v102,-v176,v134,v102
v_fma_f32 v103,-v176,v135,v103
v_mul_f32 v96,v96,v177
v_mul_f32 v97,v97,v177
v_mul_f32 v98,v98,v177
v_mul_f32 v99,v99,v177
v_mul_f32 v100,v100,v177
v_mul_f32 v101,v101,v177
v_mul_f32 v102,v102,v177
v_mul_f32 v103,v103,v177
v_cvt_pk_bf16_f32 v184,v96,v97
v_cvt_pk_bf16_f32 v185,v98,v99
v_cvt_pk_bf16_f32 v186,v100,v101
v_cvt_pk_bf16_f32 v187,v102,v103
buffer_store_dwordx4 v[184:187],v21,s[8:11],s74 offen sc1
v_fma_f32 v104,-v176,v136,v104
v_fma_f32 v105,-v176,v137,v105
v_fma_f32 v106,-v176,v138,v106
v_fma_f32 v107,-v176,v139,v107
v_fma_f32 v108,-v176,v140,v108
v_fma_f32 v109,-v176,v141,v109
v_fma_f32 v110,-v176,v142,v110
v_fma_f32 v111,-v176,v143,v111
v_mul_f32 v104,v104,v177
v_mul_f32 v105,v105,v177
v_mul_f32 v106,v106,v177
v_mul_f32 v107,v107,v177
v_mul_f32 v108,v108,v177
v_mul_f32 v109,v109,v177
v_mul_f32 v110,v110,v177
v_mul_f32 v111,v111,v177
v_cvt_pk_bf16_f32 v180,v104,v105
v_cvt_pk_bf16_f32 v181,v106,v107
v_cvt_pk_bf16_f32 v182,v108,v109
v_cvt_pk_bf16_f32 v183,v110,v111
buffer_store_dwordx4 v[180:183],v20,s[8:11],s74 offen offset:2048 sc1
v_fma_f32 v112,-v176,v144,v112
v_fma_f32 v113,-v176,v145,v113
v_fma_f32 v114,-v176,v146,v114
v_fma_f32 v115,-v176,v147,v115
v_fma_f32 v116,-v176,v148,v116
v_fma_f32 v117,-v176,v149,v117
v_fma_f32 v118,-v176,v150,v118
v_fma_f32 v119,-v176,v151,v119
v_mul_f32 v112,v112,v177
v_mul_f32 v113,v113,v177
v_mul_f32 v114,v114,v177
v_mul_f32 v115,v115,v177
v_mul_f32 v116,v116,v177
v_mul_f32 v117,v117,v177
v_mul_f32 v118,v118,v177
v_mul_f32 v119,v119,v177
v_cvt_pk_bf16_f32 v184,v112,v113
v_cvt_pk_bf16_f32 v185,v114,v115
v_cvt_pk_bf16_f32 v186,v116,v117
v_cvt_pk_bf16_f32 v187,v118,v119
buffer_store_dwordx4 v[184:187],v21,s[8:11],s74 offen offset:2048 sc1
s_lshl_b32 s82,s72,6
s_add_u32 s82,s82,s73
s_lshl_b32 s82,s82,9
s_add_u32 s82,s82,s71
s_lshl_b32 s75,s69,2
s_add_u32 s82,s82,s75
s_add_u32 s82,s82,s39
s_mov_b32 s59,s82
s_mov_b32 s82,2147483648
s_mov_b32 s39,2147483648
s_add_u32 s50,s50,1
s_sub_u32 s57,46080,s57
s_mov_b32 s51,s53
s_mov_b32 s52,s54
s_mov_b32 s37,s38
s_cmp_eq_u32 s55,0
s_cbranch_scc1 QKVQ_B0
s_cmp_eq_u32 s55,1
s_cbranch_scc1 QKVQ_CD0
s_waitcnt vmcnt(0)
s_mov_b64 exec,1
buffer_store_dword v5,v1,s[8:11],s59 offen sc1
s_mov_b64 exec,-1
s_mov_b32 s59,2147483648
s_cmp_eq_u32 s50,128
s_cbranch_scc1 QKVQ_END
s_branch QKVQ_COLD0
QKVQ_END:
s_endpgm
ROLE_QKVV:
v_lshlrev_b32 v1,4,v0
v_mov_b32 v5,1
s_lshl_b32 s56,s48,2
s_add_u32 s56,s56,s46
v_bfe_u32 v6,v0,2,2
v_lshrrev_b32 v7,4,v0
v_add_u32 v7,v6,v7
v_and_b32 v7,3,v7
v_and_b32 v15,3,v0
v_lshlrev_b32 v15,4,v15
v_lshl_add_u32 v15,v7,6,v15
v_lshl_add_u32 v15,v6,8,v15
v_lshrrev_b32 v6,5,v0
v_bfe_u32 v7,v0,4,1
v_lshlrev_b32 v16,10,v7
v_bfe_u32 v7,v0,2,2
v_lshl_add_u32 v16,v7,8,v16
v_add_u32 v6,v6,v7
v_and_b32 v6,3,v6
v_lshl_add_u32 v16,v6,6,v16
v_and_b32 v6,3,v0
v_lshl_add_u32 v16,v6,4,v16
v_add_u32 v18,46080,v16
v_lshrrev_b32 v6,5,v0
v_bfe_u32 v7,v0,4,1
v_lshlrev_b32 v20,10,v7
v_lshl_add_u32 v20,v6,8,v20
v_and_b32 v6,15,v0
v_lshl_add_u32 v20,v6,4,v20
v_lshrrev_b32 v6,5,v0
v_add_u32 v6,2,v6
v_bfe_u32 v7,v0,4,1
v_lshlrev_b32 v17,10,v7
v_bfe_u32 v7,v0,2,2
v_lshl_add_u32 v17,v7,8,v17
v_add_u32 v6,v6,v7
v_and_b32 v6,3,v6
v_lshl_add_u32 v17,v6,6,v17
v_and_b32 v6,3,v0
v_lshl_add_u32 v17,v6,4,v17
v_add_u32 v19,46080,v17
v_lshrrev_b32 v6,5,v0
v_add_u32 v6,2,v6
v_bfe_u32 v7,v0,4,1
v_lshlrev_b32 v21,10,v7
v_lshl_add_u32 v21,v6,8,v21
v_and_b32 v6,15,v0
v_lshl_add_u32 v21,v6,4,v21
s_mov_b32 s69,s56
s_mov_b32 s70,99614720
s_mov_b32 s71,196608
s_lshl_b32 s60,s69,12
s_add_u32 s70,s70,s60
v_lshrrev_b32 v6,5,v0
v_mul_u32_u24 v188,2560,v6
v_and_b32 v6,31,v0
v_lshl_add_u32 v188,v6,3,v188
v_add_u32 v188,0xa000,v188
v_min_u32 v12,7,v0
v_lshlrev_b32 v12,2,v12
v_min_u32 v13,39,v0
v_lshlrev_b32 v13,2,v13
v_mov_b32 v14,93184
s_lshl_b32 s60,s46,8
s_add_u32 s60,s60,92160
v_and_b32 v6,31,v0
v_lshlrev_b32 v190,3,v6
v_add_u32 v190,s60,v190
v_lshrrev_b32 v6,5,v0
v_lshlrev_b32 v191,5,v6
v_add_u32 v191,s60,v191
s_waitcnt vmcnt(0)
s_barrier
s_cmp_lg_u32 s46,0
s_cbranch_scc1 arr_245
v_mov_b32 v6,1
s_lshl_b32 s3,s49,2
v_mov_b32 v7,s3
s_mov_b64 exec,1
buffer_atomic_add v6,v7,s[12:15],0 offen sc1
s_mov_b64 exec,-1
arr_245:
s_lshl_b32 s58,s69,7
s_mul_i32 s63,s46,40960
s_mov_b32 s4,s24
s_mov_b32 s5,s25
s_mov_b32 s6,7864320
s_mov_b32 s7,0x20000
v_lshrrev_b32 v9,3,v0
s_mov_b32 s64,12288
v_mul_lo_u32 v9,v9,s64
v_and_b32 v10,7,v0
v_lshl_add_u32 v6,v10,4,v9
s_add_u32 m0,s63,0
s_add_u32 s65,s58,0
buffer_load_dwordx4 v6,s[4:7],s65 offen lds
s_add_u32 m0,s63,1024
s_add_u32 s65,s58,98304
buffer_load_dwordx4 v6,s[4:7],s65 offen lds
s_add_u32 m0,s63,2048
s_add_u32 s65,s58,196608
buffer_load_dwordx4 v6,s[4:7],s65 offen lds
s_add_u32 m0,s63,3072
s_add_u32 s65,s58,294912
buffer_load_dwordx4 v6,s[4:7],s65 offen lds
s_add_u32 m0,s63,4096
s_add_u32 s65,s58,393216
buffer_load_dwordx4 v6,s[4:7],s65 offen lds
s_add_u32 m0,s63,5120
s_add_u32 s65,s58,491520
buffer_load_dwordx4 v6,s[4:7],s65 offen lds
s_add_u32 m0,s63,6144
s_add_u32 s65,s58,589824
buffer_load_dwordx4 v6,s[4:7],s65 offen lds
s_add_u32 m0,s63,7168
s_add_u32 s65,s58,688128
buffer_load_dwordx4 v6,s[4:7],s65 offen lds
s_add_u32 m0,s63,8192
s_add_u32 s65,s58,786432
buffer_load_dwordx4 v6,s[4:7],s65 offen lds
s_add_u32 m0,s63,9216
s_add_u32 s65,s58,884736
buffer_load_dwordx4 v6,s[4:7],s65 offen lds
s_add_u32 m0,s63,10240
s_add_u32 s65,s58,983040
buffer_load_dwordx4 v6,s[4:7],s65 offen lds
s_add_u32 m0,s63,11264
s_add_u32 s65,s58,1081344
buffer_load_dwordx4 v6,s[4:7],s65 offen lds
s_add_u32 m0,s63,12288
s_add_u32 s65,s58,1179648
buffer_load_dwordx4 v6,s[4:7],s65 offen lds
s_add_u32 m0,s63,13312
s_add_u32 s65,s58,1277952
buffer_load_dwordx4 v6,s[4:7],s65 offen lds
s_add_u32 m0,s63,14336
s_add_u32 s65,s58,1376256
buffer_load_dwordx4 v6,s[4:7],s65 offen lds
s_add_u32 m0,s63,15360
s_add_u32 s65,s58,1474560
buffer_load_dwordx4 v6,s[4:7],s65 offen lds
s_add_u32 m0,s63,16384
s_add_u32 s65,s58,1572864
buffer_load_dwordx4 v6,s[4:7],s65 offen lds
s_add_u32 m0,s63,17408
s_add_u32 s65,s58,1671168
buffer_load_dwordx4 v6,s[4:7],s65 offen lds
s_add_u32 m0,s63,18432
s_add_u32 s65,s58,1769472
buffer_load_dwordx4 v6,s[4:7],s65 offen lds
s_add_u32 m0,s63,19456
s_add_u32 s65,s58,1867776
buffer_load_dwordx4 v6,s[4:7],s65 offen lds
s_add_u32 m0,s63,20480
s_add_u32 s65,s58,1966080
buffer_load_dwordx4 v6,s[4:7],s65 offen lds
s_add_u32 m0,s63,21504
s_add_u32 s65,s58,2064384
buffer_load_dwordx4 v6,s[4:7],s65 offen lds
s_add_u32 m0,s63,22528
s_add_u32 s65,s58,2162688
buffer_load_dwordx4 v6,s[4:7],s65 offen lds
s_add_u32 m0,s63,23552
s_add_u32 s65,s58,2260992
buffer_load_dwordx4 v6,s[4:7],s65 offen lds
s_add_u32 m0,s63,24576
s_add_u32 s65,s58,2359296
buffer_load_dwordx4 v6,s[4:7],s65 offen lds
s_add_u32 m0,s63,25600
s_add_u32 s65,s58,2457600
buffer_load_dwordx4 v6,s[4:7],s65 offen lds
s_add_u32 m0,s63,26624
s_add_u32 s65,s58,2555904
buffer_load_dwordx4 v6,s[4:7],s65 offen lds
s_add_u32 m0,s63,27648
s_add_u32 s65,s58,2654208
buffer_load_dwordx4 v6,s[4:7],s65 offen lds
s_add_u32 m0,s63,28672
s_add_u32 s65,s58,2752512
buffer_load_dwordx4 v6,s[4:7],s65 offen lds
s_add_u32 m0,s63,29696
s_add_u32 s65,s58,2850816
buffer_load_dwordx4 v6,s[4:7],s65 offen lds
s_add_u32 m0,s63,30720
s_add_u32 s65,s58,2949120
buffer_load_dwordx4 v6,s[4:7],s65 offen lds
s_add_u32 m0,s63,31744
s_add_u32 s65,s58,3047424
buffer_load_dwordx4 v6,s[4:7],s65 offen lds
s_add_u32 m0,s63,32768
s_add_u32 s65,s58,3145728
buffer_load_dwordx4 v6,s[4:7],s65 offen lds
s_add_u32 m0,s63,33792
s_add_u32 s65,s58,3244032
buffer_load_dwordx4 v6,s[4:7],s65 offen lds
s_add_u32 m0,s63,34816
s_add_u32 s65,s58,3342336
buffer_load_dwordx4 v6,s[4:7],s65 offen lds
s_add_u32 m0,s63,35840
s_add_u32 s65,s58,3440640
buffer_load_dwordx4 v6,s[4:7],s65 offen lds
s_add_u32 m0,s63,36864
s_add_u32 s65,s58,3538944
buffer_load_dwordx4 v6,s[4:7],s65 offen lds
s_add_u32 m0,s63,37888
s_add_u32 s65,s58,3637248
buffer_load_dwordx4 v6,s[4:7],s65 offen lds
s_add_u32 m0,s63,38912
s_add_u32 s65,s58,3735552
buffer_load_dwordx4 v6,s[4:7],s65 offen lds
s_add_u32 m0,s63,39936
s_add_u32 s65,s58,3833856
buffer_load_dwordx4 v6,s[4:7],s65 offen lds
s_waitcnt vmcnt(20)
v_bfe_u32 v9,v0,2,2
v_lshrrev_b32 v10,5,v0
v_lshl_add_u32 v9,v10,2,v9
v_mul_u32_u24 v9,128,v9
v_and_b32 v10,1,v0
v_lshl_add_u32 v9,v10,3,v9
v_bfe_u32 v10,v0,1,1
v_lshl_add_u32 v9,v10,4,v9
v_bfe_u32 v10,v0,4,1
v_lshl_add_u32 v9,v10,5,v9
v_add_u32 v7,s63,v9
ds_read_b64_tr_b16 a[0:1],v7 offset:0
ds_read_b64_tr_b16 a[2:3],v7 offset:2048
ds_read_b64_tr_b16 a[4:5],v7 offset:1024
ds_read_b64_tr_b16 a[6:7],v7 offset:3072
ds_read_b64_tr_b16 a[160:161],v7 offset:64
ds_read_b64_tr_b16 a[162:163],v7 offset:2112
ds_read_b64_tr_b16 a[164:165],v7 offset:1088
ds_read_b64_tr_b16 a[166:167],v7 offset:3136
ds_read_b64_tr_b16 a[8:9],v7 offset:4096
ds_read_b64_tr_b16 a[10:11],v7 offset:6144
ds_read_b64_tr_b16 a[12:13],v7 offset:5120
ds_read_b64_tr_b16 a[14:15],v7 offset:7168
s_waitcnt lgkmcnt(4)
ds_read_b64_tr_b16 a[168:169],v7 offset:4160
ds_read_b64_tr_b16 a[170:171],v7 offset:6208
ds_read_b64_tr_b16 a[172:173],v7 offset:5184
ds_read_b64_tr_b16 a[174:175],v7 offset:7232
ds_read_b64_tr_b16 a[16:17],v7 offset:8192
ds_read_b64_tr_b16 a[18:19],v7 offset:10240
ds_read_b64_tr_b16 a[20:21],v7 offset:9216
ds_read_b64_tr_b16 a[22:23],v7 offset:11264
ds_read_b64_tr_b16 a[176:177],v7 offset:8256
ds_read_b64_tr_b16 a[178:179],v7 offset:10304
ds_read_b64_tr_b16 a[180:181],v7 offset:9280
ds_read_b64_tr_b16 a[182:183],v7 offset:11328
s_waitcnt lgkmcnt(4)
ds_read_b64_tr_b16 a[24:25],v7 offset:12288
ds_read_b64_tr_b16 a[26:27],v7 offset:14336
ds_read_b64_tr_b16 a[28:29],v7 offset:13312
ds_read_b64_tr_b16 a[30:31],v7 offset:15360
ds_read_b64_tr_b16 a[184:185],v7 offset:12352
ds_read_b64_tr_b16 a[186:187],v7 offset:14400
ds_read_b64_tr_b16 a[188:189],v7 offset:13376
ds_read_b64_tr_b16 a[190:191],v7 offset:15424
ds_read_b64_tr_b16 a[32:33],v7 offset:16384
ds_read_b64_tr_b16 a[34:35],v7 offset:18432
ds_read_b64_tr_b16 a[36:37],v7 offset:17408
ds_read_b64_tr_b16 a[38:39],v7 offset:19456
s_waitcnt lgkmcnt(4)
ds_read_b64_tr_b16 a[192:193],v7 offset:16448
ds_read_b64_tr_b16 a[194:195],v7 offset:18496
ds_read_b64_tr_b16 a[196:197],v7 offset:17472
ds_read_b64_tr_b16 a[198:199],v7 offset:19520
s_waitcnt lgkmcnt(0)
s_add_u32 m0,s63,0
s_add_u32 s65,s58,3932160
buffer_load_dwordx4 v6,s[4:7],s65 offen lds
s_add_u32 m0,s63,1024
s_add_u32 s65,s58,4030464
buffer_load_dwordx4 v6,s[4:7],s65 offen lds
s_add_u32 m0,s63,2048
s_add_u32 s65,s58,4128768
buffer_load_dwordx4 v6,s[4:7],s65 offen lds
s_add_u32 m0,s63,3072
s_add_u32 s65,s58,4227072
buffer_load_dwordx4 v6,s[4:7],s65 offen lds
s_add_u32 m0,s63,4096
s_add_u32 s65,s58,4325376
buffer_load_dwordx4 v6,s[4:7],s65 offen lds
s_add_u32 m0,s63,5120
s_add_u32 s65,s58,4423680
buffer_load_dwordx4 v6,s[4:7],s65 offen lds
s_add_u32 m0,s63,6144
s_add_u32 s65,s58,4521984
buffer_load_dwordx4 v6,s[4:7],s65 offen lds
s_add_u32 m0,s63,7168
s_add_u32 s65,s58,4620288
buffer_load_dwordx4 v6,s[4:7],s65 offen lds
s_add_u32 m0,s63,8192
s_add_u32 s65,s58,4718592
buffer_load_dwordx4 v6,s[4:7],s65 offen lds
s_add_u32 m0,s63,9216
s_add_u32 s65,s58,4816896
buffer_load_dwordx4 v6,s[4:7],s65 offen lds
s_add_u32 m0,s63,10240
s_add_u32 s65,s58,4915200
buffer_load_dwordx4 v6,s[4:7],s65 offen lds
s_add_u32 m0,s63,11264
s_add_u32 s65,s58,5013504
buffer_load_dwordx4 v6,s[4:7],s65 offen lds
s_add_u32 m0,s63,12288
s_add_u32 s65,s58,5111808
buffer_load_dwordx4 v6,s[4:7],s65 offen lds
s_add_u32 m0,s63,13312
s_add_u32 s65,s58,5210112
buffer_load_dwordx4 v6,s[4:7],s65 offen lds
s_add_u32 m0,s63,14336
s_add_u32 s65,s58,5308416
buffer_load_dwordx4 v6,s[4:7],s65 offen lds
s_add_u32 m0,s63,15360
s_add_u32 s65,s58,5406720
buffer_load_dwordx4 v6,s[4:7],s65 offen lds
s_add_u32 m0,s63,16384
s_add_u32 s65,s58,5505024
buffer_load_dwordx4 v6,s[4:7],s65 offen lds
s_add_u32 m0,s63,17408
s_add_u32 s65,s58,5603328
buffer_load_dwordx4 v6,s[4:7],s65 offen lds
s_add_u32 m0,s63,18432
s_add_u32 s65,s58,5701632
buffer_load_dwordx4 v6,s[4:7],s65 offen lds
s_add_u32 m0,s63,19456
s_add_u32 s65,s58,5799936
buffer_load_dwordx4 v6,s[4:7],s65 offen lds
s_waitcnt vmcnt(20)
v_bfe_u32 v9,v0,2,2
v_lshrrev_b32 v10,5,v0
v_lshl_add_u32 v9,v10,2,v9
v_mul_u32_u24 v9,128,v9
v_and_b32 v10,1,v0
v_lshl_add_u32 v9,v10,3,v9
v_bfe_u32 v10,v0,1,1
v_lshl_add_u32 v9,v10,4,v9
v_bfe_u32 v10,v0,4,1
v_lshl_add_u32 v9,v10,5,v9
v_add_u32 v7,s63,v9
ds_read_b64_tr_b16 a[40:41],v7 offset:20480
ds_read_b64_tr_b16 a[42:43],v7 offset:22528
ds_read_b64_tr_b16 a[44:45],v7 offset:21504
ds_read_b64_tr_b16 a[46:47],v7 offset:23552
ds_read_b64_tr_b16 a[200:201],v7 offset:20544
ds_read_b64_tr_b16 a[202:203],v7 offset:22592
ds_read_b64_tr_b16 a[204:205],v7 offset:21568
ds_read_b64_tr_b16 a[206:207],v7 offset:23616
ds_read_b64_tr_b16 a[48:49],v7 offset:24576
ds_read_b64_tr_b16 a[50:51],v7 offset:26624
ds_read_b64_tr_b16 a[52:53],v7 offset:25600
ds_read_b64_tr_b16 a[54:55],v7 offset:27648
s_waitcnt lgkmcnt(4)
ds_read_b64_tr_b16 a[208:209],v7 offset:24640
ds_read_b64_tr_b16 a[210:211],v7 offset:26688
ds_read_b64_tr_b16 a[212:213],v7 offset:25664
ds_read_b64_tr_b16 a[214:215],v7 offset:27712
ds_read_b64_tr_b16 a[56:57],v7 offset:28672
ds_read_b64_tr_b16 a[58:59],v7 offset:30720
ds_read_b64_tr_b16 a[60:61],v7 offset:29696
ds_read_b64_tr_b16 a[62:63],v7 offset:31744
ds_read_b64_tr_b16 a[216:217],v7 offset:28736
ds_read_b64_tr_b16 a[218:219],v7 offset:30784
ds_read_b64_tr_b16 a[220:221],v7 offset:29760
ds_read_b64_tr_b16 a[222:223],v7 offset:31808
s_waitcnt lgkmcnt(4)
ds_read_b64_tr_b16 a[64:65],v7 offset:32768
ds_read_b64_tr_b16 a[66:67],v7 offset:34816
ds_read_b64_tr_b16 a[68:69],v7 offset:33792
ds_read_b64_tr_b16 a[70:71],v7 offset:35840
ds_read_b64_tr_b16 a[224:225],v7 offset:32832
ds_read_b64_tr_b16 a[226:227],v7 offset:34880
ds_read_b64_tr_b16 a[228:229],v7 offset:33856
ds_read_b64_tr_b16 a[230:231],v7 offset:35904
ds_read_b64_tr_b16 a[72:73],v7 offset:36864
ds_read_b64_tr_b16 a[74:75],v7 offset:38912
ds_read_b64_tr_b16 a[76:77],v7 offset:37888
ds_read_b64_tr_b16 a[78:79],v7 offset:39936
s_waitcnt lgkmcnt(4)
ds_read_b64_tr_b16 a[232:233],v7 offset:36928
ds_read_b64_tr_b16 a[234:235],v7 offset:38976
ds_read_b64_tr_b16 a[236:237],v7 offset:37952
ds_read_b64_tr_b16 a[238:239],v7 offset:40000
s_waitcnt lgkmcnt(0)
s_add_u32 m0,s63,20480
s_add_u32 s65,s58,5898240
buffer_load_dwordx4 v6,s[4:7],s65 offen lds
s_add_u32 m0,s63,21504
s_add_u32 s65,s58,5996544
buffer_load_dwordx4 v6,s[4:7],s65 offen lds
s_add_u32 m0,s63,22528
s_add_u32 s65,s58,6094848
buffer_load_dwordx4 v6,s[4:7],s65 offen lds
s_add_u32 m0,s63,23552
s_add_u32 s65,s58,6193152
buffer_load_dwordx4 v6,s[4:7],s65 offen lds
s_add_u32 m0,s63,24576
s_add_u32 s65,s58,6291456
buffer_load_dwordx4 v6,s[4:7],s65 offen lds
s_add_u32 m0,s63,25600
s_add_u32 s65,s58,6389760
buffer_load_dwordx4 v6,s[4:7],s65 offen lds
s_add_u32 m0,s63,26624
s_add_u32 s65,s58,6488064
buffer_load_dwordx4 v6,s[4:7],s65 offen lds
s_add_u32 m0,s63,27648
s_add_u32 s65,s58,6586368
buffer_load_dwordx4 v6,s[4:7],s65 offen lds
s_add_u32 m0,s63,28672
s_add_u32 s65,s58,6684672
buffer_load_dwordx4 v6,s[4:7],s65 offen lds
s_add_u32 m0,s63,29696
s_add_u32 s65,s58,6782976
buffer_load_dwordx4 v6,s[4:7],s65 offen lds
s_add_u32 m0,s63,30720
s_add_u32 s65,s58,6881280
buffer_load_dwordx4 v6,s[4:7],s65 offen lds
s_add_u32 m0,s63,31744
s_add_u32 s65,s58,6979584
buffer_load_dwordx4 v6,s[4:7],s65 offen lds
s_add_u32 m0,s63,32768
s_add_u32 s65,s58,7077888
buffer_load_dwordx4 v6,s[4:7],s65 offen lds
s_add_u32 m0,s63,33792
s_add_u32 s65,s58,7176192
buffer_load_dwordx4 v6,s[4:7],s65 offen lds
s_add_u32 m0,s63,34816
s_add_u32 s65,s58,7274496
buffer_load_dwordx4 v6,s[4:7],s65 offen lds
s_add_u32 m0,s63,35840
s_add_u32 s65,s58,7372800
buffer_load_dwordx4 v6,s[4:7],s65 offen lds
s_add_u32 m0,s63,36864
s_add_u32 s65,s58,7471104
buffer_load_dwordx4 v6,s[4:7],s65 offen lds
s_add_u32 m0,s63,37888
s_add_u32 s65,s58,7569408
buffer_load_dwordx4 v6,s[4:7],s65 offen lds
s_add_u32 m0,s63,38912
s_add_u32 s65,s58,7667712
buffer_load_dwordx4 v6,s[4:7],s65 offen lds
s_add_u32 m0,s63,39936
s_add_u32 s65,s58,7766016
buffer_load_dwordx4 v6,s[4:7],s65 offen lds
s_waitcnt vmcnt(20)
v_bfe_u32 v9,v0,2,2
v_lshrrev_b32 v10,5,v0
v_lshl_add_u32 v9,v10,2,v9
v_mul_u32_u24 v9,128,v9
v_and_b32 v10,1,v0
v_lshl_add_u32 v9,v10,3,v9
v_bfe_u32 v10,v0,1,1
v_lshl_add_u32 v9,v10,4,v9
v_bfe_u32 v10,v0,4,1
v_lshl_add_u32 v9,v10,5,v9
v_add_u32 v7,s63,v9
ds_read_b64_tr_b16 a[80:81],v7 offset:0
ds_read_b64_tr_b16 a[82:83],v7 offset:2048
ds_read_b64_tr_b16 a[84:85],v7 offset:1024
ds_read_b64_tr_b16 a[86:87],v7 offset:3072
ds_read_b64_tr_b16 a[240:241],v7 offset:64
ds_read_b64_tr_b16 a[242:243],v7 offset:2112
ds_read_b64_tr_b16 a[244:245],v7 offset:1088
ds_read_b64_tr_b16 a[246:247],v7 offset:3136
ds_read_b64_tr_b16 a[88:89],v7 offset:4096
ds_read_b64_tr_b16 a[90:91],v7 offset:6144
ds_read_b64_tr_b16 a[92:93],v7 offset:5120
ds_read_b64_tr_b16 a[94:95],v7 offset:7168
s_waitcnt lgkmcnt(4)
ds_read_b64_tr_b16 a[248:249],v7 offset:4160
ds_read_b64_tr_b16 a[250:251],v7 offset:6208
ds_read_b64_tr_b16 a[252:253],v7 offset:5184
ds_read_b64_tr_b16 a[254:255],v7 offset:7232
ds_read_b64_tr_b16 a[96:97],v7 offset:8192
ds_read_b64_tr_b16 a[98:99],v7 offset:10240
ds_read_b64_tr_b16 a[100:101],v7 offset:9216
ds_read_b64_tr_b16 a[102:103],v7 offset:11264
ds_read_b64_tr_b16 v[192:193],v7 offset:8256
ds_read_b64_tr_b16 v[194:195],v7 offset:10304
ds_read_b64_tr_b16 v[196:197],v7 offset:9280
ds_read_b64_tr_b16 v[198:199],v7 offset:11328
s_waitcnt lgkmcnt(4)
ds_read_b64_tr_b16 a[104:105],v7 offset:12288
ds_read_b64_tr_b16 a[106:107],v7 offset:14336
ds_read_b64_tr_b16 a[108:109],v7 offset:13312
ds_read_b64_tr_b16 a[110:111],v7 offset:15360
ds_read_b64_tr_b16 v[200:201],v7 offset:12352
ds_read_b64_tr_b16 v[202:203],v7 offset:14400
ds_read_b64_tr_b16 v[204:205],v7 offset:13376
ds_read_b64_tr_b16 v[206:207],v7 offset:15424
ds_read_b64_tr_b16 a[112:113],v7 offset:16384
ds_read_b64_tr_b16 a[114:115],v7 offset:18432
ds_read_b64_tr_b16 a[116:117],v7 offset:17408
ds_read_b64_tr_b16 a[118:119],v7 offset:19456
s_waitcnt lgkmcnt(4)
ds_read_b64_tr_b16 v[208:209],v7 offset:16448
ds_read_b64_tr_b16 v[210:211],v7 offset:18496
ds_read_b64_tr_b16 v[212:213],v7 offset:17472
ds_read_b64_tr_b16 v[214:215],v7 offset:19520
s_waitcnt lgkmcnt(0)
s_waitcnt vmcnt(0)
v_bfe_u32 v9,v0,2,2
v_lshrrev_b32 v10,5,v0
v_lshl_add_u32 v9,v10,2,v9
v_mul_u32_u24 v9,128,v9
v_and_b32 v10,1,v0
v_lshl_add_u32 v9,v10,3,v9
v_bfe_u32 v10,v0,1,1
v_lshl_add_u32 v9,v10,4,v9
v_bfe_u32 v10,v0,4,1
v_lshl_add_u32 v9,v10,5,v9
v_add_u32 v7,s63,v9
ds_read_b64_tr_b16 a[120:121],v7 offset:20480
ds_read_b64_tr_b16 a[122:123],v7 offset:22528
ds_read_b64_tr_b16 a[124:125],v7 offset:21504
ds_read_b64_tr_b16 a[126:127],v7 offset:23552
ds_read_b64_tr_b16 v[216:217],v7 offset:20544
ds_read_b64_tr_b16 v[218:219],v7 offset:22592
ds_read_b64_tr_b16 v[220:221],v7 offset:21568
ds_read_b64_tr_b16 v[222:223],v7 offset:23616
ds_read_b64_tr_b16 a[128:129],v7 offset:24576
ds_read_b64_tr_b16 a[130:131],v7 offset:26624
ds_read_b64_tr_b16 a[132:133],v7 offset:25600
ds_read_b64_tr_b16 a[134:135],v7 offset:27648
s_waitcnt lgkmcnt(4)
ds_read_b64_tr_b16 v[224:225],v7 offset:24640
ds_read_b64_tr_b16 v[226:227],v7 offset:26688
ds_read_b64_tr_b16 v[228:229],v7 offset:25664
ds_read_b64_tr_b16 v[230:231],v7 offset:27712
ds_read_b64_tr_b16 a[136:137],v7 offset:28672
ds_read_b64_tr_b16 a[138:139],v7 offset:30720
ds_read_b64_tr_b16 a[140:141],v7 offset:29696
ds_read_b64_tr_b16 a[142:143],v7 offset:31744
ds_read_b64_tr_b16 v[232:233],v7 offset:28736
ds_read_b64_tr_b16 v[234:235],v7 offset:30784
ds_read_b64_tr_b16 v[236:237],v7 offset:29760
ds_read_b64_tr_b16 v[238:239],v7 offset:31808
s_waitcnt lgkmcnt(4)
ds_read_b64_tr_b16 a[144:145],v7 offset:32768
ds_read_b64_tr_b16 a[146:147],v7 offset:34816
ds_read_b64_tr_b16 a[148:149],v7 offset:33792
ds_read_b64_tr_b16 a[150:151],v7 offset:35840
ds_read_b64_tr_b16 v[240:241],v7 offset:32832
ds_read_b64_tr_b16 v[242:243],v7 offset:34880
ds_read_b64_tr_b16 v[244:245],v7 offset:33856
ds_read_b64_tr_b16 v[246:247],v7 offset:35904
ds_read_b64_tr_b16 a[152:153],v7 offset:36864
ds_read_b64_tr_b16 a[154:155],v7 offset:38912
ds_read_b64_tr_b16 a[156:157],v7 offset:37888
ds_read_b64_tr_b16 a[158:159],v7 offset:39936
s_waitcnt lgkmcnt(4)
ds_read_b64_tr_b16 v[248:249],v7 offset:36928
ds_read_b64_tr_b16 v[250:251],v7 offset:38976
ds_read_b64_tr_b16 v[252:253],v7 offset:37952
ds_read_b64_tr_b16 v[254:255],v7 offset:40000
s_waitcnt lgkmcnt(0)
v_mov_b32 v24,0x3f803f80
v_mov_b32 v25,0x3f803f80
v_mov_b32 v26,0x3f803f80
v_mov_b32 v27,0x3f803f80
s_nop 1
v_mfma_f32_32x32x16_bf16 v[56:71],v[24:27],a[0:3],0
v_mfma_f32_32x32x16_bf16 v[72:87],v[24:27],a[160:163],0
v_mfma_f32_32x32x16_bf16 v[56:71],v[24:27],a[4:7],v[56:71]
v_mfma_f32_32x32x16_bf16 v[72:87],v[24:27],a[164:167],v[72:87]
v_mfma_f32_32x32x16_bf16 v[56:71],v[24:27],a[8:11],v[56:71]
v_mfma_f32_32x32x16_bf16 v[72:87],v[24:27],a[168:171],v[72:87]
v_mfma_f32_32x32x16_bf16 v[56:71],v[24:27],a[12:15],v[56:71]
v_mfma_f32_32x32x16_bf16 v[72:87],v[24:27],a[172:175],v[72:87]
v_mfma_f32_32x32x16_bf16 v[56:71],v[24:27],a[16:19],v[56:71]
v_mfma_f32_32x32x16_bf16 v[72:87],v[24:27],a[176:179],v[72:87]
v_mfma_f32_32x32x16_bf16 v[56:71],v[24:27],a[20:23],v[56:71]
v_mfma_f32_32x32x16_bf16 v[72:87],v[24:27],a[180:183],v[72:87]
v_mfma_f32_32x32x16_bf16 v[56:71],v[24:27],a[24:27],v[56:71]
v_mfma_f32_32x32x16_bf16 v[72:87],v[24:27],a[184:187],v[72:87]
v_mfma_f32_32x32x16_bf16 v[56:71],v[24:27],a[28:31],v[56:71]
v_mfma_f32_32x32x16_bf16 v[72:87],v[24:27],a[188:191],v[72:87]
v_mfma_f32_32x32x16_bf16 v[56:71],v[24:27],a[32:35],v[56:71]
v_mfma_f32_32x32x16_bf16 v[72:87],v[24:27],a[192:195],v[72:87]
v_mfma_f32_32x32x16_bf16 v[56:71],v[24:27],a[36:39],v[56:71]
v_mfma_f32_32x32x16_bf16 v[72:87],v[24:27],a[196:199],v[72:87]
v_mfma_f32_32x32x16_bf16 v[56:71],v[24:27],a[40:43],v[56:71]
v_mfma_f32_32x32x16_bf16 v[72:87],v[24:27],a[200:203],v[72:87]
v_mfma_f32_32x32x16_bf16 v[56:71],v[24:27],a[44:47],v[56:71]
v_mfma_f32_32x32x16_bf16 v[72:87],v[24:27],a[204:207],v[72:87]
v_mfma_f32_32x32x16_bf16 v[56:71],v[24:27],a[48:51],v[56:71]
v_mfma_f32_32x32x16_bf16 v[72:87],v[24:27],a[208:211],v[72:87]
v_mfma_f32_32x32x16_bf16 v[56:71],v[24:27],a[52:55],v[56:71]
v_mfma_f32_32x32x16_bf16 v[72:87],v[24:27],a[212:215],v[72:87]
v_mfma_f32_32x32x16_bf16 v[56:71],v[24:27],a[56:59],v[56:71]
v_mfma_f32_32x32x16_bf16 v[72:87],v[24:27],a[216:219],v[72:87]
v_mfma_f32_32x32x16_bf16 v[56:71],v[24:27],a[60:63],v[56:71]
v_mfma_f32_32x32x16_bf16 v[72:87],v[24:27],a[220:223],v[72:87]
v_mfma_f32_32x32x16_bf16 v[56:71],v[24:27],a[64:67],v[56:71]
v_mfma_f32_32x32x16_bf16 v[72:87],v[24:27],a[224:227],v[72:87]
v_mfma_f32_32x32x16_bf16 v[56:71],v[24:27],a[68:71],v[56:71]
v_mfma_f32_32x32x16_bf16 v[72:87],v[24:27],a[228:231],v[72:87]
v_mfma_f32_32x32x16_bf16 v[56:71],v[24:27],a[72:75],v[56:71]
v_mfma_f32_32x32x16_bf16 v[72:87],v[24:27],a[232:235],v[72:87]
v_mfma_f32_32x32x16_bf16 v[56:71],v[24:27],a[76:79],v[56:71]
v_mfma_f32_32x32x16_bf16 v[72:87],v[24:27],a[236:239],v[72:87]
v_mfma_f32_32x32x16_bf16 v[56:71],v[24:27],a[80:83],v[56:71]
v_mfma_f32_32x32x16_bf16 v[72:87],v[24:27],a[240:243],v[72:87]
v_mfma_f32_32x32x16_bf16 v[56:71],v[24:27],a[84:87],v[56:71]
v_mfma_f32_32x32x16_bf16 v[72:87],v[24:27],a[244:247],v[72:87]
v_mfma_f32_32x32x16_bf16 v[56:71],v[24:27],a[88:91],v[56:71]
v_mfma_f32_32x32x16_bf16 v[72:87],v[24:27],a[248:251],v[72:87]
v_mfma_f32_32x32x16_bf16 v[56:71],v[24:27],a[92:95],v[56:71]
v_mfma_f32_32x32x16_bf16 v[72:87],v[24:27],a[252:255],v[72:87]
v_mfma_f32_32x32x16_bf16 v[56:71],v[24:27],a[96:99],v[56:71]
v_mfma_f32_32x32x16_bf16 v[72:87],v[24:27],v[192:195],v[72:87]
v_mfma_f32_32x32x16_bf16 v[56:71],v[24:27],a[100:103],v[56:71]
v_mfma_f32_32x32x16_bf16 v[72:87],v[24:27],v[196:199],v[72:87]
v_mfma_f32_32x32x16_bf16 v[56:71],v[24:27],a[104:107],v[56:71]
v_mfma_f32_32x32x16_bf16 v[72:87],v[24:27],v[200:203],v[72:87]
v_mfma_f32_32x32x16_bf16 v[56:71],v[24:27],a[108:111],v[56:71]
v_mfma_f32_32x32x16_bf16 v[72:87],v[24:27],v[204:207],v[72:87]
v_mfma_f32_32x32x16_bf16 v[56:71],v[24:27],a[112:115],v[56:71]
v_mfma_f32_32x32x16_bf16 v[72:87],v[24:27],v[208:211],v[72:87]
v_mfma_f32_32x32x16_bf16 v[56:71],v[24:27],a[116:119],v[56:71]
v_mfma_f32_32x32x16_bf16 v[72:87],v[24:27],v[212:215],v[72:87]
v_mfma_f32_32x32x16_bf16 v[56:71],v[24:27],a[120:123],v[56:71]
v_mfma_f32_32x32x16_bf16 v[72:87],v[24:27],v[216:219],v[72:87]
v_mfma_f32_32x32x16_bf16 v[56:71],v[24:27],a[124:127],v[56:71]
v_mfma_f32_32x32x16_bf16 v[72:87],v[24:27],v[220:223],v[72:87]
v_mfma_f32_32x32x16_bf16 v[56:71],v[24:27],a[128:131],v[56:71]
v_mfma_f32_32x32x16_bf16 v[72:87],v[24:27],v[224:227],v[72:87]
v_mfma_f32_32x32x16_bf16 v[56:71],v[24:27],a[132:135],v[56:71]
v_mfma_f32_32x32x16_bf16 v[72:87],v[24:27],v[228:231],v[72:87]
v_mfma_f32_32x32x16_bf16 v[56:71],v[24:27],a[136:139],v[56:71]
v_mfma_f32_32x32x16_bf16 v[72:87],v[24:27],v[232:235],v[72:87]
v_mfma_f32_32x32x16_bf16 v[56:71],v[24:27],a[140:143],v[56:71]
v_mfma_f32_32x32x16_bf16 v[72:87],v[24:27],v[236:239],v[72:87]
v_mfma_f32_32x32x16_bf16 v[56:71],v[24:27],a[144:147],v[56:71]
v_mfma_f32_32x32x16_bf16 v[72:87],v[24:27],v[240:243],v[72:87]
v_mfma_f32_32x32x16_bf16 v[56:71],v[24:27],a[148:151],v[56:71]
v_mfma_f32_32x32x16_bf16 v[72:87],v[24:27],v[244:247],v[72:87]
v_mfma_f32_32x32x16_bf16 v[56:71],v[24:27],a[152:155],v[56:71]
v_mfma_f32_32x32x16_bf16 v[72:87],v[24:27],v[248:251],v[72:87]
v_mfma_f32_32x32x16_bf16 v[56:71],v[24:27],a[156:159],v[56:71]
v_mfma_f32_32x32x16_bf16 v[72:87],v[24:27],v[252:255],v[72:87]
s_nop 10
v_mov_b32 v120,v56
v_mov_b32 v121,v72
s_barrier
s_lshl_b32 s3,s49,2
v_mov_b32 v7,s3
s_nop 1
ibw_246:
buffer_load_dword v6,v7,s[12:15],0 offen sc1
s_waitcnt vmcnt(0)
v_cmp_ne_u32 vcc,256,v6
s_nop 0
s_cbranch_vccz ok_247
s_sleep 8
s_sub_u32 s47,s47,1
s_cbranch_scc1 ABORT
s_branch ibw_246
ok_247:
s_cmp_lg_u32 s49,0
s_cbranch_scc1 ibok_248
v_and_b32 v7,7,v0
v_lshlrev_b32 v7,2,v7
buffer_load_dword v6,v7,s[12:15],0 offen offset:32 sc1
s_waitcnt vmcnt(0)
v_cmp_ne_u32 vcc,32,v6
s_nop 0
s_cbranch_vccz ibok_248
s_barrier
s_mov_b32 s49,1
s_mov_b32 s3,s2
s_load_dwordx16 s[16:31],s[0:1],0
s_load_dwordx8 s[32:39],s[0:1],64
s_waitcnt lgkmcnt(0)
s_branch DISPATCH
ibok_248:
s_mov_b32 s50,0
s_mov_b32 s32,0
s_mov_b32 s57,0
s_mov_b32 s59,2147483648
s_mov_b32 s82,2147483648
s_mov_b32 s39,2147483648
v_mov_b32 v22,94208
s_mov_b32 s72,0
s_mov_b32 s73,0
s_mov_b32 s83,s100
s_min_u32 s62,s32,127
s_sub_u32 s60,s62,20
s_lshr_b32 s34,s60,1
s_and_b32 s33,s60,1
s_xor_b32 s33,s33,1
s_cmp_eq_u32 s33,0
s_cselect_b32 s61,20,0
s_add_u32 s34,s34,s61
s_sub_u32 s61,s60,44
s_cmp_ge_u32 s60,88
s_cselect_b32 s34,s61,s34
s_cselect_b32 s33,1,s33
s_cmp_lt_u32 s62,20
s_cselect_b32 s34,s62,s34
s_cselect_b32 s33,0,s33
s_lshl_b32 s35,s33,6
s_add_u32 s35,s35,s34
s_lshl_b32 s35,s35,9
s_add_u32 s35,s35,0
s_lshl_b32 s60,s33,5
s_add_u32 s60,s60,7
v_min_u32 v2,s60,v0
v_lshlrev_b32 v2,2,v2
s_nop 1
QKVV_COLD0:
s_cmp_lg_u32 s46,0
s_cbranch_scc1 cp_249
fb_250:
buffer_load_dword v3,v2,s[8:11],s35 offen sc1
s_waitcnt vmcnt(0)
v_cmp_eq_u32 vcc,0,v3
s_nop 0
s_cbranch_vccz ok_251
s_sleep 7
s_sub_u32 s47,s47,1
s_cbranch_scc1 ABORT
s_branch fb_250
ok_251:
cp_249:
s_barrier
s_lshl_b32 s60,s33,6
s_add_u32 s60,s60,s34
s_mul_i32 s60,s60,46080
s_add_u32 s60,s60,206569472
s_lshl_b32 s62,s46,10
s_add_u32 s62,s62,40960
s_add_u32 m0,s57,s62
s_add_u32 s63,s60,s62
buffer_load_dwordx4 v1,s[8:11],s63 offen sc1 lds
s_add_u32 m0,s57,45056
s_add_u32 s63,s60,45056
buffer_load_dwordx4 v1,s[8:11],s63 offen sc1 lds
s_mul_i32 s61,s46,10240
s_add_u32 s60,s60,s61
s_add_u32 s61,s61,s57
s_add_u32 m0,s61,0
s_add_u32 s63,s60,0
buffer_load_dwordx4 v1,s[8:11],s63 offen sc1 lds
buffer_load_dwordx4 v1,s[8:11],s63 offen offset:1024 sc1 lds
buffer_load_dwordx4 v1,s[8:11],s63 offen offset:2048 sc1 lds
buffer_load_dwordx4 v1,s[8:11],s63 offen offset:3072 sc1 lds
s_add_u32 m0,s61,4096
s_add_u32 s63,s60,4096
buffer_load_dwordx4 v1,s[8:11],s63 offen sc1 lds
buffer_load_dwordx4 v1,s[8:11],s63 offen offset:1024 sc1 lds
buffer_load_dwordx4 v1,s[8:11],s63 offen offset:2048 sc1 lds
buffer_load_dwordx4 v1,s[8:11],s63 offen offset:3072 sc1 lds
s_add_u32 m0,s61,8192
s_add_u32 s63,s60,8192
buffer_load_dwordx4 v1,s[8:11],s63 offen sc1 lds
buffer_load_dwordx4 v1,s[8:11],s63 offen offset:1024 sc1 lds
QKVV_CD0:
s_mov_b32 s51,s33
s_mov_b32 s52,s34
s_add_u32 s32,s32,1
s_min_u32 s62,s32,127
s_sub_u32 s60,s62,20
s_lshr_b32 s34,s60,1
s_and_b32 s33,s60,1
s_xor_b32 s33,s33,1
s_cmp_eq_u32 s33,0
s_cselect_b32 s61,20,0
s_add_u32 s34,s34,s61
s_sub_u32 s61,s60,44
s_cmp_ge_u32 s60,88
s_cselect_b32 s34,s61,s34
s_cselect_b32 s33,1,s33
s_cmp_lt_u32 s62,20
s_cselect_b32 s34,s62,s34
s_cselect_b32 s33,0,s33
s_lshl_b32 s35,s33,6
s_add_u32 s35,s35,s34
s_lshl_b32 s35,s35,9
s_add_u32 s35,s35,0
s_lshl_b32 s60,s33,5
s_add_u32 s60,s60,7
v_min_u32 v2,s60,v0
v_lshlrev_b32 v2,2,v2
s_cmp_lg_u32 s46,0
s_cbranch_scc1 w0_252
buffer_load_dword v3,v2,s[8:11],s35 offen sc1
w0_252:
s_waitcnt vmcnt(0)
s_mov_b64 exec,1
buffer_store_dword v5,v1,s[8:11],s59 offen sc1
s_mov_b64 exec,-1
s_mov_b32 s59,2147483648
s_cmp_lg_u32 s46,0
s_cbranch_scc1 w0_253
v_cmp_eq_u32 vcc,0,v3
s_cmp_eq_u64 vcc,0
s_cselect_b32 s36,0,2147483648
s_cmp_lt_u32 s32,128
s_cselect_b32 s36,s36,2147483648
v_mov_b32 v23,s36
ds_write_b32 v22,v23
w0_253:
s_waitcnt lgkmcnt(0)
s_barrier
ds_read_b32 v23,v22
ds_read_b128 v[24:27],v16 offset:0
ds_read_b128 v[28:31],v17 offset:0
ds_read_b128 v[32:35],v16 offset:2048
ds_read_b128 v[36:39],v17 offset:2048
ds_read_b128 v[40:43],v16 offset:4096
s_waitcnt lgkmcnt(5)
v_readfirstlane_b32 s37,v23
s_nop 4
QKVV_B0:
s_waitcnt lgkmcnt(3)
v_mfma_f32_32x32x16_bf16 v[56:71],v[24:27],a[0:3],0
ds_read_b128 v[44:47],v17 offset:4096
v_add_u32 v189,s57,v188
v_mfma_f32_32x32x16_bf16 v[72:87],v[24:27],a[160:163],0
v_add_u32 v8,0x800,v189
s_sub_u32 s66,46080,s57
s_lshl_b32 s60,s33,6
s_add_u32 s60,s60,s34
s_mul_i32 s60,s60,46080
s_add_u32 s60,s60,s37
v_mfma_f32_32x32x16_bf16 v[56:71],v[28:31],a[4:7],v[56:71]
ds_read_b128 v[48:51],v16 offset:6144
ds_read2_b64 v[156:159],v189 offset0:0 offset1:32
s_add_u32 s60,s60,206569472
s_lshl_b32 s62,s46,10
v_mfma_f32_32x32x16_bf16 v[72:87],v[28:31],a[164:167],v[72:87]
ds_read2_b64 v[160:163],v189 offset0:64 offset1:96
s_add_u32 s62,s62,40960
s_add_u32 m0,s66,s62
s_add_u32 s63,s60,s62
s_waitcnt lgkmcnt(5)
v_mfma_f32_32x32x16_bf16 v[56:71],v[32:35],a[8:11],v[56:71]
ds_read_b128 v[52:55],v17 offset:6144
ds_read2_b64 v[164:167],v189 offset0:128 offset1:160
buffer_load_dwordx4 v1,s[8:11],s63 offen sc1 lds
v_mfma_f32_32x32x16_bf16 v[72:87],v[32:35],a[168:171],v[72:87]
ds_read2_b64 v[168:171],v189 offset0:192 offset1:224
s_add_u32 m0,s66,45056
s_add_u32 s63,s60,45056
s_mul_i32 s74,s73,393216
s_add_u32 s74,s74,s39
v_mfma_f32_32x32x16_bf16 v[56:71],v[36:39],a[12:15],v[56:71]
ds_read_b128 v[24:27],v16 offset:8192
ds_read2_b64 v[172:175],v8 offset0:0 offset1:32
s_add_u32 s74,s74,s70
v_fma_f32 v88,-v124,v120,v88
v_mfma_f32_32x32x16_bf16 v[72:87],v[36:39],a[172:175],v[72:87]
buffer_load_dwordx4 v1,s[8:11],s63 offen sc1 lds
s_mul_i32 s61,s46,10240
s_add_u32 s60,s60,s61
s_add_u32 s61,s61,s66
s_waitcnt lgkmcnt(8)
v_mfma_f32_32x32x16_bf16 v[56:71],v[40:43],a[16:19],v[56:71]
ds_read_b128 v[28:31],v17 offset:8192
s_add_u32 m0,s61,0
s_add_u32 s63,s60,0
v_fma_f32 v89,-v126,v120,v89
v_fma_f32 v90,-v128,v120,v90
v_mfma_f32_32x32x16_bf16 v[72:87],v[40:43],a[176:179],v[72:87]
v_fma_f32 v91,-v130,v120,v91
v_fma_f32 v96,-v140,v120,v96
v_fma_f32 v97,-v142,v120,v97
v_fma_f32 v98,-v144,v120,v98
v_fma_f32 v99,-v146,v120,v99
v_mfma_f32_32x32x16_bf16 v[56:71],v[44:47],a[20:23],v[56:71]
ds_read_b128 v[32:35],v16 offset:10240
buffer_load_dwordx4 v1,s[8:11],s63 offen sc1 lds
v_mul_f32 v88,v88,v125
v_mul_f32 v89,v89,v127
v_mfma_f32_32x32x16_bf16 v[72:87],v[44:47],a[180:183],v[72:87]
v_mul_f32 v90,v90,v129
v_mul_f32 v91,v91,v131
v_mul_f32 v96,v96,v141
v_mul_f32 v97,v97,v143
v_mul_f32 v98,v98,v145
s_waitcnt lgkmcnt(6)
v_mfma_f32_32x32x16_bf16 v[56:71],v[48:51],a[24:27],v[56:71]
ds_read_b128 v[36:39],v17 offset:10240
v_mul_f32 v99,v99,v147
v_cvt_pk_bf16_f32 v180,v88,v89
v_cvt_pk_bf16_f32 v181,v90,v91
v_cvt_pk_bf16_f32 v182,v96,v97
v_mfma_f32_32x32x16_bf16 v[72:87],v[48:51],a[184:187],v[72:87]
buffer_load_dwordx4 v1,s[8:11],s63 offen offset:1024 sc1 lds
v_cvt_pk_bf16_f32 v183,v98,v99
buffer_store_dwordx4 v[180:183],v20,s[8:11],s74 offen sc1
v_fma_f32 v92,-v132,v120,v92
v_mfma_f32_32x32x16_bf16 v[56:71],v[52:55],a[28:31],v[56:71]
ds_read_b128 v[40:43],v16 offset:12288
v_fma_f32 v93,-v134,v120,v93
v_fma_f32 v94,-v136,v120,v94
v_fma_f32 v95,-v138,v120,v95
v_fma_f32 v100,-v148,v120,v100
v_mfma_f32_32x32x16_bf16 v[72:87],v[52:55],a[188:191],v[72:87]
v_fma_f32 v101,-v150,v120,v101
v_fma_f32 v102,-v152,v120,v102
v_fma_f32 v103,-v154,v120,v103
v_mul_f32 v92,v92,v133
v_mul_f32 v93,v93,v135
s_waitcnt lgkmcnt(3)
v_mfma_f32_32x32x16_bf16 v[56:71],v[24:27],a[32:35],v[56:71]
ds_read_b128 v[44:47],v17 offset:12288
buffer_load_dwordx4 v1,s[8:11],s63 offen offset:2048 sc1 lds
v_mul_f32 v94,v94,v137
v_mul_f32 v95,v95,v139
v_mfma_f32_32x32x16_bf16 v[72:87],v[24:27],a[192:195],v[72:87]
v_mul_f32 v100,v100,v149
v_mul_f32 v101,v101,v151
v_mul_f32 v102,v102,v153
v_mul_f32 v103,v103,v155
v_cvt_pk_bf16_f32 v184,v92,v93
v_mfma_f32_32x32x16_bf16 v[56:71],v[28:31],a[36:39],v[56:71]
ds_read_b128 v[48:51],v16 offset:14336
v_cvt_pk_bf16_f32 v185,v94,v95
v_cvt_pk_bf16_f32 v186,v100,v101
v_cvt_pk_bf16_f32 v187,v102,v103
v_mfma_f32_32x32x16_bf16 v[72:87],v[28:31],a[196:199],v[72:87]
buffer_load_dwordx4 v1,s[8:11],s63 offen offset:3072 sc1 lds
s_add_u32 m0,s61,4096
s_add_u32 s63,s60,4096
s_waitcnt lgkmcnt(3)
v_mfma_f32_32x32x16_bf16 v[56:71],v[32:35],a[40:43],v[56:71]
ds_read_b128 v[52:55],v17 offset:14336
buffer_store_dwordx4 v[184:187],v21,s[8:11],s74 offen sc1
v_fma_f32 v104,-v124,v121,v104
v_fma_f32 v105,-v126,v121,v105
v_mfma_f32_32x32x16_bf16 v[72:87],v[32:35],a[200:203],v[72:87]
v_fma_f32 v106,-v128,v121,v106
v_fma_f32 v107,-v130,v121,v107
v_fma_f32 v112,-v140,v121,v112
v_fma_f32 v113,-v142,v121,v113
v_fma_f32 v114,-v144,v121,v114
v_mfma_f32_32x32x16_bf16 v[56:71],v[36:39],a[44:47],v[56:71]
ds_read_b128 v[24:27],v16 offset:16384
buffer_load_dwordx4 v1,s[8:11],s63 offen sc1 lds
v_fma_f32 v115,-v146,v121,v115
v_mul_f32 v104,v104,v125
v_mfma_f32_32x32x16_bf16 v[72:87],v[36:39],a[204:207],v[72:87]
v_mul_f32 v105,v105,v127
v_mul_f32 v106,v106,v129
v_mul_f32 v107,v107,v131
v_mul_f32 v112,v112,v141
v_mul_f32 v113,v113,v143
s_waitcnt lgkmcnt(3)
v_mfma_f32_32x32x16_bf16 v[56:71],v[40:43],a[48:51],v[56:71]
ds_read_b128 v[28:31],v17 offset:16384
v_mul_f32 v114,v114,v145
v_mul_f32 v115,v115,v147
v_cvt_pk_bf16_f32 v180,v104,v105
v_cvt_pk_bf16_f32 v181,v106,v107
v_mfma_f32_32x32x16_bf16 v[72:87],v[40:43],a[208:211],v[72:87]
buffer_load_dwordx4 v1,s[8:11],s63 offen offset:1024 sc1 lds
v_cvt_pk_bf16_f32 v182,v112,v113
v_cvt_pk_bf16_f32 v183,v114,v115
buffer_store_dwordx4 v[180:183],v20,s[8:11],s74 offen offset:2048 sc1
v_mfma_f32_32x32x16_bf16 v[56:71],v[44:47],a[52:55],v[56:71]
ds_read_b128 v[32:35],v16 offset:18432
v_fma_f32 v108,-v132,v121,v108
v_fma_f32 v109,-v134,v121,v109
v_fma_f32 v110,-v136,v121,v110
v_fma_f32 v111,-v138,v121,v111
v_mfma_f32_32x32x16_bf16 v[72:87],v[44:47],a[212:215],v[72:87]
v_fma_f32 v116,-v148,v121,v116
v_fma_f32 v117,-v150,v121,v117
v_fma_f32 v118,-v152,v121,v118
v_fma_f32 v119,-v154,v121,v119
v_mul_f32 v108,v108,v133
s_waitcnt lgkmcnt(3)
v_mfma_f32_32x32x16_bf16 v[56:71],v[48:51],a[56:59],v[56:71]
ds_read_b128 v[36:39],v17 offset:18432
buffer_load_dwordx4 v1,s[8:11],s63 offen offset:2048 sc1 lds
v_mul_f32 v109,v109,v135
v_mul_f32 v110,v110,v137
v_mfma_f32_32x32x16_bf16 v[72:87],v[48:51],a[216:219],v[72:87]
v_mul_f32 v111,v111,v139
v_mul_f32 v116,v116,v149
v_mul_f32 v117,v117,v151
v_mul_f32 v118,v118,v153
v_mul_f32 v119,v119,v155
v_mfma_f32_32x32x16_bf16 v[56:71],v[52:55],a[60:63],v[56:71]
ds_read_b128 v[40:43],v16 offset:20480
s_waitcnt vmcnt(12)
s_mov_b64 exec,1
buffer_store_dword v5,v1,s[8:11],s59 offen sc1
s_mov_b64 exec,-1
s_mov_b32 s59,2147483648
v_mfma_f32_32x32x16_bf16 v[72:87],v[52:55],a[220:223],v[72:87]
buffer_load_dwordx4 v1,s[8:11],s63 offen offset:3072 sc1 lds
s_add_u32 m0,s61,8192
s_add_u32 s63,s60,8192
v_cvt_pk_bf16_f32 v184,v108,v109
s_waitcnt lgkmcnt(3)
v_mfma_f32_32x32x16_bf16 v[56:71],v[24:27],a[64:67],v[56:71]
ds_read_b128 v[44:47],v17 offset:20480
v_cvt_pk_bf16_f32 v185,v110,v111
v_cvt_pk_bf16_f32 v186,v116,v117
v_cvt_pk_bf16_f32 v187,v118,v119
v_mfma_f32_32x32x16_bf16 v[72:87],v[24:27],a[224:227],v[72:87]
buffer_store_dwordx4 v[184:187],v21,s[8:11],s74 offen offset:2048 sc1
s_lshl_b32 s82,s72,6
s_add_u32 s82,s82,s73
s_lshl_b32 s82,s82,9
s_add_u32 s82,s82,s71
v_mfma_f32_32x32x16_bf16 v[56:71],v[28:31],a[68:71],v[56:71]
ds_read_b128 v[48:51],v16 offset:22528
buffer_load_dwordx4 v1,s[8:11],s63 offen sc1 lds
s_lshl_b32 s75,s69,2
s_add_u32 s82,s82,s75
v_mfma_f32_32x32x16_bf16 v[72:87],v[28:31],a[228:231],v[72:87]
s_add_u32 s82,s82,s39
v_add_f32 v156,v156,v166
v_add_f32 v157,v157,v167
v_add_f32 v158,v158,v168
s_waitcnt lgkmcnt(3)
v_mfma_f32_32x32x16_bf16 v[56:71],v[32:35],a[72:75],v[56:71]
ds_read_b128 v[52:55],v17 offset:22528
v_add_f32 v159,v159,v169
v_add_f32 v160,v160,v170
v_add_f32 v161,v161,v171
v_add_f32 v162,v162,v172
v_mfma_f32_32x32x16_bf16 v[72:87],v[32:35],a[232:235],v[72:87]
buffer_load_dwordx4 v1,s[8:11],s63 offen offset:1024 sc1 lds
s_mov_b32 s53,s33
s_mov_b32 s54,s34
s_cmp_eq_u32 s37,0
s_addc_u32 s32,s32,0
v_mfma_f32_32x32x16_bf16 v[56:71],v[36:39],a[76:79],v[56:71]
ds_read_b128 v[24:27],v16 offset:24576
s_min_u32 s62,s32,127
s_sub_u32 s60,s62,20
s_lshr_b32 s34,s60,1
s_and_b32 s33,s60,1
v_mfma_f32_32x32x16_bf16 v[72:87],v[36:39],a[236:239],v[72:87]
s_xor_b32 s33,s33,1
s_cmp_eq_u32 s33,0
s_cselect_b32 s61,20,0
s_add_u32 s34,s34,s61
s_sub_u32 s61,s60,44
s_waitcnt lgkmcnt(3)
v_mfma_f32_32x32x16_bf16 v[56:71],v[40:43],a[80:83],v[56:71]
ds_read_b128 v[28:31],v17 offset:24576
s_cmp_ge_u32 s60,88
s_cselect_b32 s34,s61,s34
s_cselect_b32 s33,1,s33
v_add_f32 v163,v163,v173
v_mfma_f32_32x32x16_bf16 v[72:87],v[40:43],a[240:243],v[72:87]
s_cmp_lt_u32 s62,20
s_cselect_b32 s34,s62,s34
s_cselect_b32 s33,0,s33
s_lshl_b32 s35,s33,6
s_add_u32 s35,s35,s34
s_lshl_b32 s35,s35,9
v_mfma_f32_32x32x16_bf16 v[56:71],v[44:47],a[84:87],v[56:71]
ds_read_b128 v[32:35],v16 offset:26624
s_add_u32 s35,s35,0
s_lshl_b32 s60,s33,5
s_add_u32 s60,s60,7
v_min_u32 v2,s60,v0
v_mfma_f32_32x32x16_bf16 v[72:87],v[44:47],a[244:247],v[72:87]
v_lshlrev_b32 v2,2,v2
v_add_f32 v164,v164,v174
v_add_f32 v165,v165,v175
v_add_f32 v156,v156,v158
v_add_f32 v157,v157,v159
s_waitcnt lgkmcnt(3)
v_mfma_f32_32x32x16_bf16 v[56:71],v[48:51],a[88:91],v[56:71]
ds_read_b128 v[36:39],v17 offset:26624
s_cmp_lg_u32 s46,0
s_cbranch_scc1 w0_254
buffer_load_dword v3,v2,s[8:11],s35 offen sc1
w0_254:
v_mfma_f32_32x32x16_bf16 v[72:87],v[48:51],a[248:251],v[72:87]
v_add_f32 v160,v160,v162
v_add_f32 v161,v161,v163
v_add_f32 v156,v156,v160
v_add_f32 v157,v157,v161
v_add_f32 v156,v156,v164
v_mfma_f32_32x32x16_bf16 v[56:71],v[52:55],a[92:95],v[56:71]
ds_read_b128 v[40:43],v16 offset:28672
v_add_f32 v157,v157,v165
v_mov_b32 v158,v156
v_mov_b32 v159,v157
s_nop 0
v_permlane32_swap_b32 v156,v158
v_mfma_f32_32x32x16_bf16 v[72:87],v[52:55],a[252:255],v[72:87]
v_permlane32_swap_b32 v157,v159
v_add_f32 v176,v156,v158
v_add_f32 v177,v157,v159
v_mul_f32 v176,0x3acccccd,v176
v_mul_f32 v177,0x3acccccd,v177
s_waitcnt lgkmcnt(3)
v_mfma_f32_32x32x16_bf16 v[56:71],v[24:27],a[96:99],v[56:71]
ds_read_b128 v[44:47],v17 offset:28672
v_fma_f32 v177,-v176,v176,v177
v_max_f32 v177,0,v177
v_cvt_pk_bf16_f32 v8,v176,v177
v_lshlrev_b32 v176,16,v8
v_mfma_f32_32x32x16_bf16 v[72:87],v[24:27],v[192:195],v[72:87]
v_and_b32 v177,0xffff0000,v8
v_add_f32 v177,0x3727c5ac,v177
v_cvt_pk_bf16_f32 v8,v177,v177
v_lshlrev_b32 v177,16,v8
v_sqrt_f32 v177,v177
v_mfma_f32_32x32x16_bf16 v[56:71],v[28:31],a[100:103],v[56:71]
ds_read_b128 v[48:51],v16 offset:30720
v_cvt_pk_bf16_f32 v8,v177,v177
v_lshlrev_b32 v177,16,v8
v_rcp_f32 v177,v177
v_mfma_f32_32x32x16_bf16 v[72:87],v[28:31],v[196:199],v[72:87]
s_cmp_eq_u32 s51,0
s_cselect_b64 s[76:77],-1,0
v_cndmask_b32 v176,v176,0,s[76:77]
v_cndmask_b32 v177,v177,1.0,s[76:77]
s_mov_b32 s72,s51
s_waitcnt lgkmcnt(3)
v_mfma_f32_32x32x16_bf16 v[56:71],v[32:35],a[104:107],v[56:71]
ds_read_b128 v[52:55],v17 offset:30720
s_mov_b32 s73,s52
ds_write_b64 v190,v[176:177]
v_mfma_f32_32x32x16_bf16 v[72:87],v[32:35],v[200:203],v[72:87]
ds_read_b128 v[124:127],v191 offset:0
ds_read_b128 v[128:131],v191 offset:16
ds_read_b128 v[132:135],v191 offset:64
v_mfma_f32_32x32x16_bf16 v[56:71],v[36:39],a[108:111],v[56:71]
ds_read_b128 v[24:27],v16 offset:32768
ds_read_b128 v[136:139],v191 offset:80
ds_read_b128 v[140:143],v191 offset:128
v_mfma_f32_32x32x16_bf16 v[72:87],v[36:39],v[204:207],v[72:87]
ds_read_b128 v[144:147],v191 offset:144
ds_read_b128 v[148:151],v191 offset:192
s_waitcnt lgkmcnt(11)
v_mfma_f32_32x32x16_bf16 v[56:71],v[40:43],a[112:115],v[56:71]
ds_read_b128 v[28:31],v17 offset:32768
ds_read_b128 v[152:155],v191 offset:208
v_mfma_f32_32x32x16_bf16 v[72:87],v[40:43],v[208:211],v[72:87]
v_mfma_f32_32x32x16_bf16 v[56:71],v[44:47],a[116:119],v[56:71]
ds_read_b128 v[32:35],v16 offset:34816
v_mfma_f32_32x32x16_bf16 v[72:87],v[44:47],v[212:215],v[72:87]
s_waitcnt lgkmcnt(12)
v_mfma_f32_32x32x16_bf16 v[56:71],v[48:51],a[120:123],v[56:71]
ds_read_b128 v[36:39],v17 offset:34816
v_mfma_f32_32x32x16_bf16 v[72:87],v[48:51],v[216:219],v[72:87]
v_mfma_f32_32x32x16_bf16 v[56:71],v[52:55],a[124:127],v[56:71]
ds_read_b128 v[40:43],v16 offset:36864
v_mfma_f32_32x32x16_bf16 v[72:87],v[52:55],v[220:223],v[72:87]
s_waitcnt vmcnt(0)
s_cmp_lg_u32 s46,0
s_cbranch_scc1 w0_255
v_cmp_eq_u32 vcc,0,v3
s_cmp_eq_u64 vcc,0
s_cselect_b32 s36,0,2147483648
s_cmp_lt_u32 s32,128
s_cselect_b32 s36,s36,2147483648
v_mov_b32 v23,s36
ds_write_b32 v22,v23
w0_255:
s_waitcnt lgkmcnt(4)
v_mfma_f32_32x32x16_bf16 v[56:71],v[24:27],a[128:131],v[56:71]
ds_read_b128 v[44:47],v17 offset:36864
s_mov_b64 exec,1
buffer_store_dword v5,v1,s[8:11],s82 offen sc1
s_mov_b64 exec,-1
s_mov_b32 s82,2147483648
v_mfma_f32_32x32x16_bf16 v[72:87],v[24:27],v[224:227],v[72:87]
v_mfma_f32_32x32x16_bf16 v[56:71],v[28:31],a[132:135],v[56:71]
ds_read_b128 v[48:51],v16 offset:38912
v_mfma_f32_32x32x16_bf16 v[72:87],v[28:31],v[228:231],v[72:87]
s_waitcnt lgkmcnt(3)
v_mfma_f32_32x32x16_bf16 v[56:71],v[32:35],a[136:139],v[56:71]
ds_read_b128 v[52:55],v17 offset:38912
v_mfma_f32_32x32x16_bf16 v[72:87],v[32:35],v[232:235],v[72:87]
s_waitcnt lgkmcnt(2)
s_barrier
ds_read_b32 v23,v22
v_mfma_f32_32x32x16_bf16 v[56:71],v[36:39],a[140:143],v[56:71]
ds_read_b128 v[24:27],v18 offset:0
v_mfma_f32_32x32x16_bf16 v[72:87],v[36:39],v[236:239],v[72:87]
v_mfma_f32_32x32x16_bf16 v[56:71],v[40:43],a[144:147],v[56:71]
ds_read_b128 v[28:31],v19 offset:0
v_mfma_f32_32x32x16_bf16 v[72:87],v[40:43],v[240:243],v[72:87]
v_mfma_f32_32x32x16_bf16 v[56:71],v[44:47],a[148:151],v[56:71]
ds_read_b128 v[32:35],v18 offset:2048
v_mfma_f32_32x32x16_bf16 v[72:87],v[44:47],v[244:247],v[72:87]
s_waitcnt lgkmcnt(4)
v_mfma_f32_32x32x16_bf16 v[56:71],v[48:51],a[152:155],v[56:71]
ds_read_b128 v[36:39],v19 offset:2048
s_waitcnt lgkmcnt(4)
v_readfirstlane_b32 s38,v23
v_mfma_f32_32x32x16_bf16 v[72:87],v[48:51],v[248:251],v[72:87]
v_mfma_f32_32x32x16_bf16 v[56:71],v[52:55],a[156:159],v[56:71]
ds_read_b128 v[40:43],v18 offset:4096
v_mfma_f32_32x32x16_bf16 v[72:87],v[52:55],v[252:255],v[72:87]
s_cmp_lg_u32 s37,0
s_cbranch_scc1 nf_256
s_cmp_lt_u32 s50,2
s_cbranch_scc1 now_257
s_mov_b32 s39,0
s_add_u32 s50,s50,1
s_sub_u32 s57,46080,s57
s_mov_b32 s51,s53
s_mov_b32 s52,s54
s_mov_b32 s37,s38
s_branch QKVV_B1
s_nop 0
now_257:
s_mov_b32 s55,0
s_branch nt_258
nf_256:
s_mov_b32 s55,2
s_cmp_lg_u32 s38,0
s_cbranch_scc1 nt_258
s_mov_b32 s55,1
s_mov_b32 s37,0
s_sub_u32 s66,46080,s57
s_lshl_b32 s60,s33,6
s_add_u32 s60,s60,s34
s_mul_i32 s60,s60,46080
s_add_u32 s60,s60,s37
s_add_u32 s60,s60,206569472
s_lshl_b32 s62,s46,10
s_add_u32 s62,s62,40960
s_add_u32 m0,s66,s62
s_add_u32 s63,s60,s62
buffer_load_dwordx4 v1,s[8:11],s63 offen sc1 lds
s_add_u32 m0,s66,45056
s_add_u32 s63,s60,45056
buffer_load_dwordx4 v1,s[8:11],s63 offen sc1 lds
s_mul_i32 s61,s46,10240
s_add_u32 s60,s60,s61
s_add_u32 s61,s61,s66
s_add_u32 m0,s61,0
s_add_u32 s63,s60,0
buffer_load_dwordx4 v1,s[8:11],s63 offen sc1 lds
buffer_load_dwordx4 v1,s[8:11],s63 offen offset:1024 sc1 lds
buffer_load_dwordx4 v1,s[8:11],s63 offen offset:2048 sc1 lds
buffer_load_dwordx4 v1,s[8:11],s63 offen offset:3072 sc1 lds
s_add_u32 m0,s61,4096
s_add_u32 s63,s60,4096
buffer_load_dwordx4 v1,s[8:11],s63 offen sc1 lds
buffer_load_dwordx4 v1,s[8:11],s63 offen offset:1024 sc1 lds
buffer_load_dwordx4 v1,s[8:11],s63 offen offset:2048 sc1 lds
buffer_load_dwordx4 v1,s[8:11],s63 offen offset:3072 sc1 lds
s_add_u32 m0,s61,8192
s_add_u32 s63,s60,8192
buffer_load_dwordx4 v1,s[8:11],s63 offen sc1 lds
buffer_load_dwordx4 v1,s[8:11],s63 offen offset:1024 sc1 lds
nt_258:
s_mov_b32 s39,0
s_mul_i32 s74,s73,393216
s_add_u32 s74,s74,s39
s_add_u32 s74,s74,s70
v_fma_f32 v56,-v124,v120,v56
v_fma_f32 v57,-v126,v120,v57
v_fma_f32 v58,-v128,v120,v58
v_fma_f32 v59,-v130,v120,v59
v_fma_f32 v64,-v140,v120,v64
v_fma_f32 v65,-v142,v120,v65
v_fma_f32 v66,-v144,v120,v66
v_fma_f32 v67,-v146,v120,v67
v_mul_f32 v56,v56,v125
v_mul_f32 v57,v57,v127
v_mul_f32 v58,v58,v129
v_mul_f32 v59,v59,v131
v_mul_f32 v64,v64,v141
v_mul_f32 v65,v65,v143
v_mul_f32 v66,v66,v145
v_mul_f32 v67,v67,v147
v_cvt_pk_bf16_f32 v180,v56,v57
v_cvt_pk_bf16_f32 v181,v58,v59
v_cvt_pk_bf16_f32 v182,v64,v65
v_cvt_pk_bf16_f32 v183,v66,v67
buffer_store_dwordx4 v[180:183],v20,s[8:11],s74 offen sc1
v_fma_f32 v60,-v132,v120,v60
v_fma_f32 v61,-v134,v120,v61
v_fma_f32 v62,-v136,v120,v62
v_fma_f32 v63,-v138,v120,v63
v_fma_f32 v68,-v148,v120,v68
v_fma_f32 v69,-v150,v120,v69
v_fma_f32 v70,-v152,v120,v70
v_fma_f32 v71,-v154,v120,v71
v_mul_f32 v60,v60,v133
v_mul_f32 v61,v61,v135
v_mul_f32 v62,v62,v137
v_mul_f32 v63,v63,v139
v_mul_f32 v68,v68,v149
v_mul_f32 v69,v69,v151
v_mul_f32 v70,v70,v153
v_mul_f32 v71,v71,v155
v_cvt_pk_bf16_f32 v184,v60,v61
v_cvt_pk_bf16_f32 v185,v62,v63
v_cvt_pk_bf16_f32 v186,v68,v69
v_cvt_pk_bf16_f32 v187,v70,v71
buffer_store_dwordx4 v[184:187],v21,s[8:11],s74 offen sc1
v_fma_f32 v72,-v124,v121,v72
v_fma_f32 v73,-v126,v121,v73
v_fma_f32 v74,-v128,v121,v74
v_fma_f32 v75,-v130,v121,v75
v_fma_f32 v80,-v140,v121,v80
v_fma_f32 v81,-v142,v121,v81
v_fma_f32 v82,-v144,v121,v82
v_fma_f32 v83,-v146,v121,v83
v_mul_f32 v72,v72,v125
v_mul_f32 v73,v73,v127
v_mul_f32 v74,v74,v129
v_mul_f32 v75,v75,v131
v_mul_f32 v80,v80,v141
v_mul_f32 v81,v81,v143
v_mul_f32 v82,v82,v145
v_mul_f32 v83,v83,v147
v_cvt_pk_bf16_f32 v180,v72,v73
v_cvt_pk_bf16_f32 v181,v74,v75
v_cvt_pk_bf16_f32 v182,v80,v81
v_cvt_pk_bf16_f32 v183,v82,v83
buffer_store_dwordx4 v[180:183],v20,s[8:11],s74 offen offset:2048 sc1
v_fma_f32 v76,-v132,v121,v76
v_fma_f32 v77,-v134,v121,v77
v_fma_f32 v78,-v136,v121,v78
v_fma_f32 v79,-v138,v121,v79
v_fma_f32 v84,-v148,v121,v84
v_fma_f32 v85,-v150,v121,v85
v_fma_f32 v86,-v152,v121,v86
v_fma_f32 v87,-v154,v121,v87
v_mul_f32 v76,v76,v133
v_mul_f32 v77,v77,v135
v_mul_f32 v78,v78,v137
v_mul_f32 v79,v79,v139
v_mul_f32 v84,v84,v149
v_mul_f32 v85,v85,v151
v_mul_f32 v86,v86,v153
v_mul_f32 v87,v87,v155
v_cvt_pk_bf16_f32 v184,v76,v77
v_cvt_pk_bf16_f32 v185,v78,v79
v_cvt_pk_bf16_f32 v186,v84,v85
v_cvt_pk_bf16_f32 v187,v86,v87
buffer_store_dwordx4 v[184:187],v21,s[8:11],s74 offen offset:2048 sc1
s_lshl_b32 s82,s72,6
s_add_u32 s82,s82,s73
s_lshl_b32 s82,s82,9
s_add_u32 s82,s82,s71
s_lshl_b32 s75,s69,2
s_add_u32 s82,s82,s75
s_add_u32 s82,s82,s39
s_mov_b32 s59,s82
s_mov_b32 s82,2147483648
s_mov_b32 s39,2147483648
s_add_u32 s50,s50,1
s_sub_u32 s57,46080,s57
s_mov_b32 s51,s53
s_mov_b32 s52,s54
s_mov_b32 s37,s38
s_cmp_eq_u32 s55,0
s_cbranch_scc1 QKVV_B1
s_cmp_eq_u32 s55,1
s_cbranch_scc1 QKVV_CD1
s_waitcnt vmcnt(0)
s_mov_b64 exec,1
buffer_store_dword v5,v1,s[8:11],s59 offen sc1
s_mov_b64 exec,-1
s_mov_b32 s59,2147483648
s_cmp_eq_u32 s50,128
s_cbranch_scc1 QKVV_END
s_branch QKVV_COLD1
QKVV_COLD1:
s_cmp_lg_u32 s46,0
s_cbranch_scc1 cp_259
fb_260:
buffer_load_dword v3,v2,s[8:11],s35 offen sc1
s_waitcnt vmcnt(0)
v_cmp_eq_u32 vcc,0,v3
s_nop 0
s_cbranch_vccz ok_261
s_sleep 7
s_sub_u32 s47,s47,1
s_cbranch_scc1 ABORT
s_branch fb_260
ok_261:
cp_259:
s_barrier
s_lshl_b32 s60,s33,6
s_add_u32 s60,s60,s34
s_mul_i32 s60,s60,46080
s_add_u32 s60,s60,206569472
s_lshl_b32 s62,s46,10
s_add_u32 s62,s62,40960
s_add_u32 m0,s57,s62
s_add_u32 s63,s60,s62
buffer_load_dwordx4 v1,s[8:11],s63 offen sc1 lds
s_add_u32 m0,s57,45056
s_add_u32 s63,s60,45056
buffer_load_dwordx4 v1,s[8:11],s63 offen sc1 lds
s_mul_i32 s61,s46,10240
s_add_u32 s60,s60,s61
s_add_u32 s61,s61,s57
s_add_u32 m0,s61,0
s_add_u32 s63,s60,0
buffer_load_dwordx4 v1,s[8:11],s63 offen sc1 lds
buffer_load_dwordx4 v1,s[8:11],s63 offen offset:1024 sc1 lds
buffer_load_dwordx4 v1,s[8:11],s63 offen offset:2048 sc1 lds
buffer_load_dwordx4 v1,s[8:11],s63 offen offset:3072 sc1 lds
s_add_u32 m0,s61,4096
s_add_u32 s63,s60,4096
buffer_load_dwordx4 v1,s[8:11],s63 offen sc1 lds
buffer_load_dwordx4 v1,s[8:11],s63 offen offset:1024 sc1 lds
buffer_load_dwordx4 v1,s[8:11],s63 offen offset:2048 sc1 lds
buffer_load_dwordx4 v1,s[8:11],s63 offen offset:3072 sc1 lds
s_add_u32 m0,s61,8192
s_add_u32 s63,s60,8192
buffer_load_dwordx4 v1,s[8:11],s63 offen sc1 lds
buffer_load_dwordx4 v1,s[8:11],s63 offen offset:1024 sc1 lds
QKVV_CD1:
s_mov_b32 s51,s33
s_mov_b32 s52,s34
s_add_u32 s32,s32,1
s_min_u32 s62,s32,127
s_sub_u32 s60,s62,20
s_lshr_b32 s34,s60,1
s_and_b32 s33,s60,1
s_xor_b32 s33,s33,1
s_cmp_eq_u32 s33,0
s_cselect_b32 s61,20,0
s_add_u32 s34,s34,s61
s_sub_u32 s61,s60,44
s_cmp_ge_u32 s60,88
s_cselect_b32 s34,s61,s34
s_cselect_b32 s33,1,s33
s_cmp_lt_u32 s62,20
s_cselect_b32 s34,s62,s34
s_cselect_b32 s33,0,s33
s_lshl_b32 s35,s33,6
s_add_u32 s35,s35,s34
s_lshl_b32 s35,s35,9
s_add_u32 s35,s35,0
s_lshl_b32 s60,s33,5
s_add_u32 s60,s60,7
v_min_u32 v2,s60,v0
v_lshlrev_b32 v2,2,v2
s_cmp_lg_u32 s46,0
s_cbranch_scc1 w0_262
buffer_load_dword v3,v2,s[8:11],s35 offen sc1
w0_262:
s_waitcnt vmcnt(0)
s_mov_b64 exec,1
buffer_store_dword v5,v1,s[8:11],s59 offen sc1
s_mov_b64 exec,-1
s_mov_b32 s59,2147483648
s_cmp_lg_u32 s46,0
s_cbranch_scc1 w0_263
v_cmp_eq_u32 vcc,0,v3
s_cmp_eq_u64 vcc,0
s_cselect_b32 s36,0,2147483648
s_cmp_lt_u32 s32,128
s_cselect_b32 s36,s36,2147483648
v_mov_b32 v23,s36
ds_write_b32 v22,v23
w0_263:
s_waitcnt lgkmcnt(0)
s_barrier
ds_read_b32 v23,v22
ds_read_b128 v[24:27],v18 offset:0
ds_read_b128 v[28:31],v19 offset:0
ds_read_b128 v[32:35],v18 offset:2048
ds_read_b128 v[36:39],v19 offset:2048
ds_read_b128 v[40:43],v18 offset:4096
s_waitcnt lgkmcnt(5)
v_readfirstlane_b32 s37,v23
s_nop 4
QKVV_B1:
s_waitcnt lgkmcnt(3)
v_mfma_f32_32x32x16_bf16 v[88:103],v[24:27],a[0:3],0
ds_read_b128 v[44:47],v19 offset:4096
v_add_u32 v189,s57,v188
v_mfma_f32_32x32x16_bf16 v[104:119],v[24:27],a[160:163],0
v_add_u32 v8,0x800,v189
s_sub_u32 s66,46080,s57
s_lshl_b32 s60,s33,6
s_add_u32 s60,s60,s34
s_mul_i32 s60,s60,46080
s_add_u32 s60,s60,s37
v_mfma_f32_32x32x16_bf16 v[88:103],v[28:31],a[4:7],v[88:103]
ds_read_b128 v[48:51],v18 offset:6144
ds_read2_b64 v[156:159],v189 offset0:0 offset1:32
s_add_u32 s60,s60,206569472
s_lshl_b32 s62,s46,10
v_mfma_f32_32x32x16_bf16 v[104:119],v[28:31],a[164:167],v[104:119]
ds_read2_b64 v[160:163],v189 offset0:64 offset1:96
s_add_u32 s62,s62,40960
s_add_u32 m0,s66,s62
s_add_u32 s63,s60,s62
s_waitcnt lgkmcnt(5)
v_mfma_f32_32x32x16_bf16 v[88:103],v[32:35],a[8:11],v[88:103]
ds_read_b128 v[52:55],v19 offset:6144
ds_read2_b64 v[164:167],v189 offset0:128 offset1:160
buffer_load_dwordx4 v1,s[8:11],s63 offen sc1 lds
v_mfma_f32_32x32x16_bf16 v[104:119],v[32:35],a[168:171],v[104:119]
ds_read2_b64 v[168:171],v189 offset0:192 offset1:224
s_add_u32 m0,s66,45056
s_add_u32 s63,s60,45056
s_mul_i32 s74,s73,393216
s_add_u32 s74,s74,s39
v_mfma_f32_32x32x16_bf16 v[88:103],v[36:39],a[12:15],v[88:103]
ds_read_b128 v[24:27],v18 offset:8192
ds_read2_b64 v[172:175],v8 offset0:0 offset1:32
s_add_u32 s74,s74,s70
v_fma_f32 v56,-v124,v120,v56
v_mfma_f32_32x32x16_bf16 v[104:119],v[36:39],a[172:175],v[104:119]
buffer_load_dwordx4 v1,s[8:11],s63 offen sc1 lds
s_mul_i32 s61,s46,10240
s_add_u32 s60,s60,s61
s_add_u32 s61,s61,s66
s_waitcnt lgkmcnt(8)
v_mfma_f32_32x32x16_bf16 v[88:103],v[40:43],a[16:19],v[88:103]
ds_read_b128 v[28:31],v19 offset:8192
s_add_u32 m0,s61,0
s_add_u32 s63,s60,0
v_fma_f32 v57,-v126,v120,v57
v_fma_f32 v58,-v128,v120,v58
v_mfma_f32_32x32x16_bf16 v[104:119],v[40:43],a[176:179],v[104:119]
v_fma_f32 v59,-v130,v120,v59
v_fma_f32 v64,-v140,v120,v64
v_fma_f32 v65,-v142,v120,v65
v_fma_f32 v66,-v144,v120,v66
v_fma_f32 v67,-v146,v120,v67
v_mfma_f32_32x32x16_bf16 v[88:103],v[44:47],a[20:23],v[88:103]
ds_read_b128 v[32:35],v18 offset:10240
buffer_load_dwordx4 v1,s[8:11],s63 offen sc1 lds
v_mul_f32 v56,v56,v125
v_mul_f32 v57,v57,v127
v_mfma_f32_32x32x16_bf16 v[104:119],v[44:47],a[180:183],v[104:119]
v_mul_f32 v58,v58,v129
v_mul_f32 v59,v59,v131
v_mul_f32 v64,v64,v141
v_mul_f32 v65,v65,v143
v_mul_f32 v66,v66,v145
s_waitcnt lgkmcnt(6)
v_mfma_f32_32x32x16_bf16 v[88:103],v[48:51],a[24:27],v[88:103]
ds_read_b128 v[36:39],v19 offset:10240
v_mul_f32 v67,v67,v147
v_cvt_pk_bf16_f32 v180,v56,v57
v_cvt_pk_bf16_f32 v181,v58,v59
v_cvt_pk_bf16_f32 v182,v64,v65
v_mfma_f32_32x32x16_bf16 v[104:119],v[48:51],a[184:187],v[104:119]
buffer_load_dwordx4 v1,s[8:11],s63 offen offset:1024 sc1 lds
v_cvt_pk_bf16_f32 v183,v66,v67
buffer_store_dwordx4 v[180:183],v20,s[8:11],s74 offen sc1
v_fma_f32 v60,-v132,v120,v60
v_mfma_f32_32x32x16_bf16 v[88:103],v[52:55],a[28:31],v[88:103]
ds_read_b128 v[40:43],v18 offset:12288
v_fma_f32 v61,-v134,v120,v61
v_fma_f32 v62,-v136,v120,v62
v_fma_f32 v63,-v138,v120,v63
v_fma_f32 v68,-v148,v120,v68
v_mfma_f32_32x32x16_bf16 v[104:119],v[52:55],a[188:191],v[104:119]
v_fma_f32 v69,-v150,v120,v69
v_fma_f32 v70,-v152,v120,v70
v_fma_f32 v71,-v154,v120,v71
v_mul_f32 v60,v60,v133
v_mul_f32 v61,v61,v135
s_waitcnt lgkmcnt(3)
v_mfma_f32_32x32x16_bf16 v[88:103],v[24:27],a[32:35],v[88:103]
ds_read_b128 v[44:47],v19 offset:12288
buffer_load_dwordx4 v1,s[8:11],s63 offen offset:2048 sc1 lds
v_mul_f32 v62,v62,v137
v_mul_f32 v63,v63,v139
v_mfma_f32_32x32x16_bf16 v[104:119],v[24:27],a[192:195],v[104:119]
v_mul_f32 v68,v68,v149
v_mul_f32 v69,v69,v151
v_mul_f32 v70,v70,v153
v_mul_f32 v71,v71,v155
v_cvt_pk_bf16_f32 v184,v60,v61
v_mfma_f32_32x32x16_bf16 v[88:103],v[28:31],a[36:39],v[88:103]
ds_read_b128 v[48:51],v18 offset:14336
v_cvt_pk_bf16_f32 v185,v62,v63
v_cvt_pk_bf16_f32 v186,v68,v69
v_cvt_pk_bf16_f32 v187,v70,v71
v_mfma_f32_32x32x16_bf16 v[104:119],v[28:31],a[196:199],v[104:119]
buffer_load_dwordx4 v1,s[8:11],s63 offen offset:3072 sc1 lds
s_add_u32 m0,s61,4096
s_add_u32 s63,s60,4096
s_waitcnt lgkmcnt(3)
v_mfma_f32_32x32x16_bf16 v[88:103],v[32:35],a[40:43],v[88:103]
ds_read_b128 v[52:55],v19 offset:14336
buffer_store_dwordx4 v[184:187],v21,s[8:11],s74 offen sc1
v_fma_f32 v72,-v124,v121,v72
v_fma_f32 v73,-v126,v121,v73
v_mfma_f32_32x32x16_bf16 v[104:119],v[32:35],a[200:203],v[104:119]
v_fma_f32 v74,-v128,v121,v74
v_fma_f32 v75,-v130,v121,v75
v_fma_f32 v80,-v140,v121,v80
v_fma_f32 v81,-v142,v121,v81
v_fma_f32 v82,-v144,v121,v82
v_mfma_f32_32x32x16_bf16 v[88:103],v[36:39],a[44:47],v[88:103]
ds_read_b128 v[24:27],v18 offset:16384
buffer_load_dwordx4 v1,s[8:11],s63 offen sc1 lds
v_fma_f32 v83,-v146,v121,v83
v_mul_f32 v72,v72,v125
v_mfma_f32_32x32x16_bf16 v[104:119],v[36:39],a[204:207],v[104:119]
v_mul_f32 v73,v73,v127
v_mul_f32 v74,v74,v129
v_mul_f32 v75,v75,v131
v_mul_f32 v80,v80,v141
v_mul_f32 v81,v81,v143
s_waitcnt lgkmcnt(3)
v_mfma_f32_32x32x16_bf16 v[88:103],v[40:43],a[48:51],v[88:103]
ds_read_b128 v[28:31],v19 offset:16384
v_mul_f32 v82,v82,v145
v_mul_f32 v83,v83,v147
v_cvt_pk_bf16_f32 v180,v72,v73
v_cvt_pk_bf16_f32 v181,v74,v75
v_mfma_f32_32x32x16_bf16 v[104:119],v[40:43],a[208:211],v[104:119]
buffer_load_dwordx4 v1,s[8:11],s63 offen offset:1024 sc1 lds
v_cvt_pk_bf16_f32 v182,v80,v81
v_cvt_pk_bf16_f32 v183,v82,v83
buffer_store_dwordx4 v[180:183],v20,s[8:11],s74 offen offset:2048 sc1
v_mfma_f32_32x32x16_bf16 v[88:103],v[44:47],a[52:55],v[88:103]
ds_read_b128 v[32:35],v18 offset:18432
v_fma_f32 v76,-v132,v121,v76
v_fma_f32 v77,-v134,v121,v77
v_fma_f32 v78,-v136,v121,v78
v_fma_f32 v79,-v138,v121,v79
v_mfma_f32_32x32x16_bf16 v[104:119],v[44:47],a[212:215],v[104:119]
v_fma_f32 v84,-v148,v121,v84
v_fma_f32 v85,-v150,v121,v85
v_fma_f32 v86,-v152,v121,v86
v_fma_f32 v87,-v154,v121,v87
v_mul_f32 v76,v76,v133
s_waitcnt lgkmcnt(3)
v_mfma_f32_32x32x16_bf16 v[88:103],v[48:51],a[56:59],v[88:103]
ds_read_b128 v[36:39],v19 offset:18432
buffer_load_dwordx4 v1,s[8:11],s63 offen offset:2048 sc1 lds
v_mul_f32 v77,v77,v135
v_mul_f32 v78,v78,v137
v_mfma_f32_32x32x16_bf16 v[104:119],v[48:51],a[216:219],v[104:119]
v_mul_f32 v79,v79,v139
v_mul_f32 v84,v84,v149
v_mul_f32 v85,v85,v151
v_mul_f32 v86,v86,v153
v_mul_f32 v87,v87,v155
v_mfma_f32_32x32x16_bf16 v[88:103],v[52:55],a[60:63],v[88:103]
ds_read_b128 v[40:43],v18 offset:20480
s_waitcnt vmcnt(12)
s_mov_b64 exec,1
buffer_store_dword v5,v1,s[8:11],s59 offen sc1
s_mov_b64 exec,-1
s_mov_b32 s59,2147483648
v_mfma_f32_32x32x16_bf16 v[104:119],v[52:55],a[220:223],v[104:119]
buffer_load_dwordx4 v1,s[8:11],s63 offen offset:3072 sc1 lds
s_add_u32 m0,s61,8192
s_add_u32 s63,s60,8192
v_cvt_pk_bf16_f32 v184,v76,v77
s_waitcnt lgkmcnt(3)
v_mfma_f32_32x32x16_bf16 v[88:103],v[24:27],a[64:67],v[88:103]
ds_read_b128 v[44:47],v19 offset:20480
v_cvt_pk_bf16_f32 v185,v78,v79
v_cvt_pk_bf16_f32 v186,v84,v85
v_cvt_pk_bf16_f32 v187,v86,v87
v_mfma_f32_32x32x16_bf16 v[104:119],v[24:27],a[224:227],v[104:119]
buffer_store_dwordx4 v[184:187],v21,s[8:11],s74 offen offset:2048 sc1
s_lshl_b32 s82,s72,6
s_add_u32 s82,s82,s73
s_lshl_b32 s82,s82,9
s_add_u32 s82,s82,s71
v_mfma_f32_32x32x16_bf16 v[88:103],v[28:31],a[68:71],v[88:103]
ds_read_b128 v[48:51],v18 offset:22528
buffer_load_dwordx4 v1,s[8:11],s63 offen sc1 lds
s_lshl_b32 s75,s69,2
s_add_u32 s82,s82,s75
v_mfma_f32_32x32x16_bf16 v[104:119],v[28:31],a[228:231],v[104:119]
s_add_u32 s82,s82,s39
v_add_f32 v156,v156,v166
v_add_f32 v157,v157,v167
v_add_f32 v158,v158,v168
s_waitcnt lgkmcnt(3)
v_mfma_f32_32x32x16_bf16 v[88:103],v[32:35],a[72:75],v[88:103]
ds_read_b128 v[52:55],v19 offset:22528
v_add_f32 v159,v159,v169
v_add_f32 v160,v160,v170
v_add_f32 v161,v161,v171
v_add_f32 v162,v162,v172
v_mfma_f32_32x32x16_bf16 v[104:119],v[32:35],a[232:235],v[104:119]
buffer_load_dwordx4 v1,s[8:11],s63 offen offset:1024 sc1 lds
s_mov_b32 s53,s33
s_mov_b32 s54,s34
s_cmp_eq_u32 s37,0
s_addc_u32 s32,s32,0
v_mfma_f32_32x32x16_bf16 v[88:103],v[36:39],a[76:79],v[88:103]
ds_read_b128 v[24:27],v18 offset:24576
s_min_u32 s62,s32,127
s_sub_u32 s60,s62,20
s_lshr_b32 s34,s60,1
s_and_b32 s33,s60,1
v_mfma_f32_32x32x16_bf16 v[104:119],v[36:39],a[236:239],v[104:119]
s_xor_b32 s33,s33,1
s_cmp_eq_u32 s33,0
s_cselect_b32 s61,20,0
s_add_u32 s34,s34,s61
s_sub_u32 s61,s60,44
s_waitcnt lgkmcnt(3)
v_mfma_f32_32x32x16_bf16 v[88:103],v[40:43],a[80:83],v[88:103]
ds_read_b128 v[28:31],v19 offset:24576
s_cmp_ge_u32 s60,88
s_cselect_b32 s34,s61,s34
s_cselect_b32 s33,1,s33
v_add_f32 v163,v163,v173
v_mfma_f32_32x32x16_bf16 v[104:119],v[40:43],a[240:243],v[104:119]
s_cmp_lt_u32 s62,20
s_cselect_b32 s34,s62,s34
s_cselect_b32 s33,0,s33
s_lshl_b32 s35,s33,6
s_add_u32 s35,s35,s34
s_lshl_b32 s35,s35,9
v_mfma_f32_32x32x16_bf16 v[88:103],v[44:47],a[84:87],v[88:103]
ds_read_b128 v[32:35],v18 offset:26624
s_add_u32 s35,s35,0
s_lshl_b32 s60,s33,5
s_add_u32 s60,s60,7
v_min_u32 v2,s60,v0
v_mfma_f32_32x32x16_bf16 v[104:119],v[44:47],a[244:247],v[104:119]
v_lshlrev_b32 v2,2,v2
v_add_f32 v164,v164,v174
v_add_f32 v165,v165,v175
v_add_f32 v156,v156,v158
v_add_f32 v157,v157,v159
s_waitcnt lgkmcnt(3)
v_mfma_f32_32x32x16_bf16 v[88:103],v[48:51],a[88:91],v[88:103]
ds_read_b128 v[36:39],v19 offset:26624
s_cmp_lg_u32 s46,0
s_cbranch_scc1 w0_264
buffer_load_dword v3,v2,s[8:11],s35 offen sc1
w0_264:
v_mfma_f32_32x32x16_bf16 v[104:119],v[48:51],a[248:251],v[104:119]
v_add_f32 v160,v160,v162
v_add_f32 v161,v161,v163
v_add_f32 v156,v156,v160
v_add_f32 v157,v157,v161
v_add_f32 v156,v156,v164
v_mfma_f32_32x32x16_bf16 v[88:103],v[52:55],a[92:95],v[88:103]
ds_read_b128 v[40:43],v18 offset:28672
v_add_f32 v157,v157,v165
v_mov_b32 v158,v156
v_mov_b32 v159,v157
s_nop 0
v_permlane32_swap_b32 v156,v158
v_mfma_f32_32x32x16_bf16 v[104:119],v[52:55],a[252:255],v[104:119]
v_permlane32_swap_b32 v157,v159
v_add_f32 v176,v156,v158
v_add_f32 v177,v157,v159
v_mul_f32 v176,0x3acccccd,v176
v_mul_f32 v177,0x3acccccd,v177
s_waitcnt lgkmcnt(3)
v_mfma_f32_32x32x16_bf16 v[88:103],v[24:27],a[96:99],v[88:103]
ds_read_b128 v[44:47],v19 offset:28672
v_fma_f32 v177,-v176,v176,v177
v_max_f32 v177,0,v177
v_cvt_pk_bf16_f32 v8,v176,v177
v_lshlrev_b32 v176,16,v8
v_mfma_f32_32x32x16_bf16 v[104:119],v[24:27],v[192:195],v[104:119]
v_and_b32 v177,0xffff0000,v8
v_add_f32 v177,0x3727c5ac,v177
v_cvt_pk_bf16_f32 v8,v177,v177
v_lshlrev_b32 v177,16,v8
v_sqrt_f32 v177,v177
v_mfma_f32_32x32x16_bf16 v[88:103],v[28:31],a[100:103],v[88:103]
ds_read_b128 v[48:51],v18 offset:30720
v_cvt_pk_bf16_f32 v8,v177,v177
v_lshlrev_b32 v177,16,v8
v_rcp_f32 v177,v177
v_mfma_f32_32x32x16_bf16 v[104:119],v[28:31],v[196:199],v[104:119]
s_cmp_eq_u32 s51,0
s_cselect_b64 s[76:77],-1,0
v_cndmask_b32 v176,v176,0,s[76:77]
v_cndmask_b32 v177,v177,1.0,s[76:77]
s_mov_b32 s72,s51
s_waitcnt lgkmcnt(3)
v_mfma_f32_32x32x16_bf16 v[88:103],v[32:35],a[104:107],v[88:103]
ds_read_b128 v[52:55],v19 offset:30720
s_mov_b32 s73,s52
ds_write_b64 v190,v[176:177]
v_mfma_f32_32x32x16_bf16 v[104:119],v[32:35],v[200:203],v[104:119]
ds_read_b128 v[124:127],v191 offset:0
ds_read_b128 v[128:131],v191 offset:16
ds_read_b128 v[132:135],v191 offset:64
v_mfma_f32_32x32x16_bf16 v[88:103],v[36:39],a[108:111],v[88:103]
ds_read_b128 v[24:27],v18 offset:32768
ds_read_b128 v[136:139],v191 offset:80
ds_read_b128 v[140:143],v191 offset:128
v_mfma_f32_32x32x16_bf16 v[104:119],v[36:39],v[204:207],v[104:119]
ds_read_b128 v[144:147],v191 offset:144
ds_read_b128 v[148:151],v191 offset:192
s_waitcnt lgkmcnt(11)
v_mfma_f32_32x32x16_bf16 v[88:103],v[40:43],a[112:115],v[88:103]
ds_read_b128 v[28:31],v19 offset:32768
ds_read_b128 v[152:155],v191 offset:208
v_mfma_f32_32x32x16_bf16 v[104:119],v[40:43],v[208:211],v[104:119]
v_mfma_f32_32x32x16_bf16 v[88:103],v[44:47],a[116:119],v[88:103]
ds_read_b128 v[32:35],v18 offset:34816
v_mfma_f32_32x32x16_bf16 v[104:119],v[44:47],v[212:215],v[104:119]
s_waitcnt lgkmcnt(12)
v_mfma_f32_32x32x16_bf16 v[88:103],v[48:51],a[120:123],v[88:103]
ds_read_b128 v[36:39],v19 offset:34816
v_mfma_f32_32x32x16_bf16 v[104:119],v[48:51],v[216:219],v[104:119]
v_mfma_f32_32x32x16_bf16 v[88:103],v[52:55],a[124:127],v[88:103]
ds_read_b128 v[40:43],v18 offset:36864
v_mfma_f32_32x32x16_bf16 v[104:119],v[52:55],v[220:223],v[104:119]
s_waitcnt vmcnt(0)
s_cmp_lg_u32 s46,0
s_cbranch_scc1 w0_265
v_cmp_eq_u32 vcc,0,v3
s_cmp_eq_u64 vcc,0
s_cselect_b32 s36,0,2147483648
s_cmp_lt_u32 s32,128
s_cselect_b32 s36,s36,2147483648
v_mov_b32 v23,s36
ds_write_b32 v22,v23
w0_265:
s_waitcnt lgkmcnt(4)
v_mfma_f32_32x32x16_bf16 v[88:103],v[24:27],a[128:131],v[88:103]
ds_read_b128 v[44:47],v19 offset:36864
s_mov_b64 exec,1
buffer_store_dword v5,v1,s[8:11],s82 offen sc1
s_mov_b64 exec,-1
s_mov_b32 s82,2147483648
v_mfma_f32_32x32x16_bf16 v[104:119],v[24:27],v[224:227],v[104:119]
v_mfma_f32_32x32x16_bf16 v[88:103],v[28:31],a[132:135],v[88:103]
ds_read_b128 v[48:51],v18 offset:38912
v_mfma_f32_32x32x16_bf16 v[104:119],v[28:31],v[228:231],v[104:119]
s_waitcnt lgkmcnt(3)
v_mfma_f32_32x32x16_bf16 v[88:103],v[32:35],a[136:139],v[88:103]
ds_read_b128 v[52:55],v19 offset:38912
v_mfma_f32_32x32x16_bf16 v[104:119],v[32:35],v[232:235],v[104:119]
s_waitcnt lgkmcnt(2)
s_barrier
ds_read_b32 v23,v22
v_mfma_f32_32x32x16_bf16 v[88:103],v[36:39],a[140:143],v[88:103]
ds_read_b128 v[24:27],v16 offset:0
v_mfma_f32_32x32x16_bf16 v[104:119],v[36:39],v[236:239],v[104:119]
v_mfma_f32_32x32x16_bf16 v[88:103],v[40:43],a[144:147],v[88:103]
ds_read_b128 v[28:31],v17 offset:0
v_mfma_f32_32x32x16_bf16 v[104:119],v[40:43],v[240:243],v[104:119]
v_mfma_f32_32x32x16_bf16 v[88:103],v[44:47],a[148:151],v[88:103]
ds_read_b128 v[32:35],v16 offset:2048
v_mfma_f32_32x32x16_bf16 v[104:119],v[44:47],v[244:247],v[104:119]
s_waitcnt lgkmcnt(4)
v_mfma_f32_32x32x16_bf16 v[88:103],v[48:51],a[152:155],v[88:103]
ds_read_b128 v[36:39],v17 offset:2048
s_waitcnt lgkmcnt(4)
v_readfirstlane_b32 s38,v23
v_mfma_f32_32x32x16_bf16 v[104:119],v[48:51],v[248:251],v[104:119]
v_mfma_f32_32x32x16_bf16 v[88:103],v[52:55],a[156:159],v[88:103]
ds_read_b128 v[40:43],v16 offset:4096
v_mfma_f32_32x32x16_bf16 v[104:119],v[52:55],v[252:255],v[104:119]
s_cmp_lg_u32 s37,0
s_cbranch_scc1 nf_266
s_cmp_lt_u32 s50,2
s_cbranch_scc1 now_267
s_mov_b32 s39,0
s_add_u32 s50,s50,1
s_sub_u32 s57,46080,s57
s_mov_b32 s51,s53
s_mov_b32 s52,s54
s_mov_b32 s37,s38
s_branch QKVV_B0
s_nop 0
now_267:
s_mov_b32 s55,0
s_branch nt_268
nf_266:
s_mov_b32 s55,2
s_cmp_lg_u32 s38,0
s_cbranch_scc1 nt_268
s_mov_b32 s55,1
s_mov_b32 s37,0
s_sub_u32 s66,46080,s57
s_lshl_b32 s60,s33,6
s_add_u32 s60,s60,s34
s_mul_i32 s60,s60,46080
s_add_u32 s60,s60,s37
s_add_u32 s60,s60,206569472
s_lshl_b32 s62,s46,10
s_add_u32 s62,s62,40960
s_add_u32 m0,s66,s62
s_add_u32 s63,s60,s62
buffer_load_dwordx4 v1,s[8:11],s63 offen sc1 lds
s_add_u32 m0,s66,45056
s_add_u32 s63,s60,45056
buffer_load_dwordx4 v1,s[8:11],s63 offen sc1 lds
s_mul_i32 s61,s46,10240
s_add_u32 s60,s60,s61
s_add_u32 s61,s61,s66
s_add_u32 m0,s61,0
s_add_u32 s63,s60,0
buffer_load_dwordx4 v1,s[8:11],s63 offen sc1 lds
buffer_load_dwordx4 v1,s[8:11],s63 offen offset:1024 sc1 lds
buffer_load_dwordx4 v1,s[8:11],s63 offen offset:2048 sc1 lds
buffer_load_dwordx4 v1,s[8:11],s63 offen offset:3072 sc1 lds
s_add_u32 m0,s61,4096
s_add_u32 s63,s60,4096
buffer_load_dwordx4 v1,s[8:11],s63 offen sc1 lds
buffer_load_dwordx4 v1,s[8:11],s63 offen offset:1024 sc1 lds
buffer_load_dwordx4 v1,s[8:11],s63 offen offset:2048 sc1 lds
buffer_load_dwordx4 v1,s[8:11],s63 offen offset:3072 sc1 lds
s_add_u32 m0,s61,8192
s_add_u32 s63,s60,8192
buffer_load_dwordx4 v1,s[8:11],s63 offen sc1 lds
buffer_load_dwordx4 v1,s[8:11],s63 offen offset:1024 sc1 lds
nt_268:
s_mov_b32 s39,0
s_mul_i32 s74,s73,393216
s_add_u32 s74,s74,s39
s_add_u32 s74,s74,s70
v_fma_f32 v88,-v124,v120,v88
v_fma_f32 v89,-v126,v120,v89
v_fma_f32 v90,-v128,v120,v90
v_fma_f32 v91,-v130,v120,v91
v_fma_f32 v96,-v140,v120,v96
v_fma_f32 v97,-v142,v120,v97
v_fma_f32 v98,-v144,v120,v98
v_fma_f32 v99,-v146,v120,v99
v_mul_f32 v88,v88,v125
v_mul_f32 v89,v89,v127
v_mul_f32 v90,v90,v129
v_mul_f32 v91,v91,v131
v_mul_f32 v96,v96,v141
v_mul_f32 v97,v97,v143
v_mul_f32 v98,v98,v145
v_mul_f32 v99,v99,v147
v_cvt_pk_bf16_f32 v180,v88,v89
v_cvt_pk_bf16_f32 v181,v90,v91
v_cvt_pk_bf16_f32 v182,v96,v97
v_cvt_pk_bf16_f32 v183,v98,v99
buffer_store_dwordx4 v[180:183],v20,s[8:11],s74 offen sc1
v_fma_f32 v92,-v132,v120,v92
v_fma_f32 v93,-v134,v120,v93
v_fma_f32 v94,-v136,v120,v94
v_fma_f32 v95,-v138,v120,v95
v_fma_f32 v100,-v148,v120,v100
v_fma_f32 v101,-v150,v120,v101
v_fma_f32 v102,-v152,v120,v102
v_fma_f32 v103,-v154,v120,v103
v_mul_f32 v92,v92,v133
v_mul_f32 v93,v93,v135
v_mul_f32 v94,v94,v137
v_mul_f32 v95,v95,v139
v_mul_f32 v100,v100,v149
v_mul_f32 v101,v101,v151
v_mul_f32 v102,v102,v153
v_mul_f32 v103,v103,v155
v_cvt_pk_bf16_f32 v184,v92,v93
v_cvt_pk_bf16_f32 v185,v94,v95
v_cvt_pk_bf16_f32 v186,v100,v101
v_cvt_pk_bf16_f32 v187,v102,v103
buffer_store_dwordx4 v[184:187],v21,s[8:11],s74 offen sc1
v_fma_f32 v104,-v124,v121,v104
v_fma_f32 v105,-v126,v121,v105
v_fma_f32 v106,-v128,v121,v106
v_fma_f32 v107,-v130,v121,v107
v_fma_f32 v112,-v140,v121,v112
v_fma_f32 v113,-v142,v121,v113
v_fma_f32 v114,-v144,v121,v114
v_fma_f32 v115,-v146,v121,v115
v_mul_f32 v104,v104,v125
v_mul_f32 v105,v105,v127
v_mul_f32 v106,v106,v129
v_mul_f32 v107,v107,v131
v_mul_f32 v112,v112,v141
v_mul_f32 v113,v113,v143
v_mul_f32 v114,v114,v145
v_mul_f32 v115,v115,v147
v_cvt_pk_bf16_f32 v180,v104,v105
v_cvt_pk_bf16_f32 v181,v106,v107
v_cvt_pk_bf16_f32 v182,v112,v113
v_cvt_pk_bf16_f32 v183,v114,v115
buffer_store_dwordx4 v[180:183],v20,s[8:11],s74 offen offset:2048 sc1
v_fma_f32 v108,-v132,v121,v108
v_fma_f32 v109,-v134,v121,v109
v_fma_f32 v110,-v136,v121,v110
v_fma_f32 v111,-v138,v121,v111
v_fma_f32 v116,-v148,v121,v116
v_fma_f32 v117,-v150,v121,v117
v_fma_f32 v118,-v152,v121,v118
v_fma_f32 v119,-v154,v121,v119
v_mul_f32 v108,v108,v133
v_mul_f32 v109,v109,v135
v_mul_f32 v110,v110,v137
v_mul_f32 v111,v111,v139
v_mul_f32 v116,v116,v149
v_mul_f32 v117,v117,v151
v_mul_f32 v118,v118,v153
v_mul_f32 v119,v119,v155
v_cvt_pk_bf16_f32 v184,v108,v109
v_cvt_pk_bf16_f32 v185,v110,v111
v_cvt_pk_bf16_f32 v186,v116,v117
v_cvt_pk_bf16_f32 v187,v118,v119
buffer_store_dwordx4 v[184:187],v21,s[8:11],s74 offen offset:2048 sc1
s_lshl_b32 s82,s72,6
s_add_u32 s82,s82,s73
s_lshl_b32 s82,s82,9
s_add_u32 s82,s82,s71
s_lshl_b32 s75,s69,2
s_add_u32 s82,s82,s75
s_add_u32 s82,s82,s39
s_mov_b32 s59,s82
s_mov_b32 s82,2147483648
s_mov_b32 s39,2147483648
s_add_u32 s50,s50,1
s_sub_u32 s57,46080,s57
s_mov_b32 s51,s53
s_mov_b32 s52,s54
s_mov_b32 s37,s38
s_cmp_eq_u32 s55,0
s_cbranch_scc1 QKVV_B0
s_cmp_eq_u32 s55,1
s_cbranch_scc1 QKVV_CD0
s_waitcnt vmcnt(0)
s_mov_b64 exec,1
buffer_store_dword v5,v1,s[8:11],s59 offen sc1
s_mov_b64 exec,-1
s_mov_b32 s59,2147483648
s_cmp_eq_u32 s50,128
s_cbranch_scc1 QKVV_END
s_branch QKVV_COLD0
QKVV_END:
s_endpgm
ROLE_ATT:
v_lshlrev_b32 v1,4,v0
v_mov_b32 v5,1
s_lshl_b32 s56,s48,2
s_add_u32 s56,s56,s46
v_bfe_u32 v6,v0,2,2
v_lshrrev_b32 v7,4,v0
v_add_u32 v7,v6,v7
v_and_b32 v7,3,v7
v_and_b32 v15,3,v0
v_lshlrev_b32 v15,4,v15
v_lshl_add_u32 v15,v7,6,v15
v_lshl_add_u32 v15,v6,8,v15
s_mov_b32 s68,s48
s_and_b32 s51,s46,1
s_lshr_b32 s86,s46,1
s_lshr_b32 s87,s68,3
s_lshl_b32 s87,s87,5
s_and_b32 s60,s68,7
s_add_u32 s87,s87,s60
v_lshlrev_b32 v229,3,v0
v_mov_b32 v230,0xff800000
s_mov_b32 s80,-1
s_mov_b32 s81,0
s_mov_b32 s84,0x3d93cd3a
s_mov_b32 s85,0x3fb8aa3b
v_min_u32 v6,8,v0
v_mul_u32_u24 v7,86,v6
v_lshrrev_b32 v7,8,v7
v_mul_u32_u24 v8,3,v7
v_sub_u32 v6,v6,v8
s_mul_i32 s60,s68,3
v_add_u32 v6,s60,v6
v_lshlrev_b32 v2,2,v6
v_lshl_add_u32 v2,v7,16,v2
v_min_u32 v228,2,v0
v_lshlrev_b32 v228,2,v228
v_lshrrev_b32 v6,4,v0
v_lshlrev_b32 v6,2,v6
v_and_b32 v7,15,v0
v_add_u32 v8,0,v6
v_cmp_le_u32 s[72:73],v8,v7
v_add_u32 v8,1,v6
v_cmp_le_u32 s[74:75],v8,v7
v_add_u32 v8,2,v6
v_cmp_le_u32 s[76:77],v8,v7
v_add_u32 v8,3,v6
v_cmp_le_u32 s[78:79],v8,v7
s_mul_i32 s71,s68,12288
s_mul_i32 s60,s51,13
s_mul_i32 s69,s60,589824
s_mul_i32 s61,s68,18432
s_add_u32 s69,s69,s61
s_mul_i32 s61,s51,9216
s_add_u32 s69,s69,s61
s_add_u32 s69,s69,24120320
s_mul_i32 s70,s60,2048
s_lshl_b32 s61,s68,6
s_add_u32 s70,s70,s61
s_add_u32 s70,s70,688128
s_mul_i32 s69,s51,12582912
s_mul_i32 s61,s68,6144
s_add_u32 s69,s69,s61
s_add_u32 s69,s69,24117248
s_mul_i32 s70,s51,65536
s_lshl_b32 s61,s68,5
s_add_u32 s70,s70,s61
s_add_u32 s70,s70,688128
s_waitcnt vmcnt(0)
s_barrier
s_cmp_lg_u32 s46,0
s_cbranch_scc1 arr_269
v_mov_b32 v6,1
s_lshl_b32 s3,s49,2
v_mov_b32 v7,s3
s_mov_b64 exec,1
buffer_atomic_add v6,v7,s[12:15],0 offen sc1
s_mov_b64 exec,-1
arr_269:
s_mov_b32 s66,s56
s_and_b32 s53,s66,7
s_lshr_b32 s54,s66,3
v_lshrrev_b32 v6,4,v0
v_bfe_u32 v7,v0,2,2
v_and_b32 v8,3,v0
s_and_b32 s61,s53,3
s_lshl_b32 s60,s53,8
v_lshlrev_b32 v132,11,v6
v_lshrrev_b32 v9,1,v6
v_lshlrev_b32 v132,11,v9
v_and_b32 v9,1,v6
v_lshl_add_u32 v132,v9,12,v132
v_add_u32 v9,s61,v7
v_and_b32 v9,3,v9
v_lshl_add_u32 v132,v9,6,v132
v_lshl_add_u32 v132,v8,4,v132
v_add_u32 v132,s60,v132
s_lshl_b32 s60,s53,2
v_add_u32 v9,s60,v8
v_mul_u32_u24 v133,1280,v9
v_lshl_add_u32 v133,v6,5,v133
v_lshl_add_u32 v133,v7,3,v133
s_mov_b32 s4,s16
s_mov_b32 s5,s17
s_mov_b32 s6,2621440
s_mov_b32 s7,0x20000
s_mov_b32 s55,0
s_mul_i32 s62,s54,40960
buffer_load_dwordx2 v[32:33],v133,s[4:7],s62 offen offset:0
buffer_load_dwordx2 v[34:35],v133,s[4:7],s62 offen offset:128
buffer_load_dwordx2 v[36:37],v133,s[4:7],s62 offen offset:256
buffer_load_dwordx2 v[38:39],v133,s[4:7],s62 offen offset:384
buffer_load_dwordx2 v[40:41],v133,s[4:7],s62 offen offset:512
buffer_load_dwordx2 v[42:43],v133,s[4:7],s62 offen offset:640
buffer_load_dwordx2 v[44:45],v133,s[4:7],s62 offen offset:768
buffer_load_dwordx2 v[46:47],v133,s[4:7],s62 offen offset:896
buffer_load_dwordx2 v[48:49],v133,s[4:7],s62 offen offset:1024
buffer_load_dwordx2 v[50:51],v133,s[4:7],s62 offen offset:1152
s_add_u32 s66,s54,16
s_min_u32 s66,s66,63
s_mul_i32 s62,s66,40960
buffer_load_dwordx2 v[52:53],v133,s[4:7],s62 offen offset:0
buffer_load_dwordx2 v[54:55],v133,s[4:7],s62 offen offset:128
buffer_load_dwordx2 v[56:57],v133,s[4:7],s62 offen offset:256
buffer_load_dwordx2 v[58:59],v133,s[4:7],s62 offen offset:384
buffer_load_dwordx2 v[60:61],v133,s[4:7],s62 offen offset:512
buffer_load_dwordx2 v[62:63],v133,s[4:7],s62 offen offset:640
buffer_load_dwordx2 v[64:65],v133,s[4:7],s62 offen offset:768
buffer_load_dwordx2 v[66:67],v133,s[4:7],s62 offen offset:896
buffer_load_dwordx2 v[68:69],v133,s[4:7],s62 offen offset:1024
buffer_load_dwordx2 v[70:71],v133,s[4:7],s62 offen offset:1152
s_mul_i32 s64,s54,40960
s_add_u32 s64,s64,234749952
s_mul_i32 s65,s54,46080
s_add_u32 s65,s65,206569472
s_waitcnt vmcnt(10)
v_lshlrev_b32 v72,16,v32
v_and_b32 v73,0xffff0000,v32
v_lshlrev_b32 v74,16,v33
v_and_b32 v75,0xffff0000,v33
v_lshlrev_b32 v76,16,v34
v_and_b32 v77,0xffff0000,v34
v_lshlrev_b32 v78,16,v35
v_and_b32 v79,0xffff0000,v35
v_lshlrev_b32 v80,16,v36
v_and_b32 v81,0xffff0000,v36
v_lshlrev_b32 v82,16,v37
v_and_b32 v83,0xffff0000,v37
v_lshlrev_b32 v84,16,v38
v_and_b32 v85,0xffff0000,v38
v_lshlrev_b32 v86,16,v39
v_and_b32 v87,0xffff0000,v39
v_lshlrev_b32 v88,16,v40
v_and_b32 v89,0xffff0000,v40
v_lshlrev_b32 v90,16,v41
v_and_b32 v91,0xffff0000,v41
v_lshlrev_b32 v92,16,v42
v_and_b32 v93,0xffff0000,v42
v_lshlrev_b32 v94,16,v43
v_and_b32 v95,0xffff0000,v43
v_lshlrev_b32 v96,16,v44
v_and_b32 v97,0xffff0000,v44
v_lshlrev_b32 v98,16,v45
v_and_b32 v99,0xffff0000,v45
v_lshlrev_b32 v100,16,v46
v_and_b32 v101,0xffff0000,v46
v_lshlrev_b32 v102,16,v47
v_and_b32 v103,0xffff0000,v47
v_lshlrev_b32 v104,16,v48
v_and_b32 v105,0xffff0000,v48
v_lshlrev_b32 v106,16,v49
v_and_b32 v107,0xffff0000,v49
v_lshlrev_b32 v108,16,v50
v_and_b32 v109,0xffff0000,v50
v_lshlrev_b32 v110,16,v51
v_and_b32 v111,0xffff0000,v51
v_pk_add_f32 v[28:29],v[72:73],v[74:75]
v_pk_mul_f32 v[26:27],v[72:73],v[72:73]
v_pk_fma_f32 v[26:27],v[74:75],v[74:75],v[26:27]
v_pk_add_f32 v[28:29],v[28:29],v[76:77]
v_pk_fma_f32 v[26:27],v[76:77],v[76:77],v[26:27]
v_pk_add_f32 v[28:29],v[28:29],v[78:79]
v_pk_fma_f32 v[26:27],v[78:79],v[78:79],v[26:27]
v_pk_add_f32 v[28:29],v[28:29],v[80:81]
v_pk_fma_f32 v[26:27],v[80:81],v[80:81],v[26:27]
v_pk_add_f32 v[28:29],v[28:29],v[82:83]
v_pk_fma_f32 v[26:27],v[82:83],v[82:83],v[26:27]
v_pk_add_f32 v[28:29],v[28:29],v[84:85]
v_pk_fma_f32 v[26:27],v[84:85],v[84:85],v[26:27]
v_pk_add_f32 v[28:29],v[28:29],v[86:87]
v_pk_fma_f32 v[26:27],v[86:87],v[86:87],v[26:27]
v_pk_add_f32 v[28:29],v[28:29],v[88:89]
v_pk_fma_f32 v[26:27],v[88:89],v[88:89],v[26:27]
v_pk_add_f32 v[28:29],v[28:29],v[90:91]
v_pk_fma_f32 v[26:27],v[90:91],v[90:91],v[26:27]
v_pk_add_f32 v[28:29],v[28:29],v[92:93]
v_pk_fma_f32 v[26:27],v[92:93],v[92:93],v[26:27]
v_pk_add_f32 v[28:29],v[28:29],v[94:95]
v_pk_fma_f32 v[26:27],v[94:95],v[94:95],v[26:27]
v_pk_add_f32 v[28:29],v[28:29],v[96:97]
v_pk_fma_f32 v[26:27],v[96:97],v[96:97],v[26:27]
v_pk_add_f32 v[28:29],v[28:29],v[98:99]
v_pk_fma_f32 v[26:27],v[98:99],v[98:99],v[26:27]
v_pk_add_f32 v[28:29],v[28:29],v[100:101]
v_pk_fma_f32 v[26:27],v[100:101],v[100:101],v[26:27]
v_pk_add_f32 v[28:29],v[28:29],v[102:103]
v_pk_fma_f32 v[26:27],v[102:103],v[102:103],v[26:27]
v_pk_add_f32 v[28:29],v[28:29],v[104:105]
v_pk_fma_f32 v[26:27],v[104:105],v[104:105],v[26:27]
v_pk_add_f32 v[28:29],v[28:29],v[106:107]
v_pk_fma_f32 v[26:27],v[106:107],v[106:107],v[26:27]
v_pk_add_f32 v[28:29],v[28:29],v[108:109]
v_pk_fma_f32 v[26:27],v[108:109],v[108:109],v[26:27]
v_pk_add_f32 v[28:29],v[28:29],v[110:111]
v_pk_fma_f32 v[26:27],v[110:111],v[110:111],v[26:27]
v_add_f32 v24,v28,v29
v_add_f32 v25,v26,v27
s_nop 0
v_add_f32_dpp v24,v24,v24 row_ror:4 row_mask:0xf bank_mask:0xf
v_add_f32_dpp v25,v25,v25 row_ror:4 row_mask:0xf bank_mask:0xf
s_nop 0
v_add_f32_dpp v24,v24,v24 row_ror:8 row_mask:0xf bank_mask:0xf
v_add_f32_dpp v25,v25,v25 row_ror:8 row_mask:0xf bank_mask:0xf
v_mov_b32 v26,v24
v_mov_b32 v27,v25
s_nop 0
v_permlane32_swap_b32 v24,v26
v_permlane32_swap_b32 v25,v27
v_add_f32 v24,v24,v26
v_add_f32 v25,v25,v27
v_mov_b32 v26,v24
v_mov_b32 v27,v25
s_nop 0
v_permlane16_swap_b32 v24,v26
v_permlane16_swap_b32 v25,v27
v_add_f32 v24,v24,v26
v_add_f32 v25,v25,v27
v_mul_f32 v24,0x3acccccd,v24
v_mul_f32 v25,0x3acccccd,v25
v_fma_f32 v25,-v24,v24,v25
v_max_f32 v25,0,v25
v_cvt_pk_bf16_f32 v6,v24,v25
v_lshlrev_b32 v24,16,v6
v_and_b32 v25,0xffff0000,v6
v_add_f32 v25,0x3727c5ac,v25
v_cvt_pk_bf16_f32 v6,v25,v25
v_lshlrev_b32 v25,16,v6
v_sqrt_f32 v25,v25
s_nop 0
v_cvt_pk_bf16_f32 v6,v25,v25
v_lshlrev_b32 v25,16,v6
v_rcp_f32 v25,v25
s_nop 0
v_pk_add_f32 v[72:73],v[72:73],v[24:25] op_sel_hi:[1,0] neg_lo:[0,1] neg_hi:[0,1]
v_pk_add_f32 v[74:75],v[74:75],v[24:25] op_sel_hi:[1,0] neg_lo:[0,1] neg_hi:[0,1]
v_pk_add_f32 v[76:77],v[76:77],v[24:25] op_sel_hi:[1,0] neg_lo:[0,1] neg_hi:[0,1]
v_pk_add_f32 v[78:79],v[78:79],v[24:25] op_sel_hi:[1,0] neg_lo:[0,1] neg_hi:[0,1]
v_pk_add_f32 v[80:81],v[80:81],v[24:25] op_sel_hi:[1,0] neg_lo:[0,1] neg_hi:[0,1]
v_pk_add_f32 v[82:83],v[82:83],v[24:25] op_sel_hi:[1,0] neg_lo:[0,1] neg_hi:[0,1]
v_pk_add_f32 v[84:85],v[84:85],v[24:25] op_sel_hi:[1,0] neg_lo:[0,1] neg_hi:[0,1]
v_pk_add_f32 v[86:87],v[86:87],v[24:25] op_sel_hi:[1,0] neg_lo:[0,1] neg_hi:[0,1]
v_pk_add_f32 v[88:89],v[88:89],v[24:25] op_sel_hi:[1,0] neg_lo:[0,1] neg_hi:[0,1]
v_pk_add_f32 v[90:91],v[90:91],v[24:25] op_sel_hi:[1,0] neg_lo:[0,1] neg_hi:[0,1]
v_pk_add_f32 v[92:93],v[92:93],v[24:25] op_sel_hi:[1,0] neg_lo:[0,1] neg_hi:[0,1]
v_pk_add_f32 v[94:95],v[94:95],v[24:25] op_sel_hi:[1,0] neg_lo:[0,1] neg_hi:[0,1]
v_pk_add_f32 v[96:97],v[96:97],v[24:25] op_sel_hi:[1,0] neg_lo:[0,1] neg_hi:[0,1]
v_pk_add_f32 v[98:99],v[98:99],v[24:25] op_sel_hi:[1,0] neg_lo:[0,1] neg_hi:[0,1]
v_pk_add_f32 v[100:101],v[100:101],v[24:25] op_sel_hi:[1,0] neg_lo:[0,1] neg_hi:[0,1]
v_pk_add_f32 v[102:103],v[102:103],v[24:25] op_sel_hi:[1,0] neg_lo:[0,1] neg_hi:[0,1]
v_pk_add_f32 v[104:105],v[104:105],v[24:25] op_sel_hi:[1,0] neg_lo:[0,1] neg_hi:[0,1]
v_pk_add_f32 v[106:107],v[106:107],v[24:25] op_sel_hi:[1,0] neg_lo:[0,1] neg_hi:[0,1]
v_pk_add_f32 v[108:109],v[108:109],v[24:25] op_sel_hi:[1,0] neg_lo:[0,1] neg_hi:[0,1]
v_pk_add_f32 v[110:111],v[110:111],v[24:25] op_sel_hi:[1,0] neg_lo:[0,1] neg_hi:[0,1]
v_cvt_pk_bf16_f32 v6,v72,v73
v_lshlrev_b32 v72,16,v6
v_and_b32 v73,0xffff0000,v6
v_cvt_pk_bf16_f32 v8,v74,v75
v_lshlrev_b32 v74,16,v8
v_and_b32 v75,0xffff0000,v8
v_cvt_pk_bf16_f32 v6,v76,v77
v_lshlrev_b32 v76,16,v6
v_and_b32 v77,0xffff0000,v6
v_cvt_pk_bf16_f32 v8,v78,v79
v_lshlrev_b32 v78,16,v8
v_and_b32 v79,0xffff0000,v8
v_cvt_pk_bf16_f32 v6,v80,v81
v_lshlrev_b32 v80,16,v6
v_and_b32 v81,0xffff0000,v6
v_cvt_pk_bf16_f32 v8,v82,v83
v_lshlrev_b32 v82,16,v8
v_and_b32 v83,0xffff0000,v8
v_cvt_pk_bf16_f32 v6,v84,v85
v_lshlrev_b32 v84,16,v6
v_and_b32 v85,0xffff0000,v6
v_cvt_pk_bf16_f32 v8,v86,v87
v_lshlrev_b32 v86,16,v8
v_and_b32 v87,0xffff0000,v8
v_cvt_pk_bf16_f32 v6,v88,v89
v_lshlrev_b32 v88,16,v6
v_and_b32 v89,0xffff0000,v6
v_cvt_pk_bf16_f32 v8,v90,v91
v_lshlrev_b32 v90,16,v8
v_and_b32 v91,0xffff0000,v8
v_cvt_pk_bf16_f32 v6,v92,v93
v_lshlrev_b32 v92,16,v6
v_and_b32 v93,0xffff0000,v6
v_cvt_pk_bf16_f32 v8,v94,v95
v_lshlrev_b32 v94,16,v8
v_and_b32 v95,0xffff0000,v8
v_cvt_pk_bf16_f32 v6,v96,v97
v_lshlrev_b32 v96,16,v6
v_and_b32 v97,0xffff0000,v6
v_cvt_pk_bf16_f32 v8,v98,v99
v_lshlrev_b32 v98,16,v8
v_and_b32 v99,0xffff0000,v8
v_cvt_pk_bf16_f32 v6,v100,v101
v_lshlrev_b32 v100,16,v6
v_and_b32 v101,0xffff0000,v6
v_cvt_pk_bf16_f32 v8,v102,v103
v_lshlrev_b32 v102,16,v8
v_and_b32 v103,0xffff0000,v8
v_cvt_pk_bf16_f32 v6,v104,v105
v_lshlrev_b32 v104,16,v6
v_and_b32 v105,0xffff0000,v6
v_cvt_pk_bf16_f32 v8,v106,v107
v_lshlrev_b32 v106,16,v8
v_and_b32 v107,0xffff0000,v8
v_cvt_pk_bf16_f32 v6,v108,v109
v_lshlrev_b32 v108,16,v6
v_and_b32 v109,0xffff0000,v6
v_cvt_pk_bf16_f32 v8,v110,v111
v_lshlrev_b32 v110,16,v8
v_and_b32 v111,0xffff0000,v8
v_pk_mul_f32 v[72:73],v[72:73],v[24:25] op_sel:[0,1] op_sel_hi:[1,1]
v_pk_mul_f32 v[74:75],v[74:75],v[24:25] op_sel:[0,1] op_sel_hi:[1,1]
v_pk_mul_f32 v[76:77],v[76:77],v[24:25] op_sel:[0,1] op_sel_hi:[1,1]
v_pk_mul_f32 v[78:79],v[78:79],v[24:25] op_sel:[0,1] op_sel_hi:[1,1]
v_pk_mul_f32 v[80:81],v[80:81],v[24:25] op_sel:[0,1] op_sel_hi:[1,1]
v_pk_mul_f32 v[82:83],v[82:83],v[24:25] op_sel:[0,1] op_sel_hi:[1,1]
v_pk_mul_f32 v[84:85],v[84:85],v[24:25] op_sel:[0,1] op_sel_hi:[1,1]
v_pk_mul_f32 v[86:87],v[86:87],v[24:25] op_sel:[0,1] op_sel_hi:[1,1]
v_pk_mul_f32 v[88:89],v[88:89],v[24:25] op_sel:[0,1] op_sel_hi:[1,1]
v_pk_mul_f32 v[90:91],v[90:91],v[24:25] op_sel:[0,1] op_sel_hi:[1,1]
v_pk_mul_f32 v[92:93],v[92:93],v[24:25] op_sel:[0,1] op_sel_hi:[1,1]
v_pk_mul_f32 v[94:95],v[94:95],v[24:25] op_sel:[0,1] op_sel_hi:[1,1]
v_pk_mul_f32 v[96:97],v[96:97],v[24:25] op_sel:[0,1] op_sel_hi:[1,1]
v_pk_mul_f32 v[98:99],v[98:99],v[24:25] op_sel:[0,1] op_sel_hi:[1,1]
v_pk_mul_f32 v[100:101],v[100:101],v[24:25] op_sel:[0,1] op_sel_hi:[1,1]
v_pk_mul_f32 v[102:103],v[102:103],v[24:25] op_sel:[0,1] op_sel_hi:[1,1]
v_pk_mul_f32 v[104:105],v[104:105],v[24:25] op_sel:[0,1] op_sel_hi:[1,1]
v_pk_mul_f32 v[106:107],v[106:107],v[24:25] op_sel:[0,1] op_sel_hi:[1,1]
v_pk_mul_f32 v[108:109],v[108:109],v[24:25] op_sel:[0,1] op_sel_hi:[1,1]
v_pk_mul_f32 v[110:111],v[110:111],v[24:25] op_sel:[0,1] op_sel_hi:[1,1]
v_cvt_pk_bf16_f32 v112,v72,v73
v_lshlrev_b32 v72,16,v112
v_and_b32 v73,0xffff0000,v112
v_cvt_pk_bf16_f32 v113,v74,v75
v_lshlrev_b32 v74,16,v113
v_and_b32 v75,0xffff0000,v113
v_cvt_pk_bf16_f32 v114,v76,v77
v_lshlrev_b32 v76,16,v114
v_and_b32 v77,0xffff0000,v114
v_cvt_pk_bf16_f32 v115,v78,v79
v_lshlrev_b32 v78,16,v115
v_and_b32 v79,0xffff0000,v115
v_cvt_pk_bf16_f32 v116,v80,v81
v_lshlrev_b32 v80,16,v116
v_and_b32 v81,0xffff0000,v116
v_cvt_pk_bf16_f32 v117,v82,v83
v_lshlrev_b32 v82,16,v117
v_and_b32 v83,0xffff0000,v117
v_cvt_pk_bf16_f32 v118,v84,v85
v_lshlrev_b32 v84,16,v118
v_and_b32 v85,0xffff0000,v118
v_cvt_pk_bf16_f32 v119,v86,v87
v_lshlrev_b32 v86,16,v119
v_and_b32 v87,0xffff0000,v119
v_cvt_pk_bf16_f32 v120,v88,v89
v_lshlrev_b32 v88,16,v120
v_and_b32 v89,0xffff0000,v120
v_cvt_pk_bf16_f32 v121,v90,v91
v_lshlrev_b32 v90,16,v121
v_and_b32 v91,0xffff0000,v121
v_cvt_pk_bf16_f32 v122,v92,v93
v_lshlrev_b32 v92,16,v122
v_and_b32 v93,0xffff0000,v122
v_cvt_pk_bf16_f32 v123,v94,v95
v_lshlrev_b32 v94,16,v123
v_and_b32 v95,0xffff0000,v123
v_cvt_pk_bf16_f32 v124,v96,v97
v_lshlrev_b32 v96,16,v124
v_and_b32 v97,0xffff0000,v124
v_cvt_pk_bf16_f32 v125,v98,v99
v_lshlrev_b32 v98,16,v125
v_and_b32 v99,0xffff0000,v125
v_cvt_pk_bf16_f32 v126,v100,v101
v_lshlrev_b32 v100,16,v126
v_and_b32 v101,0xffff0000,v126
v_cvt_pk_bf16_f32 v127,v102,v103
v_lshlrev_b32 v102,16,v127
v_and_b32 v103,0xffff0000,v127
v_cvt_pk_bf16_f32 v128,v104,v105
v_lshlrev_b32 v104,16,v128
v_and_b32 v105,0xffff0000,v128
v_cvt_pk_bf16_f32 v129,v106,v107
v_lshlrev_b32 v106,16,v129
v_and_b32 v107,0xffff0000,v129
v_cvt_pk_bf16_f32 v130,v108,v109
v_lshlrev_b32 v108,16,v130
v_and_b32 v109,0xffff0000,v130
v_cvt_pk_bf16_f32 v131,v110,v111
v_lshlrev_b32 v110,16,v131
v_and_b32 v111,0xffff0000,v131
s_add_u32 s63,s65,0
v_permlane16_swap_b32 v112,v114
v_permlane16_swap_b32 v113,v115
buffer_store_dwordx4 v[112:115],v132,s[8:11],s63 offen sc1
s_add_u32 s63,s65,8192
v_permlane16_swap_b32 v116,v118
v_permlane16_swap_b32 v117,v119
buffer_store_dwordx4 v[116:119],v132,s[8:11],s63 offen sc1
s_add_u32 s63,s65,16384
v_permlane16_swap_b32 v120,v122
v_permlane16_swap_b32 v121,v123
buffer_store_dwordx4 v[120:123],v132,s[8:11],s63 offen sc1
s_add_u32 s63,s65,24576
v_permlane16_swap_b32 v124,v126
v_permlane16_swap_b32 v125,v127
buffer_store_dwordx4 v[124:127],v132,s[8:11],s63 offen sc1
s_add_u32 s63,s65,32768
v_permlane16_swap_b32 v128,v130
v_permlane16_swap_b32 v129,v131
buffer_store_dwordx4 v[128:131],v132,s[8:11],s63 offen sc1
s_add_u32 s63,s64,0
v_permlane16_swap_b32 v32,v34
v_permlane16_swap_b32 v33,v35
buffer_store_dwordx4 v[32:35],v132,s[8:11],s63 offen sc1
s_add_u32 s63,s64,8192
v_permlane16_swap_b32 v36,v38
v_permlane16_swap_b32 v37,v39
buffer_store_dwordx4 v[36:39],v132,s[8:11],s63 offen sc1
s_add_u32 s63,s64,16384
v_permlane16_swap_b32 v40,v42
v_permlane16_swap_b32 v41,v43
buffer_store_dwordx4 v[40:43],v132,s[8:11],s63 offen sc1
s_add_u32 s63,s64,24576
v_permlane16_swap_b32 v44,v46
v_permlane16_swap_b32 v45,v47
buffer_store_dwordx4 v[44:47],v132,s[8:11],s63 offen sc1
s_add_u32 s63,s64,32768
v_permlane16_swap_b32 v48,v50
v_permlane16_swap_b32 v49,v51
buffer_store_dwordx4 v[48:51],v132,s[8:11],s63 offen sc1
s_lshl_b32 s82,s55,6
s_add_u32 s82,s82,s54
s_lshl_b32 s82,s82,9
s_add_u32 s82,s82,0
s_lshl_b32 s61,s53,2
s_add_u32 s82,s82,s61
s_add_u32 s54,s54,16
s_lshl_b32 s3,s49,2
v_mov_b32 v7,s3
s_nop 1
ibw_270:
buffer_load_dword v6,v7,s[12:15],0 offen sc1
s_waitcnt vmcnt(0)
v_cmp_ne_u32 vcc,256,v6
s_nop 0
s_cbranch_vccz ok_271
s_sleep 8
s_sub_u32 s47,s47,1
s_cbranch_scc1 ABORT
s_branch ibw_270
ok_271:
s_cmp_lg_u32 s49,0
s_cbranch_scc1 ibok_272
v_and_b32 v7,7,v0
v_lshlrev_b32 v7,2,v7
buffer_load_dword v6,v7,s[12:15],0 offen offset:32 sc1
s_waitcnt vmcnt(0)
v_cmp_ne_u32 vcc,32,v6
s_nop 0
s_cbranch_vccz ibok_272
s_barrier
s_mov_b32 s49,1
s_mov_b32 s3,s2
s_load_dwordx16 s[16:31],s[0:1],0
s_load_dwordx8 s[32:39],s[0:1],64
s_waitcnt lgkmcnt(0)
s_branch DISPATCH
ibok_272:
s_mov_b64 exec,1
buffer_store_dword v5,v1,s[8:11],s82 offen sc1
s_mov_b64 exec,-1
s_add_u32 s66,s54,16
s_min_u32 s66,s66,63
s_mul_i32 s62,s66,40960
buffer_load_dwordx2 v[32:33],v133,s[4:7],s62 offen offset:0
buffer_load_dwordx2 v[34:35],v133,s[4:7],s62 offen offset:128
buffer_load_dwordx2 v[36:37],v133,s[4:7],s62 offen offset:256
buffer_load_dwordx2 v[38:39],v133,s[4:7],s62 offen offset:384
buffer_load_dwordx2 v[40:41],v133,s[4:7],s62 offen offset:512
buffer_load_dwordx2 v[42:43],v133,s[4:7],s62 offen offset:640
buffer_load_dwordx2 v[44:45],v133,s[4:7],s62 offen offset:768
buffer_load_dwordx2 v[46:47],v133,s[4:7],s62 offen offset:896
buffer_load_dwordx2 v[48:49],v133,s[4:7],s62 offen offset:1024
buffer_load_dwordx2 v[50:51],v133,s[4:7],s62 offen offset:1152
s_mul_i32 s64,s54,40960
s_add_u32 s64,s64,234749952
s_mul_i32 s65,s54,46080
s_add_u32 s65,s65,206569472
s_waitcnt vmcnt(10)
v_lshlrev_b32 v72,16,v52
v_and_b32 v73,0xffff0000,v52
v_lshlrev_b32 v74,16,v53
v_and_b32 v75,0xffff0000,v53
v_lshlrev_b32 v76,16,v54
v_and_b32 v77,0xffff0000,v54
v_lshlrev_b32 v78,16,v55
v_and_b32 v79,0xffff0000,v55
v_lshlrev_b32 v80,16,v56
v_and_b32 v81,0xffff0000,v56
v_lshlrev_b32 v82,16,v57
v_and_b32 v83,0xffff0000,v57
v_lshlrev_b32 v84,16,v58
v_and_b32 v85,0xffff0000,v58
v_lshlrev_b32 v86,16,v59
v_and_b32 v87,0xffff0000,v59
v_lshlrev_b32 v88,16,v60
v_and_b32 v89,0xffff0000,v60
v_lshlrev_b32 v90,16,v61
v_and_b32 v91,0xffff0000,v61
v_lshlrev_b32 v92,16,v62
v_and_b32 v93,0xffff0000,v62
v_lshlrev_b32 v94,16,v63
v_and_b32 v95,0xffff0000,v63
v_lshlrev_b32 v96,16,v64
v_and_b32 v97,0xffff0000,v64
v_lshlrev_b32 v98,16,v65
v_and_b32 v99,0xffff0000,v65
v_lshlrev_b32 v100,16,v66
v_and_b32 v101,0xffff0000,v66
v_lshlrev_b32 v102,16,v67
v_and_b32 v103,0xffff0000,v67
v_lshlrev_b32 v104,16,v68
v_and_b32 v105,0xffff0000,v68
v_lshlrev_b32 v106,16,v69
v_and_b32 v107,0xffff0000,v69
v_lshlrev_b32 v108,16,v70
v_and_b32 v109,0xffff0000,v70
v_lshlrev_b32 v110,16,v71
v_and_b32 v111,0xffff0000,v71
v_pk_add_f32 v[28:29],v[72:73],v[74:75]
v_pk_mul_f32 v[26:27],v[72:73],v[72:73]
v_pk_fma_f32 v[26:27],v[74:75],v[74:75],v[26:27]
v_pk_add_f32 v[28:29],v[28:29],v[76:77]
v_pk_fma_f32 v[26:27],v[76:77],v[76:77],v[26:27]
v_pk_add_f32 v[28:29],v[28:29],v[78:79]
v_pk_fma_f32 v[26:27],v[78:79],v[78:79],v[26:27]
v_pk_add_f32 v[28:29],v[28:29],v[80:81]
v_pk_fma_f32 v[26:27],v[80:81],v[80:81],v[26:27]
v_pk_add_f32 v[28:29],v[28:29],v[82:83]
v_pk_fma_f32 v[26:27],v[82:83],v[82:83],v[26:27]
v_pk_add_f32 v[28:29],v[28:29],v[84:85]
v_pk_fma_f32 v[26:27],v[84:85],v[84:85],v[26:27]
v_pk_add_f32 v[28:29],v[28:29],v[86:87]
v_pk_fma_f32 v[26:27],v[86:87],v[86:87],v[26:27]
v_pk_add_f32 v[28:29],v[28:29],v[88:89]
v_pk_fma_f32 v[26:27],v[88:89],v[88:89],v[26:27]
v_pk_add_f32 v[28:29],v[28:29],v[90:91]
v_pk_fma_f32 v[26:27],v[90:91],v[90:91],v[26:27]
v_pk_add_f32 v[28:29],v[28:29],v[92:93]
v_pk_fma_f32 v[26:27],v[92:93],v[92:93],v[26:27]
v_pk_add_f32 v[28:29],v[28:29],v[94:95]
v_pk_fma_f32 v[26:27],v[94:95],v[94:95],v[26:27]
v_pk_add_f32 v[28:29],v[28:29],v[96:97]
v_pk_fma_f32 v[26:27],v[96:97],v[96:97],v[26:27]
v_pk_add_f32 v[28:29],v[28:29],v[98:99]
v_pk_fma_f32 v[26:27],v[98:99],v[98:99],v[26:27]
v_pk_add_f32 v[28:29],v[28:29],v[100:101]
v_pk_fma_f32 v[26:27],v[100:101],v[100:101],v[26:27]
v_pk_add_f32 v[28:29],v[28:29],v[102:103]
v_pk_fma_f32 v[26:27],v[102:103],v[102:103],v[26:27]
v_pk_add_f32 v[28:29],v[28:29],v[104:105]
v_pk_fma_f32 v[26:27],v[104:105],v[104:105],v[26:27]
v_pk_add_f32 v[28:29],v[28:29],v[106:107]
v_pk_fma_f32 v[26:27],v[106:107],v[106:107],v[26:27]
v_pk_add_f32 v[28:29],v[28:29],v[108:109]
v_pk_fma_f32 v[26:27],v[108:109],v[108:109],v[26:27]
v_pk_add_f32 v[28:29],v[28:29],v[110:111]
v_pk_fma_f32 v[26:27],v[110:111],v[110:111],v[26:27]
v_add_f32 v24,v28,v29
v_add_f32 v25,v26,v27
s_nop 0
v_add_f32_dpp v24,v24,v24 row_ror:4 row_mask:0xf bank_mask:0xf
v_add_f32_dpp v25,v25,v25 row_ror:4 row_mask:0xf bank_mask:0xf
s_nop 0
v_add_f32_dpp v24,v24,v24 row_ror:8 row_mask:0xf bank_mask:0xf
v_add_f32_dpp v25,v25,v25 row_ror:8 row_mask:0xf bank_mask:0xf
v_mov_b32 v26,v24
v_mov_b32 v27,v25
s_nop 0
v_permlane32_swap_b32 v24,v26
v_permlane32_swap_b32 v25,v27
v_add_f32 v24,v24,v26
v_add_f32 v25,v25,v27
v_mov_b32 v26,v24
v_mov_b32 v27,v25
s_nop 0
v_permlane16_swap_b32 v24,v26
v_permlane16_swap_b32 v25,v27
v_add_f32 v24,v24,v26
v_add_f32 v25,v25,v27
v_mul_f32 v24,0x3acccccd,v24
v_mul_f32 v25,0x3acccccd,v25
v_fma_f32 v25,-v24,v24,v25
v_max_f32 v25,0,v25
v_cvt_pk_bf16_f32 v6,v24,v25
v_lshlrev_b32 v24,16,v6
v_and_b32 v25,0xffff0000,v6
v_add_f32 v25,0x3727c5ac,v25
v_cvt_pk_bf16_f32 v6,v25,v25
v_lshlrev_b32 v25,16,v6
v_sqrt_f32 v25,v25
s_nop 0
v_cvt_pk_bf16_f32 v6,v25,v25
v_lshlrev_b32 v25,16,v6
v_rcp_f32 v25,v25
s_nop 0
v_pk_add_f32 v[72:73],v[72:73],v[24:25] op_sel_hi:[1,0] neg_lo:[0,1] neg_hi:[0,1]
v_pk_add_f32 v[74:75],v[74:75],v[24:25] op_sel_hi:[1,0] neg_lo:[0,1] neg_hi:[0,1]
v_pk_add_f32 v[76:77],v[76:77],v[24:25] op_sel_hi:[1,0] neg_lo:[0,1] neg_hi:[0,1]
v_pk_add_f32 v[78:79],v[78:79],v[24:25] op_sel_hi:[1,0] neg_lo:[0,1] neg_hi:[0,1]
v_pk_add_f32 v[80:81],v[80:81],v[24:25] op_sel_hi:[1,0] neg_lo:[0,1] neg_hi:[0,1]
v_pk_add_f32 v[82:83],v[82:83],v[24:25] op_sel_hi:[1,0] neg_lo:[0,1] neg_hi:[0,1]
v_pk_add_f32 v[84:85],v[84:85],v[24:25] op_sel_hi:[1,0] neg_lo:[0,1] neg_hi:[0,1]
v_pk_add_f32 v[86:87],v[86:87],v[24:25] op_sel_hi:[1,0] neg_lo:[0,1] neg_hi:[0,1]
v_pk_add_f32 v[88:89],v[88:89],v[24:25] op_sel_hi:[1,0] neg_lo:[0,1] neg_hi:[0,1]
v_pk_add_f32 v[90:91],v[90:91],v[24:25] op_sel_hi:[1,0] neg_lo:[0,1] neg_hi:[0,1]
v_pk_add_f32 v[92:93],v[92:93],v[24:25] op_sel_hi:[1,0] neg_lo:[0,1] neg_hi:[0,1]
v_pk_add_f32 v[94:95],v[94:95],v[24:25] op_sel_hi:[1,0] neg_lo:[0,1] neg_hi:[0,1]
v_pk_add_f32 v[96:97],v[96:97],v[24:25] op_sel_hi:[1,0] neg_lo:[0,1] neg_hi:[0,1]
v_pk_add_f32 v[98:99],v[98:99],v[24:25] op_sel_hi:[1,0] neg_lo:[0,1] neg_hi:[0,1]
v_pk_add_f32 v[100:101],v[100:101],v[24:25] op_sel_hi:[1,0] neg_lo:[0,1] neg_hi:[0,1]
v_pk_add_f32 v[102:103],v[102:103],v[24:25] op_sel_hi:[1,0] neg_lo:[0,1] neg_hi:[0,1]
v_pk_add_f32 v[104:105],v[104:105],v[24:25] op_sel_hi:[1,0] neg_lo:[0,1] neg_hi:[0,1]
v_pk_add_f32 v[106:107],v[106:107],v[24:25] op_sel_hi:[1,0] neg_lo:[0,1] neg_hi:[0,1]
v_pk_add_f32 v[108:109],v[108:109],v[24:25] op_sel_hi:[1,0] neg_lo:[0,1] neg_hi:[0,1]
v_pk_add_f32 v[110:111],v[110:111],v[24:25] op_sel_hi:[1,0] neg_lo:[0,1] neg_hi:[0,1]
v_cvt_pk_bf16_f32 v6,v72,v73
v_lshlrev_b32 v72,16,v6
v_and_b32 v73,0xffff0000,v6
v_cvt_pk_bf16_f32 v8,v74,v75
v_lshlrev_b32 v74,16,v8
v_and_b32 v75,0xffff0000,v8
v_cvt_pk_bf16_f32 v6,v76,v77
v_lshlrev_b32 v76,16,v6
v_and_b32 v77,0xffff0000,v6
v_cvt_pk_bf16_f32 v8,v78,v79
v_lshlrev_b32 v78,16,v8
v_and_b32 v79,0xffff0000,v8
v_cvt_pk_bf16_f32 v6,v80,v81
v_lshlrev_b32 v80,16,v6
v_and_b32 v81,0xffff0000,v6
v_cvt_pk_bf16_f32 v8,v82,v83
v_lshlrev_b32 v82,16,v8
v_and_b32 v83,0xffff0000,v8
v_cvt_pk_bf16_f32 v6,v84,v85
v_lshlrev_b32 v84,16,v6
v_and_b32 v85,0xffff0000,v6
v_cvt_pk_bf16_f32 v8,v86,v87
v_lshlrev_b32 v86,16,v8
v_and_b32 v87,0xffff0000,v8
v_cvt_pk_bf16_f32 v6,v88,v89
v_lshlrev_b32 v88,16,v6
v_and_b32 v89,0xffff0000,v6
v_cvt_pk_bf16_f32 v8,v90,v91
v_lshlrev_b32 v90,16,v8
v_and_b32 v91,0xffff0000,v8
v_cvt_pk_bf16_f32 v6,v92,v93
v_lshlrev_b32 v92,16,v6
v_and_b32 v93,0xffff0000,v6
v_cvt_pk_bf16_f32 v8,v94,v95
v_lshlrev_b32 v94,16,v8
v_and_b32 v95,0xffff0000,v8
v_cvt_pk_bf16_f32 v6,v96,v97
v_lshlrev_b32 v96,16,v6
v_and_b32 v97,0xffff0000,v6
v_cvt_pk_bf16_f32 v8,v98,v99
v_lshlrev_b32 v98,16,v8
v_and_b32 v99,0xffff0000,v8
v_cvt_pk_bf16_f32 v6,v100,v101
v_lshlrev_b32 v100,16,v6
v_and_b32 v101,0xffff0000,v6
v_cvt_pk_bf16_f32 v8,v102,v103
v_lshlrev_b32 v102,16,v8
v_and_b32 v103,0xffff0000,v8
v_cvt_pk_bf16_f32 v6,v104,v105
v_lshlrev_b32 v104,16,v6
v_and_b32 v105,0xffff0000,v6
v_cvt_pk_bf16_f32 v8,v106,v107
v_lshlrev_b32 v106,16,v8
v_and_b32 v107,0xffff0000,v8
v_cvt_pk_bf16_f32 v6,v108,v109
v_lshlrev_b32 v108,16,v6
v_and_b32 v109,0xffff0000,v6
v_cvt_pk_bf16_f32 v8,v110,v111
v_lshlrev_b32 v110,16,v8
v_and_b32 v111,0xffff0000,v8
v_pk_mul_f32 v[72:73],v[72:73],v[24:25] op_sel:[0,1] op_sel_hi:[1,1]
v_pk_mul_f32 v[74:75],v[74:75],v[24:25] op_sel:[0,1] op_sel_hi:[1,1]
v_pk_mul_f32 v[76:77],v[76:77],v[24:25] op_sel:[0,1] op_sel_hi:[1,1]
v_pk_mul_f32 v[78:79],v[78:79],v[24:25] op_sel:[0,1] op_sel_hi:[1,1]
v_pk_mul_f32 v[80:81],v[80:81],v[24:25] op_sel:[0,1] op_sel_hi:[1,1]
v_pk_mul_f32 v[82:83],v[82:83],v[24:25] op_sel:[0,1] op_sel_hi:[1,1]
v_pk_mul_f32 v[84:85],v[84:85],v[24:25] op_sel:[0,1] op_sel_hi:[1,1]
v_pk_mul_f32 v[86:87],v[86:87],v[24:25] op_sel:[0,1] op_sel_hi:[1,1]
v_pk_mul_f32 v[88:89],v[88:89],v[24:25] op_sel:[0,1] op_sel_hi:[1,1]
v_pk_mul_f32 v[90:91],v[90:91],v[24:25] op_sel:[0,1] op_sel_hi:[1,1]
v_pk_mul_f32 v[92:93],v[92:93],v[24:25] op_sel:[0,1] op_sel_hi:[1,1]
v_pk_mul_f32 v[94:95],v[94:95],v[24:25] op_sel:[0,1] op_sel_hi:[1,1]
v_pk_mul_f32 v[96:97],v[96:97],v[24:25] op_sel:[0,1] op_sel_hi:[1,1]
v_pk_mul_f32 v[98:99],v[98:99],v[24:25] op_sel:[0,1] op_sel_hi:[1,1]
v_pk_mul_f32 v[100:101],v[100:101],v[24:25] op_sel:[0,1] op_sel_hi:[1,1]
v_pk_mul_f32 v[102:103],v[102:103],v[24:25] op_sel:[0,1] op_sel_hi:[1,1]
v_pk_mul_f32 v[104:105],v[104:105],v[24:25] op_sel:[0,1] op_sel_hi:[1,1]
v_pk_mul_f32 v[106:107],v[106:107],v[24:25] op_sel:[0,1] op_sel_hi:[1,1]
v_pk_mul_f32 v[108:109],v[108:109],v[24:25] op_sel:[0,1] op_sel_hi:[1,1]
v_pk_mul_f32 v[110:111],v[110:111],v[24:25] op_sel:[0,1] op_sel_hi:[1,1]
v_cvt_pk_bf16_f32 v112,v72,v73
v_lshlrev_b32 v72,16,v112
v_and_b32 v73,0xffff0000,v112
v_cvt_pk_bf16_f32 v113,v74,v75
v_lshlrev_b32 v74,16,v113
v_and_b32 v75,0xffff0000,v113
v_cvt_pk_bf16_f32 v114,v76,v77
v_lshlrev_b32 v76,16,v114
v_and_b32 v77,0xffff0000,v114
v_cvt_pk_bf16_f32 v115,v78,v79
v_lshlrev_b32 v78,16,v115
v_and_b32 v79,0xffff0000,v115
v_cvt_pk_bf16_f32 v116,v80,v81
v_lshlrev_b32 v80,16,v116
v_and_b32 v81,0xffff0000,v116
v_cvt_pk_bf16_f32 v117,v82,v83
v_lshlrev_b32 v82,16,v117
v_and_b32 v83,0xffff0000,v117
v_cvt_pk_bf16_f32 v118,v84,v85
v_lshlrev_b32 v84,16,v118
v_and_b32 v85,0xffff0000,v118
v_cvt_pk_bf16_f32 v119,v86,v87
v_lshlrev_b32 v86,16,v119
v_and_b32 v87,0xffff0000,v119
v_cvt_pk_bf16_f32 v120,v88,v89
v_lshlrev_b32 v88,16,v120
v_and_b32 v89,0xffff0000,v120
v_cvt_pk_bf16_f32 v121,v90,v91
v_lshlrev_b32 v90,16,v121
v_and_b32 v91,0xffff0000,v121
v_cvt_pk_bf16_f32 v122,v92,v93
v_lshlrev_b32 v92,16,v122
v_and_b32 v93,0xffff0000,v122
v_cvt_pk_bf16_f32 v123,v94,v95
v_lshlrev_b32 v94,16,v123
v_and_b32 v95,0xffff0000,v123
v_cvt_pk_bf16_f32 v124,v96,v97
v_lshlrev_b32 v96,16,v124
v_and_b32 v97,0xffff0000,v124
v_cvt_pk_bf16_f32 v125,v98,v99
v_lshlrev_b32 v98,16,v125
v_and_b32 v99,0xffff0000,v125
v_cvt_pk_bf16_f32 v126,v100,v101
v_lshlrev_b32 v100,16,v126
v_and_b32 v101,0xffff0000,v126
v_cvt_pk_bf16_f32 v127,v102,v103
v_lshlrev_b32 v102,16,v127
v_and_b32 v103,0xffff0000,v127
v_cvt_pk_bf16_f32 v128,v104,v105
v_lshlrev_b32 v104,16,v128
v_and_b32 v105,0xffff0000,v128
v_cvt_pk_bf16_f32 v129,v106,v107
v_lshlrev_b32 v106,16,v129
v_and_b32 v107,0xffff0000,v129
v_cvt_pk_bf16_f32 v130,v108,v109
v_lshlrev_b32 v108,16,v130
v_and_b32 v109,0xffff0000,v130
v_cvt_pk_bf16_f32 v131,v110,v111
v_lshlrev_b32 v110,16,v131
v_and_b32 v111,0xffff0000,v131
s_add_u32 s63,s65,0
v_permlane16_swap_b32 v112,v114
v_permlane16_swap_b32 v113,v115
buffer_store_dwordx4 v[112:115],v132,s[8:11],s63 offen sc1
s_add_u32 s63,s65,8192
v_permlane16_swap_b32 v116,v118
v_permlane16_swap_b32 v117,v119
buffer_store_dwordx4 v[116:119],v132,s[8:11],s63 offen sc1
s_add_u32 s63,s65,16384
v_permlane16_swap_b32 v120,v122
v_permlane16_swap_b32 v121,v123
buffer_store_dwordx4 v[120:123],v132,s[8:11],s63 offen sc1
s_add_u32 s63,s65,24576
v_permlane16_swap_b32 v124,v126
v_permlane16_swap_b32 v125,v127
buffer_store_dwordx4 v[124:127],v132,s[8:11],s63 offen sc1
s_add_u32 s63,s65,32768
v_permlane16_swap_b32 v128,v130
v_permlane16_swap_b32 v129,v131
buffer_store_dwordx4 v[128:131],v132,s[8:11],s63 offen sc1
s_add_u32 s63,s64,0
v_permlane16_swap_b32 v52,v54
v_permlane16_swap_b32 v53,v55
buffer_store_dwordx4 v[52:55],v132,s[8:11],s63 offen sc1
s_add_u32 s63,s64,8192
v_permlane16_swap_b32 v56,v58
v_permlane16_swap_b32 v57,v59
buffer_store_dwordx4 v[56:59],v132,s[8:11],s63 offen sc1
s_add_u32 s63,s64,16384
v_permlane16_swap_b32 v60,v62
v_permlane16_swap_b32 v61,v63
buffer_store_dwordx4 v[60:63],v132,s[8:11],s63 offen sc1
s_add_u32 s63,s64,24576
v_permlane16_swap_b32 v64,v66
v_permlane16_swap_b32 v65,v67
buffer_store_dwordx4 v[64:67],v132,s[8:11],s63 offen sc1
s_add_u32 s63,s64,32768
v_permlane16_swap_b32 v68,v70
v_permlane16_swap_b32 v69,v71
buffer_store_dwordx4 v[68:71],v132,s[8:11],s63 offen sc1
s_lshl_b32 s82,s55,6
s_add_u32 s82,s82,s54
s_lshl_b32 s82,s82,9
s_add_u32 s82,s82,0
s_lshl_b32 s61,s53,2
s_add_u32 s82,s82,s61
s_add_u32 s54,s54,16
R0_LOOPA:
s_add_u32 s66,s54,16
s_min_u32 s66,s66,63
s_mul_i32 s62,s66,40960
buffer_load_dwordx2 v[52:53],v133,s[4:7],s62 offen offset:0
buffer_load_dwordx2 v[54:55],v133,s[4:7],s62 offen offset:128
buffer_load_dwordx2 v[56:57],v133,s[4:7],s62 offen offset:256
buffer_load_dwordx2 v[58:59],v133,s[4:7],s62 offen offset:384
buffer_load_dwordx2 v[60:61],v133,s[4:7],s62 offen offset:512
buffer_load_dwordx2 v[62:63],v133,s[4:7],s62 offen offset:640
buffer_load_dwordx2 v[64:65],v133,s[4:7],s62 offen offset:768
buffer_load_dwordx2 v[66:67],v133,s[4:7],s62 offen offset:896
buffer_load_dwordx2 v[68:69],v133,s[4:7],s62 offen offset:1024
buffer_load_dwordx2 v[70:71],v133,s[4:7],s62 offen offset:1152
s_mul_i32 s64,s54,40960
s_add_u32 s64,s64,234749952
s_mul_i32 s65,s54,46080
s_add_u32 s65,s65,206569472
s_waitcnt vmcnt(10)
s_mov_b64 exec,1
buffer_store_dword v5,v1,s[8:11],s82 offen sc1
s_mov_b64 exec,-1
v_lshlrev_b32 v72,16,v32
v_and_b32 v73,0xffff0000,v32
v_lshlrev_b32 v74,16,v33
v_and_b32 v75,0xffff0000,v33
v_lshlrev_b32 v76,16,v34
v_and_b32 v77,0xffff0000,v34
v_lshlrev_b32 v78,16,v35
v_and_b32 v79,0xffff0000,v35
v_lshlrev_b32 v80,16,v36
v_and_b32 v81,0xffff0000,v36
v_lshlrev_b32 v82,16,v37
v_and_b32 v83,0xffff0000,v37
v_lshlrev_b32 v84,16,v38
v_and_b32 v85,0xffff0000,v38
v_lshlrev_b32 v86,16,v39
v_and_b32 v87,0xffff0000,v39
v_lshlrev_b32 v88,16,v40
v_and_b32 v89,0xffff0000,v40
v_lshlrev_b32 v90,16,v41
v_and_b32 v91,0xffff0000,v41
v_lshlrev_b32 v92,16,v42
v_and_b32 v93,0xffff0000,v42
v_lshlrev_b32 v94,16,v43
v_and_b32 v95,0xffff0000,v43
v_lshlrev_b32 v96,16,v44
v_and_b32 v97,0xffff0000,v44
v_lshlrev_b32 v98,16,v45
v_and_b32 v99,0xffff0000,v45
v_lshlrev_b32 v100,16,v46
v_and_b32 v101,0xffff0000,v46
v_lshlrev_b32 v102,16,v47
v_and_b32 v103,0xffff0000,v47
v_lshlrev_b32 v104,16,v48
v_and_b32 v105,0xffff0000,v48
v_lshlrev_b32 v106,16,v49
v_and_b32 v107,0xffff0000,v49
v_lshlrev_b32 v108,16,v50
v_and_b32 v109,0xffff0000,v50
v_lshlrev_b32 v110,16,v51
v_and_b32 v111,0xffff0000,v51
v_pk_add_f32 v[28:29],v[72:73],v[74:75]
v_pk_mul_f32 v[26:27],v[72:73],v[72:73]
v_pk_fma_f32 v[26:27],v[74:75],v[74:75],v[26:27]
v_pk_add_f32 v[28:29],v[28:29],v[76:77]
v_pk_fma_f32 v[26:27],v[76:77],v[76:77],v[26:27]
v_pk_add_f32 v[28:29],v[28:29],v[78:79]
v_pk_fma_f32 v[26:27],v[78:79],v[78:79],v[26:27]
v_pk_add_f32 v[28:29],v[28:29],v[80:81]
v_pk_fma_f32 v[26:27],v[80:81],v[80:81],v[26:27]
v_pk_add_f32 v[28:29],v[28:29],v[82:83]
v_pk_fma_f32 v[26:27],v[82:83],v[82:83],v[26:27]
v_pk_add_f32 v[28:29],v[28:29],v[84:85]
v_pk_fma_f32 v[26:27],v[84:85],v[84:85],v[26:27]
v_pk_add_f32 v[28:29],v[28:29],v[86:87]
v_pk_fma_f32 v[26:27],v[86:87],v[86:87],v[26:27]
v_pk_add_f32 v[28:29],v[28:29],v[88:89]
v_pk_fma_f32 v[26:27],v[88:89],v[88:89],v[26:27]
v_pk_add_f32 v[28:29],v[28:29],v[90:91]
v_pk_fma_f32 v[26:27],v[90:91],v[90:91],v[26:27]
v_pk_add_f32 v[28:29],v[28:29],v[92:93]
v_pk_fma_f32 v[26:27],v[92:93],v[92:93],v[26:27]
v_pk_add_f32 v[28:29],v[28:29],v[94:95]
v_pk_fma_f32 v[26:27],v[94:95],v[94:95],v[26:27]
v_pk_add_f32 v[28:29],v[28:29],v[96:97]
v_pk_fma_f32 v[26:27],v[96:97],v[96:97],v[26:27]
v_pk_add_f32 v[28:29],v[28:29],v[98:99]
v_pk_fma_f32 v[26:27],v[98:99],v[98:99],v[26:27]
v_pk_add_f32 v[28:29],v[28:29],v[100:101]
v_pk_fma_f32 v[26:27],v[100:101],v[100:101],v[26:27]
v_pk_add_f32 v[28:29],v[28:29],v[102:103]
v_pk_fma_f32 v[26:27],v[102:103],v[102:103],v[26:27]
v_pk_add_f32 v[28:29],v[28:29],v[104:105]
v_pk_fma_f32 v[26:27],v[104:105],v[104:105],v[26:27]
v_pk_add_f32 v[28:29],v[28:29],v[106:107]
v_pk_fma_f32 v[26:27],v[106:107],v[106:107],v[26:27]
v_pk_add_f32 v[28:29],v[28:29],v[108:109]
v_pk_fma_f32 v[26:27],v[108:109],v[108:109],v[26:27]
v_pk_add_f32 v[28:29],v[28:29],v[110:111]
v_pk_fma_f32 v[26:27],v[110:111],v[110:111],v[26:27]
v_add_f32 v24,v28,v29
v_add_f32 v25,v26,v27
s_nop 0
v_add_f32_dpp v24,v24,v24 row_ror:4 row_mask:0xf bank_mask:0xf
v_add_f32_dpp v25,v25,v25 row_ror:4 row_mask:0xf bank_mask:0xf
s_nop 0
v_add_f32_dpp v24,v24,v24 row_ror:8 row_mask:0xf bank_mask:0xf
v_add_f32_dpp v25,v25,v25 row_ror:8 row_mask:0xf bank_mask:0xf
v_mov_b32 v26,v24
v_mov_b32 v27,v25
s_nop 0
v_permlane32_swap_b32 v24,v26
v_permlane32_swap_b32 v25,v27
v_add_f32 v24,v24,v26
v_add_f32 v25,v25,v27
v_mov_b32 v26,v24
v_mov_b32 v27,v25
s_nop 0
v_permlane16_swap_b32 v24,v26
v_permlane16_swap_b32 v25,v27
v_add_f32 v24,v24,v26
v_add_f32 v25,v25,v27
v_mul_f32 v24,0x3acccccd,v24
v_mul_f32 v25,0x3acccccd,v25
v_fma_f32 v25,-v24,v24,v25
v_max_f32 v25,0,v25
v_cvt_pk_bf16_f32 v6,v24,v25
v_lshlrev_b32 v24,16,v6
v_and_b32 v25,0xffff0000,v6
v_add_f32 v25,0x3727c5ac,v25
v_cvt_pk_bf16_f32 v6,v25,v25
v_lshlrev_b32 v25,16,v6
v_sqrt_f32 v25,v25
s_nop 0
v_cvt_pk_bf16_f32 v6,v25,v25
v_lshlrev_b32 v25,16,v6
v_rcp_f32 v25,v25
s_nop 0
v_pk_add_f32 v[72:73],v[72:73],v[24:25] op_sel_hi:[1,0] neg_lo:[0,1] neg_hi:[0,1]
v_pk_add_f32 v[74:75],v[74:75],v[24:25] op_sel_hi:[1,0] neg_lo:[0,1] neg_hi:[0,1]
v_pk_add_f32 v[76:77],v[76:77],v[24:25] op_sel_hi:[1,0] neg_lo:[0,1] neg_hi:[0,1]
v_pk_add_f32 v[78:79],v[78:79],v[24:25] op_sel_hi:[1,0] neg_lo:[0,1] neg_hi:[0,1]
v_pk_add_f32 v[80:81],v[80:81],v[24:25] op_sel_hi:[1,0] neg_lo:[0,1] neg_hi:[0,1]
v_pk_add_f32 v[82:83],v[82:83],v[24:25] op_sel_hi:[1,0] neg_lo:[0,1] neg_hi:[0,1]
v_pk_add_f32 v[84:85],v[84:85],v[24:25] op_sel_hi:[1,0] neg_lo:[0,1] neg_hi:[0,1]
v_pk_add_f32 v[86:87],v[86:87],v[24:25] op_sel_hi:[1,0] neg_lo:[0,1] neg_hi:[0,1]
v_pk_add_f32 v[88:89],v[88:89],v[24:25] op_sel_hi:[1,0] neg_lo:[0,1] neg_hi:[0,1]
v_pk_add_f32 v[90:91],v[90:91],v[24:25] op_sel_hi:[1,0] neg_lo:[0,1] neg_hi:[0,1]
v_pk_add_f32 v[92:93],v[92:93],v[24:25] op_sel_hi:[1,0] neg_lo:[0,1] neg_hi:[0,1]
v_pk_add_f32 v[94:95],v[94:95],v[24:25] op_sel_hi:[1,0] neg_lo:[0,1] neg_hi:[0,1]
v_pk_add_f32 v[96:97],v[96:97],v[24:25] op_sel_hi:[1,0] neg_lo:[0,1] neg_hi:[0,1]
v_pk_add_f32 v[98:99],v[98:99],v[24:25] op_sel_hi:[1,0] neg_lo:[0,1] neg_hi:[0,1]
v_pk_add_f32 v[100:101],v[100:101],v[24:25] op_sel_hi:[1,0] neg_lo:[0,1] neg_hi:[0,1]
v_pk_add_f32 v[102:103],v[102:103],v[24:25] op_sel_hi:[1,0] neg_lo:[0,1] neg_hi:[0,1]
v_pk_add_f32 v[104:105],v[104:105],v[24:25] op_sel_hi:[1,0] neg_lo:[0,1] neg_hi:[0,1]
v_pk_add_f32 v[106:107],v[106:107],v[24:25] op_sel_hi:[1,0] neg_lo:[0,1] neg_hi:[0,1]
v_pk_add_f32 v[108:109],v[108:109],v[24:25] op_sel_hi:[1,0] neg_lo:[0,1] neg_hi:[0,1]
v_pk_add_f32 v[110:111],v[110:111],v[24:25] op_sel_hi:[1,0] neg_lo:[0,1] neg_hi:[0,1]
v_cvt_pk_bf16_f32 v6,v72,v73
v_lshlrev_b32 v72,16,v6
v_and_b32 v73,0xffff0000,v6
v_cvt_pk_bf16_f32 v8,v74,v75
v_lshlrev_b32 v74,16,v8
v_and_b32 v75,0xffff0000,v8
v_cvt_pk_bf16_f32 v6,v76,v77
v_lshlrev_b32 v76,16,v6
v_and_b32 v77,0xffff0000,v6
v_cvt_pk_bf16_f32 v8,v78,v79
v_lshlrev_b32 v78,16,v8
v_and_b32 v79,0xffff0000,v8
v_cvt_pk_bf16_f32 v6,v80,v81
v_lshlrev_b32 v80,16,v6
v_and_b32 v81,0xffff0000,v6
v_cvt_pk_bf16_f32 v8,v82,v83
v_lshlrev_b32 v82,16,v8
v_and_b32 v83,0xffff0000,v8
v_cvt_pk_bf16_f32 v6,v84,v85
v_lshlrev_b32 v84,16,v6
v_and_b32 v85,0xffff0000,v6
v_cvt_pk_bf16_f32 v8,v86,v87
v_lshlrev_b32 v86,16,v8
v_and_b32 v87,0xffff0000,v8
v_cvt_pk_bf16_f32 v6,v88,v89
v_lshlrev_b32 v88,16,v6
v_and_b32 v89,0xffff0000,v6
v_cvt_pk_bf16_f32 v8,v90,v91
v_lshlrev_b32 v90,16,v8
v_and_b32 v91,0xffff0000,v8
v_cvt_pk_bf16_f32 v6,v92,v93
v_lshlrev_b32 v92,16,v6
v_and_b32 v93,0xffff0000,v6
v_cvt_pk_bf16_f32 v8,v94,v95
v_lshlrev_b32 v94,16,v8
v_and_b32 v95,0xffff0000,v8
v_cvt_pk_bf16_f32 v6,v96,v97
v_lshlrev_b32 v96,16,v6
v_and_b32 v97,0xffff0000,v6
v_cvt_pk_bf16_f32 v8,v98,v99
v_lshlrev_b32 v98,16,v8
v_and_b32 v99,0xffff0000,v8
v_cvt_pk_bf16_f32 v6,v100,v101
v_lshlrev_b32 v100,16,v6
v_and_b32 v101,0xffff0000,v6
v_cvt_pk_bf16_f32 v8,v102,v103
v_lshlrev_b32 v102,16,v8
v_and_b32 v103,0xffff0000,v8
v_cvt_pk_bf16_f32 v6,v104,v105
v_lshlrev_b32 v104,16,v6
v_and_b32 v105,0xffff0000,v6
v_cvt_pk_bf16_f32 v8,v106,v107
v_lshlrev_b32 v106,16,v8
v_and_b32 v107,0xffff0000,v8
v_cvt_pk_bf16_f32 v6,v108,v109
v_lshlrev_b32 v108,16,v6
v_and_b32 v109,0xffff0000,v6
v_cvt_pk_bf16_f32 v8,v110,v111
v_lshlrev_b32 v110,16,v8
v_and_b32 v111,0xffff0000,v8
v_pk_mul_f32 v[72:73],v[72:73],v[24:25] op_sel:[0,1] op_sel_hi:[1,1]
v_pk_mul_f32 v[74:75],v[74:75],v[24:25] op_sel:[0,1] op_sel_hi:[1,1]
v_pk_mul_f32 v[76:77],v[76:77],v[24:25] op_sel:[0,1] op_sel_hi:[1,1]
v_pk_mul_f32 v[78:79],v[78:79],v[24:25] op_sel:[0,1] op_sel_hi:[1,1]
v_pk_mul_f32 v[80:81],v[80:81],v[24:25] op_sel:[0,1] op_sel_hi:[1,1]
v_pk_mul_f32 v[82:83],v[82:83],v[24:25] op_sel:[0,1] op_sel_hi:[1,1]
v_pk_mul_f32 v[84:85],v[84:85],v[24:25] op_sel:[0,1] op_sel_hi:[1,1]
v_pk_mul_f32 v[86:87],v[86:87],v[24:25] op_sel:[0,1] op_sel_hi:[1,1]
v_pk_mul_f32 v[88:89],v[88:89],v[24:25] op_sel:[0,1] op_sel_hi:[1,1]
v_pk_mul_f32 v[90:91],v[90:91],v[24:25] op_sel:[0,1] op_sel_hi:[1,1]
v_pk_mul_f32 v[92:93],v[92:93],v[24:25] op_sel:[0,1] op_sel_hi:[1,1]
v_pk_mul_f32 v[94:95],v[94:95],v[24:25] op_sel:[0,1] op_sel_hi:[1,1]
v_pk_mul_f32 v[96:97],v[96:97],v[24:25] op_sel:[0,1] op_sel_hi:[1,1]
v_pk_mul_f32 v[98:99],v[98:99],v[24:25] op_sel:[0,1] op_sel_hi:[1,1]
v_pk_mul_f32 v[100:101],v[100:101],v[24:25] op_sel:[0,1] op_sel_hi:[1,1]
v_pk_mul_f32 v[102:103],v[102:103],v[24:25] op_sel:[0,1] op_sel_hi:[1,1]
v_pk_mul_f32 v[104:105],v[104:105],v[24:25] op_sel:[0,1] op_sel_hi:[1,1]
v_pk_mul_f32 v[106:107],v[106:107],v[24:25] op_sel:[0,1] op_sel_hi:[1,1]
v_pk_mul_f32 v[108:109],v[108:109],v[24:25] op_sel:[0,1] op_sel_hi:[1,1]
v_pk_mul_f32 v[110:111],v[110:111],v[24:25] op_sel:[0,1] op_sel_hi:[1,1]
v_cvt_pk_bf16_f32 v112,v72,v73
v_lshlrev_b32 v72,16,v112
v_and_b32 v73,0xffff0000,v112
v_cvt_pk_bf16_f32 v113,v74,v75
v_lshlrev_b32 v74,16,v113
v_and_b32 v75,0xffff0000,v113
v_cvt_pk_bf16_f32 v114,v76,v77
v_lshlrev_b32 v76,16,v114
v_and_b32 v77,0xffff0000,v114
v_cvt_pk_bf16_f32 v115,v78,v79
v_lshlrev_b32 v78,16,v115
v_and_b32 v79,0xffff0000,v115
v_cvt_pk_bf16_f32 v116,v80,v81
v_lshlrev_b32 v80,16,v116
v_and_b32 v81,0xffff0000,v116
v_cvt_pk_bf16_f32 v117,v82,v83
v_lshlrev_b32 v82,16,v117
v_and_b32 v83,0xffff0000,v117
v_cvt_pk_bf16_f32 v118,v84,v85
v_lshlrev_b32 v84,16,v118
v_and_b32 v85,0xffff0000,v118
v_cvt_pk_bf16_f32 v119,v86,v87
v_lshlrev_b32 v86,16,v119
v_and_b32 v87,0xffff0000,v119
v_cvt_pk_bf16_f32 v120,v88,v89
v_lshlrev_b32 v88,16,v120
v_and_b32 v89,0xffff0000,v120
v_cvt_pk_bf16_f32 v121,v90,v91
v_lshlrev_b32 v90,16,v121
v_and_b32 v91,0xffff0000,v121
v_cvt_pk_bf16_f32 v122,v92,v93
v_lshlrev_b32 v92,16,v122
v_and_b32 v93,0xffff0000,v122
v_cvt_pk_bf16_f32 v123,v94,v95
v_lshlrev_b32 v94,16,v123
v_and_b32 v95,0xffff0000,v123
v_cvt_pk_bf16_f32 v124,v96,v97
v_lshlrev_b32 v96,16,v124
v_and_b32 v97,0xffff0000,v124
v_cvt_pk_bf16_f32 v125,v98,v99
v_lshlrev_b32 v98,16,v125
v_and_b32 v99,0xffff0000,v125
v_cvt_pk_bf16_f32 v126,v100,v101
v_lshlrev_b32 v100,16,v126
v_and_b32 v101,0xffff0000,v126
v_cvt_pk_bf16_f32 v127,v102,v103
v_lshlrev_b32 v102,16,v127
v_and_b32 v103,0xffff0000,v127
v_cvt_pk_bf16_f32 v128,v104,v105
v_lshlrev_b32 v104,16,v128
v_and_b32 v105,0xffff0000,v128
v_cvt_pk_bf16_f32 v129,v106,v107
v_lshlrev_b32 v106,16,v129
v_and_b32 v107,0xffff0000,v129
v_cvt_pk_bf16_f32 v130,v108,v109
v_lshlrev_b32 v108,16,v130
v_and_b32 v109,0xffff0000,v130
v_cvt_pk_bf16_f32 v131,v110,v111
v_lshlrev_b32 v110,16,v131
v_and_b32 v111,0xffff0000,v131
s_add_u32 s63,s65,0
v_permlane16_swap_b32 v112,v114
v_permlane16_swap_b32 v113,v115
buffer_store_dwordx4 v[112:115],v132,s[8:11],s63 offen sc1
s_add_u32 s63,s65,8192
v_permlane16_swap_b32 v116,v118
v_permlane16_swap_b32 v117,v119
buffer_store_dwordx4 v[116:119],v132,s[8:11],s63 offen sc1
s_add_u32 s63,s65,16384
v_permlane16_swap_b32 v120,v122
v_permlane16_swap_b32 v121,v123
buffer_store_dwordx4 v[120:123],v132,s[8:11],s63 offen sc1
s_add_u32 s63,s65,24576
v_permlane16_swap_b32 v124,v126
v_permlane16_swap_b32 v125,v127
buffer_store_dwordx4 v[124:127],v132,s[8:11],s63 offen sc1
s_add_u32 s63,s65,32768
v_permlane16_swap_b32 v128,v130
v_permlane16_swap_b32 v129,v131
buffer_store_dwordx4 v[128:131],v132,s[8:11],s63 offen sc1
s_add_u32 s63,s64,0
v_permlane16_swap_b32 v32,v34
v_permlane16_swap_b32 v33,v35
buffer_store_dwordx4 v[32:35],v132,s[8:11],s63 offen sc1
s_add_u32 s63,s64,8192
v_permlane16_swap_b32 v36,v38
v_permlane16_swap_b32 v37,v39
buffer_store_dwordx4 v[36:39],v132,s[8:11],s63 offen sc1
s_add_u32 s63,s64,16384
v_permlane16_swap_b32 v40,v42
v_permlane16_swap_b32 v41,v43
buffer_store_dwordx4 v[40:43],v132,s[8:11],s63 offen sc1
s_add_u32 s63,s64,24576
v_permlane16_swap_b32 v44,v46
v_permlane16_swap_b32 v45,v47
buffer_store_dwordx4 v[44:47],v132,s[8:11],s63 offen sc1
s_add_u32 s63,s64,32768
v_permlane16_swap_b32 v48,v50
v_permlane16_swap_b32 v49,v51
buffer_store_dwordx4 v[48:51],v132,s[8:11],s63 offen sc1
s_lshl_b32 s82,s55,6
s_add_u32 s82,s82,s54
s_lshl_b32 s82,s82,9
s_add_u32 s82,s82,0
s_lshl_b32 s61,s53,2
s_add_u32 s82,s82,s61
s_add_u32 s54,s54,16
s_cmp_ge_u32 s54,64
s_cbranch_scc1 R0_ENDA
s_add_u32 s66,s54,16
s_min_u32 s66,s66,63
s_mul_i32 s62,s66,40960
buffer_load_dwordx2 v[32:33],v133,s[4:7],s62 offen offset:0
buffer_load_dwordx2 v[34:35],v133,s[4:7],s62 offen offset:128
buffer_load_dwordx2 v[36:37],v133,s[4:7],s62 offen offset:256
buffer_load_dwordx2 v[38:39],v133,s[4:7],s62 offen offset:384
buffer_load_dwordx2 v[40:41],v133,s[4:7],s62 offen offset:512
buffer_load_dwordx2 v[42:43],v133,s[4:7],s62 offen offset:640
buffer_load_dwordx2 v[44:45],v133,s[4:7],s62 offen offset:768
buffer_load_dwordx2 v[46:47],v133,s[4:7],s62 offen offset:896
buffer_load_dwordx2 v[48:49],v133,s[4:7],s62 offen offset:1024
buffer_load_dwordx2 v[50:51],v133,s[4:7],s62 offen offset:1152
s_mul_i32 s64,s54,40960
s_add_u32 s64,s64,234749952
s_mul_i32 s65,s54,46080
s_add_u32 s65,s65,206569472
s_waitcnt vmcnt(10)
s_mov_b64 exec,1
buffer_store_dword v5,v1,s[8:11],s82 offen sc1
s_mov_b64 exec,-1
v_lshlrev_b32 v72,16,v52
v_and_b32 v73,0xffff0000,v52
v_lshlrev_b32 v74,16,v53
v_and_b32 v75,0xffff0000,v53
v_lshlrev_b32 v76,16,v54
v_and_b32 v77,0xffff0000,v54
v_lshlrev_b32 v78,16,v55
v_and_b32 v79,0xffff0000,v55
v_lshlrev_b32 v80,16,v56
v_and_b32 v81,0xffff0000,v56
v_lshlrev_b32 v82,16,v57
v_and_b32 v83,0xffff0000,v57
v_lshlrev_b32 v84,16,v58
v_and_b32 v85,0xffff0000,v58
v_lshlrev_b32 v86,16,v59
v_and_b32 v87,0xffff0000,v59
v_lshlrev_b32 v88,16,v60
v_and_b32 v89,0xffff0000,v60
v_lshlrev_b32 v90,16,v61
v_and_b32 v91,0xffff0000,v61
v_lshlrev_b32 v92,16,v62
v_and_b32 v93,0xffff0000,v62
v_lshlrev_b32 v94,16,v63
v_and_b32 v95,0xffff0000,v63
v_lshlrev_b32 v96,16,v64
v_and_b32 v97,0xffff0000,v64
v_lshlrev_b32 v98,16,v65
v_and_b32 v99,0xffff0000,v65
v_lshlrev_b32 v100,16,v66
v_and_b32 v101,0xffff0000,v66
v_lshlrev_b32 v102,16,v67
v_and_b32 v103,0xffff0000,v67
v_lshlrev_b32 v104,16,v68
v_and_b32 v105,0xffff0000,v68
v_lshlrev_b32 v106,16,v69
v_and_b32 v107,0xffff0000,v69
v_lshlrev_b32 v108,16,v70
v_and_b32 v109,0xffff0000,v70
v_lshlrev_b32 v110,16,v71
v_and_b32 v111,0xffff0000,v71
v_pk_add_f32 v[28:29],v[72:73],v[74:75]
v_pk_mul_f32 v[26:27],v[72:73],v[72:73]
v_pk_fma_f32 v[26:27],v[74:75],v[74:75],v[26:27]
v_pk_add_f32 v[28:29],v[28:29],v[76:77]
v_pk_fma_f32 v[26:27],v[76:77],v[76:77],v[26:27]
v_pk_add_f32 v[28:29],v[28:29],v[78:79]
v_pk_fma_f32 v[26:27],v[78:79],v[78:79],v[26:27]
v_pk_add_f32 v[28:29],v[28:29],v[80:81]
v_pk_fma_f32 v[26:27],v[80:81],v[80:81],v[26:27]
v_pk_add_f32 v[28:29],v[28:29],v[82:83]
v_pk_fma_f32 v[26:27],v[82:83],v[82:83],v[26:27]
v_pk_add_f32 v[28:29],v[28:29],v[84:85]
v_pk_fma_f32 v[26:27],v[84:85],v[84:85],v[26:27]
v_pk_add_f32 v[28:29],v[28:29],v[86:87]
v_pk_fma_f32 v[26:27],v[86:87],v[86:87],v[26:27]
v_pk_add_f32 v[28:29],v[28:29],v[88:89]
v_pk_fma_f32 v[26:27],v[88:89],v[88:89],v[26:27]
v_pk_add_f32 v[28:29],v[28:29],v[90:91]
v_pk_fma_f32 v[26:27],v[90:91],v[90:91],v[26:27]
v_pk_add_f32 v[28:29],v[28:29],v[92:93]
v_pk_fma_f32 v[26:27],v[92:93],v[92:93],v[26:27]
v_pk_add_f32 v[28:29],v[28:29],v[94:95]
v_pk_fma_f32 v[26:27],v[94:95],v[94:95],v[26:27]
v_pk_add_f32 v[28:29],v[28:29],v[96:97]
v_pk_fma_f32 v[26:27],v[96:97],v[96:97],v[26:27]
v_pk_add_f32 v[28:29],v[28:29],v[98:99]
v_pk_fma_f32 v[26:27],v[98:99],v[98:99],v[26:27]
v_pk_add_f32 v[28:29],v[28:29],v[100:101]
v_pk_fma_f32 v[26:27],v[100:101],v[100:101],v[26:27]
v_pk_add_f32 v[28:29],v[28:29],v[102:103]
v_pk_fma_f32 v[26:27],v[102:103],v[102:103],v[26:27]
v_pk_add_f32 v[28:29],v[28:29],v[104:105]
v_pk_fma_f32 v[26:27],v[104:105],v[104:105],v[26:27]
v_pk_add_f32 v[28:29],v[28:29],v[106:107]
v_pk_fma_f32 v[26:27],v[106:107],v[106:107],v[26:27]
v_pk_add_f32 v[28:29],v[28:29],v[108:109]
v_pk_fma_f32 v[26:27],v[108:109],v[108:109],v[26:27]
v_pk_add_f32 v[28:29],v[28:29],v[110:111]
v_pk_fma_f32 v[26:27],v[110:111],v[110:111],v[26:27]
v_add_f32 v24,v28,v29
v_add_f32 v25,v26,v27
s_nop 0
v_add_f32_dpp v24,v24,v24 row_ror:4 row_mask:0xf bank_mask:0xf
v_add_f32_dpp v25,v25,v25 row_ror:4 row_mask:0xf bank_mask:0xf
s_nop 0
v_add_f32_dpp v24,v24,v24 row_ror:8 row_mask:0xf bank_mask:0xf
v_add_f32_dpp v25,v25,v25 row_ror:8 row_mask:0xf bank_mask:0xf
v_mov_b32 v26,v24
v_mov_b32 v27,v25
s_nop 0
v_permlane32_swap_b32 v24,v26
v_permlane32_swap_b32 v25,v27
v_add_f32 v24,v24,v26
v_add_f32 v25,v25,v27
v_mov_b32 v26,v24
v_mov_b32 v27,v25
s_nop 0
v_permlane16_swap_b32 v24,v26
v_permlane16_swap_b32 v25,v27
v_add_f32 v24,v24,v26
v_add_f32 v25,v25,v27
v_mul_f32 v24,0x3acccccd,v24
v_mul_f32 v25,0x3acccccd,v25
v_fma_f32 v25,-v24,v24,v25
v_max_f32 v25,0,v25
v_cvt_pk_bf16_f32 v6,v24,v25
v_lshlrev_b32 v24,16,v6
v_and_b32 v25,0xffff0000,v6
v_add_f32 v25,0x3727c5ac,v25
v_cvt_pk_bf16_f32 v6,v25,v25
v_lshlrev_b32 v25,16,v6
v_sqrt_f32 v25,v25
s_nop 0
v_cvt_pk_bf16_f32 v6,v25,v25
v_lshlrev_b32 v25,16,v6
v_rcp_f32 v25,v25
s_nop 0
v_pk_add_f32 v[72:73],v[72:73],v[24:25] op_sel_hi:[1,0] neg_lo:[0,1] neg_hi:[0,1]
v_pk_add_f32 v[74:75],v[74:75],v[24:25] op_sel_hi:[1,0] neg_lo:[0,1] neg_hi:[0,1]
v_pk_add_f32 v[76:77],v[76:77],v[24:25] op_sel_hi:[1,0] neg_lo:[0,1] neg_hi:[0,1]
v_pk_add_f32 v[78:79],v[78:79],v[24:25] op_sel_hi:[1,0] neg_lo:[0,1] neg_hi:[0,1]
v_pk_add_f32 v[80:81],v[80:81],v[24:25] op_sel_hi:[1,0] neg_lo:[0,1] neg_hi:[0,1]
v_pk_add_f32 v[82:83],v[82:83],v[24:25] op_sel_hi:[1,0] neg_lo:[0,1] neg_hi:[0,1]
v_pk_add_f32 v[84:85],v[84:85],v[24:25] op_sel_hi:[1,0] neg_lo:[0,1] neg_hi:[0,1]
v_pk_add_f32 v[86:87],v[86:87],v[24:25] op_sel_hi:[1,0] neg_lo:[0,1] neg_hi:[0,1]
v_pk_add_f32 v[88:89],v[88:89],v[24:25] op_sel_hi:[1,0] neg_lo:[0,1] neg_hi:[0,1]
v_pk_add_f32 v[90:91],v[90:91],v[24:25] op_sel_hi:[1,0] neg_lo:[0,1] neg_hi:[0,1]
v_pk_add_f32 v[92:93],v[92:93],v[24:25] op_sel_hi:[1,0] neg_lo:[0,1] neg_hi:[0,1]
v_pk_add_f32 v[94:95],v[94:95],v[24:25] op_sel_hi:[1,0] neg_lo:[0,1] neg_hi:[0,1]
v_pk_add_f32 v[96:97],v[96:97],v[24:25] op_sel_hi:[1,0] neg_lo:[0,1] neg_hi:[0,1]
v_pk_add_f32 v[98:99],v[98:99],v[24:25] op_sel_hi:[1,0] neg_lo:[0,1] neg_hi:[0,1]
v_pk_add_f32 v[100:101],v[100:101],v[24:25] op_sel_hi:[1,0] neg_lo:[0,1] neg_hi:[0,1]
v_pk_add_f32 v[102:103],v[102:103],v[24:25] op_sel_hi:[1,0] neg_lo:[0,1] neg_hi:[0,1]
v_pk_add_f32 v[104:105],v[104:105],v[24:25] op_sel_hi:[1,0] neg_lo:[0,1] neg_hi:[0,1]
v_pk_add_f32 v[106:107],v[106:107],v[24:25] op_sel_hi:[1,0] neg_lo:[0,1] neg_hi:[0,1]
v_pk_add_f32 v[108:109],v[108:109],v[24:25] op_sel_hi:[1,0] neg_lo:[0,1] neg_hi:[0,1]
v_pk_add_f32 v[110:111],v[110:111],v[24:25] op_sel_hi:[1,0] neg_lo:[0,1] neg_hi:[0,1]
v_cvt_pk_bf16_f32 v6,v72,v73
v_lshlrev_b32 v72,16,v6
v_and_b32 v73,0xffff0000,v6
v_cvt_pk_bf16_f32 v8,v74,v75
v_lshlrev_b32 v74,16,v8
v_and_b32 v75,0xffff0000,v8
v_cvt_pk_bf16_f32 v6,v76,v77
v_lshlrev_b32 v76,16,v6
v_and_b32 v77,0xffff0000,v6
v_cvt_pk_bf16_f32 v8,v78,v79
v_lshlrev_b32 v78,16,v8
v_and_b32 v79,0xffff0000,v8
v_cvt_pk_bf16_f32 v6,v80,v81
v_lshlrev_b32 v80,16,v6
v_and_b32 v81,0xffff0000,v6
v_cvt_pk_bf16_f32 v8,v82,v83
v_lshlrev_b32 v82,16,v8
v_and_b32 v83,0xffff0000,v8
v_cvt_pk_bf16_f32 v6,v84,v85
v_lshlrev_b32 v84,16,v6
v_and_b32 v85,0xffff0000,v6
v_cvt_pk_bf16_f32 v8,v86,v87
v_lshlrev_b32 v86,16,v8
v_and_b32 v87,0xffff0000,v8
v_cvt_pk_bf16_f32 v6,v88,v89
v_lshlrev_b32 v88,16,v6
v_and_b32 v89,0xffff0000,v6
v_cvt_pk_bf16_f32 v8,v90,v91
v_lshlrev_b32 v90,16,v8
v_and_b32 v91,0xffff0000,v8
v_cvt_pk_bf16_f32 v6,v92,v93
v_lshlrev_b32 v92,16,v6
v_and_b32 v93,0xffff0000,v6
v_cvt_pk_bf16_f32 v8,v94,v95
v_lshlrev_b32 v94,16,v8
v_and_b32 v95,0xffff0000,v8
v_cvt_pk_bf16_f32 v6,v96,v97
v_lshlrev_b32 v96,16,v6
v_and_b32 v97,0xffff0000,v6
v_cvt_pk_bf16_f32 v8,v98,v99
v_lshlrev_b32 v98,16,v8
v_and_b32 v99,0xffff0000,v8
v_cvt_pk_bf16_f32 v6,v100,v101
v_lshlrev_b32 v100,16,v6
v_and_b32 v101,0xffff0000,v6
v_cvt_pk_bf16_f32 v8,v102,v103
v_lshlrev_b32 v102,16,v8
v_and_b32 v103,0xffff0000,v8
v_cvt_pk_bf16_f32 v6,v104,v105
v_lshlrev_b32 v104,16,v6
v_and_b32 v105,0xffff0000,v6
v_cvt_pk_bf16_f32 v8,v106,v107
v_lshlrev_b32 v106,16,v8
v_and_b32 v107,0xffff0000,v8
v_cvt_pk_bf16_f32 v6,v108,v109
v_lshlrev_b32 v108,16,v6
v_and_b32 v109,0xffff0000,v6
v_cvt_pk_bf16_f32 v8,v110,v111
v_lshlrev_b32 v110,16,v8
v_and_b32 v111,0xffff0000,v8
v_pk_mul_f32 v[72:73],v[72:73],v[24:25] op_sel:[0,1] op_sel_hi:[1,1]
v_pk_mul_f32 v[74:75],v[74:75],v[24:25] op_sel:[0,1] op_sel_hi:[1,1]
v_pk_mul_f32 v[76:77],v[76:77],v[24:25] op_sel:[0,1] op_sel_hi:[1,1]
v_pk_mul_f32 v[78:79],v[78:79],v[24:25] op_sel:[0,1] op_sel_hi:[1,1]
v_pk_mul_f32 v[80:81],v[80:81],v[24:25] op_sel:[0,1] op_sel_hi:[1,1]
v_pk_mul_f32 v[82:83],v[82:83],v[24:25] op_sel:[0,1] op_sel_hi:[1,1]
v_pk_mul_f32 v[84:85],v[84:85],v[24:25] op_sel:[0,1] op_sel_hi:[1,1]
v_pk_mul_f32 v[86:87],v[86:87],v[24:25] op_sel:[0,1] op_sel_hi:[1,1]
v_pk_mul_f32 v[88:89],v[88:89],v[24:25] op_sel:[0,1] op_sel_hi:[1,1]
v_pk_mul_f32 v[90:91],v[90:91],v[24:25] op_sel:[0,1] op_sel_hi:[1,1]
v_pk_mul_f32 v[92:93],v[92:93],v[24:25] op_sel:[0,1] op_sel_hi:[1,1]
v_pk_mul_f32 v[94:95],v[94:95],v[24:25] op_sel:[0,1] op_sel_hi:[1,1]
v_pk_mul_f32 v[96:97],v[96:97],v[24:25] op_sel:[0,1] op_sel_hi:[1,1]
v_pk_mul_f32 v[98:99],v[98:99],v[24:25] op_sel:[0,1] op_sel_hi:[1,1]
v_pk_mul_f32 v[100:101],v[100:101],v[24:25] op_sel:[0,1] op_sel_hi:[1,1]
v_pk_mul_f32 v[102:103],v[102:103],v[24:25] op_sel:[0,1] op_sel_hi:[1,1]
v_pk_mul_f32 v[104:105],v[104:105],v[24:25] op_sel:[0,1] op_sel_hi:[1,1]
v_pk_mul_f32 v[106:107],v[106:107],v[24:25] op_sel:[0,1] op_sel_hi:[1,1]
v_pk_mul_f32 v[108:109],v[108:109],v[24:25] op_sel:[0,1] op_sel_hi:[1,1]
v_pk_mul_f32 v[110:111],v[110:111],v[24:25] op_sel:[0,1] op_sel_hi:[1,1]
v_cvt_pk_bf16_f32 v112,v72,v73
v_lshlrev_b32 v72,16,v112
v_and_b32 v73,0xffff0000,v112
v_cvt_pk_bf16_f32 v113,v74,v75
v_lshlrev_b32 v74,16,v113
v_and_b32 v75,0xffff0000,v113
v_cvt_pk_bf16_f32 v114,v76,v77
v_lshlrev_b32 v76,16,v114
v_and_b32 v77,0xffff0000,v114
v_cvt_pk_bf16_f32 v115,v78,v79
v_lshlrev_b32 v78,16,v115
v_and_b32 v79,0xffff0000,v115
v_cvt_pk_bf16_f32 v116,v80,v81
v_lshlrev_b32 v80,16,v116
v_and_b32 v81,0xffff0000,v116
v_cvt_pk_bf16_f32 v117,v82,v83
v_lshlrev_b32 v82,16,v117
v_and_b32 v83,0xffff0000,v117
v_cvt_pk_bf16_f32 v118,v84,v85
v_lshlrev_b32 v84,16,v118
v_and_b32 v85,0xffff0000,v118
v_cvt_pk_bf16_f32 v119,v86,v87
v_lshlrev_b32 v86,16,v119
v_and_b32 v87,0xffff0000,v119
v_cvt_pk_bf16_f32 v120,v88,v89
v_lshlrev_b32 v88,16,v120
v_and_b32 v89,0xffff0000,v120
v_cvt_pk_bf16_f32 v121,v90,v91
v_lshlrev_b32 v90,16,v121
v_and_b32 v91,0xffff0000,v121
v_cvt_pk_bf16_f32 v122,v92,v93
v_lshlrev_b32 v92,16,v122
v_and_b32 v93,0xffff0000,v122
v_cvt_pk_bf16_f32 v123,v94,v95
v_lshlrev_b32 v94,16,v123
v_and_b32 v95,0xffff0000,v123
v_cvt_pk_bf16_f32 v124,v96,v97
v_lshlrev_b32 v96,16,v124
v_and_b32 v97,0xffff0000,v124
v_cvt_pk_bf16_f32 v125,v98,v99
v_lshlrev_b32 v98,16,v125
v_and_b32 v99,0xffff0000,v125
v_cvt_pk_bf16_f32 v126,v100,v101
v_lshlrev_b32 v100,16,v126
v_and_b32 v101,0xffff0000,v126
v_cvt_pk_bf16_f32 v127,v102,v103
v_lshlrev_b32 v102,16,v127
v_and_b32 v103,0xffff0000,v127
v_cvt_pk_bf16_f32 v128,v104,v105
v_lshlrev_b32 v104,16,v128
v_and_b32 v105,0xffff0000,v128
v_cvt_pk_bf16_f32 v129,v106,v107
v_lshlrev_b32 v106,16,v129
v_and_b32 v107,0xffff0000,v129
v_cvt_pk_bf16_f32 v130,v108,v109
v_lshlrev_b32 v108,16,v130
v_and_b32 v109,0xffff0000,v130
v_cvt_pk_bf16_f32 v131,v110,v111
v_lshlrev_b32 v110,16,v131
v_and_b32 v111,0xffff0000,v131
s_add_u32 s63,s65,0
v_permlane16_swap_b32 v112,v114
v_permlane16_swap_b32 v113,v115
buffer_store_dwordx4 v[112:115],v132,s[8:11],s63 offen sc1
s_add_u32 s63,s65,8192
v_permlane16_swap_b32 v116,v118
v_permlane16_swap_b32 v117,v119
buffer_store_dwordx4 v[116:119],v132,s[8:11],s63 offen sc1
s_add_u32 s63,s65,16384
v_permlane16_swap_b32 v120,v122
v_permlane16_swap_b32 v121,v123
buffer_store_dwordx4 v[120:123],v132,s[8:11],s63 offen sc1
s_add_u32 s63,s65,24576
v_permlane16_swap_b32 v124,v126
v_permlane16_swap_b32 v125,v127
buffer_store_dwordx4 v[124:127],v132,s[8:11],s63 offen sc1
s_add_u32 s63,s65,32768
v_permlane16_swap_b32 v128,v130
v_permlane16_swap_b32 v129,v131
buffer_store_dwordx4 v[128:131],v132,s[8:11],s63 offen sc1
s_add_u32 s63,s64,0
v_permlane16_swap_b32 v52,v54
v_permlane16_swap_b32 v53,v55
buffer_store_dwordx4 v[52:55],v132,s[8:11],s63 offen sc1
s_add_u32 s63,s64,8192
v_permlane16_swap_b32 v56,v58
v_permlane16_swap_b32 v57,v59
buffer_store_dwordx4 v[56:59],v132,s[8:11],s63 offen sc1
s_add_u32 s63,s64,16384
v_permlane16_swap_b32 v60,v62
v_permlane16_swap_b32 v61,v63
buffer_store_dwordx4 v[60:63],v132,s[8:11],s63 offen sc1
s_add_u32 s63,s64,24576
v_permlane16_swap_b32 v64,v66
v_permlane16_swap_b32 v65,v67
buffer_store_dwordx4 v[64:67],v132,s[8:11],s63 offen sc1
s_add_u32 s63,s64,32768
v_permlane16_swap_b32 v68,v70
v_permlane16_swap_b32 v69,v71
buffer_store_dwordx4 v[68:71],v132,s[8:11],s63 offen sc1
s_lshl_b32 s82,s55,6
s_add_u32 s82,s82,s54
s_lshl_b32 s82,s82,9
s_add_u32 s82,s82,0
s_lshl_b32 s61,s53,2
s_add_u32 s82,s82,s61
s_add_u32 s54,s54,16
s_cmp_lt_u32 s54,64
s_cbranch_scc1 R0_LOOPA
R0_ENDA:
s_waitcnt vmcnt(0)
s_mov_b64 exec,1
buffer_store_dword v5,v1,s[8:11],s82 offen sc1
s_mov_b64 exec,-1
s_mov_b32 s52,s86
s_mul_i32 s60,s86,196608
s_add_u32 s69,s69,s60
s_mul_i32 s60,s86,1024
s_add_u32 s70,s70,s60
v_mov_b32 v231,0
s_mov_b32 s83,s100
s_nop 0
ATT_LOOP:
s_lshl_b32 s67,s51,6
s_add_u32 s67,s67,s52
s_lshl_b32 s67,s67,9
s_add_u32 s67,s67,65536
s_mul_i32 s66,s52,393216
s_add_u32 s66,s66,s71
v_cmp_eq_u32 vcc,0,v231
s_nop 0
s_cbranch_vccz ATT_RDY
fb_273:
buffer_load_dword v3,v2,s[8:11],s67 offen sc1
s_waitcnt vmcnt(0)
v_cmp_eq_u32 vcc,0,v3
s_nop 0
s_cbranch_vccz ok_274
s_sleep 20
s_sub_u32 s47,s47,1
s_cbranch_scc1 ABORT
s_branch fb_273
ok_274:
ATT_RDY:
s_add_u32 s63,s66,124780544
buffer_load_dwordx4 v[16:19],v1,s[8:11],s63 offen sc1
buffer_load_dwordx4 v[20:23],v1,s[8:11],s63 offen offset:1024 sc1
buffer_load_dwordx4 v[24:27],v1,s[8:11],s63 offen offset:2048 sc1
buffer_load_dwordx4 v[28:31],v1,s[8:11],s63 offen offset:3072 sc1
s_add_u32 s63,s66,124784640
buffer_load_dwordx4 v[32:35],v1,s[8:11],s63 offen sc1
buffer_load_dwordx4 v[36:39],v1,s[8:11],s63 offen offset:1024 sc1
buffer_load_dwordx4 v[40:43],v1,s[8:11],s63 offen offset:2048 sc1
buffer_load_dwordx4 v[44:47],v1,s[8:11],s63 offen offset:3072 sc1
s_add_u32 s63,s66,124788736
buffer_load_dwordx4 v[48:51],v1,s[8:11],s63 offen sc1
buffer_load_dwordx4 v[52:55],v1,s[8:11],s63 offen offset:1024 sc1
buffer_load_dwordx4 v[56:59],v1,s[8:11],s63 offen offset:2048 sc1
buffer_load_dwordx4 v[60:63],v1,s[8:11],s63 offen offset:3072 sc1
s_add_u32 s63,s66,74448896
buffer_load_dwordx4 v[64:67],v1,s[8:11],s63 offen sc1
buffer_load_dwordx4 v[68:71],v1,s[8:11],s63 offen offset:1024 sc1
buffer_load_dwordx4 v[72:75],v1,s[8:11],s63 offen offset:2048 sc1
buffer_load_dwordx4 v[76:79],v1,s[8:11],s63 offen offset:3072 sc1
s_add_u32 s63,s66,74452992
buffer_load_dwordx4 v[80:83],v1,s[8:11],s63 offen sc1
buffer_load_dwordx4 v[84:87],v1,s[8:11],s63 offen offset:1024 sc1
buffer_load_dwordx4 v[88:91],v1,s[8:11],s63 offen offset:2048 sc1
buffer_load_dwordx4 v[92:95],v1,s[8:11],s63 offen offset:3072 sc1
s_add_u32 s63,s66,74457088
buffer_load_dwordx4 v[96:99],v1,s[8:11],s63 offen sc1
buffer_load_dwordx4 v[100:103],v1,s[8:11],s63 offen offset:1024 sc1
buffer_load_dwordx4 v[104:107],v1,s[8:11],s63 offen offset:2048 sc1
buffer_load_dwordx4 v[108:111],v1,s[8:11],s63 offen offset:3072 sc1
s_add_u32 s63,s66,99614720
buffer_load_dwordx4 v[112:115],v1,s[8:11],s63 offen sc1
buffer_load_dwordx4 v[116:119],v1,s[8:11],s63 offen offset:1024 sc1
buffer_load_dwordx4 v[120:123],v1,s[8:11],s63 offen offset:2048 sc1
buffer_load_dwordx4 v[124:127],v1,s[8:11],s63 offen offset:3072 sc1
s_add_u32 s63,s66,99618816
buffer_load_dwordx4 v[128:131],v1,s[8:11],s63 offen sc1
buffer_load_dwordx4 v[132:135],v1,s[8:11],s63 offen offset:1024 sc1
buffer_load_dwordx4 v[136:139],v1,s[8:11],s63 offen offset:2048 sc1
buffer_load_dwordx4 v[140:143],v1,s[8:11],s63 offen offset:3072 sc1
s_add_u32 s63,s66,99622912
buffer_load_dwordx4 v[144:147],v1,s[8:11],s63 offen sc1
buffer_load_dwordx4 v[148:151],v1,s[8:11],s63 offen offset:1024 sc1
buffer_load_dwordx4 v[152:155],v1,s[8:11],s63 offen offset:2048 sc1
buffer_load_dwordx4 v[156:159],v1,s[8:11],s63 offen offset:3072 sc1
v_lshlrev_b32 v232,7,v0
s_add_u32 s63,s66,149946368
buffer_load_dword v233,v232,s[8:11],s63 offen sc1
s_add_u32 s63,s66,149950464
buffer_load_dword v233,v232,s[8:11],s63 offen sc1
s_waitcnt vmcnt(14)
v_mfma_f32_16x16x32_bf16 v[184:187],v[64:67],v[16:19],0
v_mfma_f32_16x16x32_bf16 v[188:191],v[64:67],v[20:23],0
v_mfma_f32_16x16x32_bf16 v[192:195],v[68:71],v[20:23],0
v_mfma_f32_16x16x32_bf16 v[184:187],v[72:75],v[24:27],v[184:187]
v_mfma_f32_16x16x32_bf16 v[188:191],v[72:75],v[28:31],v[188:191]
v_mfma_f32_16x16x32_bf16 v[192:195],v[76:79],v[28:31],v[192:195]
v_mfma_f32_16x16x32_bf16 v[184:187],v[80:83],v[32:35],v[184:187]
v_mfma_f32_16x16x32_bf16 v[188:191],v[80:83],v[36:39],v[188:191]
v_mfma_f32_16x16x32_bf16 v[192:195],v[84:87],v[36:39],v[192:195]
v_mfma_f32_16x16x32_bf16 v[184:187],v[88:91],v[40:43],v[184:187]
v_mfma_f32_16x16x32_bf16 v[188:191],v[88:91],v[44:47],v[188:191]
v_mfma_f32_16x16x32_bf16 v[192:195],v[92:95],v[44:47],v[192:195]
v_mfma_f32_16x16x32_bf16 v[184:187],v[96:99],v[48:51],v[184:187]
v_mfma_f32_16x16x32_bf16 v[188:191],v[96:99],v[52:55],v[188:191]
v_mfma_f32_16x16x32_bf16 v[192:195],v[100:103],v[52:55],v[192:195]
v_mfma_f32_16x16x32_bf16 v[184:187],v[104:107],v[56:59],v[184:187]
v_mfma_f32_16x16x32_bf16 v[188:191],v[104:107],v[60:63],v[188:191]
v_mfma_f32_16x16x32_bf16 v[192:195],v[108:111],v[60:63],v[192:195]
s_nop 5
v_cvt_pk_bf16_f32 v6,v184,v185
v_lshlrev_b32 v184,16,v6
v_and_b32 v185,0xffff0000,v6
v_cvt_pk_bf16_f32 v6,v186,v187
v_lshlrev_b32 v186,16,v6
v_and_b32 v187,0xffff0000,v6
v_cvt_pk_bf16_f32 v6,v188,v189
v_lshlrev_b32 v188,16,v6
v_and_b32 v189,0xffff0000,v6
v_cvt_pk_bf16_f32 v6,v190,v191
v_lshlrev_b32 v190,16,v6
v_and_b32 v191,0xffff0000,v6
v_cvt_pk_bf16_f32 v6,v192,v193
v_lshlrev_b32 v192,16,v6
v_and_b32 v193,0xffff0000,v6
v_cvt_pk_bf16_f32 v6,v194,v195
v_lshlrev_b32 v194,16,v6
v_and_b32 v195,0xffff0000,v6
v_mul_f32 v184,s84,v184
v_mul_f32 v185,s84,v185
v_mul_f32 v186,s84,v186
v_mul_f32 v187,s84,v187
v_mul_f32 v188,s84,v188
v_mul_f32 v189,s84,v189
v_mul_f32 v190,s84,v190
v_mul_f32 v191,s84,v191
v_mul_f32 v192,s84,v192
v_mul_f32 v193,s84,v193
v_mul_f32 v194,s84,v194
v_mul_f32 v195,s84,v195
v_cvt_pk_bf16_f32 v6,v184,v185
v_lshlrev_b32 v184,16,v6
v_and_b32 v185,0xffff0000,v6
v_cvt_pk_bf16_f32 v6,v186,v187
v_lshlrev_b32 v186,16,v6
v_and_b32 v187,0xffff0000,v6
v_cvt_pk_bf16_f32 v6,v188,v189
v_lshlrev_b32 v188,16,v6
v_and_b32 v189,0xffff0000,v6
v_cvt_pk_bf16_f32 v6,v190,v191
v_lshlrev_b32 v190,16,v6
v_and_b32 v191,0xffff0000,v6
v_cvt_pk_bf16_f32 v6,v192,v193
v_lshlrev_b32 v192,16,v6
v_and_b32 v193,0xffff0000,v6
v_cvt_pk_bf16_f32 v6,v194,v195
v_lshlrev_b32 v194,16,v6
v_and_b32 v195,0xffff0000,v6
v_cndmask_b32 v184,v230,v184,s[72:73]
v_cndmask_b32 v185,v230,v185,s[74:75]
v_cndmask_b32 v186,v230,v186,s[76:77]
v_cndmask_b32 v187,v230,v187,s[78:79]
v_cndmask_b32 v192,v230,v192,s[72:73]
v_cndmask_b32 v193,v230,v193,s[74:75]
v_cndmask_b32 v194,v230,v194,s[76:77]
v_cndmask_b32 v195,v230,v195,s[78:79]
s_nop 1
fb_275:
buffer_load_dword v3,v228,s[8:11],s70 offen sc1
s_waitcnt vmcnt(0)
v_cmp_eq_u32 vcc,0,v3
s_nop 0
s_cbranch_vccz ok_276
s_sleep 10
s_sub_u32 s47,s47,1
s_cbranch_scc1 ABORT
s_branch fb_275
ok_276:
buffer_load_dwordx4 v[160:163],v1,s[8:11],s69 offen sc1
buffer_load_dwordx4 v[164:167],v1,s[8:11],s69 offen offset:1024 sc1
buffer_load_dwordx4 v[168:171],v1,s[8:11],s69 offen offset:2048 sc1
s_add_u32 s63,s69,3072
buffer_load_dwordx4 v[172:175],v1,s[8:11],s63 offen sc1
buffer_load_dwordx4 v[176:179],v1,s[8:11],s63 offen offset:1024 sc1
buffer_load_dwordx4 v[180:183],v1,s[8:11],s63 offen offset:2048 sc1
buffer_load_dword v231,v2,s[8:11],s67 offen offset:1024 sc1
s_waitcnt vmcnt(4)
v_mfma_f32_16x16x32_bf16 v[196:199],v[160:163],v[16:19],0
v_mfma_f32_16x16x32_bf16 v[200:203],v[160:163],v[24:27],0
v_mfma_f32_16x16x32_bf16 v[204:207],v[160:163],v[20:23],0
v_mfma_f32_16x16x32_bf16 v[208:211],v[160:163],v[28:31],0
v_mfma_f32_16x16x32_bf16 v[196:199],v[164:167],v[32:35],v[196:199]
v_mfma_f32_16x16x32_bf16 v[200:203],v[164:167],v[40:43],v[200:203]
v_mfma_f32_16x16x32_bf16 v[204:207],v[164:167],v[36:39],v[204:207]
v_mfma_f32_16x16x32_bf16 v[208:211],v[164:167],v[44:47],v[208:211]
v_mfma_f32_16x16x32_bf16 v[196:199],v[168:171],v[48:51],v[196:199]
v_mfma_f32_16x16x32_bf16 v[200:203],v[168:171],v[56:59],v[200:203]
v_mfma_f32_16x16x32_bf16 v[204:207],v[168:171],v[52:55],v[204:207]
v_mfma_f32_16x16x32_bf16 v[208:211],v[168:171],v[60:63],v[208:211]
s_nop 4
v_permlane32_swap_b32 v196,v197
v_permlane32_swap_b32 v200,v201
v_permlane32_swap_b32 v198,v199
v_permlane32_swap_b32 v202,v203
v_add_f32 v196,v196,v201
v_add_f32 v197,v198,v203
v_permlane32_swap_b32 v204,v205
v_permlane32_swap_b32 v208,v209
v_permlane32_swap_b32 v206,v207
v_permlane32_swap_b32 v210,v211
v_add_f32 v204,v204,v209
v_add_f32 v205,v206,v211
v_cvt_pk_bf16_f32 v6,v196,v197
v_lshlrev_b32 v196,16,v6
v_and_b32 v197,0xffff0000,v6
v_cvt_pk_bf16_f32 v6,v204,v205
v_lshlrev_b32 v204,16,v6
v_and_b32 v205,0xffff0000,v6
v_mul_f32 v196,s84,v196
v_mul_f32 v197,s84,v197
v_mul_f32 v204,s84,v204
v_mul_f32 v205,s84,v205
v_cvt_pk_bf16_f32 v6,v196,v197
v_lshlrev_b32 v196,16,v6
v_and_b32 v197,0xffff0000,v6
v_cvt_pk_bf16_f32 v6,v204,v205
v_lshlrev_b32 v204,16,v6
v_and_b32 v205,0xffff0000,v6
v_max3_f32 v6,v184,v185,v186
v_max3_f32 v6,v6,v187,v196
v_max_f32 v6,v6,v197
v_mov_b32 v7,v6
s_nop 1
v_permlane32_swap_b32 v6,v7
v_max_f32 v6,v6,v7
v_mov_b32 v7,v6
s_nop 1
v_permlane16_swap_b32 v6,v7
v_max_f32 v6,v6,v7
v_mul_f32 v6,s85,v6
v_fma_f32 v184,v184,s85,-v6
v_fma_f32 v185,v185,s85,-v6
v_fma_f32 v186,v186,s85,-v6
v_fma_f32 v187,v187,s85,-v6
v_fma_f32 v196,v196,s85,-v6
v_fma_f32 v197,v197,s85,-v6
v_exp_f32 v184,v184
v_exp_f32 v185,v185
v_exp_f32 v186,v186
v_exp_f32 v187,v187
v_exp_f32 v196,v196
v_exp_f32 v197,v197
v_add_f32 v6,v184,v185
v_add_f32 v6,v6,v186
v_add_f32 v6,v6,v187
v_add_f32 v6,v6,v196
v_add_f32 v6,v6,v197
v_mov_b32 v7,v6
s_nop 1
v_permlane32_swap_b32 v6,v7
v_add_f32 v6,v6,v7
v_mov_b32 v7,v6
s_nop 1
v_permlane16_swap_b32 v6,v7
v_add_f32 v6,v6,v7
v_rcp_f32 v6,v6
s_nop 0
v_mul_f32 v184,v184,v6
v_mul_f32 v185,v185,v6
v_mul_f32 v186,v186,v6
v_mul_f32 v187,v187,v6
v_mul_f32 v196,v196,v6
v_mul_f32 v197,v197,v6
v_cvt_pk_bf16_f32 v212,v184,v185
v_cvt_pk_bf16_f32 v213,v186,v187
v_mov_b32 v214,0
v_mov_b32 v215,0
v_cvt_pk_bf16_f32 v216,v196,v197
v_mov_b32 v217,0
v_mov_b32 v218,0
v_cvt_pk_bf16_f32 v219,v196,v197
v_max3_f32 v8,v188,v189,v190
v_max3_f32 v8,v8,v191,v192
v_max3_f32 v8,v8,v193,v194
v_max3_f32 v8,v8,v195,v204
v_max_f32 v8,v8,v205
v_mov_b32 v9,v8
s_nop 1
v_permlane32_swap_b32 v8,v9
v_max_f32 v8,v8,v9
v_mov_b32 v9,v8
s_nop 1
v_permlane16_swap_b32 v8,v9
v_max_f32 v8,v8,v9
v_mul_f32 v8,s85,v8
v_fma_f32 v188,v188,s85,-v8
v_fma_f32 v189,v189,s85,-v8
v_fma_f32 v190,v190,s85,-v8
v_fma_f32 v191,v191,s85,-v8
v_fma_f32 v192,v192,s85,-v8
v_fma_f32 v193,v193,s85,-v8
v_fma_f32 v194,v194,s85,-v8
v_fma_f32 v195,v195,s85,-v8
v_fma_f32 v204,v204,s85,-v8
v_fma_f32 v205,v205,s85,-v8
v_exp_f32 v188,v188
v_exp_f32 v189,v189
v_exp_f32 v190,v190
v_exp_f32 v191,v191
v_exp_f32 v192,v192
v_exp_f32 v193,v193
v_exp_f32 v194,v194
v_exp_f32 v195,v195
v_exp_f32 v204,v204
v_exp_f32 v205,v205
v_add_f32 v8,v188,v189
v_add_f32 v8,v8,v190
v_add_f32 v8,v8,v191
v_add_f32 v8,v8,v192
v_add_f32 v8,v8,v193
v_add_f32 v8,v8,v194
v_add_f32 v8,v8,v195
v_add_f32 v8,v8,v204
v_add_f32 v8,v8,v205
v_mov_b32 v9,v8
s_nop 1
v_permlane32_swap_b32 v8,v9
v_add_f32 v8,v8,v9
v_mov_b32 v9,v8
s_nop 1
v_permlane16_swap_b32 v8,v9
v_add_f32 v8,v8,v9
v_rcp_f32 v8,v8
s_nop 0
v_mul_f32 v188,v188,v8
v_mul_f32 v189,v189,v8
v_mul_f32 v190,v190,v8
v_mul_f32 v191,v191,v8
v_mul_f32 v192,v192,v8
v_mul_f32 v193,v193,v8
v_mul_f32 v194,v194,v8
v_mul_f32 v195,v195,v8
v_mul_f32 v204,v204,v8
v_mul_f32 v205,v205,v8
v_cvt_pk_bf16_f32 v220,v188,v189
v_cvt_pk_bf16_f32 v221,v190,v191
v_cvt_pk_bf16_f32 v222,v192,v193
v_cvt_pk_bf16_f32 v223,v194,v195
v_cvt_pk_bf16_f32 v224,v204,v205
v_mov_b32 v225,0
v_mov_b32 v226,0
v_cvt_pk_bf16_f32 v227,v204,v205
s_waitcnt vmcnt(1)
s_add_u32 s66,s66,149946368
v_mfma_f32_16x16x32_bf16 v[16:19],v[112:115],v[212:215],0
v_mfma_f32_16x16x32_bf16 v[20:23],v[116:119],v[212:215],0
v_mfma_f32_16x16x32_bf16 v[24:27],v[120:123],v[212:215],0
v_mfma_f32_16x16x32_bf16 v[28:31],v[124:127],v[212:215],0
v_mfma_f32_16x16x32_bf16 v[32:35],v[128:131],v[212:215],0
v_mfma_f32_16x16x32_bf16 v[36:39],v[132:135],v[212:215],0
v_mfma_f32_16x16x32_bf16 v[40:43],v[136:139],v[212:215],0
v_mfma_f32_16x16x32_bf16 v[44:47],v[140:143],v[212:215],0
v_mfma_f32_16x16x32_bf16 v[48:51],v[144:147],v[212:215],0
v_mfma_f32_16x16x32_bf16 v[52:55],v[148:151],v[212:215],0
v_mfma_f32_16x16x32_bf16 v[56:59],v[152:155],v[212:215],0
v_mfma_f32_16x16x32_bf16 v[60:63],v[156:159],v[212:215],0
v_mfma_f32_16x16x16_bf16 v[16:19],v[172:173],v[216:217],v[16:19]
v_mfma_f32_16x16x16_bf16 v[20:23],v[172:173],v[218:219],v[20:23]
v_mfma_f32_16x16x16_bf16 v[24:27],v[174:175],v[216:217],v[24:27]
v_mfma_f32_16x16x16_bf16 v[28:31],v[174:175],v[218:219],v[28:31]
v_mfma_f32_16x16x16_bf16 v[32:35],v[176:177],v[216:217],v[32:35]
v_mfma_f32_16x16x16_bf16 v[36:39],v[176:177],v[218:219],v[36:39]
v_mfma_f32_16x16x16_bf16 v[40:43],v[178:179],v[216:217],v[40:43]
v_mfma_f32_16x16x16_bf16 v[44:47],v[178:179],v[218:219],v[44:47]
v_mfma_f32_16x16x16_bf16 v[48:51],v[180:181],v[216:217],v[48:51]
v_mfma_f32_16x16x16_bf16 v[52:55],v[180:181],v[218:219],v[52:55]
v_mfma_f32_16x16x16_bf16 v[56:59],v[182:183],v[216:217],v[56:59]
v_mfma_f32_16x16x16_bf16 v[60:63],v[182:183],v[218:219],v[60:63]
v_mfma_f32_16x16x32_bf16 v[64:67],v[112:115],v[220:223],0
v_mfma_f32_16x16x32_bf16 v[68:71],v[116:119],v[220:223],0
v_mfma_f32_16x16x32_bf16 v[72:75],v[120:123],v[220:223],0
v_mfma_f32_16x16x32_bf16 v[76:79],v[124:127],v[220:223],0
v_mfma_f32_16x16x32_bf16 v[80:83],v[128:131],v[220:223],0
v_mfma_f32_16x16x32_bf16 v[84:87],v[132:135],v[220:223],0
v_mfma_f32_16x16x32_bf16 v[88:91],v[136:139],v[220:223],0
v_mfma_f32_16x16x32_bf16 v[92:95],v[140:143],v[220:223],0
v_mfma_f32_16x16x32_bf16 v[96:99],v[144:147],v[220:223],0
v_mfma_f32_16x16x32_bf16 v[100:103],v[148:151],v[220:223],0
v_mfma_f32_16x16x32_bf16 v[104:107],v[152:155],v[220:223],0
v_mfma_f32_16x16x32_bf16 v[108:111],v[156:159],v[220:223],0
v_mfma_f32_16x16x16_bf16 v[64:67],v[172:173],v[224:225],v[64:67]
v_mfma_f32_16x16x16_bf16 v[68:71],v[172:173],v[226:227],v[68:71]
v_mfma_f32_16x16x16_bf16 v[72:75],v[174:175],v[224:225],v[72:75]
v_mfma_f32_16x16x16_bf16 v[76:79],v[174:175],v[226:227],v[76:79]
v_mfma_f32_16x16x16_bf16 v[80:83],v[176:177],v[224:225],v[80:83]
v_mfma_f32_16x16x16_bf16 v[84:87],v[176:177],v[226:227],v[84:87]
v_mfma_f32_16x16x16_bf16 v[88:91],v[178:179],v[224:225],v[88:91]
v_mfma_f32_16x16x16_bf16 v[92:95],v[178:179],v[226:227],v[92:95]
v_mfma_f32_16x16x16_bf16 v[96:99],v[180:181],v[224:225],v[96:99]
v_mfma_f32_16x16x16_bf16 v[100:103],v[180:181],v[226:227],v[100:103]
v_mfma_f32_16x16x16_bf16 v[104:107],v[182:183],v[224:225],v[104:107]
v_mfma_f32_16x16x16_bf16 v[108:111],v[182:183],v[226:227],v[108:111]
s_cmp_lg_u32 s49,0
s_nop 5
s_cbranch_scc1 ATT_OS
v_cvt_pk_bf16_f32 v232,v16,v17
v_cvt_pk_bf16_f32 v233,v18,v19
v_cvt_pk_bf16_f32 v234,v20,v21
v_cvt_pk_bf16_f32 v235,v22,v23
s_add_u32 s63,s66,0
buffer_store_dwordx4 v[232:235],v1,s[8:11],s63 offen offset:0
v_cvt_pk_bf16_f32 v236,v24,v25
v_cvt_pk_bf16_f32 v237,v26,v27
v_cvt_pk_bf16_f32 v238,v28,v29
v_cvt_pk_bf16_f32 v239,v30,v31
buffer_store_dwordx4 v[236:239],v1,s[8:11],s63 offen offset:2048
v_cvt_pk_bf16_f32 v232,v32,v33
v_cvt_pk_bf16_f32 v233,v34,v35
v_cvt_pk_bf16_f32 v234,v36,v37
v_cvt_pk_bf16_f32 v235,v38,v39
s_add_u32 s63,s66,4096
buffer_store_dwordx4 v[232:235],v1,s[8:11],s63 offen offset:0
v_cvt_pk_bf16_f32 v236,v40,v41
v_cvt_pk_bf16_f32 v237,v42,v43
v_cvt_pk_bf16_f32 v238,v44,v45
v_cvt_pk_bf16_f32 v239,v46,v47
buffer_store_dwordx4 v[236:239],v1,s[8:11],s63 offen offset:2048
v_cvt_pk_bf16_f32 v232,v48,v49
v_cvt_pk_bf16_f32 v233,v50,v51
v_cvt_pk_bf16_f32 v234,v52,v53
v_cvt_pk_bf16_f32 v235,v54,v55
s_add_u32 s63,s66,8192
buffer_store_dwordx4 v[232:235],v1,s[8:11],s63 offen offset:0
v_cvt_pk_bf16_f32 v236,v56,v57
v_cvt_pk_bf16_f32 v237,v58,v59
v_cvt_pk_bf16_f32 v238,v60,v61
v_cvt_pk_bf16_f32 v239,v62,v63
buffer_store_dwordx4 v[236:239],v1,s[8:11],s63 offen offset:2048
v_cvt_pk_bf16_f32 v232,v64,v65
v_cvt_pk_bf16_f32 v233,v66,v67
v_cvt_pk_bf16_f32 v234,v68,v69
v_cvt_pk_bf16_f32 v235,v70,v71
s_add_u32 s63,s66,1024
buffer_store_dwordx4 v[232:235],v1,s[8:11],s63 offen offset:0
v_cvt_pk_bf16_f32 v236,v72,v73
v_cvt_pk_bf16_f32 v237,v74,v75
v_cvt_pk_bf16_f32 v238,v76,v77
v_cvt_pk_bf16_f32 v239,v78,v79
buffer_store_dwordx4 v[236:239],v1,s[8:11],s63 offen offset:2048
v_cvt_pk_bf16_f32 v232,v80,v81
v_cvt_pk_bf16_f32 v233,v82,v83
v_cvt_pk_bf16_f32 v234,v84,v85
v_cvt_pk_bf16_f32 v235,v86,v87
s_add_u32 s63,s66,5120
buffer_store_dwordx4 v[232:235],v1,s[8:11],s63 offen offset:0
v_cvt_pk_bf16_f32 v236,v88,v89
v_cvt_pk_bf16_f32 v237,v90,v91
v_cvt_pk_bf16_f32 v238,v92,v93
v_cvt_pk_bf16_f32 v239,v94,v95
buffer_store_dwordx4 v[236:239],v1,s[8:11],s63 offen offset:2048
v_cvt_pk_bf16_f32 v232,v96,v97
v_cvt_pk_bf16_f32 v233,v98,v99
v_cvt_pk_bf16_f32 v234,v100,v101
v_cvt_pk_bf16_f32 v235,v102,v103
s_add_u32 s63,s66,9216
buffer_store_dwordx4 v[232:235],v1,s[8:11],s63 offen offset:0
v_cvt_pk_bf16_f32 v236,v104,v105
v_cvt_pk_bf16_f32 v237,v106,v107
v_cvt_pk_bf16_f32 v238,v108,v109
v_cvt_pk_bf16_f32 v239,v110,v111
buffer_store_dwordx4 v[236:239],v1,s[8:11],s63 offen offset:2048
s_lshl_b32 s60,s51,6
s_add_u32 s60,s60,s52
s_lshl_b32 s60,s60,9
s_add_u32 s60,s60,262144
s_lshl_b32 s61,s87,2
s_add_u32 s60,s60,s61
s_waitcnt vmcnt(0)
s_mov_b64 exec,1
buffer_store_dword v5,v1,s[8:11],s60 offen
s_mov_b64 exec,-1
s_branch ATT_OJ
ATT_OS:
v_cvt_pk_bf16_f32 v232,v16,v17
v_cvt_pk_bf16_f32 v233,v18,v19
v_cvt_pk_bf16_f32 v234,v20,v21
v_cvt_pk_bf16_f32 v235,v22,v23
s_add_u32 s63,s66,0
buffer_store_dwordx4 v[232:235],v1,s[8:11],s63 offen sc1
v_cvt_pk_bf16_f32 v236,v24,v25
v_cvt_pk_bf16_f32 v237,v26,v27
v_cvt_pk_bf16_f32 v238,v28,v29
v_cvt_pk_bf16_f32 v239,v30,v31
buffer_store_dwordx4 v[236:239],v1,s[8:11],s63 offen offset:2048 sc1
v_cvt_pk_bf16_f32 v232,v32,v33
v_cvt_pk_bf16_f32 v233,v34,v35
v_cvt_pk_bf16_f32 v234,v36,v37
v_cvt_pk_bf16_f32 v235,v38,v39
s_add_u32 s63,s66,4096
buffer_store_dwordx4 v[232:235],v1,s[8:11],s63 offen sc1
v_cvt_pk_bf16_f32 v236,v40,v41
v_cvt_pk_bf16_f32 v237,v42,v43
v_cvt_pk_bf16_f32 v238,v44,v45
v_cvt_pk_bf16_f32 v239,v46,v47
buffer_store_dwordx4 v[236:239],v1,s[8:11],s63 offen offset:2048 sc1
v_cvt_pk_bf16_f32 v232,v48,v49
v_cvt_pk_bf16_f32 v233,v50,v51
v_cvt_pk_bf16_f32 v234,v52,v53
v_cvt_pk_bf16_f32 v235,v54,v55
s_add_u32 s63,s66,8192
buffer_store_dwordx4 v[232:235],v1,s[8:11],s63 offen sc1
v_cvt_pk_bf16_f32 v236,v56,v57
v_cvt_pk_bf16_f32 v237,v58,v59
v_cvt_pk_bf16_f32 v238,v60,v61
v_cvt_pk_bf16_f32 v239,v62,v63
buffer_store_dwordx4 v[236:239],v1,s[8:11],s63 offen offset:2048 sc1
v_cvt_pk_bf16_f32 v232,v64,v65
v_cvt_pk_bf16_f32 v233,v66,v67
v_cvt_pk_bf16_f32 v234,v68,v69
v_cvt_pk_bf16_f32 v235,v70,v71
s_add_u32 s63,s66,1024
buffer_store_dwordx4 v[232:235],v1,s[8:11],s63 offen sc1
v_cvt_pk_bf16_f32 v236,v72,v73
v_cvt_pk_bf16_f32 v237,v74,v75
v_cvt_pk_bf16_f32 v238,v76,v77
v_cvt_pk_bf16_f32 v239,v78,v79
buffer_store_dwordx4 v[236:239],v1,s[8:11],s63 offen offset:2048 sc1
v_cvt_pk_bf16_f32 v232,v80,v81
v_cvt_pk_bf16_f32 v233,v82,v83
v_cvt_pk_bf16_f32 v234,v84,v85
v_cvt_pk_bf16_f32 v235,v86,v87
s_add_u32 s63,s66,5120
buffer_store_dwordx4 v[232:235],v1,s[8:11],s63 offen sc1
v_cvt_pk_bf16_f32 v236,v88,v89
v_cvt_pk_bf16_f32 v237,v90,v91
v_cvt_pk_bf16_f32 v238,v92,v93
v_cvt_pk_bf16_f32 v239,v94,v95
buffer_store_dwordx4 v[236:239],v1,s[8:11],s63 offen offset:2048 sc1
v_cvt_pk_bf16_f32 v232,v96,v97
v_cvt_pk_bf16_f32 v233,v98,v99
v_cvt_pk_bf16_f32 v234,v100,v101
v_cvt_pk_bf16_f32 v235,v102,v103
s_add_u32 s63,s66,9216
buffer_store_dwordx4 v[232:235],v1,s[8:11],s63 offen sc1
v_cvt_pk_bf16_f32 v236,v104,v105
v_cvt_pk_bf16_f32 v237,v106,v107
v_cvt_pk_bf16_f32 v238,v108,v109
v_cvt_pk_bf16_f32 v239,v110,v111
buffer_store_dwordx4 v[236:239],v1,s[8:11],s63 offen offset:2048 sc1
s_lshl_b32 s60,s51,6
s_add_u32 s60,s60,s52
s_lshl_b32 s60,s60,9
s_add_u32 s60,s60,262144
s_lshl_b32 s61,s87,2
s_add_u32 s60,s60,s61
s_waitcnt vmcnt(0)
s_mov_b64 exec,1
buffer_store_dword v5,v1,s[8:11],s60 offen sc1
s_mov_b64 exec,-1
ATT_OJ:
s_add_u32 s69,s69,393216
s_add_u32 s70,s70,2048
s_add_u32 s52,s52,2
s_cmp_lt_u32 s52,64
s_cbranch_scc1 ATT_LOOP
s_endpgm
ROLE_WO:
v_lshlrev_b32 v1,4,v0
v_mov_b32 v5,1
s_lshl_b32 s56,s48,2
s_add_u32 s56,s56,s46
v_bfe_u32 v6,v0,2,2
v_lshrrev_b32 v7,4,v0
v_add_u32 v7,v6,v7
v_and_b32 v7,3,v7
v_and_b32 v15,3,v0
v_lshlrev_b32 v15,4,v15
v_lshl_add_u32 v15,v7,6,v15
v_lshl_add_u32 v15,v6,8,v15
v_lshrrev_b32 v6,5,v0
v_bfe_u32 v7,v0,4,1
v_lshlrev_b32 v208,10,v7
v_lshl_add_u32 v208,v6,8,v208
v_and_b32 v6,15,v0
v_lshl_add_u32 v208,v6,4,v208
v_lshrrev_b32 v6,5,v0
v_add_u32 v6,2,v6
v_bfe_u32 v7,v0,4,1
v_lshlrev_b32 v209,10,v7
v_lshl_add_u32 v209,v6,8,v209
v_and_b32 v6,15,v0
v_lshl_add_u32 v209,v6,4,v209
s_mul_i32 s64,s48,6554
s_lshr_b32 s64,s64,16
s_mul_i32 s60,s64,10
s_sub_u32 s65,s48,s60
v_min_u32 v2,1,v0
s_lshl_b32 s60,s64,4
s_add_u32 s60,s60,s46
s_lshl_b32 s60,s60,1
v_add_u32 v2,s60,v2
v_lshlrev_b32 v2,2,v2
s_and_b32 s60,s46,1
s_lshl_b32 s68,s65,1
s_add_u32 s68,s68,s60
s_lshr_b32 s69,s46,1
s_mul_i32 s71,s46,24576
s_mul_i32 s58,s46,491520
s_lshl_b32 s61,s65,7
s_add_u32 s58,s58,s61
s_mul_i32 s61,s64,1966080
s_add_u32 s58,s58,s61
s_mul_i32 s61,s64,98304
s_add_u32 s71,s71,s61
s_add_u32 s71,s71,149946368
v_bfe_u32 v6,v0,2,2
v_mul_u32_u24 v205,10240,v6
v_and_b32 v6,3,v0
v_lshl_add_u32 v205,v6,4,v205
v_lshrrev_b32 v6,4,v0
v_lshl_add_u32 v205,v6,6,v205
s_mul_i32 s74,s64,81920
s_mul_i32 s61,s69,40960
s_add_u32 s74,s74,s61
s_lshl_b32 s61,s68,9
s_add_u32 s74,s74,s61
s_add_u32 s74,s74,175112192
s_lshl1_add_u32 s75,s48,s60
s_lshl_b32 s75,s75,2
s_mul_i32 s61,s69,320
s_add_u32 s75,s75,s61
s_add_u32 s75,s75,819200
v_bfe_u32 v6,v0,4,1
v_lshlrev_b32 v206,14,v6
v_lshrrev_b32 v6,5,v0
v_lshl_add_u32 v206,v6,8,v206
v_and_b32 v6,15,v0
v_lshl_add_u32 v206,v6,4,v206
s_lshl_b32 s60,s46,11
v_add_u32 v206,s60,v206
s_lshl_b32 s60,s46,13
v_add_u32 v207,s60,v1
s_waitcnt vmcnt(0)
s_barrier
s_cmp_lg_u32 s46,0
s_cbranch_scc1 arr_277
v_mov_b32 v6,1
s_lshl_b32 s3,s49,2
v_mov_b32 v7,s3
s_mov_b64 exec,1
buffer_atomic_add v6,v7,s[12:15],0 offen sc1
s_mov_b64 exec,-1
arr_277:
s_mul_i32 s63,s46,40960
s_mov_b32 s4,s26
s_mov_b32 s5,s27
s_mov_b32 s6,7864320
s_mov_b32 s7,0x20000
v_lshrrev_b32 v9,3,v0
s_mov_b32 s64,1280
v_mul_lo_u32 v9,v9,s64
v_and_b32 v10,7,v0
v_lshl_add_u32 v6,v10,4,v9
s_add_u32 m0,s63,0
s_add_u32 s65,s58,0
buffer_load_dwordx4 v6,s[4:7],s65 offen lds
s_add_u32 m0,s63,1024
s_add_u32 s65,s58,10240
buffer_load_dwordx4 v6,s[4:7],s65 offen lds
s_add_u32 m0,s63,2048
s_add_u32 s65,s58,20480
buffer_load_dwordx4 v6,s[4:7],s65 offen lds
s_add_u32 m0,s63,3072
s_add_u32 s65,s58,30720
buffer_load_dwordx4 v6,s[4:7],s65 offen lds
s_add_u32 m0,s63,4096
s_add_u32 s65,s58,40960
buffer_load_dwordx4 v6,s[4:7],s65 offen lds
s_add_u32 m0,s63,5120
s_add_u32 s65,s58,51200
buffer_load_dwordx4 v6,s[4:7],s65 offen lds
s_add_u32 m0,s63,6144
s_add_u32 s65,s58,61440
buffer_load_dwordx4 v6,s[4:7],s65 offen lds
s_add_u32 m0,s63,7168
s_add_u32 s65,s58,71680
buffer_load_dwordx4 v6,s[4:7],s65 offen lds
s_add_u32 m0,s63,8192
s_add_u32 s65,s58,81920
buffer_load_dwordx4 v6,s[4:7],s65 offen lds
s_add_u32 m0,s63,9216
s_add_u32 s65,s58,92160
buffer_load_dwordx4 v6,s[4:7],s65 offen lds
s_add_u32 m0,s63,10240
s_add_u32 s65,s58,102400
buffer_load_dwordx4 v6,s[4:7],s65 offen lds
s_add_u32 m0,s63,11264
s_add_u32 s65,s58,112640
buffer_load_dwordx4 v6,s[4:7],s65 offen lds
s_add_u32 m0,s63,12288
s_add_u32 s65,s58,122880
buffer_load_dwordx4 v6,s[4:7],s65 offen lds
s_add_u32 m0,s63,13312
s_add_u32 s65,s58,133120
buffer_load_dwordx4 v6,s[4:7],s65 offen lds
s_add_u32 m0,s63,14336
s_add_u32 s65,s58,143360
buffer_load_dwordx4 v6,s[4:7],s65 offen lds
s_add_u32 m0,s63,15360
s_add_u32 s65,s58,153600
buffer_load_dwordx4 v6,s[4:7],s65 offen lds
s_add_u32 m0,s63,16384
s_add_u32 s65,s58,163840
buffer_load_dwordx4 v6,s[4:7],s65 offen lds
s_add_u32 m0,s63,17408
s_add_u32 s65,s58,174080
buffer_load_dwordx4 v6,s[4:7],s65 offen lds
s_add_u32 m0,s63,18432
s_add_u32 s65,s58,184320
buffer_load_dwordx4 v6,s[4:7],s65 offen lds
s_add_u32 m0,s63,19456
s_add_u32 s65,s58,194560
buffer_load_dwordx4 v6,s[4:7],s65 offen lds
s_add_u32 m0,s63,20480
s_add_u32 s65,s58,204800
buffer_load_dwordx4 v6,s[4:7],s65 offen lds
s_add_u32 m0,s63,21504
s_add_u32 s65,s58,215040
buffer_load_dwordx4 v6,s[4:7],s65 offen lds
s_add_u32 m0,s63,22528
s_add_u32 s65,s58,225280
buffer_load_dwordx4 v6,s[4:7],s65 offen lds
s_add_u32 m0,s63,23552
s_add_u32 s65,s58,235520
buffer_load_dwordx4 v6,s[4:7],s65 offen lds
s_add_u32 m0,s63,24576
s_add_u32 s65,s58,245760
buffer_load_dwordx4 v6,s[4:7],s65 offen lds
s_add_u32 m0,s63,25600
s_add_u32 s65,s58,256000
buffer_load_dwordx4 v6,s[4:7],s65 offen lds
s_add_u32 m0,s63,26624
s_add_u32 s65,s58,266240
buffer_load_dwordx4 v6,s[4:7],s65 offen lds
s_add_u32 m0,s63,27648
s_add_u32 s65,s58,276480
buffer_load_dwordx4 v6,s[4:7],s65 offen lds
s_add_u32 m0,s63,28672
s_add_u32 s65,s58,286720
buffer_load_dwordx4 v6,s[4:7],s65 offen lds
s_add_u32 m0,s63,29696
s_add_u32 s65,s58,296960
buffer_load_dwordx4 v6,s[4:7],s65 offen lds
s_add_u32 m0,s63,30720
s_add_u32 s65,s58,307200
buffer_load_dwordx4 v6,s[4:7],s65 offen lds
s_add_u32 m0,s63,31744
s_add_u32 s65,s58,317440
buffer_load_dwordx4 v6,s[4:7],s65 offen lds
s_add_u32 m0,s63,32768
s_add_u32 s65,s58,327680
buffer_load_dwordx4 v6,s[4:7],s65 offen lds
s_add_u32 m0,s63,33792
s_add_u32 s65,s58,337920
buffer_load_dwordx4 v6,s[4:7],s65 offen lds
s_add_u32 m0,s63,34816
s_add_u32 s65,s58,348160
buffer_load_dwordx4 v6,s[4:7],s65 offen lds
s_add_u32 m0,s63,35840
s_add_u32 s65,s58,358400
buffer_load_dwordx4 v6,s[4:7],s65 offen lds
s_add_u32 m0,s63,36864
s_add_u32 s65,s58,368640
buffer_load_dwordx4 v6,s[4:7],s65 offen lds
s_add_u32 m0,s63,37888
s_add_u32 s65,s58,378880
buffer_load_dwordx4 v6,s[4:7],s65 offen lds
s_add_u32 m0,s63,38912
s_add_u32 s65,s58,389120
buffer_load_dwordx4 v6,s[4:7],s65 offen lds
s_add_u32 m0,s63,39936
s_add_u32 s65,s58,399360
buffer_load_dwordx4 v6,s[4:7],s65 offen lds
s_waitcnt vmcnt(20)
v_bfe_u32 v9,v0,2,2
v_lshrrev_b32 v10,5,v0
v_lshl_add_u32 v9,v10,2,v9
v_mul_u32_u24 v9,128,v9
v_and_b32 v10,1,v0
v_lshl_add_u32 v9,v10,3,v9
v_bfe_u32 v10,v0,1,1
v_lshl_add_u32 v9,v10,5,v9
v_bfe_u32 v10,v0,4,1
v_lshl_add_u32 v9,v10,4,v9
v_add_u32 v7,s63,v9
ds_read_b64_tr_b16 a[0:1],v7 offset:0
ds_read_b64_tr_b16 a[2:3],v7 offset:2048
ds_read_b64_tr_b16 a[4:5],v7 offset:1024
ds_read_b64_tr_b16 a[6:7],v7 offset:3072
ds_read_b64_tr_b16 a[96:97],v7 offset:64
ds_read_b64_tr_b16 a[98:99],v7 offset:2112
ds_read_b64_tr_b16 a[100:101],v7 offset:1088
ds_read_b64_tr_b16 a[102:103],v7 offset:3136
ds_read_b64_tr_b16 a[8:9],v7 offset:4096
ds_read_b64_tr_b16 a[10:11],v7 offset:6144
ds_read_b64_tr_b16 a[12:13],v7 offset:5120
ds_read_b64_tr_b16 a[14:15],v7 offset:7168
s_waitcnt lgkmcnt(4)
ds_read_b64_tr_b16 a[104:105],v7 offset:4160
ds_read_b64_tr_b16 a[106:107],v7 offset:6208
ds_read_b64_tr_b16 a[108:109],v7 offset:5184
ds_read_b64_tr_b16 a[110:111],v7 offset:7232
ds_read_b64_tr_b16 a[16:17],v7 offset:8192
ds_read_b64_tr_b16 a[18:19],v7 offset:10240
ds_read_b64_tr_b16 a[20:21],v7 offset:9216
ds_read_b64_tr_b16 a[22:23],v7 offset:11264
ds_read_b64_tr_b16 a[112:113],v7 offset:8256
ds_read_b64_tr_b16 a[114:115],v7 offset:10304
ds_read_b64_tr_b16 a[116:117],v7 offset:9280
ds_read_b64_tr_b16 a[118:119],v7 offset:11328
s_waitcnt lgkmcnt(4)
ds_read_b64_tr_b16 a[24:25],v7 offset:12288
ds_read_b64_tr_b16 a[26:27],v7 offset:14336
ds_read_b64_tr_b16 a[28:29],v7 offset:13312
ds_read_b64_tr_b16 a[30:31],v7 offset:15360
ds_read_b64_tr_b16 a[120:121],v7 offset:12352
ds_read_b64_tr_b16 a[122:123],v7 offset:14400
ds_read_b64_tr_b16 a[124:125],v7 offset:13376
ds_read_b64_tr_b16 a[126:127],v7 offset:15424
ds_read_b64_tr_b16 a[32:33],v7 offset:16384
ds_read_b64_tr_b16 a[34:35],v7 offset:18432
ds_read_b64_tr_b16 a[36:37],v7 offset:17408
ds_read_b64_tr_b16 a[38:39],v7 offset:19456
s_waitcnt lgkmcnt(4)
ds_read_b64_tr_b16 a[128:129],v7 offset:16448
ds_read_b64_tr_b16 a[130:131],v7 offset:18496
ds_read_b64_tr_b16 a[132:133],v7 offset:17472
ds_read_b64_tr_b16 a[134:135],v7 offset:19520
s_waitcnt lgkmcnt(0)
s_add_u32 m0,s63,0
s_add_u32 s65,s58,409600
buffer_load_dwordx4 v6,s[4:7],s65 offen lds
s_add_u32 m0,s63,1024
s_add_u32 s65,s58,419840
buffer_load_dwordx4 v6,s[4:7],s65 offen lds
s_add_u32 m0,s63,2048
s_add_u32 s65,s58,430080
buffer_load_dwordx4 v6,s[4:7],s65 offen lds
s_add_u32 m0,s63,3072
s_add_u32 s65,s58,440320
buffer_load_dwordx4 v6,s[4:7],s65 offen lds
s_add_u32 m0,s63,4096
s_add_u32 s65,s58,450560
buffer_load_dwordx4 v6,s[4:7],s65 offen lds
s_add_u32 m0,s63,5120
s_add_u32 s65,s58,460800
buffer_load_dwordx4 v6,s[4:7],s65 offen lds
s_add_u32 m0,s63,6144
s_add_u32 s65,s58,471040
buffer_load_dwordx4 v6,s[4:7],s65 offen lds
s_add_u32 m0,s63,7168
s_add_u32 s65,s58,481280
buffer_load_dwordx4 v6,s[4:7],s65 offen lds
s_waitcnt vmcnt(8)
v_bfe_u32 v9,v0,2,2
v_lshrrev_b32 v10,5,v0
v_lshl_add_u32 v9,v10,2,v9
v_mul_u32_u24 v9,128,v9
v_and_b32 v10,1,v0
v_lshl_add_u32 v9,v10,3,v9
v_bfe_u32 v10,v0,1,1
v_lshl_add_u32 v9,v10,5,v9
v_bfe_u32 v10,v0,4,1
v_lshl_add_u32 v9,v10,4,v9
v_add_u32 v7,s63,v9
ds_read_b64_tr_b16 a[40:41],v7 offset:20480
ds_read_b64_tr_b16 a[42:43],v7 offset:22528
ds_read_b64_tr_b16 a[44:45],v7 offset:21504
ds_read_b64_tr_b16 a[46:47],v7 offset:23552
ds_read_b64_tr_b16 a[136:137],v7 offset:20544
ds_read_b64_tr_b16 a[138:139],v7 offset:22592
ds_read_b64_tr_b16 a[140:141],v7 offset:21568
ds_read_b64_tr_b16 a[142:143],v7 offset:23616
ds_read_b64_tr_b16 a[48:49],v7 offset:24576
ds_read_b64_tr_b16 a[50:51],v7 offset:26624
ds_read_b64_tr_b16 a[52:53],v7 offset:25600
ds_read_b64_tr_b16 a[54:55],v7 offset:27648
s_waitcnt lgkmcnt(4)
ds_read_b64_tr_b16 a[144:145],v7 offset:24640
ds_read_b64_tr_b16 a[146:147],v7 offset:26688
ds_read_b64_tr_b16 a[148:149],v7 offset:25664
ds_read_b64_tr_b16 a[150:151],v7 offset:27712
ds_read_b64_tr_b16 a[56:57],v7 offset:28672
ds_read_b64_tr_b16 a[58:59],v7 offset:30720
ds_read_b64_tr_b16 a[60:61],v7 offset:29696
ds_read_b64_tr_b16 a[62:63],v7 offset:31744
ds_read_b64_tr_b16 a[152:153],v7 offset:28736
ds_read_b64_tr_b16 a[154:155],v7 offset:30784
ds_read_b64_tr_b16 a[156:157],v7 offset:29760
ds_read_b64_tr_b16 a[158:159],v7 offset:31808
s_waitcnt lgkmcnt(4)
ds_read_b64_tr_b16 a[64:65],v7 offset:32768
ds_read_b64_tr_b16 a[66:67],v7 offset:34816
ds_read_b64_tr_b16 a[68:69],v7 offset:33792
ds_read_b64_tr_b16 a[70:71],v7 offset:35840
ds_read_b64_tr_b16 a[160:161],v7 offset:32832
ds_read_b64_tr_b16 a[162:163],v7 offset:34880
ds_read_b64_tr_b16 a[164:165],v7 offset:33856
ds_read_b64_tr_b16 a[166:167],v7 offset:35904
ds_read_b64_tr_b16 a[72:73],v7 offset:36864
ds_read_b64_tr_b16 a[74:75],v7 offset:38912
ds_read_b64_tr_b16 a[76:77],v7 offset:37888
ds_read_b64_tr_b16 a[78:79],v7 offset:39936
s_waitcnt lgkmcnt(4)
ds_read_b64_tr_b16 a[168:169],v7 offset:36928
ds_read_b64_tr_b16 a[170:171],v7 offset:38976
ds_read_b64_tr_b16 a[172:173],v7 offset:37952
ds_read_b64_tr_b16 a[174:175],v7 offset:40000
s_waitcnt lgkmcnt(0)
s_waitcnt vmcnt(0)
v_bfe_u32 v9,v0,2,2
v_lshrrev_b32 v10,5,v0
v_lshl_add_u32 v9,v10,2,v9
v_mul_u32_u24 v9,128,v9
v_and_b32 v10,1,v0
v_lshl_add_u32 v9,v10,3,v9
v_bfe_u32 v10,v0,1,1
v_lshl_add_u32 v9,v10,5,v9
v_bfe_u32 v10,v0,4,1
v_lshl_add_u32 v9,v10,4,v9
v_add_u32 v7,s63,v9
ds_read_b64_tr_b16 a[80:81],v7 offset:0
ds_read_b64_tr_b16 a[82:83],v7 offset:2048
ds_read_b64_tr_b16 a[84:85],v7 offset:1024
ds_read_b64_tr_b16 a[86:87],v7 offset:3072
ds_read_b64_tr_b16 a[176:177],v7 offset:64
ds_read_b64_tr_b16 a[178:179],v7 offset:2112
ds_read_b64_tr_b16 a[180:181],v7 offset:1088
ds_read_b64_tr_b16 a[182:183],v7 offset:3136
ds_read_b64_tr_b16 a[88:89],v7 offset:4096
ds_read_b64_tr_b16 a[90:91],v7 offset:6144
ds_read_b64_tr_b16 a[92:93],v7 offset:5120
ds_read_b64_tr_b16 a[94:95],v7 offset:7168
s_waitcnt lgkmcnt(4)
ds_read_b64_tr_b16 a[184:185],v7 offset:4160
ds_read_b64_tr_b16 a[186:187],v7 offset:6208
ds_read_b64_tr_b16 a[188:189],v7 offset:5184
ds_read_b64_tr_b16 a[190:191],v7 offset:7232
s_waitcnt lgkmcnt(0)
s_barrier
s_lshl_b32 s3,s49,2
v_mov_b32 v7,s3
s_nop 1
ibw_278:
buffer_load_dword v6,v7,s[12:15],0 offen sc1
s_waitcnt vmcnt(0)
v_cmp_ne_u32 vcc,256,v6
s_nop 0
s_cbranch_vccz ok_279
s_sleep 8
s_sub_u32 s47,s47,1
s_cbranch_scc1 ABORT
s_branch ibw_278
ok_279:
s_cmp_lg_u32 s49,0
s_cbranch_scc1 ibok_280
v_and_b32 v7,7,v0
v_lshlrev_b32 v7,2,v7
buffer_load_dword v6,v7,s[12:15],0 offen offset:32 sc1
s_waitcnt vmcnt(0)
v_cmp_ne_u32 vcc,32,v6
s_nop 0
s_cbranch_vccz ibok_280
s_barrier
s_mov_b32 s49,1
s_mov_b32 s3,s2
s_load_dwordx16 s[16:31],s[0:1],0
s_load_dwordx8 s[32:39],s[0:1],64
s_waitcnt lgkmcnt(0)
s_branch DISPATCH
ibok_280:
s_mov_b32 s83,s100
s_mov_b32 s32,0
s_mov_b32 s59,2147483648
s_min_u32 s62,s32,127
s_sub_u32 s60,s62,13
s_lshr_b32 s34,s60,1
s_and_b32 s33,s60,1
s_cmp_eq_u32 s33,0
s_cselect_b32 s61,13,0
s_add_u32 s34,s34,s61
s_sub_u32 s61,s60,51
s_cmp_ge_u32 s60,102
s_cselect_b32 s34,s61,s34
s_cselect_b32 s33,1,s33
s_cmp_lt_u32 s62,13
s_cselect_b32 s34,s62,s34
s_cselect_b32 s33,0,s33
s_lshl_b32 s35,s33,6
s_add_u32 s35,s35,s34
s_lshl_b32 s35,s35,9
s_add_u32 s35,s35,262144
s_mul_i32 s73,s34,393216
s_add_u32 s73,s73,s71
WO_COLD:
fb_281:
buffer_load_dword v3,v2,s[8:11],s35 offen sc1
s_waitcnt vmcnt(0)
v_cmp_eq_u32 vcc,0,v3
s_nop 0
s_cbranch_vccz ok_282
s_sleep 2
s_sub_u32 s47,s47,1
s_cbranch_scc1 ABORT
s_branch fb_281
ok_282:
s_add_u32 s63,s73,0
buffer_load_dwordx4 v[16:19],v208,s[8:11],s63 offen sc1
s_nop 7
buffer_load_dwordx4 v[20:23],v209,s[8:11],s63 offen sc1
s_nop 7
buffer_load_dwordx4 v[24:27],v208,s[8:11],s63 offen offset:2048 sc1
s_nop 7
buffer_load_dwordx4 v[28:31],v209,s[8:11],s63 offen offset:2048 sc1
s_nop 7
s_add_u32 s63,s73,4096
buffer_load_dwordx4 v[32:35],v208,s[8:11],s63 offen sc1
s_nop 7
buffer_load_dwordx4 v[36:39],v209,s[8:11],s63 offen sc1
s_nop 7
buffer_load_dwordx4 v[40:43],v208,s[8:11],s63 offen offset:2048 sc1
s_nop 7
buffer_load_dwordx4 v[44:47],v209,s[8:11],s63 offen offset:2048 sc1
s_nop 7
s_add_u32 s63,s73,8192
buffer_load_dwordx4 v[48:51],v208,s[8:11],s63 offen sc1
s_nop 7
buffer_load_dwordx4 v[52:55],v209,s[8:11],s63 offen sc1
WO_NEXT:
s_mov_b32 s51,s33
s_mov_b32 s52,s34
s_mov_b32 s72,s73
s_add_u32 s32,s32,1
s_waitcnt vmcnt(9)
v_mfma_f32_32x32x16_bf16 v[112:127],a[0:3],v[16:19],0
s_add_u32 s63,s72,8192
buffer_load_dwordx4 v[56:59],v208,s[8:11],s63 offen offset:2048 sc1
s_min_u32 s62,s32,127
s_sub_u32 s60,s62,13
s_lshr_b32 s34,s60,1
v_mfma_f32_32x32x16_bf16 v[128:143],a[96:99],v[16:19],0
s_and_b32 s33,s60,1
s_cmp_eq_u32 s33,0
s_cselect_b32 s61,13,0
s_add_u32 s34,s34,s61
s_sub_u32 s61,s60,51
v_xor_b32 v206,0x8000,v206
s_waitcnt vmcnt(9)
v_mfma_f32_32x32x16_bf16 v[112:127],a[4:7],v[20:23],v[112:127]
buffer_load_dwordx4 v[60:63],v209,s[8:11],s63 offen offset:2048 sc1
s_cmp_ge_u32 s60,102
s_cselect_b32 s34,s61,s34
s_cselect_b32 s33,1,s33
v_xor_b32 v207,0x8000,v207
v_mfma_f32_32x32x16_bf16 v[128:143],a[100:103],v[20:23],v[128:143]
s_cmp_lt_u32 s62,13
s_cselect_b32 s34,s62,s34
s_cselect_b32 s33,0,s33
s_lshl_b32 s35,s33,6
s_add_u32 s35,s35,s34
s_lshl_b32 s35,s35,9
s_waitcnt vmcnt(9)
v_mfma_f32_32x32x16_bf16 v[112:127],a[8:11],v[24:27],v[112:127]
s_add_u32 s63,s72,12288
buffer_load_dwordx4 v[64:67],v208,s[8:11],s63 offen sc1
s_add_u32 s35,s35,262144
s_mul_i32 s73,s34,393216
s_add_u32 s73,s73,s71
v_mfma_f32_32x32x16_bf16 v[128:143],a[104:107],v[24:27],v[128:143]
buffer_load_dword v3,v2,s[8:11],s35 offen sc1
s_mul_i32 s64,s52,491520
s_add_u32 s64,s64,s74
s_lshl_b32 s65,s51,6
s_add_u32 s65,s65,s52
s_waitcnt vmcnt(10)
v_mfma_f32_32x32x16_bf16 v[112:127],a[12:15],v[28:31],v[112:127]
buffer_load_dwordx4 v[68:71],v209,s[8:11],s63 offen sc1
s_mul_i32 s65,s65,640
s_add_u32 s82,s65,s75
v_mfma_f32_32x32x16_bf16 v[128:143],a[108:111],v[28:31],v[128:143]
s_waitcnt vmcnt(10)
v_mfma_f32_32x32x16_bf16 v[112:127],a[16:19],v[32:35],v[112:127]
buffer_load_dwordx4 v[72:75],v208,s[8:11],s63 offen offset:2048 sc1
v_mfma_f32_32x32x16_bf16 v[128:143],a[112:115],v[32:35],v[128:143]
s_waitcnt vmcnt(10)
v_mfma_f32_32x32x16_bf16 v[112:127],a[20:23],v[36:39],v[112:127]
buffer_load_dwordx4 v[76:79],v209,s[8:11],s63 offen offset:2048 sc1
v_mfma_f32_32x32x16_bf16 v[128:143],a[116:119],v[36:39],v[128:143]
s_waitcnt vmcnt(10)
v_mfma_f32_32x32x16_bf16 v[112:127],a[24:27],v[40:43],v[112:127]
s_add_u32 s63,s72,16384
buffer_load_dwordx4 v[80:83],v208,s[8:11],s63 offen sc1
v_mfma_f32_32x32x16_bf16 v[128:143],a[120:123],v[40:43],v[128:143]
s_waitcnt vmcnt(10)
v_mfma_f32_32x32x16_bf16 v[112:127],a[28:31],v[44:47],v[112:127]
buffer_load_dwordx4 v[84:87],v209,s[8:11],s63 offen sc1
v_mfma_f32_32x32x16_bf16 v[128:143],a[124:127],v[44:47],v[128:143]
s_waitcnt vmcnt(10)
v_mfma_f32_32x32x16_bf16 v[112:127],a[32:35],v[48:51],v[112:127]
buffer_load_dwordx4 v[88:91],v208,s[8:11],s63 offen offset:2048 sc1
v_mfma_f32_32x32x16_bf16 v[128:143],a[128:131],v[48:51],v[128:143]
s_waitcnt vmcnt(10)
v_mfma_f32_32x32x16_bf16 v[112:127],a[36:39],v[52:55],v[112:127]
buffer_load_dwordx4 v[92:95],v209,s[8:11],s63 offen offset:2048 sc1
v_mfma_f32_32x32x16_bf16 v[128:143],a[132:135],v[52:55],v[128:143]
s_waitcnt vmcnt(10)
v_mfma_f32_32x32x16_bf16 v[112:127],a[40:43],v[56:59],v[112:127]
s_add_u32 s63,s72,20480
buffer_load_dwordx4 v[96:99],v208,s[8:11],s63 offen sc1
v_mfma_f32_32x32x16_bf16 v[128:143],a[136:139],v[56:59],v[128:143]
s_waitcnt vmcnt(10)
v_mfma_f32_32x32x16_bf16 v[112:127],a[44:47],v[60:63],v[112:127]
buffer_load_dwordx4 v[100:103],v209,s[8:11],s63 offen sc1
v_mfma_f32_32x32x16_bf16 v[128:143],a[140:143],v[60:63],v[128:143]
s_waitcnt vmcnt(10)
v_mfma_f32_32x32x16_bf16 v[112:127],a[48:51],v[64:67],v[112:127]
buffer_load_dwordx4 v[104:107],v208,s[8:11],s63 offen offset:2048 sc1
v_mfma_f32_32x32x16_bf16 v[128:143],a[144:147],v[64:67],v[128:143]
s_waitcnt vmcnt(10)
v_cmp_eq_u32 vcc,0,v3
s_cmp_eq_u64 vcc,0
s_cselect_b32 s37,0,2147483648
s_cmp_lt_u32 s32,128
s_cselect_b32 s37,s37,2147483648
s_waitcnt vmcnt(9)
v_mfma_f32_32x32x16_bf16 v[112:127],a[52:55],v[68:71],v[112:127]
buffer_load_dwordx4 v[108:111],v209,s[8:11],s63 offen offset:2048 sc1
s_add_u32 s67,s73,s37
v_mfma_f32_32x32x16_bf16 v[128:143],a[148:151],v[68:71],v[128:143]
s_mov_b64 exec,1
buffer_store_dword v5,v1,s[8:11],s59 offen sc1
s_mov_b64 exec,-1
s_mov_b32 s59,2147483648
s_waitcnt vmcnt(10)
v_mfma_f32_32x32x16_bf16 v[112:127],a[56:59],v[72:75],v[112:127]
s_add_u32 s63,s67,0
buffer_load_dwordx4 v[16:19],v208,s[8:11],s63 offen sc1
v_mfma_f32_32x32x16_bf16 v[128:143],a[152:155],v[72:75],v[128:143]
s_waitcnt vmcnt(10)
v_mfma_f32_32x32x16_bf16 v[112:127],a[60:63],v[76:79],v[112:127]
buffer_load_dwordx4 v[20:23],v209,s[8:11],s63 offen sc1
v_mfma_f32_32x32x16_bf16 v[128:143],a[156:159],v[76:79],v[128:143]
s_waitcnt vmcnt(10)
v_mfma_f32_32x32x16_bf16 v[112:127],a[64:67],v[80:83],v[112:127]
buffer_load_dwordx4 v[24:27],v208,s[8:11],s63 offen offset:2048 sc1
v_mfma_f32_32x32x16_bf16 v[128:143],a[160:163],v[80:83],v[128:143]
s_waitcnt vmcnt(10)
v_mfma_f32_32x32x16_bf16 v[112:127],a[68:71],v[84:87],v[112:127]
buffer_load_dwordx4 v[28:31],v209,s[8:11],s63 offen offset:2048 sc1
v_mfma_f32_32x32x16_bf16 v[128:143],a[164:167],v[84:87],v[128:143]
s_waitcnt vmcnt(10)
v_mfma_f32_32x32x16_bf16 v[112:127],a[72:75],v[88:91],v[112:127]
s_add_u32 s63,s67,4096
buffer_load_dwordx4 v[32:35],v208,s[8:11],s63 offen sc1
buffer_load_dword v3,v2,s[8:11],s35 offen sc1
v_mfma_f32_32x32x16_bf16 v[128:143],a[168:171],v[88:91],v[128:143]
s_waitcnt vmcnt(11)
v_mfma_f32_32x32x16_bf16 v[112:127],a[76:79],v[92:95],v[112:127]
buffer_load_dwordx4 v[36:39],v209,s[8:11],s63 offen sc1
v_mfma_f32_32x32x16_bf16 v[128:143],a[172:175],v[92:95],v[128:143]
s_waitcnt vmcnt(11)
v_mfma_f32_32x32x16_bf16 v[112:127],a[80:83],v[96:99],v[112:127]
buffer_load_dwordx4 v[40:43],v208,s[8:11],s63 offen offset:2048 sc1
v_mfma_f32_32x32x16_bf16 v[128:143],a[176:179],v[96:99],v[128:143]
s_waitcnt vmcnt(11)
v_mfma_f32_32x32x16_bf16 v[112:127],a[84:87],v[100:103],v[112:127]
buffer_load_dwordx4 v[44:47],v209,s[8:11],s63 offen offset:2048 sc1
v_mfma_f32_32x32x16_bf16 v[128:143],a[180:183],v[100:103],v[128:143]
s_waitcnt vmcnt(11)
v_mfma_f32_32x32x16_bf16 v[112:127],a[88:91],v[104:107],v[112:127]
s_add_u32 s63,s67,8192
buffer_load_dwordx4 v[48:51],v208,s[8:11],s63 offen sc1
v_mfma_f32_32x32x16_bf16 v[128:143],a[184:187],v[104:107],v[128:143]
s_waitcnt vmcnt(11)
v_mfma_f32_32x32x16_bf16 v[112:127],a[92:95],v[108:111],v[112:127]
buffer_load_dwordx4 v[52:55],v209,s[8:11],s63 offen sc1
v_mfma_f32_32x32x16_bf16 v[128:143],a[188:191],v[108:111],v[128:143]
s_cmp_eq_u32 s37,0
s_cbranch_scc1 ep_283
s_waitcnt vmcnt(0)
v_cmp_eq_u32 vcc,0,v3
s_cmp_eq_u64 vcc,0
s_cselect_b32 s37,0,2147483648
s_cmp_lt_u32 s32,128
s_cselect_b32 s37,s37,2147483648
s_cmp_lg_u32 s37,0
s_cbranch_scc1 ep_283
s_add_u32 s63,s73,0
buffer_load_dwordx4 v[16:19],v208,s[8:11],s63 offen sc1
buffer_load_dwordx4 v[20:23],v209,s[8:11],s63 offen sc1
buffer_load_dwordx4 v[24:27],v208,s[8:11],s63 offen offset:2048 sc1
buffer_load_dwordx4 v[28:31],v209,s[8:11],s63 offen offset:2048 sc1
s_add_u32 s63,s73,4096
buffer_load_dwordx4 v[32:35],v208,s[8:11],s63 offen sc1
buffer_load_dwordx4 v[36:39],v209,s[8:11],s63 offen sc1
buffer_load_dwordx4 v[40:43],v208,s[8:11],s63 offen offset:2048 sc1
buffer_load_dwordx4 v[44:47],v209,s[8:11],s63 offen offset:2048 sc1
s_add_u32 s63,s73,8192
buffer_load_dwordx4 v[48:51],v208,s[8:11],s63 offen sc1
buffer_load_dwordx4 v[52:55],v209,s[8:11],s63 offen sc1
ep_283:
s_nop 7
ds_write_b128 v206,v[112:115] offset:0
ds_write_b128 v206,v[116:119] offset:1024
ds_write_b128 v206,v[120:123] offset:512
ds_write_b128 v206,v[124:127] offset:1536
s_nop 0
ds_write_b128 v206,v[128:131] offset:8192
ds_write_b128 v206,v[132:135] offset:9216
ds_write_b128 v206,v[136:139] offset:8704
ds_write_b128 v206,v[140:143] offset:9728
s_waitcnt lgkmcnt(0)
s_barrier
ds_read_b128 v[144:147],v207 offset:0
ds_read_b128 v[148:151],v207 offset:1024
ds_read_b128 v[152:155],v207 offset:2048
ds_read_b128 v[156:159],v207 offset:3072
ds_read_b128 v[160:163],v207 offset:4096
ds_read_b128 v[164:167],v207 offset:5120
ds_read_b128 v[168:171],v207 offset:6144
ds_read_b128 v[172:175],v207 offset:7168
s_waitcnt lgkmcnt(4)
v_pk_add_f32 v[144:145],v[144:145],v[152:153]
v_pk_add_f32 v[146:147],v[146:147],v[154:155]
v_pk_add_f32 v[148:149],v[148:149],v[156:157]
v_pk_add_f32 v[150:151],v[150:151],v[158:159]
s_waitcnt lgkmcnt(0)
v_pk_add_f32 v[160:161],v[160:161],v[168:169]
v_pk_add_f32 v[162:163],v[162:163],v[170:171]
v_pk_add_f32 v[164:165],v[164:165],v[172:173]
v_pk_add_f32 v[166:167],v[166:167],v[174:175]
v_pk_add_f32 v[144:145],v[144:145],v[160:161]
v_pk_add_f32 v[146:147],v[146:147],v[162:163]
v_pk_add_f32 v[148:149],v[148:149],v[164:165]
v_pk_add_f32 v[150:151],v[150:151],v[166:167]
buffer_store_dwordx4 v[144:147],v205,s[8:11],s64 offen sc1
buffer_store_dwordx4 v[148:151],v205,s[8:11],s64 offen offset:256 sc1
s_mov_b32 s59,s82
s_cmp_eq_u32 s37,0
s_cbranch_scc1 WO_NEXT
s_waitcnt vmcnt(0)
s_mov_b64 exec,1
buffer_store_dword v5,v1,s[8:11],s59 offen sc1
s_mov_b64 exec,-1
s_mov_b32 s59,2147483648
s_cmp_lt_u32 s32,128
s_cbranch_scc1 WO_COLD
s_endpgm
ROLE_R1:
s_lshr_b32 s80,s48,3
s_and_b32 s48,s48,7
v_lshlrev_b32 v1,4,v0
v_mov_b32 v5,1
s_lshl_b32 s56,s48,2
s_add_u32 s56,s56,s46
v_bfe_u32 v6,v0,2,2
v_lshrrev_b32 v7,4,v0
v_add_u32 v7,v6,v7
v_and_b32 v7,3,v7
v_and_b32 v15,3,v0
v_lshlrev_b32 v15,4,v15
v_lshl_add_u32 v15,v7,6,v15
v_lshl_add_u32 v15,v6,8,v15
v_lshrrev_b32 v6,4,v0
v_bfe_u32 v7,v0,2,2
v_and_b32 v8,3,v0
s_lshr_b32 s60,s48,2
s_lshl_b32 s70,s60,10
s_and_b32 s61,s48,3
s_lshl_b32 s60,s61,8
s_add_u32 s70,s70,s60
v_lshrrev_b32 v9,1,v6
v_lshlrev_b32 v18,11,v9
v_add_u32 v9,s61,v7
v_and_b32 v9,3,v9
v_lshl_add_u32 v18,v9,6,v18
v_lshl_add_u32 v18,v8,4,v18
v_add_u32 v18,s70,v18
v_and_b32 v9,1,v6
v_lshl_add_u32 v16,v9,3,v18
v_lshl_add_u32 v17,v9,14,v18
s_lshl_b32 s60,s48,2
v_add_u32 v9,s60,v8
v_mul_u32_u24 v19,1280,v9
v_lshl_add_u32 v19,v6,5,v19
v_lshl_add_u32 v19,v7,3,v19
v_lshlrev_b32 v21,5,v8
s_lshl_b32 s60,s46,3
v_add_u32 v20,s60,v21
v_min_u32 v2,39,v0
v_lshlrev_b32 v2,3,v2
s_lshr_b32 s60,s48,2
s_mul_i32 s60,s60,320
v_add_u32 v2,s60,v2
s_cmp_lt_u32 s46,2
s_cselect_b32 s68,0,2147483648
s_cselect_b32 s69,1.0,0
s_waitcnt vmcnt(0)
s_barrier
s_cmp_lg_u32 s46,0
s_cbranch_scc1 arr_284
v_mov_b32 v6,1
s_lshl_b32 s3,s49,2
v_mov_b32 v7,s3
s_mov_b64 exec,1
buffer_atomic_add v6,v7,s[12:15],0 offen sc1
s_mov_b64 exec,-1
arr_284:
s_lshl_b32 s3,s49,2
v_mov_b32 v7,s3
s_nop 1
ibw_285:
buffer_load_dword v6,v7,s[12:15],0 offen sc1
s_waitcnt vmcnt(0)
v_cmp_ne_u32 vcc,256,v6
s_nop 0
s_cbranch_vccz ok_286
s_sleep 8
s_sub_u32 s47,s47,1
s_cbranch_scc1 ABORT
s_branch ibw_285
ok_286:
s_cmp_lg_u32 s49,0
s_cbranch_scc1 ibok_287
v_and_b32 v7,7,v0
v_lshlrev_b32 v7,2,v7
buffer_load_dword v6,v7,s[12:15],0 offen offset:32 sc1
s_waitcnt vmcnt(0)
v_cmp_ne_u32 vcc,32,v6
s_nop 0
s_cbranch_vccz ibok_287
s_barrier
s_mov_b32 s49,1
s_mov_b32 s3,s2
s_load_dwordx16 s[16:31],s[0:1],0
s_load_dwordx8 s[32:39],s[0:1],64
s_waitcnt lgkmcnt(0)
s_branch DISPATCH
ibok_287:
R1_GO:
s_mov_b32 s83,s100
s_mov_b32 s50,64
s_mov_b32 s55,1
s_mov_b32 s59,1600000
v_mov_b32 v238,1024
v_mov_b32 v239,0
ds_write_b32 v238,v239
s_waitcnt lgkmcnt(0)
s_barrier
s_mov_b32 s82,-1
v_mov_b32 v40,0
v_mov_b32 v41,0
v_mov_b32 v42,0
v_mov_b32 v43,0
v_mov_b32 v52,0
v_mov_b32 v53,0
v_mov_b32 v54,0
v_mov_b32 v55,0
v_mov_b32 v64,0
v_mov_b32 v65,0
v_mov_b32 v66,0
v_mov_b32 v67,0
v_mov_b32 v76,0
v_mov_b32 v77,0
v_mov_b32 v78,0
v_mov_b32 v79,0
v_mov_b32 v108,0
v_mov_b32 v109,0
v_mov_b32 v120,0
v_mov_b32 v121,0
v_mov_b32 v122,0
v_mov_b32 v123,0
v_mov_b32 v132,0
v_mov_b32 v133,0
v_mov_b32 v134,0
v_mov_b32 v135,0
v_mov_b32 v144,0
v_mov_b32 v145,0
v_mov_b32 v146,0
v_mov_b32 v147,0
v_mov_b32 v156,0
v_mov_b32 v157,0
v_mov_b32 v158,0
v_mov_b32 v159,0
v_mov_b32 v188,0
v_mov_b32 v189,0
s_mov_b32 s51,s80
s_sub_u32 s52,s50,64
s_lshl_b32 s67,s51,6
s_add_u32 s67,s67,s52
s_mul_i32 s67,s67,640
s_add_u32 s67,s67,819200
fb_288:
buffer_load_dwordx2 v[236:237],v2,s[8:11],s67 offen sc1
s_waitcnt vmcnt(0)
v_min_u32 v236,v236,v237
v_cmp_eq_u32 vcc,0,v236
s_nop 0
s_cbranch_vccz ok_289
s_sleep 20
s_sub_u32 s47,s47,1
s_cbranch_scc1 ABORT
s_branch fb_288
ok_289:
s_mul_i32 s66,s52,491520
s_mul_i32 s60,s48,10240
s_add_u32 s66,s66,s60
s_lshl_b32 s60,s46,10
s_add_u32 s66,s66,s60
s_add_u32 s66,s66,175112192
s_mul_i32 s60,s52,40960
s_add_u32 s60,s60,234749952
s_mul_i32 s61,s52,46080
s_add_u32 s61,s61,209518592
s_cmp_eq_u32 s51,0
s_cselect_b32 s65,s60,s61
s_lshl_b32 s60,s46,12
s_add_u32 s65,s65,s60
s_cmp_lt_u32 s46,2
s_cbranch_scc1 g2_290
v_mov_b32 v40,0
v_mov_b32 v41,0
v_mov_b32 v42,0
v_mov_b32 v43,0
s_nop 0
s_branch g3_291
g2_290:
s_add_u32 s63,s65,32768
buffer_load_dwordx2 v[108:109],v16,s[8:11],s63 offen sc1
s_add_u32 s63,s66,8192
buffer_load_dwordx4 v[40:43],v1,s[8:11],s63 offen sc1
s_add_u32 s63,s66,90112
buffer_load_dwordx4 v[52:55],v1,s[8:11],s63 offen sc1
s_add_u32 s63,s66,172032
buffer_load_dwordx4 v[64:67],v1,s[8:11],s63 offen sc1
s_add_u32 s63,s66,253952
buffer_load_dwordx4 v[76:79],v1,s[8:11],s63 offen sc1
g3_291:
s_add_u32 s63,s65,0
buffer_load_dwordx2 v[104:105],v16,s[8:11],s63 offen sc1
s_add_u32 s63,s65,16384
buffer_load_dwordx2 v[106:107],v16,s[8:11],s63 offen sc1
s_add_u32 s63,s66,0
buffer_load_dwordx4 v[32:35],v1,s[8:11],s63 offen sc1
s_add_u32 s63,s66,4096
buffer_load_dwordx4 v[36:39],v1,s[8:11],s63 offen sc1
s_add_u32 s63,s66,81920
buffer_load_dwordx4 v[44:47],v1,s[8:11],s63 offen sc1
s_add_u32 s63,s66,86016
buffer_load_dwordx4 v[48:51],v1,s[8:11],s63 offen sc1
s_add_u32 s63,s66,163840
buffer_load_dwordx4 v[56:59],v1,s[8:11],s63 offen sc1
s_add_u32 s63,s66,167936
buffer_load_dwordx4 v[60:63],v1,s[8:11],s63 offen sc1
s_add_u32 s63,s66,245760
buffer_load_dwordx4 v[68:71],v1,s[8:11],s63 offen sc1
s_add_u32 s63,s66,249856
buffer_load_dwordx4 v[72:75],v1,s[8:11],s63 offen sc1
R1_A:
s_add_u32 s66,s50,1
s_min_u32 s66,s66,127
s_mov_b32 s53,s80
s_sub_u32 s54,s66,64
s_lshl_b32 s67,s53,6
s_add_u32 s67,s67,s54
s_mul_i32 s67,s67,640
s_add_u32 s67,s67,819200
s_lshl_b32 s60,s51,6
s_add_u32 s60,s60,s52
s_mul_i32 s71,s60,40960
s_mul_i32 s73,s60,5120
s_lshl_b32 s60,s46,12
s_add_u32 s71,s71,s60
s_add_u32 s72,s71,32768
s_add_u32 s72,s72,s68
s_cmp_eq_u32 s55,0
s_cbranch_scc1 r1p_292
s_waitcnt vmcnt(8)
v_lshlrev_b32 v192,16,v104
v_and_b32 v193,0xffff0000,v104
v_lshlrev_b32 v194,16,v105
v_and_b32 v195,0xffff0000,v105
v_lshlrev_b32 v196,16,v106
v_and_b32 v197,0xffff0000,v106
v_lshlrev_b32 v198,16,v107
v_and_b32 v199,0xffff0000,v107
v_lshlrev_b32 v200,16,v108
v_and_b32 v201,0xffff0000,v108
v_lshlrev_b32 v202,16,v109
v_and_b32 v203,0xffff0000,v109
s_waitcnt vmcnt(4)
v_pk_add_f32 v[32:33],v[32:33],v[44:45]
v_pk_add_f32 v[34:35],v[34:35],v[46:47]
v_pk_add_f32 v[36:37],v[36:37],v[48:49]
v_pk_add_f32 v[38:39],v[38:39],v[50:51]
v_pk_add_f32 v[40:41],v[40:41],v[52:53]
v_pk_add_f32 v[42:43],v[42:43],v[54:55]
s_waitcnt vmcnt(2)
v_pk_add_f32 v[32:33],v[32:33],v[56:57]
v_pk_add_f32 v[34:35],v[34:35],v[58:59]
v_pk_add_f32 v[36:37],v[36:37],v[60:61]
v_pk_add_f32 v[38:39],v[38:39],v[62:63]
v_pk_add_f32 v[40:41],v[40:41],v[64:65]
v_pk_add_f32 v[42:43],v[42:43],v[66:67]
s_waitcnt vmcnt(0)
v_pk_add_f32 v[32:33],v[32:33],v[68:69]
v_pk_add_f32 v[34:35],v[34:35],v[70:71]
v_pk_add_f32 v[36:37],v[36:37],v[72:73]
v_pk_add_f32 v[38:39],v[38:39],v[74:75]
v_pk_add_f32 v[40:41],v[40:41],v[76:77]
v_pk_add_f32 v[42:43],v[42:43],v[78:79]
s_nop 0
s_branch r1j_293
r1p_292:
s_waitcnt vmcnt(9)
v_lshlrev_b32 v192,16,v104
v_and_b32 v193,0xffff0000,v104
v_lshlrev_b32 v194,16,v105
v_and_b32 v195,0xffff0000,v105
v_lshlrev_b32 v196,16,v106
v_and_b32 v197,0xffff0000,v106
v_lshlrev_b32 v198,16,v107
v_and_b32 v199,0xffff0000,v107
v_lshlrev_b32 v200,16,v108
v_and_b32 v201,0xffff0000,v108
v_lshlrev_b32 v202,16,v109
v_and_b32 v203,0xffff0000,v109
s_waitcnt vmcnt(5)
v_pk_add_f32 v[32:33],v[32:33],v[44:45]
v_pk_add_f32 v[34:35],v[34:35],v[46:47]
v_pk_add_f32 v[36:37],v[36:37],v[48:49]
v_pk_add_f32 v[38:39],v[38:39],v[50:51]
v_pk_add_f32 v[40:41],v[40:41],v[52:53]
v_pk_add_f32 v[42:43],v[42:43],v[54:55]
s_waitcnt vmcnt(3)
v_pk_add_f32 v[32:33],v[32:33],v[56:57]
v_pk_add_f32 v[34:35],v[34:35],v[58:59]
v_pk_add_f32 v[36:37],v[36:37],v[60:61]
v_pk_add_f32 v[38:39],v[38:39],v[62:63]
v_pk_add_f32 v[40:41],v[40:41],v[64:65]
v_pk_add_f32 v[42:43],v[42:43],v[66:67]
s_waitcnt vmcnt(1)
v_pk_add_f32 v[32:33],v[32:33],v[68:69]
v_pk_add_f32 v[34:35],v[34:35],v[70:71]
v_pk_add_f32 v[36:37],v[36:37],v[72:73]
v_pk_add_f32 v[38:39],v[38:39],v[74:75]
v_pk_add_f32 v[40:41],v[40:41],v[76:77]
v_pk_add_f32 v[42:43],v[42:43],v[78:79]
s_nop 1
r1j_293:
v_cvt_pk_bf16_f32 v6,v32,v33
v_lshlrev_b32 v32,16,v6
v_and_b32 v33,0xffff0000,v6
v_cvt_pk_bf16_f32 v6,v34,v35
v_lshlrev_b32 v34,16,v6
v_and_b32 v35,0xffff0000,v6
v_cvt_pk_bf16_f32 v6,v36,v37
v_lshlrev_b32 v36,16,v6
v_and_b32 v37,0xffff0000,v6
v_cvt_pk_bf16_f32 v6,v38,v39
v_lshlrev_b32 v38,16,v6
v_and_b32 v39,0xffff0000,v6
v_cvt_pk_bf16_f32 v6,v40,v41
v_lshlrev_b32 v40,16,v6
v_and_b32 v41,0xffff0000,v6
v_cvt_pk_bf16_f32 v6,v42,v43
v_lshlrev_b32 v42,16,v6
v_and_b32 v43,0xffff0000,v6
v_pk_add_f32 v[32:33],v[32:33],v[192:193]
v_pk_add_f32 v[34:35],v[34:35],v[194:195]
v_pk_add_f32 v[36:37],v[36:37],v[196:197]
v_pk_add_f32 v[38:39],v[38:39],v[198:199]
v_pk_add_f32 v[40:41],v[40:41],v[200:201]
v_pk_add_f32 v[42:43],v[42:43],v[202:203]
v_cvt_pk_bf16_f32 v204,v32,v33
v_lshlrev_b32 v32,16,v204
v_and_b32 v33,0xffff0000,v204
v_cvt_pk_bf16_f32 v205,v34,v35
v_lshlrev_b32 v34,16,v205
v_and_b32 v35,0xffff0000,v205
v_cvt_pk_bf16_f32 v206,v36,v37
v_lshlrev_b32 v36,16,v206
v_and_b32 v37,0xffff0000,v206
v_cvt_pk_bf16_f32 v207,v38,v39
v_lshlrev_b32 v38,16,v207
v_and_b32 v39,0xffff0000,v207
v_cvt_pk_bf16_f32 v208,v40,v41
v_lshlrev_b32 v40,16,v208
v_and_b32 v41,0xffff0000,v208
v_cvt_pk_bf16_f32 v209,v42,v43
v_lshlrev_b32 v42,16,v209
v_and_b32 v43,0xffff0000,v209
v_pk_add_f32 v[28:29],v[32:33],v[34:35]
v_pk_mul_f32 v[26:27],v[32:33],v[32:33]
v_pk_fma_f32 v[26:27],v[34:35],v[34:35],v[26:27]
v_pk_add_f32 v[28:29],v[28:29],v[36:37]
v_pk_fma_f32 v[26:27],v[36:37],v[36:37],v[26:27]
v_pk_add_f32 v[28:29],v[28:29],v[38:39]
v_pk_fma_f32 v[26:27],v[38:39],v[38:39],v[26:27]
v_pk_add_f32 v[28:29],v[28:29],v[40:41]
v_pk_fma_f32 v[26:27],v[40:41],v[40:41],v[26:27]
v_pk_add_f32 v[28:29],v[28:29],v[42:43]
v_pk_fma_f32 v[26:27],v[42:43],v[42:43],v[26:27]
v_add_f32 v24,v28,v29
v_add_f32 v25,v26,v27
s_nop 0
v_add_f32_dpp v24,v24,v24 row_ror:4 row_mask:0xf bank_mask:0xf
v_add_f32_dpp v25,v25,v25 row_ror:4 row_mask:0xf bank_mask:0xf
s_nop 0
v_add_f32_dpp v24,v24,v24 row_ror:8 row_mask:0xf bank_mask:0xf
v_add_f32_dpp v25,v25,v25 row_ror:8 row_mask:0xf bank_mask:0xf
v_mov_b32 v26,v24
v_mov_b32 v27,v25
s_nop 0
v_permlane32_swap_b32 v24,v26
v_permlane32_swap_b32 v25,v27
v_add_f32 v24,v24,v26
v_add_f32 v25,v25,v27
v_mov_b32 v26,v24
v_mov_b32 v27,v25
s_nop 0
v_permlane16_swap_b32 v24,v26
v_permlane16_swap_b32 v25,v27
v_add_f32 v24,v24,v26
v_add_f32 v25,v25,v27
ds_write_b64 v20,v[24:25] offset:0
s_waitcnt lgkmcnt(0)
s_barrier
ds_read_b128 v[228:231],v21 offset:0
ds_read_b128 v[232:235],v21 offset:16
buffer_load_dwordx2 v[236:237],v2,s[8:11],s67 offen sc1
v_mov_b32 v210,v208
v_mov_b32 v211,v209
s_add_u32 s63,s71,218365952
v_permlane16_swap_b32 v204,v206
v_permlane16_swap_b32 v205,v207
buffer_store_dwordx4 v[204:207],v17,s[8:11],s63 offen sc1
s_add_u32 s63,s72,218365952
v_permlane16_swap_b32 v208,v210
v_permlane16_swap_b32 v209,v211
buffer_store_dwordx4 v[208:211],v18,s[8:11],s63 offen sc1
s_waitcnt lgkmcnt(0)
v_pk_add_f32 v[228:229],v[228:229],v[230:231]
v_pk_add_f32 v[232:233],v[232:233],v[234:235]
v_pk_add_f32 v[24:25],v[228:229],v[232:233]
v_mul_f32 v24,0x3acccccd,v24
v_mul_f32 v25,0x3acccccd,v25
v_fma_f32 v25,-v24,v24,v25
v_max_f32 v25,0,v25
v_mov_b32 v28,v24
v_mov_b32 v29,v25
v_cvt_pk_bf16_f32 v6,v24,v25
v_lshlrev_b32 v24,16,v6
v_and_b32 v25,0xffff0000,v6
v_add_f32 v25,0x3727c5ac,v25
v_cvt_pk_bf16_f32 v6,v25,v25
v_lshlrev_b32 v25,16,v6
v_sqrt_f32 v25,v25
s_nop 0
v_cvt_pk_bf16_f32 v6,v25,v25
v_lshlrev_b32 v25,16,v6
v_rcp_f32 v25,v25
s_nop 0
v_pk_add_f32 v[32:33],v[32:33],v[24:25] op_sel_hi:[1,0] neg_lo:[0,1] neg_hi:[0,1]
v_pk_add_f32 v[34:35],v[34:35],v[24:25] op_sel_hi:[1,0] neg_lo:[0,1] neg_hi:[0,1]
v_pk_add_f32 v[36:37],v[36:37],v[24:25] op_sel_hi:[1,0] neg_lo:[0,1] neg_hi:[0,1]
v_pk_add_f32 v[38:39],v[38:39],v[24:25] op_sel_hi:[1,0] neg_lo:[0,1] neg_hi:[0,1]
v_pk_add_f32 v[40:41],v[40:41],v[24:25] op_sel_hi:[1,0] neg_lo:[0,1] neg_hi:[0,1]
v_pk_add_f32 v[42:43],v[42:43],v[24:25] op_sel_hi:[1,0] neg_lo:[0,1] neg_hi:[0,1]
v_cvt_pk_bf16_f32 v6,v32,v33
v_lshlrev_b32 v32,16,v6
v_and_b32 v33,0xffff0000,v6
v_cvt_pk_bf16_f32 v8,v34,v35
v_lshlrev_b32 v34,16,v8
v_and_b32 v35,0xffff0000,v8
v_cvt_pk_bf16_f32 v6,v36,v37
v_lshlrev_b32 v36,16,v6
v_and_b32 v37,0xffff0000,v6
v_cvt_pk_bf16_f32 v8,v38,v39
v_lshlrev_b32 v38,16,v8
v_and_b32 v39,0xffff0000,v8
v_cvt_pk_bf16_f32 v6,v40,v41
v_lshlrev_b32 v40,16,v6
v_and_b32 v41,0xffff0000,v6
v_cvt_pk_bf16_f32 v8,v42,v43
v_lshlrev_b32 v42,16,v8
v_and_b32 v43,0xffff0000,v8
v_pk_mul_f32 v[32:33],v[32:33],v[24:25] op_sel:[0,1] op_sel_hi:[1,1]
v_pk_mul_f32 v[34:35],v[34:35],v[24:25] op_sel:[0,1] op_sel_hi:[1,1]
v_pk_mul_f32 v[36:37],v[36:37],v[24:25] op_sel:[0,1] op_sel_hi:[1,1]
v_pk_mul_f32 v[38:39],v[38:39],v[24:25] op_sel:[0,1] op_sel_hi:[1,1]
v_pk_mul_f32 v[40:41],v[40:41],v[24:25] op_sel:[0,1] op_sel_hi:[1,1]
v_pk_mul_f32 v[42:43],v[42:43],v[24:25] op_sel:[0,1] op_sel_hi:[1,1]
v_cvt_pk_bf16_f32 v212,v32,v33
v_lshlrev_b32 v32,16,v212
v_and_b32 v33,0xffff0000,v212
v_cvt_pk_bf16_f32 v213,v34,v35
v_lshlrev_b32 v34,16,v213
v_and_b32 v35,0xffff0000,v213
v_cvt_pk_bf16_f32 v214,v36,v37
v_lshlrev_b32 v36,16,v214
v_and_b32 v37,0xffff0000,v214
v_cvt_pk_bf16_f32 v215,v38,v39
v_lshlrev_b32 v38,16,v215
v_and_b32 v39,0xffff0000,v215
v_cvt_pk_bf16_f32 v216,v40,v41
v_lshlrev_b32 v40,16,v216
v_and_b32 v41,0xffff0000,v216
v_cvt_pk_bf16_f32 v217,v42,v43
v_lshlrev_b32 v42,16,v217
v_and_b32 v43,0xffff0000,v217
v_mov_b32 v218,v216
v_mov_b32 v219,v217
s_add_u32 s63,s71,223608832
s_add_u32 s63,s63,s73
v_permlane16_swap_b32 v212,v214
v_permlane16_swap_b32 v213,v215
buffer_store_dwordx4 v[212:215],v17,s[8:11],s63 offen sc1
s_add_u32 s63,s72,223608832
s_add_u32 s63,s63,s73
v_permlane16_swap_b32 v216,v218
v_permlane16_swap_b32 v217,v219
buffer_store_dwordx4 v[216:219],v18,s[8:11],s63 offen sc1
v_sub_f32 v28,v28,v24
v_mul_f32 v29,v29,v25
v_mul_f32 v28,v28,v25
v_mul_f32 v29,v29,v25
v_cvt_pk_bf16_f32 v6,v28,v29
v_lshlrev_b32 v28,16,v6
v_and_b32 v29,0xffff0000,v6
v_add_f32 v29,0x3727c5ac,v29
v_cvt_pk_bf16_f32 v6,v29,v29
v_lshlrev_b32 v29,16,v6
v_sqrt_f32 v29,v29
s_nop 0
v_cvt_pk_bf16_f32 v6,v29,v29
v_lshlrev_b32 v29,16,v6
v_rcp_f32 v29,v29
s_lshl_b32 s60,s46,12
s_sub_u32 s63,s71,s60
s_add_u32 s63,s63,s73
s_lshl_b32 s60,s48,5
s_add_u32 s63,s63,s60
s_add_u32 s63,s63,223649792
v_lshlrev_b32 v6,3,v0
s_cmp_lg_u32 s46,3
s_cbranch_scc1 zs_294
s_mov_b64 exec,15
buffer_store_dwordx2 v[28:29],v6,s[8:11],s63 offen sc1
s_mov_b64 exec,-1
zs_294:
s_lshl_b32 s82,s51,6
s_add_u32 s82,s82,s52
s_lshl_b32 s82,s82,9
s_add_u32 s82,s82,393216
s_lshl_b32 s61,s56,2
s_add_u32 s82,s82,s61
s_add_u32 s50,s50,1
s_cmp_eq_u32 s50,128
s_cbranch_scc1 R1_END
s_mov_b32 s51,s53
s_mov_b32 s52,s54
s_waitcnt vmcnt(4)
v_min_u32 v236,v236,v237
v_cmp_eq_u32 vcc,0,v236
s_nop 0
s_cbranch_vccnz nr_295
s_add_u32 s60,s50,0
v_mov_b32 v239,s60
ds_write_b32 v238,v239
s_mul_i32 s66,s52,491520
s_mul_i32 s60,s48,10240
s_add_u32 s66,s66,s60
s_lshl_b32 s60,s46,10
s_add_u32 s66,s66,s60
s_add_u32 s66,s66,175112192
s_mul_i32 s60,s52,40960
s_add_u32 s60,s60,234749952
s_mul_i32 s61,s52,46080
s_add_u32 s61,s61,209518592
s_cmp_eq_u32 s51,0
s_cselect_b32 s65,s60,s61
s_lshl_b32 s60,s46,12
s_add_u32 s65,s65,s60
s_cmp_lt_u32 s46,2
s_cbranch_scc1 g2_296
v_mov_b32 v120,0
v_mov_b32 v121,0
v_mov_b32 v122,0
v_mov_b32 v123,0
s_nop 0
s_branch g3_297
g2_296:
s_add_u32 s63,s65,32768
buffer_load_dwordx2 v[188:189],v16,s[8:11],s63 offen sc1
s_add_u32 s63,s66,8192
buffer_load_dwordx4 v[120:123],v1,s[8:11],s63 offen sc1
s_add_u32 s63,s66,90112
buffer_load_dwordx4 v[132:135],v1,s[8:11],s63 offen sc1
s_add_u32 s63,s66,172032
buffer_load_dwordx4 v[144:147],v1,s[8:11],s63 offen sc1
s_add_u32 s63,s66,253952
buffer_load_dwordx4 v[156:159],v1,s[8:11],s63 offen sc1
g3_297:
s_add_u32 s63,s65,0
buffer_load_dwordx2 v[184:185],v16,s[8:11],s63 offen sc1
s_add_u32 s63,s65,16384
buffer_load_dwordx2 v[186:187],v16,s[8:11],s63 offen sc1
s_add_u32 s63,s66,0
buffer_load_dwordx4 v[112:115],v1,s[8:11],s63 offen sc1
s_add_u32 s63,s66,4096
buffer_load_dwordx4 v[116:119],v1,s[8:11],s63 offen sc1
s_add_u32 s63,s66,81920
buffer_load_dwordx4 v[124:127],v1,s[8:11],s63 offen sc1
s_add_u32 s63,s66,86016
buffer_load_dwordx4 v[128:131],v1,s[8:11],s63 offen sc1
s_add_u32 s63,s66,163840
buffer_load_dwordx4 v[136:139],v1,s[8:11],s63 offen sc1
s_add_u32 s63,s66,167936
buffer_load_dwordx4 v[140:143],v1,s[8:11],s63 offen sc1
s_add_u32 s63,s66,245760
buffer_load_dwordx4 v[148:151],v1,s[8:11],s63 offen sc1
s_add_u32 s63,s66,249856
buffer_load_dwordx4 v[152:155],v1,s[8:11],s63 offen sc1
s_waitcnt vmcnt(10)
s_mov_b64 exec,1
buffer_store_dword v5,v1,s[8:11],s82 offen sc1
s_mov_b64 exec,-1
s_mov_b32 s55,0
s_branch R1_B
nr_295:
s_mov_b32 s55,1
s_waitcnt vmcnt(0)
s_mov_b64 exec,1
buffer_store_dword v5,v1,s[8:11],s82 offen sc1
s_mov_b64 exec,-1
s_mov_b32 s82,-1
s_lshl_b32 s67,s51,6
s_add_u32 s67,s67,s52
s_mul_i32 s67,s67,640
s_add_u32 s67,s67,819200
s_cmp_lg_u32 s46,0
s_cbranch_scc1 wo_298
fb_300:
buffer_load_dwordx2 v[236:237],v2,s[8:11],s67 offen sc1
s_waitcnt vmcnt(0)
v_min_u32 v236,v236,v237
v_cmp_eq_u32 vcc,0,v236
s_nop 0
s_cbranch_vccz ok_301
s_sleep 7
s_sub_u32 s47,s47,1
s_cbranch_scc1 ABORT
s_branch fb_300
ok_301:
s_add_u32 s60,s50,0
v_mov_b32 v239,s60
ds_write_b32 v238,v239
s_branch wd_299
wo_298:
ds_read_b32 v239,v238
s_waitcnt lgkmcnt(0)
v_cmp_gt_u32 vcc,s50,v239
s_nop 0
s_cbranch_vccz wd_299
s_sleep 1
s_sub_u32 s59,s59,1
s_cbranch_scc1 ABORT
s_branch wo_298
wd_299:
s_mul_i32 s66,s52,491520
s_mul_i32 s60,s48,10240
s_add_u32 s66,s66,s60
s_lshl_b32 s60,s46,10
s_add_u32 s66,s66,s60
s_add_u32 s66,s66,175112192
s_mul_i32 s60,s52,40960
s_add_u32 s60,s60,234749952
s_mul_i32 s61,s52,46080
s_add_u32 s61,s61,209518592
s_cmp_eq_u32 s51,0
s_cselect_b32 s65,s60,s61
s_lshl_b32 s60,s46,12
s_add_u32 s65,s65,s60
s_cmp_lt_u32 s46,2
s_cbranch_scc1 g2_302
v_mov_b32 v120,0
v_mov_b32 v121,0
v_mov_b32 v122,0
v_mov_b32 v123,0
s_nop 0
s_branch g3_303
g2_302:
s_add_u32 s63,s65,32768
buffer_load_dwordx2 v[188:189],v16,s[8:11],s63 offen sc1
s_add_u32 s63,s66,8192
buffer_load_dwordx4 v[120:123],v1,s[8:11],s63 offen sc1
s_add_u32 s63,s66,90112
buffer_load_dwordx4 v[132:135],v1,s[8:11],s63 offen sc1
s_add_u32 s63,s66,172032
buffer_load_dwordx4 v[144:147],v1,s[8:11],s63 offen sc1
s_add_u32 s63,s66,253952
buffer_load_dwordx4 v[156:159],v1,s[8:11],s63 offen sc1
g3_303:
s_add_u32 s63,s65,0
buffer_load_dwordx2 v[184:185],v16,s[8:11],s63 offen sc1
s_add_u32 s63,s65,16384
buffer_load_dwordx2 v[186:187],v16,s[8:11],s63 offen sc1
s_add_u32 s63,s66,0
buffer_load_dwordx4 v[112:115],v1,s[8:11],s63 offen sc1
s_add_u32 s63,s66,4096
buffer_load_dwordx4 v[116:119],v1,s[8:11],s63 offen sc1
s_add_u32 s63,s66,81920
buffer_load_dwordx4 v[124:127],v1,s[8:11],s63 offen sc1
s_add_u32 s63,s66,86016
buffer_load_dwordx4 v[128:131],v1,s[8:11],s63 offen sc1
s_add_u32 s63,s66,163840
buffer_load_dwordx4 v[136:139],v1,s[8:11],s63 offen sc1
s_add_u32 s63,s66,167936
buffer_load_dwordx4 v[140:143],v1,s[8:11],s63 offen sc1
s_add_u32 s63,s66,245760
buffer_load_dwordx4 v[148:151],v1,s[8:11],s63 offen sc1
s_add_u32 s63,s66,249856
buffer_load_dwordx4 v[152:155],v1,s[8:11],s63 offen sc1
s_branch R1_B
R1_B:
s_add_u32 s66,s50,1
s_min_u32 s66,s66,127
s_mov_b32 s53,s80
s_sub_u32 s54,s66,64
s_lshl_b32 s67,s53,6
s_add_u32 s67,s67,s54
s_mul_i32 s67,s67,640
s_add_u32 s67,s67,819200
s_lshl_b32 s60,s51,6
s_add_u32 s60,s60,s52
s_mul_i32 s71,s60,40960
s_mul_i32 s73,s60,5120
s_lshl_b32 s60,s46,12
s_add_u32 s71,s71,s60
s_add_u32 s72,s71,32768
s_add_u32 s72,s72,s68
s_cmp_eq_u32 s55,0
s_cbranch_scc1 r1p_304
s_waitcnt vmcnt(8)
v_lshlrev_b32 v192,16,v184
v_and_b32 v193,0xffff0000,v184
v_lshlrev_b32 v194,16,v185
v_and_b32 v195,0xffff0000,v185
v_lshlrev_b32 v196,16,v186
v_and_b32 v197,0xffff0000,v186
v_lshlrev_b32 v198,16,v187
v_and_b32 v199,0xffff0000,v187
v_lshlrev_b32 v200,16,v188
v_and_b32 v201,0xffff0000,v188
v_lshlrev_b32 v202,16,v189
v_and_b32 v203,0xffff0000,v189
s_waitcnt vmcnt(4)
v_pk_add_f32 v[112:113],v[112:113],v[124:125]
v_pk_add_f32 v[114:115],v[114:115],v[126:127]
v_pk_add_f32 v[116:117],v[116:117],v[128:129]
v_pk_add_f32 v[118:119],v[118:119],v[130:131]
v_pk_add_f32 v[120:121],v[120:121],v[132:133]
v_pk_add_f32 v[122:123],v[122:123],v[134:135]
s_waitcnt vmcnt(2)
v_pk_add_f32 v[112:113],v[112:113],v[136:137]
v_pk_add_f32 v[114:115],v[114:115],v[138:139]
v_pk_add_f32 v[116:117],v[116:117],v[140:141]
v_pk_add_f32 v[118:119],v[118:119],v[142:143]
v_pk_add_f32 v[120:121],v[120:121],v[144:145]
v_pk_add_f32 v[122:123],v[122:123],v[146:147]
s_waitcnt vmcnt(0)
v_pk_add_f32 v[112:113],v[112:113],v[148:149]
v_pk_add_f32 v[114:115],v[114:115],v[150:151]
v_pk_add_f32 v[116:117],v[116:117],v[152:153]
v_pk_add_f32 v[118:119],v[118:119],v[154:155]
v_pk_add_f32 v[120:121],v[120:121],v[156:157]
v_pk_add_f32 v[122:123],v[122:123],v[158:159]
s_nop 0
s_branch r1j_305
r1p_304:
s_waitcnt vmcnt(9)
v_lshlrev_b32 v192,16,v184
v_and_b32 v193,0xffff0000,v184
v_lshlrev_b32 v194,16,v185
v_and_b32 v195,0xffff0000,v185
v_lshlrev_b32 v196,16,v186
v_and_b32 v197,0xffff0000,v186
v_lshlrev_b32 v198,16,v187
v_and_b32 v199,0xffff0000,v187
v_lshlrev_b32 v200,16,v188
v_and_b32 v201,0xffff0000,v188
v_lshlrev_b32 v202,16,v189
v_and_b32 v203,0xffff0000,v189
s_waitcnt vmcnt(5)
v_pk_add_f32 v[112:113],v[112:113],v[124:125]
v_pk_add_f32 v[114:115],v[114:115],v[126:127]
v_pk_add_f32 v[116:117],v[116:117],v[128:129]
v_pk_add_f32 v[118:119],v[118:119],v[130:131]
v_pk_add_f32 v[120:121],v[120:121],v[132:133]
v_pk_add_f32 v[122:123],v[122:123],v[134:135]
s_waitcnt vmcnt(3)
v_pk_add_f32 v[112:113],v[112:113],v[136:137]
v_pk_add_f32 v[114:115],v[114:115],v[138:139]
v_pk_add_f32 v[116:117],v[116:117],v[140:141]
v_pk_add_f32 v[118:119],v[118:119],v[142:143]
v_pk_add_f32 v[120:121],v[120:121],v[144:145]
v_pk_add_f32 v[122:123],v[122:123],v[146:147]
s_waitcnt vmcnt(1)
v_pk_add_f32 v[112:113],v[112:113],v[148:149]
v_pk_add_f32 v[114:115],v[114:115],v[150:151]
v_pk_add_f32 v[116:117],v[116:117],v[152:153]
v_pk_add_f32 v[118:119],v[118:119],v[154:155]
v_pk_add_f32 v[120:121],v[120:121],v[156:157]
v_pk_add_f32 v[122:123],v[122:123],v[158:159]
s_nop 1
r1j_305:
v_cvt_pk_bf16_f32 v6,v112,v113
v_lshlrev_b32 v112,16,v6
v_and_b32 v113,0xffff0000,v6
v_cvt_pk_bf16_f32 v6,v114,v115
v_lshlrev_b32 v114,16,v6
v_and_b32 v115,0xffff0000,v6
v_cvt_pk_bf16_f32 v6,v116,v117
v_lshlrev_b32 v116,16,v6
v_and_b32 v117,0xffff0000,v6
v_cvt_pk_bf16_f32 v6,v118,v119
v_lshlrev_b32 v118,16,v6
v_and_b32 v119,0xffff0000,v6
v_cvt_pk_bf16_f32 v6,v120,v121
v_lshlrev_b32 v120,16,v6
v_and_b32 v121,0xffff0000,v6
v_cvt_pk_bf16_f32 v6,v122,v123
v_lshlrev_b32 v122,16,v6
v_and_b32 v123,0xffff0000,v6
v_pk_add_f32 v[112:113],v[112:113],v[192:193]
v_pk_add_f32 v[114:115],v[114:115],v[194:195]
v_pk_add_f32 v[116:117],v[116:117],v[196:197]
v_pk_add_f32 v[118:119],v[118:119],v[198:199]
v_pk_add_f32 v[120:121],v[120:121],v[200:201]
v_pk_add_f32 v[122:123],v[122:123],v[202:203]
v_cvt_pk_bf16_f32 v204,v112,v113
v_lshlrev_b32 v112,16,v204
v_and_b32 v113,0xffff0000,v204
v_cvt_pk_bf16_f32 v205,v114,v115
v_lshlrev_b32 v114,16,v205
v_and_b32 v115,0xffff0000,v205
v_cvt_pk_bf16_f32 v206,v116,v117
v_lshlrev_b32 v116,16,v206
v_and_b32 v117,0xffff0000,v206
v_cvt_pk_bf16_f32 v207,v118,v119
v_lshlrev_b32 v118,16,v207
v_and_b32 v119,0xffff0000,v207
v_cvt_pk_bf16_f32 v208,v120,v121
v_lshlrev_b32 v120,16,v208
v_and_b32 v121,0xffff0000,v208
v_cvt_pk_bf16_f32 v209,v122,v123
v_lshlrev_b32 v122,16,v209
v_and_b32 v123,0xffff0000,v209
v_pk_add_f32 v[28:29],v[112:113],v[114:115]
v_pk_mul_f32 v[26:27],v[112:113],v[112:113]
v_pk_fma_f32 v[26:27],v[114:115],v[114:115],v[26:27]
v_pk_add_f32 v[28:29],v[28:29],v[116:117]
v_pk_fma_f32 v[26:27],v[116:117],v[116:117],v[26:27]
v_pk_add_f32 v[28:29],v[28:29],v[118:119]
v_pk_fma_f32 v[26:27],v[118:119],v[118:119],v[26:27]
v_pk_add_f32 v[28:29],v[28:29],v[120:121]
v_pk_fma_f32 v[26:27],v[120:121],v[120:121],v[26:27]
v_pk_add_f32 v[28:29],v[28:29],v[122:123]
v_pk_fma_f32 v[26:27],v[122:123],v[122:123],v[26:27]
v_add_f32 v24,v28,v29
v_add_f32 v25,v26,v27
s_nop 0
v_add_f32_dpp v24,v24,v24 row_ror:4 row_mask:0xf bank_mask:0xf
v_add_f32_dpp v25,v25,v25 row_ror:4 row_mask:0xf bank_mask:0xf
s_nop 0
v_add_f32_dpp v24,v24,v24 row_ror:8 row_mask:0xf bank_mask:0xf
v_add_f32_dpp v25,v25,v25 row_ror:8 row_mask:0xf bank_mask:0xf
v_mov_b32 v26,v24
v_mov_b32 v27,v25
s_nop 0
v_permlane32_swap_b32 v24,v26
v_permlane32_swap_b32 v25,v27
v_add_f32 v24,v24,v26
v_add_f32 v25,v25,v27
v_mov_b32 v26,v24
v_mov_b32 v27,v25
s_nop 0
v_permlane16_swap_b32 v24,v26
v_permlane16_swap_b32 v25,v27
v_add_f32 v24,v24,v26
v_add_f32 v25,v25,v27
ds_write_b64 v20,v[24:25] offset:128
s_waitcnt lgkmcnt(0)
s_barrier
ds_read_b128 v[228:231],v21 offset:128
ds_read_b128 v[232:235],v21 offset:144
buffer_load_dwordx2 v[236:237],v2,s[8:11],s67 offen sc1
v_mov_b32 v210,v208
v_mov_b32 v211,v209
s_add_u32 s63,s71,218365952
v_permlane16_swap_b32 v204,v206
v_permlane16_swap_b32 v205,v207
buffer_store_dwordx4 v[204:207],v17,s[8:11],s63 offen sc1
s_add_u32 s63,s72,218365952
v_permlane16_swap_b32 v208,v210
v_permlane16_swap_b32 v209,v211
buffer_store_dwordx4 v[208:211],v18,s[8:11],s63 offen sc1
s_waitcnt lgkmcnt(0)
v_pk_add_f32 v[228:229],v[228:229],v[230:231]
v_pk_add_f32 v[232:233],v[232:233],v[234:235]
v_pk_add_f32 v[24:25],v[228:229],v[232:233]
v_mul_f32 v24,0x3acccccd,v24
v_mul_f32 v25,0x3acccccd,v25
v_fma_f32 v25,-v24,v24,v25
v_max_f32 v25,0,v25
v_mov_b32 v28,v24
v_mov_b32 v29,v25
v_cvt_pk_bf16_f32 v6,v24,v25
v_lshlrev_b32 v24,16,v6
v_and_b32 v25,0xffff0000,v6
v_add_f32 v25,0x3727c5ac,v25
v_cvt_pk_bf16_f32 v6,v25,v25
v_lshlrev_b32 v25,16,v6
v_sqrt_f32 v25,v25
s_nop 0
v_cvt_pk_bf16_f32 v6,v25,v25
v_lshlrev_b32 v25,16,v6
v_rcp_f32 v25,v25
s_nop 0
v_pk_add_f32 v[112:113],v[112:113],v[24:25] op_sel_hi:[1,0] neg_lo:[0,1] neg_hi:[0,1]
v_pk_add_f32 v[114:115],v[114:115],v[24:25] op_sel_hi:[1,0] neg_lo:[0,1] neg_hi:[0,1]
v_pk_add_f32 v[116:117],v[116:117],v[24:25] op_sel_hi:[1,0] neg_lo:[0,1] neg_hi:[0,1]
v_pk_add_f32 v[118:119],v[118:119],v[24:25] op_sel_hi:[1,0] neg_lo:[0,1] neg_hi:[0,1]
v_pk_add_f32 v[120:121],v[120:121],v[24:25] op_sel_hi:[1,0] neg_lo:[0,1] neg_hi:[0,1]
v_pk_add_f32 v[122:123],v[122:123],v[24:25] op_sel_hi:[1,0] neg_lo:[0,1] neg_hi:[0,1]
v_cvt_pk_bf16_f32 v6,v112,v113
v_lshlrev_b32 v112,16,v6
v_and_b32 v113,0xffff0000,v6
v_cvt_pk_bf16_f32 v8,v114,v115
v_lshlrev_b32 v114,16,v8
v_and_b32 v115,0xffff0000,v8
v_cvt_pk_bf16_f32 v6,v116,v117
v_lshlrev_b32 v116,16,v6
v_and_b32 v117,0xffff0000,v6
v_cvt_pk_bf16_f32 v8,v118,v119
v_lshlrev_b32 v118,16,v8
v_and_b32 v119,0xffff0000,v8
v_cvt_pk_bf16_f32 v6,v120,v121
v_lshlrev_b32 v120,16,v6
v_and_b32 v121,0xffff0000,v6
v_cvt_pk_bf16_f32 v8,v122,v123
v_lshlrev_b32 v122,16,v8
v_and_b32 v123,0xffff0000,v8
v_pk_mul_f32 v[112:113],v[112:113],v[24:25] op_sel:[0,1] op_sel_hi:[1,1]
v_pk_mul_f32 v[114:115],v[114:115],v[24:25] op_sel:[0,1] op_sel_hi:[1,1]
v_pk_mul_f32 v[116:117],v[116:117],v[24:25] op_sel:[0,1] op_sel_hi:[1,1]
v_pk_mul_f32 v[118:119],v[118:119],v[24:25] op_sel:[0,1] op_sel_hi:[1,1]
v_pk_mul_f32 v[120:121],v[120:121],v[24:25] op_sel:[0,1] op_sel_hi:[1,1]
v_pk_mul_f32 v[122:123],v[122:123],v[24:25] op_sel:[0,1] op_sel_hi:[1,1]
v_cvt_pk_bf16_f32 v212,v112,v113
v_lshlrev_b32 v112,16,v212
v_and_b32 v113,0xffff0000,v212
v_cvt_pk_bf16_f32 v213,v114,v115
v_lshlrev_b32 v114,16,v213
v_and_b32 v115,0xffff0000,v213
v_cvt_pk_bf16_f32 v214,v116,v117
v_lshlrev_b32 v116,16,v214
v_and_b32 v117,0xffff0000,v214
v_cvt_pk_bf16_f32 v215,v118,v119
v_lshlrev_b32 v118,16,v215
v_and_b32 v119,0xffff0000,v215
v_cvt_pk_bf16_f32 v216,v120,v121
v_lshlrev_b32 v120,16,v216
v_and_b32 v121,0xffff0000,v216
v_cvt_pk_bf16_f32 v217,v122,v123
v_lshlrev_b32 v122,16,v217
v_and_b32 v123,0xffff0000,v217
v_mov_b32 v218,v216
v_mov_b32 v219,v217
s_add_u32 s63,s71,223608832
s_add_u32 s63,s63,s73
v_permlane16_swap_b32 v212,v214
v_permlane16_swap_b32 v213,v215
buffer_store_dwordx4 v[212:215],v17,s[8:11],s63 offen sc1
s_add_u32 s63,s72,223608832
s_add_u32 s63,s63,s73
v_permlane16_swap_b32 v216,v218
v_permlane16_swap_b32 v217,v219
buffer_store_dwordx4 v[216:219],v18,s[8:11],s63 offen sc1
v_sub_f32 v28,v28,v24
v_mul_f32 v29,v29,v25
v_mul_f32 v28,v28,v25
v_mul_f32 v29,v29,v25
v_cvt_pk_bf16_f32 v6,v28,v29
v_lshlrev_b32 v28,16,v6
v_and_b32 v29,0xffff0000,v6
v_add_f32 v29,0x3727c5ac,v29
v_cvt_pk_bf16_f32 v6,v29,v29
v_lshlrev_b32 v29,16,v6
v_sqrt_f32 v29,v29
s_nop 0
v_cvt_pk_bf16_f32 v6,v29,v29
v_lshlrev_b32 v29,16,v6
v_rcp_f32 v29,v29
s_lshl_b32 s60,s46,12
s_sub_u32 s63,s71,s60
s_add_u32 s63,s63,s73
s_lshl_b32 s60,s48,5
s_add_u32 s63,s63,s60
s_add_u32 s63,s63,223649792
v_lshlrev_b32 v6,3,v0
s_cmp_lg_u32 s46,3
s_cbranch_scc1 zs_306
s_mov_b64 exec,15
buffer_store_dwordx2 v[28:29],v6,s[8:11],s63 offen sc1
s_mov_b64 exec,-1
zs_306:
s_lshl_b32 s82,s51,6
s_add_u32 s82,s82,s52
s_lshl_b32 s82,s82,9
s_add_u32 s82,s82,393216
s_lshl_b32 s61,s56,2
s_add_u32 s82,s82,s61
s_add_u32 s50,s50,1
s_cmp_eq_u32 s50,128
s_cbranch_scc1 R1_END
s_mov_b32 s51,s53
s_mov_b32 s52,s54
s_waitcnt vmcnt(4)
v_min_u32 v236,v236,v237
v_cmp_eq_u32 vcc,0,v236
s_nop 0
s_cbranch_vccnz nr_307
s_add_u32 s60,s50,0
v_mov_b32 v239,s60
ds_write_b32 v238,v239
s_mul_i32 s66,s52,491520
s_mul_i32 s60,s48,10240
s_add_u32 s66,s66,s60
s_lshl_b32 s60,s46,10
s_add_u32 s66,s66,s60
s_add_u32 s66,s66,175112192
s_mul_i32 s60,s52,40960
s_add_u32 s60,s60,234749952
s_mul_i32 s61,s52,46080
s_add_u32 s61,s61,209518592
s_cmp_eq_u32 s51,0
s_cselect_b32 s65,s60,s61
s_lshl_b32 s60,s46,12
s_add_u32 s65,s65,s60
s_cmp_lt_u32 s46,2
s_cbranch_scc1 g2_308
v_mov_b32 v40,0
v_mov_b32 v41,0
v_mov_b32 v42,0
v_mov_b32 v43,0
s_nop 0
s_branch g3_309
g2_308:
s_add_u32 s63,s65,32768
buffer_load_dwordx2 v[108:109],v16,s[8:11],s63 offen sc1
s_add_u32 s63,s66,8192
buffer_load_dwordx4 v[40:43],v1,s[8:11],s63 offen sc1
s_add_u32 s63,s66,90112
buffer_load_dwordx4 v[52:55],v1,s[8:11],s63 offen sc1
s_add_u32 s63,s66,172032
buffer_load_dwordx4 v[64:67],v1,s[8:11],s63 offen sc1
s_add_u32 s63,s66,253952
buffer_load_dwordx4 v[76:79],v1,s[8:11],s63 offen sc1
g3_309:
s_add_u32 s63,s65,0
buffer_load_dwordx2 v[104:105],v16,s[8:11],s63 offen sc1
s_add_u32 s63,s65,16384
buffer_load_dwordx2 v[106:107],v16,s[8:11],s63 offen sc1
s_add_u32 s63,s66,0
buffer_load_dwordx4 v[32:35],v1,s[8:11],s63 offen sc1
s_add_u32 s63,s66,4096
buffer_load_dwordx4 v[36:39],v1,s[8:11],s63 offen sc1
s_add_u32 s63,s66,81920
buffer_load_dwordx4 v[44:47],v1,s[8:11],s63 offen sc1
s_add_u32 s63,s66,86016
buffer_load_dwordx4 v[48:51],v1,s[8:11],s63 offen sc1
s_add_u32 s63,s66,163840
buffer_load_dwordx4 v[56:59],v1,s[8:11],s63 offen sc1
s_add_u32 s63,s66,167936
buffer_load_dwordx4 v[60:63],v1,s[8:11],s63 offen sc1
s_add_u32 s63,s66,245760
buffer_load_dwordx4 v[68:71],v1,s[8:11],s63 offen sc1
s_add_u32 s63,s66,249856
buffer_load_dwordx4 v[72:75],v1,s[8:11],s63 offen sc1
s_waitcnt vmcnt(10)
s_mov_b64 exec,1
buffer_store_dword v5,v1,s[8:11],s82 offen sc1
s_mov_b64 exec,-1
s_mov_b32 s55,0
s_branch R1_A
nr_307:
s_mov_b32 s55,1
s_waitcnt vmcnt(0)
s_mov_b64 exec,1
buffer_store_dword v5,v1,s[8:11],s82 offen sc1
s_mov_b64 exec,-1
s_mov_b32 s82,-1
s_lshl_b32 s67,s51,6
s_add_u32 s67,s67,s52
s_mul_i32 s67,s67,640
s_add_u32 s67,s67,819200
s_cmp_lg_u32 s46,0
s_cbranch_scc1 wo_310
fb_312:
buffer_load_dwordx2 v[236:237],v2,s[8:11],s67 offen sc1
s_waitcnt vmcnt(0)
v_min_u32 v236,v236,v237
v_cmp_eq_u32 vcc,0,v236
s_nop 0
s_cbranch_vccz ok_313
s_sleep 7
s_sub_u32 s47,s47,1
s_cbranch_scc1 ABORT
s_branch fb_312
ok_313:
s_add_u32 s60,s50,0
v_mov_b32 v239,s60
ds_write_b32 v238,v239
s_branch wd_311
wo_310:
ds_read_b32 v239,v238
s_waitcnt lgkmcnt(0)
v_cmp_gt_u32 vcc,s50,v239
s_nop 0
s_cbranch_vccz wd_311
s_sleep 1
s_sub_u32 s59,s59,1
s_cbranch_scc1 ABORT
s_branch wo_310
wd_311:
s_mul_i32 s66,s52,491520
s_mul_i32 s60,s48,10240
s_add_u32 s66,s66,s60
s_lshl_b32 s60,s46,10
s_add_u32 s66,s66,s60
s_add_u32 s66,s66,175112192
s_mul_i32 s60,s52,40960
s_add_u32 s60,s60,234749952
s_mul_i32 s61,s52,46080
s_add_u32 s61,s61,209518592
s_cmp_eq_u32 s51,0
s_cselect_b32 s65,s60,s61
s_lshl_b32 s60,s46,12
s_add_u32 s65,s65,s60
s_cmp_lt_u32 s46,2
s_cbranch_scc1 g2_314
v_mov_b32 v40,0
v_mov_b32 v41,0
v_mov_b32 v42,0
v_mov_b32 v43,0
s_nop 0
s_branch g3_315
g2_314:
s_add_u32 s63,s65,32768
buffer_load_dwordx2 v[108:109],v16,s[8:11],s63 offen sc1
s_add_u32 s63,s66,8192
buffer_load_dwordx4 v[40:43],v1,s[8:11],s63 offen sc1
s_add_u32 s63,s66,90112
buffer_load_dwordx4 v[52:55],v1,s[8:11],s63 offen sc1
s_add_u32 s63,s66,172032
buffer_load_dwordx4 v[64:67],v1,s[8:11],s63 offen sc1
s_add_u32 s63,s66,253952
buffer_load_dwordx4 v[76:79],v1,s[8:11],s63 offen sc1
g3_315:
s_add_u32 s63,s65,0
buffer_load_dwordx2 v[104:105],v16,s[8:11],s63 offen sc1
s_add_u32 s63,s65,16384
buffer_load_dwordx2 v[106:107],v16,s[8:11],s63 offen sc1
s_add_u32 s63,s66,0
buffer_load_dwordx4 v[32:35],v1,s[8:11],s63 offen sc1
s_add_u32 s63,s66,4096
buffer_load_dwordx4 v[36:39],v1,s[8:11],s63 offen sc1
s_add_u32 s63,s66,81920
buffer_load_dwordx4 v[44:47],v1,s[8:11],s63 offen sc1
s_add_u32 s63,s66,86016
buffer_load_dwordx4 v[48:51],v1,s[8:11],s63 offen sc1
s_add_u32 s63,s66,163840
buffer_load_dwordx4 v[56:59],v1,s[8:11],s63 offen sc1
s_add_u32 s63,s66,167936
buffer_load_dwordx4 v[60:63],v1,s[8:11],s63 offen sc1
s_add_u32 s63,s66,245760
buffer_load_dwordx4 v[68:71],v1,s[8:11],s63 offen sc1
s_add_u32 s63,s66,249856
buffer_load_dwordx4 v[72:75],v1,s[8:11],s63 offen sc1
s_branch R1_A
R1_END:
s_waitcnt vmcnt(0)
s_mov_b64 exec,1
buffer_store_dword v5,v1,s[8:11],s82 offen sc1
s_mov_b64 exec,-1
s_endpgm
ROLE_W1:
v_lshlrev_b32 v1,4,v0
v_mov_b32 v5,1
s_lshl_b32 s56,s48,2
s_add_u32 s56,s56,s46
v_bfe_u32 v6,v0,2,2
v_lshrrev_b32 v7,4,v0
v_add_u32 v7,v6,v7
v_and_b32 v7,3,v7
v_and_b32 v15,3,v0
v_lshlrev_b32 v15,4,v15
v_lshl_add_u32 v15,v7,6,v15
v_lshl_add_u32 v15,v6,8,v15
v_lshrrev_b32 v6,5,v0
v_bfe_u32 v7,v0,4,1
v_lshlrev_b32 v16,10,v7
v_bfe_u32 v7,v0,2,2
v_lshl_add_u32 v16,v7,8,v16
v_add_u32 v6,v6,v7
v_and_b32 v6,3,v6
v_lshl_add_u32 v16,v6,6,v16
v_and_b32 v6,3,v0
v_lshl_add_u32 v16,v6,4,v16
v_add_u32 v18,46080,v16
v_lshrrev_b32 v6,5,v0
v_bfe_u32 v7,v0,4,1
v_lshlrev_b32 v20,10,v7
v_lshl_add_u32 v20,v6,8,v20
v_and_b32 v6,15,v0
v_lshl_add_u32 v20,v6,4,v20
v_lshrrev_b32 v6,5,v0
v_add_u32 v6,2,v6
v_bfe_u32 v7,v0,4,1
v_lshlrev_b32 v17,10,v7
v_bfe_u32 v7,v0,2,2
v_lshl_add_u32 v17,v7,8,v17
v_add_u32 v6,v6,v7
v_and_b32 v6,3,v6
v_lshl_add_u32 v17,v6,6,v17
v_and_b32 v6,3,v0
v_lshl_add_u32 v17,v6,4,v17
v_add_u32 v19,46080,v17
v_lshrrev_b32 v6,5,v0
v_add_u32 v6,2,v6
v_bfe_u32 v7,v0,4,1
v_lshlrev_b32 v21,10,v7
v_lshl_add_u32 v21,v6,8,v21
v_and_b32 v6,15,v0
v_lshl_add_u32 v21,v6,4,v21
v_min_u32 v2,31,v0
v_lshlrev_b32 v2,2,v2
v_mov_b32 v112,0xc0135761
v_mov_b32 v113,0xbdd2d3e8
s_mov_b32 s68,0xbdd2d3e8
v_mov_b32 v116,0
v_mov_b32 v117,0
v_mov_b32 v118,0
v_mov_b32 v119,0
s_lshl_b32 s60,s56,11
s_add_u32 s61,s60,237699072
buffer_store_dwordx4 v[116:119],v1,s[8:11],s61 offen sc1
buffer_store_dwordx4 v[116:119],v1,s[8:11],s61 offen offset:1024 sc1
s_add_u32 s61,s60,238067712
buffer_store_dwordx4 v[116:119],v1,s[8:11],s61 offen sc1
buffer_store_dwordx4 v[116:119],v1,s[8:11],s61 offen offset:1024 sc1
s_waitcnt vmcnt(0)
s_barrier
s_cmp_lg_u32 s46,0
s_cbranch_scc1 arr_316
v_mov_b32 v6,1
s_lshl_b32 s3,s49,2
v_mov_b32 v7,s3
s_mov_b64 exec,1
buffer_atomic_add v6,v7,s[12:15],0 offen sc1
s_mov_b64 exec,-1
arr_316:
s_lshl_b32 s58,s56,6
s_mul_i32 s63,s46,40960
s_mov_b32 s4,s32
s_mov_b32 s5,s33
s_mov_b32 s6,819200
s_mov_b32 s7,0x20000
v_lshrrev_b32 v9,2,v0
s_mov_b32 s64,1280
v_mul_lo_u32 v9,v9,s64
v_and_b32 v10,3,v0
v_lshl_add_u32 v6,v10,4,v9
s_add_u32 m0,s63,0
s_add_u32 s65,s58,0
buffer_load_dwordx4 v6,s[4:7],s65 offen lds
s_add_u32 m0,s63,1024
s_add_u32 s65,s58,20480
buffer_load_dwordx4 v6,s[4:7],s65 offen lds
s_add_u32 m0,s63,2048
s_add_u32 s65,s58,40960
buffer_load_dwordx4 v6,s[4:7],s65 offen lds
s_add_u32 m0,s63,3072
s_add_u32 s65,s58,61440
buffer_load_dwordx4 v6,s[4:7],s65 offen lds
s_add_u32 m0,s63,4096
s_add_u32 s65,s58,81920
buffer_load_dwordx4 v6,s[4:7],s65 offen lds
s_add_u32 m0,s63,5120
s_add_u32 s65,s58,102400
buffer_load_dwordx4 v6,s[4:7],s65 offen lds
s_add_u32 m0,s63,6144
s_add_u32 s65,s58,122880
buffer_load_dwordx4 v6,s[4:7],s65 offen lds
s_add_u32 m0,s63,7168
s_add_u32 s65,s58,143360
buffer_load_dwordx4 v6,s[4:7],s65 offen lds
s_add_u32 m0,s63,8192
s_add_u32 s65,s58,163840
buffer_load_dwordx4 v6,s[4:7],s65 offen lds
s_add_u32 m0,s63,9216
s_add_u32 s65,s58,184320
buffer_load_dwordx4 v6,s[4:7],s65 offen lds
s_add_u32 m0,s63,10240
s_add_u32 s65,s58,204800
buffer_load_dwordx4 v6,s[4:7],s65 offen lds
s_add_u32 m0,s63,11264
s_add_u32 s65,s58,225280
buffer_load_dwordx4 v6,s[4:7],s65 offen lds
s_add_u32 m0,s63,12288
s_add_u32 s65,s58,245760
buffer_load_dwordx4 v6,s[4:7],s65 offen lds
s_add_u32 m0,s63,13312
s_add_u32 s65,s58,266240
buffer_load_dwordx4 v6,s[4:7],s65 offen lds
s_add_u32 m0,s63,14336
s_add_u32 s65,s58,286720
buffer_load_dwordx4 v6,s[4:7],s65 offen lds
s_add_u32 m0,s63,15360
s_add_u32 s65,s58,307200
buffer_load_dwordx4 v6,s[4:7],s65 offen lds
s_add_u32 m0,s63,16384
s_add_u32 s65,s58,327680
buffer_load_dwordx4 v6,s[4:7],s65 offen lds
s_add_u32 m0,s63,17408
s_add_u32 s65,s58,348160
buffer_load_dwordx4 v6,s[4:7],s65 offen lds
s_add_u32 m0,s63,18432
s_add_u32 s65,s58,368640
buffer_load_dwordx4 v6,s[4:7],s65 offen lds
s_add_u32 m0,s63,19456
s_add_u32 s65,s58,389120
buffer_load_dwordx4 v6,s[4:7],s65 offen lds
s_add_u32 m0,s63,20480
s_add_u32 s65,s58,409600
buffer_load_dwordx4 v6,s[4:7],s65 offen lds
s_add_u32 m0,s63,21504
s_add_u32 s65,s58,430080
buffer_load_dwordx4 v6,s[4:7],s65 offen lds
s_add_u32 m0,s63,22528
s_add_u32 s65,s58,450560
buffer_load_dwordx4 v6,s[4:7],s65 offen lds
s_add_u32 m0,s63,23552
s_add_u32 s65,s58,471040
buffer_load_dwordx4 v6,s[4:7],s65 offen lds
s_add_u32 m0,s63,24576
s_add_u32 s65,s58,491520
buffer_load_dwordx4 v6,s[4:7],s65 offen lds
s_add_u32 m0,s63,25600
s_add_u32 s65,s58,512000
buffer_load_dwordx4 v6,s[4:7],s65 offen lds
s_add_u32 m0,s63,26624
s_add_u32 s65,s58,532480
buffer_load_dwordx4 v6,s[4:7],s65 offen lds
s_add_u32 m0,s63,27648
s_add_u32 s65,s58,552960
buffer_load_dwordx4 v6,s[4:7],s65 offen lds
s_add_u32 m0,s63,28672
s_add_u32 s65,s58,573440
buffer_load_dwordx4 v6,s[4:7],s65 offen lds
s_add_u32 m0,s63,29696
s_add_u32 s65,s58,593920
buffer_load_dwordx4 v6,s[4:7],s65 offen lds
s_add_u32 m0,s63,30720
s_add_u32 s65,s58,614400
buffer_load_dwordx4 v6,s[4:7],s65 offen lds
s_add_u32 m0,s63,31744
s_add_u32 s65,s58,634880
buffer_load_dwordx4 v6,s[4:7],s65 offen lds
s_add_u32 m0,s63,32768
s_add_u32 s65,s58,655360
buffer_load_dwordx4 v6,s[4:7],s65 offen lds
s_add_u32 m0,s63,33792
s_add_u32 s65,s58,675840
buffer_load_dwordx4 v6,s[4:7],s65 offen lds
s_add_u32 m0,s63,34816
s_add_u32 s65,s58,696320
buffer_load_dwordx4 v6,s[4:7],s65 offen lds
s_add_u32 m0,s63,35840
s_add_u32 s65,s58,716800
buffer_load_dwordx4 v6,s[4:7],s65 offen lds
s_add_u32 m0,s63,36864
s_add_u32 s65,s58,737280
buffer_load_dwordx4 v6,s[4:7],s65 offen lds
s_add_u32 m0,s63,37888
s_add_u32 s65,s58,757760
buffer_load_dwordx4 v6,s[4:7],s65 offen lds
s_add_u32 m0,s63,38912
s_add_u32 s65,s58,778240
buffer_load_dwordx4 v6,s[4:7],s65 offen lds
s_add_u32 m0,s63,39936
s_add_u32 s65,s58,798720
buffer_load_dwordx4 v6,s[4:7],s65 offen lds
s_waitcnt vmcnt(20)
v_bfe_u32 v9,v0,2,2
v_lshrrev_b32 v10,5,v0
v_lshl_add_u32 v9,v10,2,v9
v_mul_u32_u24 v9,64,v9
v_and_b32 v10,1,v0
v_lshl_add_u32 v9,v10,3,v9
v_bfe_u32 v10,v0,1,1
v_lshl_add_u32 v9,v10,5,v9
v_bfe_u32 v10,v0,4,1
v_lshl_add_u32 v9,v10,4,v9
v_add_u32 v7,s63,v9
ds_read_b64_tr_b16 a[0:1],v7 offset:0
ds_read_b64_tr_b16 a[2:3],v7 offset:1024
ds_read_b64_tr_b16 a[4:5],v7 offset:512
ds_read_b64_tr_b16 a[6:7],v7 offset:1536
ds_read_b64_tr_b16 a[8:9],v7 offset:2048
ds_read_b64_tr_b16 a[10:11],v7 offset:3072
ds_read_b64_tr_b16 a[12:13],v7 offset:2560
ds_read_b64_tr_b16 a[14:15],v7 offset:3584
ds_read_b64_tr_b16 a[16:17],v7 offset:4096
ds_read_b64_tr_b16 a[18:19],v7 offset:5120
ds_read_b64_tr_b16 a[20:21],v7 offset:4608
ds_read_b64_tr_b16 a[22:23],v7 offset:5632
s_waitcnt lgkmcnt(4)
ds_read_b64_tr_b16 a[24:25],v7 offset:6144
ds_read_b64_tr_b16 a[26:27],v7 offset:7168
ds_read_b64_tr_b16 a[28:29],v7 offset:6656
ds_read_b64_tr_b16 a[30:31],v7 offset:7680
ds_read_b64_tr_b16 a[32:33],v7 offset:8192
ds_read_b64_tr_b16 a[34:35],v7 offset:9216
ds_read_b64_tr_b16 a[36:37],v7 offset:8704
ds_read_b64_tr_b16 a[38:39],v7 offset:9728
ds_read_b64_tr_b16 a[40:41],v7 offset:10240
ds_read_b64_tr_b16 a[42:43],v7 offset:11264
ds_read_b64_tr_b16 a[44:45],v7 offset:10752
ds_read_b64_tr_b16 a[46:47],v7 offset:11776
s_waitcnt lgkmcnt(4)
ds_read_b64_tr_b16 a[48:49],v7 offset:12288
ds_read_b64_tr_b16 a[50:51],v7 offset:13312
ds_read_b64_tr_b16 a[52:53],v7 offset:12800
ds_read_b64_tr_b16 a[54:55],v7 offset:13824
ds_read_b64_tr_b16 a[56:57],v7 offset:14336
ds_read_b64_tr_b16 a[58:59],v7 offset:15360
ds_read_b64_tr_b16 a[60:61],v7 offset:14848
ds_read_b64_tr_b16 a[62:63],v7 offset:15872
ds_read_b64_tr_b16 a[64:65],v7 offset:16384
ds_read_b64_tr_b16 a[66:67],v7 offset:17408
ds_read_b64_tr_b16 a[68:69],v7 offset:16896
ds_read_b64_tr_b16 a[70:71],v7 offset:17920
s_waitcnt lgkmcnt(4)
ds_read_b64_tr_b16 a[72:73],v7 offset:18432
ds_read_b64_tr_b16 a[74:75],v7 offset:19456
ds_read_b64_tr_b16 a[76:77],v7 offset:18944
ds_read_b64_tr_b16 a[78:79],v7 offset:19968
s_waitcnt lgkmcnt(0)
s_waitcnt vmcnt(0)
v_bfe_u32 v9,v0,2,2
v_lshrrev_b32 v10,5,v0
v_lshl_add_u32 v9,v10,2,v9
v_mul_u32_u24 v9,64,v9
v_and_b32 v10,1,v0
v_lshl_add_u32 v9,v10,3,v9
v_bfe_u32 v10,v0,1,1
v_lshl_add_u32 v9,v10,5,v9
v_bfe_u32 v10,v0,4,1
v_lshl_add_u32 v9,v10,4,v9
v_add_u32 v7,s63,v9
ds_read_b64_tr_b16 a[80:81],v7 offset:20480
ds_read_b64_tr_b16 a[82:83],v7 offset:21504
ds_read_b64_tr_b16 a[84:85],v7 offset:20992
ds_read_b64_tr_b16 a[86:87],v7 offset:22016
ds_read_b64_tr_b16 a[88:89],v7 offset:22528
ds_read_b64_tr_b16 a[90:91],v7 offset:23552
ds_read_b64_tr_b16 a[92:93],v7 offset:23040
ds_read_b64_tr_b16 a[94:95],v7 offset:24064
ds_read_b64_tr_b16 a[96:97],v7 offset:24576
ds_read_b64_tr_b16 a[98:99],v7 offset:25600
ds_read_b64_tr_b16 a[100:101],v7 offset:25088
ds_read_b64_tr_b16 a[102:103],v7 offset:26112
s_waitcnt lgkmcnt(4)
ds_read_b64_tr_b16 a[104:105],v7 offset:26624
ds_read_b64_tr_b16 a[106:107],v7 offset:27648
ds_read_b64_tr_b16 a[108:109],v7 offset:27136
ds_read_b64_tr_b16 a[110:111],v7 offset:28160
ds_read_b64_tr_b16 a[112:113],v7 offset:28672
ds_read_b64_tr_b16 a[114:115],v7 offset:29696
ds_read_b64_tr_b16 a[116:117],v7 offset:29184
ds_read_b64_tr_b16 a[118:119],v7 offset:30208
ds_read_b64_tr_b16 a[120:121],v7 offset:30720
ds_read_b64_tr_b16 a[122:123],v7 offset:31744
ds_read_b64_tr_b16 a[124:125],v7 offset:31232
ds_read_b64_tr_b16 a[126:127],v7 offset:32256
s_waitcnt lgkmcnt(4)
ds_read_b64_tr_b16 a[128:129],v7 offset:32768
ds_read_b64_tr_b16 a[130:131],v7 offset:33792
ds_read_b64_tr_b16 a[132:133],v7 offset:33280
ds_read_b64_tr_b16 a[134:135],v7 offset:34304
ds_read_b64_tr_b16 a[136:137],v7 offset:34816
ds_read_b64_tr_b16 a[138:139],v7 offset:35840
ds_read_b64_tr_b16 a[140:141],v7 offset:35328
ds_read_b64_tr_b16 a[142:143],v7 offset:36352
ds_read_b64_tr_b16 a[144:145],v7 offset:36864
ds_read_b64_tr_b16 a[146:147],v7 offset:37888
ds_read_b64_tr_b16 a[148:149],v7 offset:37376
ds_read_b64_tr_b16 a[150:151],v7 offset:38400
s_waitcnt lgkmcnt(4)
ds_read_b64_tr_b16 a[152:153],v7 offset:38912
ds_read_b64_tr_b16 a[154:155],v7 offset:39936
ds_read_b64_tr_b16 a[156:157],v7 offset:39424
ds_read_b64_tr_b16 a[158:159],v7 offset:40448
s_waitcnt lgkmcnt(0)
v_mov_b32 v24,0x3f803f80
v_mov_b32 v25,0x3f803f80
v_mov_b32 v26,0x3f803f80
v_mov_b32 v27,0x3f803f80
s_nop 1
v_mfma_f32_32x32x16_bf16 v[144:159],a[0:3],v[24:27],0
v_mfma_f32_32x32x16_bf16 v[144:159],a[4:7],v[24:27],v[144:159]
v_mfma_f32_32x32x16_bf16 v[144:159],a[8:11],v[24:27],v[144:159]
v_mfma_f32_32x32x16_bf16 v[144:159],a[12:15],v[24:27],v[144:159]
v_mfma_f32_32x32x16_bf16 v[144:159],a[16:19],v[24:27],v[144:159]
v_mfma_f32_32x32x16_bf16 v[144:159],a[20:23],v[24:27],v[144:159]
v_mfma_f32_32x32x16_bf16 v[144:159],a[24:27],v[24:27],v[144:159]
v_mfma_f32_32x32x16_bf16 v[144:159],a[28:31],v[24:27],v[144:159]
v_mfma_f32_32x32x16_bf16 v[144:159],a[32:35],v[24:27],v[144:159]
v_mfma_f32_32x32x16_bf16 v[144:159],a[36:39],v[24:27],v[144:159]
v_mfma_f32_32x32x16_bf16 v[144:159],a[40:43],v[24:27],v[144:159]
v_mfma_f32_32x32x16_bf16 v[144:159],a[44:47],v[24:27],v[144:159]
v_mfma_f32_32x32x16_bf16 v[144:159],a[48:51],v[24:27],v[144:159]
v_mfma_f32_32x32x16_bf16 v[144:159],a[52:55],v[24:27],v[144:159]
v_mfma_f32_32x32x16_bf16 v[144:159],a[56:59],v[24:27],v[144:159]
v_mfma_f32_32x32x16_bf16 v[144:159],a[60:63],v[24:27],v[144:159]
v_mfma_f32_32x32x16_bf16 v[144:159],a[64:67],v[24:27],v[144:159]
v_mfma_f32_32x32x16_bf16 v[144:159],a[68:71],v[24:27],v[144:159]
v_mfma_f32_32x32x16_bf16 v[144:159],a[72:75],v[24:27],v[144:159]
v_mfma_f32_32x32x16_bf16 v[144:159],a[76:79],v[24:27],v[144:159]
v_mfma_f32_32x32x16_bf16 v[144:159],a[80:83],v[24:27],v[144:159]
v_mfma_f32_32x32x16_bf16 v[144:159],a[84:87],v[24:27],v[144:159]
v_mfma_f32_32x32x16_bf16 v[144:159],a[88:91],v[24:27],v[144:159]
v_mfma_f32_32x32x16_bf16 v[144:159],a[92:95],v[24:27],v[144:159]
v_mfma_f32_32x32x16_bf16 v[144:159],a[96:99],v[24:27],v[144:159]
v_mfma_f32_32x32x16_bf16 v[144:159],a[100:103],v[24:27],v[144:159]
v_mfma_f32_32x32x16_bf16 v[144:159],a[104:107],v[24:27],v[144:159]
v_mfma_f32_32x32x16_bf16 v[144:159],a[108:111],v[24:27],v[144:159]
v_mfma_f32_32x32x16_bf16 v[144:159],a[112:115],v[24:27],v[144:159]
v_mfma_f32_32x32x16_bf16 v[144:159],a[116:119],v[24:27],v[144:159]
v_mfma_f32_32x32x16_bf16 v[144:159],a[120:123],v[24:27],v[144:159]
v_mfma_f32_32x32x16_bf16 v[144:159],a[124:127],v[24:27],v[144:159]
v_mfma_f32_32x32x16_bf16 v[144:159],a[128:131],v[24:27],v[144:159]
v_mfma_f32_32x32x16_bf16 v[144:159],a[132:135],v[24:27],v[144:159]
v_mfma_f32_32x32x16_bf16 v[144:159],a[136:139],v[24:27],v[144:159]
v_mfma_f32_32x32x16_bf16 v[144:159],a[140:143],v[24:27],v[144:159]
v_mfma_f32_32x32x16_bf16 v[144:159],a[144:147],v[24:27],v[144:159]
v_mfma_f32_32x32x16_bf16 v[144:159],a[148:151],v[24:27],v[144:159]
v_mfma_f32_32x32x16_bf16 v[144:159],a[152:155],v[24:27],v[144:159]
v_mfma_f32_32x32x16_bf16 v[144:159],a[156:159],v[24:27],v[144:159]
v_and_b32 v182,31,v0
v_lshlrev_b32 v182,3,v182
v_add_u32 v182,0xa000,v182
s_barrier
s_lshl_b32 s3,s49,2
v_mov_b32 v7,s3
s_nop 5
ibw_317:
buffer_load_dword v6,v7,s[12:15],0 offen sc1
s_waitcnt vmcnt(0)
v_cmp_ne_u32 vcc,256,v6
s_nop 0
s_cbranch_vccz ok_318
s_sleep 8
s_sub_u32 s47,s47,1
s_cbranch_scc1 ABORT
s_branch ibw_317
ok_318:
s_cmp_lg_u32 s49,0
s_cbranch_scc1 ibok_319
v_and_b32 v7,7,v0
v_lshlrev_b32 v7,2,v7
buffer_load_dword v6,v7,s[12:15],0 offen offset:32 sc1
s_waitcnt vmcnt(0)
v_cmp_ne_u32 vcc,32,v6
s_nop 0
s_cbranch_vccz ibok_319
s_barrier
s_mov_b32 s49,1
s_mov_b32 s3,s2
s_load_dwordx16 s[16:31],s[0:1],0
s_load_dwordx8 s[32:39],s[0:1],64
s_waitcnt lgkmcnt(0)
s_branch DISPATCH
ibok_319:
s_mov_b32 s50,0
s_mov_b32 s32,0
s_mov_b32 s57,0
s_mov_b32 s59,2147483648
s_mov_b32 s82,2147483648
s_mov_b32 s39,2147483648
v_mov_b32 v22,94208
v_lshl_add_u32 v22,v0,2,v22
v_mov_b32 v23,0
ds_write_b32 v22,v23
s_mov_b32 s39,1600000
v_and_b32 v72,15,v0
v_lshlrev_b32 v72,7,v72
v_min_u32 v6,51,v0
v_lshlrev_b32 v6,2,v6
v_add_u32 v2,0,v6
v_add_u32 v7,127360,v6
v_cmp_gt_u32 s[78:79],32,v0
s_nop 1
v_cndmask_b32 v2,v7,v2,s[78:79]
s_mov_b32 s51,0
s_mov_b32 s52,0
s_mul_i32 s62,s51,9
s_and_b32 s63,s52,7
s_add_u32 s62,s62,s63
s_mul_i32 s62,s62,40960
s_add_u32 s62,s62,237371392
s_lshl_b32 s63,s56,11
s_add_u32 s62,s62,s63
buffer_load_dword v73,v72,s[8:11],s62 offen sc1
s_mov_b32 s51,0
s_mov_b32 s52,1
s_mul_i32 s62,s51,9
s_and_b32 s63,s52,7
s_add_u32 s62,s62,s63
s_mul_i32 s62,s62,40960
s_add_u32 s62,s62,237371392
s_lshl_b32 s63,s56,11
s_add_u32 s62,s62,s63
buffer_load_dword v73,v72,s[8:11],s62 offen sc1
s_mov_b32 s51,0
s_mov_b32 s52,2
s_mul_i32 s62,s51,9
s_and_b32 s63,s52,7
s_add_u32 s62,s62,s63
s_mul_i32 s62,s62,40960
s_add_u32 s62,s62,237371392
s_lshl_b32 s63,s56,11
s_add_u32 s62,s62,s63
buffer_load_dword v73,v72,s[8:11],s62 offen sc1
s_mov_b32 s51,0
s_mov_b32 s52,3
s_mul_i32 s62,s51,9
s_and_b32 s63,s52,7
s_add_u32 s62,s62,s63
s_mul_i32 s62,s62,40960
s_add_u32 s62,s62,237371392
s_lshl_b32 s63,s56,11
s_add_u32 s62,s62,s63
buffer_load_dword v73,v72,s[8:11],s62 offen sc1
s_mov_b32 s51,0
s_mov_b32 s52,4
s_mul_i32 s62,s51,9
s_and_b32 s63,s52,7
s_add_u32 s62,s62,s63
s_mul_i32 s62,s62,40960
s_add_u32 s62,s62,237371392
s_lshl_b32 s63,s56,11
s_add_u32 s62,s62,s63
buffer_load_dword v73,v72,s[8:11],s62 offen sc1
s_mov_b32 s51,0
s_mov_b32 s52,5
s_mul_i32 s62,s51,9
s_and_b32 s63,s52,7
s_add_u32 s62,s62,s63
s_mul_i32 s62,s62,40960
s_add_u32 s62,s62,237371392
s_lshl_b32 s63,s56,11
s_add_u32 s62,s62,s63
buffer_load_dword v73,v72,s[8:11],s62 offen sc1
s_mov_b32 s51,0
s_mov_b32 s52,6
s_mul_i32 s62,s51,9
s_and_b32 s63,s52,7
s_add_u32 s62,s62,s63
s_mul_i32 s62,s62,40960
s_add_u32 s62,s62,237371392
s_lshl_b32 s63,s56,11
s_add_u32 s62,s62,s63
buffer_load_dword v73,v72,s[8:11],s62 offen sc1
s_mov_b32 s51,0
s_mov_b32 s52,7
s_mul_i32 s62,s51,9
s_and_b32 s63,s52,7
s_add_u32 s62,s62,s63
s_mul_i32 s62,s62,40960
s_add_u32 s62,s62,237371392
s_lshl_b32 s63,s56,11
s_add_u32 s62,s62,s63
buffer_load_dword v73,v72,s[8:11],s62 offen sc1
s_mov_b32 s51,1
s_mov_b32 s52,0
s_mul_i32 s62,s51,9
s_and_b32 s63,s52,7
s_add_u32 s62,s62,s63
s_mul_i32 s62,s62,40960
s_add_u32 s62,s62,237371392
s_lshl_b32 s63,s56,11
s_add_u32 s62,s62,s63
buffer_load_dword v73,v72,s[8:11],s62 offen sc1
s_mov_b32 s51,1
s_mov_b32 s52,1
s_mul_i32 s62,s51,9
s_and_b32 s63,s52,7
s_add_u32 s62,s62,s63
s_mul_i32 s62,s62,40960
s_add_u32 s62,s62,237371392
s_lshl_b32 s63,s56,11
s_add_u32 s62,s62,s63
buffer_load_dword v73,v72,s[8:11],s62 offen sc1
s_mov_b32 s51,1
s_mov_b32 s52,2
s_mul_i32 s62,s51,9
s_and_b32 s63,s52,7
s_add_u32 s62,s62,s63
s_mul_i32 s62,s62,40960
s_add_u32 s62,s62,237371392
s_lshl_b32 s63,s56,11
s_add_u32 s62,s62,s63
buffer_load_dword v73,v72,s[8:11],s62 offen sc1
s_mov_b32 s51,1
s_mov_b32 s52,3
s_mul_i32 s62,s51,9
s_and_b32 s63,s52,7
s_add_u32 s62,s62,s63
s_mul_i32 s62,s62,40960
s_add_u32 s62,s62,237371392
s_lshl_b32 s63,s56,11
s_add_u32 s62,s62,s63
buffer_load_dword v73,v72,s[8:11],s62 offen sc1
s_mov_b32 s51,1
s_mov_b32 s52,4
s_mul_i32 s62,s51,9
s_and_b32 s63,s52,7
s_add_u32 s62,s62,s63
s_mul_i32 s62,s62,40960
s_add_u32 s62,s62,237371392
s_lshl_b32 s63,s56,11
s_add_u32 s62,s62,s63
buffer_load_dword v73,v72,s[8:11],s62 offen sc1
s_mov_b32 s51,1
s_mov_b32 s52,5
s_mul_i32 s62,s51,9
s_and_b32 s63,s52,7
s_add_u32 s62,s62,s63
s_mul_i32 s62,s62,40960
s_add_u32 s62,s62,237371392
s_lshl_b32 s63,s56,11
s_add_u32 s62,s62,s63
buffer_load_dword v73,v72,s[8:11],s62 offen sc1
s_mov_b32 s51,1
s_mov_b32 s52,6
s_mul_i32 s62,s51,9
s_and_b32 s63,s52,7
s_add_u32 s62,s62,s63
s_mul_i32 s62,s62,40960
s_add_u32 s62,s62,237371392
s_lshl_b32 s63,s56,11
s_add_u32 s62,s62,s63
buffer_load_dword v73,v72,s[8:11],s62 offen sc1
s_mov_b32 s51,1
s_mov_b32 s52,7
s_mul_i32 s62,s51,9
s_and_b32 s63,s52,7
s_add_u32 s62,s62,s63
s_mul_i32 s62,s62,40960
s_add_u32 s62,s62,237371392
s_lshl_b32 s63,s56,11
s_add_u32 s62,s62,s63
buffer_load_dword v73,v72,s[8:11],s62 offen sc1
s_waitcnt vmcnt(0)
s_waitcnt lgkmcnt(0)
s_barrier
s_mov_b32 s83,s100
s_min_u32 s62,s32,127
s_sub_u32 s60,s62,13
s_lshr_b32 s34,s60,1
s_and_b32 s33,s60,1
s_cmp_eq_u32 s33,0
s_cselect_b32 s61,13,0
s_add_u32 s34,s34,s61
s_sub_u32 s61,s60,51
s_cmp_ge_u32 s60,102
s_cselect_b32 s34,s61,s34
s_cselect_b32 s33,1,s33
s_cmp_lt_u32 s62,13
s_cselect_b32 s34,s62,s34
s_cselect_b32 s33,0,s33
s_lshl_b32 s35,s33,6
s_add_u32 s35,s35,s34
s_lshl_b32 s35,s35,9
s_add_u32 s35,s35,393216
s_cmp_lt_u32 s34,7
s_cselect_b64 s[76:77],s[78:79],-1
s_sub_u32 s57,46080,s57
v_swap_b32 v16,v18
v_swap_b32 v17,v19
s_add_u32 s62,s32,1
s_min_u32 s62,s62,127
s_sub_u32 s60,s62,13
s_lshr_b32 s41,s60,1
s_and_b32 s40,s60,1
s_cmp_eq_u32 s40,0
s_cselect_b32 s61,13,0
s_add_u32 s41,s41,s61
s_sub_u32 s61,s60,51
s_cmp_ge_u32 s60,102
s_cselect_b32 s41,s61,s41
s_cselect_b32 s40,1,s40
s_cmp_lt_u32 s62,13
s_cselect_b32 s41,s62,s41
s_cselect_b32 s40,0,s40
s_lshl_b32 s42,s40,6
s_add_u32 s42,s42,s41
s_lshl_b32 s42,s42,9
s_add_u32 s42,s42,393216
s_cmp_lt_u32 s41,7
s_cselect_b64 s[80:81],s[78:79],-1
W1_COLD:
s_mov_b32 s37,0
s_cmp_lg_u32 s46,0
s_cbranch_scc1 wo_320
fb_322:
buffer_load_dword v3,v2,s[8:11],s35 offen sc1
s_waitcnt vmcnt(0)
v_cmp_eq_u32 vcc,0,v3
s_and_b64 vcc,vcc,s[76:77]
s_cbranch_scc0 ok_323
s_sleep 7
s_sub_u32 s47,s47,1
s_cbranch_scc1 ABORT
s_branch fb_322
ok_323:
W1_COLD2:
s_add_u32 s65,s32,1
s_or_b32 s65,s65,s37
v_mov_b32 v23,s65
ds_max_i32 v22,v23
s_branch wd_321
wo_320:
ds_read_b32 v23,v22
s_waitcnt lgkmcnt(0)
v_cmp_ge_u32 vcc,s32,v23
s_nop 0
s_cbranch_vccz wd_321
s_sleep 1
s_sub_u32 s39,s39,1
s_cbranch_scc1 ABORT
s_branch wo_320
wd_321:
s_sub_u32 s66,46080,s57
s_lshl_b32 s60,s33,6
s_add_u32 s60,s60,s34
s_mul_i32 s60,s60,46080
s_add_u32 s60,s60,s37
s_add_u32 s60,s60,223608832
s_mov_b32 s67,s60
s_mul_i32 s61,s46,10240
s_add_u32 s60,s60,s61
s_add_u32 s61,s61,s66
s_add_u32 m0,s61,0
s_add_u32 s63,s60,0
buffer_load_dwordx4 v1,s[8:11],s63 offen sc1 lds
buffer_load_dwordx4 v1,s[8:11],s63 offen offset:1024 sc1 lds
buffer_load_dwordx4 v1,s[8:11],s63 offen offset:2048 sc1 lds
buffer_load_dwordx4 v1,s[8:11],s63 offen offset:3072 sc1 lds
s_add_u32 m0,s61,4096
s_add_u32 s63,s60,4096
buffer_load_dwordx4 v1,s[8:11],s63 offen sc1 lds
buffer_load_dwordx4 v1,s[8:11],s63 offen offset:1024 sc1 lds
s_waitcnt vmcnt(6)
s_mov_b64 exec,1
s_cmp_lg_u32 s49,0
s_cbranch_scc0 ls_324
buffer_store_dword v5,v1,s[8:11],s59 offen sc1
s_branch ls_325
ls_324:
buffer_store_dword v5,v1,s[8:11],s59 offen
ls_325:
s_mov_b64 exec,-1
s_mov_b32 s59,2147483648
buffer_load_dwordx4 v1,s[8:11],s63 offen offset:2048 sc1 lds
buffer_load_dwordx4 v1,s[8:11],s63 offen offset:3072 sc1 lds
s_add_u32 m0,s61,8192
s_add_u32 s63,s60,8192
buffer_load_dwordx4 v1,s[8:11],s63 offen sc1 lds
buffer_load_dwordx4 v1,s[8:11],s63 offen offset:1024 sc1 lds
s_add_u32 m0,s66,40960
s_add_u32 s63,s67,40960
buffer_load_dwordx4 v1,s[8:11],s63 offen sc1 lds
s_mov_b32 s35,s42
buffer_load_dword v3,v2,s[8:11],s35 offen sc1
s_mov_b32 s53,s33
s_mov_b32 s54,s34
s_add_u32 s32,s32,1
s_mov_b32 s33,s40
s_mov_b32 s34,s41
s_mov_b64 s[76:77],s[80:81]
s_sub_u32 s57,46080,s57
v_swap_b32 v16,v18
v_swap_b32 v17,v19
s_mov_b32 s51,s53
s_mov_b32 s52,s54
s_mov_b32 s37,2147483648
s_waitcnt vmcnt(7)
s_branch W1_GO
W1_NEXT:
s_sub_u32 s57,46080,s57
v_swap_b32 v16,v18
v_swap_b32 v17,v19
s_mov_b32 s51,s53
s_mov_b32 s52,s54
s_waitcnt vmcnt(2)
v_cmp_eq_u32 vcc,0,v3
s_and_b64 vcc,vcc,s[76:77]
s_cselect_b32 s37,2147483648,0
s_cmp_lt_u32 s32,128
s_cselect_b32 s37,s37,2147483648
W1_GO:
s_barrier
ds_read_b128 v[24:27],v16 offset:0
ds_read_b128 v[28:31],v17 offset:0
ds_read_b128 v[32:35],v16 offset:10240
ds_read_b128 v[36:39],v17 offset:10240
ds_read_b128 v[40:43],v16 offset:20480
ds_read_b128 v[44:47],v17 offset:20480
ds_read_b128 v[48:51],v16 offset:30720
s_waitcnt lgkmcnt(6)
v_mfma_f32_32x32x16_bf16 v[56:71],a[0:3],v[24:27],0
ds_read_b128 v[52:55],v17 offset:30720
s_add_u32 s65,s32,1
s_or_b32 s65,s65,s37
v_mov_b32 v23,s65
s_waitcnt lgkmcnt(6)
v_mfma_f32_32x32x16_bf16 v[56:71],a[4:7],v[28:31],v[56:71]
ds_read_b128 v[24:27],v16 offset:2048
ds_max_i32 v22,v23
s_sub_u32 s66,46080,s57
s_waitcnt lgkmcnt(6)
v_mfma_f32_32x32x16_bf16 v[56:71],a[40:43],v[32:35],v[56:71]
ds_read_b128 v[28:31],v17 offset:2048
s_lshl_b32 s60,s33,6
s_add_u32 s60,s60,s34
s_mul_i32 s60,s60,46080
s_add_u32 s60,s60,s37
v_mfma_f32_32x32x16_bf16 v[56:71],a[44:47],v[36:39],v[56:71]
ds_read_b128 v[32:35],v16 offset:12288
s_add_u32 s60,s60,223608832
s_mov_b32 s67,s60
s_mul_i32 s61,s46,10240
s_waitcnt lgkmcnt(6)
v_mfma_f32_32x32x16_bf16 v[56:71],a[80:83],v[40:43],v[56:71]
ds_read_b128 v[36:39],v17 offset:12288
s_add_u32 s60,s60,s61
s_add_u32 s61,s61,s66
s_add_u32 m0,s61,0
s_add_u32 s63,s60,0
v_mfma_f32_32x32x16_bf16 v[56:71],a[84:87],v[44:47],v[56:71]
ds_read_b128 v[40:43],v16 offset:22528
buffer_load_dwordx4 v1,s[8:11],s63 offen sc1 lds
s_mul_i32 s71,s51,9
s_waitcnt lgkmcnt(6)
v_mfma_f32_32x32x16_bf16 v[56:71],a[120:123],v[48:51],v[56:71]
ds_read_b128 v[44:47],v17 offset:22528
s_and_b32 s72,s52,7
s_add_u32 s71,s71,s72
s_mul_i32 s71,s71,40960
s_add_u32 s71,s71,237371392
v_mfma_f32_32x32x16_bf16 v[56:71],a[124:127],v[52:55],v[56:71]
ds_read_b128 v[48:51],v16 offset:32768
s_lshl_b32 s72,s56,11
s_add_u32 s71,s71,s72
s_lshl_b32 s82,s51,6
s_waitcnt lgkmcnt(5)
v_mfma_f32_32x32x16_bf16 v[56:71],a[8:11],v[24:27],v[56:71]
ds_read_b128 v[52:55],v17 offset:32768
buffer_load_dwordx4 v1,s[8:11],s63 offen offset:1024 sc1 lds
s_add_u32 s82,s82,s52
s_lshl_b32 s82,s82,9
v_mfma_f32_32x32x16_bf16 v[56:71],a[12:15],v[28:31],v[56:71]
ds_read_b128 v[24:27],v16 offset:4096
s_add_u32 s82,s82,458752
s_lshl_b32 s70,s56,2
s_add_u32 s82,s82,s70
s_waitcnt lgkmcnt(5)
v_mfma_f32_32x32x16_bf16 v[56:71],a[48:51],v[32:35],v[56:71]
ds_read_b128 v[28:31],v17 offset:4096
buffer_load_dword v3,v2,s[8:11],s35 offen sc1
v_mfma_f32_32x32x16_bf16 v[56:71],a[52:55],v[36:39],v[56:71]
ds_read_b128 v[32:35],v16 offset:14336
buffer_load_dwordx4 v1,s[8:11],s63 offen offset:2048 sc1 lds
s_waitcnt lgkmcnt(5)
v_mfma_f32_32x32x16_bf16 v[56:71],a[88:91],v[40:43],v[56:71]
ds_read_b128 v[36:39],v17 offset:14336
s_waitcnt vmcnt(4)
s_mov_b64 exec,1
s_cmp_lg_u32 s49,0
s_cbranch_scc0 ls_326
buffer_store_dword v5,v1,s[8:11],s59 offen sc1
s_branch ls_327
ls_326:
buffer_store_dword v5,v1,s[8:11],s59 offen
ls_327:
s_mov_b64 exec,-1
s_mov_b32 s59,2147483648
v_mfma_f32_32x32x16_bf16 v[56:71],a[92:95],v[44:47],v[56:71]
ds_read_b128 v[40:43],v16 offset:24576
s_waitcnt lgkmcnt(5)
v_mfma_f32_32x32x16_bf16 v[56:71],a[128:131],v[48:51],v[56:71]
ds_read_b128 v[44:47],v17 offset:24576
buffer_load_dwordx4 v1,s[8:11],s63 offen offset:3072 sc1 lds
s_add_u32 m0,s61,4096
s_add_u32 s63,s60,4096
v_mfma_f32_32x32x16_bf16 v[56:71],a[132:135],v[52:55],v[56:71]
ds_read_b128 v[48:51],v16 offset:34816
s_waitcnt lgkmcnt(5)
v_mfma_f32_32x32x16_bf16 v[56:71],a[16:19],v[24:27],v[56:71]
ds_read_b128 v[52:55],v17 offset:34816
s_barrier
v_mfma_f32_32x32x16_bf16 v[56:71],a[20:23],v[28:31],v[56:71]
ds_read_b128 v[24:27],v16 offset:6144
v_add_u32 v183,s57,v182
buffer_load_dwordx4 v1,s[8:11],s63 offen sc1 lds
s_waitcnt lgkmcnt(5)
v_mfma_f32_32x32x16_bf16 v[56:71],a[56:59],v[32:35],v[56:71]
ds_read_b128 v[28:31],v17 offset:6144
ds_read_b64 v[180:181],v183
v_mfma_f32_32x32x16_bf16 v[56:71],a[60:63],v[36:39],v[56:71]
ds_read_b128 v[32:35],v16 offset:16384
s_waitcnt lgkmcnt(6)
v_mfma_f32_32x32x16_bf16 v[56:71],a[96:99],v[40:43],v[56:71]
ds_read_b128 v[36:39],v17 offset:16384
buffer_load_dwordx4 v1,s[8:11],s63 offen offset:1024 sc1 lds
v_mfma_f32_32x32x16_bf16 v[56:71],a[100:103],v[44:47],v[56:71]
ds_read_b128 v[40:43],v16 offset:26624
s_waitcnt lgkmcnt(6)
v_mfma_f32_32x32x16_bf16 v[56:71],a[136:139],v[48:51],v[56:71]
ds_read_b128 v[44:47],v17 offset:26624
v_mfma_f32_32x32x16_bf16 v[56:71],a[140:143],v[52:55],v[56:71]
ds_read_b128 v[48:51],v16 offset:36864
buffer_load_dwordx4 v1,s[8:11],s63 offen offset:2048 sc1 lds
s_waitcnt lgkmcnt(6)
v_mfma_f32_32x32x16_bf16 v[56:71],a[24:27],v[24:27],v[56:71]
ds_read_b128 v[52:55],v17 offset:36864
v_mfma_f32_32x32x16_bf16 v[56:71],a[28:31],v[28:31],v[56:71]
ds_read_b128 v[24:27],v16 offset:8192
s_waitcnt lgkmcnt(5)
v_mfma_f32_32x32x16_bf16 v[56:71],a[64:67],v[32:35],v[56:71]
ds_read_b128 v[28:31],v17 offset:8192
buffer_load_dwordx4 v1,s[8:11],s63 offen offset:3072 sc1 lds
s_add_u32 m0,s61,8192
s_add_u32 s63,s60,8192
v_mfma_f32_32x32x16_bf16 v[56:71],a[68:71],v[36:39],v[56:71]
ds_read_b128 v[32:35],v16 offset:18432
s_waitcnt lgkmcnt(5)
v_mfma_f32_32x32x16_bf16 v[56:71],a[104:107],v[40:43],v[56:71]
ds_read_b128 v[36:39],v17 offset:18432
v_mfma_f32_32x32x16_bf16 v[56:71],a[108:111],v[44:47],v[56:71]
ds_read_b128 v[40:43],v16 offset:28672
buffer_load_dwordx4 v1,s[8:11],s63 offen sc1 lds
s_waitcnt lgkmcnt(5)
v_mfma_f32_32x32x16_bf16 v[56:71],a[144:147],v[48:51],v[56:71]
ds_read_b128 v[44:47],v17 offset:28672
v_mfma_f32_32x32x16_bf16 v[56:71],a[148:151],v[52:55],v[56:71]
ds_read_b128 v[48:51],v16 offset:38912
s_waitcnt lgkmcnt(5)
v_mfma_f32_32x32x16_bf16 v[56:71],a[32:35],v[24:27],v[56:71]
ds_read_b128 v[52:55],v17 offset:38912
buffer_load_dwordx4 v1,s[8:11],s63 offen offset:1024 sc1 lds
s_add_u32 m0,s66,40960
s_add_u32 s63,s67,40960
v_mfma_f32_32x32x16_bf16 v[56:71],a[36:39],v[28:31],v[56:71]
s_waitcnt lgkmcnt(4)
v_mfma_f32_32x32x16_bf16 v[56:71],a[72:75],v[32:35],v[56:71]
v_mfma_f32_32x32x16_bf16 v[56:71],a[76:79],v[36:39],v[56:71]
buffer_load_dwordx4 v1,s[8:11],s63 offen sc1 lds
s_add_u32 s62,s32,1
s_min_u32 s62,s62,127
s_sub_u32 s60,s62,13
s_waitcnt lgkmcnt(2)
v_mfma_f32_32x32x16_bf16 v[56:71],a[112:115],v[40:43],v[56:71]
s_lshr_b32 s41,s60,1
s_and_b32 s40,s60,1
s_cmp_eq_u32 s40,0
s_cselect_b32 s61,13,0
s_add_u32 s41,s41,s61
s_sub_u32 s61,s60,51
v_mfma_f32_32x32x16_bf16 v[56:71],a[116:119],v[44:47],v[56:71]
s_cmp_ge_u32 s60,102
s_cselect_b32 s41,s61,s41
s_cselect_b32 s40,1,s40
s_waitcnt lgkmcnt(0)
v_mfma_f32_32x32x16_bf16 v[56:71],a[152:155],v[48:51],v[56:71]
s_cmp_lt_u32 s62,13
s_cselect_b32 s41,s62,s41
s_cselect_b32 s40,0,s40
s_lshl_b32 s42,s40,6
s_add_u32 s42,s42,s41
s_lshl_b32 s42,s42,9
v_mfma_f32_32x32x16_bf16 v[56:71],a[156:159],v[52:55],v[56:71]
s_add_u32 s42,s42,393216
s_cmp_lt_u32 s41,7
s_cselect_b64 s[80:81],s[78:79],-1
s_cmp_eq_u32 s37,0
s_cbranch_scc0 sec_330
s_mov_b32 s35,s42
buffer_load_dword v3,v2,s[8:11],s35 offen sc1
s_mov_b32 s53,s33
s_mov_b32 s54,s34
s_add_u32 s32,s32,1
s_mov_b32 s33,s40
s_mov_b32 s34,s41
s_mov_b64 s[76:77],s[80:81]
s_nop 2
ep_328:
v_pk_fma_f32 v[56:57],v[144:145],v[180:181],v[56:57] op_sel_hi:[1,0,1] neg_lo:[0,1,0] neg_hi:[0,1,0]
v_pk_fma_f32 v[58:59],v[146:147],v[180:181],v[58:59] op_sel_hi:[1,0,1] neg_lo:[0,1,0] neg_hi:[0,1,0]
v_pk_fma_f32 v[60:61],v[148:149],v[180:181],v[60:61] op_sel_hi:[1,0,1] neg_lo:[0,1,0] neg_hi:[0,1,0]
v_pk_fma_f32 v[62:63],v[150:151],v[180:181],v[62:63] op_sel_hi:[1,0,1] neg_lo:[0,1,0] neg_hi:[0,1,0]
v_pk_fma_f32 v[64:65],v[152:153],v[180:181],v[64:65] op_sel_hi:[1,0,1] neg_lo:[0,1,0] neg_hi:[0,1,0]
v_pk_fma_f32 v[66:67],v[154:155],v[180:181],v[66:67] op_sel_hi:[1,0,1] neg_lo:[0,1,0] neg_hi:[0,1,0]
v_pk_fma_f32 v[68:69],v[156:157],v[180:181],v[68:69] op_sel_hi:[1,0,1] neg_lo:[0,1,0] neg_hi:[0,1,0]
v_pk_fma_f32 v[70:71],v[158:159],v[180:181],v[70:71] op_sel_hi:[1,0,1] neg_lo:[0,1,0] neg_hi:[0,1,0]
v_pk_mul_f32 v[56:57],v[56:57],v[180:181] op_sel:[0,1] op_sel_hi:[1,1]
v_pk_mul_f32 v[58:59],v[58:59],v[180:181] op_sel:[0,1] op_sel_hi:[1,1]
v_pk_mul_f32 v[60:61],v[60:61],v[180:181] op_sel:[0,1] op_sel_hi:[1,1]
v_pk_mul_f32 v[62:63],v[62:63],v[180:181] op_sel:[0,1] op_sel_hi:[1,1]
v_pk_mul_f32 v[64:65],v[64:65],v[180:181] op_sel:[0,1] op_sel_hi:[1,1]
v_pk_mul_f32 v[66:67],v[66:67],v[180:181] op_sel:[0,1] op_sel_hi:[1,1]
v_pk_mul_f32 v[68:69],v[68:69],v[180:181] op_sel:[0,1] op_sel_hi:[1,1]
v_pk_mul_f32 v[70:71],v[70:71],v[180:181] op_sel:[0,1] op_sel_hi:[1,1]
v_cvt_pk_bf16_f32 v140,v56,v57
v_lshlrev_b32 v56,16,v140
v_and_b32 v57,0xffff0000,v140
v_cvt_pk_bf16_f32 v140,v58,v59
v_lshlrev_b32 v58,16,v140
v_and_b32 v59,0xffff0000,v140
v_cvt_pk_bf16_f32 v140,v60,v61
v_lshlrev_b32 v60,16,v140
v_and_b32 v61,0xffff0000,v140
v_cvt_pk_bf16_f32 v140,v62,v63
v_lshlrev_b32 v62,16,v140
v_and_b32 v63,0xffff0000,v140
v_cvt_pk_bf16_f32 v140,v64,v65
v_lshlrev_b32 v64,16,v140
v_and_b32 v65,0xffff0000,v140
v_cvt_pk_bf16_f32 v140,v66,v67
v_lshlrev_b32 v66,16,v140
v_and_b32 v67,0xffff0000,v140
v_cvt_pk_bf16_f32 v140,v68,v69
v_lshlrev_b32 v68,16,v140
v_and_b32 v69,0xffff0000,v140
v_cvt_pk_bf16_f32 v140,v70,v71
v_lshlrev_b32 v70,16,v140
v_and_b32 v71,0xffff0000,v140
v_pk_mul_f32 v[124:125],v[56:57],v[56:57]
v_pk_mul_f32 v[126:127],v[58:59],v[58:59]
v_pk_mul_f32 v[128:129],v[60:61],v[60:61]
v_pk_mul_f32 v[130:131],v[62:63],v[62:63]
v_pk_mul_f32 v[132:133],v[64:65],v[64:65]
v_pk_mul_f32 v[134:135],v[66:67],v[66:67]
v_pk_mul_f32 v[136:137],v[68:69],v[68:69]
v_pk_mul_f32 v[138:139],v[70:71],v[70:71]
v_pk_fma_f32 v[124:125],v[124:125],v[112:113],v[112:113] op_sel:[0,1,0] op_sel_hi:[1,1,0]
v_pk_fma_f32 v[126:127],v[126:127],v[112:113],v[112:113] op_sel:[0,1,0] op_sel_hi:[1,1,0]
v_pk_fma_f32 v[128:129],v[128:129],v[112:113],v[112:113] op_sel:[0,1,0] op_sel_hi:[1,1,0]
v_pk_fma_f32 v[130:131],v[130:131],v[112:113],v[112:113] op_sel:[0,1,0] op_sel_hi:[1,1,0]
v_pk_fma_f32 v[132:133],v[132:133],v[112:113],v[112:113] op_sel:[0,1,0] op_sel_hi:[1,1,0]
v_pk_fma_f32 v[134:135],v[134:135],v[112:113],v[112:113] op_sel:[0,1,0] op_sel_hi:[1,1,0]
v_pk_fma_f32 v[136:137],v[136:137],v[112:113],v[112:113] op_sel:[0,1,0] op_sel_hi:[1,1,0]
v_pk_fma_f32 v[138:139],v[138:139],v[112:113],v[112:113] op_sel:[0,1,0] op_sel_hi:[1,1,0]
v_pk_mul_f32 v[124:125],v[124:125],v[56:57]
v_pk_mul_f32 v[126:127],v[126:127],v[58:59]
v_pk_mul_f32 v[128:129],v[128:129],v[60:61]
v_pk_mul_f32 v[130:131],v[130:131],v[62:63]
v_pk_mul_f32 v[132:133],v[132:133],v[64:65]
v_pk_mul_f32 v[134:135],v[134:135],v[66:67]
v_pk_mul_f32 v[136:137],v[136:137],v[68:69]
v_pk_mul_f32 v[138:139],v[138:139],v[70:71]
v_exp_f32 v124,v124
v_exp_f32 v125,v125
v_exp_f32 v126,v126
v_exp_f32 v127,v127
v_exp_f32 v128,v128
v_exp_f32 v129,v129
v_exp_f32 v130,v130
v_exp_f32 v131,v131
v_exp_f32 v132,v132
v_exp_f32 v133,v133
v_exp_f32 v134,v134
v_exp_f32 v135,v135
v_exp_f32 v136,v136
v_exp_f32 v137,v137
v_exp_f32 v138,v138
v_exp_f32 v139,v139
v_pk_add_f32 v[124:125],v[124:125],1.0 op_sel_hi:[1,0]
v_pk_add_f32 v[126:127],v[126:127],1.0 op_sel_hi:[1,0]
v_pk_add_f32 v[128:129],v[128:129],1.0 op_sel_hi:[1,0]
v_pk_add_f32 v[130:131],v[130:131],1.0 op_sel_hi:[1,0]
v_pk_add_f32 v[132:133],v[132:133],1.0 op_sel_hi:[1,0]
v_pk_add_f32 v[134:135],v[134:135],1.0 op_sel_hi:[1,0]
v_pk_add_f32 v[136:137],v[136:137],1.0 op_sel_hi:[1,0]
v_pk_add_f32 v[138:139],v[138:139],1.0 op_sel_hi:[1,0]
v_rcp_f32 v124,v124
v_rcp_f32 v125,v125
v_rcp_f32 v126,v126
v_rcp_f32 v127,v127
v_rcp_f32 v128,v128
v_rcp_f32 v129,v129
v_rcp_f32 v130,v130
v_rcp_f32 v131,v131
v_rcp_f32 v132,v132
v_rcp_f32 v133,v133
v_rcp_f32 v134,v134
v_rcp_f32 v135,v135
v_rcp_f32 v136,v136
v_rcp_f32 v137,v137
v_rcp_f32 v138,v138
v_rcp_f32 v139,v139
v_pk_mul_f32 v[56:57],v[56:57],v[124:125]
v_pk_mul_f32 v[58:59],v[58:59],v[126:127]
v_pk_mul_f32 v[60:61],v[60:61],v[128:129]
v_pk_mul_f32 v[62:63],v[62:63],v[130:131]
v_pk_mul_f32 v[64:65],v[64:65],v[132:133]
v_pk_mul_f32 v[66:67],v[66:67],v[134:135]
v_pk_mul_f32 v[68:69],v[68:69],v[136:137]
v_pk_mul_f32 v[70:71],v[70:71],v[138:139]
v_cvt_pk_bf16_f32 v116,v56,v57
v_cvt_pk_bf16_f32 v117,v58,v59
v_cvt_pk_bf16_f32 v118,v60,v61
v_cvt_pk_bf16_f32 v119,v62,v63
v_cvt_pk_bf16_f32 v120,v64,v65
v_cvt_pk_bf16_f32 v121,v66,v67
v_cvt_pk_bf16_f32 v122,v68,v69
v_cvt_pk_bf16_f32 v123,v70,v71
s_cmp_lg_u32 s49,0
s_cbranch_scc0 ls_331
buffer_store_dwordx4 v[116:119],v20,s[8:11],s71 offen sc1
buffer_store_dwordx4 v[120:123],v21,s[8:11],s71 offen sc1
s_branch ls_332
ls_331:
buffer_store_dwordx4 v[116:119],v20,s[8:11],s71 offen
buffer_store_dwordx4 v[120:123],v21,s[8:11],s71 offen
ls_332:
s_mov_b32 s59,s82
s_cmp_eq_u32 s37,0
s_cbranch_scc1 W1_NEXT
s_waitcnt vmcnt(2)
v_cmp_eq_u32 vcc,0,v3
s_and_b64 vcc,vcc,s[76:77]
s_cselect_b32 s37,2147483648,0
s_cmp_lt_u32 s32,128
s_cselect_b32 s37,s37,2147483648
s_cmp_eq_u32 s37,0
s_cbranch_scc1 W1_COLD2
s_waitcnt vmcnt(0)
s_mov_b64 exec,1
s_cmp_lg_u32 s49,0
s_cbranch_scc0 ls_333
buffer_store_dword v5,v1,s[8:11],s59 offen sc1
s_branch ls_334
ls_333:
buffer_store_dword v5,v1,s[8:11],s59 offen
ls_334:
s_mov_b64 exec,-1
s_mov_b32 s59,2147483648
s_cmp_lt_u32 s32,128
s_cbranch_scc1 W1_COLD
s_branch W1_END
sec_330:
s_waitcnt vmcnt(10)
v_cmp_eq_u32 vcc,0,v3
s_and_b64 vcc,vcc,s[76:77]
s_cselect_b32 s37,2147483648,0
s_cmp_lt_u32 s32,128
s_cselect_b32 s37,s37,2147483648
s_cmp_lg_u32 s37,0
s_cbranch_scc1 nr_329
s_add_u32 s65,s32,1
s_or_b32 s65,s65,s37
v_mov_b32 v23,s65
ds_max_i32 v22,v23
s_sub_u32 s66,46080,s57
s_lshl_b32 s60,s33,6
s_add_u32 s60,s60,s34
s_mul_i32 s60,s60,46080
s_add_u32 s60,s60,s37
s_add_u32 s60,s60,223608832
s_mov_b32 s67,s60
s_mul_i32 s61,s46,10240
s_add_u32 s60,s60,s61
s_add_u32 s61,s61,s66
s_add_u32 m0,s61,0
s_add_u32 s63,s60,0
buffer_load_dwordx4 v1,s[8:11],s63 offen sc1 lds
v_pk_fma_f32 v[56:57],v[144:145],v[180:181],v[56:57] op_sel_hi:[1,0,1] neg_lo:[0,1,0] neg_hi:[0,1,0]
v_pk_fma_f32 v[58:59],v[146:147],v[180:181],v[58:59] op_sel_hi:[1,0,1] neg_lo:[0,1,0] neg_hi:[0,1,0]
v_pk_fma_f32 v[60:61],v[148:149],v[180:181],v[60:61] op_sel_hi:[1,0,1] neg_lo:[0,1,0] neg_hi:[0,1,0]
v_pk_fma_f32 v[62:63],v[150:151],v[180:181],v[62:63] op_sel_hi:[1,0,1] neg_lo:[0,1,0] neg_hi:[0,1,0]
v_pk_fma_f32 v[64:65],v[152:153],v[180:181],v[64:65] op_sel_hi:[1,0,1] neg_lo:[0,1,0] neg_hi:[0,1,0]
v_pk_fma_f32 v[66:67],v[154:155],v[180:181],v[66:67] op_sel_hi:[1,0,1] neg_lo:[0,1,0] neg_hi:[0,1,0]
v_pk_fma_f32 v[68:69],v[156:157],v[180:181],v[68:69] op_sel_hi:[1,0,1] neg_lo:[0,1,0] neg_hi:[0,1,0]
v_pk_fma_f32 v[70:71],v[158:159],v[180:181],v[70:71] op_sel_hi:[1,0,1] neg_lo:[0,1,0] neg_hi:[0,1,0]
v_pk_mul_f32 v[56:57],v[56:57],v[180:181] op_sel:[0,1] op_sel_hi:[1,1]
buffer_load_dwordx4 v1,s[8:11],s63 offen offset:1024 sc1 lds
v_pk_mul_f32 v[58:59],v[58:59],v[180:181] op_sel:[0,1] op_sel_hi:[1,1]
v_pk_mul_f32 v[60:61],v[60:61],v[180:181] op_sel:[0,1] op_sel_hi:[1,1]
v_pk_mul_f32 v[62:63],v[62:63],v[180:181] op_sel:[0,1] op_sel_hi:[1,1]
v_pk_mul_f32 v[64:65],v[64:65],v[180:181] op_sel:[0,1] op_sel_hi:[1,1]
v_pk_mul_f32 v[66:67],v[66:67],v[180:181] op_sel:[0,1] op_sel_hi:[1,1]
v_pk_mul_f32 v[68:69],v[68:69],v[180:181] op_sel:[0,1] op_sel_hi:[1,1]
v_pk_mul_f32 v[70:71],v[70:71],v[180:181] op_sel:[0,1] op_sel_hi:[1,1]
v_cvt_pk_bf16_f32 v140,v56,v57
v_lshlrev_b32 v56,16,v140
buffer_load_dwordx4 v1,s[8:11],s63 offen offset:2048 sc1 lds
v_and_b32 v57,0xffff0000,v140
v_cvt_pk_bf16_f32 v140,v58,v59
v_lshlrev_b32 v58,16,v140
v_and_b32 v59,0xffff0000,v140
v_cvt_pk_bf16_f32 v140,v60,v61
v_lshlrev_b32 v60,16,v140
v_and_b32 v61,0xffff0000,v140
v_cvt_pk_bf16_f32 v140,v62,v63
v_lshlrev_b32 v62,16,v140
buffer_load_dwordx4 v1,s[8:11],s63 offen offset:3072 sc1 lds
v_and_b32 v63,0xffff0000,v140
v_cvt_pk_bf16_f32 v140,v64,v65
v_lshlrev_b32 v64,16,v140
v_and_b32 v65,0xffff0000,v140
v_cvt_pk_bf16_f32 v140,v66,v67
v_lshlrev_b32 v66,16,v140
v_and_b32 v67,0xffff0000,v140
v_cvt_pk_bf16_f32 v140,v68,v69
v_lshlrev_b32 v68,16,v140
s_add_u32 m0,s61,4096
s_add_u32 s63,s60,4096
buffer_load_dwordx4 v1,s[8:11],s63 offen sc1 lds
v_and_b32 v69,0xffff0000,v140
v_cvt_pk_bf16_f32 v140,v70,v71
v_lshlrev_b32 v70,16,v140
v_and_b32 v71,0xffff0000,v140
v_pk_mul_f32 v[124:125],v[56:57],v[56:57]
v_pk_mul_f32 v[126:127],v[58:59],v[58:59]
v_pk_mul_f32 v[128:129],v[60:61],v[60:61]
v_pk_mul_f32 v[130:131],v[62:63],v[62:63]
v_pk_mul_f32 v[132:133],v[64:65],v[64:65]
buffer_load_dwordx4 v1,s[8:11],s63 offen offset:1024 sc1 lds
v_pk_mul_f32 v[134:135],v[66:67],v[66:67]
v_pk_mul_f32 v[136:137],v[68:69],v[68:69]
v_pk_mul_f32 v[138:139],v[70:71],v[70:71]
v_pk_fma_f32 v[124:125],v[124:125],v[112:113],v[112:113] op_sel:[0,1,0] op_sel_hi:[1,1,0]
v_pk_fma_f32 v[126:127],v[126:127],v[112:113],v[112:113] op_sel:[0,1,0] op_sel_hi:[1,1,0]
v_pk_fma_f32 v[128:129],v[128:129],v[112:113],v[112:113] op_sel:[0,1,0] op_sel_hi:[1,1,0]
v_pk_fma_f32 v[130:131],v[130:131],v[112:113],v[112:113] op_sel:[0,1,0] op_sel_hi:[1,1,0]
v_pk_fma_f32 v[132:133],v[132:133],v[112:113],v[112:113] op_sel:[0,1,0] op_sel_hi:[1,1,0]
v_pk_fma_f32 v[134:135],v[134:135],v[112:113],v[112:113] op_sel:[0,1,0] op_sel_hi:[1,1,0]
buffer_load_dwordx4 v1,s[8:11],s63 offen offset:2048 sc1 lds
v_pk_fma_f32 v[136:137],v[136:137],v[112:113],v[112:113] op_sel:[0,1,0] op_sel_hi:[1,1,0]
v_pk_fma_f32 v[138:139],v[138:139],v[112:113],v[112:113] op_sel:[0,1,0] op_sel_hi:[1,1,0]
v_pk_mul_f32 v[124:125],v[124:125],v[56:57]
v_pk_mul_f32 v[126:127],v[126:127],v[58:59]
v_pk_mul_f32 v[128:129],v[128:129],v[60:61]
v_pk_mul_f32 v[130:131],v[130:131],v[62:63]
v_pk_mul_f32 v[132:133],v[132:133],v[64:65]
v_pk_mul_f32 v[134:135],v[134:135],v[66:67]
v_pk_mul_f32 v[136:137],v[136:137],v[68:69]
buffer_load_dwordx4 v1,s[8:11],s63 offen offset:3072 sc1 lds
v_pk_mul_f32 v[138:139],v[138:139],v[70:71]
v_exp_f32 v124,v124
v_exp_f32 v125,v125
v_exp_f32 v126,v126
v_exp_f32 v127,v127
v_exp_f32 v128,v128
v_exp_f32 v129,v129
v_exp_f32 v130,v130
v_exp_f32 v131,v131
s_add_u32 m0,s61,8192
s_add_u32 s63,s60,8192
buffer_load_dwordx4 v1,s[8:11],s63 offen sc1 lds
v_exp_f32 v132,v132
v_exp_f32 v133,v133
v_exp_f32 v134,v134
v_exp_f32 v135,v135
v_exp_f32 v136,v136
v_exp_f32 v137,v137
v_exp_f32 v138,v138
v_exp_f32 v139,v139
v_pk_add_f32 v[124:125],v[124:125],1.0 op_sel_hi:[1,0]
buffer_load_dwordx4 v1,s[8:11],s63 offen offset:1024 sc1 lds
v_pk_add_f32 v[126:127],v[126:127],1.0 op_sel_hi:[1,0]
v_pk_add_f32 v[128:129],v[128:129],1.0 op_sel_hi:[1,0]
v_pk_add_f32 v[130:131],v[130:131],1.0 op_sel_hi:[1,0]
v_pk_add_f32 v[132:133],v[132:133],1.0 op_sel_hi:[1,0]
v_pk_add_f32 v[134:135],v[134:135],1.0 op_sel_hi:[1,0]
v_pk_add_f32 v[136:137],v[136:137],1.0 op_sel_hi:[1,0]
v_pk_add_f32 v[138:139],v[138:139],1.0 op_sel_hi:[1,0]
v_rcp_f32 v124,v124
v_rcp_f32 v125,v125
s_add_u32 m0,s66,40960
s_add_u32 s63,s67,40960
buffer_load_dwordx4 v1,s[8:11],s63 offen sc1 lds
v_rcp_f32 v126,v126
v_rcp_f32 v127,v127
v_rcp_f32 v128,v128
v_rcp_f32 v129,v129
v_rcp_f32 v130,v130
v_rcp_f32 v131,v131
v_rcp_f32 v132,v132
v_rcp_f32 v133,v133
v_rcp_f32 v134,v134
s_mov_b32 s35,s42
buffer_load_dword v3,v2,s[8:11],s35 offen sc1
s_mov_b32 s53,s33
s_mov_b32 s54,s34
s_add_u32 s32,s32,1
s_mov_b32 s33,s40
s_mov_b32 s34,s41
s_mov_b64 s[76:77],s[80:81]
v_rcp_f32 v135,v135
v_rcp_f32 v136,v136
v_rcp_f32 v137,v137
v_rcp_f32 v138,v138
v_rcp_f32 v139,v139
v_pk_mul_f32 v[56:57],v[56:57],v[124:125]
v_pk_mul_f32 v[58:59],v[58:59],v[126:127]
v_pk_mul_f32 v[60:61],v[60:61],v[128:129]
v_pk_mul_f32 v[62:63],v[62:63],v[130:131]
v_pk_mul_f32 v[64:65],v[64:65],v[132:133]
v_pk_mul_f32 v[66:67],v[66:67],v[134:135]
v_pk_mul_f32 v[68:69],v[68:69],v[136:137]
v_pk_mul_f32 v[70:71],v[70:71],v[138:139]
v_cvt_pk_bf16_f32 v116,v56,v57
v_cvt_pk_bf16_f32 v117,v58,v59
v_cvt_pk_bf16_f32 v118,v60,v61
v_cvt_pk_bf16_f32 v119,v62,v63
v_cvt_pk_bf16_f32 v120,v64,v65
v_cvt_pk_bf16_f32 v121,v66,v67
v_cvt_pk_bf16_f32 v122,v68,v69
v_cvt_pk_bf16_f32 v123,v70,v71
s_cmp_lg_u32 s49,0
s_cbranch_scc0 ls_335
buffer_store_dwordx4 v[116:119],v20,s[8:11],s71 offen sc1
buffer_store_dwordx4 v[120:123],v21,s[8:11],s71 offen sc1
s_branch ls_336
ls_335:
buffer_store_dwordx4 v[116:119],v20,s[8:11],s71 offen
buffer_store_dwordx4 v[120:123],v21,s[8:11],s71 offen
ls_336:
s_mov_b32 s59,s82
s_branch W1_NEXT
nr_329:
buffer_load_dword v3,v2,s[8:11],s35 offen sc1
s_branch ep_328
W1_END:
s_endpgm
ROLE_W2:
v_lshlrev_b32 v1,4,v0
v_mov_b32 v5,1
s_lshl_b32 s56,s48,2
s_add_u32 s56,s56,s46
v_bfe_u32 v6,v0,2,2
v_lshrrev_b32 v7,4,v0
v_add_u32 v7,v6,v7
v_and_b32 v7,3,v7
v_and_b32 v15,3,v0
v_lshlrev_b32 v15,4,v15
v_lshl_add_u32 v15,v7,6,v15
v_lshl_add_u32 v15,v6,8,v15
v_lshrrev_b32 v6,5,v0
v_bfe_u32 v7,v0,4,1
v_lshlrev_b32 v16,10,v7
v_lshl_add_u32 v16,v6,8,v16
v_and_b32 v6,15,v0
v_lshl_add_u32 v16,v6,4,v16
v_add_u32 v18,40960,v16
v_lshrrev_b32 v6,5,v0
v_bfe_u32 v7,v0,4,1
v_lshlrev_b32 v20,10,v7
v_lshl_add_u32 v20,v6,8,v20
v_and_b32 v6,15,v0
v_lshl_add_u32 v20,v6,4,v20
v_lshrrev_b32 v6,5,v0
v_add_u32 v6,2,v6
v_bfe_u32 v7,v0,4,1
v_lshlrev_b32 v17,10,v7
v_lshl_add_u32 v17,v6,8,v17
v_and_b32 v6,15,v0
v_lshl_add_u32 v17,v6,4,v17
v_add_u32 v19,40960,v17
v_lshrrev_b32 v6,5,v0
v_add_u32 v6,2,v6
v_bfe_u32 v7,v0,4,1
v_lshlrev_b32 v21,10,v7
v_lshl_add_u32 v21,v6,8,v21
v_and_b32 v6,15,v0
v_lshl_add_u32 v21,v6,4,v21
v_min_u32 v2,19,v0
v_lshlrev_b32 v2,2,v2
s_lshr_b32 s60,s46,1
s_add_u32 s60,s60,1
s_sub_u32 s61,32,s60
s_add_u32 s60,s60,32
s_bitcmp1_b32 s46,0
s_cselect_b32 s60,s60,s61
v_and_b32 v6,15,v0
v_add_u32 v6,s60,v6
v_lshrrev_b32 v7,5,v6
v_mul_u32_u24 v112,40960,v7
v_bfe_u32 v7,v6,4,1
v_lshl_add_u32 v112,v7,10,v112
v_and_b32 v7,15,v6
v_lshl_add_u32 v112,v7,4,v112
v_lshrrev_b32 v7,4,v0
v_lshl_add_u32 v112,v7,8,v112
v_and_b32 v6,15,v0
v_add_u32 v6,s60,v6
v_add_u32 v6,16,v6
v_lshrrev_b32 v7,5,v6
v_mul_u32_u24 v113,40960,v7
v_bfe_u32 v7,v6,4,1
v_lshl_add_u32 v113,v7,10,v113
v_and_b32 v7,15,v6
v_lshl_add_u32 v113,v7,4,v113
v_lshrrev_b32 v7,4,v0
v_lshl_add_u32 v113,v7,8,v113
v_lshrrev_b32 v6,5,v0
v_and_b32 v7,15,v0
v_lshlrev_b32 v114,3,v7
v_lshl_add_u32 v114,v6,7,v114
v_and_b32 v114,31,v0
v_lshlrev_b32 v114,3,v114
v_lshrrev_b32 v6,5,v0
v_bfe_u32 v7,v0,4,1
v_lshlrev_b32 v116,10,v7
v_bfe_u32 v7,v0,2,2
v_lshl_add_u32 v116,v7,8,v116
v_add_u32 v6,v6,v7
v_and_b32 v6,3,v6
v_lshl_add_u32 v116,v6,6,v116
v_and_b32 v6,3,v0
v_lshl_add_u32 v116,v6,4,v116
v_lshrrev_b32 v6,5,v0
v_add_u32 v6,2,v6
v_bfe_u32 v7,v0,4,1
v_lshlrev_b32 v117,10,v7
v_bfe_u32 v7,v0,2,2
v_lshl_add_u32 v117,v7,8,v117
v_add_u32 v6,v6,v7
v_and_b32 v6,3,v6
v_lshl_add_u32 v117,v6,6,v117
v_and_b32 v6,3,v0
v_lshl_add_u32 v117,v6,4,v117
v_subrev_u32 v6,40960,v112
v_cmp_gt_u32 vcc,40960,v6
s_nop 1
v_cndmask_b32 v78,0,1,vcc
v_xor_b32 v76,1,v78
v_and_b32 v74,2047,v112
v_subrev_u32 v6,40960,v113
v_cmp_gt_u32 vcc,40960,v6
s_nop 1
v_cndmask_b32 v79,0,1,vcc
v_xor_b32 v77,1,v79
v_and_b32 v75,2047,v113
s_and_b32 s68,s46,1
s_lshl_b32 s68,s68,1
s_sub_u32 s68,s68,1
s_waitcnt vmcnt(0)
s_barrier
s_cmp_lg_u32 s46,0
s_cbranch_scc1 arr_337
v_mov_b32 v6,1
s_lshl_b32 s3,s49,2
v_mov_b32 v7,s3
s_mov_b64 exec,1
buffer_atomic_add v6,v7,s[12:15],0 offen sc1
s_mov_b64 exec,-1
arr_337:
s_lshl_b32 s58,s56,6
s_mul_i32 s63,s46,40960
s_mov_b32 s4,s34
s_mov_b32 s5,s35
s_mov_b32 s6,819200
s_mov_b32 s7,0x20000
v_lshrrev_b32 v9,2,v0
s_mov_b32 s64,1280
v_mul_lo_u32 v9,v9,s64
v_and_b32 v10,3,v0
v_lshl_add_u32 v6,v10,4,v9
s_add_u32 m0,s63,0
s_add_u32 s65,s58,0
buffer_load_dwordx4 v6,s[4:7],s65 offen lds
s_add_u32 m0,s63,1024
s_add_u32 s65,s58,20480
buffer_load_dwordx4 v6,s[4:7],s65 offen lds
s_add_u32 m0,s63,2048
s_add_u32 s65,s58,40960
buffer_load_dwordx4 v6,s[4:7],s65 offen lds
s_add_u32 m0,s63,3072
s_add_u32 s65,s58,61440
buffer_load_dwordx4 v6,s[4:7],s65 offen lds
s_add_u32 m0,s63,4096
s_add_u32 s65,s58,81920
buffer_load_dwordx4 v6,s[4:7],s65 offen lds
s_add_u32 m0,s63,5120
s_add_u32 s65,s58,102400
buffer_load_dwordx4 v6,s[4:7],s65 offen lds
s_add_u32 m0,s63,6144
s_add_u32 s65,s58,122880
buffer_load_dwordx4 v6,s[4:7],s65 offen lds
s_add_u32 m0,s63,7168
s_add_u32 s65,s58,143360
buffer_load_dwordx4 v6,s[4:7],s65 offen lds
s_add_u32 m0,s63,8192
s_add_u32 s65,s58,163840
buffer_load_dwordx4 v6,s[4:7],s65 offen lds
s_add_u32 m0,s63,9216
s_add_u32 s65,s58,184320
buffer_load_dwordx4 v6,s[4:7],s65 offen lds
s_add_u32 m0,s63,10240
s_add_u32 s65,s58,204800
buffer_load_dwordx4 v6,s[4:7],s65 offen lds
s_add_u32 m0,s63,11264
s_add_u32 s65,s58,225280
buffer_load_dwordx4 v6,s[4:7],s65 offen lds
s_add_u32 m0,s63,12288
s_add_u32 s65,s58,245760
buffer_load_dwordx4 v6,s[4:7],s65 offen lds
s_add_u32 m0,s63,13312
s_add_u32 s65,s58,266240
buffer_load_dwordx4 v6,s[4:7],s65 offen lds
s_add_u32 m0,s63,14336
s_add_u32 s65,s58,286720
buffer_load_dwordx4 v6,s[4:7],s65 offen lds
s_add_u32 m0,s63,15360
s_add_u32 s65,s58,307200
buffer_load_dwordx4 v6,s[4:7],s65 offen lds
s_add_u32 m0,s63,16384
s_add_u32 s65,s58,327680
buffer_load_dwordx4 v6,s[4:7],s65 offen lds
s_add_u32 m0,s63,17408
s_add_u32 s65,s58,348160
buffer_load_dwordx4 v6,s[4:7],s65 offen lds
s_add_u32 m0,s63,18432
s_add_u32 s65,s58,368640
buffer_load_dwordx4 v6,s[4:7],s65 offen lds
s_add_u32 m0,s63,19456
s_add_u32 s65,s58,389120
buffer_load_dwordx4 v6,s[4:7],s65 offen lds
s_add_u32 m0,s63,20480
s_add_u32 s65,s58,409600
buffer_load_dwordx4 v6,s[4:7],s65 offen lds
s_add_u32 m0,s63,21504
s_add_u32 s65,s58,430080
buffer_load_dwordx4 v6,s[4:7],s65 offen lds
s_add_u32 m0,s63,22528
s_add_u32 s65,s58,450560
buffer_load_dwordx4 v6,s[4:7],s65 offen lds
s_add_u32 m0,s63,23552
s_add_u32 s65,s58,471040
buffer_load_dwordx4 v6,s[4:7],s65 offen lds
s_add_u32 m0,s63,24576
s_add_u32 s65,s58,491520
buffer_load_dwordx4 v6,s[4:7],s65 offen lds
s_add_u32 m0,s63,25600
s_add_u32 s65,s58,512000
buffer_load_dwordx4 v6,s[4:7],s65 offen lds
s_add_u32 m0,s63,26624
s_add_u32 s65,s58,532480
buffer_load_dwordx4 v6,s[4:7],s65 offen lds
s_add_u32 m0,s63,27648
s_add_u32 s65,s58,552960
buffer_load_dwordx4 v6,s[4:7],s65 offen lds
s_add_u32 m0,s63,28672
s_add_u32 s65,s58,573440
buffer_load_dwordx4 v6,s[4:7],s65 offen lds
s_add_u32 m0,s63,29696
s_add_u32 s65,s58,593920
buffer_load_dwordx4 v6,s[4:7],s65 offen lds
s_add_u32 m0,s63,30720
s_add_u32 s65,s58,614400
buffer_load_dwordx4 v6,s[4:7],s65 offen lds
s_add_u32 m0,s63,31744
s_add_u32 s65,s58,634880
buffer_load_dwordx4 v6,s[4:7],s65 offen lds
s_add_u32 m0,s63,32768
s_add_u32 s65,s58,655360
buffer_load_dwordx4 v6,s[4:7],s65 offen lds
s_add_u32 m0,s63,33792
s_add_u32 s65,s58,675840
buffer_load_dwordx4 v6,s[4:7],s65 offen lds
s_add_u32 m0,s63,34816
s_add_u32 s65,s58,696320
buffer_load_dwordx4 v6,s[4:7],s65 offen lds
s_add_u32 m0,s63,35840
s_add_u32 s65,s58,716800
buffer_load_dwordx4 v6,s[4:7],s65 offen lds
s_add_u32 m0,s63,36864
s_add_u32 s65,s58,737280
buffer_load_dwordx4 v6,s[4:7],s65 offen lds
s_add_u32 m0,s63,37888
s_add_u32 s65,s58,757760
buffer_load_dwordx4 v6,s[4:7],s65 offen lds
s_add_u32 m0,s63,38912
s_add_u32 s65,s58,778240
buffer_load_dwordx4 v6,s[4:7],s65 offen lds
s_add_u32 m0,s63,39936
s_add_u32 s65,s58,798720
buffer_load_dwordx4 v6,s[4:7],s65 offen lds
s_waitcnt vmcnt(20)
v_bfe_u32 v9,v0,2,2
v_lshrrev_b32 v10,5,v0
v_lshl_add_u32 v9,v10,2,v9
v_mul_u32_u24 v9,64,v9
v_and_b32 v10,1,v0
v_lshl_add_u32 v9,v10,3,v9
v_bfe_u32 v10,v0,1,1
v_lshl_add_u32 v9,v10,5,v9
v_bfe_u32 v10,v0,4,1
v_lshl_add_u32 v9,v10,4,v9
v_add_u32 v7,s63,v9
ds_read_b64_tr_b16 a[0:1],v7 offset:0
ds_read_b64_tr_b16 a[2:3],v7 offset:1024
ds_read_b64_tr_b16 a[4:5],v7 offset:512
ds_read_b64_tr_b16 a[6:7],v7 offset:1536
ds_read_b64_tr_b16 a[8:9],v7 offset:2048
ds_read_b64_tr_b16 a[10:11],v7 offset:3072
ds_read_b64_tr_b16 a[12:13],v7 offset:2560
ds_read_b64_tr_b16 a[14:15],v7 offset:3584
ds_read_b64_tr_b16 a[16:17],v7 offset:4096
ds_read_b64_tr_b16 a[18:19],v7 offset:5120
ds_read_b64_tr_b16 a[20:21],v7 offset:4608
ds_read_b64_tr_b16 a[22:23],v7 offset:5632
s_waitcnt lgkmcnt(4)
ds_read_b64_tr_b16 a[24:25],v7 offset:6144
ds_read_b64_tr_b16 a[26:27],v7 offset:7168
ds_read_b64_tr_b16 a[28:29],v7 offset:6656
ds_read_b64_tr_b16 a[30:31],v7 offset:7680
ds_read_b64_tr_b16 a[32:33],v7 offset:8192
ds_read_b64_tr_b16 a[34:35],v7 offset:9216
ds_read_b64_tr_b16 a[36:37],v7 offset:8704
ds_read_b64_tr_b16 a[38:39],v7 offset:9728
ds_read_b64_tr_b16 a[40:41],v7 offset:10240
ds_read_b64_tr_b16 a[42:43],v7 offset:11264
ds_read_b64_tr_b16 a[44:45],v7 offset:10752
ds_read_b64_tr_b16 a[46:47],v7 offset:11776
s_waitcnt lgkmcnt(4)
ds_read_b64_tr_b16 a[48:49],v7 offset:12288
ds_read_b64_tr_b16 a[50:51],v7 offset:13312
ds_read_b64_tr_b16 a[52:53],v7 offset:12800
ds_read_b64_tr_b16 a[54:55],v7 offset:13824
ds_read_b64_tr_b16 a[56:57],v7 offset:14336
ds_read_b64_tr_b16 a[58:59],v7 offset:15360
ds_read_b64_tr_b16 a[60:61],v7 offset:14848
ds_read_b64_tr_b16 a[62:63],v7 offset:15872
ds_read_b64_tr_b16 a[64:65],v7 offset:16384
ds_read_b64_tr_b16 a[66:67],v7 offset:17408
ds_read_b64_tr_b16 a[68:69],v7 offset:16896
ds_read_b64_tr_b16 a[70:71],v7 offset:17920
s_waitcnt lgkmcnt(4)
ds_read_b64_tr_b16 a[72:73],v7 offset:18432
ds_read_b64_tr_b16 a[74:75],v7 offset:19456
ds_read_b64_tr_b16 a[76:77],v7 offset:18944
ds_read_b64_tr_b16 a[78:79],v7 offset:19968
s_waitcnt lgkmcnt(0)
s_waitcnt vmcnt(0)
v_bfe_u32 v9,v0,2,2
v_lshrrev_b32 v10,5,v0
v_lshl_add_u32 v9,v10,2,v9
v_mul_u32_u24 v9,64,v9
v_and_b32 v10,1,v0
v_lshl_add_u32 v9,v10,3,v9
v_bfe_u32 v10,v0,1,1
v_lshl_add_u32 v9,v10,5,v9
v_bfe_u32 v10,v0,4,1
v_lshl_add_u32 v9,v10,4,v9
v_add_u32 v7,s63,v9
ds_read_b64_tr_b16 a[80:81],v7 offset:20480
ds_read_b64_tr_b16 a[82:83],v7 offset:21504
ds_read_b64_tr_b16 a[84:85],v7 offset:20992
ds_read_b64_tr_b16 a[86:87],v7 offset:22016
ds_read_b64_tr_b16 a[88:89],v7 offset:22528
ds_read_b64_tr_b16 a[90:91],v7 offset:23552
ds_read_b64_tr_b16 a[92:93],v7 offset:23040
ds_read_b64_tr_b16 a[94:95],v7 offset:24064
ds_read_b64_tr_b16 a[96:97],v7 offset:24576
ds_read_b64_tr_b16 a[98:99],v7 offset:25600
ds_read_b64_tr_b16 a[100:101],v7 offset:25088
ds_read_b64_tr_b16 a[102:103],v7 offset:26112
s_waitcnt lgkmcnt(4)
ds_read_b64_tr_b16 a[104:105],v7 offset:26624
ds_read_b64_tr_b16 a[106:107],v7 offset:27648
ds_read_b64_tr_b16 a[108:109],v7 offset:27136
ds_read_b64_tr_b16 a[110:111],v7 offset:28160
ds_read_b64_tr_b16 a[112:113],v7 offset:28672
ds_read_b64_tr_b16 a[114:115],v7 offset:29696
ds_read_b64_tr_b16 a[116:117],v7 offset:29184
ds_read_b64_tr_b16 a[118:119],v7 offset:30208
ds_read_b64_tr_b16 a[120:121],v7 offset:30720
ds_read_b64_tr_b16 a[122:123],v7 offset:31744
ds_read_b64_tr_b16 a[124:125],v7 offset:31232
ds_read_b64_tr_b16 a[126:127],v7 offset:32256
s_waitcnt lgkmcnt(4)
ds_read_b64_tr_b16 a[128:129],v7 offset:32768
ds_read_b64_tr_b16 a[130:131],v7 offset:33792
ds_read_b64_tr_b16 a[132:133],v7 offset:33280
ds_read_b64_tr_b16 a[134:135],v7 offset:34304
ds_read_b64_tr_b16 a[136:137],v7 offset:34816
ds_read_b64_tr_b16 a[138:139],v7 offset:35840
ds_read_b64_tr_b16 a[140:141],v7 offset:35328
ds_read_b64_tr_b16 a[142:143],v7 offset:36352
ds_read_b64_tr_b16 a[144:145],v7 offset:36864
ds_read_b64_tr_b16 a[146:147],v7 offset:37888
ds_read_b64_tr_b16 a[148:149],v7 offset:37376
ds_read_b64_tr_b16 a[150:151],v7 offset:38400
s_waitcnt lgkmcnt(4)
ds_read_b64_tr_b16 a[152:153],v7 offset:38912
ds_read_b64_tr_b16 a[154:155],v7 offset:39936
ds_read_b64_tr_b16 a[156:157],v7 offset:39424
ds_read_b64_tr_b16 a[158:159],v7 offset:40448
s_waitcnt lgkmcnt(0)
s_barrier
s_lshl_b32 s3,s49,2
v_mov_b32 v7,s3
s_nop 1
ibw_338:
buffer_load_dword v6,v7,s[12:15],0 offen sc1
s_waitcnt vmcnt(0)
v_cmp_ne_u32 vcc,256,v6
s_nop 0
s_cbranch_vccz ok_339
s_sleep 8
s_sub_u32 s47,s47,1
s_cbranch_scc1 ABORT
s_branch ibw_338
ok_339:
s_cmp_lg_u32 s49,0
s_cbranch_scc1 ibok_340
v_and_b32 v7,7,v0
v_lshlrev_b32 v7,2,v7
buffer_load_dword v6,v7,s[12:15],0 offen offset:32 sc1
s_waitcnt vmcnt(0)
v_cmp_ne_u32 vcc,32,v6
s_nop 0
s_cbranch_vccz ibok_340
s_barrier
s_mov_b32 s49,1
s_mov_b32 s3,s2
s_load_dwordx16 s[16:31],s[0:1],0
s_load_dwordx8 s[32:39],s[0:1],64
s_waitcnt lgkmcnt(0)
s_branch DISPATCH
ibok_340:
s_mov_b32 s50,0
s_mov_b32 s32,0
s_mov_b32 s57,0
s_mov_b32 s59,2147483648
s_mov_b32 s82,2147483648
s_mov_b32 s39,2147483648
v_mov_b32 v22,83968
v_lshl_add_u32 v22,v0,2,v22
v_mov_b32 v23,0
ds_write_b32 v22,v23
s_mov_b32 s39,1600000
v_and_b32 v72,15,v0
v_lshlrev_b32 v72,7,v72
s_mul_i32 s60,s56,-1792
s_add_u32 s60,s60,40960
v_and_b32 v6,128,v72
v_add_u32 v6,s60,v6
v_cmp_lt_u32 vcc,15,v0
s_nop 1
v_cndmask_b32 v72,v72,v6,vcc
v_min_u32 v6,59,v0
v_lshlrev_b32 v6,2,v6
v_add_u32 v2,135168,v6
v_add_u32 v7,-80,v6
v_cmp_gt_u32 s[78:79],20,v0
s_nop 1
v_cndmask_b32 v2,v7,v2,s[78:79]
s_mov_b32 s51,0
s_mov_b32 s52,0
s_mul_i32 s62,s51,8
s_and_b32 s63,s52,7
s_add_u32 s62,s62,s63
s_mul_i32 s62,s62,46080
s_add_u32 s62,s62,212467712
s_lshl_b32 s63,s56,11
s_add_u32 s62,s62,s63
buffer_load_dword v73,v72,s[8:11],s62 offen sc1
s_mov_b32 s51,0
s_mov_b32 s52,1
s_mul_i32 s62,s51,8
s_and_b32 s63,s52,7
s_add_u32 s62,s62,s63
s_mul_i32 s62,s62,46080
s_add_u32 s62,s62,212467712
s_lshl_b32 s63,s56,11
s_add_u32 s62,s62,s63
buffer_load_dword v73,v72,s[8:11],s62 offen sc1
s_mov_b32 s51,0
s_mov_b32 s52,2
s_mul_i32 s62,s51,8
s_and_b32 s63,s52,7
s_add_u32 s62,s62,s63
s_mul_i32 s62,s62,46080
s_add_u32 s62,s62,212467712
s_lshl_b32 s63,s56,11
s_add_u32 s62,s62,s63
buffer_load_dword v73,v72,s[8:11],s62 offen sc1
s_mov_b32 s51,0
s_mov_b32 s52,3
s_mul_i32 s62,s51,8
s_and_b32 s63,s52,7
s_add_u32 s62,s62,s63
s_mul_i32 s62,s62,46080
s_add_u32 s62,s62,212467712
s_lshl_b32 s63,s56,11
s_add_u32 s62,s62,s63
buffer_load_dword v73,v72,s[8:11],s62 offen sc1
s_mov_b32 s51,0
s_mov_b32 s52,4
s_mul_i32 s62,s51,8
s_and_b32 s63,s52,7
s_add_u32 s62,s62,s63
s_mul_i32 s62,s62,46080
s_add_u32 s62,s62,212467712
s_lshl_b32 s63,s56,11
s_add_u32 s62,s62,s63
buffer_load_dword v73,v72,s[8:11],s62 offen sc1
s_mov_b32 s51,0
s_mov_b32 s52,5
s_mul_i32 s62,s51,8
s_and_b32 s63,s52,7
s_add_u32 s62,s62,s63
s_mul_i32 s62,s62,46080
s_add_u32 s62,s62,212467712
s_lshl_b32 s63,s56,11
s_add_u32 s62,s62,s63
buffer_load_dword v73,v72,s[8:11],s62 offen sc1
s_mov_b32 s51,0
s_mov_b32 s52,6
s_mul_i32 s62,s51,8
s_and_b32 s63,s52,7
s_add_u32 s62,s62,s63
s_mul_i32 s62,s62,46080
s_add_u32 s62,s62,212467712
s_lshl_b32 s63,s56,11
s_add_u32 s62,s62,s63
buffer_load_dword v73,v72,s[8:11],s62 offen sc1
s_mov_b32 s51,0
s_mov_b32 s52,7
s_mul_i32 s62,s51,8
s_and_b32 s63,s52,7
s_add_u32 s62,s62,s63
s_mul_i32 s62,s62,46080
s_add_u32 s62,s62,212467712
s_lshl_b32 s63,s56,11
s_add_u32 s62,s62,s63
buffer_load_dword v73,v72,s[8:11],s62 offen sc1
s_mov_b32 s51,1
s_mov_b32 s52,0
s_mul_i32 s62,s51,8
s_and_b32 s63,s52,7
s_add_u32 s62,s62,s63
s_mul_i32 s62,s62,46080
s_add_u32 s62,s62,212467712
s_lshl_b32 s63,s56,11
s_add_u32 s62,s62,s63
buffer_load_dword v73,v72,s[8:11],s62 offen sc1
s_mov_b32 s51,1
s_mov_b32 s52,1
s_mul_i32 s62,s51,8
s_and_b32 s63,s52,7
s_add_u32 s62,s62,s63
s_mul_i32 s62,s62,46080
s_add_u32 s62,s62,212467712
s_lshl_b32 s63,s56,11
s_add_u32 s62,s62,s63
buffer_load_dword v73,v72,s[8:11],s62 offen sc1
s_mov_b32 s51,1
s_mov_b32 s52,2
s_mul_i32 s62,s51,8
s_and_b32 s63,s52,7
s_add_u32 s62,s62,s63
s_mul_i32 s62,s62,46080
s_add_u32 s62,s62,212467712
s_lshl_b32 s63,s56,11
s_add_u32 s62,s62,s63
buffer_load_dword v73,v72,s[8:11],s62 offen sc1
s_mov_b32 s51,1
s_mov_b32 s52,3
s_mul_i32 s62,s51,8
s_and_b32 s63,s52,7
s_add_u32 s62,s62,s63
s_mul_i32 s62,s62,46080
s_add_u32 s62,s62,212467712
s_lshl_b32 s63,s56,11
s_add_u32 s62,s62,s63
buffer_load_dword v73,v72,s[8:11],s62 offen sc1
s_mov_b32 s51,1
s_mov_b32 s52,4
s_mul_i32 s62,s51,8
s_and_b32 s63,s52,7
s_add_u32 s62,s62,s63
s_mul_i32 s62,s62,46080
s_add_u32 s62,s62,212467712
s_lshl_b32 s63,s56,11
s_add_u32 s62,s62,s63
buffer_load_dword v73,v72,s[8:11],s62 offen sc1
s_mov_b32 s51,1
s_mov_b32 s52,5
s_mul_i32 s62,s51,8
s_and_b32 s63,s52,7
s_add_u32 s62,s62,s63
s_mul_i32 s62,s62,46080
s_add_u32 s62,s62,212467712
s_lshl_b32 s63,s56,11
s_add_u32 s62,s62,s63
buffer_load_dword v73,v72,s[8:11],s62 offen sc1
s_mov_b32 s51,1
s_mov_b32 s52,6
s_mul_i32 s62,s51,8
s_and_b32 s63,s52,7
s_add_u32 s62,s62,s63
s_mul_i32 s62,s62,46080
s_add_u32 s62,s62,212467712
s_lshl_b32 s63,s56,11
s_add_u32 s62,s62,s63
buffer_load_dword v73,v72,s[8:11],s62 offen sc1
s_mov_b32 s51,1
s_mov_b32 s52,7
s_mul_i32 s62,s51,8
s_and_b32 s63,s52,7
s_add_u32 s62,s62,s63
s_mul_i32 s62,s62,46080
s_add_u32 s62,s62,212467712
s_lshl_b32 s63,s56,11
s_add_u32 s62,s62,s63
buffer_load_dword v73,v72,s[8:11],s62 offen sc1
s_waitcnt vmcnt(0)
s_waitcnt lgkmcnt(0)
s_barrier
s_mov_b32 s83,s100
s_min_u32 s62,s32,127
s_sub_u32 s60,s62,13
s_lshr_b32 s34,s60,1
s_and_b32 s33,s60,1
s_cmp_eq_u32 s33,0
s_cselect_b32 s61,13,0
s_add_u32 s34,s34,s61
s_sub_u32 s61,s60,51
s_cmp_ge_u32 s60,102
s_cselect_b32 s34,s61,s34
s_cselect_b32 s33,1,s33
s_cmp_lt_u32 s62,13
s_cselect_b32 s34,s62,s34
s_cselect_b32 s33,0,s33
s_add_u32 s60,s34,1
s_min_u32 s60,s60,63
s_lshl_b32 s35,s33,6
s_add_u32 s35,s35,s60
s_lshl_b32 s35,s35,9
s_add_u32 s35,s35,323584
s_cmp_lt_u32 s60,8
s_cselect_b64 s[76:77],s[78:79],-1
s_sub_u32 s57,40960,s57
v_swap_b32 v16,v18
v_swap_b32 v17,v19
s_add_u32 s62,s32,1
s_min_u32 s62,s62,127
s_sub_u32 s60,s62,13
s_lshr_b32 s41,s60,1
s_and_b32 s40,s60,1
s_cmp_eq_u32 s40,0
s_cselect_b32 s61,13,0
s_add_u32 s41,s41,s61
s_sub_u32 s61,s60,51
s_cmp_ge_u32 s60,102
s_cselect_b32 s41,s61,s41
s_cselect_b32 s40,1,s40
s_cmp_lt_u32 s62,13
s_cselect_b32 s41,s62,s41
s_cselect_b32 s40,0,s40
s_add_u32 s60,s41,1
s_min_u32 s60,s60,63
s_lshl_b32 s42,s40,6
s_add_u32 s42,s42,s60
s_lshl_b32 s42,s42,9
s_add_u32 s42,s42,323584
s_cmp_lt_u32 s60,8
s_cselect_b64 s[80:81],s[78:79],-1
W2_COLD:
s_mov_b32 s37,0
fb_341:
buffer_load_dword v3,v2,s[8:11],s35 offen sc1
s_waitcnt vmcnt(0)
v_cmp_eq_u32 vcc,0,v3
s_and_b64 vcc,vcc,s[76:77]
s_cbranch_scc0 ok_342
s_sleep 2
s_sub_u32 s47,s47,1
s_cbranch_scc1 ABORT
s_branch fb_341
ok_342:
W2_COLD2:
s_sub_u32 s66,40960,s57
s_add_u32 s61,s34,s68
s_and_b32 s62,s61,7
s_cmp_lt_u32 s61,64
s_cselect_b32 s62,s62,8
s_mul_i32 s62,s62,40960
s_and_b32 s61,s34,7
s_mul_i32 s61,s61,40960
v_mad_u32_u24 v112,v76,s62,v74
v_mad_u32_u24 v112,v78,s61,v112
v_mad_u32_u24 v113,v77,s62,v75
v_mad_u32_u24 v113,v79,s61,v113
s_mov_b32 s60,s33
s_mul_i32 s60,s60,368640
s_add_u32 s60,s60,s37
s_mul_i32 s61,s46,10240
s_add_u32 s60,s60,s61
s_add_u32 s60,s60,237371392
s_add_u32 s61,s61,s66
s_add_u32 m0,s61,0
s_add_u32 s63,s60,0
buffer_load_dwordx4 v112,s[8:11],s63 offen sc1 lds
s_add_u32 m0,s61,1024
s_nop 0
buffer_load_dwordx4 v113,s[8:11],s63 offen sc1 lds
s_add_u32 m0,s61,2048
s_add_u32 s63,s60,2048
buffer_load_dwordx4 v112,s[8:11],s63 offen sc1 lds
s_add_u32 m0,s61,3072
s_nop 0
buffer_load_dwordx4 v113,s[8:11],s63 offen sc1 lds
s_add_u32 m0,s61,4096
s_add_u32 s63,s60,4096
buffer_load_dwordx4 v112,s[8:11],s63 offen sc1 lds
s_add_u32 m0,s61,5120
s_nop 0
buffer_load_dwordx4 v113,s[8:11],s63 offen sc1 lds
s_waitcnt vmcnt(5)
s_mov_b64 exec,1
s_cmp_lg_u32 s49,0
s_cbranch_scc0 ls_343
buffer_store_dword v5,v1,s[8:11],s59 offen sc1
s_branch ls_344
ls_343:
buffer_store_dword v5,v1,s[8:11],s59 offen
ls_344:
s_mov_b64 exec,-1
s_mov_b32 s59,2147483648
s_add_u32 m0,s61,6144
s_add_u32 s63,s60,6144
buffer_load_dwordx4 v112,s[8:11],s63 offen sc1 lds
s_add_u32 m0,s61,7168
s_nop 0
buffer_load_dwordx4 v113,s[8:11],s63 offen sc1 lds
s_add_u32 m0,s61,8192
s_add_u32 s63,s60,8192
buffer_load_dwordx4 v112,s[8:11],s63 offen sc1 lds
s_add_u32 m0,s61,9216
s_nop 0
buffer_load_dwordx4 v113,s[8:11],s63 offen sc1 lds
s_mov_b32 s35,s42
s_mov_b32 s53,s33
s_mov_b32 s54,s34
s_add_u32 s32,s32,1
s_mov_b32 s33,s40
s_mov_b32 s34,s41
s_mov_b64 s[76:77],s[80:81]
s_sub_u32 s57,40960,s57
v_swap_b32 v16,v18
v_swap_b32 v17,v19
s_mov_b32 s51,s53
s_mov_b32 s52,s54
s_waitcnt vmcnt(5)
s_branch W2_GO
W2_NEXT:
s_sub_u32 s57,40960,s57
v_swap_b32 v16,v18
v_swap_b32 v17,v19
s_mov_b32 s51,s53
s_mov_b32 s52,s54
s_waitcnt vmcnt(3)
W2_GO:
s_barrier
ds_read_b128 v[24:27],v16 offset:0
ds_read_b128 v[28:31],v17 offset:0
ds_read_b128 v[32:35],v16 offset:10240
ds_read_b128 v[36:39],v17 offset:10240
ds_read_b128 v[40:43],v16 offset:20480
ds_read_b128 v[44:47],v17 offset:20480
ds_read_b128 v[48:51],v16 offset:30720
buffer_load_dword v3,v2,s[8:11],s35 offen sc1
s_waitcnt lgkmcnt(6)
v_mfma_f32_32x32x16_bf16 v[56:71],a[0:3],v[24:27],0
ds_read_b128 v[52:55],v17 offset:30720
s_lshl_b32 s60,s51,6
s_add_u32 s60,s60,s52
s_mul_i32 s60,s60,46080
s_waitcnt lgkmcnt(6)
v_mfma_f32_32x32x16_bf16 v[56:71],a[4:7],v[28:31],v[56:71]
ds_read_b128 v[24:27],v16 offset:2048
s_lshl_b32 s61,s56,11
s_add_u32 s60,s60,s61
s_add_u32 s60,s60,223608832
s_waitcnt lgkmcnt(5)
v_mfma_f32_32x32x16_bf16 v[56:71],a[40:43],v[32:35],v[56:71]
ds_read_b128 v[28:31],v17 offset:2048
buffer_load_dwordx4 v[120:123],v116,s[8:11],s60 offen sc1
buffer_load_dwordx4 v[124:127],v117,s[8:11],s60 offen sc1
v_mfma_f32_32x32x16_bf16 v[56:71],a[44:47],v[36:39],v[56:71]
ds_read_b128 v[32:35],v16 offset:12288
s_add_u32 s62,s32,1
s_min_u32 s62,s62,127
s_sub_u32 s60,s62,13
s_waitcnt lgkmcnt(5)
v_mfma_f32_32x32x16_bf16 v[56:71],a[80:83],v[40:43],v[56:71]
ds_read_b128 v[36:39],v17 offset:12288
s_lshr_b32 s41,s60,1
s_and_b32 s40,s60,1
s_cmp_eq_u32 s40,0
s_cselect_b32 s61,13,0
v_mfma_f32_32x32x16_bf16 v[56:71],a[84:87],v[44:47],v[56:71]
ds_read_b128 v[40:43],v16 offset:22528
s_add_u32 s41,s41,s61
s_sub_u32 s61,s60,51
s_mul_i32 s71,s51,8
s_waitcnt lgkmcnt(5)
v_mfma_f32_32x32x16_bf16 v[56:71],a[120:123],v[48:51],v[56:71]
ds_read_b128 v[44:47],v17 offset:22528
s_cmp_ge_u32 s60,102
s_cselect_b32 s41,s61,s41
s_cselect_b32 s40,1,s40
s_and_b32 s72,s52,7
v_mfma_f32_32x32x16_bf16 v[56:71],a[124:127],v[52:55],v[56:71]
ds_read_b128 v[48:51],v16 offset:32768
s_cmp_lt_u32 s62,13
s_cselect_b32 s41,s62,s41
s_cselect_b32 s40,0,s40
s_waitcnt lgkmcnt(5)
v_mfma_f32_32x32x16_bf16 v[56:71],a[8:11],v[24:27],v[56:71]
ds_read_b128 v[52:55],v17 offset:32768
s_add_u32 s60,s41,1
s_min_u32 s60,s60,63
s_lshl_b32 s42,s40,6
s_add_u32 s42,s42,s60
v_mfma_f32_32x32x16_bf16 v[56:71],a[12:15],v[28:31],v[56:71]
ds_read_b128 v[24:27],v16 offset:4096
s_lshl_b32 s42,s42,9
s_add_u32 s42,s42,323584
s_add_u32 s71,s71,s72
s_waitcnt lgkmcnt(5)
v_mfma_f32_32x32x16_bf16 v[56:71],a[48:51],v[32:35],v[56:71]
ds_read_b128 v[28:31],v17 offset:4096
s_cmp_lt_u32 s60,8
s_cselect_b64 s[80:81],s[78:79],-1
s_mul_i32 s71,s71,46080
s_add_u32 s71,s71,212467712
v_mfma_f32_32x32x16_bf16 v[56:71],a[52:55],v[36:39],v[56:71]
ds_read_b128 v[32:35],v16 offset:14336
s_lshl_b32 s72,s56,8
s_add_u32 s72,s72,s71
s_add_u32 s72,s72,40960
s_waitcnt lgkmcnt(5)
v_mfma_f32_32x32x16_bf16 v[56:71],a[88:91],v[40:43],v[56:71]
ds_read_b128 v[36:39],v17 offset:14336
s_waitcnt vmcnt(2)
s_mov_b64 exec,1
s_cmp_lg_u32 s49,0
s_cbranch_scc0 ls_345
buffer_store_dword v5,v1,s[8:11],s59 offen sc1
s_branch ls_346
ls_345:
buffer_store_dword v5,v1,s[8:11],s59 offen
ls_346:
s_mov_b64 exec,-1
s_mov_b32 s59,2147483648
v_mfma_f32_32x32x16_bf16 v[56:71],a[92:95],v[44:47],v[56:71]
ds_read_b128 v[40:43],v16 offset:24576
v_cmp_eq_u32 vcc,0,v3
s_and_b64 vcc,vcc,s[76:77]
s_cselect_b32 s37,2147483648,0
s_waitcnt lgkmcnt(5)
v_mfma_f32_32x32x16_bf16 v[56:71],a[128:131],v[48:51],v[56:71]
ds_read_b128 v[44:47],v17 offset:24576
s_cmp_lt_u32 s32,128
s_cselect_b32 s37,s37,2147483648
s_sub_u32 s66,40960,s57
s_add_u32 s61,s34,s68
v_mfma_f32_32x32x16_bf16 v[56:71],a[132:135],v[52:55],v[56:71]
ds_read_b128 v[48:51],v16 offset:34816
s_and_b32 s62,s61,7
s_cmp_lt_u32 s61,64
s_cselect_b32 s62,s62,8
s_waitcnt lgkmcnt(5)
v_mfma_f32_32x32x16_bf16 v[56:71],a[16:19],v[24:27],v[56:71]
ds_read_b128 v[52:55],v17 offset:34816
s_mul_i32 s62,s62,40960
s_and_b32 s61,s34,7
s_mul_i32 s61,s61,40960
v_mad_u32_u24 v112,v76,s62,v74
s_barrier
v_mfma_f32_32x32x16_bf16 v[56:71],a[20:23],v[28:31],v[56:71]
ds_read_b128 v[24:27],v16 offset:6144
v_mad_u32_u24 v112,v78,s61,v112
v_mad_u32_u24 v113,v77,s62,v75
v_mad_u32_u24 v113,v79,s61,v113
s_waitcnt lgkmcnt(5)
v_mfma_f32_32x32x16_bf16 v[56:71],a[56:59],v[32:35],v[56:71]
ds_read_b128 v[28:31],v17 offset:6144
s_mov_b32 s60,s33
s_mul_i32 s60,s60,368640
s_add_u32 s60,s60,s37
s_mul_i32 s61,s46,10240
v_mfma_f32_32x32x16_bf16 v[56:71],a[60:63],v[36:39],v[56:71]
ds_read_b128 v[32:35],v16 offset:16384
s_add_u32 s60,s60,s61
s_add_u32 s60,s60,237371392
s_add_u32 s61,s61,s66
s_waitcnt lgkmcnt(5)
v_mfma_f32_32x32x16_bf16 v[56:71],a[96:99],v[40:43],v[56:71]
ds_read_b128 v[36:39],v17 offset:16384
s_add_u32 m0,s61,0
s_add_u32 s63,s60,0
buffer_load_dwordx4 v112,s[8:11],s63 offen sc1 lds
v_mfma_f32_32x32x16_bf16 v[56:71],a[100:103],v[44:47],v[56:71]
ds_read_b128 v[40:43],v16 offset:26624
s_add_u32 m0,s61,1024
s_lshl_b32 s73,s56,11
s_add_u32 s71,s71,s73
s_waitcnt lgkmcnt(5)
v_mfma_f32_32x32x16_bf16 v[56:71],a[136:139],v[48:51],v[56:71]
ds_read_b128 v[44:47],v17 offset:26624
buffer_load_dwordx4 v113,s[8:11],s63 offen sc1 lds
s_add_u32 m0,s61,2048
s_add_u32 s63,s60,2048
v_mfma_f32_32x32x16_bf16 v[56:71],a[140:143],v[52:55],v[56:71]
ds_read_b128 v[48:51],v16 offset:36864
s_lshl_b32 s82,s51,6
s_add_u32 s82,s82,s52
s_lshl_b32 s82,s82,9
s_waitcnt lgkmcnt(5)
v_mfma_f32_32x32x16_bf16 v[56:71],a[24:27],v[24:27],v[56:71]
ds_read_b128 v[52:55],v17 offset:36864
buffer_load_dwordx4 v112,s[8:11],s63 offen sc1 lds
s_add_u32 m0,s61,3072
s_add_u32 s82,s82,524288
v_mfma_f32_32x32x16_bf16 v[56:71],a[28:31],v[28:31],v[56:71]
ds_read_b128 v[24:27],v16 offset:8192
s_lshl_b32 s70,s56,2
s_add_u32 s82,s82,s70
s_waitcnt lgkmcnt(5)
v_mfma_f32_32x32x16_bf16 v[56:71],a[64:67],v[32:35],v[56:71]
ds_read_b128 v[28:31],v17 offset:8192
buffer_load_dwordx4 v113,s[8:11],s63 offen sc1 lds
s_add_u32 m0,s61,4096
s_add_u32 s63,s60,4096
v_mfma_f32_32x32x16_bf16 v[56:71],a[68:71],v[36:39],v[56:71]
ds_read_b128 v[32:35],v16 offset:18432
s_waitcnt lgkmcnt(5)
v_mfma_f32_32x32x16_bf16 v[56:71],a[104:107],v[40:43],v[56:71]
ds_read_b128 v[36:39],v17 offset:18432
buffer_load_dwordx4 v112,s[8:11],s63 offen sc1 lds
s_add_u32 m0,s61,5120
v_mfma_f32_32x32x16_bf16 v[56:71],a[108:111],v[44:47],v[56:71]
ds_read_b128 v[40:43],v16 offset:28672
s_waitcnt lgkmcnt(5)
v_mfma_f32_32x32x16_bf16 v[56:71],a[144:147],v[48:51],v[56:71]
ds_read_b128 v[44:47],v17 offset:28672
buffer_load_dword v3,v2,s[8:11],s35 offen sc1
v_mfma_f32_32x32x16_bf16 v[56:71],a[148:151],v[52:55],v[56:71]
ds_read_b128 v[48:51],v16 offset:38912
buffer_load_dwordx4 v113,s[8:11],s63 offen sc1 lds
s_add_u32 m0,s61,6144
s_waitcnt lgkmcnt(5)
v_mfma_f32_32x32x16_bf16 v[56:71],a[32:35],v[24:27],v[56:71]
ds_read_b128 v[52:55],v17 offset:38912
s_add_u32 s63,s60,6144
v_mfma_f32_32x32x16_bf16 v[56:71],a[36:39],v[28:31],v[56:71]
buffer_load_dwordx4 v112,s[8:11],s63 offen sc1 lds
s_add_u32 m0,s61,7168
s_waitcnt lgkmcnt(4)
v_mfma_f32_32x32x16_bf16 v[56:71],a[72:75],v[32:35],v[56:71]
v_mfma_f32_32x32x16_bf16 v[56:71],a[76:79],v[36:39],v[56:71]
buffer_load_dwordx4 v113,s[8:11],s63 offen sc1 lds
s_add_u32 m0,s61,8192
s_add_u32 s63,s60,8192
s_waitcnt lgkmcnt(2)
v_mfma_f32_32x32x16_bf16 v[56:71],a[112:115],v[40:43],v[56:71]
v_mfma_f32_32x32x16_bf16 v[56:71],a[116:119],v[44:47],v[56:71]
buffer_load_dwordx4 v112,s[8:11],s63 offen sc1 lds
s_add_u32 m0,s61,9216
s_waitcnt lgkmcnt(0)
v_mfma_f32_32x32x16_bf16 v[56:71],a[152:155],v[48:51],v[56:71]
v_mfma_f32_32x32x16_bf16 v[56:71],a[156:159],v[52:55],v[56:71]
buffer_load_dwordx4 v113,s[8:11],s63 offen sc1 lds
s_waitcnt vmcnt(12)
v_lshlrev_b32 v128,16,v120
v_and_b32 v129,0xffff0000,v120
v_lshlrev_b32 v130,16,v121
v_and_b32 v131,0xffff0000,v121
v_lshlrev_b32 v132,16,v122
v_and_b32 v133,0xffff0000,v122
v_lshlrev_b32 v134,16,v123
v_and_b32 v135,0xffff0000,v123
v_lshlrev_b32 v136,16,v124
v_and_b32 v137,0xffff0000,v124
v_lshlrev_b32 v138,16,v125
v_and_b32 v139,0xffff0000,v125
v_lshlrev_b32 v140,16,v126
v_and_b32 v141,0xffff0000,v126
v_lshlrev_b32 v142,16,v127
v_and_b32 v143,0xffff0000,v127
s_cmp_eq_u32 s37,0
s_cbranch_scc0 sec_349
s_mov_b32 s35,s42
s_mov_b32 s53,s33
s_mov_b32 s54,s34
s_add_u32 s32,s32,1
s_mov_b32 s33,s40
s_mov_b32 s34,s41
s_mov_b64 s[76:77],s[80:81]
s_nop 2
ep_347:
v_cvt_pk_bf16_f32 v6,v56,v57
v_lshlrev_b32 v56,16,v6
v_and_b32 v57,0xffff0000,v6
v_cvt_pk_bf16_f32 v6,v58,v59
v_lshlrev_b32 v58,16,v6
v_and_b32 v59,0xffff0000,v6
v_cvt_pk_bf16_f32 v6,v60,v61
v_lshlrev_b32 v60,16,v6
v_and_b32 v61,0xffff0000,v6
v_cvt_pk_bf16_f32 v6,v62,v63
v_lshlrev_b32 v62,16,v6
v_and_b32 v63,0xffff0000,v6
v_cvt_pk_bf16_f32 v6,v64,v65
v_lshlrev_b32 v64,16,v6
v_and_b32 v65,0xffff0000,v6
v_cvt_pk_bf16_f32 v6,v66,v67
v_lshlrev_b32 v66,16,v6
v_and_b32 v67,0xffff0000,v6
v_cvt_pk_bf16_f32 v6,v68,v69
v_lshlrev_b32 v68,16,v6
v_and_b32 v69,0xffff0000,v6
v_cvt_pk_bf16_f32 v6,v70,v71
v_lshlrev_b32 v70,16,v6
v_and_b32 v71,0xffff0000,v6
v_pk_add_f32 v[56:57],v[56:57],v[128:129]
v_pk_add_f32 v[58:59],v[58:59],v[130:131]
v_pk_add_f32 v[60:61],v[60:61],v[132:133]
v_pk_add_f32 v[62:63],v[62:63],v[134:135]
v_pk_add_f32 v[64:65],v[64:65],v[136:137]
v_pk_add_f32 v[66:67],v[66:67],v[138:139]
v_pk_add_f32 v[68:69],v[68:69],v[140:141]
v_pk_add_f32 v[70:71],v[70:71],v[142:143]
v_cvt_pk_bf16_f32 v144,v56,v57
v_lshlrev_b32 v56,16,v144
v_and_b32 v57,0xffff0000,v144
v_cvt_pk_bf16_f32 v145,v58,v59
v_lshlrev_b32 v58,16,v145
v_and_b32 v59,0xffff0000,v145
v_cvt_pk_bf16_f32 v146,v60,v61
v_lshlrev_b32 v60,16,v146
v_and_b32 v61,0xffff0000,v146
v_cvt_pk_bf16_f32 v147,v62,v63
v_lshlrev_b32 v62,16,v147
v_and_b32 v63,0xffff0000,v147
v_cvt_pk_bf16_f32 v148,v64,v65
v_lshlrev_b32 v64,16,v148
v_and_b32 v65,0xffff0000,v148
v_cvt_pk_bf16_f32 v149,v66,v67
v_lshlrev_b32 v66,16,v149
v_and_b32 v67,0xffff0000,v149
v_cvt_pk_bf16_f32 v150,v68,v69
v_lshlrev_b32 v68,16,v150
v_and_b32 v69,0xffff0000,v150
v_cvt_pk_bf16_f32 v151,v70,v71
v_lshlrev_b32 v70,16,v151
v_and_b32 v71,0xffff0000,v151
s_cmp_lg_u32 s49,0
s_cbranch_scc0 ls_350
buffer_store_dwordx4 v[144:147],v20,s[8:11],s71 offen sc1
buffer_store_dwordx4 v[148:151],v21,s[8:11],s71 offen sc1
s_branch ls_351
ls_350:
buffer_store_dwordx4 v[144:147],v20,s[8:11],s71 offen
buffer_store_dwordx4 v[148:151],v21,s[8:11],s71 offen
ls_351:
v_pk_add_f32 v[6:7],v[56:57],v[58:59]
v_pk_mul_f32 v[8:9],v[56:57],v[56:57]
v_pk_fma_f32 v[8:9],v[58:59],v[58:59],v[8:9]
v_pk_add_f32 v[6:7],v[6:7],v[60:61]
v_pk_fma_f32 v[8:9],v[60:61],v[60:61],v[8:9]
v_pk_add_f32 v[6:7],v[6:7],v[62:63]
v_pk_fma_f32 v[8:9],v[62:63],v[62:63],v[8:9]
v_pk_add_f32 v[6:7],v[6:7],v[64:65]
v_pk_fma_f32 v[8:9],v[64:65],v[64:65],v[8:9]
v_pk_add_f32 v[6:7],v[6:7],v[66:67]
v_pk_fma_f32 v[8:9],v[66:67],v[66:67],v[8:9]
v_pk_add_f32 v[6:7],v[6:7],v[68:69]
v_pk_fma_f32 v[8:9],v[68:69],v[68:69],v[8:9]
v_pk_add_f32 v[6:7],v[6:7],v[70:71]
v_pk_fma_f32 v[8:9],v[70:71],v[70:71],v[8:9]
v_add_f32 v6,v6,v7
v_add_f32 v7,v8,v9
v_mov_b32 v8,v6
v_mov_b32 v9,v7
s_nop 0
v_permlane32_swap_b32 v6,v8
v_permlane32_swap_b32 v7,v9
v_pk_add_f32 v[6:7],v[6:7],v[8:9]
s_mov_b32 exec_hi,0
s_cmp_lg_u32 s49,0
s_cbranch_scc0 ls_352
buffer_store_dwordx2 v[6:7],v114,s[8:11],s72 offen sc1
s_branch ls_353
ls_352:
buffer_store_dwordx2 v[6:7],v114,s[8:11],s72 offen
ls_353:
s_mov_b32 exec_hi,-1
s_mov_b32 s59,s82
s_cmp_eq_u32 s37,0
s_cbranch_scc1 W2_NEXT
s_waitcnt vmcnt(3)
v_cmp_eq_u32 vcc,0,v3
s_and_b64 vcc,vcc,s[76:77]
s_cselect_b32 s37,2147483648,0
s_cmp_lt_u32 s32,128
s_cselect_b32 s37,s37,2147483648
s_cmp_eq_u32 s37,0
s_cbranch_scc1 W2_COLD2
s_waitcnt vmcnt(0)
s_mov_b64 exec,1
s_cmp_lg_u32 s49,0
s_cbranch_scc0 ls_354
buffer_store_dword v5,v1,s[8:11],s59 offen sc1
s_branch ls_355
ls_354:
buffer_store_dword v5,v1,s[8:11],s59 offen
ls_355:
s_mov_b64 exec,-1
s_mov_b32 s59,2147483648
s_cmp_lt_u32 s32,128
s_cbranch_scc1 W2_COLD
s_branch W2_END
sec_349:
s_waitcnt vmcnt(5)
v_cmp_eq_u32 vcc,0,v3
s_and_b64 vcc,vcc,s[76:77]
s_cselect_b32 s37,2147483648,0
s_cmp_lt_u32 s32,128
s_cselect_b32 s37,s37,2147483648
s_cmp_lg_u32 s37,0
s_cbranch_scc1 nr_348
s_sub_u32 s66,40960,s57
s_add_u32 s61,s34,s68
s_and_b32 s62,s61,7
s_cmp_lt_u32 s61,64
s_cselect_b32 s62,s62,8
s_mul_i32 s62,s62,40960
s_and_b32 s61,s34,7
s_mul_i32 s61,s61,40960
v_mad_u32_u24 v112,v76,s62,v74
v_mad_u32_u24 v112,v78,s61,v112
v_mad_u32_u24 v113,v77,s62,v75
v_mad_u32_u24 v113,v79,s61,v113
s_mov_b32 s60,s33
s_mul_i32 s60,s60,368640
s_add_u32 s60,s60,s37
s_mul_i32 s61,s46,10240
s_add_u32 s60,s60,s61
s_add_u32 s60,s60,237371392
s_add_u32 s61,s61,s66
s_add_u32 m0,s61,0
s_add_u32 s63,s60,0
buffer_load_dwordx4 v112,s[8:11],s63 offen sc1 lds
v_cvt_pk_bf16_f32 v6,v56,v57
v_lshlrev_b32 v56,16,v6
v_and_b32 v57,0xffff0000,v6
v_cvt_pk_bf16_f32 v6,v58,v59
s_add_u32 m0,s61,1024
s_nop 0
buffer_load_dwordx4 v113,s[8:11],s63 offen sc1 lds
v_lshlrev_b32 v58,16,v6
v_and_b32 v59,0xffff0000,v6
v_cvt_pk_bf16_f32 v6,v60,v61
v_lshlrev_b32 v60,16,v6
s_add_u32 m0,s61,2048
s_add_u32 s63,s60,2048
buffer_load_dwordx4 v112,s[8:11],s63 offen sc1 lds
v_and_b32 v61,0xffff0000,v6
v_cvt_pk_bf16_f32 v6,v62,v63
v_lshlrev_b32 v62,16,v6
v_and_b32 v63,0xffff0000,v6
s_add_u32 m0,s61,3072
s_nop 0
buffer_load_dwordx4 v113,s[8:11],s63 offen sc1 lds
v_cvt_pk_bf16_f32 v6,v64,v65
v_lshlrev_b32 v64,16,v6
v_and_b32 v65,0xffff0000,v6
v_cvt_pk_bf16_f32 v6,v66,v67
s_add_u32 m0,s61,4096
s_add_u32 s63,s60,4096
buffer_load_dwordx4 v112,s[8:11],s63 offen sc1 lds
v_lshlrev_b32 v66,16,v6
v_and_b32 v67,0xffff0000,v6
v_cvt_pk_bf16_f32 v6,v68,v69
v_lshlrev_b32 v68,16,v6
s_add_u32 m0,s61,5120
s_nop 0
buffer_load_dwordx4 v113,s[8:11],s63 offen sc1 lds
v_and_b32 v69,0xffff0000,v6
v_cvt_pk_bf16_f32 v6,v70,v71
v_lshlrev_b32 v70,16,v6
v_and_b32 v71,0xffff0000,v6
s_add_u32 m0,s61,6144
s_add_u32 s63,s60,6144
buffer_load_dwordx4 v112,s[8:11],s63 offen sc1 lds
v_pk_add_f32 v[56:57],v[56:57],v[128:129]
v_pk_add_f32 v[58:59],v[58:59],v[130:131]
v_pk_add_f32 v[60:61],v[60:61],v[132:133]
v_pk_add_f32 v[62:63],v[62:63],v[134:135]
s_add_u32 m0,s61,7168
s_nop 0
buffer_load_dwordx4 v113,s[8:11],s63 offen sc1 lds
v_pk_add_f32 v[64:65],v[64:65],v[136:137]
v_pk_add_f32 v[66:67],v[66:67],v[138:139]
v_pk_add_f32 v[68:69],v[68:69],v[140:141]
v_pk_add_f32 v[70:71],v[70:71],v[142:143]
s_add_u32 m0,s61,8192
s_add_u32 s63,s60,8192
buffer_load_dwordx4 v112,s[8:11],s63 offen sc1 lds
v_cvt_pk_bf16_f32 v144,v56,v57
v_lshlrev_b32 v56,16,v144
v_and_b32 v57,0xffff0000,v144
v_cvt_pk_bf16_f32 v145,v58,v59
s_add_u32 m0,s61,9216
s_nop 0
buffer_load_dwordx4 v113,s[8:11],s63 offen sc1 lds
v_lshlrev_b32 v58,16,v145
v_and_b32 v59,0xffff0000,v145
v_cvt_pk_bf16_f32 v146,v60,v61
v_lshlrev_b32 v60,16,v146
s_mov_b32 s35,s42
s_mov_b32 s53,s33
s_mov_b32 s54,s34
s_add_u32 s32,s32,1
s_mov_b32 s33,s40
s_mov_b32 s34,s41
s_mov_b64 s[76:77],s[80:81]
v_and_b32 v61,0xffff0000,v146
v_cvt_pk_bf16_f32 v147,v62,v63
v_lshlrev_b32 v62,16,v147
v_and_b32 v63,0xffff0000,v147
v_cvt_pk_bf16_f32 v148,v64,v65
v_lshlrev_b32 v64,16,v148
v_and_b32 v65,0xffff0000,v148
v_cvt_pk_bf16_f32 v149,v66,v67
v_lshlrev_b32 v66,16,v149
v_and_b32 v67,0xffff0000,v149
v_cvt_pk_bf16_f32 v150,v68,v69
v_lshlrev_b32 v68,16,v150
v_and_b32 v69,0xffff0000,v150
v_cvt_pk_bf16_f32 v151,v70,v71
v_lshlrev_b32 v70,16,v151
v_and_b32 v71,0xffff0000,v151
s_cmp_lg_u32 s49,0
s_cbranch_scc0 ls_356
buffer_store_dwordx4 v[144:147],v20,s[8:11],s71 offen sc1
buffer_store_dwordx4 v[148:151],v21,s[8:11],s71 offen sc1
s_branch ls_357
ls_356:
buffer_store_dwordx4 v[144:147],v20,s[8:11],s71 offen
buffer_store_dwordx4 v[148:151],v21,s[8:11],s71 offen
ls_357:
v_pk_add_f32 v[6:7],v[56:57],v[58:59]
v_pk_mul_f32 v[8:9],v[56:57],v[56:57]
v_pk_fma_f32 v[8:9],v[58:59],v[58:59],v[8:9]
v_pk_add_f32 v[6:7],v[6:7],v[60:61]
v_pk_fma_f32 v[8:9],v[60:61],v[60:61],v[8:9]
v_pk_add_f32 v[6:7],v[6:7],v[62:63]
v_pk_fma_f32 v[8:9],v[62:63],v[62:63],v[8:9]
v_pk_add_f32 v[6:7],v[6:7],v[64:65]
v_pk_fma_f32 v[8:9],v[64:65],v[64:65],v[8:9]
v_pk_add_f32 v[6:7],v[6:7],v[66:67]
v_pk_fma_f32 v[8:9],v[66:67],v[66:67],v[8:9]
v_pk_add_f32 v[6:7],v[6:7],v[68:69]
v_pk_fma_f32 v[8:9],v[68:69],v[68:69],v[8:9]
v_pk_add_f32 v[6:7],v[6:7],v[70:71]
v_pk_fma_f32 v[8:9],v[70:71],v[70:71],v[8:9]
v_add_f32 v6,v6,v7
v_add_f32 v7,v8,v9
v_mov_b32 v8,v6
v_mov_b32 v9,v7
s_nop 0
v_permlane32_swap_b32 v6,v8
v_permlane32_swap_b32 v7,v9
v_pk_add_f32 v[6:7],v[6:7],v[8:9]
s_mov_b32 exec_hi,0
s_cmp_lg_u32 s49,0
s_cbranch_scc0 ls_358
buffer_store_dwordx2 v[6:7],v114,s[8:11],s72 offen sc1
s_branch ls_359
ls_358:
buffer_store_dwordx2 v[6:7],v114,s[8:11],s72 offen
ls_359:
s_mov_b32 exec_hi,-1
s_mov_b32 s59,s82
s_branch W2_NEXT
nr_348:
buffer_load_dword v3,v2,s[8:11],s35 offen sc1
s_branch ep_347
W2_END:
s_endpgm
ROLE_W3:
v_lshlrev_b32 v1,4,v0
v_mov_b32 v5,1
s_lshl_b32 s56,s48,2
s_add_u32 s56,s56,s46
v_bfe_u32 v6,v0,2,2
v_lshrrev_b32 v7,4,v0
v_add_u32 v7,v6,v7
v_and_b32 v7,3,v7
v_and_b32 v15,3,v0
v_lshlrev_b32 v15,4,v15
v_lshl_add_u32 v15,v7,6,v15
v_lshl_add_u32 v15,v6,8,v15
v_lshrrev_b32 v6,5,v0
v_bfe_u32 v7,v0,4,1
v_lshlrev_b32 v16,10,v7
v_lshl_add_u32 v16,v6,8,v16
v_and_b32 v6,15,v0
v_lshl_add_u32 v16,v6,4,v16
v_add_u32 v18,46080,v16
v_lshrrev_b32 v6,5,v0
v_bfe_u32 v7,v0,4,1
v_lshlrev_b32 v20,10,v7
v_lshl_add_u32 v20,v6,8,v20
v_and_b32 v6,15,v0
v_lshl_add_u32 v20,v6,4,v20
v_lshrrev_b32 v6,5,v0
v_add_u32 v6,2,v6
v_bfe_u32 v7,v0,4,1
v_lshlrev_b32 v17,10,v7
v_lshl_add_u32 v17,v6,8,v17
v_and_b32 v6,15,v0
v_lshl_add_u32 v17,v6,4,v17
v_add_u32 v19,46080,v17
v_lshrrev_b32 v6,5,v0
v_add_u32 v6,2,v6
v_bfe_u32 v7,v0,4,1
v_lshlrev_b32 v21,10,v7
v_lshl_add_u32 v21,v6,8,v21
v_and_b32 v6,15,v0
v_lshl_add_u32 v21,v6,4,v21
v_min_u32 v2,19,v0
v_lshlrev_b32 v2,2,v2
v_mov_b32 v112,0xc0135761
v_mov_b32 v113,0xbdd2d3e8
s_mov_b32 s68,0xbdd2d3e8
v_lshrrev_b32 v6,5,v0
v_mul_u32_u24 v182,2560,v6
v_and_b32 v6,31,v0
v_lshl_add_u32 v182,v6,3,v182
v_add_u32 v182,0xa000,v182
s_waitcnt vmcnt(0)
s_barrier
s_cmp_lg_u32 s46,0
s_cbranch_scc1 arr_360
v_mov_b32 v6,1
s_lshl_b32 s3,s49,2
v_mov_b32 v7,s3
s_mov_b64 exec,1
buffer_atomic_add v6,v7,s[12:15],0 offen sc1
s_mov_b64 exec,-1
arr_360:
s_lshl_b32 s58,s56,6
s_mul_i32 s63,s46,40960
s_mov_b32 s4,s36
s_mov_b32 s5,s37
s_mov_b32 s6,1966080
s_mov_b32 s7,0x20000
v_lshrrev_b32 v9,2,v0
s_mov_b32 s64,3072
v_mul_lo_u32 v9,v9,s64
v_and_b32 v10,3,v0
v_lshl_add_u32 v6,v10,4,v9
s_add_u32 m0,s63,0
s_add_u32 s65,s58,0
buffer_load_dwordx4 v6,s[4:7],s65 offen lds
s_add_u32 m0,s63,1024
s_add_u32 s65,s58,49152
buffer_load_dwordx4 v6,s[4:7],s65 offen lds
s_add_u32 m0,s63,2048
s_add_u32 s65,s58,98304
buffer_load_dwordx4 v6,s[4:7],s65 offen lds
s_add_u32 m0,s63,3072
s_add_u32 s65,s58,147456
buffer_load_dwordx4 v6,s[4:7],s65 offen lds
s_add_u32 m0,s63,4096
s_add_u32 s65,s58,196608
buffer_load_dwordx4 v6,s[4:7],s65 offen lds
s_add_u32 m0,s63,5120
s_add_u32 s65,s58,245760
buffer_load_dwordx4 v6,s[4:7],s65 offen lds
s_add_u32 m0,s63,6144
s_add_u32 s65,s58,294912
buffer_load_dwordx4 v6,s[4:7],s65 offen lds
s_add_u32 m0,s63,7168
s_add_u32 s65,s58,344064
buffer_load_dwordx4 v6,s[4:7],s65 offen lds
s_add_u32 m0,s63,8192
s_add_u32 s65,s58,393216
buffer_load_dwordx4 v6,s[4:7],s65 offen lds
s_add_u32 m0,s63,9216
s_add_u32 s65,s58,442368
buffer_load_dwordx4 v6,s[4:7],s65 offen lds
s_add_u32 m0,s63,10240
s_add_u32 s65,s58,491520
buffer_load_dwordx4 v6,s[4:7],s65 offen lds
s_add_u32 m0,s63,11264
s_add_u32 s65,s58,540672
buffer_load_dwordx4 v6,s[4:7],s65 offen lds
s_add_u32 m0,s63,12288
s_add_u32 s65,s58,589824
buffer_load_dwordx4 v6,s[4:7],s65 offen lds
s_add_u32 m0,s63,13312
s_add_u32 s65,s58,638976
buffer_load_dwordx4 v6,s[4:7],s65 offen lds
s_add_u32 m0,s63,14336
s_add_u32 s65,s58,688128
buffer_load_dwordx4 v6,s[4:7],s65 offen lds
s_add_u32 m0,s63,15360
s_add_u32 s65,s58,737280
buffer_load_dwordx4 v6,s[4:7],s65 offen lds
s_add_u32 m0,s63,16384
s_add_u32 s65,s58,786432
buffer_load_dwordx4 v6,s[4:7],s65 offen lds
s_add_u32 m0,s63,17408
s_add_u32 s65,s58,835584
buffer_load_dwordx4 v6,s[4:7],s65 offen lds
s_add_u32 m0,s63,18432
s_add_u32 s65,s58,884736
buffer_load_dwordx4 v6,s[4:7],s65 offen lds
s_add_u32 m0,s63,19456
s_add_u32 s65,s58,933888
buffer_load_dwordx4 v6,s[4:7],s65 offen lds
s_add_u32 m0,s63,20480
s_add_u32 s65,s58,983040
buffer_load_dwordx4 v6,s[4:7],s65 offen lds
s_add_u32 m0,s63,21504
s_add_u32 s65,s58,1032192
buffer_load_dwordx4 v6,s[4:7],s65 offen lds
s_add_u32 m0,s63,22528
s_add_u32 s65,s58,1081344
buffer_load_dwordx4 v6,s[4:7],s65 offen lds
s_add_u32 m0,s63,23552
s_add_u32 s65,s58,1130496
buffer_load_dwordx4 v6,s[4:7],s65 offen lds
s_add_u32 m0,s63,24576
s_add_u32 s65,s58,1179648
buffer_load_dwordx4 v6,s[4:7],s65 offen lds
s_add_u32 m0,s63,25600
s_add_u32 s65,s58,1228800
buffer_load_dwordx4 v6,s[4:7],s65 offen lds
s_add_u32 m0,s63,26624
s_add_u32 s65,s58,1277952
buffer_load_dwordx4 v6,s[4:7],s65 offen lds
s_add_u32 m0,s63,27648
s_add_u32 s65,s58,1327104
buffer_load_dwordx4 v6,s[4:7],s65 offen lds
s_add_u32 m0,s63,28672
s_add_u32 s65,s58,1376256
buffer_load_dwordx4 v6,s[4:7],s65 offen lds
s_add_u32 m0,s63,29696
s_add_u32 s65,s58,1425408
buffer_load_dwordx4 v6,s[4:7],s65 offen lds
s_add_u32 m0,s63,30720
s_add_u32 s65,s58,1474560
buffer_load_dwordx4 v6,s[4:7],s65 offen lds
s_add_u32 m0,s63,31744
s_add_u32 s65,s58,1523712
buffer_load_dwordx4 v6,s[4:7],s65 offen lds
s_add_u32 m0,s63,32768
s_add_u32 s65,s58,1572864
buffer_load_dwordx4 v6,s[4:7],s65 offen lds
s_add_u32 m0,s63,33792
s_add_u32 s65,s58,1622016
buffer_load_dwordx4 v6,s[4:7],s65 offen lds
s_add_u32 m0,s63,34816
s_add_u32 s65,s58,1671168
buffer_load_dwordx4 v6,s[4:7],s65 offen lds
s_add_u32 m0,s63,35840
s_add_u32 s65,s58,1720320
buffer_load_dwordx4 v6,s[4:7],s65 offen lds
s_add_u32 m0,s63,36864
s_add_u32 s65,s58,1769472
buffer_load_dwordx4 v6,s[4:7],s65 offen lds
s_add_u32 m0,s63,37888
s_add_u32 s65,s58,1818624
buffer_load_dwordx4 v6,s[4:7],s65 offen lds
s_add_u32 m0,s63,38912
s_add_u32 s65,s58,1867776
buffer_load_dwordx4 v6,s[4:7],s65 offen lds
s_add_u32 m0,s63,39936
s_add_u32 s65,s58,1916928
buffer_load_dwordx4 v6,s[4:7],s65 offen lds
s_waitcnt vmcnt(20)
v_bfe_u32 v9,v0,2,2
v_lshrrev_b32 v10,5,v0
v_lshl_add_u32 v9,v10,2,v9
v_mul_u32_u24 v9,64,v9
v_and_b32 v10,1,v0
v_lshl_add_u32 v9,v10,3,v9
v_bfe_u32 v10,v0,1,1
v_lshl_add_u32 v9,v10,5,v9
v_bfe_u32 v10,v0,4,1
v_lshl_add_u32 v9,v10,4,v9
v_add_u32 v7,s63,v9
ds_read_b64_tr_b16 a[0:1],v7 offset:0
ds_read_b64_tr_b16 a[2:3],v7 offset:1024
ds_read_b64_tr_b16 a[4:5],v7 offset:512
ds_read_b64_tr_b16 a[6:7],v7 offset:1536
ds_read_b64_tr_b16 a[8:9],v7 offset:2048
ds_read_b64_tr_b16 a[10:11],v7 offset:3072
ds_read_b64_tr_b16 a[12:13],v7 offset:2560
ds_read_b64_tr_b16 a[14:15],v7 offset:3584
ds_read_b64_tr_b16 a[16:17],v7 offset:4096
ds_read_b64_tr_b16 a[18:19],v7 offset:5120
ds_read_b64_tr_b16 a[20:21],v7 offset:4608
ds_read_b64_tr_b16 a[22:23],v7 offset:5632
s_waitcnt lgkmcnt(4)
ds_read_b64_tr_b16 a[24:25],v7 offset:6144
ds_read_b64_tr_b16 a[26:27],v7 offset:7168
ds_read_b64_tr_b16 a[28:29],v7 offset:6656
ds_read_b64_tr_b16 a[30:31],v7 offset:7680
ds_read_b64_tr_b16 a[32:33],v7 offset:8192
ds_read_b64_tr_b16 a[34:35],v7 offset:9216
ds_read_b64_tr_b16 a[36:37],v7 offset:8704
ds_read_b64_tr_b16 a[38:39],v7 offset:9728
ds_read_b64_tr_b16 a[40:41],v7 offset:10240
ds_read_b64_tr_b16 a[42:43],v7 offset:11264
ds_read_b64_tr_b16 a[44:45],v7 offset:10752
ds_read_b64_tr_b16 a[46:47],v7 offset:11776
s_waitcnt lgkmcnt(4)
ds_read_b64_tr_b16 a[48:49],v7 offset:12288
ds_read_b64_tr_b16 a[50:51],v7 offset:13312
ds_read_b64_tr_b16 a[52:53],v7 offset:12800
ds_read_b64_tr_b16 a[54:55],v7 offset:13824
ds_read_b64_tr_b16 a[56:57],v7 offset:14336
ds_read_b64_tr_b16 a[58:59],v7 offset:15360
ds_read_b64_tr_b16 a[60:61],v7 offset:14848
ds_read_b64_tr_b16 a[62:63],v7 offset:15872
ds_read_b64_tr_b16 a[64:65],v7 offset:16384
ds_read_b64_tr_b16 a[66:67],v7 offset:17408
ds_read_b64_tr_b16 a[68:69],v7 offset:16896
ds_read_b64_tr_b16 a[70:71],v7 offset:17920
s_waitcnt lgkmcnt(4)
ds_read_b64_tr_b16 a[72:73],v7 offset:18432
ds_read_b64_tr_b16 a[74:75],v7 offset:19456
ds_read_b64_tr_b16 a[76:77],v7 offset:18944
ds_read_b64_tr_b16 a[78:79],v7 offset:19968
s_waitcnt lgkmcnt(0)
s_waitcnt vmcnt(0)
v_bfe_u32 v9,v0,2,2
v_lshrrev_b32 v10,5,v0
v_lshl_add_u32 v9,v10,2,v9
v_mul_u32_u24 v9,64,v9
v_and_b32 v10,1,v0
v_lshl_add_u32 v9,v10,3,v9
v_bfe_u32 v10,v0,1,1
v_lshl_add_u32 v9,v10,5,v9
v_bfe_u32 v10,v0,4,1
v_lshl_add_u32 v9,v10,4,v9
v_add_u32 v7,s63,v9
ds_read_b64_tr_b16 a[80:81],v7 offset:20480
ds_read_b64_tr_b16 a[82:83],v7 offset:21504
ds_read_b64_tr_b16 a[84:85],v7 offset:20992
ds_read_b64_tr_b16 a[86:87],v7 offset:22016
ds_read_b64_tr_b16 a[88:89],v7 offset:22528
ds_read_b64_tr_b16 a[90:91],v7 offset:23552
ds_read_b64_tr_b16 a[92:93],v7 offset:23040
ds_read_b64_tr_b16 a[94:95],v7 offset:24064
ds_read_b64_tr_b16 a[96:97],v7 offset:24576
ds_read_b64_tr_b16 a[98:99],v7 offset:25600
ds_read_b64_tr_b16 a[100:101],v7 offset:25088
ds_read_b64_tr_b16 a[102:103],v7 offset:26112
s_waitcnt lgkmcnt(4)
ds_read_b64_tr_b16 a[104:105],v7 offset:26624
ds_read_b64_tr_b16 a[106:107],v7 offset:27648
ds_read_b64_tr_b16 a[108:109],v7 offset:27136
ds_read_b64_tr_b16 a[110:111],v7 offset:28160
ds_read_b64_tr_b16 a[112:113],v7 offset:28672
ds_read_b64_tr_b16 a[114:115],v7 offset:29696
ds_read_b64_tr_b16 a[116:117],v7 offset:29184
ds_read_b64_tr_b16 a[118:119],v7 offset:30208
ds_read_b64_tr_b16 a[120:121],v7 offset:30720
ds_read_b64_tr_b16 a[122:123],v7 offset:31744
ds_read_b64_tr_b16 a[124:125],v7 offset:31232
ds_read_b64_tr_b16 a[126:127],v7 offset:32256
s_waitcnt lgkmcnt(4)
ds_read_b64_tr_b16 a[128:129],v7 offset:32768
ds_read_b64_tr_b16 a[130:131],v7 offset:33792
ds_read_b64_tr_b16 a[132:133],v7 offset:33280
ds_read_b64_tr_b16 a[134:135],v7 offset:34304
ds_read_b64_tr_b16 a[136:137],v7 offset:34816
ds_read_b64_tr_b16 a[138:139],v7 offset:35840
ds_read_b64_tr_b16 a[140:141],v7 offset:35328
ds_read_b64_tr_b16 a[142:143],v7 offset:36352
ds_read_b64_tr_b16 a[144:145],v7 offset:36864
ds_read_b64_tr_b16 a[146:147],v7 offset:37888
ds_read_b64_tr_b16 a[148:149],v7 offset:37376
ds_read_b64_tr_b16 a[150:151],v7 offset:38400
s_waitcnt lgkmcnt(4)
ds_read_b64_tr_b16 a[152:153],v7 offset:38912
ds_read_b64_tr_b16 a[154:155],v7 offset:39936
ds_read_b64_tr_b16 a[156:157],v7 offset:39424
ds_read_b64_tr_b16 a[158:159],v7 offset:40448
s_waitcnt lgkmcnt(0)
v_mov_b32 v24,0x3f803f80
v_mov_b32 v25,0x3f803f80
v_mov_b32 v26,0x3f803f80
v_mov_b32 v27,0x3f803f80
s_nop 1
v_mfma_f32_32x32x16_bf16 v[144:159],a[0:3],v[24:27],0
v_mfma_f32_32x32x16_bf16 v[144:159],a[4:7],v[24:27],v[144:159]
v_mfma_f32_32x32x16_bf16 v[144:159],a[8:11],v[24:27],v[144:159]
v_mfma_f32_32x32x16_bf16 v[144:159],a[12:15],v[24:27],v[144:159]
v_mfma_f32_32x32x16_bf16 v[144:159],a[16:19],v[24:27],v[144:159]
v_mfma_f32_32x32x16_bf16 v[144:159],a[20:23],v[24:27],v[144:159]
v_mfma_f32_32x32x16_bf16 v[144:159],a[24:27],v[24:27],v[144:159]
v_mfma_f32_32x32x16_bf16 v[144:159],a[28:31],v[24:27],v[144:159]
v_mfma_f32_32x32x16_bf16 v[144:159],a[32:35],v[24:27],v[144:159]
v_mfma_f32_32x32x16_bf16 v[144:159],a[36:39],v[24:27],v[144:159]
v_mfma_f32_32x32x16_bf16 v[144:159],a[40:43],v[24:27],v[144:159]
v_mfma_f32_32x32x16_bf16 v[144:159],a[44:47],v[24:27],v[144:159]
v_mfma_f32_32x32x16_bf16 v[144:159],a[48:51],v[24:27],v[144:159]
v_mfma_f32_32x32x16_bf16 v[144:159],a[52:55],v[24:27],v[144:159]
v_mfma_f32_32x32x16_bf16 v[144:159],a[56:59],v[24:27],v[144:159]
v_mfma_f32_32x32x16_bf16 v[144:159],a[60:63],v[24:27],v[144:159]
v_mfma_f32_32x32x16_bf16 v[144:159],a[64:67],v[24:27],v[144:159]
v_mfma_f32_32x32x16_bf16 v[144:159],a[68:71],v[24:27],v[144:159]
v_mfma_f32_32x32x16_bf16 v[144:159],a[72:75],v[24:27],v[144:159]
v_mfma_f32_32x32x16_bf16 v[144:159],a[76:79],v[24:27],v[144:159]
v_mfma_f32_32x32x16_bf16 v[144:159],a[80:83],v[24:27],v[144:159]
v_mfma_f32_32x32x16_bf16 v[144:159],a[84:87],v[24:27],v[144:159]
v_mfma_f32_32x32x16_bf16 v[144:159],a[88:91],v[24:27],v[144:159]
v_mfma_f32_32x32x16_bf16 v[144:159],a[92:95],v[24:27],v[144:159]
v_mfma_f32_32x32x16_bf16 v[144:159],a[96:99],v[24:27],v[144:159]
v_mfma_f32_32x32x16_bf16 v[144:159],a[100:103],v[24:27],v[144:159]
v_mfma_f32_32x32x16_bf16 v[144:159],a[104:107],v[24:27],v[144:159]
v_mfma_f32_32x32x16_bf16 v[144:159],a[108:111],v[24:27],v[144:159]
v_mfma_f32_32x32x16_bf16 v[144:159],a[112:115],v[24:27],v[144:159]
v_mfma_f32_32x32x16_bf16 v[144:159],a[116:119],v[24:27],v[144:159]
v_mfma_f32_32x32x16_bf16 v[144:159],a[120:123],v[24:27],v[144:159]
v_mfma_f32_32x32x16_bf16 v[144:159],a[124:127],v[24:27],v[144:159]
v_mfma_f32_32x32x16_bf16 v[144:159],a[128:131],v[24:27],v[144:159]
v_mfma_f32_32x32x16_bf16 v[144:159],a[132:135],v[24:27],v[144:159]
v_mfma_f32_32x32x16_bf16 v[144:159],a[136:139],v[24:27],v[144:159]
v_mfma_f32_32x32x16_bf16 v[144:159],a[140:143],v[24:27],v[144:159]
v_mfma_f32_32x32x16_bf16 v[144:159],a[144:147],v[24:27],v[144:159]
v_mfma_f32_32x32x16_bf16 v[144:159],a[148:151],v[24:27],v[144:159]
v_mfma_f32_32x32x16_bf16 v[144:159],a[152:155],v[24:27],v[144:159]
v_mfma_f32_32x32x16_bf16 v[144:159],a[156:159],v[24:27],v[144:159]
s_barrier
s_lshl_b32 s3,s49,2
v_mov_b32 v7,s3
s_nop 8
ibw_361:
buffer_load_dword v6,v7,s[12:15],0 offen sc1
s_waitcnt vmcnt(0)
v_cmp_ne_u32 vcc,256,v6
s_nop 0
s_cbranch_vccz ok_362
s_sleep 8
s_sub_u32 s47,s47,1
s_cbranch_scc1 ABORT
s_branch ibw_361
ok_362:
s_cmp_lg_u32 s49,0
s_cbranch_scc1 ibok_363
v_and_b32 v7,7,v0
v_lshlrev_b32 v7,2,v7
buffer_load_dword v6,v7,s[12:15],0 offen offset:32 sc1
s_waitcnt vmcnt(0)
v_cmp_ne_u32 vcc,32,v6
s_nop 0
s_cbranch_vccz ibok_363
s_barrier
s_mov_b32 s49,1
s_mov_b32 s3,s2
s_load_dwordx16 s[16:31],s[0:1],0
s_load_dwordx8 s[32:39],s[0:1],64
s_waitcnt lgkmcnt(0)
s_branch DISPATCH
ibok_363:
s_mov_b32 s50,0
s_mov_b32 s32,0
s_mov_b32 s57,0
s_mov_b32 s59,2147483648
s_mov_b32 s82,2147483648
s_mov_b32 s39,2147483648
v_mov_b32 v22,94208
v_lshl_add_u32 v22,v0,2,v22
v_mov_b32 v23,0
ds_write_b32 v22,v23
s_mov_b32 s39,1600000
v_and_b32 v72,15,v0
v_lshlrev_b32 v72,7,v72
v_min_u32 v6,59,v0
v_lshlrev_b32 v6,2,v6
v_add_u32 v2,198656,v6
v_add_u32 v7,-80,v6
v_cmp_gt_u32 s[78:79],20,v0
s_nop 1
v_cndmask_b32 v2,v7,v2,s[78:79]
s_mov_b32 s51,0
s_mov_b32 s52,0
s_mul_i32 s62,s51,4
s_and_b32 s63,s52,3
s_add_u32 s62,s62,s63
s_mul_i32 s62,s62,98304
s_add_u32 s62,s62,242778112
s_lshl_b32 s63,s56,11
s_add_u32 s62,s62,s63
buffer_load_dword v73,v72,s[8:11],s62 offen sc1
s_mov_b32 s51,0
s_mov_b32 s52,1
s_mul_i32 s62,s51,4
s_and_b32 s63,s52,3
s_add_u32 s62,s62,s63
s_mul_i32 s62,s62,98304
s_add_u32 s62,s62,242778112
s_lshl_b32 s63,s56,11
s_add_u32 s62,s62,s63
buffer_load_dword v73,v72,s[8:11],s62 offen sc1
s_mov_b32 s51,0
s_mov_b32 s52,2
s_mul_i32 s62,s51,4
s_and_b32 s63,s52,3
s_add_u32 s62,s62,s63
s_mul_i32 s62,s62,98304
s_add_u32 s62,s62,242778112
s_lshl_b32 s63,s56,11
s_add_u32 s62,s62,s63
buffer_load_dword v73,v72,s[8:11],s62 offen sc1
s_mov_b32 s51,0
s_mov_b32 s52,3
s_mul_i32 s62,s51,4
s_and_b32 s63,s52,3
s_add_u32 s62,s62,s63
s_mul_i32 s62,s62,98304
s_add_u32 s62,s62,242778112
s_lshl_b32 s63,s56,11
s_add_u32 s62,s62,s63
buffer_load_dword v73,v72,s[8:11],s62 offen sc1
s_mov_b32 s51,1
s_mov_b32 s52,0
s_mul_i32 s62,s51,4
s_and_b32 s63,s52,3
s_add_u32 s62,s62,s63
s_mul_i32 s62,s62,98304
s_add_u32 s62,s62,242778112
s_lshl_b32 s63,s56,11
s_add_u32 s62,s62,s63
buffer_load_dword v73,v72,s[8:11],s62 offen sc1
s_mov_b32 s51,1
s_mov_b32 s52,1
s_mul_i32 s62,s51,4
s_and_b32 s63,s52,3
s_add_u32 s62,s62,s63
s_mul_i32 s62,s62,98304
s_add_u32 s62,s62,242778112
s_lshl_b32 s63,s56,11
s_add_u32 s62,s62,s63
buffer_load_dword v73,v72,s[8:11],s62 offen sc1
s_mov_b32 s51,1
s_mov_b32 s52,2
s_mul_i32 s62,s51,4
s_and_b32 s63,s52,3
s_add_u32 s62,s62,s63
s_mul_i32 s62,s62,98304
s_add_u32 s62,s62,242778112
s_lshl_b32 s63,s56,11
s_add_u32 s62,s62,s63
buffer_load_dword v73,v72,s[8:11],s62 offen sc1
s_mov_b32 s51,1
s_mov_b32 s52,3
s_mul_i32 s62,s51,4
s_and_b32 s63,s52,3
s_add_u32 s62,s62,s63
s_mul_i32 s62,s62,98304
s_add_u32 s62,s62,242778112
s_lshl_b32 s63,s56,11
s_add_u32 s62,s62,s63
buffer_load_dword v73,v72,s[8:11],s62 offen sc1
s_waitcnt vmcnt(0)
s_waitcnt lgkmcnt(0)
s_barrier
s_mov_b32 s83,s100
s_min_u32 s62,s32,127
s_sub_u32 s60,s62,13
s_lshr_b32 s34,s60,1
s_and_b32 s33,s60,1
s_cmp_eq_u32 s33,0
s_cselect_b32 s61,13,0
s_add_u32 s34,s34,s61
s_sub_u32 s61,s60,51
s_cmp_ge_u32 s60,102
s_cselect_b32 s34,s61,s34
s_cselect_b32 s33,1,s33
s_cmp_lt_u32 s62,13
s_cselect_b32 s34,s62,s34
s_cselect_b32 s33,0,s33
s_lshl_b32 s35,s33,6
s_add_u32 s35,s35,s34
s_lshl_b32 s35,s35,9
s_add_u32 s35,s35,325632
s_cmp_lt_u32 s34,4
s_cselect_b64 s[76:77],s[78:79],-1
s_sub_u32 s57,46080,s57
v_swap_b32 v16,v18
v_swap_b32 v17,v19
s_add_u32 s62,s32,1
s_min_u32 s62,s62,127
s_sub_u32 s60,s62,13
s_lshr_b32 s41,s60,1
s_and_b32 s40,s60,1
s_cmp_eq_u32 s40,0
s_cselect_b32 s61,13,0
s_add_u32 s41,s41,s61
s_sub_u32 s61,s60,51
s_cmp_ge_u32 s60,102
s_cselect_b32 s41,s61,s41
s_cselect_b32 s40,1,s40
s_cmp_lt_u32 s62,13
s_cselect_b32 s41,s62,s41
s_cselect_b32 s40,0,s40
s_lshl_b32 s42,s40,6
s_add_u32 s42,s42,s41
s_lshl_b32 s42,s42,9
s_add_u32 s42,s42,325632
s_cmp_lt_u32 s41,4
s_cselect_b64 s[80:81],s[78:79],-1
W3_COLD:
s_mov_b32 s37,0
fb_364:
buffer_load_dword v3,v2,s[8:11],s35 offen sc1
s_waitcnt vmcnt(0)
v_cmp_eq_u32 vcc,0,v3
s_and_b64 vcc,vcc,s[76:77]
s_cbranch_scc0 ok_365
s_sleep 2
s_sub_u32 s47,s47,1
s_cbranch_scc1 ABORT
s_branch fb_364
ok_365:
W3_COLD2:
s_sub_u32 s66,46080,s57
s_mul_i32 s60,s33,8
s_and_b32 s61,s34,7
s_add_u32 s60,s60,s61
s_mul_i32 s60,s60,46080
s_add_u32 s60,s60,s37
s_add_u32 s60,s60,212467712
s_mov_b32 s67,s60
s_mul_i32 s61,s46,10240
s_add_u32 s60,s60,s61
s_add_u32 s61,s61,s66
s_add_u32 m0,s61,0
s_add_u32 s63,s60,0
buffer_load_dwordx4 v1,s[8:11],s63 offen sc1 lds
buffer_load_dwordx4 v1,s[8:11],s63 offen offset:1024 sc1 lds
buffer_load_dwordx4 v1,s[8:11],s63 offen offset:2048 sc1 lds
buffer_load_dwordx4 v1,s[8:11],s63 offen offset:3072 sc1 lds
s_add_u32 m0,s61,4096
s_add_u32 s63,s60,4096
buffer_load_dwordx4 v1,s[8:11],s63 offen sc1 lds
buffer_load_dwordx4 v1,s[8:11],s63 offen offset:1024 sc1 lds
s_waitcnt vmcnt(5)
s_mov_b64 exec,1
s_cmp_lg_u32 s49,0
s_cbranch_scc0 ls_366
buffer_store_dword v5,v1,s[8:11],s59 offen sc1
s_branch ls_367
ls_366:
buffer_store_dword v5,v1,s[8:11],s59 offen
ls_367:
s_mov_b64 exec,-1
s_mov_b32 s59,2147483648
buffer_load_dwordx4 v1,s[8:11],s63 offen offset:2048 sc1 lds
buffer_load_dwordx4 v1,s[8:11],s63 offen offset:3072 sc1 lds
s_add_u32 m0,s61,8192
s_add_u32 s63,s60,8192
buffer_load_dwordx4 v1,s[8:11],s63 offen sc1 lds
buffer_load_dwordx4 v1,s[8:11],s63 offen offset:1024 sc1 lds
s_lshl_b32 s62,s46,10
s_add_u32 s62,s62,40960
s_add_u32 m0,s66,s62
s_add_u32 s63,s67,s62
buffer_load_dwordx4 v1,s[8:11],s63 offen sc1 lds
s_add_u32 m0,s66,45056
s_add_u32 s63,s67,45056
buffer_load_dwordx4 v1,s[8:11],s63 offen sc1 lds
s_mov_b32 s35,s42
s_mov_b32 s53,s33
s_mov_b32 s54,s34
s_add_u32 s32,s32,1
s_mov_b32 s33,s40
s_mov_b32 s34,s41
s_mov_b64 s[76:77],s[80:81]
s_sub_u32 s57,46080,s57
v_swap_b32 v16,v18
v_swap_b32 v17,v19
s_mov_b32 s51,s53
s_mov_b32 s52,s54
s_waitcnt vmcnt(7)
s_branch W3_GO
W3_NEXT:
s_sub_u32 s57,46080,s57
v_swap_b32 v16,v18
v_swap_b32 v17,v19
s_mov_b32 s51,s53
s_mov_b32 s52,s54
s_waitcnt vmcnt(2)
W3_GO:
s_barrier
ds_read_b128 v[24:27],v16 offset:0
ds_read_b128 v[28:31],v17 offset:0
ds_read_b128 v[32:35],v16 offset:10240
ds_read_b128 v[36:39],v17 offset:10240
ds_read_b128 v[40:43],v16 offset:20480
ds_read_b128 v[44:47],v17 offset:20480
ds_read_b128 v[48:51],v16 offset:30720
buffer_load_dword v3,v2,s[8:11],s35 offen sc1
s_waitcnt lgkmcnt(6)
v_mfma_f32_32x32x16_bf16 v[56:71],a[0:3],v[24:27],0
ds_read_b128 v[52:55],v17 offset:30720
s_add_u32 s62,s32,1
s_min_u32 s62,s62,127
s_sub_u32 s60,s62,13
s_waitcnt lgkmcnt(6)
v_mfma_f32_32x32x16_bf16 v[56:71],a[4:7],v[28:31],v[56:71]
ds_read_b128 v[24:27],v16 offset:2048
s_lshr_b32 s41,s60,1
s_and_b32 s40,s60,1
s_mul_i32 s71,s51,4
s_waitcnt lgkmcnt(5)
v_mfma_f32_32x32x16_bf16 v[56:71],a[40:43],v[32:35],v[56:71]
ds_read_b128 v[28:31],v17 offset:2048
s_cmp_eq_u32 s40,0
s_cselect_b32 s61,13,0
s_add_u32 s41,s41,s61
s_sub_u32 s61,s60,51
v_mfma_f32_32x32x16_bf16 v[56:71],a[44:47],v[36:39],v[56:71]
ds_read_b128 v[32:35],v16 offset:12288
s_cmp_ge_u32 s60,102
s_cselect_b32 s41,s61,s41
s_cselect_b32 s40,1,s40
s_waitcnt lgkmcnt(5)
v_mfma_f32_32x32x16_bf16 v[56:71],a[80:83],v[40:43],v[56:71]
ds_read_b128 v[36:39],v17 offset:12288
s_cmp_lt_u32 s62,13
s_cselect_b32 s41,s62,s41
s_cselect_b32 s40,0,s40
s_lshl_b32 s42,s40,6
v_mfma_f32_32x32x16_bf16 v[56:71],a[84:87],v[44:47],v[56:71]
ds_read_b128 v[40:43],v16 offset:22528
s_add_u32 s42,s42,s41
s_lshl_b32 s42,s42,9
s_add_u32 s42,s42,325632
s_waitcnt lgkmcnt(5)
v_mfma_f32_32x32x16_bf16 v[56:71],a[120:123],v[48:51],v[56:71]
ds_read_b128 v[44:47],v17 offset:22528
s_cmp_lt_u32 s41,4
s_cselect_b64 s[80:81],s[78:79],-1
s_and_b32 s72,s52,3
s_add_u32 s71,s71,s72
v_mfma_f32_32x32x16_bf16 v[56:71],a[124:127],v[52:55],v[56:71]
ds_read_b128 v[48:51],v16 offset:32768
s_mul_i32 s71,s71,98304
s_add_u32 s71,s71,242778112
s_lshl_b32 s72,s56,11
s_waitcnt lgkmcnt(5)
v_mfma_f32_32x32x16_bf16 v[56:71],a[8:11],v[24:27],v[56:71]
ds_read_b128 v[52:55],v17 offset:32768
s_add_u32 s71,s71,s72
s_lshl_b32 s82,s51,6
s_add_u32 s82,s82,s52
s_lshl_b32 s82,s82,9
v_mfma_f32_32x32x16_bf16 v[56:71],a[12:15],v[28:31],v[56:71]
ds_read_b128 v[24:27],v16 offset:4096
s_add_u32 s82,s82,589824
s_lshl_b32 s70,s56,2
s_add_u32 s82,s82,s70
s_waitcnt lgkmcnt(5)
v_mfma_f32_32x32x16_bf16 v[56:71],a[48:51],v[32:35],v[56:71]
ds_read_b128 v[28:31],v17 offset:4096
v_mfma_f32_32x32x16_bf16 v[56:71],a[52:55],v[36:39],v[56:71]
ds_read_b128 v[32:35],v16 offset:14336
s_waitcnt lgkmcnt(5)
v_mfma_f32_32x32x16_bf16 v[56:71],a[88:91],v[40:43],v[56:71]
ds_read_b128 v[36:39],v17 offset:14336
s_waitcnt vmcnt(0)
s_mov_b64 exec,1
s_cmp_lg_u32 s49,0
s_cbranch_scc0 ls_368
buffer_store_dword v5,v1,s[8:11],s59 offen sc1
s_branch ls_369
ls_368:
buffer_store_dword v5,v1,s[8:11],s59 offen
ls_369:
s_mov_b64 exec,-1
s_mov_b32 s59,2147483648
v_mfma_f32_32x32x16_bf16 v[56:71],a[92:95],v[44:47],v[56:71]
ds_read_b128 v[40:43],v16 offset:24576
v_cmp_eq_u32 vcc,0,v3
s_and_b64 vcc,vcc,s[76:77]
s_cselect_b32 s37,2147483648,0
s_waitcnt lgkmcnt(5)
v_mfma_f32_32x32x16_bf16 v[56:71],a[128:131],v[48:51],v[56:71]
ds_read_b128 v[44:47],v17 offset:24576
s_cmp_lt_u32 s32,128
s_cselect_b32 s37,s37,2147483648
s_sub_u32 s66,46080,s57
s_mul_i32 s60,s33,8
v_mfma_f32_32x32x16_bf16 v[56:71],a[132:135],v[52:55],v[56:71]
ds_read_b128 v[48:51],v16 offset:34816
s_and_b32 s61,s34,7
s_add_u32 s60,s60,s61
s_mul_i32 s60,s60,46080
s_waitcnt lgkmcnt(5)
v_mfma_f32_32x32x16_bf16 v[56:71],a[16:19],v[24:27],v[56:71]
ds_read_b128 v[52:55],v17 offset:34816
s_add_u32 s60,s60,s37
s_add_u32 s60,s60,212467712
s_mov_b32 s67,s60
s_mul_i32 s61,s46,10240
s_barrier
v_mfma_f32_32x32x16_bf16 v[56:71],a[20:23],v[28:31],v[56:71]
ds_read_b128 v[24:27],v16 offset:6144
v_add_u32 v183,s57,v182
s_add_u32 s60,s60,s61
s_add_u32 s61,s61,s66
s_waitcnt lgkmcnt(5)
v_mfma_f32_32x32x16_bf16 v[56:71],a[56:59],v[32:35],v[56:71]
ds_read_b128 v[28:31],v17 offset:6144
v_add_u32 v8,0x800,v183
s_add_u32 m0,s61,0
s_add_u32 s63,s60,0
v_mfma_f32_32x32x16_bf16 v[56:71],a[60:63],v[36:39],v[56:71]
ds_read_b128 v[32:35],v16 offset:16384
ds_read2_b64 v[160:163],v183 offset0:0 offset1:32
s_waitcnt lgkmcnt(6)
v_mfma_f32_32x32x16_bf16 v[56:71],a[96:99],v[40:43],v[56:71]
ds_read_b128 v[36:39],v17 offset:16384
ds_read2_b64 v[164:167],v183 offset0:64 offset1:96
buffer_load_dwordx4 v1,s[8:11],s63 offen sc1 lds
v_mfma_f32_32x32x16_bf16 v[56:71],a[100:103],v[44:47],v[56:71]
ds_read_b128 v[40:43],v16 offset:26624
ds_read2_b64 v[168:171],v183 offset0:128 offset1:160
s_waitcnt lgkmcnt(8)
v_mfma_f32_32x32x16_bf16 v[56:71],a[136:139],v[48:51],v[56:71]
ds_read_b128 v[44:47],v17 offset:26624
ds_read2_b64 v[172:175],v183 offset0:192 offset1:224
buffer_load_dwordx4 v1,s[8:11],s63 offen offset:1024 sc1 lds
v_mfma_f32_32x32x16_bf16 v[56:71],a[140:143],v[52:55],v[56:71]
ds_read_b128 v[48:51],v16 offset:36864
ds_read2_b64 v[176:179],v8 offset0:0 offset1:32
s_waitcnt lgkmcnt(10)
v_mfma_f32_32x32x16_bf16 v[56:71],a[24:27],v[24:27],v[56:71]
ds_read_b128 v[52:55],v17 offset:36864
buffer_load_dwordx4 v1,s[8:11],s63 offen offset:2048 sc1 lds
v_mfma_f32_32x32x16_bf16 v[56:71],a[28:31],v[28:31],v[56:71]
ds_read_b128 v[24:27],v16 offset:8192
s_waitcnt lgkmcnt(9)
v_mfma_f32_32x32x16_bf16 v[56:71],a[64:67],v[32:35],v[56:71]
ds_read_b128 v[28:31],v17 offset:8192
buffer_load_dwordx4 v1,s[8:11],s63 offen offset:3072 sc1 lds
s_add_u32 m0,s61,4096
s_add_u32 s63,s60,4096
v_mfma_f32_32x32x16_bf16 v[56:71],a[68:71],v[36:39],v[56:71]
ds_read_b128 v[32:35],v16 offset:18432
s_waitcnt lgkmcnt(4)
v_add_f32 v160,v160,v170
v_add_f32 v161,v161,v171
v_mfma_f32_32x32x16_bf16 v[56:71],a[104:107],v[40:43],v[56:71]
ds_read_b128 v[36:39],v17 offset:18432
buffer_load_dwordx4 v1,s[8:11],s63 offen sc1 lds
v_add_f32 v162,v162,v172
v_add_f32 v163,v163,v173
v_mfma_f32_32x32x16_bf16 v[56:71],a[108:111],v[44:47],v[56:71]
ds_read_b128 v[40:43],v16 offset:28672
v_add_f32 v164,v164,v174
v_add_f32 v165,v165,v175
v_add_f32 v166,v166,v176
s_waitcnt lgkmcnt(5)
v_mfma_f32_32x32x16_bf16 v[56:71],a[144:147],v[48:51],v[56:71]
ds_read_b128 v[44:47],v17 offset:28672
buffer_load_dword v3,v2,s[8:11],s35 offen sc1
v_add_f32 v167,v167,v177
v_mfma_f32_32x32x16_bf16 v[56:71],a[148:151],v[52:55],v[56:71]
ds_read_b128 v[48:51],v16 offset:38912
buffer_load_dwordx4 v1,s[8:11],s63 offen offset:1024 sc1 lds
v_add_f32 v168,v168,v178
s_waitcnt lgkmcnt(5)
v_mfma_f32_32x32x16_bf16 v[56:71],a[32:35],v[24:27],v[56:71]
ds_read_b128 v[52:55],v17 offset:38912
v_add_f32 v169,v169,v179
v_add_f32 v160,v160,v162
v_add_f32 v161,v161,v163
v_add_f32 v164,v164,v166
v_mfma_f32_32x32x16_bf16 v[56:71],a[36:39],v[28:31],v[56:71]
buffer_load_dwordx4 v1,s[8:11],s63 offen offset:2048 sc1 lds
v_add_f32 v165,v165,v167
v_add_f32 v160,v160,v164
v_add_f32 v161,v161,v165
s_waitcnt lgkmcnt(4)
v_mfma_f32_32x32x16_bf16 v[56:71],a[72:75],v[32:35],v[56:71]
v_add_f32 v160,v160,v168
v_add_f32 v161,v161,v169
v_mov_b32 v162,v160
v_mov_b32 v163,v161
s_nop 0
v_permlane32_swap_b32 v160,v162
v_mfma_f32_32x32x16_bf16 v[56:71],a[76:79],v[36:39],v[56:71]
buffer_load_dwordx4 v1,s[8:11],s63 offen offset:3072 sc1 lds
s_add_u32 m0,s61,8192
s_add_u32 s63,s60,8192
v_permlane32_swap_b32 v161,v163
s_waitcnt lgkmcnt(2)
v_mfma_f32_32x32x16_bf16 v[56:71],a[112:115],v[40:43],v[56:71]
v_add_f32 v180,v160,v162
v_add_f32 v181,v161,v163
v_mul_f32 v180,0x3acccccd,v180
v_mul_f32 v181,0x3acccccd,v181
v_fma_f32 v181,-v180,v180,v181
v_mfma_f32_32x32x16_bf16 v[56:71],a[116:119],v[44:47],v[56:71]
buffer_load_dwordx4 v1,s[8:11],s63 offen sc1 lds
v_max_f32 v181,0,v181
v_cvt_pk_bf16_f32 v8,v180,v181
v_lshlrev_b32 v180,16,v8
s_waitcnt lgkmcnt(0)
v_mfma_f32_32x32x16_bf16 v[56:71],a[152:155],v[48:51],v[56:71]
v_and_b32 v181,0xffff0000,v8
v_add_f32 v181,0x3727c5ac,v181
v_cvt_pk_bf16_f32 v8,v181,v181
v_lshlrev_b32 v181,16,v8
v_sqrt_f32 v181,v181
v_mfma_f32_32x32x16_bf16 v[56:71],a[156:159],v[52:55],v[56:71]
buffer_load_dwordx4 v1,s[8:11],s63 offen offset:1024 sc1 lds
s_lshl_b32 s62,s46,10
s_add_u32 s62,s62,40960
s_add_u32 m0,s66,s62
s_add_u32 s63,s67,s62
buffer_load_dwordx4 v1,s[8:11],s63 offen sc1 lds
s_add_u32 m0,s66,45056
s_add_u32 s63,s67,45056
buffer_load_dwordx4 v1,s[8:11],s63 offen sc1 lds
v_cvt_pk_bf16_f32 v8,v181,v181
v_lshlrev_b32 v181,16,v8
v_rcp_f32 v181,v181
s_cmp_eq_u32 s37,0
s_cbranch_scc0 sec_372
s_mov_b32 s35,s42
s_mov_b32 s53,s33
s_mov_b32 s54,s34
s_add_u32 s32,s32,1
s_mov_b32 s33,s40
s_mov_b32 s34,s41
s_mov_b64 s[76:77],s[80:81]
s_nop 2
ep_370:
v_pk_fma_f32 v[56:57],v[144:145],v[180:181],v[56:57] op_sel_hi:[1,0,1] neg_lo:[0,1,0] neg_hi:[0,1,0]
v_pk_fma_f32 v[58:59],v[146:147],v[180:181],v[58:59] op_sel_hi:[1,0,1] neg_lo:[0,1,0] neg_hi:[0,1,0]
v_pk_fma_f32 v[60:61],v[148:149],v[180:181],v[60:61] op_sel_hi:[1,0,1] neg_lo:[0,1,0] neg_hi:[0,1,0]
v_pk_fma_f32 v[62:63],v[150:151],v[180:181],v[62:63] op_sel_hi:[1,0,1] neg_lo:[0,1,0] neg_hi:[0,1,0]
v_pk_fma_f32 v[64:65],v[152:153],v[180:181],v[64:65] op_sel_hi:[1,0,1] neg_lo:[0,1,0] neg_hi:[0,1,0]
v_pk_fma_f32 v[66:67],v[154:155],v[180:181],v[66:67] op_sel_hi:[1,0,1] neg_lo:[0,1,0] neg_hi:[0,1,0]
v_pk_fma_f32 v[68:69],v[156:157],v[180:181],v[68:69] op_sel_hi:[1,0,1] neg_lo:[0,1,0] neg_hi:[0,1,0]
v_pk_fma_f32 v[70:71],v[158:159],v[180:181],v[70:71] op_sel_hi:[1,0,1] neg_lo:[0,1,0] neg_hi:[0,1,0]
v_pk_mul_f32 v[56:57],v[56:57],v[180:181] op_sel:[0,1] op_sel_hi:[1,1]
v_pk_mul_f32 v[58:59],v[58:59],v[180:181] op_sel:[0,1] op_sel_hi:[1,1]
v_pk_mul_f32 v[60:61],v[60:61],v[180:181] op_sel:[0,1] op_sel_hi:[1,1]
v_pk_mul_f32 v[62:63],v[62:63],v[180:181] op_sel:[0,1] op_sel_hi:[1,1]
v_pk_mul_f32 v[64:65],v[64:65],v[180:181] op_sel:[0,1] op_sel_hi:[1,1]
v_pk_mul_f32 v[66:67],v[66:67],v[180:181] op_sel:[0,1] op_sel_hi:[1,1]
v_pk_mul_f32 v[68:69],v[68:69],v[180:181] op_sel:[0,1] op_sel_hi:[1,1]
v_pk_mul_f32 v[70:71],v[70:71],v[180:181] op_sel:[0,1] op_sel_hi:[1,1]
v_cvt_pk_bf16_f32 v140,v56,v57
v_lshlrev_b32 v56,16,v140
v_and_b32 v57,0xffff0000,v140
v_cvt_pk_bf16_f32 v140,v58,v59
v_lshlrev_b32 v58,16,v140
v_and_b32 v59,0xffff0000,v140
v_cvt_pk_bf16_f32 v140,v60,v61
v_lshlrev_b32 v60,16,v140
v_and_b32 v61,0xffff0000,v140
v_cvt_pk_bf16_f32 v140,v62,v63
v_lshlrev_b32 v62,16,v140
v_and_b32 v63,0xffff0000,v140
v_cvt_pk_bf16_f32 v140,v64,v65
v_lshlrev_b32 v64,16,v140
v_and_b32 v65,0xffff0000,v140
v_cvt_pk_bf16_f32 v140,v66,v67
v_lshlrev_b32 v66,16,v140
v_and_b32 v67,0xffff0000,v140
v_cvt_pk_bf16_f32 v140,v68,v69
v_lshlrev_b32 v68,16,v140
v_and_b32 v69,0xffff0000,v140
v_cvt_pk_bf16_f32 v140,v70,v71
v_lshlrev_b32 v70,16,v140
v_and_b32 v71,0xffff0000,v140
v_pk_mul_f32 v[124:125],v[56:57],v[56:57]
v_pk_mul_f32 v[126:127],v[58:59],v[58:59]
v_pk_mul_f32 v[128:129],v[60:61],v[60:61]
v_pk_mul_f32 v[130:131],v[62:63],v[62:63]
v_pk_mul_f32 v[132:133],v[64:65],v[64:65]
v_pk_mul_f32 v[134:135],v[66:67],v[66:67]
v_pk_mul_f32 v[136:137],v[68:69],v[68:69]
v_pk_mul_f32 v[138:139],v[70:71],v[70:71]
v_pk_fma_f32 v[124:125],v[124:125],v[112:113],v[112:113] op_sel:[0,1,0] op_sel_hi:[1,1,0]
v_pk_fma_f32 v[126:127],v[126:127],v[112:113],v[112:113] op_sel:[0,1,0] op_sel_hi:[1,1,0]
v_pk_fma_f32 v[128:129],v[128:129],v[112:113],v[112:113] op_sel:[0,1,0] op_sel_hi:[1,1,0]
v_pk_fma_f32 v[130:131],v[130:131],v[112:113],v[112:113] op_sel:[0,1,0] op_sel_hi:[1,1,0]
v_pk_fma_f32 v[132:133],v[132:133],v[112:113],v[112:113] op_sel:[0,1,0] op_sel_hi:[1,1,0]
v_pk_fma_f32 v[134:135],v[134:135],v[112:113],v[112:113] op_sel:[0,1,0] op_sel_hi:[1,1,0]
v_pk_fma_f32 v[136:137],v[136:137],v[112:113],v[112:113] op_sel:[0,1,0] op_sel_hi:[1,1,0]
v_pk_fma_f32 v[138:139],v[138:139],v[112:113],v[112:113] op_sel:[0,1,0] op_sel_hi:[1,1,0]
v_pk_mul_f32 v[124:125],v[124:125],v[56:57]
v_pk_mul_f32 v[126:127],v[126:127],v[58:59]
v_pk_mul_f32 v[128:129],v[128:129],v[60:61]
v_pk_mul_f32 v[130:131],v[130:131],v[62:63]
v_pk_mul_f32 v[132:133],v[132:133],v[64:65]
v_pk_mul_f32 v[134:135],v[134:135],v[66:67]
v_pk_mul_f32 v[136:137],v[136:137],v[68:69]
v_pk_mul_f32 v[138:139],v[138:139],v[70:71]
v_exp_f32 v124,v124
v_exp_f32 v125,v125
v_exp_f32 v126,v126
v_exp_f32 v127,v127
v_exp_f32 v128,v128
v_exp_f32 v129,v129
v_exp_f32 v130,v130
v_exp_f32 v131,v131
v_exp_f32 v132,v132
v_exp_f32 v133,v133
v_exp_f32 v134,v134
v_exp_f32 v135,v135
v_exp_f32 v136,v136
v_exp_f32 v137,v137
v_exp_f32 v138,v138
v_exp_f32 v139,v139
v_pk_add_f32 v[124:125],v[124:125],1.0 op_sel_hi:[1,0]
v_pk_add_f32 v[126:127],v[126:127],1.0 op_sel_hi:[1,0]
v_pk_add_f32 v[128:129],v[128:129],1.0 op_sel_hi:[1,0]
v_pk_add_f32 v[130:131],v[130:131],1.0 op_sel_hi:[1,0]
v_pk_add_f32 v[132:133],v[132:133],1.0 op_sel_hi:[1,0]
v_pk_add_f32 v[134:135],v[134:135],1.0 op_sel_hi:[1,0]
v_pk_add_f32 v[136:137],v[136:137],1.0 op_sel_hi:[1,0]
v_pk_add_f32 v[138:139],v[138:139],1.0 op_sel_hi:[1,0]
v_rcp_f32 v124,v124
v_rcp_f32 v125,v125
v_rcp_f32 v126,v126
v_rcp_f32 v127,v127
v_rcp_f32 v128,v128
v_rcp_f32 v129,v129
v_rcp_f32 v130,v130
v_rcp_f32 v131,v131
v_rcp_f32 v132,v132
v_rcp_f32 v133,v133
v_rcp_f32 v134,v134
v_rcp_f32 v135,v135
v_rcp_f32 v136,v136
v_rcp_f32 v137,v137
v_rcp_f32 v138,v138
v_rcp_f32 v139,v139
v_pk_mul_f32 v[56:57],v[56:57],v[124:125]
v_pk_mul_f32 v[58:59],v[58:59],v[126:127]
v_pk_mul_f32 v[60:61],v[60:61],v[128:129]
v_pk_mul_f32 v[62:63],v[62:63],v[130:131]
v_pk_mul_f32 v[64:65],v[64:65],v[132:133]
v_pk_mul_f32 v[66:67],v[66:67],v[134:135]
v_pk_mul_f32 v[68:69],v[68:69],v[136:137]
v_pk_mul_f32 v[70:71],v[70:71],v[138:139]
v_cvt_pk_bf16_f32 v116,v56,v57
v_cvt_pk_bf16_f32 v117,v58,v59
v_cvt_pk_bf16_f32 v118,v60,v61
v_cvt_pk_bf16_f32 v119,v62,v63
v_cvt_pk_bf16_f32 v120,v64,v65
v_cvt_pk_bf16_f32 v121,v66,v67
v_cvt_pk_bf16_f32 v122,v68,v69
v_cvt_pk_bf16_f32 v123,v70,v71
s_cmp_lg_u32 s49,0
s_cbranch_scc0 ls_373
buffer_store_dwordx4 v[116:119],v20,s[8:11],s71 offen sc1
buffer_store_dwordx4 v[120:123],v21,s[8:11],s71 offen sc1
s_branch ls_374
ls_373:
buffer_store_dwordx4 v[116:119],v20,s[8:11],s71 offen
buffer_store_dwordx4 v[120:123],v21,s[8:11],s71 offen
ls_374:
s_mov_b32 s59,s82
s_cmp_eq_u32 s37,0
s_cbranch_scc1 W3_NEXT
s_waitcnt vmcnt(2)
v_cmp_eq_u32 vcc,0,v3
s_and_b64 vcc,vcc,s[76:77]
s_cselect_b32 s37,2147483648,0
s_cmp_lt_u32 s32,128
s_cselect_b32 s37,s37,2147483648
s_cmp_eq_u32 s37,0
s_cbranch_scc1 W3_COLD2
s_waitcnt vmcnt(0)
s_mov_b64 exec,1
s_cmp_lg_u32 s49,0
s_cbranch_scc0 ls_375
buffer_store_dword v5,v1,s[8:11],s59 offen sc1
s_branch ls_376
ls_375:
buffer_store_dword v5,v1,s[8:11],s59 offen
ls_376:
s_mov_b64 exec,-1
s_mov_b32 s59,2147483648
s_cmp_lt_u32 s32,128
s_cbranch_scc1 W3_COLD
s_branch W3_END
sec_372:
s_waitcnt vmcnt(7)
v_cmp_eq_u32 vcc,0,v3
s_and_b64 vcc,vcc,s[76:77]
s_cselect_b32 s37,2147483648,0
s_cmp_lt_u32 s32,128
s_cselect_b32 s37,s37,2147483648
s_cmp_lg_u32 s37,0
s_cbranch_scc1 nr_371
s_sub_u32 s66,46080,s57
s_mul_i32 s60,s33,8
s_and_b32 s61,s34,7
s_add_u32 s60,s60,s61
s_mul_i32 s60,s60,46080
s_add_u32 s60,s60,s37
s_add_u32 s60,s60,212467712
s_mov_b32 s67,s60
s_mul_i32 s61,s46,10240
s_add_u32 s60,s60,s61
s_add_u32 s61,s61,s66
s_add_u32 m0,s61,0
s_add_u32 s63,s60,0
buffer_load_dwordx4 v1,s[8:11],s63 offen sc1 lds
v_pk_fma_f32 v[56:57],v[144:145],v[180:181],v[56:57] op_sel_hi:[1,0,1] neg_lo:[0,1,0] neg_hi:[0,1,0]
v_pk_fma_f32 v[58:59],v[146:147],v[180:181],v[58:59] op_sel_hi:[1,0,1] neg_lo:[0,1,0] neg_hi:[0,1,0]
v_pk_fma_f32 v[60:61],v[148:149],v[180:181],v[60:61] op_sel_hi:[1,0,1] neg_lo:[0,1,0] neg_hi:[0,1,0]
v_pk_fma_f32 v[62:63],v[150:151],v[180:181],v[62:63] op_sel_hi:[1,0,1] neg_lo:[0,1,0] neg_hi:[0,1,0]
v_pk_fma_f32 v[64:65],v[152:153],v[180:181],v[64:65] op_sel_hi:[1,0,1] neg_lo:[0,1,0] neg_hi:[0,1,0]
v_pk_fma_f32 v[66:67],v[154:155],v[180:181],v[66:67] op_sel_hi:[1,0,1] neg_lo:[0,1,0] neg_hi:[0,1,0]
v_pk_fma_f32 v[68:69],v[156:157],v[180:181],v[68:69] op_sel_hi:[1,0,1] neg_lo:[0,1,0] neg_hi:[0,1,0]
v_pk_fma_f32 v[70:71],v[158:159],v[180:181],v[70:71] op_sel_hi:[1,0,1] neg_lo:[0,1,0] neg_hi:[0,1,0]
buffer_load_dwordx4 v1,s[8:11],s63 offen offset:1024 sc1 lds
v_pk_mul_f32 v[56:57],v[56:57],v[180:181] op_sel:[0,1] op_sel_hi:[1,1]
v_pk_mul_f32 v[58:59],v[58:59],v[180:181] op_sel:[0,1] op_sel_hi:[1,1]
v_pk_mul_f32 v[60:61],v[60:61],v[180:181] op_sel:[0,1] op_sel_hi:[1,1]
v_pk_mul_f32 v[62:63],v[62:63],v[180:181] op_sel:[0,1] op_sel_hi:[1,1]
v_pk_mul_f32 v[64:65],v[64:65],v[180:181] op_sel:[0,1] op_sel_hi:[1,1]
v_pk_mul_f32 v[66:67],v[66:67],v[180:181] op_sel:[0,1] op_sel_hi:[1,1]
v_pk_mul_f32 v[68:69],v[68:69],v[180:181] op_sel:[0,1] op_sel_hi:[1,1]
v_pk_mul_f32 v[70:71],v[70:71],v[180:181] op_sel:[0,1] op_sel_hi:[1,1]
buffer_load_dwordx4 v1,s[8:11],s63 offen offset:2048 sc1 lds
v_cvt_pk_bf16_f32 v140,v56,v57
v_lshlrev_b32 v56,16,v140
v_and_b32 v57,0xffff0000,v140
v_cvt_pk_bf16_f32 v140,v58,v59
v_lshlrev_b32 v58,16,v140
v_and_b32 v59,0xffff0000,v140
v_cvt_pk_bf16_f32 v140,v60,v61
v_lshlrev_b32 v60,16,v140
buffer_load_dwordx4 v1,s[8:11],s63 offen offset:3072 sc1 lds
v_and_b32 v61,0xffff0000,v140
v_cvt_pk_bf16_f32 v140,v62,v63
v_lshlrev_b32 v62,16,v140
v_and_b32 v63,0xffff0000,v140
v_cvt_pk_bf16_f32 v140,v64,v65
v_lshlrev_b32 v64,16,v140
v_and_b32 v65,0xffff0000,v140
v_cvt_pk_bf16_f32 v140,v66,v67
s_add_u32 m0,s61,4096
s_add_u32 s63,s60,4096
buffer_load_dwordx4 v1,s[8:11],s63 offen sc1 lds
v_lshlrev_b32 v66,16,v140
v_and_b32 v67,0xffff0000,v140
v_cvt_pk_bf16_f32 v140,v68,v69
v_lshlrev_b32 v68,16,v140
v_and_b32 v69,0xffff0000,v140
v_cvt_pk_bf16_f32 v140,v70,v71
v_lshlrev_b32 v70,16,v140
v_and_b32 v71,0xffff0000,v140
buffer_load_dwordx4 v1,s[8:11],s63 offen offset:1024 sc1 lds
v_pk_mul_f32 v[124:125],v[56:57],v[56:57]
v_pk_mul_f32 v[126:127],v[58:59],v[58:59]
v_pk_mul_f32 v[128:129],v[60:61],v[60:61]
v_pk_mul_f32 v[130:131],v[62:63],v[62:63]
v_pk_mul_f32 v[132:133],v[64:65],v[64:65]
v_pk_mul_f32 v[134:135],v[66:67],v[66:67]
v_pk_mul_f32 v[136:137],v[68:69],v[68:69]
v_pk_mul_f32 v[138:139],v[70:71],v[70:71]
buffer_load_dwordx4 v1,s[8:11],s63 offen offset:2048 sc1 lds
v_pk_fma_f32 v[124:125],v[124:125],v[112:113],v[112:113] op_sel:[0,1,0] op_sel_hi:[1,1,0]
v_pk_fma_f32 v[126:127],v[126:127],v[112:113],v[112:113] op_sel:[0,1,0] op_sel_hi:[1,1,0]
v_pk_fma_f32 v[128:129],v[128:129],v[112:113],v[112:113] op_sel:[0,1,0] op_sel_hi:[1,1,0]
v_pk_fma_f32 v[130:131],v[130:131],v[112:113],v[112:113] op_sel:[0,1,0] op_sel_hi:[1,1,0]
v_pk_fma_f32 v[132:133],v[132:133],v[112:113],v[112:113] op_sel:[0,1,0] op_sel_hi:[1,1,0]
v_pk_fma_f32 v[134:135],v[134:135],v[112:113],v[112:113] op_sel:[0,1,0] op_sel_hi:[1,1,0]
v_pk_fma_f32 v[136:137],v[136:137],v[112:113],v[112:113] op_sel:[0,1,0] op_sel_hi:[1,1,0]
v_pk_fma_f32 v[138:139],v[138:139],v[112:113],v[112:113] op_sel:[0,1,0] op_sel_hi:[1,1,0]
buffer_load_dwordx4 v1,s[8:11],s63 offen offset:3072 sc1 lds
v_pk_mul_f32 v[124:125],v[124:125],v[56:57]
v_pk_mul_f32 v[126:127],v[126:127],v[58:59]
v_pk_mul_f32 v[128:129],v[128:129],v[60:61]
v_pk_mul_f32 v[130:131],v[130:131],v[62:63]
v_pk_mul_f32 v[132:133],v[132:133],v[64:65]
v_pk_mul_f32 v[134:135],v[134:135],v[66:67]
v_pk_mul_f32 v[136:137],v[136:137],v[68:69]
v_pk_mul_f32 v[138:139],v[138:139],v[70:71]
s_add_u32 m0,s61,8192
s_add_u32 s63,s60,8192
buffer_load_dwordx4 v1,s[8:11],s63 offen sc1 lds
v_exp_f32 v124,v124
v_exp_f32 v125,v125
v_exp_f32 v126,v126
v_exp_f32 v127,v127
v_exp_f32 v128,v128
v_exp_f32 v129,v129
v_exp_f32 v130,v130
v_exp_f32 v131,v131
buffer_load_dwordx4 v1,s[8:11],s63 offen offset:1024 sc1 lds
v_exp_f32 v132,v132
v_exp_f32 v133,v133
v_exp_f32 v134,v134
v_exp_f32 v135,v135
v_exp_f32 v136,v136
v_exp_f32 v137,v137
v_exp_f32 v138,v138
v_exp_f32 v139,v139
s_lshl_b32 s62,s46,10
s_add_u32 s62,s62,40960
s_add_u32 m0,s66,s62
s_add_u32 s63,s67,s62
buffer_load_dwordx4 v1,s[8:11],s63 offen sc1 lds
v_pk_add_f32 v[124:125],v[124:125],1.0 op_sel_hi:[1,0]
v_pk_add_f32 v[126:127],v[126:127],1.0 op_sel_hi:[1,0]
v_pk_add_f32 v[128:129],v[128:129],1.0 op_sel_hi:[1,0]
v_pk_add_f32 v[130:131],v[130:131],1.0 op_sel_hi:[1,0]
v_pk_add_f32 v[132:133],v[132:133],1.0 op_sel_hi:[1,0]
v_pk_add_f32 v[134:135],v[134:135],1.0 op_sel_hi:[1,0]
v_pk_add_f32 v[136:137],v[136:137],1.0 op_sel_hi:[1,0]
v_pk_add_f32 v[138:139],v[138:139],1.0 op_sel_hi:[1,0]
s_add_u32 m0,s66,45056
s_add_u32 s63,s67,45056
buffer_load_dwordx4 v1,s[8:11],s63 offen sc1 lds
v_rcp_f32 v124,v124
v_rcp_f32 v125,v125
v_rcp_f32 v126,v126
v_rcp_f32 v127,v127
v_rcp_f32 v128,v128
v_rcp_f32 v129,v129
v_rcp_f32 v130,v130
v_rcp_f32 v131,v131
s_mov_b32 s35,s42
s_mov_b32 s53,s33
s_mov_b32 s54,s34
s_add_u32 s32,s32,1
s_mov_b32 s33,s40
s_mov_b32 s34,s41
s_mov_b64 s[76:77],s[80:81]
v_rcp_f32 v132,v132
v_rcp_f32 v133,v133
v_rcp_f32 v134,v134
v_rcp_f32 v135,v135
v_rcp_f32 v136,v136
v_rcp_f32 v137,v137
v_rcp_f32 v138,v138
v_rcp_f32 v139,v139
v_pk_mul_f32 v[56:57],v[56:57],v[124:125]
v_pk_mul_f32 v[58:59],v[58:59],v[126:127]
v_pk_mul_f32 v[60:61],v[60:61],v[128:129]
v_pk_mul_f32 v[62:63],v[62:63],v[130:131]
v_pk_mul_f32 v[64:65],v[64:65],v[132:133]
v_pk_mul_f32 v[66:67],v[66:67],v[134:135]
v_pk_mul_f32 v[68:69],v[68:69],v[136:137]
v_pk_mul_f32 v[70:71],v[70:71],v[138:139]
v_cvt_pk_bf16_f32 v116,v56,v57
v_cvt_pk_bf16_f32 v117,v58,v59
v_cvt_pk_bf16_f32 v118,v60,v61
v_cvt_pk_bf16_f32 v119,v62,v63
v_cvt_pk_bf16_f32 v120,v64,v65
v_cvt_pk_bf16_f32 v121,v66,v67
v_cvt_pk_bf16_f32 v122,v68,v69
v_cvt_pk_bf16_f32 v123,v70,v71
s_cmp_lg_u32 s49,0
s_cbranch_scc0 ls_377
buffer_store_dwordx4 v[116:119],v20,s[8:11],s71 offen sc1
buffer_store_dwordx4 v[120:123],v21,s[8:11],s71 offen sc1
s_branch ls_378
ls_377:
buffer_store_dwordx4 v[116:119],v20,s[8:11],s71 offen
buffer_store_dwordx4 v[120:123],v21,s[8:11],s71 offen
ls_378:
s_mov_b32 s59,s82
s_branch W3_NEXT
nr_371:
buffer_load_dword v3,v2,s[8:11],s35 offen sc1
s_branch ep_370
W3_END:
s_endpgm
ROLE_W4:
v_lshlrev_b32 v1,4,v0
v_mov_b32 v5,1
s_lshl_b32 s56,s48,2
s_add_u32 s56,s56,s46
v_bfe_u32 v6,v0,2,2
v_lshrrev_b32 v7,4,v0
v_add_u32 v7,v6,v7
v_and_b32 v7,3,v7
v_and_b32 v15,3,v0
v_lshlrev_b32 v15,4,v15
v_lshl_add_u32 v15,v7,6,v15
v_lshl_add_u32 v15,v6,8,v15
v_lshrrev_b32 v6,5,v0
v_bfe_u32 v7,v0,4,1
v_lshlrev_b32 v208,10,v7
v_lshl_add_u32 v208,v6,8,v208
v_and_b32 v6,15,v0
v_lshl_add_u32 v208,v6,4,v208
v_lshrrev_b32 v6,5,v0
v_add_u32 v6,2,v6
v_bfe_u32 v7,v0,4,1
v_lshlrev_b32 v209,10,v7
v_lshl_add_u32 v209,v6,8,v209
v_and_b32 v6,15,v0
v_lshl_add_u32 v209,v6,4,v209
v_min_u32 v2,11,v0
s_mul_i32 s60,s46,12
v_add_u32 v2,s60,v2
v_lshlrev_b32 v2,2,v2
s_and_b32 s60,s46,1
s_lshl_b32 s68,s48,1
s_add_u32 s68,s68,s60
s_lshr_b32 s69,s46,1
s_mul_i32 s71,s46,24576
s_mul_i32 s58,s46,491520
s_lshl_b32 s61,s48,7
s_add_u32 s58,s58,s61
s_add_u32 s71,s71,242778112
v_and_b32 v6,15,v0
v_lshlrev_b32 v204,3,v6
s_lshl_b32 s60,s69,4
v_add_u32 v6,s60,v6
v_mul_u32_u24 v205,1280,v6
v_lshrrev_b32 v6,4,v0
v_lshl_add_u32 v205,v6,3,v205
s_lshl_b32 s60,s68,6
v_add_u32 v205,s60,v205
s_mov_b32 s76,s40
s_mov_b32 s77,s41
s_mov_b32 s78,2621440
s_mov_b32 s79,0x20000
s_lshl_b32 s70,s68,1
s_add_u32 s70,s70,s69
s_lshl_b32 s70,s70,10
v_bfe_u32 v6,v0,4,1
v_lshlrev_b32 v206,14,v6
v_lshrrev_b32 v6,5,v0
v_lshl_add_u32 v206,v6,8,v206
v_and_b32 v6,15,v0
v_lshl_add_u32 v206,v6,4,v206
s_lshl_b32 s60,s46,11
v_add_u32 v206,s60,v206
s_lshl_b32 s60,s46,13
v_add_u32 v207,s60,v1
s_waitcnt vmcnt(0)
s_barrier
s_cmp_lg_u32 s46,0
s_cbranch_scc1 arr_379
v_mov_b32 v6,1
s_lshl_b32 s3,s49,2
v_mov_b32 v7,s3
s_mov_b64 exec,1
buffer_atomic_add v6,v7,s[12:15],0 offen sc1
s_mov_b64 exec,-1
arr_379:
s_mul_i32 s63,s46,40960
s_mov_b32 s4,s38
s_mov_b32 s5,s39
s_mov_b32 s6,1966080
s_mov_b32 s7,0x20000
v_lshrrev_b32 v9,3,v0
s_mov_b32 s64,1280
v_mul_lo_u32 v9,v9,s64
v_and_b32 v10,7,v0
v_lshl_add_u32 v6,v10,4,v9
s_add_u32 m0,s63,0
s_add_u32 s65,s58,0
buffer_load_dwordx4 v6,s[4:7],s65 offen lds
s_add_u32 m0,s63,1024
s_add_u32 s65,s58,10240
buffer_load_dwordx4 v6,s[4:7],s65 offen lds
s_add_u32 m0,s63,2048
s_add_u32 s65,s58,20480
buffer_load_dwordx4 v6,s[4:7],s65 offen lds
s_add_u32 m0,s63,3072
s_add_u32 s65,s58,30720
buffer_load_dwordx4 v6,s[4:7],s65 offen lds
s_add_u32 m0,s63,4096
s_add_u32 s65,s58,40960
buffer_load_dwordx4 v6,s[4:7],s65 offen lds
s_add_u32 m0,s63,5120
s_add_u32 s65,s58,51200
buffer_load_dwordx4 v6,s[4:7],s65 offen lds
s_add_u32 m0,s63,6144
s_add_u32 s65,s58,61440
buffer_load_dwordx4 v6,s[4:7],s65 offen lds
s_add_u32 m0,s63,7168
s_add_u32 s65,s58,71680
buffer_load_dwordx4 v6,s[4:7],s65 offen lds
s_add_u32 m0,s63,8192
s_add_u32 s65,s58,81920
buffer_load_dwordx4 v6,s[4:7],s65 offen lds
s_add_u32 m0,s63,9216
s_add_u32 s65,s58,92160
buffer_load_dwordx4 v6,s[4:7],s65 offen lds
s_add_u32 m0,s63,10240
s_add_u32 s65,s58,102400
buffer_load_dwordx4 v6,s[4:7],s65 offen lds
s_add_u32 m0,s63,11264
s_add_u32 s65,s58,112640
buffer_load_dwordx4 v6,s[4:7],s65 offen lds
s_add_u32 m0,s63,12288
s_add_u32 s65,s58,122880
buffer_load_dwordx4 v6,s[4:7],s65 offen lds
s_add_u32 m0,s63,13312
s_add_u32 s65,s58,133120
buffer_load_dwordx4 v6,s[4:7],s65 offen lds
s_add_u32 m0,s63,14336
s_add_u32 s65,s58,143360
buffer_load_dwordx4 v6,s[4:7],s65 offen lds
s_add_u32 m0,s63,15360
s_add_u32 s65,s58,153600
buffer_load_dwordx4 v6,s[4:7],s65 offen lds
s_add_u32 m0,s63,16384
s_add_u32 s65,s58,163840
buffer_load_dwordx4 v6,s[4:7],s65 offen lds
s_add_u32 m0,s63,17408
s_add_u32 s65,s58,174080
buffer_load_dwordx4 v6,s[4:7],s65 offen lds
s_add_u32 m0,s63,18432
s_add_u32 s65,s58,184320
buffer_load_dwordx4 v6,s[4:7],s65 offen lds
s_add_u32 m0,s63,19456
s_add_u32 s65,s58,194560
buffer_load_dwordx4 v6,s[4:7],s65 offen lds
s_add_u32 m0,s63,20480
s_add_u32 s65,s58,204800
buffer_load_dwordx4 v6,s[4:7],s65 offen lds
s_add_u32 m0,s63,21504
s_add_u32 s65,s58,215040
buffer_load_dwordx4 v6,s[4:7],s65 offen lds
s_add_u32 m0,s63,22528
s_add_u32 s65,s58,225280
buffer_load_dwordx4 v6,s[4:7],s65 offen lds
s_add_u32 m0,s63,23552
s_add_u32 s65,s58,235520
buffer_load_dwordx4 v6,s[4:7],s65 offen lds
s_add_u32 m0,s63,24576
s_add_u32 s65,s58,245760
buffer_load_dwordx4 v6,s[4:7],s65 offen lds
s_add_u32 m0,s63,25600
s_add_u32 s65,s58,256000
buffer_load_dwordx4 v6,s[4:7],s65 offen lds
s_add_u32 m0,s63,26624
s_add_u32 s65,s58,266240
buffer_load_dwordx4 v6,s[4:7],s65 offen lds
s_add_u32 m0,s63,27648
s_add_u32 s65,s58,276480
buffer_load_dwordx4 v6,s[4:7],s65 offen lds
s_add_u32 m0,s63,28672
s_add_u32 s65,s58,286720
buffer_load_dwordx4 v6,s[4:7],s65 offen lds
s_add_u32 m0,s63,29696
s_add_u32 s65,s58,296960
buffer_load_dwordx4 v6,s[4:7],s65 offen lds
s_add_u32 m0,s63,30720
s_add_u32 s65,s58,307200
buffer_load_dwordx4 v6,s[4:7],s65 offen lds
s_add_u32 m0,s63,31744
s_add_u32 s65,s58,317440
buffer_load_dwordx4 v6,s[4:7],s65 offen lds
s_add_u32 m0,s63,32768
s_add_u32 s65,s58,327680
buffer_load_dwordx4 v6,s[4:7],s65 offen lds
s_add_u32 m0,s63,33792
s_add_u32 s65,s58,337920
buffer_load_dwordx4 v6,s[4:7],s65 offen lds
s_add_u32 m0,s63,34816
s_add_u32 s65,s58,348160
buffer_load_dwordx4 v6,s[4:7],s65 offen lds
s_add_u32 m0,s63,35840
s_add_u32 s65,s58,358400
buffer_load_dwordx4 v6,s[4:7],s65 offen lds
s_add_u32 m0,s63,36864
s_add_u32 s65,s58,368640
buffer_load_dwordx4 v6,s[4:7],s65 offen lds
s_add_u32 m0,s63,37888
s_add_u32 s65,s58,378880
buffer_load_dwordx4 v6,s[4:7],s65 offen lds
s_add_u32 m0,s63,38912
s_add_u32 s65,s58,389120
buffer_load_dwordx4 v6,s[4:7],s65 offen lds
s_add_u32 m0,s63,39936
s_add_u32 s65,s58,399360
buffer_load_dwordx4 v6,s[4:7],s65 offen lds
s_waitcnt vmcnt(20)
v_bfe_u32 v9,v0,2,2
v_lshrrev_b32 v10,5,v0
v_lshl_add_u32 v9,v10,2,v9
v_mul_u32_u24 v9,128,v9
v_and_b32 v10,1,v0
v_lshl_add_u32 v9,v10,3,v9
v_bfe_u32 v10,v0,1,1
v_lshl_add_u32 v9,v10,5,v9
v_bfe_u32 v10,v0,4,1
v_lshl_add_u32 v9,v10,4,v9
v_add_u32 v7,s63,v9
ds_read_b64_tr_b16 a[0:1],v7 offset:0
ds_read_b64_tr_b16 a[2:3],v7 offset:2048
ds_read_b64_tr_b16 a[4:5],v7 offset:1024
ds_read_b64_tr_b16 a[6:7],v7 offset:3072
ds_read_b64_tr_b16 a[96:97],v7 offset:64
ds_read_b64_tr_b16 a[98:99],v7 offset:2112
ds_read_b64_tr_b16 a[100:101],v7 offset:1088
ds_read_b64_tr_b16 a[102:103],v7 offset:3136
ds_read_b64_tr_b16 a[8:9],v7 offset:4096
ds_read_b64_tr_b16 a[10:11],v7 offset:6144
ds_read_b64_tr_b16 a[12:13],v7 offset:5120
ds_read_b64_tr_b16 a[14:15],v7 offset:7168
s_waitcnt lgkmcnt(4)
ds_read_b64_tr_b16 a[104:105],v7 offset:4160
ds_read_b64_tr_b16 a[106:107],v7 offset:6208
ds_read_b64_tr_b16 a[108:109],v7 offset:5184
ds_read_b64_tr_b16 a[110:111],v7 offset:7232
ds_read_b64_tr_b16 a[16:17],v7 offset:8192
ds_read_b64_tr_b16 a[18:19],v7 offset:10240
ds_read_b64_tr_b16 a[20:21],v7 offset:9216
ds_read_b64_tr_b16 a[22:23],v7 offset:11264
ds_read_b64_tr_b16 a[112:113],v7 offset:8256
ds_read_b64_tr_b16 a[114:115],v7 offset:10304
ds_read_b64_tr_b16 a[116:117],v7 offset:9280
ds_read_b64_tr_b16 a[118:119],v7 offset:11328
s_waitcnt lgkmcnt(4)
ds_read_b64_tr_b16 a[24:25],v7 offset:12288
ds_read_b64_tr_b16 a[26:27],v7 offset:14336
ds_read_b64_tr_b16 a[28:29],v7 offset:13312
ds_read_b64_tr_b16 a[30:31],v7 offset:15360
ds_read_b64_tr_b16 a[120:121],v7 offset:12352
ds_read_b64_tr_b16 a[122:123],v7 offset:14400
ds_read_b64_tr_b16 a[124:125],v7 offset:13376
ds_read_b64_tr_b16 a[126:127],v7 offset:15424
ds_read_b64_tr_b16 a[32:33],v7 offset:16384
ds_read_b64_tr_b16 a[34:35],v7 offset:18432
ds_read_b64_tr_b16 a[36:37],v7 offset:17408
ds_read_b64_tr_b16 a[38:39],v7 offset:19456
s_waitcnt lgkmcnt(4)
ds_read_b64_tr_b16 a[128:129],v7 offset:16448
ds_read_b64_tr_b16 a[130:131],v7 offset:18496
ds_read_b64_tr_b16 a[132:133],v7 offset:17472
ds_read_b64_tr_b16 a[134:135],v7 offset:19520
s_waitcnt lgkmcnt(0)
s_add_u32 m0,s63,0
s_add_u32 s65,s58,409600
buffer_load_dwordx4 v6,s[4:7],s65 offen lds
s_add_u32 m0,s63,1024
s_add_u32 s65,s58,419840
buffer_load_dwordx4 v6,s[4:7],s65 offen lds
s_add_u32 m0,s63,2048
s_add_u32 s65,s58,430080
buffer_load_dwordx4 v6,s[4:7],s65 offen lds
s_add_u32 m0,s63,3072
s_add_u32 s65,s58,440320
buffer_load_dwordx4 v6,s[4:7],s65 offen lds
s_add_u32 m0,s63,4096
s_add_u32 s65,s58,450560
buffer_load_dwordx4 v6,s[4:7],s65 offen lds
s_add_u32 m0,s63,5120
s_add_u32 s65,s58,460800
buffer_load_dwordx4 v6,s[4:7],s65 offen lds
s_add_u32 m0,s63,6144
s_add_u32 s65,s58,471040
buffer_load_dwordx4 v6,s[4:7],s65 offen lds
s_add_u32 m0,s63,7168
s_add_u32 s65,s58,481280
buffer_load_dwordx4 v6,s[4:7],s65 offen lds
s_waitcnt vmcnt(8)
v_bfe_u32 v9,v0,2,2
v_lshrrev_b32 v10,5,v0
v_lshl_add_u32 v9,v10,2,v9
v_mul_u32_u24 v9,128,v9
v_and_b32 v10,1,v0
v_lshl_add_u32 v9,v10,3,v9
v_bfe_u32 v10,v0,1,1
v_lshl_add_u32 v9,v10,5,v9
v_bfe_u32 v10,v0,4,1
v_lshl_add_u32 v9,v10,4,v9
v_add_u32 v7,s63,v9
ds_read_b64_tr_b16 a[40:41],v7 offset:20480
ds_read_b64_tr_b16 a[42:43],v7 offset:22528
ds_read_b64_tr_b16 a[44:45],v7 offset:21504
ds_read_b64_tr_b16 a[46:47],v7 offset:23552
ds_read_b64_tr_b16 a[136:137],v7 offset:20544
ds_read_b64_tr_b16 a[138:139],v7 offset:22592
ds_read_b64_tr_b16 a[140:141],v7 offset:21568
ds_read_b64_tr_b16 a[142:143],v7 offset:23616
ds_read_b64_tr_b16 a[48:49],v7 offset:24576
ds_read_b64_tr_b16 a[50:51],v7 offset:26624
ds_read_b64_tr_b16 a[52:53],v7 offset:25600
ds_read_b64_tr_b16 a[54:55],v7 offset:27648
s_waitcnt lgkmcnt(4)
ds_read_b64_tr_b16 a[144:145],v7 offset:24640
ds_read_b64_tr_b16 a[146:147],v7 offset:26688
ds_read_b64_tr_b16 a[148:149],v7 offset:25664
ds_read_b64_tr_b16 a[150:151],v7 offset:27712
ds_read_b64_tr_b16 a[56:57],v7 offset:28672
ds_read_b64_tr_b16 a[58:59],v7 offset:30720
ds_read_b64_tr_b16 a[60:61],v7 offset:29696
ds_read_b64_tr_b16 a[62:63],v7 offset:31744
ds_read_b64_tr_b16 a[152:153],v7 offset:28736
ds_read_b64_tr_b16 a[154:155],v7 offset:30784
ds_read_b64_tr_b16 a[156:157],v7 offset:29760
ds_read_b64_tr_b16 a[158:159],v7 offset:31808
s_waitcnt lgkmcnt(4)
ds_read_b64_tr_b16 a[64:65],v7 offset:32768
ds_read_b64_tr_b16 a[66:67],v7 offset:34816
ds_read_b64_tr_b16 a[68:69],v7 offset:33792
ds_read_b64_tr_b16 a[70:71],v7 offset:35840
ds_read_b64_tr_b16 a[160:161],v7 offset:32832
ds_read_b64_tr_b16 a[162:163],v7 offset:34880
ds_read_b64_tr_b16 a[164:165],v7 offset:33856
ds_read_b64_tr_b16 a[166:167],v7 offset:35904
ds_read_b64_tr_b16 a[72:73],v7 offset:36864
ds_read_b64_tr_b16 a[74:75],v7 offset:38912
ds_read_b64_tr_b16 a[76:77],v7 offset:37888
ds_read_b64_tr_b16 a[78:79],v7 offset:39936
s_waitcnt lgkmcnt(4)
ds_read_b64_tr_b16 a[168:169],v7 offset:36928
ds_read_b64_tr_b16 a[170:171],v7 offset:38976
ds_read_b64_tr_b16 a[172:173],v7 offset:37952
ds_read_b64_tr_b16 a[174:175],v7 offset:40000
s_waitcnt lgkmcnt(0)
s_waitcnt vmcnt(0)
v_bfe_u32 v9,v0,2,2
v_lshrrev_b32 v10,5,v0
v_lshl_add_u32 v9,v10,2,v9
v_mul_u32_u24 v9,128,v9
v_and_b32 v10,1,v0
v_lshl_add_u32 v9,v10,3,v9
v_bfe_u32 v10,v0,1,1
v_lshl_add_u32 v9,v10,5,v9
v_bfe_u32 v10,v0,4,1
v_lshl_add_u32 v9,v10,4,v9
v_add_u32 v7,s63,v9
ds_read_b64_tr_b16 a[80:81],v7 offset:0
ds_read_b64_tr_b16 a[82:83],v7 offset:2048
ds_read_b64_tr_b16 a[84:85],v7 offset:1024
ds_read_b64_tr_b16 a[86:87],v7 offset:3072
ds_read_b64_tr_b16 a[176:177],v7 offset:64
ds_read_b64_tr_b16 a[178:179],v7 offset:2112
ds_read_b64_tr_b16 a[180:181],v7 offset:1088
ds_read_b64_tr_b16 a[182:183],v7 offset:3136
ds_read_b64_tr_b16 a[88:89],v7 offset:4096
ds_read_b64_tr_b16 a[90:91],v7 offset:6144
ds_read_b64_tr_b16 a[92:93],v7 offset:5120
ds_read_b64_tr_b16 a[94:95],v7 offset:7168
s_waitcnt lgkmcnt(4)
ds_read_b64_tr_b16 a[184:185],v7 offset:4160
ds_read_b64_tr_b16 a[186:187],v7 offset:6208
ds_read_b64_tr_b16 a[188:189],v7 offset:5184
ds_read_b64_tr_b16 a[190:191],v7 offset:7232
s_waitcnt lgkmcnt(0)
s_barrier
s_lshl_b32 s3,s49,2
v_mov_b32 v7,s3
s_nop 1
ibw_380:
buffer_load_dword v6,v7,s[12:15],0 offen sc1
s_waitcnt vmcnt(0)
v_cmp_ne_u32 vcc,256,v6
s_nop 0
s_cbranch_vccz ok_381
s_sleep 8
s_sub_u32 s47,s47,1
s_cbranch_scc1 ABORT
s_branch ibw_380
ok_381:
s_cmp_lg_u32 s49,0
s_cbranch_scc1 ibok_382
v_and_b32 v7,7,v0
v_lshlrev_b32 v7,2,v7
buffer_load_dword v6,v7,s[12:15],0 offen offset:32 sc1
s_waitcnt vmcnt(0)
v_cmp_ne_u32 vcc,32,v6
s_nop 0
s_cbranch_vccz ibok_382
s_barrier
s_mov_b32 s49,1
s_mov_b32 s3,s2
s_load_dwordx16 s[16:31],s[0:1],0
s_load_dwordx8 s[32:39],s[0:1],64
s_waitcnt lgkmcnt(0)
s_branch DISPATCH
ibok_382:
s_mov_b32 s83,s100
s_mov_b32 s32,0
s_mov_b32 s59,2147483648
s_min_u32 s62,s32,127
s_sub_u32 s60,s62,13
s_lshr_b32 s34,s60,1
s_and_b32 s33,s60,1
s_cmp_eq_u32 s33,0
s_cselect_b32 s61,13,0
s_add_u32 s34,s34,s61
s_sub_u32 s61,s60,51
s_cmp_ge_u32 s60,102
s_cselect_b32 s34,s61,s34
s_cselect_b32 s33,1,s33
s_cmp_lt_u32 s62,13
s_cselect_b32 s34,s62,s34
s_cselect_b32 s33,0,s33
s_lshl_b32 s35,s33,6
s_add_u32 s35,s35,s34
s_lshl_b32 s35,s35,9
s_add_u32 s35,s35,589824
s_and_b32 s60,s34,3
s_lshl2_add_u32 s60,s33,s60
s_mul_i32 s73,s60,98304
s_add_u32 s73,s73,s71
W4_COLD:
fb_383:
buffer_load_dword v3,v2,s[8:11],s35 offen sc1
s_waitcnt vmcnt(0)
v_cmp_eq_u32 vcc,0,v3
s_nop 0
s_cbranch_vccz ok_384
s_sleep 2
s_sub_u32 s47,s47,1
s_cbranch_scc1 ABORT
s_branch fb_383
ok_384:
s_add_u32 s63,s73,0
buffer_load_dwordx4 v[16:19],v208,s[8:11],s63 offen sc1
s_nop 7
buffer_load_dwordx4 v[20:23],v209,s[8:11],s63 offen sc1
s_nop 7
buffer_load_dwordx4 v[24:27],v208,s[8:11],s63 offen offset:2048 sc1
s_nop 7
buffer_load_dwordx4 v[28:31],v209,s[8:11],s63 offen offset:2048 sc1
s_nop 7
s_add_u32 s63,s73,4096
buffer_load_dwordx4 v[32:35],v208,s[8:11],s63 offen sc1
s_nop 7
buffer_load_dwordx4 v[36:39],v209,s[8:11],s63 offen sc1
s_nop 7
buffer_load_dwordx4 v[40:43],v208,s[8:11],s63 offen offset:2048 sc1
s_nop 7
buffer_load_dwordx4 v[44:47],v209,s[8:11],s63 offen offset:2048 sc1
s_nop 7
s_add_u32 s63,s73,8192
buffer_load_dwordx4 v[48:51],v208,s[8:11],s63 offen sc1
s_nop 7
buffer_load_dwordx4 v[52:55],v209,s[8:11],s63 offen sc1
W4_NEXT:
s_mov_b32 s51,s33
s_mov_b32 s52,s34
s_mov_b32 s72,s73
s_add_u32 s32,s32,1
s_waitcnt vmcnt(9)
v_mfma_f32_32x32x16_bf16 v[112:127],a[0:3],v[16:19],0
s_add_u32 s63,s72,8192
buffer_load_dwordx4 v[56:59],v208,s[8:11],s63 offen offset:2048 sc1
s_min_u32 s62,s32,127
s_sub_u32 s60,s62,13
s_lshr_b32 s34,s60,1
v_mfma_f32_32x32x16_bf16 v[128:143],a[96:99],v[16:19],0
s_and_b32 s33,s60,1
s_cmp_eq_u32 s33,0
s_cselect_b32 s61,13,0
s_add_u32 s34,s34,s61
s_sub_u32 s61,s60,51
v_xor_b32 v206,0x8000,v206
s_waitcnt vmcnt(9)
v_mfma_f32_32x32x16_bf16 v[112:127],a[4:7],v[20:23],v[112:127]
buffer_load_dwordx4 v[60:63],v209,s[8:11],s63 offen offset:2048 sc1
s_cmp_ge_u32 s60,102
s_cselect_b32 s34,s61,s34
s_cselect_b32 s33,1,s33
v_xor_b32 v207,0x8000,v207
v_mfma_f32_32x32x16_bf16 v[128:143],a[100:103],v[20:23],v[128:143]
s_cmp_lt_u32 s62,13
s_cselect_b32 s34,s62,s34
s_cselect_b32 s33,0,s33
s_lshl_b32 s35,s33,6
s_add_u32 s35,s35,s34
s_lshl_b32 s35,s35,9
s_waitcnt vmcnt(9)
v_mfma_f32_32x32x16_bf16 v[112:127],a[8:11],v[24:27],v[112:127]
s_add_u32 s63,s72,12288
buffer_load_dwordx4 v[64:67],v208,s[8:11],s63 offen sc1
s_add_u32 s35,s35,589824
s_and_b32 s60,s34,3
s_lshl2_add_u32 s60,s33,s60
v_mfma_f32_32x32x16_bf16 v[128:143],a[104:107],v[24:27],v[128:143]
s_mul_i32 s73,s60,98304
s_add_u32 s73,s73,s71
buffer_load_dword v3,v2,s[8:11],s35 offen sc1
s_lshl_b32 s64,s51,6
s_add_u32 s64,s64,s52
s_waitcnt vmcnt(10)
v_mfma_f32_32x32x16_bf16 v[112:127],a[12:15],v[28:31],v[112:127]
buffer_load_dwordx4 v[68:71],v209,s[8:11],s63 offen sc1
s_and_b32 s65,s52,7
s_lshl3_add_u32 s65,s51,s65
s_lshl_b32 s82,s64,9
s_lshl2_add_u32 s82,s56,s82
v_mfma_f32_32x32x16_bf16 v[128:143],a[108:111],v[28:31],v[128:143]
s_add_u32 s82,s82,327680
s_mul_i32 s65,s65,46080
s_add_u32 s65,s65,s70
s_add_u32 s65,s65,212467712
buffer_load_dwordx4 v[176:179],v1,s[8:11],s65 offen sc1
s_waitcnt vmcnt(11)
v_mfma_f32_32x32x16_bf16 v[112:127],a[16:19],v[32:35],v[112:127]
buffer_load_dwordx4 v[72:75],v208,s[8:11],s63 offen offset:2048 sc1
s_mul_i32 s65,s64,40960
s_add_u32 s65,s65,s70
s_add_u32 s65,s65,218365952
v_mfma_f32_32x32x16_bf16 v[128:143],a[112:115],v[32:35],v[128:143]
s_waitcnt vmcnt(11)
v_mfma_f32_32x32x16_bf16 v[112:127],a[20:23],v[36:39],v[112:127]
buffer_load_dwordx4 v[76:79],v209,s[8:11],s63 offen offset:2048 sc1
v_mfma_f32_32x32x16_bf16 v[128:143],a[116:119],v[36:39],v[128:143]
s_waitcnt vmcnt(11)
v_mfma_f32_32x32x16_bf16 v[112:127],a[24:27],v[40:43],v[112:127]
s_add_u32 s63,s72,16384
buffer_load_dwordx4 v[80:83],v208,s[8:11],s63 offen sc1
v_mfma_f32_32x32x16_bf16 v[128:143],a[120:123],v[40:43],v[128:143]
s_waitcnt vmcnt(11)
v_mfma_f32_32x32x16_bf16 v[112:127],a[28:31],v[44:47],v[112:127]
buffer_load_dwordx4 v[84:87],v209,s[8:11],s63 offen sc1
v_mfma_f32_32x32x16_bf16 v[128:143],a[124:127],v[44:47],v[128:143]
s_waitcnt vmcnt(11)
v_mfma_f32_32x32x16_bf16 v[112:127],a[32:35],v[48:51],v[112:127]
buffer_load_dwordx4 v[88:91],v208,s[8:11],s63 offen offset:2048 sc1
v_mfma_f32_32x32x16_bf16 v[128:143],a[128:131],v[48:51],v[128:143]
s_waitcnt vmcnt(11)
v_mfma_f32_32x32x16_bf16 v[112:127],a[36:39],v[52:55],v[112:127]
buffer_load_dwordx4 v[92:95],v209,s[8:11],s63 offen offset:2048 sc1
v_mfma_f32_32x32x16_bf16 v[128:143],a[132:135],v[52:55],v[128:143]
s_waitcnt vmcnt(11)
v_mfma_f32_32x32x16_bf16 v[112:127],a[40:43],v[56:59],v[112:127]
s_add_u32 s63,s72,20480
buffer_load_dwordx4 v[96:99],v208,s[8:11],s63 offen sc1
v_mfma_f32_32x32x16_bf16 v[128:143],a[136:139],v[56:59],v[128:143]
s_waitcnt vmcnt(11)
v_mfma_f32_32x32x16_bf16 v[112:127],a[44:47],v[60:63],v[112:127]
buffer_load_dwordx4 v[100:103],v209,s[8:11],s63 offen sc1
v_mfma_f32_32x32x16_bf16 v[128:143],a[140:143],v[60:63],v[128:143]
s_waitcnt vmcnt(11)
v_mfma_f32_32x32x16_bf16 v[112:127],a[48:51],v[64:67],v[112:127]
buffer_load_dwordx4 v[104:107],v208,s[8:11],s63 offen offset:2048 sc1
v_mfma_f32_32x32x16_bf16 v[128:143],a[144:147],v[64:67],v[128:143]
s_waitcnt vmcnt(11)
v_cmp_eq_u32 vcc,0,v3
s_cmp_eq_u64 vcc,0
s_cselect_b32 s37,0,2147483648
s_cmp_lt_u32 s32,128
s_cselect_b32 s37,s37,2147483648
s_waitcnt vmcnt(10)
v_mfma_f32_32x32x16_bf16 v[112:127],a[52:55],v[68:71],v[112:127]
buffer_load_dwordx4 v[108:111],v209,s[8:11],s63 offen offset:2048 sc1
s_add_u32 s67,s73,s37
v_mfma_f32_32x32x16_bf16 v[128:143],a[148:151],v[68:71],v[128:143]
s_mov_b64 exec,1
buffer_store_dword v5,v1,s[8:11],s59 offen sc1
s_mov_b64 exec,-1
s_mov_b32 s59,2147483648
s_waitcnt vmcnt(10)
v_mfma_f32_32x32x16_bf16 v[112:127],a[56:59],v[72:75],v[112:127]
s_add_u32 s63,s67,0
buffer_load_dwordx4 v[16:19],v208,s[8:11],s63 offen sc1
buffer_load_dwordx4 v[180:183],v15,s[8:11],s65 offen sc1
v_mfma_f32_32x32x16_bf16 v[128:143],a[152:155],v[72:75],v[128:143]
s_waitcnt vmcnt(11)
v_mfma_f32_32x32x16_bf16 v[112:127],a[60:63],v[76:79],v[112:127]
buffer_load_dwordx4 v[20:23],v209,s[8:11],s63 offen sc1
v_mfma_f32_32x32x16_bf16 v[128:143],a[156:159],v[76:79],v[128:143]
s_waitcnt vmcnt(11)
v_mfma_f32_32x32x16_bf16 v[112:127],a[64:67],v[80:83],v[112:127]
buffer_load_dwordx4 v[24:27],v208,s[8:11],s63 offen offset:2048 sc1
v_mfma_f32_32x32x16_bf16 v[128:143],a[160:163],v[80:83],v[128:143]
s_waitcnt vmcnt(11)
v_mfma_f32_32x32x16_bf16 v[112:127],a[68:71],v[84:87],v[112:127]
buffer_load_dwordx4 v[28:31],v209,s[8:11],s63 offen offset:2048 sc1
v_mfma_f32_32x32x16_bf16 v[128:143],a[164:167],v[84:87],v[128:143]
s_waitcnt vmcnt(11)
v_mfma_f32_32x32x16_bf16 v[112:127],a[72:75],v[88:91],v[112:127]
s_add_u32 s63,s67,4096
buffer_load_dwordx4 v[32:35],v208,s[8:11],s63 offen sc1
buffer_load_dword v3,v2,s[8:11],s35 offen sc1
v_mfma_f32_32x32x16_bf16 v[128:143],a[168:171],v[88:91],v[128:143]
s_waitcnt vmcnt(12)
v_mfma_f32_32x32x16_bf16 v[112:127],a[76:79],v[92:95],v[112:127]
buffer_load_dwordx4 v[36:39],v209,s[8:11],s63 offen sc1
v_mfma_f32_32x32x16_bf16 v[128:143],a[172:175],v[92:95],v[128:143]
s_waitcnt vmcnt(12)
v_mfma_f32_32x32x16_bf16 v[112:127],a[80:83],v[96:99],v[112:127]
buffer_load_dwordx4 v[40:43],v208,s[8:11],s63 offen offset:2048 sc1
v_mfma_f32_32x32x16_bf16 v[128:143],a[176:179],v[96:99],v[128:143]
s_waitcnt vmcnt(12)
v_mfma_f32_32x32x16_bf16 v[112:127],a[84:87],v[100:103],v[112:127]
buffer_load_dwordx4 v[44:47],v209,s[8:11],s63 offen offset:2048 sc1
v_mfma_f32_32x32x16_bf16 v[128:143],a[180:183],v[100:103],v[128:143]
s_waitcnt vmcnt(12)
v_mfma_f32_32x32x16_bf16 v[112:127],a[88:91],v[104:107],v[112:127]
s_add_u32 s63,s67,8192
buffer_load_dwordx4 v[48:51],v208,s[8:11],s63 offen sc1
v_mfma_f32_32x32x16_bf16 v[128:143],a[184:187],v[104:107],v[128:143]
s_waitcnt vmcnt(12)
v_mfma_f32_32x32x16_bf16 v[112:127],a[92:95],v[108:111],v[112:127]
buffer_load_dwordx4 v[52:55],v209,s[8:11],s63 offen sc1
v_mfma_f32_32x32x16_bf16 v[128:143],a[188:191],v[108:111],v[128:143]
s_cmp_eq_u32 s37,0
s_cbranch_scc1 ep_385
s_waitcnt vmcnt(0)
v_cmp_eq_u32 vcc,0,v3
s_cmp_eq_u64 vcc,0
s_cselect_b32 s37,0,2147483648
s_cmp_lt_u32 s32,128
s_cselect_b32 s37,s37,2147483648
s_cmp_lg_u32 s37,0
s_cbranch_scc1 ep_385
s_add_u32 s63,s73,0
buffer_load_dwordx4 v[16:19],v208,s[8:11],s63 offen sc1
buffer_load_dwordx4 v[20:23],v209,s[8:11],s63 offen sc1
buffer_load_dwordx4 v[24:27],v208,s[8:11],s63 offen offset:2048 sc1
buffer_load_dwordx4 v[28:31],v209,s[8:11],s63 offen offset:2048 sc1
s_add_u32 s63,s73,4096
buffer_load_dwordx4 v[32:35],v208,s[8:11],s63 offen sc1
buffer_load_dwordx4 v[36:39],v209,s[8:11],s63 offen sc1
buffer_load_dwordx4 v[40:43],v208,s[8:11],s63 offen offset:2048 sc1
buffer_load_dwordx4 v[44:47],v209,s[8:11],s63 offen offset:2048 sc1
s_add_u32 s63,s73,8192
buffer_load_dwordx4 v[48:51],v208,s[8:11],s63 offen sc1
buffer_load_dwordx4 v[52:55],v209,s[8:11],s63 offen sc1
ep_385:
s_nop 7
ds_write_b128 v206,v[112:115] offset:0
ds_write_b128 v206,v[116:119] offset:1024
ds_write_b128 v206,v[120:123] offset:512
ds_write_b128 v206,v[124:127] offset:1536
s_nop 0
ds_write_b128 v206,v[128:131] offset:8192
ds_write_b128 v206,v[132:135] offset:9216
ds_write_b128 v206,v[136:139] offset:8704
ds_write_b128 v206,v[140:143] offset:9728
s_waitcnt vmcnt(10)
s_mov_b64 exec,1
s_cmp_lg_u32 s49,0
s_cbranch_scc0 ls_386
buffer_store_dword v5,v1,s[8:11],s82 offen sc1
s_branch ls_387
ls_386:
buffer_store_dword v5,v1,s[8:11],s82 offen
ls_387:
s_mov_b64 exec,-1
v_lshlrev_b32 v184,16,v176
v_and_b32 v185,0xffff0000,v176
v_lshlrev_b32 v186,16,v177
v_and_b32 v187,0xffff0000,v177
v_lshlrev_b32 v188,16,v178
v_and_b32 v189,0xffff0000,v178
v_lshlrev_b32 v190,16,v179
v_and_b32 v191,0xffff0000,v179
v_lshlrev_b32 v192,16,v180
v_and_b32 v193,0xffff0000,v180
v_lshlrev_b32 v194,16,v181
v_and_b32 v195,0xffff0000,v181
v_lshlrev_b32 v196,16,v182
v_and_b32 v197,0xffff0000,v182
v_lshlrev_b32 v198,16,v183
v_and_b32 v199,0xffff0000,v183
s_waitcnt lgkmcnt(0)
s_barrier
ds_read_b128 v[144:147],v207 offset:0
ds_read_b128 v[148:151],v207 offset:1024
ds_read_b128 v[152:155],v207 offset:2048
ds_read_b128 v[156:159],v207 offset:3072
ds_read_b128 v[160:163],v207 offset:4096
ds_read_b128 v[164:167],v207 offset:5120
ds_read_b128 v[168:171],v207 offset:6144
ds_read_b128 v[172:175],v207 offset:7168
s_waitcnt lgkmcnt(4)
v_pk_add_f32 v[144:145],v[144:145],v[152:153]
v_pk_add_f32 v[146:147],v[146:147],v[154:155]
v_pk_add_f32 v[148:149],v[148:149],v[156:157]
v_pk_add_f32 v[150:151],v[150:151],v[158:159]
s_waitcnt lgkmcnt(0)
v_pk_add_f32 v[160:161],v[160:161],v[168:169]
v_pk_add_f32 v[162:163],v[162:163],v[170:171]
v_pk_add_f32 v[164:165],v[164:165],v[172:173]
v_pk_add_f32 v[166:167],v[166:167],v[174:175]
v_pk_add_f32 v[144:145],v[144:145],v[160:161]
v_pk_add_f32 v[146:147],v[146:147],v[162:163]
v_pk_add_f32 v[148:149],v[148:149],v[164:165]
v_pk_add_f32 v[150:151],v[150:151],v[166:167]
v_cvt_pk_bf16_f32 v6,v144,v145
v_lshlrev_b32 v144,16,v6
v_and_b32 v145,0xffff0000,v6
v_cvt_pk_bf16_f32 v6,v146,v147
v_lshlrev_b32 v146,16,v6
v_and_b32 v147,0xffff0000,v6
v_cvt_pk_bf16_f32 v6,v148,v149
v_lshlrev_b32 v148,16,v6
v_and_b32 v149,0xffff0000,v6
v_cvt_pk_bf16_f32 v6,v150,v151
v_lshlrev_b32 v150,16,v6
v_and_b32 v151,0xffff0000,v6
v_pk_add_f32 v[144:145],v[144:145],v[184:185]
v_pk_add_f32 v[146:147],v[146:147],v[186:187]
v_pk_add_f32 v[148:149],v[148:149],v[188:189]
v_pk_add_f32 v[150:151],v[150:151],v[190:191]
v_cvt_pk_bf16_f32 v6,v144,v145
v_lshlrev_b32 v144,16,v6
v_and_b32 v145,0xffff0000,v6
v_cvt_pk_bf16_f32 v6,v146,v147
v_lshlrev_b32 v146,16,v6
v_and_b32 v147,0xffff0000,v6
v_cvt_pk_bf16_f32 v6,v148,v149
v_lshlrev_b32 v148,16,v6
v_and_b32 v149,0xffff0000,v6
v_cvt_pk_bf16_f32 v6,v150,v151
v_lshlrev_b32 v150,16,v6
v_and_b32 v151,0xffff0000,v6
v_pk_add_f32 v[144:145],v[144:145],v[192:193]
v_pk_add_f32 v[146:147],v[146:147],v[194:195]
v_pk_add_f32 v[148:149],v[148:149],v[196:197]
v_pk_add_f32 v[150:151],v[150:151],v[198:199]
v_cvt_pk_bf16_f32 v200,v144,v145
v_lshlrev_b32 v144,16,v200
v_and_b32 v145,0xffff0000,v200
v_cvt_pk_bf16_f32 v201,v146,v147
v_lshlrev_b32 v146,16,v201
v_and_b32 v147,0xffff0000,v201
v_cvt_pk_bf16_f32 v202,v148,v149
v_lshlrev_b32 v148,16,v202
v_and_b32 v149,0xffff0000,v202
v_cvt_pk_bf16_f32 v203,v150,v151
v_lshlrev_b32 v150,16,v203
v_and_b32 v151,0xffff0000,v203
s_cmp_lg_u32 s51,0
s_cbranch_scc1 w4o_388
s_mul_i32 s62,s52,46080
s_add_u32 s62,s62,209518592
s_add_u32 s63,s62,s70
buffer_store_dwordx4 v[200:203],v15,s[8:11],s63 offen sc1
v_add_f32 v6,v144,v145
v_mul_f32 v7,v144,v144
v_fmac_f32 v7,v145,v145
v_add_f32 v6,v6,v146
v_fmac_f32 v7,v146,v146
v_add_f32 v6,v6,v147
v_fmac_f32 v7,v147,v147
v_add_f32 v6,v6,v148
v_fmac_f32 v7,v148,v148
v_add_f32 v6,v6,v149
v_fmac_f32 v7,v149,v149
v_add_f32 v6,v6,v150
v_fmac_f32 v7,v150,v150
v_add_f32 v6,v6,v151
v_fmac_f32 v7,v151,v151
v_mov_b32 v8,v6
v_mov_b32 v9,v7
s_nop 0
v_permlane32_swap_b32 v6,v8
v_permlane32_swap_b32 v7,v9
v_add_f32 v6,v6,v8
v_add_f32 v7,v7,v9
v_mov_b32 v8,v6
v_mov_b32 v9,v7
s_nop 0
v_permlane16_swap_b32 v6,v8
v_permlane16_swap_b32 v7,v9
v_add_f32 v6,v6,v8
v_add_f32 v7,v7,v9
s_lshl_b32 s63,s68,8
s_lshl_b32 s60,s69,7
s_add_u32 s63,s63,s60
s_add_u32 s63,s63,s62
s_add_u32 s63,s63,40960
s_mov_b64 exec,0xffff
buffer_store_dwordx2 v[6:7],v204,s[8:11],s63 offen sc1
s_mov_b64 exec,-1
s_mov_b32 s66,1
s_lshl_b32 s59,s66,6
s_add_u32 s59,s59,s52
s_lshl_b32 s59,s59,9
s_add_u32 s59,s59,0
s_lshl_b32 s61,s56,2
s_add_u32 s59,s59,s61
s_branch w4n_389
w4o_388:
s_mul_i32 s62,s52,40960
buffer_store_dwordx2 v[200:201],v205,s[76:79],s62 offen
buffer_store_dwordx2 v[202:203],v205,s[76:79],s62 offen offset:32
w4n_389:
s_cmp_eq_u32 s37,0
s_cbranch_scc1 W4_NEXT
s_waitcnt vmcnt(0)
s_mov_b64 exec,1
buffer_store_dword v5,v1,s[8:11],s59 offen sc1
s_mov_b64 exec,-1
s_mov_b32 s59,2147483648
s_cmp_lt_u32 s32,128
s_cbranch_scc1 W4_COLD
s_endpgm
.section .rodata,"a"
.p2align 6
.amdhsa_kernel interleave_layers__memory_aug_recurrent_mem_tr__mixer_s_mlp__prompt_kernel
  .amdhsa_next_free_vgpr 512
  .amdhsa_next_free_sgpr 102
  .amdhsa_accum_offset 256
  .amdhsa_group_segment_fixed_size 0
  .amdhsa_kernarg_size 120
  .amdhsa_user_sgpr_count 2
  .amdhsa_user_sgpr_kernarg_segment_ptr 1
  .amdhsa_system_sgpr_workgroup_id_x 1
.end_amdhsa_kernel
```

```asm
; @launch grid=(256,1,1) block=(256,1,1) lds=163840
.amdgcn_target "amdgcn-amd-amdhsa--gfx950"
.text
.globl interleave_layers__memory_aug_recurrent_mem_tr__mixer_s_mlp__prompt_kernel
.p2align 8
.type interleave_layers__memory_aug_recurrent_mem_tr__mixer_s_mlp__prompt_kernel,@function
interleave_layers__memory_aug_recurrent_mem_tr__mixer_s_mlp__prompt_kernel:
s_cmp_ge_u32 s2,256
s_cbranch_scc1 EXIT
s_load_dwordx16 s[16:31],s[0:1],0
s_load_dwordx8 s[32:39],s[0:1],64
s_load_dwordx4 s[40:43],s[0:1],96
s_load_dwordx2 s[44:45],s[0:1],112
v_lshrrev_b32 v1,6,v0
v_and_b32 v0,63,v0
v_readfirstlane_b32 s46,v1
s_mov_b32 s47,200000
s_mov_b32 s49,0
s_getreg_b32 s4,hwreg(HW_REG_XCC_ID)
s_and_b32 s4,s4,7
s_waitcnt lgkmcnt(0)
s_mov_b32 s8,s44
s_mov_b32 s9,s45
s_mov_b32 s10,268435456
s_mov_b32 s11,0x20000
s_mov_b32 s12,s42
s_mov_b32 s13,s43
s_mov_b32 s14,256
s_mov_b32 s15,0x20000
v_lshlrev_b32 v1,4,v0
v_mov_b32 v4,0
v_mov_b32 v5,0
v_mov_b32 v6,0
v_mov_b32 v7,0
s_lshl_b32 s5,s2,2
s_add_u32 s5,s5,s46
s_lshl_b32 s5,s5,10
buffer_store_dwordx4 v[4:7],v1,s[8:11],s5 offen sc1
s_cmp_ge_u32 s4,4
s_cbranch_scc1 VOTE_DONE
s_cmp_lg_u32 s46,1
s_cbranch_scc1 VOTE_DONE
s_and_b32 s52,s2,24
s_cbranch_scc1 VOTE_DONE
s_mov_b64 exec,1
v_mov_b32 v12,0
s_and_b32 s53,s2,63
s_lshl_b32 s53,s53,7
s_lshr_b32 s52,s2,6
s_mul_i32 s52,s52,3
s_add_u32 s52,s52,s46
s_lshl_b32 s52,s52,14
s_add_u32 s53,s53,s52
s_add_u32 s53,s53,11796480
s_add_u32 s59,s53,0x2000
buffer_store_dword v12,v12,s[8:11],s53 offen sc1
buffer_store_dword v12,v12,s[8:11],s59 offen sc1
s_waitcnt vmcnt(0)
s_memtime s[54:55]
s_waitcnt lgkmcnt(0)
buffer_load_dword v13,v12,s[8:11],s53 offen sc1
s_waitcnt vmcnt(0)
s_memtime s[56:57]
s_waitcnt lgkmcnt(0)
s_sub_u32 s50,s56,s54
s_memtime s[54:55]
s_waitcnt lgkmcnt(0)
buffer_load_dword v13,v12,s[8:11],s59 offen sc1
s_waitcnt vmcnt(0)
s_memtime s[56:57]
s_waitcnt lgkmcnt(0)
s_sub_u32 s51,s56,s54
s_cmp_lt_u32 s51,s50
s_cselect_b32 s52,1,-1
v_mov_b32 v13,s52
v_mov_b32 v12,192
buffer_atomic_add v13,v12,s[12:15],0 offen sc1
s_mov_b64 exec,-1
VOTE_DONE:
v_mov_b32 v2,0
s_cmp_lg_u32 s46,0
s_cbranch_scc1 TK_DONE
s_mov_b64 exec,1
v_mov_b32 v1,1
s_lshl_b32 s5,s4,2
v_mov_b32 v3,s5
buffer_atomic_add v1,v3,s[12:15],0 offen offset:32 sc0 sc1
s_waitcnt vmcnt(0)
v_readfirstlane_b32 s5,v1
s_lshl_b32 s6,s4,5
s_add_u32 s6,s6,s5
s_cmp_lt_u32 s5,32
s_cselect_b32 s6,s6,999
v_mov_b32 v1,s6
ds_write_b32 v2,v1
s_mov_b64 exec,-1
s_waitcnt lgkmcnt(0)
TK_DONE:
s_barrier
ds_read_b32 v1,v2
s_waitcnt lgkmcnt(0)
v_readfirstlane_b32 s3,v1
s_barrier
s_nop 2
s_branch DISPATCH
ROLE_CS:
s_lshr_b32 s28,s48,4
s_and_b32 s29,s48,15
s_mul_i32 s82,s28,2097152
s_add_u32 s82,s82,2097152
v_lshlrev_b32 v1,4,v0
v_and_b32 v12,1,v0
v_mul_u32_u24 v2,0xaaaa,v12
v_or_b32 v2,0x4444,v2
s_add_u32 s60,s46,1
s_and_b32 s60,s60,3
s_lshl_b32 s60,s60,11
s_add_u32 s60,s60,131072
v_add_u32 v3,s60,v1
s_add_u32 s60,s46,2
s_and_b32 s60,s60,3
s_lshl_b32 s60,s60,11
s_add_u32 s60,s60,131072
v_add_u32 v4,s60,v1
s_add_u32 s60,s46,3
s_and_b32 s60,s60,3
s_lshl_b32 s60,s60,11
s_add_u32 s60,s60,131072
v_add_u32 v5,s60,v1
v_add_u32 v59,139264,v1
s_lshl_b32 s60,s46,11
s_add_u32 s60,s60,131072
v_add_u32 v22,s60,v1
s_lshr_b32 s60,s46,1
s_lshl_b32 s60,s60,10
s_and_b32 s61,s46,1
s_lshl_b32 s61,s61,3
s_add_u32 s60,s60,s61
v_add_u32 v23,s60,v59
s_mul_i32 s60,s46,20480
v_add_u32 v21,s60,v1
v_and_b32 v11,7,v0
v_lshlrev_b32 v11,2,v11
v_bfe_u32 v12,v0,3,2
v_lshl_add_u32 v11,v12,7,v11
s_xor_b32 s60,s28,1
s_lshl_b32 s60,s60,19
s_lshl_b32 s61,s46,11
s_add_u32 s83,s60,s61
s_add_u32 s83,s83,10485760
s_mov_b32 s36,0
s_mov_b32 s88,0xcccccccc
s_mov_b32 s89,0xcccccccc
s_mov_b32 s90,0x33333333
s_mov_b32 s91,0x33333333
s_mov_b32 s87,0x3dd53b95
v_lshrrev_b32 v14,4,v0
v_and_b32 v15,15,v0
v_lshrrev_b32 v12,2,v15
v_add_u32 v12,v12,v14
v_and_b32 v12,3,v12
v_lshlrev_b32 v6,3,v12
v_lshl_add_u32 v6,v15,5,v6
s_mul_i32 s60,s46,1536
s_add_u32 s60,s60,141312
v_add_u32 v6,s60,v6
v_add_u32 v12,v0,v14
v_and_b32 v12,3,v12
v_lshlrev_b32 v7,3,v12
v_lshrrev_b32 v12,2,v0
v_lshl_add_u32 v7,v12,5,v7
v_add_u32 v7,141312,v7
s_min_u32 s62,s46,2
v_lshrrev_b32 v12,2,v15
v_and_b32 v13,1,v15
v_lshl_add_u32 v12,v12,1,v13
v_bfe_u32 v13,v15,1,1
v_lshlrev_b32 v8,8,v14
v_lshl_add_u32 v8,v12,5,v8
v_xor_b32 v16,1,v13
v_lshl_add_u32 v8,v16,4,v8
v_lshlrev_b32 v20,8,v14
v_lshl_add_u32 v20,v13,7,v20
v_and_b32 v16,3,v12
v_lshl_add_u32 v20,v16,5,v20
v_lshrrev_b32 v16,2,v12
v_lshl_add_u32 v20,v16,4,v20
v_min_u32 v12,5,v0
s_mul_i32 s60,s48,3
v_add_u32 v9,s60,v12
v_lshlrev_b32 v9,2,v9
v_add_u32 v13,65524,v9
v_cmp_lt_u32 vcc,2,v12
s_nop 1
v_cndmask_b32 v9,v9,v13,vcc
s_mul_i32 s84,s48,12288
s_add_u32 s84,s84,74448896
s_mul_i32 s60,s29,3072
s_lshl_b32 s61,s62,10
s_add_u32 s60,s60,s61
s_add_u32 s60,s60,s82
s_add_u32 s33,s60,163840
s_add_u32 s34,s60,557056
s_mul_i32 s85,s48,6144
s_add_u32 s85,s85,24117248
s_lshl_b32 s86,s48,5
s_lshl_b32 s61,s62,2
s_add_u32 s86,s86,688128
s_lshr_b32 s60,s29,2
s_lshl_b32 s60,s60,7
s_and_b32 s63,s29,3
s_mul_i32 s63,s63,12
s_add_u32 s60,s60,s63
s_add_u32 s60,s60,s61
s_add_u32 s60,s60,s82
s_add_u32 s35,s60,951296
s_cmp_eq_u32 s46,3
s_cbranch_scc1 si_1
v_mov_b32 v12,-1
v_mov_b32 v13,0
s_cmp_lg_u32 s49,0
s_cbranch_scc1 ls_2
s_add_u32 s60,s33,0
buffer_store_dword v12,v1,s[8:11],s60 offen
s_add_u32 s60,s33,49152
buffer_store_dword v12,v1,s[8:11],s60 offen
s_add_u32 s60,s33,98304
buffer_store_dword v12,v1,s[8:11],s60 offen
s_add_u32 s60,s33,147456
buffer_store_dword v12,v1,s[8:11],s60 offen
s_add_u32 s60,s33,196608
buffer_store_dword v12,v1,s[8:11],s60 offen
s_add_u32 s60,s33,245760
buffer_store_dword v12,v1,s[8:11],s60 offen
s_add_u32 s60,s33,294912
buffer_store_dword v12,v1,s[8:11],s60 offen
s_add_u32 s60,s33,344064
buffer_store_dword v12,v1,s[8:11],s60 offen
s_mov_b64 exec,1
buffer_store_dword v13,v1,s[8:11],s35 offen
buffer_store_dword v13,v1,s[8:11],s35 offen offset:512
s_mov_b64 exec,-1
s_branch ls_3
ls_2:
s_add_u32 s60,s33,0
buffer_store_dword v12,v1,s[8:11],s60 offen sc1
s_add_u32 s60,s33,49152
buffer_store_dword v12,v1,s[8:11],s60 offen sc1
s_add_u32 s60,s33,98304
buffer_store_dword v12,v1,s[8:11],s60 offen sc1
s_add_u32 s60,s33,147456
buffer_store_dword v12,v1,s[8:11],s60 offen sc1
s_add_u32 s60,s33,196608
buffer_store_dword v12,v1,s[8:11],s60 offen sc1
s_add_u32 s60,s33,245760
buffer_store_dword v12,v1,s[8:11],s60 offen sc1
s_add_u32 s60,s33,294912
buffer_store_dword v12,v1,s[8:11],s60 offen sc1
s_add_u32 s60,s33,344064
buffer_store_dword v12,v1,s[8:11],s60 offen sc1
s_mov_b64 exec,1
buffer_store_dword v13,v1,s[8:11],s35 offen sc1
buffer_store_dword v13,v1,s[8:11],s35 offen offset:512 sc1
s_mov_b64 exec,-1
ls_3:
si_1:
s_mul_i32 s73,s48,384
s_mov_b32 s74,s73
v_add_u32 v12,0,v0
v_mul_u32_u24 v13,2731,v12
v_lshrrev_b32 v13,16,v13
v_mul_u32_u24 v16,24,v13
v_sub_u32 v12,v12,v16
v_mul_u32_u24 v104,12288,v13
v_lshl_add_u32 v104,v12,4,v104
v_add_u32 v12,64,v0
v_mul_u32_u24 v13,2731,v12
v_lshrrev_b32 v13,16,v13
v_mul_u32_u24 v16,24,v13
v_sub_u32 v12,v12,v16
v_mul_u32_u24 v105,12288,v13
v_lshl_add_u32 v105,v12,4,v105
v_add_u32 v12,128,v0
v_mul_u32_u24 v13,2731,v12
v_lshrrev_b32 v13,16,v13
v_mul_u32_u24 v16,24,v13
v_sub_u32 v12,v12,v16
v_mul_u32_u24 v106,12288,v13
v_lshl_add_u32 v106,v12,4,v106
s_mov_b32 s4,s20
s_mov_b32 s5,s21
s_mov_b32 s6,7864320
s_mov_b32 s7,0x20000
s_mov_b32 s52,s22
s_mov_b32 s53,s23
s_mov_b32 s54,7864320
s_mov_b32 s55,0x20000
s_branch SV_LOAD
ROLE_CV:
s_lshr_b32 s28,s48,3
s_and_b32 s29,s48,7
s_mul_i32 s82,s28,2097152
s_add_u32 s82,s82,2097152
v_lshlrev_b32 v1,4,v0
v_and_b32 v12,1,v0
v_mul_u32_u24 v2,0xaaaa,v12
v_or_b32 v2,0x4444,v2
s_add_u32 s60,s46,1
s_and_b32 s60,s60,3
s_lshl_b32 s60,s60,11
s_add_u32 s60,s60,131072
v_add_u32 v3,s60,v1
s_add_u32 s60,s46,2
s_and_b32 s60,s60,3
s_lshl_b32 s60,s60,11
s_add_u32 s60,s60,131072
v_add_u32 v4,s60,v1
s_add_u32 s60,s46,3
s_and_b32 s60,s60,3
s_lshl_b32 s60,s60,11
s_add_u32 s60,s60,131072
v_add_u32 v5,s60,v1
v_add_u32 v59,139264,v1
s_lshl_b32 s60,s46,11
s_add_u32 s60,s60,131072
v_add_u32 v22,s60,v1
s_lshr_b32 s60,s46,1
s_lshl_b32 s60,s60,10
s_and_b32 s61,s46,1
s_lshl_b32 s61,s61,3
s_add_u32 s60,s60,s61
v_add_u32 v23,s60,v59
s_mul_i32 s60,s46,20480
v_add_u32 v21,s60,v1
v_and_b32 v11,7,v0
v_lshlrev_b32 v11,2,v11
v_bfe_u32 v12,v0,3,2
v_lshl_add_u32 v11,v12,7,v11
s_xor_b32 s60,s28,1
s_lshl_b32 s60,s60,19
s_lshl_b32 s61,s46,11
s_add_u32 s83,s60,s61
s_add_u32 s83,s83,10485760
s_mov_b32 s36,1
v_mov_b32 v8,0
v_mov_b32 v9,0
v_mov_b32 v20,0
s_and_b32 s62,s46,1
s_lshl_b32 s60,s62,11
v_add_u32 v6,s60,v1
s_lshl_b32 s60,s62,3
s_add_u32 s60,s60,1024
v_add_u32 v7,s60,v1
s_lshr_b32 s61,s46,1
s_lshl_b32 s60,s29,1
s_add_u32 s60,s60,s61
s_mul_i32 s60,s60,3072
s_add_u32 s60,s60,s82
s_add_u32 s34,s60,557056
s_lshl_b32 s60,s48,1
s_add_u32 s60,s60,s61
s_mul_i32 s85,s60,6144
s_add_u32 s85,s85,24120320
s_lshl_b32 s86,s60,5
s_lshl_b32 s61,s62,2
s_add_u32 s86,s86,s61
s_add_u32 s86,s86,688132
v_mov_b32 v12,-1
v_mov_b32 v13,-1
v_mov_b32 v14,-1
v_mov_b32 v15,-1
s_cmp_lg_u32 s49,0
s_cbranch_scc1 ls_4
s_add_u32 s60,s34,0
buffer_store_dwordx4 v[12:15],v6,s[8:11],s60 offen
buffer_store_dwordx2 v[12:13],v7,s[8:11],s60 offen
s_add_u32 s60,s34,49152
buffer_store_dwordx4 v[12:15],v6,s[8:11],s60 offen
buffer_store_dwordx2 v[12:13],v7,s[8:11],s60 offen
s_add_u32 s60,s34,98304
buffer_store_dwordx4 v[12:15],v6,s[8:11],s60 offen
buffer_store_dwordx2 v[12:13],v7,s[8:11],s60 offen
s_add_u32 s60,s34,147456
buffer_store_dwordx4 v[12:15],v6,s[8:11],s60 offen
buffer_store_dwordx2 v[12:13],v7,s[8:11],s60 offen
s_add_u32 s60,s34,196608
buffer_store_dwordx4 v[12:15],v6,s[8:11],s60 offen
buffer_store_dwordx2 v[12:13],v7,s[8:11],s60 offen
s_add_u32 s60,s34,245760
buffer_store_dwordx4 v[12:15],v6,s[8:11],s60 offen
buffer_store_dwordx2 v[12:13],v7,s[8:11],s60 offen
s_add_u32 s60,s34,294912
buffer_store_dwordx4 v[12:15],v6,s[8:11],s60 offen
buffer_store_dwordx2 v[12:13],v7,s[8:11],s60 offen
s_add_u32 s60,s34,344064
buffer_store_dwordx4 v[12:15],v6,s[8:11],s60 offen
buffer_store_dwordx2 v[12:13],v7,s[8:11],s60 offen
s_branch ls_5
ls_4:
s_add_u32 s60,s34,0
buffer_store_dwordx4 v[12:15],v6,s[8:11],s60 offen sc1
buffer_store_dwordx2 v[12:13],v7,s[8:11],s60 offen sc1
s_add_u32 s60,s34,49152
buffer_store_dwordx4 v[12:15],v6,s[8:11],s60 offen sc1
buffer_store_dwordx2 v[12:13],v7,s[8:11],s60 offen sc1
s_add_u32 s60,s34,98304
buffer_store_dwordx4 v[12:15],v6,s[8:11],s60 offen sc1
buffer_store_dwordx2 v[12:13],v7,s[8:11],s60 offen sc1
s_add_u32 s60,s34,147456
buffer_store_dwordx4 v[12:15],v6,s[8:11],s60 offen sc1
buffer_store_dwordx2 v[12:13],v7,s[8:11],s60 offen sc1
s_add_u32 s60,s34,196608
buffer_store_dwordx4 v[12:15],v6,s[8:11],s60 offen sc1
buffer_store_dwordx2 v[12:13],v7,s[8:11],s60 offen sc1
s_add_u32 s60,s34,245760
buffer_store_dwordx4 v[12:15],v6,s[8:11],s60 offen sc1
buffer_store_dwordx2 v[12:13],v7,s[8:11],s60 offen sc1
s_add_u32 s60,s34,294912
buffer_store_dwordx4 v[12:15],v6,s[8:11],s60 offen sc1
buffer_store_dwordx2 v[12:13],v7,s[8:11],s60 offen sc1
s_add_u32 s60,s34,344064
buffer_store_dwordx4 v[12:15],v6,s[8:11],s60 offen sc1
buffer_store_dwordx2 v[12:13],v7,s[8:11],s60 offen sc1
s_nop 0
ls_5:
s_mul_i32 s73,s48,768
s_add_u32 s74,s73,96
v_add_u32 v12,0,v0
v_mul_u32_u24 v13,2731,v12
v_lshrrev_b32 v13,16,v13
v_mul_u32_u24 v16,24,v13
v_sub_u32 v12,v12,v16
v_mul_u32_u24 v104,12288,v13
v_lshl_add_u32 v104,v12,4,v104
v_mul_u32_u24 v13,43,v12
v_lshrrev_b32 v13,8,v13
v_mul_u32_u24 v13,96,v13
v_add_u32 v104,v104,v13
v_add_u32 v12,64,v0
v_mul_u32_u24 v13,2731,v12
v_lshrrev_b32 v13,16,v13
v_mul_u32_u24 v16,24,v13
v_sub_u32 v12,v12,v16
v_mul_u32_u24 v105,12288,v13
v_lshl_add_u32 v105,v12,4,v105
v_mul_u32_u24 v13,43,v12
v_lshrrev_b32 v13,8,v13
v_mul_u32_u24 v13,96,v13
v_add_u32 v105,v105,v13
v_add_u32 v12,128,v0
v_mul_u32_u24 v13,2731,v12
v_lshrrev_b32 v13,16,v13
v_mul_u32_u24 v16,24,v13
v_sub_u32 v12,v12,v16
v_mul_u32_u24 v106,12288,v13
v_lshl_add_u32 v106,v12,4,v106
v_mul_u32_u24 v13,43,v12
v_lshrrev_b32 v13,8,v13
v_mul_u32_u24 v13,96,v13
v_add_u32 v106,v106,v13
s_mov_b32 s4,s24
s_mov_b32 s5,s25
s_mov_b32 s6,7864320
s_mov_b32 s7,0x20000
s_mov_b32 s52,s24
s_mov_b32 s53,s25
s_mov_b32 s54,7864320
s_mov_b32 s55,0x20000
SV_LOAD:
s_waitcnt vmcnt(0)
s_barrier
s_cmp_lg_u32 s46,0
s_cbranch_scc1 arr_6
v_mov_b32 v12,1
s_lshl_b32 s3,s49,2
v_mov_b32 v13,s3
s_mov_b64 exec,1
buffer_atomic_add v12,v13,s[12:15],0 offen sc1
s_mov_b64 exec,-1
arr_6:
s_and_b32 s60,s46,1
s_mul_i32 s60,s60,196608
s_lshr_b32 s61,s46,1
s_mul_i32 s75,s61,393216
s_add_u32 s75,s75,s60
s_mul_i32 s76,s61,393216
s_add_u32 s76,s76,s60
s_mul_i32 s77,s46,6144
v_lshrrev_b32 v14,4,v0
v_and_b32 v15,15,v0
v_and_b32 v12,1,v14
v_lshlrev_b32 v12,2,v12
v_lshrrev_b32 v13,1,v14
v_lshl_add_u32 v12,v13,4,v12
v_bfe_u32 v13,v0,2,1
v_add_u32 v12,v12,v13
v_bfe_u32 v13,v0,3,1
v_lshl_add_u32 v12,v13,3,v12
v_mul_u32_u24 v107,384,v12
v_and_b32 v13,3,v0
v_lshl_add_u32 v107,v13,3,v107
s_mul_i32 s60,s46,96
v_add_u32 v107,s60,v107
s_add_u32 s60,s75,s73
s_add_u32 m0,s77,0
s_add_u32 s61,s60,0
buffer_load_dwordx4 v104,s[4:7],s61 offen lds
s_add_u32 m0,s77,1024
s_add_u32 s61,s60,0
buffer_load_dwordx4 v105,s[4:7],s61 offen lds
s_add_u32 m0,s77,2048
s_add_u32 s61,s60,0
buffer_load_dwordx4 v106,s[4:7],s61 offen lds
s_add_u32 m0,s77,3072
s_add_u32 s61,s60,98304
buffer_load_dwordx4 v104,s[4:7],s61 offen lds
s_add_u32 m0,s77,4096
s_add_u32 s61,s60,98304
buffer_load_dwordx4 v105,s[4:7],s61 offen lds
s_add_u32 m0,s77,5120
s_add_u32 s61,s60,98304
buffer_load_dwordx4 v106,s[4:7],s61 offen lds
s_add_u32 s60,s75,s74
s_add_u32 m0,s77,24576
s_add_u32 s61,s60,0
buffer_load_dwordx4 v104,s[52:55],s61 offen lds
s_add_u32 m0,s77,25600
s_add_u32 s61,s60,0
buffer_load_dwordx4 v105,s[52:55],s61 offen lds
s_add_u32 m0,s77,26624
s_add_u32 s61,s60,0
buffer_load_dwordx4 v106,s[52:55],s61 offen lds
s_add_u32 m0,s77,27648
s_add_u32 s61,s60,98304
buffer_load_dwordx4 v104,s[52:55],s61 offen lds
s_add_u32 m0,s77,28672
s_add_u32 s61,s60,98304
buffer_load_dwordx4 v105,s[52:55],s61 offen lds
s_add_u32 m0,s77,29696
s_add_u32 s61,s60,98304
buffer_load_dwordx4 v106,s[52:55],s61 offen lds
s_add_u32 s60,s75,s73
s_add_u32 m0,s77,49152
s_add_u32 s61,s60,786432
buffer_load_dwordx4 v104,s[4:7],s61 offen lds
s_add_u32 m0,s77,50176
s_add_u32 s61,s60,786432
buffer_load_dwordx4 v105,s[4:7],s61 offen lds
s_add_u32 m0,s77,51200
s_add_u32 s61,s60,786432
buffer_load_dwordx4 v106,s[4:7],s61 offen lds
s_add_u32 m0,s77,52224
s_add_u32 s61,s60,884736
buffer_load_dwordx4 v104,s[4:7],s61 offen lds
s_add_u32 m0,s77,53248
s_add_u32 s61,s60,884736
buffer_load_dwordx4 v105,s[4:7],s61 offen lds
s_add_u32 m0,s77,54272
s_add_u32 s61,s60,884736
buffer_load_dwordx4 v106,s[4:7],s61 offen lds
s_add_u32 s60,s75,s74
s_add_u32 m0,s77,73728
s_add_u32 s61,s60,786432
buffer_load_dwordx4 v104,s[52:55],s61 offen lds
s_add_u32 m0,s77,74752
s_add_u32 s61,s60,786432
buffer_load_dwordx4 v105,s[52:55],s61 offen lds
s_add_u32 m0,s77,75776
s_add_u32 s61,s60,786432
buffer_load_dwordx4 v106,s[52:55],s61 offen lds
s_add_u32 m0,s77,76800
s_add_u32 s61,s60,884736
buffer_load_dwordx4 v104,s[52:55],s61 offen lds
s_add_u32 m0,s77,77824
s_add_u32 s61,s60,884736
buffer_load_dwordx4 v105,s[52:55],s61 offen lds
s_add_u32 m0,s77,78848
s_add_u32 s61,s60,884736
buffer_load_dwordx4 v106,s[52:55],s61 offen lds
s_add_u32 s60,s75,s73
s_add_u32 m0,s77,98304
s_add_u32 s61,s60,1572864
buffer_load_dwordx4 v104,s[4:7],s61 offen lds
s_add_u32 m0,s77,99328
s_add_u32 s61,s60,1572864
buffer_load_dwordx4 v105,s[4:7],s61 offen lds
s_add_u32 m0,s77,100352
s_add_u32 s61,s60,1572864
buffer_load_dwordx4 v106,s[4:7],s61 offen lds
s_add_u32 m0,s77,101376
s_add_u32 s61,s60,1671168
buffer_load_dwordx4 v104,s[4:7],s61 offen lds
s_add_u32 m0,s77,102400
s_add_u32 s61,s60,1671168
buffer_load_dwordx4 v105,s[4:7],s61 offen lds
s_add_u32 m0,s77,103424
s_add_u32 s61,s60,1671168
buffer_load_dwordx4 v106,s[4:7],s61 offen lds
s_waitcnt vmcnt(24)
s_barrier
s_add_u32 s60,s75,s74
s_add_u32 m0,s77,122880
s_add_u32 s61,s60,1572864
buffer_load_dwordx4 v104,s[52:55],s61 offen lds
s_add_u32 m0,s77,123904
s_add_u32 s61,s60,1572864
buffer_load_dwordx4 v105,s[52:55],s61 offen lds
s_add_u32 m0,s77,124928
s_add_u32 s61,s60,1572864
buffer_load_dwordx4 v106,s[52:55],s61 offen lds
s_add_u32 m0,s77,125952
s_add_u32 s61,s60,1671168
buffer_load_dwordx4 v104,s[52:55],s61 offen lds
s_add_u32 m0,s77,126976
s_add_u32 s61,s60,1671168
buffer_load_dwordx4 v105,s[52:55],s61 offen lds
s_add_u32 m0,s77,128000
s_add_u32 s61,s60,1671168
buffer_load_dwordx4 v106,s[52:55],s61 offen lds
v_add_u32 v12,0,v107
s_cmp_eq_u32 s46,1
s_cbranch_scc1 lw_9
s_cmp_eq_u32 s46,2
s_cbranch_scc1 lw_10
s_cmp_eq_u32 s46,3
s_cbranch_scc1 lw_11
lw_8:
ds_read_b64_tr_b16 a[0:1],v12 offset:0
ds_read_b64_tr_b16 a[2:3],v12 offset:768
ds_read_b64_tr_b16 a[4:5],v12 offset:12288
ds_read_b64_tr_b16 a[6:7],v12 offset:13056
ds_read_b64_tr_b16 a[8:9],v12 offset:32
ds_read_b64_tr_b16 a[10:11],v12 offset:800
ds_read_b64_tr_b16 a[12:13],v12 offset:12320
ds_read_b64_tr_b16 a[14:15],v12 offset:13088
ds_read_b64_tr_b16 a[16:17],v12 offset:64
ds_read_b64_tr_b16 a[18:19],v12 offset:832
ds_read_b64_tr_b16 a[20:21],v12 offset:12352
ds_read_b64_tr_b16 a[22:23],v12 offset:13120
s_branch ld_7
lw_9:
ds_read_b64_tr_b16 a[240:241],v12 offset:0
ds_read_b64_tr_b16 a[242:243],v12 offset:768
ds_read_b64_tr_b16 a[244:245],v12 offset:12288
ds_read_b64_tr_b16 a[246:247],v12 offset:13056
ds_read_b64_tr_b16 a[248:249],v12 offset:32
ds_read_b64_tr_b16 a[250:251],v12 offset:800
ds_read_b64_tr_b16 a[252:253],v12 offset:12320
ds_read_b64_tr_b16 a[254:255],v12 offset:13088
ds_read_b64_tr_b16 v[112:113],v12 offset:64
ds_read_b64_tr_b16 v[114:115],v12 offset:832
ds_read_b64_tr_b16 v[116:117],v12 offset:12352
ds_read_b64_tr_b16 v[118:119],v12 offset:13120
s_branch ld_7
lw_10:
ds_read_b64_tr_b16 a[160:161],v12 offset:0
ds_read_b64_tr_b16 a[162:163],v12 offset:768
ds_read_b64_tr_b16 a[164:165],v12 offset:12288
ds_read_b64_tr_b16 a[166:167],v12 offset:13056
ds_read_b64_tr_b16 a[168:169],v12 offset:32
ds_read_b64_tr_b16 a[170:171],v12 offset:800
ds_read_b64_tr_b16 a[172:173],v12 offset:12320
ds_read_b64_tr_b16 a[174:175],v12 offset:13088
ds_read_b64_tr_b16 a[176:177],v12 offset:64
ds_read_b64_tr_b16 a[178:179],v12 offset:832
ds_read_b64_tr_b16 a[180:181],v12 offset:12352
ds_read_b64_tr_b16 a[182:183],v12 offset:13120
s_branch ld_7
lw_11:
ds_read_b64_tr_b16 a[80:81],v12 offset:0
ds_read_b64_tr_b16 a[82:83],v12 offset:768
ds_read_b64_tr_b16 a[84:85],v12 offset:12288
ds_read_b64_tr_b16 a[86:87],v12 offset:13056
ds_read_b64_tr_b16 a[88:89],v12 offset:32
ds_read_b64_tr_b16 a[90:91],v12 offset:800
ds_read_b64_tr_b16 a[92:93],v12 offset:12320
ds_read_b64_tr_b16 a[94:95],v12 offset:13088
ds_read_b64_tr_b16 a[96:97],v12 offset:64
ds_read_b64_tr_b16 a[98:99],v12 offset:832
ds_read_b64_tr_b16 a[100:101],v12 offset:12352
ds_read_b64_tr_b16 a[102:103],v12 offset:13120
ld_7:
s_waitcnt lgkmcnt(0)
s_waitcnt vmcnt(24)
s_barrier
s_add_u32 s60,s75,s73
s_add_u32 m0,s77,0
s_add_u32 s61,s60,2359296
buffer_load_dwordx4 v104,s[4:7],s61 offen lds
s_add_u32 m0,s77,1024
s_add_u32 s61,s60,2359296
buffer_load_dwordx4 v105,s[4:7],s61 offen lds
s_add_u32 m0,s77,2048
s_add_u32 s61,s60,2359296
buffer_load_dwordx4 v106,s[4:7],s61 offen lds
s_add_u32 m0,s77,3072
s_add_u32 s61,s60,2457600
buffer_load_dwordx4 v104,s[4:7],s61 offen lds
s_add_u32 m0,s77,4096
s_add_u32 s61,s60,2457600
buffer_load_dwordx4 v105,s[4:7],s61 offen lds
s_add_u32 m0,s77,5120
s_add_u32 s61,s60,2457600
buffer_load_dwordx4 v106,s[4:7],s61 offen lds
v_add_u32 v12,24576,v107
s_cmp_eq_u32 s46,1
s_cbranch_scc1 lw_14
s_cmp_eq_u32 s46,2
s_cbranch_scc1 lw_15
s_cmp_eq_u32 s46,3
s_cbranch_scc1 lw_16
lw_13:
ds_read_b64_tr_b16 a[24:25],v12 offset:0
ds_read_b64_tr_b16 a[26:27],v12 offset:768
ds_read_b64_tr_b16 a[28:29],v12 offset:12288
ds_read_b64_tr_b16 a[30:31],v12 offset:13056
ds_read_b64_tr_b16 a[32:33],v12 offset:32
ds_read_b64_tr_b16 a[34:35],v12 offset:800
ds_read_b64_tr_b16 a[36:37],v12 offset:12320
ds_read_b64_tr_b16 a[38:39],v12 offset:13088
ds_read_b64_tr_b16 v[24:25],v12 offset:64
ds_read_b64_tr_b16 v[26:27],v12 offset:832
ds_read_b64_tr_b16 v[28:29],v12 offset:12352
ds_read_b64_tr_b16 v[30:31],v12 offset:13120
s_branch ld_12
lw_14:
ds_read_b64_tr_b16 v[120:121],v12 offset:0
ds_read_b64_tr_b16 v[122:123],v12 offset:768
ds_read_b64_tr_b16 v[124:125],v12 offset:12288
ds_read_b64_tr_b16 v[126:127],v12 offset:13056
ds_read_b64_tr_b16 v[128:129],v12 offset:32
ds_read_b64_tr_b16 v[130:131],v12 offset:800
ds_read_b64_tr_b16 v[132:133],v12 offset:12320
ds_read_b64_tr_b16 v[134:135],v12 offset:13088
ds_read_b64_tr_b16 v[72:73],v12 offset:64
ds_read_b64_tr_b16 v[74:75],v12 offset:832
ds_read_b64_tr_b16 v[76:77],v12 offset:12352
ds_read_b64_tr_b16 v[78:79],v12 offset:13120
s_branch ld_12
lw_15:
ds_read_b64_tr_b16 a[184:185],v12 offset:0
ds_read_b64_tr_b16 a[186:187],v12 offset:768
ds_read_b64_tr_b16 a[188:189],v12 offset:12288
ds_read_b64_tr_b16 a[190:191],v12 offset:13056
ds_read_b64_tr_b16 a[192:193],v12 offset:32
ds_read_b64_tr_b16 a[194:195],v12 offset:800
ds_read_b64_tr_b16 a[196:197],v12 offset:12320
ds_read_b64_tr_b16 a[198:199],v12 offset:13088
ds_read_b64_tr_b16 v[56:57],v12 offset:64
ds_read_b64_tr_b16 v[58:59],v12 offset:832
ds_read_b64_tr_b16 v[60:61],v12 offset:12352
ds_read_b64_tr_b16 v[62:63],v12 offset:13120
s_branch ld_12
lw_16:
ds_read_b64_tr_b16 a[104:105],v12 offset:0
ds_read_b64_tr_b16 a[106:107],v12 offset:768
ds_read_b64_tr_b16 a[108:109],v12 offset:12288
ds_read_b64_tr_b16 a[110:111],v12 offset:13056
ds_read_b64_tr_b16 a[112:113],v12 offset:32
ds_read_b64_tr_b16 a[114:115],v12 offset:800
ds_read_b64_tr_b16 a[116:117],v12 offset:12320
ds_read_b64_tr_b16 a[118:119],v12 offset:13088
ds_read_b64_tr_b16 v[40:41],v12 offset:64
ds_read_b64_tr_b16 v[42:43],v12 offset:832
ds_read_b64_tr_b16 v[44:45],v12 offset:12352
ds_read_b64_tr_b16 v[46:47],v12 offset:13120
ld_12:
s_waitcnt lgkmcnt(0)
s_waitcnt vmcnt(24)
s_barrier
s_add_u32 s60,s75,s74
s_add_u32 m0,s77,24576
s_add_u32 s61,s60,2359296
buffer_load_dwordx4 v104,s[52:55],s61 offen lds
s_add_u32 m0,s77,25600
s_add_u32 s61,s60,2359296
buffer_load_dwordx4 v105,s[52:55],s61 offen lds
s_add_u32 m0,s77,26624
s_add_u32 s61,s60,2359296
buffer_load_dwordx4 v106,s[52:55],s61 offen lds
s_add_u32 m0,s77,27648
s_add_u32 s61,s60,2457600
buffer_load_dwordx4 v104,s[52:55],s61 offen lds
s_add_u32 m0,s77,28672
s_add_u32 s61,s60,2457600
buffer_load_dwordx4 v105,s[52:55],s61 offen lds
s_add_u32 m0,s77,29696
s_add_u32 s61,s60,2457600
buffer_load_dwordx4 v106,s[52:55],s61 offen lds
v_add_u32 v12,49152,v107
s_cmp_eq_u32 s46,1
s_cbranch_scc1 lw_19
s_cmp_eq_u32 s46,2
s_cbranch_scc1 lw_20
s_cmp_eq_u32 s46,3
s_cbranch_scc1 lw_21
lw_18:
ds_read_b64_tr_b16 a[40:41],v12 offset:0
ds_read_b64_tr_b16 a[42:43],v12 offset:768
ds_read_b64_tr_b16 a[44:45],v12 offset:12288
ds_read_b64_tr_b16 a[46:47],v12 offset:13056
ds_read_b64_tr_b16 a[48:49],v12 offset:32
ds_read_b64_tr_b16 a[50:51],v12 offset:800
ds_read_b64_tr_b16 a[52:53],v12 offset:12320
ds_read_b64_tr_b16 a[54:55],v12 offset:13088
ds_read_b64_tr_b16 a[56:57],v12 offset:64
ds_read_b64_tr_b16 a[58:59],v12 offset:832
ds_read_b64_tr_b16 a[60:61],v12 offset:12352
ds_read_b64_tr_b16 a[62:63],v12 offset:13120
s_branch ld_17
lw_19:
ds_read_b64_tr_b16 v[136:137],v12 offset:0
ds_read_b64_tr_b16 v[138:139],v12 offset:768
ds_read_b64_tr_b16 v[140:141],v12 offset:12288
ds_read_b64_tr_b16 v[142:143],v12 offset:13056
ds_read_b64_tr_b16 v[144:145],v12 offset:32
ds_read_b64_tr_b16 v[146:147],v12 offset:800
ds_read_b64_tr_b16 v[148:149],v12 offset:12320
ds_read_b64_tr_b16 v[150:151],v12 offset:13088
ds_read_b64_tr_b16 v[152:153],v12 offset:64
ds_read_b64_tr_b16 v[154:155],v12 offset:832
ds_read_b64_tr_b16 v[156:157],v12 offset:12352
ds_read_b64_tr_b16 v[158:159],v12 offset:13120
s_branch ld_17
lw_20:
ds_read_b64_tr_b16 a[200:201],v12 offset:0
ds_read_b64_tr_b16 a[202:203],v12 offset:768
ds_read_b64_tr_b16 a[204:205],v12 offset:12288
ds_read_b64_tr_b16 a[206:207],v12 offset:13056
ds_read_b64_tr_b16 a[208:209],v12 offset:32
ds_read_b64_tr_b16 a[210:211],v12 offset:800
ds_read_b64_tr_b16 a[212:213],v12 offset:12320
ds_read_b64_tr_b16 a[214:215],v12 offset:13088
ds_read_b64_tr_b16 a[216:217],v12 offset:64
ds_read_b64_tr_b16 a[218:219],v12 offset:832
ds_read_b64_tr_b16 a[220:221],v12 offset:12352
ds_read_b64_tr_b16 a[222:223],v12 offset:13120
s_branch ld_17
lw_21:
ds_read_b64_tr_b16 a[120:121],v12 offset:0
ds_read_b64_tr_b16 a[122:123],v12 offset:768
ds_read_b64_tr_b16 a[124:125],v12 offset:12288
ds_read_b64_tr_b16 a[126:127],v12 offset:13056
ds_read_b64_tr_b16 a[128:129],v12 offset:32
ds_read_b64_tr_b16 a[130:131],v12 offset:800
ds_read_b64_tr_b16 a[132:133],v12 offset:12320
ds_read_b64_tr_b16 a[134:135],v12 offset:13088
ds_read_b64_tr_b16 a[136:137],v12 offset:64
ds_read_b64_tr_b16 a[138:139],v12 offset:832
ds_read_b64_tr_b16 a[140:141],v12 offset:12352
ds_read_b64_tr_b16 a[142:143],v12 offset:13120
ld_17:
s_waitcnt lgkmcnt(0)
s_waitcnt vmcnt(24)
s_barrier
s_add_u32 s60,s75,s73
s_add_u32 m0,s77,49152
s_add_u32 s61,s60,3145728
buffer_load_dwordx4 v104,s[4:7],s61 offen lds
s_add_u32 m0,s77,50176
s_add_u32 s61,s60,3145728
buffer_load_dwordx4 v105,s[4:7],s61 offen lds
s_add_u32 m0,s77,51200
s_add_u32 s61,s60,3145728
buffer_load_dwordx4 v106,s[4:7],s61 offen lds
s_add_u32 m0,s77,52224
s_add_u32 s61,s60,3244032
buffer_load_dwordx4 v104,s[4:7],s61 offen lds
s_add_u32 m0,s77,53248
s_add_u32 s61,s60,3244032
buffer_load_dwordx4 v105,s[4:7],s61 offen lds
s_add_u32 m0,s77,54272
s_add_u32 s61,s60,3244032
buffer_load_dwordx4 v106,s[4:7],s61 offen lds
v_add_u32 v12,73728,v107
s_cmp_eq_u32 s46,1
s_cbranch_scc1 lw_24
s_cmp_eq_u32 s46,2
s_cbranch_scc1 lw_25
s_cmp_eq_u32 s46,3
s_cbranch_scc1 lw_26
lw_23:
ds_read_b64_tr_b16 a[64:65],v12 offset:0
ds_read_b64_tr_b16 a[66:67],v12 offset:768
ds_read_b64_tr_b16 a[68:69],v12 offset:12288
ds_read_b64_tr_b16 a[70:71],v12 offset:13056
ds_read_b64_tr_b16 a[72:73],v12 offset:32
ds_read_b64_tr_b16 a[74:75],v12 offset:800
ds_read_b64_tr_b16 a[76:77],v12 offset:12320
ds_read_b64_tr_b16 a[78:79],v12 offset:13088
ds_read_b64_tr_b16 v[32:33],v12 offset:64
ds_read_b64_tr_b16 v[34:35],v12 offset:832
ds_read_b64_tr_b16 v[36:37],v12 offset:12352
ds_read_b64_tr_b16 v[38:39],v12 offset:13120
s_branch ld_22
lw_24:
ds_read_b64_tr_b16 v[160:161],v12 offset:0
ds_read_b64_tr_b16 v[162:163],v12 offset:768
ds_read_b64_tr_b16 v[164:165],v12 offset:12288
ds_read_b64_tr_b16 v[166:167],v12 offset:13056
ds_read_b64_tr_b16 v[168:169],v12 offset:32
ds_read_b64_tr_b16 v[170:171],v12 offset:800
ds_read_b64_tr_b16 v[172:173],v12 offset:12320
ds_read_b64_tr_b16 v[174:175],v12 offset:13088
ds_read_b64_tr_b16 v[80:81],v12 offset:64
ds_read_b64_tr_b16 v[82:83],v12 offset:832
ds_read_b64_tr_b16 v[84:85],v12 offset:12352
ds_read_b64_tr_b16 v[86:87],v12 offset:13120
s_branch ld_22
lw_25:
ds_read_b64_tr_b16 a[224:225],v12 offset:0
ds_read_b64_tr_b16 a[226:227],v12 offset:768
ds_read_b64_tr_b16 a[228:229],v12 offset:12288
ds_read_b64_tr_b16 a[230:231],v12 offset:13056
ds_read_b64_tr_b16 a[232:233],v12 offset:32
ds_read_b64_tr_b16 a[234:235],v12 offset:800
ds_read_b64_tr_b16 a[236:237],v12 offset:12320
ds_read_b64_tr_b16 a[238:239],v12 offset:13088
ds_read_b64_tr_b16 v[64:65],v12 offset:64
ds_read_b64_tr_b16 v[66:67],v12 offset:832
ds_read_b64_tr_b16 v[68:69],v12 offset:12352
ds_read_b64_tr_b16 v[70:71],v12 offset:13120
s_branch ld_22
lw_26:
ds_read_b64_tr_b16 a[144:145],v12 offset:0
ds_read_b64_tr_b16 a[146:147],v12 offset:768
ds_read_b64_tr_b16 a[148:149],v12 offset:12288
ds_read_b64_tr_b16 a[150:151],v12 offset:13056
ds_read_b64_tr_b16 a[152:153],v12 offset:32
ds_read_b64_tr_b16 a[154:155],v12 offset:800
ds_read_b64_tr_b16 a[156:157],v12 offset:12320
ds_read_b64_tr_b16 a[158:159],v12 offset:13088
ds_read_b64_tr_b16 v[48:49],v12 offset:64
ds_read_b64_tr_b16 v[50:51],v12 offset:832
ds_read_b64_tr_b16 v[52:53],v12 offset:12352
ds_read_b64_tr_b16 v[54:55],v12 offset:13120
ld_22:
s_waitcnt lgkmcnt(0)
s_waitcnt vmcnt(24)
s_barrier
s_add_u32 s60,s75,s74
s_add_u32 m0,s77,73728
s_add_u32 s61,s60,3145728
buffer_load_dwordx4 v104,s[52:55],s61 offen lds
s_add_u32 m0,s77,74752
s_add_u32 s61,s60,3145728
buffer_load_dwordx4 v105,s[52:55],s61 offen lds
s_add_u32 m0,s77,75776
s_add_u32 s61,s60,3145728
buffer_load_dwordx4 v106,s[52:55],s61 offen lds
s_add_u32 m0,s77,76800
s_add_u32 s61,s60,3244032
buffer_load_dwordx4 v104,s[52:55],s61 offen lds
s_add_u32 m0,s77,77824
s_add_u32 s61,s60,3244032
buffer_load_dwordx4 v105,s[52:55],s61 offen lds
s_add_u32 m0,s77,78848
s_add_u32 s61,s60,3244032
buffer_load_dwordx4 v106,s[52:55],s61 offen lds
v_add_u32 v12,98304,v107
s_cmp_eq_u32 s46,1
s_cbranch_scc1 lw_29
s_cmp_eq_u32 s46,2
s_cbranch_scc1 lw_30
s_cmp_eq_u32 s46,3
s_cbranch_scc1 lw_31
lw_28:
ds_read_b64_tr_b16 a[80:81],v12 offset:0
ds_read_b64_tr_b16 a[82:83],v12 offset:768
ds_read_b64_tr_b16 a[84:85],v12 offset:12288
ds_read_b64_tr_b16 a[86:87],v12 offset:13056
ds_read_b64_tr_b16 a[88:89],v12 offset:32
ds_read_b64_tr_b16 a[90:91],v12 offset:800
ds_read_b64_tr_b16 a[92:93],v12 offset:12320
ds_read_b64_tr_b16 a[94:95],v12 offset:13088
ds_read_b64_tr_b16 a[96:97],v12 offset:64
ds_read_b64_tr_b16 a[98:99],v12 offset:832
ds_read_b64_tr_b16 a[100:101],v12 offset:12352
ds_read_b64_tr_b16 a[102:103],v12 offset:13120
s_branch ld_27
lw_29:
ds_read_b64_tr_b16 a[0:1],v12 offset:0
ds_read_b64_tr_b16 a[2:3],v12 offset:768
ds_read_b64_tr_b16 a[4:5],v12 offset:12288
ds_read_b64_tr_b16 a[6:7],v12 offset:13056
ds_read_b64_tr_b16 a[8:9],v12 offset:32
ds_read_b64_tr_b16 a[10:11],v12 offset:800
ds_read_b64_tr_b16 a[12:13],v12 offset:12320
ds_read_b64_tr_b16 a[14:15],v12 offset:13088
ds_read_b64_tr_b16 a[16:17],v12 offset:64
ds_read_b64_tr_b16 a[18:19],v12 offset:832
ds_read_b64_tr_b16 a[20:21],v12 offset:12352
ds_read_b64_tr_b16 a[22:23],v12 offset:13120
s_branch ld_27
lw_30:
ds_read_b64_tr_b16 a[240:241],v12 offset:0
ds_read_b64_tr_b16 a[242:243],v12 offset:768
ds_read_b64_tr_b16 a[244:245],v12 offset:12288
ds_read_b64_tr_b16 a[246:247],v12 offset:13056
ds_read_b64_tr_b16 a[248:249],v12 offset:32
ds_read_b64_tr_b16 a[250:251],v12 offset:800
ds_read_b64_tr_b16 a[252:253],v12 offset:12320
ds_read_b64_tr_b16 a[254:255],v12 offset:13088
ds_read_b64_tr_b16 v[112:113],v12 offset:64
ds_read_b64_tr_b16 v[114:115],v12 offset:832
ds_read_b64_tr_b16 v[116:117],v12 offset:12352
ds_read_b64_tr_b16 v[118:119],v12 offset:13120
s_branch ld_27
lw_31:
ds_read_b64_tr_b16 a[160:161],v12 offset:0
ds_read_b64_tr_b16 a[162:163],v12 offset:768
ds_read_b64_tr_b16 a[164:165],v12 offset:12288
ds_read_b64_tr_b16 a[166:167],v12 offset:13056
ds_read_b64_tr_b16 a[168:169],v12 offset:32
ds_read_b64_tr_b16 a[170:171],v12 offset:800
ds_read_b64_tr_b16 a[172:173],v12 offset:12320
ds_read_b64_tr_b16 a[174:175],v12 offset:13088
ds_read_b64_tr_b16 a[176:177],v12 offset:64
ds_read_b64_tr_b16 a[178:179],v12 offset:832
ds_read_b64_tr_b16 a[180:181],v12 offset:12352
ds_read_b64_tr_b16 a[182:183],v12 offset:13120
ld_27:
s_waitcnt lgkmcnt(0)
s_waitcnt vmcnt(24)
s_barrier
s_add_u32 s60,s75,s73
s_add_u32 m0,s77,98304
s_add_u32 s61,s60,3932160
buffer_load_dwordx4 v104,s[4:7],s61 offen lds
s_add_u32 m0,s77,99328
s_add_u32 s61,s60,3932160
buffer_load_dwordx4 v105,s[4:7],s61 offen lds
s_add_u32 m0,s77,100352
s_add_u32 s61,s60,3932160
buffer_load_dwordx4 v106,s[4:7],s61 offen lds
s_add_u32 m0,s77,101376
s_add_u32 s61,s60,4030464
buffer_load_dwordx4 v104,s[4:7],s61 offen lds
s_add_u32 m0,s77,102400
s_add_u32 s61,s60,4030464
buffer_load_dwordx4 v105,s[4:7],s61 offen lds
s_add_u32 m0,s77,103424
s_add_u32 s61,s60,4030464
buffer_load_dwordx4 v106,s[4:7],s61 offen lds
v_add_u32 v12,122880,v107
s_cmp_eq_u32 s46,1
s_cbranch_scc1 lw_34
s_cmp_eq_u32 s46,2
s_cbranch_scc1 lw_35
s_cmp_eq_u32 s46,3
s_cbranch_scc1 lw_36
lw_33:
ds_read_b64_tr_b16 a[104:105],v12 offset:0
ds_read_b64_tr_b16 a[106:107],v12 offset:768
ds_read_b64_tr_b16 a[108:109],v12 offset:12288
ds_read_b64_tr_b16 a[110:111],v12 offset:13056
ds_read_b64_tr_b16 a[112:113],v12 offset:32
ds_read_b64_tr_b16 a[114:115],v12 offset:800
ds_read_b64_tr_b16 a[116:117],v12 offset:12320
ds_read_b64_tr_b16 a[118:119],v12 offset:13088
ds_read_b64_tr_b16 v[40:41],v12 offset:64
ds_read_b64_tr_b16 v[42:43],v12 offset:832
ds_read_b64_tr_b16 v[44:45],v12 offset:12352
ds_read_b64_tr_b16 v[46:47],v12 offset:13120
s_branch ld_32
lw_34:
ds_read_b64_tr_b16 a[24:25],v12 offset:0
ds_read_b64_tr_b16 a[26:27],v12 offset:768
ds_read_b64_tr_b16 a[28:29],v12 offset:12288
ds_read_b64_tr_b16 a[30:31],v12 offset:13056
ds_read_b64_tr_b16 a[32:33],v12 offset:32
ds_read_b64_tr_b16 a[34:35],v12 offset:800
ds_read_b64_tr_b16 a[36:37],v12 offset:12320
ds_read_b64_tr_b16 a[38:39],v12 offset:13088
ds_read_b64_tr_b16 v[24:25],v12 offset:64
ds_read_b64_tr_b16 v[26:27],v12 offset:832
ds_read_b64_tr_b16 v[28:29],v12 offset:12352
ds_read_b64_tr_b16 v[30:31],v12 offset:13120
s_branch ld_32
lw_35:
ds_read_b64_tr_b16 v[120:121],v12 offset:0
ds_read_b64_tr_b16 v[122:123],v12 offset:768
ds_read_b64_tr_b16 v[124:125],v12 offset:12288
ds_read_b64_tr_b16 v[126:127],v12 offset:13056
ds_read_b64_tr_b16 v[128:129],v12 offset:32
ds_read_b64_tr_b16 v[130:131],v12 offset:800
ds_read_b64_tr_b16 v[132:133],v12 offset:12320
ds_read_b64_tr_b16 v[134:135],v12 offset:13088
ds_read_b64_tr_b16 v[72:73],v12 offset:64
ds_read_b64_tr_b16 v[74:75],v12 offset:832
ds_read_b64_tr_b16 v[76:77],v12 offset:12352
ds_read_b64_tr_b16 v[78:79],v12 offset:13120
s_branch ld_32
lw_36:
ds_read_b64_tr_b16 a[184:185],v12 offset:0
ds_read_b64_tr_b16 a[186:187],v12 offset:768
ds_read_b64_tr_b16 a[188:189],v12 offset:12288
ds_read_b64_tr_b16 a[190:191],v12 offset:13056
ds_read_b64_tr_b16 a[192:193],v12 offset:32
ds_read_b64_tr_b16 a[194:195],v12 offset:800
ds_read_b64_tr_b16 a[196:197],v12 offset:12320
ds_read_b64_tr_b16 a[198:199],v12 offset:13088
ds_read_b64_tr_b16 v[56:57],v12 offset:64
ds_read_b64_tr_b16 v[58:59],v12 offset:832
ds_read_b64_tr_b16 v[60:61],v12 offset:12352
ds_read_b64_tr_b16 v[62:63],v12 offset:13120
ld_32:
s_waitcnt lgkmcnt(0)
s_waitcnt vmcnt(24)
s_barrier
s_add_u32 s60,s75,s74
s_add_u32 m0,s77,122880
s_add_u32 s61,s60,3932160
buffer_load_dwordx4 v104,s[52:55],s61 offen lds
s_add_u32 m0,s77,123904
s_add_u32 s61,s60,3932160
buffer_load_dwordx4 v105,s[52:55],s61 offen lds
s_add_u32 m0,s77,124928
s_add_u32 s61,s60,3932160
buffer_load_dwordx4 v106,s[52:55],s61 offen lds
s_add_u32 m0,s77,125952
s_add_u32 s61,s60,4030464
buffer_load_dwordx4 v104,s[52:55],s61 offen lds
s_add_u32 m0,s77,126976
s_add_u32 s61,s60,4030464
buffer_load_dwordx4 v105,s[52:55],s61 offen lds
s_add_u32 m0,s77,128000
s_add_u32 s61,s60,4030464
buffer_load_dwordx4 v106,s[52:55],s61 offen lds
v_add_u32 v12,0,v107
s_cmp_eq_u32 s46,1
s_cbranch_scc1 lw_39
s_cmp_eq_u32 s46,2
s_cbranch_scc1 lw_40
s_cmp_eq_u32 s46,3
s_cbranch_scc1 lw_41
lw_38:
ds_read_b64_tr_b16 a[120:121],v12 offset:0
ds_read_b64_tr_b16 a[122:123],v12 offset:768
ds_read_b64_tr_b16 a[124:125],v12 offset:12288
ds_read_b64_tr_b16 a[126:127],v12 offset:13056
ds_read_b64_tr_b16 a[128:129],v12 offset:32
ds_read_b64_tr_b16 a[130:131],v12 offset:800
ds_read_b64_tr_b16 a[132:133],v12 offset:12320
ds_read_b64_tr_b16 a[134:135],v12 offset:13088
ds_read_b64_tr_b16 a[136:137],v12 offset:64
ds_read_b64_tr_b16 a[138:139],v12 offset:832
ds_read_b64_tr_b16 a[140:141],v12 offset:12352
ds_read_b64_tr_b16 a[142:143],v12 offset:13120
s_branch ld_37
lw_39:
ds_read_b64_tr_b16 a[40:41],v12 offset:0
ds_read_b64_tr_b16 a[42:43],v12 offset:768
ds_read_b64_tr_b16 a[44:45],v12 offset:12288
ds_read_b64_tr_b16 a[46:47],v12 offset:13056
ds_read_b64_tr_b16 a[48:49],v12 offset:32
ds_read_b64_tr_b16 a[50:51],v12 offset:800
ds_read_b64_tr_b16 a[52:53],v12 offset:12320
ds_read_b64_tr_b16 a[54:55],v12 offset:13088
ds_read_b64_tr_b16 a[56:57],v12 offset:64
ds_read_b64_tr_b16 a[58:59],v12 offset:832
ds_read_b64_tr_b16 a[60:61],v12 offset:12352
ds_read_b64_tr_b16 a[62:63],v12 offset:13120
s_branch ld_37
lw_40:
ds_read_b64_tr_b16 v[136:137],v12 offset:0
ds_read_b64_tr_b16 v[138:139],v12 offset:768
ds_read_b64_tr_b16 v[140:141],v12 offset:12288
ds_read_b64_tr_b16 v[142:143],v12 offset:13056
ds_read_b64_tr_b16 v[144:145],v12 offset:32
ds_read_b64_tr_b16 v[146:147],v12 offset:800
ds_read_b64_tr_b16 v[148:149],v12 offset:12320
ds_read_b64_tr_b16 v[150:151],v12 offset:13088
ds_read_b64_tr_b16 v[152:153],v12 offset:64
ds_read_b64_tr_b16 v[154:155],v12 offset:832
ds_read_b64_tr_b16 v[156:157],v12 offset:12352
ds_read_b64_tr_b16 v[158:159],v12 offset:13120
s_branch ld_37
lw_41:
ds_read_b64_tr_b16 a[200:201],v12 offset:0
ds_read_b64_tr_b16 a[202:203],v12 offset:768
ds_read_b64_tr_b16 a[204:205],v12 offset:12288
ds_read_b64_tr_b16 a[206:207],v12 offset:13056
ds_read_b64_tr_b16 a[208:209],v12 offset:32
ds_read_b64_tr_b16 a[210:211],v12 offset:800
ds_read_b64_tr_b16 a[212:213],v12 offset:12320
ds_read_b64_tr_b16 a[214:215],v12 offset:13088
ds_read_b64_tr_b16 a[216:217],v12 offset:64
ds_read_b64_tr_b16 a[218:219],v12 offset:832
ds_read_b64_tr_b16 a[220:221],v12 offset:12352
ds_read_b64_tr_b16 a[222:223],v12 offset:13120
ld_37:
s_waitcnt lgkmcnt(0)
s_waitcnt vmcnt(24)
s_barrier
s_add_u32 s60,s75,s73
s_add_u32 m0,s77,0
s_add_u32 s61,s60,4718592
buffer_load_dwordx4 v104,s[4:7],s61 offen lds
s_add_u32 m0,s77,1024
s_add_u32 s61,s60,4718592
buffer_load_dwordx4 v105,s[4:7],s61 offen lds
s_add_u32 m0,s77,2048
s_add_u32 s61,s60,4718592
buffer_load_dwordx4 v106,s[4:7],s61 offen lds
s_add_u32 m0,s77,3072
s_add_u32 s61,s60,4816896
buffer_load_dwordx4 v104,s[4:7],s61 offen lds
s_add_u32 m0,s77,4096
s_add_u32 s61,s60,4816896
buffer_load_dwordx4 v105,s[4:7],s61 offen lds
s_add_u32 m0,s77,5120
s_add_u32 s61,s60,4816896
buffer_load_dwordx4 v106,s[4:7],s61 offen lds
v_add_u32 v12,24576,v107
s_cmp_eq_u32 s46,1
s_cbranch_scc1 lw_44
s_cmp_eq_u32 s46,2
s_cbranch_scc1 lw_45
s_cmp_eq_u32 s46,3
s_cbranch_scc1 lw_46
lw_43:
ds_read_b64_tr_b16 a[144:145],v12 offset:0
ds_read_b64_tr_b16 a[146:147],v12 offset:768
ds_read_b64_tr_b16 a[148:149],v12 offset:12288
ds_read_b64_tr_b16 a[150:151],v12 offset:13056
ds_read_b64_tr_b16 a[152:153],v12 offset:32
ds_read_b64_tr_b16 a[154:155],v12 offset:800
ds_read_b64_tr_b16 a[156:157],v12 offset:12320
ds_read_b64_tr_b16 a[158:159],v12 offset:13088
ds_read_b64_tr_b16 v[48:49],v12 offset:64
ds_read_b64_tr_b16 v[50:51],v12 offset:832
ds_read_b64_tr_b16 v[52:53],v12 offset:12352
ds_read_b64_tr_b16 v[54:55],v12 offset:13120
s_branch ld_42
lw_44:
ds_read_b64_tr_b16 a[64:65],v12 offset:0
ds_read_b64_tr_b16 a[66:67],v12 offset:768
ds_read_b64_tr_b16 a[68:69],v12 offset:12288
ds_read_b64_tr_b16 a[70:71],v12 offset:13056
ds_read_b64_tr_b16 a[72:73],v12 offset:32
ds_read_b64_tr_b16 a[74:75],v12 offset:800
ds_read_b64_tr_b16 a[76:77],v12 offset:12320
ds_read_b64_tr_b16 a[78:79],v12 offset:13088
ds_read_b64_tr_b16 v[32:33],v12 offset:64
ds_read_b64_tr_b16 v[34:35],v12 offset:832
ds_read_b64_tr_b16 v[36:37],v12 offset:12352
ds_read_b64_tr_b16 v[38:39],v12 offset:13120
s_branch ld_42
lw_45:
ds_read_b64_tr_b16 v[160:161],v12 offset:0
ds_read_b64_tr_b16 v[162:163],v12 offset:768
ds_read_b64_tr_b16 v[164:165],v12 offset:12288
ds_read_b64_tr_b16 v[166:167],v12 offset:13056
ds_read_b64_tr_b16 v[168:169],v12 offset:32
ds_read_b64_tr_b16 v[170:171],v12 offset:800
ds_read_b64_tr_b16 v[172:173],v12 offset:12320
ds_read_b64_tr_b16 v[174:175],v12 offset:13088
ds_read_b64_tr_b16 v[80:81],v12 offset:64
ds_read_b64_tr_b16 v[82:83],v12 offset:832
ds_read_b64_tr_b16 v[84:85],v12 offset:12352
ds_read_b64_tr_b16 v[86:87],v12 offset:13120
s_branch ld_42
lw_46:
ds_read_b64_tr_b16 a[224:225],v12 offset:0
ds_read_b64_tr_b16 a[226:227],v12 offset:768
ds_read_b64_tr_b16 a[228:229],v12 offset:12288
ds_read_b64_tr_b16 a[230:231],v12 offset:13056
ds_read_b64_tr_b16 a[232:233],v12 offset:32
ds_read_b64_tr_b16 a[234:235],v12 offset:800
ds_read_b64_tr_b16 a[236:237],v12 offset:12320
ds_read_b64_tr_b16 a[238:239],v12 offset:13088
ds_read_b64_tr_b16 v[64:65],v12 offset:64
ds_read_b64_tr_b16 v[66:67],v12 offset:832
ds_read_b64_tr_b16 v[68:69],v12 offset:12352
ds_read_b64_tr_b16 v[70:71],v12 offset:13120
ld_42:
s_waitcnt lgkmcnt(0)
s_waitcnt vmcnt(24)
s_barrier
s_add_u32 s60,s75,s74
s_add_u32 m0,s77,24576
s_add_u32 s61,s60,4718592
buffer_load_dwordx4 v104,s[52:55],s61 offen lds
s_add_u32 m0,s77,25600
s_add_u32 s61,s60,4718592
buffer_load_dwordx4 v105,s[52:55],s61 offen lds
s_add_u32 m0,s77,26624
s_add_u32 s61,s60,4718592
buffer_load_dwordx4 v106,s[52:55],s61 offen lds
s_add_u32 m0,s77,27648
s_add_u32 s61,s60,4816896
buffer_load_dwordx4 v104,s[52:55],s61 offen lds
s_add_u32 m0,s77,28672
s_add_u32 s61,s60,4816896
buffer_load_dwordx4 v105,s[52:55],s61 offen lds
s_add_u32 m0,s77,29696
s_add_u32 s61,s60,4816896
buffer_load_dwordx4 v106,s[52:55],s61 offen lds
v_add_u32 v12,49152,v107
s_cmp_eq_u32 s46,1
s_cbranch_scc1 lw_49
s_cmp_eq_u32 s46,2
s_cbranch_scc1 lw_50
s_cmp_eq_u32 s46,3
s_cbranch_scc1 lw_51
lw_48:
ds_read_b64_tr_b16 a[160:161],v12 offset:0
ds_read_b64_tr_b16 a[162:163],v12 offset:768
ds_read_b64_tr_b16 a[164:165],v12 offset:12288
ds_read_b64_tr_b16 a[166:167],v12 offset:13056
ds_read_b64_tr_b16 a[168:169],v12 offset:32
ds_read_b64_tr_b16 a[170:171],v12 offset:800
ds_read_b64_tr_b16 a[172:173],v12 offset:12320
ds_read_b64_tr_b16 a[174:175],v12 offset:13088
ds_read_b64_tr_b16 a[176:177],v12 offset:64
ds_read_b64_tr_b16 a[178:179],v12 offset:832
ds_read_b64_tr_b16 a[180:181],v12 offset:12352
ds_read_b64_tr_b16 a[182:183],v12 offset:13120
s_branch ld_47
lw_49:
ds_read_b64_tr_b16 a[80:81],v12 offset:0
ds_read_b64_tr_b16 a[82:83],v12 offset:768
ds_read_b64_tr_b16 a[84:85],v12 offset:12288
ds_read_b64_tr_b16 a[86:87],v12 offset:13056
ds_read_b64_tr_b16 a[88:89],v12 offset:32
ds_read_b64_tr_b16 a[90:91],v12 offset:800
ds_read_b64_tr_b16 a[92:93],v12 offset:12320
ds_read_b64_tr_b16 a[94:95],v12 offset:13088
ds_read_b64_tr_b16 a[96:97],v12 offset:64
ds_read_b64_tr_b16 a[98:99],v12 offset:832
ds_read_b64_tr_b16 a[100:101],v12 offset:12352
ds_read_b64_tr_b16 a[102:103],v12 offset:13120
s_branch ld_47
lw_50:
ds_read_b64_tr_b16 a[0:1],v12 offset:0
ds_read_b64_tr_b16 a[2:3],v12 offset:768
ds_read_b64_tr_b16 a[4:5],v12 offset:12288
ds_read_b64_tr_b16 a[6:7],v12 offset:13056
ds_read_b64_tr_b16 a[8:9],v12 offset:32
ds_read_b64_tr_b16 a[10:11],v12 offset:800
ds_read_b64_tr_b16 a[12:13],v12 offset:12320
ds_read_b64_tr_b16 a[14:15],v12 offset:13088
ds_read_b64_tr_b16 a[16:17],v12 offset:64
ds_read_b64_tr_b16 a[18:19],v12 offset:832
ds_read_b64_tr_b16 a[20:21],v12 offset:12352
ds_read_b64_tr_b16 a[22:23],v12 offset:13120
s_branch ld_47
lw_51:
ds_read_b64_tr_b16 a[240:241],v12 offset:0
ds_read_b64_tr_b16 a[242:243],v12 offset:768
ds_read_b64_tr_b16 a[244:245],v12 offset:12288
ds_read_b64_tr_b16 a[246:247],v12 offset:13056
ds_read_b64_tr_b16 a[248:249],v12 offset:32
ds_read_b64_tr_b16 a[250:251],v12 offset:800
ds_read_b64_tr_b16 a[252:253],v12 offset:12320
ds_read_b64_tr_b16 a[254:255],v12 offset:13088
ds_read_b64_tr_b16 v[112:113],v12 offset:64
ds_read_b64_tr_b16 v[114:115],v12 offset:832
ds_read_b64_tr_b16 v[116:117],v12 offset:12352
ds_read_b64_tr_b16 v[118:119],v12 offset:13120
ld_47:
s_waitcnt lgkmcnt(0)
s_waitcnt vmcnt(24)
s_barrier
s_add_u32 s60,s75,s73
s_add_u32 m0,s77,49152
s_add_u32 s61,s60,5505024
buffer_load_dwordx4 v104,s[4:7],s61 offen lds
s_add_u32 m0,s77,50176
s_add_u32 s61,s60,5505024
buffer_load_dwordx4 v105,s[4:7],s61 offen lds
s_add_u32 m0,s77,51200
s_add_u32 s61,s60,5505024
buffer_load_dwordx4 v106,s[4:7],s61 offen lds
s_add_u32 m0,s77,52224
s_add_u32 s61,s60,5603328
buffer_load_dwordx4 v104,s[4:7],s61 offen lds
s_add_u32 m0,s77,53248
s_add_u32 s61,s60,5603328
buffer_load_dwordx4 v105,s[4:7],s61 offen lds
s_add_u32 m0,s77,54272
s_add_u32 s61,s60,5603328
buffer_load_dwordx4 v106,s[4:7],s61 offen lds
v_add_u32 v12,73728,v107
s_cmp_eq_u32 s46,1
s_cbranch_scc1 lw_54
s_cmp_eq_u32 s46,2
s_cbranch_scc1 lw_55
s_cmp_eq_u32 s46,3
s_cbranch_scc1 lw_56
lw_53:
ds_read_b64_tr_b16 a[184:185],v12 offset:0
ds_read_b64_tr_b16 a[186:187],v12 offset:768
ds_read_b64_tr_b16 a[188:189],v12 offset:12288
ds_read_b64_tr_b16 a[190:191],v12 offset:13056
ds_read_b64_tr_b16 a[192:193],v12 offset:32
ds_read_b64_tr_b16 a[194:195],v12 offset:800
ds_read_b64_tr_b16 a[196:197],v12 offset:12320
ds_read_b64_tr_b16 a[198:199],v12 offset:13088
ds_read_b64_tr_b16 v[56:57],v12 offset:64
ds_read_b64_tr_b16 v[58:59],v12 offset:832
ds_read_b64_tr_b16 v[60:61],v12 offset:12352
ds_read_b64_tr_b16 v[62:63],v12 offset:13120
s_branch ld_52
lw_54:
ds_read_b64_tr_b16 a[104:105],v12 offset:0
ds_read_b64_tr_b16 a[106:107],v12 offset:768
ds_read_b64_tr_b16 a[108:109],v12 offset:12288
ds_read_b64_tr_b16 a[110:111],v12 offset:13056
ds_read_b64_tr_b16 a[112:113],v12 offset:32
ds_read_b64_tr_b16 a[114:115],v12 offset:800
ds_read_b64_tr_b16 a[116:117],v12 offset:12320
ds_read_b64_tr_b16 a[118:119],v12 offset:13088
ds_read_b64_tr_b16 v[40:41],v12 offset:64
ds_read_b64_tr_b16 v[42:43],v12 offset:832
ds_read_b64_tr_b16 v[44:45],v12 offset:12352
ds_read_b64_tr_b16 v[46:47],v12 offset:13120
s_branch ld_52
lw_55:
ds_read_b64_tr_b16 a[24:25],v12 offset:0
ds_read_b64_tr_b16 a[26:27],v12 offset:768
ds_read_b64_tr_b16 a[28:29],v12 offset:12288
ds_read_b64_tr_b16 a[30:31],v12 offset:13056
ds_read_b64_tr_b16 a[32:33],v12 offset:32
ds_read_b64_tr_b16 a[34:35],v12 offset:800
ds_read_b64_tr_b16 a[36:37],v12 offset:12320
ds_read_b64_tr_b16 a[38:39],v12 offset:13088
ds_read_b64_tr_b16 v[24:25],v12 offset:64
ds_read_b64_tr_b16 v[26:27],v12 offset:832
ds_read_b64_tr_b16 v[28:29],v12 offset:12352
ds_read_b64_tr_b16 v[30:31],v12 offset:13120
s_branch ld_52
lw_56:
ds_read_b64_tr_b16 v[120:121],v12 offset:0
ds_read_b64_tr_b16 v[122:123],v12 offset:768
ds_read_b64_tr_b16 v[124:125],v12 offset:12288
ds_read_b64_tr_b16 v[126:127],v12 offset:13056
ds_read_b64_tr_b16 v[128:129],v12 offset:32
ds_read_b64_tr_b16 v[130:131],v12 offset:800
ds_read_b64_tr_b16 v[132:133],v12 offset:12320
ds_read_b64_tr_b16 v[134:135],v12 offset:13088
ds_read_b64_tr_b16 v[72:73],v12 offset:64
ds_read_b64_tr_b16 v[74:75],v12 offset:832
ds_read_b64_tr_b16 v[76:77],v12 offset:12352
ds_read_b64_tr_b16 v[78:79],v12 offset:13120
ld_52:
s_waitcnt lgkmcnt(0)
s_waitcnt vmcnt(24)
s_barrier
s_add_u32 s60,s75,s74
s_add_u32 m0,s77,73728
s_add_u32 s61,s60,5505024
buffer_load_dwordx4 v104,s[52:55],s61 offen lds
s_add_u32 m0,s77,74752
s_add_u32 s61,s60,5505024
buffer_load_dwordx4 v105,s[52:55],s61 offen lds
s_add_u32 m0,s77,75776
s_add_u32 s61,s60,5505024
buffer_load_dwordx4 v106,s[52:55],s61 offen lds
s_add_u32 m0,s77,76800
s_add_u32 s61,s60,5603328
buffer_load_dwordx4 v104,s[52:55],s61 offen lds
s_add_u32 m0,s77,77824
s_add_u32 s61,s60,5603328
buffer_load_dwordx4 v105,s[52:55],s61 offen lds
s_add_u32 m0,s77,78848
s_add_u32 s61,s60,5603328
buffer_load_dwordx4 v106,s[52:55],s61 offen lds
v_add_u32 v12,98304,v107
s_cmp_eq_u32 s46,1
s_cbranch_scc1 lw_59
s_cmp_eq_u32 s46,2
s_cbranch_scc1 lw_60
s_cmp_eq_u32 s46,3
s_cbranch_scc1 lw_61
lw_58:
ds_read_b64_tr_b16 a[200:201],v12 offset:0
ds_read_b64_tr_b16 a[202:203],v12 offset:768
ds_read_b64_tr_b16 a[204:205],v12 offset:12288
ds_read_b64_tr_b16 a[206:207],v12 offset:13056
ds_read_b64_tr_b16 a[208:209],v12 offset:32
ds_read_b64_tr_b16 a[210:211],v12 offset:800
ds_read_b64_tr_b16 a[212:213],v12 offset:12320
ds_read_b64_tr_b16 a[214:215],v12 offset:13088
ds_read_b64_tr_b16 a[216:217],v12 offset:64
ds_read_b64_tr_b16 a[218:219],v12 offset:832
ds_read_b64_tr_b16 a[220:221],v12 offset:12352
ds_read_b64_tr_b16 a[222:223],v12 offset:13120
s_branch ld_57
lw_59:
ds_read_b64_tr_b16 a[120:121],v12 offset:0
ds_read_b64_tr_b16 a[122:123],v12 offset:768
ds_read_b64_tr_b16 a[124:125],v12 offset:12288
ds_read_b64_tr_b16 a[126:127],v12 offset:13056
ds_read_b64_tr_b16 a[128:129],v12 offset:32
ds_read_b64_tr_b16 a[130:131],v12 offset:800
ds_read_b64_tr_b16 a[132:133],v12 offset:12320
ds_read_b64_tr_b16 a[134:135],v12 offset:13088
ds_read_b64_tr_b16 a[136:137],v12 offset:64
ds_read_b64_tr_b16 a[138:139],v12 offset:832
ds_read_b64_tr_b16 a[140:141],v12 offset:12352
ds_read_b64_tr_b16 a[142:143],v12 offset:13120
s_branch ld_57
lw_60:
ds_read_b64_tr_b16 a[40:41],v12 offset:0
ds_read_b64_tr_b16 a[42:43],v12 offset:768
ds_read_b64_tr_b16 a[44:45],v12 offset:12288
ds_read_b64_tr_b16 a[46:47],v12 offset:13056
ds_read_b64_tr_b16 a[48:49],v12 offset:32
ds_read_b64_tr_b16 a[50:51],v12 offset:800
ds_read_b64_tr_b16 a[52:53],v12 offset:12320
ds_read_b64_tr_b16 a[54:55],v12 offset:13088
ds_read_b64_tr_b16 a[56:57],v12 offset:64
ds_read_b64_tr_b16 a[58:59],v12 offset:832
ds_read_b64_tr_b16 a[60:61],v12 offset:12352
ds_read_b64_tr_b16 a[62:63],v12 offset:13120
s_branch ld_57
lw_61:
ds_read_b64_tr_b16 v[136:137],v12 offset:0
ds_read_b64_tr_b16 v[138:139],v12 offset:768
ds_read_b64_tr_b16 v[140:141],v12 offset:12288
ds_read_b64_tr_b16 v[142:143],v12 offset:13056
ds_read_b64_tr_b16 v[144:145],v12 offset:32
ds_read_b64_tr_b16 v[146:147],v12 offset:800
ds_read_b64_tr_b16 v[148:149],v12 offset:12320
ds_read_b64_tr_b16 v[150:151],v12 offset:13088
ds_read_b64_tr_b16 v[152:153],v12 offset:64
ds_read_b64_tr_b16 v[154:155],v12 offset:832
ds_read_b64_tr_b16 v[156:157],v12 offset:12352
ds_read_b64_tr_b16 v[158:159],v12 offset:13120
ld_57:
s_waitcnt lgkmcnt(0)
s_waitcnt vmcnt(24)
s_barrier
s_add_u32 s60,s76,s73
s_add_u32 m0,s77,98304
s_add_u32 s61,s60,6291456
buffer_load_dwordx4 v104,s[4:7],s61 offen lds
s_add_u32 m0,s77,99328
s_add_u32 s61,s60,6291456
buffer_load_dwordx4 v105,s[4:7],s61 offen lds
s_add_u32 m0,s77,100352
s_add_u32 s61,s60,6291456
buffer_load_dwordx4 v106,s[4:7],s61 offen lds
s_add_u32 m0,s77,101376
s_add_u32 s61,s60,6389760
buffer_load_dwordx4 v104,s[4:7],s61 offen lds
s_add_u32 m0,s77,102400
s_add_u32 s61,s60,6389760
buffer_load_dwordx4 v105,s[4:7],s61 offen lds
s_add_u32 m0,s77,103424
s_add_u32 s61,s60,6389760
buffer_load_dwordx4 v106,s[4:7],s61 offen lds
v_add_u32 v12,122880,v107
s_cmp_eq_u32 s46,1
s_cbranch_scc1 lw_64
s_cmp_eq_u32 s46,2
s_cbranch_scc1 lw_65
s_cmp_eq_u32 s46,3
s_cbranch_scc1 lw_66
lw_63:
ds_read_b64_tr_b16 a[224:225],v12 offset:0
ds_read_b64_tr_b16 a[226:227],v12 offset:768
ds_read_b64_tr_b16 a[228:229],v12 offset:12288
ds_read_b64_tr_b16 a[230:231],v12 offset:13056
ds_read_b64_tr_b16 a[232:233],v12 offset:32
ds_read_b64_tr_b16 a[234:235],v12 offset:800
ds_read_b64_tr_b16 a[236:237],v12 offset:12320
ds_read_b64_tr_b16 a[238:239],v12 offset:13088
ds_read_b64_tr_b16 v[64:65],v12 offset:64
ds_read_b64_tr_b16 v[66:67],v12 offset:832
ds_read_b64_tr_b16 v[68:69],v12 offset:12352
ds_read_b64_tr_b16 v[70:71],v12 offset:13120
s_branch ld_62
lw_64:
ds_read_b64_tr_b16 a[144:145],v12 offset:0
ds_read_b64_tr_b16 a[146:147],v12 offset:768
ds_read_b64_tr_b16 a[148:149],v12 offset:12288
ds_read_b64_tr_b16 a[150:151],v12 offset:13056
ds_read_b64_tr_b16 a[152:153],v12 offset:32
ds_read_b64_tr_b16 a[154:155],v12 offset:800
ds_read_b64_tr_b16 a[156:157],v12 offset:12320
ds_read_b64_tr_b16 a[158:159],v12 offset:13088
ds_read_b64_tr_b16 v[48:49],v12 offset:64
ds_read_b64_tr_b16 v[50:51],v12 offset:832
ds_read_b64_tr_b16 v[52:53],v12 offset:12352
ds_read_b64_tr_b16 v[54:55],v12 offset:13120
s_branch ld_62
lw_65:
ds_read_b64_tr_b16 a[64:65],v12 offset:0
ds_read_b64_tr_b16 a[66:67],v12 offset:768
ds_read_b64_tr_b16 a[68:69],v12 offset:12288
ds_read_b64_tr_b16 a[70:71],v12 offset:13056
ds_read_b64_tr_b16 a[72:73],v12 offset:32
ds_read_b64_tr_b16 a[74:75],v12 offset:800
ds_read_b64_tr_b16 a[76:77],v12 offset:12320
ds_read_b64_tr_b16 a[78:79],v12 offset:13088
ds_read_b64_tr_b16 v[32:33],v12 offset:64
ds_read_b64_tr_b16 v[34:35],v12 offset:832
ds_read_b64_tr_b16 v[36:37],v12 offset:12352
ds_read_b64_tr_b16 v[38:39],v12 offset:13120
s_branch ld_62
lw_66:
ds_read_b64_tr_b16 v[160:161],v12 offset:0
ds_read_b64_tr_b16 v[162:163],v12 offset:768
ds_read_b64_tr_b16 v[164:165],v12 offset:12288
ds_read_b64_tr_b16 v[166:167],v12 offset:13056
ds_read_b64_tr_b16 v[168:169],v12 offset:32
ds_read_b64_tr_b16 v[170:171],v12 offset:800
ds_read_b64_tr_b16 v[172:173],v12 offset:12320
ds_read_b64_tr_b16 v[174:175],v12 offset:13088
ds_read_b64_tr_b16 v[80:81],v12 offset:64
ds_read_b64_tr_b16 v[82:83],v12 offset:832
ds_read_b64_tr_b16 v[84:85],v12 offset:12352
ds_read_b64_tr_b16 v[86:87],v12 offset:13120
ld_62:
s_waitcnt lgkmcnt(0)
s_waitcnt vmcnt(24)
s_barrier
s_add_u32 s60,s76,s74
s_add_u32 m0,s77,122880
s_add_u32 s61,s60,6291456
buffer_load_dwordx4 v104,s[52:55],s61 offen lds
s_add_u32 m0,s77,123904
s_add_u32 s61,s60,6291456
buffer_load_dwordx4 v105,s[52:55],s61 offen lds
s_add_u32 m0,s77,124928
s_add_u32 s61,s60,6291456
buffer_load_dwordx4 v106,s[52:55],s61 offen lds
s_add_u32 m0,s77,125952
s_add_u32 s61,s60,6389760
buffer_load_dwordx4 v104,s[52:55],s61 offen lds
s_add_u32 m0,s77,126976
s_add_u32 s61,s60,6389760
buffer_load_dwordx4 v105,s[52:55],s61 offen lds
s_add_u32 m0,s77,128000
s_add_u32 s61,s60,6389760
buffer_load_dwordx4 v106,s[52:55],s61 offen lds
v_add_u32 v12,0,v107
s_cmp_eq_u32 s46,1
s_cbranch_scc1 lw_69
s_cmp_eq_u32 s46,2
s_cbranch_scc1 lw_70
s_cmp_eq_u32 s46,3
s_cbranch_scc1 lw_71
lw_68:
ds_read_b64_tr_b16 a[240:241],v12 offset:0
ds_read_b64_tr_b16 a[242:243],v12 offset:768
ds_read_b64_tr_b16 a[244:245],v12 offset:12288
ds_read_b64_tr_b16 a[246:247],v12 offset:13056
ds_read_b64_tr_b16 a[248:249],v12 offset:32
ds_read_b64_tr_b16 a[250:251],v12 offset:800
ds_read_b64_tr_b16 a[252:253],v12 offset:12320
ds_read_b64_tr_b16 a[254:255],v12 offset:13088
ds_read_b64_tr_b16 v[112:113],v12 offset:64
ds_read_b64_tr_b16 v[114:115],v12 offset:832
ds_read_b64_tr_b16 v[116:117],v12 offset:12352
ds_read_b64_tr_b16 v[118:119],v12 offset:13120
s_branch ld_67
lw_69:
ds_read_b64_tr_b16 a[160:161],v12 offset:0
ds_read_b64_tr_b16 a[162:163],v12 offset:768
ds_read_b64_tr_b16 a[164:165],v12 offset:12288
ds_read_b64_tr_b16 a[166:167],v12 offset:13056
ds_read_b64_tr_b16 a[168:169],v12 offset:32
ds_read_b64_tr_b16 a[170:171],v12 offset:800
ds_read_b64_tr_b16 a[172:173],v12 offset:12320
ds_read_b64_tr_b16 a[174:175],v12 offset:13088
ds_read_b64_tr_b16 a[176:177],v12 offset:64
ds_read_b64_tr_b16 a[178:179],v12 offset:832
ds_read_b64_tr_b16 a[180:181],v12 offset:12352
ds_read_b64_tr_b16 a[182:183],v12 offset:13120
s_branch ld_67
lw_70:
ds_read_b64_tr_b16 a[80:81],v12 offset:0
ds_read_b64_tr_b16 a[82:83],v12 offset:768
ds_read_b64_tr_b16 a[84:85],v12 offset:12288
ds_read_b64_tr_b16 a[86:87],v12 offset:13056
ds_read_b64_tr_b16 a[88:89],v12 offset:32
ds_read_b64_tr_b16 a[90:91],v12 offset:800
ds_read_b64_tr_b16 a[92:93],v12 offset:12320
ds_read_b64_tr_b16 a[94:95],v12 offset:13088
ds_read_b64_tr_b16 a[96:97],v12 offset:64
ds_read_b64_tr_b16 a[98:99],v12 offset:832
ds_read_b64_tr_b16 a[100:101],v12 offset:12352
ds_read_b64_tr_b16 a[102:103],v12 offset:13120
s_branch ld_67
lw_71:
ds_read_b64_tr_b16 a[0:1],v12 offset:0
ds_read_b64_tr_b16 a[2:3],v12 offset:768
ds_read_b64_tr_b16 a[4:5],v12 offset:12288
ds_read_b64_tr_b16 a[6:7],v12 offset:13056
ds_read_b64_tr_b16 a[8:9],v12 offset:32
ds_read_b64_tr_b16 a[10:11],v12 offset:800
ds_read_b64_tr_b16 a[12:13],v12 offset:12320
ds_read_b64_tr_b16 a[14:15],v12 offset:13088
ds_read_b64_tr_b16 a[16:17],v12 offset:64
ds_read_b64_tr_b16 a[18:19],v12 offset:832
ds_read_b64_tr_b16 a[20:21],v12 offset:12352
ds_read_b64_tr_b16 a[22:23],v12 offset:13120
ld_67:
s_waitcnt lgkmcnt(0)
s_waitcnt vmcnt(24)
s_barrier
s_add_u32 s60,s76,s73
s_add_u32 m0,s77,0
s_add_u32 s61,s60,7077888
buffer_load_dwordx4 v104,s[4:7],s61 offen lds
s_add_u32 m0,s77,1024
s_add_u32 s61,s60,7077888
buffer_load_dwordx4 v105,s[4:7],s61 offen lds
s_add_u32 m0,s77,2048
s_add_u32 s61,s60,7077888
buffer_load_dwordx4 v106,s[4:7],s61 offen lds
s_add_u32 m0,s77,3072
s_add_u32 s61,s60,7176192
buffer_load_dwordx4 v104,s[4:7],s61 offen lds
s_add_u32 m0,s77,4096
s_add_u32 s61,s60,7176192
buffer_load_dwordx4 v105,s[4:7],s61 offen lds
s_add_u32 m0,s77,5120
s_add_u32 s61,s60,7176192
buffer_load_dwordx4 v106,s[4:7],s61 offen lds
v_add_u32 v12,24576,v107
s_cmp_eq_u32 s46,1
s_cbranch_scc1 lw_74
s_cmp_eq_u32 s46,2
s_cbranch_scc1 lw_75
s_cmp_eq_u32 s46,3
s_cbranch_scc1 lw_76
lw_73:
ds_read_b64_tr_b16 v[120:121],v12 offset:0
ds_read_b64_tr_b16 v[122:123],v12 offset:768
ds_read_b64_tr_b16 v[124:125],v12 offset:12288
ds_read_b64_tr_b16 v[126:127],v12 offset:13056
ds_read_b64_tr_b16 v[128:129],v12 offset:32
ds_read_b64_tr_b16 v[130:131],v12 offset:800
ds_read_b64_tr_b16 v[132:133],v12 offset:12320
ds_read_b64_tr_b16 v[134:135],v12 offset:13088
ds_read_b64_tr_b16 v[72:73],v12 offset:64
ds_read_b64_tr_b16 v[74:75],v12 offset:832
ds_read_b64_tr_b16 v[76:77],v12 offset:12352
ds_read_b64_tr_b16 v[78:79],v12 offset:13120
s_branch ld_72
lw_74:
ds_read_b64_tr_b16 a[184:185],v12 offset:0
ds_read_b64_tr_b16 a[186:187],v12 offset:768
ds_read_b64_tr_b16 a[188:189],v12 offset:12288
ds_read_b64_tr_b16 a[190:191],v12 offset:13056
ds_read_b64_tr_b16 a[192:193],v12 offset:32
ds_read_b64_tr_b16 a[194:195],v12 offset:800
ds_read_b64_tr_b16 a[196:197],v12 offset:12320
ds_read_b64_tr_b16 a[198:199],v12 offset:13088
ds_read_b64_tr_b16 v[56:57],v12 offset:64
ds_read_b64_tr_b16 v[58:59],v12 offset:832
ds_read_b64_tr_b16 v[60:61],v12 offset:12352
ds_read_b64_tr_b16 v[62:63],v12 offset:13120
s_branch ld_72
lw_75:
ds_read_b64_tr_b16 a[104:105],v12 offset:0
ds_read_b64_tr_b16 a[106:107],v12 offset:768
ds_read_b64_tr_b16 a[108:109],v12 offset:12288
ds_read_b64_tr_b16 a[110:111],v12 offset:13056
ds_read_b64_tr_b16 a[112:113],v12 offset:32
ds_read_b64_tr_b16 a[114:115],v12 offset:800
ds_read_b64_tr_b16 a[116:117],v12 offset:12320
ds_read_b64_tr_b16 a[118:119],v12 offset:13088
ds_read_b64_tr_b16 v[40:41],v12 offset:64
ds_read_b64_tr_b16 v[42:43],v12 offset:832
ds_read_b64_tr_b16 v[44:45],v12 offset:12352
ds_read_b64_tr_b16 v[46:47],v12 offset:13120
s_branch ld_72
lw_76:
ds_read_b64_tr_b16 a[24:25],v12 offset:0
ds_read_b64_tr_b16 a[26:27],v12 offset:768
ds_read_b64_tr_b16 a[28:29],v12 offset:12288
ds_read_b64_tr_b16 a[30:31],v12 offset:13056
ds_read_b64_tr_b16 a[32:33],v12 offset:32
ds_read_b64_tr_b16 a[34:35],v12 offset:800
ds_read_b64_tr_b16 a[36:37],v12 offset:12320
ds_read_b64_tr_b16 a[38:39],v12 offset:13088
ds_read_b64_tr_b16 v[24:25],v12 offset:64
ds_read_b64_tr_b16 v[26:27],v12 offset:832
ds_read_b64_tr_b16 v[28:29],v12 offset:12352
ds_read_b64_tr_b16 v[30:31],v12 offset:13120
ld_72:
s_waitcnt lgkmcnt(0)
s_waitcnt vmcnt(24)
s_barrier
s_add_u32 s60,s76,s74
s_add_u32 m0,s77,24576
s_add_u32 s61,s60,7077888
buffer_load_dwordx4 v104,s[52:55],s61 offen lds
s_add_u32 m0,s77,25600
s_add_u32 s61,s60,7077888
buffer_load_dwordx4 v105,s[52:55],s61 offen lds
s_add_u32 m0,s77,26624
s_add_u32 s61,s60,7077888
buffer_load_dwordx4 v106,s[52:55],s61 offen lds
s_add_u32 m0,s77,27648
s_add_u32 s61,s60,7176192
buffer_load_dwordx4 v104,s[52:55],s61 offen lds
s_add_u32 m0,s77,28672
s_add_u32 s61,s60,7176192
buffer_load_dwordx4 v105,s[52:55],s61 offen lds
s_add_u32 m0,s77,29696
s_add_u32 s61,s60,7176192
buffer_load_dwordx4 v106,s[52:55],s61 offen lds
v_add_u32 v12,49152,v107
s_cmp_eq_u32 s46,1
s_cbranch_scc1 lw_79
s_cmp_eq_u32 s46,2
s_cbranch_scc1 lw_80
s_cmp_eq_u32 s46,3
s_cbranch_scc1 lw_81
lw_78:
ds_read_b64_tr_b16 v[136:137],v12 offset:0
ds_read_b64_tr_b16 v[138:139],v12 offset:768
ds_read_b64_tr_b16 v[140:141],v12 offset:12288
ds_read_b64_tr_b16 v[142:143],v12 offset:13056
ds_read_b64_tr_b16 v[144:145],v12 offset:32
ds_read_b64_tr_b16 v[146:147],v12 offset:800
ds_read_b64_tr_b16 v[148:149],v12 offset:12320
ds_read_b64_tr_b16 v[150:151],v12 offset:13088
ds_read_b64_tr_b16 v[152:153],v12 offset:64
ds_read_b64_tr_b16 v[154:155],v12 offset:832
ds_read_b64_tr_b16 v[156:157],v12 offset:12352
ds_read_b64_tr_b16 v[158:159],v12 offset:13120
s_branch ld_77
lw_79:
ds_read_b64_tr_b16 a[200:201],v12 offset:0
ds_read_b64_tr_b16 a[202:203],v12 offset:768
ds_read_b64_tr_b16 a[204:205],v12 offset:12288
ds_read_b64_tr_b16 a[206:207],v12 offset:13056
ds_read_b64_tr_b16 a[208:209],v12 offset:32
ds_read_b64_tr_b16 a[210:211],v12 offset:800
ds_read_b64_tr_b16 a[212:213],v12 offset:12320
ds_read_b64_tr_b16 a[214:215],v12 offset:13088
ds_read_b64_tr_b16 a[216:217],v12 offset:64
ds_read_b64_tr_b16 a[218:219],v12 offset:832
ds_read_b64_tr_b16 a[220:221],v12 offset:12352
ds_read_b64_tr_b16 a[222:223],v12 offset:13120
s_branch ld_77
lw_80:
ds_read_b64_tr_b16 a[120:121],v12 offset:0
ds_read_b64_tr_b16 a[122:123],v12 offset:768
ds_read_b64_tr_b16 a[124:125],v12 offset:12288
ds_read_b64_tr_b16 a[126:127],v12 offset:13056
ds_read_b64_tr_b16 a[128:129],v12 offset:32
ds_read_b64_tr_b16 a[130:131],v12 offset:800
ds_read_b64_tr_b16 a[132:133],v12 offset:12320
ds_read_b64_tr_b16 a[134:135],v12 offset:13088
ds_read_b64_tr_b16 a[136:137],v12 offset:64
ds_read_b64_tr_b16 a[138:139],v12 offset:832
ds_read_b64_tr_b16 a[140:141],v12 offset:12352
ds_read_b64_tr_b16 a[142:143],v12 offset:13120
s_branch ld_77
lw_81:
ds_read_b64_tr_b16 a[40:41],v12 offset:0
ds_read_b64_tr_b16 a[42:43],v12 offset:768
ds_read_b64_tr_b16 a[44:45],v12 offset:12288
ds_read_b64_tr_b16 a[46:47],v12 offset:13056
ds_read_b64_tr_b16 a[48:49],v12 offset:32
ds_read_b64_tr_b16 a[50:51],v12 offset:800
ds_read_b64_tr_b16 a[52:53],v12 offset:12320
ds_read_b64_tr_b16 a[54:55],v12 offset:13088
ds_read_b64_tr_b16 a[56:57],v12 offset:64
ds_read_b64_tr_b16 a[58:59],v12 offset:832
ds_read_b64_tr_b16 a[60:61],v12 offset:12352
ds_read_b64_tr_b16 a[62:63],v12 offset:13120
ld_77:
s_waitcnt lgkmcnt(0)
s_waitcnt vmcnt(24)
s_barrier
v_add_u32 v12,73728,v107
s_cmp_eq_u32 s46,1
s_cbranch_scc1 lw_84
s_cmp_eq_u32 s46,2
s_cbranch_scc1 lw_85
s_cmp_eq_u32 s46,3
s_cbranch_scc1 lw_86
lw_83:
ds_read_b64_tr_b16 v[160:161],v12 offset:0
ds_read_b64_tr_b16 v[162:163],v12 offset:768
ds_read_b64_tr_b16 v[164:165],v12 offset:12288
ds_read_b64_tr_b16 v[166:167],v12 offset:13056
ds_read_b64_tr_b16 v[168:169],v12 offset:32
ds_read_b64_tr_b16 v[170:171],v12 offset:800
ds_read_b64_tr_b16 v[172:173],v12 offset:12320
ds_read_b64_tr_b16 v[174:175],v12 offset:13088
ds_read_b64_tr_b16 v[80:81],v12 offset:64
ds_read_b64_tr_b16 v[82:83],v12 offset:832
ds_read_b64_tr_b16 v[84:85],v12 offset:12352
ds_read_b64_tr_b16 v[86:87],v12 offset:13120
s_branch ld_82
lw_84:
ds_read_b64_tr_b16 a[224:225],v12 offset:0
ds_read_b64_tr_b16 a[226:227],v12 offset:768
ds_read_b64_tr_b16 a[228:229],v12 offset:12288
ds_read_b64_tr_b16 a[230:231],v12 offset:13056
ds_read_b64_tr_b16 a[232:233],v12 offset:32
ds_read_b64_tr_b16 a[234:235],v12 offset:800
ds_read_b64_tr_b16 a[236:237],v12 offset:12320
ds_read_b64_tr_b16 a[238:239],v12 offset:13088
ds_read_b64_tr_b16 v[64:65],v12 offset:64
ds_read_b64_tr_b16 v[66:67],v12 offset:832
ds_read_b64_tr_b16 v[68:69],v12 offset:12352
ds_read_b64_tr_b16 v[70:71],v12 offset:13120
s_branch ld_82
lw_85:
ds_read_b64_tr_b16 a[144:145],v12 offset:0
ds_read_b64_tr_b16 a[146:147],v12 offset:768
ds_read_b64_tr_b16 a[148:149],v12 offset:12288
ds_read_b64_tr_b16 a[150:151],v12 offset:13056
ds_read_b64_tr_b16 a[152:153],v12 offset:32
ds_read_b64_tr_b16 a[154:155],v12 offset:800
ds_read_b64_tr_b16 a[156:157],v12 offset:12320
ds_read_b64_tr_b16 a[158:159],v12 offset:13088
ds_read_b64_tr_b16 v[48:49],v12 offset:64
ds_read_b64_tr_b16 v[50:51],v12 offset:832
ds_read_b64_tr_b16 v[52:53],v12 offset:12352
ds_read_b64_tr_b16 v[54:55],v12 offset:13120
s_branch ld_82
lw_86:
ds_read_b64_tr_b16 a[64:65],v12 offset:0
ds_read_b64_tr_b16 a[66:67],v12 offset:768
ds_read_b64_tr_b16 a[68:69],v12 offset:12288
ds_read_b64_tr_b16 a[70:71],v12 offset:13056
ds_read_b64_tr_b16 a[72:73],v12 offset:32
ds_read_b64_tr_b16 a[74:75],v12 offset:800
ds_read_b64_tr_b16 a[76:77],v12 offset:12320
ds_read_b64_tr_b16 a[78:79],v12 offset:13088
ds_read_b64_tr_b16 v[32:33],v12 offset:64
ds_read_b64_tr_b16 v[34:35],v12 offset:832
ds_read_b64_tr_b16 v[36:37],v12 offset:12352
ds_read_b64_tr_b16 v[38:39],v12 offset:13120
ld_82:
s_waitcnt lgkmcnt(0)
s_waitcnt vmcnt(18)
s_barrier
v_add_u32 v12,98304,v107
ds_read_b64_tr_b16 v[176:177],v12 offset:0
ds_read_b64_tr_b16 v[178:179],v12 offset:768
ds_read_b64_tr_b16 v[180:181],v12 offset:12288
ds_read_b64_tr_b16 v[182:183],v12 offset:13056
ds_read_b64_tr_b16 v[184:185],v12 offset:32
ds_read_b64_tr_b16 v[186:187],v12 offset:800
ds_read_b64_tr_b16 v[188:189],v12 offset:12320
ds_read_b64_tr_b16 v[190:191],v12 offset:13088
ds_read_b64_tr_b16 v[192:193],v12 offset:64
ds_read_b64_tr_b16 v[194:195],v12 offset:832
ds_read_b64_tr_b16 v[196:197],v12 offset:12352
ds_read_b64_tr_b16 v[198:199],v12 offset:13120
s_waitcnt lgkmcnt(0)
s_waitcnt vmcnt(12)
s_barrier
v_add_u32 v12,122880,v107
ds_read_b64_tr_b16 v[200:201],v12 offset:0
ds_read_b64_tr_b16 v[202:203],v12 offset:768
ds_read_b64_tr_b16 v[204:205],v12 offset:12288
ds_read_b64_tr_b16 v[206:207],v12 offset:13056
ds_read_b64_tr_b16 v[208:209],v12 offset:32
ds_read_b64_tr_b16 v[210:211],v12 offset:800
ds_read_b64_tr_b16 v[212:213],v12 offset:12320
ds_read_b64_tr_b16 v[214:215],v12 offset:13088
ds_read_b64_tr_b16 v[88:89],v12 offset:64
ds_read_b64_tr_b16 v[90:91],v12 offset:832
ds_read_b64_tr_b16 v[92:93],v12 offset:12352
ds_read_b64_tr_b16 v[94:95],v12 offset:13120
s_waitcnt lgkmcnt(0)
s_waitcnt vmcnt(6)
s_barrier
v_add_u32 v12,0,v107
ds_read_b64_tr_b16 v[216:217],v12 offset:0
ds_read_b64_tr_b16 v[218:219],v12 offset:768
ds_read_b64_tr_b16 v[220:221],v12 offset:12288
ds_read_b64_tr_b16 v[222:223],v12 offset:13056
ds_read_b64_tr_b16 v[224:225],v12 offset:32
ds_read_b64_tr_b16 v[226:227],v12 offset:800
ds_read_b64_tr_b16 v[228:229],v12 offset:12320
ds_read_b64_tr_b16 v[230:231],v12 offset:13088
ds_read_b64_tr_b16 v[232:233],v12 offset:64
ds_read_b64_tr_b16 v[234:235],v12 offset:832
ds_read_b64_tr_b16 v[236:237],v12 offset:12352
ds_read_b64_tr_b16 v[238:239],v12 offset:13120
s_waitcnt lgkmcnt(0)
s_waitcnt vmcnt(0)
s_barrier
v_add_u32 v12,24576,v107
ds_read_b64_tr_b16 v[240:241],v12 offset:0
ds_read_b64_tr_b16 v[242:243],v12 offset:768
ds_read_b64_tr_b16 v[244:245],v12 offset:12288
ds_read_b64_tr_b16 v[246:247],v12 offset:13056
ds_read_b64_tr_b16 v[248:249],v12 offset:32
ds_read_b64_tr_b16 v[250:251],v12 offset:800
ds_read_b64_tr_b16 v[252:253],v12 offset:12320
ds_read_b64_tr_b16 v[254:255],v12 offset:13088
ds_read_b64_tr_b16 v[96:97],v12 offset:64
ds_read_b64_tr_b16 v[98:99],v12 offset:832
ds_read_b64_tr_b16 v[100:101],v12 offset:12352
ds_read_b64_tr_b16 v[102:103],v12 offset:13120
s_waitcnt lgkmcnt(0)
s_barrier
ds_write_b128 v21,v[24:27] offset:0
ds_write_b128 v21,v[28:31] offset:1024
ds_write_b128 v21,v[32:35] offset:2048
ds_write_b128 v21,v[36:39] offset:3072
ds_write_b128 v21,v[40:43] offset:4096
ds_write_b128 v21,v[44:47] offset:5120
ds_write_b128 v21,v[48:51] offset:6144
ds_write_b128 v21,v[52:55] offset:7168
ds_write_b128 v21,v[56:59] offset:8192
ds_write_b128 v21,v[60:63] offset:9216
ds_write_b128 v21,v[64:67] offset:10240
ds_write_b128 v21,v[68:71] offset:11264
ds_write_b128 v21,v[72:75] offset:12288
ds_write_b128 v21,v[76:79] offset:13312
ds_write_b128 v21,v[80:83] offset:14336
ds_write_b128 v21,v[84:87] offset:15360
ds_write_b128 v21,v[88:91] offset:16384
ds_write_b128 v21,v[92:95] offset:17408
ds_write_b128 v21,v[96:99] offset:18432
ds_write_b128 v21,v[100:103] offset:19456
s_waitcnt lgkmcnt(0)
v_add_u32 v59,139264,v1
s_barrier
s_lshl_b32 s3,s49,2
v_mov_b32 v13,s3
s_nop 1
ibw_87:
buffer_load_dword v12,v13,s[12:15],0 offen sc1
s_waitcnt vmcnt(0)
v_cmp_ne_u32 vcc,256,v12
s_nop 0
s_cbranch_vccz ok_88
s_sleep 8
s_sub_u32 s47,s47,1
s_cbranch_scc1 ABORT
s_branch ibw_87
ok_88:
s_cmp_lg_u32 s49,0
s_cbranch_scc1 ibok_89
v_and_b32 v13,7,v0
v_lshlrev_b32 v13,2,v13
buffer_load_dword v12,v13,s[12:15],0 offen offset:32 sc1
s_waitcnt vmcnt(0)
v_cmp_ne_u32 vcc,32,v12
s_nop 0
s_cbranch_vccz ibok_89
s_barrier
s_mov_b32 s49,1
s_mov_b32 s3,s2
s_load_dwordx16 s[16:31],s[0:1],0
s_load_dwordx8 s[32:39],s[0:1],64
s_waitcnt lgkmcnt(0)
s_branch DISPATCH
ibok_89:
v_mov_b32 v13,192
buffer_load_dword v12,v13,s[12:15],0 offen sc1
s_waitcnt vmcnt(0)
v_readfirstlane_b32 s60,v12
s_cmp_gt_i32 s60,0
s_cselect_b32 s60,0x2000,0
s_add_u32 s83,s83,s60
s_mul_i32 s6,s46,2048
v_sub_u32 v18,v23,v22
v_add_u32 v18,v18,v1
v_add_u32 v18,8192,v18
s_mov_b32 s37,0x3f80
s_mov_b32 s81,0x3f800000
s_add_u32 s6,s6,s82
s_mov_b32 s7,0
s_add_u32 s7,s7,s82
s_add_u32 s7,s7,950272
s_mov_b32 s50,0
s_mov_b32 s4,0
s_mov_b32 s5,0
s_mov_b32 s78,2147483648
s_mov_b32 s79,2147483648
s_mov_b32 s30,2147483648
s_sub_u32 s60,s4,s5
s_cmp_gt_i32 s60,14
s_cselect_b32 s51,1,0
s_cmp_eq_u32 s4,64
s_cselect_b32 s51,1,s51
s_cmp_eq_u32 s51,0
s_cselect_b32 s52,s4,s5
s_addc_u32 s4,s4,0
s_add_u32 s5,s5,s51
s_and_b32 s60,s52,1
s_lshl2_add_u32 s60,s51,s60
s_lshl_b32 s68,s60,16
s_add_u32 s68,s68,s83
s_mul_i32 s59,s60,20480
s_add_u32 s59,s59,s6
s_lshl_b32 s69,s51,9
s_add_u32 s69,s69,s7
s_bfe_u32 s57,s52,65537
s_add_u32 s58,s52,1
s_cmp_lg_u32 s36,0
s_cbranch_scc1 CV_START
s_cmp_eq_u32 s46,3
s_cbranch_scc1 CH_START
s_lshl_b32 s60,s46,2
s_add_u32 s60,s60,147456
v_mov_b32 v20,s60
v_mov_b32 v12,0
ds_write_b32 v20,v12
v_add_u32 v58,106496,v1
v_mov_b32 v9,147468
s_lshl_b32 s85,s46,12
s_add_u32 s84,s84,s85
s_add_u32 s74,s85,81920
s_add_u32 s75,s74,s74
s_add_u32 s75,s75,24576
s_mul_i32 s60,s29,3
s_add_u32 s60,s60,s46
v_lshlrev_b32 v13,7,v0
s_add_u32 s61,s60,0
s_min_u32 s61,s61,115
s_lshl_b32 s61,s61,13
s_add_u32 s61,s61,s82
buffer_load_dword v14,v13,s[8:11],s61 offen sc1
s_add_u32 s61,s60,48
s_min_u32 s61,s61,115
s_lshl_b32 s61,s61,13
s_add_u32 s61,s61,s82
buffer_load_dword v14,v13,s[8:11],s61 offen sc1
s_add_u32 s61,s60,96
s_min_u32 s61,s61,115
s_lshl_b32 s61,s61,13
s_add_u32 s61,s61,s82
buffer_load_dword v14,v13,s[8:11],s61 offen sc1
s_waitcnt vmcnt(0)
s_mov_b64 vcc,-1
s_waitcnt lgkmcnt(0)
v_mov_b32 v10,0
v_mov_b32 v11,0
v_mov_b32 v24,0
v_mov_b32 v25,0
v_mov_b32 v26,0
v_mov_b32 v27,0
v_mov_b32 v28,0
v_mov_b32 v29,0
v_mov_b32 v30,0
v_mov_b32 v31,0
v_mov_b32 v32,0
v_mov_b32 v33,0
v_mov_b32 v34,0
v_mov_b32 v35,0
v_mov_b32 v36,0
v_mov_b32 v37,0
v_mov_b32 v38,0
v_mov_b32 v39,0
v_mov_b32 v40,0
v_mov_b32 v41,0
v_mov_b32 v42,0
v_mov_b32 v43,0
v_mov_b32 v44,0
v_mov_b32 v45,0
v_mov_b32 v46,0
v_mov_b32 v47,0
s_cmp_lg_u32 s49,0
s_cbranch_scc1 CS_LOOP_S
CS_LOOP_F:
s_barrier
buffer_load_dwordx2 v[80:81],v18,s[8:11],s59 offen sc1
buffer_load_dwordx4 v[72:75],v1,s[8:11],s59 offen sc1
buffer_load_dwordx4 v[76:79],v1,s[8:11],s59 offen offset:1024 sc1
s_cbranch_vccz fj_92f
s_waitcnt vmcnt(2)
s_sleep 3
fj_92f:
buffer_load_dwordx2 v[90:91],v18,s[8:11],s68 offen sc1
buffer_load_dwordx4 v[82:85],v1,s[8:11],s68 offen sc1
buffer_load_dwordx4 v[86:89],v1,s[8:11],s68 offen offset:1024 sc1
v_mfma_f32_32x32x8_bf16 v[24:39],v[10:11],v[10:11],0
v_mfma_f32_16x16x16_bf16 v[40:43],v[10:11],v[10:11],0
v_mfma_f32_16x16x16_bf16 v[44:47],v[10:11],v[10:11],0
fj_92:
fa_90:
s_waitcnt vmcnt(5)
v_lshlrev_b32 v108,16,v80
v_and_b32 v109,0xffff0000,v80
v_lshlrev_b32 v110,16,v81
v_and_b32 v111,0xffff0000,v81
s_waitcnt vmcnt(4)
v_lshlrev_b32 v92,16,v72
v_and_b32 v93,0xffff0000,v72
v_lshlrev_b32 v94,16,v73
v_and_b32 v95,0xffff0000,v73
v_lshlrev_b32 v96,16,v74
v_and_b32 v97,0xffff0000,v74
v_lshlrev_b32 v98,16,v75
v_and_b32 v99,0xffff0000,v75
s_waitcnt vmcnt(3)
v_lshlrev_b32 v100,16,v76
v_and_b32 v101,0xffff0000,v76
v_lshlrev_b32 v102,16,v77
v_and_b32 v103,0xffff0000,v77
v_lshlrev_b32 v104,16,v78
v_and_b32 v105,0xffff0000,v78
v_lshlrev_b32 v106,16,v79
v_and_b32 v107,0xffff0000,v79
s_waitcnt vmcnt(2)
v_dot2c_f32_bf16 v108,s37,v90
v_dot2c_f32_bf16 v109,s81,v90
v_dot2c_f32_bf16 v110,s37,v91
v_dot2c_f32_bf16 v111,s81,v91
v_bitop3_b32 v16,v80,v90,s57 bitop3:0x7e
v_cvt_pk_bf16_f32 v56,v108,v109
s_nop 0
v_cvt_pk_bf16_f32 v57,v110,v111
ds_write_b64 v23,v[56:57]
s_waitcnt vmcnt(1)
v_dot2c_f32_bf16 v92,s37,v82
v_dot2c_f32_bf16 v93,s81,v82
v_dot2c_f32_bf16 v94,s37,v83
v_dot2c_f32_bf16 v95,s81,v83
v_dot2c_f32_bf16 v96,s37,v84
v_dot2c_f32_bf16 v97,s81,v84
v_dot2c_f32_bf16 v98,s37,v85
v_dot2c_f32_bf16 v99,s81,v85
v_bitop3_b32 v17,v72,v82,s57 bitop3:0x7e
v_or_b32 v16,v16,v17
v_cvt_pk_bf16_f32 v48,v92,v93
v_cvt_pk_bf16_f32 v49,v94,v95
v_cvt_pk_bf16_f32 v50,v96,v97
v_cvt_pk_bf16_f32 v51,v98,v99
ds_write_b128 v22,v[48:51] offset:0
s_waitcnt vmcnt(0)
v_dot2c_f32_bf16 v100,s37,v86
v_dot2c_f32_bf16 v101,s81,v86
v_dot2c_f32_bf16 v102,s37,v87
v_dot2c_f32_bf16 v103,s81,v87
v_dot2c_f32_bf16 v104,s37,v88
v_dot2c_f32_bf16 v105,s81,v88
v_dot2c_f32_bf16 v106,s37,v89
v_dot2c_f32_bf16 v107,s81,v89
v_bitop3_b32 v17,v76,v86,s57 bitop3:0x7e
v_bitop3_b32 v16,v16,v17,1 bitop3:0xa8
v_cmp_ne_u32 vcc,0,v16
v_cvt_pk_bf16_f32 v52,v100,v101
v_cvt_pk_bf16_f32 v53,v102,v103
v_cvt_pk_bf16_f32 v54,v104,v105
v_cvt_pk_bf16_f32 v55,v106,v107
ds_write_b128 v22,v[52:55] offset:1024
s_cbranch_vccnz fr_91
fj_92g:
v_smfmac_f32_16x16x64_bf16 v[24:27],v[48:51],a[0:7],v2
ds_read_b128 v[72:75],v21 offset:0
v_xor_b32 v58,57344,v58
v_smfmac_f32_16x16x64_bf16 v[28:31],v[48:51],a[8:15],v2
ds_read_b128 v[76:79],v21 offset:1024
s_sub_u32 s60,s4,s5
v_smfmac_f32_16x16x64_bf16 v[32:35],v[48:51],a[16:23],v2
ds_read_b128 v[80:83],v21 offset:2048
s_cmp_gt_i32 s60,14
v_smfmac_f32_16x16x64_bf16 v[36:39],v[48:51],a[24:31],v2
ds_read_b128 v[84:87],v21 offset:3072
s_cselect_b32 s53,1,0
s_waitcnt lgkmcnt(4)
s_barrier
v_smfmac_f32_16x16x64_bf16 v[40:43],v[48:51],a[32:39],v2
ds_read_b128 v[60:63],v3 offset:0
s_cmp_eq_u32 s4,64
v_smfmac_f32_16x16x64_bf16 v[24:27],v[52:55],a[40:47],v2
ds_read_b128 v[64:67],v3 offset:1024
s_cselect_b32 s53,1,s53
v_smfmac_f32_16x16x64_bf16 v[28:31],v[52:55],a[48:55],v2
ds_read_b128 v[68:71],v4 offset:0
s_cmp_eq_u32 s53,0
v_smfmac_f32_16x16x64_bf16 v[32:35],v[52:55],a[56:63],v2
s_cselect_b32 s54,s4,s5
s_addc_u32 s4,s4,0
s_add_u32 s5,s5,s53
v_smfmac_f32_16x16x64_bf16 v[36:39],v[52:55],a[64:71],v2
s_mul_i32 s73,s54,393216
s_add_u32 s73,s73,s84
s_sub_u32 s74,s75,s74
v_smfmac_f32_16x16x64_bf16 v[40:43],v[52:55],a[72:79],v2
s_mov_b32 m0,s74
s_and_b32 s60,s52,1
s_waitcnt lgkmcnt(5)
v_smfmac_f32_16x16x64_bf16 v[44:47],v[48:51],v[72:79],v2
ds_read_b128 v[72:75],v21 offset:4096
s_waitcnt lgkmcnt(4)
v_smfmac_f32_16x16x64_bf16 v[44:47],v[52:55],v[80:87],v2
ds_read_b128 v[76:79],v21 offset:5120
s_waitcnt lgkmcnt(4)
v_smfmac_f32_16x16x64_bf16 v[24:27],v[60:63],a[80:87],v2
ds_read_b128 v[80:83],v21 offset:6144
s_lshl2_add_u32 s60,s51,s60
v_smfmac_f32_16x16x64_bf16 v[28:31],v[60:63],a[88:95],v2
ds_read_b128 v[84:87],v21 offset:7168
s_mul_i32 s60,s60,49152
v_smfmac_f32_16x16x64_bf16 v[32:35],v[60:63],a[96:103],v2
s_add_u32 s71,s60,s34
s_add_u32 s70,s60,s33
s_lshl_b32 s60,s51,9
v_smfmac_f32_16x16x64_bf16 v[36:39],v[60:63],a[104:111],v2
s_add_u32 s72,s60,s35
buffer_load_dwordx4 v1,s[8:11],s73 offen sc1 lds
v_smfmac_f32_16x16x64_bf16 v[40:43],v[60:63],a[112:119],v2
buffer_load_dwordx4 v1,s[8:11],s73 offen offset:1024 sc1 lds
s_waitcnt lgkmcnt(2)
v_smfmac_f32_16x16x64_bf16 v[44:47],v[60:63],v[72:79],v2
ds_read_b128 v[60:63],v4 offset:1024
v_smfmac_f32_16x16x64_bf16 v[24:27],v[64:67],a[120:127],v2
ds_read_b128 v[72:75],v21 offset:8192
v_smfmac_f32_16x16x64_bf16 v[28:31],v[64:67],a[128:135],v2
ds_read_b128 v[76:79],v21 offset:9216
v_smfmac_f32_16x16x64_bf16 v[32:35],v[64:67],a[136:143],v2
buffer_load_dwordx4 v1,s[8:11],s73 offen offset:2048 sc1 lds
v_smfmac_f32_16x16x64_bf16 v[36:39],v[64:67],a[144:151],v2
buffer_load_dwordx4 v1,s[8:11],s73 offen offset:3072 sc1 lds
v_add_u32 v17,s85,v58
v_smfmac_f32_16x16x64_bf16 v[40:43],v[64:67],a[152:159],v2
v_mov_b32 v16,s58
s_and_b32 s60,s54,1
s_waitcnt lgkmcnt(3)
v_smfmac_f32_16x16x64_bf16 v[44:47],v[64:67],v[80:87],v2
ds_read_b128 v[64:67],v5 offset:0
s_lshl2_add_u32 s60,s53,s60
v_smfmac_f32_16x16x64_bf16 v[24:27],v[68:71],a[160:167],v2
ds_read_b128 v[80:83],v21 offset:10240
s_lshl_b32 s68,s60,16
v_smfmac_f32_16x16x64_bf16 v[28:31],v[68:71],a[168:175],v2
ds_read_b128 v[84:87],v21 offset:11264
s_add_u32 s68,s68,s83
v_smfmac_f32_16x16x64_bf16 v[32:35],v[68:71],a[176:183],v2
s_mul_i32 s59,s60,20480
s_add_u32 s59,s59,s6
s_lshl_b32 s69,s53,9
v_smfmac_f32_16x16x64_bf16 v[36:39],v[68:71],a[184:191],v2
s_add_u32 s69,s69,s7
s_bfe_u32 s31,s54,65537
s_add_u32 s32,s54,1
v_smfmac_f32_16x16x64_bf16 v[40:43],v[68:71],a[192:199],v2
s_add_u32 s50,s50,1
s_mov_b32 s51,s53
s_waitcnt lgkmcnt(3)
v_smfmac_f32_16x16x64_bf16 v[44:47],v[68:71],v[72:79],v2
ds_read_b128 v[68:71],v5 offset:1024
s_mov_b32 s52,s54
v_smfmac_f32_16x16x64_bf16 v[24:27],v[60:63],a[200:207],v2
ds_read_b128 v[72:75],v21 offset:12288
s_mov_b32 s58,s32
v_smfmac_f32_16x16x64_bf16 v[28:31],v[60:63],a[208:215],v2
ds_read_b128 v[76:79],v21 offset:13312
s_mov_b64 vcc,s[88:89]
v_smfmac_f32_16x16x64_bf16 v[32:35],v[60:63],a[216:223],v2
ds_read_b128 v[48:51],v58 offset:0
v_smfmac_f32_16x16x64_bf16 v[36:39],v[60:63],a[224:231],v2
v_smfmac_f32_16x16x64_bf16 v[40:43],v[60:63],a[232:239],v2
ds_read_b128 v[52:55],v58 offset:1024
s_waitcnt lgkmcnt(5)
v_smfmac_f32_16x16x64_bf16 v[44:47],v[60:63],v[80:87],v2
ds_read_b128 v[60:63],v59 offset:0
v_smfmac_f32_16x16x64_bf16 v[24:27],v[64:67],a[240:247],v2
ds_read_b128 v[80:83],v21 offset:14336
v_smfmac_f32_16x16x64_bf16 v[28:31],v[64:67],a[248:255],v2
ds_read_b128 v[84:87],v21 offset:15360
v_smfmac_f32_16x16x64_bf16 v[32:35],v[64:67],v[112:119],v2
ds_read_b128 v[88:91],v58 offset:2048
v_smfmac_f32_16x16x64_bf16 v[36:39],v[64:67],v[120:127],v2
v_smfmac_f32_16x16x64_bf16 v[40:43],v[64:67],v[128:135],v2
ds_read_b128 v[92:95],v58 offset:3072
s_waitcnt lgkmcnt(7)
v_smfmac_f32_16x16x64_bf16 v[44:47],v[64:67],v[72:79],v2
ds_read_b128 v[64:67],v59 offset:1024
v_smfmac_f32_16x16x64_bf16 v[24:27],v[68:71],v[136:143],v2
ds_read_b128 v[72:75],v21 offset:16384
v_smfmac_f32_16x16x64_bf16 v[28:31],v[68:71],v[144:151],v2
ds_read_b128 v[76:79],v21 offset:17408
v_smfmac_f32_16x16x64_bf16 v[32:35],v[68:71],v[152:159],v2
ds_read_b128 v[96:99],v58 offset:4096
v_smfmac_f32_16x16x64_bf16 v[36:39],v[68:71],v[160:167],v2
v_smfmac_f32_16x16x64_bf16 v[40:43],v[68:71],v[168:175],v2
ds_read_b128 v[100:103],v58 offset:5120
s_waitcnt lgkmcnt(7)
v_smfmac_f32_16x16x64_bf16 v[44:47],v[68:71],v[80:87],v2
ds_read_b128 v[80:83],v21 offset:18432
v_smfmac_f32_16x16x64_bf16 v[24:27],v[60:63],v[176:183],v2
ds_read_b128 v[84:87],v21 offset:19456
v_smfmac_f32_16x16x64_bf16 v[36:39],v[60:63],v[200:207],v2
ds_read_b128 v[104:107],v58 offset:6144
s_waitcnt lgkmcnt(7)
v_smfmac_f32_16x16x64_bf16 v[24:27],v[64:67],v[216:223],v2
v_smfmac_f32_16x16x64_bf16 v[36:39],v[64:67],v[240:247],v2
ds_read_b128 v[108:111],v58 offset:7168
v_smfmac_f32_16x16x64_bf16 v[28:31],v[60:63],v[184:191],v2
v_smfmac_f32_16x16x64_bf16 v[40:43],v[60:63],v[208:215],v2
s_nop 3
v_add_f32 v24,v24,v25
v_smfmac_f32_16x16x64_bf16 v[28:31],v[64:67],v[224:231],v2
v_add_f32 v26,v26,v27
v_smfmac_f32_16x16x64_bf16 v[40:43],v[64:67],v[248:255],v2
v_add_f32 v36,v36,v37
v_smfmac_f32_16x16x64_bf16 v[32:35],v[60:63],v[192:199],v2
v_add_f32 v38,v38,v39
s_waitcnt lgkmcnt(6)
v_smfmac_f32_16x16x64_bf16 v[44:47],v[60:63],v[72:79],v2
v_cvt_pk_bf16_f32 v37,v24,v26
v_smfmac_f32_16x16x64_bf16 v[32:35],v[64:67],v[232:239],v2
v_cvt_pk_bf16_f32 v36,v36,v38
s_waitcnt lgkmcnt(2)
v_smfmac_f32_16x16x64_bf16 v[44:47],v[64:67],v[80:87],v2
ds_write_b64 v6,v[36:37] offset:0
v_add_f32 v28,v28,v29
v_add_f32 v30,v30,v31
v_add_f32 v40,v40,v41
v_add_f32 v42,v42,v43
v_cvt_pk_bf16_f32 v41,v28,v30
v_cvt_pk_bf16_f32 v40,v40,v42
ds_write_b64 v6,v[40:41] offset:512
v_add_f32 v32,v32,v33
v_add_f32 v34,v34,v35
v_add_f32 v44,v44,v45
v_add_f32 v46,v46,v47
v_cvt_pk_bf16_f32 v45,v32,v34
v_cvt_pk_bf16_f32 v44,v44,v46
ds_write_b64 v6,v[44:45] offset:1024
ds_read_b128 v[72:75],v58 offset:8192
ds_read_b128 v[76:79],v58 offset:9216
s_waitcnt lgkmcnt(2)
s_barrier
ds_read_b64_tr_b16 v[24:25],v7 offset:0
ds_read_b64_tr_b16 v[26:27],v7 offset:512
ds_read_b64_tr_b16 v[28:29],v7 offset:1024
ds_read_b64_tr_b16 v[30:31],v7 offset:1536
ds_read_b64_tr_b16 v[32:33],v7 offset:2048
ds_read_b64_tr_b16 v[34:35],v7 offset:2560
ds_read_b64_tr_b16 v[36:37],v7 offset:3072
ds_read_b64_tr_b16 v[38:39],v7 offset:3584
s_waitcnt lgkmcnt(6)
v_mfma_f32_16x16x32_bf16 v[60:63],v[48:51],v[24:27],0
ds_read_b64_tr_b16 v[40:41],v7 offset:4096
v_mfma_f32_16x16x32_bf16 v[64:67],v[52:55],v[24:27],0
ds_read_b64_tr_b16 v[42:43],v7 offset:4608
v_mfma_f32_16x16x32_bf16 v[68:71],v[24:27],v[24:27],0
ds_read_b128 v[80:83],v58 offset:10240
s_waitcnt lgkmcnt(7)
v_mfma_f32_16x16x32_bf16 v[60:63],v[88:91],v[28:31],v[60:63]
ds_read_b128 v[84:87],v58 offset:11264
v_mfma_f32_16x16x32_bf16 v[64:67],v[92:95],v[28:31],v[64:67]
ds_read_b64_tr_b16 v[44:45],v7 offset:5120
v_mfma_f32_16x16x32_bf16 v[68:71],v[28:31],v[28:31],v[68:71]
ds_read_b64_tr_b16 v[46:47],v7 offset:5632
s_waitcnt lgkmcnt(8)
v_mfma_f32_16x16x32_bf16 v[60:63],v[96:99],v[32:35],v[60:63]
ds_read_b128 v[24:27],v17 offset:12288
v_mfma_f32_16x16x32_bf16 v[64:67],v[100:103],v[32:35],v[64:67]
ds_read_b128 v[28:31],v17 offset:13312
v_mfma_f32_16x16x32_bf16 v[68:71],v[32:35],v[32:35],v[68:71]
s_waitcnt lgkmcnt(8)
v_mfma_f32_16x16x32_bf16 v[60:63],v[104:107],v[36:39],v[60:63]
ds_read_b128 v[32:35],v17 offset:14336
v_mfma_f32_16x16x32_bf16 v[64:67],v[108:111],v[36:39],v[64:67]
v_mfma_f32_16x16x32_bf16 v[68:71],v[36:39],v[36:39],v[68:71]
s_waitcnt lgkmcnt(7)
v_mfma_f32_16x16x32_bf16 v[60:63],v[72:75],v[40:43],v[60:63]
ds_read_b128 v[36:39],v17 offset:15360
v_mfma_f32_16x16x32_bf16 v[64:67],v[76:79],v[40:43],v[64:67]
v_mfma_f32_16x16x32_bf16 v[68:71],v[40:43],v[40:43],v[68:71]
s_waitcnt lgkmcnt(4)
v_mfma_f32_16x16x32_bf16 v[60:63],v[80:83],v[44:47],v[60:63]
v_mfma_f32_16x16x32_bf16 v[64:67],v[84:87],v[44:47],v[64:67]
buffer_load_dwordx4 v[48:51],v1,s[8:11],s71 offen sc1
v_mfma_f32_16x16x32_bf16 v[68:71],v[44:47],v[44:47],v[68:71]
s_nop 5
v_cndmask_b32_dpp v60,v64,v60,vcc quad_perm:[2,3,2,3] row_mask:0xf bank_mask:0xf
v_cndmask_b32_dpp v61,v65,v61,vcc quad_perm:[2,3,2,3] row_mask:0xf bank_mask:0xf
v_cndmask_b32_dpp v62,v66,v62,vcc quad_perm:[2,3,2,3] row_mask:0xf bank_mask:0xf
v_cndmask_b32_dpp v63,v67,v63,vcc quad_perm:[2,3,2,3] row_mask:0xf bank_mask:0xf
v_max3_f32 v12,v60,v61,v62
v_cndmask_b32_dpp v68,v69,v68,vcc quad_perm:[2,3,2,3] row_mask:0xf bank_mask:0xf
v_max3_f32 v12,v12,v63,v68
s_nop 1
v_max_f32_dpp v13,v12,v12 quad_perm:[2,3,0,1] row_mask:0xf bank_mask:0xf
v_max_f32_dpp v12,v12,v12 quad_perm:[2,3,0,1] row_mask:0xf bank_mask:0xf
s_nop 1
v_permlane32_swap_b32 v12,v13
v_max_f32 v15,v12,v13
v_max_f32 v12,v12,v13
s_mov_b64 exec,1
buffer_store_dword v16,v1,s[8:11],s72 offen
s_mov_b64 exec,-1
v_permlane16_swap_b32 v12,v15
v_max_f32 v12,v12,v15
v_mul_f32 v12,s87,v12
v_fma_f32 v60,v60,s87,-v12
v_fma_f32 v61,v61,s87,-v12
v_fma_f32 v62,v62,s87,-v12
v_fma_f32 v63,v63,s87,-v12
v_fma_f32 v68,v68,s87,-v12
v_exp_f32 v60,v60
v_exp_f32 v61,v61
v_exp_f32 v62,v62
v_exp_f32 v63,v63
v_exp_f32 v68,v68
v_cvt_pk_bf16_f32 v70,v60,v61
v_cvt_pk_bf16_f32 v71,v62,v63
v_cndmask_b32 v46,v70,v10,vcc
v_cndmask_b32 v47,v71,v10,vcc
v_cndmask_b32_dpp v44,v70,v10,vcc quad_perm:[2,3,0,1] row_mask:0xf bank_mask:0xf
v_cndmask_b32_dpp v45,v71,v10,vcc quad_perm:[2,3,0,1] row_mask:0xf bank_mask:0xf
s_mov_b64 vcc,s[90:91]
s_waitcnt lgkmcnt(0)
v_cndmask_b32 v40,v70,v10,vcc
v_mfma_f32_16x16x32_bf16 v[64:67],v[28:31],v[44:47],0
v_cndmask_b32 v41,v71,v10,vcc
v_cndmask_b32_dpp v42,v70,v10,vcc quad_perm:[2,3,0,1] row_mask:0xf bank_mask:0xf
v_mfma_f32_16x16x32_bf16 v[52:55],v[36:39],v[44:47],0
v_cndmask_b32_dpp v43,v71,v10,vcc quad_perm:[2,3,0,1] row_mask:0xf bank_mask:0xf
v_mov_b32_dpp v14,v68 quad_perm:[2,3,0,1] row_mask:0xf bank_mask:0xf
v_add_f32 v12,v60,v61
v_mfma_f32_16x16x32_bf16 v[64:67],v[24:27],v[40:43],v[64:67]
v_cvt_pk_bf16_f32 v56,v68,v14
v_cvt_pk_bf16_f32 v57,v14,v68
v_mfma_f32_16x16x32_bf16 v[52:55],v[32:35],v[40:43],v[52:55]
v_cndmask_b32 v56,v56,v10,vcc
v_cndmask_b32 v57,v10,v57,vcc
ds_read_b32 v0,v9
v_add_f32 v13,v62,v63
v_add_f32 v12,v12,v68
v_add_f32 v12,v12,v13
s_waitcnt vmcnt(1)
v_bitop3_b32 v17,v48,v50,s57 bitop3:0x7e
v_add_f32_dpp v13,v12,v12 quad_perm:[2,3,0,1] row_mask:0xf bank_mask:0xf
v_and_b32 v17,1,v17
v_add_f32_dpp v12,v12,v12 quad_perm:[2,3,0,1] row_mask:0xf bank_mask:0xf
v_cmp_ne_u32 vcc,0,v17
s_cbranch_vccnz vb_93
vo_94:
v_mfma_f32_16x16x16_bf16 v[64:67],v[48:49],v[56:57],v[64:67]
v_permlane32_swap_b32 v12,v13
v_add_f32 v15,v12,v13
v_mfma_f32_16x16x16_bf16 v[52:55],v[50:51],v[56:57],v[52:55]
v_add_f32 v12,v12,v13
s_nop 1
v_permlane16_swap_b32 v12,v15
v_add_f32 v12,v12,v15
v_rcp_f32 v12,v12
s_nop 0
v_mul_f32 v64,v64,v12
v_mul_f32 v65,v65,v12
v_mul_f32 v66,v66,v12
v_mul_f32 v67,v67,v12
v_mul_f32 v52,v52,v12
v_mul_f32 v53,v53,v12
v_mul_f32 v54,v54,v12
v_mul_f32 v55,v55,v12
v_cvt_pk_bf16_f32 v48,v64,v65
v_cvt_pk_bf16_f32 v49,v66,v67
v_cvt_pk_bf16_f32 v50,v52,v53
v_cvt_pk_bf16_f32 v51,v54,v55
v_and_or_b32 v48,v48,-2,s57
buffer_store_dwordx4 v[48:51],v8,s[8:11],s70 offen
s_mov_b32 s57,s31
v_mov_b32 v12,s50
s_waitcnt lgkmcnt(0)
v_cmp_ne_u32 vcc,s50,v0
ds_write_b32 v20,v12
s_cmp_lt_u32 s50,128
s_cbranch_scc1 CS_LOOP_F
s_branch CS_DONE
fr_91:
v_bitop3_b32 v12,v72,v76,s57 bitop3:0x7e
v_bitop3_b32 v13,v80,v80,s57 bitop3:0x7e
v_xor_b32 v14,s57,v80
v_or3_b32 v12,v12,v13,v14
v_and_b32 v12,1,v12
v_cmp_ne_u32 vcc,0,v12
s_cbranch_vccz sk_95
buffer_load_dwordx2 v[80:81],v18,s[8:11],s59 offen sc1
buffer_load_dwordx4 v[72:75],v1,s[8:11],s59 offen sc1
buffer_load_dwordx4 v[76:79],v1,s[8:11],s59 offen offset:1024 sc1
sk_95:
buffer_load_dwordx2 v[90:91],v18,s[8:11],s68 offen sc1
buffer_load_dwordx4 v[82:85],v1,s[8:11],s68 offen sc1
buffer_load_dwordx4 v[86:89],v1,s[8:11],s68 offen offset:1024 sc1
s_sub_u32 s47,s47,1
s_cbranch_scc1 ABORT
s_waitcnt lgkmcnt(0)
s_branch fa_90
vb_93:
s_sub_u32 s47,s47,1
s_cbranch_scc1 ABORT
buffer_load_dwordx4 v[48:51],v1,s[8:11],s71 offen sc1
s_waitcnt vmcnt(0)
v_bitop3_b32 v17,v48,v50,s57 bitop3:0x7e
v_and_b32 v17,1,v17
v_cmp_ne_u32 vcc,0,v17
s_nop 0
s_cbranch_vccnz vb_93
s_branch vo_94
CS_LOOP_S:
s_barrier
buffer_load_dwordx2 v[80:81],v18,s[8:11],s59 offen sc1
buffer_load_dwordx4 v[72:75],v1,s[8:11],s59 offen sc1
buffer_load_dwordx4 v[76:79],v1,s[8:11],s59 offen offset:1024 sc1
s_cbranch_vccz fj_98f
s_waitcnt vmcnt(2)
s_sleep 3
fj_98f:
buffer_load_dwordx2 v[90:91],v18,s[8:11],s68 offen sc1
buffer_load_dwordx4 v[82:85],v1,s[8:11],s68 offen sc1
buffer_load_dwordx4 v[86:89],v1,s[8:11],s68 offen offset:1024 sc1
v_mfma_f32_32x32x8_bf16 v[24:39],v[10:11],v[10:11],0
v_mfma_f32_16x16x16_bf16 v[40:43],v[10:11],v[10:11],0
v_mfma_f32_16x16x16_bf16 v[44:47],v[10:11],v[10:11],0
fj_98:
fa_96:
s_waitcnt vmcnt(5)
v_lshlrev_b32 v108,16,v80
v_and_b32 v109,0xffff0000,v80
v_lshlrev_b32 v110,16,v81
v_and_b32 v111,0xffff0000,v81
s_waitcnt vmcnt(4)
v_lshlrev_b32 v92,16,v72
v_and_b32 v93,0xffff0000,v72
v_lshlrev_b32 v94,16,v73
v_and_b32 v95,0xffff0000,v73
v_lshlrev_b32 v96,16,v74
v_and_b32 v97,0xffff0000,v74
v_lshlrev_b32 v98,16,v75
v_and_b32 v99,0xffff0000,v75
s_waitcnt vmcnt(3)
v_lshlrev_b32 v100,16,v76
v_and_b32 v101,0xffff0000,v76
v_lshlrev_b32 v102,16,v77
v_and_b32 v103,0xffff0000,v77
v_lshlrev_b32 v104,16,v78
v_and_b32 v105,0xffff0000,v78
v_lshlrev_b32 v106,16,v79
v_and_b32 v107,0xffff0000,v79
s_waitcnt vmcnt(2)
v_dot2c_f32_bf16 v108,s37,v90
v_dot2c_f32_bf16 v109,s81,v90
v_dot2c_f32_bf16 v110,s37,v91
v_dot2c_f32_bf16 v111,s81,v91
v_bitop3_b32 v16,v80,v90,s57 bitop3:0x7e
v_cvt_pk_bf16_f32 v56,v108,v109
s_nop 0
v_cvt_pk_bf16_f32 v57,v110,v111
ds_write_b64 v23,v[56:57]
s_waitcnt vmcnt(1)
v_dot2c_f32_bf16 v92,s37,v82
v_dot2c_f32_bf16 v93,s81,v82
v_dot2c_f32_bf16 v94,s37,v83
v_dot2c_f32_bf16 v95,s81,v83
v_dot2c_f32_bf16 v96,s37,v84
v_dot2c_f32_bf16 v97,s81,v84
v_dot2c_f32_bf16 v98,s37,v85
v_dot2c_f32_bf16 v99,s81,v85
v_bitop3_b32 v17,v72,v82,s57 bitop3:0x7e
v_or_b32 v16,v16,v17
v_cvt_pk_bf16_f32 v48,v92,v93
v_cvt_pk_bf16_f32 v49,v94,v95
v_cvt_pk_bf16_f32 v50,v96,v97
v_cvt_pk_bf16_f32 v51,v98,v99
ds_write_b128 v22,v[48:51] offset:0
s_waitcnt vmcnt(0)
v_dot2c_f32_bf16 v100,s37,v86
v_dot2c_f32_bf16 v101,s81,v86
v_dot2c_f32_bf16 v102,s37,v87
v_dot2c_f32_bf16 v103,s81,v87
v_dot2c_f32_bf16 v104,s37,v88
v_dot2c_f32_bf16 v105,s81,v88
v_dot2c_f32_bf16 v106,s37,v89
v_dot2c_f32_bf16 v107,s81,v89
v_bitop3_b32 v17,v76,v86,s57 bitop3:0x7e
v_bitop3_b32 v16,v16,v17,1 bitop3:0xa8
v_cmp_ne_u32 vcc,0,v16
v_cvt_pk_bf16_f32 v52,v100,v101
v_cvt_pk_bf16_f32 v53,v102,v103
v_cvt_pk_bf16_f32 v54,v104,v105
v_cvt_pk_bf16_f32 v55,v106,v107
ds_write_b128 v22,v[52:55] offset:1024
s_cbranch_vccnz fr_97
fj_98g:
v_smfmac_f32_16x16x64_bf16 v[24:27],v[48:51],a[0:7],v2
ds_read_b128 v[72:75],v21 offset:0
v_xor_b32 v58,57344,v58
v_smfmac_f32_16x16x64_bf16 v[28:31],v[48:51],a[8:15],v2
ds_read_b128 v[76:79],v21 offset:1024
s_sub_u32 s60,s4,s5
v_smfmac_f32_16x16x64_bf16 v[32:35],v[48:51],a[16:23],v2
ds_read_b128 v[80:83],v21 offset:2048
s_cmp_gt_i32 s60,14
v_smfmac_f32_16x16x64_bf16 v[36:39],v[48:51],a[24:31],v2
ds_read_b128 v[84:87],v21 offset:3072
s_cselect_b32 s53,1,0
s_waitcnt lgkmcnt(4)
s_barrier
v_smfmac_f32_16x16x64_bf16 v[40:43],v[48:51],a[32:39],v2
ds_read_b128 v[60:63],v3 offset:0
s_cmp_eq_u32 s4,64
v_smfmac_f32_16x16x64_bf16 v[24:27],v[52:55],a[40:47],v2
ds_read_b128 v[64:67],v3 offset:1024
s_cselect_b32 s53,1,s53
v_smfmac_f32_16x16x64_bf16 v[28:31],v[52:55],a[48:55],v2
ds_read_b128 v[68:71],v4 offset:0
s_cmp_eq_u32 s53,0
v_smfmac_f32_16x16x64_bf16 v[32:35],v[52:55],a[56:63],v2
s_cselect_b32 s54,s4,s5
s_addc_u32 s4,s4,0
s_add_u32 s5,s5,s53
v_smfmac_f32_16x16x64_bf16 v[36:39],v[52:55],a[64:71],v2
s_mul_i32 s73,s54,393216
s_add_u32 s73,s73,s84
s_sub_u32 s74,s75,s74
v_smfmac_f32_16x16x64_bf16 v[40:43],v[52:55],a[72:79],v2
s_mov_b32 m0,s74
s_and_b32 s60,s52,1
s_waitcnt lgkmcnt(5)
v_smfmac_f32_16x16x64_bf16 v[44:47],v[48:51],v[72:79],v2
ds_read_b128 v[72:75],v21 offset:4096
s_waitcnt lgkmcnt(4)
v_smfmac_f32_16x16x64_bf16 v[44:47],v[52:55],v[80:87],v2
ds_read_b128 v[76:79],v21 offset:5120
s_waitcnt lgkmcnt(4)
v_smfmac_f32_16x16x64_bf16 v[24:27],v[60:63],a[80:87],v2
ds_read_b128 v[80:83],v21 offset:6144
s_lshl2_add_u32 s60,s51,s60
v_smfmac_f32_16x16x64_bf16 v[28:31],v[60:63],a[88:95],v2
ds_read_b128 v[84:87],v21 offset:7168
s_mul_i32 s60,s60,49152
v_smfmac_f32_16x16x64_bf16 v[32:35],v[60:63],a[96:103],v2
s_add_u32 s71,s60,s34
s_add_u32 s70,s60,s33
s_lshl_b32 s60,s51,9
v_smfmac_f32_16x16x64_bf16 v[36:39],v[60:63],a[104:111],v2
s_add_u32 s72,s60,s35
buffer_load_dwordx4 v1,s[8:11],s73 offen sc1 lds
v_smfmac_f32_16x16x64_bf16 v[40:43],v[60:63],a[112:119],v2
buffer_load_dwordx4 v1,s[8:11],s73 offen offset:1024 sc1 lds
s_waitcnt lgkmcnt(2)
v_smfmac_f32_16x16x64_bf16 v[44:47],v[60:63],v[72:79],v2
ds_read_b128 v[60:63],v4 offset:1024
v_smfmac_f32_16x16x64_bf16 v[24:27],v[64:67],a[120:127],v2
ds_read_b128 v[72:75],v21 offset:8192
v_smfmac_f32_16x16x64_bf16 v[28:31],v[64:67],a[128:135],v2
ds_read_b128 v[76:79],v21 offset:9216
v_smfmac_f32_16x16x64_bf16 v[32:35],v[64:67],a[136:143],v2
buffer_load_dwordx4 v1,s[8:11],s73 offen offset:2048 sc1 lds
v_smfmac_f32_16x16x64_bf16 v[36:39],v[64:67],a[144:151],v2
buffer_load_dwordx4 v1,s[8:11],s73 offen offset:3072 sc1 lds
v_add_u32 v17,s85,v58
v_smfmac_f32_16x16x64_bf16 v[40:43],v[64:67],a[152:159],v2
v_mov_b32 v16,s58
s_and_b32 s60,s54,1
s_waitcnt lgkmcnt(3)
v_smfmac_f32_16x16x64_bf16 v[44:47],v[64:67],v[80:87],v2
ds_read_b128 v[64:67],v5 offset:0
s_lshl2_add_u32 s60,s53,s60
v_smfmac_f32_16x16x64_bf16 v[24:27],v[68:71],a[160:167],v2
ds_read_b128 v[80:83],v21 offset:10240
s_lshl_b32 s68,s60,16
v_smfmac_f32_16x16x64_bf16 v[28:31],v[68:71],a[168:175],v2
ds_read_b128 v[84:87],v21 offset:11264
s_add_u32 s68,s68,s83
v_smfmac_f32_16x16x64_bf16 v[32:35],v[68:71],a[176:183],v2
s_mul_i32 s59,s60,20480
s_add_u32 s59,s59,s6
s_lshl_b32 s69,s53,9
v_smfmac_f32_16x16x64_bf16 v[36:39],v[68:71],a[184:191],v2
s_add_u32 s69,s69,s7
s_bfe_u32 s31,s54,65537
s_add_u32 s32,s54,1
v_smfmac_f32_16x16x64_bf16 v[40:43],v[68:71],a[192:199],v2
s_add_u32 s50,s50,1
s_mov_b32 s51,s53
s_waitcnt lgkmcnt(3)
v_smfmac_f32_16x16x64_bf16 v[44:47],v[68:71],v[72:79],v2
ds_read_b128 v[68:71],v5 offset:1024
s_mov_b32 s52,s54
v_smfmac_f32_16x16x64_bf16 v[24:27],v[60:63],a[200:207],v2
ds_read_b128 v[72:75],v21 offset:12288
s_mov_b32 s58,s32
v_smfmac_f32_16x16x64_bf16 v[28:31],v[60:63],a[208:215],v2
ds_read_b128 v[76:79],v21 offset:13312
s_mov_b64 vcc,s[88:89]
v_smfmac_f32_16x16x64_bf16 v[32:35],v[60:63],a[216:223],v2
ds_read_b128 v[48:51],v58 offset:0
v_smfmac_f32_16x16x64_bf16 v[36:39],v[60:63],a[224:231],v2
v_smfmac_f32_16x16x64_bf16 v[40:43],v[60:63],a[232:239],v2
ds_read_b128 v[52:55],v58 offset:1024
s_waitcnt lgkmcnt(5)
v_smfmac_f32_16x16x64_bf16 v[44:47],v[60:63],v[80:87],v2
ds_read_b128 v[60:63],v59 offset:0
v_smfmac_f32_16x16x64_bf16 v[24:27],v[64:67],a[240:247],v2
ds_read_b128 v[80:83],v21 offset:14336
v_smfmac_f32_16x16x64_bf16 v[28:31],v[64:67],a[248:255],v2
ds_read_b128 v[84:87],v21 offset:15360
v_smfmac_f32_16x16x64_bf16 v[32:35],v[64:67],v[112:119],v2
ds_read_b128 v[88:91],v58 offset:2048
v_smfmac_f32_16x16x64_bf16 v[36:39],v[64:67],v[120:127],v2
v_smfmac_f32_16x16x64_bf16 v[40:43],v[64:67],v[128:135],v2
ds_read_b128 v[92:95],v58 offset:3072
s_waitcnt lgkmcnt(7)
v_smfmac_f32_16x16x64_bf16 v[44:47],v[64:67],v[72:79],v2
ds_read_b128 v[64:67],v59 offset:1024
v_smfmac_f32_16x16x64_bf16 v[24:27],v[68:71],v[136:143],v2
ds_read_b128 v[72:75],v21 offset:16384
v_smfmac_f32_16x16x64_bf16 v[28:31],v[68:71],v[144:151],v2
ds_read_b128 v[76:79],v21 offset:17408
v_smfmac_f32_16x16x64_bf16 v[32:35],v[68:71],v[152:159],v2
ds_read_b128 v[96:99],v58 offset:4096
v_smfmac_f32_16x16x64_bf16 v[36:39],v[68:71],v[160:167],v2
v_smfmac_f32_16x16x64_bf16 v[40:43],v[68:71],v[168:175],v2
ds_read_b128 v[100:103],v58 offset:5120
s_waitcnt lgkmcnt(7)
v_smfmac_f32_16x16x64_bf16 v[44:47],v[68:71],v[80:87],v2
ds_read_b128 v[80:83],v21 offset:18432
v_smfmac_f32_16x16x64_bf16 v[24:27],v[60:63],v[176:183],v2
ds_read_b128 v[84:87],v21 offset:19456
v_smfmac_f32_16x16x64_bf16 v[36:39],v[60:63],v[200:207],v2
ds_read_b128 v[104:107],v58 offset:6144
s_waitcnt lgkmcnt(7)
v_smfmac_f32_16x16x64_bf16 v[24:27],v[64:67],v[216:223],v2
v_smfmac_f32_16x16x64_bf16 v[36:39],v[64:67],v[240:247],v2
ds_read_b128 v[108:111],v58 offset:7168
v_smfmac_f32_16x16x64_bf16 v[28:31],v[60:63],v[184:191],v2
v_smfmac_f32_16x16x64_bf16 v[40:43],v[60:63],v[208:215],v2
s_nop 3
v_add_f32 v24,v24,v25
v_smfmac_f32_16x16x64_bf16 v[28:31],v[64:67],v[224:231],v2
v_add_f32 v26,v26,v27
v_smfmac_f32_16x16x64_bf16 v[40:43],v[64:67],v[248:255],v2
v_add_f32 v36,v36,v37
v_smfmac_f32_16x16x64_bf16 v[32:35],v[60:63],v[192:199],v2
v_add_f32 v38,v38,v39
s_waitcnt lgkmcnt(6)
v_smfmac_f32_16x16x64_bf16 v[44:47],v[60:63],v[72:79],v2
v_cvt_pk_bf16_f32 v37,v24,v26
v_smfmac_f32_16x16x64_bf16 v[32:35],v[64:67],v[232:239],v2
v_cvt_pk_bf16_f32 v36,v36,v38
s_waitcnt lgkmcnt(2)
v_smfmac_f32_16x16x64_bf16 v[44:47],v[64:67],v[80:87],v2
ds_write_b64 v6,v[36:37] offset:0
v_add_f32 v28,v28,v29
v_add_f32 v30,v30,v31
v_add_f32 v40,v40,v41
v_add_f32 v42,v42,v43
v_cvt_pk_bf16_f32 v41,v28,v30
v_cvt_pk_bf16_f32 v40,v40,v42
ds_write_b64 v6,v[40:41] offset:512
v_add_f32 v32,v32,v33
v_add_f32 v34,v34,v35
v_add_f32 v44,v44,v45
v_add_f32 v46,v46,v47
v_cvt_pk_bf16_f32 v45,v32,v34
v_cvt_pk_bf16_f32 v44,v44,v46
ds_write_b64 v6,v[44:45] offset:1024
ds_read_b128 v[72:75],v58 offset:8192
ds_read_b128 v[76:79],v58 offset:9216
s_waitcnt lgkmcnt(2)
s_barrier
ds_read_b64_tr_b16 v[24:25],v7 offset:0
ds_read_b64_tr_b16 v[26:27],v7 offset:512
ds_read_b64_tr_b16 v[28:29],v7 offset:1024
ds_read_b64_tr_b16 v[30:31],v7 offset:1536
ds_read_b64_tr_b16 v[32:33],v7 offset:2048
ds_read_b64_tr_b16 v[34:35],v7 offset:2560
ds_read_b64_tr_b16 v[36:37],v7 offset:3072
ds_read_b64_tr_b16 v[38:39],v7 offset:3584
s_waitcnt lgkmcnt(6)
v_mfma_f32_16x16x32_bf16 v[60:63],v[48:51],v[24:27],0
ds_read_b64_tr_b16 v[40:41],v7 offset:4096
v_mfma_f32_16x16x32_bf16 v[64:67],v[52:55],v[24:27],0
ds_read_b64_tr_b16 v[42:43],v7 offset:4608
v_mfma_f32_16x16x32_bf16 v[68:71],v[24:27],v[24:27],0
ds_read_b128 v[80:83],v58 offset:10240
s_waitcnt lgkmcnt(7)
v_mfma_f32_16x16x32_bf16 v[60:63],v[88:91],v[28:31],v[60:63]
ds_read_b128 v[84:87],v58 offset:11264
v_mfma_f32_16x16x32_bf16 v[64:67],v[92:95],v[28:31],v[64:67]
ds_read_b64_tr_b16 v[44:45],v7 offset:5120
v_mfma_f32_16x16x32_bf16 v[68:71],v[28:31],v[28:31],v[68:71]
ds_read_b64_tr_b16 v[46:47],v7 offset:5632
s_waitcnt lgkmcnt(8)
v_mfma_f32_16x16x32_bf16 v[60:63],v[96:99],v[32:35],v[60:63]
ds_read_b128 v[24:27],v17 offset:12288
v_mfma_f32_16x16x32_bf16 v[64:67],v[100:103],v[32:35],v[64:67]
ds_read_b128 v[28:31],v17 offset:13312
v_mfma_f32_16x16x32_bf16 v[68:71],v[32:35],v[32:35],v[68:71]
s_waitcnt lgkmcnt(8)
v_mfma_f32_16x16x32_bf16 v[60:63],v[104:107],v[36:39],v[60:63]
ds_read_b128 v[32:35],v17 offset:14336
v_mfma_f32_16x16x32_bf16 v[64:67],v[108:111],v[36:39],v[64:67]
v_mfma_f32_16x16x32_bf16 v[68:71],v[36:39],v[36:39],v[68:71]
s_waitcnt lgkmcnt(7)
v_mfma_f32_16x16x32_bf16 v[60:63],v[72:75],v[40:43],v[60:63]
ds_read_b128 v[36:39],v17 offset:15360
v_mfma_f32_16x16x32_bf16 v[64:67],v[76:79],v[40:43],v[64:67]
v_mfma_f32_16x16x32_bf16 v[68:71],v[40:43],v[40:43],v[68:71]
s_waitcnt lgkmcnt(4)
v_mfma_f32_16x16x32_bf16 v[60:63],v[80:83],v[44:47],v[60:63]
v_mfma_f32_16x16x32_bf16 v[64:67],v[84:87],v[44:47],v[64:67]
buffer_load_dwordx4 v[48:51],v1,s[8:11],s71 offen sc1
v_mfma_f32_16x16x32_bf16 v[68:71],v[44:47],v[44:47],v[68:71]
s_nop 5
v_cndmask_b32_dpp v60,v64,v60,vcc quad_perm:[2,3,2,3] row_mask:0xf bank_mask:0xf
v_cndmask_b32_dpp v61,v65,v61,vcc quad_perm:[2,3,2,3] row_mask:0xf bank_mask:0xf
v_cndmask_b32_dpp v62,v66,v62,vcc quad_perm:[2,3,2,3] row_mask:0xf bank_mask:0xf
v_cndmask_b32_dpp v63,v67,v63,vcc quad_perm:[2,3,2,3] row_mask:0xf bank_mask:0xf
v_max3_f32 v12,v60,v61,v62
v_cndmask_b32_dpp v68,v69,v68,vcc quad_perm:[2,3,2,3] row_mask:0xf bank_mask:0xf
v_max3_f32 v12,v12,v63,v68
s_nop 1
v_max_f32_dpp v13,v12,v12 quad_perm:[2,3,0,1] row_mask:0xf bank_mask:0xf
v_max_f32_dpp v12,v12,v12 quad_perm:[2,3,0,1] row_mask:0xf bank_mask:0xf
s_nop 1
v_permlane32_swap_b32 v12,v13
v_max_f32 v15,v12,v13
v_max_f32 v12,v12,v13
s_mov_b64 exec,1
buffer_store_dword v16,v1,s[8:11],s72 offen sc1
s_mov_b64 exec,-1
v_permlane16_swap_b32 v12,v15
v_max_f32 v12,v12,v15
v_mul_f32 v12,s87,v12
v_fma_f32 v60,v60,s87,-v12
v_fma_f32 v61,v61,s87,-v12
v_fma_f32 v62,v62,s87,-v12
v_fma_f32 v63,v63,s87,-v12
v_fma_f32 v68,v68,s87,-v12
v_exp_f32 v60,v60
v_exp_f32 v61,v61
v_exp_f32 v62,v62
v_exp_f32 v63,v63
v_exp_f32 v68,v68
v_cvt_pk_bf16_f32 v70,v60,v61
v_cvt_pk_bf16_f32 v71,v62,v63
v_cndmask_b32 v46,v70,v10,vcc
v_cndmask_b32 v47,v71,v10,vcc
v_cndmask_b32_dpp v44,v70,v10,vcc quad_perm:[2,3,0,1] row_mask:0xf bank_mask:0xf
v_cndmask_b32_dpp v45,v71,v10,vcc quad_perm:[2,3,0,1] row_mask:0xf bank_mask:0xf
s_mov_b64 vcc,s[90:91]
s_waitcnt lgkmcnt(0)
v_cndmask_b32 v40,v70,v10,vcc
v_mfma_f32_16x16x32_bf16 v[64:67],v[28:31],v[44:47],0
v_cndmask_b32 v41,v71,v10,vcc
v_cndmask_b32_dpp v42,v70,v10,vcc quad_perm:[2,3,0,1] row_mask:0xf bank_mask:0xf
v_mfma_f32_16x16x32_bf16 v[52:55],v[36:39],v[44:47],0
v_cndmask_b32_dpp v43,v71,v10,vcc quad_perm:[2,3,0,1] row_mask:0xf bank_mask:0xf
v_mov_b32_dpp v14,v68 quad_perm:[2,3,0,1] row_mask:0xf bank_mask:0xf
v_add_f32 v12,v60,v61
v_mfma_f32_16x16x32_bf16 v[64:67],v[24:27],v[40:43],v[64:67]
v_cvt_pk_bf16_f32 v56,v68,v14
v_cvt_pk_bf16_f32 v57,v14,v68
v_mfma_f32_16x16x32_bf16 v[52:55],v[32:35],v[40:43],v[52:55]
v_cndmask_b32 v56,v56,v10,vcc
v_cndmask_b32 v57,v10,v57,vcc
ds_read_b32 v0,v9
v_add_f32 v13,v62,v63
v_add_f32 v12,v12,v68
v_add_f32 v12,v12,v13
s_waitcnt vmcnt(1)
v_bitop3_b32 v17,v48,v50,s57 bitop3:0x7e
v_add_f32_dpp v13,v12,v12 quad_perm:[2,3,0,1] row_mask:0xf bank_mask:0xf
v_and_b32 v17,1,v17
v_add_f32_dpp v12,v12,v12 quad_perm:[2,3,0,1] row_mask:0xf bank_mask:0xf
v_cmp_ne_u32 vcc,0,v17
s_cbranch_vccnz vb_99
vo_100:
v_mfma_f32_16x16x16_bf16 v[64:67],v[48:49],v[56:57],v[64:67]
v_permlane32_swap_b32 v12,v13
v_add_f32 v15,v12,v13
v_mfma_f32_16x16x16_bf16 v[52:55],v[50:51],v[56:57],v[52:55]
v_add_f32 v12,v12,v13
s_nop 1
v_permlane16_swap_b32 v12,v15
v_add_f32 v12,v12,v15
v_rcp_f32 v12,v12
s_nop 0
v_mul_f32 v64,v64,v12
v_mul_f32 v65,v65,v12
v_mul_f32 v66,v66,v12
v_mul_f32 v67,v67,v12
v_mul_f32 v52,v52,v12
v_mul_f32 v53,v53,v12
v_mul_f32 v54,v54,v12
v_mul_f32 v55,v55,v12
v_cvt_pk_bf16_f32 v48,v64,v65
v_cvt_pk_bf16_f32 v49,v66,v67
v_cvt_pk_bf16_f32 v50,v52,v53
v_cvt_pk_bf16_f32 v51,v54,v55
v_and_or_b32 v48,v48,-2,s57
buffer_store_dwordx4 v[48:51],v8,s[8:11],s70 offen sc1
s_mov_b32 s57,s31
v_mov_b32 v12,s50
s_waitcnt lgkmcnt(0)
v_cmp_ne_u32 vcc,s50,v0
ds_write_b32 v20,v12
s_cmp_lt_u32 s50,128
s_cbranch_scc1 CS_LOOP_S
s_branch CS_DONE
fr_97:
v_bitop3_b32 v12,v72,v76,s57 bitop3:0x7e
v_bitop3_b32 v13,v80,v80,s57 bitop3:0x7e
v_xor_b32 v14,s57,v80
v_or3_b32 v12,v12,v13,v14
v_and_b32 v12,1,v12
v_cmp_ne_u32 vcc,0,v12
s_cbranch_vccz sk_101
buffer_load_dwordx2 v[80:81],v18,s[8:11],s59 offen sc1
buffer_load_dwordx4 v[72:75],v1,s[8:11],s59 offen sc1
buffer_load_dwordx4 v[76:79],v1,s[8:11],s59 offen offset:1024 sc1
sk_101:
buffer_load_dwordx2 v[90:91],v18,s[8:11],s68 offen sc1
buffer_load_dwordx4 v[82:85],v1,s[8:11],s68 offen sc1
buffer_load_dwordx4 v[86:89],v1,s[8:11],s68 offen offset:1024 sc1
s_sub_u32 s47,s47,1
s_cbranch_scc1 ABORT
s_waitcnt lgkmcnt(0)
s_branch fa_96
vb_99:
s_sub_u32 s47,s47,1
s_cbranch_scc1 ABORT
buffer_load_dwordx4 v[48:51],v1,s[8:11],s71 offen sc1
s_waitcnt vmcnt(0)
v_bitop3_b32 v17,v48,v50,s57 bitop3:0x7e
v_and_b32 v17,1,v17
v_cmp_ne_u32 vcc,0,v17
s_nop 0
s_cbranch_vccnz vb_99
s_branch vo_100
CH_START:
s_sub_u32 s60,s4,s5
s_cmp_gt_i32 s60,14
s_cselect_b32 s53,1,0
s_cmp_eq_u32 s4,64
s_cselect_b32 s53,1,s53
s_cmp_eq_u32 s53,0
s_cselect_b32 s54,s4,s5
s_addc_u32 s4,s4,0
s_add_u32 s5,s5,s53
s_sub_u32 s60,s4,s5
s_cmp_gt_i32 s60,14
s_cselect_b32 s55,1,0
s_cmp_eq_u32 s4,64
s_cselect_b32 s55,1,s55
s_cmp_eq_u32 s55,0
s_cselect_b32 s56,s4,s5
s_addc_u32 s4,s4,0
s_add_u32 s5,s5,s55
s_mov_b32 s74,81920
s_mul_i32 s73,s52,393216
s_add_u32 s73,s73,s84
s_lshl_b32 s75,s51,6
s_add_u32 s75,s75,s52
s_lshl_b32 s75,s75,9
s_add_u32 s75,s75,131072
fl_102:
buffer_load_dword v12,v9,s[8:11],s75 offen sc1
s_waitcnt vmcnt(0)
v_cmp_eq_u32 vcc,0,v12
s_nop 0
s_cbranch_vccz ok_103
s_sleep 1
s_sub_u32 s47,s47,1
s_cbranch_scc1 ABORT
s_branch fl_102
ok_103:
s_add_u32 m0,s74,0
s_add_u32 s67,s73,0
buffer_load_dwordx4 v1,s[8:11],s67 offen sc1 lds
buffer_load_dwordx4 v1,s[8:11],s67 offen offset:1024 sc1 lds
buffer_load_dwordx4 v1,s[8:11],s67 offen offset:2048 sc1 lds
buffer_load_dwordx4 v1,s[8:11],s67 offen offset:3072 sc1 lds
s_add_u32 m0,s74,4096
s_add_u32 s67,s73,4096
buffer_load_dwordx4 v1,s[8:11],s67 offen sc1 lds
buffer_load_dwordx4 v1,s[8:11],s67 offen offset:1024 sc1 lds
buffer_load_dwordx4 v1,s[8:11],s67 offen offset:2048 sc1 lds
buffer_load_dwordx4 v1,s[8:11],s67 offen offset:3072 sc1 lds
s_add_u32 m0,s74,8192
s_add_u32 s67,s73,8192
buffer_load_dwordx4 v1,s[8:11],s67 offen sc1 lds
buffer_load_dwordx4 v1,s[8:11],s67 offen offset:1024 sc1 lds
buffer_load_dwordx4 v1,s[8:11],s67 offen offset:2048 sc1 lds
buffer_load_dwordx4 v1,s[8:11],s67 offen offset:3072 sc1 lds
s_add_u32 m0,s74,12288
s_add_u32 s67,s73,25165824
buffer_load_dwordx4 v1,s[8:11],s67 offen sc1 lds
buffer_load_dwordx4 v1,s[8:11],s67 offen offset:1024 sc1 lds
buffer_load_dwordx4 v1,s[8:11],s67 offen offset:2048 sc1 lds
buffer_load_dwordx4 v1,s[8:11],s67 offen offset:3072 sc1 lds
s_add_u32 m0,s74,16384
s_add_u32 s67,s73,25169920
buffer_load_dwordx4 v1,s[8:11],s67 offen sc1 lds
buffer_load_dwordx4 v1,s[8:11],s67 offen offset:1024 sc1 lds
buffer_load_dwordx4 v1,s[8:11],s67 offen offset:2048 sc1 lds
buffer_load_dwordx4 v1,s[8:11],s67 offen offset:3072 sc1 lds
s_add_u32 m0,s74,20480
s_add_u32 s67,s73,25174016
buffer_load_dwordx4 v1,s[8:11],s67 offen sc1 lds
buffer_load_dwordx4 v1,s[8:11],s67 offen offset:1024 sc1 lds
buffer_load_dwordx4 v1,s[8:11],s67 offen offset:2048 sc1 lds
buffer_load_dwordx4 v1,s[8:11],s67 offen offset:3072 sc1 lds
s_mov_b32 s74,106496
s_mul_i32 s73,s54,393216
s_add_u32 s73,s73,s84
s_lshl_b32 s75,s53,6
s_add_u32 s75,s75,s54
s_lshl_b32 s75,s75,9
s_add_u32 s75,s75,131072
s_lshl_b32 s76,s55,6
s_add_u32 s76,s76,s56
s_lshl_b32 s76,s76,9
s_add_u32 s76,s76,131072
s_mov_b32 s77,1
v_min_u32 v8,2,v0
v_lshlrev_b32 v8,2,v8
v_add_u32 v8,147456,v8
v_mov_b32 v58,147468
s_mov_b32 s80,0
v_mov_b32 v24,0
v_mov_b32 v25,0
v_mov_b32 v26,0
v_mov_b32 v27,0
v_mov_b32 v28,0
v_mov_b32 v29,0
v_mov_b32 v30,0
v_mov_b32 v31,0
v_mov_b32 v32,0
v_mov_b32 v33,0
v_mov_b32 v34,0
v_mov_b32 v35,0
v_mov_b32 v36,0
v_mov_b32 v37,0
v_mov_b32 v38,0
v_mov_b32 v39,0
v_mov_b32 v40,0
v_mov_b32 v41,0
v_mov_b32 v42,0
v_mov_b32 v43,0
v_mov_b32 v44,0
v_mov_b32 v45,0
v_mov_b32 v46,0
v_mov_b32 v47,0
s_nop 1
CH_LOOP:
v_mov_b32 v14,s50
s_nop 1
db_107:
buffer_load_dword v12,v11,s[8:11],s69 offen sc1
s_waitcnt vmcnt(0)
v_cmp_gt_u32 vcc,s58,v12
s_cbranch_vccz dbok_108
s_sub_u32 s47,s47,1
s_cbranch_scc1 ABORT
s_branch db_107
dbok_108:
ds_write_b32 v58,v14
buffer_load_dwordx2 v[68:69],v18,s[8:11],s59 offen sc1
buffer_load_dwordx4 v[60:63],v1,s[8:11],s59 offen sc1
buffer_load_dwordx4 v[64:67],v1,s[8:11],s59 offen offset:1024 sc1
s_barrier
s_waitcnt vmcnt(2)
s_sleep 3
fj_106f:
buffer_load_dwordx2 v[78:79],v18,s[8:11],s68 offen sc1
buffer_load_dwordx4 v[70:73],v1,s[8:11],s68 offen sc1
buffer_load_dwordx4 v[74:77],v1,s[8:11],s68 offen offset:1024 sc1
s_mov_b64 vcc,s[90:91]
ds_read_b64_tr_b16 v[100:101],v7 offset:0
ds_read_b64_tr_b16 v[102:103],v7 offset:512
ds_read_b64_tr_b16 v[48:49],v7 offset:1024
ds_read_b64_tr_b16 v[50:51],v7 offset:1536
ds_read_b64_tr_b16 v[104:105],v7 offset:2048
ds_read_b64_tr_b16 v[106:107],v7 offset:2560
ds_read_b64_tr_b16 v[52:53],v7 offset:3072
ds_read_b64_tr_b16 v[54:55],v7 offset:3584
ds_read_b64_tr_b16 v[108:109],v7 offset:4096
ds_read_b64_tr_b16 v[110:111],v7 offset:4608
ds_read_b64_tr_b16 v[12:13],v7 offset:5120
ds_read_b64_tr_b16 v[14:15],v7 offset:5632
s_waitcnt lgkmcnt(8)
v_cndmask_b32_dpp v100,v48,v100,vcc quad_perm:[0,1,0,1] row_mask:0xf bank_mask:0xf
v_cndmask_b32_dpp v101,v49,v101,vcc quad_perm:[0,1,0,1] row_mask:0xf bank_mask:0xf
v_cndmask_b32_dpp v102,v50,v102,vcc quad_perm:[0,1,0,1] row_mask:0xf bank_mask:0xf
v_cndmask_b32_dpp v103,v51,v103,vcc quad_perm:[0,1,0,1] row_mask:0xf bank_mask:0xf
s_waitcnt lgkmcnt(4)
v_cndmask_b32_dpp v104,v52,v104,vcc quad_perm:[0,1,0,1] row_mask:0xf bank_mask:0xf
v_cndmask_b32_dpp v105,v53,v105,vcc quad_perm:[0,1,0,1] row_mask:0xf bank_mask:0xf
v_cndmask_b32_dpp v106,v54,v106,vcc quad_perm:[0,1,0,1] row_mask:0xf bank_mask:0xf
v_cndmask_b32_dpp v107,v55,v107,vcc quad_perm:[0,1,0,1] row_mask:0xf bank_mask:0xf
s_waitcnt lgkmcnt(0)
v_cndmask_b32_dpp v108,v12,v108,vcc quad_perm:[0,1,0,1] row_mask:0xf bank_mask:0xf
v_cndmask_b32_dpp v109,v13,v109,vcc quad_perm:[0,1,0,1] row_mask:0xf bank_mask:0xf
v_cndmask_b32_dpp v110,v14,v110,vcc quad_perm:[0,1,0,1] row_mask:0xf bank_mask:0xf
v_cndmask_b32_dpp v111,v15,v111,vcc quad_perm:[0,1,0,1] row_mask:0xf bank_mask:0xf
fj_106:
fa_104:
s_waitcnt vmcnt(5)
v_lshlrev_b32 v96,16,v68
v_and_b32 v97,0xffff0000,v68
v_lshlrev_b32 v98,16,v69
v_and_b32 v99,0xffff0000,v69
s_waitcnt vmcnt(4)
v_lshlrev_b32 v80,16,v60
v_and_b32 v81,0xffff0000,v60
v_lshlrev_b32 v82,16,v61
v_and_b32 v83,0xffff0000,v61
v_lshlrev_b32 v84,16,v62
v_and_b32 v85,0xffff0000,v62
v_lshlrev_b32 v86,16,v63
v_and_b32 v87,0xffff0000,v63
s_waitcnt vmcnt(3)
v_lshlrev_b32 v88,16,v64
v_and_b32 v89,0xffff0000,v64
v_lshlrev_b32 v90,16,v65
v_and_b32 v91,0xffff0000,v65
v_lshlrev_b32 v92,16,v66
v_and_b32 v93,0xffff0000,v66
v_lshlrev_b32 v94,16,v67
v_and_b32 v95,0xffff0000,v67
s_waitcnt vmcnt(2)
v_dot2c_f32_bf16 v96,s37,v78
v_dot2c_f32_bf16 v97,s81,v78
v_dot2c_f32_bf16 v98,s37,v79
v_dot2c_f32_bf16 v99,s81,v79
v_bitop3_b32 v16,v68,v78,s57 bitop3:0x7e
v_cvt_pk_bf16_f32 v56,v96,v97
s_nop 0
v_cvt_pk_bf16_f32 v57,v98,v99
ds_write_b64 v23,v[56:57]
s_waitcnt vmcnt(1)
v_dot2c_f32_bf16 v80,s37,v70
v_dot2c_f32_bf16 v81,s81,v70
v_dot2c_f32_bf16 v82,s37,v71
v_dot2c_f32_bf16 v83,s81,v71
v_dot2c_f32_bf16 v84,s37,v72
v_dot2c_f32_bf16 v85,s81,v72
v_dot2c_f32_bf16 v86,s37,v73
v_dot2c_f32_bf16 v87,s81,v73
v_bitop3_b32 v17,v60,v70,s57 bitop3:0x7e
v_or_b32 v16,v16,v17
v_cvt_pk_bf16_f32 v48,v80,v81
v_cvt_pk_bf16_f32 v49,v82,v83
v_cvt_pk_bf16_f32 v50,v84,v85
v_cvt_pk_bf16_f32 v51,v86,v87
ds_write_b128 v22,v[48:51] offset:0
s_waitcnt vmcnt(0)
v_dot2c_f32_bf16 v88,s37,v74
v_dot2c_f32_bf16 v89,s81,v74
v_dot2c_f32_bf16 v90,s37,v75
v_dot2c_f32_bf16 v91,s81,v75
v_dot2c_f32_bf16 v92,s37,v76
v_dot2c_f32_bf16 v93,s81,v76
v_dot2c_f32_bf16 v94,s37,v77
v_dot2c_f32_bf16 v95,s81,v77
v_bitop3_b32 v17,v64,v74,s57 bitop3:0x7e
v_bitop3_b32 v16,v16,v17,1 bitop3:0xa8
v_cmp_ne_u32 vcc,0,v16
v_cvt_pk_bf16_f32 v52,v88,v89
v_cvt_pk_bf16_f32 v53,v90,v91
v_cvt_pk_bf16_f32 v54,v92,v93
v_cvt_pk_bf16_f32 v55,v94,v95
ds_write_b128 v22,v[52:55] offset:1024
s_cbranch_vccnz fr_105
fj_106g:
v_smfmac_f32_16x16x64_bf16 v[24:27],v[48:51],a[0:7],v2
ds_read_b128 v[72:75],v21 offset:0
s_and_b32 s60,s54,1
v_smfmac_f32_16x16x64_bf16 v[28:31],v[48:51],a[8:15],v2
ds_read_b128 v[76:79],v21 offset:1024
s_lshl2_add_u32 s60,s53,s60
v_smfmac_f32_16x16x64_bf16 v[32:35],v[48:51],a[16:23],v2
ds_read_b128 v[80:83],v21 offset:2048
s_lshl_b32 s68,s60,16
v_smfmac_f32_16x16x64_bf16 v[36:39],v[48:51],a[24:31],v2
ds_read_b128 v[84:87],v21 offset:3072
s_add_u32 s68,s68,s83
s_waitcnt lgkmcnt(4)
s_barrier
v_smfmac_f32_16x16x64_bf16 v[40:43],v[48:51],a[32:39],v2
ds_read_b128 v[60:63],v3 offset:0
s_mul_i32 s59,s60,20480
v_smfmac_f32_16x16x64_bf16 v[24:27],v[52:55],a[40:47],v2
ds_read_b128 v[64:67],v3 offset:1024
s_add_u32 s59,s59,s6
v_smfmac_f32_16x16x64_bf16 v[28:31],v[52:55],a[48:55],v2
ds_read_b128 v[68:71],v4 offset:0
s_lshl_b32 s69,s53,9
v_smfmac_f32_16x16x64_bf16 v[32:35],v[52:55],a[56:63],v2
s_add_u32 m0,s74,12288
s_add_u32 s67,s73,25165824
s_add_u32 s69,s69,s7
v_smfmac_f32_16x16x64_bf16 v[36:39],v[52:55],a[64:71],v2
buffer_load_dwordx4 v1,s[8:11],s67 offen sc1 lds
s_bfe_u32 s31,s54,65537
v_smfmac_f32_16x16x64_bf16 v[40:43],v[52:55],a[72:79],v2
buffer_load_dwordx4 v1,s[8:11],s67 offen offset:1024 sc1 lds
s_waitcnt lgkmcnt(5)
v_smfmac_f32_16x16x64_bf16 v[44:47],v[48:51],v[72:79],v2
ds_read_b128 v[72:75],v21 offset:4096
s_waitcnt lgkmcnt(4)
v_smfmac_f32_16x16x64_bf16 v[44:47],v[52:55],v[80:87],v2
ds_read_b128 v[76:79],v21 offset:5120
s_waitcnt lgkmcnt(4)
v_smfmac_f32_16x16x64_bf16 v[24:27],v[60:63],a[80:87],v2
ds_read_b128 v[80:83],v21 offset:6144
s_add_u32 s32,s54,1
v_smfmac_f32_16x16x64_bf16 v[28:31],v[60:63],a[88:95],v2
ds_read_b128 v[84:87],v21 offset:7168
v_smfmac_f32_16x16x64_bf16 v[32:35],v[60:63],a[96:103],v2
buffer_load_dwordx4 v1,s[8:11],s67 offen offset:2048 sc1 lds
v_smfmac_f32_16x16x64_bf16 v[36:39],v[60:63],a[104:111],v2
buffer_load_dwordx4 v1,s[8:11],s67 offen offset:3072 sc1 lds
v_smfmac_f32_16x16x64_bf16 v[40:43],v[60:63],a[112:119],v2
s_add_u32 m0,s74,16384
s_add_u32 s67,s73,25169920
s_waitcnt lgkmcnt(2)
v_smfmac_f32_16x16x64_bf16 v[44:47],v[60:63],v[72:79],v2
ds_read_b128 v[60:63],v4 offset:1024
v_smfmac_f32_16x16x64_bf16 v[24:27],v[64:67],a[120:127],v2
ds_read_b128 v[72:75],v21 offset:8192
v_smfmac_f32_16x16x64_bf16 v[28:31],v[64:67],a[128:135],v2
ds_read_b128 v[76:79],v21 offset:9216
v_smfmac_f32_16x16x64_bf16 v[32:35],v[64:67],a[136:143],v2
v_mov_b32 v17,1
buffer_load_dwordx4 v1,s[8:11],s67 offen sc1 lds
v_smfmac_f32_16x16x64_bf16 v[36:39],v[64:67],a[144:151],v2
s_mov_b64 exec,1
buffer_store_dword v17,v1,s[8:11],s79 offen sc1
s_mov_b64 exec,-1
v_smfmac_f32_16x16x64_bf16 v[40:43],v[64:67],a[152:159],v2
buffer_store_dwordx4 v[100:103],v20,s[8:11],s78 offen sc1
s_waitcnt lgkmcnt(3)
v_smfmac_f32_16x16x64_bf16 v[44:47],v[64:67],v[80:87],v2
ds_read_b128 v[64:67],v5 offset:0
v_smfmac_f32_16x16x64_bf16 v[24:27],v[68:71],a[160:167],v2
ds_read_b128 v[80:83],v21 offset:10240
v_smfmac_f32_16x16x64_bf16 v[28:31],v[68:71],a[168:175],v2
ds_read_b128 v[84:87],v21 offset:11264
v_smfmac_f32_16x16x64_bf16 v[32:35],v[68:71],a[176:183],v2
buffer_store_dwordx4 v[104:107],v20,s[8:11],s78 offen offset:1024 sc1
v_smfmac_f32_16x16x64_bf16 v[36:39],v[68:71],a[184:191],v2
buffer_store_dwordx4 v[108:111],v20,s[8:11],s78 offen offset:2048 sc1
s_and_b32 s79,s78,2147483648
v_smfmac_f32_16x16x64_bf16 v[40:43],v[68:71],a[192:199],v2
s_or_b32 s79,s79,s30
s_mov_b32 s78,2147483648
s_waitcnt lgkmcnt(3)
v_smfmac_f32_16x16x64_bf16 v[44:47],v[68:71],v[72:79],v2
ds_read_b128 v[68:71],v5 offset:1024
v_smfmac_f32_16x16x64_bf16 v[24:27],v[60:63],a[200:207],v2
ds_read_b128 v[72:75],v21 offset:12288
v_smfmac_f32_16x16x64_bf16 v[28:31],v[60:63],a[208:215],v2
ds_read_b128 v[76:79],v21 offset:13312
v_smfmac_f32_16x16x64_bf16 v[32:35],v[60:63],a[216:223],v2
buffer_load_dword v10,v9,s[8:11],s76 offen sc1
v_smfmac_f32_16x16x64_bf16 v[36:39],v[60:63],a[224:231],v2
buffer_load_dwordx4 v1,s[8:11],s67 offen offset:1024 sc1 lds
v_smfmac_f32_16x16x64_bf16 v[40:43],v[60:63],a[232:239],v2
buffer_load_dwordx4 v1,s[8:11],s67 offen offset:2048 sc1 lds
s_waitcnt lgkmcnt(3)
v_smfmac_f32_16x16x64_bf16 v[44:47],v[60:63],v[80:87],v2
ds_read_b128 v[60:63],v59 offset:0
v_smfmac_f32_16x16x64_bf16 v[24:27],v[64:67],a[240:247],v2
ds_read_b128 v[80:83],v21 offset:14336
v_smfmac_f32_16x16x64_bf16 v[28:31],v[64:67],a[248:255],v2
ds_read_b128 v[84:87],v21 offset:15360
v_smfmac_f32_16x16x64_bf16 v[32:35],v[64:67],v[112:119],v2
buffer_load_dwordx4 v1,s[8:11],s67 offen offset:3072 sc1 lds
v_smfmac_f32_16x16x64_bf16 v[36:39],v[64:67],v[120:127],v2
s_add_u32 m0,s74,20480
s_add_u32 s67,s73,25174016
v_smfmac_f32_16x16x64_bf16 v[40:43],v[64:67],v[128:135],v2
buffer_load_dwordx4 v1,s[8:11],s67 offen sc1 lds
s_waitcnt lgkmcnt(3)
v_smfmac_f32_16x16x64_bf16 v[44:47],v[64:67],v[72:79],v2
ds_read_b128 v[64:67],v59 offset:1024
v_smfmac_f32_16x16x64_bf16 v[24:27],v[68:71],v[136:143],v2
ds_read_b128 v[72:75],v21 offset:16384
v_smfmac_f32_16x16x64_bf16 v[28:31],v[68:71],v[144:151],v2
ds_read_b128 v[76:79],v21 offset:17408
v_smfmac_f32_16x16x64_bf16 v[32:35],v[68:71],v[152:159],v2
buffer_load_dwordx4 v1,s[8:11],s67 offen offset:1024 sc1 lds
v_smfmac_f32_16x16x64_bf16 v[36:39],v[68:71],v[160:167],v2
buffer_load_dwordx4 v1,s[8:11],s67 offen offset:2048 sc1 lds
v_smfmac_f32_16x16x64_bf16 v[40:43],v[68:71],v[168:175],v2
buffer_load_dwordx4 v1,s[8:11],s67 offen offset:3072 sc1 lds
s_waitcnt lgkmcnt(3)
v_smfmac_f32_16x16x64_bf16 v[44:47],v[68:71],v[80:87],v2
ds_read_b128 v[80:83],v21 offset:18432
v_smfmac_f32_16x16x64_bf16 v[24:27],v[60:63],v[176:183],v2
ds_read_b128 v[84:87],v21 offset:19456
v_smfmac_f32_16x16x64_bf16 v[36:39],v[60:63],v[200:207],v2
s_waitcnt lgkmcnt(4)
v_smfmac_f32_16x16x64_bf16 v[24:27],v[64:67],v[216:223],v2
v_smfmac_f32_16x16x64_bf16 v[36:39],v[64:67],v[240:247],v2
v_smfmac_f32_16x16x64_bf16 v[28:31],v[60:63],v[184:191],v2
v_smfmac_f32_16x16x64_bf16 v[40:43],v[60:63],v[208:215],v2
s_nop 4
v_add_f32 v24,v24,v25
v_smfmac_f32_16x16x64_bf16 v[28:31],v[64:67],v[224:231],v2
v_add_f32 v26,v26,v27
v_smfmac_f32_16x16x64_bf16 v[40:43],v[64:67],v[248:255],v2
v_add_f32 v36,v36,v37
v_smfmac_f32_16x16x64_bf16 v[32:35],v[60:63],v[192:199],v2
v_add_f32 v38,v38,v39
s_waitcnt lgkmcnt(2)
v_smfmac_f32_16x16x64_bf16 v[44:47],v[60:63],v[72:79],v2
v_cvt_pk_bf16_f32 v37,v24,v26
v_smfmac_f32_16x16x64_bf16 v[32:35],v[64:67],v[232:239],v2
v_cvt_pk_bf16_f32 v36,v36,v38
s_waitcnt lgkmcnt(0)
v_smfmac_f32_16x16x64_bf16 v[44:47],v[64:67],v[80:87],v2
ds_write_b64 v6,v[36:37] offset:0
v_add_f32 v28,v28,v29
v_add_f32 v30,v30,v31
v_add_f32 v40,v40,v41
v_add_f32 v42,v42,v43
v_cvt_pk_bf16_f32 v41,v28,v30
v_cvt_pk_bf16_f32 v40,v40,v42
ds_write_b64 v6,v[40:41] offset:512
v_add_f32 v32,v32,v33
v_add_f32 v34,v34,v35
v_add_f32 v44,v44,v45
v_add_f32 v46,v46,v47
v_cvt_pk_bf16_f32 v45,v32,v34
v_cvt_pk_bf16_f32 v44,v44,v46
ds_write_b64 v6,v[44:45] offset:1024
s_waitcnt lgkmcnt(0)
s_barrier
buffer_load_dword v16,v11,s[8:11],s69 offen sc1
s_lshl_b32 s60,s51,6
s_add_u32 s60,s60,s52
s_mul_i32 s78,s60,196608
s_add_u32 s78,s78,s85
s_lshl_b32 s60,s60,10
s_add_u32 s30,s60,s86
s_cmp_ge_u32 s54,63
s_cselect_b32 s77,0,s77
s_cmp_eq_u32 s53,s51
s_cselect_b32 s60,1,s77
s_cmp_eq_u32 s60,0
s_cbranch_scc0 h1_109
h2_110:
s_add_u32 s50,s50,1
s_mov_b32 s51,s53
s_mov_b32 s52,s54
s_mov_b32 s57,s31
s_mov_b32 s58,s32
s_mov_b32 s53,s55
s_mov_b32 s54,s56
s_mov_b32 s75,s76
s_sub_u32 s60,s4,s5
s_cmp_gt_i32 s60,14
s_cselect_b32 s55,1,0
s_cmp_eq_u32 s4,64
s_cselect_b32 s55,1,s55
s_cmp_eq_u32 s55,0
s_cselect_b32 s56,s4,s5
s_addc_u32 s4,s4,0
s_add_u32 s5,s5,s55
s_lshl_b32 s76,s55,6
s_add_u32 s76,s76,s56
s_lshl_b32 s76,s76,9
s_add_u32 s76,s76,131072
s_mul_i32 s73,s54,393216
s_add_u32 s73,s73,s84
s_xor_b32 s74,s74,57344
v_mov_b32 v24,0
v_mov_b32 v25,0
v_mov_b32 v26,0
v_mov_b32 v27,0
v_mov_b32 v28,0
v_mov_b32 v29,0
v_mov_b32 v30,0
v_mov_b32 v31,0
v_mov_b32 v32,0
v_mov_b32 v33,0
v_mov_b32 v34,0
v_mov_b32 v35,0
v_mov_b32 v36,0
v_mov_b32 v37,0
v_mov_b32 v38,0
v_mov_b32 v39,0
v_mov_b32 v40,0
v_mov_b32 v41,0
v_mov_b32 v42,0
v_mov_b32 v43,0
v_mov_b32 v44,0
v_mov_b32 v45,0
v_mov_b32 v46,0
v_mov_b32 v47,0
s_waitcnt vmcnt(0)
v_cmp_eq_u32 vcc,0,v10
s_cmp_lg_u64 vcc,0
s_cselect_b32 s77,1,0
v_cmp_gt_u32 vcc,s58,v16
s_nop 0
s_cbranch_vccz CH_RUNG
s_cmp_lt_u32 s50,128
s_cbranch_scc1 CH_LOOP
s_branch CS_DONE
h1_109:
s_mov_b64 vcc,s[90:91]
ds_read_b64_tr_b16 v[100:101],v7 offset:0
ds_read_b64_tr_b16 v[102:103],v7 offset:512
ds_read_b64_tr_b16 v[48:49],v7 offset:1024
ds_read_b64_tr_b16 v[50:51],v7 offset:1536
ds_read_b64_tr_b16 v[104:105],v7 offset:2048
ds_read_b64_tr_b16 v[106:107],v7 offset:2560
ds_read_b64_tr_b16 v[52:53],v7 offset:3072
ds_read_b64_tr_b16 v[54:55],v7 offset:3584
ds_read_b64_tr_b16 v[108:109],v7 offset:4096
ds_read_b64_tr_b16 v[110:111],v7 offset:4608
ds_read_b64_tr_b16 v[12:13],v7 offset:5120
ds_read_b64_tr_b16 v[14:15],v7 offset:5632
s_waitcnt lgkmcnt(8)
v_cndmask_b32_dpp v100,v48,v100,vcc quad_perm:[0,1,0,1] row_mask:0xf bank_mask:0xf
v_cndmask_b32_dpp v101,v49,v101,vcc quad_perm:[0,1,0,1] row_mask:0xf bank_mask:0xf
v_cndmask_b32_dpp v102,v50,v102,vcc quad_perm:[0,1,0,1] row_mask:0xf bank_mask:0xf
v_cndmask_b32_dpp v103,v51,v103,vcc quad_perm:[0,1,0,1] row_mask:0xf bank_mask:0xf
s_waitcnt lgkmcnt(4)
v_cndmask_b32_dpp v104,v52,v104,vcc quad_perm:[0,1,0,1] row_mask:0xf bank_mask:0xf
v_cndmask_b32_dpp v105,v53,v105,vcc quad_perm:[0,1,0,1] row_mask:0xf bank_mask:0xf
v_cndmask_b32_dpp v106,v54,v106,vcc quad_perm:[0,1,0,1] row_mask:0xf bank_mask:0xf
v_cndmask_b32_dpp v107,v55,v107,vcc quad_perm:[0,1,0,1] row_mask:0xf bank_mask:0xf
s_waitcnt lgkmcnt(0)
v_cndmask_b32_dpp v108,v12,v108,vcc quad_perm:[0,1,0,1] row_mask:0xf bank_mask:0xf
v_cndmask_b32_dpp v109,v13,v109,vcc quad_perm:[0,1,0,1] row_mask:0xf bank_mask:0xf
v_cndmask_b32_dpp v110,v14,v110,vcc quad_perm:[0,1,0,1] row_mask:0xf bank_mask:0xf
v_cndmask_b32_dpp v111,v15,v111,vcc quad_perm:[0,1,0,1] row_mask:0xf bank_mask:0xf
s_cmp_eq_u32 s50,127
s_cbranch_scc1 sp_111x
sp_111:
ds_read_b32 v12,v8
s_waitcnt lgkmcnt(0)
v_cmp_ge_u32 vcc,s50,v12
s_nop 0
s_cbranch_vccz ok_112
s_sleep 1
s_sub_u32 s47,s47,1
s_cbranch_scc1 ABORT
s_branch sp_111
ok_112:
sp_111x:
s_waitcnt vmcnt(0)
s_cmp_ge_u32 s79,2147483648
s_cbranch_scc1 pf_113
v_mov_b32 v17,1
s_mov_b64 exec,1
buffer_store_dword v17,v1,s[8:11],s79 offen sc1
s_mov_b64 exec,-1
s_mov_b32 s79,2147483648
pf_113:
s_cmp_eq_u32 s78,2147483648
s_cbranch_scc1 pk_114
buffer_store_dwordx4 v[100:103],v20,s[8:11],s78 offen sc1
buffer_store_dwordx4 v[104:107],v20,s[8:11],s78 offen offset:1024 sc1
buffer_store_dwordx4 v[108:111],v20,s[8:11],s78 offen offset:2048 sc1
s_mov_b32 s79,s30
s_mov_b32 s78,2147483648
pk_114:
s_waitcnt vmcnt(0)
s_cmp_ge_u32 s79,2147483648
s_cbranch_scc1 pf_115
v_mov_b32 v17,1
s_mov_b64 exec,1
buffer_store_dword v17,v1,s[8:11],s79 offen sc1
s_mov_b64 exec,-1
s_mov_b32 s79,2147483648
pf_115:
s_cmp_eq_u32 s77,0
s_cbranch_scc1 h2_110
fl_116:
buffer_load_dword v12,v9,s[8:11],s75 offen sc1
s_waitcnt vmcnt(0)
v_cmp_eq_u32 vcc,0,v12
s_nop 0
s_cbranch_vccz ok_117
s_sleep 1
s_sub_u32 s47,s47,1
s_cbranch_scc1 ABORT
s_branch fl_116
ok_117:
s_add_u32 m0,s74,0
s_add_u32 s67,s73,0
buffer_load_dwordx4 v1,s[8:11],s67 offen sc1 lds
buffer_load_dwordx4 v1,s[8:11],s67 offen offset:1024 sc1 lds
buffer_load_dwordx4 v1,s[8:11],s67 offen offset:2048 sc1 lds
buffer_load_dwordx4 v1,s[8:11],s67 offen offset:3072 sc1 lds
s_add_u32 m0,s74,4096
s_add_u32 s67,s73,4096
buffer_load_dwordx4 v1,s[8:11],s67 offen sc1 lds
buffer_load_dwordx4 v1,s[8:11],s67 offen offset:1024 sc1 lds
buffer_load_dwordx4 v1,s[8:11],s67 offen offset:2048 sc1 lds
buffer_load_dwordx4 v1,s[8:11],s67 offen offset:3072 sc1 lds
s_add_u32 m0,s74,8192
s_add_u32 s67,s73,8192
buffer_load_dwordx4 v1,s[8:11],s67 offen sc1 lds
buffer_load_dwordx4 v1,s[8:11],s67 offen offset:1024 sc1 lds
buffer_load_dwordx4 v1,s[8:11],s67 offen offset:2048 sc1 lds
buffer_load_dwordx4 v1,s[8:11],s67 offen offset:3072 sc1 lds
s_add_u32 m0,s74,12288
s_add_u32 s67,s73,25165824
buffer_load_dwordx4 v1,s[8:11],s67 offen sc1 lds
buffer_load_dwordx4 v1,s[8:11],s67 offen offset:1024 sc1 lds
buffer_load_dwordx4 v1,s[8:11],s67 offen offset:2048 sc1 lds
buffer_load_dwordx4 v1,s[8:11],s67 offen offset:3072 sc1 lds
s_add_u32 m0,s74,16384
s_add_u32 s67,s73,25169920
buffer_load_dwordx4 v1,s[8:11],s67 offen sc1 lds
buffer_load_dwordx4 v1,s[8:11],s67 offen offset:1024 sc1 lds
buffer_load_dwordx4 v1,s[8:11],s67 offen offset:2048 sc1 lds
buffer_load_dwordx4 v1,s[8:11],s67 offen offset:3072 sc1 lds
s_add_u32 m0,s74,20480
s_add_u32 s67,s73,25174016
buffer_load_dwordx4 v1,s[8:11],s67 offen sc1 lds
buffer_load_dwordx4 v1,s[8:11],s67 offen offset:1024 sc1 lds
buffer_load_dwordx4 v1,s[8:11],s67 offen offset:2048 sc1 lds
buffer_load_dwordx4 v1,s[8:11],s67 offen offset:3072 sc1 lds
s_branch h2_110
fr_105:
v_bitop3_b32 v12,v60,v64,s57 bitop3:0x7e
v_bitop3_b32 v13,v68,v68,s57 bitop3:0x7e
v_xor_b32 v14,s57,v68
v_or3_b32 v12,v12,v13,v14
v_and_b32 v12,1,v12
v_cmp_ne_u32 vcc,0,v12
s_cbranch_vccz sk_118
buffer_load_dwordx2 v[68:69],v18,s[8:11],s59 offen sc1
buffer_load_dwordx4 v[60:63],v1,s[8:11],s59 offen sc1
buffer_load_dwordx4 v[64:67],v1,s[8:11],s59 offen offset:1024 sc1
sk_118:
buffer_load_dwordx2 v[78:79],v18,s[8:11],s68 offen sc1
buffer_load_dwordx4 v[70:73],v1,s[8:11],s68 offen sc1
buffer_load_dwordx4 v[74:77],v1,s[8:11],s68 offen offset:1024 sc1
s_sub_u32 s47,s47,1
s_cbranch_scc1 ABORT
s_waitcnt lgkmcnt(0)
s_branch fa_104
CH_RUNG:
v_mov_b32 v14,s50
ds_write_b32 v58,v14
buffer_load_dwordx2 v[68:69],v18,s[8:11],s59 offen sc1
buffer_load_dwordx4 v[60:63],v1,s[8:11],s59 offen sc1
buffer_load_dwordx4 v[64:67],v1,s[8:11],s59 offen offset:1024 sc1
fj_106e:
buffer_load_dwordx2 v[78:79],v18,s[8:11],s68 offen sc1
buffer_load_dwordx4 v[70:73],v1,s[8:11],s68 offen sc1
buffer_load_dwordx4 v[74:77],v1,s[8:11],s68 offen offset:1024 sc1
s_mov_b64 vcc,s[90:91]
ds_read_b64_tr_b16 v[100:101],v7 offset:0
ds_read_b64_tr_b16 v[102:103],v7 offset:512
ds_read_b64_tr_b16 v[48:49],v7 offset:1024
ds_read_b64_tr_b16 v[50:51],v7 offset:1536
ds_read_b64_tr_b16 v[104:105],v7 offset:2048
ds_read_b64_tr_b16 v[106:107],v7 offset:2560
ds_read_b64_tr_b16 v[52:53],v7 offset:3072
ds_read_b64_tr_b16 v[54:55],v7 offset:3584
ds_read_b64_tr_b16 v[108:109],v7 offset:4096
ds_read_b64_tr_b16 v[110:111],v7 offset:4608
ds_read_b64_tr_b16 v[12:13],v7 offset:5120
ds_read_b64_tr_b16 v[14:15],v7 offset:5632
s_waitcnt lgkmcnt(8)
v_cndmask_b32_dpp v100,v48,v100,vcc quad_perm:[0,1,0,1] row_mask:0xf bank_mask:0xf
v_cndmask_b32_dpp v101,v49,v101,vcc quad_perm:[0,1,0,1] row_mask:0xf bank_mask:0xf
v_cndmask_b32_dpp v102,v50,v102,vcc quad_perm:[0,1,0,1] row_mask:0xf bank_mask:0xf
v_cndmask_b32_dpp v103,v51,v103,vcc quad_perm:[0,1,0,1] row_mask:0xf bank_mask:0xf
s_waitcnt lgkmcnt(4)
v_cndmask_b32_dpp v104,v52,v104,vcc quad_perm:[0,1,0,1] row_mask:0xf bank_mask:0xf
v_cndmask_b32_dpp v105,v53,v105,vcc quad_perm:[0,1,0,1] row_mask:0xf bank_mask:0xf
v_cndmask_b32_dpp v106,v54,v106,vcc quad_perm:[0,1,0,1] row_mask:0xf bank_mask:0xf
v_cndmask_b32_dpp v107,v55,v107,vcc quad_perm:[0,1,0,1] row_mask:0xf bank_mask:0xf
s_waitcnt lgkmcnt(0)
v_cndmask_b32_dpp v108,v12,v108,vcc quad_perm:[0,1,0,1] row_mask:0xf bank_mask:0xf
v_cndmask_b32_dpp v109,v13,v109,vcc quad_perm:[0,1,0,1] row_mask:0xf bank_mask:0xf
v_cndmask_b32_dpp v110,v14,v110,vcc quad_perm:[0,1,0,1] row_mask:0xf bank_mask:0xf
v_cndmask_b32_dpp v111,v15,v111,vcc quad_perm:[0,1,0,1] row_mask:0xf bank_mask:0xf
s_barrier
s_branch fj_106
CS_DONE:
v_lshrrev_b32 v0,4,v1
s_add_u32 s61,s48,0
s_endpgm
CV_START:
s_and_b32 s60,s46,1
s_lshl1_add_u32 s60,s49,s60
s_cmp_eq_u32 s60,1
s_cbranch_scc1 CV_LOOP_F1
s_cmp_eq_u32 s60,2
s_cbranch_scc1 CV_LOOP_S0
s_cmp_eq_u32 s60,3
s_cbranch_scc1 CV_LOOP_S1
CV_LOOP_F0:
v_mov_b32 v24,0
v_mov_b32 v25,0
v_mov_b32 v26,0
v_mov_b32 v27,0
v_mov_b32 v28,0
v_mov_b32 v29,0
v_mov_b32 v30,0
v_mov_b32 v31,0
v_mov_b32 v32,0
v_mov_b32 v33,0
v_mov_b32 v34,0
v_mov_b32 v35,0
v_mov_b32 v36,0
v_mov_b32 v37,0
v_mov_b32 v38,0
v_mov_b32 v39,0
v_mov_b32 v40,0
v_mov_b32 v41,0
v_mov_b32 v42,0
v_mov_b32 v43,0
v_mov_b32 v44,0
v_mov_b32 v45,0
v_mov_b32 v46,0
v_mov_b32 v47,0
s_cmp_lg_u32 s46,0
s_cbranch_scc1 np_122
db_123:
buffer_load_dword v12,v11,s[8:11],s69 offen sc1
s_waitcnt vmcnt(0)
v_cmp_gt_u32 vcc,s58,v12
s_cbranch_vccz dbok_124
s_sub_u32 s47,s47,1
s_cbranch_scc1 ABORT
s_branch db_123
dbok_124:
np_122:
s_barrier
buffer_load_dwordx2 v[68:69],v18,s[8:11],s59 offen sc1
buffer_load_dwordx4 v[60:63],v1,s[8:11],s59 offen sc1
buffer_load_dwordx4 v[64:67],v1,s[8:11],s59 offen offset:1024 sc1
s_waitcnt vmcnt(2)
s_sleep 3
fj_121f:
buffer_load_dwordx2 v[78:79],v18,s[8:11],s68 offen sc1
buffer_load_dwordx4 v[70:73],v1,s[8:11],s68 offen sc1
buffer_load_dwordx4 v[74:77],v1,s[8:11],s68 offen offset:1024 sc1
fj_121:
fa_119:
s_waitcnt vmcnt(5)
v_lshlrev_b32 v96,16,v68
v_and_b32 v97,0xffff0000,v68
v_lshlrev_b32 v98,16,v69
v_and_b32 v99,0xffff0000,v69
s_waitcnt vmcnt(4)
v_lshlrev_b32 v80,16,v60
v_and_b32 v81,0xffff0000,v60
v_lshlrev_b32 v82,16,v61
v_and_b32 v83,0xffff0000,v61
v_lshlrev_b32 v84,16,v62
v_and_b32 v85,0xffff0000,v62
v_lshlrev_b32 v86,16,v63
v_and_b32 v87,0xffff0000,v63
s_waitcnt vmcnt(3)
v_lshlrev_b32 v88,16,v64
v_and_b32 v89,0xffff0000,v64
v_lshlrev_b32 v90,16,v65
v_and_b32 v91,0xffff0000,v65
v_lshlrev_b32 v92,16,v66
v_and_b32 v93,0xffff0000,v66
v_lshlrev_b32 v94,16,v67
v_and_b32 v95,0xffff0000,v67
s_waitcnt vmcnt(2)
v_dot2c_f32_bf16 v96,s37,v78
v_dot2c_f32_bf16 v97,s81,v78
v_dot2c_f32_bf16 v98,s37,v79
v_dot2c_f32_bf16 v99,s81,v79
v_bitop3_b32 v16,v68,v78,s57 bitop3:0x7e
v_cvt_pk_bf16_f32 v56,v96,v97
s_nop 0
v_cvt_pk_bf16_f32 v57,v98,v99
ds_write_b64 v23,v[56:57]
s_waitcnt vmcnt(1)
v_dot2c_f32_bf16 v80,s37,v70
v_dot2c_f32_bf16 v81,s81,v70
v_dot2c_f32_bf16 v82,s37,v71
v_dot2c_f32_bf16 v83,s81,v71
v_dot2c_f32_bf16 v84,s37,v72
v_dot2c_f32_bf16 v85,s81,v72
v_dot2c_f32_bf16 v86,s37,v73
v_dot2c_f32_bf16 v87,s81,v73
v_bitop3_b32 v17,v60,v70,s57 bitop3:0x7e
v_or_b32 v16,v16,v17
v_cvt_pk_bf16_f32 v48,v80,v81
v_cvt_pk_bf16_f32 v49,v82,v83
v_cvt_pk_bf16_f32 v50,v84,v85
v_cvt_pk_bf16_f32 v51,v86,v87
ds_write_b128 v22,v[48:51] offset:0
s_waitcnt vmcnt(0)
v_dot2c_f32_bf16 v88,s37,v74
v_dot2c_f32_bf16 v89,s81,v74
v_dot2c_f32_bf16 v90,s37,v75
v_dot2c_f32_bf16 v91,s81,v75
v_dot2c_f32_bf16 v92,s37,v76
v_dot2c_f32_bf16 v93,s81,v76
v_dot2c_f32_bf16 v94,s37,v77
v_dot2c_f32_bf16 v95,s81,v77
v_bitop3_b32 v17,v64,v74,s57 bitop3:0x7e
v_bitop3_b32 v16,v16,v17,1 bitop3:0xa8
v_cmp_ne_u32 vcc,0,v16
v_cvt_pk_bf16_f32 v52,v88,v89
v_cvt_pk_bf16_f32 v53,v90,v91
v_cvt_pk_bf16_f32 v54,v92,v93
v_cvt_pk_bf16_f32 v55,v94,v95
ds_write_b128 v22,v[52:55] offset:1024
s_cbranch_vccnz fr_120
fj_121g:
v_smfmac_f32_16x16x64_bf16 v[24:27],v[48:51],a[0:7],v2
ds_read_b128 v[72:75],v21 offset:0
s_and_b32 s60,s52,1
v_smfmac_f32_16x16x64_bf16 v[28:31],v[48:51],a[8:15],v2
ds_read_b128 v[76:79],v21 offset:1024
s_lshl2_add_u32 s60,s51,s60
v_smfmac_f32_16x16x64_bf16 v[32:35],v[48:51],a[16:23],v2
ds_read_b128 v[80:83],v21 offset:2048
s_mul_i32 s60,s60,49152
v_smfmac_f32_16x16x64_bf16 v[36:39],v[48:51],a[24:31],v2
ds_read_b128 v[84:87],v21 offset:3072
s_add_u32 s71,s60,s34
s_waitcnt lgkmcnt(4)
s_barrier
v_smfmac_f32_16x16x64_bf16 v[40:43],v[48:51],a[32:39],v2
ds_read_b128 v[60:63],v3 offset:0
v_smfmac_f32_16x16x64_bf16 v[24:27],v[52:55],a[40:47],v2
ds_read_b128 v[64:67],v3 offset:1024
v_mov_b32 v17,1
v_smfmac_f32_16x16x64_bf16 v[28:31],v[52:55],a[48:55],v2
ds_read_b128 v[68:71],v4 offset:0
v_smfmac_f32_16x16x64_bf16 v[32:35],v[52:55],a[56:63],v2
s_mov_b64 exec,1
buffer_store_dword v17,v1,s[8:11],s79 offen sc1
s_mov_b64 exec,-1
v_smfmac_f32_16x16x64_bf16 v[36:39],v[52:55],a[64:71],v2
buffer_store_dwordx4 v[100:103],v6,s[8:11],s78 offen sc1
v_smfmac_f32_16x16x64_bf16 v[40:43],v[52:55],a[72:79],v2
buffer_store_dwordx2 v[104:105],v7,s[8:11],s78 offen sc1
s_waitcnt lgkmcnt(5)
v_smfmac_f32_16x16x64_bf16 v[44:47],v[48:51],v[72:79],v2
ds_read_b128 v[72:75],v21 offset:4096
s_waitcnt lgkmcnt(4)
v_smfmac_f32_16x16x64_bf16 v[44:47],v[52:55],v[80:87],v2
ds_read_b128 v[76:79],v21 offset:5120
s_waitcnt lgkmcnt(4)
v_smfmac_f32_16x16x64_bf16 v[24:27],v[60:63],a[80:87],v2
ds_read_b128 v[80:83],v21 offset:6144
s_and_b32 s79,s78,2147483648
v_smfmac_f32_16x16x64_bf16 v[28:31],v[60:63],a[88:95],v2
ds_read_b128 v[84:87],v21 offset:7168
s_or_b32 s79,s79,s30
v_smfmac_f32_16x16x64_bf16 v[32:35],v[60:63],a[96:103],v2
s_mov_b32 s78,2147483648
v_smfmac_f32_16x16x64_bf16 v[36:39],v[60:63],a[104:111],v2
v_smfmac_f32_16x16x64_bf16 v[40:43],v[60:63],a[112:119],v2
s_waitcnt lgkmcnt(2)
v_smfmac_f32_16x16x64_bf16 v[44:47],v[60:63],v[72:79],v2
ds_read_b128 v[60:63],v4 offset:1024
v_smfmac_f32_16x16x64_bf16 v[24:27],v[64:67],a[120:127],v2
ds_read_b128 v[72:75],v21 offset:8192
v_smfmac_f32_16x16x64_bf16 v[28:31],v[64:67],a[128:135],v2
ds_read_b128 v[76:79],v21 offset:9216
v_smfmac_f32_16x16x64_bf16 v[32:35],v[64:67],a[136:143],v2
v_smfmac_f32_16x16x64_bf16 v[36:39],v[64:67],a[144:151],v2
v_smfmac_f32_16x16x64_bf16 v[40:43],v[64:67],a[152:159],v2
s_waitcnt lgkmcnt(3)
v_smfmac_f32_16x16x64_bf16 v[44:47],v[64:67],v[80:87],v2
ds_read_b128 v[64:67],v5 offset:0
v_smfmac_f32_16x16x64_bf16 v[24:27],v[68:71],a[160:167],v2
ds_read_b128 v[80:83],v21 offset:10240
v_smfmac_f32_16x16x64_bf16 v[28:31],v[68:71],a[168:175],v2
ds_read_b128 v[84:87],v21 offset:11264
v_smfmac_f32_16x16x64_bf16 v[32:35],v[68:71],a[176:183],v2
v_smfmac_f32_16x16x64_bf16 v[36:39],v[68:71],a[184:191],v2
v_smfmac_f32_16x16x64_bf16 v[40:43],v[68:71],a[192:199],v2
s_waitcnt lgkmcnt(3)
v_smfmac_f32_16x16x64_bf16 v[44:47],v[68:71],v[72:79],v2
ds_read_b128 v[68:71],v5 offset:1024
v_smfmac_f32_16x16x64_bf16 v[24:27],v[60:63],a[200:207],v2
ds_read_b128 v[72:75],v21 offset:12288
v_smfmac_f32_16x16x64_bf16 v[28:31],v[60:63],a[208:215],v2
ds_read_b128 v[76:79],v21 offset:13312
v_smfmac_f32_16x16x64_bf16 v[32:35],v[60:63],a[216:223],v2
v_smfmac_f32_16x16x64_bf16 v[36:39],v[60:63],a[224:231],v2
v_smfmac_f32_16x16x64_bf16 v[40:43],v[60:63],a[232:239],v2
s_waitcnt lgkmcnt(3)
v_smfmac_f32_16x16x64_bf16 v[44:47],v[60:63],v[80:87],v2
ds_read_b128 v[60:63],v59 offset:0
v_smfmac_f32_16x16x64_bf16 v[24:27],v[64:67],a[240:247],v2
ds_read_b128 v[80:83],v21 offset:14336
v_smfmac_f32_16x16x64_bf16 v[28:31],v[64:67],a[248:255],v2
ds_read_b128 v[84:87],v21 offset:15360
v_smfmac_f32_16x16x64_bf16 v[32:35],v[64:67],v[112:119],v2
v_smfmac_f32_16x16x64_bf16 v[36:39],v[64:67],v[120:127],v2
v_smfmac_f32_16x16x64_bf16 v[40:43],v[64:67],v[128:135],v2
s_waitcnt lgkmcnt(3)
v_smfmac_f32_16x16x64_bf16 v[44:47],v[64:67],v[72:79],v2
ds_read_b128 v[64:67],v59 offset:1024
v_smfmac_f32_16x16x64_bf16 v[24:27],v[68:71],v[136:143],v2
ds_read_b128 v[72:75],v21 offset:16384
v_smfmac_f32_16x16x64_bf16 v[28:31],v[68:71],v[144:151],v2
ds_read_b128 v[76:79],v21 offset:17408
v_smfmac_f32_16x16x64_bf16 v[32:35],v[68:71],v[152:159],v2
v_smfmac_f32_16x16x64_bf16 v[36:39],v[68:71],v[160:167],v2
v_smfmac_f32_16x16x64_bf16 v[40:43],v[68:71],v[168:175],v2
s_waitcnt lgkmcnt(3)
v_smfmac_f32_16x16x64_bf16 v[44:47],v[68:71],v[80:87],v2
ds_read_b128 v[80:83],v21 offset:18432
v_smfmac_f32_16x16x64_bf16 v[24:27],v[60:63],v[176:183],v2
ds_read_b128 v[84:87],v21 offset:19456
v_smfmac_f32_16x16x64_bf16 v[28:31],v[60:63],v[184:191],v2
s_waitcnt lgkmcnt(4)
v_smfmac_f32_16x16x64_bf16 v[24:27],v[64:67],v[216:223],v2
v_smfmac_f32_16x16x64_bf16 v[28:31],v[64:67],v[224:231],v2
v_smfmac_f32_16x16x64_bf16 v[32:35],v[60:63],v[192:199],v2
v_smfmac_f32_16x16x64_bf16 v[36:39],v[60:63],v[200:207],v2
s_nop 4
v_add_f32 v24,v24,v25
v_smfmac_f32_16x16x64_bf16 v[32:35],v[64:67],v[232:239],v2
v_add_f32 v26,v26,v27
v_smfmac_f32_16x16x64_bf16 v[36:39],v[64:67],v[240:247],v2
v_add_f32 v28,v28,v29
v_smfmac_f32_16x16x64_bf16 v[40:43],v[60:63],v[208:215],v2
v_add_f32 v30,v30,v31
s_waitcnt lgkmcnt(2)
v_smfmac_f32_16x16x64_bf16 v[44:47],v[60:63],v[72:79],v2
v_cvt_pk_bf16_f32 v100,v24,v26
v_smfmac_f32_16x16x64_bf16 v[40:43],v[64:67],v[248:255],v2
v_cvt_pk_bf16_f32 v101,v28,v30
s_waitcnt lgkmcnt(0)
v_smfmac_f32_16x16x64_bf16 v[44:47],v[64:67],v[80:87],v2
v_and_or_b32 v100,v100,-2,s57
v_add_f32 v32,v32,v33
v_add_f32 v34,v34,v35
v_add_f32 v36,v36,v37
v_add_f32 v38,v38,v39
v_cvt_pk_bf16_f32 v102,v32,v34
v_cvt_pk_bf16_f32 v103,v36,v38
v_and_or_b32 v102,v102,-2,s57
buffer_store_dwordx4 v[100:103],v6,s[8:11],s71 offen
v_add_f32 v40,v40,v41
v_add_f32 v42,v42,v43
v_add_f32 v44,v44,v45
v_add_f32 v46,v46,v47
v_cvt_pk_bf16_f32 v104,v40,v42
v_cvt_pk_bf16_f32 v105,v44,v46
v_and_or_b32 v104,v104,-2,s57
buffer_store_dwordx2 v[104:105],v7,s[8:11],s71 offen
s_lshl_b32 s60,s51,6
s_add_u32 s60,s60,s52
s_mul_i32 s78,s60,196608
s_add_u32 s78,s78,s85
s_lshl_b32 s60,s60,10
s_add_u32 s30,s60,s86
s_sub_u32 s60,s4,s5
s_cmp_gt_i32 s60,14
s_cselect_b32 s53,1,0
s_cmp_eq_u32 s4,64
s_cselect_b32 s53,1,s53
s_cmp_eq_u32 s53,0
s_cselect_b32 s54,s4,s5
s_addc_u32 s4,s4,0
s_add_u32 s5,s5,s53
s_and_b32 s60,s54,1
s_lshl2_add_u32 s60,s53,s60
s_lshl_b32 s68,s60,16
s_add_u32 s68,s68,s83
s_mul_i32 s59,s60,20480
s_add_u32 s59,s59,s6
s_lshl_b32 s69,s53,9
s_add_u32 s69,s69,s7
s_bfe_u32 s31,s54,65537
s_add_u32 s32,s54,1
s_cmp_lg_u32 s53,s51
s_cbranch_scc1 nx_125
s_waitcnt vmcnt(0)
s_cmp_ge_u32 s79,2147483648
s_cbranch_scc1 pf_126
v_mov_b32 v17,1
s_mov_b64 exec,1
buffer_store_dword v17,v1,s[8:11],s79 offen sc1
s_mov_b64 exec,-1
s_mov_b32 s79,2147483648
pf_126:
s_cmp_eq_u32 s78,2147483648
s_cbranch_scc1 pk_127
buffer_store_dwordx4 v[100:103],v6,s[8:11],s78 offen sc1
buffer_store_dwordx2 v[104:105],v7,s[8:11],s78 offen sc1
s_mov_b32 s79,s30
s_mov_b32 s78,2147483648
pk_127:
s_waitcnt vmcnt(0)
s_cmp_ge_u32 s79,2147483648
s_cbranch_scc1 pf_128
v_mov_b32 v17,1
s_mov_b64 exec,1
buffer_store_dword v17,v1,s[8:11],s79 offen sc1
s_mov_b64 exec,-1
s_mov_b32 s79,2147483648
pf_128:
nx_125:
s_add_u32 s50,s50,1
s_mov_b32 s51,s53
s_mov_b32 s52,s54
s_mov_b32 s57,s31
s_mov_b32 s58,s32
s_cmp_lt_u32 s50,128
s_cbranch_scc1 CV_LOOP_F0
s_branch CV_DONE
fr_120:
v_bitop3_b32 v12,v60,v64,s57 bitop3:0x7e
v_bitop3_b32 v13,v68,v68,s57 bitop3:0x7e
v_xor_b32 v14,s57,v68
v_or3_b32 v12,v12,v13,v14
v_and_b32 v12,1,v12
v_cmp_ne_u32 vcc,0,v12
s_cbranch_vccz sk_129
buffer_load_dwordx2 v[68:69],v18,s[8:11],s59 offen sc1
buffer_load_dwordx4 v[60:63],v1,s[8:11],s59 offen sc1
buffer_load_dwordx4 v[64:67],v1,s[8:11],s59 offen offset:1024 sc1
sk_129:
buffer_load_dwordx2 v[78:79],v18,s[8:11],s68 offen sc1
buffer_load_dwordx4 v[70:73],v1,s[8:11],s68 offen sc1
buffer_load_dwordx4 v[74:77],v1,s[8:11],s68 offen offset:1024 sc1
s_sub_u32 s47,s47,1
s_cbranch_scc1 ABORT
s_waitcnt lgkmcnt(0)
s_branch fa_119
CV_LOOP_F1:
v_mov_b32 v24,0
v_mov_b32 v25,0
v_mov_b32 v26,0
v_mov_b32 v27,0
v_mov_b32 v28,0
v_mov_b32 v29,0
v_mov_b32 v30,0
v_mov_b32 v31,0
v_mov_b32 v32,0
v_mov_b32 v33,0
v_mov_b32 v34,0
v_mov_b32 v35,0
v_mov_b32 v36,0
v_mov_b32 v37,0
v_mov_b32 v38,0
v_mov_b32 v39,0
v_mov_b32 v40,0
v_mov_b32 v41,0
v_mov_b32 v42,0
v_mov_b32 v43,0
v_mov_b32 v44,0
v_mov_b32 v45,0
v_mov_b32 v46,0
v_mov_b32 v47,0
s_barrier
buffer_load_dwordx2 v[68:69],v18,s[8:11],s59 offen sc1
buffer_load_dwordx4 v[60:63],v1,s[8:11],s59 offen sc1
buffer_load_dwordx4 v[64:67],v1,s[8:11],s59 offen offset:1024 sc1
s_waitcnt vmcnt(2)
s_sleep 3
fj_132f:
buffer_load_dwordx2 v[78:79],v18,s[8:11],s68 offen sc1
buffer_load_dwordx4 v[70:73],v1,s[8:11],s68 offen sc1
buffer_load_dwordx4 v[74:77],v1,s[8:11],s68 offen offset:1024 sc1
fj_132:
fa_130:
s_waitcnt vmcnt(5)
v_lshlrev_b32 v96,16,v68
v_and_b32 v97,0xffff0000,v68
v_lshlrev_b32 v98,16,v69
v_and_b32 v99,0xffff0000,v69
s_waitcnt vmcnt(4)
v_lshlrev_b32 v80,16,v60
v_and_b32 v81,0xffff0000,v60
v_lshlrev_b32 v82,16,v61
v_and_b32 v83,0xffff0000,v61
v_lshlrev_b32 v84,16,v62
v_and_b32 v85,0xffff0000,v62
v_lshlrev_b32 v86,16,v63
v_and_b32 v87,0xffff0000,v63
s_waitcnt vmcnt(3)
v_lshlrev_b32 v88,16,v64
v_and_b32 v89,0xffff0000,v64
v_lshlrev_b32 v90,16,v65
v_and_b32 v91,0xffff0000,v65
v_lshlrev_b32 v92,16,v66
v_and_b32 v93,0xffff0000,v66
v_lshlrev_b32 v94,16,v67
v_and_b32 v95,0xffff0000,v67
s_waitcnt vmcnt(2)
v_dot2c_f32_bf16 v96,s37,v78
v_dot2c_f32_bf16 v97,s81,v78
v_dot2c_f32_bf16 v98,s37,v79
v_dot2c_f32_bf16 v99,s81,v79
v_bitop3_b32 v16,v68,v78,s57 bitop3:0x7e
v_cvt_pk_bf16_f32 v56,v96,v97
s_nop 0
v_cvt_pk_bf16_f32 v57,v98,v99
ds_write_b64 v23,v[56:57]
s_waitcnt vmcnt(1)
v_dot2c_f32_bf16 v80,s37,v70
v_dot2c_f32_bf16 v81,s81,v70
v_dot2c_f32_bf16 v82,s37,v71
v_dot2c_f32_bf16 v83,s81,v71
v_dot2c_f32_bf16 v84,s37,v72
v_dot2c_f32_bf16 v85,s81,v72
v_dot2c_f32_bf16 v86,s37,v73
v_dot2c_f32_bf16 v87,s81,v73
v_bitop3_b32 v17,v60,v70,s57 bitop3:0x7e
v_or_b32 v16,v16,v17
v_cvt_pk_bf16_f32 v48,v80,v81
v_cvt_pk_bf16_f32 v49,v82,v83
v_cvt_pk_bf16_f32 v50,v84,v85
v_cvt_pk_bf16_f32 v51,v86,v87
ds_write_b128 v22,v[48:51] offset:0
s_waitcnt vmcnt(0)
v_dot2c_f32_bf16 v88,s37,v74
v_dot2c_f32_bf16 v89,s81,v74
v_dot2c_f32_bf16 v90,s37,v75
v_dot2c_f32_bf16 v91,s81,v75
v_dot2c_f32_bf16 v92,s37,v76
v_dot2c_f32_bf16 v93,s81,v76
v_dot2c_f32_bf16 v94,s37,v77
v_dot2c_f32_bf16 v95,s81,v77
v_bitop3_b32 v17,v64,v74,s57 bitop3:0x7e
v_bitop3_b32 v16,v16,v17,1 bitop3:0xa8
v_cmp_ne_u32 vcc,0,v16
v_cvt_pk_bf16_f32 v52,v88,v89
v_cvt_pk_bf16_f32 v53,v90,v91
v_cvt_pk_bf16_f32 v54,v92,v93
v_cvt_pk_bf16_f32 v55,v94,v95
ds_write_b128 v22,v[52:55] offset:1024
s_cbranch_vccnz fr_131
fj_132g:
v_smfmac_f32_16x16x64_bf16 v[24:27],v[48:51],a[0:7],v2
ds_read_b128 v[72:75],v21 offset:0
s_and_b32 s60,s52,1
v_smfmac_f32_16x16x64_bf16 v[28:31],v[48:51],a[8:15],v2
ds_read_b128 v[76:79],v21 offset:1024
s_lshl2_add_u32 s60,s51,s60
v_smfmac_f32_16x16x64_bf16 v[32:35],v[48:51],a[16:23],v2
ds_read_b128 v[80:83],v21 offset:2048
s_mul_i32 s60,s60,49152
v_smfmac_f32_16x16x64_bf16 v[36:39],v[48:51],a[24:31],v2
ds_read_b128 v[84:87],v21 offset:3072
s_add_u32 s71,s60,s34
s_waitcnt lgkmcnt(4)
s_barrier
v_smfmac_f32_16x16x64_bf16 v[40:43],v[48:51],a[32:39],v2
ds_read_b128 v[60:63],v3 offset:0
v_smfmac_f32_16x16x64_bf16 v[24:27],v[52:55],a[40:47],v2
ds_read_b128 v[64:67],v3 offset:1024
v_mov_b32 v17,1
v_smfmac_f32_16x16x64_bf16 v[28:31],v[52:55],a[48:55],v2
ds_read_b128 v[68:71],v4 offset:0
v_smfmac_f32_16x16x64_bf16 v[32:35],v[52:55],a[56:63],v2
s_mov_b64 exec,1
buffer_store_dword v17,v1,s[8:11],s79 offen sc1
s_mov_b64 exec,-1
v_smfmac_f32_16x16x64_bf16 v[36:39],v[52:55],a[64:71],v2
buffer_store_dwordx4 v[102:105],v6,s[8:11],s78 offen sc1
v_smfmac_f32_16x16x64_bf16 v[40:43],v[52:55],a[72:79],v2
buffer_store_dwordx2 v[100:101],v7,s[8:11],s78 offen sc1
s_waitcnt lgkmcnt(5)
v_smfmac_f32_16x16x64_bf16 v[44:47],v[48:51],v[72:79],v2
ds_read_b128 v[72:75],v21 offset:4096
s_waitcnt lgkmcnt(4)
v_smfmac_f32_16x16x64_bf16 v[44:47],v[52:55],v[80:87],v2
ds_read_b128 v[76:79],v21 offset:5120
s_waitcnt lgkmcnt(4)
v_smfmac_f32_16x16x64_bf16 v[24:27],v[60:63],a[80:87],v2
ds_read_b128 v[80:83],v21 offset:6144
s_and_b32 s79,s78,2147483648
v_smfmac_f32_16x16x64_bf16 v[28:31],v[60:63],a[88:95],v2
ds_read_b128 v[84:87],v21 offset:7168
s_or_b32 s79,s79,s30
v_smfmac_f32_16x16x64_bf16 v[32:35],v[60:63],a[96:103],v2
s_mov_b32 s78,2147483648
v_smfmac_f32_16x16x64_bf16 v[36:39],v[60:63],a[104:111],v2
v_smfmac_f32_16x16x64_bf16 v[40:43],v[60:63],a[112:119],v2
s_waitcnt lgkmcnt(2)
v_smfmac_f32_16x16x64_bf16 v[44:47],v[60:63],v[72:79],v2
ds_read_b128 v[60:63],v4 offset:1024
v_smfmac_f32_16x16x64_bf16 v[24:27],v[64:67],a[120:127],v2
ds_read_b128 v[72:75],v21 offset:8192
v_smfmac_f32_16x16x64_bf16 v[28:31],v[64:67],a[128:135],v2
ds_read_b128 v[76:79],v21 offset:9216
v_smfmac_f32_16x16x64_bf16 v[32:35],v[64:67],a[136:143],v2
v_smfmac_f32_16x16x64_bf16 v[36:39],v[64:67],a[144:151],v2
v_smfmac_f32_16x16x64_bf16 v[40:43],v[64:67],a[152:159],v2
s_waitcnt lgkmcnt(3)
v_smfmac_f32_16x16x64_bf16 v[44:47],v[64:67],v[80:87],v2
ds_read_b128 v[64:67],v5 offset:0
v_smfmac_f32_16x16x64_bf16 v[24:27],v[68:71],a[160:167],v2
ds_read_b128 v[80:83],v21 offset:10240
v_smfmac_f32_16x16x64_bf16 v[28:31],v[68:71],a[168:175],v2
ds_read_b128 v[84:87],v21 offset:11264
v_smfmac_f32_16x16x64_bf16 v[32:35],v[68:71],a[176:183],v2
v_smfmac_f32_16x16x64_bf16 v[36:39],v[68:71],a[184:191],v2
v_smfmac_f32_16x16x64_bf16 v[40:43],v[68:71],a[192:199],v2
s_waitcnt lgkmcnt(3)
v_smfmac_f32_16x16x64_bf16 v[44:47],v[68:71],v[72:79],v2
ds_read_b128 v[68:71],v5 offset:1024
v_smfmac_f32_16x16x64_bf16 v[24:27],v[60:63],a[200:207],v2
ds_read_b128 v[72:75],v21 offset:12288
v_smfmac_f32_16x16x64_bf16 v[28:31],v[60:63],a[208:215],v2
ds_read_b128 v[76:79],v21 offset:13312
v_smfmac_f32_16x16x64_bf16 v[32:35],v[60:63],a[216:223],v2
v_smfmac_f32_16x16x64_bf16 v[36:39],v[60:63],a[224:231],v2
v_smfmac_f32_16x16x64_bf16 v[40:43],v[60:63],a[232:239],v2
s_waitcnt lgkmcnt(3)
v_smfmac_f32_16x16x64_bf16 v[44:47],v[60:63],v[80:87],v2
ds_read_b128 v[60:63],v59 offset:0
v_smfmac_f32_16x16x64_bf16 v[24:27],v[64:67],a[240:247],v2
ds_read_b128 v[80:83],v21 offset:14336
v_smfmac_f32_16x16x64_bf16 v[28:31],v[64:67],a[248:255],v2
ds_read_b128 v[84:87],v21 offset:15360
v_smfmac_f32_16x16x64_bf16 v[32:35],v[64:67],v[112:119],v2
v_smfmac_f32_16x16x64_bf16 v[36:39],v[64:67],v[120:127],v2
v_smfmac_f32_16x16x64_bf16 v[40:43],v[64:67],v[128:135],v2
s_waitcnt lgkmcnt(3)
v_smfmac_f32_16x16x64_bf16 v[44:47],v[64:67],v[72:79],v2
ds_read_b128 v[64:67],v59 offset:1024
v_smfmac_f32_16x16x64_bf16 v[24:27],v[68:71],v[136:143],v2
ds_read_b128 v[72:75],v21 offset:16384
v_smfmac_f32_16x16x64_bf16 v[28:31],v[68:71],v[144:151],v2
ds_read_b128 v[76:79],v21 offset:17408
v_smfmac_f32_16x16x64_bf16 v[32:35],v[68:71],v[152:159],v2
v_smfmac_f32_16x16x64_bf16 v[36:39],v[68:71],v[160:167],v2
v_smfmac_f32_16x16x64_bf16 v[40:43],v[68:71],v[168:175],v2
s_waitcnt lgkmcnt(3)
v_smfmac_f32_16x16x64_bf16 v[44:47],v[68:71],v[80:87],v2
ds_read_b128 v[80:83],v21 offset:18432
v_smfmac_f32_16x16x64_bf16 v[24:27],v[60:63],v[176:183],v2
ds_read_b128 v[84:87],v21 offset:19456
v_smfmac_f32_16x16x64_bf16 v[28:31],v[60:63],v[184:191],v2
s_waitcnt lgkmcnt(4)
v_smfmac_f32_16x16x64_bf16 v[24:27],v[64:67],v[216:223],v2
v_smfmac_f32_16x16x64_bf16 v[28:31],v[64:67],v[224:231],v2
v_smfmac_f32_16x16x64_bf16 v[32:35],v[60:63],v[192:199],v2
v_smfmac_f32_16x16x64_bf16 v[36:39],v[60:63],v[200:207],v2
s_nop 4
v_add_f32 v24,v24,v25
v_smfmac_f32_16x16x64_bf16 v[32:35],v[64:67],v[232:239],v2
v_add_f32 v26,v26,v27
v_smfmac_f32_16x16x64_bf16 v[36:39],v[64:67],v[240:247],v2
v_add_f32 v28,v28,v29
v_smfmac_f32_16x16x64_bf16 v[40:43],v[60:63],v[208:215],v2
v_add_f32 v30,v30,v31
s_waitcnt lgkmcnt(2)
v_smfmac_f32_16x16x64_bf16 v[44:47],v[60:63],v[72:79],v2
v_cvt_pk_bf16_f32 v100,v24,v26
v_smfmac_f32_16x16x64_bf16 v[40:43],v[64:67],v[248:255],v2
v_cvt_pk_bf16_f32 v101,v28,v30
s_waitcnt lgkmcnt(0)
v_smfmac_f32_16x16x64_bf16 v[44:47],v[64:67],v[80:87],v2
v_and_or_b32 v100,v100,-2,s57
buffer_store_dwordx2 v[100:101],v7,s[8:11],s71 offen
v_add_f32 v32,v32,v33
v_add_f32 v34,v34,v35
v_add_f32 v36,v36,v37
v_add_f32 v38,v38,v39
v_cvt_pk_bf16_f32 v102,v32,v34
v_cvt_pk_bf16_f32 v103,v36,v38
v_and_or_b32 v102,v102,-2,s57
v_add_f32 v40,v40,v41
v_add_f32 v42,v42,v43
v_add_f32 v44,v44,v45
v_add_f32 v46,v46,v47
v_cvt_pk_bf16_f32 v104,v40,v42
v_cvt_pk_bf16_f32 v105,v44,v46
v_and_or_b32 v104,v104,-2,s57
buffer_store_dwordx4 v[102:105],v6,s[8:11],s71 offen
s_lshl_b32 s60,s51,6
s_add_u32 s60,s60,s52
s_mul_i32 s78,s60,196608
s_add_u32 s78,s78,s85
s_lshl_b32 s60,s60,10
s_add_u32 s30,s60,s86
s_sub_u32 s60,s4,s5
s_cmp_gt_i32 s60,14
s_cselect_b32 s53,1,0
s_cmp_eq_u32 s4,64
s_cselect_b32 s53,1,s53
s_cmp_eq_u32 s53,0
s_cselect_b32 s54,s4,s5
s_addc_u32 s4,s4,0
s_add_u32 s5,s5,s53
s_and_b32 s60,s54,1
s_lshl2_add_u32 s60,s53,s60
s_lshl_b32 s68,s60,16
s_add_u32 s68,s68,s83
s_mul_i32 s59,s60,20480
s_add_u32 s59,s59,s6
s_lshl_b32 s69,s53,9
s_add_u32 s69,s69,s7
s_bfe_u32 s31,s54,65537
s_add_u32 s32,s54,1
s_cmp_lg_u32 s53,s51
s_cbranch_scc1 nx_133
s_waitcnt vmcnt(0)
s_cmp_ge_u32 s79,2147483648
s_cbranch_scc1 pf_134
v_mov_b32 v17,1
s_mov_b64 exec,1
buffer_store_dword v17,v1,s[8:11],s79 offen sc1
s_mov_b64 exec,-1
s_mov_b32 s79,2147483648
pf_134:
s_cmp_eq_u32 s78,2147483648
s_cbranch_scc1 pk_135
buffer_store_dwordx4 v[102:105],v6,s[8:11],s78 offen sc1
buffer_store_dwordx2 v[100:101],v7,s[8:11],s78 offen sc1
s_mov_b32 s79,s30
s_mov_b32 s78,2147483648
pk_135:
s_waitcnt vmcnt(0)
s_cmp_ge_u32 s79,2147483648
s_cbranch_scc1 pf_136
v_mov_b32 v17,1
s_mov_b64 exec,1
buffer_store_dword v17,v1,s[8:11],s79 offen sc1
s_mov_b64 exec,-1
s_mov_b32 s79,2147483648
pf_136:
nx_133:
s_add_u32 s50,s50,1
s_mov_b32 s51,s53
s_mov_b32 s52,s54
s_mov_b32 s57,s31
s_mov_b32 s58,s32
s_cmp_lt_u32 s50,128
s_cbranch_scc1 CV_LOOP_F1
s_branch CV_DONE
fr_131:
v_bitop3_b32 v12,v60,v64,s57 bitop3:0x7e
v_bitop3_b32 v13,v68,v68,s57 bitop3:0x7e
v_xor_b32 v14,s57,v68
v_or3_b32 v12,v12,v13,v14
v_and_b32 v12,1,v12
v_cmp_ne_u32 vcc,0,v12
s_cbranch_vccz sk_137
buffer_load_dwordx2 v[68:69],v18,s[8:11],s59 offen sc1
buffer_load_dwordx4 v[60:63],v1,s[8:11],s59 offen sc1
buffer_load_dwordx4 v[64:67],v1,s[8:11],s59 offen offset:1024 sc1
sk_137:
buffer_load_dwordx2 v[78:79],v18,s[8:11],s68 offen sc1
buffer_load_dwordx4 v[70:73],v1,s[8:11],s68 offen sc1
buffer_load_dwordx4 v[74:77],v1,s[8:11],s68 offen offset:1024 sc1
s_sub_u32 s47,s47,1
s_cbranch_scc1 ABORT
s_waitcnt lgkmcnt(0)
s_branch fa_130
CV_LOOP_S0:
v_mov_b32 v24,0
v_mov_b32 v25,0
v_mov_b32 v26,0
v_mov_b32 v27,0
v_mov_b32 v28,0
v_mov_b32 v29,0
v_mov_b32 v30,0
v_mov_b32 v31,0
v_mov_b32 v32,0
v_mov_b32 v33,0
v_mov_b32 v34,0
v_mov_b32 v35,0
v_mov_b32 v36,0
v_mov_b32 v37,0
v_mov_b32 v38,0
v_mov_b32 v39,0
v_mov_b32 v40,0
v_mov_b32 v41,0
v_mov_b32 v42,0
v_mov_b32 v43,0
v_mov_b32 v44,0
v_mov_b32 v45,0
v_mov_b32 v46,0
v_mov_b32 v47,0
s_cmp_lg_u32 s46,0
s_cbranch_scc1 np_141
db_142:
buffer_load_dword v12,v11,s[8:11],s69 offen sc1
s_waitcnt vmcnt(0)
v_cmp_gt_u32 vcc,s58,v12
s_cbranch_vccz dbok_143
s_sub_u32 s47,s47,1
s_cbranch_scc1 ABORT
s_branch db_142
dbok_143:
np_141:
s_barrier
buffer_load_dwordx2 v[68:69],v18,s[8:11],s59 offen sc1
buffer_load_dwordx4 v[60:63],v1,s[8:11],s59 offen sc1
buffer_load_dwordx4 v[64:67],v1,s[8:11],s59 offen offset:1024 sc1
s_waitcnt vmcnt(2)
s_sleep 3
fj_140f:
buffer_load_dwordx2 v[78:79],v18,s[8:11],s68 offen sc1
buffer_load_dwordx4 v[70:73],v1,s[8:11],s68 offen sc1
buffer_load_dwordx4 v[74:77],v1,s[8:11],s68 offen offset:1024 sc1
fj_140:
fa_138:
s_waitcnt vmcnt(5)
v_lshlrev_b32 v96,16,v68
v_and_b32 v97,0xffff0000,v68
v_lshlrev_b32 v98,16,v69
v_and_b32 v99,0xffff0000,v69
s_waitcnt vmcnt(4)
v_lshlrev_b32 v80,16,v60
v_and_b32 v81,0xffff0000,v60
v_lshlrev_b32 v82,16,v61
v_and_b32 v83,0xffff0000,v61
v_lshlrev_b32 v84,16,v62
v_and_b32 v85,0xffff0000,v62
v_lshlrev_b32 v86,16,v63
v_and_b32 v87,0xffff0000,v63
s_waitcnt vmcnt(3)
v_lshlrev_b32 v88,16,v64
v_and_b32 v89,0xffff0000,v64
v_lshlrev_b32 v90,16,v65
v_and_b32 v91,0xffff0000,v65
v_lshlrev_b32 v92,16,v66
v_and_b32 v93,0xffff0000,v66
v_lshlrev_b32 v94,16,v67
v_and_b32 v95,0xffff0000,v67
s_waitcnt vmcnt(2)
v_dot2c_f32_bf16 v96,s37,v78
v_dot2c_f32_bf16 v97,s81,v78
v_dot2c_f32_bf16 v98,s37,v79
v_dot2c_f32_bf16 v99,s81,v79
v_bitop3_b32 v16,v68,v78,s57 bitop3:0x7e
v_cvt_pk_bf16_f32 v56,v96,v97
s_nop 0
v_cvt_pk_bf16_f32 v57,v98,v99
ds_write_b64 v23,v[56:57]
s_waitcnt vmcnt(1)
v_dot2c_f32_bf16 v80,s37,v70
v_dot2c_f32_bf16 v81,s81,v70
v_dot2c_f32_bf16 v82,s37,v71
v_dot2c_f32_bf16 v83,s81,v71
v_dot2c_f32_bf16 v84,s37,v72
v_dot2c_f32_bf16 v85,s81,v72
v_dot2c_f32_bf16 v86,s37,v73
v_dot2c_f32_bf16 v87,s81,v73
v_bitop3_b32 v17,v60,v70,s57 bitop3:0x7e
v_or_b32 v16,v16,v17
v_cvt_pk_bf16_f32 v48,v80,v81
v_cvt_pk_bf16_f32 v49,v82,v83
v_cvt_pk_bf16_f32 v50,v84,v85
v_cvt_pk_bf16_f32 v51,v86,v87
ds_write_b128 v22,v[48:51] offset:0
s_waitcnt vmcnt(0)
v_dot2c_f32_bf16 v88,s37,v74
v_dot2c_f32_bf16 v89,s81,v74
v_dot2c_f32_bf16 v90,s37,v75
v_dot2c_f32_bf16 v91,s81,v75
v_dot2c_f32_bf16 v92,s37,v76
v_dot2c_f32_bf16 v93,s81,v76
v_dot2c_f32_bf16 v94,s37,v77
v_dot2c_f32_bf16 v95,s81,v77
v_bitop3_b32 v17,v64,v74,s57 bitop3:0x7e
v_bitop3_b32 v16,v16,v17,1 bitop3:0xa8
v_cmp_ne_u32 vcc,0,v16
v_cvt_pk_bf16_f32 v52,v88,v89
v_cvt_pk_bf16_f32 v53,v90,v91
v_cvt_pk_bf16_f32 v54,v92,v93
v_cvt_pk_bf16_f32 v55,v94,v95
ds_write_b128 v22,v[52:55] offset:1024
s_cbranch_vccnz fr_139
fj_140g:
v_smfmac_f32_16x16x64_bf16 v[24:27],v[48:51],a[0:7],v2
ds_read_b128 v[72:75],v21 offset:0
s_and_b32 s60,s52,1
v_smfmac_f32_16x16x64_bf16 v[28:31],v[48:51],a[8:15],v2
ds_read_b128 v[76:79],v21 offset:1024
s_lshl2_add_u32 s60,s51,s60
v_smfmac_f32_16x16x64_bf16 v[32:35],v[48:51],a[16:23],v2
ds_read_b128 v[80:83],v21 offset:2048
s_mul_i32 s60,s60,49152
v_smfmac_f32_16x16x64_bf16 v[36:39],v[48:51],a[24:31],v2
ds_read_b128 v[84:87],v21 offset:3072
s_add_u32 s71,s60,s34
s_waitcnt lgkmcnt(4)
s_barrier
v_smfmac_f32_16x16x64_bf16 v[40:43],v[48:51],a[32:39],v2
ds_read_b128 v[60:63],v3 offset:0
v_smfmac_f32_16x16x64_bf16 v[24:27],v[52:55],a[40:47],v2
ds_read_b128 v[64:67],v3 offset:1024
v_mov_b32 v17,1
v_smfmac_f32_16x16x64_bf16 v[28:31],v[52:55],a[48:55],v2
ds_read_b128 v[68:71],v4 offset:0
v_smfmac_f32_16x16x64_bf16 v[32:35],v[52:55],a[56:63],v2
s_mov_b64 exec,1
buffer_store_dword v17,v1,s[8:11],s79 offen sc1
s_mov_b64 exec,-1
v_smfmac_f32_16x16x64_bf16 v[36:39],v[52:55],a[64:71],v2
buffer_store_dwordx4 v[100:103],v6,s[8:11],s78 offen sc1
v_smfmac_f32_16x16x64_bf16 v[40:43],v[52:55],a[72:79],v2
buffer_store_dwordx2 v[104:105],v7,s[8:11],s78 offen sc1
s_waitcnt lgkmcnt(5)
v_smfmac_f32_16x16x64_bf16 v[44:47],v[48:51],v[72:79],v2
ds_read_b128 v[72:75],v21 offset:4096
s_waitcnt lgkmcnt(4)
v_smfmac_f32_16x16x64_bf16 v[44:47],v[52:55],v[80:87],v2
ds_read_b128 v[76:79],v21 offset:5120
s_waitcnt lgkmcnt(4)
v_smfmac_f32_16x16x64_bf16 v[24:27],v[60:63],a[80:87],v2
ds_read_b128 v[80:83],v21 offset:6144
s_and_b32 s79,s78,2147483648
v_smfmac_f32_16x16x64_bf16 v[28:31],v[60:63],a[88:95],v2
ds_read_b128 v[84:87],v21 offset:7168
s_or_b32 s79,s79,s30
v_smfmac_f32_16x16x64_bf16 v[32:35],v[60:63],a[96:103],v2
s_mov_b32 s78,2147483648
v_smfmac_f32_16x16x64_bf16 v[36:39],v[60:63],a[104:111],v2
v_smfmac_f32_16x16x64_bf16 v[40:43],v[60:63],a[112:119],v2
s_waitcnt lgkmcnt(2)
v_smfmac_f32_16x16x64_bf16 v[44:47],v[60:63],v[72:79],v2
ds_read_b128 v[60:63],v4 offset:1024
v_smfmac_f32_16x16x64_bf16 v[24:27],v[64:67],a[120:127],v2
ds_read_b128 v[72:75],v21 offset:8192
v_smfmac_f32_16x16x64_bf16 v[28:31],v[64:67],a[128:135],v2
ds_read_b128 v[76:79],v21 offset:9216
v_smfmac_f32_16x16x64_bf16 v[32:35],v[64:67],a[136:143],v2
v_smfmac_f32_16x16x64_bf16 v[36:39],v[64:67],a[144:151],v2
v_smfmac_f32_16x16x64_bf16 v[40:43],v[64:67],a[152:159],v2
s_waitcnt lgkmcnt(3)
v_smfmac_f32_16x16x64_bf16 v[44:47],v[64:67],v[80:87],v2
ds_read_b128 v[64:67],v5 offset:0
v_smfmac_f32_16x16x64_bf16 v[24:27],v[68:71],a[160:167],v2
ds_read_b128 v[80:83],v21 offset:10240
v_smfmac_f32_16x16x64_bf16 v[28:31],v[68:71],a[168:175],v2
ds_read_b128 v[84:87],v21 offset:11264
v_smfmac_f32_16x16x64_bf16 v[32:35],v[68:71],a[176:183],v2
v_smfmac_f32_16x16x64_bf16 v[36:39],v[68:71],a[184:191],v2
v_smfmac_f32_16x16x64_bf16 v[40:43],v[68:71],a[192:199],v2
s_waitcnt lgkmcnt(3)
v_smfmac_f32_16x16x64_bf16 v[44:47],v[68:71],v[72:79],v2
ds_read_b128 v[68:71],v5 offset:1024
v_smfmac_f32_16x16x64_bf16 v[24:27],v[60:63],a[200:207],v2
ds_read_b128 v[72:75],v21 offset:12288
v_smfmac_f32_16x16x64_bf16 v[28:31],v[60:63],a[208:215],v2
ds_read_b128 v[76:79],v21 offset:13312
v_smfmac_f32_16x16x64_bf16 v[32:35],v[60:63],a[216:223],v2
v_smfmac_f32_16x16x64_bf16 v[36:39],v[60:63],a[224:231],v2
v_smfmac_f32_16x16x64_bf16 v[40:43],v[60:63],a[232:239],v2
s_waitcnt lgkmcnt(3)
v_smfmac_f32_16x16x64_bf16 v[44:47],v[60:63],v[80:87],v2
ds_read_b128 v[60:63],v59 offset:0
v_smfmac_f32_16x16x64_bf16 v[24:27],v[64:67],a[240:247],v2
ds_read_b128 v[80:83],v21 offset:14336
v_smfmac_f32_16x16x64_bf16 v[28:31],v[64:67],a[248:255],v2
ds_read_b128 v[84:87],v21 offset:15360
v_smfmac_f32_16x16x64_bf16 v[32:35],v[64:67],v[112:119],v2
v_smfmac_f32_16x16x64_bf16 v[36:39],v[64:67],v[120:127],v2
v_smfmac_f32_16x16x64_bf16 v[40:43],v[64:67],v[128:135],v2
s_waitcnt lgkmcnt(3)
v_smfmac_f32_16x16x64_bf16 v[44:47],v[64:67],v[72:79],v2
ds_read_b128 v[64:67],v59 offset:1024
v_smfmac_f32_16x16x64_bf16 v[24:27],v[68:71],v[136:143],v2
ds_read_b128 v[72:75],v21 offset:16384
v_smfmac_f32_16x16x64_bf16 v[28:31],v[68:71],v[144:151],v2
ds_read_b128 v[76:79],v21 offset:17408
v_smfmac_f32_16x16x64_bf16 v[32:35],v[68:71],v[152:159],v2
v_smfmac_f32_16x16x64_bf16 v[36:39],v[68:71],v[160:167],v2
v_smfmac_f32_16x16x64_bf16 v[40:43],v[68:71],v[168:175],v2
s_waitcnt lgkmcnt(3)
v_smfmac_f32_16x16x64_bf16 v[44:47],v[68:71],v[80:87],v2
ds_read_b128 v[80:83],v21 offset:18432
v_smfmac_f32_16x16x64_bf16 v[24:27],v[60:63],v[176:183],v2
ds_read_b128 v[84:87],v21 offset:19456
v_smfmac_f32_16x16x64_bf16 v[28:31],v[60:63],v[184:191],v2
s_waitcnt lgkmcnt(4)
v_smfmac_f32_16x16x64_bf16 v[24:27],v[64:67],v[216:223],v2
v_smfmac_f32_16x16x64_bf16 v[28:31],v[64:67],v[224:231],v2
v_smfmac_f32_16x16x64_bf16 v[32:35],v[60:63],v[192:199],v2
v_smfmac_f32_16x16x64_bf16 v[36:39],v[60:63],v[200:207],v2
s_nop 4
v_add_f32 v24,v24,v25
v_smfmac_f32_16x16x64_bf16 v[32:35],v[64:67],v[232:239],v2
v_add_f32 v26,v26,v27
v_smfmac_f32_16x16x64_bf16 v[36:39],v[64:67],v[240:247],v2
v_add_f32 v28,v28,v29
v_smfmac_f32_16x16x64_bf16 v[40:43],v[60:63],v[208:215],v2
v_add_f32 v30,v30,v31
s_waitcnt lgkmcnt(2)
v_smfmac_f32_16x16x64_bf16 v[44:47],v[60:63],v[72:79],v2
v_cvt_pk_bf16_f32 v100,v24,v26
v_smfmac_f32_16x16x64_bf16 v[40:43],v[64:67],v[248:255],v2
v_cvt_pk_bf16_f32 v101,v28,v30
s_waitcnt lgkmcnt(0)
v_smfmac_f32_16x16x64_bf16 v[44:47],v[64:67],v[80:87],v2
v_and_or_b32 v100,v100,-2,s57
v_add_f32 v32,v32,v33
v_add_f32 v34,v34,v35
v_add_f32 v36,v36,v37
v_add_f32 v38,v38,v39
v_cvt_pk_bf16_f32 v102,v32,v34
v_cvt_pk_bf16_f32 v103,v36,v38
v_and_or_b32 v102,v102,-2,s57
buffer_store_dwordx4 v[100:103],v6,s[8:11],s71 offen sc1
v_add_f32 v40,v40,v41
v_add_f32 v42,v42,v43
v_add_f32 v44,v44,v45
v_add_f32 v46,v46,v47
v_cvt_pk_bf16_f32 v104,v40,v42
v_cvt_pk_bf16_f32 v105,v44,v46
v_and_or_b32 v104,v104,-2,s57
buffer_store_dwordx2 v[104:105],v7,s[8:11],s71 offen sc1
s_lshl_b32 s60,s51,6
s_add_u32 s60,s60,s52
s_mul_i32 s78,s60,196608
s_add_u32 s78,s78,s85
s_lshl_b32 s60,s60,10
s_add_u32 s30,s60,s86
s_sub_u32 s60,s4,s5
s_cmp_gt_i32 s60,14
s_cselect_b32 s53,1,0
s_cmp_eq_u32 s4,64
s_cselect_b32 s53,1,s53
s_cmp_eq_u32 s53,0
s_cselect_b32 s54,s4,s5
s_addc_u32 s4,s4,0
s_add_u32 s5,s5,s53
s_and_b32 s60,s54,1
s_lshl2_add_u32 s60,s53,s60
s_lshl_b32 s68,s60,16
s_add_u32 s68,s68,s83
s_mul_i32 s59,s60,20480
s_add_u32 s59,s59,s6
s_lshl_b32 s69,s53,9
s_add_u32 s69,s69,s7
s_bfe_u32 s31,s54,65537
s_add_u32 s32,s54,1
s_cmp_lg_u32 s53,s51
s_cbranch_scc1 nx_144
s_waitcnt vmcnt(0)
s_cmp_ge_u32 s79,2147483648
s_cbranch_scc1 pf_145
v_mov_b32 v17,1
s_mov_b64 exec,1
buffer_store_dword v17,v1,s[8:11],s79 offen sc1
s_mov_b64 exec,-1
s_mov_b32 s79,2147483648
pf_145:
s_cmp_eq_u32 s78,2147483648
s_cbranch_scc1 pk_146
buffer_store_dwordx4 v[100:103],v6,s[8:11],s78 offen sc1
buffer_store_dwordx2 v[104:105],v7,s[8:11],s78 offen sc1
s_mov_b32 s79,s30
s_mov_b32 s78,2147483648
pk_146:
s_waitcnt vmcnt(0)
s_cmp_ge_u32 s79,2147483648
s_cbranch_scc1 pf_147
v_mov_b32 v17,1
s_mov_b64 exec,1
buffer_store_dword v17,v1,s[8:11],s79 offen sc1
s_mov_b64 exec,-1
s_mov_b32 s79,2147483648
pf_147:
nx_144:
s_add_u32 s50,s50,1
s_mov_b32 s51,s53
s_mov_b32 s52,s54
s_mov_b32 s57,s31
s_mov_b32 s58,s32
s_cmp_lt_u32 s50,128
s_cbranch_scc1 CV_LOOP_S0
s_branch CV_DONE
fr_139:
v_bitop3_b32 v12,v60,v64,s57 bitop3:0x7e
v_bitop3_b32 v13,v68,v68,s57 bitop3:0x7e
v_xor_b32 v14,s57,v68
v_or3_b32 v12,v12,v13,v14
v_and_b32 v12,1,v12
v_cmp_ne_u32 vcc,0,v12
s_cbranch_vccz sk_148
buffer_load_dwordx2 v[68:69],v18,s[8:11],s59 offen sc1
buffer_load_dwordx4 v[60:63],v1,s[8:11],s59 offen sc1
buffer_load_dwordx4 v[64:67],v1,s[8:11],s59 offen offset:1024 sc1
sk_148:
buffer_load_dwordx2 v[78:79],v18,s[8:11],s68 offen sc1
buffer_load_dwordx4 v[70:73],v1,s[8:11],s68 offen sc1
buffer_load_dwordx4 v[74:77],v1,s[8:11],s68 offen offset:1024 sc1
s_sub_u32 s47,s47,1
s_cbranch_scc1 ABORT
s_waitcnt lgkmcnt(0)
s_branch fa_138
CV_LOOP_S1:
v_mov_b32 v24,0
v_mov_b32 v25,0
v_mov_b32 v26,0
v_mov_b32 v27,0
v_mov_b32 v28,0
v_mov_b32 v29,0
v_mov_b32 v30,0
v_mov_b32 v31,0
v_mov_b32 v32,0
v_mov_b32 v33,0
v_mov_b32 v34,0
v_mov_b32 v35,0
v_mov_b32 v36,0
v_mov_b32 v37,0
v_mov_b32 v38,0
v_mov_b32 v39,0
v_mov_b32 v40,0
v_mov_b32 v41,0
v_mov_b32 v42,0
v_mov_b32 v43,0
v_mov_b32 v44,0
v_mov_b32 v45,0
v_mov_b32 v46,0
v_mov_b32 v47,0
s_barrier
buffer_load_dwordx2 v[68:69],v18,s[8:11],s59 offen sc1
buffer_load_dwordx4 v[60:63],v1,s[8:11],s59 offen sc1
buffer_load_dwordx4 v[64:67],v1,s[8:11],s59 offen offset:1024 sc1
s_waitcnt vmcnt(2)
s_sleep 3
fj_151f:
buffer_load_dwordx2 v[78:79],v18,s[8:11],s68 offen sc1
buffer_load_dwordx4 v[70:73],v1,s[8:11],s68 offen sc1
buffer_load_dwordx4 v[74:77],v1,s[8:11],s68 offen offset:1024 sc1
fj_151:
fa_149:
s_waitcnt vmcnt(5)
v_lshlrev_b32 v96,16,v68
v_and_b32 v97,0xffff0000,v68
v_lshlrev_b32 v98,16,v69
v_and_b32 v99,0xffff0000,v69
s_waitcnt vmcnt(4)
v_lshlrev_b32 v80,16,v60
v_and_b32 v81,0xffff0000,v60
v_lshlrev_b32 v82,16,v61
v_and_b32 v83,0xffff0000,v61
v_lshlrev_b32 v84,16,v62
v_and_b32 v85,0xffff0000,v62
v_lshlrev_b32 v86,16,v63
v_and_b32 v87,0xffff0000,v63
s_waitcnt vmcnt(3)
v_lshlrev_b32 v88,16,v64
v_and_b32 v89,0xffff0000,v64
v_lshlrev_b32 v90,16,v65
v_and_b32 v91,0xffff0000,v65
v_lshlrev_b32 v92,16,v66
v_and_b32 v93,0xffff0000,v66
v_lshlrev_b32 v94,16,v67
v_and_b32 v95,0xffff0000,v67
s_waitcnt vmcnt(2)
v_dot2c_f32_bf16 v96,s37,v78
v_dot2c_f32_bf16 v97,s81,v78
v_dot2c_f32_bf16 v98,s37,v79
v_dot2c_f32_bf16 v99,s81,v79
v_bitop3_b32 v16,v68,v78,s57 bitop3:0x7e
v_cvt_pk_bf16_f32 v56,v96,v97
s_nop 0
v_cvt_pk_bf16_f32 v57,v98,v99
ds_write_b64 v23,v[56:57]
s_waitcnt vmcnt(1)
v_dot2c_f32_bf16 v80,s37,v70
v_dot2c_f32_bf16 v81,s81,v70
v_dot2c_f32_bf16 v82,s37,v71
v_dot2c_f32_bf16 v83,s81,v71
v_dot2c_f32_bf16 v84,s37,v72
v_dot2c_f32_bf16 v85,s81,v72
v_dot2c_f32_bf16 v86,s37,v73
v_dot2c_f32_bf16 v87,s81,v73
v_bitop3_b32 v17,v60,v70,s57 bitop3:0x7e
v_or_b32 v16,v16,v17
v_cvt_pk_bf16_f32 v48,v80,v81
v_cvt_pk_bf16_f32 v49,v82,v83
v_cvt_pk_bf16_f32 v50,v84,v85
v_cvt_pk_bf16_f32 v51,v86,v87
ds_write_b128 v22,v[48:51] offset:0
s_waitcnt vmcnt(0)
v_dot2c_f32_bf16 v88,s37,v74
v_dot2c_f32_bf16 v89,s81,v74
v_dot2c_f32_bf16 v90,s37,v75
v_dot2c_f32_bf16 v91,s81,v75
v_dot2c_f32_bf16 v92,s37,v76
v_dot2c_f32_bf16 v93,s81,v76
v_dot2c_f32_bf16 v94,s37,v77
v_dot2c_f32_bf16 v95,s81,v77
v_bitop3_b32 v17,v64,v74,s57 bitop3:0x7e
v_bitop3_b32 v16,v16,v17,1 bitop3:0xa8
v_cmp_ne_u32 vcc,0,v16
v_cvt_pk_bf16_f32 v52,v88,v89
v_cvt_pk_bf16_f32 v53,v90,v91
v_cvt_pk_bf16_f32 v54,v92,v93
v_cvt_pk_bf16_f32 v55,v94,v95
ds_write_b128 v22,v[52:55] offset:1024
s_cbranch_vccnz fr_150
fj_151g:
v_smfmac_f32_16x16x64_bf16 v[24:27],v[48:51],a[0:7],v2
ds_read_b128 v[72:75],v21 offset:0
s_and_b32 s60,s52,1
v_smfmac_f32_16x16x64_bf16 v[28:31],v[48:51],a[8:15],v2
ds_read_b128 v[76:79],v21 offset:1024
s_lshl2_add_u32 s60,s51,s60
v_smfmac_f32_16x16x64_bf16 v[32:35],v[48:51],a[16:23],v2
ds_read_b128 v[80:83],v21 offset:2048
s_mul_i32 s60,s60,49152
v_smfmac_f32_16x16x64_bf16 v[36:39],v[48:51],a[24:31],v2
ds_read_b128 v[84:87],v21 offset:3072
s_add_u32 s71,s60,s34
s_waitcnt lgkmcnt(4)
s_barrier
v_smfmac_f32_16x16x64_bf16 v[40:43],v[48:51],a[32:39],v2
ds_read_b128 v[60:63],v3 offset:0
v_smfmac_f32_16x16x64_bf16 v[24:27],v[52:55],a[40:47],v2
ds_read_b128 v[64:67],v3 offset:1024
v_mov_b32 v17,1
v_smfmac_f32_16x16x64_bf16 v[28:31],v[52:55],a[48:55],v2
ds_read_b128 v[68:71],v4 offset:0
v_smfmac_f32_16x16x64_bf16 v[32:35],v[52:55],a[56:63],v2
s_mov_b64 exec,1
buffer_store_dword v17,v1,s[8:11],s79 offen sc1
s_mov_b64 exec,-1
v_smfmac_f32_16x16x64_bf16 v[36:39],v[52:55],a[64:71],v2
buffer_store_dwordx4 v[102:105],v6,s[8:11],s78 offen sc1
v_smfmac_f32_16x16x64_bf16 v[40:43],v[52:55],a[72:79],v2
buffer_store_dwordx2 v[100:101],v7,s[8:11],s78 offen sc1
s_waitcnt lgkmcnt(5)
v_smfmac_f32_16x16x64_bf16 v[44:47],v[48:51],v[72:79],v2
ds_read_b128 v[72:75],v21 offset:4096
s_waitcnt lgkmcnt(4)
v_smfmac_f32_16x16x64_bf16 v[44:47],v[52:55],v[80:87],v2
ds_read_b128 v[76:79],v21 offset:5120
s_waitcnt lgkmcnt(4)
v_smfmac_f32_16x16x64_bf16 v[24:27],v[60:63],a[80:87],v2
ds_read_b128 v[80:83],v21 offset:6144
s_and_b32 s79,s78,2147483648
v_smfmac_f32_16x16x64_bf16 v[28:31],v[60:63],a[88:95],v2
ds_read_b128 v[84:87],v21 offset:7168
s_or_b32 s79,s79,s30
v_smfmac_f32_16x16x64_bf16 v[32:35],v[60:63],a[96:103],v2
s_mov_b32 s78,2147483648
v_smfmac_f32_16x16x64_bf16 v[36:39],v[60:63],a[104:111],v2
v_smfmac_f32_16x16x64_bf16 v[40:43],v[60:63],a[112:119],v2
s_waitcnt lgkmcnt(2)
v_smfmac_f32_16x16x64_bf16 v[44:47],v[60:63],v[72:79],v2
ds_read_b128 v[60:63],v4 offset:1024
v_smfmac_f32_16x16x64_bf16 v[24:27],v[64:67],a[120:127],v2
ds_read_b128 v[72:75],v21 offset:8192
v_smfmac_f32_16x16x64_bf16 v[28:31],v[64:67],a[128:135],v2
ds_read_b128 v[76:79],v21 offset:9216
v_smfmac_f32_16x16x64_bf16 v[32:35],v[64:67],a[136:143],v2
v_smfmac_f32_16x16x64_bf16 v[36:39],v[64:67],a[144:151],v2
v_smfmac_f32_16x16x64_bf16 v[40:43],v[64:67],a[152:159],v2
s_waitcnt lgkmcnt(3)
v_smfmac_f32_16x16x64_bf16 v[44:47],v[64:67],v[80:87],v2
ds_read_b128 v[64:67],v5 offset:0
v_smfmac_f32_16x16x64_bf16 v[24:27],v[68:71],a[160:167],v2
ds_read_b128 v[80:83],v21 offset:10240
v_smfmac_f32_16x16x64_bf16 v[28:31],v[68:71],a[168:175],v2
ds_read_b128 v[84:87],v21 offset:11264
v_smfmac_f32_16x16x64_bf16 v[32:35],v[68:71],a[176:183],v2
v_smfmac_f32_16x16x64_bf16 v[36:39],v[68:71],a[184:191],v2
v_smfmac_f32_16x16x64_bf16 v[40:43],v[68:71],a[192:199],v2
s_waitcnt lgkmcnt(3)
v_smfmac_f32_16x16x64_bf16 v[44:47],v[68:71],v[72:79],v2
ds_read_b128 v[68:71],v5 offset:1024
v_smfmac_f32_16x16x64_bf16 v[24:27],v[60:63],a[200:207],v2
ds_read_b128 v[72:75],v21 offset:12288
v_smfmac_f32_16x16x64_bf16 v[28:31],v[60:63],a[208:215],v2
ds_read_b128 v[76:79],v21 offset:13312
v_smfmac_f32_16x16x64_bf16 v[32:35],v[60:63],a[216:223],v2
v_smfmac_f32_16x16x64_bf16 v[36:39],v[60:63],a[224:231],v2
v_smfmac_f32_16x16x64_bf16 v[40:43],v[60:63],a[232:239],v2
s_waitcnt lgkmcnt(3)
v_smfmac_f32_16x16x64_bf16 v[44:47],v[60:63],v[80:87],v2
ds_read_b128 v[60:63],v59 offset:0
v_smfmac_f32_16x16x64_bf16 v[24:27],v[64:67],a[240:247],v2
ds_read_b128 v[80:83],v21 offset:14336
v_smfmac_f32_16x16x64_bf16 v[28:31],v[64:67],a[248:255],v2
ds_read_b128 v[84:87],v21 offset:15360
v_smfmac_f32_16x16x64_bf16 v[32:35],v[64:67],v[112:119],v2
v_smfmac_f32_16x16x64_bf16 v[36:39],v[64:67],v[120:127],v2
v_smfmac_f32_16x16x64_bf16 v[40:43],v[64:67],v[128:135],v2
s_waitcnt lgkmcnt(3)
v_smfmac_f32_16x16x64_bf16 v[44:47],v[64:67],v[72:79],v2
ds_read_b128 v[64:67],v59 offset:1024
v_smfmac_f32_16x16x64_bf16 v[24:27],v[68:71],v[136:143],v2
ds_read_b128 v[72:75],v21 offset:16384
v_smfmac_f32_16x16x64_bf16 v[28:31],v[68:71],v[144:151],v2
ds_read_b128 v[76:79],v21 offset:17408
v_smfmac_f32_16x16x64_bf16 v[32:35],v[68:71],v[152:159],v2
v_smfmac_f32_16x16x64_bf16 v[36:39],v[68:71],v[160:167],v2
v_smfmac_f32_16x16x64_bf16 v[40:43],v[68:71],v[168:175],v2
s_waitcnt lgkmcnt(3)
v_smfmac_f32_16x16x64_bf16 v[44:47],v[68:71],v[80:87],v2
ds_read_b128 v[80:83],v21 offset:18432
v_smfmac_f32_16x16x64_bf16 v[24:27],v[60:63],v[176:183],v2
ds_read_b128 v[84:87],v21 offset:19456
v_smfmac_f32_16x16x64_bf16 v[28:31],v[60:63],v[184:191],v2
s_waitcnt lgkmcnt(4)
v_smfmac_f32_16x16x64_bf16 v[24:27],v[64:67],v[216:223],v2
v_smfmac_f32_16x16x64_bf16 v[28:31],v[64:67],v[224:231],v2
v_smfmac_f32_16x16x64_bf16 v[32:35],v[60:63],v[192:199],v2
v_smfmac_f32_16x16x64_bf16 v[36:39],v[60:63],v[200:207],v2
s_nop 4
v_add_f32 v24,v24,v25
v_smfmac_f32_16x16x64_bf16 v[32:35],v[64:67],v[232:239],v2
v_add_f32 v26,v26,v27
v_smfmac_f32_16x16x64_bf16 v[36:39],v[64:67],v[240:247],v2
v_add_f32 v28,v28,v29
v_smfmac_f32_16x16x64_bf16 v[40:43],v[60:63],v[208:215],v2
v_add_f32 v30,v30,v31
s_waitcnt lgkmcnt(2)
v_smfmac_f32_16x16x64_bf16 v[44:47],v[60:63],v[72:79],v2
v_cvt_pk_bf16_f32 v100,v24,v26
v_smfmac_f32_16x16x64_bf16 v[40:43],v[64:67],v[248:255],v2
v_cvt_pk_bf16_f32 v101,v28,v30
s_waitcnt lgkmcnt(0)
v_smfmac_f32_16x16x64_bf16 v[44:47],v[64:67],v[80:87],v2
v_and_or_b32 v100,v100,-2,s57
buffer_store_dwordx2 v[100:101],v7,s[8:11],s71 offen sc1
v_add_f32 v32,v32,v33
v_add_f32 v34,v34,v35
v_add_f32 v36,v36,v37
v_add_f32 v38,v38,v39
v_cvt_pk_bf16_f32 v102,v32,v34
v_cvt_pk_bf16_f32 v103,v36,v38
v_and_or_b32 v102,v102,-2,s57
v_add_f32 v40,v40,v41
v_add_f32 v42,v42,v43
v_add_f32 v44,v44,v45
v_add_f32 v46,v46,v47
v_cvt_pk_bf16_f32 v104,v40,v42
v_cvt_pk_bf16_f32 v105,v44,v46
v_and_or_b32 v104,v104,-2,s57
buffer_store_dwordx4 v[102:105],v6,s[8:11],s71 offen sc1
s_lshl_b32 s60,s51,6
s_add_u32 s60,s60,s52
s_mul_i32 s78,s60,196608
s_add_u32 s78,s78,s85
s_lshl_b32 s60,s60,10
s_add_u32 s30,s60,s86
s_sub_u32 s60,s4,s5
s_cmp_gt_i32 s60,14
s_cselect_b32 s53,1,0
s_cmp_eq_u32 s4,64
s_cselect_b32 s53,1,s53
s_cmp_eq_u32 s53,0
s_cselect_b32 s54,s4,s5
s_addc_u32 s4,s4,0
s_add_u32 s5,s5,s53
s_and_b32 s60,s54,1
s_lshl2_add_u32 s60,s53,s60
s_lshl_b32 s68,s60,16
s_add_u32 s68,s68,s83
s_mul_i32 s59,s60,20480
s_add_u32 s59,s59,s6
s_lshl_b32 s69,s53,9
s_add_u32 s69,s69,s7
s_bfe_u32 s31,s54,65537
s_add_u32 s32,s54,1
s_cmp_lg_u32 s53,s51
s_cbranch_scc1 nx_152
s_waitcnt vmcnt(0)
s_cmp_ge_u32 s79,2147483648
s_cbranch_scc1 pf_153
v_mov_b32 v17,1
s_mov_b64 exec,1
buffer_store_dword v17,v1,s[8:11],s79 offen sc1
s_mov_b64 exec,-1
s_mov_b32 s79,2147483648
pf_153:
s_cmp_eq_u32 s78,2147483648
s_cbranch_scc1 pk_154
buffer_store_dwordx4 v[102:105],v6,s[8:11],s78 offen sc1
buffer_store_dwordx2 v[100:101],v7,s[8:11],s78 offen sc1
s_mov_b32 s79,s30
s_mov_b32 s78,2147483648
pk_154:
s_waitcnt vmcnt(0)
s_cmp_ge_u32 s79,2147483648
s_cbranch_scc1 pf_155
v_mov_b32 v17,1
s_mov_b64 exec,1
buffer_store_dword v17,v1,s[8:11],s79 offen sc1
s_mov_b64 exec,-1
s_mov_b32 s79,2147483648
pf_155:
nx_152:
s_add_u32 s50,s50,1
s_mov_b32 s51,s53
s_mov_b32 s52,s54
s_mov_b32 s57,s31
s_mov_b32 s58,s32
s_cmp_lt_u32 s50,128
s_cbranch_scc1 CV_LOOP_S1
s_branch CV_DONE
fr_150:
v_bitop3_b32 v12,v60,v64,s57 bitop3:0x7e
v_bitop3_b32 v13,v68,v68,s57 bitop3:0x7e
v_xor_b32 v14,s57,v68
v_or3_b32 v12,v12,v13,v14
v_and_b32 v12,1,v12
v_cmp_ne_u32 vcc,0,v12
s_cbranch_vccz sk_156
buffer_load_dwordx2 v[68:69],v18,s[8:11],s59 offen sc1
buffer_load_dwordx4 v[60:63],v1,s[8:11],s59 offen sc1
buffer_load_dwordx4 v[64:67],v1,s[8:11],s59 offen offset:1024 sc1
sk_156:
buffer_load_dwordx2 v[78:79],v18,s[8:11],s68 offen sc1
buffer_load_dwordx4 v[70:73],v1,s[8:11],s68 offen sc1
buffer_load_dwordx4 v[74:77],v1,s[8:11],s68 offen offset:1024 sc1
s_sub_u32 s47,s47,1
s_cbranch_scc1 ABORT
s_waitcnt lgkmcnt(0)
s_branch fa_149
CV_DONE:
s_add_u32 s61,s48,32
s_endpgm
ROLE_CW:
s_lshr_b32 s28,s48,3
s_and_b32 s29,s48,7
s_mul_i32 s82,s28,2097152
s_add_u32 s82,s82,2097152
v_lshlrev_b32 v1,4,v0
v_and_b32 v12,1,v0
v_mul_u32_u24 v2,0xaaaa,v12
v_or_b32 v2,0x4444,v2
v_lshrrev_b32 v14,4,v0
v_and_b32 v15,15,v0
v_min_u32 v3,11,v15
v_lshlrev_b32 v3,2,v3
v_lshl_add_u32 v3,v14,7,v3
s_mul_i32 s60,s46,24576
v_add_u32 v4,s60,v1
v_mul_u32_u24 v5,704,v14
v_and_b32 v12,3,v15
v_lshl_add_u32 v5,v12,2,v5
v_bfe_u32 v12,v15,2,1
v_lshl_add_u32 v5,v12,5,v5
v_bfe_u32 v12,v15,3,1
v_lshl_add_u32 v5,v12,4,v5
s_mul_i32 s60,s46,2816
s_add_u32 s60,s60,98304
v_add_u32 v5,s60,v5
s_mul_i32 s60,s46,24
s_min_u32 s60,s60,64
s_cmp_lt_u32 s46,2
s_cselect_b32 s61,23,15
s_mov_b32 s88,0xffff
s_cselect_b32 s88,0xffffff,s88
s_mov_b32 s89,0
v_and_b32 v12,31,v0
v_min_u32 v12,s61,v12
v_add_u32 v12,s60,v12
v_lshrrev_b32 v13,5,v0
v_lshl_add_u32 v12,v12,1,v13
v_bfe_u32 v13,v12,2,3
v_mul_u32_u24 v6,352,v13
v_mul_u32_u24 v17,1280,v13
v_lshrrev_b32 v13,5,v12
v_lshl_add_u32 v6,v13,6,v6
v_lshl_add_u32 v17,v13,5,v17
v_and_b32 v13,3,v12
v_lshl_add_u32 v17,v13,3,v17
v_and_b32 v13,1,v12
v_lshl_add_u32 v6,v13,5,v6
v_bfe_u32 v13,v12,1,1
v_lshl_add_u32 v6,v13,4,v6
v_add_u32 v6,98304,v6
s_mul_i32 s60,s29,1280
v_lshlrev_b32 v9,3,v12
v_add_u32 v9,s60,v9
v_lshrrev_b32 v13,13,v9
v_lshl_add_u32 v9,v13,13,v9
v_xor_b32 v10,1,v12
v_or_b32 v10,v10,v13
v_and_b32 v10,1,v10
s_mov_b32 s4,s18
s_mov_b32 s5,s19
s_mov_b32 s6,10240
s_mov_b32 s7,0x20000
s_mul_i32 s60,s29,160
buffer_load_dwordx2 v[32:33],v17,s[4:7],s60 offen
s_mul_i32 s84,s29,0
s_add_u32 s84,s84,s82
s_lshl_b32 s83,s28,19
s_lshr_b32 s60,s29,1
s_and_b32 s61,s29,1
s_mul_i32 s62,s61,0
s_add_u32 s83,s83,s62
s_add_u32 s83,s83,10485760
s_lshl_b32 s85,s60,7
s_lshl_b32 s61,s61,2
s_add_u32 s61,s61,s46
s_lshl_b32 s61,s61,2
s_add_u32 s85,s85,s61
s_add_u32 s85,s85,s82
s_add_u32 s85,s85,950272
s_mul_i32 s33,s46,12288
s_add_u32 s33,s33,s82
s_add_u32 s33,s33,163840
s_mov_b32 s35,0
s_add_u32 s35,s35,s82
s_add_u32 s35,s35,951296
s_cmp_eq_u32 s28,0
s_cselect_b32 s63,0xffff0000,0
s_waitcnt vmcnt(0)
s_cselect_b64 vcc,-1,0
v_bfi_b32 v36,v10,0,v32
v_lshlrev_b32 v34,16,v32
v_lshlrev_b32 v35,16,v36
v_sub_f32 v34,v34,v35
v_lshrrev_b32 v34,16,v34
v_and_b32 v34,-2,v34
v_cndmask_b32 v36,v34,v36,vcc
v_cndmask_b32 v37,0,v33,vcc
s_nop 0
v_permlane32_swap_b32 v36,v38
v_permlane32_swap_b32 v37,v39
v_mov_b32 v40,-1
v_mov_b32 v41,-1
v_mov_b32 v42,-1
v_mov_b32 v43,-1
v_mov_b32 v44,1
s_mov_b64 exec,s[88:89]
s_add_u32 s60,s83,0
buffer_store_dwordx4 v[36:39],v9,s[8:11],s60 offen sc1
s_add_u32 s60,s83,8192
buffer_store_dwordx4 v[36:39],v9,s[8:11],s60 offen sc1
s_add_u32 s60,s83,65536
buffer_store_dwordx4 v[40:43],v9,s[8:11],s60 offen sc1
s_add_u32 s60,s83,73728
buffer_store_dwordx4 v[40:43],v9,s[8:11],s60 offen sc1
s_add_u32 s60,s83,131072
buffer_store_dwordx4 v[40:43],v9,s[8:11],s60 offen sc1
s_add_u32 s60,s83,139264
buffer_store_dwordx4 v[40:43],v9,s[8:11],s60 offen sc1
s_add_u32 s60,s83,196608
buffer_store_dwordx4 v[40:43],v9,s[8:11],s60 offen sc1
s_add_u32 s60,s83,204800
buffer_store_dwordx4 v[40:43],v9,s[8:11],s60 offen sc1
s_add_u32 s60,s83,262144
buffer_store_dwordx4 v[36:39],v9,s[8:11],s60 offen sc1
s_add_u32 s60,s83,270336
buffer_store_dwordx4 v[36:39],v9,s[8:11],s60 offen sc1
s_add_u32 s60,s83,327680
buffer_store_dwordx4 v[40:43],v9,s[8:11],s60 offen sc1
s_add_u32 s60,s83,335872
buffer_store_dwordx4 v[40:43],v9,s[8:11],s60 offen sc1
s_add_u32 s60,s83,393216
buffer_store_dwordx4 v[40:43],v9,s[8:11],s60 offen sc1
s_add_u32 s60,s83,401408
buffer_store_dwordx4 v[40:43],v9,s[8:11],s60 offen sc1
s_add_u32 s60,s83,458752
buffer_store_dwordx4 v[40:43],v9,s[8:11],s60 offen sc1
s_add_u32 s60,s83,466944
buffer_store_dwordx4 v[40:43],v9,s[8:11],s60 offen sc1
s_cmp_lg_u32 s49,0
s_cbranch_scc1 ls_157
s_add_u32 s60,s84,0
buffer_store_dwordx4 v[36:39],v9,s[8:11],s60 offen
s_add_u32 s60,s84,20480
buffer_store_dwordx4 v[40:43],v9,s[8:11],s60 offen
s_add_u32 s60,s84,40960
buffer_store_dwordx4 v[40:43],v9,s[8:11],s60 offen
s_add_u32 s60,s84,61440
buffer_store_dwordx4 v[40:43],v9,s[8:11],s60 offen
s_add_u32 s60,s84,81920
buffer_store_dwordx4 v[36:39],v9,s[8:11],s60 offen
s_add_u32 s60,s84,102400
buffer_store_dwordx4 v[40:43],v9,s[8:11],s60 offen
s_add_u32 s60,s84,122880
buffer_store_dwordx4 v[40:43],v9,s[8:11],s60 offen
s_add_u32 s60,s84,143360
buffer_store_dwordx4 v[40:43],v9,s[8:11],s60 offen
s_mov_b64 exec,1
buffer_store_dword v44,v1,s[8:11],s85 offen
buffer_store_dword v44,v1,s[8:11],s85 offen offset:512
s_branch ls_158
ls_157:
s_add_u32 s60,s84,0
buffer_store_dwordx4 v[36:39],v9,s[8:11],s60 offen sc1
s_add_u32 s60,s84,20480
buffer_store_dwordx4 v[40:43],v9,s[8:11],s60 offen sc1
s_add_u32 s60,s84,40960
buffer_store_dwordx4 v[40:43],v9,s[8:11],s60 offen sc1
s_add_u32 s60,s84,61440
buffer_store_dwordx4 v[40:43],v9,s[8:11],s60 offen sc1
s_add_u32 s60,s84,81920
buffer_store_dwordx4 v[36:39],v9,s[8:11],s60 offen sc1
s_add_u32 s60,s84,102400
buffer_store_dwordx4 v[40:43],v9,s[8:11],s60 offen sc1
s_add_u32 s60,s84,122880
buffer_store_dwordx4 v[40:43],v9,s[8:11],s60 offen sc1
s_add_u32 s60,s84,143360
buffer_store_dwordx4 v[40:43],v9,s[8:11],s60 offen sc1
s_mov_b64 exec,1
buffer_store_dword v44,v1,s[8:11],s85 offen sc1
buffer_store_dword v44,v1,s[8:11],s85 offen offset:512 sc1
ls_158:
s_mov_b64 exec,-1
s_waitcnt vmcnt(0)
s_barrier
s_cmp_lg_u32 s46,0
s_cbranch_scc1 arr_159
v_mov_b32 v12,1
s_lshl_b32 s3,s49,2
v_mov_b32 v13,s3
s_mov_b64 exec,1
buffer_atomic_add v12,v13,s[12:15],0 offen sc1
s_mov_b64 exec,-1
arr_159:
s_mov_b32 s4,s26
s_mov_b32 s5,s27
s_mov_b32 s6,7864320
s_mov_b32 s7,0x20000
s_lshl_b32 s60,s28,2
s_add_u32 s60,s60,s46
s_mul_i32 s73,s60,983040
s_mul_i32 s60,s29,160
s_add_u32 s73,s73,s60
s_mul_i32 s74,s46,40960
v_add_u32 v12,0,v0
v_mul_u32_u24 v13,6554,v12
v_lshrrev_b32 v13,16,v13
v_mul_u32_u24 v16,10,v13
v_sub_u32 v12,v12,v16
v_mul_u32_u24 v20,1280,v13
v_lshl_add_u32 v20,v12,4,v20
v_add_u32 v12,64,v0
v_mul_u32_u24 v13,6554,v12
v_lshrrev_b32 v13,16,v13
v_mul_u32_u24 v16,10,v13
v_sub_u32 v12,v12,v16
v_mul_u32_u24 v21,1280,v13
v_lshl_add_u32 v21,v12,4,v21
v_add_u32 v12,128,v0
v_mul_u32_u24 v13,6554,v12
v_lshrrev_b32 v13,16,v13
v_mul_u32_u24 v16,10,v13
v_sub_u32 v12,v12,v16
v_mul_u32_u24 v22,1280,v13
v_lshl_add_u32 v22,v12,4,v22
v_add_u32 v12,192,v0
v_mul_u32_u24 v13,6554,v12
v_lshrrev_b32 v13,16,v13
v_mul_u32_u24 v16,10,v13
v_sub_u32 v12,v12,v16
v_mul_u32_u24 v23,1280,v13
v_lshl_add_u32 v23,v12,4,v23
v_add_u32 v12,256,v0
v_mul_u32_u24 v13,6554,v12
v_lshrrev_b32 v13,16,v13
v_mul_u32_u24 v16,10,v13
v_sub_u32 v12,v12,v16
v_mul_u32_u24 v24,1280,v13
v_lshl_add_u32 v24,v12,4,v24
v_add_u32 v12,320,v0
v_mul_u32_u24 v13,6554,v12
v_lshrrev_b32 v13,16,v13
v_mul_u32_u24 v16,10,v13
v_sub_u32 v12,v12,v16
v_mul_u32_u24 v25,1280,v13
v_lshl_add_u32 v25,v12,4,v25
v_add_u32 v12,384,v0
v_mul_u32_u24 v13,6554,v12
v_lshrrev_b32 v13,16,v13
v_mul_u32_u24 v16,10,v13
v_sub_u32 v12,v12,v16
v_mul_u32_u24 v26,1280,v13
v_lshl_add_u32 v26,v12,4,v26
v_add_u32 v12,448,v0
v_mul_u32_u24 v13,6554,v12
v_lshrrev_b32 v13,16,v13
v_mul_u32_u24 v16,10,v13
v_sub_u32 v12,v12,v16
v_mul_u32_u24 v27,1280,v13
v_lshl_add_u32 v27,v12,4,v27
v_add_u32 v12,512,v0
v_mul_u32_u24 v13,6554,v12
v_lshrrev_b32 v13,16,v13
v_mul_u32_u24 v16,10,v13
v_sub_u32 v12,v12,v16
v_mul_u32_u24 v28,1280,v13
v_lshl_add_u32 v28,v12,4,v28
v_add_u32 v12,576,v0
v_mul_u32_u24 v13,6554,v12
v_lshrrev_b32 v13,16,v13
v_mul_u32_u24 v16,10,v13
v_sub_u32 v12,v12,v16
v_mul_u32_u24 v29,1280,v13
v_lshl_add_u32 v29,v12,4,v29
v_lshrrev_b32 v14,4,v0
v_and_b32 v12,1,v14
v_lshlrev_b32 v12,5,v12
v_lshrrev_b32 v13,1,v14
v_lshl_add_u32 v12,v13,2,v12
v_bfe_u32 v13,v0,2,1
v_add_u32 v12,v12,v13
v_bfe_u32 v13,v0,3,1
v_lshl_add_u32 v12,v13,4,v12
v_mul_u32_u24 v30,160,v12
v_and_b32 v13,3,v0
v_lshl_add_u32 v30,v13,3,v30
v_add_u32 v30,s74,v30
s_add_u32 s61,s73,0
s_add_u32 m0,s74,0
s_nop 0
buffer_load_dwordx4 v20,s[4:7],s61 offen lds
s_add_u32 m0,s74,1024
s_nop 0
buffer_load_dwordx4 v21,s[4:7],s61 offen lds
s_add_u32 m0,s74,2048
s_nop 0
buffer_load_dwordx4 v22,s[4:7],s61 offen lds
s_add_u32 m0,s74,3072
s_nop 0
buffer_load_dwordx4 v23,s[4:7],s61 offen lds
s_add_u32 m0,s74,4096
s_nop 0
buffer_load_dwordx4 v24,s[4:7],s61 offen lds
s_add_u32 m0,s74,5120
s_nop 0
buffer_load_dwordx4 v25,s[4:7],s61 offen lds
s_add_u32 m0,s74,6144
s_nop 0
buffer_load_dwordx4 v26,s[4:7],s61 offen lds
s_add_u32 m0,s74,7168
s_nop 0
buffer_load_dwordx4 v27,s[4:7],s61 offen lds
s_add_u32 m0,s74,8192
s_nop 0
buffer_load_dwordx4 v28,s[4:7],s61 offen lds
s_add_u32 m0,s74,9216
s_nop 0
buffer_load_dwordx4 v29,s[4:7],s61 offen lds
s_add_u32 s61,s73,81920
s_add_u32 m0,s74,10240
s_nop 0
buffer_load_dwordx4 v20,s[4:7],s61 offen lds
s_add_u32 m0,s74,11264
s_nop 0
buffer_load_dwordx4 v21,s[4:7],s61 offen lds
s_add_u32 m0,s74,12288
s_nop 0
buffer_load_dwordx4 v22,s[4:7],s61 offen lds
s_add_u32 m0,s74,13312
s_nop 0
buffer_load_dwordx4 v23,s[4:7],s61 offen lds
s_add_u32 m0,s74,14336
s_nop 0
buffer_load_dwordx4 v24,s[4:7],s61 offen lds
s_add_u32 m0,s74,15360
s_nop 0
buffer_load_dwordx4 v25,s[4:7],s61 offen lds
s_add_u32 m0,s74,16384
s_nop 0
buffer_load_dwordx4 v26,s[4:7],s61 offen lds
s_add_u32 m0,s74,17408
s_nop 0
buffer_load_dwordx4 v27,s[4:7],s61 offen lds
s_add_u32 m0,s74,18432
s_nop 0
buffer_load_dwordx4 v28,s[4:7],s61 offen lds
s_add_u32 m0,s74,19456
s_nop 0
buffer_load_dwordx4 v29,s[4:7],s61 offen lds
s_add_u32 s61,s73,163840
s_add_u32 m0,s74,20480
s_nop 0
buffer_load_dwordx4 v20,s[4:7],s61 offen lds
s_add_u32 m0,s74,21504
s_nop 0
buffer_load_dwordx4 v21,s[4:7],s61 offen lds
s_add_u32 m0,s74,22528
s_nop 0
buffer_load_dwordx4 v22,s[4:7],s61 offen lds
s_add_u32 m0,s74,23552
s_nop 0
buffer_load_dwordx4 v23,s[4:7],s61 offen lds
s_add_u32 m0,s74,24576
s_nop 0
buffer_load_dwordx4 v24,s[4:7],s61 offen lds
s_add_u32 m0,s74,25600
s_nop 0
buffer_load_dwordx4 v25,s[4:7],s61 offen lds
s_add_u32 m0,s74,26624
s_nop 0
buffer_load_dwordx4 v26,s[4:7],s61 offen lds
s_add_u32 m0,s74,27648
s_nop 0
buffer_load_dwordx4 v27,s[4:7],s61 offen lds
s_add_u32 m0,s74,28672
s_nop 0
buffer_load_dwordx4 v28,s[4:7],s61 offen lds
s_add_u32 m0,s74,29696
s_nop 0
buffer_load_dwordx4 v29,s[4:7],s61 offen lds
s_add_u32 s61,s73,245760
s_add_u32 m0,s74,30720
s_nop 0
buffer_load_dwordx4 v20,s[4:7],s61 offen lds
s_add_u32 m0,s74,31744
s_nop 0
buffer_load_dwordx4 v21,s[4:7],s61 offen lds
s_add_u32 m0,s74,32768
s_nop 0
buffer_load_dwordx4 v22,s[4:7],s61 offen lds
s_add_u32 m0,s74,33792
s_nop 0
buffer_load_dwordx4 v23,s[4:7],s61 offen lds
s_add_u32 m0,s74,34816
s_nop 0
buffer_load_dwordx4 v24,s[4:7],s61 offen lds
s_add_u32 m0,s74,35840
s_nop 0
buffer_load_dwordx4 v25,s[4:7],s61 offen lds
s_add_u32 m0,s74,36864
s_nop 0
buffer_load_dwordx4 v26,s[4:7],s61 offen lds
s_add_u32 m0,s74,37888
s_nop 0
buffer_load_dwordx4 v27,s[4:7],s61 offen lds
s_add_u32 m0,s74,38912
s_nop 0
buffer_load_dwordx4 v28,s[4:7],s61 offen lds
s_add_u32 m0,s74,39936
s_nop 0
buffer_load_dwordx4 v29,s[4:7],s61 offen lds
s_waitcnt vmcnt(30)
ds_read_b64_tr_b16 a[0:1],v30 offset:0
ds_read_b64_tr_b16 a[2:3],v30 offset:320
ds_read_b64_tr_b16 a[4:5],v30 offset:1280
ds_read_b64_tr_b16 a[6:7],v30 offset:1600
ds_read_b64_tr_b16 a[8:9],v30 offset:32
ds_read_b64_tr_b16 a[10:11],v30 offset:352
ds_read_b64_tr_b16 a[12:13],v30 offset:1312
ds_read_b64_tr_b16 a[14:15],v30 offset:1632
ds_read_b64_tr_b16 a[16:17],v30 offset:64
ds_read_b64_tr_b16 a[18:19],v30 offset:384
ds_read_b64_tr_b16 a[20:21],v30 offset:1344
ds_read_b64_tr_b16 a[22:23],v30 offset:1664
s_waitcnt lgkmcnt(4)
ds_read_b64_tr_b16 a[24:25],v30 offset:96
ds_read_b64_tr_b16 a[26:27],v30 offset:416
ds_read_b64_tr_b16 a[28:29],v30 offset:1376
ds_read_b64_tr_b16 a[30:31],v30 offset:1696
ds_read_b64_tr_b16 v[32:33],v30 offset:128
ds_read_b64_tr_b16 v[34:35],v30 offset:448
ds_read_b64_tr_b16 v[36:37],v30 offset:1408
ds_read_b64_tr_b16 v[38:39],v30 offset:1728
s_waitcnt lgkmcnt(0)
s_add_u32 s61,s73,327680
s_add_u32 m0,s74,0
s_nop 0
buffer_load_dwordx4 v20,s[4:7],s61 offen lds
s_add_u32 m0,s74,1024
s_nop 0
buffer_load_dwordx4 v21,s[4:7],s61 offen lds
s_add_u32 m0,s74,2048
s_nop 0
buffer_load_dwordx4 v22,s[4:7],s61 offen lds
s_add_u32 m0,s74,3072
s_nop 0
buffer_load_dwordx4 v23,s[4:7],s61 offen lds
s_add_u32 m0,s74,4096
s_nop 0
buffer_load_dwordx4 v24,s[4:7],s61 offen lds
s_add_u32 m0,s74,5120
s_nop 0
buffer_load_dwordx4 v25,s[4:7],s61 offen lds
s_add_u32 m0,s74,6144
s_nop 0
buffer_load_dwordx4 v26,s[4:7],s61 offen lds
s_add_u32 m0,s74,7168
s_nop 0
buffer_load_dwordx4 v27,s[4:7],s61 offen lds
s_add_u32 m0,s74,8192
s_nop 0
buffer_load_dwordx4 v28,s[4:7],s61 offen lds
s_add_u32 m0,s74,9216
s_nop 0
buffer_load_dwordx4 v29,s[4:7],s61 offen lds
s_waitcnt vmcnt(30)
ds_read_b64_tr_b16 a[32:33],v30 offset:10240
ds_read_b64_tr_b16 a[34:35],v30 offset:10560
ds_read_b64_tr_b16 a[36:37],v30 offset:11520
ds_read_b64_tr_b16 a[38:39],v30 offset:11840
ds_read_b64_tr_b16 a[40:41],v30 offset:10272
ds_read_b64_tr_b16 a[42:43],v30 offset:10592
ds_read_b64_tr_b16 a[44:45],v30 offset:11552
ds_read_b64_tr_b16 a[46:47],v30 offset:11872
ds_read_b64_tr_b16 a[48:49],v30 offset:10304
ds_read_b64_tr_b16 a[50:51],v30 offset:10624
ds_read_b64_tr_b16 a[52:53],v30 offset:11584
ds_read_b64_tr_b16 a[54:55],v30 offset:11904
s_waitcnt lgkmcnt(4)
ds_read_b64_tr_b16 a[56:57],v30 offset:10336
ds_read_b64_tr_b16 a[58:59],v30 offset:10656
ds_read_b64_tr_b16 a[60:61],v30 offset:11616
ds_read_b64_tr_b16 a[62:63],v30 offset:11936
ds_read_b64_tr_b16 v[40:41],v30 offset:10368
ds_read_b64_tr_b16 v[42:43],v30 offset:10688
ds_read_b64_tr_b16 v[44:45],v30 offset:11648
ds_read_b64_tr_b16 v[46:47],v30 offset:11968
s_waitcnt lgkmcnt(0)
s_add_u32 s61,s73,409600
s_add_u32 m0,s74,10240
s_nop 0
buffer_load_dwordx4 v20,s[4:7],s61 offen lds
s_add_u32 m0,s74,11264
s_nop 0
buffer_load_dwordx4 v21,s[4:7],s61 offen lds
s_add_u32 m0,s74,12288
s_nop 0
buffer_load_dwordx4 v22,s[4:7],s61 offen lds
s_add_u32 m0,s74,13312
s_nop 0
buffer_load_dwordx4 v23,s[4:7],s61 offen lds
s_add_u32 m0,s74,14336
s_nop 0
buffer_load_dwordx4 v24,s[4:7],s61 offen lds
s_add_u32 m0,s74,15360
s_nop 0
buffer_load_dwordx4 v25,s[4:7],s61 offen lds
s_add_u32 m0,s74,16384
s_nop 0
buffer_load_dwordx4 v26,s[4:7],s61 offen lds
s_add_u32 m0,s74,17408
s_nop 0
buffer_load_dwordx4 v27,s[4:7],s61 offen lds
s_add_u32 m0,s74,18432
s_nop 0
buffer_load_dwordx4 v28,s[4:7],s61 offen lds
s_add_u32 m0,s74,19456
s_nop 0
buffer_load_dwordx4 v29,s[4:7],s61 offen lds
s_waitcnt vmcnt(30)
ds_read_b64_tr_b16 a[64:65],v30 offset:20480
ds_read_b64_tr_b16 a[66:67],v30 offset:20800
ds_read_b64_tr_b16 a[68:69],v30 offset:21760
ds_read_b64_tr_b16 a[70:71],v30 offset:22080
ds_read_b64_tr_b16 a[72:73],v30 offset:20512
ds_read_b64_tr_b16 a[74:75],v30 offset:20832
ds_read_b64_tr_b16 a[76:77],v30 offset:21792
ds_read_b64_tr_b16 a[78:79],v30 offset:22112
ds_read_b64_tr_b16 a[80:81],v30 offset:20544
ds_read_b64_tr_b16 a[82:83],v30 offset:20864
ds_read_b64_tr_b16 a[84:85],v30 offset:21824
ds_read_b64_tr_b16 a[86:87],v30 offset:22144
s_waitcnt lgkmcnt(4)
ds_read_b64_tr_b16 a[88:89],v30 offset:20576
ds_read_b64_tr_b16 a[90:91],v30 offset:20896
ds_read_b64_tr_b16 a[92:93],v30 offset:21856
ds_read_b64_tr_b16 a[94:95],v30 offset:22176
ds_read_b64_tr_b16 v[48:49],v30 offset:20608
ds_read_b64_tr_b16 v[50:51],v30 offset:20928
ds_read_b64_tr_b16 v[52:53],v30 offset:21888
ds_read_b64_tr_b16 v[54:55],v30 offset:22208
s_waitcnt lgkmcnt(0)
s_add_u32 s61,s73,491520
s_add_u32 m0,s74,20480
s_nop 0
buffer_load_dwordx4 v20,s[4:7],s61 offen lds
s_add_u32 m0,s74,21504
s_nop 0
buffer_load_dwordx4 v21,s[4:7],s61 offen lds
s_add_u32 m0,s74,22528
s_nop 0
buffer_load_dwordx4 v22,s[4:7],s61 offen lds
s_add_u32 m0,s74,23552
s_nop 0
buffer_load_dwordx4 v23,s[4:7],s61 offen lds
s_add_u32 m0,s74,24576
s_nop 0
buffer_load_dwordx4 v24,s[4:7],s61 offen lds
s_add_u32 m0,s74,25600
s_nop 0
buffer_load_dwordx4 v25,s[4:7],s61 offen lds
s_add_u32 m0,s74,26624
s_nop 0
buffer_load_dwordx4 v26,s[4:7],s61 offen lds
s_add_u32 m0,s74,27648
s_nop 0
buffer_load_dwordx4 v27,s[4:7],s61 offen lds
s_add_u32 m0,s74,28672
s_nop 0
buffer_load_dwordx4 v28,s[4:7],s61 offen lds
s_add_u32 m0,s74,29696
s_nop 0
buffer_load_dwordx4 v29,s[4:7],s61 offen lds
s_waitcnt vmcnt(30)
ds_read_b64_tr_b16 a[96:97],v30 offset:30720
ds_read_b64_tr_b16 a[98:99],v30 offset:31040
ds_read_b64_tr_b16 a[100:101],v30 offset:32000
ds_read_b64_tr_b16 a[102:103],v30 offset:32320
ds_read_b64_tr_b16 a[104:105],v30 offset:30752
ds_read_b64_tr_b16 a[106:107],v30 offset:31072
ds_read_b64_tr_b16 a[108:109],v30 offset:32032
ds_read_b64_tr_b16 a[110:111],v30 offset:32352
ds_read_b64_tr_b16 a[112:113],v30 offset:30784
ds_read_b64_tr_b16 a[114:115],v30 offset:31104
ds_read_b64_tr_b16 a[116:117],v30 offset:32064
ds_read_b64_tr_b16 a[118:119],v30 offset:32384
s_waitcnt lgkmcnt(4)
ds_read_b64_tr_b16 a[120:121],v30 offset:30816
ds_read_b64_tr_b16 a[122:123],v30 offset:31136
ds_read_b64_tr_b16 a[124:125],v30 offset:32096
ds_read_b64_tr_b16 a[126:127],v30 offset:32416
ds_read_b64_tr_b16 v[56:57],v30 offset:30848
ds_read_b64_tr_b16 v[58:59],v30 offset:31168
ds_read_b64_tr_b16 v[60:61],v30 offset:32128
ds_read_b64_tr_b16 v[62:63],v30 offset:32448
s_waitcnt lgkmcnt(0)
s_add_u32 s61,s73,573440
s_add_u32 m0,s74,30720
s_nop 0
buffer_load_dwordx4 v20,s[4:7],s61 offen lds
s_add_u32 m0,s74,31744
s_nop 0
buffer_load_dwordx4 v21,s[4:7],s61 offen lds
s_add_u32 m0,s74,32768
s_nop 0
buffer_load_dwordx4 v22,s[4:7],s61 offen lds
s_add_u32 m0,s74,33792
s_nop 0
buffer_load_dwordx4 v23,s[4:7],s61 offen lds
s_add_u32 m0,s74,34816
s_nop 0
buffer_load_dwordx4 v24,s[4:7],s61 offen lds
s_add_u32 m0,s74,35840
s_nop 0
buffer_load_dwordx4 v25,s[4:7],s61 offen lds
s_add_u32 m0,s74,36864
s_nop 0
buffer_load_dwordx4 v26,s[4:7],s61 offen lds
s_add_u32 m0,s74,37888
s_nop 0
buffer_load_dwordx4 v27,s[4:7],s61 offen lds
s_add_u32 m0,s74,38912
s_nop 0
buffer_load_dwordx4 v28,s[4:7],s61 offen lds
s_add_u32 m0,s74,39936
s_nop 0
buffer_load_dwordx4 v29,s[4:7],s61 offen lds
s_waitcnt vmcnt(30)
ds_read_b64_tr_b16 a[128:129],v30 offset:0
ds_read_b64_tr_b16 a[130:131],v30 offset:320
ds_read_b64_tr_b16 a[132:133],v30 offset:1280
ds_read_b64_tr_b16 a[134:135],v30 offset:1600
ds_read_b64_tr_b16 a[136:137],v30 offset:32
ds_read_b64_tr_b16 a[138:139],v30 offset:352
ds_read_b64_tr_b16 a[140:141],v30 offset:1312
ds_read_b64_tr_b16 a[142:143],v30 offset:1632
ds_read_b64_tr_b16 a[144:145],v30 offset:64
ds_read_b64_tr_b16 a[146:147],v30 offset:384
ds_read_b64_tr_b16 a[148:149],v30 offset:1344
ds_read_b64_tr_b16 a[150:151],v30 offset:1664
s_waitcnt lgkmcnt(4)
ds_read_b64_tr_b16 a[152:153],v30 offset:96
ds_read_b64_tr_b16 a[154:155],v30 offset:416
ds_read_b64_tr_b16 a[156:157],v30 offset:1376
ds_read_b64_tr_b16 a[158:159],v30 offset:1696
ds_read_b64_tr_b16 v[64:65],v30 offset:128
ds_read_b64_tr_b16 v[66:67],v30 offset:448
ds_read_b64_tr_b16 v[68:69],v30 offset:1408
ds_read_b64_tr_b16 v[70:71],v30 offset:1728
s_waitcnt lgkmcnt(0)
s_add_u32 s61,s73,655360
s_add_u32 m0,s74,0
s_nop 0
buffer_load_dwordx4 v20,s[4:7],s61 offen lds
s_add_u32 m0,s74,1024
s_nop 0
buffer_load_dwordx4 v21,s[4:7],s61 offen lds
s_add_u32 m0,s74,2048
s_nop 0
buffer_load_dwordx4 v22,s[4:7],s61 offen lds
s_add_u32 m0,s74,3072
s_nop 0
buffer_load_dwordx4 v23,s[4:7],s61 offen lds
s_add_u32 m0,s74,4096
s_nop 0
buffer_load_dwordx4 v24,s[4:7],s61 offen lds
s_add_u32 m0,s74,5120
s_nop 0
buffer_load_dwordx4 v25,s[4:7],s61 offen lds
s_add_u32 m0,s74,6144
s_nop 0
buffer_load_dwordx4 v26,s[4:7],s61 offen lds
s_add_u32 m0,s74,7168
s_nop 0
buffer_load_dwordx4 v27,s[4:7],s61 offen lds
s_add_u32 m0,s74,8192
s_nop 0
buffer_load_dwordx4 v28,s[4:7],s61 offen lds
s_add_u32 m0,s74,9216
s_nop 0
buffer_load_dwordx4 v29,s[4:7],s61 offen lds
s_waitcnt vmcnt(30)
ds_read_b64_tr_b16 a[160:161],v30 offset:10240
ds_read_b64_tr_b16 a[162:163],v30 offset:10560
ds_read_b64_tr_b16 a[164:165],v30 offset:11520
ds_read_b64_tr_b16 a[166:167],v30 offset:11840
ds_read_b64_tr_b16 a[168:169],v30 offset:10272
ds_read_b64_tr_b16 a[170:171],v30 offset:10592
ds_read_b64_tr_b16 a[172:173],v30 offset:11552
ds_read_b64_tr_b16 a[174:175],v30 offset:11872
ds_read_b64_tr_b16 a[176:177],v30 offset:10304
ds_read_b64_tr_b16 a[178:179],v30 offset:10624
ds_read_b64_tr_b16 a[180:181],v30 offset:11584
ds_read_b64_tr_b16 a[182:183],v30 offset:11904
s_waitcnt lgkmcnt(4)
ds_read_b64_tr_b16 a[184:185],v30 offset:10336
ds_read_b64_tr_b16 a[186:187],v30 offset:10656
ds_read_b64_tr_b16 a[188:189],v30 offset:11616
ds_read_b64_tr_b16 a[190:191],v30 offset:11936
ds_read_b64_tr_b16 v[72:73],v30 offset:10368
ds_read_b64_tr_b16 v[74:75],v30 offset:10688
ds_read_b64_tr_b16 v[76:77],v30 offset:11648
ds_read_b64_tr_b16 v[78:79],v30 offset:11968
s_waitcnt lgkmcnt(0)
s_add_u32 s61,s73,737280
s_add_u32 m0,s74,10240
s_nop 0
buffer_load_dwordx4 v20,s[4:7],s61 offen lds
s_add_u32 m0,s74,11264
s_nop 0
buffer_load_dwordx4 v21,s[4:7],s61 offen lds
s_add_u32 m0,s74,12288
s_nop 0
buffer_load_dwordx4 v22,s[4:7],s61 offen lds
s_add_u32 m0,s74,13312
s_nop 0
buffer_load_dwordx4 v23,s[4:7],s61 offen lds
s_add_u32 m0,s74,14336
s_nop 0
buffer_load_dwordx4 v24,s[4:7],s61 offen lds
s_add_u32 m0,s74,15360
s_nop 0
buffer_load_dwordx4 v25,s[4:7],s61 offen lds
s_add_u32 m0,s74,16384
s_nop 0
buffer_load_dwordx4 v26,s[4:7],s61 offen lds
s_add_u32 m0,s74,17408
s_nop 0
buffer_load_dwordx4 v27,s[4:7],s61 offen lds
s_add_u32 m0,s74,18432
s_nop 0
buffer_load_dwordx4 v28,s[4:7],s61 offen lds
s_add_u32 m0,s74,19456
s_nop 0
buffer_load_dwordx4 v29,s[4:7],s61 offen lds
s_waitcnt vmcnt(30)
ds_read_b64_tr_b16 a[192:193],v30 offset:20480
ds_read_b64_tr_b16 a[194:195],v30 offset:20800
ds_read_b64_tr_b16 a[196:197],v30 offset:21760
ds_read_b64_tr_b16 a[198:199],v30 offset:22080
ds_read_b64_tr_b16 a[200:201],v30 offset:20512
ds_read_b64_tr_b16 a[202:203],v30 offset:20832
ds_read_b64_tr_b16 a[204:205],v30 offset:21792
ds_read_b64_tr_b16 a[206:207],v30 offset:22112
ds_read_b64_tr_b16 a[208:209],v30 offset:20544
ds_read_b64_tr_b16 a[210:211],v30 offset:20864
ds_read_b64_tr_b16 a[212:213],v30 offset:21824
ds_read_b64_tr_b16 a[214:215],v30 offset:22144
s_waitcnt lgkmcnt(4)
ds_read_b64_tr_b16 a[216:217],v30 offset:20576
ds_read_b64_tr_b16 a[218:219],v30 offset:20896
ds_read_b64_tr_b16 a[220:221],v30 offset:21856
ds_read_b64_tr_b16 a[222:223],v30 offset:22176
ds_read_b64_tr_b16 v[80:81],v30 offset:20608
ds_read_b64_tr_b16 v[82:83],v30 offset:20928
ds_read_b64_tr_b16 v[84:85],v30 offset:21888
ds_read_b64_tr_b16 v[86:87],v30 offset:22208
s_waitcnt lgkmcnt(0)
s_add_u32 s61,s73,819200
s_add_u32 m0,s74,20480
s_nop 0
buffer_load_dwordx4 v20,s[4:7],s61 offen lds
s_add_u32 m0,s74,21504
s_nop 0
buffer_load_dwordx4 v21,s[4:7],s61 offen lds
s_add_u32 m0,s74,22528
s_nop 0
buffer_load_dwordx4 v22,s[4:7],s61 offen lds
s_add_u32 m0,s74,23552
s_nop 0
buffer_load_dwordx4 v23,s[4:7],s61 offen lds
s_add_u32 m0,s74,24576
s_nop 0
buffer_load_dwordx4 v24,s[4:7],s61 offen lds
s_add_u32 m0,s74,25600
s_nop 0
buffer_load_dwordx4 v25,s[4:7],s61 offen lds
s_add_u32 m0,s74,26624
s_nop 0
buffer_load_dwordx4 v26,s[4:7],s61 offen lds
s_add_u32 m0,s74,27648
s_nop 0
buffer_load_dwordx4 v27,s[4:7],s61 offen lds
s_add_u32 m0,s74,28672
s_nop 0
buffer_load_dwordx4 v28,s[4:7],s61 offen lds
s_add_u32 m0,s74,29696
s_nop 0
buffer_load_dwordx4 v29,s[4:7],s61 offen lds
s_waitcnt vmcnt(30)
ds_read_b64_tr_b16 a[224:225],v30 offset:30720
ds_read_b64_tr_b16 a[226:227],v30 offset:31040
ds_read_b64_tr_b16 a[228:229],v30 offset:32000
ds_read_b64_tr_b16 a[230:231],v30 offset:32320
ds_read_b64_tr_b16 a[232:233],v30 offset:30752
ds_read_b64_tr_b16 a[234:235],v30 offset:31072
ds_read_b64_tr_b16 a[236:237],v30 offset:32032
ds_read_b64_tr_b16 a[238:239],v30 offset:32352
ds_read_b64_tr_b16 a[240:241],v30 offset:30784
ds_read_b64_tr_b16 a[242:243],v30 offset:31104
ds_read_b64_tr_b16 a[244:245],v30 offset:32064
ds_read_b64_tr_b16 a[246:247],v30 offset:32384
s_waitcnt lgkmcnt(4)
ds_read_b64_tr_b16 a[248:249],v30 offset:30816
ds_read_b64_tr_b16 a[250:251],v30 offset:31136
ds_read_b64_tr_b16 a[252:253],v30 offset:32096
ds_read_b64_tr_b16 a[254:255],v30 offset:32416
ds_read_b64_tr_b16 v[88:89],v30 offset:30848
ds_read_b64_tr_b16 v[90:91],v30 offset:31168
ds_read_b64_tr_b16 v[92:93],v30 offset:32128
ds_read_b64_tr_b16 v[94:95],v30 offset:32448
s_waitcnt lgkmcnt(0)
s_add_u32 s61,s73,901120
s_add_u32 m0,s74,30720
s_nop 0
buffer_load_dwordx4 v20,s[4:7],s61 offen lds
s_add_u32 m0,s74,31744
s_nop 0
buffer_load_dwordx4 v21,s[4:7],s61 offen lds
s_add_u32 m0,s74,32768
s_nop 0
buffer_load_dwordx4 v22,s[4:7],s61 offen lds
s_add_u32 m0,s74,33792
s_nop 0
buffer_load_dwordx4 v23,s[4:7],s61 offen lds
s_add_u32 m0,s74,34816
s_nop 0
buffer_load_dwordx4 v24,s[4:7],s61 offen lds
s_add_u32 m0,s74,35840
s_nop 0
buffer_load_dwordx4 v25,s[4:7],s61 offen lds
s_add_u32 m0,s74,36864
s_nop 0
buffer_load_dwordx4 v26,s[4:7],s61 offen lds
s_add_u32 m0,s74,37888
s_nop 0
buffer_load_dwordx4 v27,s[4:7],s61 offen lds
s_add_u32 m0,s74,38912
s_nop 0
buffer_load_dwordx4 v28,s[4:7],s61 offen lds
s_add_u32 m0,s74,39936
s_nop 0
buffer_load_dwordx4 v29,s[4:7],s61 offen lds
s_waitcnt vmcnt(30)
ds_read_b64_tr_b16 v[128:129],v30 offset:0
ds_read_b64_tr_b16 v[130:131],v30 offset:320
ds_read_b64_tr_b16 v[132:133],v30 offset:1280
ds_read_b64_tr_b16 v[134:135],v30 offset:1600
ds_read_b64_tr_b16 v[136:137],v30 offset:32
ds_read_b64_tr_b16 v[138:139],v30 offset:352
ds_read_b64_tr_b16 v[140:141],v30 offset:1312
ds_read_b64_tr_b16 v[142:143],v30 offset:1632
ds_read_b64_tr_b16 v[144:145],v30 offset:64
ds_read_b64_tr_b16 v[146:147],v30 offset:384
ds_read_b64_tr_b16 v[148:149],v30 offset:1344
ds_read_b64_tr_b16 v[150:151],v30 offset:1664
s_waitcnt lgkmcnt(4)
ds_read_b64_tr_b16 v[152:153],v30 offset:96
ds_read_b64_tr_b16 v[154:155],v30 offset:416
ds_read_b64_tr_b16 v[156:157],v30 offset:1376
ds_read_b64_tr_b16 v[158:159],v30 offset:1696
ds_read_b64_tr_b16 v[96:97],v30 offset:128
ds_read_b64_tr_b16 v[98:99],v30 offset:448
ds_read_b64_tr_b16 v[100:101],v30 offset:1408
ds_read_b64_tr_b16 v[102:103],v30 offset:1728
s_waitcnt lgkmcnt(0)
s_waitcnt vmcnt(20)
ds_read_b64_tr_b16 v[160:161],v30 offset:10240
ds_read_b64_tr_b16 v[162:163],v30 offset:10560
ds_read_b64_tr_b16 v[164:165],v30 offset:11520
ds_read_b64_tr_b16 v[166:167],v30 offset:11840
ds_read_b64_tr_b16 v[168:169],v30 offset:10272
ds_read_b64_tr_b16 v[170:171],v30 offset:10592
ds_read_b64_tr_b16 v[172:173],v30 offset:11552
ds_read_b64_tr_b16 v[174:175],v30 offset:11872
ds_read_b64_tr_b16 v[176:177],v30 offset:10304
ds_read_b64_tr_b16 v[178:179],v30 offset:10624
ds_read_b64_tr_b16 v[180:181],v30 offset:11584
ds_read_b64_tr_b16 v[182:183],v30 offset:11904
s_waitcnt lgkmcnt(4)
ds_read_b64_tr_b16 v[184:185],v30 offset:10336
ds_read_b64_tr_b16 v[186:187],v30 offset:10656
ds_read_b64_tr_b16 v[188:189],v30 offset:11616
ds_read_b64_tr_b16 v[190:191],v30 offset:11936
ds_read_b64_tr_b16 v[104:105],v30 offset:10368
ds_read_b64_tr_b16 v[106:107],v30 offset:10688
ds_read_b64_tr_b16 v[108:109],v30 offset:11648
ds_read_b64_tr_b16 v[110:111],v30 offset:11968
s_waitcnt lgkmcnt(0)
s_waitcnt vmcnt(10)
ds_read_b64_tr_b16 v[192:193],v30 offset:20480
ds_read_b64_tr_b16 v[194:195],v30 offset:20800
ds_read_b64_tr_b16 v[196:197],v30 offset:21760
ds_read_b64_tr_b16 v[198:199],v30 offset:22080
ds_read_b64_tr_b16 v[200:201],v30 offset:20512
ds_read_b64_tr_b16 v[202:203],v30 offset:20832
ds_read_b64_tr_b16 v[204:205],v30 offset:21792
ds_read_b64_tr_b16 v[206:207],v30 offset:22112
ds_read_b64_tr_b16 v[208:209],v30 offset:20544
ds_read_b64_tr_b16 v[210:211],v30 offset:20864
ds_read_b64_tr_b16 v[212:213],v30 offset:21824
ds_read_b64_tr_b16 v[214:215],v30 offset:22144
s_waitcnt lgkmcnt(4)
ds_read_b64_tr_b16 v[216:217],v30 offset:20576
ds_read_b64_tr_b16 v[218:219],v30 offset:20896
ds_read_b64_tr_b16 v[220:221],v30 offset:21856
ds_read_b64_tr_b16 v[222:223],v30 offset:22176
ds_read_b64_tr_b16 v[112:113],v30 offset:20608
ds_read_b64_tr_b16 v[114:115],v30 offset:20928
ds_read_b64_tr_b16 v[116:117],v30 offset:21888
ds_read_b64_tr_b16 v[118:119],v30 offset:22208
s_waitcnt lgkmcnt(0)
s_waitcnt vmcnt(0)
ds_read_b64_tr_b16 v[224:225],v30 offset:30720
ds_read_b64_tr_b16 v[226:227],v30 offset:31040
ds_read_b64_tr_b16 v[228:229],v30 offset:32000
ds_read_b64_tr_b16 v[230:231],v30 offset:32320
ds_read_b64_tr_b16 v[232:233],v30 offset:30752
ds_read_b64_tr_b16 v[234:235],v30 offset:31072
ds_read_b64_tr_b16 v[236:237],v30 offset:32032
ds_read_b64_tr_b16 v[238:239],v30 offset:32352
ds_read_b64_tr_b16 v[240:241],v30 offset:30784
ds_read_b64_tr_b16 v[242:243],v30 offset:31104
ds_read_b64_tr_b16 v[244:245],v30 offset:32064
ds_read_b64_tr_b16 v[246:247],v30 offset:32384
s_waitcnt lgkmcnt(4)
ds_read_b64_tr_b16 v[248:249],v30 offset:30816
ds_read_b64_tr_b16 v[250:251],v30 offset:31136
ds_read_b64_tr_b16 v[252:253],v30 offset:32096
ds_read_b64_tr_b16 v[254:255],v30 offset:32416
ds_read_b64_tr_b16 v[120:121],v30 offset:30848
ds_read_b64_tr_b16 v[122:123],v30 offset:31168
ds_read_b64_tr_b16 v[124:125],v30 offset:32128
ds_read_b64_tr_b16 v[126:127],v30 offset:32448
s_waitcnt lgkmcnt(0)
s_barrier
ds_write_b128 v4,v[32:35] offset:0
ds_write_b128 v4,v[36:39] offset:1024
ds_write_b128 v4,v[40:43] offset:2048
ds_write_b128 v4,v[44:47] offset:3072
ds_write_b128 v4,v[48:51] offset:4096
ds_write_b128 v4,v[52:55] offset:5120
ds_write_b128 v4,v[56:59] offset:6144
ds_write_b128 v4,v[60:63] offset:7168
s_waitcnt lgkmcnt(0)
ds_write_b128 v4,v[64:67] offset:8192
ds_write_b128 v4,v[68:71] offset:9216
ds_write_b128 v4,v[72:75] offset:10240
ds_write_b128 v4,v[76:79] offset:11264
ds_write_b128 v4,v[80:83] offset:12288
ds_write_b128 v4,v[84:87] offset:13312
ds_write_b128 v4,v[88:91] offset:14336
ds_write_b128 v4,v[92:95] offset:15360
s_waitcnt lgkmcnt(0)
ds_write_b128 v4,v[96:99] offset:16384
ds_write_b128 v4,v[100:103] offset:17408
ds_write_b128 v4,v[104:107] offset:18432
ds_write_b128 v4,v[108:111] offset:19456
ds_write_b128 v4,v[112:115] offset:20480
ds_write_b128 v4,v[116:119] offset:21504
ds_write_b128 v4,v[120:123] offset:22528
ds_write_b128 v4,v[124:127] offset:23552
s_waitcnt lgkmcnt(0)
s_barrier
s_lshl_b32 s3,s49,2
v_mov_b32 v13,s3
s_nop 1
ibw_160:
buffer_load_dword v12,v13,s[12:15],0 offen sc1
s_waitcnt vmcnt(0)
v_cmp_ne_u32 vcc,256,v12
s_nop 0
s_cbranch_vccz ok_161
s_sleep 8
s_sub_u32 s47,s47,1
s_cbranch_scc1 ABORT
s_branch ibw_160
ok_161:
s_cmp_lg_u32 s49,0
s_cbranch_scc1 ibok_162
v_and_b32 v13,7,v0
v_lshlrev_b32 v13,2,v13
buffer_load_dword v12,v13,s[12:15],0 offen offset:32 sc1
s_waitcnt vmcnt(0)
v_cmp_ne_u32 vcc,32,v12
s_nop 0
s_cbranch_vccz ibok_162
s_barrier
s_mov_b32 s49,1
s_mov_b32 s3,s2
s_load_dwordx16 s[16:31],s[0:1],0
s_load_dwordx8 s[32:39],s[0:1],64
s_waitcnt lgkmcnt(0)
s_branch DISPATCH
ibok_162:
v_mov_b32 v13,192
buffer_load_dword v12,v13,s[12:15],0 offen sc1
s_waitcnt vmcnt(0)
v_readfirstlane_b32 s60,v12
s_cmp_gt_i32 s60,0
s_cselect_b32 s60,0x2000,0
s_add_u32 s83,s83,s60
s_mov_b32 s50,0
s_mov_b32 s77,0
s_cmp_lg_u32 s49,0
s_cbranch_scc1 CW_LOOP_S
CW_LOOP_F:
s_sub_u32 s60,s50,14
s_lshr_b32 s52,s60,1
s_and_b32 s51,s60,1
s_cmp_eq_u32 s51,0
s_cselect_b32 s61,14,0
s_add_u32 s52,s52,s61
s_sub_u32 s61,s60,50
s_cmp_ge_u32 s60,100
s_cselect_b32 s52,s61,s52
s_cselect_b32 s51,1,s51
s_cmp_lt_u32 s50,14
s_cselect_b32 s52,s50,s52
s_cselect_b32 s51,0,s51
s_cmp_eq_u32 s52,63
s_cbranch_scc1 CW_NEXT_F
s_add_u32 s58,s52,1
s_lshl_b32 s61,s51,9
s_add_u32 s72,s61,s35
s_add_u32 s69,s61,s85
s_lshl_b32 s61,s51,2
s_and_b32 s60,s52,1
s_add_u32 s60,s60,s61
s_mul_i32 s70,s60,49152
s_add_u32 s70,s70,s33
s_add_u32 s71,s70,4096
s_add_u32 s80,s70,8192
s_bfe_u32 s57,s52,65537
s_bfe_u32 s31,s58,65537
s_and_b32 s60,s58,1
s_add_u32 s60,s60,s61
s_mul_i32 s59,s60,20480
s_add_u32 s59,s59,s84
s_lshl_b32 s68,s60,16
s_add_u32 s68,s68,s83
s_xor_b32 s77,s77,11264
v_add_u32 v7,s77,v5
v_add_u32 v8,s77,v6
s_add_u32 s60,s52,2
v_mov_b32 v16,s60
v_mov_b32 v80,0
v_mov_b32 v81,0
v_mov_b32 v82,0
v_mov_b32 v83,0
v_mov_b32 v84,0
v_mov_b32 v85,0
v_mov_b32 v86,0
v_mov_b32 v87,0
v_mov_b32 v88,0
v_mov_b32 v89,0
v_mov_b32 v90,0
v_mov_b32 v91,0
v_mov_b32 v92,0
v_mov_b32 v93,0
v_mov_b32 v94,0
v_mov_b32 v95,0
v_mov_b32 v96,0
v_mov_b32 v97,0
v_mov_b32 v98,0
v_mov_b32 v99,0
ds_read_b128 v[100:103],v4 offset:0
ds_read_b128 v[104:107],v4 offset:1024
ds_read_b128 v[108:111],v4 offset:2048
ds_read_b128 v[112:115],v4 offset:3072
s_cmp_lg_u32 s46,0
s_cbranch_scc1 np_163
db_164:
buffer_load_dword v12,v3,s[8:11],s72 offen sc1
s_waitcnt vmcnt(0)
v_cmp_gt_u32 vcc,s58,v12
s_cbranch_vccz dbok_165
s_sub_u32 s47,s47,1
s_cbranch_scc1 ABORT
s_branch db_164
dbok_165:
np_163:
s_barrier
buffer_load_dwordx4 v[32:35],v1,s[8:11],s70 offen sc1
s_nop 7
buffer_load_dwordx4 v[36:39],v1,s[8:11],s70 offen offset:1024 sc1
s_nop 7
buffer_load_dwordx4 v[40:43],v1,s[8:11],s70 offen offset:2048 sc1
s_nop 7
buffer_load_dwordx4 v[44:47],v1,s[8:11],s70 offen offset:3072 sc1
s_nop 7
buffer_load_dwordx4 v[48:51],v1,s[8:11],s71 offen sc1
s_waitcnt vmcnt(4)
v_and_b32 v12,1,v32
v_cmp_ne_u32 vcc,s57,v12
s_cbranch_vccnz ws_166
wg_175:
v_smfmac_f32_16x16x64_bf16 v[80:83],v[32:35],a[0:7],v2
buffer_load_dwordx4 v[52:55],v1,s[8:11],s71 offen offset:1024 sc1
v_smfmac_f32_16x16x64_bf16 v[84:87],v[32:35],a[8:15],v2
s_waitcnt vmcnt(4)
v_and_b32 v12,1,v36
v_smfmac_f32_16x16x64_bf16 v[88:91],v[32:35],a[16:23],v2
v_cmp_ne_u32 vcc,s57,v12
v_smfmac_f32_16x16x64_bf16 v[92:95],v[32:35],a[24:31],v2
s_waitcnt lgkmcnt(2)
v_smfmac_f32_16x16x64_bf16 v[96:99],v[32:35],v[100:107],v2
s_cbranch_vccnz ws_167
wg_176:
v_smfmac_f32_16x16x64_bf16 v[80:83],v[36:39],a[32:39],v2
buffer_load_dwordx4 v[56:59],v1,s[8:11],s71 offen offset:2048 sc1
v_smfmac_f32_16x16x64_bf16 v[84:87],v[36:39],a[40:47],v2
s_waitcnt vmcnt(4)
v_and_b32 v12,1,v40
v_smfmac_f32_16x16x64_bf16 v[88:91],v[36:39],a[48:55],v2
v_cmp_ne_u32 vcc,s57,v12
ds_read_b128 v[100:103],v4 offset:4096
v_smfmac_f32_16x16x64_bf16 v[92:95],v[36:39],a[56:63],v2
ds_read_b128 v[104:107],v4 offset:5120
s_waitcnt lgkmcnt(2)
v_smfmac_f32_16x16x64_bf16 v[96:99],v[36:39],v[108:115],v2
s_cbranch_vccnz ws_168
wg_177:
v_smfmac_f32_16x16x64_bf16 v[80:83],v[40:43],a[64:71],v2
buffer_load_dwordx4 v[60:63],v1,s[8:11],s71 offen offset:3072 sc1
v_smfmac_f32_16x16x64_bf16 v[84:87],v[40:43],a[72:79],v2
s_waitcnt vmcnt(4)
v_and_b32 v12,1,v44
v_smfmac_f32_16x16x64_bf16 v[88:91],v[40:43],a[80:87],v2
v_cmp_ne_u32 vcc,s57,v12
ds_read_b128 v[108:111],v4 offset:6144
v_smfmac_f32_16x16x64_bf16 v[92:95],v[40:43],a[88:95],v2
ds_read_b128 v[112:115],v4 offset:7168
s_waitcnt lgkmcnt(2)
v_smfmac_f32_16x16x64_bf16 v[96:99],v[40:43],v[100:107],v2
s_cbranch_vccnz ws_169
wg_178:
v_smfmac_f32_16x16x64_bf16 v[80:83],v[44:47],a[96:103],v2
buffer_load_dwordx4 v[64:67],v1,s[8:11],s80 offen sc1
v_smfmac_f32_16x16x64_bf16 v[84:87],v[44:47],a[104:111],v2
s_waitcnt vmcnt(4)
v_and_b32 v12,1,v48
v_smfmac_f32_16x16x64_bf16 v[88:91],v[44:47],a[112:119],v2
v_cmp_ne_u32 vcc,s57,v12
ds_read_b128 v[100:103],v4 offset:8192
v_smfmac_f32_16x16x64_bf16 v[92:95],v[44:47],a[120:127],v2
ds_read_b128 v[104:107],v4 offset:9216
s_waitcnt lgkmcnt(2)
v_smfmac_f32_16x16x64_bf16 v[96:99],v[44:47],v[108:115],v2
s_cbranch_vccnz ws_170
wg_179:
v_smfmac_f32_16x16x64_bf16 v[80:83],v[48:51],a[128:135],v2
buffer_load_dwordx4 v[68:71],v1,s[8:11],s80 offen offset:1024 sc1
v_smfmac_f32_16x16x64_bf16 v[84:87],v[48:51],a[136:143],v2
s_waitcnt vmcnt(4)
v_and_b32 v12,1,v52
v_smfmac_f32_16x16x64_bf16 v[88:91],v[48:51],a[144:151],v2
v_cmp_ne_u32 vcc,s57,v12
ds_read_b128 v[108:111],v4 offset:10240
v_smfmac_f32_16x16x64_bf16 v[92:95],v[48:51],a[152:159],v2
ds_read_b128 v[112:115],v4 offset:11264
s_waitcnt lgkmcnt(2)
v_smfmac_f32_16x16x64_bf16 v[96:99],v[48:51],v[100:107],v2
s_cbranch_vccnz ws_171
wg_180:
v_smfmac_f32_16x16x64_bf16 v[80:83],v[52:55],a[160:167],v2
s_waitcnt vmcnt(2)
v_bitop3_b32 v12,v56,v60,s57 bitop3:0x7e
v_smfmac_f32_16x16x64_bf16 v[84:87],v[52:55],a[168:175],v2
v_and_b32 v12,1,v12
buffer_load_dwordx4 v[72:75],v1,s[8:11],s80 offen offset:2048 sc1
v_smfmac_f32_16x16x64_bf16 v[88:91],v[52:55],a[176:183],v2
v_cmp_ne_u32 vcc,0,v12
ds_read_b128 v[100:103],v4 offset:12288
v_smfmac_f32_16x16x64_bf16 v[92:95],v[52:55],a[184:191],v2
ds_read_b128 v[104:107],v4 offset:13312
s_waitcnt lgkmcnt(2)
v_smfmac_f32_16x16x64_bf16 v[96:99],v[52:55],v[108:115],v2
s_cbranch_vccnz ws_172
wg_181:
v_smfmac_f32_16x16x64_bf16 v[80:83],v[56:59],a[192:199],v2
buffer_load_dwordx4 v[76:79],v1,s[8:11],s80 offen offset:3072 sc1
v_smfmac_f32_16x16x64_bf16 v[84:87],v[56:59],a[200:207],v2
ds_read_b128 v[108:111],v4 offset:14336
v_smfmac_f32_16x16x64_bf16 v[88:91],v[56:59],a[208:215],v2
ds_read_b128 v[112:115],v4 offset:15360
v_smfmac_f32_16x16x64_bf16 v[92:95],v[56:59],a[216:223],v2
s_waitcnt lgkmcnt(2)
v_smfmac_f32_16x16x64_bf16 v[96:99],v[56:59],v[100:107],v2
ds_read_b128 v[100:103],v4 offset:16384
v_smfmac_f32_16x16x64_bf16 v[80:83],v[60:63],a[224:231],v2
s_waitcnt vmcnt(2)
v_bitop3_b32 v12,v64,v68,s57 bitop3:0x7e
v_smfmac_f32_16x16x64_bf16 v[84:87],v[60:63],a[232:239],v2
v_and_b32 v12,1,v12
ds_read_b128 v[104:107],v4 offset:17408
v_smfmac_f32_16x16x64_bf16 v[88:91],v[60:63],a[240:247],v2
v_cmp_ne_u32 vcc,0,v12
v_smfmac_f32_16x16x64_bf16 v[92:95],v[60:63],a[248:255],v2
s_waitcnt lgkmcnt(2)
v_smfmac_f32_16x16x64_bf16 v[96:99],v[60:63],v[108:115],v2
s_cbranch_vccnz ws_173
wg_182:
v_smfmac_f32_16x16x64_bf16 v[80:83],v[64:67],v[128:135],v2
ds_read_b128 v[108:111],v4 offset:18432
v_smfmac_f32_16x16x64_bf16 v[84:87],v[64:67],v[136:143],v2
ds_read_b128 v[112:115],v4 offset:19456
v_smfmac_f32_16x16x64_bf16 v[88:91],v[64:67],v[144:151],v2
v_smfmac_f32_16x16x64_bf16 v[92:95],v[64:67],v[152:159],v2
s_waitcnt lgkmcnt(2)
v_smfmac_f32_16x16x64_bf16 v[96:99],v[64:67],v[100:107],v2
ds_read_b128 v[100:103],v4 offset:20480
v_smfmac_f32_16x16x64_bf16 v[80:83],v[68:71],v[160:167],v2
s_waitcnt vmcnt(0)
v_bitop3_b32 v12,v72,v76,s57 bitop3:0x7e
v_smfmac_f32_16x16x64_bf16 v[84:87],v[68:71],v[168:175],v2
v_and_b32 v12,1,v12
ds_read_b128 v[104:107],v4 offset:21504
v_smfmac_f32_16x16x64_bf16 v[88:91],v[68:71],v[176:183],v2
v_cmp_ne_u32 vcc,0,v12
v_smfmac_f32_16x16x64_bf16 v[92:95],v[68:71],v[184:191],v2
s_waitcnt lgkmcnt(2)
v_smfmac_f32_16x16x64_bf16 v[96:99],v[68:71],v[108:115],v2
s_cbranch_vccnz ws_174
wg_183:
v_smfmac_f32_16x16x64_bf16 v[80:83],v[72:75],v[192:199],v2
ds_read_b128 v[108:111],v4 offset:22528
v_smfmac_f32_16x16x64_bf16 v[80:83],v[76:79],v[224:231],v2
ds_read_b128 v[112:115],v4 offset:23552
v_smfmac_f32_16x16x64_bf16 v[84:87],v[72:75],v[200:207],v2
v_smfmac_f32_16x16x64_bf16 v[84:87],v[76:79],v[232:239],v2
v_smfmac_f32_16x16x64_bf16 v[88:91],v[72:75],v[208:215],v2
s_nop 3
v_add_f32 v80,v80,v81
v_smfmac_f32_16x16x64_bf16 v[88:91],v[76:79],v[240:247],v2
v_add_f32 v82,v82,v83
ds_write2_b32 v7,v80,v82 offset0:0 offset1:88
v_smfmac_f32_16x16x64_bf16 v[92:95],v[72:75],v[216:223],v2
v_add_f32 v84,v84,v85
v_smfmac_f32_16x16x64_bf16 v[92:95],v[76:79],v[248:255],v2
v_add_f32 v86,v86,v87
s_waitcnt lgkmcnt(3)
v_smfmac_f32_16x16x64_bf16 v[96:99],v[72:75],v[100:107],v2
ds_write2_b32 v7,v84,v86 offset0:16 offset1:104
s_waitcnt lgkmcnt(2)
v_smfmac_f32_16x16x64_bf16 v[96:99],v[76:79],v[108:115],v2
v_add_f32 v88,v88,v89
v_add_f32 v90,v90,v91
ds_write2_b32 v7,v88,v90 offset0:32 offset1:120
v_add_f32 v92,v92,v93
v_add_f32 v94,v94,v95
ds_write2_b32 v7,v92,v94 offset0:48 offset1:136
s_nop 1
v_add_f32 v96,v96,v97
v_add_f32 v98,v98,v99
ds_write2_b32 v7,v96,v98 offset0:64 offset1:152
s_waitcnt lgkmcnt(0)
s_barrier
ds_read_b128 v[32:35],v8 offset:0
ds_read_b128 v[36:39],v8 offset:2816
ds_read_b128 v[40:43],v8 offset:5632
ds_read_b128 v[44:47],v8 offset:8448
s_mov_b64 exec,1
buffer_store_dword v16,v1,s[8:11],s69 offen
s_mov_b64 exec,-1
s_waitcnt lgkmcnt(2)
v_pk_add_f32 v[32:33],v[32:33],v[36:37]
v_pk_add_f32 v[34:35],v[34:35],v[38:39]
s_waitcnt lgkmcnt(0)
v_pk_add_f32 v[40:41],v[40:41],v[44:45]
v_pk_add_f32 v[42:43],v[42:43],v[46:47]
v_pk_add_f32 v[32:33],v[32:33],v[40:41]
v_pk_add_f32 v[34:35],v[34:35],v[42:43]
v_cvt_pk_bf16_f32 v32,v32,v33
v_cvt_pk_bf16_f32 v33,v34,v35
v_bfi_b32 v32,v10,s31,v32
s_nop 0
v_permlane32_swap_b32 v33,v35
v_permlane32_swap_b32 v32,v34
s_mov_b64 exec,s[88:89]
buffer_store_dwordx4 v[32:35],v9,s[8:11],s59 offen
s_barrier
buffer_store_dwordx4 v[32:35],v9,s[8:11],s68 offen sc1
s_mov_b64 exec,-1
s_nop 0
CW_NEXT_F:
s_add_u32 s50,s50,1
s_cmp_lt_u32 s50,128
s_cbranch_scc1 CW_LOOP_F
s_branch CW_DONE
ws_166:
buffer_load_dwordx4 v[32:35],v1,s[8:11],s70 offen sc1
buffer_load_dwordx4 v[36:39],v1,s[8:11],s70 offen offset:1024 sc1
buffer_load_dwordx4 v[40:43],v1,s[8:11],s70 offen offset:2048 sc1
buffer_load_dwordx4 v[44:47],v1,s[8:11],s70 offen offset:3072 sc1
buffer_load_dwordx4 v[48:51],v1,s[8:11],s71 offen sc1
s_sub_u32 s47,s47,1
s_cbranch_scc1 ABORT
s_waitcnt vmcnt(4)
v_and_b32 v12,1,v32
v_cmp_ne_u32 vcc,s57,v12
s_nop 0
s_cbranch_vccnz ws_166
s_branch wg_175
ws_167:
buffer_load_dwordx4 v[36:39],v1,s[8:11],s70 offen offset:1024 sc1
buffer_load_dwordx4 v[40:43],v1,s[8:11],s70 offen offset:2048 sc1
buffer_load_dwordx4 v[44:47],v1,s[8:11],s70 offen offset:3072 sc1
buffer_load_dwordx4 v[48:51],v1,s[8:11],s71 offen sc1
buffer_load_dwordx4 v[52:55],v1,s[8:11],s71 offen offset:1024 sc1
s_sub_u32 s47,s47,1
s_cbranch_scc1 ABORT
s_waitcnt vmcnt(4)
v_and_b32 v12,1,v36
v_cmp_ne_u32 vcc,s57,v12
s_nop 0
s_cbranch_vccnz ws_167
s_branch wg_176
ws_168:
buffer_load_dwordx4 v[40:43],v1,s[8:11],s70 offen offset:2048 sc1
buffer_load_dwordx4 v[44:47],v1,s[8:11],s70 offen offset:3072 sc1
buffer_load_dwordx4 v[48:51],v1,s[8:11],s71 offen sc1
buffer_load_dwordx4 v[52:55],v1,s[8:11],s71 offen offset:1024 sc1
buffer_load_dwordx4 v[56:59],v1,s[8:11],s71 offen offset:2048 sc1
s_sub_u32 s47,s47,1
s_cbranch_scc1 ABORT
s_waitcnt vmcnt(4)
v_and_b32 v12,1,v40
v_cmp_ne_u32 vcc,s57,v12
s_nop 0
s_cbranch_vccnz ws_168
s_branch wg_177
ws_169:
buffer_load_dwordx4 v[44:47],v1,s[8:11],s70 offen offset:3072 sc1
buffer_load_dwordx4 v[48:51],v1,s[8:11],s71 offen sc1
buffer_load_dwordx4 v[52:55],v1,s[8:11],s71 offen offset:1024 sc1
buffer_load_dwordx4 v[56:59],v1,s[8:11],s71 offen offset:2048 sc1
buffer_load_dwordx4 v[60:63],v1,s[8:11],s71 offen offset:3072 sc1
s_sub_u32 s47,s47,1
s_cbranch_scc1 ABORT
s_waitcnt vmcnt(4)
v_and_b32 v12,1,v44
v_cmp_ne_u32 vcc,s57,v12
s_nop 0
s_cbranch_vccnz ws_169
s_branch wg_178
ws_170:
buffer_load_dwordx4 v[48:51],v1,s[8:11],s71 offen sc1
buffer_load_dwordx4 v[52:55],v1,s[8:11],s71 offen offset:1024 sc1
buffer_load_dwordx4 v[56:59],v1,s[8:11],s71 offen offset:2048 sc1
buffer_load_dwordx4 v[60:63],v1,s[8:11],s71 offen offset:3072 sc1
buffer_load_dwordx4 v[64:67],v1,s[8:11],s80 offen sc1
s_sub_u32 s47,s47,1
s_cbranch_scc1 ABORT
s_waitcnt vmcnt(4)
v_and_b32 v12,1,v48
v_cmp_ne_u32 vcc,s57,v12
s_nop 0
s_cbranch_vccnz ws_170
s_branch wg_179
ws_171:
buffer_load_dwordx4 v[52:55],v1,s[8:11],s71 offen offset:1024 sc1
buffer_load_dwordx4 v[56:59],v1,s[8:11],s71 offen offset:2048 sc1
buffer_load_dwordx4 v[60:63],v1,s[8:11],s71 offen offset:3072 sc1
buffer_load_dwordx4 v[64:67],v1,s[8:11],s80 offen sc1
buffer_load_dwordx4 v[68:71],v1,s[8:11],s80 offen offset:1024 sc1
s_sub_u32 s47,s47,1
s_cbranch_scc1 ABORT
s_waitcnt vmcnt(4)
v_and_b32 v12,1,v52
v_cmp_ne_u32 vcc,s57,v12
s_nop 0
s_cbranch_vccnz ws_171
s_branch wg_180
ws_172:
buffer_load_dwordx4 v[56:59],v1,s[8:11],s71 offen offset:2048 sc1
buffer_load_dwordx4 v[60:63],v1,s[8:11],s71 offen offset:3072 sc1
buffer_load_dwordx4 v[64:67],v1,s[8:11],s80 offen sc1
buffer_load_dwordx4 v[68:71],v1,s[8:11],s80 offen offset:1024 sc1
buffer_load_dwordx4 v[72:75],v1,s[8:11],s80 offen offset:2048 sc1
s_sub_u32 s47,s47,1
s_cbranch_scc1 ABORT
s_waitcnt vmcnt(3)
v_bitop3_b32 v12,v56,v60,s57 bitop3:0x7e
v_and_b32 v12,1,v12
v_cmp_ne_u32 vcc,0,v12
s_nop 0
s_cbranch_vccnz ws_172
s_branch wg_181
ws_173:
buffer_load_dwordx4 v[64:67],v1,s[8:11],s80 offen sc1
buffer_load_dwordx4 v[68:71],v1,s[8:11],s80 offen offset:1024 sc1
buffer_load_dwordx4 v[72:75],v1,s[8:11],s80 offen offset:2048 sc1
buffer_load_dwordx4 v[76:79],v1,s[8:11],s80 offen offset:3072 sc1
s_sub_u32 s47,s47,1
s_cbranch_scc1 ABORT
s_waitcnt vmcnt(2)
v_bitop3_b32 v12,v64,v68,s57 bitop3:0x7e
v_and_b32 v12,1,v12
v_cmp_ne_u32 vcc,0,v12
s_nop 0
s_cbranch_vccnz ws_173
s_branch wg_182
ws_174:
buffer_load_dwordx4 v[72:75],v1,s[8:11],s80 offen offset:2048 sc1
buffer_load_dwordx4 v[76:79],v1,s[8:11],s80 offen offset:3072 sc1
s_sub_u32 s47,s47,1
s_cbranch_scc1 ABORT
s_waitcnt vmcnt(0)
v_bitop3_b32 v12,v72,v76,s57 bitop3:0x7e
v_and_b32 v12,1,v12
v_cmp_ne_u32 vcc,0,v12
s_nop 0
s_cbranch_vccnz ws_174
s_branch wg_183
CW_LOOP_S:
s_sub_u32 s60,s50,14
s_lshr_b32 s52,s60,1
s_and_b32 s51,s60,1
s_cmp_eq_u32 s51,0
s_cselect_b32 s61,14,0
s_add_u32 s52,s52,s61
s_sub_u32 s61,s60,50
s_cmp_ge_u32 s60,100
s_cselect_b32 s52,s61,s52
s_cselect_b32 s51,1,s51
s_cmp_lt_u32 s50,14
s_cselect_b32 s52,s50,s52
s_cselect_b32 s51,0,s51
s_cmp_eq_u32 s52,63
s_cbranch_scc1 CW_NEXT_S
s_add_u32 s58,s52,1
s_lshl_b32 s61,s51,9
s_add_u32 s72,s61,s35
s_add_u32 s69,s61,s85
s_lshl_b32 s61,s51,2
s_and_b32 s60,s52,1
s_add_u32 s60,s60,s61
s_mul_i32 s70,s60,49152
s_add_u32 s70,s70,s33
s_add_u32 s71,s70,4096
s_add_u32 s80,s70,8192
s_bfe_u32 s57,s52,65537
s_bfe_u32 s31,s58,65537
s_and_b32 s60,s58,1
s_add_u32 s60,s60,s61
s_mul_i32 s59,s60,20480
s_add_u32 s59,s59,s84
s_lshl_b32 s68,s60,16
s_add_u32 s68,s68,s83
s_xor_b32 s77,s77,11264
v_add_u32 v7,s77,v5
v_add_u32 v8,s77,v6
s_add_u32 s60,s52,2
v_mov_b32 v16,s60
v_mov_b32 v80,0
v_mov_b32 v81,0
v_mov_b32 v82,0
v_mov_b32 v83,0
v_mov_b32 v84,0
v_mov_b32 v85,0
v_mov_b32 v86,0
v_mov_b32 v87,0
v_mov_b32 v88,0
v_mov_b32 v89,0
v_mov_b32 v90,0
v_mov_b32 v91,0
v_mov_b32 v92,0
v_mov_b32 v93,0
v_mov_b32 v94,0
v_mov_b32 v95,0
v_mov_b32 v96,0
v_mov_b32 v97,0
v_mov_b32 v98,0
v_mov_b32 v99,0
ds_read_b128 v[100:103],v4 offset:0
ds_read_b128 v[104:107],v4 offset:1024
ds_read_b128 v[108:111],v4 offset:2048
ds_read_b128 v[112:115],v4 offset:3072
s_cmp_lg_u32 s46,0
s_cbranch_scc1 np_184
db_185:
buffer_load_dword v12,v3,s[8:11],s72 offen sc1
s_waitcnt vmcnt(0)
v_cmp_gt_u32 vcc,s58,v12
s_cbranch_vccz dbok_186
s_sub_u32 s47,s47,1
s_cbranch_scc1 ABORT
s_branch db_185
dbok_186:
np_184:
s_barrier
buffer_load_dwordx4 v[32:35],v1,s[8:11],s70 offen sc1
s_nop 7
buffer_load_dwordx4 v[36:39],v1,s[8:11],s70 offen offset:1024 sc1
s_nop 7
buffer_load_dwordx4 v[40:43],v1,s[8:11],s70 offen offset:2048 sc1
s_nop 7
buffer_load_dwordx4 v[44:47],v1,s[8:11],s70 offen offset:3072 sc1
s_nop 7
buffer_load_dwordx4 v[48:51],v1,s[8:11],s71 offen sc1
s_waitcnt vmcnt(4)
v_and_b32 v12,1,v32
v_cmp_ne_u32 vcc,s57,v12
s_cbranch_vccnz ws_187
wg_196:
v_smfmac_f32_16x16x64_bf16 v[80:83],v[32:35],a[0:7],v2
buffer_load_dwordx4 v[52:55],v1,s[8:11],s71 offen offset:1024 sc1
v_smfmac_f32_16x16x64_bf16 v[84:87],v[32:35],a[8:15],v2
s_waitcnt vmcnt(4)
v_and_b32 v12,1,v36
v_smfmac_f32_16x16x64_bf16 v[88:91],v[32:35],a[16:23],v2
v_cmp_ne_u32 vcc,s57,v12
v_smfmac_f32_16x16x64_bf16 v[92:95],v[32:35],a[24:31],v2
s_waitcnt lgkmcnt(2)
v_smfmac_f32_16x16x64_bf16 v[96:99],v[32:35],v[100:107],v2
s_cbranch_vccnz ws_188
wg_197:
v_smfmac_f32_16x16x64_bf16 v[80:83],v[36:39],a[32:39],v2
buffer_load_dwordx4 v[56:59],v1,s[8:11],s71 offen offset:2048 sc1
v_smfmac_f32_16x16x64_bf16 v[84:87],v[36:39],a[40:47],v2
s_waitcnt vmcnt(4)
v_and_b32 v12,1,v40
v_smfmac_f32_16x16x64_bf16 v[88:91],v[36:39],a[48:55],v2
v_cmp_ne_u32 vcc,s57,v12
ds_read_b128 v[100:103],v4 offset:4096
v_smfmac_f32_16x16x64_bf16 v[92:95],v[36:39],a[56:63],v2
ds_read_b128 v[104:107],v4 offset:5120
s_waitcnt lgkmcnt(2)
v_smfmac_f32_16x16x64_bf16 v[96:99],v[36:39],v[108:115],v2
s_cbranch_vccnz ws_189
wg_198:
v_smfmac_f32_16x16x64_bf16 v[80:83],v[40:43],a[64:71],v2
buffer_load_dwordx4 v[60:63],v1,s[8:11],s71 offen offset:3072 sc1
v_smfmac_f32_16x16x64_bf16 v[84:87],v[40:43],a[72:79],v2
s_waitcnt vmcnt(4)
v_and_b32 v12,1,v44
v_smfmac_f32_16x16x64_bf16 v[88:91],v[40:43],a[80:87],v2
v_cmp_ne_u32 vcc,s57,v12
ds_read_b128 v[108:111],v4 offset:6144
v_smfmac_f32_16x16x64_bf16 v[92:95],v[40:43],a[88:95],v2
ds_read_b128 v[112:115],v4 offset:7168
s_waitcnt lgkmcnt(2)
v_smfmac_f32_16x16x64_bf16 v[96:99],v[40:43],v[100:107],v2
s_cbranch_vccnz ws_190
wg_199:
v_smfmac_f32_16x16x64_bf16 v[80:83],v[44:47],a[96:103],v2
buffer_load_dwordx4 v[64:67],v1,s[8:11],s80 offen sc1
v_smfmac_f32_16x16x64_bf16 v[84:87],v[44:47],a[104:111],v2
s_waitcnt vmcnt(4)
v_and_b32 v12,1,v48
v_smfmac_f32_16x16x64_bf16 v[88:91],v[44:47],a[112:119],v2
v_cmp_ne_u32 vcc,s57,v12
ds_read_b128 v[100:103],v4 offset:8192
v_smfmac_f32_16x16x64_bf16 v[92:95],v[44:47],a[120:127],v2
ds_read_b128 v[104:107],v4 offset:9216
s_waitcnt lgkmcnt(2)
v_smfmac_f32_16x16x64_bf16 v[96:99],v[44:47],v[108:115],v2
s_cbranch_vccnz ws_191
wg_200:
v_smfmac_f32_16x16x64_bf16 v[80:83],v[48:51],a[128:135],v2
buffer_load_dwordx4 v[68:71],v1,s[8:11],s80 offen offset:1024 sc1
v_smfmac_f32_16x16x64_bf16 v[84:87],v[48:51],a[136:143],v2
s_waitcnt vmcnt(4)
v_and_b32 v12,1,v52
v_smfmac_f32_16x16x64_bf16 v[88:91],v[48:51],a[144:151],v2
v_cmp_ne_u32 vcc,s57,v12
ds_read_b128 v[108:111],v4 offset:10240
v_smfmac_f32_16x16x64_bf16 v[92:95],v[48:51],a[152:159],v2
ds_read_b128 v[112:115],v4 offset:11264
s_waitcnt lgkmcnt(2)
v_smfmac_f32_16x16x64_bf16 v[96:99],v[48:51],v[100:107],v2
s_cbranch_vccnz ws_192
wg_201:
v_smfmac_f32_16x16x64_bf16 v[80:83],v[52:55],a[160:167],v2
s_waitcnt vmcnt(2)
v_bitop3_b32 v12,v56,v60,s57 bitop3:0x7e
v_smfmac_f32_16x16x64_bf16 v[84:87],v[52:55],a[168:175],v2
v_and_b32 v12,1,v12
buffer_load_dwordx4 v[72:75],v1,s[8:11],s80 offen offset:2048 sc1
v_smfmac_f32_16x16x64_bf16 v[88:91],v[52:55],a[176:183],v2
v_cmp_ne_u32 vcc,0,v12
ds_read_b128 v[100:103],v4 offset:12288
v_smfmac_f32_16x16x64_bf16 v[92:95],v[52:55],a[184:191],v2
ds_read_b128 v[104:107],v4 offset:13312
s_waitcnt lgkmcnt(2)
v_smfmac_f32_16x16x64_bf16 v[96:99],v[52:55],v[108:115],v2
s_cbranch_vccnz ws_193
wg_202:
v_smfmac_f32_16x16x64_bf16 v[80:83],v[56:59],a[192:199],v2
buffer_load_dwordx4 v[76:79],v1,s[8:11],s80 offen offset:3072 sc1
v_smfmac_f32_16x16x64_bf16 v[84:87],v[56:59],a[200:207],v2
ds_read_b128 v[108:111],v4 offset:14336
v_smfmac_f32_16x16x64_bf16 v[88:91],v[56:59],a[208:215],v2
ds_read_b128 v[112:115],v4 offset:15360
v_smfmac_f32_16x16x64_bf16 v[92:95],v[56:59],a[216:223],v2
s_waitcnt lgkmcnt(2)
v_smfmac_f32_16x16x64_bf16 v[96:99],v[56:59],v[100:107],v2
ds_read_b128 v[100:103],v4 offset:16384
v_smfmac_f32_16x16x64_bf16 v[80:83],v[60:63],a[224:231],v2
s_waitcnt vmcnt(2)
v_bitop3_b32 v12,v64,v68,s57 bitop3:0x7e
v_smfmac_f32_16x16x64_bf16 v[84:87],v[60:63],a[232:239],v2
v_and_b32 v12,1,v12
ds_read_b128 v[104:107],v4 offset:17408
v_smfmac_f32_16x16x64_bf16 v[88:91],v[60:63],a[240:247],v2
v_cmp_ne_u32 vcc,0,v12
v_smfmac_f32_16x16x64_bf16 v[92:95],v[60:63],a[248:255],v2
s_waitcnt lgkmcnt(2)
v_smfmac_f32_16x16x64_bf16 v[96:99],v[60:63],v[108:115],v2
s_cbranch_vccnz ws_194
wg_203:
v_smfmac_f32_16x16x64_bf16 v[80:83],v[64:67],v[128:135],v2
ds_read_b128 v[108:111],v4 offset:18432
v_smfmac_f32_16x16x64_bf16 v[84:87],v[64:67],v[136:143],v2
ds_read_b128 v[112:115],v4 offset:19456
v_smfmac_f32_16x16x64_bf16 v[88:91],v[64:67],v[144:151],v2
v_smfmac_f32_16x16x64_bf16 v[92:95],v[64:67],v[152:159],v2
s_waitcnt lgkmcnt(2)
v_smfmac_f32_16x16x64_bf16 v[96:99],v[64:67],v[100:107],v2
ds_read_b128 v[100:103],v4 offset:20480
v_smfmac_f32_16x16x64_bf16 v[80:83],v[68:71],v[160:167],v2
s_waitcnt vmcnt(0)
v_bitop3_b32 v12,v72,v76,s57 bitop3:0x7e
v_smfmac_f32_16x16x64_bf16 v[84:87],v[68:71],v[168:175],v2
v_and_b32 v12,1,v12
ds_read_b128 v[104:107],v4 offset:21504
v_smfmac_f32_16x16x64_bf16 v[88:91],v[68:71],v[176:183],v2
v_cmp_ne_u32 vcc,0,v12
v_smfmac_f32_16x16x64_bf16 v[92:95],v[68:71],v[184:191],v2
s_waitcnt lgkmcnt(2)
v_smfmac_f32_16x16x64_bf16 v[96:99],v[68:71],v[108:115],v2
s_cbranch_vccnz ws_195
wg_204:
v_smfmac_f32_16x16x64_bf16 v[80:83],v[72:75],v[192:199],v2
ds_read_b128 v[108:111],v4 offset:22528
v_smfmac_f32_16x16x64_bf16 v[80:83],v[76:79],v[224:231],v2
ds_read_b128 v[112:115],v4 offset:23552
v_smfmac_f32_16x16x64_bf16 v[84:87],v[72:75],v[200:207],v2
v_smfmac_f32_16x16x64_bf16 v[84:87],v[76:79],v[232:239],v2
v_smfmac_f32_16x16x64_bf16 v[88:91],v[72:75],v[208:215],v2
s_nop 3
v_add_f32 v80,v80,v81
v_smfmac_f32_16x16x64_bf16 v[88:91],v[76:79],v[240:247],v2
v_add_f32 v82,v82,v83
ds_write2_b32 v7,v80,v82 offset0:0 offset1:88
v_smfmac_f32_16x16x64_bf16 v[92:95],v[72:75],v[216:223],v2
v_add_f32 v84,v84,v85
v_smfmac_f32_16x16x64_bf16 v[92:95],v[76:79],v[248:255],v2
v_add_f32 v86,v86,v87
s_waitcnt lgkmcnt(3)
v_smfmac_f32_16x16x64_bf16 v[96:99],v[72:75],v[100:107],v2
ds_write2_b32 v7,v84,v86 offset0:16 offset1:104
s_waitcnt lgkmcnt(2)
v_smfmac_f32_16x16x64_bf16 v[96:99],v[76:79],v[108:115],v2
v_add_f32 v88,v88,v89
v_add_f32 v90,v90,v91
ds_write2_b32 v7,v88,v90 offset0:32 offset1:120
v_add_f32 v92,v92,v93
v_add_f32 v94,v94,v95
ds_write2_b32 v7,v92,v94 offset0:48 offset1:136
s_nop 1
v_add_f32 v96,v96,v97
v_add_f32 v98,v98,v99
ds_write2_b32 v7,v96,v98 offset0:64 offset1:152
s_waitcnt lgkmcnt(0)
s_barrier
ds_read_b128 v[32:35],v8 offset:0
ds_read_b128 v[36:39],v8 offset:2816
ds_read_b128 v[40:43],v8 offset:5632
ds_read_b128 v[44:47],v8 offset:8448
s_mov_b64 exec,1
buffer_store_dword v16,v1,s[8:11],s69 offen sc1
s_mov_b64 exec,-1
s_waitcnt lgkmcnt(2)
v_pk_add_f32 v[32:33],v[32:33],v[36:37]
v_pk_add_f32 v[34:35],v[34:35],v[38:39]
s_waitcnt lgkmcnt(0)
v_pk_add_f32 v[40:41],v[40:41],v[44:45]
v_pk_add_f32 v[42:43],v[42:43],v[46:47]
v_pk_add_f32 v[32:33],v[32:33],v[40:41]
v_pk_add_f32 v[34:35],v[34:35],v[42:43]
v_cvt_pk_bf16_f32 v32,v32,v33
v_cvt_pk_bf16_f32 v33,v34,v35
v_bfi_b32 v32,v10,s31,v32
s_nop 0
v_permlane32_swap_b32 v33,v35
v_permlane32_swap_b32 v32,v34
s_mov_b64 exec,s[88:89]
buffer_store_dwordx4 v[32:35],v9,s[8:11],s59 offen sc1
s_barrier
buffer_store_dwordx4 v[32:35],v9,s[8:11],s68 offen sc1
s_mov_b64 exec,-1
s_nop 0
CW_NEXT_S:
s_add_u32 s50,s50,1
s_cmp_lt_u32 s50,128
s_cbranch_scc1 CW_LOOP_S
s_branch CW_DONE
ws_187:
buffer_load_dwordx4 v[32:35],v1,s[8:11],s70 offen sc1
buffer_load_dwordx4 v[36:39],v1,s[8:11],s70 offen offset:1024 sc1
buffer_load_dwordx4 v[40:43],v1,s[8:11],s70 offen offset:2048 sc1
buffer_load_dwordx4 v[44:47],v1,s[8:11],s70 offen offset:3072 sc1
buffer_load_dwordx4 v[48:51],v1,s[8:11],s71 offen sc1
s_sub_u32 s47,s47,1
s_cbranch_scc1 ABORT
s_waitcnt vmcnt(4)
v_and_b32 v12,1,v32
v_cmp_ne_u32 vcc,s57,v12
s_nop 0
s_cbranch_vccnz ws_187
s_branch wg_196
ws_188:
buffer_load_dwordx4 v[36:39],v1,s[8:11],s70 offen offset:1024 sc1
buffer_load_dwordx4 v[40:43],v1,s[8:11],s70 offen offset:2048 sc1
buffer_load_dwordx4 v[44:47],v1,s[8:11],s70 offen offset:3072 sc1
buffer_load_dwordx4 v[48:51],v1,s[8:11],s71 offen sc1
buffer_load_dwordx4 v[52:55],v1,s[8:11],s71 offen offset:1024 sc1
s_sub_u32 s47,s47,1
s_cbranch_scc1 ABORT
s_waitcnt vmcnt(4)
v_and_b32 v12,1,v36
v_cmp_ne_u32 vcc,s57,v12
s_nop 0
s_cbranch_vccnz ws_188
s_branch wg_197
ws_189:
buffer_load_dwordx4 v[40:43],v1,s[8:11],s70 offen offset:2048 sc1
buffer_load_dwordx4 v[44:47],v1,s[8:11],s70 offen offset:3072 sc1
buffer_load_dwordx4 v[48:51],v1,s[8:11],s71 offen sc1
buffer_load_dwordx4 v[52:55],v1,s[8:11],s71 offen offset:1024 sc1
buffer_load_dwordx4 v[56:59],v1,s[8:11],s71 offen offset:2048 sc1
s_sub_u32 s47,s47,1
s_cbranch_scc1 ABORT
s_waitcnt vmcnt(4)
v_and_b32 v12,1,v40
v_cmp_ne_u32 vcc,s57,v12
s_nop 0
s_cbranch_vccnz ws_189
s_branch wg_198
ws_190:
buffer_load_dwordx4 v[44:47],v1,s[8:11],s70 offen offset:3072 sc1
buffer_load_dwordx4 v[48:51],v1,s[8:11],s71 offen sc1
buffer_load_dwordx4 v[52:55],v1,s[8:11],s71 offen offset:1024 sc1
buffer_load_dwordx4 v[56:59],v1,s[8:11],s71 offen offset:2048 sc1
buffer_load_dwordx4 v[60:63],v1,s[8:11],s71 offen offset:3072 sc1
s_sub_u32 s47,s47,1
s_cbranch_scc1 ABORT
s_waitcnt vmcnt(4)
v_and_b32 v12,1,v44
v_cmp_ne_u32 vcc,s57,v12
s_nop 0
s_cbranch_vccnz ws_190
s_branch wg_199
ws_191:
buffer_load_dwordx4 v[48:51],v1,s[8:11],s71 offen sc1
buffer_load_dwordx4 v[52:55],v1,s[8:11],s71 offen offset:1024 sc1
buffer_load_dwordx4 v[56:59],v1,s[8:11],s71 offen offset:2048 sc1
buffer_load_dwordx4 v[60:63],v1,s[8:11],s71 offen offset:3072 sc1
buffer_load_dwordx4 v[64:67],v1,s[8:11],s80 offen sc1
s_sub_u32 s47,s47,1
s_cbranch_scc1 ABORT
s_waitcnt vmcnt(4)
v_and_b32 v12,1,v48
v_cmp_ne_u32 vcc,s57,v12
s_nop 0
s_cbranch_vccnz ws_191
s_branch wg_200
ws_192:
buffer_load_dwordx4 v[52:55],v1,s[8:11],s71 offen offset:1024 sc1
buffer_load_dwordx4 v[56:59],v1,s[8:11],s71 offen offset:2048 sc1
buffer_load_dwordx4 v[60:63],v1,s[8:11],s71 offen offset:3072 sc1
buffer_load_dwordx4 v[64:67],v1,s[8:11],s80 offen sc1
buffer_load_dwordx4 v[68:71],v1,s[8:11],s80 offen offset:1024 sc1
s_sub_u32 s47,s47,1
s_cbranch_scc1 ABORT
s_waitcnt vmcnt(4)
v_and_b32 v12,1,v52
v_cmp_ne_u32 vcc,s57,v12
s_nop 0
s_cbranch_vccnz ws_192
s_branch wg_201
ws_193:
buffer_load_dwordx4 v[56:59],v1,s[8:11],s71 offen offset:2048 sc1
buffer_load_dwordx4 v[60:63],v1,s[8:11],s71 offen offset:3072 sc1
buffer_load_dwordx4 v[64:67],v1,s[8:11],s80 offen sc1
buffer_load_dwordx4 v[68:71],v1,s[8:11],s80 offen offset:1024 sc1
buffer_load_dwordx4 v[72:75],v1,s[8:11],s80 offen offset:2048 sc1
s_sub_u32 s47,s47,1
s_cbranch_scc1 ABORT
s_waitcnt vmcnt(3)
v_bitop3_b32 v12,v56,v60,s57 bitop3:0x7e
v_and_b32 v12,1,v12
v_cmp_ne_u32 vcc,0,v12
s_nop 0
s_cbranch_vccnz ws_193
s_branch wg_202
ws_194:
buffer_load_dwordx4 v[64:67],v1,s[8:11],s80 offen sc1
buffer_load_dwordx4 v[68:71],v1,s[8:11],s80 offen offset:1024 sc1
buffer_load_dwordx4 v[72:75],v1,s[8:11],s80 offen offset:2048 sc1
buffer_load_dwordx4 v[76:79],v1,s[8:11],s80 offen offset:3072 sc1
s_sub_u32 s47,s47,1
s_cbranch_scc1 ABORT
s_waitcnt vmcnt(2)
v_bitop3_b32 v12,v64,v68,s57 bitop3:0x7e
v_and_b32 v12,1,v12
v_cmp_ne_u32 vcc,0,v12
s_nop 0
s_cbranch_vccnz ws_194
s_branch wg_203
ws_195:
buffer_load_dwordx4 v[72:75],v1,s[8:11],s80 offen offset:2048 sc1
buffer_load_dwordx4 v[76:79],v1,s[8:11],s80 offen offset:3072 sc1
s_sub_u32 s47,s47,1
s_cbranch_scc1 ABORT
s_waitcnt vmcnt(0)
v_bitop3_b32 v12,v72,v76,s57 bitop3:0x7e
v_and_b32 v12,1,v12
v_cmp_ne_u32 vcc,0,v12
s_nop 0
s_cbranch_vccnz ws_195
s_branch wg_204
CW_DONE:
s_add_u32 s61,s48,48
s_endpgm
DISPATCH:
s_sub_u32 s48,s3,0
s_cmp_lt_u32 s3,16
s_cbranch_scc1 ROLE_CS
s_sub_u32 s48,s3,16
s_cmp_lt_u32 s3,24
s_cbranch_scc1 ROLE_CV
s_sub_u32 s48,s3,24
s_cmp_lt_u32 s3,32
s_cbranch_scc1 ROLE_CW
s_sub_u32 s48,s3,16
s_cmp_lt_u32 s3,48
s_cbranch_scc1 ROLE_CS
s_sub_u32 s48,s3,40
s_cmp_lt_u32 s3,56
s_cbranch_scc1 ROLE_CV
s_sub_u32 s48,s3,48
s_cmp_lt_u32 s3,64
s_cbranch_scc1 ROLE_CW
s_sub_u32 s48,s3,64
s_cmp_lt_u32 s3,74
s_cbranch_scc1 ROLE_W4
s_sub_u32 s48,s3,74
s_cmp_lt_u32 s3,79
s_cbranch_scc1 ROLE_W1
s_sub_u32 s48,s3,79
s_cmp_lt_u32 s3,91
s_cbranch_scc1 ROLE_W3
s_sub_u32 s48,s3,91
s_cmp_lt_u32 s3,96
s_cbranch_scc1 ROLE_W2
s_sub_u32 s48,s3,96
s_cmp_lt_u32 s3,104
s_cbranch_scc1 ROLE_QKVQ
s_sub_u32 s48,s3,104
s_cmp_lt_u32 s3,112
s_cbranch_scc1 ROLE_QKVV
s_sub_u32 s48,s3,112
s_cmp_lt_u32 s3,128
s_cbranch_scc1 ROLE_R1
s_sub_u32 s48,s3,128
s_cmp_lt_u32 s3,138
s_cbranch_scc1 ROLE_WO
s_sub_u32 s48,s3,138
s_cmp_lt_u32 s3,146
s_cbranch_scc1 ROLE_ATT
s_sub_u32 s48,s3,138
s_cmp_lt_u32 s3,156
s_cbranch_scc1 ROLE_QKVQ
s_sub_u32 s48,s3,148
s_cmp_lt_u32 s3,160
s_cbranch_scc1 ROLE_QKVV
s_sub_u32 s48,s3,150
s_cmp_lt_u32 s3,170
s_cbranch_scc1 ROLE_WO
s_sub_u32 s48,s3,162
s_cmp_lt_u32 s3,178
s_cbranch_scc1 ROLE_ATT
s_sub_u32 s48,s3,160
s_cmp_lt_u32 s3,188
s_cbranch_scc1 ROLE_QKVQ
s_sub_u32 s48,s3,176
s_cmp_lt_u32 s3,192
s_cbranch_scc1 ROLE_QKVV
s_sub_u32 s48,s3,172
s_cmp_lt_u32 s3,202
s_cbranch_scc1 ROLE_WO
s_sub_u32 s48,s3,186
s_cmp_lt_u32 s3,210
s_cbranch_scc1 ROLE_ATT
s_sub_u32 s48,s3,182
s_cmp_lt_u32 s3,220
s_cbranch_scc1 ROLE_QKVQ
s_sub_u32 s48,s3,204
s_cmp_lt_u32 s3,224
s_cbranch_scc1 ROLE_QKVV
s_sub_u32 s48,s3,194
s_cmp_lt_u32 s3,234
s_cbranch_scc1 ROLE_WO
s_sub_u32 s48,s3,210
s_cmp_lt_u32 s3,242
s_cbranch_scc1 ROLE_ATT
s_sub_u32 s48,s3,204
s_cmp_lt_u32 s3,252
s_cbranch_scc1 ROLE_QKVQ
s_sub_u32 s48,s3,232
s_cmp_lt_u32 s3,256
s_cbranch_scc1 ROLE_QKVV
s_branch ROLE_SPARE
EXIT:
s_endpgm
ABORT:
s_mov_b64 exec,1
v_mov_b32 v1,s2
v_add_u32 v1,0x10000,v1
v_mov_b32 v2,8
buffer_store_dword v1,v2,s[12:15],0 offen
s_endpgm
ROLE_SPARE:
s_waitcnt vmcnt(0)
s_barrier
s_cmp_lg_u32 s46,0
s_cbranch_scc1 arr_205
v_mov_b32 v12,1
s_lshl_b32 s3,s49,2
v_mov_b32 v13,s3
s_mov_b64 exec,1
buffer_atomic_add v12,v13,s[12:15],0 offen sc1
s_mov_b64 exec,-1
arr_205:
s_lshl_b32 s3,s49,2
v_mov_b32 v13,s3
s_nop 1
ibw_206:
buffer_load_dword v12,v13,s[12:15],0 offen sc1
s_waitcnt vmcnt(0)
v_cmp_ne_u32 vcc,256,v12
s_nop 0
s_cbranch_vccz ok_207
s_sleep 8
s_sub_u32 s47,s47,1
s_cbranch_scc1 ABORT
s_branch ibw_206
ok_207:
s_cmp_lg_u32 s49,0
s_cbranch_scc1 ibok_208
v_and_b32 v13,7,v0
v_lshlrev_b32 v13,2,v13
buffer_load_dword v12,v13,s[12:15],0 offen offset:32 sc1
s_waitcnt vmcnt(0)
v_cmp_ne_u32 vcc,32,v12
s_nop 0
s_cbranch_vccz ibok_208
s_barrier
s_mov_b32 s49,1
s_mov_b32 s3,s2
s_load_dwordx16 s[16:31],s[0:1],0
s_load_dwordx8 s[32:39],s[0:1],64
s_waitcnt lgkmcnt(0)
s_branch DISPATCH
ibok_208:
s_endpgm
ROLE_QKVQ:
v_lshlrev_b32 v1,4,v0
v_mov_b32 v5,1
s_lshl_b32 s56,s48,2
s_add_u32 s56,s56,s46
v_bfe_u32 v6,v0,2,2
v_lshrrev_b32 v7,4,v0
v_add_u32 v7,v6,v7
v_and_b32 v7,3,v7
v_and_b32 v15,3,v0
v_lshlrev_b32 v15,4,v15
v_lshl_add_u32 v15,v7,6,v15
v_lshl_add_u32 v15,v6,8,v15
v_lshrrev_b32 v6,5,v0
v_bfe_u32 v7,v0,4,1
v_lshlrev_b32 v16,10,v7
v_bfe_u32 v7,v0,2,2
v_lshl_add_u32 v16,v7,8,v16
v_add_u32 v6,v6,v7
v_and_b32 v6,3,v6
v_lshl_add_u32 v16,v6,6,v16
v_and_b32 v6,3,v0
v_lshl_add_u32 v16,v6,4,v16
v_add_u32 v18,46080,v16
v_lshrrev_b32 v6,5,v0
v_bfe_u32 v7,v0,4,1
v_lshlrev_b32 v20,10,v7
v_lshl_add_u32 v20,v6,8,v20
v_and_b32 v6,15,v0
v_lshl_add_u32 v20,v6,4,v20
v_lshrrev_b32 v6,5,v0
v_add_u32 v6,2,v6
v_bfe_u32 v7,v0,4,1
v_lshlrev_b32 v17,10,v7
v_bfe_u32 v7,v0,2,2
v_lshl_add_u32 v17,v7,8,v17
v_add_u32 v6,v6,v7
v_and_b32 v6,3,v6
v_lshl_add_u32 v17,v6,6,v17
v_and_b32 v6,3,v0
v_lshl_add_u32 v17,v6,4,v17
v_add_u32 v19,46080,v17
v_lshrrev_b32 v6,5,v0
v_add_u32 v6,2,v6
v_bfe_u32 v7,v0,4,1
v_lshlrev_b32 v21,10,v7
v_lshl_add_u32 v21,v6,8,v21
v_and_b32 v6,15,v0
v_lshl_add_u32 v21,v6,4,v21
s_cmp_ge_u32 s48,24
s_cselect_b32 s68,1,0
s_mul_i32 s60,s68,96
s_sub_u32 s69,s56,s60
s_mul_i32 s70,s68,50331648
s_add_u32 s70,s70,74448896
s_mul_i32 s60,s68,65536
s_sub_u32 s71,131072,s60
s_lshl_b32 s60,s69,12
s_add_u32 s70,s70,s60
v_lshrrev_b32 v6,5,v0
v_mul_u32_u24 v188,2560,v6
v_and_b32 v6,31,v0
v_lshl_add_u32 v188,v6,3,v188
v_add_u32 v188,0xa000,v188
v_min_u32 v12,7,v0
v_lshlrev_b32 v12,2,v12
v_min_u32 v13,39,v0
v_lshlrev_b32 v13,2,v13
v_mov_b32 v14,93184
s_waitcnt vmcnt(0)
s_barrier
s_cmp_lg_u32 s46,0
s_cbranch_scc1 arr_209
v_mov_b32 v6,1
s_lshl_b32 s3,s49,2
v_mov_b32 v7,s3
s_mov_b64 exec,1
buffer_atomic_add v6,v7,s[12:15],0 offen sc1
s_mov_b64 exec,-1
arr_209:
s_lshl_b32 s58,s69,7
s_mul_i32 s63,s46,40960
s_cmp_eq_u32 s68,0
s_cselect_b32 s4,s22,s20
s_cselect_b32 s5,s23,s21
s_mov_b32 s6,7864320
s_mov_b32 s7,0x20000
v_lshrrev_b32 v9,3,v0
s_mov_b32 s64,12288
v_mul_lo_u32 v9,v9,s64
v_and_b32 v10,7,v0
v_lshl_add_u32 v6,v10,4,v9
s_add_u32 m0,s63,0
s_add_u32 s65,s58,0
buffer_load_dwordx4 v6,s[4:7],s65 offen lds
s_add_u32 m0,s63,1024
s_add_u32 s65,s58,98304
buffer_load_dwordx4 v6,s[4:7],s65 offen lds
s_add_u32 m0,s63,2048
s_add_u32 s65,s58,196608
buffer_load_dwordx4 v6,s[4:7],s65 offen lds
s_add_u32 m0,s63,3072
s_add_u32 s65,s58,294912
buffer_load_dwordx4 v6,s[4:7],s65 offen lds
s_add_u32 m0,s63,4096
s_add_u32 s65,s58,393216
buffer_load_dwordx4 v6,s[4:7],s65 offen lds
s_add_u32 m0,s63,5120
s_add_u32 s65,s58,491520
buffer_load_dwordx4 v6,s[4:7],s65 offen lds
s_add_u32 m0,s63,6144
s_add_u32 s65,s58,589824
buffer_load_dwordx4 v6,s[4:7],s65 offen lds
s_add_u32 m0,s63,7168
s_add_u32 s65,s58,688128
buffer_load_dwordx4 v6,s[4:7],s65 offen lds
s_add_u32 m0,s63,8192
s_add_u32 s65,s58,786432
buffer_load_dwordx4 v6,s[4:7],s65 offen lds
s_add_u32 m0,s63,9216
s_add_u32 s65,s58,884736
buffer_load_dwordx4 v6,s[4:7],s65 offen lds
s_add_u32 m0,s63,10240
s_add_u32 s65,s58,983040
buffer_load_dwordx4 v6,s[4:7],s65 offen lds
s_add_u32 m0,s63,11264
s_add_u32 s65,s58,1081344
buffer_load_dwordx4 v6,s[4:7],s65 offen lds
s_add_u32 m0,s63,12288
s_add_u32 s65,s58,1179648
buffer_load_dwordx4 v6,s[4:7],s65 offen lds
s_add_u32 m0,s63,13312
s_add_u32 s65,s58,1277952
buffer_load_dwordx4 v6,s[4:7],s65 offen lds
s_add_u32 m0,s63,14336
s_add_u32 s65,s58,1376256
buffer_load_dwordx4 v6,s[4:7],s65 offen lds
s_add_u32 m0,s63,15360
s_add_u32 s65,s58,1474560
buffer_load_dwordx4 v6,s[4:7],s65 offen lds
s_add_u32 m0,s63,16384
s_add_u32 s65,s58,1572864
buffer_load_dwordx4 v6,s[4:7],s65 offen lds
s_add_u32 m0,s63,17408
s_add_u32 s65,s58,1671168
buffer_load_dwordx4 v6,s[4:7],s65 offen lds
s_add_u32 m0,s63,18432
s_add_u32 s65,s58,1769472
buffer_load_dwordx4 v6,s[4:7],s65 offen lds
s_add_u32 m0,s63,19456
s_add_u32 s65,s58,1867776
buffer_load_dwordx4 v6,s[4:7],s65 offen lds
s_add_u32 m0,s63,20480
s_add_u32 s65,s58,1966080
buffer_load_dwordx4 v6,s[4:7],s65 offen lds
s_add_u32 m0,s63,21504
s_add_u32 s65,s58,2064384
buffer_load_dwordx4 v6,s[4:7],s65 offen lds
s_add_u32 m0,s63,22528
s_add_u32 s65,s58,2162688
buffer_load_dwordx4 v6,s[4:7],s65 offen lds
s_add_u32 m0,s63,23552
s_add_u32 s65,s58,2260992
buffer_load_dwordx4 v6,s[4:7],s65 offen lds
s_add_u32 m0,s63,24576
s_add_u32 s65,s58,2359296
buffer_load_dwordx4 v6,s[4:7],s65 offen lds
s_add_u32 m0,s63,25600
s_add_u32 s65,s58,2457600
buffer_load_dwordx4 v6,s[4:7],s65 offen lds
s_add_u32 m0,s63,26624
s_add_u32 s65,s58,2555904
buffer_load_dwordx4 v6,s[4:7],s65 offen lds
s_add_u32 m0,s63,27648
s_add_u32 s65,s58,2654208
buffer_load_dwordx4 v6,s[4:7],s65 offen lds
s_add_u32 m0,s63,28672
s_add_u32 s65,s58,2752512
buffer_load_dwordx4 v6,s[4:7],s65 offen lds
s_add_u32 m0,s63,29696
s_add_u32 s65,s58,2850816
buffer_load_dwordx4 v6,s[4:7],s65 offen lds
s_add_u32 m0,s63,30720
s_add_u32 s65,s58,2949120
buffer_load_dwordx4 v6,s[4:7],s65 offen lds
s_add_u32 m0,s63,31744
s_add_u32 s65,s58,3047424
buffer_load_dwordx4 v6,s[4:7],s65 offen lds
s_add_u32 m0,s63,32768
s_add_u32 s65,s58,3145728
buffer_load_dwordx4 v6,s[4:7],s65 offen lds
s_add_u32 m0,s63,33792
s_add_u32 s65,s58,3244032
buffer_load_dwordx4 v6,s[4:7],s65 offen lds
s_add_u32 m0,s63,34816
s_add_u32 s65,s58,3342336
buffer_load_dwordx4 v6,s[4:7],s65 offen lds
s_add_u32 m0,s63,35840
s_add_u32 s65,s58,3440640
buffer_load_dwordx4 v6,s[4:7],s65 offen lds
s_add_u32 m0,s63,36864
s_add_u32 s65,s58,3538944
buffer_load_dwordx4 v6,s[4:7],s65 offen lds
s_add_u32 m0,s63,37888
s_add_u32 s65,s58,3637248
buffer_load_dwordx4 v6,s[4:7],s65 offen lds
s_add_u32 m0,s63,38912
s_add_u32 s65,s58,3735552
buffer_load_dwordx4 v6,s[4:7],s65 offen lds
s_add_u32 m0,s63,39936
s_add_u32 s65,s58,3833856
buffer_load_dwordx4 v6,s[4:7],s65 offen lds
s_waitcnt vmcnt(20)
v_bfe_u32 v9,v0,2,2
v_lshrrev_b32 v10,5,v0
v_lshl_add_u32 v9,v10,2,v9
v_mul_u32_u24 v9,128,v9
v_and_b32 v10,1,v0
v_lshl_add_u32 v9,v10,3,v9
v_bfe_u32 v10,v0,1,1
v_lshl_add_u32 v9,v10,5,v9
v_bfe_u32 v10,v0,4,1
v_lshl_add_u32 v9,v10,4,v9
v_add_u32 v7,s63,v9
ds_read_b64_tr_b16 a[0:1],v7 offset:0
ds_read_b64_tr_b16 a[2:3],v7 offset:2048
ds_read_b64_tr_b16 a[4:5],v7 offset:1024
ds_read_b64_tr_b16 a[6:7],v7 offset:3072
ds_read_b64_tr_b16 a[160:161],v7 offset:64
ds_read_b64_tr_b16 a[162:163],v7 offset:2112
ds_read_b64_tr_b16 a[164:165],v7 offset:1088
ds_read_b64_tr_b16 a[166:167],v7 offset:3136
ds_read_b64_tr_b16 a[8:9],v7 offset:4096
ds_read_b64_tr_b16 a[10:11],v7 offset:6144
ds_read_b64_tr_b16 a[12:13],v7 offset:5120
ds_read_b64_tr_b16 a[14:15],v7 offset:7168
s_waitcnt lgkmcnt(4)
ds_read_b64_tr_b16 a[168:169],v7 offset:4160
ds_read_b64_tr_b16 a[170:171],v7 offset:6208
ds_read_b64_tr_b16 a[172:173],v7 offset:5184
ds_read_b64_tr_b16 a[174:175],v7 offset:7232
ds_read_b64_tr_b16 a[16:17],v7 offset:8192
ds_read_b64_tr_b16 a[18:19],v7 offset:10240
ds_read_b64_tr_b16 a[20:21],v7 offset:9216
ds_read_b64_tr_b16 a[22:23],v7 offset:11264
ds_read_b64_tr_b16 a[176:177],v7 offset:8256
ds_read_b64_tr_b16 a[178:179],v7 offset:10304
ds_read_b64_tr_b16 a[180:181],v7 offset:9280
ds_read_b64_tr_b16 a[182:183],v7 offset:11328
s_waitcnt lgkmcnt(4)
ds_read_b64_tr_b16 a[24:25],v7 offset:12288
ds_read_b64_tr_b16 a[26:27],v7 offset:14336
ds_read_b64_tr_b16 a[28:29],v7 offset:13312
ds_read_b64_tr_b16 a[30:31],v7 offset:15360
ds_read_b64_tr_b16 a[184:185],v7 offset:12352
ds_read_b64_tr_b16 a[186:187],v7 offset:14400
ds_read_b64_tr_b16 a[188:189],v7 offset:13376
ds_read_b64_tr_b16 a[190:191],v7 offset:15424
ds_read_b64_tr_b16 a[32:33],v7 offset:16384
ds_read_b64_tr_b16 a[34:35],v7 offset:18432
ds_read_b64_tr_b16 a[36:37],v7 offset:17408
ds_read_b64_tr_b16 a[38:39],v7 offset:19456
s_waitcnt lgkmcnt(4)
ds_read_b64_tr_b16 a[192:193],v7 offset:16448
ds_read_b64_tr_b16 a[194:195],v7 offset:18496
ds_read_b64_tr_b16 a[196:197],v7 offset:17472
ds_read_b64_tr_b16 a[198:199],v7 offset:19520
s_waitcnt lgkmcnt(0)
s_add_u32 m0,s63,0
s_add_u32 s65,s58,3932160
buffer_load_dwordx4 v6,s[4:7],s65 offen lds
s_add_u32 m0,s63,1024
s_add_u32 s65,s58,4030464
buffer_load_dwordx4 v6,s[4:7],s65 offen lds
s_add_u32 m0,s63,2048
s_add_u32 s65,s58,4128768
buffer_load_dwordx4 v6,s[4:7],s65 offen lds
s_add_u32 m0,s63,3072
s_add_u32 s65,s58,4227072
buffer_load_dwordx4 v6,s[4:7],s65 offen lds
s_add_u32 m0,s63,4096
s_add_u32 s65,s58,4325376
buffer_load_dwordx4 v6,s[4:7],s65 offen lds
s_add_u32 m0,s63,5120
s_add_u32 s65,s58,4423680
buffer_load_dwordx4 v6,s[4:7],s65 offen lds
s_add_u32 m0,s63,6144
s_add_u32 s65,s58,4521984
buffer_load_dwordx4 v6,s[4:7],s65 offen lds
s_add_u32 m0,s63,7168
s_add_u32 s65,s58,4620288
buffer_load_dwordx4 v6,s[4:7],s65 offen lds
s_add_u32 m0,s63,8192
s_add_u32 s65,s58,4718592
buffer_load_dwordx4 v6,s[4:7],s65 offen lds
s_add_u32 m0,s63,9216
s_add_u32 s65,s58,4816896
buffer_load_dwordx4 v6,s[4:7],s65 offen lds
s_add_u32 m0,s63,10240
s_add_u32 s65,s58,4915200
buffer_load_dwordx4 v6,s[4:7],s65 offen lds
s_add_u32 m0,s63,11264
s_add_u32 s65,s58,5013504
buffer_load_dwordx4 v6,s[4:7],s65 offen lds
s_add_u32 m0,s63,12288
s_add_u32 s65,s58,5111808
buffer_load_dwordx4 v6,s[4:7],s65 offen lds
s_add_u32 m0,s63,13312
s_add_u32 s65,s58,5210112
buffer_load_dwordx4 v6,s[4:7],s65 offen lds
s_add_u32 m0,s63,14336
s_add_u32 s65,s58,5308416
buffer_load_dwordx4 v6,s[4:7],s65 offen lds
s_add_u32 m0,s63,15360
s_add_u32 s65,s58,5406720
buffer_load_dwordx4 v6,s[4:7],s65 offen lds
s_add_u32 m0,s63,16384
s_add_u32 s65,s58,5505024
buffer_load_dwordx4 v6,s[4:7],s65 offen lds
s_add_u32 m0,s63,17408
s_add_u32 s65,s58,5603328
buffer_load_dwordx4 v6,s[4:7],s65 offen lds
s_add_u32 m0,s63,18432
s_add_u32 s65,s58,5701632
buffer_load_dwordx4 v6,s[4:7],s65 offen lds
s_add_u32 m0,s63,19456
s_add_u32 s65,s58,5799936
buffer_load_dwordx4 v6,s[4:7],s65 offen lds
s_waitcnt vmcnt(20)
v_bfe_u32 v9,v0,2,2
v_lshrrev_b32 v10,5,v0
v_lshl_add_u32 v9,v10,2,v9
v_mul_u32_u24 v9,128,v9
v_and_b32 v10,1,v0
v_lshl_add_u32 v9,v10,3,v9
v_bfe_u32 v10,v0,1,1
v_lshl_add_u32 v9,v10,5,v9
v_bfe_u32 v10,v0,4,1
v_lshl_add_u32 v9,v10,4,v9
v_add_u32 v7,s63,v9
ds_read_b64_tr_b16 a[40:41],v7 offset:20480
ds_read_b64_tr_b16 a[42:43],v7 offset:22528
ds_read_b64_tr_b16 a[44:45],v7 offset:21504
ds_read_b64_tr_b16 a[46:47],v7 offset:23552
ds_read_b64_tr_b16 a[200:201],v7 offset:20544
ds_read_b64_tr_b16 a[202:203],v7 offset:22592
ds_read_b64_tr_b16 a[204:205],v7 offset:21568
ds_read_b64_tr_b16 a[206:207],v7 offset:23616
ds_read_b64_tr_b16 a[48:49],v7 offset:24576
ds_read_b64_tr_b16 a[50:51],v7 offset:26624
ds_read_b64_tr_b16 a[52:53],v7 offset:25600
ds_read_b64_tr_b16 a[54:55],v7 offset:27648
s_waitcnt lgkmcnt(4)
ds_read_b64_tr_b16 a[208:209],v7 offset:24640
ds_read_b64_tr_b16 a[210:211],v7 offset:26688
ds_read_b64_tr_b16 a[212:213],v7 offset:25664
ds_read_b64_tr_b16 a[214:215],v7 offset:27712
ds_read_b64_tr_b16 a[56:57],v7 offset:28672
ds_read_b64_tr_b16 a[58:59],v7 offset:30720
ds_read_b64_tr_b16 a[60:61],v7 offset:29696
ds_read_b64_tr_b16 a[62:63],v7 offset:31744
ds_read_b64_tr_b16 a[216:217],v7 offset:28736
ds_read_b64_tr_b16 a[218:219],v7 offset:30784
ds_read_b64_tr_b16 a[220:221],v7 offset:29760
ds_read_b64_tr_b16 a[222:223],v7 offset:31808
s_waitcnt lgkmcnt(4)
ds_read_b64_tr_b16 a[64:65],v7 offset:32768
ds_read_b64_tr_b16 a[66:67],v7 offset:34816
ds_read_b64_tr_b16 a[68:69],v7 offset:33792
ds_read_b64_tr_b16 a[70:71],v7 offset:35840
ds_read_b64_tr_b16 a[224:225],v7 offset:32832
ds_read_b64_tr_b16 a[226:227],v7 offset:34880
ds_read_b64_tr_b16 a[228:229],v7 offset:33856
ds_read_b64_tr_b16 a[230:231],v7 offset:35904
ds_read_b64_tr_b16 a[72:73],v7 offset:36864
ds_read_b64_tr_b16 a[74:75],v7 offset:38912
ds_read_b64_tr_b16 a[76:77],v7 offset:37888
ds_read_b64_tr_b16 a[78:79],v7 offset:39936
s_waitcnt lgkmcnt(4)
ds_read_b64_tr_b16 a[232:233],v7 offset:36928
ds_read_b64_tr_b16 a[234:235],v7 offset:38976
ds_read_b64_tr_b16 a[236:237],v7 offset:37952
ds_read_b64_tr_b16 a[238:239],v7 offset:40000
s_waitcnt lgkmcnt(0)
s_add_u32 m0,s63,20480
s_add_u32 s65,s58,5898240
buffer_load_dwordx4 v6,s[4:7],s65 offen lds
s_add_u32 m0,s63,21504
s_add_u32 s65,s58,5996544
buffer_load_dwordx4 v6,s[4:7],s65 offen lds
s_add_u32 m0,s63,22528
s_add_u32 s65,s58,6094848
buffer_load_dwordx4 v6,s[4:7],s65 offen lds
s_add_u32 m0,s63,23552
s_add_u32 s65,s58,6193152
buffer_load_dwordx4 v6,s[4:7],s65 offen lds
s_add_u32 m0,s63,24576
s_add_u32 s65,s58,6291456
buffer_load_dwordx4 v6,s[4:7],s65 offen lds
s_add_u32 m0,s63,25600
s_add_u32 s65,s58,6389760
buffer_load_dwordx4 v6,s[4:7],s65 offen lds
s_add_u32 m0,s63,26624
s_add_u32 s65,s58,6488064
buffer_load_dwordx4 v6,s[4:7],s65 offen lds
s_add_u32 m0,s63,27648
s_add_u32 s65,s58,6586368
buffer_load_dwordx4 v6,s[4:7],s65 offen lds
s_add_u32 m0,s63,28672
s_add_u32 s65,s58,6684672
buffer_load_dwordx4 v6,s[4:7],s65 offen lds
s_add_u32 m0,s63,29696
s_add_u32 s65,s58,6782976
buffer_load_dwordx4 v6,s[4:7],s65 offen lds
s_add_u32 m0,s63,30720
s_add_u32 s65,s58,6881280
buffer_load_dwordx4 v6,s[4:7],s65 offen lds
s_add_u32 m0,s63,31744
s_add_u32 s65,s58,6979584
buffer_load_dwordx4 v6,s[4:7],s65 offen lds
s_add_u32 m0,s63,32768
s_add_u32 s65,s58,7077888
buffer_load_dwordx4 v6,s[4:7],s65 offen lds
s_add_u32 m0,s63,33792
s_add_u32 s65,s58,7176192
buffer_load_dwordx4 v6,s[4:7],s65 offen lds
s_add_u32 m0,s63,34816
s_add_u32 s65,s58,7274496
buffer_load_dwordx4 v6,s[4:7],s65 offen lds
s_add_u32 m0,s63,35840
s_add_u32 s65,s58,7372800
buffer_load_dwordx4 v6,s[4:7],s65 offen lds
s_add_u32 m0,s63,36864
s_add_u32 s65,s58,7471104
buffer_load_dwordx4 v6,s[4:7],s65 offen lds
s_add_u32 m0,s63,37888
s_add_u32 s65,s58,7569408
buffer_load_dwordx4 v6,s[4:7],s65 offen lds
s_add_u32 m0,s63,38912
s_add_u32 s65,s58,7667712
buffer_load_dwordx4 v6,s[4:7],s65 offen lds
s_add_u32 m0,s63,39936
s_add_u32 s65,s58,7766016
buffer_load_dwordx4 v6,s[4:7],s65 offen lds
s_waitcnt vmcnt(20)
v_bfe_u32 v9,v0,2,2
v_lshrrev_b32 v10,5,v0
v_lshl_add_u32 v9,v10,2,v9
v_mul_u32_u24 v9,128,v9
v_and_b32 v10,1,v0
v_lshl_add_u32 v9,v10,3,v9
v_bfe_u32 v10,v0,1,1
v_lshl_add_u32 v9,v10,5,v9
v_bfe_u32 v10,v0,4,1
v_lshl_add_u32 v9,v10,4,v9
v_add_u32 v7,s63,v9
ds_read_b64_tr_b16 a[80:81],v7 offset:0
ds_read_b64_tr_b16 a[82:83],v7 offset:2048
ds_read_b64_tr_b16 a[84:85],v7 offset:1024
ds_read_b64_tr_b16 a[86:87],v7 offset:3072
ds_read_b64_tr_b16 a[240:241],v7 offset:64
ds_read_b64_tr_b16 a[242:243],v7 offset:2112
ds_read_b64_tr_b16 a[244:245],v7 offset:1088
ds_read_b64_tr_b16 a[246:247],v7 offset:3136
ds_read_b64_tr_b16 a[88:89],v7 offset:4096
ds_read_b64_tr_b16 a[90:91],v7 offset:6144
ds_read_b64_tr_b16 a[92:93],v7 offset:5120
ds_read_b64_tr_b16 a[94:95],v7 offset:7168
s_waitcnt lgkmcnt(4)
ds_read_b64_tr_b16 a[248:249],v7 offset:4160
ds_read_b64_tr_b16 a[250:251],v7 offset:6208
ds_read_b64_tr_b16 a[252:253],v7 offset:5184
ds_read_b64_tr_b16 a[254:255],v7 offset:7232
ds_read_b64_tr_b16 a[96:97],v7 offset:8192
ds_read_b64_tr_b16 a[98:99],v7 offset:10240
ds_read_b64_tr_b16 a[100:101],v7 offset:9216
ds_read_b64_tr_b16 a[102:103],v7 offset:11264
ds_read_b64_tr_b16 v[192:193],v7 offset:8256
ds_read_b64_tr_b16 v[194:195],v7 offset:10304
ds_read_b64_tr_b16 v[196:197],v7 offset:9280
ds_read_b64_tr_b16 v[198:199],v7 offset:11328
s_waitcnt lgkmcnt(4)
ds_read_b64_tr_b16 a[104:105],v7 offset:12288
ds_read_b64_tr_b16 a[106:107],v7 offset:14336
ds_read_b64_tr_b16 a[108:109],v7 offset:13312
ds_read_b64_tr_b16 a[110:111],v7 offset:15360
ds_read_b64_tr_b16 v[200:201],v7 offset:12352
ds_read_b64_tr_b16 v[202:203],v7 offset:14400
ds_read_b64_tr_b16 v[204:205],v7 offset:13376
ds_read_b64_tr_b16 v[206:207],v7 offset:15424
ds_read_b64_tr_b16 a[112:113],v7 offset:16384
ds_read_b64_tr_b16 a[114:115],v7 offset:18432
ds_read_b64_tr_b16 a[116:117],v7 offset:17408
ds_read_b64_tr_b16 a[118:119],v7 offset:19456
s_waitcnt lgkmcnt(4)
ds_read_b64_tr_b16 v[208:209],v7 offset:16448
ds_read_b64_tr_b16 v[210:211],v7 offset:18496
ds_read_b64_tr_b16 v[212:213],v7 offset:17472
ds_read_b64_tr_b16 v[214:215],v7 offset:19520
s_waitcnt lgkmcnt(0)
s_waitcnt vmcnt(0)
v_bfe_u32 v9,v0,2,2
v_lshrrev_b32 v10,5,v0
v_lshl_add_u32 v9,v10,2,v9
v_mul_u32_u24 v9,128,v9
v_and_b32 v10,1,v0
v_lshl_add_u32 v9,v10,3,v9
v_bfe_u32 v10,v0,1,1
v_lshl_add_u32 v9,v10,5,v9
v_bfe_u32 v10,v0,4,1
v_lshl_add_u32 v9,v10,4,v9
v_add_u32 v7,s63,v9
ds_read_b64_tr_b16 a[120:121],v7 offset:20480
ds_read_b64_tr_b16 a[122:123],v7 offset:22528
ds_read_b64_tr_b16 a[124:125],v7 offset:21504
ds_read_b64_tr_b16 a[126:127],v7 offset:23552
ds_read_b64_tr_b16 v[216:217],v7 offset:20544
ds_read_b64_tr_b16 v[218:219],v7 offset:22592
ds_read_b64_tr_b16 v[220:221],v7 offset:21568
ds_read_b64_tr_b16 v[222:223],v7 offset:23616
ds_read_b64_tr_b16 a[128:129],v7 offset:24576
ds_read_b64_tr_b16 a[130:131],v7 offset:26624
ds_read_b64_tr_b16 a[132:133],v7 offset:25600
ds_read_b64_tr_b16 a[134:135],v7 offset:27648
s_waitcnt lgkmcnt(4)
ds_read_b64_tr_b16 v[224:225],v7 offset:24640
ds_read_b64_tr_b16 v[226:227],v7 offset:26688
ds_read_b64_tr_b16 v[228:229],v7 offset:25664
ds_read_b64_tr_b16 v[230:231],v7 offset:27712
ds_read_b64_tr_b16 a[136:137],v7 offset:28672
ds_read_b64_tr_b16 a[138:139],v7 offset:30720
ds_read_b64_tr_b16 a[140:141],v7 offset:29696
ds_read_b64_tr_b16 a[142:143],v7 offset:31744
ds_read_b64_tr_b16 v[232:233],v7 offset:28736
ds_read_b64_tr_b16 v[234:235],v7 offset:30784
ds_read_b64_tr_b16 v[236:237],v7 offset:29760
ds_read_b64_tr_b16 v[238:239],v7 offset:31808
s_waitcnt lgkmcnt(4)
ds_read_b64_tr_b16 a[144:145],v7 offset:32768
ds_read_b64_tr_b16 a[146:147],v7 offset:34816
ds_read_b64_tr_b16 a[148:149],v7 offset:33792
ds_read_b64_tr_b16 a[150:151],v7 offset:35840
ds_read_b64_tr_b16 v[240:241],v7 offset:32832
ds_read_b64_tr_b16 v[242:243],v7 offset:34880
ds_read_b64_tr_b16 v[244:245],v7 offset:33856
ds_read_b64_tr_b16 v[246:247],v7 offset:35904
ds_read_b64_tr_b16 a[152:153],v7 offset:36864
ds_read_b64_tr_b16 a[154:155],v7 offset:38912
ds_read_b64_tr_b16 a[156:157],v7 offset:37888
ds_read_b64_tr_b16 a[158:159],v7 offset:39936
s_waitcnt lgkmcnt(4)
ds_read_b64_tr_b16 v[248:249],v7 offset:36928
ds_read_b64_tr_b16 v[250:251],v7 offset:38976
ds_read_b64_tr_b16 v[252:253],v7 offset:37952
ds_read_b64_tr_b16 v[254:255],v7 offset:40000
s_waitcnt lgkmcnt(0)
v_mov_b32 v24,0x3f803f80
v_mov_b32 v25,0x3f803f80
v_mov_b32 v26,0x3f803f80
v_mov_b32 v27,0x3f803f80
s_nop 1
v_mfma_f32_32x32x16_bf16 v[120:135],a[0:3],v[24:27],0
v_mfma_f32_32x32x16_bf16 v[136:151],a[160:163],v[24:27],0
v_mfma_f32_32x32x16_bf16 v[120:135],a[4:7],v[24:27],v[120:135]
v_mfma_f32_32x32x16_bf16 v[136:151],a[164:167],v[24:27],v[136:151]
v_mfma_f32_32x32x16_bf16 v[120:135],a[8:11],v[24:27],v[120:135]
v_mfma_f32_32x32x16_bf16 v[136:151],a[168:171],v[24:27],v[136:151]
v_mfma_f32_32x32x16_bf16 v[120:135],a[12:15],v[24:27],v[120:135]
v_mfma_f32_32x32x16_bf16 v[136:151],a[172:175],v[24:27],v[136:151]
v_mfma_f32_32x32x16_bf16 v[120:135],a[16:19],v[24:27],v[120:135]
v_mfma_f32_32x32x16_bf16 v[136:151],a[176:179],v[24:27],v[136:151]
v_mfma_f32_32x32x16_bf16 v[120:135],a[20:23],v[24:27],v[120:135]
v_mfma_f32_32x32x16_bf16 v[136:151],a[180:183],v[24:27],v[136:151]
v_mfma_f32_32x32x16_bf16 v[120:135],a[24:27],v[24:27],v[120:135]
v_mfma_f32_32x32x16_bf16 v[136:151],a[184:187],v[24:27],v[136:151]
v_mfma_f32_32x32x16_bf16 v[120:135],a[28:31],v[24:27],v[120:135]
v_mfma_f32_32x32x16_bf16 v[136:151],a[188:191],v[24:27],v[136:151]
v_mfma_f32_32x32x16_bf16 v[120:135],a[32:35],v[24:27],v[120:135]
v_mfma_f32_32x32x16_bf16 v[136:151],a[192:195],v[24:27],v[136:151]
v_mfma_f32_32x32x16_bf16 v[120:135],a[36:39],v[24:27],v[120:135]
v_mfma_f32_32x32x16_bf16 v[136:151],a[196:199],v[24:27],v[136:151]
v_mfma_f32_32x32x16_bf16 v[120:135],a[40:43],v[24:27],v[120:135]
v_mfma_f32_32x32x16_bf16 v[136:151],a[200:203],v[24:27],v[136:151]
v_mfma_f32_32x32x16_bf16 v[120:135],a[44:47],v[24:27],v[120:135]
v_mfma_f32_32x32x16_bf16 v[136:151],a[204:207],v[24:27],v[136:151]
v_mfma_f32_32x32x16_bf16 v[120:135],a[48:51],v[24:27],v[120:135]
v_mfma_f32_32x32x16_bf16 v[136:151],a[208:211],v[24:27],v[136:151]
v_mfma_f32_32x32x16_bf16 v[120:135],a[52:55],v[24:27],v[120:135]
v_mfma_f32_32x32x16_bf16 v[136:151],a[212:215],v[24:27],v[136:151]
v_mfma_f32_32x32x16_bf16 v[120:135],a[56:59],v[24:27],v[120:135]
v_mfma_f32_32x32x16_bf16 v[136:151],a[216:219],v[24:27],v[136:151]
v_mfma_f32_32x32x16_bf16 v[120:135],a[60:63],v[24:27],v[120:135]
v_mfma_f32_32x32x16_bf16 v[136:151],a[220:223],v[24:27],v[136:151]
v_mfma_f32_32x32x16_bf16 v[120:135],a[64:67],v[24:27],v[120:135]
v_mfma_f32_32x32x16_bf16 v[136:151],a[224:227],v[24:27],v[136:151]
v_mfma_f32_32x32x16_bf16 v[120:135],a[68:71],v[24:27],v[120:135]
v_mfma_f32_32x32x16_bf16 v[136:151],a[228:231],v[24:27],v[136:151]
v_mfma_f32_32x32x16_bf16 v[120:135],a[72:75],v[24:27],v[120:135]
v_mfma_f32_32x32x16_bf16 v[136:151],a[232:235],v[24:27],v[136:151]
v_mfma_f32_32x32x16_bf16 v[120:135],a[76:79],v[24:27],v[120:135]
v_mfma_f32_32x32x16_bf16 v[136:151],a[236:239],v[24:27],v[136:151]
v_mfma_f32_32x32x16_bf16 v[120:135],a[80:83],v[24:27],v[120:135]
v_mfma_f32_32x32x16_bf16 v[136:151],a[240:243],v[24:27],v[136:151]
v_mfma_f32_32x32x16_bf16 v[120:135],a[84:87],v[24:27],v[120:135]
v_mfma_f32_32x32x16_bf16 v[136:151],a[244:247],v[24:27],v[136:151]
v_mfma_f32_32x32x16_bf16 v[120:135],a[88:91],v[24:27],v[120:135]
v_mfma_f32_32x32x16_bf16 v[136:151],a[248:251],v[24:27],v[136:151]
v_mfma_f32_32x32x16_bf16 v[120:135],a[92:95],v[24:27],v[120:135]
v_mfma_f32_32x32x16_bf16 v[136:151],a[252:255],v[24:27],v[136:151]
v_mfma_f32_32x32x16_bf16 v[120:135],a[96:99],v[24:27],v[120:135]
v_mfma_f32_32x32x16_bf16 v[136:151],v[192:195],v[24:27],v[136:151]
v_mfma_f32_32x32x16_bf16 v[120:135],a[100:103],v[24:27],v[120:135]
v_mfma_f32_32x32x16_bf16 v[136:151],v[196:199],v[24:27],v[136:151]
v_mfma_f32_32x32x16_bf16 v[120:135],a[104:107],v[24:27],v[120:135]
v_mfma_f32_32x32x16_bf16 v[136:151],v[200:203],v[24:27],v[136:151]
v_mfma_f32_32x32x16_bf16 v[120:135],a[108:111],v[24:27],v[120:135]
v_mfma_f32_32x32x16_bf16 v[136:151],v[204:207],v[24:27],v[136:151]
v_mfma_f32_32x32x16_bf16 v[120:135],a[112:115],v[24:27],v[120:135]
v_mfma_f32_32x32x16_bf16 v[136:151],v[208:211],v[24:27],v[136:151]
v_mfma_f32_32x32x16_bf16 v[120:135],a[116:119],v[24:27],v[120:135]
v_mfma_f32_32x32x16_bf16 v[136:151],v[212:215],v[24:27],v[136:151]
v_mfma_f32_32x32x16_bf16 v[120:135],a[120:123],v[24:27],v[120:135]
v_mfma_f32_32x32x16_bf16 v[136:151],v[216:219],v[24:27],v[136:151]
v_mfma_f32_32x32x16_bf16 v[120:135],a[124:127],v[24:27],v[120:135]
v_mfma_f32_32x32x16_bf16 v[136:151],v[220:223],v[24:27],v[136:151]
v_mfma_f32_32x32x16_bf16 v[120:135],a[128:131],v[24:27],v[120:135]
v_mfma_f32_32x32x16_bf16 v[136:151],v[224:227],v[24:27],v[136:151]
v_mfma_f32_32x32x16_bf16 v[120:135],a[132:135],v[24:27],v[120:135]
v_mfma_f32_32x32x16_bf16 v[136:151],v[228:231],v[24:27],v[136:151]
v_mfma_f32_32x32x16_bf16 v[120:135],a[136:139],v[24:27],v[120:135]
v_mfma_f32_32x32x16_bf16 v[136:151],v[232:235],v[24:27],v[136:151]
v_mfma_f32_32x32x16_bf16 v[120:135],a[140:143],v[24:27],v[120:135]
v_mfma_f32_32x32x16_bf16 v[136:151],v[236:239],v[24:27],v[136:151]
v_mfma_f32_32x32x16_bf16 v[120:135],a[144:147],v[24:27],v[120:135]
v_mfma_f32_32x32x16_bf16 v[136:151],v[240:243],v[24:27],v[136:151]
v_mfma_f32_32x32x16_bf16 v[120:135],a[148:151],v[24:27],v[120:135]
v_mfma_f32_32x32x16_bf16 v[136:151],v[244:247],v[24:27],v[136:151]
v_mfma_f32_32x32x16_bf16 v[120:135],a[152:155],v[24:27],v[120:135]
v_mfma_f32_32x32x16_bf16 v[136:151],v[248:251],v[24:27],v[136:151]
v_mfma_f32_32x32x16_bf16 v[120:135],a[156:159],v[24:27],v[120:135]
v_mfma_f32_32x32x16_bf16 v[136:151],v[252:255],v[24:27],v[136:151]
s_barrier
s_lshl_b32 s3,s49,2
v_mov_b32 v7,s3
s_nop 8
ibw_210:
buffer_load_dword v6,v7,s[12:15],0 offen sc1
s_waitcnt vmcnt(0)
v_cmp_ne_u32 vcc,256,v6
s_nop 0
s_cbranch_vccz ok_211
s_sleep 8
s_sub_u32 s47,s47,1
s_cbranch_scc1 ABORT
s_branch ibw_210
ok_211:
s_cmp_lg_u32 s49,0
s_cbranch_scc1 ibok_212
v_and_b32 v7,7,v0
v_lshlrev_b32 v7,2,v7
buffer_load_dword v6,v7,s[12:15],0 offen offset:32 sc1
s_waitcnt vmcnt(0)
v_cmp_ne_u32 vcc,32,v6
s_nop 0
s_cbranch_vccz ibok_212
s_barrier
s_mov_b32 s49,1
s_mov_b32 s3,s2
s_load_dwordx16 s[16:31],s[0:1],0
s_load_dwordx8 s[32:39],s[0:1],64
s_waitcnt lgkmcnt(0)
s_branch DISPATCH
ibok_212:
s_mov_b32 s50,0
s_mov_b32 s32,0
s_mov_b32 s57,0
s_mov_b32 s59,2147483648
s_mov_b32 s82,2147483648
s_mov_b32 s39,2147483648
v_mov_b32 v22,94208
s_mov_b32 s72,0
s_mov_b32 s73,0
s_mov_b32 s83,s100
s_min_u32 s62,s32,127
s_sub_u32 s60,s62,20
s_lshr_b32 s34,s60,1
s_and_b32 s33,s60,1
s_xor_b32 s33,s33,1
s_cmp_eq_u32 s33,0
s_cselect_b32 s61,20,0
s_add_u32 s34,s34,s61
s_sub_u32 s61,s60,44
s_cmp_ge_u32 s60,88
s_cselect_b32 s34,s61,s34
s_cselect_b32 s33,1,s33
s_cmp_lt_u32 s62,20
s_cselect_b32 s34,s62,s34
s_cselect_b32 s33,0,s33
s_lshl_b32 s35,s33,6
s_add_u32 s35,s35,s34
s_lshl_b32 s35,s35,9
s_add_u32 s35,s35,0
s_lshl_b32 s60,s33,5
s_add_u32 s60,s60,7
v_min_u32 v2,s60,v0
v_lshlrev_b32 v2,2,v2
s_nop 1
QKVQ_COLD0:
s_cmp_lg_u32 s46,0
s_cbranch_scc1 cp_213
fb_214:
buffer_load_dword v3,v2,s[8:11],s35 offen sc1
s_waitcnt vmcnt(0)
v_cmp_eq_u32 vcc,0,v3
s_nop 0
s_cbranch_vccz ok_215
s_sleep 7
s_sub_u32 s47,s47,1
s_cbranch_scc1 ABORT
s_branch fb_214
ok_215:
cp_213:
s_barrier
s_lshl_b32 s60,s33,6
s_add_u32 s60,s60,s34
s_mul_i32 s60,s60,46080
s_add_u32 s60,s60,206569472
s_lshl_b32 s62,s46,10
s_add_u32 s62,s62,40960
s_add_u32 m0,s57,s62
s_add_u32 s63,s60,s62
buffer_load_dwordx4 v1,s[8:11],s63 offen sc1 lds
s_add_u32 m0,s57,45056
s_add_u32 s63,s60,45056
buffer_load_dwordx4 v1,s[8:11],s63 offen sc1 lds
s_mul_i32 s61,s46,10240
s_add_u32 s60,s60,s61
s_add_u32 s61,s61,s57
s_add_u32 m0,s61,0
s_add_u32 s63,s60,0
buffer_load_dwordx4 v1,s[8:11],s63 offen sc1 lds
buffer_load_dwordx4 v1,s[8:11],s63 offen offset:1024 sc1 lds
buffer_load_dwordx4 v1,s[8:11],s63 offen offset:2048 sc1 lds
buffer_load_dwordx4 v1,s[8:11],s63 offen offset:3072 sc1 lds
s_add_u32 m0,s61,4096
s_add_u32 s63,s60,4096
buffer_load_dwordx4 v1,s[8:11],s63 offen sc1 lds
buffer_load_dwordx4 v1,s[8:11],s63 offen offset:1024 sc1 lds
buffer_load_dwordx4 v1,s[8:11],s63 offen offset:2048 sc1 lds
buffer_load_dwordx4 v1,s[8:11],s63 offen offset:3072 sc1 lds
s_add_u32 m0,s61,8192
s_add_u32 s63,s60,8192
buffer_load_dwordx4 v1,s[8:11],s63 offen sc1 lds
buffer_load_dwordx4 v1,s[8:11],s63 offen offset:1024 sc1 lds
QKVQ_CD0:
s_mov_b32 s51,s33
s_mov_b32 s52,s34
s_add_u32 s32,s32,1
s_min_u32 s62,s32,127
s_sub_u32 s60,s62,20
s_lshr_b32 s34,s60,1
s_and_b32 s33,s60,1
s_xor_b32 s33,s33,1
s_cmp_eq_u32 s33,0
s_cselect_b32 s61,20,0
s_add_u32 s34,s34,s61
s_sub_u32 s61,s60,44
s_cmp_ge_u32 s60,88
s_cselect_b32 s34,s61,s34
s_cselect_b32 s33,1,s33
s_cmp_lt_u32 s62,20
s_cselect_b32 s34,s62,s34
s_cselect_b32 s33,0,s33
s_lshl_b32 s35,s33,6
s_add_u32 s35,s35,s34
s_lshl_b32 s35,s35,9
s_add_u32 s35,s35,0
s_lshl_b32 s60,s33,5
s_add_u32 s60,s60,7
v_min_u32 v2,s60,v0
v_lshlrev_b32 v2,2,v2
s_cmp_lg_u32 s46,0
s_cbranch_scc1 w0_216
buffer_load_dword v3,v2,s[8:11],s35 offen sc1
w0_216:
s_waitcnt vmcnt(0)
s_mov_b64 exec,1
buffer_store_dword v5,v1,s[8:11],s59 offen sc1
s_mov_b64 exec,-1
s_mov_b32 s59,2147483648
s_cmp_lg_u32 s46,0
s_cbranch_scc1 w0_217
v_cmp_eq_u32 vcc,0,v3
s_cmp_eq_u64 vcc,0
s_cselect_b32 s36,0,2147483648
s_cmp_lt_u32 s32,128
s_cselect_b32 s36,s36,2147483648
v_mov_b32 v23,s36
ds_write_b32 v22,v23
w0_217:
s_waitcnt lgkmcnt(0)
s_barrier
ds_read_b32 v23,v22
ds_read_b128 v[24:27],v16 offset:0
ds_read_b128 v[28:31],v17 offset:0
ds_read_b128 v[32:35],v16 offset:2048
ds_read_b128 v[36:39],v17 offset:2048
ds_read_b128 v[40:43],v16 offset:4096
s_waitcnt lgkmcnt(5)
v_readfirstlane_b32 s37,v23
s_nop 4
QKVQ_B0:
s_waitcnt lgkmcnt(3)
v_mfma_f32_32x32x16_bf16 v[56:71],a[0:3],v[24:27],0
ds_read_b128 v[44:47],v17 offset:4096
v_add_u32 v189,s57,v188
v_mfma_f32_32x32x16_bf16 v[72:87],a[160:163],v[24:27],0
v_add_u32 v8,0x800,v189
s_sub_u32 s66,46080,s57
s_lshl_b32 s60,s33,6
s_add_u32 s60,s60,s34
s_mul_i32 s60,s60,46080
s_add_u32 s60,s60,s37
v_mfma_f32_32x32x16_bf16 v[56:71],a[4:7],v[28:31],v[56:71]
ds_read_b128 v[48:51],v16 offset:6144
ds_read2_b64 v[156:159],v189 offset0:0 offset1:32
s_add_u32 s60,s60,206569472
s_lshl_b32 s62,s46,10
v_mfma_f32_32x32x16_bf16 v[72:87],a[164:167],v[28:31],v[72:87]
ds_read2_b64 v[160:163],v189 offset0:64 offset1:96
s_add_u32 s62,s62,40960
s_add_u32 m0,s66,s62
s_add_u32 s63,s60,s62
s_waitcnt lgkmcnt(5)
v_mfma_f32_32x32x16_bf16 v[56:71],a[8:11],v[32:35],v[56:71]
ds_read_b128 v[52:55],v17 offset:6144
ds_read2_b64 v[164:167],v189 offset0:128 offset1:160
buffer_load_dwordx4 v1,s[8:11],s63 offen sc1 lds
v_mfma_f32_32x32x16_bf16 v[72:87],a[168:171],v[32:35],v[72:87]
ds_read2_b64 v[168:171],v189 offset0:192 offset1:224
s_add_u32 m0,s66,45056
s_add_u32 s63,s60,45056
s_mul_i32 s74,s73,393216
s_add_u32 s74,s74,s39
v_mfma_f32_32x32x16_bf16 v[56:71],a[12:15],v[36:39],v[56:71]
ds_read_b128 v[24:27],v16 offset:8192
ds_read2_b64 v[172:175],v8 offset0:0 offset1:32
s_add_u32 s74,s74,s70
v_fma_f32 v88,-v176,v120,v88
v_mfma_f32_32x32x16_bf16 v[72:87],a[172:175],v[36:39],v[72:87]
buffer_load_dwordx4 v1,s[8:11],s63 offen sc1 lds
s_mul_i32 s61,s46,10240
s_add_u32 s60,s60,s61
s_add_u32 s61,s61,s66
s_waitcnt lgkmcnt(8)
v_mfma_f32_32x32x16_bf16 v[56:71],a[16:19],v[40:43],v[56:71]
ds_read_b128 v[28:31],v17 offset:8192
s_add_u32 m0,s61,0
s_add_u32 s63,s60,0
v_fma_f32 v89,-v176,v121,v89
v_fma_f32 v90,-v176,v122,v90
v_mfma_f32_32x32x16_bf16 v[72:87],a[176:179],v[40:43],v[72:87]
v_fma_f32 v91,-v176,v123,v91
v_fma_f32 v92,-v176,v124,v92
v_fma_f32 v93,-v176,v125,v93
v_fma_f32 v94,-v176,v126,v94
v_fma_f32 v95,-v176,v127,v95
v_mfma_f32_32x32x16_bf16 v[56:71],a[20:23],v[44:47],v[56:71]
ds_read_b128 v[32:35],v16 offset:10240
buffer_load_dwordx4 v1,s[8:11],s63 offen sc1 lds
v_mul_f32 v88,v88,v177
v_mul_f32 v89,v89,v177
v_mfma_f32_32x32x16_bf16 v[72:87],a[180:183],v[44:47],v[72:87]
v_mul_f32 v90,v90,v177
v_mul_f32 v91,v91,v177
v_mul_f32 v92,v92,v177
v_mul_f32 v93,v93,v177
v_mul_f32 v94,v94,v177
s_waitcnt lgkmcnt(6)
v_mfma_f32_32x32x16_bf16 v[56:71],a[24:27],v[48:51],v[56:71]
ds_read_b128 v[36:39],v17 offset:10240
v_mul_f32 v95,v95,v177
v_cvt_pk_bf16_f32 v180,v88,v89
v_cvt_pk_bf16_f32 v181,v90,v91
v_cvt_pk_bf16_f32 v182,v92,v93
v_mfma_f32_32x32x16_bf16 v[72:87],a[184:187],v[48:51],v[72:87]
buffer_load_dwordx4 v1,s[8:11],s63 offen offset:1024 sc1 lds
v_cvt_pk_bf16_f32 v183,v94,v95
buffer_store_dwordx4 v[180:183],v20,s[8:11],s74 offen sc1
v_fma_f32 v96,-v176,v128,v96
v_mfma_f32_32x32x16_bf16 v[56:71],a[28:31],v[52:55],v[56:71]
ds_read_b128 v[40:43],v16 offset:12288
v_fma_f32 v97,-v176,v129,v97
v_fma_f32 v98,-v176,v130,v98
v_fma_f32 v99,-v176,v131,v99
v_fma_f32 v100,-v176,v132,v100
v_mfma_f32_32x32x16_bf16 v[72:87],a[188:191],v[52:55],v[72:87]
v_fma_f32 v101,-v176,v133,v101
v_fma_f32 v102,-v176,v134,v102
v_fma_f32 v103,-v176,v135,v103
v_mul_f32 v96,v96,v177
v_mul_f32 v97,v97,v177
s_waitcnt lgkmcnt(3)
v_mfma_f32_32x32x16_bf16 v[56:71],a[32:35],v[24:27],v[56:71]
ds_read_b128 v[44:47],v17 offset:12288
buffer_load_dwordx4 v1,s[8:11],s63 offen offset:2048 sc1 lds
v_mul_f32 v98,v98,v177
v_mul_f32 v99,v99,v177
v_mfma_f32_32x32x16_bf16 v[72:87],a[192:195],v[24:27],v[72:87]
v_mul_f32 v100,v100,v177
v_mul_f32 v101,v101,v177
v_mul_f32 v102,v102,v177
v_mul_f32 v103,v103,v177
v_cvt_pk_bf16_f32 v184,v96,v97
v_mfma_f32_32x32x16_bf16 v[56:71],a[36:39],v[28:31],v[56:71]
ds_read_b128 v[48:51],v16 offset:14336
v_cvt_pk_bf16_f32 v185,v98,v99
v_cvt_pk_bf16_f32 v186,v100,v101
v_cvt_pk_bf16_f32 v187,v102,v103
v_mfma_f32_32x32x16_bf16 v[72:87],a[196:199],v[28:31],v[72:87]
buffer_load_dwordx4 v1,s[8:11],s63 offen offset:3072 sc1 lds
s_add_u32 m0,s61,4096
s_add_u32 s63,s60,4096
s_waitcnt lgkmcnt(3)
v_mfma_f32_32x32x16_bf16 v[56:71],a[40:43],v[32:35],v[56:71]
ds_read_b128 v[52:55],v17 offset:14336
buffer_store_dwordx4 v[184:187],v21,s[8:11],s74 offen sc1
v_fma_f32 v104,-v176,v136,v104
v_fma_f32 v105,-v176,v137,v105
v_mfma_f32_32x32x16_bf16 v[72:87],a[200:203],v[32:35],v[72:87]
v_fma_f32 v106,-v176,v138,v106
v_fma_f32 v107,-v176,v139,v107
v_fma_f32 v108,-v176,v140,v108
v_fma_f32 v109,-v176,v141,v109
v_fma_f32 v110,-v176,v142,v110
v_mfma_f32_32x32x16_bf16 v[56:71],a[44:47],v[36:39],v[56:71]
ds_read_b128 v[24:27],v16 offset:16384
buffer_load_dwordx4 v1,s[8:11],s63 offen sc1 lds
v_fma_f32 v111,-v176,v143,v111
v_mul_f32 v104,v104,v177
v_mfma_f32_32x32x16_bf16 v[72:87],a[204:207],v[36:39],v[72:87]
v_mul_f32 v105,v105,v177
v_mul_f32 v106,v106,v177
v_mul_f32 v107,v107,v177
v_mul_f32 v108,v108,v177
v_mul_f32 v109,v109,v177
s_waitcnt lgkmcnt(3)
v_mfma_f32_32x32x16_bf16 v[56:71],a[48:51],v[40:43],v[56:71]
ds_read_b128 v[28:31],v17 offset:16384
v_mul_f32 v110,v110,v177
v_mul_f32 v111,v111,v177
v_cvt_pk_bf16_f32 v180,v104,v105
v_cvt_pk_bf16_f32 v181,v106,v107
v_mfma_f32_32x32x16_bf16 v[72:87],a[208:211],v[40:43],v[72:87]
buffer_load_dwordx4 v1,s[8:11],s63 offen offset:1024 sc1 lds
v_cvt_pk_bf16_f32 v182,v108,v109
v_cvt_pk_bf16_f32 v183,v110,v111
buffer_store_dwordx4 v[180:183],v20,s[8:11],s74 offen offset:2048 sc1
v_mfma_f32_32x32x16_bf16 v[56:71],a[52:55],v[44:47],v[56:71]
ds_read_b128 v[32:35],v16 offset:18432
v_fma_f32 v112,-v176,v144,v112
v_fma_f32 v113,-v176,v145,v113
v_fma_f32 v114,-v176,v146,v114
v_fma_f32 v115,-v176,v147,v115
v_mfma_f32_32x32x16_bf16 v[72:87],a[212:215],v[44:47],v[72:87]
v_fma_f32 v116,-v176,v148,v116
v_fma_f32 v117,-v176,v149,v117
v_fma_f32 v118,-v176,v150,v118
v_fma_f32 v119,-v176,v151,v119
v_mul_f32 v112,v112,v177
s_waitcnt lgkmcnt(3)
v_mfma_f32_32x32x16_bf16 v[56:71],a[56:59],v[48:51],v[56:71]
ds_read_b128 v[36:39],v17 offset:18432
buffer_load_dwordx4 v1,s[8:11],s63 offen offset:2048 sc1 lds
v_mul_f32 v113,v113,v177
v_mul_f32 v114,v114,v177
v_mfma_f32_32x32x16_bf16 v[72:87],a[216:219],v[48:51],v[72:87]
v_mul_f32 v115,v115,v177
v_mul_f32 v116,v116,v177
v_mul_f32 v117,v117,v177
v_mul_f32 v118,v118,v177
v_mul_f32 v119,v119,v177
v_mfma_f32_32x32x16_bf16 v[56:71],a[60:63],v[52:55],v[56:71]
ds_read_b128 v[40:43],v16 offset:20480
s_waitcnt vmcnt(12)
s_mov_b64 exec,1
buffer_store_dword v5,v1,s[8:11],s59 offen sc1
s_mov_b64 exec,-1
s_mov_b32 s59,2147483648
v_mfma_f32_32x32x16_bf16 v[72:87],a[220:223],v[52:55],v[72:87]
buffer_load_dwordx4 v1,s[8:11],s63 offen offset:3072 sc1 lds
s_add_u32 m0,s61,8192
s_add_u32 s63,s60,8192
v_cvt_pk_bf16_f32 v184,v112,v113
s_waitcnt lgkmcnt(3)
v_mfma_f32_32x32x16_bf16 v[56:71],a[64:67],v[24:27],v[56:71]
ds_read_b128 v[44:47],v17 offset:20480
v_cvt_pk_bf16_f32 v185,v114,v115
v_cvt_pk_bf16_f32 v186,v116,v117
v_cvt_pk_bf16_f32 v187,v118,v119
v_mfma_f32_32x32x16_bf16 v[72:87],a[224:227],v[24:27],v[72:87]
buffer_store_dwordx4 v[184:187],v21,s[8:11],s74 offen offset:2048 sc1
s_lshl_b32 s82,s72,6
s_add_u32 s82,s82,s73
s_lshl_b32 s82,s82,9
s_add_u32 s82,s82,s71
v_mfma_f32_32x32x16_bf16 v[56:71],a[68:71],v[28:31],v[56:71]
ds_read_b128 v[48:51],v16 offset:22528
buffer_load_dwordx4 v1,s[8:11],s63 offen sc1 lds
s_lshl_b32 s75,s69,2
s_add_u32 s82,s82,s75
v_mfma_f32_32x32x16_bf16 v[72:87],a[228:231],v[28:31],v[72:87]
s_add_u32 s82,s82,s39
v_add_f32 v156,v156,v166
v_add_f32 v157,v157,v167
v_add_f32 v158,v158,v168
s_waitcnt lgkmcnt(3)
v_mfma_f32_32x32x16_bf16 v[56:71],a[72:75],v[32:35],v[56:71]
ds_read_b128 v[52:55],v17 offset:22528
v_add_f32 v159,v159,v169
v_add_f32 v160,v160,v170
v_add_f32 v161,v161,v171
v_add_f32 v162,v162,v172
v_mfma_f32_32x32x16_bf16 v[72:87],a[232:235],v[32:35],v[72:87]
buffer_load_dwordx4 v1,s[8:11],s63 offen offset:1024 sc1 lds
s_mov_b32 s53,s33
s_mov_b32 s54,s34
s_cmp_eq_u32 s37,0
s_addc_u32 s32,s32,0
v_mfma_f32_32x32x16_bf16 v[56:71],a[76:79],v[36:39],v[56:71]
ds_read_b128 v[24:27],v16 offset:24576
s_min_u32 s62,s32,127
s_sub_u32 s60,s62,20
s_lshr_b32 s34,s60,1
s_and_b32 s33,s60,1
v_mfma_f32_32x32x16_bf16 v[72:87],a[236:239],v[36:39],v[72:87]
s_xor_b32 s33,s33,1
s_cmp_eq_u32 s33,0
s_cselect_b32 s61,20,0
s_add_u32 s34,s34,s61
s_sub_u32 s61,s60,44
s_waitcnt lgkmcnt(3)
v_mfma_f32_32x32x16_bf16 v[56:71],a[80:83],v[40:43],v[56:71]
ds_read_b128 v[28:31],v17 offset:24576
s_cmp_ge_u32 s60,88
s_cselect_b32 s34,s61,s34
s_cselect_b32 s33,1,s33
v_add_f32 v163,v163,v173
v_mfma_f32_32x32x16_bf16 v[72:87],a[240:243],v[40:43],v[72:87]
s_cmp_lt_u32 s62,20
s_cselect_b32 s34,s62,s34
s_cselect_b32 s33,0,s33
s_lshl_b32 s35,s33,6
s_add_u32 s35,s35,s34
s_lshl_b32 s35,s35,9
v_mfma_f32_32x32x16_bf16 v[56:71],a[84:87],v[44:47],v[56:71]
ds_read_b128 v[32:35],v16 offset:26624
s_add_u32 s35,s35,0
s_lshl_b32 s60,s33,5
s_add_u32 s60,s60,7
v_min_u32 v2,s60,v0
v_mfma_f32_32x32x16_bf16 v[72:87],a[244:247],v[44:47],v[72:87]
v_lshlrev_b32 v2,2,v2
v_add_f32 v164,v164,v174
v_add_f32 v165,v165,v175
v_add_f32 v156,v156,v158
v_add_f32 v157,v157,v159
s_waitcnt lgkmcnt(3)
v_mfma_f32_32x32x16_bf16 v[56:71],a[88:91],v[48:51],v[56:71]
ds_read_b128 v[36:39],v17 offset:26624
s_cmp_lg_u32 s46,0
s_cbranch_scc1 w0_218
buffer_load_dword v3,v2,s[8:11],s35 offen sc1
w0_218:
v_mfma_f32_32x32x16_bf16 v[72:87],a[248:251],v[48:51],v[72:87]
v_add_f32 v160,v160,v162
v_add_f32 v161,v161,v163
v_add_f32 v156,v156,v160
v_add_f32 v157,v157,v161
v_add_f32 v156,v156,v164
v_mfma_f32_32x32x16_bf16 v[56:71],a[92:95],v[52:55],v[56:71]
ds_read_b128 v[40:43],v16 offset:28672
v_add_f32 v157,v157,v165
v_mov_b32 v158,v156
v_mov_b32 v159,v157
s_nop 0
v_permlane32_swap_b32 v156,v158
v_mfma_f32_32x32x16_bf16 v[72:87],a[252:255],v[52:55],v[72:87]
v_permlane32_swap_b32 v157,v159
v_add_f32 v176,v156,v158
v_add_f32 v177,v157,v159
v_mul_f32 v176,0x3acccccd,v176
v_mul_f32 v177,0x3acccccd,v177
s_waitcnt lgkmcnt(3)
v_mfma_f32_32x32x16_bf16 v[56:71],a[96:99],v[24:27],v[56:71]
ds_read_b128 v[44:47],v17 offset:28672
v_fma_f32 v177,-v176,v176,v177
v_max_f32 v177,0,v177
v_cvt_pk_bf16_f32 v8,v176,v177
v_lshlrev_b32 v176,16,v8
v_mfma_f32_32x32x16_bf16 v[72:87],v[192:195],v[24:27],v[72:87]
v_and_b32 v177,0xffff0000,v8
v_add_f32 v177,0x3727c5ac,v177
v_cvt_pk_bf16_f32 v8,v177,v177
v_lshlrev_b32 v177,16,v8
v_sqrt_f32 v177,v177
v_mfma_f32_32x32x16_bf16 v[56:71],a[100:103],v[28:31],v[56:71]
ds_read_b128 v[48:51],v16 offset:30720
v_cvt_pk_bf16_f32 v8,v177,v177
v_lshlrev_b32 v177,16,v8
v_rcp_f32 v177,v177
v_mfma_f32_32x32x16_bf16 v[72:87],v[196:199],v[28:31],v[72:87]
s_cmp_eq_u32 s51,0
s_cselect_b64 s[76:77],-1,0
v_cndmask_b32 v176,v176,0,s[76:77]
v_cndmask_b32 v177,v177,1.0,s[76:77]
s_mov_b32 s72,s51
s_waitcnt lgkmcnt(3)
v_mfma_f32_32x32x16_bf16 v[56:71],a[104:107],v[32:35],v[56:71]
ds_read_b128 v[52:55],v17 offset:30720
s_mov_b32 s73,s52
v_mfma_f32_32x32x16_bf16 v[72:87],v[200:203],v[32:35],v[72:87]
v_mfma_f32_32x32x16_bf16 v[56:71],a[108:111],v[36:39],v[56:71]
ds_read_b128 v[24:27],v16 offset:32768
v_mfma_f32_32x32x16_bf16 v[72:87],v[204:207],v[36:39],v[72:87]
s_waitcnt lgkmcnt(3)
v_mfma_f32_32x32x16_bf16 v[56:71],a[112:115],v[40:43],v[56:71]
ds_read_b128 v[28:31],v17 offset:32768
v_mfma_f32_32x32x16_bf16 v[72:87],v[208:211],v[40:43],v[72:87]
v_mfma_f32_32x32x16_bf16 v[56:71],a[116:119],v[44:47],v[56:71]
ds_read_b128 v[32:35],v16 offset:34816
v_mfma_f32_32x32x16_bf16 v[72:87],v[212:215],v[44:47],v[72:87]
s_waitcnt lgkmcnt(3)
v_mfma_f32_32x32x16_bf16 v[56:71],a[120:123],v[48:51],v[56:71]
ds_read_b128 v[36:39],v17 offset:34816
v_mfma_f32_32x32x16_bf16 v[72:87],v[216:219],v[48:51],v[72:87]
v_mfma_f32_32x32x16_bf16 v[56:71],a[124:127],v[52:55],v[56:71]
ds_read_b128 v[40:43],v16 offset:36864
v_mfma_f32_32x32x16_bf16 v[72:87],v[220:223],v[52:55],v[72:87]
s_waitcnt vmcnt(0)
s_cmp_lg_u32 s46,0
s_cbranch_scc1 w0_219
v_cmp_eq_u32 vcc,0,v3
s_cmp_eq_u64 vcc,0
s_cselect_b32 s36,0,2147483648
s_cmp_lt_u32 s32,128
s_cselect_b32 s36,s36,2147483648
v_mov_b32 v23,s36
ds_write_b32 v22,v23
w0_219:
s_waitcnt lgkmcnt(3)
v_mfma_f32_32x32x16_bf16 v[56:71],a[128:131],v[24:27],v[56:71]
ds_read_b128 v[44:47],v17 offset:36864
s_mov_b64 exec,1
buffer_store_dword v5,v1,s[8:11],s82 offen sc1
s_mov_b64 exec,-1
s_mov_b32 s82,2147483648
v_mfma_f32_32x32x16_bf16 v[72:87],v[224:227],v[24:27],v[72:87]
v_mfma_f32_32x32x16_bf16 v[56:71],a[132:135],v[28:31],v[56:71]
ds_read_b128 v[48:51],v16 offset:38912
v_mfma_f32_32x32x16_bf16 v[72:87],v[228:231],v[28:31],v[72:87]
s_waitcnt lgkmcnt(3)
v_mfma_f32_32x32x16_bf16 v[56:71],a[136:139],v[32:35],v[56:71]
ds_read_b128 v[52:55],v17 offset:38912
v_mfma_f32_32x32x16_bf16 v[72:87],v[232:235],v[32:35],v[72:87]
s_waitcnt lgkmcnt(2)
s_barrier
ds_read_b32 v23,v22
v_mfma_f32_32x32x16_bf16 v[56:71],a[140:143],v[36:39],v[56:71]
ds_read_b128 v[24:27],v18 offset:0
v_mfma_f32_32x32x16_bf16 v[72:87],v[236:239],v[36:39],v[72:87]
v_mfma_f32_32x32x16_bf16 v[56:71],a[144:147],v[40:43],v[56:71]
ds_read_b128 v[28:31],v19 offset:0
v_mfma_f32_32x32x16_bf16 v[72:87],v[240:243],v[40:43],v[72:87]
v_mfma_f32_32x32x16_bf16 v[56:71],a[148:151],v[44:47],v[56:71]
ds_read_b128 v[32:35],v18 offset:2048
v_mfma_f32_32x32x16_bf16 v[72:87],v[244:247],v[44:47],v[72:87]
s_waitcnt lgkmcnt(4)
v_mfma_f32_32x32x16_bf16 v[56:71],a[152:155],v[48:51],v[56:71]
ds_read_b128 v[36:39],v19 offset:2048
s_waitcnt lgkmcnt(4)
v_readfirstlane_b32 s38,v23
v_mfma_f32_32x32x16_bf16 v[72:87],v[248:251],v[48:51],v[72:87]
v_mfma_f32_32x32x16_bf16 v[56:71],a[156:159],v[52:55],v[56:71]
ds_read_b128 v[40:43],v18 offset:4096
v_mfma_f32_32x32x16_bf16 v[72:87],v[252:255],v[52:55],v[72:87]
s_cmp_lg_u32 s37,0
s_cbranch_scc1 nf_220
s_cmp_lt_u32 s50,2
s_cbranch_scc1 now_221
s_mov_b32 s39,0
s_add_u32 s50,s50,1
s_sub_u32 s57,46080,s57
s_mov_b32 s51,s53
s_mov_b32 s52,s54
s_mov_b32 s37,s38
s_branch QKVQ_B1
s_nop 0
now_221:
s_mov_b32 s55,0
s_branch nt_222
nf_220:
s_mov_b32 s55,2
s_cmp_lg_u32 s38,0
s_cbranch_scc1 nt_222
s_mov_b32 s55,1
s_mov_b32 s37,0
s_sub_u32 s66,46080,s57
s_lshl_b32 s60,s33,6
s_add_u32 s60,s60,s34
s_mul_i32 s60,s60,46080
s_add_u32 s60,s60,s37
s_add_u32 s60,s60,206569472
s_lshl_b32 s62,s46,10
s_add_u32 s62,s62,40960
s_add_u32 m0,s66,s62
s_add_u32 s63,s60,s62
buffer_load_dwordx4 v1,s[8:11],s63 offen sc1 lds
s_add_u32 m0,s66,45056
s_add_u32 s63,s60,45056
buffer_load_dwordx4 v1,s[8:11],s63 offen sc1 lds
s_mul_i32 s61,s46,10240
s_add_u32 s60,s60,s61
s_add_u32 s61,s61,s66
s_add_u32 m0,s61,0
s_add_u32 s63,s60,0
buffer_load_dwordx4 v1,s[8:11],s63 offen sc1 lds
buffer_load_dwordx4 v1,s[8:11],s63 offen offset:1024 sc1 lds
buffer_load_dwordx4 v1,s[8:11],s63 offen offset:2048 sc1 lds
buffer_load_dwordx4 v1,s[8:11],s63 offen offset:3072 sc1 lds
s_add_u32 m0,s61,4096
s_add_u32 s63,s60,4096
buffer_load_dwordx4 v1,s[8:11],s63 offen sc1 lds
buffer_load_dwordx4 v1,s[8:11],s63 offen offset:1024 sc1 lds
buffer_load_dwordx4 v1,s[8:11],s63 offen offset:2048 sc1 lds
buffer_load_dwordx4 v1,s[8:11],s63 offen offset:3072 sc1 lds
s_add_u32 m0,s61,8192
s_add_u32 s63,s60,8192
buffer_load_dwordx4 v1,s[8:11],s63 offen sc1 lds
buffer_load_dwordx4 v1,s[8:11],s63 offen offset:1024 sc1 lds
nt_222:
s_mov_b32 s39,0
s_mul_i32 s74,s73,393216
s_add_u32 s74,s74,s39
s_add_u32 s74,s74,s70
v_fma_f32 v56,-v176,v120,v56
v_fma_f32 v57,-v176,v121,v57
v_fma_f32 v58,-v176,v122,v58
v_fma_f32 v59,-v176,v123,v59
v_fma_f32 v60,-v176,v124,v60
v_fma_f32 v61,-v176,v125,v61
v_fma_f32 v62,-v176,v126,v62
v_fma_f32 v63,-v176,v127,v63
v_mul_f32 v56,v56,v177
v_mul_f32 v57,v57,v177
v_mul_f32 v58,v58,v177
v_mul_f32 v59,v59,v177
v_mul_f32 v60,v60,v177
v_mul_f32 v61,v61,v177
v_mul_f32 v62,v62,v177
v_mul_f32 v63,v63,v177
v_cvt_pk_bf16_f32 v180,v56,v57
v_cvt_pk_bf16_f32 v181,v58,v59
v_cvt_pk_bf16_f32 v182,v60,v61
v_cvt_pk_bf16_f32 v183,v62,v63
buffer_store_dwordx4 v[180:183],v20,s[8:11],s74 offen sc1
v_fma_f32 v64,-v176,v128,v64
v_fma_f32 v65,-v176,v129,v65
v_fma_f32 v66,-v176,v130,v66
v_fma_f32 v67,-v176,v131,v67
v_fma_f32 v68,-v176,v132,v68
v_fma_f32 v69,-v176,v133,v69
v_fma_f32 v70,-v176,v134,v70
v_fma_f32 v71,-v176,v135,v71
v_mul_f32 v64,v64,v177
v_mul_f32 v65,v65,v177
v_mul_f32 v66,v66,v177
v_mul_f32 v67,v67,v177
v_mul_f32 v68,v68,v177
v_mul_f32 v69,v69,v177
v_mul_f32 v70,v70,v177
v_mul_f32 v71,v71,v177
v_cvt_pk_bf16_f32 v184,v64,v65
v_cvt_pk_bf16_f32 v185,v66,v67
v_cvt_pk_bf16_f32 v186,v68,v69
v_cvt_pk_bf16_f32 v187,v70,v71
buffer_store_dwordx4 v[184:187],v21,s[8:11],s74 offen sc1
v_fma_f32 v72,-v176,v136,v72
v_fma_f32 v73,-v176,v137,v73
v_fma_f32 v74,-v176,v138,v74
v_fma_f32 v75,-v176,v139,v75
v_fma_f32 v76,-v176,v140,v76
v_fma_f32 v77,-v176,v141,v77
v_fma_f32 v78,-v176,v142,v78
v_fma_f32 v79,-v176,v143,v79
v_mul_f32 v72,v72,v177
v_mul_f32 v73,v73,v177
v_mul_f32 v74,v74,v177
v_mul_f32 v75,v75,v177
v_mul_f32 v76,v76,v177
v_mul_f32 v77,v77,v177
v_mul_f32 v78,v78,v177
v_mul_f32 v79,v79,v177
v_cvt_pk_bf16_f32 v180,v72,v73
v_cvt_pk_bf16_f32 v181,v74,v75
v_cvt_pk_bf16_f32 v182,v76,v77
v_cvt_pk_bf16_f32 v183,v78,v79
buffer_store_dwordx4 v[180:183],v20,s[8:11],s74 offen offset:2048 sc1
v_fma_f32 v80,-v176,v144,v80
v_fma_f32 v81,-v176,v145,v81
v_fma_f32 v82,-v176,v146,v82
v_fma_f32 v83,-v176,v147,v83
v_fma_f32 v84,-v176,v148,v84
v_fma_f32 v85,-v176,v149,v85
v_fma_f32 v86,-v176,v150,v86
v_fma_f32 v87,-v176,v151,v87
v_mul_f32 v80,v80,v177
v_mul_f32 v81,v81,v177
v_mul_f32 v82,v82,v177
v_mul_f32 v83,v83,v177
v_mul_f32 v84,v84,v177
v_mul_f32 v85,v85,v177
v_mul_f32 v86,v86,v177
v_mul_f32 v87,v87,v177
v_cvt_pk_bf16_f32 v184,v80,v81
v_cvt_pk_bf16_f32 v185,v82,v83
v_cvt_pk_bf16_f32 v186,v84,v85
v_cvt_pk_bf16_f32 v187,v86,v87
buffer_store_dwordx4 v[184:187],v21,s[8:11],s74 offen offset:2048 sc1
s_lshl_b32 s82,s72,6
s_add_u32 s82,s82,s73
s_lshl_b32 s82,s82,9
s_add_u32 s82,s82,s71
s_lshl_b32 s75,s69,2
s_add_u32 s82,s82,s75
s_add_u32 s82,s82,s39
s_mov_b32 s59,s82
s_mov_b32 s82,2147483648
s_mov_b32 s39,2147483648
s_add_u32 s50,s50,1
s_sub_u32 s57,46080,s57
s_mov_b32 s51,s53
s_mov_b32 s52,s54
s_mov_b32 s37,s38
s_cmp_eq_u32 s55,0
s_cbranch_scc1 QKVQ_B1
s_cmp_eq_u32 s55,1
s_cbranch_scc1 QKVQ_CD1
s_waitcnt vmcnt(0)
s_mov_b64 exec,1
buffer_store_dword v5,v1,s[8:11],s59 offen sc1
s_mov_b64 exec,-1
s_mov_b32 s59,2147483648
s_cmp_eq_u32 s50,128
s_cbranch_scc1 QKVQ_END
s_branch QKVQ_COLD1
QKVQ_COLD1:
s_cmp_lg_u32 s46,0
s_cbranch_scc1 cp_223
fb_224:
buffer_load_dword v3,v2,s[8:11],s35 offen sc1
s_waitcnt vmcnt(0)
v_cmp_eq_u32 vcc,0,v3
s_nop 0
s_cbranch_vccz ok_225
s_sleep 7
s_sub_u32 s47,s47,1
s_cbranch_scc1 ABORT
s_branch fb_224
ok_225:
cp_223:
s_barrier
s_lshl_b32 s60,s33,6
s_add_u32 s60,s60,s34
s_mul_i32 s60,s60,46080
s_add_u32 s60,s60,206569472
s_lshl_b32 s62,s46,10
s_add_u32 s62,s62,40960
s_add_u32 m0,s57,s62
s_add_u32 s63,s60,s62
buffer_load_dwordx4 v1,s[8:11],s63 offen sc1 lds
s_add_u32 m0,s57,45056
s_add_u32 s63,s60,45056
buffer_load_dwordx4 v1,s[8:11],s63 offen sc1 lds
s_mul_i32 s61,s46,10240
s_add_u32 s60,s60,s61
s_add_u32 s61,s61,s57
s_add_u32 m0,s61,0
s_add_u32 s63,s60,0
buffer_load_dwordx4 v1,s[8:11],s63 offen sc1 lds
buffer_load_dwordx4 v1,s[8:11],s63 offen offset:1024 sc1 lds
buffer_load_dwordx4 v1,s[8:11],s63 offen offset:2048 sc1 lds
buffer_load_dwordx4 v1,s[8:11],s63 offen offset:3072 sc1 lds
s_add_u32 m0,s61,4096
s_add_u32 s63,s60,4096
buffer_load_dwordx4 v1,s[8:11],s63 offen sc1 lds
buffer_load_dwordx4 v1,s[8:11],s63 offen offset:1024 sc1 lds
buffer_load_dwordx4 v1,s[8:11],s63 offen offset:2048 sc1 lds
buffer_load_dwordx4 v1,s[8:11],s63 offen offset:3072 sc1 lds
s_add_u32 m0,s61,8192
s_add_u32 s63,s60,8192
buffer_load_dwordx4 v1,s[8:11],s63 offen sc1 lds
buffer_load_dwordx4 v1,s[8:11],s63 offen offset:1024 sc1 lds
QKVQ_CD1:
s_mov_b32 s51,s33
s_mov_b32 s52,s34
s_add_u32 s32,s32,1
s_min_u32 s62,s32,127
s_sub_u32 s60,s62,20
s_lshr_b32 s34,s60,1
s_and_b32 s33,s60,1
s_xor_b32 s33,s33,1
s_cmp_eq_u32 s33,0
s_cselect_b32 s61,20,0
s_add_u32 s34,s34,s61
s_sub_u32 s61,s60,44
s_cmp_ge_u32 s60,88
s_cselect_b32 s34,s61,s34
s_cselect_b32 s33,1,s33
s_cmp_lt_u32 s62,20
s_cselect_b32 s34,s62,s34
s_cselect_b32 s33,0,s33
s_lshl_b32 s35,s33,6
s_add_u32 s35,s35,s34
s_lshl_b32 s35,s35,9
s_add_u32 s35,s35,0
s_lshl_b32 s60,s33,5
s_add_u32 s60,s60,7
v_min_u32 v2,s60,v0
v_lshlrev_b32 v2,2,v2
s_cmp_lg_u32 s46,0
s_cbranch_scc1 w0_226
buffer_load_dword v3,v2,s[8:11],s35 offen sc1
w0_226:
s_waitcnt vmcnt(0)
s_mov_b64 exec,1
buffer_store_dword v5,v1,s[8:11],s59 offen sc1
s_mov_b64 exec,-1
s_mov_b32 s59,2147483648
s_cmp_lg_u32 s46,0
s_cbranch_scc1 w0_227
v_cmp_eq_u32 vcc,0,v3
s_cmp_eq_u64 vcc,0
s_cselect_b32 s36,0,2147483648
s_cmp_lt_u32 s32,128
s_cselect_b32 s36,s36,2147483648
v_mov_b32 v23,s36
ds_write_b32 v22,v23
w0_227:
s_waitcnt lgkmcnt(0)
s_barrier
ds_read_b32 v23,v22
ds_read_b128 v[24:27],v18 offset:0
ds_read_b128 v[28:31],v19 offset:0
ds_read_b128 v[32:35],v18 offset:2048
ds_read_b128 v[36:39],v19 offset:2048
ds_read_b128 v[40:43],v18 offset:4096
s_waitcnt lgkmcnt(5)
v_readfirstlane_b32 s37,v23
s_nop 4
QKVQ_B1:
s_waitcnt lgkmcnt(3)
v_mfma_f32_32x32x16_bf16 v[88:103],a[0:3],v[24:27],0
ds_read_b128 v[44:47],v19 offset:4096
v_add_u32 v189,s57,v188
v_mfma_f32_32x32x16_bf16 v[104:119],a[160:163],v[24:27],0
v_add_u32 v8,0x800,v189
s_sub_u32 s66,46080,s57
s_lshl_b32 s60,s33,6
s_add_u32 s60,s60,s34
s_mul_i32 s60,s60,46080
s_add_u32 s60,s60,s37
v_mfma_f32_32x32x16_bf16 v[88:103],a[4:7],v[28:31],v[88:103]
ds_read_b128 v[48:51],v18 offset:6144
ds_read2_b64 v[156:159],v189 offset0:0 offset1:32
s_add_u32 s60,s60,206569472
s_lshl_b32 s62,s46,10
v_mfma_f32_32x32x16_bf16 v[104:119],a[164:167],v[28:31],v[104:119]
ds_read2_b64 v[160:163],v189 offset0:64 offset1:96
s_add_u32 s62,s62,40960
s_add_u32 m0,s66,s62
s_add_u32 s63,s60,s62
s_waitcnt lgkmcnt(5)
v_mfma_f32_32x32x16_bf16 v[88:103],a[8:11],v[32:35],v[88:103]
ds_read_b128 v[52:55],v19 offset:6144
ds_read2_b64 v[164:167],v189 offset0:128 offset1:160
buffer_load_dwordx4 v1,s[8:11],s63 offen sc1 lds
v_mfma_f32_32x32x16_bf16 v[104:119],a[168:171],v[32:35],v[104:119]
ds_read2_b64 v[168:171],v189 offset0:192 offset1:224
s_add_u32 m0,s66,45056
s_add_u32 s63,s60,45056
s_mul_i32 s74,s73,393216
s_add_u32 s74,s74,s39
v_mfma_f32_32x32x16_bf16 v[88:103],a[12:15],v[36:39],v[88:103]
ds_read_b128 v[24:27],v18 offset:8192
ds_read2_b64 v[172:175],v8 offset0:0 offset1:32
s_add_u32 s74,s74,s70
v_fma_f32 v56,-v176,v120,v56
v_mfma_f32_32x32x16_bf16 v[104:119],a[172:175],v[36:39],v[104:119]
buffer_load_dwordx4 v1,s[8:11],s63 offen sc1 lds
s_mul_i32 s61,s46,10240
s_add_u32 s60,s60,s61
s_add_u32 s61,s61,s66
s_waitcnt lgkmcnt(8)
v_mfma_f32_32x32x16_bf16 v[88:103],a[16:19],v[40:43],v[88:103]
ds_read_b128 v[28:31],v19 offset:8192
s_add_u32 m0,s61,0
s_add_u32 s63,s60,0
v_fma_f32 v57,-v176,v121,v57
v_fma_f32 v58,-v176,v122,v58
v_mfma_f32_32x32x16_bf16 v[104:119],a[176:179],v[40:43],v[104:119]
v_fma_f32 v59,-v176,v123,v59
v_fma_f32 v60,-v176,v124,v60
v_fma_f32 v61,-v176,v125,v61
v_fma_f32 v62,-v176,v126,v62
v_fma_f32 v63,-v176,v127,v63
v_mfma_f32_32x32x16_bf16 v[88:103],a[20:23],v[44:47],v[88:103]
ds_read_b128 v[32:35],v18 offset:10240
buffer_load_dwordx4 v1,s[8:11],s63 offen sc1 lds
v_mul_f32 v56,v56,v177
v_mul_f32 v57,v57,v177
v_mfma_f32_32x32x16_bf16 v[104:119],a[180:183],v[44:47],v[104:119]
v_mul_f32 v58,v58,v177
v_mul_f32 v59,v59,v177
v_mul_f32 v60,v60,v177
v_mul_f32 v61,v61,v177
v_mul_f32 v62,v62,v177
s_waitcnt lgkmcnt(6)
v_mfma_f32_32x32x16_bf16 v[88:103],a[24:27],v[48:51],v[88:103]
ds_read_b128 v[36:39],v19 offset:10240
v_mul_f32 v63,v63,v177
v_cvt_pk_bf16_f32 v180,v56,v57
v_cvt_pk_bf16_f32 v181,v58,v59
v_cvt_pk_bf16_f32 v182,v60,v61
v_mfma_f32_32x32x16_bf16 v[104:119],a[184:187],v[48:51],v[104:119]
buffer_load_dwordx4 v1,s[8:11],s63 offen offset:1024 sc1 lds
v_cvt_pk_bf16_f32 v183,v62,v63
buffer_store_dwordx4 v[180:183],v20,s[8:11],s74 offen sc1
v_fma_f32 v64,-v176,v128,v64
v_mfma_f32_32x32x16_bf16 v[88:103],a[28:31],v[52:55],v[88:103]
ds_read_b128 v[40:43],v18 offset:12288
v_fma_f32 v65,-v176,v129,v65
v_fma_f32 v66,-v176,v130,v66
v_fma_f32 v67,-v176,v131,v67
v_fma_f32 v68,-v176,v132,v68
v_mfma_f32_32x32x16_bf16 v[104:119],a[188:191],v[52:55],v[104:119]
v_fma_f32 v69,-v176,v133,v69
v_fma_f32 v70,-v176,v134,v70
v_fma_f32 v71,-v176,v135,v71
v_mul_f32 v64,v64,v177
v_mul_f32 v65,v65,v177
s_waitcnt lgkmcnt(3)
v_mfma_f32_32x32x16_bf16 v[88:103],a[32:35],v[24:27],v[88:103]
ds_read_b128 v[44:47],v19 offset:12288
buffer_load_dwordx4 v1,s[8:11],s63 offen offset:2048 sc1 lds
v_mul_f32 v66,v66,v177
v_mul_f32 v67,v67,v177
v_mfma_f32_32x32x16_bf16 v[104:119],a[192:195],v[24:27],v[104:119]
v_mul_f32 v68,v68,v177
v_mul_f32 v69,v69,v177
v_mul_f32 v70,v70,v177
v_mul_f32 v71,v71,v177
v_cvt_pk_bf16_f32 v184,v64,v65
v_mfma_f32_32x32x16_bf16 v[88:103],a[36:39],v[28:31],v[88:103]
ds_read_b128 v[48:51],v18 offset:14336
v_cvt_pk_bf16_f32 v185,v66,v67
v_cvt_pk_bf16_f32 v186,v68,v69
v_cvt_pk_bf16_f32 v187,v70,v71
v_mfma_f32_32x32x16_bf16 v[104:119],a[196:199],v[28:31],v[104:119]
buffer_load_dwordx4 v1,s[8:11],s63 offen offset:3072 sc1 lds
s_add_u32 m0,s61,4096
s_add_u32 s63,s60,4096
s_waitcnt lgkmcnt(3)
v_mfma_f32_32x32x16_bf16 v[88:103],a[40:43],v[32:35],v[88:103]
ds_read_b128 v[52:55],v19 offset:14336
buffer_store_dwordx4 v[184:187],v21,s[8:11],s74 offen sc1
v_fma_f32 v72,-v176,v136,v72
v_fma_f32 v73,-v176,v137,v73
v_mfma_f32_32x32x16_bf16 v[104:119],a[200:203],v[32:35],v[104:119]
v_fma_f32 v74,-v176,v138,v74
v_fma_f32 v75,-v176,v139,v75
v_fma_f32 v76,-v176,v140,v76
v_fma_f32 v77,-v176,v141,v77
v_fma_f32 v78,-v176,v142,v78
v_mfma_f32_32x32x16_bf16 v[88:103],a[44:47],v[36:39],v[88:103]
ds_read_b128 v[24:27],v18 offset:16384
buffer_load_dwordx4 v1,s[8:11],s63 offen sc1 lds
v_fma_f32 v79,-v176,v143,v79
v_mul_f32 v72,v72,v177
v_mfma_f32_32x32x16_bf16 v[104:119],a[204:207],v[36:39],v[104:119]
v_mul_f32 v73,v73,v177
v_mul_f32 v74,v74,v177
v_mul_f32 v75,v75,v177
v_mul_f32 v76,v76,v177
v_mul_f32 v77,v77,v177
s_waitcnt lgkmcnt(3)
v_mfma_f32_32x32x16_bf16 v[88:103],a[48:51],v[40:43],v[88:103]
ds_read_b128 v[28:31],v19 offset:16384
v_mul_f32 v78,v78,v177
v_mul_f32 v79,v79,v177
v_cvt_pk_bf16_f32 v180,v72,v73
v_cvt_pk_bf16_f32 v181,v74,v75
v_mfma_f32_32x32x16_bf16 v[104:119],a[208:211],v[40:43],v[104:119]
buffer_load_dwordx4 v1,s[8:11],s63 offen offset:1024 sc1 lds
v_cvt_pk_bf16_f32 v182,v76,v77
v_cvt_pk_bf16_f32 v183,v78,v79
buffer_store_dwordx4 v[180:183],v20,s[8:11],s74 offen offset:2048 sc1
v_mfma_f32_32x32x16_bf16 v[88:103],a[52:55],v[44:47],v[88:103]
ds_read_b128 v[32:35],v18 offset:18432
v_fma_f32 v80,-v176,v144,v80
v_fma_f32 v81,-v176,v145,v81
v_fma_f32 v82,-v176,v146,v82
v_fma_f32 v83,-v176,v147,v83
v_mfma_f32_32x32x16_bf16 v[104:119],a[212:215],v[44:47],v[104:119]
v_fma_f32 v84,-v176,v148,v84
v_fma_f32 v85,-v176,v149,v85
v_fma_f32 v86,-v176,v150,v86
v_fma_f32 v87,-v176,v151,v87
v_mul_f32 v80,v80,v177
s_waitcnt lgkmcnt(3)
v_mfma_f32_32x32x16_bf16 v[88:103],a[56:59],v[48:51],v[88:103]
ds_read_b128 v[36:39],v19 offset:18432
buffer_load_dwordx4 v1,s[8:11],s63 offen offset:2048 sc1 lds
v_mul_f32 v81,v81,v177
v_mul_f32 v82,v82,v177
v_mfma_f32_32x32x16_bf16 v[104:119],a[216:219],v[48:51],v[104:119]
v_mul_f32 v83,v83,v177
v_mul_f32 v84,v84,v177
v_mul_f32 v85,v85,v177
v_mul_f32 v86,v86,v177
v_mul_f32 v87,v87,v177
v_mfma_f32_32x32x16_bf16 v[88:103],a[60:63],v[52:55],v[88:103]
ds_read_b128 v[40:43],v18 offset:20480
s_waitcnt vmcnt(12)
s_mov_b64 exec,1
buffer_store_dword v5,v1,s[8:11],s59 offen sc1
s_mov_b64 exec,-1
s_mov_b32 s59,2147483648
v_mfma_f32_32x32x16_bf16 v[104:119],a[220:223],v[52:55],v[104:119]
buffer_load_dwordx4 v1,s[8:11],s63 offen offset:3072 sc1 lds
s_add_u32 m0,s61,8192
s_add_u32 s63,s60,8192
v_cvt_pk_bf16_f32 v184,v80,v81
s_waitcnt lgkmcnt(3)
v_mfma_f32_32x32x16_bf16 v[88:103],a[64:67],v[24:27],v[88:103]
ds_read_b128 v[44:47],v19 offset:20480
v_cvt_pk_bf16_f32 v185,v82,v83
v_cvt_pk_bf16_f32 v186,v84,v85
v_cvt_pk_bf16_f32 v187,v86,v87
v_mfma_f32_32x32x16_bf16 v[104:119],a[224:227],v[24:27],v[104:119]
buffer_store_dwordx4 v[184:187],v21,s[8:11],s74 offen offset:2048 sc1
s_lshl_b32 s82,s72,6
s_add_u32 s82,s82,s73
s_lshl_b32 s82,s82,9
s_add_u32 s82,s82,s71
v_mfma_f32_32x32x16_bf16 v[88:103],a[68:71],v[28:31],v[88:103]
ds_read_b128 v[48:51],v18 offset:22528
buffer_load_dwordx4 v1,s[8:11],s63 offen sc1 lds
s_lshl_b32 s75,s69,2
s_add_u32 s82,s82,s75
v_mfma_f32_32x32x16_bf16 v[104:119],a[228:231],v[28:31],v[104:119]
s_add_u32 s82,s82,s39
v_add_f32 v156,v156,v166
v_add_f32 v157,v157,v167
v_add_f32 v158,v158,v168
s_waitcnt lgkmcnt(3)
v_mfma_f32_32x32x16_bf16 v[88:103],a[72:75],v[32:35],v[88:103]
ds_read_b128 v[52:55],v19 offset:22528
v_add_f32 v159,v159,v169
v_add_f32 v160,v160,v170
v_add_f32 v161,v161,v171
v_add_f32 v162,v162,v172
v_mfma_f32_32x32x16_bf16 v[104:119],a[232:235],v[32:35],v[104:119]
buffer_load_dwordx4 v1,s[8:11],s63 offen offset:1024 sc1 lds
s_mov_b32 s53,s33
s_mov_b32 s54,s34
s_cmp_eq_u32 s37,0
s_addc_u32 s32,s32,0
v_mfma_f32_32x32x16_bf16 v[88:103],a[76:79],v[36:39],v[88:103]
ds_read_b128 v[24:27],v18 offset:24576
s_min_u32 s62,s32,127
s_sub_u32 s60,s62,20
s_lshr_b32 s34,s60,1
s_and_b32 s33,s60,1
v_mfma_f32_32x32x16_bf16 v[104:119],a[236:239],v[36:39],v[104:119]
s_xor_b32 s33,s33,1
s_cmp_eq_u32 s33,0
s_cselect_b32 s61,20,0
s_add_u32 s34,s34,s61
s_sub_u32 s61,s60,44
s_waitcnt lgkmcnt(3)
v_mfma_f32_32x32x16_bf16 v[88:103],a[80:83],v[40:43],v[88:103]
ds_read_b128 v[28:31],v19 offset:24576
s_cmp_ge_u32 s60,88
s_cselect_b32 s34,s61,s34
s_cselect_b32 s33,1,s33
v_add_f32 v163,v163,v173
v_mfma_f32_32x32x16_bf16 v[104:119],a[240:243],v[40:43],v[104:119]
s_cmp_lt_u32 s62,20
s_cselect_b32 s34,s62,s34
s_cselect_b32 s33,0,s33
s_lshl_b32 s35,s33,6
s_add_u32 s35,s35,s34
s_lshl_b32 s35,s35,9
v_mfma_f32_32x32x16_bf16 v[88:103],a[84:87],v[44:47],v[88:103]
ds_read_b128 v[32:35],v18 offset:26624
s_add_u32 s35,s35,0
s_lshl_b32 s60,s33,5
s_add_u32 s60,s60,7
v_min_u32 v2,s60,v0
v_mfma_f32_32x32x16_bf16 v[104:119],a[244:247],v[44:47],v[104:119]
v_lshlrev_b32 v2,2,v2
v_add_f32 v164,v164,v174
v_add_f32 v165,v165,v175
v_add_f32 v156,v156,v158
v_add_f32 v157,v157,v159
s_waitcnt lgkmcnt(3)
v_mfma_f32_32x32x16_bf16 v[88:103],a[88:91],v[48:51],v[88:103]
ds_read_b128 v[36:39],v19 offset:26624
s_cmp_lg_u32 s46,0
s_cbranch_scc1 w0_228
buffer_load_dword v3,v2,s[8:11],s35 offen sc1
w0_228:
v_mfma_f32_32x32x16_bf16 v[104:119],a[248:251],v[48:51],v[104:119]
v_add_f32 v160,v160,v162
v_add_f32 v161,v161,v163
v_add_f32 v156,v156,v160
v_add_f32 v157,v157,v161
v_add_f32 v156,v156,v164
v_mfma_f32_32x32x16_bf16 v[88:103],a[92:95],v[52:55],v[88:103]
ds_read_b128 v[40:43],v18 offset:28672
v_add_f32 v157,v157,v165
v_mov_b32 v158,v156
v_mov_b32 v159,v157
s_nop 0
v_permlane32_swap_b32 v156,v158
v_mfma_f32_32x32x16_bf16 v[104:119],a[252:255],v[52:55],v[104:119]
v_permlane32_swap_b32 v157,v159
v_add_f32 v176,v156,v158
v_add_f32 v177,v157,v159
v_mul_f32 v176,0x3acccccd,v176
v_mul_f32 v177,0x3acccccd,v177
s_waitcnt lgkmcnt(3)
v_mfma_f32_32x32x16_bf16 v[88:103],a[96:99],v[24:27],v[88:103]
ds_read_b128 v[44:47],v19 offset:28672
v_fma_f32 v177,-v176,v176,v177
v_max_f32 v177,0,v177
v_cvt_pk_bf16_f32 v8,v176,v177
v_lshlrev_b32 v176,16,v8
v_mfma_f32_32x32x16_bf16 v[104:119],v[192:195],v[24:27],v[104:119]
v_and_b32 v177,0xffff0000,v8
v_add_f32 v177,0x3727c5ac,v177
v_cvt_pk_bf16_f32 v8,v177,v177
v_lshlrev_b32 v177,16,v8
v_sqrt_f32 v177,v177
v_mfma_f32_32x32x16_bf16 v[88:103],a[100:103],v[28:31],v[88:103]
ds_read_b128 v[48:51],v18 offset:30720
v_cvt_pk_bf16_f32 v8,v177,v177
v_lshlrev_b32 v177,16,v8
v_rcp_f32 v177,v177
v_mfma_f32_32x32x16_bf16 v[104:119],v[196:199],v[28:31],v[104:119]
s_cmp_eq_u32 s51,0
s_cselect_b64 s[76:77],-1,0
v_cndmask_b32 v176,v176,0,s[76:77]
v_cndmask_b32 v177,v177,1.0,s[76:77]
s_mov_b32 s72,s51
s_waitcnt lgkmcnt(3)
v_mfma_f32_32x32x16_bf16 v[88:103],a[104:107],v[32:35],v[88:103]
ds_read_b128 v[52:55],v19 offset:30720
s_mov_b32 s73,s52
v_mfma_f32_32x32x16_bf16 v[104:119],v[200:203],v[32:35],v[104:119]
v_mfma_f32_32x32x16_bf16 v[88:103],a[108:111],v[36:39],v[88:103]
ds_read_b128 v[24:27],v18 offset:32768
v_mfma_f32_32x32x16_bf16 v[104:119],v[204:207],v[36:39],v[104:119]
s_waitcnt lgkmcnt(3)
v_mfma_f32_32x32x16_bf16 v[88:103],a[112:115],v[40:43],v[88:103]
ds_read_b128 v[28:31],v19 offset:32768
v_mfma_f32_32x32x16_bf16 v[104:119],v[208:211],v[40:43],v[104:119]
v_mfma_f32_32x32x16_bf16 v[88:103],a[116:119],v[44:47],v[88:103]
ds_read_b128 v[32:35],v18 offset:34816
v_mfma_f32_32x32x16_bf16 v[104:119],v[212:215],v[44:47],v[104:119]
s_waitcnt lgkmcnt(3)
v_mfma_f32_32x32x16_bf16 v[88:103],a[120:123],v[48:51],v[88:103]
ds_read_b128 v[36:39],v19 offset:34816
v_mfma_f32_32x32x16_bf16 v[104:119],v[216:219],v[48:51],v[104:119]
v_mfma_f32_32x32x16_bf16 v[88:103],a[124:127],v[52:55],v[88:103]
ds_read_b128 v[40:43],v18 offset:36864
v_mfma_f32_32x32x16_bf16 v[104:119],v[220:223],v[52:55],v[104:119]
s_waitcnt vmcnt(0)
s_cmp_lg_u32 s46,0
s_cbranch_scc1 w0_229
v_cmp_eq_u32 vcc,0,v3
s_cmp_eq_u64 vcc,0
s_cselect_b32 s36,0,2147483648
s_cmp_lt_u32 s32,128
s_cselect_b32 s36,s36,2147483648
v_mov_b32 v23,s36
ds_write_b32 v22,v23
w0_229:
s_waitcnt lgkmcnt(3)
v_mfma_f32_32x32x16_bf16 v[88:103],a[128:131],v[24:27],v[88:103]
ds_read_b128 v[44:47],v19 offset:36864
s_mov_b64 exec,1
buffer_store_dword v5,v1,s[8:11],s82 offen sc1
s_mov_b64 exec,-1
s_mov_b32 s82,2147483648
v_mfma_f32_32x32x16_bf16 v[104:119],v[224:227],v[24:27],v[104:119]
v_mfma_f32_32x32x16_bf16 v[88:103],a[132:135],v[28:31],v[88:103]
ds_read_b128 v[48:51],v18 offset:38912
v_mfma_f32_32x32x16_bf16 v[104:119],v[228:231],v[28:31],v[104:119]
s_waitcnt lgkmcnt(3)
v_mfma_f32_32x32x16_bf16 v[88:103],a[136:139],v[32:35],v[88:103]
ds_read_b128 v[52:55],v19 offset:38912
v_mfma_f32_32x32x16_bf16 v[104:119],v[232:235],v[32:35],v[104:119]
s_waitcnt lgkmcnt(2)
s_barrier
ds_read_b32 v23,v22
v_mfma_f32_32x32x16_bf16 v[88:103],a[140:143],v[36:39],v[88:103]
ds_read_b128 v[24:27],v16 offset:0
v_mfma_f32_32x32x16_bf16 v[104:119],v[236:239],v[36:39],v[104:119]
v_mfma_f32_32x32x16_bf16 v[88:103],a[144:147],v[40:43],v[88:103]
ds_read_b128 v[28:31],v17 offset:0
v_mfma_f32_32x32x16_bf16 v[104:119],v[240:243],v[40:43],v[104:119]
v_mfma_f32_32x32x16_bf16 v[88:103],a[148:151],v[44:47],v[88:103]
ds_read_b128 v[32:35],v16 offset:2048
v_mfma_f32_32x32x16_bf16 v[104:119],v[244:247],v[44:47],v[104:119]
s_waitcnt lgkmcnt(4)
v_mfma_f32_32x32x16_bf16 v[88:103],a[152:155],v[48:51],v[88:103]
ds_read_b128 v[36:39],v17 offset:2048
s_waitcnt lgkmcnt(4)
v_readfirstlane_b32 s38,v23
v_mfma_f32_32x32x16_bf16 v[104:119],v[248:251],v[48:51],v[104:119]
v_mfma_f32_32x32x16_bf16 v[88:103],a[156:159],v[52:55],v[88:103]
ds_read_b128 v[40:43],v16 offset:4096
v_mfma_f32_32x32x16_bf16 v[104:119],v[252:255],v[52:55],v[104:119]
s_cmp_lg_u32 s37,0
s_cbranch_scc1 nf_230
s_cmp_lt_u32 s50,2
s_cbranch_scc1 now_231
s_mov_b32 s39,0
s_add_u32 s50,s50,1
s_sub_u32 s57,46080,s57
s_mov_b32 s51,s53
s_mov_b32 s52,s54
s_mov_b32 s37,s38
s_branch QKVQ_B0
s_nop 0
now_231:
s_mov_b32 s55,0
s_branch nt_232
nf_230:
s_mov_b32 s55,2
s_cmp_lg_u32 s38,0
s_cbranch_scc1 nt_232
s_mov_b32 s55,1
s_mov_b32 s37,0
s_sub_u32 s66,46080,s57
s_lshl_b32 s60,s33,6
s_add_u32 s60,s60,s34
s_mul_i32 s60,s60,46080
s_add_u32 s60,s60,s37
s_add_u32 s60,s60,206569472
s_lshl_b32 s62,s46,10
s_add_u32 s62,s62,40960
s_add_u32 m0,s66,s62
s_add_u32 s63,s60,s62
buffer_load_dwordx4 v1,s[8:11],s63 offen sc1 lds
s_add_u32 m0,s66,45056
s_add_u32 s63,s60,45056
buffer_load_dwordx4 v1,s[8:11],s63 offen sc1 lds
s_mul_i32 s61,s46,10240
s_add_u32 s60,s60,s61
s_add_u32 s61,s61,s66
s_add_u32 m0,s61,0
s_add_u32 s63,s60,0
buffer_load_dwordx4 v1,s[8:11],s63 offen sc1 lds
buffer_load_dwordx4 v1,s[8:11],s63 offen offset:1024 sc1 lds
buffer_load_dwordx4 v1,s[8:11],s63 offen offset:2048 sc1 lds
buffer_load_dwordx4 v1,s[8:11],s63 offen offset:3072 sc1 lds
s_add_u32 m0,s61,4096
s_add_u32 s63,s60,4096
buffer_load_dwordx4 v1,s[8:11],s63 offen sc1 lds
buffer_load_dwordx4 v1,s[8:11],s63 offen offset:1024 sc1 lds
buffer_load_dwordx4 v1,s[8:11],s63 offen offset:2048 sc1 lds
buffer_load_dwordx4 v1,s[8:11],s63 offen offset:3072 sc1 lds
s_add_u32 m0,s61,8192
s_add_u32 s63,s60,8192
buffer_load_dwordx4 v1,s[8:11],s63 offen sc1 lds
buffer_load_dwordx4 v1,s[8:11],s63 offen offset:1024 sc1 lds
nt_232:
s_mov_b32 s39,0
s_mul_i32 s74,s73,393216
s_add_u32 s74,s74,s39
s_add_u32 s74,s74,s70
v_fma_f32 v88,-v176,v120,v88
v_fma_f32 v89,-v176,v121,v89
v_fma_f32 v90,-v176,v122,v90
v_fma_f32 v91,-v176,v123,v91
v_fma_f32 v92,-v176,v124,v92
v_fma_f32 v93,-v176,v125,v93
v_fma_f32 v94,-v176,v126,v94
v_fma_f32 v95,-v176,v127,v95
v_mul_f32 v88,v88,v177
v_mul_f32 v89,v89,v177
v_mul_f32 v90,v90,v177
v_mul_f32 v91,v91,v177
v_mul_f32 v92,v92,v177
v_mul_f32 v93,v93,v177
v_mul_f32 v94,v94,v177
v_mul_f32 v95,v95,v177
v_cvt_pk_bf16_f32 v180,v88,v89
v_cvt_pk_bf16_f32 v181,v90,v91
v_cvt_pk_bf16_f32 v182,v92,v93
v_cvt_pk_bf16_f32 v183,v94,v95
buffer_store_dwordx4 v[180:183],v20,s[8:11],s74 offen sc1
v_fma_f32 v96,-v176,v128,v96
v_fma_f32 v97,-v176,v129,v97
v_fma_f32 v98,-v176,v130,v98
v_fma_f32 v99,-v176,v131,v99
v_fma_f32 v100,-v176,v132,v100
v_fma_f32 v101,-v176,v133,v101
v_fma_f32 v102,-v176,v134,v102
v_fma_f32 v103,-v176,v135,v103
v_mul_f32 v96,v96,v177
v_mul_f32 v97,v97,v177
v_mul_f32 v98,v98,v177
v_mul_f32 v99,v99,v177
v_mul_f32 v100,v100,v177
v_mul_f32 v101,v101,v177
v_mul_f32 v102,v102,v177
v_mul_f32 v103,v103,v177
v_cvt_pk_bf16_f32 v184,v96,v97
v_cvt_pk_bf16_f32 v185,v98,v99
v_cvt_pk_bf16_f32 v186,v100,v101
v_cvt_pk_bf16_f32 v187,v102,v103
buffer_store_dwordx4 v[184:187],v21,s[8:11],s74 offen sc1
v_fma_f32 v104,-v176,v136,v104
v_fma_f32 v105,-v176,v137,v105
v_fma_f32 v106,-v176,v138,v106
v_fma_f32 v107,-v176,v139,v107
v_fma_f32 v108,-v176,v140,v108
v_fma_f32 v109,-v176,v141,v109
v_fma_f32 v110,-v176,v142,v110
v_fma_f32 v111,-v176,v143,v111
v_mul_f32 v104,v104,v177
v_mul_f32 v105,v105,v177
v_mul_f32 v106,v106,v177
v_mul_f32 v107,v107,v177
v_mul_f32 v108,v108,v177
v_mul_f32 v109,v109,v177
v_mul_f32 v110,v110,v177
v_mul_f32 v111,v111,v177
v_cvt_pk_bf16_f32 v180,v104,v105
v_cvt_pk_bf16_f32 v181,v106,v107
v_cvt_pk_bf16_f32 v182,v108,v109
v_cvt_pk_bf16_f32 v183,v110,v111
buffer_store_dwordx4 v[180:183],v20,s[8:11],s74 offen offset:2048 sc1
v_fma_f32 v112,-v176,v144,v112
v_fma_f32 v113,-v176,v145,v113
v_fma_f32 v114,-v176,v146,v114
v_fma_f32 v115,-v176,v147,v115
v_fma_f32 v116,-v176,v148,v116
v_fma_f32 v117,-v176,v149,v117
v_fma_f32 v118,-v176,v150,v118
v_fma_f32 v119,-v176,v151,v119
v_mul_f32 v112,v112,v177
v_mul_f32 v113,v113,v177
v_mul_f32 v114,v114,v177
v_mul_f32 v115,v115,v177
v_mul_f32 v116,v116,v177
v_mul_f32 v117,v117,v177
v_mul_f32 v118,v118,v177
v_mul_f32 v119,v119,v177
v_cvt_pk_bf16_f32 v184,v112,v113
v_cvt_pk_bf16_f32 v185,v114,v115
v_cvt_pk_bf16_f32 v186,v116,v117
v_cvt_pk_bf16_f32 v187,v118,v119
buffer_store_dwordx4 v[184:187],v21,s[8:11],s74 offen offset:2048 sc1
s_lshl_b32 s82,s72,6
s_add_u32 s82,s82,s73
s_lshl_b32 s82,s82,9
s_add_u32 s82,s82,s71
s_lshl_b32 s75,s69,2
s_add_u32 s82,s82,s75
s_add_u32 s82,s82,s39
s_mov_b32 s59,s82
s_mov_b32 s82,2147483648
s_mov_b32 s39,2147483648
s_add_u32 s50,s50,1
s_sub_u32 s57,46080,s57
s_mov_b32 s51,s53
s_mov_b32 s52,s54
s_mov_b32 s37,s38
s_cmp_eq_u32 s55,0
s_cbranch_scc1 QKVQ_B0
s_cmp_eq_u32 s55,1
s_cbranch_scc1 QKVQ_CD0
s_waitcnt vmcnt(0)
s_mov_b64 exec,1
buffer_store_dword v5,v1,s[8:11],s59 offen sc1
s_mov_b64 exec,-1
s_mov_b32 s59,2147483648
s_cmp_eq_u32 s50,128
s_cbranch_scc1 QKVQ_END
s_branch QKVQ_COLD0
QKVQ_END:
s_endpgm
ROLE_QKVV:
v_lshlrev_b32 v1,4,v0
v_mov_b32 v5,1
s_lshl_b32 s56,s48,2
s_add_u32 s56,s56,s46
v_bfe_u32 v6,v0,2,2
v_lshrrev_b32 v7,4,v0
v_add_u32 v7,v6,v7
v_and_b32 v7,3,v7
v_and_b32 v15,3,v0
v_lshlrev_b32 v15,4,v15
v_lshl_add_u32 v15,v7,6,v15
v_lshl_add_u32 v15,v6,8,v15
v_lshrrev_b32 v6,5,v0
v_bfe_u32 v7,v0,4,1
v_lshlrev_b32 v16,10,v7
v_bfe_u32 v7,v0,2,2
v_lshl_add_u32 v16,v7,8,v16
v_add_u32 v6,v6,v7
v_and_b32 v6,3,v6
v_lshl_add_u32 v16,v6,6,v16
v_and_b32 v6,3,v0
v_lshl_add_u32 v16,v6,4,v16
v_add_u32 v18,46080,v16
v_lshrrev_b32 v6,5,v0
v_bfe_u32 v7,v0,4,1
v_lshlrev_b32 v20,10,v7
v_lshl_add_u32 v20,v6,8,v20
v_and_b32 v6,15,v0
v_lshl_add_u32 v20,v6,4,v20
v_lshrrev_b32 v6,5,v0
v_add_u32 v6,2,v6
v_bfe_u32 v7,v0,4,1
v_lshlrev_b32 v17,10,v7
v_bfe_u32 v7,v0,2,2
v_lshl_add_u32 v17,v7,8,v17
v_add_u32 v6,v6,v7
v_and_b32 v6,3,v6
v_lshl_add_u32 v17,v6,6,v17
v_and_b32 v6,3,v0
v_lshl_add_u32 v17,v6,4,v17
v_add_u32 v19,46080,v17
v_lshrrev_b32 v6,5,v0
v_add_u32 v6,2,v6
v_bfe_u32 v7,v0,4,1
v_lshlrev_b32 v21,10,v7
v_lshl_add_u32 v21,v6,8,v21
v_and_b32 v6,15,v0
v_lshl_add_u32 v21,v6,4,v21
s_mov_b32 s69,s56
s_mov_b32 s70,99614720
s_mov_b32 s71,196608
s_lshl_b32 s60,s69,12
s_add_u32 s70,s70,s60
v_lshrrev_b32 v6,5,v0
v_mul_u32_u24 v188,2560,v6
v_and_b32 v6,31,v0
v_lshl_add_u32 v188,v6,3,v188
v_add_u32 v188,0xa000,v188
v_min_u32 v12,7,v0
v_lshlrev_b32 v12,2,v12
v_min_u32 v13,39,v0
v_lshlrev_b32 v13,2,v13
v_mov_b32 v14,93184
s_lshl_b32 s60,s46,8
s_add_u32 s60,s60,92160
v_and_b32 v6,31,v0
v_lshlrev_b32 v190,3,v6
v_add_u32 v190,s60,v190
v_lshrrev_b32 v6,5,v0
v_lshlrev_b32 v191,5,v6
v_add_u32 v191,s60,v191
s_waitcnt vmcnt(0)
s_barrier
s_cmp_lg_u32 s46,0
s_cbranch_scc1 arr_233
v_mov_b32 v6,1
s_lshl_b32 s3,s49,2
v_mov_b32 v7,s3
s_mov_b64 exec,1
buffer_atomic_add v6,v7,s[12:15],0 offen sc1
s_mov_b64 exec,-1
arr_233:
s_lshl_b32 s58,s69,7
s_mul_i32 s63,s46,40960
s_mov_b32 s4,s24
s_mov_b32 s5,s25
s_mov_b32 s6,7864320
s_mov_b32 s7,0x20000
v_lshrrev_b32 v9,3,v0
s_mov_b32 s64,12288
v_mul_lo_u32 v9,v9,s64
v_and_b32 v10,7,v0
v_lshl_add_u32 v6,v10,4,v9
s_add_u32 m0,s63,0
s_add_u32 s65,s58,0
buffer_load_dwordx4 v6,s[4:7],s65 offen lds
s_add_u32 m0,s63,1024
s_add_u32 s65,s58,98304
buffer_load_dwordx4 v6,s[4:7],s65 offen lds
s_add_u32 m0,s63,2048
s_add_u32 s65,s58,196608
buffer_load_dwordx4 v6,s[4:7],s65 offen lds
s_add_u32 m0,s63,3072
s_add_u32 s65,s58,294912
buffer_load_dwordx4 v6,s[4:7],s65 offen lds
s_add_u32 m0,s63,4096
s_add_u32 s65,s58,393216
buffer_load_dwordx4 v6,s[4:7],s65 offen lds
s_add_u32 m0,s63,5120
s_add_u32 s65,s58,491520
buffer_load_dwordx4 v6,s[4:7],s65 offen lds
s_add_u32 m0,s63,6144
s_add_u32 s65,s58,589824
buffer_load_dwordx4 v6,s[4:7],s65 offen lds
s_add_u32 m0,s63,7168
s_add_u32 s65,s58,688128
buffer_load_dwordx4 v6,s[4:7],s65 offen lds
s_add_u32 m0,s63,8192
s_add_u32 s65,s58,786432
buffer_load_dwordx4 v6,s[4:7],s65 offen lds
s_add_u32 m0,s63,9216
s_add_u32 s65,s58,884736
buffer_load_dwordx4 v6,s[4:7],s65 offen lds
s_add_u32 m0,s63,10240
s_add_u32 s65,s58,983040
buffer_load_dwordx4 v6,s[4:7],s65 offen lds
s_add_u32 m0,s63,11264
s_add_u32 s65,s58,1081344
buffer_load_dwordx4 v6,s[4:7],s65 offen lds
s_add_u32 m0,s63,12288
s_add_u32 s65,s58,1179648
buffer_load_dwordx4 v6,s[4:7],s65 offen lds
s_add_u32 m0,s63,13312
s_add_u32 s65,s58,1277952
buffer_load_dwordx4 v6,s[4:7],s65 offen lds
s_add_u32 m0,s63,14336
s_add_u32 s65,s58,1376256
buffer_load_dwordx4 v6,s[4:7],s65 offen lds
s_add_u32 m0,s63,15360
s_add_u32 s65,s58,1474560
buffer_load_dwordx4 v6,s[4:7],s65 offen lds
s_add_u32 m0,s63,16384
s_add_u32 s65,s58,1572864
buffer_load_dwordx4 v6,s[4:7],s65 offen lds
s_add_u32 m0,s63,17408
s_add_u32 s65,s58,1671168
buffer_load_dwordx4 v6,s[4:7],s65 offen lds
s_add_u32 m0,s63,18432
s_add_u32 s65,s58,1769472
buffer_load_dwordx4 v6,s[4:7],s65 offen lds
s_add_u32 m0,s63,19456
s_add_u32 s65,s58,1867776
buffer_load_dwordx4 v6,s[4:7],s65 offen lds
s_add_u32 m0,s63,20480
s_add_u32 s65,s58,1966080
buffer_load_dwordx4 v6,s[4:7],s65 offen lds
s_add_u32 m0,s63,21504
s_add_u32 s65,s58,2064384
buffer_load_dwordx4 v6,s[4:7],s65 offen lds
s_add_u32 m0,s63,22528
s_add_u32 s65,s58,2162688
buffer_load_dwordx4 v6,s[4:7],s65 offen lds
s_add_u32 m0,s63,23552
s_add_u32 s65,s58,2260992
buffer_load_dwordx4 v6,s[4:7],s65 offen lds
s_add_u32 m0,s63,24576
s_add_u32 s65,s58,2359296
buffer_load_dwordx4 v6,s[4:7],s65 offen lds
s_add_u32 m0,s63,25600
s_add_u32 s65,s58,2457600
buffer_load_dwordx4 v6,s[4:7],s65 offen lds
s_add_u32 m0,s63,26624
s_add_u32 s65,s58,2555904
buffer_load_dwordx4 v6,s[4:7],s65 offen lds
s_add_u32 m0,s63,27648
s_add_u32 s65,s58,2654208
buffer_load_dwordx4 v6,s[4:7],s65 offen lds
s_add_u32 m0,s63,28672
s_add_u32 s65,s58,2752512
buffer_load_dwordx4 v6,s[4:7],s65 offen lds
s_add_u32 m0,s63,29696
s_add_u32 s65,s58,2850816
buffer_load_dwordx4 v6,s[4:7],s65 offen lds
s_add_u32 m0,s63,30720
s_add_u32 s65,s58,2949120
buffer_load_dwordx4 v6,s[4:7],s65 offen lds
s_add_u32 m0,s63,31744
s_add_u32 s65,s58,3047424
buffer_load_dwordx4 v6,s[4:7],s65 offen lds
s_add_u32 m0,s63,32768
s_add_u32 s65,s58,3145728
buffer_load_dwordx4 v6,s[4:7],s65 offen lds
s_add_u32 m0,s63,33792
s_add_u32 s65,s58,3244032
buffer_load_dwordx4 v6,s[4:7],s65 offen lds
s_add_u32 m0,s63,34816
s_add_u32 s65,s58,3342336
buffer_load_dwordx4 v6,s[4:7],s65 offen lds
s_add_u32 m0,s63,35840
s_add_u32 s65,s58,3440640
buffer_load_dwordx4 v6,s[4:7],s65 offen lds
s_add_u32 m0,s63,36864
s_add_u32 s65,s58,3538944
buffer_load_dwordx4 v6,s[4:7],s65 offen lds
s_add_u32 m0,s63,37888
s_add_u32 s65,s58,3637248
buffer_load_dwordx4 v6,s[4:7],s65 offen lds
s_add_u32 m0,s63,38912
s_add_u32 s65,s58,3735552
buffer_load_dwordx4 v6,s[4:7],s65 offen lds
s_add_u32 m0,s63,39936
s_add_u32 s65,s58,3833856
buffer_load_dwordx4 v6,s[4:7],s65 offen lds
s_waitcnt vmcnt(20)
v_bfe_u32 v9,v0,2,2
v_lshrrev_b32 v10,5,v0
v_lshl_add_u32 v9,v10,2,v9
v_mul_u32_u24 v9,128,v9
v_and_b32 v10,1,v0
v_lshl_add_u32 v9,v10,3,v9
v_bfe_u32 v10,v0,1,1
v_lshl_add_u32 v9,v10,4,v9
v_bfe_u32 v10,v0,4,1
v_lshl_add_u32 v9,v10,5,v9
v_add_u32 v7,s63,v9
ds_read_b64_tr_b16 a[0:1],v7 offset:0
ds_read_b64_tr_b16 a[2:3],v7 offset:2048
ds_read_b64_tr_b16 a[4:5],v7 offset:1024
ds_read_b64_tr_b16 a[6:7],v7 offset:3072
ds_read_b64_tr_b16 a[160:161],v7 offset:64
ds_read_b64_tr_b16 a[162:163],v7 offset:2112
ds_read_b64_tr_b16 a[164:165],v7 offset:1088
ds_read_b64_tr_b16 a[166:167],v7 offset:3136
ds_read_b64_tr_b16 a[8:9],v7 offset:4096
ds_read_b64_tr_b16 a[10:11],v7 offset:6144
ds_read_b64_tr_b16 a[12:13],v7 offset:5120
ds_read_b64_tr_b16 a[14:15],v7 offset:7168
s_waitcnt lgkmcnt(4)
ds_read_b64_tr_b16 a[168:169],v7 offset:4160
ds_read_b64_tr_b16 a[170:171],v7 offset:6208
ds_read_b64_tr_b16 a[172:173],v7 offset:5184
ds_read_b64_tr_b16 a[174:175],v7 offset:7232
ds_read_b64_tr_b16 a[16:17],v7 offset:8192
ds_read_b64_tr_b16 a[18:19],v7 offset:10240
ds_read_b64_tr_b16 a[20:21],v7 offset:9216
ds_read_b64_tr_b16 a[22:23],v7 offset:11264
ds_read_b64_tr_b16 a[176:177],v7 offset:8256
ds_read_b64_tr_b16 a[178:179],v7 offset:10304
ds_read_b64_tr_b16 a[180:181],v7 offset:9280
ds_read_b64_tr_b16 a[182:183],v7 offset:11328
s_waitcnt lgkmcnt(4)
ds_read_b64_tr_b16 a[24:25],v7 offset:12288
ds_read_b64_tr_b16 a[26:27],v7 offset:14336
ds_read_b64_tr_b16 a[28:29],v7 offset:13312
ds_read_b64_tr_b16 a[30:31],v7 offset:15360
ds_read_b64_tr_b16 a[184:185],v7 offset:12352
ds_read_b64_tr_b16 a[186:187],v7 offset:14400
ds_read_b64_tr_b16 a[188:189],v7 offset:13376
ds_read_b64_tr_b16 a[190:191],v7 offset:15424
ds_read_b64_tr_b16 a[32:33],v7 offset:16384
ds_read_b64_tr_b16 a[34:35],v7 offset:18432
ds_read_b64_tr_b16 a[36:37],v7 offset:17408
ds_read_b64_tr_b16 a[38:39],v7 offset:19456
s_waitcnt lgkmcnt(4)
ds_read_b64_tr_b16 a[192:193],v7 offset:16448
ds_read_b64_tr_b16 a[194:195],v7 offset:18496
ds_read_b64_tr_b16 a[196:197],v7 offset:17472
ds_read_b64_tr_b16 a[198:199],v7 offset:19520
s_waitcnt lgkmcnt(0)
s_add_u32 m0,s63,0
s_add_u32 s65,s58,3932160
buffer_load_dwordx4 v6,s[4:7],s65 offen lds
s_add_u32 m0,s63,1024
s_add_u32 s65,s58,4030464
buffer_load_dwordx4 v6,s[4:7],s65 offen lds
s_add_u32 m0,s63,2048
s_add_u32 s65,s58,4128768
buffer_load_dwordx4 v6,s[4:7],s65 offen lds
s_add_u32 m0,s63,3072
s_add_u32 s65,s58,4227072
buffer_load_dwordx4 v6,s[4:7],s65 offen lds
s_add_u32 m0,s63,4096
s_add_u32 s65,s58,4325376
buffer_load_dwordx4 v6,s[4:7],s65 offen lds
s_add_u32 m0,s63,5120
s_add_u32 s65,s58,4423680
buffer_load_dwordx4 v6,s[4:7],s65 offen lds
s_add_u32 m0,s63,6144
s_add_u32 s65,s58,4521984
buffer_load_dwordx4 v6,s[4:7],s65 offen lds
s_add_u32 m0,s63,7168
s_add_u32 s65,s58,4620288
buffer_load_dwordx4 v6,s[4:7],s65 offen lds
s_add_u32 m0,s63,8192
s_add_u32 s65,s58,4718592
buffer_load_dwordx4 v6,s[4:7],s65 offen lds
s_add_u32 m0,s63,9216
s_add_u32 s65,s58,4816896
buffer_load_dwordx4 v6,s[4:7],s65 offen lds
s_add_u32 m0,s63,10240
s_add_u32 s65,s58,4915200
buffer_load_dwordx4 v6,s[4:7],s65 offen lds
s_add_u32 m0,s63,11264
s_add_u32 s65,s58,5013504
buffer_load_dwordx4 v6,s[4:7],s65 offen lds
s_add_u32 m0,s63,12288
s_add_u32 s65,s58,5111808
buffer_load_dwordx4 v6,s[4:7],s65 offen lds
s_add_u32 m0,s63,13312
s_add_u32 s65,s58,5210112
buffer_load_dwordx4 v6,s[4:7],s65 offen lds
s_add_u32 m0,s63,14336
s_add_u32 s65,s58,5308416
buffer_load_dwordx4 v6,s[4:7],s65 offen lds
s_add_u32 m0,s63,15360
s_add_u32 s65,s58,5406720
buffer_load_dwordx4 v6,s[4:7],s65 offen lds
s_add_u32 m0,s63,16384
s_add_u32 s65,s58,5505024
buffer_load_dwordx4 v6,s[4:7],s65 offen lds
s_add_u32 m0,s63,17408
s_add_u32 s65,s58,5603328
buffer_load_dwordx4 v6,s[4:7],s65 offen lds
s_add_u32 m0,s63,18432
s_add_u32 s65,s58,5701632
buffer_load_dwordx4 v6,s[4:7],s65 offen lds
s_add_u32 m0,s63,19456
s_add_u32 s65,s58,5799936
buffer_load_dwordx4 v6,s[4:7],s65 offen lds
s_waitcnt vmcnt(20)
v_bfe_u32 v9,v0,2,2
v_lshrrev_b32 v10,5,v0
v_lshl_add_u32 v9,v10,2,v9
v_mul_u32_u24 v9,128,v9
v_and_b32 v10,1,v0
v_lshl_add_u32 v9,v10,3,v9
v_bfe_u32 v10,v0,1,1
v_lshl_add_u32 v9,v10,4,v9
v_bfe_u32 v10,v0,4,1
v_lshl_add_u32 v9,v10,5,v9
v_add_u32 v7,s63,v9
ds_read_b64_tr_b16 a[40:41],v7 offset:20480
ds_read_b64_tr_b16 a[42:43],v7 offset:22528
ds_read_b64_tr_b16 a[44:45],v7 offset:21504
ds_read_b64_tr_b16 a[46:47],v7 offset:23552
ds_read_b64_tr_b16 a[200:201],v7 offset:20544
ds_read_b64_tr_b16 a[202:203],v7 offset:22592
ds_read_b64_tr_b16 a[204:205],v7 offset:21568
ds_read_b64_tr_b16 a[206:207],v7 offset:23616
ds_read_b64_tr_b16 a[48:49],v7 offset:24576
ds_read_b64_tr_b16 a[50:51],v7 offset:26624
ds_read_b64_tr_b16 a[52:53],v7 offset:25600
ds_read_b64_tr_b16 a[54:55],v7 offset:27648
s_waitcnt lgkmcnt(4)
ds_read_b64_tr_b16 a[208:209],v7 offset:24640
ds_read_b64_tr_b16 a[210:211],v7 offset:26688
ds_read_b64_tr_b16 a[212:213],v7 offset:25664
ds_read_b64_tr_b16 a[214:215],v7 offset:27712
ds_read_b64_tr_b16 a[56:57],v7 offset:28672
ds_read_b64_tr_b16 a[58:59],v7 offset:30720
ds_read_b64_tr_b16 a[60:61],v7 offset:29696
ds_read_b64_tr_b16 a[62:63],v7 offset:31744
ds_read_b64_tr_b16 a[216:217],v7 offset:28736
ds_read_b64_tr_b16 a[218:219],v7 offset:30784
ds_read_b64_tr_b16 a[220:221],v7 offset:29760
ds_read_b64_tr_b16 a[222:223],v7 offset:31808
s_waitcnt lgkmcnt(4)
ds_read_b64_tr_b16 a[64:65],v7 offset:32768
ds_read_b64_tr_b16 a[66:67],v7 offset:34816
ds_read_b64_tr_b16 a[68:69],v7 offset:33792
ds_read_b64_tr_b16 a[70:71],v7 offset:35840
ds_read_b64_tr_b16 a[224:225],v7 offset:32832
ds_read_b64_tr_b16 a[226:227],v7 offset:34880
ds_read_b64_tr_b16 a[228:229],v7 offset:33856
ds_read_b64_tr_b16 a[230:231],v7 offset:35904
ds_read_b64_tr_b16 a[72:73],v7 offset:36864
ds_read_b64_tr_b16 a[74:75],v7 offset:38912
ds_read_b64_tr_b16 a[76:77],v7 offset:37888
ds_read_b64_tr_b16 a[78:79],v7 offset:39936
s_waitcnt lgkmcnt(4)
ds_read_b64_tr_b16 a[232:233],v7 offset:36928
ds_read_b64_tr_b16 a[234:235],v7 offset:38976
ds_read_b64_tr_b16 a[236:237],v7 offset:37952
ds_read_b64_tr_b16 a[238:239],v7 offset:40000
s_waitcnt lgkmcnt(0)
s_add_u32 m0,s63,20480
s_add_u32 s65,s58,5898240
buffer_load_dwordx4 v6,s[4:7],s65 offen lds
s_add_u32 m0,s63,21504
s_add_u32 s65,s58,5996544
buffer_load_dwordx4 v6,s[4:7],s65 offen lds
s_add_u32 m0,s63,22528
s_add_u32 s65,s58,6094848
buffer_load_dwordx4 v6,s[4:7],s65 offen lds
s_add_u32 m0,s63,23552
s_add_u32 s65,s58,6193152
buffer_load_dwordx4 v6,s[4:7],s65 offen lds
s_add_u32 m0,s63,24576
s_add_u32 s65,s58,6291456
buffer_load_dwordx4 v6,s[4:7],s65 offen lds
s_add_u32 m0,s63,25600
s_add_u32 s65,s58,6389760
buffer_load_dwordx4 v6,s[4:7],s65 offen lds
s_add_u32 m0,s63,26624
s_add_u32 s65,s58,6488064
buffer_load_dwordx4 v6,s[4:7],s65 offen lds
s_add_u32 m0,s63,27648
s_add_u32 s65,s58,6586368
buffer_load_dwordx4 v6,s[4:7],s65 offen lds
s_add_u32 m0,s63,28672
s_add_u32 s65,s58,6684672
buffer_load_dwordx4 v6,s[4:7],s65 offen lds
s_add_u32 m0,s63,29696
s_add_u32 s65,s58,6782976
buffer_load_dwordx4 v6,s[4:7],s65 offen lds
s_add_u32 m0,s63,30720
s_add_u32 s65,s58,6881280
buffer_load_dwordx4 v6,s[4:7],s65 offen lds
s_add_u32 m0,s63,31744
s_add_u32 s65,s58,6979584
buffer_load_dwordx4 v6,s[4:7],s65 offen lds
s_add_u32 m0,s63,32768
s_add_u32 s65,s58,7077888
buffer_load_dwordx4 v6,s[4:7],s65 offen lds
s_add_u32 m0,s63,33792
s_add_u32 s65,s58,7176192
buffer_load_dwordx4 v6,s[4:7],s65 offen lds
s_add_u32 m0,s63,34816
s_add_u32 s65,s58,7274496
buffer_load_dwordx4 v6,s[4:7],s65 offen lds
s_add_u32 m0,s63,35840
s_add_u32 s65,s58,7372800
buffer_load_dwordx4 v6,s[4:7],s65 offen lds
s_add_u32 m0,s63,36864
s_add_u32 s65,s58,7471104
buffer_load_dwordx4 v6,s[4:7],s65 offen lds
s_add_u32 m0,s63,37888
s_add_u32 s65,s58,7569408
buffer_load_dwordx4 v6,s[4:7],s65 offen lds
s_add_u32 m0,s63,38912
s_add_u32 s65,s58,7667712
buffer_load_dwordx4 v6,s[4:7],s65 offen lds
s_add_u32 m0,s63,39936
s_add_u32 s65,s58,7766016
buffer_load_dwordx4 v6,s[4:7],s65 offen lds
s_waitcnt vmcnt(20)
v_bfe_u32 v9,v0,2,2
v_lshrrev_b32 v10,5,v0
v_lshl_add_u32 v9,v10,2,v9
v_mul_u32_u24 v9,128,v9
v_and_b32 v10,1,v0
v_lshl_add_u32 v9,v10,3,v9
v_bfe_u32 v10,v0,1,1
v_lshl_add_u32 v9,v10,4,v9
v_bfe_u32 v10,v0,4,1
v_lshl_add_u32 v9,v10,5,v9
v_add_u32 v7,s63,v9
ds_read_b64_tr_b16 a[80:81],v7 offset:0
ds_read_b64_tr_b16 a[82:83],v7 offset:2048
ds_read_b64_tr_b16 a[84:85],v7 offset:1024
ds_read_b64_tr_b16 a[86:87],v7 offset:3072
ds_read_b64_tr_b16 a[240:241],v7 offset:64
ds_read_b64_tr_b16 a[242:243],v7 offset:2112
ds_read_b64_tr_b16 a[244:245],v7 offset:1088
ds_read_b64_tr_b16 a[246:247],v7 offset:3136
ds_read_b64_tr_b16 a[88:89],v7 offset:4096
ds_read_b64_tr_b16 a[90:91],v7 offset:6144
ds_read_b64_tr_b16 a[92:93],v7 offset:5120
ds_read_b64_tr_b16 a[94:95],v7 offset:7168
s_waitcnt lgkmcnt(4)
ds_read_b64_tr_b16 a[248:249],v7 offset:4160
ds_read_b64_tr_b16 a[250:251],v7 offset:6208
ds_read_b64_tr_b16 a[252:253],v7 offset:5184
ds_read_b64_tr_b16 a[254:255],v7 offset:7232
ds_read_b64_tr_b16 a[96:97],v7 offset:8192
ds_read_b64_tr_b16 a[98:99],v7 offset:10240
ds_read_b64_tr_b16 a[100:101],v7 offset:9216
ds_read_b64_tr_b16 a[102:103],v7 offset:11264
ds_read_b64_tr_b16 v[192:193],v7 offset:8256
ds_read_b64_tr_b16 v[194:195],v7 offset:10304
ds_read_b64_tr_b16 v[196:197],v7 offset:9280
ds_read_b64_tr_b16 v[198:199],v7 offset:11328
s_waitcnt lgkmcnt(4)
ds_read_b64_tr_b16 a[104:105],v7 offset:12288
ds_read_b64_tr_b16 a[106:107],v7 offset:14336
ds_read_b64_tr_b16 a[108:109],v7 offset:13312
ds_read_b64_tr_b16 a[110:111],v7 offset:15360
ds_read_b64_tr_b16 v[200:201],v7 offset:12352
ds_read_b64_tr_b16 v[202:203],v7 offset:14400
ds_read_b64_tr_b16 v[204:205],v7 offset:13376
ds_read_b64_tr_b16 v[206:207],v7 offset:15424
ds_read_b64_tr_b16 a[112:113],v7 offset:16384
ds_read_b64_tr_b16 a[114:115],v7 offset:18432
ds_read_b64_tr_b16 a[116:117],v7 offset:17408
ds_read_b64_tr_b16 a[118:119],v7 offset:19456
s_waitcnt lgkmcnt(4)
ds_read_b64_tr_b16 v[208:209],v7 offset:16448
ds_read_b64_tr_b16 v[210:211],v7 offset:18496
ds_read_b64_tr_b16 v[212:213],v7 offset:17472
ds_read_b64_tr_b16 v[214:215],v7 offset:19520
s_waitcnt lgkmcnt(0)
s_waitcnt vmcnt(0)
v_bfe_u32 v9,v0,2,2
v_lshrrev_b32 v10,5,v0
v_lshl_add_u32 v9,v10,2,v9
v_mul_u32_u24 v9,128,v9
v_and_b32 v10,1,v0
v_lshl_add_u32 v9,v10,3,v9
v_bfe_u32 v10,v0,1,1
v_lshl_add_u32 v9,v10,4,v9
v_bfe_u32 v10,v0,4,1
v_lshl_add_u32 v9,v10,5,v9
v_add_u32 v7,s63,v9
ds_read_b64_tr_b16 a[120:121],v7 offset:20480
ds_read_b64_tr_b16 a[122:123],v7 offset:22528
ds_read_b64_tr_b16 a[124:125],v7 offset:21504
ds_read_b64_tr_b16 a[126:127],v7 offset:23552
ds_read_b64_tr_b16 v[216:217],v7 offset:20544
ds_read_b64_tr_b16 v[218:219],v7 offset:22592
ds_read_b64_tr_b16 v[220:221],v7 offset:21568
ds_read_b64_tr_b16 v[222:223],v7 offset:23616
ds_read_b64_tr_b16 a[128:129],v7 offset:24576
ds_read_b64_tr_b16 a[130:131],v7 offset:26624
ds_read_b64_tr_b16 a[132:133],v7 offset:25600
ds_read_b64_tr_b16 a[134:135],v7 offset:27648
s_waitcnt lgkmcnt(4)
ds_read_b64_tr_b16 v[224:225],v7 offset:24640
ds_read_b64_tr_b16 v[226:227],v7 offset:26688
ds_read_b64_tr_b16 v[228:229],v7 offset:25664
ds_read_b64_tr_b16 v[230:231],v7 offset:27712
ds_read_b64_tr_b16 a[136:137],v7 offset:28672
ds_read_b64_tr_b16 a[138:139],v7 offset:30720
ds_read_b64_tr_b16 a[140:141],v7 offset:29696
ds_read_b64_tr_b16 a[142:143],v7 offset:31744
ds_read_b64_tr_b16 v[232:233],v7 offset:28736
ds_read_b64_tr_b16 v[234:235],v7 offset:30784
ds_read_b64_tr_b16 v[236:237],v7 offset:29760
ds_read_b64_tr_b16 v[238:239],v7 offset:31808
s_waitcnt lgkmcnt(4)
ds_read_b64_tr_b16 a[144:145],v7 offset:32768
ds_read_b64_tr_b16 a[146:147],v7 offset:34816
ds_read_b64_tr_b16 a[148:149],v7 offset:33792
ds_read_b64_tr_b16 a[150:151],v7 offset:35840
ds_read_b64_tr_b16 v[240:241],v7 offset:32832
ds_read_b64_tr_b16 v[242:243],v7 offset:34880
ds_read_b64_tr_b16 v[244:245],v7 offset:33856
ds_read_b64_tr_b16 v[246:247],v7 offset:35904
ds_read_b64_tr_b16 a[152:153],v7 offset:36864
ds_read_b64_tr_b16 a[154:155],v7 offset:38912
ds_read_b64_tr_b16 a[156:157],v7 offset:37888
ds_read_b64_tr_b16 a[158:159],v7 offset:39936
s_waitcnt lgkmcnt(4)
ds_read_b64_tr_b16 v[248:249],v7 offset:36928
ds_read_b64_tr_b16 v[250:251],v7 offset:38976
ds_read_b64_tr_b16 v[252:253],v7 offset:37952
ds_read_b64_tr_b16 v[254:255],v7 offset:40000
s_waitcnt lgkmcnt(0)
v_mov_b32 v24,0x3f803f80
v_mov_b32 v25,0x3f803f80
v_mov_b32 v26,0x3f803f80
v_mov_b32 v27,0x3f803f80
s_nop 1
v_mfma_f32_32x32x16_bf16 v[56:71],v[24:27],a[0:3],0
v_mfma_f32_32x32x16_bf16 v[72:87],v[24:27],a[160:163],0
v_mfma_f32_32x32x16_bf16 v[56:71],v[24:27],a[4:7],v[56:71]
v_mfma_f32_32x32x16_bf16 v[72:87],v[24:27],a[164:167],v[72:87]
v_mfma_f32_32x32x16_bf16 v[56:71],v[24:27],a[8:11],v[56:71]
v_mfma_f32_32x32x16_bf16 v[72:87],v[24:27],a[168:171],v[72:87]
v_mfma_f32_32x32x16_bf16 v[56:71],v[24:27],a[12:15],v[56:71]
v_mfma_f32_32x32x16_bf16 v[72:87],v[24:27],a[172:175],v[72:87]
v_mfma_f32_32x32x16_bf16 v[56:71],v[24:27],a[16:19],v[56:71]
v_mfma_f32_32x32x16_bf16 v[72:87],v[24:27],a[176:179],v[72:87]
v_mfma_f32_32x32x16_bf16 v[56:71],v[24:27],a[20:23],v[56:71]
v_mfma_f32_32x32x16_bf16 v[72:87],v[24:27],a[180:183],v[72:87]
v_mfma_f32_32x32x16_bf16 v[56:71],v[24:27],a[24:27],v[56:71]
v_mfma_f32_32x32x16_bf16 v[72:87],v[24:27],a[184:187],v[72:87]
v_mfma_f32_32x32x16_bf16 v[56:71],v[24:27],a[28:31],v[56:71]
v_mfma_f32_32x32x16_bf16 v[72:87],v[24:27],a[188:191],v[72:87]
v_mfma_f32_32x32x16_bf16 v[56:71],v[24:27],a[32:35],v[56:71]
v_mfma_f32_32x32x16_bf16 v[72:87],v[24:27],a[192:195],v[72:87]
v_mfma_f32_32x32x16_bf16 v[56:71],v[24:27],a[36:39],v[56:71]
v_mfma_f32_32x32x16_bf16 v[72:87],v[24:27],a[196:199],v[72:87]
v_mfma_f32_32x32x16_bf16 v[56:71],v[24:27],a[40:43],v[56:71]
v_mfma_f32_32x32x16_bf16 v[72:87],v[24:27],a[200:203],v[72:87]
v_mfma_f32_32x32x16_bf16 v[56:71],v[24:27],a[44:47],v[56:71]
v_mfma_f32_32x32x16_bf16 v[72:87],v[24:27],a[204:207],v[72:87]
v_mfma_f32_32x32x16_bf16 v[56:71],v[24:27],a[48:51],v[56:71]
v_mfma_f32_32x32x16_bf16 v[72:87],v[24:27],a[208:211],v[72:87]
v_mfma_f32_32x32x16_bf16 v[56:71],v[24:27],a[52:55],v[56:71]
v_mfma_f32_32x32x16_bf16 v[72:87],v[24:27],a[212:215],v[72:87]
v_mfma_f32_32x32x16_bf16 v[56:71],v[24:27],a[56:59],v[56:71]
v_mfma_f32_32x32x16_bf16 v[72:87],v[24:27],a[216:219],v[72:87]
v_mfma_f32_32x32x16_bf16 v[56:71],v[24:27],a[60:63],v[56:71]
v_mfma_f32_32x32x16_bf16 v[72:87],v[24:27],a[220:223],v[72:87]
v_mfma_f32_32x32x16_bf16 v[56:71],v[24:27],a[64:67],v[56:71]
v_mfma_f32_32x32x16_bf16 v[72:87],v[24:27],a[224:227],v[72:87]
v_mfma_f32_32x32x16_bf16 v[56:71],v[24:27],a[68:71],v[56:71]
v_mfma_f32_32x32x16_bf16 v[72:87],v[24:27],a[228:231],v[72:87]
v_mfma_f32_32x32x16_bf16 v[56:71],v[24:27],a[72:75],v[56:71]
v_mfma_f32_32x32x16_bf16 v[72:87],v[24:27],a[232:235],v[72:87]
v_mfma_f32_32x32x16_bf16 v[56:71],v[24:27],a[76:79],v[56:71]
v_mfma_f32_32x32x16_bf16 v[72:87],v[24:27],a[236:239],v[72:87]
v_mfma_f32_32x32x16_bf16 v[56:71],v[24:27],a[80:83],v[56:71]
v_mfma_f32_32x32x16_bf16 v[72:87],v[24:27],a[240:243],v[72:87]
v_mfma_f32_32x32x16_bf16 v[56:71],v[24:27],a[84:87],v[56:71]
v_mfma_f32_32x32x16_bf16 v[72:87],v[24:27],a[244:247],v[72:87]
v_mfma_f32_32x32x16_bf16 v[56:71],v[24:27],a[88:91],v[56:71]
v_mfma_f32_32x32x16_bf16 v[72:87],v[24:27],a[248:251],v[72:87]
v_mfma_f32_32x32x16_bf16 v[56:71],v[24:27],a[92:95],v[56:71]
v_mfma_f32_32x32x16_bf16 v[72:87],v[24:27],a[252:255],v[72:87]
v_mfma_f32_32x32x16_bf16 v[56:71],v[24:27],a[96:99],v[56:71]
v_mfma_f32_32x32x16_bf16 v[72:87],v[24:27],v[192:195],v[72:87]
v_mfma_f32_32x32x16_bf16 v[56:71],v[24:27],a[100:103],v[56:71]
v_mfma_f32_32x32x16_bf16 v[72:87],v[24:27],v[196:199],v[72:87]
v_mfma_f32_32x32x16_bf16 v[56:71],v[24:27],a[104:107],v[56:71]
v_mfma_f32_32x32x16_bf16 v[72:87],v[24:27],v[200:203],v[72:87]
v_mfma_f32_32x32x16_bf16 v[56:71],v[24:27],a[108:111],v[56:71]
v_mfma_f32_32x32x16_bf16 v[72:87],v[24:27],v[204:207],v[72:87]
v_mfma_f32_32x32x16_bf16 v[56:71],v[24:27],a[112:115],v[56:71]
v_mfma_f32_32x32x16_bf16 v[72:87],v[24:27],v[208:211],v[72:87]
v_mfma_f32_32x32x16_bf16 v[56:71],v[24:27],a[116:119],v[56:71]
v_mfma_f32_32x32x16_bf16 v[72:87],v[24:27],v[212:215],v[72:87]
v_mfma_f32_32x32x16_bf16 v[56:71],v[24:27],a[120:123],v[56:71]
v_mfma_f32_32x32x16_bf16 v[72:87],v[24:27],v[216:219],v[72:87]
v_mfma_f32_32x32x16_bf16 v[56:71],v[24:27],a[124:127],v[56:71]
v_mfma_f32_32x32x16_bf16 v[72:87],v[24:27],v[220:223],v[72:87]
v_mfma_f32_32x32x16_bf16 v[56:71],v[24:27],a[128:131],v[56:71]
v_mfma_f32_32x32x16_bf16 v[72:87],v[24:27],v[224:227],v[72:87]
v_mfma_f32_32x32x16_bf16 v[56:71],v[24:27],a[132:135],v[56:71]
v_mfma_f32_32x32x16_bf16 v[72:87],v[24:27],v[228:231],v[72:87]
v_mfma_f32_32x32x16_bf16 v[56:71],v[24:27],a[136:139],v[56:71]
v_mfma_f32_32x32x16_bf16 v[72:87],v[24:27],v[232:235],v[72:87]
v_mfma_f32_32x32x16_bf16 v[56:71],v[24:27],a[140:143],v[56:71]
v_mfma_f32_32x32x16_bf16 v[72:87],v[24:27],v[236:239],v[72:87]
v_mfma_f32_32x32x16_bf16 v[56:71],v[24:27],a[144:147],v[56:71]
v_mfma_f32_32x32x16_bf16 v[72:87],v[24:27],v[240:243],v[72:87]
v_mfma_f32_32x32x16_bf16 v[56:71],v[24:27],a[148:151],v[56:71]
v_mfma_f32_32x32x16_bf16 v[72:87],v[24:27],v[244:247],v[72:87]
v_mfma_f32_32x32x16_bf16 v[56:71],v[24:27],a[152:155],v[56:71]
v_mfma_f32_32x32x16_bf16 v[72:87],v[24:27],v[248:251],v[72:87]
v_mfma_f32_32x32x16_bf16 v[56:71],v[24:27],a[156:159],v[56:71]
v_mfma_f32_32x32x16_bf16 v[72:87],v[24:27],v[252:255],v[72:87]
s_nop 10
v_mov_b32 v120,v56
v_mov_b32 v121,v72
s_barrier
s_lshl_b32 s3,s49,2
v_mov_b32 v7,s3
s_nop 1
ibw_234:
buffer_load_dword v6,v7,s[12:15],0 offen sc1
s_waitcnt vmcnt(0)
v_cmp_ne_u32 vcc,256,v6
s_nop 0
s_cbranch_vccz ok_235
s_sleep 8
s_sub_u32 s47,s47,1
s_cbranch_scc1 ABORT
s_branch ibw_234
ok_235:
s_cmp_lg_u32 s49,0
s_cbranch_scc1 ibok_236
v_and_b32 v7,7,v0
v_lshlrev_b32 v7,2,v7
buffer_load_dword v6,v7,s[12:15],0 offen offset:32 sc1
s_waitcnt vmcnt(0)
v_cmp_ne_u32 vcc,32,v6
s_nop 0
s_cbranch_vccz ibok_236
s_barrier
s_mov_b32 s49,1
s_mov_b32 s3,s2
s_load_dwordx16 s[16:31],s[0:1],0
s_load_dwordx8 s[32:39],s[0:1],64
s_waitcnt lgkmcnt(0)
s_branch DISPATCH
ibok_236:
s_mov_b32 s50,0
s_mov_b32 s32,0
s_mov_b32 s57,0
s_mov_b32 s59,2147483648
s_mov_b32 s82,2147483648
s_mov_b32 s39,2147483648
v_mov_b32 v22,94208
s_mov_b32 s72,0
s_mov_b32 s73,0
s_mov_b32 s83,s100
s_min_u32 s62,s32,127
s_sub_u32 s60,s62,20
s_lshr_b32 s34,s60,1
s_and_b32 s33,s60,1
s_xor_b32 s33,s33,1
s_cmp_eq_u32 s33,0
s_cselect_b32 s61,20,0
s_add_u32 s34,s34,s61
s_sub_u32 s61,s60,44
s_cmp_ge_u32 s60,88
s_cselect_b32 s34,s61,s34
s_cselect_b32 s33,1,s33
s_cmp_lt_u32 s62,20
s_cselect_b32 s34,s62,s34
s_cselect_b32 s33,0,s33
s_lshl_b32 s35,s33,6
s_add_u32 s35,s35,s34
s_lshl_b32 s35,s35,9
s_add_u32 s35,s35,0
s_lshl_b32 s60,s33,5
s_add_u32 s60,s60,7
v_min_u32 v2,s60,v0
v_lshlrev_b32 v2,2,v2
s_nop 1
QKVV_COLD0:
s_cmp_lg_u32 s46,0
s_cbranch_scc1 cp_237
fb_238:
buffer_load_dword v3,v2,s[8:11],s35 offen sc1
s_waitcnt vmcnt(0)
v_cmp_eq_u32 vcc,0,v3
s_nop 0
s_cbranch_vccz ok_239
s_sleep 7
s_sub_u32 s47,s47,1
s_cbranch_scc1 ABORT
s_branch fb_238
ok_239:
cp_237:
s_barrier
s_lshl_b32 s60,s33,6
s_add_u32 s60,s60,s34
s_mul_i32 s60,s60,46080
s_add_u32 s60,s60,206569472
s_lshl_b32 s62,s46,10
s_add_u32 s62,s62,40960
s_add_u32 m0,s57,s62
s_add_u32 s63,s60,s62
buffer_load_dwordx4 v1,s[8:11],s63 offen sc1 lds
s_add_u32 m0,s57,45056
s_add_u32 s63,s60,45056
buffer_load_dwordx4 v1,s[8:11],s63 offen sc1 lds
s_mul_i32 s61,s46,10240
s_add_u32 s60,s60,s61
s_add_u32 s61,s61,s57
s_add_u32 m0,s61,0
s_add_u32 s63,s60,0
buffer_load_dwordx4 v1,s[8:11],s63 offen sc1 lds
buffer_load_dwordx4 v1,s[8:11],s63 offen offset:1024 sc1 lds
buffer_load_dwordx4 v1,s[8:11],s63 offen offset:2048 sc1 lds
buffer_load_dwordx4 v1,s[8:11],s63 offen offset:3072 sc1 lds
s_add_u32 m0,s61,4096
s_add_u32 s63,s60,4096
buffer_load_dwordx4 v1,s[8:11],s63 offen sc1 lds
buffer_load_dwordx4 v1,s[8:11],s63 offen offset:1024 sc1 lds
buffer_load_dwordx4 v1,s[8:11],s63 offen offset:2048 sc1 lds
buffer_load_dwordx4 v1,s[8:11],s63 offen offset:3072 sc1 lds
s_add_u32 m0,s61,8192
s_add_u32 s63,s60,8192
buffer_load_dwordx4 v1,s[8:11],s63 offen sc1 lds
buffer_load_dwordx4 v1,s[8:11],s63 offen offset:1024 sc1 lds
QKVV_CD0:
s_mov_b32 s51,s33
s_mov_b32 s52,s34
s_add_u32 s32,s32,1
s_min_u32 s62,s32,127
s_sub_u32 s60,s62,20
s_lshr_b32 s34,s60,1
s_and_b32 s33,s60,1
s_xor_b32 s33,s33,1
s_cmp_eq_u32 s33,0
s_cselect_b32 s61,20,0
s_add_u32 s34,s34,s61
s_sub_u32 s61,s60,44
s_cmp_ge_u32 s60,88
s_cselect_b32 s34,s61,s34
s_cselect_b32 s33,1,s33
s_cmp_lt_u32 s62,20
s_cselect_b32 s34,s62,s34
s_cselect_b32 s33,0,s33
s_lshl_b32 s35,s33,6
s_add_u32 s35,s35,s34
s_lshl_b32 s35,s35,9
s_add_u32 s35,s35,0
s_lshl_b32 s60,s33,5
s_add_u32 s60,s60,7
v_min_u32 v2,s60,v0
v_lshlrev_b32 v2,2,v2
s_cmp_lg_u32 s46,0
s_cbranch_scc1 w0_240
buffer_load_dword v3,v2,s[8:11],s35 offen sc1
w0_240:
s_waitcnt vmcnt(0)
s_mov_b64 exec,1
buffer_store_dword v5,v1,s[8:11],s59 offen sc1
s_mov_b64 exec,-1
s_mov_b32 s59,2147483648
s_cmp_lg_u32 s46,0
s_cbranch_scc1 w0_241
v_cmp_eq_u32 vcc,0,v3
s_cmp_eq_u64 vcc,0
s_cselect_b32 s36,0,2147483648
s_cmp_lt_u32 s32,128
s_cselect_b32 s36,s36,2147483648
v_mov_b32 v23,s36
ds_write_b32 v22,v23
w0_241:
s_waitcnt lgkmcnt(0)
s_barrier
ds_read_b32 v23,v22
ds_read_b128 v[24:27],v16 offset:0
ds_read_b128 v[28:31],v17 offset:0
ds_read_b128 v[32:35],v16 offset:2048
ds_read_b128 v[36:39],v17 offset:2048
ds_read_b128 v[40:43],v16 offset:4096
s_waitcnt lgkmcnt(5)
v_readfirstlane_b32 s37,v23
s_nop 4
QKVV_B0:
s_waitcnt lgkmcnt(3)
v_mfma_f32_32x32x16_bf16 v[56:71],v[24:27],a[0:3],0
ds_read_b128 v[44:47],v17 offset:4096
v_add_u32 v189,s57,v188
v_mfma_f32_32x32x16_bf16 v[72:87],v[24:27],a[160:163],0
v_add_u32 v8,0x800,v189
s_sub_u32 s66,46080,s57
s_lshl_b32 s60,s33,6
s_add_u32 s60,s60,s34
s_mul_i32 s60,s60,46080
s_add_u32 s60,s60,s37
v_mfma_f32_32x32x16_bf16 v[56:71],v[28:31],a[4:7],v[56:71]
ds_read_b128 v[48:51],v16 offset:6144
ds_read2_b64 v[156:159],v189 offset0:0 offset1:32
s_add_u32 s60,s60,206569472
s_lshl_b32 s62,s46,10
v_mfma_f32_32x32x16_bf16 v[72:87],v[28:31],a[164:167],v[72:87]
ds_read2_b64 v[160:163],v189 offset0:64 offset1:96
s_add_u32 s62,s62,40960
s_add_u32 m0,s66,s62
s_add_u32 s63,s60,s62
s_waitcnt lgkmcnt(5)
v_mfma_f32_32x32x16_bf16 v[56:71],v[32:35],a[8:11],v[56:71]
ds_read_b128 v[52:55],v17 offset:6144
ds_read2_b64 v[164:167],v189 offset0:128 offset1:160
buffer_load_dwordx4 v1,s[8:11],s63 offen sc1 lds
v_mfma_f32_32x32x16_bf16 v[72:87],v[32:35],a[168:171],v[72:87]
ds_read2_b64 v[168:171],v189 offset0:192 offset1:224
s_add_u32 m0,s66,45056
s_add_u32 s63,s60,45056
s_mul_i32 s74,s73,393216
s_add_u32 s74,s74,s39
v_mfma_f32_32x32x16_bf16 v[56:71],v[36:39],a[12:15],v[56:71]
ds_read_b128 v[24:27],v16 offset:8192
ds_read2_b64 v[172:175],v8 offset0:0 offset1:32
s_add_u32 s74,s74,s70
v_fma_f32 v88,-v124,v120,v88
v_mfma_f32_32x32x16_bf16 v[72:87],v[36:39],a[172:175],v[72:87]
buffer_load_dwordx4 v1,s[8:11],s63 offen sc1 lds
s_mul_i32 s61,s46,10240
s_add_u32 s60,s60,s61
s_add_u32 s61,s61,s66
s_waitcnt lgkmcnt(8)
v_mfma_f32_32x32x16_bf16 v[56:71],v[40:43],a[16:19],v[56:71]
ds_read_b128 v[28:31],v17 offset:8192
s_add_u32 m0,s61,0
s_add_u32 s63,s60,0
v_fma_f32 v89,-v126,v120,v89
v_fma_f32 v90,-v128,v120,v90
v_mfma_f32_32x32x16_bf16 v[72:87],v[40:43],a[176:179],v[72:87]
v_fma_f32 v91,-v130,v120,v91
v_fma_f32 v96,-v140,v120,v96
v_fma_f32 v97,-v142,v120,v97
v_fma_f32 v98,-v144,v120,v98
v_fma_f32 v99,-v146,v120,v99
v_mfma_f32_32x32x16_bf16 v[56:71],v[44:47],a[20:23],v[56:71]
ds_read_b128 v[32:35],v16 offset:10240
buffer_load_dwordx4 v1,s[8:11],s63 offen sc1 lds
v_mul_f32 v88,v88,v125
v_mul_f32 v89,v89,v127
v_mfma_f32_32x32x16_bf16 v[72:87],v[44:47],a[180:183],v[72:87]
v_mul_f32 v90,v90,v129
v_mul_f32 v91,v91,v131
v_mul_f32 v96,v96,v141
v_mul_f32 v97,v97,v143
v_mul_f32 v98,v98,v145
s_waitcnt lgkmcnt(6)
v_mfma_f32_32x32x16_bf16 v[56:71],v[48:51],a[24:27],v[56:71]
ds_read_b128 v[36:39],v17 offset:10240
v_mul_f32 v99,v99,v147
v_cvt_pk_bf16_f32 v180,v88,v89
v_cvt_pk_bf16_f32 v181,v90,v91
v_cvt_pk_bf16_f32 v182,v96,v97
v_mfma_f32_32x32x16_bf16 v[72:87],v[48:51],a[184:187],v[72:87]
buffer_load_dwordx4 v1,s[8:11],s63 offen offset:1024 sc1 lds
v_cvt_pk_bf16_f32 v183,v98,v99
buffer_store_dwordx4 v[180:183],v20,s[8:11],s74 offen sc1
v_fma_f32 v92,-v132,v120,v92
v_mfma_f32_32x32x16_bf16 v[56:71],v[52:55],a[28:31],v[56:71]
ds_read_b128 v[40:43],v16 offset:12288
v_fma_f32 v93,-v134,v120,v93
v_fma_f32 v94,-v136,v120,v94
v_fma_f32 v95,-v138,v120,v95
v_fma_f32 v100,-v148,v120,v100
v_mfma_f32_32x32x16_bf16 v[72:87],v[52:55],a[188:191],v[72:87]
v_fma_f32 v101,-v150,v120,v101
v_fma_f32 v102,-v152,v120,v102
v_fma_f32 v103,-v154,v120,v103
v_mul_f32 v92,v92,v133
v_mul_f32 v93,v93,v135
s_waitcnt lgkmcnt(3)
v_mfma_f32_32x32x16_bf16 v[56:71],v[24:27],a[32:35],v[56:71]
ds_read_b128 v[44:47],v17 offset:12288
buffer_load_dwordx4 v1,s[8:11],s63 offen offset:2048 sc1 lds
v_mul_f32 v94,v94,v137
v_mul_f32 v95,v95,v139
v_mfma_f32_32x32x16_bf16 v[72:87],v[24:27],a[192:195],v[72:87]
v_mul_f32 v100,v100,v149
v_mul_f32 v101,v101,v151
v_mul_f32 v102,v102,v153
v_mul_f32 v103,v103,v155
v_cvt_pk_bf16_f32 v184,v92,v93
v_mfma_f32_32x32x16_bf16 v[56:71],v[28:31],a[36:39],v[56:71]
ds_read_b128 v[48:51],v16 offset:14336
v_cvt_pk_bf16_f32 v185,v94,v95
v_cvt_pk_bf16_f32 v186,v100,v101
v_cvt_pk_bf16_f32 v187,v102,v103
v_mfma_f32_32x32x16_bf16 v[72:87],v[28:31],a[196:199],v[72:87]
buffer_load_dwordx4 v1,s[8:11],s63 offen offset:3072 sc1 lds
s_add_u32 m0,s61,4096
s_add_u32 s63,s60,4096
s_waitcnt lgkmcnt(3)
v_mfma_f32_32x32x16_bf16 v[56:71],v[32:35],a[40:43],v[56:71]
ds_read_b128 v[52:55],v17 offset:14336
buffer_store_dwordx4 v[184:187],v21,s[8:11],s74 offen sc1
v_fma_f32 v104,-v124,v121,v104
v_fma_f32 v105,-v126,v121,v105
v_mfma_f32_32x32x16_bf16 v[72:87],v[32:35],a[200:203],v[72:87]
v_fma_f32 v106,-v128,v121,v106
v_fma_f32 v107,-v130,v121,v107
v_fma_f32 v112,-v140,v121,v112
v_fma_f32 v113,-v142,v121,v113
v_fma_f32 v114,-v144,v121,v114
v_mfma_f32_32x32x16_bf16 v[56:71],v[36:39],a[44:47],v[56:71]
ds_read_b128 v[24:27],v16 offset:16384
buffer_load_dwordx4 v1,s[8:11],s63 offen sc1 lds
v_fma_f32 v115,-v146,v121,v115
v_mul_f32 v104,v104,v125
v_mfma_f32_32x32x16_bf16 v[72:87],v[36:39],a[204:207],v[72:87]
v_mul_f32 v105,v105,v127
v_mul_f32 v106,v106,v129
v_mul_f32 v107,v107,v131
v_mul_f32 v112,v112,v141
v_mul_f32 v113,v113,v143
s_waitcnt lgkmcnt(3)
v_mfma_f32_32x32x16_bf16 v[56:71],v[40:43],a[48:51],v[56:71]
ds_read_b128 v[28:31],v17 offset:16384
v_mul_f32 v114,v114,v145
v_mul_f32 v115,v115,v147
v_cvt_pk_bf16_f32 v180,v104,v105
v_cvt_pk_bf16_f32 v181,v106,v107
v_mfma_f32_32x32x16_bf16 v[72:87],v[40:43],a[208:211],v[72:87]
buffer_load_dwordx4 v1,s[8:11],s63 offen offset:1024 sc1 lds
v_cvt_pk_bf16_f32 v182,v112,v113
v_cvt_pk_bf16_f32 v183,v114,v115
buffer_store_dwordx4 v[180:183],v20,s[8:11],s74 offen offset:2048 sc1
v_mfma_f32_32x32x16_bf16 v[56:71],v[44:47],a[52:55],v[56:71]
ds_read_b128 v[32:35],v16 offset:18432
v_fma_f32 v108,-v132,v121,v108
v_fma_f32 v109,-v134,v121,v109
v_fma_f32 v110,-v136,v121,v110
v_fma_f32 v111,-v138,v121,v111
v_mfma_f32_32x32x16_bf16 v[72:87],v[44:47],a[212:215],v[72:87]
v_fma_f32 v116,-v148,v121,v116
v_fma_f32 v117,-v150,v121,v117
v_fma_f32 v118,-v152,v121,v118
v_fma_f32 v119,-v154,v121,v119
v_mul_f32 v108,v108,v133
s_waitcnt lgkmcnt(3)
v_mfma_f32_32x32x16_bf16 v[56:71],v[48:51],a[56:59],v[56:71]
ds_read_b128 v[36:39],v17 offset:18432
buffer_load_dwordx4 v1,s[8:11],s63 offen offset:2048 sc1 lds
v_mul_f32 v109,v109,v135
v_mul_f32 v110,v110,v137
v_mfma_f32_32x32x16_bf16 v[72:87],v[48:51],a[216:219],v[72:87]
v_mul_f32 v111,v111,v139
v_mul_f32 v116,v116,v149
v_mul_f32 v117,v117,v151
v_mul_f32 v118,v118,v153
v_mul_f32 v119,v119,v155
v_mfma_f32_32x32x16_bf16 v[56:71],v[52:55],a[60:63],v[56:71]
ds_read_b128 v[40:43],v16 offset:20480
s_waitcnt vmcnt(12)
s_mov_b64 exec,1
buffer_store_dword v5,v1,s[8:11],s59 offen sc1
s_mov_b64 exec,-1
s_mov_b32 s59,2147483648
v_mfma_f32_32x32x16_bf16 v[72:87],v[52:55],a[220:223],v[72:87]
buffer_load_dwordx4 v1,s[8:11],s63 offen offset:3072 sc1 lds
s_add_u32 m0,s61,8192
s_add_u32 s63,s60,8192
v_cvt_pk_bf16_f32 v184,v108,v109
s_waitcnt lgkmcnt(3)
v_mfma_f32_32x32x16_bf16 v[56:71],v[24:27],a[64:67],v[56:71]
ds_read_b128 v[44:47],v17 offset:20480
v_cvt_pk_bf16_f32 v185,v110,v111
v_cvt_pk_bf16_f32 v186,v116,v117
v_cvt_pk_bf16_f32 v187,v118,v119
v_mfma_f32_32x32x16_bf16 v[72:87],v[24:27],a[224:227],v[72:87]
buffer_store_dwordx4 v[184:187],v21,s[8:11],s74 offen offset:2048 sc1
s_lshl_b32 s82,s72,6
s_add_u32 s82,s82,s73
s_lshl_b32 s82,s82,9
s_add_u32 s82,s82,s71
v_mfma_f32_32x32x16_bf16 v[56:71],v[28:31],a[68:71],v[56:71]
ds_read_b128 v[48:51],v16 offset:22528
buffer_load_dwordx4 v1,s[8:11],s63 offen sc1 lds
s_lshl_b32 s75,s69,2
s_add_u32 s82,s82,s75
v_mfma_f32_32x32x16_bf16 v[72:87],v[28:31],a[228:231],v[72:87]
s_add_u32 s82,s82,s39
v_add_f32 v156,v156,v166
v_add_f32 v157,v157,v167
v_add_f32 v158,v158,v168
s_waitcnt lgkmcnt(3)
v_mfma_f32_32x32x16_bf16 v[56:71],v[32:35],a[72:75],v[56:71]
ds_read_b128 v[52:55],v17 offset:22528
v_add_f32 v159,v159,v169
v_add_f32 v160,v160,v170
v_add_f32 v161,v161,v171
v_add_f32 v162,v162,v172
v_mfma_f32_32x32x16_bf16 v[72:87],v[32:35],a[232:235],v[72:87]
buffer_load_dwordx4 v1,s[8:11],s63 offen offset:1024 sc1 lds
s_mov_b32 s53,s33
s_mov_b32 s54,s34
s_cmp_eq_u32 s37,0
s_addc_u32 s32,s32,0
v_mfma_f32_32x32x16_bf16 v[56:71],v[36:39],a[76:79],v[56:71]
ds_read_b128 v[24:27],v16 offset:24576
s_min_u32 s62,s32,127
s_sub_u32 s60,s62,20
s_lshr_b32 s34,s60,1
s_and_b32 s33,s60,1
v_mfma_f32_32x32x16_bf16 v[72:87],v[36:39],a[236:239],v[72:87]
s_xor_b32 s33,s33,1
s_cmp_eq_u32 s33,0
s_cselect_b32 s61,20,0
s_add_u32 s34,s34,s61
s_sub_u32 s61,s60,44
s_waitcnt lgkmcnt(3)
v_mfma_f32_32x32x16_bf16 v[56:71],v[40:43],a[80:83],v[56:71]
ds_read_b128 v[28:31],v17 offset:24576
s_cmp_ge_u32 s60,88
s_cselect_b32 s34,s61,s34
s_cselect_b32 s33,1,s33
v_add_f32 v163,v163,v173
v_mfma_f32_32x32x16_bf16 v[72:87],v[40:43],a[240:243],v[72:87]
s_cmp_lt_u32 s62,20
s_cselect_b32 s34,s62,s34
s_cselect_b32 s33,0,s33
s_lshl_b32 s35,s33,6
s_add_u32 s35,s35,s34
s_lshl_b32 s35,s35,9
v_mfma_f32_32x32x16_bf16 v[56:71],v[44:47],a[84:87],v[56:71]
ds_read_b128 v[32:35],v16 offset:26624
s_add_u32 s35,s35,0
s_lshl_b32 s60,s33,5
s_add_u32 s60,s60,7
v_min_u32 v2,s60,v0
v_mfma_f32_32x32x16_bf16 v[72:87],v[44:47],a[244:247],v[72:87]
v_lshlrev_b32 v2,2,v2
v_add_f32 v164,v164,v174
v_add_f32 v165,v165,v175
v_add_f32 v156,v156,v158
v_add_f32 v157,v157,v159
s_waitcnt lgkmcnt(3)
v_mfma_f32_32x32x16_bf16 v[56:71],v[48:51],a[88:91],v[56:71]
ds_read_b128 v[36:39],v17 offset:26624
s_cmp_lg_u32 s46,0
s_cbranch_scc1 w0_242
buffer_load_dword v3,v2,s[8:11],s35 offen sc1
w0_242:
v_mfma_f32_32x32x16_bf16 v[72:87],v[48:51],a[248:251],v[72:87]
v_add_f32 v160,v160,v162
v_add_f32 v161,v161,v163
v_add_f32 v156,v156,v160
v_add_f32 v157,v157,v161
v_add_f32 v156,v156,v164
v_mfma_f32_32x32x16_bf16 v[56:71],v[52:55],a[92:95],v[56:71]
ds_read_b128 v[40:43],v16 offset:28672
v_add_f32 v157,v157,v165
v_mov_b32 v158,v156
v_mov_b32 v159,v157
s_nop 0
v_permlane32_swap_b32 v156,v158
v_mfma_f32_32x32x16_bf16 v[72:87],v[52:55],a[252:255],v[72:87]
v_permlane32_swap_b32 v157,v159
v_add_f32 v176,v156,v158
v_add_f32 v177,v157,v159
v_mul_f32 v176,0x3acccccd,v176
v_mul_f32 v177,0x3acccccd,v177
s_waitcnt lgkmcnt(3)
v_mfma_f32_32x32x16_bf16 v[56:71],v[24:27],a[96:99],v[56:71]
ds_read_b128 v[44:47],v17 offset:28672
v_fma_f32 v177,-v176,v176,v177
v_max_f32 v177,0,v177
v_cvt_pk_bf16_f32 v8,v176,v177
v_lshlrev_b32 v176,16,v8
v_mfma_f32_32x32x16_bf16 v[72:87],v[24:27],v[192:195],v[72:87]
v_and_b32 v177,0xffff0000,v8
v_add_f32 v177,0x3727c5ac,v177
v_cvt_pk_bf16_f32 v8,v177,v177
v_lshlrev_b32 v177,16,v8
v_sqrt_f32 v177,v177
v_mfma_f32_32x32x16_bf16 v[56:71],v[28:31],a[100:103],v[56:71]
ds_read_b128 v[48:51],v16 offset:30720
v_cvt_pk_bf16_f32 v8,v177,v177
v_lshlrev_b32 v177,16,v8
v_rcp_f32 v177,v177
v_mfma_f32_32x32x16_bf16 v[72:87],v[28:31],v[196:199],v[72:87]
s_cmp_eq_u32 s51,0
s_cselect_b64 s[76:77],-1,0
v_cndmask_b32 v176,v176,0,s[76:77]
v_cndmask_b32 v177,v177,1.0,s[76:77]
s_mov_b32 s72,s51
s_waitcnt lgkmcnt(3)
v_mfma_f32_32x32x16_bf16 v[56:71],v[32:35],a[104:107],v[56:71]
ds_read_b128 v[52:55],v17 offset:30720
s_mov_b32 s73,s52
ds_write_b64 v190,v[176:177]
v_mfma_f32_32x32x16_bf16 v[72:87],v[32:35],v[200:203],v[72:87]
ds_read_b128 v[124:127],v191 offset:0
ds_read_b128 v[128:131],v191 offset:16
ds_read_b128 v[132:135],v191 offset:64
v_mfma_f32_32x32x16_bf16 v[56:71],v[36:39],a[108:111],v[56:71]
ds_read_b128 v[24:27],v16 offset:32768
ds_read_b128 v[136:139],v191 offset:80
ds_read_b128 v[140:143],v191 offset:128
v_mfma_f32_32x32x16_bf16 v[72:87],v[36:39],v[204:207],v[72:87]
ds_read_b128 v[144:147],v191 offset:144
ds_read_b128 v[148:151],v191 offset:192
s_waitcnt lgkmcnt(11)
v_mfma_f32_32x32x16_bf16 v[56:71],v[40:43],a[112:115],v[56:71]
ds_read_b128 v[28:31],v17 offset:32768
ds_read_b128 v[152:155],v191 offset:208
v_mfma_f32_32x32x16_bf16 v[72:87],v[40:43],v[208:211],v[72:87]
v_mfma_f32_32x32x16_bf16 v[56:71],v[44:47],a[116:119],v[56:71]
ds_read_b128 v[32:35],v16 offset:34816
v_mfma_f32_32x32x16_bf16 v[72:87],v[44:47],v[212:215],v[72:87]
s_waitcnt lgkmcnt(12)
v_mfma_f32_32x32x16_bf16 v[56:71],v[48:51],a[120:123],v[56:71]
ds_read_b128 v[36:39],v17 offset:34816
v_mfma_f32_32x32x16_bf16 v[72:87],v[48:51],v[216:219],v[72:87]
v_mfma_f32_32x32x16_bf16 v[56:71],v[52:55],a[124:127],v[56:71]
ds_read_b128 v[40:43],v16 offset:36864
v_mfma_f32_32x32x16_bf16 v[72:87],v[52:55],v[220:223],v[72:87]
s_waitcnt vmcnt(0)
s_cmp_lg_u32 s46,0
s_cbranch_scc1 w0_243
v_cmp_eq_u32 vcc,0,v3
s_cmp_eq_u64 vcc,0
s_cselect_b32 s36,0,2147483648
s_cmp_lt_u32 s32,128
s_cselect_b32 s36,s36,2147483648
v_mov_b32 v23,s36
ds_write_b32 v22,v23
w0_243:
s_waitcnt lgkmcnt(4)
v_mfma_f32_32x32x16_bf16 v[56:71],v[24:27],a[128:131],v[56:71]
ds_read_b128 v[44:47],v17 offset:36864
s_mov_b64 exec,1
buffer_store_dword v5,v1,s[8:11],s82 offen sc1
s_mov_b64 exec,-1
s_mov_b32 s82,2147483648
v_mfma_f32_32x32x16_bf16 v[72:87],v[24:27],v[224:227],v[72:87]
v_mfma_f32_32x32x16_bf16 v[56:71],v[28:31],a[132:135],v[56:71]
ds_read_b128 v[48:51],v16 offset:38912
v_mfma_f32_32x32x16_bf16 v[72:87],v[28:31],v[228:231],v[72:87]
s_waitcnt lgkmcnt(3)
v_mfma_f32_32x32x16_bf16 v[56:71],v[32:35],a[136:139],v[56:71]
ds_read_b128 v[52:55],v17 offset:38912
v_mfma_f32_32x32x16_bf16 v[72:87],v[32:35],v[232:235],v[72:87]
s_waitcnt lgkmcnt(2)
s_barrier
ds_read_b32 v23,v22
v_mfma_f32_32x32x16_bf16 v[56:71],v[36:39],a[140:143],v[56:71]
ds_read_b128 v[24:27],v18 offset:0
v_mfma_f32_32x32x16_bf16 v[72:87],v[36:39],v[236:239],v[72:87]
v_mfma_f32_32x32x16_bf16 v[56:71],v[40:43],a[144:147],v[56:71]
ds_read_b128 v[28:31],v19 offset:0
v_mfma_f32_32x32x16_bf16 v[72:87],v[40:43],v[240:243],v[72:87]
v_mfma_f32_32x32x16_bf16 v[56:71],v[44:47],a[148:151],v[56:71]
ds_read_b128 v[32:35],v18 offset:2048
v_mfma_f32_32x32x16_bf16 v[72:87],v[44:47],v[244:247],v[72:87]
s_waitcnt lgkmcnt(4)
v_mfma_f32_32x32x16_bf16 v[56:71],v[48:51],a[152:155],v[56:71]
ds_read_b128 v[36:39],v19 offset:2048
s_waitcnt lgkmcnt(4)
v_readfirstlane_b32 s38,v23
v_mfma_f32_32x32x16_bf16 v[72:87],v[48:51],v[248:251],v[72:87]
v_mfma_f32_32x32x16_bf16 v[56:71],v[52:55],a[156:159],v[56:71]
ds_read_b128 v[40:43],v18 offset:4096
v_mfma_f32_32x32x16_bf16 v[72:87],v[52:55],v[252:255],v[72:87]
s_cmp_lg_u32 s37,0
s_cbranch_scc1 nf_244
s_cmp_lt_u32 s50,2
s_cbranch_scc1 now_245
s_mov_b32 s39,0
s_add_u32 s50,s50,1
s_sub_u32 s57,46080,s57
s_mov_b32 s51,s53
s_mov_b32 s52,s54
s_mov_b32 s37,s38
s_branch QKVV_B1
s_nop 0
now_245:
s_mov_b32 s55,0
s_branch nt_246
nf_244:
s_mov_b32 s55,2
s_cmp_lg_u32 s38,0
s_cbranch_scc1 nt_246
s_mov_b32 s55,1
s_mov_b32 s37,0
s_sub_u32 s66,46080,s57
s_lshl_b32 s60,s33,6
s_add_u32 s60,s60,s34
s_mul_i32 s60,s60,46080
s_add_u32 s60,s60,s37
s_add_u32 s60,s60,206569472
s_lshl_b32 s62,s46,10
s_add_u32 s62,s62,40960
s_add_u32 m0,s66,s62
s_add_u32 s63,s60,s62
buffer_load_dwordx4 v1,s[8:11],s63 offen sc1 lds
s_add_u32 m0,s66,45056
s_add_u32 s63,s60,45056
buffer_load_dwordx4 v1,s[8:11],s63 offen sc1 lds
s_mul_i32 s61,s46,10240
s_add_u32 s60,s60,s61
s_add_u32 s61,s61,s66
s_add_u32 m0,s61,0
s_add_u32 s63,s60,0
buffer_load_dwordx4 v1,s[8:11],s63 offen sc1 lds
buffer_load_dwordx4 v1,s[8:11],s63 offen offset:1024 sc1 lds
buffer_load_dwordx4 v1,s[8:11],s63 offen offset:2048 sc1 lds
buffer_load_dwordx4 v1,s[8:11],s63 offen offset:3072 sc1 lds
s_add_u32 m0,s61,4096
s_add_u32 s63,s60,4096
buffer_load_dwordx4 v1,s[8:11],s63 offen sc1 lds
buffer_load_dwordx4 v1,s[8:11],s63 offen offset:1024 sc1 lds
buffer_load_dwordx4 v1,s[8:11],s63 offen offset:2048 sc1 lds
buffer_load_dwordx4 v1,s[8:11],s63 offen offset:3072 sc1 lds
s_add_u32 m0,s61,8192
s_add_u32 s63,s60,8192
buffer_load_dwordx4 v1,s[8:11],s63 offen sc1 lds
buffer_load_dwordx4 v1,s[8:11],s63 offen offset:1024 sc1 lds
nt_246:
s_mov_b32 s39,0
s_mul_i32 s74,s73,393216
s_add_u32 s74,s74,s39
s_add_u32 s74,s74,s70
v_fma_f32 v56,-v124,v120,v56
v_fma_f32 v57,-v126,v120,v57
v_fma_f32 v58,-v128,v120,v58
v_fma_f32 v59,-v130,v120,v59
v_fma_f32 v64,-v140,v120,v64
v_fma_f32 v65,-v142,v120,v65
v_fma_f32 v66,-v144,v120,v66
v_fma_f32 v67,-v146,v120,v67
v_mul_f32 v56,v56,v125
v_mul_f32 v57,v57,v127
v_mul_f32 v58,v58,v129
v_mul_f32 v59,v59,v131
v_mul_f32 v64,v64,v141
v_mul_f32 v65,v65,v143
v_mul_f32 v66,v66,v145
v_mul_f32 v67,v67,v147
v_cvt_pk_bf16_f32 v180,v56,v57
v_cvt_pk_bf16_f32 v181,v58,v59
v_cvt_pk_bf16_f32 v182,v64,v65
v_cvt_pk_bf16_f32 v183,v66,v67
buffer_store_dwordx4 v[180:183],v20,s[8:11],s74 offen sc1
v_fma_f32 v60,-v132,v120,v60
v_fma_f32 v61,-v134,v120,v61
v_fma_f32 v62,-v136,v120,v62
v_fma_f32 v63,-v138,v120,v63
v_fma_f32 v68,-v148,v120,v68
v_fma_f32 v69,-v150,v120,v69
v_fma_f32 v70,-v152,v120,v70
v_fma_f32 v71,-v154,v120,v71
v_mul_f32 v60,v60,v133
v_mul_f32 v61,v61,v135
v_mul_f32 v62,v62,v137
v_mul_f32 v63,v63,v139
v_mul_f32 v68,v68,v149
v_mul_f32 v69,v69,v151
v_mul_f32 v70,v70,v153
v_mul_f32 v71,v71,v155
v_cvt_pk_bf16_f32 v184,v60,v61
v_cvt_pk_bf16_f32 v185,v62,v63
v_cvt_pk_bf16_f32 v186,v68,v69
v_cvt_pk_bf16_f32 v187,v70,v71
buffer_store_dwordx4 v[184:187],v21,s[8:11],s74 offen sc1
v_fma_f32 v72,-v124,v121,v72
v_fma_f32 v73,-v126,v121,v73
v_fma_f32 v74,-v128,v121,v74
v_fma_f32 v75,-v130,v121,v75
v_fma_f32 v80,-v140,v121,v80
v_fma_f32 v81,-v142,v121,v81
v_fma_f32 v82,-v144,v121,v82
v_fma_f32 v83,-v146,v121,v83
v_mul_f32 v72,v72,v125
v_mul_f32 v73,v73,v127
v_mul_f32 v74,v74,v129
v_mul_f32 v75,v75,v131
v_mul_f32 v80,v80,v141
v_mul_f32 v81,v81,v143
v_mul_f32 v82,v82,v145
v_mul_f32 v83,v83,v147
v_cvt_pk_bf16_f32 v180,v72,v73
v_cvt_pk_bf16_f32 v181,v74,v75
v_cvt_pk_bf16_f32 v182,v80,v81
v_cvt_pk_bf16_f32 v183,v82,v83
buffer_store_dwordx4 v[180:183],v20,s[8:11],s74 offen offset:2048 sc1
v_fma_f32 v76,-v132,v121,v76
v_fma_f32 v77,-v134,v121,v77
v_fma_f32 v78,-v136,v121,v78
v_fma_f32 v79,-v138,v121,v79
v_fma_f32 v84,-v148,v121,v84
v_fma_f32 v85,-v150,v121,v85
v_fma_f32 v86,-v152,v121,v86
v_fma_f32 v87,-v154,v121,v87
v_mul_f32 v76,v76,v133
v_mul_f32 v77,v77,v135
v_mul_f32 v78,v78,v137
v_mul_f32 v79,v79,v139
v_mul_f32 v84,v84,v149
v_mul_f32 v85,v85,v151
v_mul_f32 v86,v86,v153
v_mul_f32 v87,v87,v155
v_cvt_pk_bf16_f32 v184,v76,v77
v_cvt_pk_bf16_f32 v185,v78,v79
v_cvt_pk_bf16_f32 v186,v84,v85
v_cvt_pk_bf16_f32 v187,v86,v87
buffer_store_dwordx4 v[184:187],v21,s[8:11],s74 offen offset:2048 sc1
s_lshl_b32 s82,s72,6
s_add_u32 s82,s82,s73
s_lshl_b32 s82,s82,9
s_add_u32 s82,s82,s71
s_lshl_b32 s75,s69,2
s_add_u32 s82,s82,s75
s_add_u32 s82,s82,s39
s_mov_b32 s59,s82
s_mov_b32 s82,2147483648
s_mov_b32 s39,2147483648
s_add_u32 s50,s50,1
s_sub_u32 s57,46080,s57
s_mov_b32 s51,s53
s_mov_b32 s52,s54
s_mov_b32 s37,s38
s_cmp_eq_u32 s55,0
s_cbranch_scc1 QKVV_B1
s_cmp_eq_u32 s55,1
s_cbranch_scc1 QKVV_CD1
s_waitcnt vmcnt(0)
s_mov_b64 exec,1
buffer_store_dword v5,v1,s[8:11],s59 offen sc1
s_mov_b64 exec,-1
s_mov_b32 s59,2147483648
s_cmp_eq_u32 s50,128
s_cbranch_scc1 QKVV_END
s_branch QKVV_COLD1
QKVV_COLD1:
s_cmp_lg_u32 s46,0
s_cbranch_scc1 cp_247
fb_248:
buffer_load_dword v3,v2,s[8:11],s35 offen sc1
s_waitcnt vmcnt(0)
v_cmp_eq_u32 vcc,0,v3
s_nop 0
s_cbranch_vccz ok_249
s_sleep 7
s_sub_u32 s47,s47,1
s_cbranch_scc1 ABORT
s_branch fb_248
ok_249:
cp_247:
s_barrier
s_lshl_b32 s60,s33,6
s_add_u32 s60,s60,s34
s_mul_i32 s60,s60,46080
s_add_u32 s60,s60,206569472
s_lshl_b32 s62,s46,10
s_add_u32 s62,s62,40960
s_add_u32 m0,s57,s62
s_add_u32 s63,s60,s62
buffer_load_dwordx4 v1,s[8:11],s63 offen sc1 lds
s_add_u32 m0,s57,45056
s_add_u32 s63,s60,45056
buffer_load_dwordx4 v1,s[8:11],s63 offen sc1 lds
s_mul_i32 s61,s46,10240
s_add_u32 s60,s60,s61
s_add_u32 s61,s61,s57
s_add_u32 m0,s61,0
s_add_u32 s63,s60,0
buffer_load_dwordx4 v1,s[8:11],s63 offen sc1 lds
buffer_load_dwordx4 v1,s[8:11],s63 offen offset:1024 sc1 lds
buffer_load_dwordx4 v1,s[8:11],s63 offen offset:2048 sc1 lds
buffer_load_dwordx4 v1,s[8:11],s63 offen offset:3072 sc1 lds
s_add_u32 m0,s61,4096
s_add_u32 s63,s60,4096
buffer_load_dwordx4 v1,s[8:11],s63 offen sc1 lds
buffer_load_dwordx4 v1,s[8:11],s63 offen offset:1024 sc1 lds
buffer_load_dwordx4 v1,s[8:11],s63 offen offset:2048 sc1 lds
buffer_load_dwordx4 v1,s[8:11],s63 offen offset:3072 sc1 lds
s_add_u32 m0,s61,8192
s_add_u32 s63,s60,8192
buffer_load_dwordx4 v1,s[8:11],s63 offen sc1 lds
buffer_load_dwordx4 v1,s[8:11],s63 offen offset:1024 sc1 lds
QKVV_CD1:
s_mov_b32 s51,s33
s_mov_b32 s52,s34
s_add_u32 s32,s32,1
s_min_u32 s62,s32,127
s_sub_u32 s60,s62,20
s_lshr_b32 s34,s60,1
s_and_b32 s33,s60,1
s_xor_b32 s33,s33,1
s_cmp_eq_u32 s33,0
s_cselect_b32 s61,20,0
s_add_u32 s34,s34,s61
s_sub_u32 s61,s60,44
s_cmp_ge_u32 s60,88
s_cselect_b32 s34,s61,s34
s_cselect_b32 s33,1,s33
s_cmp_lt_u32 s62,20
s_cselect_b32 s34,s62,s34
s_cselect_b32 s33,0,s33
s_lshl_b32 s35,s33,6
s_add_u32 s35,s35,s34
s_lshl_b32 s35,s35,9
s_add_u32 s35,s35,0
s_lshl_b32 s60,s33,5
s_add_u32 s60,s60,7
v_min_u32 v2,s60,v0
v_lshlrev_b32 v2,2,v2
s_cmp_lg_u32 s46,0
s_cbranch_scc1 w0_250
buffer_load_dword v3,v2,s[8:11],s35 offen sc1
w0_250:
s_waitcnt vmcnt(0)
s_mov_b64 exec,1
buffer_store_dword v5,v1,s[8:11],s59 offen sc1
s_mov_b64 exec,-1
s_mov_b32 s59,2147483648
s_cmp_lg_u32 s46,0
s_cbranch_scc1 w0_251
v_cmp_eq_u32 vcc,0,v3
s_cmp_eq_u64 vcc,0
s_cselect_b32 s36,0,2147483648
s_cmp_lt_u32 s32,128
s_cselect_b32 s36,s36,2147483648
v_mov_b32 v23,s36
ds_write_b32 v22,v23
w0_251:
s_waitcnt lgkmcnt(0)
s_barrier
ds_read_b32 v23,v22
ds_read_b128 v[24:27],v18 offset:0
ds_read_b128 v[28:31],v19 offset:0
ds_read_b128 v[32:35],v18 offset:2048
ds_read_b128 v[36:39],v19 offset:2048
ds_read_b128 v[40:43],v18 offset:4096
s_waitcnt lgkmcnt(5)
v_readfirstlane_b32 s37,v23
s_nop 4
QKVV_B1:
s_waitcnt lgkmcnt(3)
v_mfma_f32_32x32x16_bf16 v[88:103],v[24:27],a[0:3],0
ds_read_b128 v[44:47],v19 offset:4096
v_add_u32 v189,s57,v188
v_mfma_f32_32x32x16_bf16 v[104:119],v[24:27],a[160:163],0
v_add_u32 v8,0x800,v189
s_sub_u32 s66,46080,s57
s_lshl_b32 s60,s33,6
s_add_u32 s60,s60,s34
s_mul_i32 s60,s60,46080
s_add_u32 s60,s60,s37
v_mfma_f32_32x32x16_bf16 v[88:103],v[28:31],a[4:7],v[88:103]
ds_read_b128 v[48:51],v18 offset:6144
ds_read2_b64 v[156:159],v189 offset0:0 offset1:32
s_add_u32 s60,s60,206569472
s_lshl_b32 s62,s46,10
v_mfma_f32_32x32x16_bf16 v[104:119],v[28:31],a[164:167],v[104:119]
ds_read2_b64 v[160:163],v189 offset0:64 offset1:96
s_add_u32 s62,s62,40960
s_add_u32 m0,s66,s62
s_add_u32 s63,s60,s62
s_waitcnt lgkmcnt(5)
v_mfma_f32_32x32x16_bf16 v[88:103],v[32:35],a[8:11],v[88:103]
ds_read_b128 v[52:55],v19 offset:6144
ds_read2_b64 v[164:167],v189 offset0:128 offset1:160
buffer_load_dwordx4 v1,s[8:11],s63 offen sc1 lds
v_mfma_f32_32x32x16_bf16 v[104:119],v[32:35],a[168:171],v[104:119]
ds_read2_b64 v[168:171],v189 offset0:192 offset1:224
s_add_u32 m0,s66,45056
s_add_u32 s63,s60,45056
s_mul_i32 s74,s73,393216
s_add_u32 s74,s74,s39
v_mfma_f32_32x32x16_bf16 v[88:103],v[36:39],a[12:15],v[88:103]
ds_read_b128 v[24:27],v18 offset:8192
ds_read2_b64 v[172:175],v8 offset0:0 offset1:32
s_add_u32 s74,s74,s70
v_fma_f32 v56,-v124,v120,v56
v_mfma_f32_32x32x16_bf16 v[104:119],v[36:39],a[172:175],v[104:119]
buffer_load_dwordx4 v1,s[8:11],s63 offen sc1 lds
s_mul_i32 s61,s46,10240
s_add_u32 s60,s60,s61
s_add_u32 s61,s61,s66
s_waitcnt lgkmcnt(8)
v_mfma_f32_32x32x16_bf16 v[88:103],v[40:43],a[16:19],v[88:103]
ds_read_b128 v[28:31],v19 offset:8192
s_add_u32 m0,s61,0
s_add_u32 s63,s60,0
v_fma_f32 v57,-v126,v120,v57
v_fma_f32 v58,-v128,v120,v58
v_mfma_f32_32x32x16_bf16 v[104:119],v[40:43],a[176:179],v[104:119]
v_fma_f32 v59,-v130,v120,v59
v_fma_f32 v64,-v140,v120,v64
v_fma_f32 v65,-v142,v120,v65
v_fma_f32 v66,-v144,v120,v66
v_fma_f32 v67,-v146,v120,v67
v_mfma_f32_32x32x16_bf16 v[88:103],v[44:47],a[20:23],v[88:103]
ds_read_b128 v[32:35],v18 offset:10240
buffer_load_dwordx4 v1,s[8:11],s63 offen sc1 lds
v_mul_f32 v56,v56,v125
v_mul_f32 v57,v57,v127
v_mfma_f32_32x32x16_bf16 v[104:119],v[44:47],a[180:183],v[104:119]
v_mul_f32 v58,v58,v129
v_mul_f32 v59,v59,v131
v_mul_f32 v64,v64,v141
v_mul_f32 v65,v65,v143
v_mul_f32 v66,v66,v145
s_waitcnt lgkmcnt(6)
v_mfma_f32_32x32x16_bf16 v[88:103],v[48:51],a[24:27],v[88:103]
ds_read_b128 v[36:39],v19 offset:10240
v_mul_f32 v67,v67,v147
v_cvt_pk_bf16_f32 v180,v56,v57
v_cvt_pk_bf16_f32 v181,v58,v59
v_cvt_pk_bf16_f32 v182,v64,v65
v_mfma_f32_32x32x16_bf16 v[104:119],v[48:51],a[184:187],v[104:119]
buffer_load_dwordx4 v1,s[8:11],s63 offen offset:1024 sc1 lds
v_cvt_pk_bf16_f32 v183,v66,v67
buffer_store_dwordx4 v[180:183],v20,s[8:11],s74 offen sc1
v_fma_f32 v60,-v132,v120,v60
v_mfma_f32_32x32x16_bf16 v[88:103],v[52:55],a[28:31],v[88:103]
ds_read_b128 v[40:43],v18 offset:12288
v_fma_f32 v61,-v134,v120,v61
v_fma_f32 v62,-v136,v120,v62
v_fma_f32 v63,-v138,v120,v63
v_fma_f32 v68,-v148,v120,v68
v_mfma_f32_32x32x16_bf16 v[104:119],v[52:55],a[188:191],v[104:119]
v_fma_f32 v69,-v150,v120,v69
v_fma_f32 v70,-v152,v120,v70
v_fma_f32 v71,-v154,v120,v71
v_mul_f32 v60,v60,v133
v_mul_f32 v61,v61,v135
s_waitcnt lgkmcnt(3)
v_mfma_f32_32x32x16_bf16 v[88:103],v[24:27],a[32:35],v[88:103]
ds_read_b128 v[44:47],v19 offset:12288
buffer_load_dwordx4 v1,s[8:11],s63 offen offset:2048 sc1 lds
v_mul_f32 v62,v62,v137
v_mul_f32 v63,v63,v139
v_mfma_f32_32x32x16_bf16 v[104:119],v[24:27],a[192:195],v[104:119]
v_mul_f32 v68,v68,v149
v_mul_f32 v69,v69,v151
v_mul_f32 v70,v70,v153
v_mul_f32 v71,v71,v155
v_cvt_pk_bf16_f32 v184,v60,v61
v_mfma_f32_32x32x16_bf16 v[88:103],v[28:31],a[36:39],v[88:103]
ds_read_b128 v[48:51],v18 offset:14336
v_cvt_pk_bf16_f32 v185,v62,v63
v_cvt_pk_bf16_f32 v186,v68,v69
v_cvt_pk_bf16_f32 v187,v70,v71
v_mfma_f32_32x32x16_bf16 v[104:119],v[28:31],a[196:199],v[104:119]
buffer_load_dwordx4 v1,s[8:11],s63 offen offset:3072 sc1 lds
s_add_u32 m0,s61,4096
s_add_u32 s63,s60,4096
s_waitcnt lgkmcnt(3)
v_mfma_f32_32x32x16_bf16 v[88:103],v[32:35],a[40:43],v[88:103]
ds_read_b128 v[52:55],v19 offset:14336
buffer_store_dwordx4 v[184:187],v21,s[8:11],s74 offen sc1
v_fma_f32 v72,-v124,v121,v72
v_fma_f32 v73,-v126,v121,v73
v_mfma_f32_32x32x16_bf16 v[104:119],v[32:35],a[200:203],v[104:119]
v_fma_f32 v74,-v128,v121,v74
v_fma_f32 v75,-v130,v121,v75
v_fma_f32 v80,-v140,v121,v80
v_fma_f32 v81,-v142,v121,v81
v_fma_f32 v82,-v144,v121,v82
v_mfma_f32_32x32x16_bf16 v[88:103],v[36:39],a[44:47],v[88:103]
ds_read_b128 v[24:27],v18 offset:16384
buffer_load_dwordx4 v1,s[8:11],s63 offen sc1 lds
v_fma_f32 v83,-v146,v121,v83
v_mul_f32 v72,v72,v125
v_mfma_f32_32x32x16_bf16 v[104:119],v[36:39],a[204:207],v[104:119]
v_mul_f32 v73,v73,v127
v_mul_f32 v74,v74,v129
v_mul_f32 v75,v75,v131
v_mul_f32 v80,v80,v141
v_mul_f32 v81,v81,v143
s_waitcnt lgkmcnt(3)
v_mfma_f32_32x32x16_bf16 v[88:103],v[40:43],a[48:51],v[88:103]
ds_read_b128 v[28:31],v19 offset:16384
v_mul_f32 v82,v82,v145
v_mul_f32 v83,v83,v147
v_cvt_pk_bf16_f32 v180,v72,v73
v_cvt_pk_bf16_f32 v181,v74,v75
v_mfma_f32_32x32x16_bf16 v[104:119],v[40:43],a[208:211],v[104:119]
buffer_load_dwordx4 v1,s[8:11],s63 offen offset:1024 sc1 lds
v_cvt_pk_bf16_f32 v182,v80,v81
v_cvt_pk_bf16_f32 v183,v82,v83
buffer_store_dwordx4 v[180:183],v20,s[8:11],s74 offen offset:2048 sc1
v_mfma_f32_32x32x16_bf16 v[88:103],v[44:47],a[52:55],v[88:103]
ds_read_b128 v[32:35],v18 offset:18432
v_fma_f32 v76,-v132,v121,v76
v_fma_f32 v77,-v134,v121,v77
v_fma_f32 v78,-v136,v121,v78
v_fma_f32 v79,-v138,v121,v79
v_mfma_f32_32x32x16_bf16 v[104:119],v[44:47],a[212:215],v[104:119]
v_fma_f32 v84,-v148,v121,v84
v_fma_f32 v85,-v150,v121,v85
v_fma_f32 v86,-v152,v121,v86
v_fma_f32 v87,-v154,v121,v87
v_mul_f32 v76,v76,v133
s_waitcnt lgkmcnt(3)
v_mfma_f32_32x32x16_bf16 v[88:103],v[48:51],a[56:59],v[88:103]
ds_read_b128 v[36:39],v19 offset:18432
buffer_load_dwordx4 v1,s[8:11],s63 offen offset:2048 sc1 lds
v_mul_f32 v77,v77,v135
v_mul_f32 v78,v78,v137
v_mfma_f32_32x32x16_bf16 v[104:119],v[48:51],a[216:219],v[104:119]
v_mul_f32 v79,v79,v139
v_mul_f32 v84,v84,v149
v_mul_f32 v85,v85,v151
v_mul_f32 v86,v86,v153
v_mul_f32 v87,v87,v155
v_mfma_f32_32x32x16_bf16 v[88:103],v[52:55],a[60:63],v[88:103]
ds_read_b128 v[40:43],v18 offset:20480
s_waitcnt vmcnt(12)
s_mov_b64 exec,1
buffer_store_dword v5,v1,s[8:11],s59 offen sc1
s_mov_b64 exec,-1
s_mov_b32 s59,2147483648
v_mfma_f32_32x32x16_bf16 v[104:119],v[52:55],a[220:223],v[104:119]
buffer_load_dwordx4 v1,s[8:11],s63 offen offset:3072 sc1 lds
s_add_u32 m0,s61,8192
s_add_u32 s63,s60,8192
v_cvt_pk_bf16_f32 v184,v76,v77
s_waitcnt lgkmcnt(3)
v_mfma_f32_32x32x16_bf16 v[88:103],v[24:27],a[64:67],v[88:103]
ds_read_b128 v[44:47],v19 offset:20480
v_cvt_pk_bf16_f32 v185,v78,v79
v_cvt_pk_bf16_f32 v186,v84,v85
v_cvt_pk_bf16_f32 v187,v86,v87
v_mfma_f32_32x32x16_bf16 v[104:119],v[24:27],a[224:227],v[104:119]
buffer_store_dwordx4 v[184:187],v21,s[8:11],s74 offen offset:2048 sc1
s_lshl_b32 s82,s72,6
s_add_u32 s82,s82,s73
s_lshl_b32 s82,s82,9
s_add_u32 s82,s82,s71
v_mfma_f32_32x32x16_bf16 v[88:103],v[28:31],a[68:71],v[88:103]
ds_read_b128 v[48:51],v18 offset:22528
buffer_load_dwordx4 v1,s[8:11],s63 offen sc1 lds
s_lshl_b32 s75,s69,2
s_add_u32 s82,s82,s75
v_mfma_f32_32x32x16_bf16 v[104:119],v[28:31],a[228:231],v[104:119]
s_add_u32 s82,s82,s39
v_add_f32 v156,v156,v166
v_add_f32 v157,v157,v167
v_add_f32 v158,v158,v168
s_waitcnt lgkmcnt(3)
v_mfma_f32_32x32x16_bf16 v[88:103],v[32:35],a[72:75],v[88:103]
ds_read_b128 v[52:55],v19 offset:22528
v_add_f32 v159,v159,v169
v_add_f32 v160,v160,v170
v_add_f32 v161,v161,v171
v_add_f32 v162,v162,v172
v_mfma_f32_32x32x16_bf16 v[104:119],v[32:35],a[232:235],v[104:119]
buffer_load_dwordx4 v1,s[8:11],s63 offen offset:1024 sc1 lds
s_mov_b32 s53,s33
s_mov_b32 s54,s34
s_cmp_eq_u32 s37,0
s_addc_u32 s32,s32,0
v_mfma_f32_32x32x16_bf16 v[88:103],v[36:39],a[76:79],v[88:103]
ds_read_b128 v[24:27],v18 offset:24576
s_min_u32 s62,s32,127
s_sub_u32 s60,s62,20
s_lshr_b32 s34,s60,1
s_and_b32 s33,s60,1
v_mfma_f32_32x32x16_bf16 v[104:119],v[36:39],a[236:239],v[104:119]
s_xor_b32 s33,s33,1
s_cmp_eq_u32 s33,0
s_cselect_b32 s61,20,0
s_add_u32 s34,s34,s61
s_sub_u32 s61,s60,44
s_waitcnt lgkmcnt(3)
v_mfma_f32_32x32x16_bf16 v[88:103],v[40:43],a[80:83],v[88:103]
ds_read_b128 v[28:31],v19 offset:24576
s_cmp_ge_u32 s60,88
s_cselect_b32 s34,s61,s34
s_cselect_b32 s33,1,s33
v_add_f32 v163,v163,v173
v_mfma_f32_32x32x16_bf16 v[104:119],v[40:43],a[240:243],v[104:119]
s_cmp_lt_u32 s62,20
s_cselect_b32 s34,s62,s34
s_cselect_b32 s33,0,s33
s_lshl_b32 s35,s33,6
s_add_u32 s35,s35,s34
s_lshl_b32 s35,s35,9
v_mfma_f32_32x32x16_bf16 v[88:103],v[44:47],a[84:87],v[88:103]
ds_read_b128 v[32:35],v18 offset:26624
s_add_u32 s35,s35,0
s_lshl_b32 s60,s33,5
s_add_u32 s60,s60,7
v_min_u32 v2,s60,v0
v_mfma_f32_32x32x16_bf16 v[104:119],v[44:47],a[244:247],v[104:119]
v_lshlrev_b32 v2,2,v2
v_add_f32 v164,v164,v174
v_add_f32 v165,v165,v175
v_add_f32 v156,v156,v158
v_add_f32 v157,v157,v159
s_waitcnt lgkmcnt(3)
v_mfma_f32_32x32x16_bf16 v[88:103],v[48:51],a[88:91],v[88:103]
ds_read_b128 v[36:39],v19 offset:26624
s_cmp_lg_u32 s46,0
s_cbranch_scc1 w0_252
buffer_load_dword v3,v2,s[8:11],s35 offen sc1
w0_252:
v_mfma_f32_32x32x16_bf16 v[104:119],v[48:51],a[248:251],v[104:119]
v_add_f32 v160,v160,v162
v_add_f32 v161,v161,v163
v_add_f32 v156,v156,v160
v_add_f32 v157,v157,v161
v_add_f32 v156,v156,v164
v_mfma_f32_32x32x16_bf16 v[88:103],v[52:55],a[92:95],v[88:103]
ds_read_b128 v[40:43],v18 offset:28672
v_add_f32 v157,v157,v165
v_mov_b32 v158,v156
v_mov_b32 v159,v157
s_nop 0
v_permlane32_swap_b32 v156,v158
v_mfma_f32_32x32x16_bf16 v[104:119],v[52:55],a[252:255],v[104:119]
v_permlane32_swap_b32 v157,v159
v_add_f32 v176,v156,v158
v_add_f32 v177,v157,v159
v_mul_f32 v176,0x3acccccd,v176
v_mul_f32 v177,0x3acccccd,v177
s_waitcnt lgkmcnt(3)
v_mfma_f32_32x32x16_bf16 v[88:103],v[24:27],a[96:99],v[88:103]
ds_read_b128 v[44:47],v19 offset:28672
v_fma_f32 v177,-v176,v176,v177
v_max_f32 v177,0,v177
v_cvt_pk_bf16_f32 v8,v176,v177
v_lshlrev_b32 v176,16,v8
v_mfma_f32_32x32x16_bf16 v[104:119],v[24:27],v[192:195],v[104:119]
v_and_b32 v177,0xffff0000,v8
v_add_f32 v177,0x3727c5ac,v177
v_cvt_pk_bf16_f32 v8,v177,v177
v_lshlrev_b32 v177,16,v8
v_sqrt_f32 v177,v177
v_mfma_f32_32x32x16_bf16 v[88:103],v[28:31],a[100:103],v[88:103]
ds_read_b128 v[48:51],v18 offset:30720
v_cvt_pk_bf16_f32 v8,v177,v177
v_lshlrev_b32 v177,16,v8
v_rcp_f32 v177,v177
v_mfma_f32_32x32x16_bf16 v[104:119],v[28:31],v[196:199],v[104:119]
s_cmp_eq_u32 s51,0
s_cselect_b64 s[76:77],-1,0
v_cndmask_b32 v176,v176,0,s[76:77]
v_cndmask_b32 v177,v177,1.0,s[76:77]
s_mov_b32 s72,s51
s_waitcnt lgkmcnt(3)
v_mfma_f32_32x32x16_bf16 v[88:103],v[32:35],a[104:107],v[88:103]
ds_read_b128 v[52:55],v19 offset:30720
s_mov_b32 s73,s52
ds_write_b64 v190,v[176:177]
v_mfma_f32_32x32x16_bf16 v[104:119],v[32:35],v[200:203],v[104:119]
ds_read_b128 v[124:127],v191 offset:0
ds_read_b128 v[128:131],v191 offset:16
ds_read_b128 v[132:135],v191 offset:64
v_mfma_f32_32x32x16_bf16 v[88:103],v[36:39],a[108:111],v[88:103]
ds_read_b128 v[24:27],v18 offset:32768
ds_read_b128 v[136:139],v191 offset:80
ds_read_b128 v[140:143],v191 offset:128
v_mfma_f32_32x32x16_bf16 v[104:119],v[36:39],v[204:207],v[104:119]
ds_read_b128 v[144:147],v191 offset:144
ds_read_b128 v[148:151],v191 offset:192
s_waitcnt lgkmcnt(11)
v_mfma_f32_32x32x16_bf16 v[88:103],v[40:43],a[112:115],v[88:103]
ds_read_b128 v[28:31],v19 offset:32768
ds_read_b128 v[152:155],v191 offset:208
v_mfma_f32_32x32x16_bf16 v[104:119],v[40:43],v[208:211],v[104:119]
v_mfma_f32_32x32x16_bf16 v[88:103],v[44:47],a[116:119],v[88:103]
ds_read_b128 v[32:35],v18 offset:34816
v_mfma_f32_32x32x16_bf16 v[104:119],v[44:47],v[212:215],v[104:119]
s_waitcnt lgkmcnt(12)
v_mfma_f32_32x32x16_bf16 v[88:103],v[48:51],a[120:123],v[88:103]
ds_read_b128 v[36:39],v19 offset:34816
v_mfma_f32_32x32x16_bf16 v[104:119],v[48:51],v[216:219],v[104:119]
v_mfma_f32_32x32x16_bf16 v[88:103],v[52:55],a[124:127],v[88:103]
ds_read_b128 v[40:43],v18 offset:36864
v_mfma_f32_32x32x16_bf16 v[104:119],v[52:55],v[220:223],v[104:119]
s_waitcnt vmcnt(0)
s_cmp_lg_u32 s46,0
s_cbranch_scc1 w0_253
v_cmp_eq_u32 vcc,0,v3
s_cmp_eq_u64 vcc,0
s_cselect_b32 s36,0,2147483648
s_cmp_lt_u32 s32,128
s_cselect_b32 s36,s36,2147483648
v_mov_b32 v23,s36
ds_write_b32 v22,v23
w0_253:
s_waitcnt lgkmcnt(4)
v_mfma_f32_32x32x16_bf16 v[88:103],v[24:27],a[128:131],v[88:103]
ds_read_b128 v[44:47],v19 offset:36864
s_mov_b64 exec,1
buffer_store_dword v5,v1,s[8:11],s82 offen sc1
s_mov_b64 exec,-1
s_mov_b32 s82,2147483648
v_mfma_f32_32x32x16_bf16 v[104:119],v[24:27],v[224:227],v[104:119]
v_mfma_f32_32x32x16_bf16 v[88:103],v[28:31],a[132:135],v[88:103]
ds_read_b128 v[48:51],v18 offset:38912
v_mfma_f32_32x32x16_bf16 v[104:119],v[28:31],v[228:231],v[104:119]
s_waitcnt lgkmcnt(3)
v_mfma_f32_32x32x16_bf16 v[88:103],v[32:35],a[136:139],v[88:103]
ds_read_b128 v[52:55],v19 offset:38912
v_mfma_f32_32x32x16_bf16 v[104:119],v[32:35],v[232:235],v[104:119]
s_waitcnt lgkmcnt(2)
s_barrier
ds_read_b32 v23,v22
v_mfma_f32_32x32x16_bf16 v[88:103],v[36:39],a[140:143],v[88:103]
ds_read_b128 v[24:27],v16 offset:0
v_mfma_f32_32x32x16_bf16 v[104:119],v[36:39],v[236:239],v[104:119]
v_mfma_f32_32x32x16_bf16 v[88:103],v[40:43],a[144:147],v[88:103]
ds_read_b128 v[28:31],v17 offset:0
v_mfma_f32_32x32x16_bf16 v[104:119],v[40:43],v[240:243],v[104:119]
v_mfma_f32_32x32x16_bf16 v[88:103],v[44:47],a[148:151],v[88:103]
ds_read_b128 v[32:35],v16 offset:2048
v_mfma_f32_32x32x16_bf16 v[104:119],v[44:47],v[244:247],v[104:119]
s_waitcnt lgkmcnt(4)
v_mfma_f32_32x32x16_bf16 v[88:103],v[48:51],a[152:155],v[88:103]
ds_read_b128 v[36:39],v17 offset:2048
s_waitcnt lgkmcnt(4)
v_readfirstlane_b32 s38,v23
v_mfma_f32_32x32x16_bf16 v[104:119],v[48:51],v[248:251],v[104:119]
v_mfma_f32_32x32x16_bf16 v[88:103],v[52:55],a[156:159],v[88:103]
ds_read_b128 v[40:43],v16 offset:4096
v_mfma_f32_32x32x16_bf16 v[104:119],v[52:55],v[252:255],v[104:119]
s_cmp_lg_u32 s37,0
s_cbranch_scc1 nf_254
s_cmp_lt_u32 s50,2
s_cbranch_scc1 now_255
s_mov_b32 s39,0
s_add_u32 s50,s50,1
s_sub_u32 s57,46080,s57
s_mov_b32 s51,s53
s_mov_b32 s52,s54
s_mov_b32 s37,s38
s_branch QKVV_B0
s_nop 0
now_255:
s_mov_b32 s55,0
s_branch nt_256
nf_254:
s_mov_b32 s55,2
s_cmp_lg_u32 s38,0
s_cbranch_scc1 nt_256
s_mov_b32 s55,1
s_mov_b32 s37,0
s_sub_u32 s66,46080,s57
s_lshl_b32 s60,s33,6
s_add_u32 s60,s60,s34
s_mul_i32 s60,s60,46080
s_add_u32 s60,s60,s37
s_add_u32 s60,s60,206569472
s_lshl_b32 s62,s46,10
s_add_u32 s62,s62,40960
s_add_u32 m0,s66,s62
s_add_u32 s63,s60,s62
buffer_load_dwordx4 v1,s[8:11],s63 offen sc1 lds
s_add_u32 m0,s66,45056
s_add_u32 s63,s60,45056
buffer_load_dwordx4 v1,s[8:11],s63 offen sc1 lds
s_mul_i32 s61,s46,10240
s_add_u32 s60,s60,s61
s_add_u32 s61,s61,s66
s_add_u32 m0,s61,0
s_add_u32 s63,s60,0
buffer_load_dwordx4 v1,s[8:11],s63 offen sc1 lds
buffer_load_dwordx4 v1,s[8:11],s63 offen offset:1024 sc1 lds
buffer_load_dwordx4 v1,s[8:11],s63 offen offset:2048 sc1 lds
buffer_load_dwordx4 v1,s[8:11],s63 offen offset:3072 sc1 lds
s_add_u32 m0,s61,4096
s_add_u32 s63,s60,4096
buffer_load_dwordx4 v1,s[8:11],s63 offen sc1 lds
buffer_load_dwordx4 v1,s[8:11],s63 offen offset:1024 sc1 lds
buffer_load_dwordx4 v1,s[8:11],s63 offen offset:2048 sc1 lds
buffer_load_dwordx4 v1,s[8:11],s63 offen offset:3072 sc1 lds
s_add_u32 m0,s61,8192
s_add_u32 s63,s60,8192
buffer_load_dwordx4 v1,s[8:11],s63 offen sc1 lds
buffer_load_dwordx4 v1,s[8:11],s63 offen offset:1024 sc1 lds
nt_256:
s_mov_b32 s39,0
s_mul_i32 s74,s73,393216
s_add_u32 s74,s74,s39
s_add_u32 s74,s74,s70
v_fma_f32 v88,-v124,v120,v88
v_fma_f32 v89,-v126,v120,v89
v_fma_f32 v90,-v128,v120,v90
v_fma_f32 v91,-v130,v120,v91
v_fma_f32 v96,-v140,v120,v96
v_fma_f32 v97,-v142,v120,v97
v_fma_f32 v98,-v144,v120,v98
v_fma_f32 v99,-v146,v120,v99
v_mul_f32 v88,v88,v125
v_mul_f32 v89,v89,v127
v_mul_f32 v90,v90,v129
v_mul_f32 v91,v91,v131
v_mul_f32 v96,v96,v141
v_mul_f32 v97,v97,v143
v_mul_f32 v98,v98,v145
v_mul_f32 v99,v99,v147
v_cvt_pk_bf16_f32 v180,v88,v89
v_cvt_pk_bf16_f32 v181,v90,v91
v_cvt_pk_bf16_f32 v182,v96,v97
v_cvt_pk_bf16_f32 v183,v98,v99
buffer_store_dwordx4 v[180:183],v20,s[8:11],s74 offen sc1
v_fma_f32 v92,-v132,v120,v92
v_fma_f32 v93,-v134,v120,v93
v_fma_f32 v94,-v136,v120,v94
v_fma_f32 v95,-v138,v120,v95
v_fma_f32 v100,-v148,v120,v100
v_fma_f32 v101,-v150,v120,v101
v_fma_f32 v102,-v152,v120,v102
v_fma_f32 v103,-v154,v120,v103
v_mul_f32 v92,v92,v133
v_mul_f32 v93,v93,v135
v_mul_f32 v94,v94,v137
v_mul_f32 v95,v95,v139
v_mul_f32 v100,v100,v149
v_mul_f32 v101,v101,v151
v_mul_f32 v102,v102,v153
v_mul_f32 v103,v103,v155
v_cvt_pk_bf16_f32 v184,v92,v93
v_cvt_pk_bf16_f32 v185,v94,v95
v_cvt_pk_bf16_f32 v186,v100,v101
v_cvt_pk_bf16_f32 v187,v102,v103
buffer_store_dwordx4 v[184:187],v21,s[8:11],s74 offen sc1
v_fma_f32 v104,-v124,v121,v104
v_fma_f32 v105,-v126,v121,v105
v_fma_f32 v106,-v128,v121,v106
v_fma_f32 v107,-v130,v121,v107
v_fma_f32 v112,-v140,v121,v112
v_fma_f32 v113,-v142,v121,v113
v_fma_f32 v114,-v144,v121,v114
v_fma_f32 v115,-v146,v121,v115
v_mul_f32 v104,v104,v125
v_mul_f32 v105,v105,v127
v_mul_f32 v106,v106,v129
v_mul_f32 v107,v107,v131
v_mul_f32 v112,v112,v141
v_mul_f32 v113,v113,v143
v_mul_f32 v114,v114,v145
v_mul_f32 v115,v115,v147
v_cvt_pk_bf16_f32 v180,v104,v105
v_cvt_pk_bf16_f32 v181,v106,v107
v_cvt_pk_bf16_f32 v182,v112,v113
v_cvt_pk_bf16_f32 v183,v114,v115
buffer_store_dwordx4 v[180:183],v20,s[8:11],s74 offen offset:2048 sc1
v_fma_f32 v108,-v132,v121,v108
v_fma_f32 v109,-v134,v121,v109
v_fma_f32 v110,-v136,v121,v110
v_fma_f32 v111,-v138,v121,v111
v_fma_f32 v116,-v148,v121,v116
v_fma_f32 v117,-v150,v121,v117
v_fma_f32 v118,-v152,v121,v118
v_fma_f32 v119,-v154,v121,v119
v_mul_f32 v108,v108,v133
v_mul_f32 v109,v109,v135
v_mul_f32 v110,v110,v137
v_mul_f32 v111,v111,v139
v_mul_f32 v116,v116,v149
v_mul_f32 v117,v117,v151
v_mul_f32 v118,v118,v153
v_mul_f32 v119,v119,v155
v_cvt_pk_bf16_f32 v184,v108,v109
v_cvt_pk_bf16_f32 v185,v110,v111
v_cvt_pk_bf16_f32 v186,v116,v117
v_cvt_pk_bf16_f32 v187,v118,v119
buffer_store_dwordx4 v[184:187],v21,s[8:11],s74 offen offset:2048 sc1
s_lshl_b32 s82,s72,6
s_add_u32 s82,s82,s73
s_lshl_b32 s82,s82,9
s_add_u32 s82,s82,s71
s_lshl_b32 s75,s69,2
s_add_u32 s82,s82,s75
s_add_u32 s82,s82,s39
s_mov_b32 s59,s82
s_mov_b32 s82,2147483648
s_mov_b32 s39,2147483648
s_add_u32 s50,s50,1
s_sub_u32 s57,46080,s57
s_mov_b32 s51,s53
s_mov_b32 s52,s54
s_mov_b32 s37,s38
s_cmp_eq_u32 s55,0
s_cbranch_scc1 QKVV_B0
s_cmp_eq_u32 s55,1
s_cbranch_scc1 QKVV_CD0
s_waitcnt vmcnt(0)
s_mov_b64 exec,1
buffer_store_dword v5,v1,s[8:11],s59 offen sc1
s_mov_b64 exec,-1
s_mov_b32 s59,2147483648
s_cmp_eq_u32 s50,128
s_cbranch_scc1 QKVV_END
s_branch QKVV_COLD0
QKVV_END:
s_endpgm
ROLE_ATT:
v_lshlrev_b32 v1,4,v0
v_mov_b32 v5,1
s_lshl_b32 s56,s48,2
s_add_u32 s56,s56,s46
v_bfe_u32 v6,v0,2,2
v_lshrrev_b32 v7,4,v0
v_add_u32 v7,v6,v7
v_and_b32 v7,3,v7
v_and_b32 v15,3,v0
v_lshlrev_b32 v15,4,v15
v_lshl_add_u32 v15,v7,6,v15
v_lshl_add_u32 v15,v6,8,v15
s_mov_b32 s68,s48
s_and_b32 s51,s46,1
s_lshr_b32 s86,s46,1
s_lshr_b32 s87,s68,3
s_lshl_b32 s87,s87,5
s_and_b32 s60,s68,7
s_add_u32 s87,s87,s60
v_lshlrev_b32 v229,3,v0
v_mov_b32 v230,0xff800000
s_mov_b32 s80,-1
s_mov_b32 s81,0
s_mov_b32 s84,0x3d93cd3a
s_mov_b32 s85,0x3fb8aa3b
v_min_u32 v6,8,v0
v_mul_u32_u24 v7,86,v6
v_lshrrev_b32 v7,8,v7
v_mul_u32_u24 v8,3,v7
v_sub_u32 v6,v6,v8
s_mul_i32 s60,s68,3
v_add_u32 v6,s60,v6
v_lshlrev_b32 v2,2,v6
v_lshl_add_u32 v2,v7,16,v2
v_min_u32 v228,2,v0
v_lshlrev_b32 v228,2,v228
v_lshrrev_b32 v6,4,v0
v_lshlrev_b32 v6,2,v6
v_and_b32 v7,15,v0
v_add_u32 v8,0,v6
v_cmp_le_u32 s[72:73],v8,v7
v_add_u32 v8,1,v6
v_cmp_le_u32 s[74:75],v8,v7
v_add_u32 v8,2,v6
v_cmp_le_u32 s[76:77],v8,v7
v_add_u32 v8,3,v6
v_cmp_le_u32 s[78:79],v8,v7
s_mul_i32 s71,s68,12288
s_mul_i32 s60,s51,14
s_mul_i32 s69,s60,589824
s_mul_i32 s61,s68,18432
s_add_u32 s69,s69,s61
s_mul_i32 s61,s51,9216
s_add_u32 s69,s69,s61
s_add_u32 s69,s69,24120320
s_mul_i32 s70,s60,2048
s_lshl_b32 s61,s68,6
s_add_u32 s70,s70,s61
s_add_u32 s70,s70,688128
s_mul_i32 s69,s51,12582912
s_mul_i32 s61,s68,6144
s_add_u32 s69,s69,s61
s_add_u32 s69,s69,24117248
s_mul_i32 s70,s51,65536
s_lshl_b32 s61,s68,5
s_add_u32 s70,s70,s61
s_add_u32 s70,s70,688128
s_waitcnt vmcnt(0)
s_barrier
s_cmp_lg_u32 s46,0
s_cbranch_scc1 arr_257
v_mov_b32 v6,1
s_lshl_b32 s3,s49,2
v_mov_b32 v7,s3
s_mov_b64 exec,1
buffer_atomic_add v6,v7,s[12:15],0 offen sc1
s_mov_b64 exec,-1
arr_257:
s_mov_b32 s66,s56
s_and_b32 s53,s66,7
s_lshr_b32 s54,s66,3
v_lshrrev_b32 v6,4,v0
v_bfe_u32 v7,v0,2,2
v_and_b32 v8,3,v0
s_and_b32 s61,s53,3
s_lshl_b32 s60,s53,8
v_lshlrev_b32 v132,11,v6
v_lshrrev_b32 v9,1,v6
v_lshlrev_b32 v132,11,v9
v_and_b32 v9,1,v6
v_lshl_add_u32 v132,v9,12,v132
v_add_u32 v9,s61,v7
v_and_b32 v9,3,v9
v_lshl_add_u32 v132,v9,6,v132
v_lshl_add_u32 v132,v8,4,v132
v_add_u32 v132,s60,v132
s_lshl_b32 s60,s53,2
v_add_u32 v9,s60,v8
v_mul_u32_u24 v133,1280,v9
v_lshl_add_u32 v133,v6,5,v133
v_lshl_add_u32 v133,v7,3,v133
s_mov_b32 s4,s16
s_mov_b32 s5,s17
s_mov_b32 s6,2621440
s_mov_b32 s7,0x20000
s_mov_b32 s55,0
s_mul_i32 s62,s54,40960
buffer_load_dwordx2 v[32:33],v133,s[4:7],s62 offen offset:0
buffer_load_dwordx2 v[34:35],v133,s[4:7],s62 offen offset:128
buffer_load_dwordx2 v[36:37],v133,s[4:7],s62 offen offset:256
buffer_load_dwordx2 v[38:39],v133,s[4:7],s62 offen offset:384
buffer_load_dwordx2 v[40:41],v133,s[4:7],s62 offen offset:512
buffer_load_dwordx2 v[42:43],v133,s[4:7],s62 offen offset:640
buffer_load_dwordx2 v[44:45],v133,s[4:7],s62 offen offset:768
buffer_load_dwordx2 v[46:47],v133,s[4:7],s62 offen offset:896
buffer_load_dwordx2 v[48:49],v133,s[4:7],s62 offen offset:1024
buffer_load_dwordx2 v[50:51],v133,s[4:7],s62 offen offset:1152
s_add_u32 s66,s54,16
s_min_u32 s66,s66,63
s_mul_i32 s62,s66,40960
buffer_load_dwordx2 v[52:53],v133,s[4:7],s62 offen offset:0
buffer_load_dwordx2 v[54:55],v133,s[4:7],s62 offen offset:128
buffer_load_dwordx2 v[56:57],v133,s[4:7],s62 offen offset:256
buffer_load_dwordx2 v[58:59],v133,s[4:7],s62 offen offset:384
buffer_load_dwordx2 v[60:61],v133,s[4:7],s62 offen offset:512
buffer_load_dwordx2 v[62:63],v133,s[4:7],s62 offen offset:640
buffer_load_dwordx2 v[64:65],v133,s[4:7],s62 offen offset:768
buffer_load_dwordx2 v[66:67],v133,s[4:7],s62 offen offset:896
buffer_load_dwordx2 v[68:69],v133,s[4:7],s62 offen offset:1024
buffer_load_dwordx2 v[70:71],v133,s[4:7],s62 offen offset:1152
s_mul_i32 s64,s54,40960
s_add_u32 s64,s64,234749952
s_mul_i32 s65,s54,46080
s_add_u32 s65,s65,206569472
s_waitcnt vmcnt(10)
v_lshlrev_b32 v72,16,v32
v_and_b32 v73,0xffff0000,v32
v_lshlrev_b32 v74,16,v33
v_and_b32 v75,0xffff0000,v33
v_lshlrev_b32 v76,16,v34
v_and_b32 v77,0xffff0000,v34
v_lshlrev_b32 v78,16,v35
v_and_b32 v79,0xffff0000,v35
v_lshlrev_b32 v80,16,v36
v_and_b32 v81,0xffff0000,v36
v_lshlrev_b32 v82,16,v37
v_and_b32 v83,0xffff0000,v37
v_lshlrev_b32 v84,16,v38
v_and_b32 v85,0xffff0000,v38
v_lshlrev_b32 v86,16,v39
v_and_b32 v87,0xffff0000,v39
v_lshlrev_b32 v88,16,v40
v_and_b32 v89,0xffff0000,v40
v_lshlrev_b32 v90,16,v41
v_and_b32 v91,0xffff0000,v41
v_lshlrev_b32 v92,16,v42
v_and_b32 v93,0xffff0000,v42
v_lshlrev_b32 v94,16,v43
v_and_b32 v95,0xffff0000,v43
v_lshlrev_b32 v96,16,v44
v_and_b32 v97,0xffff0000,v44
v_lshlrev_b32 v98,16,v45
v_and_b32 v99,0xffff0000,v45
v_lshlrev_b32 v100,16,v46
v_and_b32 v101,0xffff0000,v46
v_lshlrev_b32 v102,16,v47
v_and_b32 v103,0xffff0000,v47
v_lshlrev_b32 v104,16,v48
v_and_b32 v105,0xffff0000,v48
v_lshlrev_b32 v106,16,v49
v_and_b32 v107,0xffff0000,v49
v_lshlrev_b32 v108,16,v50
v_and_b32 v109,0xffff0000,v50
v_lshlrev_b32 v110,16,v51
v_and_b32 v111,0xffff0000,v51
v_pk_add_f32 v[28:29],v[72:73],v[74:75]
v_pk_mul_f32 v[26:27],v[72:73],v[72:73]
v_pk_fma_f32 v[26:27],v[74:75],v[74:75],v[26:27]
v_pk_add_f32 v[28:29],v[28:29],v[76:77]
v_pk_fma_f32 v[26:27],v[76:77],v[76:77],v[26:27]
v_pk_add_f32 v[28:29],v[28:29],v[78:79]
v_pk_fma_f32 v[26:27],v[78:79],v[78:79],v[26:27]
v_pk_add_f32 v[28:29],v[28:29],v[80:81]
v_pk_fma_f32 v[26:27],v[80:81],v[80:81],v[26:27]
v_pk_add_f32 v[28:29],v[28:29],v[82:83]
v_pk_fma_f32 v[26:27],v[82:83],v[82:83],v[26:27]
v_pk_add_f32 v[28:29],v[28:29],v[84:85]
v_pk_fma_f32 v[26:27],v[84:85],v[84:85],v[26:27]
v_pk_add_f32 v[28:29],v[28:29],v[86:87]
v_pk_fma_f32 v[26:27],v[86:87],v[86:87],v[26:27]
v_pk_add_f32 v[28:29],v[28:29],v[88:89]
v_pk_fma_f32 v[26:27],v[88:89],v[88:89],v[26:27]
v_pk_add_f32 v[28:29],v[28:29],v[90:91]
v_pk_fma_f32 v[26:27],v[90:91],v[90:91],v[26:27]
v_pk_add_f32 v[28:29],v[28:29],v[92:93]
v_pk_fma_f32 v[26:27],v[92:93],v[92:93],v[26:27]
v_pk_add_f32 v[28:29],v[28:29],v[94:95]
v_pk_fma_f32 v[26:27],v[94:95],v[94:95],v[26:27]
v_pk_add_f32 v[28:29],v[28:29],v[96:97]
v_pk_fma_f32 v[26:27],v[96:97],v[96:97],v[26:27]
v_pk_add_f32 v[28:29],v[28:29],v[98:99]
v_pk_fma_f32 v[26:27],v[98:99],v[98:99],v[26:27]
v_pk_add_f32 v[28:29],v[28:29],v[100:101]
v_pk_fma_f32 v[26:27],v[100:101],v[100:101],v[26:27]
v_pk_add_f32 v[28:29],v[28:29],v[102:103]
v_pk_fma_f32 v[26:27],v[102:103],v[102:103],v[26:27]
v_pk_add_f32 v[28:29],v[28:29],v[104:105]
v_pk_fma_f32 v[26:27],v[104:105],v[104:105],v[26:27]
v_pk_add_f32 v[28:29],v[28:29],v[106:107]
v_pk_fma_f32 v[26:27],v[106:107],v[106:107],v[26:27]
v_pk_add_f32 v[28:29],v[28:29],v[108:109]
v_pk_fma_f32 v[26:27],v[108:109],v[108:109],v[26:27]
v_pk_add_f32 v[28:29],v[28:29],v[110:111]
v_pk_fma_f32 v[26:27],v[110:111],v[110:111],v[26:27]
v_add_f32 v24,v28,v29
v_add_f32 v25,v26,v27
s_nop 0
v_add_f32_dpp v24,v24,v24 row_ror:4 row_mask:0xf bank_mask:0xf
v_add_f32_dpp v25,v25,v25 row_ror:4 row_mask:0xf bank_mask:0xf
s_nop 0
v_add_f32_dpp v24,v24,v24 row_ror:8 row_mask:0xf bank_mask:0xf
v_add_f32_dpp v25,v25,v25 row_ror:8 row_mask:0xf bank_mask:0xf
v_mov_b32 v26,v24
v_mov_b32 v27,v25
s_nop 0
v_permlane32_swap_b32 v24,v26
v_permlane32_swap_b32 v25,v27
v_add_f32 v24,v24,v26
v_add_f32 v25,v25,v27
v_mov_b32 v26,v24
v_mov_b32 v27,v25
s_nop 0
v_permlane16_swap_b32 v24,v26
v_permlane16_swap_b32 v25,v27
v_add_f32 v24,v24,v26
v_add_f32 v25,v25,v27
v_mul_f32 v24,0x3acccccd,v24
v_mul_f32 v25,0x3acccccd,v25
v_fma_f32 v25,-v24,v24,v25
v_max_f32 v25,0,v25
v_cvt_pk_bf16_f32 v6,v24,v25
v_lshlrev_b32 v24,16,v6
v_and_b32 v25,0xffff0000,v6
v_add_f32 v25,0x3727c5ac,v25
v_cvt_pk_bf16_f32 v6,v25,v25
v_lshlrev_b32 v25,16,v6
v_sqrt_f32 v25,v25
s_nop 0
v_cvt_pk_bf16_f32 v6,v25,v25
v_lshlrev_b32 v25,16,v6
v_rcp_f32 v25,v25
s_nop 0
v_pk_add_f32 v[72:73],v[72:73],v[24:25] op_sel_hi:[1,0] neg_lo:[0,1] neg_hi:[0,1]
v_pk_add_f32 v[74:75],v[74:75],v[24:25] op_sel_hi:[1,0] neg_lo:[0,1] neg_hi:[0,1]
v_pk_add_f32 v[76:77],v[76:77],v[24:25] op_sel_hi:[1,0] neg_lo:[0,1] neg_hi:[0,1]
v_pk_add_f32 v[78:79],v[78:79],v[24:25] op_sel_hi:[1,0] neg_lo:[0,1] neg_hi:[0,1]
v_pk_add_f32 v[80:81],v[80:81],v[24:25] op_sel_hi:[1,0] neg_lo:[0,1] neg_hi:[0,1]
v_pk_add_f32 v[82:83],v[82:83],v[24:25] op_sel_hi:[1,0] neg_lo:[0,1] neg_hi:[0,1]
v_pk_add_f32 v[84:85],v[84:85],v[24:25] op_sel_hi:[1,0] neg_lo:[0,1] neg_hi:[0,1]
v_pk_add_f32 v[86:87],v[86:87],v[24:25] op_sel_hi:[1,0] neg_lo:[0,1] neg_hi:[0,1]
v_pk_add_f32 v[88:89],v[88:89],v[24:25] op_sel_hi:[1,0] neg_lo:[0,1] neg_hi:[0,1]
v_pk_add_f32 v[90:91],v[90:91],v[24:25] op_sel_hi:[1,0] neg_lo:[0,1] neg_hi:[0,1]
v_pk_add_f32 v[92:93],v[92:93],v[24:25] op_sel_hi:[1,0] neg_lo:[0,1] neg_hi:[0,1]
v_pk_add_f32 v[94:95],v[94:95],v[24:25] op_sel_hi:[1,0] neg_lo:[0,1] neg_hi:[0,1]
v_pk_add_f32 v[96:97],v[96:97],v[24:25] op_sel_hi:[1,0] neg_lo:[0,1] neg_hi:[0,1]
v_pk_add_f32 v[98:99],v[98:99],v[24:25] op_sel_hi:[1,0] neg_lo:[0,1] neg_hi:[0,1]
v_pk_add_f32 v[100:101],v[100:101],v[24:25] op_sel_hi:[1,0] neg_lo:[0,1] neg_hi:[0,1]
v_pk_add_f32 v[102:103],v[102:103],v[24:25] op_sel_hi:[1,0] neg_lo:[0,1] neg_hi:[0,1]
v_pk_add_f32 v[104:105],v[104:105],v[24:25] op_sel_hi:[1,0] neg_lo:[0,1] neg_hi:[0,1]
v_pk_add_f32 v[106:107],v[106:107],v[24:25] op_sel_hi:[1,0] neg_lo:[0,1] neg_hi:[0,1]
v_pk_add_f32 v[108:109],v[108:109],v[24:25] op_sel_hi:[1,0] neg_lo:[0,1] neg_hi:[0,1]
v_pk_add_f32 v[110:111],v[110:111],v[24:25] op_sel_hi:[1,0] neg_lo:[0,1] neg_hi:[0,1]
v_cvt_pk_bf16_f32 v6,v72,v73
v_lshlrev_b32 v72,16,v6
v_and_b32 v73,0xffff0000,v6
v_cvt_pk_bf16_f32 v8,v74,v75
v_lshlrev_b32 v74,16,v8
v_and_b32 v75,0xffff0000,v8
v_cvt_pk_bf16_f32 v6,v76,v77
v_lshlrev_b32 v76,16,v6
v_and_b32 v77,0xffff0000,v6
v_cvt_pk_bf16_f32 v8,v78,v79
v_lshlrev_b32 v78,16,v8
v_and_b32 v79,0xffff0000,v8
v_cvt_pk_bf16_f32 v6,v80,v81
v_lshlrev_b32 v80,16,v6
v_and_b32 v81,0xffff0000,v6
v_cvt_pk_bf16_f32 v8,v82,v83
v_lshlrev_b32 v82,16,v8
v_and_b32 v83,0xffff0000,v8
v_cvt_pk_bf16_f32 v6,v84,v85
v_lshlrev_b32 v84,16,v6
v_and_b32 v85,0xffff0000,v6
v_cvt_pk_bf16_f32 v8,v86,v87
v_lshlrev_b32 v86,16,v8
v_and_b32 v87,0xffff0000,v8
v_cvt_pk_bf16_f32 v6,v88,v89
v_lshlrev_b32 v88,16,v6
v_and_b32 v89,0xffff0000,v6
v_cvt_pk_bf16_f32 v8,v90,v91
v_lshlrev_b32 v90,16,v8
v_and_b32 v91,0xffff0000,v8
v_cvt_pk_bf16_f32 v6,v92,v93
v_lshlrev_b32 v92,16,v6
v_and_b32 v93,0xffff0000,v6
v_cvt_pk_bf16_f32 v8,v94,v95
v_lshlrev_b32 v94,16,v8
v_and_b32 v95,0xffff0000,v8
v_cvt_pk_bf16_f32 v6,v96,v97
v_lshlrev_b32 v96,16,v6
v_and_b32 v97,0xffff0000,v6
v_cvt_pk_bf16_f32 v8,v98,v99
v_lshlrev_b32 v98,16,v8
v_and_b32 v99,0xffff0000,v8
v_cvt_pk_bf16_f32 v6,v100,v101
v_lshlrev_b32 v100,16,v6
v_and_b32 v101,0xffff0000,v6
v_cvt_pk_bf16_f32 v8,v102,v103
v_lshlrev_b32 v102,16,v8
v_and_b32 v103,0xffff0000,v8
v_cvt_pk_bf16_f32 v6,v104,v105
v_lshlrev_b32 v104,16,v6
v_and_b32 v105,0xffff0000,v6
v_cvt_pk_bf16_f32 v8,v106,v107
v_lshlrev_b32 v106,16,v8
v_and_b32 v107,0xffff0000,v8
v_cvt_pk_bf16_f32 v6,v108,v109
v_lshlrev_b32 v108,16,v6
v_and_b32 v109,0xffff0000,v6
v_cvt_pk_bf16_f32 v8,v110,v111
v_lshlrev_b32 v110,16,v8
v_and_b32 v111,0xffff0000,v8
v_pk_mul_f32 v[72:73],v[72:73],v[24:25] op_sel:[0,1] op_sel_hi:[1,1]
v_pk_mul_f32 v[74:75],v[74:75],v[24:25] op_sel:[0,1] op_sel_hi:[1,1]
v_pk_mul_f32 v[76:77],v[76:77],v[24:25] op_sel:[0,1] op_sel_hi:[1,1]
v_pk_mul_f32 v[78:79],v[78:79],v[24:25] op_sel:[0,1] op_sel_hi:[1,1]
v_pk_mul_f32 v[80:81],v[80:81],v[24:25] op_sel:[0,1] op_sel_hi:[1,1]
v_pk_mul_f32 v[82:83],v[82:83],v[24:25] op_sel:[0,1] op_sel_hi:[1,1]
v_pk_mul_f32 v[84:85],v[84:85],v[24:25] op_sel:[0,1] op_sel_hi:[1,1]
v_pk_mul_f32 v[86:87],v[86:87],v[24:25] op_sel:[0,1] op_sel_hi:[1,1]
v_pk_mul_f32 v[88:89],v[88:89],v[24:25] op_sel:[0,1] op_sel_hi:[1,1]
v_pk_mul_f32 v[90:91],v[90:91],v[24:25] op_sel:[0,1] op_sel_hi:[1,1]
v_pk_mul_f32 v[92:93],v[92:93],v[24:25] op_sel:[0,1] op_sel_hi:[1,1]
v_pk_mul_f32 v[94:95],v[94:95],v[24:25] op_sel:[0,1] op_sel_hi:[1,1]
v_pk_mul_f32 v[96:97],v[96:97],v[24:25] op_sel:[0,1] op_sel_hi:[1,1]
v_pk_mul_f32 v[98:99],v[98:99],v[24:25] op_sel:[0,1] op_sel_hi:[1,1]
v_pk_mul_f32 v[100:101],v[100:101],v[24:25] op_sel:[0,1] op_sel_hi:[1,1]
v_pk_mul_f32 v[102:103],v[102:103],v[24:25] op_sel:[0,1] op_sel_hi:[1,1]
v_pk_mul_f32 v[104:105],v[104:105],v[24:25] op_sel:[0,1] op_sel_hi:[1,1]
v_pk_mul_f32 v[106:107],v[106:107],v[24:25] op_sel:[0,1] op_sel_hi:[1,1]
v_pk_mul_f32 v[108:109],v[108:109],v[24:25] op_sel:[0,1] op_sel_hi:[1,1]
v_pk_mul_f32 v[110:111],v[110:111],v[24:25] op_sel:[0,1] op_sel_hi:[1,1]
v_cvt_pk_bf16_f32 v112,v72,v73
v_lshlrev_b32 v72,16,v112
v_and_b32 v73,0xffff0000,v112
v_cvt_pk_bf16_f32 v113,v74,v75
v_lshlrev_b32 v74,16,v113
v_and_b32 v75,0xffff0000,v113
v_cvt_pk_bf16_f32 v114,v76,v77
v_lshlrev_b32 v76,16,v114
v_and_b32 v77,0xffff0000,v114
v_cvt_pk_bf16_f32 v115,v78,v79
v_lshlrev_b32 v78,16,v115
v_and_b32 v79,0xffff0000,v115
v_cvt_pk_bf16_f32 v116,v80,v81
v_lshlrev_b32 v80,16,v116
v_and_b32 v81,0xffff0000,v116
v_cvt_pk_bf16_f32 v117,v82,v83
v_lshlrev_b32 v82,16,v117
v_and_b32 v83,0xffff0000,v117
v_cvt_pk_bf16_f32 v118,v84,v85
v_lshlrev_b32 v84,16,v118
v_and_b32 v85,0xffff0000,v118
v_cvt_pk_bf16_f32 v119,v86,v87
v_lshlrev_b32 v86,16,v119
v_and_b32 v87,0xffff0000,v119
v_cvt_pk_bf16_f32 v120,v88,v89
v_lshlrev_b32 v88,16,v120
v_and_b32 v89,0xffff0000,v120
v_cvt_pk_bf16_f32 v121,v90,v91
v_lshlrev_b32 v90,16,v121
v_and_b32 v91,0xffff0000,v121
v_cvt_pk_bf16_f32 v122,v92,v93
v_lshlrev_b32 v92,16,v122
v_and_b32 v93,0xffff0000,v122
v_cvt_pk_bf16_f32 v123,v94,v95
v_lshlrev_b32 v94,16,v123
v_and_b32 v95,0xffff0000,v123
v_cvt_pk_bf16_f32 v124,v96,v97
v_lshlrev_b32 v96,16,v124
v_and_b32 v97,0xffff0000,v124
v_cvt_pk_bf16_f32 v125,v98,v99
v_lshlrev_b32 v98,16,v125
v_and_b32 v99,0xffff0000,v125
v_cvt_pk_bf16_f32 v126,v100,v101
v_lshlrev_b32 v100,16,v126
v_and_b32 v101,0xffff0000,v126
v_cvt_pk_bf16_f32 v127,v102,v103
v_lshlrev_b32 v102,16,v127
v_and_b32 v103,0xffff0000,v127
v_cvt_pk_bf16_f32 v128,v104,v105
v_lshlrev_b32 v104,16,v128
v_and_b32 v105,0xffff0000,v128
v_cvt_pk_bf16_f32 v129,v106,v107
v_lshlrev_b32 v106,16,v129
v_and_b32 v107,0xffff0000,v129
v_cvt_pk_bf16_f32 v130,v108,v109
v_lshlrev_b32 v108,16,v130
v_and_b32 v109,0xffff0000,v130
v_cvt_pk_bf16_f32 v131,v110,v111
v_lshlrev_b32 v110,16,v131
v_and_b32 v111,0xffff0000,v131
s_add_u32 s63,s65,0
v_permlane16_swap_b32 v112,v114
v_permlane16_swap_b32 v113,v115
buffer_store_dwordx4 v[112:115],v132,s[8:11],s63 offen sc1
s_add_u32 s63,s65,8192
v_permlane16_swap_b32 v116,v118
v_permlane16_swap_b32 v117,v119
buffer_store_dwordx4 v[116:119],v132,s[8:11],s63 offen sc1
s_add_u32 s63,s65,16384
v_permlane16_swap_b32 v120,v122
v_permlane16_swap_b32 v121,v123
buffer_store_dwordx4 v[120:123],v132,s[8:11],s63 offen sc1
s_add_u32 s63,s65,24576
v_permlane16_swap_b32 v124,v126
v_permlane16_swap_b32 v125,v127
buffer_store_dwordx4 v[124:127],v132,s[8:11],s63 offen sc1
s_add_u32 s63,s65,32768
v_permlane16_swap_b32 v128,v130
v_permlane16_swap_b32 v129,v131
buffer_store_dwordx4 v[128:131],v132,s[8:11],s63 offen sc1
s_add_u32 s63,s64,0
v_permlane16_swap_b32 v32,v34
v_permlane16_swap_b32 v33,v35
buffer_store_dwordx4 v[32:35],v132,s[8:11],s63 offen sc1
s_add_u32 s63,s64,8192
v_permlane16_swap_b32 v36,v38
v_permlane16_swap_b32 v37,v39
buffer_store_dwordx4 v[36:39],v132,s[8:11],s63 offen sc1
s_add_u32 s63,s64,16384
v_permlane16_swap_b32 v40,v42
v_permlane16_swap_b32 v41,v43
buffer_store_dwordx4 v[40:43],v132,s[8:11],s63 offen sc1
s_add_u32 s63,s64,24576
v_permlane16_swap_b32 v44,v46
v_permlane16_swap_b32 v45,v47
buffer_store_dwordx4 v[44:47],v132,s[8:11],s63 offen sc1
s_add_u32 s63,s64,32768
v_permlane16_swap_b32 v48,v50
v_permlane16_swap_b32 v49,v51
buffer_store_dwordx4 v[48:51],v132,s[8:11],s63 offen sc1
s_lshl_b32 s82,s55,6
s_add_u32 s82,s82,s54
s_lshl_b32 s82,s82,9
s_add_u32 s82,s82,0
s_lshl_b32 s61,s53,2
s_add_u32 s82,s82,s61
s_add_u32 s54,s54,16
s_lshl_b32 s3,s49,2
v_mov_b32 v7,s3
s_nop 1
ibw_258:
buffer_load_dword v6,v7,s[12:15],0 offen sc1
s_waitcnt vmcnt(0)
v_cmp_ne_u32 vcc,256,v6
s_nop 0
s_cbranch_vccz ok_259
s_sleep 8
s_sub_u32 s47,s47,1
s_cbranch_scc1 ABORT
s_branch ibw_258
ok_259:
s_cmp_lg_u32 s49,0
s_cbranch_scc1 ibok_260
v_and_b32 v7,7,v0
v_lshlrev_b32 v7,2,v7
buffer_load_dword v6,v7,s[12:15],0 offen offset:32 sc1
s_waitcnt vmcnt(0)
v_cmp_ne_u32 vcc,32,v6
s_nop 0
s_cbranch_vccz ibok_260
s_barrier
s_mov_b32 s49,1
s_mov_b32 s3,s2
s_load_dwordx16 s[16:31],s[0:1],0
s_load_dwordx8 s[32:39],s[0:1],64
s_waitcnt lgkmcnt(0)
s_branch DISPATCH
ibok_260:
s_mov_b64 exec,1
buffer_store_dword v5,v1,s[8:11],s82 offen sc1
s_mov_b64 exec,-1
s_add_u32 s66,s54,16
s_min_u32 s66,s66,63
s_mul_i32 s62,s66,40960
buffer_load_dwordx2 v[32:33],v133,s[4:7],s62 offen offset:0
buffer_load_dwordx2 v[34:35],v133,s[4:7],s62 offen offset:128
buffer_load_dwordx2 v[36:37],v133,s[4:7],s62 offen offset:256
buffer_load_dwordx2 v[38:39],v133,s[4:7],s62 offen offset:384
buffer_load_dwordx2 v[40:41],v133,s[4:7],s62 offen offset:512
buffer_load_dwordx2 v[42:43],v133,s[4:7],s62 offen offset:640
buffer_load_dwordx2 v[44:45],v133,s[4:7],s62 offen offset:768
buffer_load_dwordx2 v[46:47],v133,s[4:7],s62 offen offset:896
buffer_load_dwordx2 v[48:49],v133,s[4:7],s62 offen offset:1024
buffer_load_dwordx2 v[50:51],v133,s[4:7],s62 offen offset:1152
s_mul_i32 s64,s54,40960
s_add_u32 s64,s64,234749952
s_mul_i32 s65,s54,46080
s_add_u32 s65,s65,206569472
s_waitcnt vmcnt(10)
v_lshlrev_b32 v72,16,v52
v_and_b32 v73,0xffff0000,v52
v_lshlrev_b32 v74,16,v53
v_and_b32 v75,0xffff0000,v53
v_lshlrev_b32 v76,16,v54
v_and_b32 v77,0xffff0000,v54
v_lshlrev_b32 v78,16,v55
v_and_b32 v79,0xffff0000,v55
v_lshlrev_b32 v80,16,v56
v_and_b32 v81,0xffff0000,v56
v_lshlrev_b32 v82,16,v57
v_and_b32 v83,0xffff0000,v57
v_lshlrev_b32 v84,16,v58
v_and_b32 v85,0xffff0000,v58
v_lshlrev_b32 v86,16,v59
v_and_b32 v87,0xffff0000,v59
v_lshlrev_b32 v88,16,v60
v_and_b32 v89,0xffff0000,v60
v_lshlrev_b32 v90,16,v61
v_and_b32 v91,0xffff0000,v61
v_lshlrev_b32 v92,16,v62
v_and_b32 v93,0xffff0000,v62
v_lshlrev_b32 v94,16,v63
v_and_b32 v95,0xffff0000,v63
v_lshlrev_b32 v96,16,v64
v_and_b32 v97,0xffff0000,v64
v_lshlrev_b32 v98,16,v65
v_and_b32 v99,0xffff0000,v65
v_lshlrev_b32 v100,16,v66
v_and_b32 v101,0xffff0000,v66
v_lshlrev_b32 v102,16,v67
v_and_b32 v103,0xffff0000,v67
v_lshlrev_b32 v104,16,v68
v_and_b32 v105,0xffff0000,v68
v_lshlrev_b32 v106,16,v69
v_and_b32 v107,0xffff0000,v69
v_lshlrev_b32 v108,16,v70
v_and_b32 v109,0xffff0000,v70
v_lshlrev_b32 v110,16,v71
v_and_b32 v111,0xffff0000,v71
v_pk_add_f32 v[28:29],v[72:73],v[74:75]
v_pk_mul_f32 v[26:27],v[72:73],v[72:73]
v_pk_fma_f32 v[26:27],v[74:75],v[74:75],v[26:27]
v_pk_add_f32 v[28:29],v[28:29],v[76:77]
v_pk_fma_f32 v[26:27],v[76:77],v[76:77],v[26:27]
v_pk_add_f32 v[28:29],v[28:29],v[78:79]
v_pk_fma_f32 v[26:27],v[78:79],v[78:79],v[26:27]
v_pk_add_f32 v[28:29],v[28:29],v[80:81]
v_pk_fma_f32 v[26:27],v[80:81],v[80:81],v[26:27]
v_pk_add_f32 v[28:29],v[28:29],v[82:83]
v_pk_fma_f32 v[26:27],v[82:83],v[82:83],v[26:27]
v_pk_add_f32 v[28:29],v[28:29],v[84:85]
v_pk_fma_f32 v[26:27],v[84:85],v[84:85],v[26:27]
v_pk_add_f32 v[28:29],v[28:29],v[86:87]
v_pk_fma_f32 v[26:27],v[86:87],v[86:87],v[26:27]
v_pk_add_f32 v[28:29],v[28:29],v[88:89]
v_pk_fma_f32 v[26:27],v[88:89],v[88:89],v[26:27]
v_pk_add_f32 v[28:29],v[28:29],v[90:91]
v_pk_fma_f32 v[26:27],v[90:91],v[90:91],v[26:27]
v_pk_add_f32 v[28:29],v[28:29],v[92:93]
v_pk_fma_f32 v[26:27],v[92:93],v[92:93],v[26:27]
v_pk_add_f32 v[28:29],v[28:29],v[94:95]
v_pk_fma_f32 v[26:27],v[94:95],v[94:95],v[26:27]
v_pk_add_f32 v[28:29],v[28:29],v[96:97]
v_pk_fma_f32 v[26:27],v[96:97],v[96:97],v[26:27]
v_pk_add_f32 v[28:29],v[28:29],v[98:99]
v_pk_fma_f32 v[26:27],v[98:99],v[98:99],v[26:27]
v_pk_add_f32 v[28:29],v[28:29],v[100:101]
v_pk_fma_f32 v[26:27],v[100:101],v[100:101],v[26:27]
v_pk_add_f32 v[28:29],v[28:29],v[102:103]
v_pk_fma_f32 v[26:27],v[102:103],v[102:103],v[26:27]
v_pk_add_f32 v[28:29],v[28:29],v[104:105]
v_pk_fma_f32 v[26:27],v[104:105],v[104:105],v[26:27]
v_pk_add_f32 v[28:29],v[28:29],v[106:107]
v_pk_fma_f32 v[26:27],v[106:107],v[106:107],v[26:27]
v_pk_add_f32 v[28:29],v[28:29],v[108:109]
v_pk_fma_f32 v[26:27],v[108:109],v[108:109],v[26:27]
v_pk_add_f32 v[28:29],v[28:29],v[110:111]
v_pk_fma_f32 v[26:27],v[110:111],v[110:111],v[26:27]
v_add_f32 v24,v28,v29
v_add_f32 v25,v26,v27
s_nop 0
v_add_f32_dpp v24,v24,v24 row_ror:4 row_mask:0xf bank_mask:0xf
v_add_f32_dpp v25,v25,v25 row_ror:4 row_mask:0xf bank_mask:0xf
s_nop 0
v_add_f32_dpp v24,v24,v24 row_ror:8 row_mask:0xf bank_mask:0xf
v_add_f32_dpp v25,v25,v25 row_ror:8 row_mask:0xf bank_mask:0xf
v_mov_b32 v26,v24
v_mov_b32 v27,v25
s_nop 0
v_permlane32_swap_b32 v24,v26
v_permlane32_swap_b32 v25,v27
v_add_f32 v24,v24,v26
v_add_f32 v25,v25,v27
v_mov_b32 v26,v24
v_mov_b32 v27,v25
s_nop 0
v_permlane16_swap_b32 v24,v26
v_permlane16_swap_b32 v25,v27
v_add_f32 v24,v24,v26
v_add_f32 v25,v25,v27
v_mul_f32 v24,0x3acccccd,v24
v_mul_f32 v25,0x3acccccd,v25
v_fma_f32 v25,-v24,v24,v25
v_max_f32 v25,0,v25
v_cvt_pk_bf16_f32 v6,v24,v25
v_lshlrev_b32 v24,16,v6
v_and_b32 v25,0xffff0000,v6
v_add_f32 v25,0x3727c5ac,v25
v_cvt_pk_bf16_f32 v6,v25,v25
v_lshlrev_b32 v25,16,v6
v_sqrt_f32 v25,v25
s_nop 0
v_cvt_pk_bf16_f32 v6,v25,v25
v_lshlrev_b32 v25,16,v6
v_rcp_f32 v25,v25
s_nop 0
v_pk_add_f32 v[72:73],v[72:73],v[24:25] op_sel_hi:[1,0] neg_lo:[0,1] neg_hi:[0,1]
v_pk_add_f32 v[74:75],v[74:75],v[24:25] op_sel_hi:[1,0] neg_lo:[0,1] neg_hi:[0,1]
v_pk_add_f32 v[76:77],v[76:77],v[24:25] op_sel_hi:[1,0] neg_lo:[0,1] neg_hi:[0,1]
v_pk_add_f32 v[78:79],v[78:79],v[24:25] op_sel_hi:[1,0] neg_lo:[0,1] neg_hi:[0,1]
v_pk_add_f32 v[80:81],v[80:81],v[24:25] op_sel_hi:[1,0] neg_lo:[0,1] neg_hi:[0,1]
v_pk_add_f32 v[82:83],v[82:83],v[24:25] op_sel_hi:[1,0] neg_lo:[0,1] neg_hi:[0,1]
v_pk_add_f32 v[84:85],v[84:85],v[24:25] op_sel_hi:[1,0] neg_lo:[0,1] neg_hi:[0,1]
v_pk_add_f32 v[86:87],v[86:87],v[24:25] op_sel_hi:[1,0] neg_lo:[0,1] neg_hi:[0,1]
v_pk_add_f32 v[88:89],v[88:89],v[24:25] op_sel_hi:[1,0] neg_lo:[0,1] neg_hi:[0,1]
v_pk_add_f32 v[90:91],v[90:91],v[24:25] op_sel_hi:[1,0] neg_lo:[0,1] neg_hi:[0,1]
v_pk_add_f32 v[92:93],v[92:93],v[24:25] op_sel_hi:[1,0] neg_lo:[0,1] neg_hi:[0,1]
v_pk_add_f32 v[94:95],v[94:95],v[24:25] op_sel_hi:[1,0] neg_lo:[0,1] neg_hi:[0,1]
v_pk_add_f32 v[96:97],v[96:97],v[24:25] op_sel_hi:[1,0] neg_lo:[0,1] neg_hi:[0,1]
v_pk_add_f32 v[98:99],v[98:99],v[24:25] op_sel_hi:[1,0] neg_lo:[0,1] neg_hi:[0,1]
v_pk_add_f32 v[100:101],v[100:101],v[24:25] op_sel_hi:[1,0] neg_lo:[0,1] neg_hi:[0,1]
v_pk_add_f32 v[102:103],v[102:103],v[24:25] op_sel_hi:[1,0] neg_lo:[0,1] neg_hi:[0,1]
v_pk_add_f32 v[104:105],v[104:105],v[24:25] op_sel_hi:[1,0] neg_lo:[0,1] neg_hi:[0,1]
v_pk_add_f32 v[106:107],v[106:107],v[24:25] op_sel_hi:[1,0] neg_lo:[0,1] neg_hi:[0,1]
v_pk_add_f32 v[108:109],v[108:109],v[24:25] op_sel_hi:[1,0] neg_lo:[0,1] neg_hi:[0,1]
v_pk_add_f32 v[110:111],v[110:111],v[24:25] op_sel_hi:[1,0] neg_lo:[0,1] neg_hi:[0,1]
v_cvt_pk_bf16_f32 v6,v72,v73
v_lshlrev_b32 v72,16,v6
v_and_b32 v73,0xffff0000,v6
v_cvt_pk_bf16_f32 v8,v74,v75
v_lshlrev_b32 v74,16,v8
v_and_b32 v75,0xffff0000,v8
v_cvt_pk_bf16_f32 v6,v76,v77
v_lshlrev_b32 v76,16,v6
v_and_b32 v77,0xffff0000,v6
v_cvt_pk_bf16_f32 v8,v78,v79
v_lshlrev_b32 v78,16,v8
v_and_b32 v79,0xffff0000,v8
v_cvt_pk_bf16_f32 v6,v80,v81
v_lshlrev_b32 v80,16,v6
v_and_b32 v81,0xffff0000,v6
v_cvt_pk_bf16_f32 v8,v82,v83
v_lshlrev_b32 v82,16,v8
v_and_b32 v83,0xffff0000,v8
v_cvt_pk_bf16_f32 v6,v84,v85
v_lshlrev_b32 v84,16,v6
v_and_b32 v85,0xffff0000,v6
v_cvt_pk_bf16_f32 v8,v86,v87
v_lshlrev_b32 v86,16,v8
v_and_b32 v87,0xffff0000,v8
v_cvt_pk_bf16_f32 v6,v88,v89
v_lshlrev_b32 v88,16,v6
v_and_b32 v89,0xffff0000,v6
v_cvt_pk_bf16_f32 v8,v90,v91
v_lshlrev_b32 v90,16,v8
v_and_b32 v91,0xffff0000,v8
v_cvt_pk_bf16_f32 v6,v92,v93
v_lshlrev_b32 v92,16,v6
v_and_b32 v93,0xffff0000,v6
v_cvt_pk_bf16_f32 v8,v94,v95
v_lshlrev_b32 v94,16,v8
v_and_b32 v95,0xffff0000,v8
v_cvt_pk_bf16_f32 v6,v96,v97
v_lshlrev_b32 v96,16,v6
v_and_b32 v97,0xffff0000,v6
v_cvt_pk_bf16_f32 v8,v98,v99
v_lshlrev_b32 v98,16,v8
v_and_b32 v99,0xffff0000,v8
v_cvt_pk_bf16_f32 v6,v100,v101
v_lshlrev_b32 v100,16,v6
v_and_b32 v101,0xffff0000,v6
v_cvt_pk_bf16_f32 v8,v102,v103
v_lshlrev_b32 v102,16,v8
v_and_b32 v103,0xffff0000,v8
v_cvt_pk_bf16_f32 v6,v104,v105
v_lshlrev_b32 v104,16,v6
v_and_b32 v105,0xffff0000,v6
v_cvt_pk_bf16_f32 v8,v106,v107
v_lshlrev_b32 v106,16,v8
v_and_b32 v107,0xffff0000,v8
v_cvt_pk_bf16_f32 v6,v108,v109
v_lshlrev_b32 v108,16,v6
v_and_b32 v109,0xffff0000,v6
v_cvt_pk_bf16_f32 v8,v110,v111
v_lshlrev_b32 v110,16,v8
v_and_b32 v111,0xffff0000,v8
v_pk_mul_f32 v[72:73],v[72:73],v[24:25] op_sel:[0,1] op_sel_hi:[1,1]
v_pk_mul_f32 v[74:75],v[74:75],v[24:25] op_sel:[0,1] op_sel_hi:[1,1]
v_pk_mul_f32 v[76:77],v[76:77],v[24:25] op_sel:[0,1] op_sel_hi:[1,1]
v_pk_mul_f32 v[78:79],v[78:79],v[24:25] op_sel:[0,1] op_sel_hi:[1,1]
v_pk_mul_f32 v[80:81],v[80:81],v[24:25] op_sel:[0,1] op_sel_hi:[1,1]
v_pk_mul_f32 v[82:83],v[82:83],v[24:25] op_sel:[0,1] op_sel_hi:[1,1]
v_pk_mul_f32 v[84:85],v[84:85],v[24:25] op_sel:[0,1] op_sel_hi:[1,1]
v_pk_mul_f32 v[86:87],v[86:87],v[24:25] op_sel:[0,1] op_sel_hi:[1,1]
v_pk_mul_f32 v[88:89],v[88:89],v[24:25] op_sel:[0,1] op_sel_hi:[1,1]
v_pk_mul_f32 v[90:91],v[90:91],v[24:25] op_sel:[0,1] op_sel_hi:[1,1]
v_pk_mul_f32 v[92:93],v[92:93],v[24:25] op_sel:[0,1] op_sel_hi:[1,1]
v_pk_mul_f32 v[94:95],v[94:95],v[24:25] op_sel:[0,1] op_sel_hi:[1,1]
v_pk_mul_f32 v[96:97],v[96:97],v[24:25] op_sel:[0,1] op_sel_hi:[1,1]
v_pk_mul_f32 v[98:99],v[98:99],v[24:25] op_sel:[0,1] op_sel_hi:[1,1]
v_pk_mul_f32 v[100:101],v[100:101],v[24:25] op_sel:[0,1] op_sel_hi:[1,1]
v_pk_mul_f32 v[102:103],v[102:103],v[24:25] op_sel:[0,1] op_sel_hi:[1,1]
v_pk_mul_f32 v[104:105],v[104:105],v[24:25] op_sel:[0,1] op_sel_hi:[1,1]
v_pk_mul_f32 v[106:107],v[106:107],v[24:25] op_sel:[0,1] op_sel_hi:[1,1]
v_pk_mul_f32 v[108:109],v[108:109],v[24:25] op_sel:[0,1] op_sel_hi:[1,1]
v_pk_mul_f32 v[110:111],v[110:111],v[24:25] op_sel:[0,1] op_sel_hi:[1,1]
v_cvt_pk_bf16_f32 v112,v72,v73
v_lshlrev_b32 v72,16,v112
v_and_b32 v73,0xffff0000,v112
v_cvt_pk_bf16_f32 v113,v74,v75
v_lshlrev_b32 v74,16,v113
v_and_b32 v75,0xffff0000,v113
v_cvt_pk_bf16_f32 v114,v76,v77
v_lshlrev_b32 v76,16,v114
v_and_b32 v77,0xffff0000,v114
v_cvt_pk_bf16_f32 v115,v78,v79
v_lshlrev_b32 v78,16,v115
v_and_b32 v79,0xffff0000,v115
v_cvt_pk_bf16_f32 v116,v80,v81
v_lshlrev_b32 v80,16,v116
v_and_b32 v81,0xffff0000,v116
v_cvt_pk_bf16_f32 v117,v82,v83
v_lshlrev_b32 v82,16,v117
v_and_b32 v83,0xffff0000,v117
v_cvt_pk_bf16_f32 v118,v84,v85
v_lshlrev_b32 v84,16,v118
v_and_b32 v85,0xffff0000,v118
v_cvt_pk_bf16_f32 v119,v86,v87
v_lshlrev_b32 v86,16,v119
v_and_b32 v87,0xffff0000,v119
v_cvt_pk_bf16_f32 v120,v88,v89
v_lshlrev_b32 v88,16,v120
v_and_b32 v89,0xffff0000,v120
v_cvt_pk_bf16_f32 v121,v90,v91
v_lshlrev_b32 v90,16,v121
v_and_b32 v91,0xffff0000,v121
v_cvt_pk_bf16_f32 v122,v92,v93
v_lshlrev_b32 v92,16,v122
v_and_b32 v93,0xffff0000,v122
v_cvt_pk_bf16_f32 v123,v94,v95
v_lshlrev_b32 v94,16,v123
v_and_b32 v95,0xffff0000,v123
v_cvt_pk_bf16_f32 v124,v96,v97
v_lshlrev_b32 v96,16,v124
v_and_b32 v97,0xffff0000,v124
v_cvt_pk_bf16_f32 v125,v98,v99
v_lshlrev_b32 v98,16,v125
v_and_b32 v99,0xffff0000,v125
v_cvt_pk_bf16_f32 v126,v100,v101
v_lshlrev_b32 v100,16,v126
v_and_b32 v101,0xffff0000,v126
v_cvt_pk_bf16_f32 v127,v102,v103
v_lshlrev_b32 v102,16,v127
v_and_b32 v103,0xffff0000,v127
v_cvt_pk_bf16_f32 v128,v104,v105
v_lshlrev_b32 v104,16,v128
v_and_b32 v105,0xffff0000,v128
v_cvt_pk_bf16_f32 v129,v106,v107
v_lshlrev_b32 v106,16,v129
v_and_b32 v107,0xffff0000,v129
v_cvt_pk_bf16_f32 v130,v108,v109
v_lshlrev_b32 v108,16,v130
v_and_b32 v109,0xffff0000,v130
v_cvt_pk_bf16_f32 v131,v110,v111
v_lshlrev_b32 v110,16,v131
v_and_b32 v111,0xffff0000,v131
s_add_u32 s63,s65,0
v_permlane16_swap_b32 v112,v114
v_permlane16_swap_b32 v113,v115
buffer_store_dwordx4 v[112:115],v132,s[8:11],s63 offen sc1
s_add_u32 s63,s65,8192
v_permlane16_swap_b32 v116,v118
v_permlane16_swap_b32 v117,v119
buffer_store_dwordx4 v[116:119],v132,s[8:11],s63 offen sc1
s_add_u32 s63,s65,16384
v_permlane16_swap_b32 v120,v122
v_permlane16_swap_b32 v121,v123
buffer_store_dwordx4 v[120:123],v132,s[8:11],s63 offen sc1
s_add_u32 s63,s65,24576
v_permlane16_swap_b32 v124,v126
v_permlane16_swap_b32 v125,v127
buffer_store_dwordx4 v[124:127],v132,s[8:11],s63 offen sc1
s_add_u32 s63,s65,32768
v_permlane16_swap_b32 v128,v130
v_permlane16_swap_b32 v129,v131
buffer_store_dwordx4 v[128:131],v132,s[8:11],s63 offen sc1
s_add_u32 s63,s64,0
v_permlane16_swap_b32 v52,v54
v_permlane16_swap_b32 v53,v55
buffer_store_dwordx4 v[52:55],v132,s[8:11],s63 offen sc1
s_add_u32 s63,s64,8192
v_permlane16_swap_b32 v56,v58
v_permlane16_swap_b32 v57,v59
buffer_store_dwordx4 v[56:59],v132,s[8:11],s63 offen sc1
s_add_u32 s63,s64,16384
v_permlane16_swap_b32 v60,v62
v_permlane16_swap_b32 v61,v63
buffer_store_dwordx4 v[60:63],v132,s[8:11],s63 offen sc1
s_add_u32 s63,s64,24576
v_permlane16_swap_b32 v64,v66
v_permlane16_swap_b32 v65,v67
buffer_store_dwordx4 v[64:67],v132,s[8:11],s63 offen sc1
s_add_u32 s63,s64,32768
v_permlane16_swap_b32 v68,v70
v_permlane16_swap_b32 v69,v71
buffer_store_dwordx4 v[68:71],v132,s[8:11],s63 offen sc1
s_lshl_b32 s82,s55,6
s_add_u32 s82,s82,s54
s_lshl_b32 s82,s82,9
s_add_u32 s82,s82,0
s_lshl_b32 s61,s53,2
s_add_u32 s82,s82,s61
s_add_u32 s54,s54,16
R0_LOOPA:
s_add_u32 s66,s54,16
s_min_u32 s66,s66,63
s_mul_i32 s62,s66,40960
buffer_load_dwordx2 v[52:53],v133,s[4:7],s62 offen offset:0
buffer_load_dwordx2 v[54:55],v133,s[4:7],s62 offen offset:128
buffer_load_dwordx2 v[56:57],v133,s[4:7],s62 offen offset:256
buffer_load_dwordx2 v[58:59],v133,s[4:7],s62 offen offset:384
buffer_load_dwordx2 v[60:61],v133,s[4:7],s62 offen offset:512
buffer_load_dwordx2 v[62:63],v133,s[4:7],s62 offen offset:640
buffer_load_dwordx2 v[64:65],v133,s[4:7],s62 offen offset:768
buffer_load_dwordx2 v[66:67],v133,s[4:7],s62 offen offset:896
buffer_load_dwordx2 v[68:69],v133,s[4:7],s62 offen offset:1024
buffer_load_dwordx2 v[70:71],v133,s[4:7],s62 offen offset:1152
s_mul_i32 s64,s54,40960
s_add_u32 s64,s64,234749952
s_mul_i32 s65,s54,46080
s_add_u32 s65,s65,206569472
s_waitcnt vmcnt(10)
s_mov_b64 exec,1
buffer_store_dword v5,v1,s[8:11],s82 offen sc1
s_mov_b64 exec,-1
v_lshlrev_b32 v72,16,v32
v_and_b32 v73,0xffff0000,v32
v_lshlrev_b32 v74,16,v33
v_and_b32 v75,0xffff0000,v33
v_lshlrev_b32 v76,16,v34
v_and_b32 v77,0xffff0000,v34
v_lshlrev_b32 v78,16,v35
v_and_b32 v79,0xffff0000,v35
v_lshlrev_b32 v80,16,v36
v_and_b32 v81,0xffff0000,v36
v_lshlrev_b32 v82,16,v37
v_and_b32 v83,0xffff0000,v37
v_lshlrev_b32 v84,16,v38
v_and_b32 v85,0xffff0000,v38
v_lshlrev_b32 v86,16,v39
v_and_b32 v87,0xffff0000,v39
v_lshlrev_b32 v88,16,v40
v_and_b32 v89,0xffff0000,v40
v_lshlrev_b32 v90,16,v41
v_and_b32 v91,0xffff0000,v41
v_lshlrev_b32 v92,16,v42
v_and_b32 v93,0xffff0000,v42
v_lshlrev_b32 v94,16,v43
v_and_b32 v95,0xffff0000,v43
v_lshlrev_b32 v96,16,v44
v_and_b32 v97,0xffff0000,v44
v_lshlrev_b32 v98,16,v45
v_and_b32 v99,0xffff0000,v45
v_lshlrev_b32 v100,16,v46
v_and_b32 v101,0xffff0000,v46
v_lshlrev_b32 v102,16,v47
v_and_b32 v103,0xffff0000,v47
v_lshlrev_b32 v104,16,v48
v_and_b32 v105,0xffff0000,v48
v_lshlrev_b32 v106,16,v49
v_and_b32 v107,0xffff0000,v49
v_lshlrev_b32 v108,16,v50
v_and_b32 v109,0xffff0000,v50
v_lshlrev_b32 v110,16,v51
v_and_b32 v111,0xffff0000,v51
v_pk_add_f32 v[28:29],v[72:73],v[74:75]
v_pk_mul_f32 v[26:27],v[72:73],v[72:73]
v_pk_fma_f32 v[26:27],v[74:75],v[74:75],v[26:27]
v_pk_add_f32 v[28:29],v[28:29],v[76:77]
v_pk_fma_f32 v[26:27],v[76:77],v[76:77],v[26:27]
v_pk_add_f32 v[28:29],v[28:29],v[78:79]
v_pk_fma_f32 v[26:27],v[78:79],v[78:79],v[26:27]
v_pk_add_f32 v[28:29],v[28:29],v[80:81]
v_pk_fma_f32 v[26:27],v[80:81],v[80:81],v[26:27]
v_pk_add_f32 v[28:29],v[28:29],v[82:83]
v_pk_fma_f32 v[26:27],v[82:83],v[82:83],v[26:27]
v_pk_add_f32 v[28:29],v[28:29],v[84:85]
v_pk_fma_f32 v[26:27],v[84:85],v[84:85],v[26:27]
v_pk_add_f32 v[28:29],v[28:29],v[86:87]
v_pk_fma_f32 v[26:27],v[86:87],v[86:87],v[26:27]
v_pk_add_f32 v[28:29],v[28:29],v[88:89]
v_pk_fma_f32 v[26:27],v[88:89],v[88:89],v[26:27]
v_pk_add_f32 v[28:29],v[28:29],v[90:91]
v_pk_fma_f32 v[26:27],v[90:91],v[90:91],v[26:27]
v_pk_add_f32 v[28:29],v[28:29],v[92:93]
v_pk_fma_f32 v[26:27],v[92:93],v[92:93],v[26:27]
v_pk_add_f32 v[28:29],v[28:29],v[94:95]
v_pk_fma_f32 v[26:27],v[94:95],v[94:95],v[26:27]
v_pk_add_f32 v[28:29],v[28:29],v[96:97]
v_pk_fma_f32 v[26:27],v[96:97],v[96:97],v[26:27]
v_pk_add_f32 v[28:29],v[28:29],v[98:99]
v_pk_fma_f32 v[26:27],v[98:99],v[98:99],v[26:27]
v_pk_add_f32 v[28:29],v[28:29],v[100:101]
v_pk_fma_f32 v[26:27],v[100:101],v[100:101],v[26:27]
v_pk_add_f32 v[28:29],v[28:29],v[102:103]
v_pk_fma_f32 v[26:27],v[102:103],v[102:103],v[26:27]
v_pk_add_f32 v[28:29],v[28:29],v[104:105]
v_pk_fma_f32 v[26:27],v[104:105],v[104:105],v[26:27]
v_pk_add_f32 v[28:29],v[28:29],v[106:107]
v_pk_fma_f32 v[26:27],v[106:107],v[106:107],v[26:27]
v_pk_add_f32 v[28:29],v[28:29],v[108:109]
v_pk_fma_f32 v[26:27],v[108:109],v[108:109],v[26:27]
v_pk_add_f32 v[28:29],v[28:29],v[110:111]
v_pk_fma_f32 v[26:27],v[110:111],v[110:111],v[26:27]
v_add_f32 v24,v28,v29
v_add_f32 v25,v26,v27
s_nop 0
v_add_f32_dpp v24,v24,v24 row_ror:4 row_mask:0xf bank_mask:0xf
v_add_f32_dpp v25,v25,v25 row_ror:4 row_mask:0xf bank_mask:0xf
s_nop 0
v_add_f32_dpp v24,v24,v24 row_ror:8 row_mask:0xf bank_mask:0xf
v_add_f32_dpp v25,v25,v25 row_ror:8 row_mask:0xf bank_mask:0xf
v_mov_b32 v26,v24
v_mov_b32 v27,v25
s_nop 0
v_permlane32_swap_b32 v24,v26
v_permlane32_swap_b32 v25,v27
v_add_f32 v24,v24,v26
v_add_f32 v25,v25,v27
v_mov_b32 v26,v24
v_mov_b32 v27,v25
s_nop 0
v_permlane16_swap_b32 v24,v26
v_permlane16_swap_b32 v25,v27
v_add_f32 v24,v24,v26
v_add_f32 v25,v25,v27
v_mul_f32 v24,0x3acccccd,v24
v_mul_f32 v25,0x3acccccd,v25
v_fma_f32 v25,-v24,v24,v25
v_max_f32 v25,0,v25
v_cvt_pk_bf16_f32 v6,v24,v25
v_lshlrev_b32 v24,16,v6
v_and_b32 v25,0xffff0000,v6
v_add_f32 v25,0x3727c5ac,v25
v_cvt_pk_bf16_f32 v6,v25,v25
v_lshlrev_b32 v25,16,v6
v_sqrt_f32 v25,v25
s_nop 0
v_cvt_pk_bf16_f32 v6,v25,v25
v_lshlrev_b32 v25,16,v6
v_rcp_f32 v25,v25
s_nop 0
v_pk_add_f32 v[72:73],v[72:73],v[24:25] op_sel_hi:[1,0] neg_lo:[0,1] neg_hi:[0,1]
v_pk_add_f32 v[74:75],v[74:75],v[24:25] op_sel_hi:[1,0] neg_lo:[0,1] neg_hi:[0,1]
v_pk_add_f32 v[76:77],v[76:77],v[24:25] op_sel_hi:[1,0] neg_lo:[0,1] neg_hi:[0,1]
v_pk_add_f32 v[78:79],v[78:79],v[24:25] op_sel_hi:[1,0] neg_lo:[0,1] neg_hi:[0,1]
v_pk_add_f32 v[80:81],v[80:81],v[24:25] op_sel_hi:[1,0] neg_lo:[0,1] neg_hi:[0,1]
v_pk_add_f32 v[82:83],v[82:83],v[24:25] op_sel_hi:[1,0] neg_lo:[0,1] neg_hi:[0,1]
v_pk_add_f32 v[84:85],v[84:85],v[24:25] op_sel_hi:[1,0] neg_lo:[0,1] neg_hi:[0,1]
v_pk_add_f32 v[86:87],v[86:87],v[24:25] op_sel_hi:[1,0] neg_lo:[0,1] neg_hi:[0,1]
v_pk_add_f32 v[88:89],v[88:89],v[24:25] op_sel_hi:[1,0] neg_lo:[0,1] neg_hi:[0,1]
v_pk_add_f32 v[90:91],v[90:91],v[24:25] op_sel_hi:[1,0] neg_lo:[0,1] neg_hi:[0,1]
v_pk_add_f32 v[92:93],v[92:93],v[24:25] op_sel_hi:[1,0] neg_lo:[0,1] neg_hi:[0,1]
v_pk_add_f32 v[94:95],v[94:95],v[24:25] op_sel_hi:[1,0] neg_lo:[0,1] neg_hi:[0,1]
v_pk_add_f32 v[96:97],v[96:97],v[24:25] op_sel_hi:[1,0] neg_lo:[0,1] neg_hi:[0,1]
v_pk_add_f32 v[98:99],v[98:99],v[24:25] op_sel_hi:[1,0] neg_lo:[0,1] neg_hi:[0,1]
v_pk_add_f32 v[100:101],v[100:101],v[24:25] op_sel_hi:[1,0] neg_lo:[0,1] neg_hi:[0,1]
v_pk_add_f32 v[102:103],v[102:103],v[24:25] op_sel_hi:[1,0] neg_lo:[0,1] neg_hi:[0,1]
v_pk_add_f32 v[104:105],v[104:105],v[24:25] op_sel_hi:[1,0] neg_lo:[0,1] neg_hi:[0,1]
v_pk_add_f32 v[106:107],v[106:107],v[24:25] op_sel_hi:[1,0] neg_lo:[0,1] neg_hi:[0,1]
v_pk_add_f32 v[108:109],v[108:109],v[24:25] op_sel_hi:[1,0] neg_lo:[0,1] neg_hi:[0,1]
v_pk_add_f32 v[110:111],v[110:111],v[24:25] op_sel_hi:[1,0] neg_lo:[0,1] neg_hi:[0,1]
v_cvt_pk_bf16_f32 v6,v72,v73
v_lshlrev_b32 v72,16,v6
v_and_b32 v73,0xffff0000,v6
v_cvt_pk_bf16_f32 v8,v74,v75
v_lshlrev_b32 v74,16,v8
v_and_b32 v75,0xffff0000,v8
v_cvt_pk_bf16_f32 v6,v76,v77
v_lshlrev_b32 v76,16,v6
v_and_b32 v77,0xffff0000,v6
v_cvt_pk_bf16_f32 v8,v78,v79
v_lshlrev_b32 v78,16,v8
v_and_b32 v79,0xffff0000,v8
v_cvt_pk_bf16_f32 v6,v80,v81
v_lshlrev_b32 v80,16,v6
v_and_b32 v81,0xffff0000,v6
v_cvt_pk_bf16_f32 v8,v82,v83
v_lshlrev_b32 v82,16,v8
v_and_b32 v83,0xffff0000,v8
v_cvt_pk_bf16_f32 v6,v84,v85
v_lshlrev_b32 v84,16,v6
v_and_b32 v85,0xffff0000,v6
v_cvt_pk_bf16_f32 v8,v86,v87
v_lshlrev_b32 v86,16,v8
v_and_b32 v87,0xffff0000,v8
v_cvt_pk_bf16_f32 v6,v88,v89
v_lshlrev_b32 v88,16,v6
v_and_b32 v89,0xffff0000,v6
v_cvt_pk_bf16_f32 v8,v90,v91
v_lshlrev_b32 v90,16,v8
v_and_b32 v91,0xffff0000,v8
v_cvt_pk_bf16_f32 v6,v92,v93
v_lshlrev_b32 v92,16,v6
v_and_b32 v93,0xffff0000,v6
v_cvt_pk_bf16_f32 v8,v94,v95
v_lshlrev_b32 v94,16,v8
v_and_b32 v95,0xffff0000,v8
v_cvt_pk_bf16_f32 v6,v96,v97
v_lshlrev_b32 v96,16,v6
v_and_b32 v97,0xffff0000,v6
v_cvt_pk_bf16_f32 v8,v98,v99
v_lshlrev_b32 v98,16,v8
v_and_b32 v99,0xffff0000,v8
v_cvt_pk_bf16_f32 v6,v100,v101
v_lshlrev_b32 v100,16,v6
v_and_b32 v101,0xffff0000,v6
v_cvt_pk_bf16_f32 v8,v102,v103
v_lshlrev_b32 v102,16,v8
v_and_b32 v103,0xffff0000,v8
v_cvt_pk_bf16_f32 v6,v104,v105
v_lshlrev_b32 v104,16,v6
v_and_b32 v105,0xffff0000,v6
v_cvt_pk_bf16_f32 v8,v106,v107
v_lshlrev_b32 v106,16,v8
v_and_b32 v107,0xffff0000,v8
v_cvt_pk_bf16_f32 v6,v108,v109
v_lshlrev_b32 v108,16,v6
v_and_b32 v109,0xffff0000,v6
v_cvt_pk_bf16_f32 v8,v110,v111
v_lshlrev_b32 v110,16,v8
v_and_b32 v111,0xffff0000,v8
v_pk_mul_f32 v[72:73],v[72:73],v[24:25] op_sel:[0,1] op_sel_hi:[1,1]
v_pk_mul_f32 v[74:75],v[74:75],v[24:25] op_sel:[0,1] op_sel_hi:[1,1]
v_pk_mul_f32 v[76:77],v[76:77],v[24:25] op_sel:[0,1] op_sel_hi:[1,1]
v_pk_mul_f32 v[78:79],v[78:79],v[24:25] op_sel:[0,1] op_sel_hi:[1,1]
v_pk_mul_f32 v[80:81],v[80:81],v[24:25] op_sel:[0,1] op_sel_hi:[1,1]
v_pk_mul_f32 v[82:83],v[82:83],v[24:25] op_sel:[0,1] op_sel_hi:[1,1]
v_pk_mul_f32 v[84:85],v[84:85],v[24:25] op_sel:[0,1] op_sel_hi:[1,1]
v_pk_mul_f32 v[86:87],v[86:87],v[24:25] op_sel:[0,1] op_sel_hi:[1,1]
v_pk_mul_f32 v[88:89],v[88:89],v[24:25] op_sel:[0,1] op_sel_hi:[1,1]
v_pk_mul_f32 v[90:91],v[90:91],v[24:25] op_sel:[0,1] op_sel_hi:[1,1]
v_pk_mul_f32 v[92:93],v[92:93],v[24:25] op_sel:[0,1] op_sel_hi:[1,1]
v_pk_mul_f32 v[94:95],v[94:95],v[24:25] op_sel:[0,1] op_sel_hi:[1,1]
v_pk_mul_f32 v[96:97],v[96:97],v[24:25] op_sel:[0,1] op_sel_hi:[1,1]
v_pk_mul_f32 v[98:99],v[98:99],v[24:25] op_sel:[0,1] op_sel_hi:[1,1]
v_pk_mul_f32 v[100:101],v[100:101],v[24:25] op_sel:[0,1] op_sel_hi:[1,1]
v_pk_mul_f32 v[102:103],v[102:103],v[24:25] op_sel:[0,1] op_sel_hi:[1,1]
v_pk_mul_f32 v[104:105],v[104:105],v[24:25] op_sel:[0,1] op_sel_hi:[1,1]
v_pk_mul_f32 v[106:107],v[106:107],v[24:25] op_sel:[0,1] op_sel_hi:[1,1]
v_pk_mul_f32 v[108:109],v[108:109],v[24:25] op_sel:[0,1] op_sel_hi:[1,1]
v_pk_mul_f32 v[110:111],v[110:111],v[24:25] op_sel:[0,1] op_sel_hi:[1,1]
v_cvt_pk_bf16_f32 v112,v72,v73
v_lshlrev_b32 v72,16,v112
v_and_b32 v73,0xffff0000,v112
v_cvt_pk_bf16_f32 v113,v74,v75
v_lshlrev_b32 v74,16,v113
v_and_b32 v75,0xffff0000,v113
v_cvt_pk_bf16_f32 v114,v76,v77
v_lshlrev_b32 v76,16,v114
v_and_b32 v77,0xffff0000,v114
v_cvt_pk_bf16_f32 v115,v78,v79
v_lshlrev_b32 v78,16,v115
v_and_b32 v79,0xffff0000,v115
v_cvt_pk_bf16_f32 v116,v80,v81
v_lshlrev_b32 v80,16,v116
v_and_b32 v81,0xffff0000,v116
v_cvt_pk_bf16_f32 v117,v82,v83
v_lshlrev_b32 v82,16,v117
v_and_b32 v83,0xffff0000,v117
v_cvt_pk_bf16_f32 v118,v84,v85
v_lshlrev_b32 v84,16,v118
v_and_b32 v85,0xffff0000,v118
v_cvt_pk_bf16_f32 v119,v86,v87
v_lshlrev_b32 v86,16,v119
v_and_b32 v87,0xffff0000,v119
v_cvt_pk_bf16_f32 v120,v88,v89
v_lshlrev_b32 v88,16,v120
v_and_b32 v89,0xffff0000,v120
v_cvt_pk_bf16_f32 v121,v90,v91
v_lshlrev_b32 v90,16,v121
v_and_b32 v91,0xffff0000,v121
v_cvt_pk_bf16_f32 v122,v92,v93
v_lshlrev_b32 v92,16,v122
v_and_b32 v93,0xffff0000,v122
v_cvt_pk_bf16_f32 v123,v94,v95
v_lshlrev_b32 v94,16,v123
v_and_b32 v95,0xffff0000,v123
v_cvt_pk_bf16_f32 v124,v96,v97
v_lshlrev_b32 v96,16,v124
v_and_b32 v97,0xffff0000,v124
v_cvt_pk_bf16_f32 v125,v98,v99
v_lshlrev_b32 v98,16,v125
v_and_b32 v99,0xffff0000,v125
v_cvt_pk_bf16_f32 v126,v100,v101
v_lshlrev_b32 v100,16,v126
v_and_b32 v101,0xffff0000,v126
v_cvt_pk_bf16_f32 v127,v102,v103
v_lshlrev_b32 v102,16,v127
v_and_b32 v103,0xffff0000,v127
v_cvt_pk_bf16_f32 v128,v104,v105
v_lshlrev_b32 v104,16,v128
v_and_b32 v105,0xffff0000,v128
v_cvt_pk_bf16_f32 v129,v106,v107
v_lshlrev_b32 v106,16,v129
v_and_b32 v107,0xffff0000,v129
v_cvt_pk_bf16_f32 v130,v108,v109
v_lshlrev_b32 v108,16,v130
v_and_b32 v109,0xffff0000,v130
v_cvt_pk_bf16_f32 v131,v110,v111
v_lshlrev_b32 v110,16,v131
v_and_b32 v111,0xffff0000,v131
s_add_u32 s63,s65,0
v_permlane16_swap_b32 v112,v114
v_permlane16_swap_b32 v113,v115
buffer_store_dwordx4 v[112:115],v132,s[8:11],s63 offen sc1
s_add_u32 s63,s65,8192
v_permlane16_swap_b32 v116,v118
v_permlane16_swap_b32 v117,v119
buffer_store_dwordx4 v[116:119],v132,s[8:11],s63 offen sc1
s_add_u32 s63,s65,16384
v_permlane16_swap_b32 v120,v122
v_permlane16_swap_b32 v121,v123
buffer_store_dwordx4 v[120:123],v132,s[8:11],s63 offen sc1
s_add_u32 s63,s65,24576
v_permlane16_swap_b32 v124,v126
v_permlane16_swap_b32 v125,v127
buffer_store_dwordx4 v[124:127],v132,s[8:11],s63 offen sc1
s_add_u32 s63,s65,32768
v_permlane16_swap_b32 v128,v130
v_permlane16_swap_b32 v129,v131
buffer_store_dwordx4 v[128:131],v132,s[8:11],s63 offen sc1
s_add_u32 s63,s64,0
v_permlane16_swap_b32 v32,v34
v_permlane16_swap_b32 v33,v35
buffer_store_dwordx4 v[32:35],v132,s[8:11],s63 offen sc1
s_add_u32 s63,s64,8192
v_permlane16_swap_b32 v36,v38
v_permlane16_swap_b32 v37,v39
buffer_store_dwordx4 v[36:39],v132,s[8:11],s63 offen sc1
s_add_u32 s63,s64,16384
v_permlane16_swap_b32 v40,v42
v_permlane16_swap_b32 v41,v43
buffer_store_dwordx4 v[40:43],v132,s[8:11],s63 offen sc1
s_add_u32 s63,s64,24576
v_permlane16_swap_b32 v44,v46
v_permlane16_swap_b32 v45,v47
buffer_store_dwordx4 v[44:47],v132,s[8:11],s63 offen sc1
s_add_u32 s63,s64,32768
v_permlane16_swap_b32 v48,v50
v_permlane16_swap_b32 v49,v51
buffer_store_dwordx4 v[48:51],v132,s[8:11],s63 offen sc1
s_lshl_b32 s82,s55,6
s_add_u32 s82,s82,s54
s_lshl_b32 s82,s82,9
s_add_u32 s82,s82,0
s_lshl_b32 s61,s53,2
s_add_u32 s82,s82,s61
s_add_u32 s54,s54,16
s_cmp_ge_u32 s54,64
s_cbranch_scc1 R0_ENDA
s_add_u32 s66,s54,16
s_min_u32 s66,s66,63
s_mul_i32 s62,s66,40960
buffer_load_dwordx2 v[32:33],v133,s[4:7],s62 offen offset:0
buffer_load_dwordx2 v[34:35],v133,s[4:7],s62 offen offset:128
buffer_load_dwordx2 v[36:37],v133,s[4:7],s62 offen offset:256
buffer_load_dwordx2 v[38:39],v133,s[4:7],s62 offen offset:384
buffer_load_dwordx2 v[40:41],v133,s[4:7],s62 offen offset:512
buffer_load_dwordx2 v[42:43],v133,s[4:7],s62 offen offset:640
buffer_load_dwordx2 v[44:45],v133,s[4:7],s62 offen offset:768
buffer_load_dwordx2 v[46:47],v133,s[4:7],s62 offen offset:896
buffer_load_dwordx2 v[48:49],v133,s[4:7],s62 offen offset:1024
buffer_load_dwordx2 v[50:51],v133,s[4:7],s62 offen offset:1152
s_mul_i32 s64,s54,40960
s_add_u32 s64,s64,234749952
s_mul_i32 s65,s54,46080
s_add_u32 s65,s65,206569472
s_waitcnt vmcnt(10)
s_mov_b64 exec,1
buffer_store_dword v5,v1,s[8:11],s82 offen sc1
s_mov_b64 exec,-1
v_lshlrev_b32 v72,16,v52
v_and_b32 v73,0xffff0000,v52
v_lshlrev_b32 v74,16,v53
v_and_b32 v75,0xffff0000,v53
v_lshlrev_b32 v76,16,v54
v_and_b32 v77,0xffff0000,v54
v_lshlrev_b32 v78,16,v55
v_and_b32 v79,0xffff0000,v55
v_lshlrev_b32 v80,16,v56
v_and_b32 v81,0xffff0000,v56
v_lshlrev_b32 v82,16,v57
v_and_b32 v83,0xffff0000,v57
v_lshlrev_b32 v84,16,v58
v_and_b32 v85,0xffff0000,v58
v_lshlrev_b32 v86,16,v59
v_and_b32 v87,0xffff0000,v59
v_lshlrev_b32 v88,16,v60
v_and_b32 v89,0xffff0000,v60
v_lshlrev_b32 v90,16,v61
v_and_b32 v91,0xffff0000,v61
v_lshlrev_b32 v92,16,v62
v_and_b32 v93,0xffff0000,v62
v_lshlrev_b32 v94,16,v63
v_and_b32 v95,0xffff0000,v63
v_lshlrev_b32 v96,16,v64
v_and_b32 v97,0xffff0000,v64
v_lshlrev_b32 v98,16,v65
v_and_b32 v99,0xffff0000,v65
v_lshlrev_b32 v100,16,v66
v_and_b32 v101,0xffff0000,v66
v_lshlrev_b32 v102,16,v67
v_and_b32 v103,0xffff0000,v67
v_lshlrev_b32 v104,16,v68
v_and_b32 v105,0xffff0000,v68
v_lshlrev_b32 v106,16,v69
v_and_b32 v107,0xffff0000,v69
v_lshlrev_b32 v108,16,v70
v_and_b32 v109,0xffff0000,v70
v_lshlrev_b32 v110,16,v71
v_and_b32 v111,0xffff0000,v71
v_pk_add_f32 v[28:29],v[72:73],v[74:75]
v_pk_mul_f32 v[26:27],v[72:73],v[72:73]
v_pk_fma_f32 v[26:27],v[74:75],v[74:75],v[26:27]
v_pk_add_f32 v[28:29],v[28:29],v[76:77]
v_pk_fma_f32 v[26:27],v[76:77],v[76:77],v[26:27]
v_pk_add_f32 v[28:29],v[28:29],v[78:79]
v_pk_fma_f32 v[26:27],v[78:79],v[78:79],v[26:27]
v_pk_add_f32 v[28:29],v[28:29],v[80:81]
v_pk_fma_f32 v[26:27],v[80:81],v[80:81],v[26:27]
v_pk_add_f32 v[28:29],v[28:29],v[82:83]
v_pk_fma_f32 v[26:27],v[82:83],v[82:83],v[26:27]
v_pk_add_f32 v[28:29],v[28:29],v[84:85]
v_pk_fma_f32 v[26:27],v[84:85],v[84:85],v[26:27]
v_pk_add_f32 v[28:29],v[28:29],v[86:87]
v_pk_fma_f32 v[26:27],v[86:87],v[86:87],v[26:27]
v_pk_add_f32 v[28:29],v[28:29],v[88:89]
v_pk_fma_f32 v[26:27],v[88:89],v[88:89],v[26:27]
v_pk_add_f32 v[28:29],v[28:29],v[90:91]
v_pk_fma_f32 v[26:27],v[90:91],v[90:91],v[26:27]
v_pk_add_f32 v[28:29],v[28:29],v[92:93]
v_pk_fma_f32 v[26:27],v[92:93],v[92:93],v[26:27]
v_pk_add_f32 v[28:29],v[28:29],v[94:95]
v_pk_fma_f32 v[26:27],v[94:95],v[94:95],v[26:27]
v_pk_add_f32 v[28:29],v[28:29],v[96:97]
v_pk_fma_f32 v[26:27],v[96:97],v[96:97],v[26:27]
v_pk_add_f32 v[28:29],v[28:29],v[98:99]
v_pk_fma_f32 v[26:27],v[98:99],v[98:99],v[26:27]
v_pk_add_f32 v[28:29],v[28:29],v[100:101]
v_pk_fma_f32 v[26:27],v[100:101],v[100:101],v[26:27]
v_pk_add_f32 v[28:29],v[28:29],v[102:103]
v_pk_fma_f32 v[26:27],v[102:103],v[102:103],v[26:27]
v_pk_add_f32 v[28:29],v[28:29],v[104:105]
v_pk_fma_f32 v[26:27],v[104:105],v[104:105],v[26:27]
v_pk_add_f32 v[28:29],v[28:29],v[106:107]
v_pk_fma_f32 v[26:27],v[106:107],v[106:107],v[26:27]
v_pk_add_f32 v[28:29],v[28:29],v[108:109]
v_pk_fma_f32 v[26:27],v[108:109],v[108:109],v[26:27]
v_pk_add_f32 v[28:29],v[28:29],v[110:111]
v_pk_fma_f32 v[26:27],v[110:111],v[110:111],v[26:27]
v_add_f32 v24,v28,v29
v_add_f32 v25,v26,v27
s_nop 0
v_add_f32_dpp v24,v24,v24 row_ror:4 row_mask:0xf bank_mask:0xf
v_add_f32_dpp v25,v25,v25 row_ror:4 row_mask:0xf bank_mask:0xf
s_nop 0
v_add_f32_dpp v24,v24,v24 row_ror:8 row_mask:0xf bank_mask:0xf
v_add_f32_dpp v25,v25,v25 row_ror:8 row_mask:0xf bank_mask:0xf
v_mov_b32 v26,v24
v_mov_b32 v27,v25
s_nop 0
v_permlane32_swap_b32 v24,v26
v_permlane32_swap_b32 v25,v27
v_add_f32 v24,v24,v26
v_add_f32 v25,v25,v27
v_mov_b32 v26,v24
v_mov_b32 v27,v25
s_nop 0
v_permlane16_swap_b32 v24,v26
v_permlane16_swap_b32 v25,v27
v_add_f32 v24,v24,v26
v_add_f32 v25,v25,v27
v_mul_f32 v24,0x3acccccd,v24
v_mul_f32 v25,0x3acccccd,v25
v_fma_f32 v25,-v24,v24,v25
v_max_f32 v25,0,v25
v_cvt_pk_bf16_f32 v6,v24,v25
v_lshlrev_b32 v24,16,v6
v_and_b32 v25,0xffff0000,v6
v_add_f32 v25,0x3727c5ac,v25
v_cvt_pk_bf16_f32 v6,v25,v25
v_lshlrev_b32 v25,16,v6
v_sqrt_f32 v25,v25
s_nop 0
v_cvt_pk_bf16_f32 v6,v25,v25
v_lshlrev_b32 v25,16,v6
v_rcp_f32 v25,v25
s_nop 0
v_pk_add_f32 v[72:73],v[72:73],v[24:25] op_sel_hi:[1,0] neg_lo:[0,1] neg_hi:[0,1]
v_pk_add_f32 v[74:75],v[74:75],v[24:25] op_sel_hi:[1,0] neg_lo:[0,1] neg_hi:[0,1]
v_pk_add_f32 v[76:77],v[76:77],v[24:25] op_sel_hi:[1,0] neg_lo:[0,1] neg_hi:[0,1]
v_pk_add_f32 v[78:79],v[78:79],v[24:25] op_sel_hi:[1,0] neg_lo:[0,1] neg_hi:[0,1]
v_pk_add_f32 v[80:81],v[80:81],v[24:25] op_sel_hi:[1,0] neg_lo:[0,1] neg_hi:[0,1]
v_pk_add_f32 v[82:83],v[82:83],v[24:25] op_sel_hi:[1,0] neg_lo:[0,1] neg_hi:[0,1]
v_pk_add_f32 v[84:85],v[84:85],v[24:25] op_sel_hi:[1,0] neg_lo:[0,1] neg_hi:[0,1]
v_pk_add_f32 v[86:87],v[86:87],v[24:25] op_sel_hi:[1,0] neg_lo:[0,1] neg_hi:[0,1]
v_pk_add_f32 v[88:89],v[88:89],v[24:25] op_sel_hi:[1,0] neg_lo:[0,1] neg_hi:[0,1]
v_pk_add_f32 v[90:91],v[90:91],v[24:25] op_sel_hi:[1,0] neg_lo:[0,1] neg_hi:[0,1]
v_pk_add_f32 v[92:93],v[92:93],v[24:25] op_sel_hi:[1,0] neg_lo:[0,1] neg_hi:[0,1]
v_pk_add_f32 v[94:95],v[94:95],v[24:25] op_sel_hi:[1,0] neg_lo:[0,1] neg_hi:[0,1]
v_pk_add_f32 v[96:97],v[96:97],v[24:25] op_sel_hi:[1,0] neg_lo:[0,1] neg_hi:[0,1]
v_pk_add_f32 v[98:99],v[98:99],v[24:25] op_sel_hi:[1,0] neg_lo:[0,1] neg_hi:[0,1]
v_pk_add_f32 v[100:101],v[100:101],v[24:25] op_sel_hi:[1,0] neg_lo:[0,1] neg_hi:[0,1]
v_pk_add_f32 v[102:103],v[102:103],v[24:25] op_sel_hi:[1,0] neg_lo:[0,1] neg_hi:[0,1]
v_pk_add_f32 v[104:105],v[104:105],v[24:25] op_sel_hi:[1,0] neg_lo:[0,1] neg_hi:[0,1]
v_pk_add_f32 v[106:107],v[106:107],v[24:25] op_sel_hi:[1,0] neg_lo:[0,1] neg_hi:[0,1]
v_pk_add_f32 v[108:109],v[108:109],v[24:25] op_sel_hi:[1,0] neg_lo:[0,1] neg_hi:[0,1]
v_pk_add_f32 v[110:111],v[110:111],v[24:25] op_sel_hi:[1,0] neg_lo:[0,1] neg_hi:[0,1]
v_cvt_pk_bf16_f32 v6,v72,v73
v_lshlrev_b32 v72,16,v6
v_and_b32 v73,0xffff0000,v6
v_cvt_pk_bf16_f32 v8,v74,v75
v_lshlrev_b32 v74,16,v8
v_and_b32 v75,0xffff0000,v8
v_cvt_pk_bf16_f32 v6,v76,v77
v_lshlrev_b32 v76,16,v6
v_and_b32 v77,0xffff0000,v6
v_cvt_pk_bf16_f32 v8,v78,v79
v_lshlrev_b32 v78,16,v8
v_and_b32 v79,0xffff0000,v8
v_cvt_pk_bf16_f32 v6,v80,v81
v_lshlrev_b32 v80,16,v6
v_and_b32 v81,0xffff0000,v6
v_cvt_pk_bf16_f32 v8,v82,v83
v_lshlrev_b32 v82,16,v8
v_and_b32 v83,0xffff0000,v8
v_cvt_pk_bf16_f32 v6,v84,v85
v_lshlrev_b32 v84,16,v6
v_and_b32 v85,0xffff0000,v6
v_cvt_pk_bf16_f32 v8,v86,v87
v_lshlrev_b32 v86,16,v8
v_and_b32 v87,0xffff0000,v8
v_cvt_pk_bf16_f32 v6,v88,v89
v_lshlrev_b32 v88,16,v6
v_and_b32 v89,0xffff0000,v6
v_cvt_pk_bf16_f32 v8,v90,v91
v_lshlrev_b32 v90,16,v8
v_and_b32 v91,0xffff0000,v8
v_cvt_pk_bf16_f32 v6,v92,v93
v_lshlrev_b32 v92,16,v6
v_and_b32 v93,0xffff0000,v6
v_cvt_pk_bf16_f32 v8,v94,v95
v_lshlrev_b32 v94,16,v8
v_and_b32 v95,0xffff0000,v8
v_cvt_pk_bf16_f32 v6,v96,v97
v_lshlrev_b32 v96,16,v6
v_and_b32 v97,0xffff0000,v6
v_cvt_pk_bf16_f32 v8,v98,v99
v_lshlrev_b32 v98,16,v8
v_and_b32 v99,0xffff0000,v8
v_cvt_pk_bf16_f32 v6,v100,v101
v_lshlrev_b32 v100,16,v6
v_and_b32 v101,0xffff0000,v6
v_cvt_pk_bf16_f32 v8,v102,v103
v_lshlrev_b32 v102,16,v8
v_and_b32 v103,0xffff0000,v8
v_cvt_pk_bf16_f32 v6,v104,v105
v_lshlrev_b32 v104,16,v6
v_and_b32 v105,0xffff0000,v6
v_cvt_pk_bf16_f32 v8,v106,v107
v_lshlrev_b32 v106,16,v8
v_and_b32 v107,0xffff0000,v8
v_cvt_pk_bf16_f32 v6,v108,v109
v_lshlrev_b32 v108,16,v6
v_and_b32 v109,0xffff0000,v6
v_cvt_pk_bf16_f32 v8,v110,v111
v_lshlrev_b32 v110,16,v8
v_and_b32 v111,0xffff0000,v8
v_pk_mul_f32 v[72:73],v[72:73],v[24:25] op_sel:[0,1] op_sel_hi:[1,1]
v_pk_mul_f32 v[74:75],v[74:75],v[24:25] op_sel:[0,1] op_sel_hi:[1,1]
v_pk_mul_f32 v[76:77],v[76:77],v[24:25] op_sel:[0,1] op_sel_hi:[1,1]
v_pk_mul_f32 v[78:79],v[78:79],v[24:25] op_sel:[0,1] op_sel_hi:[1,1]
v_pk_mul_f32 v[80:81],v[80:81],v[24:25] op_sel:[0,1] op_sel_hi:[1,1]
v_pk_mul_f32 v[82:83],v[82:83],v[24:25] op_sel:[0,1] op_sel_hi:[1,1]
v_pk_mul_f32 v[84:85],v[84:85],v[24:25] op_sel:[0,1] op_sel_hi:[1,1]
v_pk_mul_f32 v[86:87],v[86:87],v[24:25] op_sel:[0,1] op_sel_hi:[1,1]
v_pk_mul_f32 v[88:89],v[88:89],v[24:25] op_sel:[0,1] op_sel_hi:[1,1]
v_pk_mul_f32 v[90:91],v[90:91],v[24:25] op_sel:[0,1] op_sel_hi:[1,1]
v_pk_mul_f32 v[92:93],v[92:93],v[24:25] op_sel:[0,1] op_sel_hi:[1,1]
v_pk_mul_f32 v[94:95],v[94:95],v[24:25] op_sel:[0,1] op_sel_hi:[1,1]
v_pk_mul_f32 v[96:97],v[96:97],v[24:25] op_sel:[0,1] op_sel_hi:[1,1]
v_pk_mul_f32 v[98:99],v[98:99],v[24:25] op_sel:[0,1] op_sel_hi:[1,1]
v_pk_mul_f32 v[100:101],v[100:101],v[24:25] op_sel:[0,1] op_sel_hi:[1,1]
v_pk_mul_f32 v[102:103],v[102:103],v[24:25] op_sel:[0,1] op_sel_hi:[1,1]
v_pk_mul_f32 v[104:105],v[104:105],v[24:25] op_sel:[0,1] op_sel_hi:[1,1]
v_pk_mul_f32 v[106:107],v[106:107],v[24:25] op_sel:[0,1] op_sel_hi:[1,1]
v_pk_mul_f32 v[108:109],v[108:109],v[24:25] op_sel:[0,1] op_sel_hi:[1,1]
v_pk_mul_f32 v[110:111],v[110:111],v[24:25] op_sel:[0,1] op_sel_hi:[1,1]
v_cvt_pk_bf16_f32 v112,v72,v73
v_lshlrev_b32 v72,16,v112
v_and_b32 v73,0xffff0000,v112
v_cvt_pk_bf16_f32 v113,v74,v75
v_lshlrev_b32 v74,16,v113
v_and_b32 v75,0xffff0000,v113
v_cvt_pk_bf16_f32 v114,v76,v77
v_lshlrev_b32 v76,16,v114
v_and_b32 v77,0xffff0000,v114
v_cvt_pk_bf16_f32 v115,v78,v79
v_lshlrev_b32 v78,16,v115
v_and_b32 v79,0xffff0000,v115
v_cvt_pk_bf16_f32 v116,v80,v81
v_lshlrev_b32 v80,16,v116
v_and_b32 v81,0xffff0000,v116
v_cvt_pk_bf16_f32 v117,v82,v83
v_lshlrev_b32 v82,16,v117
v_and_b32 v83,0xffff0000,v117
v_cvt_pk_bf16_f32 v118,v84,v85
v_lshlrev_b32 v84,16,v118
v_and_b32 v85,0xffff0000,v118
v_cvt_pk_bf16_f32 v119,v86,v87
v_lshlrev_b32 v86,16,v119
v_and_b32 v87,0xffff0000,v119
v_cvt_pk_bf16_f32 v120,v88,v89
v_lshlrev_b32 v88,16,v120
v_and_b32 v89,0xffff0000,v120
v_cvt_pk_bf16_f32 v121,v90,v91
v_lshlrev_b32 v90,16,v121
v_and_b32 v91,0xffff0000,v121
v_cvt_pk_bf16_f32 v122,v92,v93
v_lshlrev_b32 v92,16,v122
v_and_b32 v93,0xffff0000,v122
v_cvt_pk_bf16_f32 v123,v94,v95
v_lshlrev_b32 v94,16,v123
v_and_b32 v95,0xffff0000,v123
v_cvt_pk_bf16_f32 v124,v96,v97
v_lshlrev_b32 v96,16,v124
v_and_b32 v97,0xffff0000,v124
v_cvt_pk_bf16_f32 v125,v98,v99
v_lshlrev_b32 v98,16,v125
v_and_b32 v99,0xffff0000,v125
v_cvt_pk_bf16_f32 v126,v100,v101
v_lshlrev_b32 v100,16,v126
v_and_b32 v101,0xffff0000,v126
v_cvt_pk_bf16_f32 v127,v102,v103
v_lshlrev_b32 v102,16,v127
v_and_b32 v103,0xffff0000,v127
v_cvt_pk_bf16_f32 v128,v104,v105
v_lshlrev_b32 v104,16,v128
v_and_b32 v105,0xffff0000,v128
v_cvt_pk_bf16_f32 v129,v106,v107
v_lshlrev_b32 v106,16,v129
v_and_b32 v107,0xffff0000,v129
v_cvt_pk_bf16_f32 v130,v108,v109
v_lshlrev_b32 v108,16,v130
v_and_b32 v109,0xffff0000,v130
v_cvt_pk_bf16_f32 v131,v110,v111
v_lshlrev_b32 v110,16,v131
v_and_b32 v111,0xffff0000,v131
s_add_u32 s63,s65,0
v_permlane16_swap_b32 v112,v114
v_permlane16_swap_b32 v113,v115
buffer_store_dwordx4 v[112:115],v132,s[8:11],s63 offen sc1
s_add_u32 s63,s65,8192
v_permlane16_swap_b32 v116,v118
v_permlane16_swap_b32 v117,v119
buffer_store_dwordx4 v[116:119],v132,s[8:11],s63 offen sc1
s_add_u32 s63,s65,16384
v_permlane16_swap_b32 v120,v122
v_permlane16_swap_b32 v121,v123
buffer_store_dwordx4 v[120:123],v132,s[8:11],s63 offen sc1
s_add_u32 s63,s65,24576
v_permlane16_swap_b32 v124,v126
v_permlane16_swap_b32 v125,v127
buffer_store_dwordx4 v[124:127],v132,s[8:11],s63 offen sc1
s_add_u32 s63,s65,32768
v_permlane16_swap_b32 v128,v130
v_permlane16_swap_b32 v129,v131
buffer_store_dwordx4 v[128:131],v132,s[8:11],s63 offen sc1
s_add_u32 s63,s64,0
v_permlane16_swap_b32 v52,v54
v_permlane16_swap_b32 v53,v55
buffer_store_dwordx4 v[52:55],v132,s[8:11],s63 offen sc1
s_add_u32 s63,s64,8192
v_permlane16_swap_b32 v56,v58
v_permlane16_swap_b32 v57,v59
buffer_store_dwordx4 v[56:59],v132,s[8:11],s63 offen sc1
s_add_u32 s63,s64,16384
v_permlane16_swap_b32 v60,v62
v_permlane16_swap_b32 v61,v63
buffer_store_dwordx4 v[60:63],v132,s[8:11],s63 offen sc1
s_add_u32 s63,s64,24576
v_permlane16_swap_b32 v64,v66
v_permlane16_swap_b32 v65,v67
buffer_store_dwordx4 v[64:67],v132,s[8:11],s63 offen sc1
s_add_u32 s63,s64,32768
v_permlane16_swap_b32 v68,v70
v_permlane16_swap_b32 v69,v71
buffer_store_dwordx4 v[68:71],v132,s[8:11],s63 offen sc1
s_lshl_b32 s82,s55,6
s_add_u32 s82,s82,s54
s_lshl_b32 s82,s82,9
s_add_u32 s82,s82,0
s_lshl_b32 s61,s53,2
s_add_u32 s82,s82,s61
s_add_u32 s54,s54,16
s_cmp_lt_u32 s54,64
s_cbranch_scc1 R0_LOOPA
R0_ENDA:
s_waitcnt vmcnt(0)
s_mov_b64 exec,1
buffer_store_dword v5,v1,s[8:11],s82 offen sc1
s_mov_b64 exec,-1
s_mov_b32 s52,s86
s_mul_i32 s60,s86,196608
s_add_u32 s69,s69,s60
s_mul_i32 s60,s86,1024
s_add_u32 s70,s70,s60
v_mov_b32 v231,0
s_mov_b32 s83,s100
s_nop 0
ATT_LOOP:
s_lshl_b32 s67,s51,6
s_add_u32 s67,s67,s52
s_lshl_b32 s67,s67,9
s_add_u32 s67,s67,65536
s_mul_i32 s66,s52,393216
s_add_u32 s66,s66,s71
v_cmp_eq_u32 vcc,0,v231
s_nop 0
s_cbranch_vccz ATT_RDY
fb_261:
buffer_load_dword v3,v2,s[8:11],s67 offen sc1
s_waitcnt vmcnt(0)
v_cmp_eq_u32 vcc,0,v3
s_nop 0
s_cbranch_vccz ok_262
s_sleep 20
s_sub_u32 s47,s47,1
s_cbranch_scc1 ABORT
s_branch fb_261
ok_262:
ATT_RDY:
s_add_u32 s63,s66,124780544
buffer_load_dwordx4 v[16:19],v1,s[8:11],s63 offen sc1
buffer_load_dwordx4 v[20:23],v1,s[8:11],s63 offen offset:1024 sc1
buffer_load_dwordx4 v[24:27],v1,s[8:11],s63 offen offset:2048 sc1
buffer_load_dwordx4 v[28:31],v1,s[8:11],s63 offen offset:3072 sc1
s_add_u32 s63,s66,124784640
buffer_load_dwordx4 v[32:35],v1,s[8:11],s63 offen sc1
buffer_load_dwordx4 v[36:39],v1,s[8:11],s63 offen offset:1024 sc1
buffer_load_dwordx4 v[40:43],v1,s[8:11],s63 offen offset:2048 sc1
buffer_load_dwordx4 v[44:47],v1,s[8:11],s63 offen offset:3072 sc1
s_add_u32 s63,s66,124788736
buffer_load_dwordx4 v[48:51],v1,s[8:11],s63 offen sc1
buffer_load_dwordx4 v[52:55],v1,s[8:11],s63 offen offset:1024 sc1
buffer_load_dwordx4 v[56:59],v1,s[8:11],s63 offen offset:2048 sc1
buffer_load_dwordx4 v[60:63],v1,s[8:11],s63 offen offset:3072 sc1
s_add_u32 s63,s66,74448896
buffer_load_dwordx4 v[64:67],v1,s[8:11],s63 offen sc1
buffer_load_dwordx4 v[68:71],v1,s[8:11],s63 offen offset:1024 sc1
buffer_load_dwordx4 v[72:75],v1,s[8:11],s63 offen offset:2048 sc1
buffer_load_dwordx4 v[76:79],v1,s[8:11],s63 offen offset:3072 sc1
s_add_u32 s63,s66,74452992
buffer_load_dwordx4 v[80:83],v1,s[8:11],s63 offen sc1
buffer_load_dwordx4 v[84:87],v1,s[8:11],s63 offen offset:1024 sc1
buffer_load_dwordx4 v[88:91],v1,s[8:11],s63 offen offset:2048 sc1
buffer_load_dwordx4 v[92:95],v1,s[8:11],s63 offen offset:3072 sc1
s_add_u32 s63,s66,74457088
buffer_load_dwordx4 v[96:99],v1,s[8:11],s63 offen sc1
buffer_load_dwordx4 v[100:103],v1,s[8:11],s63 offen offset:1024 sc1
buffer_load_dwordx4 v[104:107],v1,s[8:11],s63 offen offset:2048 sc1
buffer_load_dwordx4 v[108:111],v1,s[8:11],s63 offen offset:3072 sc1
s_add_u32 s63,s66,99614720
buffer_load_dwordx4 v[112:115],v1,s[8:11],s63 offen sc1
buffer_load_dwordx4 v[116:119],v1,s[8:11],s63 offen offset:1024 sc1
buffer_load_dwordx4 v[120:123],v1,s[8:11],s63 offen offset:2048 sc1
buffer_load_dwordx4 v[124:127],v1,s[8:11],s63 offen offset:3072 sc1
s_add_u32 s63,s66,99618816
buffer_load_dwordx4 v[128:131],v1,s[8:11],s63 offen sc1
buffer_load_dwordx4 v[132:135],v1,s[8:11],s63 offen offset:1024 sc1
buffer_load_dwordx4 v[136:139],v1,s[8:11],s63 offen offset:2048 sc1
buffer_load_dwordx4 v[140:143],v1,s[8:11],s63 offen offset:3072 sc1
s_add_u32 s63,s66,99622912
buffer_load_dwordx4 v[144:147],v1,s[8:11],s63 offen sc1
buffer_load_dwordx4 v[148:151],v1,s[8:11],s63 offen offset:1024 sc1
buffer_load_dwordx4 v[152:155],v1,s[8:11],s63 offen offset:2048 sc1
buffer_load_dwordx4 v[156:159],v1,s[8:11],s63 offen offset:3072 sc1
v_lshlrev_b32 v232,7,v0
s_add_u32 s63,s66,149946368
buffer_load_dword v233,v232,s[8:11],s63 offen sc1
s_add_u32 s63,s66,149950464
buffer_load_dword v233,v232,s[8:11],s63 offen sc1
s_waitcnt vmcnt(14)
v_mfma_f32_16x16x32_bf16 v[184:187],v[64:67],v[16:19],0
v_mfma_f32_16x16x32_bf16 v[188:191],v[64:67],v[20:23],0
v_mfma_f32_16x16x32_bf16 v[192:195],v[68:71],v[20:23],0
v_mfma_f32_16x16x32_bf16 v[184:187],v[72:75],v[24:27],v[184:187]
v_mfma_f32_16x16x32_bf16 v[188:191],v[72:75],v[28:31],v[188:191]
v_mfma_f32_16x16x32_bf16 v[192:195],v[76:79],v[28:31],v[192:195]
v_mfma_f32_16x16x32_bf16 v[184:187],v[80:83],v[32:35],v[184:187]
v_mfma_f32_16x16x32_bf16 v[188:191],v[80:83],v[36:39],v[188:191]
v_mfma_f32_16x16x32_bf16 v[192:195],v[84:87],v[36:39],v[192:195]
v_mfma_f32_16x16x32_bf16 v[184:187],v[88:91],v[40:43],v[184:187]
v_mfma_f32_16x16x32_bf16 v[188:191],v[88:91],v[44:47],v[188:191]
v_mfma_f32_16x16x32_bf16 v[192:195],v[92:95],v[44:47],v[192:195]
v_mfma_f32_16x16x32_bf16 v[184:187],v[96:99],v[48:51],v[184:187]
v_mfma_f32_16x16x32_bf16 v[188:191],v[96:99],v[52:55],v[188:191]
v_mfma_f32_16x16x32_bf16 v[192:195],v[100:103],v[52:55],v[192:195]
v_mfma_f32_16x16x32_bf16 v[184:187],v[104:107],v[56:59],v[184:187]
v_mfma_f32_16x16x32_bf16 v[188:191],v[104:107],v[60:63],v[188:191]
v_mfma_f32_16x16x32_bf16 v[192:195],v[108:111],v[60:63],v[192:195]
s_nop 5
v_cvt_pk_bf16_f32 v6,v184,v185
v_lshlrev_b32 v184,16,v6
v_and_b32 v185,0xffff0000,v6
v_cvt_pk_bf16_f32 v6,v186,v187
v_lshlrev_b32 v186,16,v6
v_and_b32 v187,0xffff0000,v6
v_cvt_pk_bf16_f32 v6,v188,v189
v_lshlrev_b32 v188,16,v6
v_and_b32 v189,0xffff0000,v6
v_cvt_pk_bf16_f32 v6,v190,v191
v_lshlrev_b32 v190,16,v6
v_and_b32 v191,0xffff0000,v6
v_cvt_pk_bf16_f32 v6,v192,v193
v_lshlrev_b32 v192,16,v6
v_and_b32 v193,0xffff0000,v6
v_cvt_pk_bf16_f32 v6,v194,v195
v_lshlrev_b32 v194,16,v6
v_and_b32 v195,0xffff0000,v6
v_mul_f32 v184,s84,v184
v_mul_f32 v185,s84,v185
v_mul_f32 v186,s84,v186
v_mul_f32 v187,s84,v187
v_mul_f32 v188,s84,v188
v_mul_f32 v189,s84,v189
v_mul_f32 v190,s84,v190
v_mul_f32 v191,s84,v191
v_mul_f32 v192,s84,v192
v_mul_f32 v193,s84,v193
v_mul_f32 v194,s84,v194
v_mul_f32 v195,s84,v195
v_cvt_pk_bf16_f32 v6,v184,v185
v_lshlrev_b32 v184,16,v6
v_and_b32 v185,0xffff0000,v6
v_cvt_pk_bf16_f32 v6,v186,v187
v_lshlrev_b32 v186,16,v6
v_and_b32 v187,0xffff0000,v6
v_cvt_pk_bf16_f32 v6,v188,v189
v_lshlrev_b32 v188,16,v6
v_and_b32 v189,0xffff0000,v6
v_cvt_pk_bf16_f32 v6,v190,v191
v_lshlrev_b32 v190,16,v6
v_and_b32 v191,0xffff0000,v6
v_cvt_pk_bf16_f32 v6,v192,v193
v_lshlrev_b32 v192,16,v6
v_and_b32 v193,0xffff0000,v6
v_cvt_pk_bf16_f32 v6,v194,v195
v_lshlrev_b32 v194,16,v6
v_and_b32 v195,0xffff0000,v6
v_cndmask_b32 v184,v230,v184,s[72:73]
v_cndmask_b32 v185,v230,v185,s[74:75]
v_cndmask_b32 v186,v230,v186,s[76:77]
v_cndmask_b32 v187,v230,v187,s[78:79]
v_cndmask_b32 v192,v230,v192,s[72:73]
v_cndmask_b32 v193,v230,v193,s[74:75]
v_cndmask_b32 v194,v230,v194,s[76:77]
v_cndmask_b32 v195,v230,v195,s[78:79]
s_nop 1
fb_263:
buffer_load_dword v3,v228,s[8:11],s70 offen sc1
s_waitcnt vmcnt(0)
v_cmp_eq_u32 vcc,0,v3
s_nop 0
s_cbranch_vccz ok_264
s_sleep 10
s_sub_u32 s47,s47,1
s_cbranch_scc1 ABORT
s_branch fb_263
ok_264:
buffer_load_dwordx4 v[160:163],v1,s[8:11],s69 offen sc1
buffer_load_dwordx4 v[164:167],v1,s[8:11],s69 offen offset:1024 sc1
buffer_load_dwordx4 v[168:171],v1,s[8:11],s69 offen offset:2048 sc1
s_add_u32 s63,s69,3072
buffer_load_dwordx4 v[172:175],v1,s[8:11],s63 offen sc1
buffer_load_dwordx4 v[176:179],v1,s[8:11],s63 offen offset:1024 sc1
buffer_load_dwordx4 v[180:183],v1,s[8:11],s63 offen offset:2048 sc1
buffer_load_dword v231,v2,s[8:11],s67 offen offset:1024 sc1
s_waitcnt vmcnt(4)
v_mfma_f32_16x16x32_bf16 v[196:199],v[160:163],v[16:19],0
v_mfma_f32_16x16x32_bf16 v[200:203],v[160:163],v[24:27],0
v_mfma_f32_16x16x32_bf16 v[204:207],v[160:163],v[20:23],0
v_mfma_f32_16x16x32_bf16 v[208:211],v[160:163],v[28:31],0
v_mfma_f32_16x16x32_bf16 v[196:199],v[164:167],v[32:35],v[196:199]
v_mfma_f32_16x16x32_bf16 v[200:203],v[164:167],v[40:43],v[200:203]
v_mfma_f32_16x16x32_bf16 v[204:207],v[164:167],v[36:39],v[204:207]
v_mfma_f32_16x16x32_bf16 v[208:211],v[164:167],v[44:47],v[208:211]
v_mfma_f32_16x16x32_bf16 v[196:199],v[168:171],v[48:51],v[196:199]
v_mfma_f32_16x16x32_bf16 v[200:203],v[168:171],v[56:59],v[200:203]
v_mfma_f32_16x16x32_bf16 v[204:207],v[168:171],v[52:55],v[204:207]
v_mfma_f32_16x16x32_bf16 v[208:211],v[168:171],v[60:63],v[208:211]
s_nop 4
v_permlane32_swap_b32 v196,v197
v_permlane32_swap_b32 v200,v201
v_permlane32_swap_b32 v198,v199
v_permlane32_swap_b32 v202,v203
v_add_f32 v196,v196,v201
v_add_f32 v197,v198,v203
v_permlane32_swap_b32 v204,v205
v_permlane32_swap_b32 v208,v209
v_permlane32_swap_b32 v206,v207
v_permlane32_swap_b32 v210,v211
v_add_f32 v204,v204,v209
v_add_f32 v205,v206,v211
v_cvt_pk_bf16_f32 v6,v196,v197
v_lshlrev_b32 v196,16,v6
v_and_b32 v197,0xffff0000,v6
v_cvt_pk_bf16_f32 v6,v204,v205
v_lshlrev_b32 v204,16,v6
v_and_b32 v205,0xffff0000,v6
v_mul_f32 v196,s84,v196
v_mul_f32 v197,s84,v197
v_mul_f32 v204,s84,v204
v_mul_f32 v205,s84,v205
v_cvt_pk_bf16_f32 v6,v196,v197
v_lshlrev_b32 v196,16,v6
v_and_b32 v197,0xffff0000,v6
v_cvt_pk_bf16_f32 v6,v204,v205
v_lshlrev_b32 v204,16,v6
v_and_b32 v205,0xffff0000,v6
v_max3_f32 v6,v184,v185,v186
v_max3_f32 v6,v6,v187,v196
v_max_f32 v6,v6,v197
v_mov_b32 v7,v6
s_nop 1
v_permlane32_swap_b32 v6,v7
v_max_f32 v6,v6,v7
v_mov_b32 v7,v6
s_nop 1
v_permlane16_swap_b32 v6,v7
v_max_f32 v6,v6,v7
v_mul_f32 v6,s85,v6
v_fma_f32 v184,v184,s85,-v6
v_fma_f32 v185,v185,s85,-v6
v_fma_f32 v186,v186,s85,-v6
v_fma_f32 v187,v187,s85,-v6
v_fma_f32 v196,v196,s85,-v6
v_fma_f32 v197,v197,s85,-v6
v_exp_f32 v184,v184
v_exp_f32 v185,v185
v_exp_f32 v186,v186
v_exp_f32 v187,v187
v_exp_f32 v196,v196
v_exp_f32 v197,v197
v_add_f32 v6,v184,v185
v_add_f32 v6,v6,v186
v_add_f32 v6,v6,v187
v_add_f32 v6,v6,v196
v_add_f32 v6,v6,v197
v_mov_b32 v7,v6
s_nop 1
v_permlane32_swap_b32 v6,v7
v_add_f32 v6,v6,v7
v_mov_b32 v7,v6
s_nop 1
v_permlane16_swap_b32 v6,v7
v_add_f32 v6,v6,v7
v_rcp_f32 v6,v6
s_nop 0
v_mul_f32 v184,v184,v6
v_mul_f32 v185,v185,v6
v_mul_f32 v186,v186,v6
v_mul_f32 v187,v187,v6
v_mul_f32 v196,v196,v6
v_mul_f32 v197,v197,v6
v_cvt_pk_bf16_f32 v212,v184,v185
v_cvt_pk_bf16_f32 v213,v186,v187
v_mov_b32 v214,0
v_mov_b32 v215,0
v_cvt_pk_bf16_f32 v216,v196,v197
v_mov_b32 v217,0
v_mov_b32 v218,0
v_cvt_pk_bf16_f32 v219,v196,v197
v_max3_f32 v8,v188,v189,v190
v_max3_f32 v8,v8,v191,v192
v_max3_f32 v8,v8,v193,v194
v_max3_f32 v8,v8,v195,v204
v_max_f32 v8,v8,v205
v_mov_b32 v9,v8
s_nop 1
v_permlane32_swap_b32 v8,v9
v_max_f32 v8,v8,v9
v_mov_b32 v9,v8
s_nop 1
v_permlane16_swap_b32 v8,v9
v_max_f32 v8,v8,v9
v_mul_f32 v8,s85,v8
v_fma_f32 v188,v188,s85,-v8
v_fma_f32 v189,v189,s85,-v8
v_fma_f32 v190,v190,s85,-v8
v_fma_f32 v191,v191,s85,-v8
v_fma_f32 v192,v192,s85,-v8
v_fma_f32 v193,v193,s85,-v8
v_fma_f32 v194,v194,s85,-v8
v_fma_f32 v195,v195,s85,-v8
v_fma_f32 v204,v204,s85,-v8
v_fma_f32 v205,v205,s85,-v8
v_exp_f32 v188,v188
v_exp_f32 v189,v189
v_exp_f32 v190,v190
v_exp_f32 v191,v191
v_exp_f32 v192,v192
v_exp_f32 v193,v193
v_exp_f32 v194,v194
v_exp_f32 v195,v195
v_exp_f32 v204,v204
v_exp_f32 v205,v205
v_add_f32 v8,v188,v189
v_add_f32 v8,v8,v190
v_add_f32 v8,v8,v191
v_add_f32 v8,v8,v192
v_add_f32 v8,v8,v193
v_add_f32 v8,v8,v194
v_add_f32 v8,v8,v195
v_add_f32 v8,v8,v204
v_add_f32 v8,v8,v205
v_mov_b32 v9,v8
s_nop 1
v_permlane32_swap_b32 v8,v9
v_add_f32 v8,v8,v9
v_mov_b32 v9,v8
s_nop 1
v_permlane16_swap_b32 v8,v9
v_add_f32 v8,v8,v9
v_rcp_f32 v8,v8
s_nop 0
v_mul_f32 v188,v188,v8
v_mul_f32 v189,v189,v8
v_mul_f32 v190,v190,v8
v_mul_f32 v191,v191,v8
v_mul_f32 v192,v192,v8
v_mul_f32 v193,v193,v8
v_mul_f32 v194,v194,v8
v_mul_f32 v195,v195,v8
v_mul_f32 v204,v204,v8
v_mul_f32 v205,v205,v8
v_cvt_pk_bf16_f32 v220,v188,v189
v_cvt_pk_bf16_f32 v221,v190,v191
v_cvt_pk_bf16_f32 v222,v192,v193
v_cvt_pk_bf16_f32 v223,v194,v195
v_cvt_pk_bf16_f32 v224,v204,v205
v_mov_b32 v225,0
v_mov_b32 v226,0
v_cvt_pk_bf16_f32 v227,v204,v205
s_waitcnt vmcnt(1)
s_add_u32 s66,s66,149946368
v_mfma_f32_16x16x32_bf16 v[16:19],v[112:115],v[212:215],0
v_mfma_f32_16x16x32_bf16 v[20:23],v[116:119],v[212:215],0
v_mfma_f32_16x16x32_bf16 v[24:27],v[120:123],v[212:215],0
v_mfma_f32_16x16x32_bf16 v[28:31],v[124:127],v[212:215],0
v_mfma_f32_16x16x32_bf16 v[32:35],v[128:131],v[212:215],0
v_mfma_f32_16x16x32_bf16 v[36:39],v[132:135],v[212:215],0
v_mfma_f32_16x16x32_bf16 v[40:43],v[136:139],v[212:215],0
v_mfma_f32_16x16x32_bf16 v[44:47],v[140:143],v[212:215],0
v_mfma_f32_16x16x32_bf16 v[48:51],v[144:147],v[212:215],0
v_mfma_f32_16x16x32_bf16 v[52:55],v[148:151],v[212:215],0
v_mfma_f32_16x16x32_bf16 v[56:59],v[152:155],v[212:215],0
v_mfma_f32_16x16x32_bf16 v[60:63],v[156:159],v[212:215],0
v_mfma_f32_16x16x16_bf16 v[16:19],v[172:173],v[216:217],v[16:19]
v_mfma_f32_16x16x16_bf16 v[20:23],v[172:173],v[218:219],v[20:23]
v_mfma_f32_16x16x16_bf16 v[24:27],v[174:175],v[216:217],v[24:27]
v_mfma_f32_16x16x16_bf16 v[28:31],v[174:175],v[218:219],v[28:31]
v_mfma_f32_16x16x16_bf16 v[32:35],v[176:177],v[216:217],v[32:35]
v_mfma_f32_16x16x16_bf16 v[36:39],v[176:177],v[218:219],v[36:39]
v_mfma_f32_16x16x16_bf16 v[40:43],v[178:179],v[216:217],v[40:43]
v_mfma_f32_16x16x16_bf16 v[44:47],v[178:179],v[218:219],v[44:47]
v_mfma_f32_16x16x16_bf16 v[48:51],v[180:181],v[216:217],v[48:51]
v_mfma_f32_16x16x16_bf16 v[52:55],v[180:181],v[218:219],v[52:55]
v_mfma_f32_16x16x16_bf16 v[56:59],v[182:183],v[216:217],v[56:59]
v_mfma_f32_16x16x16_bf16 v[60:63],v[182:183],v[218:219],v[60:63]
v_mfma_f32_16x16x32_bf16 v[64:67],v[112:115],v[220:223],0
v_mfma_f32_16x16x32_bf16 v[68:71],v[116:119],v[220:223],0
v_mfma_f32_16x16x32_bf16 v[72:75],v[120:123],v[220:223],0
v_mfma_f32_16x16x32_bf16 v[76:79],v[124:127],v[220:223],0
v_mfma_f32_16x16x32_bf16 v[80:83],v[128:131],v[220:223],0
v_mfma_f32_16x16x32_bf16 v[84:87],v[132:135],v[220:223],0
v_mfma_f32_16x16x32_bf16 v[88:91],v[136:139],v[220:223],0
v_mfma_f32_16x16x32_bf16 v[92:95],v[140:143],v[220:223],0
v_mfma_f32_16x16x32_bf16 v[96:99],v[144:147],v[220:223],0
v_mfma_f32_16x16x32_bf16 v[100:103],v[148:151],v[220:223],0
v_mfma_f32_16x16x32_bf16 v[104:107],v[152:155],v[220:223],0
v_mfma_f32_16x16x32_bf16 v[108:111],v[156:159],v[220:223],0
v_mfma_f32_16x16x16_bf16 v[64:67],v[172:173],v[224:225],v[64:67]
v_mfma_f32_16x16x16_bf16 v[68:71],v[172:173],v[226:227],v[68:71]
v_mfma_f32_16x16x16_bf16 v[72:75],v[174:175],v[224:225],v[72:75]
v_mfma_f32_16x16x16_bf16 v[76:79],v[174:175],v[226:227],v[76:79]
v_mfma_f32_16x16x16_bf16 v[80:83],v[176:177],v[224:225],v[80:83]
v_mfma_f32_16x16x16_bf16 v[84:87],v[176:177],v[226:227],v[84:87]
v_mfma_f32_16x16x16_bf16 v[88:91],v[178:179],v[224:225],v[88:91]
v_mfma_f32_16x16x16_bf16 v[92:95],v[178:179],v[226:227],v[92:95]
v_mfma_f32_16x16x16_bf16 v[96:99],v[180:181],v[224:225],v[96:99]
v_mfma_f32_16x16x16_bf16 v[100:103],v[180:181],v[226:227],v[100:103]
v_mfma_f32_16x16x16_bf16 v[104:107],v[182:183],v[224:225],v[104:107]
v_mfma_f32_16x16x16_bf16 v[108:111],v[182:183],v[226:227],v[108:111]
s_cmp_lg_u32 s49,0
s_nop 5
s_cbranch_scc1 ATT_OS
v_cvt_pk_bf16_f32 v232,v16,v17
v_cvt_pk_bf16_f32 v233,v18,v19
v_cvt_pk_bf16_f32 v234,v20,v21
v_cvt_pk_bf16_f32 v235,v22,v23
s_add_u32 s63,s66,0
buffer_store_dwordx4 v[232:235],v1,s[8:11],s63 offen offset:0
v_cvt_pk_bf16_f32 v236,v24,v25
v_cvt_pk_bf16_f32 v237,v26,v27
v_cvt_pk_bf16_f32 v238,v28,v29
v_cvt_pk_bf16_f32 v239,v30,v31
buffer_store_dwordx4 v[236:239],v1,s[8:11],s63 offen offset:2048
v_cvt_pk_bf16_f32 v232,v32,v33
v_cvt_pk_bf16_f32 v233,v34,v35
v_cvt_pk_bf16_f32 v234,v36,v37
v_cvt_pk_bf16_f32 v235,v38,v39
s_add_u32 s63,s66,4096
buffer_store_dwordx4 v[232:235],v1,s[8:11],s63 offen offset:0
v_cvt_pk_bf16_f32 v236,v40,v41
v_cvt_pk_bf16_f32 v237,v42,v43
v_cvt_pk_bf16_f32 v238,v44,v45
v_cvt_pk_bf16_f32 v239,v46,v47
buffer_store_dwordx4 v[236:239],v1,s[8:11],s63 offen offset:2048
v_cvt_pk_bf16_f32 v232,v48,v49
v_cvt_pk_bf16_f32 v233,v50,v51
v_cvt_pk_bf16_f32 v234,v52,v53
v_cvt_pk_bf16_f32 v235,v54,v55
s_add_u32 s63,s66,8192
buffer_store_dwordx4 v[232:235],v1,s[8:11],s63 offen offset:0
v_cvt_pk_bf16_f32 v236,v56,v57
v_cvt_pk_bf16_f32 v237,v58,v59
v_cvt_pk_bf16_f32 v238,v60,v61
v_cvt_pk_bf16_f32 v239,v62,v63
buffer_store_dwordx4 v[236:239],v1,s[8:11],s63 offen offset:2048
v_cvt_pk_bf16_f32 v232,v64,v65
v_cvt_pk_bf16_f32 v233,v66,v67
v_cvt_pk_bf16_f32 v234,v68,v69
v_cvt_pk_bf16_f32 v235,v70,v71
s_add_u32 s63,s66,1024
buffer_store_dwordx4 v[232:235],v1,s[8:11],s63 offen offset:0
v_cvt_pk_bf16_f32 v236,v72,v73
v_cvt_pk_bf16_f32 v237,v74,v75
v_cvt_pk_bf16_f32 v238,v76,v77
v_cvt_pk_bf16_f32 v239,v78,v79
buffer_store_dwordx4 v[236:239],v1,s[8:11],s63 offen offset:2048
v_cvt_pk_bf16_f32 v232,v80,v81
v_cvt_pk_bf16_f32 v233,v82,v83
v_cvt_pk_bf16_f32 v234,v84,v85
v_cvt_pk_bf16_f32 v235,v86,v87
s_add_u32 s63,s66,5120
buffer_store_dwordx4 v[232:235],v1,s[8:11],s63 offen offset:0
v_cvt_pk_bf16_f32 v236,v88,v89
v_cvt_pk_bf16_f32 v237,v90,v91
v_cvt_pk_bf16_f32 v238,v92,v93
v_cvt_pk_bf16_f32 v239,v94,v95
buffer_store_dwordx4 v[236:239],v1,s[8:11],s63 offen offset:2048
v_cvt_pk_bf16_f32 v232,v96,v97
v_cvt_pk_bf16_f32 v233,v98,v99
v_cvt_pk_bf16_f32 v234,v100,v101
v_cvt_pk_bf16_f32 v235,v102,v103
s_add_u32 s63,s66,9216
buffer_store_dwordx4 v[232:235],v1,s[8:11],s63 offen offset:0
v_cvt_pk_bf16_f32 v236,v104,v105
v_cvt_pk_bf16_f32 v237,v106,v107
v_cvt_pk_bf16_f32 v238,v108,v109
v_cvt_pk_bf16_f32 v239,v110,v111
buffer_store_dwordx4 v[236:239],v1,s[8:11],s63 offen offset:2048
s_lshl_b32 s60,s51,6
s_add_u32 s60,s60,s52
s_lshl_b32 s60,s60,9
s_add_u32 s60,s60,262144
s_lshl_b32 s61,s87,2
s_add_u32 s60,s60,s61
s_waitcnt vmcnt(0)
s_mov_b64 exec,1
buffer_store_dword v5,v1,s[8:11],s60 offen
s_mov_b64 exec,-1
s_branch ATT_OJ
ATT_OS:
v_cvt_pk_bf16_f32 v232,v16,v17
v_cvt_pk_bf16_f32 v233,v18,v19
v_cvt_pk_bf16_f32 v234,v20,v21
v_cvt_pk_bf16_f32 v235,v22,v23
s_add_u32 s63,s66,0
buffer_store_dwordx4 v[232:235],v1,s[8:11],s63 offen sc1
v_cvt_pk_bf16_f32 v236,v24,v25
v_cvt_pk_bf16_f32 v237,v26,v27
v_cvt_pk_bf16_f32 v238,v28,v29
v_cvt_pk_bf16_f32 v239,v30,v31
buffer_store_dwordx4 v[236:239],v1,s[8:11],s63 offen offset:2048 sc1
v_cvt_pk_bf16_f32 v232,v32,v33
v_cvt_pk_bf16_f32 v233,v34,v35
v_cvt_pk_bf16_f32 v234,v36,v37
v_cvt_pk_bf16_f32 v235,v38,v39
s_add_u32 s63,s66,4096
buffer_store_dwordx4 v[232:235],v1,s[8:11],s63 offen sc1
v_cvt_pk_bf16_f32 v236,v40,v41
v_cvt_pk_bf16_f32 v237,v42,v43
v_cvt_pk_bf16_f32 v238,v44,v45
v_cvt_pk_bf16_f32 v239,v46,v47
buffer_store_dwordx4 v[236:239],v1,s[8:11],s63 offen offset:2048 sc1
v_cvt_pk_bf16_f32 v232,v48,v49
v_cvt_pk_bf16_f32 v233,v50,v51
v_cvt_pk_bf16_f32 v234,v52,v53
v_cvt_pk_bf16_f32 v235,v54,v55
s_add_u32 s63,s66,8192
buffer_store_dwordx4 v[232:235],v1,s[8:11],s63 offen sc1
v_cvt_pk_bf16_f32 v236,v56,v57
v_cvt_pk_bf16_f32 v237,v58,v59
v_cvt_pk_bf16_f32 v238,v60,v61
v_cvt_pk_bf16_f32 v239,v62,v63
buffer_store_dwordx4 v[236:239],v1,s[8:11],s63 offen offset:2048 sc1
v_cvt_pk_bf16_f32 v232,v64,v65
v_cvt_pk_bf16_f32 v233,v66,v67
v_cvt_pk_bf16_f32 v234,v68,v69
v_cvt_pk_bf16_f32 v235,v70,v71
s_add_u32 s63,s66,1024
buffer_store_dwordx4 v[232:235],v1,s[8:11],s63 offen sc1
v_cvt_pk_bf16_f32 v236,v72,v73
v_cvt_pk_bf16_f32 v237,v74,v75
v_cvt_pk_bf16_f32 v238,v76,v77
v_cvt_pk_bf16_f32 v239,v78,v79
buffer_store_dwordx4 v[236:239],v1,s[8:11],s63 offen offset:2048 sc1
v_cvt_pk_bf16_f32 v232,v80,v81
v_cvt_pk_bf16_f32 v233,v82,v83
v_cvt_pk_bf16_f32 v234,v84,v85
v_cvt_pk_bf16_f32 v235,v86,v87
s_add_u32 s63,s66,5120
buffer_store_dwordx4 v[232:235],v1,s[8:11],s63 offen sc1
v_cvt_pk_bf16_f32 v236,v88,v89
v_cvt_pk_bf16_f32 v237,v90,v91
v_cvt_pk_bf16_f32 v238,v92,v93
v_cvt_pk_bf16_f32 v239,v94,v95
buffer_store_dwordx4 v[236:239],v1,s[8:11],s63 offen offset:2048 sc1
v_cvt_pk_bf16_f32 v232,v96,v97
v_cvt_pk_bf16_f32 v233,v98,v99
v_cvt_pk_bf16_f32 v234,v100,v101
v_cvt_pk_bf16_f32 v235,v102,v103
s_add_u32 s63,s66,9216
buffer_store_dwordx4 v[232:235],v1,s[8:11],s63 offen sc1
v_cvt_pk_bf16_f32 v236,v104,v105
v_cvt_pk_bf16_f32 v237,v106,v107
v_cvt_pk_bf16_f32 v238,v108,v109
v_cvt_pk_bf16_f32 v239,v110,v111
buffer_store_dwordx4 v[236:239],v1,s[8:11],s63 offen offset:2048 sc1
s_lshl_b32 s60,s51,6
s_add_u32 s60,s60,s52
s_lshl_b32 s60,s60,9
s_add_u32 s60,s60,262144
s_lshl_b32 s61,s87,2
s_add_u32 s60,s60,s61
s_waitcnt vmcnt(0)
s_mov_b64 exec,1
buffer_store_dword v5,v1,s[8:11],s60 offen sc1
s_mov_b64 exec,-1
ATT_OJ:
s_add_u32 s69,s69,393216
s_add_u32 s70,s70,2048
s_add_u32 s52,s52,2
s_cmp_lt_u32 s52,64
s_cbranch_scc1 ATT_LOOP
s_endpgm
ROLE_WO:
v_lshlrev_b32 v1,4,v0
v_mov_b32 v5,1
s_lshl_b32 s56,s48,2
s_add_u32 s56,s56,s46
v_bfe_u32 v6,v0,2,2
v_lshrrev_b32 v7,4,v0
v_add_u32 v7,v6,v7
v_and_b32 v7,3,v7
v_and_b32 v15,3,v0
v_lshlrev_b32 v15,4,v15
v_lshl_add_u32 v15,v7,6,v15
v_lshl_add_u32 v15,v6,8,v15
v_lshrrev_b32 v6,5,v0
v_bfe_u32 v7,v0,4,1
v_lshlrev_b32 v208,10,v7
v_lshl_add_u32 v208,v6,8,v208
v_and_b32 v6,15,v0
v_lshl_add_u32 v208,v6,4,v208
v_lshrrev_b32 v6,5,v0
v_add_u32 v6,2,v6
v_bfe_u32 v7,v0,4,1
v_lshlrev_b32 v209,10,v7
v_lshl_add_u32 v209,v6,8,v209
v_and_b32 v6,15,v0
v_lshl_add_u32 v209,v6,4,v209
s_mul_i32 s64,s48,6554
s_lshr_b32 s64,s64,16
s_mul_i32 s60,s64,10
s_sub_u32 s65,s48,s60
v_min_u32 v2,1,v0
s_lshl_b32 s60,s64,4
s_add_u32 s60,s60,s46
s_lshl_b32 s60,s60,1
v_add_u32 v2,s60,v2
v_lshlrev_b32 v2,2,v2
s_and_b32 s60,s46,1
s_lshl_b32 s68,s65,1
s_add_u32 s68,s68,s60
s_lshr_b32 s69,s46,1
s_mul_i32 s71,s46,24576
s_mul_i32 s58,s46,491520
s_lshl_b32 s61,s65,7
s_add_u32 s58,s58,s61
s_mul_i32 s61,s64,1966080
s_add_u32 s58,s58,s61
s_mul_i32 s61,s64,98304
s_add_u32 s71,s71,s61
s_add_u32 s71,s71,149946368
v_bfe_u32 v6,v0,2,2
v_mul_u32_u24 v205,10240,v6
v_and_b32 v6,3,v0
v_lshl_add_u32 v205,v6,4,v205
v_lshrrev_b32 v6,4,v0
v_lshl_add_u32 v205,v6,6,v205
s_mul_i32 s74,s64,81920
s_mul_i32 s61,s69,40960
s_add_u32 s74,s74,s61
s_lshl_b32 s61,s68,9
s_add_u32 s74,s74,s61
s_add_u32 s74,s74,175112192
s_lshl1_add_u32 s75,s48,s60
s_lshl_b32 s75,s75,2
s_mul_i32 s61,s69,320
s_add_u32 s75,s75,s61
s_add_u32 s75,s75,819200
v_bfe_u32 v6,v0,4,1
v_lshlrev_b32 v206,14,v6
v_lshrrev_b32 v6,5,v0
v_lshl_add_u32 v206,v6,8,v206
v_and_b32 v6,15,v0
v_lshl_add_u32 v206,v6,4,v206
s_lshl_b32 s60,s46,11
v_add_u32 v206,s60,v206
s_lshl_b32 s60,s46,13
v_add_u32 v207,s60,v1
s_waitcnt vmcnt(0)
s_barrier
s_cmp_lg_u32 s46,0
s_cbranch_scc1 arr_265
v_mov_b32 v6,1
s_lshl_b32 s3,s49,2
v_mov_b32 v7,s3
s_mov_b64 exec,1
buffer_atomic_add v6,v7,s[12:15],0 offen sc1
s_mov_b64 exec,-1
arr_265:
s_mul_i32 s63,s46,40960
s_mov_b32 s4,s26
s_mov_b32 s5,s27
s_mov_b32 s6,7864320
s_mov_b32 s7,0x20000
v_lshrrev_b32 v9,3,v0
s_mov_b32 s64,1280
v_mul_lo_u32 v9,v9,s64
v_and_b32 v10,7,v0
v_lshl_add_u32 v6,v10,4,v9
s_add_u32 m0,s63,0
s_add_u32 s65,s58,0
buffer_load_dwordx4 v6,s[4:7],s65 offen lds
s_add_u32 m0,s63,1024
s_add_u32 s65,s58,10240
buffer_load_dwordx4 v6,s[4:7],s65 offen lds
s_add_u32 m0,s63,2048
s_add_u32 s65,s58,20480
buffer_load_dwordx4 v6,s[4:7],s65 offen lds
s_add_u32 m0,s63,3072
s_add_u32 s65,s58,30720
buffer_load_dwordx4 v6,s[4:7],s65 offen lds
s_add_u32 m0,s63,4096
s_add_u32 s65,s58,40960
buffer_load_dwordx4 v6,s[4:7],s65 offen lds
s_add_u32 m0,s63,5120
s_add_u32 s65,s58,51200
buffer_load_dwordx4 v6,s[4:7],s65 offen lds
s_add_u32 m0,s63,6144
s_add_u32 s65,s58,61440
buffer_load_dwordx4 v6,s[4:7],s65 offen lds
s_add_u32 m0,s63,7168
s_add_u32 s65,s58,71680
buffer_load_dwordx4 v6,s[4:7],s65 offen lds
s_add_u32 m0,s63,8192
s_add_u32 s65,s58,81920
buffer_load_dwordx4 v6,s[4:7],s65 offen lds
s_add_u32 m0,s63,9216
s_add_u32 s65,s58,92160
buffer_load_dwordx4 v6,s[4:7],s65 offen lds
s_add_u32 m0,s63,10240
s_add_u32 s65,s58,102400
buffer_load_dwordx4 v6,s[4:7],s65 offen lds
s_add_u32 m0,s63,11264
s_add_u32 s65,s58,112640
buffer_load_dwordx4 v6,s[4:7],s65 offen lds
s_add_u32 m0,s63,12288
s_add_u32 s65,s58,122880
buffer_load_dwordx4 v6,s[4:7],s65 offen lds
s_add_u32 m0,s63,13312
s_add_u32 s65,s58,133120
buffer_load_dwordx4 v6,s[4:7],s65 offen lds
s_add_u32 m0,s63,14336
s_add_u32 s65,s58,143360
buffer_load_dwordx4 v6,s[4:7],s65 offen lds
s_add_u32 m0,s63,15360
s_add_u32 s65,s58,153600
buffer_load_dwordx4 v6,s[4:7],s65 offen lds
s_add_u32 m0,s63,16384
s_add_u32 s65,s58,163840
buffer_load_dwordx4 v6,s[4:7],s65 offen lds
s_add_u32 m0,s63,17408
s_add_u32 s65,s58,174080
buffer_load_dwordx4 v6,s[4:7],s65 offen lds
s_add_u32 m0,s63,18432
s_add_u32 s65,s58,184320
buffer_load_dwordx4 v6,s[4:7],s65 offen lds
s_add_u32 m0,s63,19456
s_add_u32 s65,s58,194560
buffer_load_dwordx4 v6,s[4:7],s65 offen lds
s_add_u32 m0,s63,20480
s_add_u32 s65,s58,204800
buffer_load_dwordx4 v6,s[4:7],s65 offen lds
s_add_u32 m0,s63,21504
s_add_u32 s65,s58,215040
buffer_load_dwordx4 v6,s[4:7],s65 offen lds
s_add_u32 m0,s63,22528
s_add_u32 s65,s58,225280
buffer_load_dwordx4 v6,s[4:7],s65 offen lds
s_add_u32 m0,s63,23552
s_add_u32 s65,s58,235520
buffer_load_dwordx4 v6,s[4:7],s65 offen lds
s_add_u32 m0,s63,24576
s_add_u32 s65,s58,245760
buffer_load_dwordx4 v6,s[4:7],s65 offen lds
s_add_u32 m0,s63,25600
s_add_u32 s65,s58,256000
buffer_load_dwordx4 v6,s[4:7],s65 offen lds
s_add_u32 m0,s63,26624
s_add_u32 s65,s58,266240
buffer_load_dwordx4 v6,s[4:7],s65 offen lds
s_add_u32 m0,s63,27648
s_add_u32 s65,s58,276480
buffer_load_dwordx4 v6,s[4:7],s65 offen lds
s_add_u32 m0,s63,28672
s_add_u32 s65,s58,286720
buffer_load_dwordx4 v6,s[4:7],s65 offen lds
s_add_u32 m0,s63,29696
s_add_u32 s65,s58,296960
buffer_load_dwordx4 v6,s[4:7],s65 offen lds
s_add_u32 m0,s63,30720
s_add_u32 s65,s58,307200
buffer_load_dwordx4 v6,s[4:7],s65 offen lds
s_add_u32 m0,s63,31744
s_add_u32 s65,s58,317440
buffer_load_dwordx4 v6,s[4:7],s65 offen lds
s_add_u32 m0,s63,32768
s_add_u32 s65,s58,327680
buffer_load_dwordx4 v6,s[4:7],s65 offen lds
s_add_u32 m0,s63,33792
s_add_u32 s65,s58,337920
buffer_load_dwordx4 v6,s[4:7],s65 offen lds
s_add_u32 m0,s63,34816
s_add_u32 s65,s58,348160
buffer_load_dwordx4 v6,s[4:7],s65 offen lds
s_add_u32 m0,s63,35840
s_add_u32 s65,s58,358400
buffer_load_dwordx4 v6,s[4:7],s65 offen lds
s_add_u32 m0,s63,36864
s_add_u32 s65,s58,368640
buffer_load_dwordx4 v6,s[4:7],s65 offen lds
s_add_u32 m0,s63,37888
s_add_u32 s65,s58,378880
buffer_load_dwordx4 v6,s[4:7],s65 offen lds
s_add_u32 m0,s63,38912
s_add_u32 s65,s58,389120
buffer_load_dwordx4 v6,s[4:7],s65 offen lds
s_add_u32 m0,s63,39936
s_add_u32 s65,s58,399360
buffer_load_dwordx4 v6,s[4:7],s65 offen lds
s_waitcnt vmcnt(20)
v_bfe_u32 v9,v0,2,2
v_lshrrev_b32 v10,5,v0
v_lshl_add_u32 v9,v10,2,v9
v_mul_u32_u24 v9,128,v9
v_and_b32 v10,1,v0
v_lshl_add_u32 v9,v10,3,v9
v_bfe_u32 v10,v0,1,1
v_lshl_add_u32 v9,v10,5,v9
v_bfe_u32 v10,v0,4,1
v_lshl_add_u32 v9,v10,4,v9
v_add_u32 v7,s63,v9
ds_read_b64_tr_b16 a[0:1],v7 offset:0
ds_read_b64_tr_b16 a[2:3],v7 offset:2048
ds_read_b64_tr_b16 a[4:5],v7 offset:1024
ds_read_b64_tr_b16 a[6:7],v7 offset:3072
ds_read_b64_tr_b16 a[96:97],v7 offset:64
ds_read_b64_tr_b16 a[98:99],v7 offset:2112
ds_read_b64_tr_b16 a[100:101],v7 offset:1088
ds_read_b64_tr_b16 a[102:103],v7 offset:3136
ds_read_b64_tr_b16 a[8:9],v7 offset:4096
ds_read_b64_tr_b16 a[10:11],v7 offset:6144
ds_read_b64_tr_b16 a[12:13],v7 offset:5120
ds_read_b64_tr_b16 a[14:15],v7 offset:7168
s_waitcnt lgkmcnt(4)
ds_read_b64_tr_b16 a[104:105],v7 offset:4160
ds_read_b64_tr_b16 a[106:107],v7 offset:6208
ds_read_b64_tr_b16 a[108:109],v7 offset:5184
ds_read_b64_tr_b16 a[110:111],v7 offset:7232
ds_read_b64_tr_b16 a[16:17],v7 offset:8192
ds_read_b64_tr_b16 a[18:19],v7 offset:10240
ds_read_b64_tr_b16 a[20:21],v7 offset:9216
ds_read_b64_tr_b16 a[22:23],v7 offset:11264
ds_read_b64_tr_b16 a[112:113],v7 offset:8256
ds_read_b64_tr_b16 a[114:115],v7 offset:10304
ds_read_b64_tr_b16 a[116:117],v7 offset:9280
ds_read_b64_tr_b16 a[118:119],v7 offset:11328
s_waitcnt lgkmcnt(4)
ds_read_b64_tr_b16 a[24:25],v7 offset:12288
ds_read_b64_tr_b16 a[26:27],v7 offset:14336
ds_read_b64_tr_b16 a[28:29],v7 offset:13312
ds_read_b64_tr_b16 a[30:31],v7 offset:15360
ds_read_b64_tr_b16 a[120:121],v7 offset:12352
ds_read_b64_tr_b16 a[122:123],v7 offset:14400
ds_read_b64_tr_b16 a[124:125],v7 offset:13376
ds_read_b64_tr_b16 a[126:127],v7 offset:15424
ds_read_b64_tr_b16 a[32:33],v7 offset:16384
ds_read_b64_tr_b16 a[34:35],v7 offset:18432
ds_read_b64_tr_b16 a[36:37],v7 offset:17408
ds_read_b64_tr_b16 a[38:39],v7 offset:19456
s_waitcnt lgkmcnt(4)
ds_read_b64_tr_b16 a[128:129],v7 offset:16448
ds_read_b64_tr_b16 a[130:131],v7 offset:18496
ds_read_b64_tr_b16 a[132:133],v7 offset:17472
ds_read_b64_tr_b16 a[134:135],v7 offset:19520
s_waitcnt lgkmcnt(0)
s_add_u32 m0,s63,0
s_add_u32 s65,s58,409600
buffer_load_dwordx4 v6,s[4:7],s65 offen lds
s_add_u32 m0,s63,1024
s_add_u32 s65,s58,419840
buffer_load_dwordx4 v6,s[4:7],s65 offen lds
s_add_u32 m0,s63,2048
s_add_u32 s65,s58,430080
buffer_load_dwordx4 v6,s[4:7],s65 offen lds
s_add_u32 m0,s63,3072
s_add_u32 s65,s58,440320
buffer_load_dwordx4 v6,s[4:7],s65 offen lds
s_add_u32 m0,s63,4096
s_add_u32 s65,s58,450560
buffer_load_dwordx4 v6,s[4:7],s65 offen lds
s_add_u32 m0,s63,5120
s_add_u32 s65,s58,460800
buffer_load_dwordx4 v6,s[4:7],s65 offen lds
s_add_u32 m0,s63,6144
s_add_u32 s65,s58,471040
buffer_load_dwordx4 v6,s[4:7],s65 offen lds
s_add_u32 m0,s63,7168
s_add_u32 s65,s58,481280
buffer_load_dwordx4 v6,s[4:7],s65 offen lds
s_waitcnt vmcnt(8)
v_bfe_u32 v9,v0,2,2
v_lshrrev_b32 v10,5,v0
v_lshl_add_u32 v9,v10,2,v9
v_mul_u32_u24 v9,128,v9
v_and_b32 v10,1,v0
v_lshl_add_u32 v9,v10,3,v9
v_bfe_u32 v10,v0,1,1
v_lshl_add_u32 v9,v10,5,v9
v_bfe_u32 v10,v0,4,1
v_lshl_add_u32 v9,v10,4,v9
v_add_u32 v7,s63,v9
ds_read_b64_tr_b16 a[40:41],v7 offset:20480
ds_read_b64_tr_b16 a[42:43],v7 offset:22528
ds_read_b64_tr_b16 a[44:45],v7 offset:21504
ds_read_b64_tr_b16 a[46:47],v7 offset:23552
ds_read_b64_tr_b16 a[136:137],v7 offset:20544
ds_read_b64_tr_b16 a[138:139],v7 offset:22592
ds_read_b64_tr_b16 a[140:141],v7 offset:21568
ds_read_b64_tr_b16 a[142:143],v7 offset:23616
ds_read_b64_tr_b16 a[48:49],v7 offset:24576
ds_read_b64_tr_b16 a[50:51],v7 offset:26624
ds_read_b64_tr_b16 a[52:53],v7 offset:25600
ds_read_b64_tr_b16 a[54:55],v7 offset:27648
s_waitcnt lgkmcnt(4)
ds_read_b64_tr_b16 a[144:145],v7 offset:24640
ds_read_b64_tr_b16 a[146:147],v7 offset:26688
ds_read_b64_tr_b16 a[148:149],v7 offset:25664
ds_read_b64_tr_b16 a[150:151],v7 offset:27712
ds_read_b64_tr_b16 a[56:57],v7 offset:28672
ds_read_b64_tr_b16 a[58:59],v7 offset:30720
ds_read_b64_tr_b16 a[60:61],v7 offset:29696
ds_read_b64_tr_b16 a[62:63],v7 offset:31744
ds_read_b64_tr_b16 a[152:153],v7 offset:28736
ds_read_b64_tr_b16 a[154:155],v7 offset:30784
ds_read_b64_tr_b16 a[156:157],v7 offset:29760
ds_read_b64_tr_b16 a[158:159],v7 offset:31808
s_waitcnt lgkmcnt(4)
ds_read_b64_tr_b16 a[64:65],v7 offset:32768
ds_read_b64_tr_b16 a[66:67],v7 offset:34816
ds_read_b64_tr_b16 a[68:69],v7 offset:33792
ds_read_b64_tr_b16 a[70:71],v7 offset:35840
ds_read_b64_tr_b16 a[160:161],v7 offset:32832
ds_read_b64_tr_b16 a[162:163],v7 offset:34880
ds_read_b64_tr_b16 a[164:165],v7 offset:33856
ds_read_b64_tr_b16 a[166:167],v7 offset:35904
ds_read_b64_tr_b16 a[72:73],v7 offset:36864
ds_read_b64_tr_b16 a[74:75],v7 offset:38912
ds_read_b64_tr_b16 a[76:77],v7 offset:37888
ds_read_b64_tr_b16 a[78:79],v7 offset:39936
s_waitcnt lgkmcnt(4)
ds_read_b64_tr_b16 a[168:169],v7 offset:36928
ds_read_b64_tr_b16 a[170:171],v7 offset:38976
ds_read_b64_tr_b16 a[172:173],v7 offset:37952
ds_read_b64_tr_b16 a[174:175],v7 offset:40000
s_waitcnt lgkmcnt(0)
s_waitcnt vmcnt(0)
v_bfe_u32 v9,v0,2,2
v_lshrrev_b32 v10,5,v0
v_lshl_add_u32 v9,v10,2,v9
v_mul_u32_u24 v9,128,v9
v_and_b32 v10,1,v0
v_lshl_add_u32 v9,v10,3,v9
v_bfe_u32 v10,v0,1,1
v_lshl_add_u32 v9,v10,5,v9
v_bfe_u32 v10,v0,4,1
v_lshl_add_u32 v9,v10,4,v9
v_add_u32 v7,s63,v9
ds_read_b64_tr_b16 a[80:81],v7 offset:0
ds_read_b64_tr_b16 a[82:83],v7 offset:2048
ds_read_b64_tr_b16 a[84:85],v7 offset:1024
ds_read_b64_tr_b16 a[86:87],v7 offset:3072
ds_read_b64_tr_b16 a[176:177],v7 offset:64
ds_read_b64_tr_b16 a[178:179],v7 offset:2112
ds_read_b64_tr_b16 a[180:181],v7 offset:1088
ds_read_b64_tr_b16 a[182:183],v7 offset:3136
ds_read_b64_tr_b16 a[88:89],v7 offset:4096
ds_read_b64_tr_b16 a[90:91],v7 offset:6144
ds_read_b64_tr_b16 a[92:93],v7 offset:5120
ds_read_b64_tr_b16 a[94:95],v7 offset:7168
s_waitcnt lgkmcnt(4)
ds_read_b64_tr_b16 a[184:185],v7 offset:4160
ds_read_b64_tr_b16 a[186:187],v7 offset:6208
ds_read_b64_tr_b16 a[188:189],v7 offset:5184
ds_read_b64_tr_b16 a[190:191],v7 offset:7232
s_waitcnt lgkmcnt(0)
s_barrier
s_lshl_b32 s3,s49,2
v_mov_b32 v7,s3
s_nop 1
ibw_266:
buffer_load_dword v6,v7,s[12:15],0 offen sc1
s_waitcnt vmcnt(0)
v_cmp_ne_u32 vcc,256,v6
s_nop 0
s_cbranch_vccz ok_267
s_sleep 8
s_sub_u32 s47,s47,1
s_cbranch_scc1 ABORT
s_branch ibw_266
ok_267:
s_cmp_lg_u32 s49,0
s_cbranch_scc1 ibok_268
v_and_b32 v7,7,v0
v_lshlrev_b32 v7,2,v7
buffer_load_dword v6,v7,s[12:15],0 offen offset:32 sc1
s_waitcnt vmcnt(0)
v_cmp_ne_u32 vcc,32,v6
s_nop 0
s_cbranch_vccz ibok_268
s_barrier
s_mov_b32 s49,1
s_mov_b32 s3,s2
s_load_dwordx16 s[16:31],s[0:1],0
s_load_dwordx8 s[32:39],s[0:1],64
s_waitcnt lgkmcnt(0)
s_branch DISPATCH
ibok_268:
s_mov_b32 s83,s100
s_mov_b32 s32,0
s_mov_b32 s59,2147483648
s_min_u32 s62,s32,127
s_sub_u32 s60,s62,14
s_lshr_b32 s34,s60,1
s_and_b32 s33,s60,1
s_cmp_eq_u32 s33,0
s_cselect_b32 s61,14,0
s_add_u32 s34,s34,s61
s_sub_u32 s61,s60,50
s_cmp_ge_u32 s60,100
s_cselect_b32 s34,s61,s34
s_cselect_b32 s33,1,s33
s_cmp_lt_u32 s62,14
s_cselect_b32 s34,s62,s34
s_cselect_b32 s33,0,s33
s_lshl_b32 s35,s33,6
s_add_u32 s35,s35,s34
s_lshl_b32 s35,s35,9
s_add_u32 s35,s35,262144
s_mul_i32 s73,s34,393216
s_add_u32 s73,s73,s71
WO_COLD:
fb_269:
buffer_load_dword v3,v2,s[8:11],s35 offen sc1
s_waitcnt vmcnt(0)
v_cmp_eq_u32 vcc,0,v3
s_nop 0
s_cbranch_vccz ok_270
s_sleep 2
s_sub_u32 s47,s47,1
s_cbranch_scc1 ABORT
s_branch fb_269
ok_270:
s_add_u32 s63,s73,0
buffer_load_dwordx4 v[16:19],v208,s[8:11],s63 offen sc1
s_nop 7
buffer_load_dwordx4 v[20:23],v209,s[8:11],s63 offen sc1
s_nop 7
buffer_load_dwordx4 v[24:27],v208,s[8:11],s63 offen offset:2048 sc1
s_nop 7
buffer_load_dwordx4 v[28:31],v209,s[8:11],s63 offen offset:2048 sc1
s_nop 7
s_add_u32 s63,s73,4096
buffer_load_dwordx4 v[32:35],v208,s[8:11],s63 offen sc1
s_nop 7
buffer_load_dwordx4 v[36:39],v209,s[8:11],s63 offen sc1
s_nop 7
buffer_load_dwordx4 v[40:43],v208,s[8:11],s63 offen offset:2048 sc1
s_nop 7
buffer_load_dwordx4 v[44:47],v209,s[8:11],s63 offen offset:2048 sc1
s_nop 7
s_add_u32 s63,s73,8192
buffer_load_dwordx4 v[48:51],v208,s[8:11],s63 offen sc1
s_nop 7
buffer_load_dwordx4 v[52:55],v209,s[8:11],s63 offen sc1
WO_NEXT:
s_mov_b32 s51,s33
s_mov_b32 s52,s34
s_mov_b32 s72,s73
s_add_u32 s32,s32,1
s_waitcnt vmcnt(9)
v_mfma_f32_32x32x16_bf16 v[112:127],a[0:3],v[16:19],0
s_add_u32 s63,s72,8192
buffer_load_dwordx4 v[56:59],v208,s[8:11],s63 offen offset:2048 sc1
s_min_u32 s62,s32,127
s_sub_u32 s60,s62,14
s_lshr_b32 s34,s60,1
v_mfma_f32_32x32x16_bf16 v[128:143],a[96:99],v[16:19],0
s_and_b32 s33,s60,1
s_cmp_eq_u32 s33,0
s_cselect_b32 s61,14,0
s_add_u32 s34,s34,s61
s_sub_u32 s61,s60,50
v_xor_b32 v206,0x8000,v206
s_waitcnt vmcnt(9)
v_mfma_f32_32x32x16_bf16 v[112:127],a[4:7],v[20:23],v[112:127]
buffer_load_dwordx4 v[60:63],v209,s[8:11],s63 offen offset:2048 sc1
s_cmp_ge_u32 s60,100
s_cselect_b32 s34,s61,s34
s_cselect_b32 s33,1,s33
v_xor_b32 v207,0x8000,v207
v_mfma_f32_32x32x16_bf16 v[128:143],a[100:103],v[20:23],v[128:143]
s_cmp_lt_u32 s62,14
s_cselect_b32 s34,s62,s34
s_cselect_b32 s33,0,s33
s_lshl_b32 s35,s33,6
s_add_u32 s35,s35,s34
s_lshl_b32 s35,s35,9
s_waitcnt vmcnt(9)
v_mfma_f32_32x32x16_bf16 v[112:127],a[8:11],v[24:27],v[112:127]
s_add_u32 s63,s72,12288
buffer_load_dwordx4 v[64:67],v208,s[8:11],s63 offen sc1
s_add_u32 s35,s35,262144
s_mul_i32 s73,s34,393216
s_add_u32 s73,s73,s71
v_mfma_f32_32x32x16_bf16 v[128:143],a[104:107],v[24:27],v[128:143]
buffer_load_dword v3,v2,s[8:11],s35 offen sc1
s_mul_i32 s64,s52,491520
s_add_u32 s64,s64,s74
s_lshl_b32 s65,s51,6
s_add_u32 s65,s65,s52
s_waitcnt vmcnt(10)
v_mfma_f32_32x32x16_bf16 v[112:127],a[12:15],v[28:31],v[112:127]
buffer_load_dwordx4 v[68:71],v209,s[8:11],s63 offen sc1
s_mul_i32 s65,s65,640
s_add_u32 s82,s65,s75
v_mfma_f32_32x32x16_bf16 v[128:143],a[108:111],v[28:31],v[128:143]
s_waitcnt vmcnt(10)
v_mfma_f32_32x32x16_bf16 v[112:127],a[16:19],v[32:35],v[112:127]
buffer_load_dwordx4 v[72:75],v208,s[8:11],s63 offen offset:2048 sc1
v_mfma_f32_32x32x16_bf16 v[128:143],a[112:115],v[32:35],v[128:143]
s_waitcnt vmcnt(10)
v_mfma_f32_32x32x16_bf16 v[112:127],a[20:23],v[36:39],v[112:127]
buffer_load_dwordx4 v[76:79],v209,s[8:11],s63 offen offset:2048 sc1
v_mfma_f32_32x32x16_bf16 v[128:143],a[116:119],v[36:39],v[128:143]
s_waitcnt vmcnt(10)
v_mfma_f32_32x32x16_bf16 v[112:127],a[24:27],v[40:43],v[112:127]
s_add_u32 s63,s72,16384
buffer_load_dwordx4 v[80:83],v208,s[8:11],s63 offen sc1
v_mfma_f32_32x32x16_bf16 v[128:143],a[120:123],v[40:43],v[128:143]
s_waitcnt vmcnt(10)
v_mfma_f32_32x32x16_bf16 v[112:127],a[28:31],v[44:47],v[112:127]
buffer_load_dwordx4 v[84:87],v209,s[8:11],s63 offen sc1
v_mfma_f32_32x32x16_bf16 v[128:143],a[124:127],v[44:47],v[128:143]
s_waitcnt vmcnt(10)
v_mfma_f32_32x32x16_bf16 v[112:127],a[32:35],v[48:51],v[112:127]
buffer_load_dwordx4 v[88:91],v208,s[8:11],s63 offen offset:2048 sc1
v_mfma_f32_32x32x16_bf16 v[128:143],a[128:131],v[48:51],v[128:143]
s_waitcnt vmcnt(10)
v_mfma_f32_32x32x16_bf16 v[112:127],a[36:39],v[52:55],v[112:127]
buffer_load_dwordx4 v[92:95],v209,s[8:11],s63 offen offset:2048 sc1
v_mfma_f32_32x32x16_bf16 v[128:143],a[132:135],v[52:55],v[128:143]
s_waitcnt vmcnt(10)
v_mfma_f32_32x32x16_bf16 v[112:127],a[40:43],v[56:59],v[112:127]
s_add_u32 s63,s72,20480
buffer_load_dwordx4 v[96:99],v208,s[8:11],s63 offen sc1
v_mfma_f32_32x32x16_bf16 v[128:143],a[136:139],v[56:59],v[128:143]
s_waitcnt vmcnt(10)
v_mfma_f32_32x32x16_bf16 v[112:127],a[44:47],v[60:63],v[112:127]
buffer_load_dwordx4 v[100:103],v209,s[8:11],s63 offen sc1
v_mfma_f32_32x32x16_bf16 v[128:143],a[140:143],v[60:63],v[128:143]
s_waitcnt vmcnt(10)
v_mfma_f32_32x32x16_bf16 v[112:127],a[48:51],v[64:67],v[112:127]
buffer_load_dwordx4 v[104:107],v208,s[8:11],s63 offen offset:2048 sc1
v_mfma_f32_32x32x16_bf16 v[128:143],a[144:147],v[64:67],v[128:143]
s_waitcnt vmcnt(10)
v_cmp_eq_u32 vcc,0,v3
s_cmp_eq_u64 vcc,0
s_cselect_b32 s37,0,2147483648
s_cmp_lt_u32 s32,128
s_cselect_b32 s37,s37,2147483648
s_waitcnt vmcnt(9)
v_mfma_f32_32x32x16_bf16 v[112:127],a[52:55],v[68:71],v[112:127]
buffer_load_dwordx4 v[108:111],v209,s[8:11],s63 offen offset:2048 sc1
s_add_u32 s67,s73,s37
v_mfma_f32_32x32x16_bf16 v[128:143],a[148:151],v[68:71],v[128:143]
s_mov_b64 exec,1
buffer_store_dword v5,v1,s[8:11],s59 offen sc1
s_mov_b64 exec,-1
s_mov_b32 s59,2147483648
s_waitcnt vmcnt(10)
v_mfma_f32_32x32x16_bf16 v[112:127],a[56:59],v[72:75],v[112:127]
s_add_u32 s63,s67,0
buffer_load_dwordx4 v[16:19],v208,s[8:11],s63 offen sc1
v_mfma_f32_32x32x16_bf16 v[128:143],a[152:155],v[72:75],v[128:143]
s_waitcnt vmcnt(10)
v_mfma_f32_32x32x16_bf16 v[112:127],a[60:63],v[76:79],v[112:127]
buffer_load_dwordx4 v[20:23],v209,s[8:11],s63 offen sc1
v_mfma_f32_32x32x16_bf16 v[128:143],a[156:159],v[76:79],v[128:143]
s_waitcnt vmcnt(10)
v_mfma_f32_32x32x16_bf16 v[112:127],a[64:67],v[80:83],v[112:127]
buffer_load_dwordx4 v[24:27],v208,s[8:11],s63 offen offset:2048 sc1
v_mfma_f32_32x32x16_bf16 v[128:143],a[160:163],v[80:83],v[128:143]
s_waitcnt vmcnt(10)
v_mfma_f32_32x32x16_bf16 v[112:127],a[68:71],v[84:87],v[112:127]
buffer_load_dwordx4 v[28:31],v209,s[8:11],s63 offen offset:2048 sc1
v_mfma_f32_32x32x16_bf16 v[128:143],a[164:167],v[84:87],v[128:143]
s_waitcnt vmcnt(10)
v_mfma_f32_32x32x16_bf16 v[112:127],a[72:75],v[88:91],v[112:127]
s_add_u32 s63,s67,4096
buffer_load_dwordx4 v[32:35],v208,s[8:11],s63 offen sc1
buffer_load_dword v3,v2,s[8:11],s35 offen sc1
v_mfma_f32_32x32x16_bf16 v[128:143],a[168:171],v[88:91],v[128:143]
s_waitcnt vmcnt(11)
v_mfma_f32_32x32x16_bf16 v[112:127],a[76:79],v[92:95],v[112:127]
buffer_load_dwordx4 v[36:39],v209,s[8:11],s63 offen sc1
v_mfma_f32_32x32x16_bf16 v[128:143],a[172:175],v[92:95],v[128:143]
s_waitcnt vmcnt(11)
v_mfma_f32_32x32x16_bf16 v[112:127],a[80:83],v[96:99],v[112:127]
buffer_load_dwordx4 v[40:43],v208,s[8:11],s63 offen offset:2048 sc1
v_mfma_f32_32x32x16_bf16 v[128:143],a[176:179],v[96:99],v[128:143]
s_waitcnt vmcnt(11)
v_mfma_f32_32x32x16_bf16 v[112:127],a[84:87],v[100:103],v[112:127]
buffer_load_dwordx4 v[44:47],v209,s[8:11],s63 offen offset:2048 sc1
v_mfma_f32_32x32x16_bf16 v[128:143],a[180:183],v[100:103],v[128:143]
s_waitcnt vmcnt(11)
v_mfma_f32_32x32x16_bf16 v[112:127],a[88:91],v[104:107],v[112:127]
s_add_u32 s63,s67,8192
buffer_load_dwordx4 v[48:51],v208,s[8:11],s63 offen sc1
v_mfma_f32_32x32x16_bf16 v[128:143],a[184:187],v[104:107],v[128:143]
s_waitcnt vmcnt(11)
v_mfma_f32_32x32x16_bf16 v[112:127],a[92:95],v[108:111],v[112:127]
buffer_load_dwordx4 v[52:55],v209,s[8:11],s63 offen sc1
v_mfma_f32_32x32x16_bf16 v[128:143],a[188:191],v[108:111],v[128:143]
s_cmp_eq_u32 s37,0
s_cbranch_scc1 ep_271
s_waitcnt vmcnt(0)
v_cmp_eq_u32 vcc,0,v3
s_cmp_eq_u64 vcc,0
s_cselect_b32 s37,0,2147483648
s_cmp_lt_u32 s32,128
s_cselect_b32 s37,s37,2147483648
s_cmp_lg_u32 s37,0
s_cbranch_scc1 ep_271
s_add_u32 s63,s73,0
buffer_load_dwordx4 v[16:19],v208,s[8:11],s63 offen sc1
buffer_load_dwordx4 v[20:23],v209,s[8:11],s63 offen sc1
buffer_load_dwordx4 v[24:27],v208,s[8:11],s63 offen offset:2048 sc1
buffer_load_dwordx4 v[28:31],v209,s[8:11],s63 offen offset:2048 sc1
s_add_u32 s63,s73,4096
buffer_load_dwordx4 v[32:35],v208,s[8:11],s63 offen sc1
buffer_load_dwordx4 v[36:39],v209,s[8:11],s63 offen sc1
buffer_load_dwordx4 v[40:43],v208,s[8:11],s63 offen offset:2048 sc1
buffer_load_dwordx4 v[44:47],v209,s[8:11],s63 offen offset:2048 sc1
s_add_u32 s63,s73,8192
buffer_load_dwordx4 v[48:51],v208,s[8:11],s63 offen sc1
buffer_load_dwordx4 v[52:55],v209,s[8:11],s63 offen sc1
ep_271:
s_nop 7
ds_write_b128 v206,v[112:115] offset:0
ds_write_b128 v206,v[116:119] offset:1024
ds_write_b128 v206,v[120:123] offset:512
ds_write_b128 v206,v[124:127] offset:1536
s_nop 0
ds_write_b128 v206,v[128:131] offset:8192
ds_write_b128 v206,v[132:135] offset:9216
ds_write_b128 v206,v[136:139] offset:8704
ds_write_b128 v206,v[140:143] offset:9728
s_waitcnt lgkmcnt(0)
s_barrier
ds_read_b128 v[144:147],v207 offset:0
ds_read_b128 v[148:151],v207 offset:1024
ds_read_b128 v[152:155],v207 offset:2048
ds_read_b128 v[156:159],v207 offset:3072
ds_read_b128 v[160:163],v207 offset:4096
ds_read_b128 v[164:167],v207 offset:5120
ds_read_b128 v[168:171],v207 offset:6144
ds_read_b128 v[172:175],v207 offset:7168
s_waitcnt lgkmcnt(4)
v_pk_add_f32 v[144:145],v[144:145],v[152:153]
v_pk_add_f32 v[146:147],v[146:147],v[154:155]
v_pk_add_f32 v[148:149],v[148:149],v[156:157]
v_pk_add_f32 v[150:151],v[150:151],v[158:159]
s_waitcnt lgkmcnt(0)
v_pk_add_f32 v[160:161],v[160:161],v[168:169]
v_pk_add_f32 v[162:163],v[162:163],v[170:171]
v_pk_add_f32 v[164:165],v[164:165],v[172:173]
v_pk_add_f32 v[166:167],v[166:167],v[174:175]
v_pk_add_f32 v[144:145],v[144:145],v[160:161]
v_pk_add_f32 v[146:147],v[146:147],v[162:163]
v_pk_add_f32 v[148:149],v[148:149],v[164:165]
v_pk_add_f32 v[150:151],v[150:151],v[166:167]
buffer_store_dwordx4 v[144:147],v205,s[8:11],s64 offen sc1
buffer_store_dwordx4 v[148:151],v205,s[8:11],s64 offen offset:256 sc1
s_mov_b32 s59,s82
s_cmp_eq_u32 s37,0
s_cbranch_scc1 WO_NEXT
s_waitcnt vmcnt(0)
s_mov_b64 exec,1
buffer_store_dword v5,v1,s[8:11],s59 offen sc1
s_mov_b64 exec,-1
s_mov_b32 s59,2147483648
s_cmp_lt_u32 s32,128
s_cbranch_scc1 WO_COLD
s_endpgm
ROLE_R1:
s_lshr_b32 s80,s48,3
s_and_b32 s48,s48,7
v_lshlrev_b32 v1,4,v0
v_mov_b32 v5,1
s_lshl_b32 s56,s48,2
s_add_u32 s56,s56,s46
v_bfe_u32 v6,v0,2,2
v_lshrrev_b32 v7,4,v0
v_add_u32 v7,v6,v7
v_and_b32 v7,3,v7
v_and_b32 v15,3,v0
v_lshlrev_b32 v15,4,v15
v_lshl_add_u32 v15,v7,6,v15
v_lshl_add_u32 v15,v6,8,v15
v_lshrrev_b32 v6,4,v0
v_bfe_u32 v7,v0,2,2
v_and_b32 v8,3,v0
s_lshr_b32 s60,s48,2
s_lshl_b32 s70,s60,10
s_and_b32 s61,s48,3
s_lshl_b32 s60,s61,8
s_add_u32 s70,s70,s60
v_lshrrev_b32 v9,1,v6
v_lshlrev_b32 v18,11,v9
v_add_u32 v9,s61,v7
v_and_b32 v9,3,v9
v_lshl_add_u32 v18,v9,6,v18
v_lshl_add_u32 v18,v8,4,v18
v_add_u32 v18,s70,v18
v_and_b32 v9,1,v6
v_lshl_add_u32 v16,v9,3,v18
v_lshl_add_u32 v17,v9,14,v18
s_lshl_b32 s60,s48,2
v_add_u32 v9,s60,v8
v_mul_u32_u24 v19,1280,v9
v_lshl_add_u32 v19,v6,5,v19
v_lshl_add_u32 v19,v7,3,v19
v_lshlrev_b32 v21,5,v8
s_lshl_b32 s60,s46,3
v_add_u32 v20,s60,v21
v_min_u32 v2,39,v0
v_lshlrev_b32 v2,3,v2
s_lshr_b32 s60,s48,2
s_mul_i32 s60,s60,320
v_add_u32 v2,s60,v2
s_cmp_lt_u32 s46,2
s_cselect_b32 s68,0,2147483648
s_cselect_b32 s69,1.0,0
s_waitcnt vmcnt(0)
s_barrier
s_cmp_lg_u32 s46,0
s_cbranch_scc1 arr_272
v_mov_b32 v6,1
s_lshl_b32 s3,s49,2
v_mov_b32 v7,s3
s_mov_b64 exec,1
buffer_atomic_add v6,v7,s[12:15],0 offen sc1
s_mov_b64 exec,-1
arr_272:
s_lshl_b32 s3,s49,2
v_mov_b32 v7,s3
s_nop 1
ibw_273:
buffer_load_dword v6,v7,s[12:15],0 offen sc1
s_waitcnt vmcnt(0)
v_cmp_ne_u32 vcc,256,v6
s_nop 0
s_cbranch_vccz ok_274
s_sleep 8
s_sub_u32 s47,s47,1
s_cbranch_scc1 ABORT
s_branch ibw_273
ok_274:
s_cmp_lg_u32 s49,0
s_cbranch_scc1 ibok_275
v_and_b32 v7,7,v0
v_lshlrev_b32 v7,2,v7
buffer_load_dword v6,v7,s[12:15],0 offen offset:32 sc1
s_waitcnt vmcnt(0)
v_cmp_ne_u32 vcc,32,v6
s_nop 0
s_cbranch_vccz ibok_275
s_barrier
s_mov_b32 s49,1
s_mov_b32 s3,s2
s_load_dwordx16 s[16:31],s[0:1],0
s_load_dwordx8 s[32:39],s[0:1],64
s_waitcnt lgkmcnt(0)
s_branch DISPATCH
ibok_275:
R1_GO:
s_mov_b32 s83,s100
s_mov_b32 s50,64
s_mov_b32 s55,1
s_mov_b32 s59,1600000
v_mov_b32 v238,1024
v_mov_b32 v239,0
ds_write_b32 v238,v239
s_waitcnt lgkmcnt(0)
s_barrier
s_mov_b32 s82,-1
v_mov_b32 v40,0
v_mov_b32 v41,0
v_mov_b32 v42,0
v_mov_b32 v43,0
v_mov_b32 v52,0
v_mov_b32 v53,0
v_mov_b32 v54,0
v_mov_b32 v55,0
v_mov_b32 v64,0
v_mov_b32 v65,0
v_mov_b32 v66,0
v_mov_b32 v67,0
v_mov_b32 v76,0
v_mov_b32 v77,0
v_mov_b32 v78,0
v_mov_b32 v79,0
v_mov_b32 v108,0
v_mov_b32 v109,0
v_mov_b32 v120,0
v_mov_b32 v121,0
v_mov_b32 v122,0
v_mov_b32 v123,0
v_mov_b32 v132,0
v_mov_b32 v133,0
v_mov_b32 v134,0
v_mov_b32 v135,0
v_mov_b32 v144,0
v_mov_b32 v145,0
v_mov_b32 v146,0
v_mov_b32 v147,0
v_mov_b32 v156,0
v_mov_b32 v157,0
v_mov_b32 v158,0
v_mov_b32 v159,0
v_mov_b32 v188,0
v_mov_b32 v189,0
s_mov_b32 s51,s80
s_sub_u32 s52,s50,64
s_lshl_b32 s67,s51,6
s_add_u32 s67,s67,s52
s_mul_i32 s67,s67,640
s_add_u32 s67,s67,819200
fb_276:
buffer_load_dwordx2 v[236:237],v2,s[8:11],s67 offen sc1
s_waitcnt vmcnt(0)
v_min_u32 v236,v236,v237
v_cmp_eq_u32 vcc,0,v236
s_nop 0
s_cbranch_vccz ok_277
s_sleep 20
s_sub_u32 s47,s47,1
s_cbranch_scc1 ABORT
s_branch fb_276
ok_277:
s_mul_i32 s66,s52,491520
s_mul_i32 s60,s48,10240
s_add_u32 s66,s66,s60
s_lshl_b32 s60,s46,10
s_add_u32 s66,s66,s60
s_add_u32 s66,s66,175112192
s_mul_i32 s60,s52,40960
s_add_u32 s60,s60,234749952
s_mul_i32 s61,s52,46080
s_add_u32 s61,s61,209518592
s_cmp_eq_u32 s51,0
s_cselect_b32 s65,s60,s61
s_lshl_b32 s60,s46,12
s_add_u32 s65,s65,s60
s_cmp_lt_u32 s46,2
s_cbranch_scc1 g2_278
v_mov_b32 v40,0
v_mov_b32 v41,0
v_mov_b32 v42,0
v_mov_b32 v43,0
s_nop 0
s_branch g3_279
g2_278:
s_add_u32 s63,s65,32768
buffer_load_dwordx2 v[108:109],v16,s[8:11],s63 offen sc1
s_add_u32 s63,s66,8192
buffer_load_dwordx4 v[40:43],v1,s[8:11],s63 offen sc1
s_add_u32 s63,s66,90112
buffer_load_dwordx4 v[52:55],v1,s[8:11],s63 offen sc1
s_add_u32 s63,s66,172032
buffer_load_dwordx4 v[64:67],v1,s[8:11],s63 offen sc1
s_add_u32 s63,s66,253952
buffer_load_dwordx4 v[76:79],v1,s[8:11],s63 offen sc1
g3_279:
s_add_u32 s63,s65,0
buffer_load_dwordx2 v[104:105],v16,s[8:11],s63 offen sc1
s_add_u32 s63,s65,16384
buffer_load_dwordx2 v[106:107],v16,s[8:11],s63 offen sc1
s_add_u32 s63,s66,0
buffer_load_dwordx4 v[32:35],v1,s[8:11],s63 offen sc1
s_add_u32 s63,s66,4096
buffer_load_dwordx4 v[36:39],v1,s[8:11],s63 offen sc1
s_add_u32 s63,s66,81920
buffer_load_dwordx4 v[44:47],v1,s[8:11],s63 offen sc1
s_add_u32 s63,s66,86016
buffer_load_dwordx4 v[48:51],v1,s[8:11],s63 offen sc1
s_add_u32 s63,s66,163840
buffer_load_dwordx4 v[56:59],v1,s[8:11],s63 offen sc1
s_add_u32 s63,s66,167936
buffer_load_dwordx4 v[60:63],v1,s[8:11],s63 offen sc1
s_add_u32 s63,s66,245760
buffer_load_dwordx4 v[68:71],v1,s[8:11],s63 offen sc1
s_add_u32 s63,s66,249856
buffer_load_dwordx4 v[72:75],v1,s[8:11],s63 offen sc1
R1_A:
s_add_u32 s66,s50,1
s_min_u32 s66,s66,127
s_mov_b32 s53,s80
s_sub_u32 s54,s66,64
s_lshl_b32 s67,s53,6
s_add_u32 s67,s67,s54
s_mul_i32 s67,s67,640
s_add_u32 s67,s67,819200
s_lshl_b32 s60,s51,6
s_add_u32 s60,s60,s52
s_mul_i32 s71,s60,40960
s_mul_i32 s73,s60,5120
s_lshl_b32 s60,s46,12
s_add_u32 s71,s71,s60
s_add_u32 s72,s71,32768
s_add_u32 s72,s72,s68
s_cmp_eq_u32 s55,0
s_cbranch_scc1 r1p_280
s_waitcnt vmcnt(8)
v_lshlrev_b32 v192,16,v104
v_and_b32 v193,0xffff0000,v104
v_lshlrev_b32 v194,16,v105
v_and_b32 v195,0xffff0000,v105
v_lshlrev_b32 v196,16,v106
v_and_b32 v197,0xffff0000,v106
v_lshlrev_b32 v198,16,v107
v_and_b32 v199,0xffff0000,v107
v_lshlrev_b32 v200,16,v108
v_and_b32 v201,0xffff0000,v108
v_lshlrev_b32 v202,16,v109
v_and_b32 v203,0xffff0000,v109
s_waitcnt vmcnt(4)
v_pk_add_f32 v[32:33],v[32:33],v[44:45]
v_pk_add_f32 v[34:35],v[34:35],v[46:47]
v_pk_add_f32 v[36:37],v[36:37],v[48:49]
v_pk_add_f32 v[38:39],v[38:39],v[50:51]
v_pk_add_f32 v[40:41],v[40:41],v[52:53]
v_pk_add_f32 v[42:43],v[42:43],v[54:55]
s_waitcnt vmcnt(2)
v_pk_add_f32 v[32:33],v[32:33],v[56:57]
v_pk_add_f32 v[34:35],v[34:35],v[58:59]
v_pk_add_f32 v[36:37],v[36:37],v[60:61]
v_pk_add_f32 v[38:39],v[38:39],v[62:63]
v_pk_add_f32 v[40:41],v[40:41],v[64:65]
v_pk_add_f32 v[42:43],v[42:43],v[66:67]
s_waitcnt vmcnt(0)
v_pk_add_f32 v[32:33],v[32:33],v[68:69]
v_pk_add_f32 v[34:35],v[34:35],v[70:71]
v_pk_add_f32 v[36:37],v[36:37],v[72:73]
v_pk_add_f32 v[38:39],v[38:39],v[74:75]
v_pk_add_f32 v[40:41],v[40:41],v[76:77]
v_pk_add_f32 v[42:43],v[42:43],v[78:79]
s_nop 0
s_branch r1j_281
r1p_280:
s_waitcnt vmcnt(9)
v_lshlrev_b32 v192,16,v104
v_and_b32 v193,0xffff0000,v104
v_lshlrev_b32 v194,16,v105
v_and_b32 v195,0xffff0000,v105
v_lshlrev_b32 v196,16,v106
v_and_b32 v197,0xffff0000,v106
v_lshlrev_b32 v198,16,v107
v_and_b32 v199,0xffff0000,v107
v_lshlrev_b32 v200,16,v108
v_and_b32 v201,0xffff0000,v108
v_lshlrev_b32 v202,16,v109
v_and_b32 v203,0xffff0000,v109
s_waitcnt vmcnt(5)
v_pk_add_f32 v[32:33],v[32:33],v[44:45]
v_pk_add_f32 v[34:35],v[34:35],v[46:47]
v_pk_add_f32 v[36:37],v[36:37],v[48:49]
v_pk_add_f32 v[38:39],v[38:39],v[50:51]
v_pk_add_f32 v[40:41],v[40:41],v[52:53]
v_pk_add_f32 v[42:43],v[42:43],v[54:55]
s_waitcnt vmcnt(3)
v_pk_add_f32 v[32:33],v[32:33],v[56:57]
v_pk_add_f32 v[34:35],v[34:35],v[58:59]
v_pk_add_f32 v[36:37],v[36:37],v[60:61]
v_pk_add_f32 v[38:39],v[38:39],v[62:63]
v_pk_add_f32 v[40:41],v[40:41],v[64:65]
v_pk_add_f32 v[42:43],v[42:43],v[66:67]
s_waitcnt vmcnt(1)
v_pk_add_f32 v[32:33],v[32:33],v[68:69]
v_pk_add_f32 v[34:35],v[34:35],v[70:71]
v_pk_add_f32 v[36:37],v[36:37],v[72:73]
v_pk_add_f32 v[38:39],v[38:39],v[74:75]
v_pk_add_f32 v[40:41],v[40:41],v[76:77]
v_pk_add_f32 v[42:43],v[42:43],v[78:79]
s_nop 1
r1j_281:
v_cvt_pk_bf16_f32 v6,v32,v33
v_lshlrev_b32 v32,16,v6
v_and_b32 v33,0xffff0000,v6
v_cvt_pk_bf16_f32 v6,v34,v35
v_lshlrev_b32 v34,16,v6
v_and_b32 v35,0xffff0000,v6
v_cvt_pk_bf16_f32 v6,v36,v37
v_lshlrev_b32 v36,16,v6
v_and_b32 v37,0xffff0000,v6
v_cvt_pk_bf16_f32 v6,v38,v39
v_lshlrev_b32 v38,16,v6
v_and_b32 v39,0xffff0000,v6
v_cvt_pk_bf16_f32 v6,v40,v41
v_lshlrev_b32 v40,16,v6
v_and_b32 v41,0xffff0000,v6
v_cvt_pk_bf16_f32 v6,v42,v43
v_lshlrev_b32 v42,16,v6
v_and_b32 v43,0xffff0000,v6
v_pk_add_f32 v[32:33],v[32:33],v[192:193]
v_pk_add_f32 v[34:35],v[34:35],v[194:195]
v_pk_add_f32 v[36:37],v[36:37],v[196:197]
v_pk_add_f32 v[38:39],v[38:39],v[198:199]
v_pk_add_f32 v[40:41],v[40:41],v[200:201]
v_pk_add_f32 v[42:43],v[42:43],v[202:203]
v_cvt_pk_bf16_f32 v204,v32,v33
v_lshlrev_b32 v32,16,v204
v_and_b32 v33,0xffff0000,v204
v_cvt_pk_bf16_f32 v205,v34,v35
v_lshlrev_b32 v34,16,v205
v_and_b32 v35,0xffff0000,v205
v_cvt_pk_bf16_f32 v206,v36,v37
v_lshlrev_b32 v36,16,v206
v_and_b32 v37,0xffff0000,v206
v_cvt_pk_bf16_f32 v207,v38,v39
v_lshlrev_b32 v38,16,v207
v_and_b32 v39,0xffff0000,v207
v_cvt_pk_bf16_f32 v208,v40,v41
v_lshlrev_b32 v40,16,v208
v_and_b32 v41,0xffff0000,v208
v_cvt_pk_bf16_f32 v209,v42,v43
v_lshlrev_b32 v42,16,v209
v_and_b32 v43,0xffff0000,v209
v_pk_add_f32 v[28:29],v[32:33],v[34:35]
v_pk_mul_f32 v[26:27],v[32:33],v[32:33]
v_pk_fma_f32 v[26:27],v[34:35],v[34:35],v[26:27]
v_pk_add_f32 v[28:29],v[28:29],v[36:37]
v_pk_fma_f32 v[26:27],v[36:37],v[36:37],v[26:27]
v_pk_add_f32 v[28:29],v[28:29],v[38:39]
v_pk_fma_f32 v[26:27],v[38:39],v[38:39],v[26:27]
v_pk_add_f32 v[28:29],v[28:29],v[40:41]
v_pk_fma_f32 v[26:27],v[40:41],v[40:41],v[26:27]
v_pk_add_f32 v[28:29],v[28:29],v[42:43]
v_pk_fma_f32 v[26:27],v[42:43],v[42:43],v[26:27]
v_add_f32 v24,v28,v29
v_add_f32 v25,v26,v27
s_nop 0
v_add_f32_dpp v24,v24,v24 row_ror:4 row_mask:0xf bank_mask:0xf
v_add_f32_dpp v25,v25,v25 row_ror:4 row_mask:0xf bank_mask:0xf
s_nop 0
v_add_f32_dpp v24,v24,v24 row_ror:8 row_mask:0xf bank_mask:0xf
v_add_f32_dpp v25,v25,v25 row_ror:8 row_mask:0xf bank_mask:0xf
v_mov_b32 v26,v24
v_mov_b32 v27,v25
s_nop 0
v_permlane32_swap_b32 v24,v26
v_permlane32_swap_b32 v25,v27
v_add_f32 v24,v24,v26
v_add_f32 v25,v25,v27
v_mov_b32 v26,v24
v_mov_b32 v27,v25
s_nop 0
v_permlane16_swap_b32 v24,v26
v_permlane16_swap_b32 v25,v27
v_add_f32 v24,v24,v26
v_add_f32 v25,v25,v27
ds_write_b64 v20,v[24:25] offset:0
s_waitcnt lgkmcnt(0)
s_barrier
ds_read_b128 v[228:231],v21 offset:0
ds_read_b128 v[232:235],v21 offset:16
buffer_load_dwordx2 v[236:237],v2,s[8:11],s67 offen sc1
v_mov_b32 v210,v208
v_mov_b32 v211,v209
s_add_u32 s63,s71,218365952
v_permlane16_swap_b32 v204,v206
v_permlane16_swap_b32 v205,v207
buffer_store_dwordx4 v[204:207],v17,s[8:11],s63 offen sc1
s_add_u32 s63,s72,218365952
v_permlane16_swap_b32 v208,v210
v_permlane16_swap_b32 v209,v211
buffer_store_dwordx4 v[208:211],v18,s[8:11],s63 offen sc1
s_waitcnt lgkmcnt(0)
v_pk_add_f32 v[228:229],v[228:229],v[230:231]
v_pk_add_f32 v[232:233],v[232:233],v[234:235]
v_pk_add_f32 v[24:25],v[228:229],v[232:233]
v_mul_f32 v24,0x3acccccd,v24
v_mul_f32 v25,0x3acccccd,v25
v_fma_f32 v25,-v24,v24,v25
v_max_f32 v25,0,v25
v_mov_b32 v28,v24
v_mov_b32 v29,v25
v_cvt_pk_bf16_f32 v6,v24,v25
v_lshlrev_b32 v24,16,v6
v_and_b32 v25,0xffff0000,v6
v_add_f32 v25,0x3727c5ac,v25
v_cvt_pk_bf16_f32 v6,v25,v25
v_lshlrev_b32 v25,16,v6
v_sqrt_f32 v25,v25
s_nop 0
v_cvt_pk_bf16_f32 v6,v25,v25
v_lshlrev_b32 v25,16,v6
v_rcp_f32 v25,v25
s_nop 0
v_pk_add_f32 v[32:33],v[32:33],v[24:25] op_sel_hi:[1,0] neg_lo:[0,1] neg_hi:[0,1]
v_pk_add_f32 v[34:35],v[34:35],v[24:25] op_sel_hi:[1,0] neg_lo:[0,1] neg_hi:[0,1]
v_pk_add_f32 v[36:37],v[36:37],v[24:25] op_sel_hi:[1,0] neg_lo:[0,1] neg_hi:[0,1]
v_pk_add_f32 v[38:39],v[38:39],v[24:25] op_sel_hi:[1,0] neg_lo:[0,1] neg_hi:[0,1]
v_pk_add_f32 v[40:41],v[40:41],v[24:25] op_sel_hi:[1,0] neg_lo:[0,1] neg_hi:[0,1]
v_pk_add_f32 v[42:43],v[42:43],v[24:25] op_sel_hi:[1,0] neg_lo:[0,1] neg_hi:[0,1]
v_cvt_pk_bf16_f32 v6,v32,v33
v_lshlrev_b32 v32,16,v6
v_and_b32 v33,0xffff0000,v6
v_cvt_pk_bf16_f32 v8,v34,v35
v_lshlrev_b32 v34,16,v8
v_and_b32 v35,0xffff0000,v8
v_cvt_pk_bf16_f32 v6,v36,v37
v_lshlrev_b32 v36,16,v6
v_and_b32 v37,0xffff0000,v6
v_cvt_pk_bf16_f32 v8,v38,v39
v_lshlrev_b32 v38,16,v8
v_and_b32 v39,0xffff0000,v8
v_cvt_pk_bf16_f32 v6,v40,v41
v_lshlrev_b32 v40,16,v6
v_and_b32 v41,0xffff0000,v6
v_cvt_pk_bf16_f32 v8,v42,v43
v_lshlrev_b32 v42,16,v8
v_and_b32 v43,0xffff0000,v8
v_pk_mul_f32 v[32:33],v[32:33],v[24:25] op_sel:[0,1] op_sel_hi:[1,1]
v_pk_mul_f32 v[34:35],v[34:35],v[24:25] op_sel:[0,1] op_sel_hi:[1,1]
v_pk_mul_f32 v[36:37],v[36:37],v[24:25] op_sel:[0,1] op_sel_hi:[1,1]
v_pk_mul_f32 v[38:39],v[38:39],v[24:25] op_sel:[0,1] op_sel_hi:[1,1]
v_pk_mul_f32 v[40:41],v[40:41],v[24:25] op_sel:[0,1] op_sel_hi:[1,1]
v_pk_mul_f32 v[42:43],v[42:43],v[24:25] op_sel:[0,1] op_sel_hi:[1,1]
v_cvt_pk_bf16_f32 v212,v32,v33
v_lshlrev_b32 v32,16,v212
v_and_b32 v33,0xffff0000,v212
v_cvt_pk_bf16_f32 v213,v34,v35
v_lshlrev_b32 v34,16,v213
v_and_b32 v35,0xffff0000,v213
v_cvt_pk_bf16_f32 v214,v36,v37
v_lshlrev_b32 v36,16,v214
v_and_b32 v37,0xffff0000,v214
v_cvt_pk_bf16_f32 v215,v38,v39
v_lshlrev_b32 v38,16,v215
v_and_b32 v39,0xffff0000,v215
v_cvt_pk_bf16_f32 v216,v40,v41
v_lshlrev_b32 v40,16,v216
v_and_b32 v41,0xffff0000,v216
v_cvt_pk_bf16_f32 v217,v42,v43
v_lshlrev_b32 v42,16,v217
v_and_b32 v43,0xffff0000,v217
v_mov_b32 v218,v216
v_mov_b32 v219,v217
s_add_u32 s63,s71,223608832
s_add_u32 s63,s63,s73
v_permlane16_swap_b32 v212,v214
v_permlane16_swap_b32 v213,v215
buffer_store_dwordx4 v[212:215],v17,s[8:11],s63 offen sc1
s_add_u32 s63,s72,223608832
s_add_u32 s63,s63,s73
v_permlane16_swap_b32 v216,v218
v_permlane16_swap_b32 v217,v219
buffer_store_dwordx4 v[216:219],v18,s[8:11],s63 offen sc1
v_sub_f32 v28,v28,v24
v_mul_f32 v29,v29,v25
v_mul_f32 v28,v28,v25
v_mul_f32 v29,v29,v25
v_cvt_pk_bf16_f32 v6,v28,v29
v_lshlrev_b32 v28,16,v6
v_and_b32 v29,0xffff0000,v6
v_add_f32 v29,0x3727c5ac,v29
v_cvt_pk_bf16_f32 v6,v29,v29
v_lshlrev_b32 v29,16,v6
v_sqrt_f32 v29,v29
s_nop 0
v_cvt_pk_bf16_f32 v6,v29,v29
v_lshlrev_b32 v29,16,v6
v_rcp_f32 v29,v29
s_lshl_b32 s60,s46,12
s_sub_u32 s63,s71,s60
s_add_u32 s63,s63,s73
s_lshl_b32 s60,s48,5
s_add_u32 s63,s63,s60
s_add_u32 s63,s63,223649792
v_lshlrev_b32 v6,3,v0
s_cmp_lg_u32 s46,3
s_cbranch_scc1 zs_282
s_mov_b64 exec,15
buffer_store_dwordx2 v[28:29],v6,s[8:11],s63 offen sc1
s_mov_b64 exec,-1
zs_282:
s_lshl_b32 s82,s51,6
s_add_u32 s82,s82,s52
s_lshl_b32 s82,s82,9
s_add_u32 s82,s82,393216
s_lshl_b32 s61,s56,2
s_add_u32 s82,s82,s61
s_add_u32 s50,s50,1
s_cmp_eq_u32 s50,128
s_cbranch_scc1 R1_END
s_mov_b32 s51,s53
s_mov_b32 s52,s54
s_waitcnt vmcnt(4)
v_min_u32 v236,v236,v237
v_cmp_eq_u32 vcc,0,v236
s_nop 0
s_cbranch_vccnz nr_283
s_add_u32 s60,s50,0
v_mov_b32 v239,s60
ds_write_b32 v238,v239
s_mul_i32 s66,s52,491520
s_mul_i32 s60,s48,10240
s_add_u32 s66,s66,s60
s_lshl_b32 s60,s46,10
s_add_u32 s66,s66,s60
s_add_u32 s66,s66,175112192
s_mul_i32 s60,s52,40960
s_add_u32 s60,s60,234749952
s_mul_i32 s61,s52,46080
s_add_u32 s61,s61,209518592
s_cmp_eq_u32 s51,0
s_cselect_b32 s65,s60,s61
s_lshl_b32 s60,s46,12
s_add_u32 s65,s65,s60
s_cmp_lt_u32 s46,2
s_cbranch_scc1 g2_284
v_mov_b32 v120,0
v_mov_b32 v121,0
v_mov_b32 v122,0
v_mov_b32 v123,0
s_nop 0
s_branch g3_285
g2_284:
s_add_u32 s63,s65,32768
buffer_load_dwordx2 v[188:189],v16,s[8:11],s63 offen sc1
s_add_u32 s63,s66,8192
buffer_load_dwordx4 v[120:123],v1,s[8:11],s63 offen sc1
s_add_u32 s63,s66,90112
buffer_load_dwordx4 v[132:135],v1,s[8:11],s63 offen sc1
s_add_u32 s63,s66,172032
buffer_load_dwordx4 v[144:147],v1,s[8:11],s63 offen sc1
s_add_u32 s63,s66,253952
buffer_load_dwordx4 v[156:159],v1,s[8:11],s63 offen sc1
g3_285:
s_add_u32 s63,s65,0
buffer_load_dwordx2 v[184:185],v16,s[8:11],s63 offen sc1
s_add_u32 s63,s65,16384
buffer_load_dwordx2 v[186:187],v16,s[8:11],s63 offen sc1
s_add_u32 s63,s66,0
buffer_load_dwordx4 v[112:115],v1,s[8:11],s63 offen sc1
s_add_u32 s63,s66,4096
buffer_load_dwordx4 v[116:119],v1,s[8:11],s63 offen sc1
s_add_u32 s63,s66,81920
buffer_load_dwordx4 v[124:127],v1,s[8:11],s63 offen sc1
s_add_u32 s63,s66,86016
buffer_load_dwordx4 v[128:131],v1,s[8:11],s63 offen sc1
s_add_u32 s63,s66,163840
buffer_load_dwordx4 v[136:139],v1,s[8:11],s63 offen sc1
s_add_u32 s63,s66,167936
buffer_load_dwordx4 v[140:143],v1,s[8:11],s63 offen sc1
s_add_u32 s63,s66,245760
buffer_load_dwordx4 v[148:151],v1,s[8:11],s63 offen sc1
s_add_u32 s63,s66,249856
buffer_load_dwordx4 v[152:155],v1,s[8:11],s63 offen sc1
s_waitcnt vmcnt(10)
s_mov_b64 exec,1
buffer_store_dword v5,v1,s[8:11],s82 offen sc1
s_mov_b64 exec,-1
s_mov_b32 s55,0
s_branch R1_B
nr_283:
s_mov_b32 s55,1
s_waitcnt vmcnt(0)
s_mov_b64 exec,1
buffer_store_dword v5,v1,s[8:11],s82 offen sc1
s_mov_b64 exec,-1
s_mov_b32 s82,-1
s_lshl_b32 s67,s51,6
s_add_u32 s67,s67,s52
s_mul_i32 s67,s67,640
s_add_u32 s67,s67,819200
s_cmp_lg_u32 s46,0
s_cbranch_scc1 wo_286
fb_288:
buffer_load_dwordx2 v[236:237],v2,s[8:11],s67 offen sc1
s_waitcnt vmcnt(0)
v_min_u32 v236,v236,v237
v_cmp_eq_u32 vcc,0,v236
s_nop 0
s_cbranch_vccz ok_289
s_sleep 7
s_sub_u32 s47,s47,1
s_cbranch_scc1 ABORT
s_branch fb_288
ok_289:
s_add_u32 s60,s50,0
v_mov_b32 v239,s60
ds_write_b32 v238,v239
s_branch wd_287
wo_286:
ds_read_b32 v239,v238
s_waitcnt lgkmcnt(0)
v_cmp_gt_u32 vcc,s50,v239
s_nop 0
s_cbranch_vccz wd_287
s_sleep 1
s_sub_u32 s59,s59,1
s_cbranch_scc1 ABORT
s_branch wo_286
wd_287:
s_mul_i32 s66,s52,491520
s_mul_i32 s60,s48,10240
s_add_u32 s66,s66,s60
s_lshl_b32 s60,s46,10
s_add_u32 s66,s66,s60
s_add_u32 s66,s66,175112192
s_mul_i32 s60,s52,40960
s_add_u32 s60,s60,234749952
s_mul_i32 s61,s52,46080
s_add_u32 s61,s61,209518592
s_cmp_eq_u32 s51,0
s_cselect_b32 s65,s60,s61
s_lshl_b32 s60,s46,12
s_add_u32 s65,s65,s60
s_cmp_lt_u32 s46,2
s_cbranch_scc1 g2_290
v_mov_b32 v120,0
v_mov_b32 v121,0
v_mov_b32 v122,0
v_mov_b32 v123,0
s_nop 0
s_branch g3_291
g2_290:
s_add_u32 s63,s65,32768
buffer_load_dwordx2 v[188:189],v16,s[8:11],s63 offen sc1
s_add_u32 s63,s66,8192
buffer_load_dwordx4 v[120:123],v1,s[8:11],s63 offen sc1
s_add_u32 s63,s66,90112
buffer_load_dwordx4 v[132:135],v1,s[8:11],s63 offen sc1
s_add_u32 s63,s66,172032
buffer_load_dwordx4 v[144:147],v1,s[8:11],s63 offen sc1
s_add_u32 s63,s66,253952
buffer_load_dwordx4 v[156:159],v1,s[8:11],s63 offen sc1
g3_291:
s_add_u32 s63,s65,0
buffer_load_dwordx2 v[184:185],v16,s[8:11],s63 offen sc1
s_add_u32 s63,s65,16384
buffer_load_dwordx2 v[186:187],v16,s[8:11],s63 offen sc1
s_add_u32 s63,s66,0
buffer_load_dwordx4 v[112:115],v1,s[8:11],s63 offen sc1
s_add_u32 s63,s66,4096
buffer_load_dwordx4 v[116:119],v1,s[8:11],s63 offen sc1
s_add_u32 s63,s66,81920
buffer_load_dwordx4 v[124:127],v1,s[8:11],s63 offen sc1
s_add_u32 s63,s66,86016
buffer_load_dwordx4 v[128:131],v1,s[8:11],s63 offen sc1
s_add_u32 s63,s66,163840
buffer_load_dwordx4 v[136:139],v1,s[8:11],s63 offen sc1
s_add_u32 s63,s66,167936
buffer_load_dwordx4 v[140:143],v1,s[8:11],s63 offen sc1
s_add_u32 s63,s66,245760
buffer_load_dwordx4 v[148:151],v1,s[8:11],s63 offen sc1
s_add_u32 s63,s66,249856
buffer_load_dwordx4 v[152:155],v1,s[8:11],s63 offen sc1
s_branch R1_B
R1_B:
s_add_u32 s66,s50,1
s_min_u32 s66,s66,127
s_mov_b32 s53,s80
s_sub_u32 s54,s66,64
s_lshl_b32 s67,s53,6
s_add_u32 s67,s67,s54
s_mul_i32 s67,s67,640
s_add_u32 s67,s67,819200
s_lshl_b32 s60,s51,6
s_add_u32 s60,s60,s52
s_mul_i32 s71,s60,40960
s_mul_i32 s73,s60,5120
s_lshl_b32 s60,s46,12
s_add_u32 s71,s71,s60
s_add_u32 s72,s71,32768
s_add_u32 s72,s72,s68
s_cmp_eq_u32 s55,0
s_cbranch_scc1 r1p_292
s_waitcnt vmcnt(8)
v_lshlrev_b32 v192,16,v184
v_and_b32 v193,0xffff0000,v184
v_lshlrev_b32 v194,16,v185
v_and_b32 v195,0xffff0000,v185
v_lshlrev_b32 v196,16,v186
v_and_b32 v197,0xffff0000,v186
v_lshlrev_b32 v198,16,v187
v_and_b32 v199,0xffff0000,v187
v_lshlrev_b32 v200,16,v188
v_and_b32 v201,0xffff0000,v188
v_lshlrev_b32 v202,16,v189
v_and_b32 v203,0xffff0000,v189
s_waitcnt vmcnt(4)
v_pk_add_f32 v[112:113],v[112:113],v[124:125]
v_pk_add_f32 v[114:115],v[114:115],v[126:127]
v_pk_add_f32 v[116:117],v[116:117],v[128:129]
v_pk_add_f32 v[118:119],v[118:119],v[130:131]
v_pk_add_f32 v[120:121],v[120:121],v[132:133]
v_pk_add_f32 v[122:123],v[122:123],v[134:135]
s_waitcnt vmcnt(2)
v_pk_add_f32 v[112:113],v[112:113],v[136:137]
v_pk_add_f32 v[114:115],v[114:115],v[138:139]
v_pk_add_f32 v[116:117],v[116:117],v[140:141]
v_pk_add_f32 v[118:119],v[118:119],v[142:143]
v_pk_add_f32 v[120:121],v[120:121],v[144:145]
v_pk_add_f32 v[122:123],v[122:123],v[146:147]
s_waitcnt vmcnt(0)
v_pk_add_f32 v[112:113],v[112:113],v[148:149]
v_pk_add_f32 v[114:115],v[114:115],v[150:151]
v_pk_add_f32 v[116:117],v[116:117],v[152:153]
v_pk_add_f32 v[118:119],v[118:119],v[154:155]
v_pk_add_f32 v[120:121],v[120:121],v[156:157]
v_pk_add_f32 v[122:123],v[122:123],v[158:159]
s_nop 0
s_branch r1j_293
r1p_292:
s_waitcnt vmcnt(9)
v_lshlrev_b32 v192,16,v184
v_and_b32 v193,0xffff0000,v184
v_lshlrev_b32 v194,16,v185
v_and_b32 v195,0xffff0000,v185
v_lshlrev_b32 v196,16,v186
v_and_b32 v197,0xffff0000,v186
v_lshlrev_b32 v198,16,v187
v_and_b32 v199,0xffff0000,v187
v_lshlrev_b32 v200,16,v188
v_and_b32 v201,0xffff0000,v188
v_lshlrev_b32 v202,16,v189
v_and_b32 v203,0xffff0000,v189
s_waitcnt vmcnt(5)
v_pk_add_f32 v[112:113],v[112:113],v[124:125]
v_pk_add_f32 v[114:115],v[114:115],v[126:127]
v_pk_add_f32 v[116:117],v[116:117],v[128:129]
v_pk_add_f32 v[118:119],v[118:119],v[130:131]
v_pk_add_f32 v[120:121],v[120:121],v[132:133]
v_pk_add_f32 v[122:123],v[122:123],v[134:135]
s_waitcnt vmcnt(3)
v_pk_add_f32 v[112:113],v[112:113],v[136:137]
v_pk_add_f32 v[114:115],v[114:115],v[138:139]
v_pk_add_f32 v[116:117],v[116:117],v[140:141]
v_pk_add_f32 v[118:119],v[118:119],v[142:143]
v_pk_add_f32 v[120:121],v[120:121],v[144:145]
v_pk_add_f32 v[122:123],v[122:123],v[146:147]
s_waitcnt vmcnt(1)
v_pk_add_f32 v[112:113],v[112:113],v[148:149]
v_pk_add_f32 v[114:115],v[114:115],v[150:151]
v_pk_add_f32 v[116:117],v[116:117],v[152:153]
v_pk_add_f32 v[118:119],v[118:119],v[154:155]
v_pk_add_f32 v[120:121],v[120:121],v[156:157]
v_pk_add_f32 v[122:123],v[122:123],v[158:159]
s_nop 1
r1j_293:
v_cvt_pk_bf16_f32 v6,v112,v113
v_lshlrev_b32 v112,16,v6
v_and_b32 v113,0xffff0000,v6
v_cvt_pk_bf16_f32 v6,v114,v115
v_lshlrev_b32 v114,16,v6
v_and_b32 v115,0xffff0000,v6
v_cvt_pk_bf16_f32 v6,v116,v117
v_lshlrev_b32 v116,16,v6
v_and_b32 v117,0xffff0000,v6
v_cvt_pk_bf16_f32 v6,v118,v119
v_lshlrev_b32 v118,16,v6
v_and_b32 v119,0xffff0000,v6
v_cvt_pk_bf16_f32 v6,v120,v121
v_lshlrev_b32 v120,16,v6
v_and_b32 v121,0xffff0000,v6
v_cvt_pk_bf16_f32 v6,v122,v123
v_lshlrev_b32 v122,16,v6
v_and_b32 v123,0xffff0000,v6
v_pk_add_f32 v[112:113],v[112:113],v[192:193]
v_pk_add_f32 v[114:115],v[114:115],v[194:195]
v_pk_add_f32 v[116:117],v[116:117],v[196:197]
v_pk_add_f32 v[118:119],v[118:119],v[198:199]
v_pk_add_f32 v[120:121],v[120:121],v[200:201]
v_pk_add_f32 v[122:123],v[122:123],v[202:203]
v_cvt_pk_bf16_f32 v204,v112,v113
v_lshlrev_b32 v112,16,v204
v_and_b32 v113,0xffff0000,v204
v_cvt_pk_bf16_f32 v205,v114,v115
v_lshlrev_b32 v114,16,v205
v_and_b32 v115,0xffff0000,v205
v_cvt_pk_bf16_f32 v206,v116,v117
v_lshlrev_b32 v116,16,v206
v_and_b32 v117,0xffff0000,v206
v_cvt_pk_bf16_f32 v207,v118,v119
v_lshlrev_b32 v118,16,v207
v_and_b32 v119,0xffff0000,v207
v_cvt_pk_bf16_f32 v208,v120,v121
v_lshlrev_b32 v120,16,v208
v_and_b32 v121,0xffff0000,v208
v_cvt_pk_bf16_f32 v209,v122,v123
v_lshlrev_b32 v122,16,v209
v_and_b32 v123,0xffff0000,v209
v_pk_add_f32 v[28:29],v[112:113],v[114:115]
v_pk_mul_f32 v[26:27],v[112:113],v[112:113]
v_pk_fma_f32 v[26:27],v[114:115],v[114:115],v[26:27]
v_pk_add_f32 v[28:29],v[28:29],v[116:117]
v_pk_fma_f32 v[26:27],v[116:117],v[116:117],v[26:27]
v_pk_add_f32 v[28:29],v[28:29],v[118:119]
v_pk_fma_f32 v[26:27],v[118:119],v[118:119],v[26:27]
v_pk_add_f32 v[28:29],v[28:29],v[120:121]
v_pk_fma_f32 v[26:27],v[120:121],v[120:121],v[26:27]
v_pk_add_f32 v[28:29],v[28:29],v[122:123]
v_pk_fma_f32 v[26:27],v[122:123],v[122:123],v[26:27]
v_add_f32 v24,v28,v29
v_add_f32 v25,v26,v27
s_nop 0
v_add_f32_dpp v24,v24,v24 row_ror:4 row_mask:0xf bank_mask:0xf
v_add_f32_dpp v25,v25,v25 row_ror:4 row_mask:0xf bank_mask:0xf
s_nop 0
v_add_f32_dpp v24,v24,v24 row_ror:8 row_mask:0xf bank_mask:0xf
v_add_f32_dpp v25,v25,v25 row_ror:8 row_mask:0xf bank_mask:0xf
v_mov_b32 v26,v24
v_mov_b32 v27,v25
s_nop 0
v_permlane32_swap_b32 v24,v26
v_permlane32_swap_b32 v25,v27
v_add_f32 v24,v24,v26
v_add_f32 v25,v25,v27
v_mov_b32 v26,v24
v_mov_b32 v27,v25
s_nop 0
v_permlane16_swap_b32 v24,v26
v_permlane16_swap_b32 v25,v27
v_add_f32 v24,v24,v26
v_add_f32 v25,v25,v27
ds_write_b64 v20,v[24:25] offset:128
s_waitcnt lgkmcnt(0)
s_barrier
ds_read_b128 v[228:231],v21 offset:128
ds_read_b128 v[232:235],v21 offset:144
buffer_load_dwordx2 v[236:237],v2,s[8:11],s67 offen sc1
v_mov_b32 v210,v208
v_mov_b32 v211,v209
s_add_u32 s63,s71,218365952
v_permlane16_swap_b32 v204,v206
v_permlane16_swap_b32 v205,v207
buffer_store_dwordx4 v[204:207],v17,s[8:11],s63 offen sc1
s_add_u32 s63,s72,218365952
v_permlane16_swap_b32 v208,v210
v_permlane16_swap_b32 v209,v211
buffer_store_dwordx4 v[208:211],v18,s[8:11],s63 offen sc1
s_waitcnt lgkmcnt(0)
v_pk_add_f32 v[228:229],v[228:229],v[230:231]
v_pk_add_f32 v[232:233],v[232:233],v[234:235]
v_pk_add_f32 v[24:25],v[228:229],v[232:233]
v_mul_f32 v24,0x3acccccd,v24
v_mul_f32 v25,0x3acccccd,v25
v_fma_f32 v25,-v24,v24,v25
v_max_f32 v25,0,v25
v_mov_b32 v28,v24
v_mov_b32 v29,v25
v_cvt_pk_bf16_f32 v6,v24,v25
v_lshlrev_b32 v24,16,v6
v_and_b32 v25,0xffff0000,v6
v_add_f32 v25,0x3727c5ac,v25
v_cvt_pk_bf16_f32 v6,v25,v25
v_lshlrev_b32 v25,16,v6
v_sqrt_f32 v25,v25
s_nop 0
v_cvt_pk_bf16_f32 v6,v25,v25
v_lshlrev_b32 v25,16,v6
v_rcp_f32 v25,v25
s_nop 0
v_pk_add_f32 v[112:113],v[112:113],v[24:25] op_sel_hi:[1,0] neg_lo:[0,1] neg_hi:[0,1]
v_pk_add_f32 v[114:115],v[114:115],v[24:25] op_sel_hi:[1,0] neg_lo:[0,1] neg_hi:[0,1]
v_pk_add_f32 v[116:117],v[116:117],v[24:25] op_sel_hi:[1,0] neg_lo:[0,1] neg_hi:[0,1]
v_pk_add_f32 v[118:119],v[118:119],v[24:25] op_sel_hi:[1,0] neg_lo:[0,1] neg_hi:[0,1]
v_pk_add_f32 v[120:121],v[120:121],v[24:25] op_sel_hi:[1,0] neg_lo:[0,1] neg_hi:[0,1]
v_pk_add_f32 v[122:123],v[122:123],v[24:25] op_sel_hi:[1,0] neg_lo:[0,1] neg_hi:[0,1]
v_cvt_pk_bf16_f32 v6,v112,v113
v_lshlrev_b32 v112,16,v6
v_and_b32 v113,0xffff0000,v6
v_cvt_pk_bf16_f32 v8,v114,v115
v_lshlrev_b32 v114,16,v8
v_and_b32 v115,0xffff0000,v8
v_cvt_pk_bf16_f32 v6,v116,v117
v_lshlrev_b32 v116,16,v6
v_and_b32 v117,0xffff0000,v6
v_cvt_pk_bf16_f32 v8,v118,v119
v_lshlrev_b32 v118,16,v8
v_and_b32 v119,0xffff0000,v8
v_cvt_pk_bf16_f32 v6,v120,v121
v_lshlrev_b32 v120,16,v6
v_and_b32 v121,0xffff0000,v6
v_cvt_pk_bf16_f32 v8,v122,v123
v_lshlrev_b32 v122,16,v8
v_and_b32 v123,0xffff0000,v8
v_pk_mul_f32 v[112:113],v[112:113],v[24:25] op_sel:[0,1] op_sel_hi:[1,1]
v_pk_mul_f32 v[114:115],v[114:115],v[24:25] op_sel:[0,1] op_sel_hi:[1,1]
v_pk_mul_f32 v[116:117],v[116:117],v[24:25] op_sel:[0,1] op_sel_hi:[1,1]
v_pk_mul_f32 v[118:119],v[118:119],v[24:25] op_sel:[0,1] op_sel_hi:[1,1]
v_pk_mul_f32 v[120:121],v[120:121],v[24:25] op_sel:[0,1] op_sel_hi:[1,1]
v_pk_mul_f32 v[122:123],v[122:123],v[24:25] op_sel:[0,1] op_sel_hi:[1,1]
v_cvt_pk_bf16_f32 v212,v112,v113
v_lshlrev_b32 v112,16,v212
v_and_b32 v113,0xffff0000,v212
v_cvt_pk_bf16_f32 v213,v114,v115
v_lshlrev_b32 v114,16,v213
v_and_b32 v115,0xffff0000,v213
v_cvt_pk_bf16_f32 v214,v116,v117
v_lshlrev_b32 v116,16,v214
v_and_b32 v117,0xffff0000,v214
v_cvt_pk_bf16_f32 v215,v118,v119
v_lshlrev_b32 v118,16,v215
v_and_b32 v119,0xffff0000,v215
v_cvt_pk_bf16_f32 v216,v120,v121
v_lshlrev_b32 v120,16,v216
v_and_b32 v121,0xffff0000,v216
v_cvt_pk_bf16_f32 v217,v122,v123
v_lshlrev_b32 v122,16,v217
v_and_b32 v123,0xffff0000,v217
v_mov_b32 v218,v216
v_mov_b32 v219,v217
s_add_u32 s63,s71,223608832
s_add_u32 s63,s63,s73
v_permlane16_swap_b32 v212,v214
v_permlane16_swap_b32 v213,v215
buffer_store_dwordx4 v[212:215],v17,s[8:11],s63 offen sc1
s_add_u32 s63,s72,223608832
s_add_u32 s63,s63,s73
v_permlane16_swap_b32 v216,v218
v_permlane16_swap_b32 v217,v219
buffer_store_dwordx4 v[216:219],v18,s[8:11],s63 offen sc1
v_sub_f32 v28,v28,v24
v_mul_f32 v29,v29,v25
v_mul_f32 v28,v28,v25
v_mul_f32 v29,v29,v25
v_cvt_pk_bf16_f32 v6,v28,v29
v_lshlrev_b32 v28,16,v6
v_and_b32 v29,0xffff0000,v6
v_add_f32 v29,0x3727c5ac,v29
v_cvt_pk_bf16_f32 v6,v29,v29
v_lshlrev_b32 v29,16,v6
v_sqrt_f32 v29,v29
s_nop 0
v_cvt_pk_bf16_f32 v6,v29,v29
v_lshlrev_b32 v29,16,v6
v_rcp_f32 v29,v29
s_lshl_b32 s60,s46,12
s_sub_u32 s63,s71,s60
s_add_u32 s63,s63,s73
s_lshl_b32 s60,s48,5
s_add_u32 s63,s63,s60
s_add_u32 s63,s63,223649792
v_lshlrev_b32 v6,3,v0
s_cmp_lg_u32 s46,3
s_cbranch_scc1 zs_294
s_mov_b64 exec,15
buffer_store_dwordx2 v[28:29],v6,s[8:11],s63 offen sc1
s_mov_b64 exec,-1
zs_294:
s_lshl_b32 s82,s51,6
s_add_u32 s82,s82,s52
s_lshl_b32 s82,s82,9
s_add_u32 s82,s82,393216
s_lshl_b32 s61,s56,2
s_add_u32 s82,s82,s61
s_add_u32 s50,s50,1
s_cmp_eq_u32 s50,128
s_cbranch_scc1 R1_END
s_mov_b32 s51,s53
s_mov_b32 s52,s54
s_waitcnt vmcnt(4)
v_min_u32 v236,v236,v237
v_cmp_eq_u32 vcc,0,v236
s_nop 0
s_cbranch_vccnz nr_295
s_add_u32 s60,s50,0
v_mov_b32 v239,s60
ds_write_b32 v238,v239
s_mul_i32 s66,s52,491520
s_mul_i32 s60,s48,10240
s_add_u32 s66,s66,s60
s_lshl_b32 s60,s46,10
s_add_u32 s66,s66,s60
s_add_u32 s66,s66,175112192
s_mul_i32 s60,s52,40960
s_add_u32 s60,s60,234749952
s_mul_i32 s61,s52,46080
s_add_u32 s61,s61,209518592
s_cmp_eq_u32 s51,0
s_cselect_b32 s65,s60,s61
s_lshl_b32 s60,s46,12
s_add_u32 s65,s65,s60
s_cmp_lt_u32 s46,2
s_cbranch_scc1 g2_296
v_mov_b32 v40,0
v_mov_b32 v41,0
v_mov_b32 v42,0
v_mov_b32 v43,0
s_nop 0
s_branch g3_297
g2_296:
s_add_u32 s63,s65,32768
buffer_load_dwordx2 v[108:109],v16,s[8:11],s63 offen sc1
s_add_u32 s63,s66,8192
buffer_load_dwordx4 v[40:43],v1,s[8:11],s63 offen sc1
s_add_u32 s63,s66,90112
buffer_load_dwordx4 v[52:55],v1,s[8:11],s63 offen sc1
s_add_u32 s63,s66,172032
buffer_load_dwordx4 v[64:67],v1,s[8:11],s63 offen sc1
s_add_u32 s63,s66,253952
buffer_load_dwordx4 v[76:79],v1,s[8:11],s63 offen sc1
g3_297:
s_add_u32 s63,s65,0
buffer_load_dwordx2 v[104:105],v16,s[8:11],s63 offen sc1
s_add_u32 s63,s65,16384
buffer_load_dwordx2 v[106:107],v16,s[8:11],s63 offen sc1
s_add_u32 s63,s66,0
buffer_load_dwordx4 v[32:35],v1,s[8:11],s63 offen sc1
s_add_u32 s63,s66,4096
buffer_load_dwordx4 v[36:39],v1,s[8:11],s63 offen sc1
s_add_u32 s63,s66,81920
buffer_load_dwordx4 v[44:47],v1,s[8:11],s63 offen sc1
s_add_u32 s63,s66,86016
buffer_load_dwordx4 v[48:51],v1,s[8:11],s63 offen sc1
s_add_u32 s63,s66,163840
buffer_load_dwordx4 v[56:59],v1,s[8:11],s63 offen sc1
s_add_u32 s63,s66,167936
buffer_load_dwordx4 v[60:63],v1,s[8:11],s63 offen sc1
s_add_u32 s63,s66,245760
buffer_load_dwordx4 v[68:71],v1,s[8:11],s63 offen sc1
s_add_u32 s63,s66,249856
buffer_load_dwordx4 v[72:75],v1,s[8:11],s63 offen sc1
s_waitcnt vmcnt(10)
s_mov_b64 exec,1
buffer_store_dword v5,v1,s[8:11],s82 offen sc1
s_mov_b64 exec,-1
s_mov_b32 s55,0
s_branch R1_A
nr_295:
s_mov_b32 s55,1
s_waitcnt vmcnt(0)
s_mov_b64 exec,1
buffer_store_dword v5,v1,s[8:11],s82 offen sc1
s_mov_b64 exec,-1
s_mov_b32 s82,-1
s_lshl_b32 s67,s51,6
s_add_u32 s67,s67,s52
s_mul_i32 s67,s67,640
s_add_u32 s67,s67,819200
s_cmp_lg_u32 s46,0
s_cbranch_scc1 wo_298
fb_300:
buffer_load_dwordx2 v[236:237],v2,s[8:11],s67 offen sc1
s_waitcnt vmcnt(0)
v_min_u32 v236,v236,v237
v_cmp_eq_u32 vcc,0,v236
s_nop 0
s_cbranch_vccz ok_301
s_sleep 7
s_sub_u32 s47,s47,1
s_cbranch_scc1 ABORT
s_branch fb_300
ok_301:
s_add_u32 s60,s50,0
v_mov_b32 v239,s60
ds_write_b32 v238,v239
s_branch wd_299
wo_298:
ds_read_b32 v239,v238
s_waitcnt lgkmcnt(0)
v_cmp_gt_u32 vcc,s50,v239
s_nop 0
s_cbranch_vccz wd_299
s_sleep 1
s_sub_u32 s59,s59,1
s_cbranch_scc1 ABORT
s_branch wo_298
wd_299:
s_mul_i32 s66,s52,491520
s_mul_i32 s60,s48,10240
s_add_u32 s66,s66,s60
s_lshl_b32 s60,s46,10
s_add_u32 s66,s66,s60
s_add_u32 s66,s66,175112192
s_mul_i32 s60,s52,40960
s_add_u32 s60,s60,234749952
s_mul_i32 s61,s52,46080
s_add_u32 s61,s61,209518592
s_cmp_eq_u32 s51,0
s_cselect_b32 s65,s60,s61
s_lshl_b32 s60,s46,12
s_add_u32 s65,s65,s60
s_cmp_lt_u32 s46,2
s_cbranch_scc1 g2_302
v_mov_b32 v40,0
v_mov_b32 v41,0
v_mov_b32 v42,0
v_mov_b32 v43,0
s_nop 0
s_branch g3_303
g2_302:
s_add_u32 s63,s65,32768
buffer_load_dwordx2 v[108:109],v16,s[8:11],s63 offen sc1
s_add_u32 s63,s66,8192
buffer_load_dwordx4 v[40:43],v1,s[8:11],s63 offen sc1
s_add_u32 s63,s66,90112
buffer_load_dwordx4 v[52:55],v1,s[8:11],s63 offen sc1
s_add_u32 s63,s66,172032
buffer_load_dwordx4 v[64:67],v1,s[8:11],s63 offen sc1
s_add_u32 s63,s66,253952
buffer_load_dwordx4 v[76:79],v1,s[8:11],s63 offen sc1
g3_303:
s_add_u32 s63,s65,0
buffer_load_dwordx2 v[104:105],v16,s[8:11],s63 offen sc1
s_add_u32 s63,s65,16384
buffer_load_dwordx2 v[106:107],v16,s[8:11],s63 offen sc1
s_add_u32 s63,s66,0
buffer_load_dwordx4 v[32:35],v1,s[8:11],s63 offen sc1
s_add_u32 s63,s66,4096
buffer_load_dwordx4 v[36:39],v1,s[8:11],s63 offen sc1
s_add_u32 s63,s66,81920
buffer_load_dwordx4 v[44:47],v1,s[8:11],s63 offen sc1
s_add_u32 s63,s66,86016
buffer_load_dwordx4 v[48:51],v1,s[8:11],s63 offen sc1
s_add_u32 s63,s66,163840
buffer_load_dwordx4 v[56:59],v1,s[8:11],s63 offen sc1
s_add_u32 s63,s66,167936
buffer_load_dwordx4 v[60:63],v1,s[8:11],s63 offen sc1
s_add_u32 s63,s66,245760
buffer_load_dwordx4 v[68:71],v1,s[8:11],s63 offen sc1
s_add_u32 s63,s66,249856
buffer_load_dwordx4 v[72:75],v1,s[8:11],s63 offen sc1
s_branch R1_A
R1_END:
s_waitcnt vmcnt(0)
s_mov_b64 exec,1
buffer_store_dword v5,v1,s[8:11],s82 offen sc1
s_mov_b64 exec,-1
s_endpgm
ROLE_W1:
v_lshlrev_b32 v1,4,v0
v_mov_b32 v5,1
s_lshl_b32 s56,s48,2
s_add_u32 s56,s56,s46
v_bfe_u32 v6,v0,2,2
v_lshrrev_b32 v7,4,v0
v_add_u32 v7,v6,v7
v_and_b32 v7,3,v7
v_and_b32 v15,3,v0
v_lshlrev_b32 v15,4,v15
v_lshl_add_u32 v15,v7,6,v15
v_lshl_add_u32 v15,v6,8,v15
v_lshrrev_b32 v6,5,v0
v_bfe_u32 v7,v0,4,1
v_lshlrev_b32 v16,10,v7
v_bfe_u32 v7,v0,2,2
v_lshl_add_u32 v16,v7,8,v16
v_add_u32 v6,v6,v7
v_and_b32 v6,3,v6
v_lshl_add_u32 v16,v6,6,v16
v_and_b32 v6,3,v0
v_lshl_add_u32 v16,v6,4,v16
v_add_u32 v18,46080,v16
v_lshrrev_b32 v6,5,v0
v_bfe_u32 v7,v0,4,1
v_lshlrev_b32 v20,10,v7
v_lshl_add_u32 v20,v6,8,v20
v_and_b32 v6,15,v0
v_lshl_add_u32 v20,v6,4,v20
v_lshrrev_b32 v6,5,v0
v_add_u32 v6,2,v6
v_bfe_u32 v7,v0,4,1
v_lshlrev_b32 v17,10,v7
v_bfe_u32 v7,v0,2,2
v_lshl_add_u32 v17,v7,8,v17
v_add_u32 v6,v6,v7
v_and_b32 v6,3,v6
v_lshl_add_u32 v17,v6,6,v17
v_and_b32 v6,3,v0
v_lshl_add_u32 v17,v6,4,v17
v_add_u32 v19,46080,v17
v_lshrrev_b32 v6,5,v0
v_add_u32 v6,2,v6
v_bfe_u32 v7,v0,4,1
v_lshlrev_b32 v21,10,v7
v_lshl_add_u32 v21,v6,8,v21
v_and_b32 v6,15,v0
v_lshl_add_u32 v21,v6,4,v21
v_min_u32 v2,31,v0
v_lshlrev_b32 v2,2,v2
v_mov_b32 v112,0xc0135761
v_mov_b32 v113,0xbdd2d3e8
s_mov_b32 s68,0xbdd2d3e8
v_mov_b32 v116,0
v_mov_b32 v117,0
v_mov_b32 v118,0
v_mov_b32 v119,0
s_lshl_b32 s60,s56,11
s_add_u32 s61,s60,237699072
buffer_store_dwordx4 v[116:119],v1,s[8:11],s61 offen sc1
buffer_store_dwordx4 v[116:119],v1,s[8:11],s61 offen offset:1024 sc1
s_add_u32 s61,s60,238067712
buffer_store_dwordx4 v[116:119],v1,s[8:11],s61 offen sc1
buffer_store_dwordx4 v[116:119],v1,s[8:11],s61 offen offset:1024 sc1
s_waitcnt vmcnt(0)
s_barrier
s_cmp_lg_u32 s46,0
s_cbranch_scc1 arr_304
v_mov_b32 v6,1
s_lshl_b32 s3,s49,2
v_mov_b32 v7,s3
s_mov_b64 exec,1
buffer_atomic_add v6,v7,s[12:15],0 offen sc1
s_mov_b64 exec,-1
arr_304:
s_lshl_b32 s58,s56,6
s_mul_i32 s63,s46,40960
s_mov_b32 s4,s32
s_mov_b32 s5,s33
s_mov_b32 s6,819200
s_mov_b32 s7,0x20000
v_lshrrev_b32 v9,2,v0
s_mov_b32 s64,1280
v_mul_lo_u32 v9,v9,s64
v_and_b32 v10,3,v0
v_lshl_add_u32 v6,v10,4,v9
s_add_u32 m0,s63,0
s_add_u32 s65,s58,0
buffer_load_dwordx4 v6,s[4:7],s65 offen lds
s_add_u32 m0,s63,1024
s_add_u32 s65,s58,20480
buffer_load_dwordx4 v6,s[4:7],s65 offen lds
s_add_u32 m0,s63,2048
s_add_u32 s65,s58,40960
buffer_load_dwordx4 v6,s[4:7],s65 offen lds
s_add_u32 m0,s63,3072
s_add_u32 s65,s58,61440
buffer_load_dwordx4 v6,s[4:7],s65 offen lds
s_add_u32 m0,s63,4096
s_add_u32 s65,s58,81920
buffer_load_dwordx4 v6,s[4:7],s65 offen lds
s_add_u32 m0,s63,5120
s_add_u32 s65,s58,102400
buffer_load_dwordx4 v6,s[4:7],s65 offen lds
s_add_u32 m0,s63,6144
s_add_u32 s65,s58,122880
buffer_load_dwordx4 v6,s[4:7],s65 offen lds
s_add_u32 m0,s63,7168
s_add_u32 s65,s58,143360
buffer_load_dwordx4 v6,s[4:7],s65 offen lds
s_add_u32 m0,s63,8192
s_add_u32 s65,s58,163840
buffer_load_dwordx4 v6,s[4:7],s65 offen lds
s_add_u32 m0,s63,9216
s_add_u32 s65,s58,184320
buffer_load_dwordx4 v6,s[4:7],s65 offen lds
s_add_u32 m0,s63,10240
s_add_u32 s65,s58,204800
buffer_load_dwordx4 v6,s[4:7],s65 offen lds
s_add_u32 m0,s63,11264
s_add_u32 s65,s58,225280
buffer_load_dwordx4 v6,s[4:7],s65 offen lds
s_add_u32 m0,s63,12288
s_add_u32 s65,s58,245760
buffer_load_dwordx4 v6,s[4:7],s65 offen lds
s_add_u32 m0,s63,13312
s_add_u32 s65,s58,266240
buffer_load_dwordx4 v6,s[4:7],s65 offen lds
s_add_u32 m0,s63,14336
s_add_u32 s65,s58,286720
buffer_load_dwordx4 v6,s[4:7],s65 offen lds
s_add_u32 m0,s63,15360
s_add_u32 s65,s58,307200
buffer_load_dwordx4 v6,s[4:7],s65 offen lds
s_add_u32 m0,s63,16384
s_add_u32 s65,s58,327680
buffer_load_dwordx4 v6,s[4:7],s65 offen lds
s_add_u32 m0,s63,17408
s_add_u32 s65,s58,348160
buffer_load_dwordx4 v6,s[4:7],s65 offen lds
s_add_u32 m0,s63,18432
s_add_u32 s65,s58,368640
buffer_load_dwordx4 v6,s[4:7],s65 offen lds
s_add_u32 m0,s63,19456
s_add_u32 s65,s58,389120
buffer_load_dwordx4 v6,s[4:7],s65 offen lds
s_add_u32 m0,s63,20480
s_add_u32 s65,s58,409600
buffer_load_dwordx4 v6,s[4:7],s65 offen lds
s_add_u32 m0,s63,21504
s_add_u32 s65,s58,430080
buffer_load_dwordx4 v6,s[4:7],s65 offen lds
s_add_u32 m0,s63,22528
s_add_u32 s65,s58,450560
buffer_load_dwordx4 v6,s[4:7],s65 offen lds
s_add_u32 m0,s63,23552
s_add_u32 s65,s58,471040
buffer_load_dwordx4 v6,s[4:7],s65 offen lds
s_add_u32 m0,s63,24576
s_add_u32 s65,s58,491520
buffer_load_dwordx4 v6,s[4:7],s65 offen lds
s_add_u32 m0,s63,25600
s_add_u32 s65,s58,512000
buffer_load_dwordx4 v6,s[4:7],s65 offen lds
s_add_u32 m0,s63,26624
s_add_u32 s65,s58,532480
buffer_load_dwordx4 v6,s[4:7],s65 offen lds
s_add_u32 m0,s63,27648
s_add_u32 s65,s58,552960
buffer_load_dwordx4 v6,s[4:7],s65 offen lds
s_add_u32 m0,s63,28672
s_add_u32 s65,s58,573440
buffer_load_dwordx4 v6,s[4:7],s65 offen lds
s_add_u32 m0,s63,29696
s_add_u32 s65,s58,593920
buffer_load_dwordx4 v6,s[4:7],s65 offen lds
s_add_u32 m0,s63,30720
s_add_u32 s65,s58,614400
buffer_load_dwordx4 v6,s[4:7],s65 offen lds
s_add_u32 m0,s63,31744
s_add_u32 s65,s58,634880
buffer_load_dwordx4 v6,s[4:7],s65 offen lds
s_add_u32 m0,s63,32768
s_add_u32 s65,s58,655360
buffer_load_dwordx4 v6,s[4:7],s65 offen lds
s_add_u32 m0,s63,33792
s_add_u32 s65,s58,675840
buffer_load_dwordx4 v6,s[4:7],s65 offen lds
s_add_u32 m0,s63,34816
s_add_u32 s65,s58,696320
buffer_load_dwordx4 v6,s[4:7],s65 offen lds
s_add_u32 m0,s63,35840
s_add_u32 s65,s58,716800
buffer_load_dwordx4 v6,s[4:7],s65 offen lds
s_add_u32 m0,s63,36864
s_add_u32 s65,s58,737280
buffer_load_dwordx4 v6,s[4:7],s65 offen lds
s_add_u32 m0,s63,37888
s_add_u32 s65,s58,757760
buffer_load_dwordx4 v6,s[4:7],s65 offen lds
s_add_u32 m0,s63,38912
s_add_u32 s65,s58,778240
buffer_load_dwordx4 v6,s[4:7],s65 offen lds
s_add_u32 m0,s63,39936
s_add_u32 s65,s58,798720
buffer_load_dwordx4 v6,s[4:7],s65 offen lds
s_waitcnt vmcnt(20)
v_bfe_u32 v9,v0,2,2
v_lshrrev_b32 v10,5,v0
v_lshl_add_u32 v9,v10,2,v9
v_mul_u32_u24 v9,64,v9
v_and_b32 v10,1,v0
v_lshl_add_u32 v9,v10,3,v9
v_bfe_u32 v10,v0,1,1
v_lshl_add_u32 v9,v10,5,v9
v_bfe_u32 v10,v0,4,1
v_lshl_add_u32 v9,v10,4,v9
v_add_u32 v7,s63,v9
ds_read_b64_tr_b16 a[0:1],v7 offset:0
ds_read_b64_tr_b16 a[2:3],v7 offset:1024
ds_read_b64_tr_b16 a[4:5],v7 offset:512
ds_read_b64_tr_b16 a[6:7],v7 offset:1536
ds_read_b64_tr_b16 a[8:9],v7 offset:2048
ds_read_b64_tr_b16 a[10:11],v7 offset:3072
ds_read_b64_tr_b16 a[12:13],v7 offset:2560
ds_read_b64_tr_b16 a[14:15],v7 offset:3584
ds_read_b64_tr_b16 a[16:17],v7 offset:4096
ds_read_b64_tr_b16 a[18:19],v7 offset:5120
ds_read_b64_tr_b16 a[20:21],v7 offset:4608
ds_read_b64_tr_b16 a[22:23],v7 offset:5632
s_waitcnt lgkmcnt(4)
ds_read_b64_tr_b16 a[24:25],v7 offset:6144
ds_read_b64_tr_b16 a[26:27],v7 offset:7168
ds_read_b64_tr_b16 a[28:29],v7 offset:6656
ds_read_b64_tr_b16 a[30:31],v7 offset:7680
ds_read_b64_tr_b16 a[32:33],v7 offset:8192
ds_read_b64_tr_b16 a[34:35],v7 offset:9216
ds_read_b64_tr_b16 a[36:37],v7 offset:8704
ds_read_b64_tr_b16 a[38:39],v7 offset:9728
ds_read_b64_tr_b16 a[40:41],v7 offset:10240
ds_read_b64_tr_b16 a[42:43],v7 offset:11264
ds_read_b64_tr_b16 a[44:45],v7 offset:10752
ds_read_b64_tr_b16 a[46:47],v7 offset:11776
s_waitcnt lgkmcnt(4)
ds_read_b64_tr_b16 a[48:49],v7 offset:12288
ds_read_b64_tr_b16 a[50:51],v7 offset:13312
ds_read_b64_tr_b16 a[52:53],v7 offset:12800
ds_read_b64_tr_b16 a[54:55],v7 offset:13824
ds_read_b64_tr_b16 a[56:57],v7 offset:14336
ds_read_b64_tr_b16 a[58:59],v7 offset:15360
ds_read_b64_tr_b16 a[60:61],v7 offset:14848
ds_read_b64_tr_b16 a[62:63],v7 offset:15872
ds_read_b64_tr_b16 a[64:65],v7 offset:16384
ds_read_b64_tr_b16 a[66:67],v7 offset:17408
ds_read_b64_tr_b16 a[68:69],v7 offset:16896
ds_read_b64_tr_b16 a[70:71],v7 offset:17920
s_waitcnt lgkmcnt(4)
ds_read_b64_tr_b16 a[72:73],v7 offset:18432
ds_read_b64_tr_b16 a[74:75],v7 offset:19456
ds_read_b64_tr_b16 a[76:77],v7 offset:18944
ds_read_b64_tr_b16 a[78:79],v7 offset:19968
s_waitcnt lgkmcnt(0)
s_waitcnt vmcnt(0)
v_bfe_u32 v9,v0,2,2
v_lshrrev_b32 v10,5,v0
v_lshl_add_u32 v9,v10,2,v9
v_mul_u32_u24 v9,64,v9
v_and_b32 v10,1,v0
v_lshl_add_u32 v9,v10,3,v9
v_bfe_u32 v10,v0,1,1
v_lshl_add_u32 v9,v10,5,v9
v_bfe_u32 v10,v0,4,1
v_lshl_add_u32 v9,v10,4,v9
v_add_u32 v7,s63,v9
ds_read_b64_tr_b16 a[80:81],v7 offset:20480
ds_read_b64_tr_b16 a[82:83],v7 offset:21504
ds_read_b64_tr_b16 a[84:85],v7 offset:20992
ds_read_b64_tr_b16 a[86:87],v7 offset:22016
ds_read_b64_tr_b16 a[88:89],v7 offset:22528
ds_read_b64_tr_b16 a[90:91],v7 offset:23552
ds_read_b64_tr_b16 a[92:93],v7 offset:23040
ds_read_b64_tr_b16 a[94:95],v7 offset:24064
ds_read_b64_tr_b16 a[96:97],v7 offset:24576
ds_read_b64_tr_b16 a[98:99],v7 offset:25600
ds_read_b64_tr_b16 a[100:101],v7 offset:25088
ds_read_b64_tr_b16 a[102:103],v7 offset:26112
s_waitcnt lgkmcnt(4)
ds_read_b64_tr_b16 a[104:105],v7 offset:26624
ds_read_b64_tr_b16 a[106:107],v7 offset:27648
ds_read_b64_tr_b16 a[108:109],v7 offset:27136
ds_read_b64_tr_b16 a[110:111],v7 offset:28160
ds_read_b64_tr_b16 a[112:113],v7 offset:28672
ds_read_b64_tr_b16 a[114:115],v7 offset:29696
ds_read_b64_tr_b16 a[116:117],v7 offset:29184
ds_read_b64_tr_b16 a[118:119],v7 offset:30208
ds_read_b64_tr_b16 a[120:121],v7 offset:30720
ds_read_b64_tr_b16 a[122:123],v7 offset:31744
ds_read_b64_tr_b16 a[124:125],v7 offset:31232
ds_read_b64_tr_b16 a[126:127],v7 offset:32256
s_waitcnt lgkmcnt(4)
ds_read_b64_tr_b16 a[128:129],v7 offset:32768
ds_read_b64_tr_b16 a[130:131],v7 offset:33792
ds_read_b64_tr_b16 a[132:133],v7 offset:33280
ds_read_b64_tr_b16 a[134:135],v7 offset:34304
ds_read_b64_tr_b16 a[136:137],v7 offset:34816
ds_read_b64_tr_b16 a[138:139],v7 offset:35840
ds_read_b64_tr_b16 a[140:141],v7 offset:35328
ds_read_b64_tr_b16 a[142:143],v7 offset:36352
ds_read_b64_tr_b16 a[144:145],v7 offset:36864
ds_read_b64_tr_b16 a[146:147],v7 offset:37888
ds_read_b64_tr_b16 a[148:149],v7 offset:37376
ds_read_b64_tr_b16 a[150:151],v7 offset:38400
s_waitcnt lgkmcnt(4)
ds_read_b64_tr_b16 a[152:153],v7 offset:38912
ds_read_b64_tr_b16 a[154:155],v7 offset:39936
ds_read_b64_tr_b16 a[156:157],v7 offset:39424
ds_read_b64_tr_b16 a[158:159],v7 offset:40448
s_waitcnt lgkmcnt(0)
v_mov_b32 v24,0x3f803f80
v_mov_b32 v25,0x3f803f80
v_mov_b32 v26,0x3f803f80
v_mov_b32 v27,0x3f803f80
s_nop 1
v_mfma_f32_32x32x16_bf16 v[144:159],a[0:3],v[24:27],0
v_mfma_f32_32x32x16_bf16 v[144:159],a[4:7],v[24:27],v[144:159]
v_mfma_f32_32x32x16_bf16 v[144:159],a[8:11],v[24:27],v[144:159]
v_mfma_f32_32x32x16_bf16 v[144:159],a[12:15],v[24:27],v[144:159]
v_mfma_f32_32x32x16_bf16 v[144:159],a[16:19],v[24:27],v[144:159]
v_mfma_f32_32x32x16_bf16 v[144:159],a[20:23],v[24:27],v[144:159]
v_mfma_f32_32x32x16_bf16 v[144:159],a[24:27],v[24:27],v[144:159]
v_mfma_f32_32x32x16_bf16 v[144:159],a[28:31],v[24:27],v[144:159]
v_mfma_f32_32x32x16_bf16 v[144:159],a[32:35],v[24:27],v[144:159]
v_mfma_f32_32x32x16_bf16 v[144:159],a[36:39],v[24:27],v[144:159]
v_mfma_f32_32x32x16_bf16 v[144:159],a[40:43],v[24:27],v[144:159]
v_mfma_f32_32x32x16_bf16 v[144:159],a[44:47],v[24:27],v[144:159]
v_mfma_f32_32x32x16_bf16 v[144:159],a[48:51],v[24:27],v[144:159]
v_mfma_f32_32x32x16_bf16 v[144:159],a[52:55],v[24:27],v[144:159]
v_mfma_f32_32x32x16_bf16 v[144:159],a[56:59],v[24:27],v[144:159]
v_mfma_f32_32x32x16_bf16 v[144:159],a[60:63],v[24:27],v[144:159]
v_mfma_f32_32x32x16_bf16 v[144:159],a[64:67],v[24:27],v[144:159]
v_mfma_f32_32x32x16_bf16 v[144:159],a[68:71],v[24:27],v[144:159]
v_mfma_f32_32x32x16_bf16 v[144:159],a[72:75],v[24:27],v[144:159]
v_mfma_f32_32x32x16_bf16 v[144:159],a[76:79],v[24:27],v[144:159]
v_mfma_f32_32x32x16_bf16 v[144:159],a[80:83],v[24:27],v[144:159]
v_mfma_f32_32x32x16_bf16 v[144:159],a[84:87],v[24:27],v[144:159]
v_mfma_f32_32x32x16_bf16 v[144:159],a[88:91],v[24:27],v[144:159]
v_mfma_f32_32x32x16_bf16 v[144:159],a[92:95],v[24:27],v[144:159]
v_mfma_f32_32x32x16_bf16 v[144:159],a[96:99],v[24:27],v[144:159]
v_mfma_f32_32x32x16_bf16 v[144:159],a[100:103],v[24:27],v[144:159]
v_mfma_f32_32x32x16_bf16 v[144:159],a[104:107],v[24:27],v[144:159]
v_mfma_f32_32x32x16_bf16 v[144:159],a[108:111],v[24:27],v[144:159]
v_mfma_f32_32x32x16_bf16 v[144:159],a[112:115],v[24:27],v[144:159]
v_mfma_f32_32x32x16_bf16 v[144:159],a[116:119],v[24:27],v[144:159]
v_mfma_f32_32x32x16_bf16 v[144:159],a[120:123],v[24:27],v[144:159]
v_mfma_f32_32x32x16_bf16 v[144:159],a[124:127],v[24:27],v[144:159]
v_mfma_f32_32x32x16_bf16 v[144:159],a[128:131],v[24:27],v[144:159]
v_mfma_f32_32x32x16_bf16 v[144:159],a[132:135],v[24:27],v[144:159]
v_mfma_f32_32x32x16_bf16 v[144:159],a[136:139],v[24:27],v[144:159]
v_mfma_f32_32x32x16_bf16 v[144:159],a[140:143],v[24:27],v[144:159]
v_mfma_f32_32x32x16_bf16 v[144:159],a[144:147],v[24:27],v[144:159]
v_mfma_f32_32x32x16_bf16 v[144:159],a[148:151],v[24:27],v[144:159]
v_mfma_f32_32x32x16_bf16 v[144:159],a[152:155],v[24:27],v[144:159]
v_mfma_f32_32x32x16_bf16 v[144:159],a[156:159],v[24:27],v[144:159]
v_and_b32 v182,31,v0
v_lshlrev_b32 v182,3,v182
v_add_u32 v182,0xa000,v182
s_barrier
s_lshl_b32 s3,s49,2
v_mov_b32 v7,s3
s_nop 5
ibw_305:
buffer_load_dword v6,v7,s[12:15],0 offen sc1
s_waitcnt vmcnt(0)
v_cmp_ne_u32 vcc,256,v6
s_nop 0
s_cbranch_vccz ok_306
s_sleep 8
s_sub_u32 s47,s47,1
s_cbranch_scc1 ABORT
s_branch ibw_305
ok_306:
s_cmp_lg_u32 s49,0
s_cbranch_scc1 ibok_307
v_and_b32 v7,7,v0
v_lshlrev_b32 v7,2,v7
buffer_load_dword v6,v7,s[12:15],0 offen offset:32 sc1
s_waitcnt vmcnt(0)
v_cmp_ne_u32 vcc,32,v6
s_nop 0
s_cbranch_vccz ibok_307
s_barrier
s_mov_b32 s49,1
s_mov_b32 s3,s2
s_load_dwordx16 s[16:31],s[0:1],0
s_load_dwordx8 s[32:39],s[0:1],64
s_waitcnt lgkmcnt(0)
s_branch DISPATCH
ibok_307:
s_mov_b32 s50,0
s_mov_b32 s32,0
s_mov_b32 s57,0
s_mov_b32 s59,2147483648
s_mov_b32 s82,2147483648
s_mov_b32 s39,2147483648
v_mov_b32 v22,94208
v_lshl_add_u32 v22,v0,2,v22
v_mov_b32 v23,0
ds_write_b32 v22,v23
s_mov_b32 s39,1600000
v_and_b32 v72,15,v0
v_lshlrev_b32 v72,7,v72
v_min_u32 v6,51,v0
v_lshlrev_b32 v6,2,v6
v_add_u32 v2,0,v6
v_add_u32 v7,127360,v6
v_cmp_gt_u32 s[78:79],32,v0
s_nop 1
v_cndmask_b32 v2,v7,v2,s[78:79]
s_mov_b32 s51,0
s_mov_b32 s52,0
s_mul_i32 s62,s51,9
s_and_b32 s63,s52,7
s_add_u32 s62,s62,s63
s_mul_i32 s62,s62,40960
s_add_u32 s62,s62,237371392
s_lshl_b32 s63,s56,11
s_add_u32 s62,s62,s63
buffer_load_dword v73,v72,s[8:11],s62 offen sc1
s_mov_b32 s51,0
s_mov_b32 s52,1
s_mul_i32 s62,s51,9
s_and_b32 s63,s52,7
s_add_u32 s62,s62,s63
s_mul_i32 s62,s62,40960
s_add_u32 s62,s62,237371392
s_lshl_b32 s63,s56,11
s_add_u32 s62,s62,s63
buffer_load_dword v73,v72,s[8:11],s62 offen sc1
s_mov_b32 s51,0
s_mov_b32 s52,2
s_mul_i32 s62,s51,9
s_and_b32 s63,s52,7
s_add_u32 s62,s62,s63
s_mul_i32 s62,s62,40960
s_add_u32 s62,s62,237371392
s_lshl_b32 s63,s56,11
s_add_u32 s62,s62,s63
buffer_load_dword v73,v72,s[8:11],s62 offen sc1
s_mov_b32 s51,0
s_mov_b32 s52,3
s_mul_i32 s62,s51,9
s_and_b32 s63,s52,7
s_add_u32 s62,s62,s63
s_mul_i32 s62,s62,40960
s_add_u32 s62,s62,237371392
s_lshl_b32 s63,s56,11
s_add_u32 s62,s62,s63
buffer_load_dword v73,v72,s[8:11],s62 offen sc1
s_mov_b32 s51,0
s_mov_b32 s52,4
s_mul_i32 s62,s51,9
s_and_b32 s63,s52,7
s_add_u32 s62,s62,s63
s_mul_i32 s62,s62,40960
s_add_u32 s62,s62,237371392
s_lshl_b32 s63,s56,11
s_add_u32 s62,s62,s63
buffer_load_dword v73,v72,s[8:11],s62 offen sc1
s_mov_b32 s51,0
s_mov_b32 s52,5
s_mul_i32 s62,s51,9
s_and_b32 s63,s52,7
s_add_u32 s62,s62,s63
s_mul_i32 s62,s62,40960
s_add_u32 s62,s62,237371392
s_lshl_b32 s63,s56,11
s_add_u32 s62,s62,s63
buffer_load_dword v73,v72,s[8:11],s62 offen sc1
s_mov_b32 s51,0
s_mov_b32 s52,6
s_mul_i32 s62,s51,9
s_and_b32 s63,s52,7
s_add_u32 s62,s62,s63
s_mul_i32 s62,s62,40960
s_add_u32 s62,s62,237371392
s_lshl_b32 s63,s56,11
s_add_u32 s62,s62,s63
buffer_load_dword v73,v72,s[8:11],s62 offen sc1
s_mov_b32 s51,0
s_mov_b32 s52,7
s_mul_i32 s62,s51,9
s_and_b32 s63,s52,7
s_add_u32 s62,s62,s63
s_mul_i32 s62,s62,40960
s_add_u32 s62,s62,237371392
s_lshl_b32 s63,s56,11
s_add_u32 s62,s62,s63
buffer_load_dword v73,v72,s[8:11],s62 offen sc1
s_mov_b32 s51,1
s_mov_b32 s52,0
s_mul_i32 s62,s51,9
s_and_b32 s63,s52,7
s_add_u32 s62,s62,s63
s_mul_i32 s62,s62,40960
s_add_u32 s62,s62,237371392
s_lshl_b32 s63,s56,11
s_add_u32 s62,s62,s63
buffer_load_dword v73,v72,s[8:11],s62 offen sc1
s_mov_b32 s51,1
s_mov_b32 s52,1
s_mul_i32 s62,s51,9
s_and_b32 s63,s52,7
s_add_u32 s62,s62,s63
s_mul_i32 s62,s62,40960
s_add_u32 s62,s62,237371392
s_lshl_b32 s63,s56,11
s_add_u32 s62,s62,s63
buffer_load_dword v73,v72,s[8:11],s62 offen sc1
s_mov_b32 s51,1
s_mov_b32 s52,2
s_mul_i32 s62,s51,9
s_and_b32 s63,s52,7
s_add_u32 s62,s62,s63
s_mul_i32 s62,s62,40960
s_add_u32 s62,s62,237371392
s_lshl_b32 s63,s56,11
s_add_u32 s62,s62,s63
buffer_load_dword v73,v72,s[8:11],s62 offen sc1
s_mov_b32 s51,1
s_mov_b32 s52,3
s_mul_i32 s62,s51,9
s_and_b32 s63,s52,7
s_add_u32 s62,s62,s63
s_mul_i32 s62,s62,40960
s_add_u32 s62,s62,237371392
s_lshl_b32 s63,s56,11
s_add_u32 s62,s62,s63
buffer_load_dword v73,v72,s[8:11],s62 offen sc1
s_mov_b32 s51,1
s_mov_b32 s52,4
s_mul_i32 s62,s51,9
s_and_b32 s63,s52,7
s_add_u32 s62,s62,s63
s_mul_i32 s62,s62,40960
s_add_u32 s62,s62,237371392
s_lshl_b32 s63,s56,11
s_add_u32 s62,s62,s63
buffer_load_dword v73,v72,s[8:11],s62 offen sc1
s_mov_b32 s51,1
s_mov_b32 s52,5
s_mul_i32 s62,s51,9
s_and_b32 s63,s52,7
s_add_u32 s62,s62,s63
s_mul_i32 s62,s62,40960
s_add_u32 s62,s62,237371392
s_lshl_b32 s63,s56,11
s_add_u32 s62,s62,s63
buffer_load_dword v73,v72,s[8:11],s62 offen sc1
s_mov_b32 s51,1
s_mov_b32 s52,6
s_mul_i32 s62,s51,9
s_and_b32 s63,s52,7
s_add_u32 s62,s62,s63
s_mul_i32 s62,s62,40960
s_add_u32 s62,s62,237371392
s_lshl_b32 s63,s56,11
s_add_u32 s62,s62,s63
buffer_load_dword v73,v72,s[8:11],s62 offen sc1
s_mov_b32 s51,1
s_mov_b32 s52,7
s_mul_i32 s62,s51,9
s_and_b32 s63,s52,7
s_add_u32 s62,s62,s63
s_mul_i32 s62,s62,40960
s_add_u32 s62,s62,237371392
s_lshl_b32 s63,s56,11
s_add_u32 s62,s62,s63
buffer_load_dword v73,v72,s[8:11],s62 offen sc1
s_waitcnt vmcnt(0)
s_waitcnt lgkmcnt(0)
s_barrier
s_mov_b32 s83,s100
s_min_u32 s62,s32,127
s_sub_u32 s60,s62,14
s_lshr_b32 s34,s60,1
s_and_b32 s33,s60,1
s_cmp_eq_u32 s33,0
s_cselect_b32 s61,14,0
s_add_u32 s34,s34,s61
s_sub_u32 s61,s60,50
s_cmp_ge_u32 s60,100
s_cselect_b32 s34,s61,s34
s_cselect_b32 s33,1,s33
s_cmp_lt_u32 s62,14
s_cselect_b32 s34,s62,s34
s_cselect_b32 s33,0,s33
s_lshl_b32 s35,s33,6
s_add_u32 s35,s35,s34
s_lshl_b32 s35,s35,9
s_add_u32 s35,s35,393216
s_cmp_lt_u32 s34,7
s_cselect_b64 s[76:77],s[78:79],-1
s_sub_u32 s57,46080,s57
v_swap_b32 v16,v18
v_swap_b32 v17,v19
s_add_u32 s62,s32,1
s_min_u32 s62,s62,127
s_sub_u32 s60,s62,14
s_lshr_b32 s41,s60,1
s_and_b32 s40,s60,1
s_cmp_eq_u32 s40,0
s_cselect_b32 s61,14,0
s_add_u32 s41,s41,s61
s_sub_u32 s61,s60,50
s_cmp_ge_u32 s60,100
s_cselect_b32 s41,s61,s41
s_cselect_b32 s40,1,s40
s_cmp_lt_u32 s62,14
s_cselect_b32 s41,s62,s41
s_cselect_b32 s40,0,s40
s_lshl_b32 s42,s40,6
s_add_u32 s42,s42,s41
s_lshl_b32 s42,s42,9
s_add_u32 s42,s42,393216
s_cmp_lt_u32 s41,7
s_cselect_b64 s[80:81],s[78:79],-1
W1_COLD:
s_mov_b32 s37,0
s_cmp_lg_u32 s46,0
s_cbranch_scc1 wo_308
fb_310:
buffer_load_dword v3,v2,s[8:11],s35 offen sc1
s_waitcnt vmcnt(0)
v_cmp_eq_u32 vcc,0,v3
s_and_b64 vcc,vcc,s[76:77]
s_cbranch_scc0 ok_311
s_sleep 7
s_sub_u32 s47,s47,1
s_cbranch_scc1 ABORT
s_branch fb_310
ok_311:
W1_COLD2:
s_add_u32 s65,s32,1
s_or_b32 s65,s65,s37
v_mov_b32 v23,s65
ds_max_i32 v22,v23
s_branch wd_309
wo_308:
ds_read_b32 v23,v22
s_waitcnt lgkmcnt(0)
v_cmp_ge_u32 vcc,s32,v23
s_nop 0
s_cbranch_vccz wd_309
s_sleep 1
s_sub_u32 s39,s39,1
s_cbranch_scc1 ABORT
s_branch wo_308
wd_309:
s_sub_u32 s66,46080,s57
s_lshl_b32 s60,s33,6
s_add_u32 s60,s60,s34
s_mul_i32 s60,s60,46080
s_add_u32 s60,s60,s37
s_add_u32 s60,s60,223608832
s_mov_b32 s67,s60
s_mul_i32 s61,s46,10240
s_add_u32 s60,s60,s61
s_add_u32 s61,s61,s66
s_add_u32 m0,s61,0
s_add_u32 s63,s60,0
buffer_load_dwordx4 v1,s[8:11],s63 offen sc1 lds
buffer_load_dwordx4 v1,s[8:11],s63 offen offset:1024 sc1 lds
buffer_load_dwordx4 v1,s[8:11],s63 offen offset:2048 sc1 lds
buffer_load_dwordx4 v1,s[8:11],s63 offen offset:3072 sc1 lds
s_add_u32 m0,s61,4096
s_add_u32 s63,s60,4096
buffer_load_dwordx4 v1,s[8:11],s63 offen sc1 lds
buffer_load_dwordx4 v1,s[8:11],s63 offen offset:1024 sc1 lds
s_waitcnt vmcnt(6)
s_mov_b64 exec,1
s_cmp_lg_u32 s49,0
s_cbranch_scc0 ls_312
buffer_store_dword v5,v1,s[8:11],s59 offen sc1
s_branch ls_313
ls_312:
buffer_store_dword v5,v1,s[8:11],s59 offen
ls_313:
s_mov_b64 exec,-1
s_mov_b32 s59,2147483648
buffer_load_dwordx4 v1,s[8:11],s63 offen offset:2048 sc1 lds
buffer_load_dwordx4 v1,s[8:11],s63 offen offset:3072 sc1 lds
s_add_u32 m0,s61,8192
s_add_u32 s63,s60,8192
buffer_load_dwordx4 v1,s[8:11],s63 offen sc1 lds
buffer_load_dwordx4 v1,s[8:11],s63 offen offset:1024 sc1 lds
s_add_u32 m0,s66,40960
s_add_u32 s63,s67,40960
buffer_load_dwordx4 v1,s[8:11],s63 offen sc1 lds
s_mov_b32 s35,s42
buffer_load_dword v3,v2,s[8:11],s35 offen sc1
s_mov_b32 s53,s33
s_mov_b32 s54,s34
s_add_u32 s32,s32,1
s_mov_b32 s33,s40
s_mov_b32 s34,s41
s_mov_b64 s[76:77],s[80:81]
s_sub_u32 s57,46080,s57
v_swap_b32 v16,v18
v_swap_b32 v17,v19
s_mov_b32 s51,s53
s_mov_b32 s52,s54
s_mov_b32 s37,2147483648
s_waitcnt vmcnt(7)
s_branch W1_GO
W1_NEXT:
s_sub_u32 s57,46080,s57
v_swap_b32 v16,v18
v_swap_b32 v17,v19
s_mov_b32 s51,s53
s_mov_b32 s52,s54
s_waitcnt vmcnt(2)
v_cmp_eq_u32 vcc,0,v3
s_and_b64 vcc,vcc,s[76:77]
s_cselect_b32 s37,2147483648,0
s_cmp_lt_u32 s32,128
s_cselect_b32 s37,s37,2147483648
W1_GO:
s_barrier
ds_read_b128 v[24:27],v16 offset:0
ds_read_b128 v[28:31],v17 offset:0
ds_read_b128 v[32:35],v16 offset:10240
ds_read_b128 v[36:39],v17 offset:10240
ds_read_b128 v[40:43],v16 offset:20480
ds_read_b128 v[44:47],v17 offset:20480
ds_read_b128 v[48:51],v16 offset:30720
s_waitcnt lgkmcnt(6)
v_mfma_f32_32x32x16_bf16 v[56:71],a[0:3],v[24:27],0
ds_read_b128 v[52:55],v17 offset:30720
s_add_u32 s65,s32,1
s_or_b32 s65,s65,s37
v_mov_b32 v23,s65
s_waitcnt lgkmcnt(6)
v_mfma_f32_32x32x16_bf16 v[56:71],a[4:7],v[28:31],v[56:71]
ds_read_b128 v[24:27],v16 offset:2048
ds_max_i32 v22,v23
s_sub_u32 s66,46080,s57
s_waitcnt lgkmcnt(6)
v_mfma_f32_32x32x16_bf16 v[56:71],a[40:43],v[32:35],v[56:71]
ds_read_b128 v[28:31],v17 offset:2048
s_lshl_b32 s60,s33,6
s_add_u32 s60,s60,s34
s_mul_i32 s60,s60,46080
s_add_u32 s60,s60,s37
v_mfma_f32_32x32x16_bf16 v[56:71],a[44:47],v[36:39],v[56:71]
ds_read_b128 v[32:35],v16 offset:12288
s_add_u32 s60,s60,223608832
s_mov_b32 s67,s60
s_mul_i32 s61,s46,10240
s_waitcnt lgkmcnt(6)
v_mfma_f32_32x32x16_bf16 v[56:71],a[80:83],v[40:43],v[56:71]
ds_read_b128 v[36:39],v17 offset:12288
s_add_u32 s60,s60,s61
s_add_u32 s61,s61,s66
s_add_u32 m0,s61,0
s_add_u32 s63,s60,0
v_mfma_f32_32x32x16_bf16 v[56:71],a[84:87],v[44:47],v[56:71]
ds_read_b128 v[40:43],v16 offset:22528
buffer_load_dwordx4 v1,s[8:11],s63 offen sc1 lds
s_mul_i32 s71,s51,9
s_waitcnt lgkmcnt(6)
v_mfma_f32_32x32x16_bf16 v[56:71],a[120:123],v[48:51],v[56:71]
ds_read_b128 v[44:47],v17 offset:22528
s_and_b32 s72,s52,7
s_add_u32 s71,s71,s72
s_mul_i32 s71,s71,40960
s_add_u32 s71,s71,237371392
v_mfma_f32_32x32x16_bf16 v[56:71],a[124:127],v[52:55],v[56:71]
ds_read_b128 v[48:51],v16 offset:32768
s_lshl_b32 s72,s56,11
s_add_u32 s71,s71,s72
s_lshl_b32 s82,s51,6
s_waitcnt lgkmcnt(5)
v_mfma_f32_32x32x16_bf16 v[56:71],a[8:11],v[24:27],v[56:71]
ds_read_b128 v[52:55],v17 offset:32768
buffer_load_dwordx4 v1,s[8:11],s63 offen offset:1024 sc1 lds
s_add_u32 s82,s82,s52
s_lshl_b32 s82,s82,9
v_mfma_f32_32x32x16_bf16 v[56:71],a[12:15],v[28:31],v[56:71]
ds_read_b128 v[24:27],v16 offset:4096
s_add_u32 s82,s82,458752
s_lshl_b32 s70,s56,2
s_add_u32 s82,s82,s70
s_waitcnt lgkmcnt(5)
v_mfma_f32_32x32x16_bf16 v[56:71],a[48:51],v[32:35],v[56:71]
ds_read_b128 v[28:31],v17 offset:4096
buffer_load_dword v3,v2,s[8:11],s35 offen sc1
v_mfma_f32_32x32x16_bf16 v[56:71],a[52:55],v[36:39],v[56:71]
ds_read_b128 v[32:35],v16 offset:14336
buffer_load_dwordx4 v1,s[8:11],s63 offen offset:2048 sc1 lds
s_waitcnt lgkmcnt(5)
v_mfma_f32_32x32x16_bf16 v[56:71],a[88:91],v[40:43],v[56:71]
ds_read_b128 v[36:39],v17 offset:14336
s_waitcnt vmcnt(4)
s_mov_b64 exec,1
s_cmp_lg_u32 s49,0
s_cbranch_scc0 ls_314
buffer_store_dword v5,v1,s[8:11],s59 offen sc1
s_branch ls_315
ls_314:
buffer_store_dword v5,v1,s[8:11],s59 offen
ls_315:
s_mov_b64 exec,-1
s_mov_b32 s59,2147483648
v_mfma_f32_32x32x16_bf16 v[56:71],a[92:95],v[44:47],v[56:71]
ds_read_b128 v[40:43],v16 offset:24576
s_waitcnt lgkmcnt(5)
v_mfma_f32_32x32x16_bf16 v[56:71],a[128:131],v[48:51],v[56:71]
ds_read_b128 v[44:47],v17 offset:24576
buffer_load_dwordx4 v1,s[8:11],s63 offen offset:3072 sc1 lds
s_add_u32 m0,s61,4096
s_add_u32 s63,s60,4096
v_mfma_f32_32x32x16_bf16 v[56:71],a[132:135],v[52:55],v[56:71]
ds_read_b128 v[48:51],v16 offset:34816
s_waitcnt lgkmcnt(5)
v_mfma_f32_32x32x16_bf16 v[56:71],a[16:19],v[24:27],v[56:71]
ds_read_b128 v[52:55],v17 offset:34816
s_barrier
v_mfma_f32_32x32x16_bf16 v[56:71],a[20:23],v[28:31],v[56:71]
ds_read_b128 v[24:27],v16 offset:6144
v_add_u32 v183,s57,v182
buffer_load_dwordx4 v1,s[8:11],s63 offen sc1 lds
s_waitcnt lgkmcnt(5)
v_mfma_f32_32x32x16_bf16 v[56:71],a[56:59],v[32:35],v[56:71]
ds_read_b128 v[28:31],v17 offset:6144
ds_read_b64 v[180:181],v183
v_mfma_f32_32x32x16_bf16 v[56:71],a[60:63],v[36:39],v[56:71]
ds_read_b128 v[32:35],v16 offset:16384
s_waitcnt lgkmcnt(6)
v_mfma_f32_32x32x16_bf16 v[56:71],a[96:99],v[40:43],v[56:71]
ds_read_b128 v[36:39],v17 offset:16384
buffer_load_dwordx4 v1,s[8:11],s63 offen offset:1024 sc1 lds
v_mfma_f32_32x32x16_bf16 v[56:71],a[100:103],v[44:47],v[56:71]
ds_read_b128 v[40:43],v16 offset:26624
s_waitcnt lgkmcnt(6)
v_mfma_f32_32x32x16_bf16 v[56:71],a[136:139],v[48:51],v[56:71]
ds_read_b128 v[44:47],v17 offset:26624
v_mfma_f32_32x32x16_bf16 v[56:71],a[140:143],v[52:55],v[56:71]
ds_read_b128 v[48:51],v16 offset:36864
buffer_load_dwordx4 v1,s[8:11],s63 offen offset:2048 sc1 lds
s_waitcnt lgkmcnt(6)
v_mfma_f32_32x32x16_bf16 v[56:71],a[24:27],v[24:27],v[56:71]
ds_read_b128 v[52:55],v17 offset:36864
v_mfma_f32_32x32x16_bf16 v[56:71],a[28:31],v[28:31],v[56:71]
ds_read_b128 v[24:27],v16 offset:8192
s_waitcnt lgkmcnt(5)
v_mfma_f32_32x32x16_bf16 v[56:71],a[64:67],v[32:35],v[56:71]
ds_read_b128 v[28:31],v17 offset:8192
buffer_load_dwordx4 v1,s[8:11],s63 offen offset:3072 sc1 lds
s_add_u32 m0,s61,8192
s_add_u32 s63,s60,8192
v_mfma_f32_32x32x16_bf16 v[56:71],a[68:71],v[36:39],v[56:71]
ds_read_b128 v[32:35],v16 offset:18432
s_waitcnt lgkmcnt(5)
v_mfma_f32_32x32x16_bf16 v[56:71],a[104:107],v[40:43],v[56:71]
ds_read_b128 v[36:39],v17 offset:18432
v_mfma_f32_32x32x16_bf16 v[56:71],a[108:111],v[44:47],v[56:71]
ds_read_b128 v[40:43],v16 offset:28672
buffer_load_dwordx4 v1,s[8:11],s63 offen sc1 lds
s_waitcnt lgkmcnt(5)
v_mfma_f32_32x32x16_bf16 v[56:71],a[144:147],v[48:51],v[56:71]
ds_read_b128 v[44:47],v17 offset:28672
v_mfma_f32_32x32x16_bf16 v[56:71],a[148:151],v[52:55],v[56:71]
ds_read_b128 v[48:51],v16 offset:38912
s_waitcnt lgkmcnt(5)
v_mfma_f32_32x32x16_bf16 v[56:71],a[32:35],v[24:27],v[56:71]
ds_read_b128 v[52:55],v17 offset:38912
buffer_load_dwordx4 v1,s[8:11],s63 offen offset:1024 sc1 lds
s_add_u32 m0,s66,40960
s_add_u32 s63,s67,40960
v_mfma_f32_32x32x16_bf16 v[56:71],a[36:39],v[28:31],v[56:71]
s_waitcnt lgkmcnt(4)
v_mfma_f32_32x32x16_bf16 v[56:71],a[72:75],v[32:35],v[56:71]
v_mfma_f32_32x32x16_bf16 v[56:71],a[76:79],v[36:39],v[56:71]
buffer_load_dwordx4 v1,s[8:11],s63 offen sc1 lds
s_add_u32 s62,s32,1
s_min_u32 s62,s62,127
s_sub_u32 s60,s62,14
s_waitcnt lgkmcnt(2)
v_mfma_f32_32x32x16_bf16 v[56:71],a[112:115],v[40:43],v[56:71]
s_lshr_b32 s41,s60,1
s_and_b32 s40,s60,1
s_cmp_eq_u32 s40,0
s_cselect_b32 s61,14,0
s_add_u32 s41,s41,s61
s_sub_u32 s61,s60,50
v_mfma_f32_32x32x16_bf16 v[56:71],a[116:119],v[44:47],v[56:71]
s_cmp_ge_u32 s60,100
s_cselect_b32 s41,s61,s41
s_cselect_b32 s40,1,s40
s_waitcnt lgkmcnt(0)
v_mfma_f32_32x32x16_bf16 v[56:71],a[152:155],v[48:51],v[56:71]
s_cmp_lt_u32 s62,14
s_cselect_b32 s41,s62,s41
s_cselect_b32 s40,0,s40
s_lshl_b32 s42,s40,6
s_add_u32 s42,s42,s41
s_lshl_b32 s42,s42,9
v_mfma_f32_32x32x16_bf16 v[56:71],a[156:159],v[52:55],v[56:71]
s_add_u32 s42,s42,393216
s_cmp_lt_u32 s41,7
s_cselect_b64 s[80:81],s[78:79],-1
s_cmp_eq_u32 s37,0
s_cbranch_scc0 sec_318
s_mov_b32 s35,s42
buffer_load_dword v3,v2,s[8:11],s35 offen sc1
s_mov_b32 s53,s33
s_mov_b32 s54,s34
s_add_u32 s32,s32,1
s_mov_b32 s33,s40
s_mov_b32 s34,s41
s_mov_b64 s[76:77],s[80:81]
s_nop 2
ep_316:
v_pk_fma_f32 v[56:57],v[144:145],v[180:181],v[56:57] op_sel_hi:[1,0,1] neg_lo:[0,1,0] neg_hi:[0,1,0]
v_pk_fma_f32 v[58:59],v[146:147],v[180:181],v[58:59] op_sel_hi:[1,0,1] neg_lo:[0,1,0] neg_hi:[0,1,0]
v_pk_fma_f32 v[60:61],v[148:149],v[180:181],v[60:61] op_sel_hi:[1,0,1] neg_lo:[0,1,0] neg_hi:[0,1,0]
v_pk_fma_f32 v[62:63],v[150:151],v[180:181],v[62:63] op_sel_hi:[1,0,1] neg_lo:[0,1,0] neg_hi:[0,1,0]
v_pk_fma_f32 v[64:65],v[152:153],v[180:181],v[64:65] op_sel_hi:[1,0,1] neg_lo:[0,1,0] neg_hi:[0,1,0]
v_pk_fma_f32 v[66:67],v[154:155],v[180:181],v[66:67] op_sel_hi:[1,0,1] neg_lo:[0,1,0] neg_hi:[0,1,0]
v_pk_fma_f32 v[68:69],v[156:157],v[180:181],v[68:69] op_sel_hi:[1,0,1] neg_lo:[0,1,0] neg_hi:[0,1,0]
v_pk_fma_f32 v[70:71],v[158:159],v[180:181],v[70:71] op_sel_hi:[1,0,1] neg_lo:[0,1,0] neg_hi:[0,1,0]
v_pk_mul_f32 v[56:57],v[56:57],v[180:181] op_sel:[0,1] op_sel_hi:[1,1]
v_pk_mul_f32 v[58:59],v[58:59],v[180:181] op_sel:[0,1] op_sel_hi:[1,1]
v_pk_mul_f32 v[60:61],v[60:61],v[180:181] op_sel:[0,1] op_sel_hi:[1,1]
v_pk_mul_f32 v[62:63],v[62:63],v[180:181] op_sel:[0,1] op_sel_hi:[1,1]
v_pk_mul_f32 v[64:65],v[64:65],v[180:181] op_sel:[0,1] op_sel_hi:[1,1]
v_pk_mul_f32 v[66:67],v[66:67],v[180:181] op_sel:[0,1] op_sel_hi:[1,1]
v_pk_mul_f32 v[68:69],v[68:69],v[180:181] op_sel:[0,1] op_sel_hi:[1,1]
v_pk_mul_f32 v[70:71],v[70:71],v[180:181] op_sel:[0,1] op_sel_hi:[1,1]
v_cvt_pk_bf16_f32 v140,v56,v57
v_lshlrev_b32 v56,16,v140
v_and_b32 v57,0xffff0000,v140
v_cvt_pk_bf16_f32 v140,v58,v59
v_lshlrev_b32 v58,16,v140
v_and_b32 v59,0xffff0000,v140
v_cvt_pk_bf16_f32 v140,v60,v61
v_lshlrev_b32 v60,16,v140
v_and_b32 v61,0xffff0000,v140
v_cvt_pk_bf16_f32 v140,v62,v63
v_lshlrev_b32 v62,16,v140
v_and_b32 v63,0xffff0000,v140
v_cvt_pk_bf16_f32 v140,v64,v65
v_lshlrev_b32 v64,16,v140
v_and_b32 v65,0xffff0000,v140
v_cvt_pk_bf16_f32 v140,v66,v67
v_lshlrev_b32 v66,16,v140
v_and_b32 v67,0xffff0000,v140
v_cvt_pk_bf16_f32 v140,v68,v69
v_lshlrev_b32 v68,16,v140
v_and_b32 v69,0xffff0000,v140
v_cvt_pk_bf16_f32 v140,v70,v71
v_lshlrev_b32 v70,16,v140
v_and_b32 v71,0xffff0000,v140
v_pk_mul_f32 v[124:125],v[56:57],v[56:57]
v_pk_mul_f32 v[126:127],v[58:59],v[58:59]
v_pk_mul_f32 v[128:129],v[60:61],v[60:61]
v_pk_mul_f32 v[130:131],v[62:63],v[62:63]
v_pk_mul_f32 v[132:133],v[64:65],v[64:65]
v_pk_mul_f32 v[134:135],v[66:67],v[66:67]
v_pk_mul_f32 v[136:137],v[68:69],v[68:69]
v_pk_mul_f32 v[138:139],v[70:71],v[70:71]
v_pk_fma_f32 v[124:125],v[124:125],v[112:113],v[112:113] op_sel:[0,1,0] op_sel_hi:[1,1,0]
v_pk_fma_f32 v[126:127],v[126:127],v[112:113],v[112:113] op_sel:[0,1,0] op_sel_hi:[1,1,0]
v_pk_fma_f32 v[128:129],v[128:129],v[112:113],v[112:113] op_sel:[0,1,0] op_sel_hi:[1,1,0]
v_pk_fma_f32 v[130:131],v[130:131],v[112:113],v[112:113] op_sel:[0,1,0] op_sel_hi:[1,1,0]
v_pk_fma_f32 v[132:133],v[132:133],v[112:113],v[112:113] op_sel:[0,1,0] op_sel_hi:[1,1,0]
v_pk_fma_f32 v[134:135],v[134:135],v[112:113],v[112:113] op_sel:[0,1,0] op_sel_hi:[1,1,0]
v_pk_fma_f32 v[136:137],v[136:137],v[112:113],v[112:113] op_sel:[0,1,0] op_sel_hi:[1,1,0]
v_pk_fma_f32 v[138:139],v[138:139],v[112:113],v[112:113] op_sel:[0,1,0] op_sel_hi:[1,1,0]
v_pk_mul_f32 v[124:125],v[124:125],v[56:57]
v_pk_mul_f32 v[126:127],v[126:127],v[58:59]
v_pk_mul_f32 v[128:129],v[128:129],v[60:61]
v_pk_mul_f32 v[130:131],v[130:131],v[62:63]
v_pk_mul_f32 v[132:133],v[132:133],v[64:65]
v_pk_mul_f32 v[134:135],v[134:135],v[66:67]
v_pk_mul_f32 v[136:137],v[136:137],v[68:69]
v_pk_mul_f32 v[138:139],v[138:139],v[70:71]
v_exp_f32 v124,v124
v_exp_f32 v125,v125
v_exp_f32 v126,v126
v_exp_f32 v127,v127
v_exp_f32 v128,v128
v_exp_f32 v129,v129
v_exp_f32 v130,v130
v_exp_f32 v131,v131
v_exp_f32 v132,v132
v_exp_f32 v133,v133
v_exp_f32 v134,v134
v_exp_f32 v135,v135
v_exp_f32 v136,v136
v_exp_f32 v137,v137
v_exp_f32 v138,v138
v_exp_f32 v139,v139
v_pk_add_f32 v[124:125],v[124:125],1.0 op_sel_hi:[1,0]
v_pk_add_f32 v[126:127],v[126:127],1.0 op_sel_hi:[1,0]
v_pk_add_f32 v[128:129],v[128:129],1.0 op_sel_hi:[1,0]
v_pk_add_f32 v[130:131],v[130:131],1.0 op_sel_hi:[1,0]
v_pk_add_f32 v[132:133],v[132:133],1.0 op_sel_hi:[1,0]
v_pk_add_f32 v[134:135],v[134:135],1.0 op_sel_hi:[1,0]
v_pk_add_f32 v[136:137],v[136:137],1.0 op_sel_hi:[1,0]
v_pk_add_f32 v[138:139],v[138:139],1.0 op_sel_hi:[1,0]
v_rcp_f32 v124,v124
v_rcp_f32 v125,v125
v_rcp_f32 v126,v126
v_rcp_f32 v127,v127
v_rcp_f32 v128,v128
v_rcp_f32 v129,v129
v_rcp_f32 v130,v130
v_rcp_f32 v131,v131
v_rcp_f32 v132,v132
v_rcp_f32 v133,v133
v_rcp_f32 v134,v134
v_rcp_f32 v135,v135
v_rcp_f32 v136,v136
v_rcp_f32 v137,v137
v_rcp_f32 v138,v138
v_rcp_f32 v139,v139
v_pk_mul_f32 v[56:57],v[56:57],v[124:125]
v_pk_mul_f32 v[58:59],v[58:59],v[126:127]
v_pk_mul_f32 v[60:61],v[60:61],v[128:129]
v_pk_mul_f32 v[62:63],v[62:63],v[130:131]
v_pk_mul_f32 v[64:65],v[64:65],v[132:133]
v_pk_mul_f32 v[66:67],v[66:67],v[134:135]
v_pk_mul_f32 v[68:69],v[68:69],v[136:137]
v_pk_mul_f32 v[70:71],v[70:71],v[138:139]
v_cvt_pk_bf16_f32 v116,v56,v57
v_cvt_pk_bf16_f32 v117,v58,v59
v_cvt_pk_bf16_f32 v118,v60,v61
v_cvt_pk_bf16_f32 v119,v62,v63
v_cvt_pk_bf16_f32 v120,v64,v65
v_cvt_pk_bf16_f32 v121,v66,v67
v_cvt_pk_bf16_f32 v122,v68,v69
v_cvt_pk_bf16_f32 v123,v70,v71
s_cmp_lg_u32 s49,0
s_cbranch_scc0 ls_319
buffer_store_dwordx4 v[116:119],v20,s[8:11],s71 offen sc1
buffer_store_dwordx4 v[120:123],v21,s[8:11],s71 offen sc1
s_branch ls_320
ls_319:
buffer_store_dwordx4 v[116:119],v20,s[8:11],s71 offen
buffer_store_dwordx4 v[120:123],v21,s[8:11],s71 offen
ls_320:
s_mov_b32 s59,s82
s_cmp_eq_u32 s37,0
s_cbranch_scc1 W1_NEXT
s_waitcnt vmcnt(2)
v_cmp_eq_u32 vcc,0,v3
s_and_b64 vcc,vcc,s[76:77]
s_cselect_b32 s37,2147483648,0
s_cmp_lt_u32 s32,128
s_cselect_b32 s37,s37,2147483648
s_cmp_eq_u32 s37,0
s_cbranch_scc1 W1_COLD2
s_waitcnt vmcnt(0)
s_mov_b64 exec,1
s_cmp_lg_u32 s49,0
s_cbranch_scc0 ls_321
buffer_store_dword v5,v1,s[8:11],s59 offen sc1
s_branch ls_322
ls_321:
buffer_store_dword v5,v1,s[8:11],s59 offen
ls_322:
s_mov_b64 exec,-1
s_mov_b32 s59,2147483648
s_cmp_lt_u32 s32,128
s_cbranch_scc1 W1_COLD
s_branch W1_END
sec_318:
s_waitcnt vmcnt(10)
v_cmp_eq_u32 vcc,0,v3
s_and_b64 vcc,vcc,s[76:77]
s_cselect_b32 s37,2147483648,0
s_cmp_lt_u32 s32,128
s_cselect_b32 s37,s37,2147483648
s_cmp_lg_u32 s37,0
s_cbranch_scc1 nr_317
s_add_u32 s65,s32,1
s_or_b32 s65,s65,s37
v_mov_b32 v23,s65
ds_max_i32 v22,v23
s_sub_u32 s66,46080,s57
s_lshl_b32 s60,s33,6
s_add_u32 s60,s60,s34
s_mul_i32 s60,s60,46080
s_add_u32 s60,s60,s37
s_add_u32 s60,s60,223608832
s_mov_b32 s67,s60
s_mul_i32 s61,s46,10240
s_add_u32 s60,s60,s61
s_add_u32 s61,s61,s66
s_add_u32 m0,s61,0
s_add_u32 s63,s60,0
buffer_load_dwordx4 v1,s[8:11],s63 offen sc1 lds
v_pk_fma_f32 v[56:57],v[144:145],v[180:181],v[56:57] op_sel_hi:[1,0,1] neg_lo:[0,1,0] neg_hi:[0,1,0]
v_pk_fma_f32 v[58:59],v[146:147],v[180:181],v[58:59] op_sel_hi:[1,0,1] neg_lo:[0,1,0] neg_hi:[0,1,0]
v_pk_fma_f32 v[60:61],v[148:149],v[180:181],v[60:61] op_sel_hi:[1,0,1] neg_lo:[0,1,0] neg_hi:[0,1,0]
v_pk_fma_f32 v[62:63],v[150:151],v[180:181],v[62:63] op_sel_hi:[1,0,1] neg_lo:[0,1,0] neg_hi:[0,1,0]
v_pk_fma_f32 v[64:65],v[152:153],v[180:181],v[64:65] op_sel_hi:[1,0,1] neg_lo:[0,1,0] neg_hi:[0,1,0]
v_pk_fma_f32 v[66:67],v[154:155],v[180:181],v[66:67] op_sel_hi:[1,0,1] neg_lo:[0,1,0] neg_hi:[0,1,0]
v_pk_fma_f32 v[68:69],v[156:157],v[180:181],v[68:69] op_sel_hi:[1,0,1] neg_lo:[0,1,0] neg_hi:[0,1,0]
v_pk_fma_f32 v[70:71],v[158:159],v[180:181],v[70:71] op_sel_hi:[1,0,1] neg_lo:[0,1,0] neg_hi:[0,1,0]
v_pk_mul_f32 v[56:57],v[56:57],v[180:181] op_sel:[0,1] op_sel_hi:[1,1]
buffer_load_dwordx4 v1,s[8:11],s63 offen offset:1024 sc1 lds
v_pk_mul_f32 v[58:59],v[58:59],v[180:181] op_sel:[0,1] op_sel_hi:[1,1]
v_pk_mul_f32 v[60:61],v[60:61],v[180:181] op_sel:[0,1] op_sel_hi:[1,1]
v_pk_mul_f32 v[62:63],v[62:63],v[180:181] op_sel:[0,1] op_sel_hi:[1,1]
v_pk_mul_f32 v[64:65],v[64:65],v[180:181] op_sel:[0,1] op_sel_hi:[1,1]
v_pk_mul_f32 v[66:67],v[66:67],v[180:181] op_sel:[0,1] op_sel_hi:[1,1]
v_pk_mul_f32 v[68:69],v[68:69],v[180:181] op_sel:[0,1] op_sel_hi:[1,1]
v_pk_mul_f32 v[70:71],v[70:71],v[180:181] op_sel:[0,1] op_sel_hi:[1,1]
v_cvt_pk_bf16_f32 v140,v56,v57
v_lshlrev_b32 v56,16,v140
buffer_load_dwordx4 v1,s[8:11],s63 offen offset:2048 sc1 lds
v_and_b32 v57,0xffff0000,v140
v_cvt_pk_bf16_f32 v140,v58,v59
v_lshlrev_b32 v58,16,v140
v_and_b32 v59,0xffff0000,v140
v_cvt_pk_bf16_f32 v140,v60,v61
v_lshlrev_b32 v60,16,v140
v_and_b32 v61,0xffff0000,v140
v_cvt_pk_bf16_f32 v140,v62,v63
v_lshlrev_b32 v62,16,v140
buffer_load_dwordx4 v1,s[8:11],s63 offen offset:3072 sc1 lds
v_and_b32 v63,0xffff0000,v140
v_cvt_pk_bf16_f32 v140,v64,v65
v_lshlrev_b32 v64,16,v140
v_and_b32 v65,0xffff0000,v140
v_cvt_pk_bf16_f32 v140,v66,v67
v_lshlrev_b32 v66,16,v140
v_and_b32 v67,0xffff0000,v140
v_cvt_pk_bf16_f32 v140,v68,v69
v_lshlrev_b32 v68,16,v140
s_add_u32 m0,s61,4096
s_add_u32 s63,s60,4096
buffer_load_dwordx4 v1,s[8:11],s63 offen sc1 lds
v_and_b32 v69,0xffff0000,v140
v_cvt_pk_bf16_f32 v140,v70,v71
v_lshlrev_b32 v70,16,v140
v_and_b32 v71,0xffff0000,v140
v_pk_mul_f32 v[124:125],v[56:57],v[56:57]
v_pk_mul_f32 v[126:127],v[58:59],v[58:59]
v_pk_mul_f32 v[128:129],v[60:61],v[60:61]
v_pk_mul_f32 v[130:131],v[62:63],v[62:63]
v_pk_mul_f32 v[132:133],v[64:65],v[64:65]
buffer_load_dwordx4 v1,s[8:11],s63 offen offset:1024 sc1 lds
v_pk_mul_f32 v[134:135],v[66:67],v[66:67]
v_pk_mul_f32 v[136:137],v[68:69],v[68:69]
v_pk_mul_f32 v[138:139],v[70:71],v[70:71]
v_pk_fma_f32 v[124:125],v[124:125],v[112:113],v[112:113] op_sel:[0,1,0] op_sel_hi:[1,1,0]
v_pk_fma_f32 v[126:127],v[126:127],v[112:113],v[112:113] op_sel:[0,1,0] op_sel_hi:[1,1,0]
v_pk_fma_f32 v[128:129],v[128:129],v[112:113],v[112:113] op_sel:[0,1,0] op_sel_hi:[1,1,0]
v_pk_fma_f32 v[130:131],v[130:131],v[112:113],v[112:113] op_sel:[0,1,0] op_sel_hi:[1,1,0]
v_pk_fma_f32 v[132:133],v[132:133],v[112:113],v[112:113] op_sel:[0,1,0] op_sel_hi:[1,1,0]
v_pk_fma_f32 v[134:135],v[134:135],v[112:113],v[112:113] op_sel:[0,1,0] op_sel_hi:[1,1,0]
buffer_load_dwordx4 v1,s[8:11],s63 offen offset:2048 sc1 lds
v_pk_fma_f32 v[136:137],v[136:137],v[112:113],v[112:113] op_sel:[0,1,0] op_sel_hi:[1,1,0]
v_pk_fma_f32 v[138:139],v[138:139],v[112:113],v[112:113] op_sel:[0,1,0] op_sel_hi:[1,1,0]
v_pk_mul_f32 v[124:125],v[124:125],v[56:57]
v_pk_mul_f32 v[126:127],v[126:127],v[58:59]
v_pk_mul_f32 v[128:129],v[128:129],v[60:61]
v_pk_mul_f32 v[130:131],v[130:131],v[62:63]
v_pk_mul_f32 v[132:133],v[132:133],v[64:65]
v_pk_mul_f32 v[134:135],v[134:135],v[66:67]
v_pk_mul_f32 v[136:137],v[136:137],v[68:69]
buffer_load_dwordx4 v1,s[8:11],s63 offen offset:3072 sc1 lds
v_pk_mul_f32 v[138:139],v[138:139],v[70:71]
v_exp_f32 v124,v124
v_exp_f32 v125,v125
v_exp_f32 v126,v126
v_exp_f32 v127,v127
v_exp_f32 v128,v128
v_exp_f32 v129,v129
v_exp_f32 v130,v130
v_exp_f32 v131,v131
s_add_u32 m0,s61,8192
s_add_u32 s63,s60,8192
buffer_load_dwordx4 v1,s[8:11],s63 offen sc1 lds
v_exp_f32 v132,v132
v_exp_f32 v133,v133
v_exp_f32 v134,v134
v_exp_f32 v135,v135
v_exp_f32 v136,v136
v_exp_f32 v137,v137
v_exp_f32 v138,v138
v_exp_f32 v139,v139
v_pk_add_f32 v[124:125],v[124:125],1.0 op_sel_hi:[1,0]
buffer_load_dwordx4 v1,s[8:11],s63 offen offset:1024 sc1 lds
v_pk_add_f32 v[126:127],v[126:127],1.0 op_sel_hi:[1,0]
v_pk_add_f32 v[128:129],v[128:129],1.0 op_sel_hi:[1,0]
v_pk_add_f32 v[130:131],v[130:131],1.0 op_sel_hi:[1,0]
v_pk_add_f32 v[132:133],v[132:133],1.0 op_sel_hi:[1,0]
v_pk_add_f32 v[134:135],v[134:135],1.0 op_sel_hi:[1,0]
v_pk_add_f32 v[136:137],v[136:137],1.0 op_sel_hi:[1,0]
v_pk_add_f32 v[138:139],v[138:139],1.0 op_sel_hi:[1,0]
v_rcp_f32 v124,v124
v_rcp_f32 v125,v125
s_add_u32 m0,s66,40960
s_add_u32 s63,s67,40960
buffer_load_dwordx4 v1,s[8:11],s63 offen sc1 lds
v_rcp_f32 v126,v126
v_rcp_f32 v127,v127
v_rcp_f32 v128,v128
v_rcp_f32 v129,v129
v_rcp_f32 v130,v130
v_rcp_f32 v131,v131
v_rcp_f32 v132,v132
v_rcp_f32 v133,v133
v_rcp_f32 v134,v134
s_mov_b32 s35,s42
buffer_load_dword v3,v2,s[8:11],s35 offen sc1
s_mov_b32 s53,s33
s_mov_b32 s54,s34
s_add_u32 s32,s32,1
s_mov_b32 s33,s40
s_mov_b32 s34,s41
s_mov_b64 s[76:77],s[80:81]
v_rcp_f32 v135,v135
v_rcp_f32 v136,v136
v_rcp_f32 v137,v137
v_rcp_f32 v138,v138
v_rcp_f32 v139,v139
v_pk_mul_f32 v[56:57],v[56:57],v[124:125]
v_pk_mul_f32 v[58:59],v[58:59],v[126:127]
v_pk_mul_f32 v[60:61],v[60:61],v[128:129]
v_pk_mul_f32 v[62:63],v[62:63],v[130:131]
v_pk_mul_f32 v[64:65],v[64:65],v[132:133]
v_pk_mul_f32 v[66:67],v[66:67],v[134:135]
v_pk_mul_f32 v[68:69],v[68:69],v[136:137]
v_pk_mul_f32 v[70:71],v[70:71],v[138:139]
v_cvt_pk_bf16_f32 v116,v56,v57
v_cvt_pk_bf16_f32 v117,v58,v59
v_cvt_pk_bf16_f32 v118,v60,v61
v_cvt_pk_bf16_f32 v119,v62,v63
v_cvt_pk_bf16_f32 v120,v64,v65
v_cvt_pk_bf16_f32 v121,v66,v67
v_cvt_pk_bf16_f32 v122,v68,v69
v_cvt_pk_bf16_f32 v123,v70,v71
s_cmp_lg_u32 s49,0
s_cbranch_scc0 ls_323
buffer_store_dwordx4 v[116:119],v20,s[8:11],s71 offen sc1
buffer_store_dwordx4 v[120:123],v21,s[8:11],s71 offen sc1
s_branch ls_324
ls_323:
buffer_store_dwordx4 v[116:119],v20,s[8:11],s71 offen
buffer_store_dwordx4 v[120:123],v21,s[8:11],s71 offen
ls_324:
s_mov_b32 s59,s82
s_branch W1_NEXT
nr_317:
buffer_load_dword v3,v2,s[8:11],s35 offen sc1
s_branch ep_316
W1_END:
s_endpgm
ROLE_W2:
v_lshlrev_b32 v1,4,v0
v_mov_b32 v5,1
s_lshl_b32 s56,s48,2
s_add_u32 s56,s56,s46
v_bfe_u32 v6,v0,2,2
v_lshrrev_b32 v7,4,v0
v_add_u32 v7,v6,v7
v_and_b32 v7,3,v7
v_and_b32 v15,3,v0
v_lshlrev_b32 v15,4,v15
v_lshl_add_u32 v15,v7,6,v15
v_lshl_add_u32 v15,v6,8,v15
v_lshrrev_b32 v6,5,v0
v_bfe_u32 v7,v0,4,1
v_lshlrev_b32 v16,10,v7
v_lshl_add_u32 v16,v6,8,v16
v_and_b32 v6,15,v0
v_lshl_add_u32 v16,v6,4,v16
v_add_u32 v18,40960,v16
v_lshrrev_b32 v6,5,v0
v_bfe_u32 v7,v0,4,1
v_lshlrev_b32 v20,10,v7
v_lshl_add_u32 v20,v6,8,v20
v_and_b32 v6,15,v0
v_lshl_add_u32 v20,v6,4,v20
v_lshrrev_b32 v6,5,v0
v_add_u32 v6,2,v6
v_bfe_u32 v7,v0,4,1
v_lshlrev_b32 v17,10,v7
v_lshl_add_u32 v17,v6,8,v17
v_and_b32 v6,15,v0
v_lshl_add_u32 v17,v6,4,v17
v_add_u32 v19,40960,v17
v_lshrrev_b32 v6,5,v0
v_add_u32 v6,2,v6
v_bfe_u32 v7,v0,4,1
v_lshlrev_b32 v21,10,v7
v_lshl_add_u32 v21,v6,8,v21
v_and_b32 v6,15,v0
v_lshl_add_u32 v21,v6,4,v21
v_min_u32 v2,19,v0
v_lshlrev_b32 v2,2,v2
s_lshr_b32 s60,s46,1
s_add_u32 s60,s60,1
s_sub_u32 s61,32,s60
s_add_u32 s60,s60,32
s_bitcmp1_b32 s46,0
s_cselect_b32 s60,s60,s61
v_and_b32 v6,15,v0
v_add_u32 v6,s60,v6
v_lshrrev_b32 v7,5,v6
v_mul_u32_u24 v112,40960,v7
v_bfe_u32 v7,v6,4,1
v_lshl_add_u32 v112,v7,10,v112
v_and_b32 v7,15,v6
v_lshl_add_u32 v112,v7,4,v112
v_lshrrev_b32 v7,4,v0
v_lshl_add_u32 v112,v7,8,v112
v_and_b32 v6,15,v0
v_add_u32 v6,s60,v6
v_add_u32 v6,16,v6
v_lshrrev_b32 v7,5,v6
v_mul_u32_u24 v113,40960,v7
v_bfe_u32 v7,v6,4,1
v_lshl_add_u32 v113,v7,10,v113
v_and_b32 v7,15,v6
v_lshl_add_u32 v113,v7,4,v113
v_lshrrev_b32 v7,4,v0
v_lshl_add_u32 v113,v7,8,v113
v_lshrrev_b32 v6,5,v0
v_and_b32 v7,15,v0
v_lshlrev_b32 v114,3,v7
v_lshl_add_u32 v114,v6,7,v114
v_and_b32 v114,31,v0
v_lshlrev_b32 v114,3,v114
v_lshrrev_b32 v6,5,v0
v_bfe_u32 v7,v0,4,1
v_lshlrev_b32 v116,10,v7
v_bfe_u32 v7,v0,2,2
v_lshl_add_u32 v116,v7,8,v116
v_add_u32 v6,v6,v7
v_and_b32 v6,3,v6
v_lshl_add_u32 v116,v6,6,v116
v_and_b32 v6,3,v0
v_lshl_add_u32 v116,v6,4,v116
v_lshrrev_b32 v6,5,v0
v_add_u32 v6,2,v6
v_bfe_u32 v7,v0,4,1
v_lshlrev_b32 v117,10,v7
v_bfe_u32 v7,v0,2,2
v_lshl_add_u32 v117,v7,8,v117
v_add_u32 v6,v6,v7
v_and_b32 v6,3,v6
v_lshl_add_u32 v117,v6,6,v117
v_and_b32 v6,3,v0
v_lshl_add_u32 v117,v6,4,v117
v_subrev_u32 v6,40960,v112
v_cmp_gt_u32 vcc,40960,v6
s_nop 1
v_cndmask_b32 v78,0,1,vcc
v_xor_b32 v76,1,v78
v_and_b32 v74,2047,v112
v_subrev_u32 v6,40960,v113
v_cmp_gt_u32 vcc,40960,v6
s_nop 1
v_cndmask_b32 v79,0,1,vcc
v_xor_b32 v77,1,v79
v_and_b32 v75,2047,v113
s_and_b32 s68,s46,1
s_lshl_b32 s68,s68,1
s_sub_u32 s68,s68,1
s_waitcnt vmcnt(0)
s_barrier
s_cmp_lg_u32 s46,0
s_cbranch_scc1 arr_325
v_mov_b32 v6,1
s_lshl_b32 s3,s49,2
v_mov_b32 v7,s3
s_mov_b64 exec,1
buffer_atomic_add v6,v7,s[12:15],0 offen sc1
s_mov_b64 exec,-1
arr_325:
s_lshl_b32 s58,s56,6
s_mul_i32 s63,s46,40960
s_mov_b32 s4,s34
s_mov_b32 s5,s35
s_mov_b32 s6,819200
s_mov_b32 s7,0x20000
v_lshrrev_b32 v9,2,v0
s_mov_b32 s64,1280
v_mul_lo_u32 v9,v9,s64
v_and_b32 v10,3,v0
v_lshl_add_u32 v6,v10,4,v9
s_add_u32 m0,s63,0
s_add_u32 s65,s58,0
buffer_load_dwordx4 v6,s[4:7],s65 offen lds
s_add_u32 m0,s63,1024
s_add_u32 s65,s58,20480
buffer_load_dwordx4 v6,s[4:7],s65 offen lds
s_add_u32 m0,s63,2048
s_add_u32 s65,s58,40960
buffer_load_dwordx4 v6,s[4:7],s65 offen lds
s_add_u32 m0,s63,3072
s_add_u32 s65,s58,61440
buffer_load_dwordx4 v6,s[4:7],s65 offen lds
s_add_u32 m0,s63,4096
s_add_u32 s65,s58,81920
buffer_load_dwordx4 v6,s[4:7],s65 offen lds
s_add_u32 m0,s63,5120
s_add_u32 s65,s58,102400
buffer_load_dwordx4 v6,s[4:7],s65 offen lds
s_add_u32 m0,s63,6144
s_add_u32 s65,s58,122880
buffer_load_dwordx4 v6,s[4:7],s65 offen lds
s_add_u32 m0,s63,7168
s_add_u32 s65,s58,143360
buffer_load_dwordx4 v6,s[4:7],s65 offen lds
s_add_u32 m0,s63,8192
s_add_u32 s65,s58,163840
buffer_load_dwordx4 v6,s[4:7],s65 offen lds
s_add_u32 m0,s63,9216
s_add_u32 s65,s58,184320
buffer_load_dwordx4 v6,s[4:7],s65 offen lds
s_add_u32 m0,s63,10240
s_add_u32 s65,s58,204800
buffer_load_dwordx4 v6,s[4:7],s65 offen lds
s_add_u32 m0,s63,11264
s_add_u32 s65,s58,225280
buffer_load_dwordx4 v6,s[4:7],s65 offen lds
s_add_u32 m0,s63,12288
s_add_u32 s65,s58,245760
buffer_load_dwordx4 v6,s[4:7],s65 offen lds
s_add_u32 m0,s63,13312
s_add_u32 s65,s58,266240
buffer_load_dwordx4 v6,s[4:7],s65 offen lds
s_add_u32 m0,s63,14336
s_add_u32 s65,s58,286720
buffer_load_dwordx4 v6,s[4:7],s65 offen lds
s_add_u32 m0,s63,15360
s_add_u32 s65,s58,307200
buffer_load_dwordx4 v6,s[4:7],s65 offen lds
s_add_u32 m0,s63,16384
s_add_u32 s65,s58,327680
buffer_load_dwordx4 v6,s[4:7],s65 offen lds
s_add_u32 m0,s63,17408
s_add_u32 s65,s58,348160
buffer_load_dwordx4 v6,s[4:7],s65 offen lds
s_add_u32 m0,s63,18432
s_add_u32 s65,s58,368640
buffer_load_dwordx4 v6,s[4:7],s65 offen lds
s_add_u32 m0,s63,19456
s_add_u32 s65,s58,389120
buffer_load_dwordx4 v6,s[4:7],s65 offen lds
s_add_u32 m0,s63,20480
s_add_u32 s65,s58,409600
buffer_load_dwordx4 v6,s[4:7],s65 offen lds
s_add_u32 m0,s63,21504
s_add_u32 s65,s58,430080
buffer_load_dwordx4 v6,s[4:7],s65 offen lds
s_add_u32 m0,s63,22528
s_add_u32 s65,s58,450560
buffer_load_dwordx4 v6,s[4:7],s65 offen lds
s_add_u32 m0,s63,23552
s_add_u32 s65,s58,471040
buffer_load_dwordx4 v6,s[4:7],s65 offen lds
s_add_u32 m0,s63,24576
s_add_u32 s65,s58,491520
buffer_load_dwordx4 v6,s[4:7],s65 offen lds
s_add_u32 m0,s63,25600
s_add_u32 s65,s58,512000
buffer_load_dwordx4 v6,s[4:7],s65 offen lds
s_add_u32 m0,s63,26624
s_add_u32 s65,s58,532480
buffer_load_dwordx4 v6,s[4:7],s65 offen lds
s_add_u32 m0,s63,27648
s_add_u32 s65,s58,552960
buffer_load_dwordx4 v6,s[4:7],s65 offen lds
s_add_u32 m0,s63,28672
s_add_u32 s65,s58,573440
buffer_load_dwordx4 v6,s[4:7],s65 offen lds
s_add_u32 m0,s63,29696
s_add_u32 s65,s58,593920
buffer_load_dwordx4 v6,s[4:7],s65 offen lds
s_add_u32 m0,s63,30720
s_add_u32 s65,s58,614400
buffer_load_dwordx4 v6,s[4:7],s65 offen lds
s_add_u32 m0,s63,31744
s_add_u32 s65,s58,634880
buffer_load_dwordx4 v6,s[4:7],s65 offen lds
s_add_u32 m0,s63,32768
s_add_u32 s65,s58,655360
buffer_load_dwordx4 v6,s[4:7],s65 offen lds
s_add_u32 m0,s63,33792
s_add_u32 s65,s58,675840
buffer_load_dwordx4 v6,s[4:7],s65 offen lds
s_add_u32 m0,s63,34816
s_add_u32 s65,s58,696320
buffer_load_dwordx4 v6,s[4:7],s65 offen lds
s_add_u32 m0,s63,35840
s_add_u32 s65,s58,716800
buffer_load_dwordx4 v6,s[4:7],s65 offen lds
s_add_u32 m0,s63,36864
s_add_u32 s65,s58,737280
buffer_load_dwordx4 v6,s[4:7],s65 offen lds
s_add_u32 m0,s63,37888
s_add_u32 s65,s58,757760
buffer_load_dwordx4 v6,s[4:7],s65 offen lds
s_add_u32 m0,s63,38912
s_add_u32 s65,s58,778240
buffer_load_dwordx4 v6,s[4:7],s65 offen lds
s_add_u32 m0,s63,39936
s_add_u32 s65,s58,798720
buffer_load_dwordx4 v6,s[4:7],s65 offen lds
s_waitcnt vmcnt(20)
v_bfe_u32 v9,v0,2,2
v_lshrrev_b32 v10,5,v0
v_lshl_add_u32 v9,v10,2,v9
v_mul_u32_u24 v9,64,v9
v_and_b32 v10,1,v0
v_lshl_add_u32 v9,v10,3,v9
v_bfe_u32 v10,v0,1,1
v_lshl_add_u32 v9,v10,5,v9
v_bfe_u32 v10,v0,4,1
v_lshl_add_u32 v9,v10,4,v9
v_add_u32 v7,s63,v9
ds_read_b64_tr_b16 a[0:1],v7 offset:0
ds_read_b64_tr_b16 a[2:3],v7 offset:1024
ds_read_b64_tr_b16 a[4:5],v7 offset:512
ds_read_b64_tr_b16 a[6:7],v7 offset:1536
ds_read_b64_tr_b16 a[8:9],v7 offset:2048
ds_read_b64_tr_b16 a[10:11],v7 offset:3072
ds_read_b64_tr_b16 a[12:13],v7 offset:2560
ds_read_b64_tr_b16 a[14:15],v7 offset:3584
ds_read_b64_tr_b16 a[16:17],v7 offset:4096
ds_read_b64_tr_b16 a[18:19],v7 offset:5120
ds_read_b64_tr_b16 a[20:21],v7 offset:4608
ds_read_b64_tr_b16 a[22:23],v7 offset:5632
s_waitcnt lgkmcnt(4)
ds_read_b64_tr_b16 a[24:25],v7 offset:6144
ds_read_b64_tr_b16 a[26:27],v7 offset:7168
ds_read_b64_tr_b16 a[28:29],v7 offset:6656
ds_read_b64_tr_b16 a[30:31],v7 offset:7680
ds_read_b64_tr_b16 a[32:33],v7 offset:8192
ds_read_b64_tr_b16 a[34:35],v7 offset:9216
ds_read_b64_tr_b16 a[36:37],v7 offset:8704
ds_read_b64_tr_b16 a[38:39],v7 offset:9728
ds_read_b64_tr_b16 a[40:41],v7 offset:10240
ds_read_b64_tr_b16 a[42:43],v7 offset:11264
ds_read_b64_tr_b16 a[44:45],v7 offset:10752
ds_read_b64_tr_b16 a[46:47],v7 offset:11776
s_waitcnt lgkmcnt(4)
ds_read_b64_tr_b16 a[48:49],v7 offset:12288
ds_read_b64_tr_b16 a[50:51],v7 offset:13312
ds_read_b64_tr_b16 a[52:53],v7 offset:12800
ds_read_b64_tr_b16 a[54:55],v7 offset:13824
ds_read_b64_tr_b16 a[56:57],v7 offset:14336
ds_read_b64_tr_b16 a[58:59],v7 offset:15360
ds_read_b64_tr_b16 a[60:61],v7 offset:14848
ds_read_b64_tr_b16 a[62:63],v7 offset:15872
ds_read_b64_tr_b16 a[64:65],v7 offset:16384
ds_read_b64_tr_b16 a[66:67],v7 offset:17408
ds_read_b64_tr_b16 a[68:69],v7 offset:16896
ds_read_b64_tr_b16 a[70:71],v7 offset:17920
s_waitcnt lgkmcnt(4)
ds_read_b64_tr_b16 a[72:73],v7 offset:18432
ds_read_b64_tr_b16 a[74:75],v7 offset:19456
ds_read_b64_tr_b16 a[76:77],v7 offset:18944
ds_read_b64_tr_b16 a[78:79],v7 offset:19968
s_waitcnt lgkmcnt(0)
s_waitcnt vmcnt(0)
v_bfe_u32 v9,v0,2,2
v_lshrrev_b32 v10,5,v0
v_lshl_add_u32 v9,v10,2,v9
v_mul_u32_u24 v9,64,v9
v_and_b32 v10,1,v0
v_lshl_add_u32 v9,v10,3,v9
v_bfe_u32 v10,v0,1,1
v_lshl_add_u32 v9,v10,5,v9
v_bfe_u32 v10,v0,4,1
v_lshl_add_u32 v9,v10,4,v9
v_add_u32 v7,s63,v9
ds_read_b64_tr_b16 a[80:81],v7 offset:20480
ds_read_b64_tr_b16 a[82:83],v7 offset:21504
ds_read_b64_tr_b16 a[84:85],v7 offset:20992
ds_read_b64_tr_b16 a[86:87],v7 offset:22016
ds_read_b64_tr_b16 a[88:89],v7 offset:22528
ds_read_b64_tr_b16 a[90:91],v7 offset:23552
ds_read_b64_tr_b16 a[92:93],v7 offset:23040
ds_read_b64_tr_b16 a[94:95],v7 offset:24064
ds_read_b64_tr_b16 a[96:97],v7 offset:24576
ds_read_b64_tr_b16 a[98:99],v7 offset:25600
ds_read_b64_tr_b16 a[100:101],v7 offset:25088
ds_read_b64_tr_b16 a[102:103],v7 offset:26112
s_waitcnt lgkmcnt(4)
ds_read_b64_tr_b16 a[104:105],v7 offset:26624
ds_read_b64_tr_b16 a[106:107],v7 offset:27648
ds_read_b64_tr_b16 a[108:109],v7 offset:27136
ds_read_b64_tr_b16 a[110:111],v7 offset:28160
ds_read_b64_tr_b16 a[112:113],v7 offset:28672
ds_read_b64_tr_b16 a[114:115],v7 offset:29696
ds_read_b64_tr_b16 a[116:117],v7 offset:29184
ds_read_b64_tr_b16 a[118:119],v7 offset:30208
ds_read_b64_tr_b16 a[120:121],v7 offset:30720
ds_read_b64_tr_b16 a[122:123],v7 offset:31744
ds_read_b64_tr_b16 a[124:125],v7 offset:31232
ds_read_b64_tr_b16 a[126:127],v7 offset:32256
s_waitcnt lgkmcnt(4)
ds_read_b64_tr_b16 a[128:129],v7 offset:32768
ds_read_b64_tr_b16 a[130:131],v7 offset:33792
ds_read_b64_tr_b16 a[132:133],v7 offset:33280
ds_read_b64_tr_b16 a[134:135],v7 offset:34304
ds_read_b64_tr_b16 a[136:137],v7 offset:34816
ds_read_b64_tr_b16 a[138:139],v7 offset:35840
ds_read_b64_tr_b16 a[140:141],v7 offset:35328
ds_read_b64_tr_b16 a[142:143],v7 offset:36352
ds_read_b64_tr_b16 a[144:145],v7 offset:36864
ds_read_b64_tr_b16 a[146:147],v7 offset:37888
ds_read_b64_tr_b16 a[148:149],v7 offset:37376
ds_read_b64_tr_b16 a[150:151],v7 offset:38400
s_waitcnt lgkmcnt(4)
ds_read_b64_tr_b16 a[152:153],v7 offset:38912
ds_read_b64_tr_b16 a[154:155],v7 offset:39936
ds_read_b64_tr_b16 a[156:157],v7 offset:39424
ds_read_b64_tr_b16 a[158:159],v7 offset:40448
s_waitcnt lgkmcnt(0)
s_barrier
s_lshl_b32 s3,s49,2
v_mov_b32 v7,s3
s_nop 1
ibw_326:
buffer_load_dword v6,v7,s[12:15],0 offen sc1
s_waitcnt vmcnt(0)
v_cmp_ne_u32 vcc,256,v6
s_nop 0
s_cbranch_vccz ok_327
s_sleep 8
s_sub_u32 s47,s47,1
s_cbranch_scc1 ABORT
s_branch ibw_326
ok_327:
s_cmp_lg_u32 s49,0
s_cbranch_scc1 ibok_328
v_and_b32 v7,7,v0
v_lshlrev_b32 v7,2,v7
buffer_load_dword v6,v7,s[12:15],0 offen offset:32 sc1
s_waitcnt vmcnt(0)
v_cmp_ne_u32 vcc,32,v6
s_nop 0
s_cbranch_vccz ibok_328
s_barrier
s_mov_b32 s49,1
s_mov_b32 s3,s2
s_load_dwordx16 s[16:31],s[0:1],0
s_load_dwordx8 s[32:39],s[0:1],64
s_waitcnt lgkmcnt(0)
s_branch DISPATCH
ibok_328:
s_mov_b32 s50,0
s_mov_b32 s32,0
s_mov_b32 s57,0
s_mov_b32 s59,2147483648
s_mov_b32 s82,2147483648
s_mov_b32 s39,2147483648
v_mov_b32 v22,83968
v_lshl_add_u32 v22,v0,2,v22
v_mov_b32 v23,0
ds_write_b32 v22,v23
s_mov_b32 s39,1600000
v_and_b32 v72,15,v0
v_lshlrev_b32 v72,7,v72
s_mul_i32 s60,s56,-1792
s_add_u32 s60,s60,40960
v_and_b32 v6,128,v72
v_add_u32 v6,s60,v6
v_cmp_lt_u32 vcc,15,v0
s_nop 1
v_cndmask_b32 v72,v72,v6,vcc
v_min_u32 v6,59,v0
v_lshlrev_b32 v6,2,v6
v_add_u32 v2,135168,v6
v_add_u32 v7,-80,v6
v_cmp_gt_u32 s[78:79],20,v0
s_nop 1
v_cndmask_b32 v2,v7,v2,s[78:79]
s_mov_b32 s51,0
s_mov_b32 s52,0
s_mul_i32 s62,s51,8
s_and_b32 s63,s52,7
s_add_u32 s62,s62,s63
s_mul_i32 s62,s62,46080
s_add_u32 s62,s62,212467712
s_lshl_b32 s63,s56,11
s_add_u32 s62,s62,s63
buffer_load_dword v73,v72,s[8:11],s62 offen sc1
s_mov_b32 s51,0
s_mov_b32 s52,1
s_mul_i32 s62,s51,8
s_and_b32 s63,s52,7
s_add_u32 s62,s62,s63
s_mul_i32 s62,s62,46080
s_add_u32 s62,s62,212467712
s_lshl_b32 s63,s56,11
s_add_u32 s62,s62,s63
buffer_load_dword v73,v72,s[8:11],s62 offen sc1
s_mov_b32 s51,0
s_mov_b32 s52,2
s_mul_i32 s62,s51,8
s_and_b32 s63,s52,7
s_add_u32 s62,s62,s63
s_mul_i32 s62,s62,46080
s_add_u32 s62,s62,212467712
s_lshl_b32 s63,s56,11
s_add_u32 s62,s62,s63
buffer_load_dword v73,v72,s[8:11],s62 offen sc1
s_mov_b32 s51,0
s_mov_b32 s52,3
s_mul_i32 s62,s51,8
s_and_b32 s63,s52,7
s_add_u32 s62,s62,s63
s_mul_i32 s62,s62,46080
s_add_u32 s62,s62,212467712
s_lshl_b32 s63,s56,11
s_add_u32 s62,s62,s63
buffer_load_dword v73,v72,s[8:11],s62 offen sc1
s_mov_b32 s51,0
s_mov_b32 s52,4
s_mul_i32 s62,s51,8
s_and_b32 s63,s52,7
s_add_u32 s62,s62,s63
s_mul_i32 s62,s62,46080
s_add_u32 s62,s62,212467712
s_lshl_b32 s63,s56,11
s_add_u32 s62,s62,s63
buffer_load_dword v73,v72,s[8:11],s62 offen sc1
s_mov_b32 s51,0
s_mov_b32 s52,5
s_mul_i32 s62,s51,8
s_and_b32 s63,s52,7
s_add_u32 s62,s62,s63
s_mul_i32 s62,s62,46080
s_add_u32 s62,s62,212467712
s_lshl_b32 s63,s56,11
s_add_u32 s62,s62,s63
buffer_load_dword v73,v72,s[8:11],s62 offen sc1
s_mov_b32 s51,0
s_mov_b32 s52,6
s_mul_i32 s62,s51,8
s_and_b32 s63,s52,7
s_add_u32 s62,s62,s63
s_mul_i32 s62,s62,46080
s_add_u32 s62,s62,212467712
s_lshl_b32 s63,s56,11
s_add_u32 s62,s62,s63
buffer_load_dword v73,v72,s[8:11],s62 offen sc1
s_mov_b32 s51,0
s_mov_b32 s52,7
s_mul_i32 s62,s51,8
s_and_b32 s63,s52,7
s_add_u32 s62,s62,s63
s_mul_i32 s62,s62,46080
s_add_u32 s62,s62,212467712
s_lshl_b32 s63,s56,11
s_add_u32 s62,s62,s63
buffer_load_dword v73,v72,s[8:11],s62 offen sc1
s_mov_b32 s51,1
s_mov_b32 s52,0
s_mul_i32 s62,s51,8
s_and_b32 s63,s52,7
s_add_u32 s62,s62,s63
s_mul_i32 s62,s62,46080
s_add_u32 s62,s62,212467712
s_lshl_b32 s63,s56,11
s_add_u32 s62,s62,s63
buffer_load_dword v73,v72,s[8:11],s62 offen sc1
s_mov_b32 s51,1
s_mov_b32 s52,1
s_mul_i32 s62,s51,8
s_and_b32 s63,s52,7
s_add_u32 s62,s62,s63
s_mul_i32 s62,s62,46080
s_add_u32 s62,s62,212467712
s_lshl_b32 s63,s56,11
s_add_u32 s62,s62,s63
buffer_load_dword v73,v72,s[8:11],s62 offen sc1
s_mov_b32 s51,1
s_mov_b32 s52,2
s_mul_i32 s62,s51,8
s_and_b32 s63,s52,7
s_add_u32 s62,s62,s63
s_mul_i32 s62,s62,46080
s_add_u32 s62,s62,212467712
s_lshl_b32 s63,s56,11
s_add_u32 s62,s62,s63
buffer_load_dword v73,v72,s[8:11],s62 offen sc1
s_mov_b32 s51,1
s_mov_b32 s52,3
s_mul_i32 s62,s51,8
s_and_b32 s63,s52,7
s_add_u32 s62,s62,s63
s_mul_i32 s62,s62,46080
s_add_u32 s62,s62,212467712
s_lshl_b32 s63,s56,11
s_add_u32 s62,s62,s63
buffer_load_dword v73,v72,s[8:11],s62 offen sc1
s_mov_b32 s51,1
s_mov_b32 s52,4
s_mul_i32 s62,s51,8
s_and_b32 s63,s52,7
s_add_u32 s62,s62,s63
s_mul_i32 s62,s62,46080
s_add_u32 s62,s62,212467712
s_lshl_b32 s63,s56,11
s_add_u32 s62,s62,s63
buffer_load_dword v73,v72,s[8:11],s62 offen sc1
s_mov_b32 s51,1
s_mov_b32 s52,5
s_mul_i32 s62,s51,8
s_and_b32 s63,s52,7
s_add_u32 s62,s62,s63
s_mul_i32 s62,s62,46080
s_add_u32 s62,s62,212467712
s_lshl_b32 s63,s56,11
s_add_u32 s62,s62,s63
buffer_load_dword v73,v72,s[8:11],s62 offen sc1
s_mov_b32 s51,1
s_mov_b32 s52,6
s_mul_i32 s62,s51,8
s_and_b32 s63,s52,7
s_add_u32 s62,s62,s63
s_mul_i32 s62,s62,46080
s_add_u32 s62,s62,212467712
s_lshl_b32 s63,s56,11
s_add_u32 s62,s62,s63
buffer_load_dword v73,v72,s[8:11],s62 offen sc1
s_mov_b32 s51,1
s_mov_b32 s52,7
s_mul_i32 s62,s51,8
s_and_b32 s63,s52,7
s_add_u32 s62,s62,s63
s_mul_i32 s62,s62,46080
s_add_u32 s62,s62,212467712
s_lshl_b32 s63,s56,11
s_add_u32 s62,s62,s63
buffer_load_dword v73,v72,s[8:11],s62 offen sc1
s_waitcnt vmcnt(0)
s_waitcnt lgkmcnt(0)
s_barrier
s_mov_b32 s83,s100
s_min_u32 s62,s32,127
s_sub_u32 s60,s62,14
s_lshr_b32 s34,s60,1
s_and_b32 s33,s60,1
s_cmp_eq_u32 s33,0
s_cselect_b32 s61,14,0
s_add_u32 s34,s34,s61
s_sub_u32 s61,s60,50
s_cmp_ge_u32 s60,100
s_cselect_b32 s34,s61,s34
s_cselect_b32 s33,1,s33
s_cmp_lt_u32 s62,14
s_cselect_b32 s34,s62,s34
s_cselect_b32 s33,0,s33
s_add_u32 s60,s34,1
s_min_u32 s60,s60,63
s_lshl_b32 s35,s33,6
s_add_u32 s35,s35,s60
s_lshl_b32 s35,s35,9
s_add_u32 s35,s35,323584
s_cmp_lt_u32 s60,8
s_cselect_b64 s[76:77],s[78:79],-1
s_sub_u32 s57,40960,s57
v_swap_b32 v16,v18
v_swap_b32 v17,v19
s_add_u32 s62,s32,1
s_min_u32 s62,s62,127
s_sub_u32 s60,s62,14
s_lshr_b32 s41,s60,1
s_and_b32 s40,s60,1
s_cmp_eq_u32 s40,0
s_cselect_b32 s61,14,0
s_add_u32 s41,s41,s61
s_sub_u32 s61,s60,50
s_cmp_ge_u32 s60,100
s_cselect_b32 s41,s61,s41
s_cselect_b32 s40,1,s40
s_cmp_lt_u32 s62,14
s_cselect_b32 s41,s62,s41
s_cselect_b32 s40,0,s40
s_add_u32 s60,s41,1
s_min_u32 s60,s60,63
s_lshl_b32 s42,s40,6
s_add_u32 s42,s42,s60
s_lshl_b32 s42,s42,9
s_add_u32 s42,s42,323584
s_cmp_lt_u32 s60,8
s_cselect_b64 s[80:81],s[78:79],-1
W2_COLD:
s_mov_b32 s37,0
fb_329:
buffer_load_dword v3,v2,s[8:11],s35 offen sc1
s_waitcnt vmcnt(0)
v_cmp_eq_u32 vcc,0,v3
s_and_b64 vcc,vcc,s[76:77]
s_cbranch_scc0 ok_330
s_sleep 2
s_sub_u32 s47,s47,1
s_cbranch_scc1 ABORT
s_branch fb_329
ok_330:
W2_COLD2:
s_sub_u32 s66,40960,s57
s_add_u32 s61,s34,s68
s_and_b32 s62,s61,7
s_cmp_lt_u32 s61,64
s_cselect_b32 s62,s62,8
s_mul_i32 s62,s62,40960
s_and_b32 s61,s34,7
s_mul_i32 s61,s61,40960
v_mad_u32_u24 v112,v76,s62,v74
v_mad_u32_u24 v112,v78,s61,v112
v_mad_u32_u24 v113,v77,s62,v75
v_mad_u32_u24 v113,v79,s61,v113
s_mov_b32 s60,s33
s_mul_i32 s60,s60,368640
s_add_u32 s60,s60,s37
s_mul_i32 s61,s46,10240
s_add_u32 s60,s60,s61
s_add_u32 s60,s60,237371392
s_add_u32 s61,s61,s66
s_add_u32 m0,s61,0
s_add_u32 s63,s60,0
buffer_load_dwordx4 v112,s[8:11],s63 offen sc1 lds
s_add_u32 m0,s61,1024
s_nop 0
buffer_load_dwordx4 v113,s[8:11],s63 offen sc1 lds
s_add_u32 m0,s61,2048
s_add_u32 s63,s60,2048
buffer_load_dwordx4 v112,s[8:11],s63 offen sc1 lds
s_add_u32 m0,s61,3072
s_nop 0
buffer_load_dwordx4 v113,s[8:11],s63 offen sc1 lds
s_add_u32 m0,s61,4096
s_add_u32 s63,s60,4096
buffer_load_dwordx4 v112,s[8:11],s63 offen sc1 lds
s_add_u32 m0,s61,5120
s_nop 0
buffer_load_dwordx4 v113,s[8:11],s63 offen sc1 lds
s_waitcnt vmcnt(5)
s_mov_b64 exec,1
s_cmp_lg_u32 s49,0
s_cbranch_scc0 ls_331
buffer_store_dword v5,v1,s[8:11],s59 offen sc1
s_branch ls_332
ls_331:
buffer_store_dword v5,v1,s[8:11],s59 offen
ls_332:
s_mov_b64 exec,-1
s_mov_b32 s59,2147483648
s_add_u32 m0,s61,6144
s_add_u32 s63,s60,6144
buffer_load_dwordx4 v112,s[8:11],s63 offen sc1 lds
s_add_u32 m0,s61,7168
s_nop 0
buffer_load_dwordx4 v113,s[8:11],s63 offen sc1 lds
s_add_u32 m0,s61,8192
s_add_u32 s63,s60,8192
buffer_load_dwordx4 v112,s[8:11],s63 offen sc1 lds
s_add_u32 m0,s61,9216
s_nop 0
buffer_load_dwordx4 v113,s[8:11],s63 offen sc1 lds
s_mov_b32 s35,s42
s_mov_b32 s53,s33
s_mov_b32 s54,s34
s_add_u32 s32,s32,1
s_mov_b32 s33,s40
s_mov_b32 s34,s41
s_mov_b64 s[76:77],s[80:81]
s_sub_u32 s57,40960,s57
v_swap_b32 v16,v18
v_swap_b32 v17,v19
s_mov_b32 s51,s53
s_mov_b32 s52,s54
s_waitcnt vmcnt(5)
s_branch W2_GO
W2_NEXT:
s_sub_u32 s57,40960,s57
v_swap_b32 v16,v18
v_swap_b32 v17,v19
s_mov_b32 s51,s53
s_mov_b32 s52,s54
s_waitcnt vmcnt(3)
W2_GO:
s_barrier
ds_read_b128 v[24:27],v16 offset:0
ds_read_b128 v[28:31],v17 offset:0
ds_read_b128 v[32:35],v16 offset:10240
ds_read_b128 v[36:39],v17 offset:10240
ds_read_b128 v[40:43],v16 offset:20480
ds_read_b128 v[44:47],v17 offset:20480
ds_read_b128 v[48:51],v16 offset:30720
buffer_load_dword v3,v2,s[8:11],s35 offen sc1
s_waitcnt lgkmcnt(6)
v_mfma_f32_32x32x16_bf16 v[56:71],a[0:3],v[24:27],0
ds_read_b128 v[52:55],v17 offset:30720
s_lshl_b32 s60,s51,6
s_add_u32 s60,s60,s52
s_mul_i32 s60,s60,46080
s_waitcnt lgkmcnt(6)
v_mfma_f32_32x32x16_bf16 v[56:71],a[4:7],v[28:31],v[56:71]
ds_read_b128 v[24:27],v16 offset:2048
s_lshl_b32 s61,s56,11
s_add_u32 s60,s60,s61
s_add_u32 s60,s60,223608832
s_waitcnt lgkmcnt(5)
v_mfma_f32_32x32x16_bf16 v[56:71],a[40:43],v[32:35],v[56:71]
ds_read_b128 v[28:31],v17 offset:2048
buffer_load_dwordx4 v[120:123],v116,s[8:11],s60 offen sc1
buffer_load_dwordx4 v[124:127],v117,s[8:11],s60 offen sc1
v_mfma_f32_32x32x16_bf16 v[56:71],a[44:47],v[36:39],v[56:71]
ds_read_b128 v[32:35],v16 offset:12288
s_add_u32 s62,s32,1
s_min_u32 s62,s62,127
s_sub_u32 s60,s62,14
s_waitcnt lgkmcnt(5)
v_mfma_f32_32x32x16_bf16 v[56:71],a[80:83],v[40:43],v[56:71]
ds_read_b128 v[36:39],v17 offset:12288
s_lshr_b32 s41,s60,1
s_and_b32 s40,s60,1
s_cmp_eq_u32 s40,0
s_cselect_b32 s61,14,0
v_mfma_f32_32x32x16_bf16 v[56:71],a[84:87],v[44:47],v[56:71]
ds_read_b128 v[40:43],v16 offset:22528
s_add_u32 s41,s41,s61
s_sub_u32 s61,s60,50
s_mul_i32 s71,s51,8
s_waitcnt lgkmcnt(5)
v_mfma_f32_32x32x16_bf16 v[56:71],a[120:123],v[48:51],v[56:71]
ds_read_b128 v[44:47],v17 offset:22528
s_cmp_ge_u32 s60,100
s_cselect_b32 s41,s61,s41
s_cselect_b32 s40,1,s40
s_and_b32 s72,s52,7
v_mfma_f32_32x32x16_bf16 v[56:71],a[124:127],v[52:55],v[56:71]
ds_read_b128 v[48:51],v16 offset:32768
s_cmp_lt_u32 s62,14
s_cselect_b32 s41,s62,s41
s_cselect_b32 s40,0,s40
s_waitcnt lgkmcnt(5)
v_mfma_f32_32x32x16_bf16 v[56:71],a[8:11],v[24:27],v[56:71]
ds_read_b128 v[52:55],v17 offset:32768
s_add_u32 s60,s41,1
s_min_u32 s60,s60,63
s_lshl_b32 s42,s40,6
s_add_u32 s42,s42,s60
v_mfma_f32_32x32x16_bf16 v[56:71],a[12:15],v[28:31],v[56:71]
ds_read_b128 v[24:27],v16 offset:4096
s_lshl_b32 s42,s42,9
s_add_u32 s42,s42,323584
s_add_u32 s71,s71,s72
s_waitcnt lgkmcnt(5)
v_mfma_f32_32x32x16_bf16 v[56:71],a[48:51],v[32:35],v[56:71]
ds_read_b128 v[28:31],v17 offset:4096
s_cmp_lt_u32 s60,8
s_cselect_b64 s[80:81],s[78:79],-1
s_mul_i32 s71,s71,46080
s_add_u32 s71,s71,212467712
v_mfma_f32_32x32x16_bf16 v[56:71],a[52:55],v[36:39],v[56:71]
ds_read_b128 v[32:35],v16 offset:14336
s_lshl_b32 s72,s56,8
s_add_u32 s72,s72,s71
s_add_u32 s72,s72,40960
s_waitcnt lgkmcnt(5)
v_mfma_f32_32x32x16_bf16 v[56:71],a[88:91],v[40:43],v[56:71]
ds_read_b128 v[36:39],v17 offset:14336
s_waitcnt vmcnt(2)
s_mov_b64 exec,1
s_cmp_lg_u32 s49,0
s_cbranch_scc0 ls_333
buffer_store_dword v5,v1,s[8:11],s59 offen sc1
s_branch ls_334
ls_333:
buffer_store_dword v5,v1,s[8:11],s59 offen
ls_334:
s_mov_b64 exec,-1
s_mov_b32 s59,2147483648
v_mfma_f32_32x32x16_bf16 v[56:71],a[92:95],v[44:47],v[56:71]
ds_read_b128 v[40:43],v16 offset:24576
v_cmp_eq_u32 vcc,0,v3
s_and_b64 vcc,vcc,s[76:77]
s_cselect_b32 s37,2147483648,0
s_waitcnt lgkmcnt(5)
v_mfma_f32_32x32x16_bf16 v[56:71],a[128:131],v[48:51],v[56:71]
ds_read_b128 v[44:47],v17 offset:24576
s_cmp_lt_u32 s32,128
s_cselect_b32 s37,s37,2147483648
s_sub_u32 s66,40960,s57
s_add_u32 s61,s34,s68
v_mfma_f32_32x32x16_bf16 v[56:71],a[132:135],v[52:55],v[56:71]
ds_read_b128 v[48:51],v16 offset:34816
s_and_b32 s62,s61,7
s_cmp_lt_u32 s61,64
s_cselect_b32 s62,s62,8
s_waitcnt lgkmcnt(5)
v_mfma_f32_32x32x16_bf16 v[56:71],a[16:19],v[24:27],v[56:71]
ds_read_b128 v[52:55],v17 offset:34816
s_mul_i32 s62,s62,40960
s_and_b32 s61,s34,7
s_mul_i32 s61,s61,40960
v_mad_u32_u24 v112,v76,s62,v74
s_barrier
v_mfma_f32_32x32x16_bf16 v[56:71],a[20:23],v[28:31],v[56:71]
ds_read_b128 v[24:27],v16 offset:6144
v_mad_u32_u24 v112,v78,s61,v112
v_mad_u32_u24 v113,v77,s62,v75
v_mad_u32_u24 v113,v79,s61,v113
s_waitcnt lgkmcnt(5)
v_mfma_f32_32x32x16_bf16 v[56:71],a[56:59],v[32:35],v[56:71]
ds_read_b128 v[28:31],v17 offset:6144
s_mov_b32 s60,s33
s_mul_i32 s60,s60,368640
s_add_u32 s60,s60,s37
s_mul_i32 s61,s46,10240
v_mfma_f32_32x32x16_bf16 v[56:71],a[60:63],v[36:39],v[56:71]
ds_read_b128 v[32:35],v16 offset:16384
s_add_u32 s60,s60,s61
s_add_u32 s60,s60,237371392
s_add_u32 s61,s61,s66
s_waitcnt lgkmcnt(5)
v_mfma_f32_32x32x16_bf16 v[56:71],a[96:99],v[40:43],v[56:71]
ds_read_b128 v[36:39],v17 offset:16384
s_add_u32 m0,s61,0
s_add_u32 s63,s60,0
buffer_load_dwordx4 v112,s[8:11],s63 offen sc1 lds
v_mfma_f32_32x32x16_bf16 v[56:71],a[100:103],v[44:47],v[56:71]
ds_read_b128 v[40:43],v16 offset:26624
s_add_u32 m0,s61,1024
s_lshl_b32 s73,s56,11
s_add_u32 s71,s71,s73
s_waitcnt lgkmcnt(5)
v_mfma_f32_32x32x16_bf16 v[56:71],a[136:139],v[48:51],v[56:71]
ds_read_b128 v[44:47],v17 offset:26624
buffer_load_dwordx4 v113,s[8:11],s63 offen sc1 lds
s_add_u32 m0,s61,2048
s_add_u32 s63,s60,2048
v_mfma_f32_32x32x16_bf16 v[56:71],a[140:143],v[52:55],v[56:71]
ds_read_b128 v[48:51],v16 offset:36864
s_lshl_b32 s82,s51,6
s_add_u32 s82,s82,s52
s_lshl_b32 s82,s82,9
s_waitcnt lgkmcnt(5)
v_mfma_f32_32x32x16_bf16 v[56:71],a[24:27],v[24:27],v[56:71]
ds_read_b128 v[52:55],v17 offset:36864
buffer_load_dwordx4 v112,s[8:11],s63 offen sc1 lds
s_add_u32 m0,s61,3072
s_add_u32 s82,s82,524288
v_mfma_f32_32x32x16_bf16 v[56:71],a[28:31],v[28:31],v[56:71]
ds_read_b128 v[24:27],v16 offset:8192
s_lshl_b32 s70,s56,2
s_add_u32 s82,s82,s70
s_waitcnt lgkmcnt(5)
v_mfma_f32_32x32x16_bf16 v[56:71],a[64:67],v[32:35],v[56:71]
ds_read_b128 v[28:31],v17 offset:8192
buffer_load_dwordx4 v113,s[8:11],s63 offen sc1 lds
s_add_u32 m0,s61,4096
s_add_u32 s63,s60,4096
v_mfma_f32_32x32x16_bf16 v[56:71],a[68:71],v[36:39],v[56:71]
ds_read_b128 v[32:35],v16 offset:18432
s_waitcnt lgkmcnt(5)
v_mfma_f32_32x32x16_bf16 v[56:71],a[104:107],v[40:43],v[56:71]
ds_read_b128 v[36:39],v17 offset:18432
buffer_load_dwordx4 v112,s[8:11],s63 offen sc1 lds
s_add_u32 m0,s61,5120
v_mfma_f32_32x32x16_bf16 v[56:71],a[108:111],v[44:47],v[56:71]
ds_read_b128 v[40:43],v16 offset:28672
s_waitcnt lgkmcnt(5)
v_mfma_f32_32x32x16_bf16 v[56:71],a[144:147],v[48:51],v[56:71]
ds_read_b128 v[44:47],v17 offset:28672
buffer_load_dword v3,v2,s[8:11],s35 offen sc1
v_mfma_f32_32x32x16_bf16 v[56:71],a[148:151],v[52:55],v[56:71]
ds_read_b128 v[48:51],v16 offset:38912
buffer_load_dwordx4 v113,s[8:11],s63 offen sc1 lds
s_add_u32 m0,s61,6144
s_waitcnt lgkmcnt(5)
v_mfma_f32_32x32x16_bf16 v[56:71],a[32:35],v[24:27],v[56:71]
ds_read_b128 v[52:55],v17 offset:38912
s_add_u32 s63,s60,6144
v_mfma_f32_32x32x16_bf16 v[56:71],a[36:39],v[28:31],v[56:71]
buffer_load_dwordx4 v112,s[8:11],s63 offen sc1 lds
s_add_u32 m0,s61,7168
s_waitcnt lgkmcnt(4)
v_mfma_f32_32x32x16_bf16 v[56:71],a[72:75],v[32:35],v[56:71]
v_mfma_f32_32x32x16_bf16 v[56:71],a[76:79],v[36:39],v[56:71]
buffer_load_dwordx4 v113,s[8:11],s63 offen sc1 lds
s_add_u32 m0,s61,8192
s_add_u32 s63,s60,8192
s_waitcnt lgkmcnt(2)
v_mfma_f32_32x32x16_bf16 v[56:71],a[112:115],v[40:43],v[56:71]
v_mfma_f32_32x32x16_bf16 v[56:71],a[116:119],v[44:47],v[56:71]
buffer_load_dwordx4 v112,s[8:11],s63 offen sc1 lds
s_add_u32 m0,s61,9216
s_waitcnt lgkmcnt(0)
v_mfma_f32_32x32x16_bf16 v[56:71],a[152:155],v[48:51],v[56:71]
v_mfma_f32_32x32x16_bf16 v[56:71],a[156:159],v[52:55],v[56:71]
buffer_load_dwordx4 v113,s[8:11],s63 offen sc1 lds
s_waitcnt vmcnt(12)
v_lshlrev_b32 v128,16,v120
v_and_b32 v129,0xffff0000,v120
v_lshlrev_b32 v130,16,v121
v_and_b32 v131,0xffff0000,v121
v_lshlrev_b32 v132,16,v122
v_and_b32 v133,0xffff0000,v122
v_lshlrev_b32 v134,16,v123
v_and_b32 v135,0xffff0000,v123
v_lshlrev_b32 v136,16,v124
v_and_b32 v137,0xffff0000,v124
v_lshlrev_b32 v138,16,v125
v_and_b32 v139,0xffff0000,v125
v_lshlrev_b32 v140,16,v126
v_and_b32 v141,0xffff0000,v126
v_lshlrev_b32 v142,16,v127
v_and_b32 v143,0xffff0000,v127
s_cmp_eq_u32 s37,0
s_cbranch_scc0 sec_337
s_mov_b32 s35,s42
s_mov_b32 s53,s33
s_mov_b32 s54,s34
s_add_u32 s32,s32,1
s_mov_b32 s33,s40
s_mov_b32 s34,s41
s_mov_b64 s[76:77],s[80:81]
s_nop 2
ep_335:
v_cvt_pk_bf16_f32 v6,v56,v57
v_lshlrev_b32 v56,16,v6
v_and_b32 v57,0xffff0000,v6
v_cvt_pk_bf16_f32 v6,v58,v59
v_lshlrev_b32 v58,16,v6
v_and_b32 v59,0xffff0000,v6
v_cvt_pk_bf16_f32 v6,v60,v61
v_lshlrev_b32 v60,16,v6
v_and_b32 v61,0xffff0000,v6
v_cvt_pk_bf16_f32 v6,v62,v63
v_lshlrev_b32 v62,16,v6
v_and_b32 v63,0xffff0000,v6
v_cvt_pk_bf16_f32 v6,v64,v65
v_lshlrev_b32 v64,16,v6
v_and_b32 v65,0xffff0000,v6
v_cvt_pk_bf16_f32 v6,v66,v67
v_lshlrev_b32 v66,16,v6
v_and_b32 v67,0xffff0000,v6
v_cvt_pk_bf16_f32 v6,v68,v69
v_lshlrev_b32 v68,16,v6
v_and_b32 v69,0xffff0000,v6
v_cvt_pk_bf16_f32 v6,v70,v71
v_lshlrev_b32 v70,16,v6
v_and_b32 v71,0xffff0000,v6
v_pk_add_f32 v[56:57],v[56:57],v[128:129]
v_pk_add_f32 v[58:59],v[58:59],v[130:131]
v_pk_add_f32 v[60:61],v[60:61],v[132:133]
v_pk_add_f32 v[62:63],v[62:63],v[134:135]
v_pk_add_f32 v[64:65],v[64:65],v[136:137]
v_pk_add_f32 v[66:67],v[66:67],v[138:139]
v_pk_add_f32 v[68:69],v[68:69],v[140:141]
v_pk_add_f32 v[70:71],v[70:71],v[142:143]
v_cvt_pk_bf16_f32 v144,v56,v57
v_lshlrev_b32 v56,16,v144
v_and_b32 v57,0xffff0000,v144
v_cvt_pk_bf16_f32 v145,v58,v59
v_lshlrev_b32 v58,16,v145
v_and_b32 v59,0xffff0000,v145
v_cvt_pk_bf16_f32 v146,v60,v61
v_lshlrev_b32 v60,16,v146
v_and_b32 v61,0xffff0000,v146
v_cvt_pk_bf16_f32 v147,v62,v63
v_lshlrev_b32 v62,16,v147
v_and_b32 v63,0xffff0000,v147
v_cvt_pk_bf16_f32 v148,v64,v65
v_lshlrev_b32 v64,16,v148
v_and_b32 v65,0xffff0000,v148
v_cvt_pk_bf16_f32 v149,v66,v67
v_lshlrev_b32 v66,16,v149
v_and_b32 v67,0xffff0000,v149
v_cvt_pk_bf16_f32 v150,v68,v69
v_lshlrev_b32 v68,16,v150
v_and_b32 v69,0xffff0000,v150
v_cvt_pk_bf16_f32 v151,v70,v71
v_lshlrev_b32 v70,16,v151
v_and_b32 v71,0xffff0000,v151
s_cmp_lg_u32 s49,0
s_cbranch_scc0 ls_338
buffer_store_dwordx4 v[144:147],v20,s[8:11],s71 offen sc1
buffer_store_dwordx4 v[148:151],v21,s[8:11],s71 offen sc1
s_branch ls_339
ls_338:
buffer_store_dwordx4 v[144:147],v20,s[8:11],s71 offen
buffer_store_dwordx4 v[148:151],v21,s[8:11],s71 offen
ls_339:
v_pk_add_f32 v[6:7],v[56:57],v[58:59]
v_pk_mul_f32 v[8:9],v[56:57],v[56:57]
v_pk_fma_f32 v[8:9],v[58:59],v[58:59],v[8:9]
v_pk_add_f32 v[6:7],v[6:7],v[60:61]
v_pk_fma_f32 v[8:9],v[60:61],v[60:61],v[8:9]
v_pk_add_f32 v[6:7],v[6:7],v[62:63]
v_pk_fma_f32 v[8:9],v[62:63],v[62:63],v[8:9]
v_pk_add_f32 v[6:7],v[6:7],v[64:65]
v_pk_fma_f32 v[8:9],v[64:65],v[64:65],v[8:9]
v_pk_add_f32 v[6:7],v[6:7],v[66:67]
v_pk_fma_f32 v[8:9],v[66:67],v[66:67],v[8:9]
v_pk_add_f32 v[6:7],v[6:7],v[68:69]
v_pk_fma_f32 v[8:9],v[68:69],v[68:69],v[8:9]
v_pk_add_f32 v[6:7],v[6:7],v[70:71]
v_pk_fma_f32 v[8:9],v[70:71],v[70:71],v[8:9]
v_add_f32 v6,v6,v7
v_add_f32 v7,v8,v9
v_mov_b32 v8,v6
v_mov_b32 v9,v7
s_nop 0
v_permlane32_swap_b32 v6,v8
v_permlane32_swap_b32 v7,v9
v_pk_add_f32 v[6:7],v[6:7],v[8:9]
s_mov_b32 exec_hi,0
s_cmp_lg_u32 s49,0
s_cbranch_scc0 ls_340
buffer_store_dwordx2 v[6:7],v114,s[8:11],s72 offen sc1
s_branch ls_341
ls_340:
buffer_store_dwordx2 v[6:7],v114,s[8:11],s72 offen
ls_341:
s_mov_b32 exec_hi,-1
s_mov_b32 s59,s82
s_cmp_eq_u32 s37,0
s_cbranch_scc1 W2_NEXT
s_waitcnt vmcnt(3)
v_cmp_eq_u32 vcc,0,v3
s_and_b64 vcc,vcc,s[76:77]
s_cselect_b32 s37,2147483648,0
s_cmp_lt_u32 s32,128
s_cselect_b32 s37,s37,2147483648
s_cmp_eq_u32 s37,0
s_cbranch_scc1 W2_COLD2
s_waitcnt vmcnt(0)
s_mov_b64 exec,1
s_cmp_lg_u32 s49,0
s_cbranch_scc0 ls_342
buffer_store_dword v5,v1,s[8:11],s59 offen sc1
s_branch ls_343
ls_342:
buffer_store_dword v5,v1,s[8:11],s59 offen
ls_343:
s_mov_b64 exec,-1
s_mov_b32 s59,2147483648
s_cmp_lt_u32 s32,128
s_cbranch_scc1 W2_COLD
s_branch W2_END
sec_337:
s_waitcnt vmcnt(5)
v_cmp_eq_u32 vcc,0,v3
s_and_b64 vcc,vcc,s[76:77]
s_cselect_b32 s37,2147483648,0
s_cmp_lt_u32 s32,128
s_cselect_b32 s37,s37,2147483648
s_cmp_lg_u32 s37,0
s_cbranch_scc1 nr_336
s_sub_u32 s66,40960,s57
s_add_u32 s61,s34,s68
s_and_b32 s62,s61,7
s_cmp_lt_u32 s61,64
s_cselect_b32 s62,s62,8
s_mul_i32 s62,s62,40960
s_and_b32 s61,s34,7
s_mul_i32 s61,s61,40960
v_mad_u32_u24 v112,v76,s62,v74
v_mad_u32_u24 v112,v78,s61,v112
v_mad_u32_u24 v113,v77,s62,v75
v_mad_u32_u24 v113,v79,s61,v113
s_mov_b32 s60,s33
s_mul_i32 s60,s60,368640
s_add_u32 s60,s60,s37
s_mul_i32 s61,s46,10240
s_add_u32 s60,s60,s61
s_add_u32 s60,s60,237371392
s_add_u32 s61,s61,s66
s_add_u32 m0,s61,0
s_add_u32 s63,s60,0
buffer_load_dwordx4 v112,s[8:11],s63 offen sc1 lds
v_cvt_pk_bf16_f32 v6,v56,v57
v_lshlrev_b32 v56,16,v6
v_and_b32 v57,0xffff0000,v6
v_cvt_pk_bf16_f32 v6,v58,v59
s_add_u32 m0,s61,1024
s_nop 0
buffer_load_dwordx4 v113,s[8:11],s63 offen sc1 lds
v_lshlrev_b32 v58,16,v6
v_and_b32 v59,0xffff0000,v6
v_cvt_pk_bf16_f32 v6,v60,v61
v_lshlrev_b32 v60,16,v6
s_add_u32 m0,s61,2048
s_add_u32 s63,s60,2048
buffer_load_dwordx4 v112,s[8:11],s63 offen sc1 lds
v_and_b32 v61,0xffff0000,v6
v_cvt_pk_bf16_f32 v6,v62,v63
v_lshlrev_b32 v62,16,v6
v_and_b32 v63,0xffff0000,v6
s_add_u32 m0,s61,3072
s_nop 0
buffer_load_dwordx4 v113,s[8:11],s63 offen sc1 lds
v_cvt_pk_bf16_f32 v6,v64,v65
v_lshlrev_b32 v64,16,v6
v_and_b32 v65,0xffff0000,v6
v_cvt_pk_bf16_f32 v6,v66,v67
s_add_u32 m0,s61,4096
s_add_u32 s63,s60,4096
buffer_load_dwordx4 v112,s[8:11],s63 offen sc1 lds
v_lshlrev_b32 v66,16,v6
v_and_b32 v67,0xffff0000,v6
v_cvt_pk_bf16_f32 v6,v68,v69
v_lshlrev_b32 v68,16,v6
s_add_u32 m0,s61,5120
s_nop 0
buffer_load_dwordx4 v113,s[8:11],s63 offen sc1 lds
v_and_b32 v69,0xffff0000,v6
v_cvt_pk_bf16_f32 v6,v70,v71
v_lshlrev_b32 v70,16,v6
v_and_b32 v71,0xffff0000,v6
s_add_u32 m0,s61,6144
s_add_u32 s63,s60,6144
buffer_load_dwordx4 v112,s[8:11],s63 offen sc1 lds
v_pk_add_f32 v[56:57],v[56:57],v[128:129]
v_pk_add_f32 v[58:59],v[58:59],v[130:131]
v_pk_add_f32 v[60:61],v[60:61],v[132:133]
v_pk_add_f32 v[62:63],v[62:63],v[134:135]
s_add_u32 m0,s61,7168
s_nop 0
buffer_load_dwordx4 v113,s[8:11],s63 offen sc1 lds
v_pk_add_f32 v[64:65],v[64:65],v[136:137]
v_pk_add_f32 v[66:67],v[66:67],v[138:139]
v_pk_add_f32 v[68:69],v[68:69],v[140:141]
v_pk_add_f32 v[70:71],v[70:71],v[142:143]
s_add_u32 m0,s61,8192
s_add_u32 s63,s60,8192
buffer_load_dwordx4 v112,s[8:11],s63 offen sc1 lds
v_cvt_pk_bf16_f32 v144,v56,v57
v_lshlrev_b32 v56,16,v144
v_and_b32 v57,0xffff0000,v144
v_cvt_pk_bf16_f32 v145,v58,v59
s_add_u32 m0,s61,9216
s_nop 0
buffer_load_dwordx4 v113,s[8:11],s63 offen sc1 lds
v_lshlrev_b32 v58,16,v145
v_and_b32 v59,0xffff0000,v145
v_cvt_pk_bf16_f32 v146,v60,v61
v_lshlrev_b32 v60,16,v146
s_mov_b32 s35,s42
s_mov_b32 s53,s33
s_mov_b32 s54,s34
s_add_u32 s32,s32,1
s_mov_b32 s33,s40
s_mov_b32 s34,s41
s_mov_b64 s[76:77],s[80:81]
v_and_b32 v61,0xffff0000,v146
v_cvt_pk_bf16_f32 v147,v62,v63
v_lshlrev_b32 v62,16,v147
v_and_b32 v63,0xffff0000,v147
v_cvt_pk_bf16_f32 v148,v64,v65
v_lshlrev_b32 v64,16,v148
v_and_b32 v65,0xffff0000,v148
v_cvt_pk_bf16_f32 v149,v66,v67
v_lshlrev_b32 v66,16,v149
v_and_b32 v67,0xffff0000,v149
v_cvt_pk_bf16_f32 v150,v68,v69
v_lshlrev_b32 v68,16,v150
v_and_b32 v69,0xffff0000,v150
v_cvt_pk_bf16_f32 v151,v70,v71
v_lshlrev_b32 v70,16,v151
v_and_b32 v71,0xffff0000,v151
s_cmp_lg_u32 s49,0
s_cbranch_scc0 ls_344
buffer_store_dwordx4 v[144:147],v20,s[8:11],s71 offen sc1
buffer_store_dwordx4 v[148:151],v21,s[8:11],s71 offen sc1
s_branch ls_345
ls_344:
buffer_store_dwordx4 v[144:147],v20,s[8:11],s71 offen
buffer_store_dwordx4 v[148:151],v21,s[8:11],s71 offen
ls_345:
v_pk_add_f32 v[6:7],v[56:57],v[58:59]
v_pk_mul_f32 v[8:9],v[56:57],v[56:57]
v_pk_fma_f32 v[8:9],v[58:59],v[58:59],v[8:9]
v_pk_add_f32 v[6:7],v[6:7],v[60:61]
v_pk_fma_f32 v[8:9],v[60:61],v[60:61],v[8:9]
v_pk_add_f32 v[6:7],v[6:7],v[62:63]
v_pk_fma_f32 v[8:9],v[62:63],v[62:63],v[8:9]
v_pk_add_f32 v[6:7],v[6:7],v[64:65]
v_pk_fma_f32 v[8:9],v[64:65],v[64:65],v[8:9]
v_pk_add_f32 v[6:7],v[6:7],v[66:67]
v_pk_fma_f32 v[8:9],v[66:67],v[66:67],v[8:9]
v_pk_add_f32 v[6:7],v[6:7],v[68:69]
v_pk_fma_f32 v[8:9],v[68:69],v[68:69],v[8:9]
v_pk_add_f32 v[6:7],v[6:7],v[70:71]
v_pk_fma_f32 v[8:9],v[70:71],v[70:71],v[8:9]
v_add_f32 v6,v6,v7
v_add_f32 v7,v8,v9
v_mov_b32 v8,v6
v_mov_b32 v9,v7
s_nop 0
v_permlane32_swap_b32 v6,v8
v_permlane32_swap_b32 v7,v9
v_pk_add_f32 v[6:7],v[6:7],v[8:9]
s_mov_b32 exec_hi,0
s_cmp_lg_u32 s49,0
s_cbranch_scc0 ls_346
buffer_store_dwordx2 v[6:7],v114,s[8:11],s72 offen sc1
s_branch ls_347
ls_346:
buffer_store_dwordx2 v[6:7],v114,s[8:11],s72 offen
ls_347:
s_mov_b32 exec_hi,-1
s_mov_b32 s59,s82
s_branch W2_NEXT
nr_336:
buffer_load_dword v3,v2,s[8:11],s35 offen sc1
s_branch ep_335
W2_END:
s_endpgm
ROLE_W3:
v_lshlrev_b32 v1,4,v0
v_mov_b32 v5,1
s_lshl_b32 s56,s48,2
s_add_u32 s56,s56,s46
v_bfe_u32 v6,v0,2,2
v_lshrrev_b32 v7,4,v0
v_add_u32 v7,v6,v7
v_and_b32 v7,3,v7
v_and_b32 v15,3,v0
v_lshlrev_b32 v15,4,v15
v_lshl_add_u32 v15,v7,6,v15
v_lshl_add_u32 v15,v6,8,v15
v_lshrrev_b32 v6,5,v0
v_bfe_u32 v7,v0,4,1
v_lshlrev_b32 v16,10,v7
v_lshl_add_u32 v16,v6,8,v16
v_and_b32 v6,15,v0
v_lshl_add_u32 v16,v6,4,v16
v_add_u32 v18,46080,v16
v_lshrrev_b32 v6,5,v0
v_bfe_u32 v7,v0,4,1
v_lshlrev_b32 v20,10,v7
v_lshl_add_u32 v20,v6,8,v20
v_and_b32 v6,15,v0
v_lshl_add_u32 v20,v6,4,v20
v_lshrrev_b32 v6,5,v0
v_add_u32 v6,2,v6
v_bfe_u32 v7,v0,4,1
v_lshlrev_b32 v17,10,v7
v_lshl_add_u32 v17,v6,8,v17
v_and_b32 v6,15,v0
v_lshl_add_u32 v17,v6,4,v17
v_add_u32 v19,46080,v17
v_lshrrev_b32 v6,5,v0
v_add_u32 v6,2,v6
v_bfe_u32 v7,v0,4,1
v_lshlrev_b32 v21,10,v7
v_lshl_add_u32 v21,v6,8,v21
v_and_b32 v6,15,v0
v_lshl_add_u32 v21,v6,4,v21
v_min_u32 v2,19,v0
v_lshlrev_b32 v2,2,v2
v_mov_b32 v112,0xc0135761
v_mov_b32 v113,0xbdd2d3e8
s_mov_b32 s68,0xbdd2d3e8
v_lshrrev_b32 v6,5,v0
v_mul_u32_u24 v182,2560,v6
v_and_b32 v6,31,v0
v_lshl_add_u32 v182,v6,3,v182
v_add_u32 v182,0xa000,v182
s_waitcnt vmcnt(0)
s_barrier
s_cmp_lg_u32 s46,0
s_cbranch_scc1 arr_348
v_mov_b32 v6,1
s_lshl_b32 s3,s49,2
v_mov_b32 v7,s3
s_mov_b64 exec,1
buffer_atomic_add v6,v7,s[12:15],0 offen sc1
s_mov_b64 exec,-1
arr_348:
s_lshl_b32 s58,s56,6
s_mul_i32 s63,s46,40960
s_mov_b32 s4,s36
s_mov_b32 s5,s37
s_mov_b32 s6,1966080
s_mov_b32 s7,0x20000
v_lshrrev_b32 v9,2,v0
s_mov_b32 s64,3072
v_mul_lo_u32 v9,v9,s64
v_and_b32 v10,3,v0
v_lshl_add_u32 v6,v10,4,v9
s_add_u32 m0,s63,0
s_add_u32 s65,s58,0
buffer_load_dwordx4 v6,s[4:7],s65 offen lds
s_add_u32 m0,s63,1024
s_add_u32 s65,s58,49152
buffer_load_dwordx4 v6,s[4:7],s65 offen lds
s_add_u32 m0,s63,2048
s_add_u32 s65,s58,98304
buffer_load_dwordx4 v6,s[4:7],s65 offen lds
s_add_u32 m0,s63,3072
s_add_u32 s65,s58,147456
buffer_load_dwordx4 v6,s[4:7],s65 offen lds
s_add_u32 m0,s63,4096
s_add_u32 s65,s58,196608
buffer_load_dwordx4 v6,s[4:7],s65 offen lds
s_add_u32 m0,s63,5120
s_add_u32 s65,s58,245760
buffer_load_dwordx4 v6,s[4:7],s65 offen lds
s_add_u32 m0,s63,6144
s_add_u32 s65,s58,294912
buffer_load_dwordx4 v6,s[4:7],s65 offen lds
s_add_u32 m0,s63,7168
s_add_u32 s65,s58,344064
buffer_load_dwordx4 v6,s[4:7],s65 offen lds
s_add_u32 m0,s63,8192
s_add_u32 s65,s58,393216
buffer_load_dwordx4 v6,s[4:7],s65 offen lds
s_add_u32 m0,s63,9216
s_add_u32 s65,s58,442368
buffer_load_dwordx4 v6,s[4:7],s65 offen lds
s_add_u32 m0,s63,10240
s_add_u32 s65,s58,491520
buffer_load_dwordx4 v6,s[4:7],s65 offen lds
s_add_u32 m0,s63,11264
s_add_u32 s65,s58,540672
buffer_load_dwordx4 v6,s[4:7],s65 offen lds
s_add_u32 m0,s63,12288
s_add_u32 s65,s58,589824
buffer_load_dwordx4 v6,s[4:7],s65 offen lds
s_add_u32 m0,s63,13312
s_add_u32 s65,s58,638976
buffer_load_dwordx4 v6,s[4:7],s65 offen lds
s_add_u32 m0,s63,14336
s_add_u32 s65,s58,688128
buffer_load_dwordx4 v6,s[4:7],s65 offen lds
s_add_u32 m0,s63,15360
s_add_u32 s65,s58,737280
buffer_load_dwordx4 v6,s[4:7],s65 offen lds
s_add_u32 m0,s63,16384
s_add_u32 s65,s58,786432
buffer_load_dwordx4 v6,s[4:7],s65 offen lds
s_add_u32 m0,s63,17408
s_add_u32 s65,s58,835584
buffer_load_dwordx4 v6,s[4:7],s65 offen lds
s_add_u32 m0,s63,18432
s_add_u32 s65,s58,884736
buffer_load_dwordx4 v6,s[4:7],s65 offen lds
s_add_u32 m0,s63,19456
s_add_u32 s65,s58,933888
buffer_load_dwordx4 v6,s[4:7],s65 offen lds
s_add_u32 m0,s63,20480
s_add_u32 s65,s58,983040
buffer_load_dwordx4 v6,s[4:7],s65 offen lds
s_add_u32 m0,s63,21504
s_add_u32 s65,s58,1032192
buffer_load_dwordx4 v6,s[4:7],s65 offen lds
s_add_u32 m0,s63,22528
s_add_u32 s65,s58,1081344
buffer_load_dwordx4 v6,s[4:7],s65 offen lds
s_add_u32 m0,s63,23552
s_add_u32 s65,s58,1130496
buffer_load_dwordx4 v6,s[4:7],s65 offen lds
s_add_u32 m0,s63,24576
s_add_u32 s65,s58,1179648
buffer_load_dwordx4 v6,s[4:7],s65 offen lds
s_add_u32 m0,s63,25600
s_add_u32 s65,s58,1228800
buffer_load_dwordx4 v6,s[4:7],s65 offen lds
s_add_u32 m0,s63,26624
s_add_u32 s65,s58,1277952
buffer_load_dwordx4 v6,s[4:7],s65 offen lds
s_add_u32 m0,s63,27648
s_add_u32 s65,s58,1327104
buffer_load_dwordx4 v6,s[4:7],s65 offen lds
s_add_u32 m0,s63,28672
s_add_u32 s65,s58,1376256
buffer_load_dwordx4 v6,s[4:7],s65 offen lds
s_add_u32 m0,s63,29696
s_add_u32 s65,s58,1425408
buffer_load_dwordx4 v6,s[4:7],s65 offen lds
s_add_u32 m0,s63,30720
s_add_u32 s65,s58,1474560
buffer_load_dwordx4 v6,s[4:7],s65 offen lds
s_add_u32 m0,s63,31744
s_add_u32 s65,s58,1523712
buffer_load_dwordx4 v6,s[4:7],s65 offen lds
s_add_u32 m0,s63,32768
s_add_u32 s65,s58,1572864
buffer_load_dwordx4 v6,s[4:7],s65 offen lds
s_add_u32 m0,s63,33792
s_add_u32 s65,s58,1622016
buffer_load_dwordx4 v6,s[4:7],s65 offen lds
s_add_u32 m0,s63,34816
s_add_u32 s65,s58,1671168
buffer_load_dwordx4 v6,s[4:7],s65 offen lds
s_add_u32 m0,s63,35840
s_add_u32 s65,s58,1720320
buffer_load_dwordx4 v6,s[4:7],s65 offen lds
s_add_u32 m0,s63,36864
s_add_u32 s65,s58,1769472
buffer_load_dwordx4 v6,s[4:7],s65 offen lds
s_add_u32 m0,s63,37888
s_add_u32 s65,s58,1818624
buffer_load_dwordx4 v6,s[4:7],s65 offen lds
s_add_u32 m0,s63,38912
s_add_u32 s65,s58,1867776
buffer_load_dwordx4 v6,s[4:7],s65 offen lds
s_add_u32 m0,s63,39936
s_add_u32 s65,s58,1916928
buffer_load_dwordx4 v6,s[4:7],s65 offen lds
s_waitcnt vmcnt(20)
v_bfe_u32 v9,v0,2,2
v_lshrrev_b32 v10,5,v0
v_lshl_add_u32 v9,v10,2,v9
v_mul_u32_u24 v9,64,v9
v_and_b32 v10,1,v0
v_lshl_add_u32 v9,v10,3,v9
v_bfe_u32 v10,v0,1,1
v_lshl_add_u32 v9,v10,5,v9
v_bfe_u32 v10,v0,4,1
v_lshl_add_u32 v9,v10,4,v9
v_add_u32 v7,s63,v9
ds_read_b64_tr_b16 a[0:1],v7 offset:0
ds_read_b64_tr_b16 a[2:3],v7 offset:1024
ds_read_b64_tr_b16 a[4:5],v7 offset:512
ds_read_b64_tr_b16 a[6:7],v7 offset:1536
ds_read_b64_tr_b16 a[8:9],v7 offset:2048
ds_read_b64_tr_b16 a[10:11],v7 offset:3072
ds_read_b64_tr_b16 a[12:13],v7 offset:2560
ds_read_b64_tr_b16 a[14:15],v7 offset:3584
ds_read_b64_tr_b16 a[16:17],v7 offset:4096
ds_read_b64_tr_b16 a[18:19],v7 offset:5120
ds_read_b64_tr_b16 a[20:21],v7 offset:4608
ds_read_b64_tr_b16 a[22:23],v7 offset:5632
s_waitcnt lgkmcnt(4)
ds_read_b64_tr_b16 a[24:25],v7 offset:6144
ds_read_b64_tr_b16 a[26:27],v7 offset:7168
ds_read_b64_tr_b16 a[28:29],v7 offset:6656
ds_read_b64_tr_b16 a[30:31],v7 offset:7680
ds_read_b64_tr_b16 a[32:33],v7 offset:8192
ds_read_b64_tr_b16 a[34:35],v7 offset:9216
ds_read_b64_tr_b16 a[36:37],v7 offset:8704
ds_read_b64_tr_b16 a[38:39],v7 offset:9728
ds_read_b64_tr_b16 a[40:41],v7 offset:10240
ds_read_b64_tr_b16 a[42:43],v7 offset:11264
ds_read_b64_tr_b16 a[44:45],v7 offset:10752
ds_read_b64_tr_b16 a[46:47],v7 offset:11776
s_waitcnt lgkmcnt(4)
ds_read_b64_tr_b16 a[48:49],v7 offset:12288
ds_read_b64_tr_b16 a[50:51],v7 offset:13312
ds_read_b64_tr_b16 a[52:53],v7 offset:12800
ds_read_b64_tr_b16 a[54:55],v7 offset:13824
ds_read_b64_tr_b16 a[56:57],v7 offset:14336
ds_read_b64_tr_b16 a[58:59],v7 offset:15360
ds_read_b64_tr_b16 a[60:61],v7 offset:14848
ds_read_b64_tr_b16 a[62:63],v7 offset:15872
ds_read_b64_tr_b16 a[64:65],v7 offset:16384
ds_read_b64_tr_b16 a[66:67],v7 offset:17408
ds_read_b64_tr_b16 a[68:69],v7 offset:16896
ds_read_b64_tr_b16 a[70:71],v7 offset:17920
s_waitcnt lgkmcnt(4)
ds_read_b64_tr_b16 a[72:73],v7 offset:18432
ds_read_b64_tr_b16 a[74:75],v7 offset:19456
ds_read_b64_tr_b16 a[76:77],v7 offset:18944
ds_read_b64_tr_b16 a[78:79],v7 offset:19968
s_waitcnt lgkmcnt(0)
s_waitcnt vmcnt(0)
v_bfe_u32 v9,v0,2,2
v_lshrrev_b32 v10,5,v0
v_lshl_add_u32 v9,v10,2,v9
v_mul_u32_u24 v9,64,v9
v_and_b32 v10,1,v0
v_lshl_add_u32 v9,v10,3,v9
v_bfe_u32 v10,v0,1,1
v_lshl_add_u32 v9,v10,5,v9
v_bfe_u32 v10,v0,4,1
v_lshl_add_u32 v9,v10,4,v9
v_add_u32 v7,s63,v9
ds_read_b64_tr_b16 a[80:81],v7 offset:20480
ds_read_b64_tr_b16 a[82:83],v7 offset:21504
ds_read_b64_tr_b16 a[84:85],v7 offset:20992
ds_read_b64_tr_b16 a[86:87],v7 offset:22016
ds_read_b64_tr_b16 a[88:89],v7 offset:22528
ds_read_b64_tr_b16 a[90:91],v7 offset:23552
ds_read_b64_tr_b16 a[92:93],v7 offset:23040
ds_read_b64_tr_b16 a[94:95],v7 offset:24064
ds_read_b64_tr_b16 a[96:97],v7 offset:24576
ds_read_b64_tr_b16 a[98:99],v7 offset:25600
ds_read_b64_tr_b16 a[100:101],v7 offset:25088
ds_read_b64_tr_b16 a[102:103],v7 offset:26112
s_waitcnt lgkmcnt(4)
ds_read_b64_tr_b16 a[104:105],v7 offset:26624
ds_read_b64_tr_b16 a[106:107],v7 offset:27648
ds_read_b64_tr_b16 a[108:109],v7 offset:27136
ds_read_b64_tr_b16 a[110:111],v7 offset:28160
ds_read_b64_tr_b16 a[112:113],v7 offset:28672
ds_read_b64_tr_b16 a[114:115],v7 offset:29696
ds_read_b64_tr_b16 a[116:117],v7 offset:29184
ds_read_b64_tr_b16 a[118:119],v7 offset:30208
ds_read_b64_tr_b16 a[120:121],v7 offset:30720
ds_read_b64_tr_b16 a[122:123],v7 offset:31744
ds_read_b64_tr_b16 a[124:125],v7 offset:31232
ds_read_b64_tr_b16 a[126:127],v7 offset:32256
s_waitcnt lgkmcnt(4)
ds_read_b64_tr_b16 a[128:129],v7 offset:32768
ds_read_b64_tr_b16 a[130:131],v7 offset:33792
ds_read_b64_tr_b16 a[132:133],v7 offset:33280
ds_read_b64_tr_b16 a[134:135],v7 offset:34304
ds_read_b64_tr_b16 a[136:137],v7 offset:34816
ds_read_b64_tr_b16 a[138:139],v7 offset:35840
ds_read_b64_tr_b16 a[140:141],v7 offset:35328
ds_read_b64_tr_b16 a[142:143],v7 offset:36352
ds_read_b64_tr_b16 a[144:145],v7 offset:36864
ds_read_b64_tr_b16 a[146:147],v7 offset:37888
ds_read_b64_tr_b16 a[148:149],v7 offset:37376
ds_read_b64_tr_b16 a[150:151],v7 offset:38400
s_waitcnt lgkmcnt(4)
ds_read_b64_tr_b16 a[152:153],v7 offset:38912
ds_read_b64_tr_b16 a[154:155],v7 offset:39936
ds_read_b64_tr_b16 a[156:157],v7 offset:39424
ds_read_b64_tr_b16 a[158:159],v7 offset:40448
s_waitcnt lgkmcnt(0)
v_mov_b32 v24,0x3f803f80
v_mov_b32 v25,0x3f803f80
v_mov_b32 v26,0x3f803f80
v_mov_b32 v27,0x3f803f80
s_nop 1
v_mfma_f32_32x32x16_bf16 v[144:159],a[0:3],v[24:27],0
v_mfma_f32_32x32x16_bf16 v[144:159],a[4:7],v[24:27],v[144:159]
v_mfma_f32_32x32x16_bf16 v[144:159],a[8:11],v[24:27],v[144:159]
v_mfma_f32_32x32x16_bf16 v[144:159],a[12:15],v[24:27],v[144:159]
v_mfma_f32_32x32x16_bf16 v[144:159],a[16:19],v[24:27],v[144:159]
v_mfma_f32_32x32x16_bf16 v[144:159],a[20:23],v[24:27],v[144:159]
v_mfma_f32_32x32x16_bf16 v[144:159],a[24:27],v[24:27],v[144:159]
v_mfma_f32_32x32x16_bf16 v[144:159],a[28:31],v[24:27],v[144:159]
v_mfma_f32_32x32x16_bf16 v[144:159],a[32:35],v[24:27],v[144:159]
v_mfma_f32_32x32x16_bf16 v[144:159],a[36:39],v[24:27],v[144:159]
v_mfma_f32_32x32x16_bf16 v[144:159],a[40:43],v[24:27],v[144:159]
v_mfma_f32_32x32x16_bf16 v[144:159],a[44:47],v[24:27],v[144:159]
v_mfma_f32_32x32x16_bf16 v[144:159],a[48:51],v[24:27],v[144:159]
v_mfma_f32_32x32x16_bf16 v[144:159],a[52:55],v[24:27],v[144:159]
v_mfma_f32_32x32x16_bf16 v[144:159],a[56:59],v[24:27],v[144:159]
v_mfma_f32_32x32x16_bf16 v[144:159],a[60:63],v[24:27],v[144:159]
v_mfma_f32_32x32x16_bf16 v[144:159],a[64:67],v[24:27],v[144:159]
v_mfma_f32_32x32x16_bf16 v[144:159],a[68:71],v[24:27],v[144:159]
v_mfma_f32_32x32x16_bf16 v[144:159],a[72:75],v[24:27],v[144:159]
v_mfma_f32_32x32x16_bf16 v[144:159],a[76:79],v[24:27],v[144:159]
v_mfma_f32_32x32x16_bf16 v[144:159],a[80:83],v[24:27],v[144:159]
v_mfma_f32_32x32x16_bf16 v[144:159],a[84:87],v[24:27],v[144:159]
v_mfma_f32_32x32x16_bf16 v[144:159],a[88:91],v[24:27],v[144:159]
v_mfma_f32_32x32x16_bf16 v[144:159],a[92:95],v[24:27],v[144:159]
v_mfma_f32_32x32x16_bf16 v[144:159],a[96:99],v[24:27],v[144:159]
v_mfma_f32_32x32x16_bf16 v[144:159],a[100:103],v[24:27],v[144:159]
v_mfma_f32_32x32x16_bf16 v[144:159],a[104:107],v[24:27],v[144:159]
v_mfma_f32_32x32x16_bf16 v[144:159],a[108:111],v[24:27],v[144:159]
v_mfma_f32_32x32x16_bf16 v[144:159],a[112:115],v[24:27],v[144:159]
v_mfma_f32_32x32x16_bf16 v[144:159],a[116:119],v[24:27],v[144:159]
v_mfma_f32_32x32x16_bf16 v[144:159],a[120:123],v[24:27],v[144:159]
v_mfma_f32_32x32x16_bf16 v[144:159],a[124:127],v[24:27],v[144:159]
v_mfma_f32_32x32x16_bf16 v[144:159],a[128:131],v[24:27],v[144:159]
v_mfma_f32_32x32x16_bf16 v[144:159],a[132:135],v[24:27],v[144:159]
v_mfma_f32_32x32x16_bf16 v[144:159],a[136:139],v[24:27],v[144:159]
v_mfma_f32_32x32x16_bf16 v[144:159],a[140:143],v[24:27],v[144:159]
v_mfma_f32_32x32x16_bf16 v[144:159],a[144:147],v[24:27],v[144:159]
v_mfma_f32_32x32x16_bf16 v[144:159],a[148:151],v[24:27],v[144:159]
v_mfma_f32_32x32x16_bf16 v[144:159],a[152:155],v[24:27],v[144:159]
v_mfma_f32_32x32x16_bf16 v[144:159],a[156:159],v[24:27],v[144:159]
s_barrier
s_lshl_b32 s3,s49,2
v_mov_b32 v7,s3
s_nop 8
ibw_349:
buffer_load_dword v6,v7,s[12:15],0 offen sc1
s_waitcnt vmcnt(0)
v_cmp_ne_u32 vcc,256,v6
s_nop 0
s_cbranch_vccz ok_350
s_sleep 8
s_sub_u32 s47,s47,1
s_cbranch_scc1 ABORT
s_branch ibw_349
ok_350:
s_cmp_lg_u32 s49,0
s_cbranch_scc1 ibok_351
v_and_b32 v7,7,v0
v_lshlrev_b32 v7,2,v7
buffer_load_dword v6,v7,s[12:15],0 offen offset:32 sc1
s_waitcnt vmcnt(0)
v_cmp_ne_u32 vcc,32,v6
s_nop 0
s_cbranch_vccz ibok_351
s_barrier
s_mov_b32 s49,1
s_mov_b32 s3,s2
s_load_dwordx16 s[16:31],s[0:1],0
s_load_dwordx8 s[32:39],s[0:1],64
s_waitcnt lgkmcnt(0)
s_branch DISPATCH
ibok_351:
s_mov_b32 s50,0
s_mov_b32 s32,0
s_mov_b32 s57,0
s_mov_b32 s59,2147483648
s_mov_b32 s82,2147483648
s_mov_b32 s39,2147483648
v_mov_b32 v22,94208
v_lshl_add_u32 v22,v0,2,v22
v_mov_b32 v23,0
ds_write_b32 v22,v23
s_mov_b32 s39,1600000
v_and_b32 v72,15,v0
v_lshlrev_b32 v72,7,v72
v_min_u32 v6,59,v0
v_lshlrev_b32 v6,2,v6
v_add_u32 v2,198656,v6
v_add_u32 v7,-80,v6
v_cmp_gt_u32 s[78:79],20,v0
s_nop 1
v_cndmask_b32 v2,v7,v2,s[78:79]
s_mov_b32 s51,0
s_mov_b32 s52,0
s_mul_i32 s62,s51,4
s_and_b32 s63,s52,3
s_add_u32 s62,s62,s63
s_mul_i32 s62,s62,98304
s_add_u32 s62,s62,242778112
s_lshl_b32 s63,s56,11
s_add_u32 s62,s62,s63
buffer_load_dword v73,v72,s[8:11],s62 offen sc1
s_mov_b32 s51,0
s_mov_b32 s52,1
s_mul_i32 s62,s51,4
s_and_b32 s63,s52,3
s_add_u32 s62,s62,s63
s_mul_i32 s62,s62,98304
s_add_u32 s62,s62,242778112
s_lshl_b32 s63,s56,11
s_add_u32 s62,s62,s63
buffer_load_dword v73,v72,s[8:11],s62 offen sc1
s_mov_b32 s51,0
s_mov_b32 s52,2
s_mul_i32 s62,s51,4
s_and_b32 s63,s52,3
s_add_u32 s62,s62,s63
s_mul_i32 s62,s62,98304
s_add_u32 s62,s62,242778112
s_lshl_b32 s63,s56,11
s_add_u32 s62,s62,s63
buffer_load_dword v73,v72,s[8:11],s62 offen sc1
s_mov_b32 s51,0
s_mov_b32 s52,3
s_mul_i32 s62,s51,4
s_and_b32 s63,s52,3
s_add_u32 s62,s62,s63
s_mul_i32 s62,s62,98304
s_add_u32 s62,s62,242778112
s_lshl_b32 s63,s56,11
s_add_u32 s62,s62,s63
buffer_load_dword v73,v72,s[8:11],s62 offen sc1
s_mov_b32 s51,1
s_mov_b32 s52,0
s_mul_i32 s62,s51,4
s_and_b32 s63,s52,3
s_add_u32 s62,s62,s63
s_mul_i32 s62,s62,98304
s_add_u32 s62,s62,242778112
s_lshl_b32 s63,s56,11
s_add_u32 s62,s62,s63
buffer_load_dword v73,v72,s[8:11],s62 offen sc1
s_mov_b32 s51,1
s_mov_b32 s52,1
s_mul_i32 s62,s51,4
s_and_b32 s63,s52,3
s_add_u32 s62,s62,s63
s_mul_i32 s62,s62,98304
s_add_u32 s62,s62,242778112
s_lshl_b32 s63,s56,11
s_add_u32 s62,s62,s63
buffer_load_dword v73,v72,s[8:11],s62 offen sc1
s_mov_b32 s51,1
s_mov_b32 s52,2
s_mul_i32 s62,s51,4
s_and_b32 s63,s52,3
s_add_u32 s62,s62,s63
s_mul_i32 s62,s62,98304
s_add_u32 s62,s62,242778112
s_lshl_b32 s63,s56,11
s_add_u32 s62,s62,s63
buffer_load_dword v73,v72,s[8:11],s62 offen sc1
s_mov_b32 s51,1
s_mov_b32 s52,3
s_mul_i32 s62,s51,4
s_and_b32 s63,s52,3
s_add_u32 s62,s62,s63
s_mul_i32 s62,s62,98304
s_add_u32 s62,s62,242778112
s_lshl_b32 s63,s56,11
s_add_u32 s62,s62,s63
buffer_load_dword v73,v72,s[8:11],s62 offen sc1
s_waitcnt vmcnt(0)
s_waitcnt lgkmcnt(0)
s_barrier
s_mov_b32 s83,s100
s_min_u32 s62,s32,127
s_sub_u32 s60,s62,14
s_lshr_b32 s34,s60,1
s_and_b32 s33,s60,1
s_cmp_eq_u32 s33,0
s_cselect_b32 s61,14,0
s_add_u32 s34,s34,s61
s_sub_u32 s61,s60,50
s_cmp_ge_u32 s60,100
s_cselect_b32 s34,s61,s34
s_cselect_b32 s33,1,s33
s_cmp_lt_u32 s62,14
s_cselect_b32 s34,s62,s34
s_cselect_b32 s33,0,s33
s_lshl_b32 s35,s33,6
s_add_u32 s35,s35,s34
s_lshl_b32 s35,s35,9
s_add_u32 s35,s35,325632
s_cmp_lt_u32 s34,4
s_cselect_b64 s[76:77],s[78:79],-1
s_sub_u32 s57,46080,s57
v_swap_b32 v16,v18
v_swap_b32 v17,v19
s_add_u32 s62,s32,1
s_min_u32 s62,s62,127
s_sub_u32 s60,s62,14
s_lshr_b32 s41,s60,1
s_and_b32 s40,s60,1
s_cmp_eq_u32 s40,0
s_cselect_b32 s61,14,0
s_add_u32 s41,s41,s61
s_sub_u32 s61,s60,50
s_cmp_ge_u32 s60,100
s_cselect_b32 s41,s61,s41
s_cselect_b32 s40,1,s40
s_cmp_lt_u32 s62,14
s_cselect_b32 s41,s62,s41
s_cselect_b32 s40,0,s40
s_lshl_b32 s42,s40,6
s_add_u32 s42,s42,s41
s_lshl_b32 s42,s42,9
s_add_u32 s42,s42,325632
s_cmp_lt_u32 s41,4
s_cselect_b64 s[80:81],s[78:79],-1
W3_COLD:
s_mov_b32 s37,0
fb_352:
buffer_load_dword v3,v2,s[8:11],s35 offen sc1
s_waitcnt vmcnt(0)
v_cmp_eq_u32 vcc,0,v3
s_and_b64 vcc,vcc,s[76:77]
s_cbranch_scc0 ok_353
s_sleep 2
s_sub_u32 s47,s47,1
s_cbranch_scc1 ABORT
s_branch fb_352
ok_353:
W3_COLD2:
s_sub_u32 s66,46080,s57
s_mul_i32 s60,s33,8
s_and_b32 s61,s34,7
s_add_u32 s60,s60,s61
s_mul_i32 s60,s60,46080
s_add_u32 s60,s60,s37
s_add_u32 s60,s60,212467712
s_mov_b32 s67,s60
s_mul_i32 s61,s46,10240
s_add_u32 s60,s60,s61
s_add_u32 s61,s61,s66
s_add_u32 m0,s61,0
s_add_u32 s63,s60,0
buffer_load_dwordx4 v1,s[8:11],s63 offen sc1 lds
buffer_load_dwordx4 v1,s[8:11],s63 offen offset:1024 sc1 lds
buffer_load_dwordx4 v1,s[8:11],s63 offen offset:2048 sc1 lds
buffer_load_dwordx4 v1,s[8:11],s63 offen offset:3072 sc1 lds
s_add_u32 m0,s61,4096
s_add_u32 s63,s60,4096
buffer_load_dwordx4 v1,s[8:11],s63 offen sc1 lds
buffer_load_dwordx4 v1,s[8:11],s63 offen offset:1024 sc1 lds
s_waitcnt vmcnt(5)
s_mov_b64 exec,1
s_cmp_lg_u32 s49,0
s_cbranch_scc0 ls_354
buffer_store_dword v5,v1,s[8:11],s59 offen sc1
s_branch ls_355
ls_354:
buffer_store_dword v5,v1,s[8:11],s59 offen
ls_355:
s_mov_b64 exec,-1
s_mov_b32 s59,2147483648
buffer_load_dwordx4 v1,s[8:11],s63 offen offset:2048 sc1 lds
buffer_load_dwordx4 v1,s[8:11],s63 offen offset:3072 sc1 lds
s_add_u32 m0,s61,8192
s_add_u32 s63,s60,8192
buffer_load_dwordx4 v1,s[8:11],s63 offen sc1 lds
buffer_load_dwordx4 v1,s[8:11],s63 offen offset:1024 sc1 lds
s_lshl_b32 s62,s46,10
s_add_u32 s62,s62,40960
s_add_u32 m0,s66,s62
s_add_u32 s63,s67,s62
buffer_load_dwordx4 v1,s[8:11],s63 offen sc1 lds
s_add_u32 m0,s66,45056
s_add_u32 s63,s67,45056
buffer_load_dwordx4 v1,s[8:11],s63 offen sc1 lds
s_mov_b32 s35,s42
s_mov_b32 s53,s33
s_mov_b32 s54,s34
s_add_u32 s32,s32,1
s_mov_b32 s33,s40
s_mov_b32 s34,s41
s_mov_b64 s[76:77],s[80:81]
s_sub_u32 s57,46080,s57
v_swap_b32 v16,v18
v_swap_b32 v17,v19
s_mov_b32 s51,s53
s_mov_b32 s52,s54
s_waitcnt vmcnt(7)
s_branch W3_GO
W3_NEXT:
s_sub_u32 s57,46080,s57
v_swap_b32 v16,v18
v_swap_b32 v17,v19
s_mov_b32 s51,s53
s_mov_b32 s52,s54
s_waitcnt vmcnt(2)
W3_GO:
s_barrier
ds_read_b128 v[24:27],v16 offset:0
ds_read_b128 v[28:31],v17 offset:0
ds_read_b128 v[32:35],v16 offset:10240
ds_read_b128 v[36:39],v17 offset:10240
ds_read_b128 v[40:43],v16 offset:20480
ds_read_b128 v[44:47],v17 offset:20480
ds_read_b128 v[48:51],v16 offset:30720
buffer_load_dword v3,v2,s[8:11],s35 offen sc1
s_waitcnt lgkmcnt(6)
v_mfma_f32_32x32x16_bf16 v[56:71],a[0:3],v[24:27],0
ds_read_b128 v[52:55],v17 offset:30720
s_add_u32 s62,s32,1
s_min_u32 s62,s62,127
s_sub_u32 s60,s62,14
s_waitcnt lgkmcnt(6)
v_mfma_f32_32x32x16_bf16 v[56:71],a[4:7],v[28:31],v[56:71]
ds_read_b128 v[24:27],v16 offset:2048
s_lshr_b32 s41,s60,1
s_and_b32 s40,s60,1
s_mul_i32 s71,s51,4
s_waitcnt lgkmcnt(5)
v_mfma_f32_32x32x16_bf16 v[56:71],a[40:43],v[32:35],v[56:71]
ds_read_b128 v[28:31],v17 offset:2048
s_cmp_eq_u32 s40,0
s_cselect_b32 s61,14,0
s_add_u32 s41,s41,s61
s_sub_u32 s61,s60,50
v_mfma_f32_32x32x16_bf16 v[56:71],a[44:47],v[36:39],v[56:71]
ds_read_b128 v[32:35],v16 offset:12288
s_cmp_ge_u32 s60,100
s_cselect_b32 s41,s61,s41
s_cselect_b32 s40,1,s40
s_waitcnt lgkmcnt(5)
v_mfma_f32_32x32x16_bf16 v[56:71],a[80:83],v[40:43],v[56:71]
ds_read_b128 v[36:39],v17 offset:12288
s_cmp_lt_u32 s62,14
s_cselect_b32 s41,s62,s41
s_cselect_b32 s40,0,s40
s_lshl_b32 s42,s40,6
v_mfma_f32_32x32x16_bf16 v[56:71],a[84:87],v[44:47],v[56:71]
ds_read_b128 v[40:43],v16 offset:22528
s_add_u32 s42,s42,s41
s_lshl_b32 s42,s42,9
s_add_u32 s42,s42,325632
s_waitcnt lgkmcnt(5)
v_mfma_f32_32x32x16_bf16 v[56:71],a[120:123],v[48:51],v[56:71]
ds_read_b128 v[44:47],v17 offset:22528
s_cmp_lt_u32 s41,4
s_cselect_b64 s[80:81],s[78:79],-1
s_and_b32 s72,s52,3
s_add_u32 s71,s71,s72
v_mfma_f32_32x32x16_bf16 v[56:71],a[124:127],v[52:55],v[56:71]
ds_read_b128 v[48:51],v16 offset:32768
s_mul_i32 s71,s71,98304
s_add_u32 s71,s71,242778112
s_lshl_b32 s72,s56,11
s_waitcnt lgkmcnt(5)
v_mfma_f32_32x32x16_bf16 v[56:71],a[8:11],v[24:27],v[56:71]
ds_read_b128 v[52:55],v17 offset:32768
s_add_u32 s71,s71,s72
s_lshl_b32 s82,s51,6
s_add_u32 s82,s82,s52
s_lshl_b32 s82,s82,9
v_mfma_f32_32x32x16_bf16 v[56:71],a[12:15],v[28:31],v[56:71]
ds_read_b128 v[24:27],v16 offset:4096
s_add_u32 s82,s82,589824
s_lshl_b32 s70,s56,2
s_add_u32 s82,s82,s70
s_waitcnt lgkmcnt(5)
v_mfma_f32_32x32x16_bf16 v[56:71],a[48:51],v[32:35],v[56:71]
ds_read_b128 v[28:31],v17 offset:4096
v_mfma_f32_32x32x16_bf16 v[56:71],a[52:55],v[36:39],v[56:71]
ds_read_b128 v[32:35],v16 offset:14336
s_waitcnt lgkmcnt(5)
v_mfma_f32_32x32x16_bf16 v[56:71],a[88:91],v[40:43],v[56:71]
ds_read_b128 v[36:39],v17 offset:14336
s_waitcnt vmcnt(0)
s_mov_b64 exec,1
s_cmp_lg_u32 s49,0
s_cbranch_scc0 ls_356
buffer_store_dword v5,v1,s[8:11],s59 offen sc1
s_branch ls_357
ls_356:
buffer_store_dword v5,v1,s[8:11],s59 offen
ls_357:
s_mov_b64 exec,-1
s_mov_b32 s59,2147483648
v_mfma_f32_32x32x16_bf16 v[56:71],a[92:95],v[44:47],v[56:71]
ds_read_b128 v[40:43],v16 offset:24576
v_cmp_eq_u32 vcc,0,v3
s_and_b64 vcc,vcc,s[76:77]
s_cselect_b32 s37,2147483648,0
s_waitcnt lgkmcnt(5)
v_mfma_f32_32x32x16_bf16 v[56:71],a[128:131],v[48:51],v[56:71]
ds_read_b128 v[44:47],v17 offset:24576
s_cmp_lt_u32 s32,128
s_cselect_b32 s37,s37,2147483648
s_sub_u32 s66,46080,s57
s_mul_i32 s60,s33,8
v_mfma_f32_32x32x16_bf16 v[56:71],a[132:135],v[52:55],v[56:71]
ds_read_b128 v[48:51],v16 offset:34816
s_and_b32 s61,s34,7
s_add_u32 s60,s60,s61
s_mul_i32 s60,s60,46080
s_waitcnt lgkmcnt(5)
v_mfma_f32_32x32x16_bf16 v[56:71],a[16:19],v[24:27],v[56:71]
ds_read_b128 v[52:55],v17 offset:34816
s_add_u32 s60,s60,s37
s_add_u32 s60,s60,212467712
s_mov_b32 s67,s60
s_mul_i32 s61,s46,10240
s_barrier
v_mfma_f32_32x32x16_bf16 v[56:71],a[20:23],v[28:31],v[56:71]
ds_read_b128 v[24:27],v16 offset:6144
v_add_u32 v183,s57,v182
s_add_u32 s60,s60,s61
s_add_u32 s61,s61,s66
s_waitcnt lgkmcnt(5)
v_mfma_f32_32x32x16_bf16 v[56:71],a[56:59],v[32:35],v[56:71]
ds_read_b128 v[28:31],v17 offset:6144
v_add_u32 v8,0x800,v183
s_add_u32 m0,s61,0
s_add_u32 s63,s60,0
v_mfma_f32_32x32x16_bf16 v[56:71],a[60:63],v[36:39],v[56:71]
ds_read_b128 v[32:35],v16 offset:16384
ds_read2_b64 v[160:163],v183 offset0:0 offset1:32
s_waitcnt lgkmcnt(6)
v_mfma_f32_32x32x16_bf16 v[56:71],a[96:99],v[40:43],v[56:71]
ds_read_b128 v[36:39],v17 offset:16384
ds_read2_b64 v[164:167],v183 offset0:64 offset1:96
buffer_load_dwordx4 v1,s[8:11],s63 offen sc1 lds
v_mfma_f32_32x32x16_bf16 v[56:71],a[100:103],v[44:47],v[56:71]
ds_read_b128 v[40:43],v16 offset:26624
ds_read2_b64 v[168:171],v183 offset0:128 offset1:160
s_waitcnt lgkmcnt(8)
v_mfma_f32_32x32x16_bf16 v[56:71],a[136:139],v[48:51],v[56:71]
ds_read_b128 v[44:47],v17 offset:26624
ds_read2_b64 v[172:175],v183 offset0:192 offset1:224
buffer_load_dwordx4 v1,s[8:11],s63 offen offset:1024 sc1 lds
v_mfma_f32_32x32x16_bf16 v[56:71],a[140:143],v[52:55],v[56:71]
ds_read_b128 v[48:51],v16 offset:36864
ds_read2_b64 v[176:179],v8 offset0:0 offset1:32
s_waitcnt lgkmcnt(10)
v_mfma_f32_32x32x16_bf16 v[56:71],a[24:27],v[24:27],v[56:71]
ds_read_b128 v[52:55],v17 offset:36864
buffer_load_dwordx4 v1,s[8:11],s63 offen offset:2048 sc1 lds
v_mfma_f32_32x32x16_bf16 v[56:71],a[28:31],v[28:31],v[56:71]
ds_read_b128 v[24:27],v16 offset:8192
s_waitcnt lgkmcnt(9)
v_mfma_f32_32x32x16_bf16 v[56:71],a[64:67],v[32:35],v[56:71]
ds_read_b128 v[28:31],v17 offset:8192
buffer_load_dwordx4 v1,s[8:11],s63 offen offset:3072 sc1 lds
s_add_u32 m0,s61,4096
s_add_u32 s63,s60,4096
v_mfma_f32_32x32x16_bf16 v[56:71],a[68:71],v[36:39],v[56:71]
ds_read_b128 v[32:35],v16 offset:18432
s_waitcnt lgkmcnt(4)
v_add_f32 v160,v160,v170
v_add_f32 v161,v161,v171
v_mfma_f32_32x32x16_bf16 v[56:71],a[104:107],v[40:43],v[56:71]
ds_read_b128 v[36:39],v17 offset:18432
buffer_load_dwordx4 v1,s[8:11],s63 offen sc1 lds
v_add_f32 v162,v162,v172
v_add_f32 v163,v163,v173
v_mfma_f32_32x32x16_bf16 v[56:71],a[108:111],v[44:47],v[56:71]
ds_read_b128 v[40:43],v16 offset:28672
v_add_f32 v164,v164,v174
v_add_f32 v165,v165,v175
v_add_f32 v166,v166,v176
s_waitcnt lgkmcnt(5)
v_mfma_f32_32x32x16_bf16 v[56:71],a[144:147],v[48:51],v[56:71]
ds_read_b128 v[44:47],v17 offset:28672
buffer_load_dword v3,v2,s[8:11],s35 offen sc1
v_add_f32 v167,v167,v177
v_mfma_f32_32x32x16_bf16 v[56:71],a[148:151],v[52:55],v[56:71]
ds_read_b128 v[48:51],v16 offset:38912
buffer_load_dwordx4 v1,s[8:11],s63 offen offset:1024 sc1 lds
v_add_f32 v168,v168,v178
s_waitcnt lgkmcnt(5)
v_mfma_f32_32x32x16_bf16 v[56:71],a[32:35],v[24:27],v[56:71]
ds_read_b128 v[52:55],v17 offset:38912
v_add_f32 v169,v169,v179
v_add_f32 v160,v160,v162
v_add_f32 v161,v161,v163
v_add_f32 v164,v164,v166
v_mfma_f32_32x32x16_bf16 v[56:71],a[36:39],v[28:31],v[56:71]
buffer_load_dwordx4 v1,s[8:11],s63 offen offset:2048 sc1 lds
v_add_f32 v165,v165,v167
v_add_f32 v160,v160,v164
v_add_f32 v161,v161,v165
s_waitcnt lgkmcnt(4)
v_mfma_f32_32x32x16_bf16 v[56:71],a[72:75],v[32:35],v[56:71]
v_add_f32 v160,v160,v168
v_add_f32 v161,v161,v169
v_mov_b32 v162,v160
v_mov_b32 v163,v161
s_nop 0
v_permlane32_swap_b32 v160,v162
v_mfma_f32_32x32x16_bf16 v[56:71],a[76:79],v[36:39],v[56:71]
buffer_load_dwordx4 v1,s[8:11],s63 offen offset:3072 sc1 lds
s_add_u32 m0,s61,8192
s_add_u32 s63,s60,8192
v_permlane32_swap_b32 v161,v163
s_waitcnt lgkmcnt(2)
v_mfma_f32_32x32x16_bf16 v[56:71],a[112:115],v[40:43],v[56:71]
v_add_f32 v180,v160,v162
v_add_f32 v181,v161,v163
v_mul_f32 v180,0x3acccccd,v180
v_mul_f32 v181,0x3acccccd,v181
v_fma_f32 v181,-v180,v180,v181
v_mfma_f32_32x32x16_bf16 v[56:71],a[116:119],v[44:47],v[56:71]
buffer_load_dwordx4 v1,s[8:11],s63 offen sc1 lds
v_max_f32 v181,0,v181
v_cvt_pk_bf16_f32 v8,v180,v181
v_lshlrev_b32 v180,16,v8
s_waitcnt lgkmcnt(0)
v_mfma_f32_32x32x16_bf16 v[56:71],a[152:155],v[48:51],v[56:71]
v_and_b32 v181,0xffff0000,v8
v_add_f32 v181,0x3727c5ac,v181
v_cvt_pk_bf16_f32 v8,v181,v181
v_lshlrev_b32 v181,16,v8
v_sqrt_f32 v181,v181
v_mfma_f32_32x32x16_bf16 v[56:71],a[156:159],v[52:55],v[56:71]
buffer_load_dwordx4 v1,s[8:11],s63 offen offset:1024 sc1 lds
s_lshl_b32 s62,s46,10
s_add_u32 s62,s62,40960
s_add_u32 m0,s66,s62
s_add_u32 s63,s67,s62
buffer_load_dwordx4 v1,s[8:11],s63 offen sc1 lds
s_add_u32 m0,s66,45056
s_add_u32 s63,s67,45056
buffer_load_dwordx4 v1,s[8:11],s63 offen sc1 lds
v_cvt_pk_bf16_f32 v8,v181,v181
v_lshlrev_b32 v181,16,v8
v_rcp_f32 v181,v181
s_cmp_eq_u32 s37,0
s_cbranch_scc0 sec_360
s_mov_b32 s35,s42
s_mov_b32 s53,s33
s_mov_b32 s54,s34
s_add_u32 s32,s32,1
s_mov_b32 s33,s40
s_mov_b32 s34,s41
s_mov_b64 s[76:77],s[80:81]
s_nop 2
ep_358:
v_pk_fma_f32 v[56:57],v[144:145],v[180:181],v[56:57] op_sel_hi:[1,0,1] neg_lo:[0,1,0] neg_hi:[0,1,0]
v_pk_fma_f32 v[58:59],v[146:147],v[180:181],v[58:59] op_sel_hi:[1,0,1] neg_lo:[0,1,0] neg_hi:[0,1,0]
v_pk_fma_f32 v[60:61],v[148:149],v[180:181],v[60:61] op_sel_hi:[1,0,1] neg_lo:[0,1,0] neg_hi:[0,1,0]
v_pk_fma_f32 v[62:63],v[150:151],v[180:181],v[62:63] op_sel_hi:[1,0,1] neg_lo:[0,1,0] neg_hi:[0,1,0]
v_pk_fma_f32 v[64:65],v[152:153],v[180:181],v[64:65] op_sel_hi:[1,0,1] neg_lo:[0,1,0] neg_hi:[0,1,0]
v_pk_fma_f32 v[66:67],v[154:155],v[180:181],v[66:67] op_sel_hi:[1,0,1] neg_lo:[0,1,0] neg_hi:[0,1,0]
v_pk_fma_f32 v[68:69],v[156:157],v[180:181],v[68:69] op_sel_hi:[1,0,1] neg_lo:[0,1,0] neg_hi:[0,1,0]
v_pk_fma_f32 v[70:71],v[158:159],v[180:181],v[70:71] op_sel_hi:[1,0,1] neg_lo:[0,1,0] neg_hi:[0,1,0]
v_pk_mul_f32 v[56:57],v[56:57],v[180:181] op_sel:[0,1] op_sel_hi:[1,1]
v_pk_mul_f32 v[58:59],v[58:59],v[180:181] op_sel:[0,1] op_sel_hi:[1,1]
v_pk_mul_f32 v[60:61],v[60:61],v[180:181] op_sel:[0,1] op_sel_hi:[1,1]
v_pk_mul_f32 v[62:63],v[62:63],v[180:181] op_sel:[0,1] op_sel_hi:[1,1]
v_pk_mul_f32 v[64:65],v[64:65],v[180:181] op_sel:[0,1] op_sel_hi:[1,1]
v_pk_mul_f32 v[66:67],v[66:67],v[180:181] op_sel:[0,1] op_sel_hi:[1,1]
v_pk_mul_f32 v[68:69],v[68:69],v[180:181] op_sel:[0,1] op_sel_hi:[1,1]
v_pk_mul_f32 v[70:71],v[70:71],v[180:181] op_sel:[0,1] op_sel_hi:[1,1]
v_cvt_pk_bf16_f32 v140,v56,v57
v_lshlrev_b32 v56,16,v140
v_and_b32 v57,0xffff0000,v140
v_cvt_pk_bf16_f32 v140,v58,v59
v_lshlrev_b32 v58,16,v140
v_and_b32 v59,0xffff0000,v140
v_cvt_pk_bf16_f32 v140,v60,v61
v_lshlrev_b32 v60,16,v140
v_and_b32 v61,0xffff0000,v140
v_cvt_pk_bf16_f32 v140,v62,v63
v_lshlrev_b32 v62,16,v140
v_and_b32 v63,0xffff0000,v140
v_cvt_pk_bf16_f32 v140,v64,v65
v_lshlrev_b32 v64,16,v140
v_and_b32 v65,0xffff0000,v140
v_cvt_pk_bf16_f32 v140,v66,v67
v_lshlrev_b32 v66,16,v140
v_and_b32 v67,0xffff0000,v140
v_cvt_pk_bf16_f32 v140,v68,v69
v_lshlrev_b32 v68,16,v140
v_and_b32 v69,0xffff0000,v140
v_cvt_pk_bf16_f32 v140,v70,v71
v_lshlrev_b32 v70,16,v140
v_and_b32 v71,0xffff0000,v140
v_pk_mul_f32 v[124:125],v[56:57],v[56:57]
v_pk_mul_f32 v[126:127],v[58:59],v[58:59]
v_pk_mul_f32 v[128:129],v[60:61],v[60:61]
v_pk_mul_f32 v[130:131],v[62:63],v[62:63]
v_pk_mul_f32 v[132:133],v[64:65],v[64:65]
v_pk_mul_f32 v[134:135],v[66:67],v[66:67]
v_pk_mul_f32 v[136:137],v[68:69],v[68:69]
v_pk_mul_f32 v[138:139],v[70:71],v[70:71]
v_pk_fma_f32 v[124:125],v[124:125],v[112:113],v[112:113] op_sel:[0,1,0] op_sel_hi:[1,1,0]
v_pk_fma_f32 v[126:127],v[126:127],v[112:113],v[112:113] op_sel:[0,1,0] op_sel_hi:[1,1,0]
v_pk_fma_f32 v[128:129],v[128:129],v[112:113],v[112:113] op_sel:[0,1,0] op_sel_hi:[1,1,0]
v_pk_fma_f32 v[130:131],v[130:131],v[112:113],v[112:113] op_sel:[0,1,0] op_sel_hi:[1,1,0]
v_pk_fma_f32 v[132:133],v[132:133],v[112:113],v[112:113] op_sel:[0,1,0] op_sel_hi:[1,1,0]
v_pk_fma_f32 v[134:135],v[134:135],v[112:113],v[112:113] op_sel:[0,1,0] op_sel_hi:[1,1,0]
v_pk_fma_f32 v[136:137],v[136:137],v[112:113],v[112:113] op_sel:[0,1,0] op_sel_hi:[1,1,0]
v_pk_fma_f32 v[138:139],v[138:139],v[112:113],v[112:113] op_sel:[0,1,0] op_sel_hi:[1,1,0]
v_pk_mul_f32 v[124:125],v[124:125],v[56:57]
v_pk_mul_f32 v[126:127],v[126:127],v[58:59]
v_pk_mul_f32 v[128:129],v[128:129],v[60:61]
v_pk_mul_f32 v[130:131],v[130:131],v[62:63]
v_pk_mul_f32 v[132:133],v[132:133],v[64:65]
v_pk_mul_f32 v[134:135],v[134:135],v[66:67]
v_pk_mul_f32 v[136:137],v[136:137],v[68:69]
v_pk_mul_f32 v[138:139],v[138:139],v[70:71]
v_exp_f32 v124,v124
v_exp_f32 v125,v125
v_exp_f32 v126,v126
v_exp_f32 v127,v127
v_exp_f32 v128,v128
v_exp_f32 v129,v129
v_exp_f32 v130,v130
v_exp_f32 v131,v131
v_exp_f32 v132,v132
v_exp_f32 v133,v133
v_exp_f32 v134,v134
v_exp_f32 v135,v135
v_exp_f32 v136,v136
v_exp_f32 v137,v137
v_exp_f32 v138,v138
v_exp_f32 v139,v139
v_pk_add_f32 v[124:125],v[124:125],1.0 op_sel_hi:[1,0]
v_pk_add_f32 v[126:127],v[126:127],1.0 op_sel_hi:[1,0]
v_pk_add_f32 v[128:129],v[128:129],1.0 op_sel_hi:[1,0]
v_pk_add_f32 v[130:131],v[130:131],1.0 op_sel_hi:[1,0]
v_pk_add_f32 v[132:133],v[132:133],1.0 op_sel_hi:[1,0]
v_pk_add_f32 v[134:135],v[134:135],1.0 op_sel_hi:[1,0]
v_pk_add_f32 v[136:137],v[136:137],1.0 op_sel_hi:[1,0]
v_pk_add_f32 v[138:139],v[138:139],1.0 op_sel_hi:[1,0]
v_rcp_f32 v124,v124
v_rcp_f32 v125,v125
v_rcp_f32 v126,v126
v_rcp_f32 v127,v127
v_rcp_f32 v128,v128
v_rcp_f32 v129,v129
v_rcp_f32 v130,v130
v_rcp_f32 v131,v131
v_rcp_f32 v132,v132
v_rcp_f32 v133,v133
v_rcp_f32 v134,v134
v_rcp_f32 v135,v135
v_rcp_f32 v136,v136
v_rcp_f32 v137,v137
v_rcp_f32 v138,v138
v_rcp_f32 v139,v139
v_pk_mul_f32 v[56:57],v[56:57],v[124:125]
v_pk_mul_f32 v[58:59],v[58:59],v[126:127]
v_pk_mul_f32 v[60:61],v[60:61],v[128:129]
v_pk_mul_f32 v[62:63],v[62:63],v[130:131]
v_pk_mul_f32 v[64:65],v[64:65],v[132:133]
v_pk_mul_f32 v[66:67],v[66:67],v[134:135]
v_pk_mul_f32 v[68:69],v[68:69],v[136:137]
v_pk_mul_f32 v[70:71],v[70:71],v[138:139]
v_cvt_pk_bf16_f32 v116,v56,v57
v_cvt_pk_bf16_f32 v117,v58,v59
v_cvt_pk_bf16_f32 v118,v60,v61
v_cvt_pk_bf16_f32 v119,v62,v63
v_cvt_pk_bf16_f32 v120,v64,v65
v_cvt_pk_bf16_f32 v121,v66,v67
v_cvt_pk_bf16_f32 v122,v68,v69
v_cvt_pk_bf16_f32 v123,v70,v71
s_cmp_lg_u32 s49,0
s_cbranch_scc0 ls_361
buffer_store_dwordx4 v[116:119],v20,s[8:11],s71 offen sc1
buffer_store_dwordx4 v[120:123],v21,s[8:11],s71 offen sc1
s_branch ls_362
ls_361:
buffer_store_dwordx4 v[116:119],v20,s[8:11],s71 offen
buffer_store_dwordx4 v[120:123],v21,s[8:11],s71 offen
ls_362:
s_mov_b32 s59,s82
s_cmp_eq_u32 s37,0
s_cbranch_scc1 W3_NEXT
s_waitcnt vmcnt(2)
v_cmp_eq_u32 vcc,0,v3
s_and_b64 vcc,vcc,s[76:77]
s_cselect_b32 s37,2147483648,0
s_cmp_lt_u32 s32,128
s_cselect_b32 s37,s37,2147483648
s_cmp_eq_u32 s37,0
s_cbranch_scc1 W3_COLD2
s_waitcnt vmcnt(0)
s_mov_b64 exec,1
s_cmp_lg_u32 s49,0
s_cbranch_scc0 ls_363
buffer_store_dword v5,v1,s[8:11],s59 offen sc1
s_branch ls_364
ls_363:
buffer_store_dword v5,v1,s[8:11],s59 offen
ls_364:
s_mov_b64 exec,-1
s_mov_b32 s59,2147483648
s_cmp_lt_u32 s32,128
s_cbranch_scc1 W3_COLD
s_branch W3_END
sec_360:
s_waitcnt vmcnt(7)
v_cmp_eq_u32 vcc,0,v3
s_and_b64 vcc,vcc,s[76:77]
s_cselect_b32 s37,2147483648,0
s_cmp_lt_u32 s32,128
s_cselect_b32 s37,s37,2147483648
s_cmp_lg_u32 s37,0
s_cbranch_scc1 nr_359
s_sub_u32 s66,46080,s57
s_mul_i32 s60,s33,8
s_and_b32 s61,s34,7
s_add_u32 s60,s60,s61
s_mul_i32 s60,s60,46080
s_add_u32 s60,s60,s37
s_add_u32 s60,s60,212467712
s_mov_b32 s67,s60
s_mul_i32 s61,s46,10240
s_add_u32 s60,s60,s61
s_add_u32 s61,s61,s66
s_add_u32 m0,s61,0
s_add_u32 s63,s60,0
buffer_load_dwordx4 v1,s[8:11],s63 offen sc1 lds
v_pk_fma_f32 v[56:57],v[144:145],v[180:181],v[56:57] op_sel_hi:[1,0,1] neg_lo:[0,1,0] neg_hi:[0,1,0]
v_pk_fma_f32 v[58:59],v[146:147],v[180:181],v[58:59] op_sel_hi:[1,0,1] neg_lo:[0,1,0] neg_hi:[0,1,0]
v_pk_fma_f32 v[60:61],v[148:149],v[180:181],v[60:61] op_sel_hi:[1,0,1] neg_lo:[0,1,0] neg_hi:[0,1,0]
v_pk_fma_f32 v[62:63],v[150:151],v[180:181],v[62:63] op_sel_hi:[1,0,1] neg_lo:[0,1,0] neg_hi:[0,1,0]
v_pk_fma_f32 v[64:65],v[152:153],v[180:181],v[64:65] op_sel_hi:[1,0,1] neg_lo:[0,1,0] neg_hi:[0,1,0]
v_pk_fma_f32 v[66:67],v[154:155],v[180:181],v[66:67] op_sel_hi:[1,0,1] neg_lo:[0,1,0] neg_hi:[0,1,0]
v_pk_fma_f32 v[68:69],v[156:157],v[180:181],v[68:69] op_sel_hi:[1,0,1] neg_lo:[0,1,0] neg_hi:[0,1,0]
v_pk_fma_f32 v[70:71],v[158:159],v[180:181],v[70:71] op_sel_hi:[1,0,1] neg_lo:[0,1,0] neg_hi:[0,1,0]
buffer_load_dwordx4 v1,s[8:11],s63 offen offset:1024 sc1 lds
v_pk_mul_f32 v[56:57],v[56:57],v[180:181] op_sel:[0,1] op_sel_hi:[1,1]
v_pk_mul_f32 v[58:59],v[58:59],v[180:181] op_sel:[0,1] op_sel_hi:[1,1]
v_pk_mul_f32 v[60:61],v[60:61],v[180:181] op_sel:[0,1] op_sel_hi:[1,1]
v_pk_mul_f32 v[62:63],v[62:63],v[180:181] op_sel:[0,1] op_sel_hi:[1,1]
v_pk_mul_f32 v[64:65],v[64:65],v[180:181] op_sel:[0,1] op_sel_hi:[1,1]
v_pk_mul_f32 v[66:67],v[66:67],v[180:181] op_sel:[0,1] op_sel_hi:[1,1]
v_pk_mul_f32 v[68:69],v[68:69],v[180:181] op_sel:[0,1] op_sel_hi:[1,1]
v_pk_mul_f32 v[70:71],v[70:71],v[180:181] op_sel:[0,1] op_sel_hi:[1,1]
buffer_load_dwordx4 v1,s[8:11],s63 offen offset:2048 sc1 lds
v_cvt_pk_bf16_f32 v140,v56,v57
v_lshlrev_b32 v56,16,v140
v_and_b32 v57,0xffff0000,v140
v_cvt_pk_bf16_f32 v140,v58,v59
v_lshlrev_b32 v58,16,v140
v_and_b32 v59,0xffff0000,v140
v_cvt_pk_bf16_f32 v140,v60,v61
v_lshlrev_b32 v60,16,v140
buffer_load_dwordx4 v1,s[8:11],s63 offen offset:3072 sc1 lds
v_and_b32 v61,0xffff0000,v140
v_cvt_pk_bf16_f32 v140,v62,v63
v_lshlrev_b32 v62,16,v140
v_and_b32 v63,0xffff0000,v140
v_cvt_pk_bf16_f32 v140,v64,v65
v_lshlrev_b32 v64,16,v140
v_and_b32 v65,0xffff0000,v140
v_cvt_pk_bf16_f32 v140,v66,v67
s_add_u32 m0,s61,4096
s_add_u32 s63,s60,4096
buffer_load_dwordx4 v1,s[8:11],s63 offen sc1 lds
v_lshlrev_b32 v66,16,v140
v_and_b32 v67,0xffff0000,v140
v_cvt_pk_bf16_f32 v140,v68,v69
v_lshlrev_b32 v68,16,v140
v_and_b32 v69,0xffff0000,v140
v_cvt_pk_bf16_f32 v140,v70,v71
v_lshlrev_b32 v70,16,v140
v_and_b32 v71,0xffff0000,v140
buffer_load_dwordx4 v1,s[8:11],s63 offen offset:1024 sc1 lds
v_pk_mul_f32 v[124:125],v[56:57],v[56:57]
v_pk_mul_f32 v[126:127],v[58:59],v[58:59]
v_pk_mul_f32 v[128:129],v[60:61],v[60:61]
v_pk_mul_f32 v[130:131],v[62:63],v[62:63]
v_pk_mul_f32 v[132:133],v[64:65],v[64:65]
v_pk_mul_f32 v[134:135],v[66:67],v[66:67]
v_pk_mul_f32 v[136:137],v[68:69],v[68:69]
v_pk_mul_f32 v[138:139],v[70:71],v[70:71]
buffer_load_dwordx4 v1,s[8:11],s63 offen offset:2048 sc1 lds
v_pk_fma_f32 v[124:125],v[124:125],v[112:113],v[112:113] op_sel:[0,1,0] op_sel_hi:[1,1,0]
v_pk_fma_f32 v[126:127],v[126:127],v[112:113],v[112:113] op_sel:[0,1,0] op_sel_hi:[1,1,0]
v_pk_fma_f32 v[128:129],v[128:129],v[112:113],v[112:113] op_sel:[0,1,0] op_sel_hi:[1,1,0]
v_pk_fma_f32 v[130:131],v[130:131],v[112:113],v[112:113] op_sel:[0,1,0] op_sel_hi:[1,1,0]
v_pk_fma_f32 v[132:133],v[132:133],v[112:113],v[112:113] op_sel:[0,1,0] op_sel_hi:[1,1,0]
v_pk_fma_f32 v[134:135],v[134:135],v[112:113],v[112:113] op_sel:[0,1,0] op_sel_hi:[1,1,0]
v_pk_fma_f32 v[136:137],v[136:137],v[112:113],v[112:113] op_sel:[0,1,0] op_sel_hi:[1,1,0]
v_pk_fma_f32 v[138:139],v[138:139],v[112:113],v[112:113] op_sel:[0,1,0] op_sel_hi:[1,1,0]
buffer_load_dwordx4 v1,s[8:11],s63 offen offset:3072 sc1 lds
v_pk_mul_f32 v[124:125],v[124:125],v[56:57]
v_pk_mul_f32 v[126:127],v[126:127],v[58:59]
v_pk_mul_f32 v[128:129],v[128:129],v[60:61]
v_pk_mul_f32 v[130:131],v[130:131],v[62:63]
v_pk_mul_f32 v[132:133],v[132:133],v[64:65]
v_pk_mul_f32 v[134:135],v[134:135],v[66:67]
v_pk_mul_f32 v[136:137],v[136:137],v[68:69]
v_pk_mul_f32 v[138:139],v[138:139],v[70:71]
s_add_u32 m0,s61,8192
s_add_u32 s63,s60,8192
buffer_load_dwordx4 v1,s[8:11],s63 offen sc1 lds
v_exp_f32 v124,v124
v_exp_f32 v125,v125
v_exp_f32 v126,v126
v_exp_f32 v127,v127
v_exp_f32 v128,v128
v_exp_f32 v129,v129
v_exp_f32 v130,v130
v_exp_f32 v131,v131
buffer_load_dwordx4 v1,s[8:11],s63 offen offset:1024 sc1 lds
v_exp_f32 v132,v132
v_exp_f32 v133,v133
v_exp_f32 v134,v134
v_exp_f32 v135,v135
v_exp_f32 v136,v136
v_exp_f32 v137,v137
v_exp_f32 v138,v138
v_exp_f32 v139,v139
s_lshl_b32 s62,s46,10
s_add_u32 s62,s62,40960
s_add_u32 m0,s66,s62
s_add_u32 s63,s67,s62
buffer_load_dwordx4 v1,s[8:11],s63 offen sc1 lds
v_pk_add_f32 v[124:125],v[124:125],1.0 op_sel_hi:[1,0]
v_pk_add_f32 v[126:127],v[126:127],1.0 op_sel_hi:[1,0]
v_pk_add_f32 v[128:129],v[128:129],1.0 op_sel_hi:[1,0]
v_pk_add_f32 v[130:131],v[130:131],1.0 op_sel_hi:[1,0]
v_pk_add_f32 v[132:133],v[132:133],1.0 op_sel_hi:[1,0]
v_pk_add_f32 v[134:135],v[134:135],1.0 op_sel_hi:[1,0]
v_pk_add_f32 v[136:137],v[136:137],1.0 op_sel_hi:[1,0]
v_pk_add_f32 v[138:139],v[138:139],1.0 op_sel_hi:[1,0]
s_add_u32 m0,s66,45056
s_add_u32 s63,s67,45056
buffer_load_dwordx4 v1,s[8:11],s63 offen sc1 lds
v_rcp_f32 v124,v124
v_rcp_f32 v125,v125
v_rcp_f32 v126,v126
v_rcp_f32 v127,v127
v_rcp_f32 v128,v128
v_rcp_f32 v129,v129
v_rcp_f32 v130,v130
v_rcp_f32 v131,v131
s_mov_b32 s35,s42
s_mov_b32 s53,s33
s_mov_b32 s54,s34
s_add_u32 s32,s32,1
s_mov_b32 s33,s40
s_mov_b32 s34,s41
s_mov_b64 s[76:77],s[80:81]
v_rcp_f32 v132,v132
v_rcp_f32 v133,v133
v_rcp_f32 v134,v134
v_rcp_f32 v135,v135
v_rcp_f32 v136,v136
v_rcp_f32 v137,v137
v_rcp_f32 v138,v138
v_rcp_f32 v139,v139
v_pk_mul_f32 v[56:57],v[56:57],v[124:125]
v_pk_mul_f32 v[58:59],v[58:59],v[126:127]
v_pk_mul_f32 v[60:61],v[60:61],v[128:129]
v_pk_mul_f32 v[62:63],v[62:63],v[130:131]
v_pk_mul_f32 v[64:65],v[64:65],v[132:133]
v_pk_mul_f32 v[66:67],v[66:67],v[134:135]
v_pk_mul_f32 v[68:69],v[68:69],v[136:137]
v_pk_mul_f32 v[70:71],v[70:71],v[138:139]
v_cvt_pk_bf16_f32 v116,v56,v57
v_cvt_pk_bf16_f32 v117,v58,v59
v_cvt_pk_bf16_f32 v118,v60,v61
v_cvt_pk_bf16_f32 v119,v62,v63
v_cvt_pk_bf16_f32 v120,v64,v65
v_cvt_pk_bf16_f32 v121,v66,v67
v_cvt_pk_bf16_f32 v122,v68,v69
v_cvt_pk_bf16_f32 v123,v70,v71
s_cmp_lg_u32 s49,0
s_cbranch_scc0 ls_365
buffer_store_dwordx4 v[116:119],v20,s[8:11],s71 offen sc1
buffer_store_dwordx4 v[120:123],v21,s[8:11],s71 offen sc1
s_branch ls_366
ls_365:
buffer_store_dwordx4 v[116:119],v20,s[8:11],s71 offen
buffer_store_dwordx4 v[120:123],v21,s[8:11],s71 offen
ls_366:
s_mov_b32 s59,s82
s_branch W3_NEXT
nr_359:
buffer_load_dword v3,v2,s[8:11],s35 offen sc1
s_branch ep_358
W3_END:
s_endpgm
ROLE_W4:
v_lshlrev_b32 v1,4,v0
v_mov_b32 v5,1
s_lshl_b32 s56,s48,2
s_add_u32 s56,s56,s46
v_bfe_u32 v6,v0,2,2
v_lshrrev_b32 v7,4,v0
v_add_u32 v7,v6,v7
v_and_b32 v7,3,v7
v_and_b32 v15,3,v0
v_lshlrev_b32 v15,4,v15
v_lshl_add_u32 v15,v7,6,v15
v_lshl_add_u32 v15,v6,8,v15
v_lshrrev_b32 v6,5,v0
v_bfe_u32 v7,v0,4,1
v_lshlrev_b32 v208,10,v7
v_lshl_add_u32 v208,v6,8,v208
v_and_b32 v6,15,v0
v_lshl_add_u32 v208,v6,4,v208
v_lshrrev_b32 v6,5,v0
v_add_u32 v6,2,v6
v_bfe_u32 v7,v0,4,1
v_lshlrev_b32 v209,10,v7
v_lshl_add_u32 v209,v6,8,v209
v_and_b32 v6,15,v0
v_lshl_add_u32 v209,v6,4,v209
v_min_u32 v2,11,v0
s_mul_i32 s60,s46,12
v_add_u32 v2,s60,v2
v_lshlrev_b32 v2,2,v2
s_and_b32 s60,s46,1
s_lshl_b32 s68,s48,1
s_add_u32 s68,s68,s60
s_lshr_b32 s69,s46,1
s_mul_i32 s71,s46,24576
s_mul_i32 s58,s46,491520
s_lshl_b32 s61,s48,7
s_add_u32 s58,s58,s61
s_add_u32 s71,s71,242778112
v_and_b32 v6,15,v0
v_lshlrev_b32 v204,3,v6
s_lshl_b32 s60,s69,4
v_add_u32 v6,s60,v6
v_mul_u32_u24 v205,1280,v6
v_lshrrev_b32 v6,4,v0
v_lshl_add_u32 v205,v6,3,v205
s_lshl_b32 s60,s68,6
v_add_u32 v205,s60,v205
s_mov_b32 s76,s40
s_mov_b32 s77,s41
s_mov_b32 s78,2621440
s_mov_b32 s79,0x20000
s_lshl_b32 s70,s68,1
s_add_u32 s70,s70,s69
s_lshl_b32 s70,s70,10
v_bfe_u32 v6,v0,4,1
v_lshlrev_b32 v206,14,v6
v_lshrrev_b32 v6,5,v0
v_lshl_add_u32 v206,v6,8,v206
v_and_b32 v6,15,v0
v_lshl_add_u32 v206,v6,4,v206
s_lshl_b32 s60,s46,11
v_add_u32 v206,s60,v206
s_lshl_b32 s60,s46,13
v_add_u32 v207,s60,v1
s_waitcnt vmcnt(0)
s_barrier
s_cmp_lg_u32 s46,0
s_cbranch_scc1 arr_367
v_mov_b32 v6,1
s_lshl_b32 s3,s49,2
v_mov_b32 v7,s3
s_mov_b64 exec,1
buffer_atomic_add v6,v7,s[12:15],0 offen sc1
s_mov_b64 exec,-1
arr_367:
s_mul_i32 s63,s46,40960
s_mov_b32 s4,s38
s_mov_b32 s5,s39
s_mov_b32 s6,1966080
s_mov_b32 s7,0x20000
v_lshrrev_b32 v9,3,v0
s_mov_b32 s64,1280
v_mul_lo_u32 v9,v9,s64
v_and_b32 v10,7,v0
v_lshl_add_u32 v6,v10,4,v9
s_add_u32 m0,s63,0
s_add_u32 s65,s58,0
buffer_load_dwordx4 v6,s[4:7],s65 offen lds
s_add_u32 m0,s63,1024
s_add_u32 s65,s58,10240
buffer_load_dwordx4 v6,s[4:7],s65 offen lds
s_add_u32 m0,s63,2048
s_add_u32 s65,s58,20480
buffer_load_dwordx4 v6,s[4:7],s65 offen lds
s_add_u32 m0,s63,3072
s_add_u32 s65,s58,30720
buffer_load_dwordx4 v6,s[4:7],s65 offen lds
s_add_u32 m0,s63,4096
s_add_u32 s65,s58,40960
buffer_load_dwordx4 v6,s[4:7],s65 offen lds
s_add_u32 m0,s63,5120
s_add_u32 s65,s58,51200
buffer_load_dwordx4 v6,s[4:7],s65 offen lds
s_add_u32 m0,s63,6144
s_add_u32 s65,s58,61440
buffer_load_dwordx4 v6,s[4:7],s65 offen lds
s_add_u32 m0,s63,7168
s_add_u32 s65,s58,71680
buffer_load_dwordx4 v6,s[4:7],s65 offen lds
s_add_u32 m0,s63,8192
s_add_u32 s65,s58,81920
buffer_load_dwordx4 v6,s[4:7],s65 offen lds
s_add_u32 m0,s63,9216
s_add_u32 s65,s58,92160
buffer_load_dwordx4 v6,s[4:7],s65 offen lds
s_add_u32 m0,s63,10240
s_add_u32 s65,s58,102400
buffer_load_dwordx4 v6,s[4:7],s65 offen lds
s_add_u32 m0,s63,11264
s_add_u32 s65,s58,112640
buffer_load_dwordx4 v6,s[4:7],s65 offen lds
s_add_u32 m0,s63,12288
s_add_u32 s65,s58,122880
buffer_load_dwordx4 v6,s[4:7],s65 offen lds
s_add_u32 m0,s63,13312
s_add_u32 s65,s58,133120
buffer_load_dwordx4 v6,s[4:7],s65 offen lds
s_add_u32 m0,s63,14336
s_add_u32 s65,s58,143360
buffer_load_dwordx4 v6,s[4:7],s65 offen lds
s_add_u32 m0,s63,15360
s_add_u32 s65,s58,153600
buffer_load_dwordx4 v6,s[4:7],s65 offen lds
s_add_u32 m0,s63,16384
s_add_u32 s65,s58,163840
buffer_load_dwordx4 v6,s[4:7],s65 offen lds
s_add_u32 m0,s63,17408
s_add_u32 s65,s58,174080
buffer_load_dwordx4 v6,s[4:7],s65 offen lds
s_add_u32 m0,s63,18432
s_add_u32 s65,s58,184320
buffer_load_dwordx4 v6,s[4:7],s65 offen lds
s_add_u32 m0,s63,19456
s_add_u32 s65,s58,194560
buffer_load_dwordx4 v6,s[4:7],s65 offen lds
s_add_u32 m0,s63,20480
s_add_u32 s65,s58,204800
buffer_load_dwordx4 v6,s[4:7],s65 offen lds
s_add_u32 m0,s63,21504
s_add_u32 s65,s58,215040
buffer_load_dwordx4 v6,s[4:7],s65 offen lds
s_add_u32 m0,s63,22528
s_add_u32 s65,s58,225280
buffer_load_dwordx4 v6,s[4:7],s65 offen lds
s_add_u32 m0,s63,23552
s_add_u32 s65,s58,235520
buffer_load_dwordx4 v6,s[4:7],s65 offen lds
s_add_u32 m0,s63,24576
s_add_u32 s65,s58,245760
buffer_load_dwordx4 v6,s[4:7],s65 offen lds
s_add_u32 m0,s63,25600
s_add_u32 s65,s58,256000
buffer_load_dwordx4 v6,s[4:7],s65 offen lds
s_add_u32 m0,s63,26624
s_add_u32 s65,s58,266240
buffer_load_dwordx4 v6,s[4:7],s65 offen lds
s_add_u32 m0,s63,27648
s_add_u32 s65,s58,276480
buffer_load_dwordx4 v6,s[4:7],s65 offen lds
s_add_u32 m0,s63,28672
s_add_u32 s65,s58,286720
buffer_load_dwordx4 v6,s[4:7],s65 offen lds
s_add_u32 m0,s63,29696
s_add_u32 s65,s58,296960
buffer_load_dwordx4 v6,s[4:7],s65 offen lds
s_add_u32 m0,s63,30720
s_add_u32 s65,s58,307200
buffer_load_dwordx4 v6,s[4:7],s65 offen lds
s_add_u32 m0,s63,31744
s_add_u32 s65,s58,317440
buffer_load_dwordx4 v6,s[4:7],s65 offen lds
s_add_u32 m0,s63,32768
s_add_u32 s65,s58,327680
buffer_load_dwordx4 v6,s[4:7],s65 offen lds
s_add_u32 m0,s63,33792
s_add_u32 s65,s58,337920
buffer_load_dwordx4 v6,s[4:7],s65 offen lds
s_add_u32 m0,s63,34816
s_add_u32 s65,s58,348160
buffer_load_dwordx4 v6,s[4:7],s65 offen lds
s_add_u32 m0,s63,35840
s_add_u32 s65,s58,358400
buffer_load_dwordx4 v6,s[4:7],s65 offen lds
s_add_u32 m0,s63,36864
s_add_u32 s65,s58,368640
buffer_load_dwordx4 v6,s[4:7],s65 offen lds
s_add_u32 m0,s63,37888
s_add_u32 s65,s58,378880
buffer_load_dwordx4 v6,s[4:7],s65 offen lds
s_add_u32 m0,s63,38912
s_add_u32 s65,s58,389120
buffer_load_dwordx4 v6,s[4:7],s65 offen lds
s_add_u32 m0,s63,39936
s_add_u32 s65,s58,399360
buffer_load_dwordx4 v6,s[4:7],s65 offen lds
s_waitcnt vmcnt(20)
v_bfe_u32 v9,v0,2,2
v_lshrrev_b32 v10,5,v0
v_lshl_add_u32 v9,v10,2,v9
v_mul_u32_u24 v9,128,v9
v_and_b32 v10,1,v0
v_lshl_add_u32 v9,v10,3,v9
v_bfe_u32 v10,v0,1,1
v_lshl_add_u32 v9,v10,5,v9
v_bfe_u32 v10,v0,4,1
v_lshl_add_u32 v9,v10,4,v9
v_add_u32 v7,s63,v9
ds_read_b64_tr_b16 a[0:1],v7 offset:0
ds_read_b64_tr_b16 a[2:3],v7 offset:2048
ds_read_b64_tr_b16 a[4:5],v7 offset:1024
ds_read_b64_tr_b16 a[6:7],v7 offset:3072
ds_read_b64_tr_b16 a[96:97],v7 offset:64
ds_read_b64_tr_b16 a[98:99],v7 offset:2112
ds_read_b64_tr_b16 a[100:101],v7 offset:1088
ds_read_b64_tr_b16 a[102:103],v7 offset:3136
ds_read_b64_tr_b16 a[8:9],v7 offset:4096
ds_read_b64_tr_b16 a[10:11],v7 offset:6144
ds_read_b64_tr_b16 a[12:13],v7 offset:5120
ds_read_b64_tr_b16 a[14:15],v7 offset:7168
s_waitcnt lgkmcnt(4)
ds_read_b64_tr_b16 a[104:105],v7 offset:4160
ds_read_b64_tr_b16 a[106:107],v7 offset:6208
ds_read_b64_tr_b16 a[108:109],v7 offset:5184
ds_read_b64_tr_b16 a[110:111],v7 offset:7232
ds_read_b64_tr_b16 a[16:17],v7 offset:8192
ds_read_b64_tr_b16 a[18:19],v7 offset:10240
ds_read_b64_tr_b16 a[20:21],v7 offset:9216
ds_read_b64_tr_b16 a[22:23],v7 offset:11264
ds_read_b64_tr_b16 a[112:113],v7 offset:8256
ds_read_b64_tr_b16 a[114:115],v7 offset:10304
ds_read_b64_tr_b16 a[116:117],v7 offset:9280
ds_read_b64_tr_b16 a[118:119],v7 offset:11328
s_waitcnt lgkmcnt(4)
ds_read_b64_tr_b16 a[24:25],v7 offset:12288
ds_read_b64_tr_b16 a[26:27],v7 offset:14336
ds_read_b64_tr_b16 a[28:29],v7 offset:13312
ds_read_b64_tr_b16 a[30:31],v7 offset:15360
ds_read_b64_tr_b16 a[120:121],v7 offset:12352
ds_read_b64_tr_b16 a[122:123],v7 offset:14400
ds_read_b64_tr_b16 a[124:125],v7 offset:13376
ds_read_b64_tr_b16 a[126:127],v7 offset:15424
ds_read_b64_tr_b16 a[32:33],v7 offset:16384
ds_read_b64_tr_b16 a[34:35],v7 offset:18432
ds_read_b64_tr_b16 a[36:37],v7 offset:17408
ds_read_b64_tr_b16 a[38:39],v7 offset:19456
s_waitcnt lgkmcnt(4)
ds_read_b64_tr_b16 a[128:129],v7 offset:16448
ds_read_b64_tr_b16 a[130:131],v7 offset:18496
ds_read_b64_tr_b16 a[132:133],v7 offset:17472
ds_read_b64_tr_b16 a[134:135],v7 offset:19520
s_waitcnt lgkmcnt(0)
s_add_u32 m0,s63,0
s_add_u32 s65,s58,409600
buffer_load_dwordx4 v6,s[4:7],s65 offen lds
s_add_u32 m0,s63,1024
s_add_u32 s65,s58,419840
buffer_load_dwordx4 v6,s[4:7],s65 offen lds
s_add_u32 m0,s63,2048
s_add_u32 s65,s58,430080
buffer_load_dwordx4 v6,s[4:7],s65 offen lds
s_add_u32 m0,s63,3072
s_add_u32 s65,s58,440320
buffer_load_dwordx4 v6,s[4:7],s65 offen lds
s_add_u32 m0,s63,4096
s_add_u32 s65,s58,450560
buffer_load_dwordx4 v6,s[4:7],s65 offen lds
s_add_u32 m0,s63,5120
s_add_u32 s65,s58,460800
buffer_load_dwordx4 v6,s[4:7],s65 offen lds
s_add_u32 m0,s63,6144
s_add_u32 s65,s58,471040
buffer_load_dwordx4 v6,s[4:7],s65 offen lds
s_add_u32 m0,s63,7168
s_add_u32 s65,s58,481280
buffer_load_dwordx4 v6,s[4:7],s65 offen lds
s_waitcnt vmcnt(8)
v_bfe_u32 v9,v0,2,2
v_lshrrev_b32 v10,5,v0
v_lshl_add_u32 v9,v10,2,v9
v_mul_u32_u24 v9,128,v9
v_and_b32 v10,1,v0
v_lshl_add_u32 v9,v10,3,v9
v_bfe_u32 v10,v0,1,1
v_lshl_add_u32 v9,v10,5,v9
v_bfe_u32 v10,v0,4,1
v_lshl_add_u32 v9,v10,4,v9
v_add_u32 v7,s63,v9
ds_read_b64_tr_b16 a[40:41],v7 offset:20480
ds_read_b64_tr_b16 a[42:43],v7 offset:22528
ds_read_b64_tr_b16 a[44:45],v7 offset:21504
ds_read_b64_tr_b16 a[46:47],v7 offset:23552
ds_read_b64_tr_b16 a[136:137],v7 offset:20544
ds_read_b64_tr_b16 a[138:139],v7 offset:22592
ds_read_b64_tr_b16 a[140:141],v7 offset:21568
ds_read_b64_tr_b16 a[142:143],v7 offset:23616
ds_read_b64_tr_b16 a[48:49],v7 offset:24576
ds_read_b64_tr_b16 a[50:51],v7 offset:26624
ds_read_b64_tr_b16 a[52:53],v7 offset:25600
ds_read_b64_tr_b16 a[54:55],v7 offset:27648
s_waitcnt lgkmcnt(4)
ds_read_b64_tr_b16 a[144:145],v7 offset:24640
ds_read_b64_tr_b16 a[146:147],v7 offset:26688
ds_read_b64_tr_b16 a[148:149],v7 offset:25664
ds_read_b64_tr_b16 a[150:151],v7 offset:27712
ds_read_b64_tr_b16 a[56:57],v7 offset:28672
ds_read_b64_tr_b16 a[58:59],v7 offset:30720
ds_read_b64_tr_b16 a[60:61],v7 offset:29696
ds_read_b64_tr_b16 a[62:63],v7 offset:31744
ds_read_b64_tr_b16 a[152:153],v7 offset:28736
ds_read_b64_tr_b16 a[154:155],v7 offset:30784
ds_read_b64_tr_b16 a[156:157],v7 offset:29760
ds_read_b64_tr_b16 a[158:159],v7 offset:31808
s_waitcnt lgkmcnt(4)
ds_read_b64_tr_b16 a[64:65],v7 offset:32768
ds_read_b64_tr_b16 a[66:67],v7 offset:34816
ds_read_b64_tr_b16 a[68:69],v7 offset:33792
ds_read_b64_tr_b16 a[70:71],v7 offset:35840
ds_read_b64_tr_b16 a[160:161],v7 offset:32832
ds_read_b64_tr_b16 a[162:163],v7 offset:34880
ds_read_b64_tr_b16 a[164:165],v7 offset:33856
ds_read_b64_tr_b16 a[166:167],v7 offset:35904
ds_read_b64_tr_b16 a[72:73],v7 offset:36864
ds_read_b64_tr_b16 a[74:75],v7 offset:38912
ds_read_b64_tr_b16 a[76:77],v7 offset:37888
ds_read_b64_tr_b16 a[78:79],v7 offset:39936
s_waitcnt lgkmcnt(4)
ds_read_b64_tr_b16 a[168:169],v7 offset:36928
ds_read_b64_tr_b16 a[170:171],v7 offset:38976
ds_read_b64_tr_b16 a[172:173],v7 offset:37952
ds_read_b64_tr_b16 a[174:175],v7 offset:40000
s_waitcnt lgkmcnt(0)
s_waitcnt vmcnt(0)
v_bfe_u32 v9,v0,2,2
v_lshrrev_b32 v10,5,v0
v_lshl_add_u32 v9,v10,2,v9
v_mul_u32_u24 v9,128,v9
v_and_b32 v10,1,v0
v_lshl_add_u32 v9,v10,3,v9
v_bfe_u32 v10,v0,1,1
v_lshl_add_u32 v9,v10,5,v9
v_bfe_u32 v10,v0,4,1
v_lshl_add_u32 v9,v10,4,v9
v_add_u32 v7,s63,v9
ds_read_b64_tr_b16 a[80:81],v7 offset:0
ds_read_b64_tr_b16 a[82:83],v7 offset:2048
ds_read_b64_tr_b16 a[84:85],v7 offset:1024
ds_read_b64_tr_b16 a[86:87],v7 offset:3072
ds_read_b64_tr_b16 a[176:177],v7 offset:64
ds_read_b64_tr_b16 a[178:179],v7 offset:2112
ds_read_b64_tr_b16 a[180:181],v7 offset:1088
ds_read_b64_tr_b16 a[182:183],v7 offset:3136
ds_read_b64_tr_b16 a[88:89],v7 offset:4096
ds_read_b64_tr_b16 a[90:91],v7 offset:6144
ds_read_b64_tr_b16 a[92:93],v7 offset:5120
ds_read_b64_tr_b16 a[94:95],v7 offset:7168
s_waitcnt lgkmcnt(4)
ds_read_b64_tr_b16 a[184:185],v7 offset:4160
ds_read_b64_tr_b16 a[186:187],v7 offset:6208
ds_read_b64_tr_b16 a[188:189],v7 offset:5184
ds_read_b64_tr_b16 a[190:191],v7 offset:7232
s_waitcnt lgkmcnt(0)
s_barrier
s_lshl_b32 s3,s49,2
v_mov_b32 v7,s3
s_nop 1
ibw_368:
buffer_load_dword v6,v7,s[12:15],0 offen sc1
s_waitcnt vmcnt(0)
v_cmp_ne_u32 vcc,256,v6
s_nop 0
s_cbranch_vccz ok_369
s_sleep 8
s_sub_u32 s47,s47,1
s_cbranch_scc1 ABORT
s_branch ibw_368
ok_369:
s_cmp_lg_u32 s49,0
s_cbranch_scc1 ibok_370
v_and_b32 v7,7,v0
v_lshlrev_b32 v7,2,v7
buffer_load_dword v6,v7,s[12:15],0 offen offset:32 sc1
s_waitcnt vmcnt(0)
v_cmp_ne_u32 vcc,32,v6
s_nop 0
s_cbranch_vccz ibok_370
s_barrier
s_mov_b32 s49,1
s_mov_b32 s3,s2
s_load_dwordx16 s[16:31],s[0:1],0
s_load_dwordx8 s[32:39],s[0:1],64
s_waitcnt lgkmcnt(0)
s_branch DISPATCH
ibok_370:
s_mov_b32 s83,s100
s_mov_b32 s32,0
s_mov_b32 s59,2147483648
s_min_u32 s62,s32,127
s_sub_u32 s60,s62,14
s_lshr_b32 s34,s60,1
s_and_b32 s33,s60,1
s_cmp_eq_u32 s33,0
s_cselect_b32 s61,14,0
s_add_u32 s34,s34,s61
s_sub_u32 s61,s60,50
s_cmp_ge_u32 s60,100
s_cselect_b32 s34,s61,s34
s_cselect_b32 s33,1,s33
s_cmp_lt_u32 s62,14
s_cselect_b32 s34,s62,s34
s_cselect_b32 s33,0,s33
s_lshl_b32 s35,s33,6
s_add_u32 s35,s35,s34
s_lshl_b32 s35,s35,9
s_add_u32 s35,s35,589824
s_and_b32 s60,s34,3
s_lshl2_add_u32 s60,s33,s60
s_mul_i32 s73,s60,98304
s_add_u32 s73,s73,s71
W4_COLD:
fb_371:
buffer_load_dword v3,v2,s[8:11],s35 offen sc1
s_waitcnt vmcnt(0)
v_cmp_eq_u32 vcc,0,v3
s_nop 0
s_cbranch_vccz ok_372
s_sleep 2
s_sub_u32 s47,s47,1
s_cbranch_scc1 ABORT
s_branch fb_371
ok_372:
s_add_u32 s63,s73,0
buffer_load_dwordx4 v[16:19],v208,s[8:11],s63 offen sc1
s_nop 7
buffer_load_dwordx4 v[20:23],v209,s[8:11],s63 offen sc1
s_nop 7
buffer_load_dwordx4 v[24:27],v208,s[8:11],s63 offen offset:2048 sc1
s_nop 7
buffer_load_dwordx4 v[28:31],v209,s[8:11],s63 offen offset:2048 sc1
s_nop 7
s_add_u32 s63,s73,4096
buffer_load_dwordx4 v[32:35],v208,s[8:11],s63 offen sc1
s_nop 7
buffer_load_dwordx4 v[36:39],v209,s[8:11],s63 offen sc1
s_nop 7
buffer_load_dwordx4 v[40:43],v208,s[8:11],s63 offen offset:2048 sc1
s_nop 7
buffer_load_dwordx4 v[44:47],v209,s[8:11],s63 offen offset:2048 sc1
s_nop 7
s_add_u32 s63,s73,8192
buffer_load_dwordx4 v[48:51],v208,s[8:11],s63 offen sc1
s_nop 7
buffer_load_dwordx4 v[52:55],v209,s[8:11],s63 offen sc1
W4_NEXT:
s_mov_b32 s51,s33
s_mov_b32 s52,s34
s_mov_b32 s72,s73
s_add_u32 s32,s32,1
s_waitcnt vmcnt(9)
v_mfma_f32_32x32x16_bf16 v[112:127],a[0:3],v[16:19],0
s_add_u32 s63,s72,8192
buffer_load_dwordx4 v[56:59],v208,s[8:11],s63 offen offset:2048 sc1
s_min_u32 s62,s32,127
s_sub_u32 s60,s62,14
s_lshr_b32 s34,s60,1
v_mfma_f32_32x32x16_bf16 v[128:143],a[96:99],v[16:19],0
s_and_b32 s33,s60,1
s_cmp_eq_u32 s33,0
s_cselect_b32 s61,14,0
s_add_u32 s34,s34,s61
s_sub_u32 s61,s60,50
v_xor_b32 v206,0x8000,v206
s_waitcnt vmcnt(9)
v_mfma_f32_32x32x16_bf16 v[112:127],a[4:7],v[20:23],v[112:127]
buffer_load_dwordx4 v[60:63],v209,s[8:11],s63 offen offset:2048 sc1
s_cmp_ge_u32 s60,100
s_cselect_b32 s34,s61,s34
s_cselect_b32 s33,1,s33
v_xor_b32 v207,0x8000,v207
v_mfma_f32_32x32x16_bf16 v[128:143],a[100:103],v[20:23],v[128:143]
s_cmp_lt_u32 s62,14
s_cselect_b32 s34,s62,s34
s_cselect_b32 s33,0,s33
s_lshl_b32 s35,s33,6
s_add_u32 s35,s35,s34
s_lshl_b32 s35,s35,9
s_waitcnt vmcnt(9)
v_mfma_f32_32x32x16_bf16 v[112:127],a[8:11],v[24:27],v[112:127]
s_add_u32 s63,s72,12288
buffer_load_dwordx4 v[64:67],v208,s[8:11],s63 offen sc1
s_add_u32 s35,s35,589824
s_and_b32 s60,s34,3
s_lshl2_add_u32 s60,s33,s60
v_mfma_f32_32x32x16_bf16 v[128:143],a[104:107],v[24:27],v[128:143]
s_mul_i32 s73,s60,98304
s_add_u32 s73,s73,s71
buffer_load_dword v3,v2,s[8:11],s35 offen sc1
s_lshl_b32 s64,s51,6
s_add_u32 s64,s64,s52
s_waitcnt vmcnt(10)
v_mfma_f32_32x32x16_bf16 v[112:127],a[12:15],v[28:31],v[112:127]
buffer_load_dwordx4 v[68:71],v209,s[8:11],s63 offen sc1
s_and_b32 s65,s52,7
s_lshl3_add_u32 s65,s51,s65
s_lshl_b32 s82,s64,9
s_lshl2_add_u32 s82,s56,s82
v_mfma_f32_32x32x16_bf16 v[128:143],a[108:111],v[28:31],v[128:143]
s_add_u32 s82,s82,327680
s_mul_i32 s65,s65,46080
s_add_u32 s65,s65,s70
s_add_u32 s65,s65,212467712
buffer_load_dwordx4 v[176:179],v1,s[8:11],s65 offen sc1
s_waitcnt vmcnt(11)
v_mfma_f32_32x32x16_bf16 v[112:127],a[16:19],v[32:35],v[112:127]
buffer_load_dwordx4 v[72:75],v208,s[8:11],s63 offen offset:2048 sc1
s_mul_i32 s65,s64,40960
s_add_u32 s65,s65,s70
s_add_u32 s65,s65,218365952
v_mfma_f32_32x32x16_bf16 v[128:143],a[112:115],v[32:35],v[128:143]
s_waitcnt vmcnt(11)
v_mfma_f32_32x32x16_bf16 v[112:127],a[20:23],v[36:39],v[112:127]
buffer_load_dwordx4 v[76:79],v209,s[8:11],s63 offen offset:2048 sc1
v_mfma_f32_32x32x16_bf16 v[128:143],a[116:119],v[36:39],v[128:143]
s_waitcnt vmcnt(11)
v_mfma_f32_32x32x16_bf16 v[112:127],a[24:27],v[40:43],v[112:127]
s_add_u32 s63,s72,16384
buffer_load_dwordx4 v[80:83],v208,s[8:11],s63 offen sc1
v_mfma_f32_32x32x16_bf16 v[128:143],a[120:123],v[40:43],v[128:143]
s_waitcnt vmcnt(11)
v_mfma_f32_32x32x16_bf16 v[112:127],a[28:31],v[44:47],v[112:127]
buffer_load_dwordx4 v[84:87],v209,s[8:11],s63 offen sc1
v_mfma_f32_32x32x16_bf16 v[128:143],a[124:127],v[44:47],v[128:143]
s_waitcnt vmcnt(11)
v_mfma_f32_32x32x16_bf16 v[112:127],a[32:35],v[48:51],v[112:127]
buffer_load_dwordx4 v[88:91],v208,s[8:11],s63 offen offset:2048 sc1
v_mfma_f32_32x32x16_bf16 v[128:143],a[128:131],v[48:51],v[128:143]
s_waitcnt vmcnt(11)
v_mfma_f32_32x32x16_bf16 v[112:127],a[36:39],v[52:55],v[112:127]
buffer_load_dwordx4 v[92:95],v209,s[8:11],s63 offen offset:2048 sc1
v_mfma_f32_32x32x16_bf16 v[128:143],a[132:135],v[52:55],v[128:143]
s_waitcnt vmcnt(11)
v_mfma_f32_32x32x16_bf16 v[112:127],a[40:43],v[56:59],v[112:127]
s_add_u32 s63,s72,20480
buffer_load_dwordx4 v[96:99],v208,s[8:11],s63 offen sc1
v_mfma_f32_32x32x16_bf16 v[128:143],a[136:139],v[56:59],v[128:143]
s_waitcnt vmcnt(11)
v_mfma_f32_32x32x16_bf16 v[112:127],a[44:47],v[60:63],v[112:127]
buffer_load_dwordx4 v[100:103],v209,s[8:11],s63 offen sc1
v_mfma_f32_32x32x16_bf16 v[128:143],a[140:143],v[60:63],v[128:143]
s_waitcnt vmcnt(11)
v_mfma_f32_32x32x16_bf16 v[112:127],a[48:51],v[64:67],v[112:127]
buffer_load_dwordx4 v[104:107],v208,s[8:11],s63 offen offset:2048 sc1
v_mfma_f32_32x32x16_bf16 v[128:143],a[144:147],v[64:67],v[128:143]
s_waitcnt vmcnt(11)
v_cmp_eq_u32 vcc,0,v3
s_cmp_eq_u64 vcc,0
s_cselect_b32 s37,0,2147483648
s_cmp_lt_u32 s32,128
s_cselect_b32 s37,s37,2147483648
s_waitcnt vmcnt(10)
v_mfma_f32_32x32x16_bf16 v[112:127],a[52:55],v[68:71],v[112:127]
buffer_load_dwordx4 v[108:111],v209,s[8:11],s63 offen offset:2048 sc1
s_add_u32 s67,s73,s37
v_mfma_f32_32x32x16_bf16 v[128:143],a[148:151],v[68:71],v[128:143]
s_mov_b64 exec,1
buffer_store_dword v5,v1,s[8:11],s59 offen sc1
s_mov_b64 exec,-1
s_mov_b32 s59,2147483648
s_waitcnt vmcnt(10)
v_mfma_f32_32x32x16_bf16 v[112:127],a[56:59],v[72:75],v[112:127]
s_add_u32 s63,s67,0
buffer_load_dwordx4 v[16:19],v208,s[8:11],s63 offen sc1
buffer_load_dwordx4 v[180:183],v15,s[8:11],s65 offen sc1
v_mfma_f32_32x32x16_bf16 v[128:143],a[152:155],v[72:75],v[128:143]
s_waitcnt vmcnt(11)
v_mfma_f32_32x32x16_bf16 v[112:127],a[60:63],v[76:79],v[112:127]
buffer_load_dwordx4 v[20:23],v209,s[8:11],s63 offen sc1
v_mfma_f32_32x32x16_bf16 v[128:143],a[156:159],v[76:79],v[128:143]
s_waitcnt vmcnt(11)
v_mfma_f32_32x32x16_bf16 v[112:127],a[64:67],v[80:83],v[112:127]
buffer_load_dwordx4 v[24:27],v208,s[8:11],s63 offen offset:2048 sc1
v_mfma_f32_32x32x16_bf16 v[128:143],a[160:163],v[80:83],v[128:143]
s_waitcnt vmcnt(11)
v_mfma_f32_32x32x16_bf16 v[112:127],a[68:71],v[84:87],v[112:127]
buffer_load_dwordx4 v[28:31],v209,s[8:11],s63 offen offset:2048 sc1
v_mfma_f32_32x32x16_bf16 v[128:143],a[164:167],v[84:87],v[128:143]
s_waitcnt vmcnt(11)
v_mfma_f32_32x32x16_bf16 v[112:127],a[72:75],v[88:91],v[112:127]
s_add_u32 s63,s67,4096
buffer_load_dwordx4 v[32:35],v208,s[8:11],s63 offen sc1
buffer_load_dword v3,v2,s[8:11],s35 offen sc1
v_mfma_f32_32x32x16_bf16 v[128:143],a[168:171],v[88:91],v[128:143]
s_waitcnt vmcnt(12)
v_mfma_f32_32x32x16_bf16 v[112:127],a[76:79],v[92:95],v[112:127]
buffer_load_dwordx4 v[36:39],v209,s[8:11],s63 offen sc1
v_mfma_f32_32x32x16_bf16 v[128:143],a[172:175],v[92:95],v[128:143]
s_waitcnt vmcnt(12)
v_mfma_f32_32x32x16_bf16 v[112:127],a[80:83],v[96:99],v[112:127]
buffer_load_dwordx4 v[40:43],v208,s[8:11],s63 offen offset:2048 sc1
v_mfma_f32_32x32x16_bf16 v[128:143],a[176:179],v[96:99],v[128:143]
s_waitcnt vmcnt(12)
v_mfma_f32_32x32x16_bf16 v[112:127],a[84:87],v[100:103],v[112:127]
buffer_load_dwordx4 v[44:47],v209,s[8:11],s63 offen offset:2048 sc1
v_mfma_f32_32x32x16_bf16 v[128:143],a[180:183],v[100:103],v[128:143]
s_waitcnt vmcnt(12)
v_mfma_f32_32x32x16_bf16 v[112:127],a[88:91],v[104:107],v[112:127]
s_add_u32 s63,s67,8192
buffer_load_dwordx4 v[48:51],v208,s[8:11],s63 offen sc1
v_mfma_f32_32x32x16_bf16 v[128:143],a[184:187],v[104:107],v[128:143]
s_waitcnt vmcnt(12)
v_mfma_f32_32x32x16_bf16 v[112:127],a[92:95],v[108:111],v[112:127]
buffer_load_dwordx4 v[52:55],v209,s[8:11],s63 offen sc1
v_mfma_f32_32x32x16_bf16 v[128:143],a[188:191],v[108:111],v[128:143]
s_cmp_eq_u32 s37,0
s_cbranch_scc1 ep_373
s_waitcnt vmcnt(0)
v_cmp_eq_u32 vcc,0,v3
s_cmp_eq_u64 vcc,0
s_cselect_b32 s37,0,2147483648
s_cmp_lt_u32 s32,128
s_cselect_b32 s37,s37,2147483648
s_cmp_lg_u32 s37,0
s_cbranch_scc1 ep_373
s_add_u32 s63,s73,0
buffer_load_dwordx4 v[16:19],v208,s[8:11],s63 offen sc1
buffer_load_dwordx4 v[20:23],v209,s[8:11],s63 offen sc1
buffer_load_dwordx4 v[24:27],v208,s[8:11],s63 offen offset:2048 sc1
buffer_load_dwordx4 v[28:31],v209,s[8:11],s63 offen offset:2048 sc1
s_add_u32 s63,s73,4096
buffer_load_dwordx4 v[32:35],v208,s[8:11],s63 offen sc1
buffer_load_dwordx4 v[36:39],v209,s[8:11],s63 offen sc1
buffer_load_dwordx4 v[40:43],v208,s[8:11],s63 offen offset:2048 sc1
buffer_load_dwordx4 v[44:47],v209,s[8:11],s63 offen offset:2048 sc1
s_add_u32 s63,s73,8192
buffer_load_dwordx4 v[48:51],v208,s[8:11],s63 offen sc1
buffer_load_dwordx4 v[52:55],v209,s[8:11],s63 offen sc1
ep_373:
s_nop 7
ds_write_b128 v206,v[112:115] offset:0
ds_write_b128 v206,v[116:119] offset:1024
ds_write_b128 v206,v[120:123] offset:512
ds_write_b128 v206,v[124:127] offset:1536
s_nop 0
ds_write_b128 v206,v[128:131] offset:8192
ds_write_b128 v206,v[132:135] offset:9216
ds_write_b128 v206,v[136:139] offset:8704
ds_write_b128 v206,v[140:143] offset:9728
s_waitcnt vmcnt(10)
s_mov_b64 exec,1
s_cmp_lg_u32 s49,0
s_cbranch_scc0 ls_374
buffer_store_dword v5,v1,s[8:11],s82 offen sc1
s_branch ls_375
ls_374:
buffer_store_dword v5,v1,s[8:11],s82 offen
ls_375:
s_mov_b64 exec,-1
v_lshlrev_b32 v184,16,v176
v_and_b32 v185,0xffff0000,v176
v_lshlrev_b32 v186,16,v177
v_and_b32 v187,0xffff0000,v177
v_lshlrev_b32 v188,16,v178
v_and_b32 v189,0xffff0000,v178
v_lshlrev_b32 v190,16,v179
v_and_b32 v191,0xffff0000,v179
v_lshlrev_b32 v192,16,v180
v_and_b32 v193,0xffff0000,v180
v_lshlrev_b32 v194,16,v181
v_and_b32 v195,0xffff0000,v181
v_lshlrev_b32 v196,16,v182
v_and_b32 v197,0xffff0000,v182
v_lshlrev_b32 v198,16,v183
v_and_b32 v199,0xffff0000,v183
s_waitcnt lgkmcnt(0)
s_barrier
ds_read_b128 v[144:147],v207 offset:0
ds_read_b128 v[148:151],v207 offset:1024
ds_read_b128 v[152:155],v207 offset:2048
ds_read_b128 v[156:159],v207 offset:3072
ds_read_b128 v[160:163],v207 offset:4096
ds_read_b128 v[164:167],v207 offset:5120
ds_read_b128 v[168:171],v207 offset:6144
ds_read_b128 v[172:175],v207 offset:7168
s_waitcnt lgkmcnt(4)
v_pk_add_f32 v[144:145],v[144:145],v[152:153]
v_pk_add_f32 v[146:147],v[146:147],v[154:155]
v_pk_add_f32 v[148:149],v[148:149],v[156:157]
v_pk_add_f32 v[150:151],v[150:151],v[158:159]
s_waitcnt lgkmcnt(0)
v_pk_add_f32 v[160:161],v[160:161],v[168:169]
v_pk_add_f32 v[162:163],v[162:163],v[170:171]
v_pk_add_f32 v[164:165],v[164:165],v[172:173]
v_pk_add_f32 v[166:167],v[166:167],v[174:175]
v_pk_add_f32 v[144:145],v[144:145],v[160:161]
v_pk_add_f32 v[146:147],v[146:147],v[162:163]
v_pk_add_f32 v[148:149],v[148:149],v[164:165]
v_pk_add_f32 v[150:151],v[150:151],v[166:167]
v_cvt_pk_bf16_f32 v6,v144,v145
v_lshlrev_b32 v144,16,v6
v_and_b32 v145,0xffff0000,v6
v_cvt_pk_bf16_f32 v6,v146,v147
v_lshlrev_b32 v146,16,v6
v_and_b32 v147,0xffff0000,v6
v_cvt_pk_bf16_f32 v6,v148,v149
v_lshlrev_b32 v148,16,v6
v_and_b32 v149,0xffff0000,v6
v_cvt_pk_bf16_f32 v6,v150,v151
v_lshlrev_b32 v150,16,v6
v_and_b32 v151,0xffff0000,v6
v_pk_add_f32 v[144:145],v[144:145],v[184:185]
v_pk_add_f32 v[146:147],v[146:147],v[186:187]
v_pk_add_f32 v[148:149],v[148:149],v[188:189]
v_pk_add_f32 v[150:151],v[150:151],v[190:191]
v_cvt_pk_bf16_f32 v6,v144,v145
v_lshlrev_b32 v144,16,v6
v_and_b32 v145,0xffff0000,v6
v_cvt_pk_bf16_f32 v6,v146,v147
v_lshlrev_b32 v146,16,v6
v_and_b32 v147,0xffff0000,v6
v_cvt_pk_bf16_f32 v6,v148,v149
v_lshlrev_b32 v148,16,v6
v_and_b32 v149,0xffff0000,v6
v_cvt_pk_bf16_f32 v6,v150,v151
v_lshlrev_b32 v150,16,v6
v_and_b32 v151,0xffff0000,v6
v_pk_add_f32 v[144:145],v[144:145],v[192:193]
v_pk_add_f32 v[146:147],v[146:147],v[194:195]
v_pk_add_f32 v[148:149],v[148:149],v[196:197]
v_pk_add_f32 v[150:151],v[150:151],v[198:199]
v_cvt_pk_bf16_f32 v200,v144,v145
v_lshlrev_b32 v144,16,v200
v_and_b32 v145,0xffff0000,v200
v_cvt_pk_bf16_f32 v201,v146,v147
v_lshlrev_b32 v146,16,v201
v_and_b32 v147,0xffff0000,v201
v_cvt_pk_bf16_f32 v202,v148,v149
v_lshlrev_b32 v148,16,v202
v_and_b32 v149,0xffff0000,v202
v_cvt_pk_bf16_f32 v203,v150,v151
v_lshlrev_b32 v150,16,v203
v_and_b32 v151,0xffff0000,v203
s_cmp_lg_u32 s51,0
s_cbranch_scc1 w4o_376
s_mul_i32 s62,s52,46080
s_add_u32 s62,s62,209518592
s_add_u32 s63,s62,s70
buffer_store_dwordx4 v[200:203],v15,s[8:11],s63 offen sc1
v_add_f32 v6,v144,v145
v_mul_f32 v7,v144,v144
v_fmac_f32 v7,v145,v145
v_add_f32 v6,v6,v146
v_fmac_f32 v7,v146,v146
v_add_f32 v6,v6,v147
v_fmac_f32 v7,v147,v147
v_add_f32 v6,v6,v148
v_fmac_f32 v7,v148,v148
v_add_f32 v6,v6,v149
v_fmac_f32 v7,v149,v149
v_add_f32 v6,v6,v150
v_fmac_f32 v7,v150,v150
v_add_f32 v6,v6,v151
v_fmac_f32 v7,v151,v151
v_mov_b32 v8,v6
v_mov_b32 v9,v7
s_nop 0
v_permlane32_swap_b32 v6,v8
v_permlane32_swap_b32 v7,v9
v_add_f32 v6,v6,v8
v_add_f32 v7,v7,v9
v_mov_b32 v8,v6
v_mov_b32 v9,v7
s_nop 0
v_permlane16_swap_b32 v6,v8
v_permlane16_swap_b32 v7,v9
v_add_f32 v6,v6,v8
v_add_f32 v7,v7,v9
s_lshl_b32 s63,s68,8
s_lshl_b32 s60,s69,7
s_add_u32 s63,s63,s60
s_add_u32 s63,s63,s62
s_add_u32 s63,s63,40960
s_mov_b64 exec,0xffff
buffer_store_dwordx2 v[6:7],v204,s[8:11],s63 offen sc1
s_mov_b64 exec,-1
s_mov_b32 s66,1
s_lshl_b32 s59,s66,6
s_add_u32 s59,s59,s52
s_lshl_b32 s59,s59,9
s_add_u32 s59,s59,0
s_lshl_b32 s61,s56,2
s_add_u32 s59,s59,s61
s_branch w4n_377
w4o_376:
s_mul_i32 s62,s52,40960
buffer_store_dwordx2 v[200:201],v205,s[76:79],s62 offen
buffer_store_dwordx2 v[202:203],v205,s[76:79],s62 offen offset:32
w4n_377:
s_cmp_eq_u32 s37,0
s_cbranch_scc1 W4_NEXT
s_waitcnt vmcnt(0)
s_mov_b64 exec,1
buffer_store_dword v5,v1,s[8:11],s59 offen sc1
s_mov_b64 exec,-1
s_mov_b32 s59,2147483648
s_cmp_lt_u32 s32,128
s_cbranch_scc1 W4_COLD
s_endpgm
.section .rodata,"a"
.p2align 6
.amdhsa_kernel interleave_layers__memory_aug_recurrent_mem_tr__mixer_s_mlp__prompt_kernel
  .amdhsa_next_free_vgpr 512
  .amdhsa_next_free_sgpr 102
  .amdhsa_accum_offset 256
  .amdhsa_group_segment_fixed_size 0
  .amdhsa_kernarg_size 120
  .amdhsa_user_sgpr_count 2
  .amdhsa_user_sgpr_kernarg_segment_ptr 1
  .amdhsa_system_sgpr_workgroup_id_x 1
.end_amdhsa_kernel
```

```asm
; @launch grid=(256,1,1) block=(256,1,1) lds=163840
.amdgcn_target "amdgcn-amd-amdhsa--gfx950"
.text
.globl interleave_layers__memory_aug_recurrent_mem_tr__mixer_s_mlp__prompt_kernel
.p2align 8
.type interleave_layers__memory_aug_recurrent_mem_tr__mixer_s_mlp__prompt_kernel,@function
interleave_layers__memory_aug_recurrent_mem_tr__mixer_s_mlp__prompt_kernel:
s_cmp_ge_u32 s2,256
s_cbranch_scc1 EXIT
s_load_dwordx16 s[16:31],s[0:1],0
s_load_dwordx8 s[32:39],s[0:1],64
s_load_dwordx4 s[40:43],s[0:1],96
s_load_dwordx2 s[44:45],s[0:1],112
v_lshrrev_b32 v1,6,v0
v_and_b32 v0,63,v0
v_readfirstlane_b32 s46,v1
s_mov_b32 s47,200000
s_mov_b32 s49,0
s_getreg_b32 s4,hwreg(HW_REG_XCC_ID)
s_and_b32 s4,s4,7
s_waitcnt lgkmcnt(0)
s_mov_b32 s8,s44
s_mov_b32 s9,s45
s_mov_b32 s10,268435456
s_mov_b32 s11,0x20000
s_mov_b32 s12,s42
s_mov_b32 s13,s43
s_mov_b32 s14,256
s_mov_b32 s15,0x20000
v_lshlrev_b32 v1,4,v0
v_mov_b32 v4,0
v_mov_b32 v5,0
v_mov_b32 v6,0
v_mov_b32 v7,0
s_lshl_b32 s5,s2,2
s_add_u32 s5,s5,s46
s_lshl_b32 s5,s5,10
buffer_store_dwordx4 v[4:7],v1,s[8:11],s5 offen sc1
s_cmp_ge_u32 s4,4
s_cbranch_scc1 VOTE_DONE
s_cmp_lg_u32 s46,1
s_cbranch_scc1 VOTE_DONE
s_and_b32 s52,s2,24
s_cbranch_scc1 VOTE_DONE
s_mov_b64 exec,1
v_mov_b32 v12,0
s_and_b32 s53,s2,63
s_lshl_b32 s53,s53,7
s_lshr_b32 s52,s2,6
s_mul_i32 s52,s52,3
s_add_u32 s52,s52,s46
s_lshl_b32 s52,s52,14
s_add_u32 s53,s53,s52
s_add_u32 s53,s53,11796480
s_add_u32 s59,s53,0x2000
buffer_store_dword v12,v12,s[8:11],s53 offen sc1
buffer_store_dword v12,v12,s[8:11],s59 offen sc1
s_waitcnt vmcnt(0)
s_memtime s[54:55]
s_waitcnt lgkmcnt(0)
buffer_load_dword v13,v12,s[8:11],s53 offen sc1
s_waitcnt vmcnt(0)
s_memtime s[56:57]
s_waitcnt lgkmcnt(0)
s_sub_u32 s50,s56,s54
s_memtime s[54:55]
s_waitcnt lgkmcnt(0)
buffer_load_dword v13,v12,s[8:11],s59 offen sc1
s_waitcnt vmcnt(0)
s_memtime s[56:57]
s_waitcnt lgkmcnt(0)
s_sub_u32 s51,s56,s54
s_cmp_lt_u32 s51,s50
s_cselect_b32 s52,1,-1
v_mov_b32 v13,s52
v_mov_b32 v12,192
buffer_atomic_add v13,v12,s[12:15],0 offen sc1
s_mov_b64 exec,-1
VOTE_DONE:
v_mov_b32 v2,0
s_cmp_lg_u32 s46,0
s_cbranch_scc1 TK_DONE
s_mov_b64 exec,1
v_mov_b32 v1,1
s_lshl_b32 s5,s4,2
v_mov_b32 v3,s5
buffer_atomic_add v1,v3,s[12:15],0 offen offset:32 sc0 sc1
s_waitcnt vmcnt(0)
v_readfirstlane_b32 s5,v1
s_lshl_b32 s6,s4,5
s_add_u32 s6,s6,s5
s_cmp_lt_u32 s5,32
s_cselect_b32 s6,s6,999
v_mov_b32 v1,s6
ds_write_b32 v2,v1
s_mov_b64 exec,-1
s_waitcnt lgkmcnt(0)
TK_DONE:
s_barrier
ds_read_b32 v1,v2
s_waitcnt lgkmcnt(0)
v_readfirstlane_b32 s3,v1
s_barrier
s_nop 2
s_branch DISPATCH
ROLE_CS:
s_lshr_b32 s28,s48,4
s_and_b32 s29,s48,15
s_mul_i32 s82,s28,2097152
s_add_u32 s82,s82,2097152
v_lshlrev_b32 v1,4,v0
v_and_b32 v12,1,v0
v_mul_u32_u24 v2,0xaaaa,v12
v_or_b32 v2,0x4444,v2
s_add_u32 s60,s46,1
s_and_b32 s60,s60,3
s_lshl_b32 s60,s60,11
s_add_u32 s60,s60,131072
v_add_u32 v3,s60,v1
s_add_u32 s60,s46,2
s_and_b32 s60,s60,3
s_lshl_b32 s60,s60,11
s_add_u32 s60,s60,131072
v_add_u32 v4,s60,v1
s_add_u32 s60,s46,3
s_and_b32 s60,s60,3
s_lshl_b32 s60,s60,11
s_add_u32 s60,s60,131072
v_add_u32 v5,s60,v1
v_add_u32 v59,139264,v1
s_lshl_b32 s60,s46,11
s_add_u32 s60,s60,131072
v_add_u32 v22,s60,v1
s_lshr_b32 s60,s46,1
s_lshl_b32 s60,s60,10
s_and_b32 s61,s46,1
s_lshl_b32 s61,s61,3
s_add_u32 s60,s60,s61
v_add_u32 v23,s60,v59
s_mul_i32 s60,s46,20480
v_add_u32 v21,s60,v1
v_and_b32 v11,7,v0
v_lshlrev_b32 v11,2,v11
v_bfe_u32 v12,v0,3,2
v_lshl_add_u32 v11,v12,7,v11
s_xor_b32 s60,s28,1
s_lshl_b32 s60,s60,19
s_lshl_b32 s61,s46,11
s_add_u32 s83,s60,s61
s_add_u32 s83,s83,10485760
s_mov_b32 s36,0
s_mov_b32 s88,0xcccccccc
s_mov_b32 s89,0xcccccccc
s_mov_b32 s90,0x33333333
s_mov_b32 s91,0x33333333
s_mov_b32 s87,0x3dd53b95
v_lshrrev_b32 v14,4,v0
v_and_b32 v15,15,v0
v_lshrrev_b32 v12,2,v15
v_add_u32 v12,v12,v14
v_and_b32 v12,3,v12
v_lshlrev_b32 v6,3,v12
v_lshl_add_u32 v6,v15,5,v6
s_mul_i32 s60,s46,1536
s_add_u32 s60,s60,141312
v_add_u32 v6,s60,v6
v_add_u32 v12,v0,v14
v_and_b32 v12,3,v12
v_lshlrev_b32 v7,3,v12
v_lshrrev_b32 v12,2,v0
v_lshl_add_u32 v7,v12,5,v7
v_add_u32 v7,141312,v7
s_min_u32 s62,s46,2
v_lshrrev_b32 v12,2,v15
v_and_b32 v13,1,v15
v_lshl_add_u32 v12,v12,1,v13
v_bfe_u32 v13,v15,1,1
v_lshlrev_b32 v8,8,v14
v_lshl_add_u32 v8,v12,5,v8
v_xor_b32 v16,1,v13
v_lshl_add_u32 v8,v16,4,v8
v_lshlrev_b32 v20,8,v14
v_lshl_add_u32 v20,v13,7,v20
v_and_b32 v16,3,v12
v_lshl_add_u32 v20,v16,5,v20
v_lshrrev_b32 v16,2,v12
v_lshl_add_u32 v20,v16,4,v20
v_min_u32 v12,5,v0
s_mul_i32 s60,s48,3
v_add_u32 v9,s60,v12
v_lshlrev_b32 v9,2,v9
v_add_u32 v13,65524,v9
v_cmp_lt_u32 vcc,2,v12
s_nop 1
v_cndmask_b32 v9,v9,v13,vcc
s_mul_i32 s84,s48,12288
s_add_u32 s84,s84,74448896
s_mul_i32 s60,s29,3072
s_lshl_b32 s61,s62,10
s_add_u32 s60,s60,s61
s_add_u32 s60,s60,s82
s_add_u32 s33,s60,163840
s_add_u32 s34,s60,557056
s_mul_i32 s85,s48,6144
s_add_u32 s85,s85,24117248
s_lshl_b32 s86,s48,5
s_lshl_b32 s61,s62,2
s_add_u32 s86,s86,688128
s_lshr_b32 s60,s29,2
s_lshl_b32 s60,s60,7
s_and_b32 s63,s29,3
s_mul_i32 s63,s63,12
s_add_u32 s60,s60,s63
s_add_u32 s60,s60,s61
s_add_u32 s60,s60,s82
s_add_u32 s35,s60,951296
s_cmp_eq_u32 s46,3
s_cbranch_scc1 si_1
v_mov_b32 v12,-1
v_mov_b32 v13,0
s_cmp_lg_u32 s49,0
s_cbranch_scc1 ls_2
s_add_u32 s60,s33,0
buffer_store_dword v12,v1,s[8:11],s60 offen
s_add_u32 s60,s33,49152
buffer_store_dword v12,v1,s[8:11],s60 offen
s_add_u32 s60,s33,98304
buffer_store_dword v12,v1,s[8:11],s60 offen
s_add_u32 s60,s33,147456
buffer_store_dword v12,v1,s[8:11],s60 offen
s_add_u32 s60,s33,196608
buffer_store_dword v12,v1,s[8:11],s60 offen
s_add_u32 s60,s33,245760
buffer_store_dword v12,v1,s[8:11],s60 offen
s_add_u32 s60,s33,294912
buffer_store_dword v12,v1,s[8:11],s60 offen
s_add_u32 s60,s33,344064
buffer_store_dword v12,v1,s[8:11],s60 offen
s_mov_b64 exec,1
buffer_store_dword v13,v1,s[8:11],s35 offen
buffer_store_dword v13,v1,s[8:11],s35 offen offset:512
s_mov_b64 exec,-1
s_branch ls_3
ls_2:
s_add_u32 s60,s33,0
buffer_store_dword v12,v1,s[8:11],s60 offen sc1
s_add_u32 s60,s33,49152
buffer_store_dword v12,v1,s[8:11],s60 offen sc1
s_add_u32 s60,s33,98304
buffer_store_dword v12,v1,s[8:11],s60 offen sc1
s_add_u32 s60,s33,147456
buffer_store_dword v12,v1,s[8:11],s60 offen sc1
s_add_u32 s60,s33,196608
buffer_store_dword v12,v1,s[8:11],s60 offen sc1
s_add_u32 s60,s33,245760
buffer_store_dword v12,v1,s[8:11],s60 offen sc1
s_add_u32 s60,s33,294912
buffer_store_dword v12,v1,s[8:11],s60 offen sc1
s_add_u32 s60,s33,344064
buffer_store_dword v12,v1,s[8:11],s60 offen sc1
s_mov_b64 exec,1
buffer_store_dword v13,v1,s[8:11],s35 offen sc1
buffer_store_dword v13,v1,s[8:11],s35 offen offset:512 sc1
s_mov_b64 exec,-1
ls_3:
si_1:
s_mul_i32 s73,s48,384
s_mov_b32 s74,s73
v_add_u32 v12,0,v0
v_mul_u32_u24 v13,2731,v12
v_lshrrev_b32 v13,16,v13
v_mul_u32_u24 v16,24,v13
v_sub_u32 v12,v12,v16
v_mul_u32_u24 v104,12288,v13
v_lshl_add_u32 v104,v12,4,v104
v_add_u32 v12,64,v0
v_mul_u32_u24 v13,2731,v12
v_lshrrev_b32 v13,16,v13
v_mul_u32_u24 v16,24,v13
v_sub_u32 v12,v12,v16
v_mul_u32_u24 v105,12288,v13
v_lshl_add_u32 v105,v12,4,v105
v_add_u32 v12,128,v0
v_mul_u32_u24 v13,2731,v12
v_lshrrev_b32 v13,16,v13
v_mul_u32_u24 v16,24,v13
v_sub_u32 v12,v12,v16
v_mul_u32_u24 v106,12288,v13
v_lshl_add_u32 v106,v12,4,v106
s_mov_b32 s4,s20
s_mov_b32 s5,s21
s_mov_b32 s6,7864320
s_mov_b32 s7,0x20000
s_mov_b32 s52,s22
s_mov_b32 s53,s23
s_mov_b32 s54,7864320
s_mov_b32 s55,0x20000
s_branch SV_LOAD
ROLE_CV:
s_lshr_b32 s28,s48,3
s_and_b32 s29,s48,7
s_mul_i32 s82,s28,2097152
s_add_u32 s82,s82,2097152
v_lshlrev_b32 v1,4,v0
v_and_b32 v12,1,v0
v_mul_u32_u24 v2,0xaaaa,v12
v_or_b32 v2,0x4444,v2
s_add_u32 s60,s46,1
s_and_b32 s60,s60,3
s_lshl_b32 s60,s60,11
s_add_u32 s60,s60,131072
v_add_u32 v3,s60,v1
s_add_u32 s60,s46,2
s_and_b32 s60,s60,3
s_lshl_b32 s60,s60,11
s_add_u32 s60,s60,131072
v_add_u32 v4,s60,v1
s_add_u32 s60,s46,3
s_and_b32 s60,s60,3
s_lshl_b32 s60,s60,11
s_add_u32 s60,s60,131072
v_add_u32 v5,s60,v1
v_add_u32 v59,139264,v1
s_lshl_b32 s60,s46,11
s_add_u32 s60,s60,131072
v_add_u32 v22,s60,v1
s_lshr_b32 s60,s46,1
s_lshl_b32 s60,s60,10
s_and_b32 s61,s46,1
s_lshl_b32 s61,s61,3
s_add_u32 s60,s60,s61
v_add_u32 v23,s60,v59
s_mul_i32 s60,s46,20480
v_add_u32 v21,s60,v1
v_and_b32 v11,7,v0
v_lshlrev_b32 v11,2,v11
v_bfe_u32 v12,v0,3,2
v_lshl_add_u32 v11,v12,7,v11
s_xor_b32 s60,s28,1
s_lshl_b32 s60,s60,19
s_lshl_b32 s61,s46,11
s_add_u32 s83,s60,s61
s_add_u32 s83,s83,10485760
s_mov_b32 s36,1
v_mov_b32 v8,0
v_mov_b32 v9,0
v_mov_b32 v20,0
s_and_b32 s62,s46,1
s_lshl_b32 s60,s62,11
v_add_u32 v6,s60,v1
s_lshl_b32 s60,s62,3
s_add_u32 s60,s60,1024
v_add_u32 v7,s60,v1
s_lshr_b32 s61,s46,1
s_lshl_b32 s60,s29,1
s_add_u32 s60,s60,s61
s_mul_i32 s60,s60,3072
s_add_u32 s60,s60,s82
s_add_u32 s34,s60,557056
s_lshl_b32 s60,s48,1
s_add_u32 s60,s60,s61
s_mul_i32 s85,s60,6144
s_add_u32 s85,s85,24120320
s_lshl_b32 s86,s60,5
s_lshl_b32 s61,s62,2
s_add_u32 s86,s86,s61
s_add_u32 s86,s86,688132
v_mov_b32 v12,-1
v_mov_b32 v13,-1
v_mov_b32 v14,-1
v_mov_b32 v15,-1
s_cmp_lg_u32 s49,0
s_cbranch_scc1 ls_4
s_add_u32 s60,s34,0
buffer_store_dwordx4 v[12:15],v6,s[8:11],s60 offen
buffer_store_dwordx2 v[12:13],v7,s[8:11],s60 offen
s_add_u32 s60,s34,49152
buffer_store_dwordx4 v[12:15],v6,s[8:11],s60 offen
buffer_store_dwordx2 v[12:13],v7,s[8:11],s60 offen
s_add_u32 s60,s34,98304
buffer_store_dwordx4 v[12:15],v6,s[8:11],s60 offen
buffer_store_dwordx2 v[12:13],v7,s[8:11],s60 offen
s_add_u32 s60,s34,147456
buffer_store_dwordx4 v[12:15],v6,s[8:11],s60 offen
buffer_store_dwordx2 v[12:13],v7,s[8:11],s60 offen
s_add_u32 s60,s34,196608
buffer_store_dwordx4 v[12:15],v6,s[8:11],s60 offen
buffer_store_dwordx2 v[12:13],v7,s[8:11],s60 offen
s_add_u32 s60,s34,245760
buffer_store_dwordx4 v[12:15],v6,s[8:11],s60 offen
buffer_store_dwordx2 v[12:13],v7,s[8:11],s60 offen
s_add_u32 s60,s34,294912
buffer_store_dwordx4 v[12:15],v6,s[8:11],s60 offen
buffer_store_dwordx2 v[12:13],v7,s[8:11],s60 offen
s_add_u32 s60,s34,344064
buffer_store_dwordx4 v[12:15],v6,s[8:11],s60 offen
buffer_store_dwordx2 v[12:13],v7,s[8:11],s60 offen
s_branch ls_5
ls_4:
s_add_u32 s60,s34,0
buffer_store_dwordx4 v[12:15],v6,s[8:11],s60 offen sc1
buffer_store_dwordx2 v[12:13],v7,s[8:11],s60 offen sc1
s_add_u32 s60,s34,49152
buffer_store_dwordx4 v[12:15],v6,s[8:11],s60 offen sc1
buffer_store_dwordx2 v[12:13],v7,s[8:11],s60 offen sc1
s_add_u32 s60,s34,98304
buffer_store_dwordx4 v[12:15],v6,s[8:11],s60 offen sc1
buffer_store_dwordx2 v[12:13],v7,s[8:11],s60 offen sc1
s_add_u32 s60,s34,147456
buffer_store_dwordx4 v[12:15],v6,s[8:11],s60 offen sc1
buffer_store_dwordx2 v[12:13],v7,s[8:11],s60 offen sc1
s_add_u32 s60,s34,196608
buffer_store_dwordx4 v[12:15],v6,s[8:11],s60 offen sc1
buffer_store_dwordx2 v[12:13],v7,s[8:11],s60 offen sc1
s_add_u32 s60,s34,245760
buffer_store_dwordx4 v[12:15],v6,s[8:11],s60 offen sc1
buffer_store_dwordx2 v[12:13],v7,s[8:11],s60 offen sc1
s_add_u32 s60,s34,294912
buffer_store_dwordx4 v[12:15],v6,s[8:11],s60 offen sc1
buffer_store_dwordx2 v[12:13],v7,s[8:11],s60 offen sc1
s_add_u32 s60,s34,344064
buffer_store_dwordx4 v[12:15],v6,s[8:11],s60 offen sc1
buffer_store_dwordx2 v[12:13],v7,s[8:11],s60 offen sc1
s_nop 0
ls_5:
s_mul_i32 s73,s48,768
s_add_u32 s74,s73,96
v_add_u32 v12,0,v0
v_mul_u32_u24 v13,2731,v12
v_lshrrev_b32 v13,16,v13
v_mul_u32_u24 v16,24,v13
v_sub_u32 v12,v12,v16
v_mul_u32_u24 v104,12288,v13
v_lshl_add_u32 v104,v12,4,v104
v_mul_u32_u24 v13,43,v12
v_lshrrev_b32 v13,8,v13
v_mul_u32_u24 v13,96,v13
v_add_u32 v104,v104,v13
v_add_u32 v12,64,v0
v_mul_u32_u24 v13,2731,v12
v_lshrrev_b32 v13,16,v13
v_mul_u32_u24 v16,24,v13
v_sub_u32 v12,v12,v16
v_mul_u32_u24 v105,12288,v13
v_lshl_add_u32 v105,v12,4,v105
v_mul_u32_u24 v13,43,v12
v_lshrrev_b32 v13,8,v13
v_mul_u32_u24 v13,96,v13
v_add_u32 v105,v105,v13
v_add_u32 v12,128,v0
v_mul_u32_u24 v13,2731,v12
v_lshrrev_b32 v13,16,v13
v_mul_u32_u24 v16,24,v13
v_sub_u32 v12,v12,v16
v_mul_u32_u24 v106,12288,v13
v_lshl_add_u32 v106,v12,4,v106
v_mul_u32_u24 v13,43,v12
v_lshrrev_b32 v13,8,v13
v_mul_u32_u24 v13,96,v13
v_add_u32 v106,v106,v13
s_mov_b32 s4,s24
s_mov_b32 s5,s25
s_mov_b32 s6,7864320
s_mov_b32 s7,0x20000
s_mov_b32 s52,s24
s_mov_b32 s53,s25
s_mov_b32 s54,7864320
s_mov_b32 s55,0x20000
SV_LOAD:
s_waitcnt vmcnt(0)
s_barrier
s_cmp_lg_u32 s46,0
s_cbranch_scc1 arr_6
v_mov_b32 v12,1
s_lshl_b32 s3,s49,2
v_mov_b32 v13,s3
s_mov_b64 exec,1
buffer_atomic_add v12,v13,s[12:15],0 offen sc1
s_mov_b64 exec,-1
arr_6:
s_and_b32 s60,s46,1
s_mul_i32 s60,s60,196608
s_lshr_b32 s61,s46,1
s_mul_i32 s75,s61,393216
s_add_u32 s75,s75,s60
s_mul_i32 s76,s61,393216
s_add_u32 s76,s76,s60
s_mul_i32 s77,s46,6144
v_lshrrev_b32 v14,4,v0
v_and_b32 v15,15,v0
v_and_b32 v12,1,v14
v_lshlrev_b32 v12,2,v12
v_lshrrev_b32 v13,1,v14
v_lshl_add_u32 v12,v13,4,v12
v_bfe_u32 v13,v0,2,1
v_add_u32 v12,v12,v13
v_bfe_u32 v13,v0,3,1
v_lshl_add_u32 v12,v13,3,v12
v_mul_u32_u24 v107,384,v12
v_and_b32 v13,3,v0
v_lshl_add_u32 v107,v13,3,v107
s_mul_i32 s60,s46,96
v_add_u32 v107,s60,v107
s_add_u32 s60,s75,s73
s_add_u32 m0,s77,0
s_add_u32 s61,s60,0
buffer_load_dwordx4 v104,s[4:7],s61 offen lds
s_add_u32 m0,s77,1024
s_add_u32 s61,s60,0
buffer_load_dwordx4 v105,s[4:7],s61 offen lds
s_add_u32 m0,s77,2048
s_add_u32 s61,s60,0
buffer_load_dwordx4 v106,s[4:7],s61 offen lds
s_add_u32 m0,s77,3072
s_add_u32 s61,s60,98304
buffer_load_dwordx4 v104,s[4:7],s61 offen lds
s_add_u32 m0,s77,4096
s_add_u32 s61,s60,98304
buffer_load_dwordx4 v105,s[4:7],s61 offen lds
s_add_u32 m0,s77,5120
s_add_u32 s61,s60,98304
buffer_load_dwordx4 v106,s[4:7],s61 offen lds
s_add_u32 s60,s75,s74
s_add_u32 m0,s77,24576
s_add_u32 s61,s60,0
buffer_load_dwordx4 v104,s[52:55],s61 offen lds
s_add_u32 m0,s77,25600
s_add_u32 s61,s60,0
buffer_load_dwordx4 v105,s[52:55],s61 offen lds
s_add_u32 m0,s77,26624
s_add_u32 s61,s60,0
buffer_load_dwordx4 v106,s[52:55],s61 offen lds
s_add_u32 m0,s77,27648
s_add_u32 s61,s60,98304
buffer_load_dwordx4 v104,s[52:55],s61 offen lds
s_add_u32 m0,s77,28672
s_add_u32 s61,s60,98304
buffer_load_dwordx4 v105,s[52:55],s61 offen lds
s_add_u32 m0,s77,29696
s_add_u32 s61,s60,98304
buffer_load_dwordx4 v106,s[52:55],s61 offen lds
s_add_u32 s60,s75,s73
s_add_u32 m0,s77,49152
s_add_u32 s61,s60,786432
buffer_load_dwordx4 v104,s[4:7],s61 offen lds
s_add_u32 m0,s77,50176
s_add_u32 s61,s60,786432
buffer_load_dwordx4 v105,s[4:7],s61 offen lds
s_add_u32 m0,s77,51200
s_add_u32 s61,s60,786432
buffer_load_dwordx4 v106,s[4:7],s61 offen lds
s_add_u32 m0,s77,52224
s_add_u32 s61,s60,884736
buffer_load_dwordx4 v104,s[4:7],s61 offen lds
s_add_u32 m0,s77,53248
s_add_u32 s61,s60,884736
buffer_load_dwordx4 v105,s[4:7],s61 offen lds
s_add_u32 m0,s77,54272
s_add_u32 s61,s60,884736
buffer_load_dwordx4 v106,s[4:7],s61 offen lds
s_add_u32 s60,s75,s74
s_add_u32 m0,s77,73728
s_add_u32 s61,s60,786432
buffer_load_dwordx4 v104,s[52:55],s61 offen lds
s_add_u32 m0,s77,74752
s_add_u32 s61,s60,786432
buffer_load_dwordx4 v105,s[52:55],s61 offen lds
s_add_u32 m0,s77,75776
s_add_u32 s61,s60,786432
buffer_load_dwordx4 v106,s[52:55],s61 offen lds
s_add_u32 m0,s77,76800
s_add_u32 s61,s60,884736
buffer_load_dwordx4 v104,s[52:55],s61 offen lds
s_add_u32 m0,s77,77824
s_add_u32 s61,s60,884736
buffer_load_dwordx4 v105,s[52:55],s61 offen lds
s_add_u32 m0,s77,78848
s_add_u32 s61,s60,884736
buffer_load_dwordx4 v106,s[52:55],s61 offen lds
s_add_u32 s60,s75,s73
s_add_u32 m0,s77,98304
s_add_u32 s61,s60,1572864
buffer_load_dwordx4 v104,s[4:7],s61 offen lds
s_add_u32 m0,s77,99328
s_add_u32 s61,s60,1572864
buffer_load_dwordx4 v105,s[4:7],s61 offen lds
s_add_u32 m0,s77,100352
s_add_u32 s61,s60,1572864
buffer_load_dwordx4 v106,s[4:7],s61 offen lds
s_add_u32 m0,s77,101376
s_add_u32 s61,s60,1671168
buffer_load_dwordx4 v104,s[4:7],s61 offen lds
s_add_u32 m0,s77,102400
s_add_u32 s61,s60,1671168
buffer_load_dwordx4 v105,s[4:7],s61 offen lds
s_add_u32 m0,s77,103424
s_add_u32 s61,s60,1671168
buffer_load_dwordx4 v106,s[4:7],s61 offen lds
s_waitcnt vmcnt(24)
s_barrier
s_add_u32 s60,s75,s74
s_add_u32 m0,s77,122880
s_add_u32 s61,s60,1572864
buffer_load_dwordx4 v104,s[52:55],s61 offen lds
s_add_u32 m0,s77,123904
s_add_u32 s61,s60,1572864
buffer_load_dwordx4 v105,s[52:55],s61 offen lds
s_add_u32 m0,s77,124928
s_add_u32 s61,s60,1572864
buffer_load_dwordx4 v106,s[52:55],s61 offen lds
s_add_u32 m0,s77,125952
s_add_u32 s61,s60,1671168
buffer_load_dwordx4 v104,s[52:55],s61 offen lds
s_add_u32 m0,s77,126976
s_add_u32 s61,s60,1671168
buffer_load_dwordx4 v105,s[52:55],s61 offen lds
s_add_u32 m0,s77,128000
s_add_u32 s61,s60,1671168
buffer_load_dwordx4 v106,s[52:55],s61 offen lds
v_add_u32 v12,0,v107
s_cmp_eq_u32 s46,1
s_cbranch_scc1 lw_9
s_cmp_eq_u32 s46,2
s_cbranch_scc1 lw_10
s_cmp_eq_u32 s46,3
s_cbranch_scc1 lw_11
lw_8:
ds_read_b64_tr_b16 a[0:1],v12 offset:0
ds_read_b64_tr_b16 a[2:3],v12 offset:768
ds_read_b64_tr_b16 a[4:5],v12 offset:12288
ds_read_b64_tr_b16 a[6:7],v12 offset:13056
ds_read_b64_tr_b16 a[8:9],v12 offset:32
ds_read_b64_tr_b16 a[10:11],v12 offset:800
ds_read_b64_tr_b16 a[12:13],v12 offset:12320
ds_read_b64_tr_b16 a[14:15],v12 offset:13088
ds_read_b64_tr_b16 a[16:17],v12 offset:64
ds_read_b64_tr_b16 a[18:19],v12 offset:832
ds_read_b64_tr_b16 a[20:21],v12 offset:12352
ds_read_b64_tr_b16 a[22:23],v12 offset:13120
s_branch ld_7
lw_9:
ds_read_b64_tr_b16 a[240:241],v12 offset:0
ds_read_b64_tr_b16 a[242:243],v12 offset:768
ds_read_b64_tr_b16 a[244:245],v12 offset:12288
ds_read_b64_tr_b16 a[246:247],v12 offset:13056
ds_read_b64_tr_b16 a[248:249],v12 offset:32
ds_read_b64_tr_b16 a[250:251],v12 offset:800
ds_read_b64_tr_b16 a[252:253],v12 offset:12320
ds_read_b64_tr_b16 a[254:255],v12 offset:13088
ds_read_b64_tr_b16 v[112:113],v12 offset:64
ds_read_b64_tr_b16 v[114:115],v12 offset:832
ds_read_b64_tr_b16 v[116:117],v12 offset:12352
ds_read_b64_tr_b16 v[118:119],v12 offset:13120
s_branch ld_7
lw_10:
ds_read_b64_tr_b16 a[160:161],v12 offset:0
ds_read_b64_tr_b16 a[162:163],v12 offset:768
ds_read_b64_tr_b16 a[164:165],v12 offset:12288
ds_read_b64_tr_b16 a[166:167],v12 offset:13056
ds_read_b64_tr_b16 a[168:169],v12 offset:32
ds_read_b64_tr_b16 a[170:171],v12 offset:800
ds_read_b64_tr_b16 a[172:173],v12 offset:12320
ds_read_b64_tr_b16 a[174:175],v12 offset:13088
ds_read_b64_tr_b16 a[176:177],v12 offset:64
ds_read_b64_tr_b16 a[178:179],v12 offset:832
ds_read_b64_tr_b16 a[180:181],v12 offset:12352
ds_read_b64_tr_b16 a[182:183],v12 offset:13120
s_branch ld_7
lw_11:
ds_read_b64_tr_b16 a[80:81],v12 offset:0
ds_read_b64_tr_b16 a[82:83],v12 offset:768
ds_read_b64_tr_b16 a[84:85],v12 offset:12288
ds_read_b64_tr_b16 a[86:87],v12 offset:13056
ds_read_b64_tr_b16 a[88:89],v12 offset:32
ds_read_b64_tr_b16 a[90:91],v12 offset:800
ds_read_b64_tr_b16 a[92:93],v12 offset:12320
ds_read_b64_tr_b16 a[94:95],v12 offset:13088
ds_read_b64_tr_b16 a[96:97],v12 offset:64
ds_read_b64_tr_b16 a[98:99],v12 offset:832
ds_read_b64_tr_b16 a[100:101],v12 offset:12352
ds_read_b64_tr_b16 a[102:103],v12 offset:13120
ld_7:
s_waitcnt lgkmcnt(0)
s_waitcnt vmcnt(24)
s_barrier
s_add_u32 s60,s75,s73
s_add_u32 m0,s77,0
s_add_u32 s61,s60,2359296
buffer_load_dwordx4 v104,s[4:7],s61 offen lds
s_add_u32 m0,s77,1024
s_add_u32 s61,s60,2359296
buffer_load_dwordx4 v105,s[4:7],s61 offen lds
s_add_u32 m0,s77,2048
s_add_u32 s61,s60,2359296
buffer_load_dwordx4 v106,s[4:7],s61 offen lds
s_add_u32 m0,s77,3072
s_add_u32 s61,s60,2457600
buffer_load_dwordx4 v104,s[4:7],s61 offen lds
s_add_u32 m0,s77,4096
s_add_u32 s61,s60,2457600
buffer_load_dwordx4 v105,s[4:7],s61 offen lds
s_add_u32 m0,s77,5120
s_add_u32 s61,s60,2457600
buffer_load_dwordx4 v106,s[4:7],s61 offen lds
v_add_u32 v12,24576,v107
s_cmp_eq_u32 s46,1
s_cbranch_scc1 lw_14
s_cmp_eq_u32 s46,2
s_cbranch_scc1 lw_15
s_cmp_eq_u32 s46,3
s_cbranch_scc1 lw_16
lw_13:
ds_read_b64_tr_b16 a[24:25],v12 offset:0
ds_read_b64_tr_b16 a[26:27],v12 offset:768
ds_read_b64_tr_b16 a[28:29],v12 offset:12288
ds_read_b64_tr_b16 a[30:31],v12 offset:13056
ds_read_b64_tr_b16 a[32:33],v12 offset:32
ds_read_b64_tr_b16 a[34:35],v12 offset:800
ds_read_b64_tr_b16 a[36:37],v12 offset:12320
ds_read_b64_tr_b16 a[38:39],v12 offset:13088
ds_read_b64_tr_b16 v[24:25],v12 offset:64
ds_read_b64_tr_b16 v[26:27],v12 offset:832
ds_read_b64_tr_b16 v[28:29],v12 offset:12352
ds_read_b64_tr_b16 v[30:31],v12 offset:13120
s_branch ld_12
lw_14:
ds_read_b64_tr_b16 v[120:121],v12 offset:0
ds_read_b64_tr_b16 v[122:123],v12 offset:768
ds_read_b64_tr_b16 v[124:125],v12 offset:12288
ds_read_b64_tr_b16 v[126:127],v12 offset:13056
ds_read_b64_tr_b16 v[128:129],v12 offset:32
ds_read_b64_tr_b16 v[130:131],v12 offset:800
ds_read_b64_tr_b16 v[132:133],v12 offset:12320
ds_read_b64_tr_b16 v[134:135],v12 offset:13088
ds_read_b64_tr_b16 v[72:73],v12 offset:64
ds_read_b64_tr_b16 v[74:75],v12 offset:832
ds_read_b64_tr_b16 v[76:77],v12 offset:12352
ds_read_b64_tr_b16 v[78:79],v12 offset:13120
s_branch ld_12
lw_15:
ds_read_b64_tr_b16 a[184:185],v12 offset:0
ds_read_b64_tr_b16 a[186:187],v12 offset:768
ds_read_b64_tr_b16 a[188:189],v12 offset:12288
ds_read_b64_tr_b16 a[190:191],v12 offset:13056
ds_read_b64_tr_b16 a[192:193],v12 offset:32
ds_read_b64_tr_b16 a[194:195],v12 offset:800
ds_read_b64_tr_b16 a[196:197],v12 offset:12320
ds_read_b64_tr_b16 a[198:199],v12 offset:13088
ds_read_b64_tr_b16 v[56:57],v12 offset:64
ds_read_b64_tr_b16 v[58:59],v12 offset:832
ds_read_b64_tr_b16 v[60:61],v12 offset:12352
ds_read_b64_tr_b16 v[62:63],v12 offset:13120
s_branch ld_12
lw_16:
ds_read_b64_tr_b16 a[104:105],v12 offset:0
ds_read_b64_tr_b16 a[106:107],v12 offset:768
ds_read_b64_tr_b16 a[108:109],v12 offset:12288
ds_read_b64_tr_b16 a[110:111],v12 offset:13056
ds_read_b64_tr_b16 a[112:113],v12 offset:32
ds_read_b64_tr_b16 a[114:115],v12 offset:800
ds_read_b64_tr_b16 a[116:117],v12 offset:12320
ds_read_b64_tr_b16 a[118:119],v12 offset:13088
ds_read_b64_tr_b16 v[40:41],v12 offset:64
ds_read_b64_tr_b16 v[42:43],v12 offset:832
ds_read_b64_tr_b16 v[44:45],v12 offset:12352
ds_read_b64_tr_b16 v[46:47],v12 offset:13120
ld_12:
s_waitcnt lgkmcnt(0)
s_waitcnt vmcnt(24)
s_barrier
s_add_u32 s60,s75,s74
s_add_u32 m0,s77,24576
s_add_u32 s61,s60,2359296
buffer_load_dwordx4 v104,s[52:55],s61 offen lds
s_add_u32 m0,s77,25600
s_add_u32 s61,s60,2359296
buffer_load_dwordx4 v105,s[52:55],s61 offen lds
s_add_u32 m0,s77,26624
s_add_u32 s61,s60,2359296
buffer_load_dwordx4 v106,s[52:55],s61 offen lds
s_add_u32 m0,s77,27648
s_add_u32 s61,s60,2457600
buffer_load_dwordx4 v104,s[52:55],s61 offen lds
s_add_u32 m0,s77,28672
s_add_u32 s61,s60,2457600
buffer_load_dwordx4 v105,s[52:55],s61 offen lds
s_add_u32 m0,s77,29696
s_add_u32 s61,s60,2457600
buffer_load_dwordx4 v106,s[52:55],s61 offen lds
v_add_u32 v12,49152,v107
s_cmp_eq_u32 s46,1
s_cbranch_scc1 lw_19
s_cmp_eq_u32 s46,2
s_cbranch_scc1 lw_20
s_cmp_eq_u32 s46,3
s_cbranch_scc1 lw_21
lw_18:
ds_read_b64_tr_b16 a[40:41],v12 offset:0
ds_read_b64_tr_b16 a[42:43],v12 offset:768
ds_read_b64_tr_b16 a[44:45],v12 offset:12288
ds_read_b64_tr_b16 a[46:47],v12 offset:13056
ds_read_b64_tr_b16 a[48:49],v12 offset:32
ds_read_b64_tr_b16 a[50:51],v12 offset:800
ds_read_b64_tr_b16 a[52:53],v12 offset:12320
ds_read_b64_tr_b16 a[54:55],v12 offset:13088
ds_read_b64_tr_b16 a[56:57],v12 offset:64
ds_read_b64_tr_b16 a[58:59],v12 offset:832
ds_read_b64_tr_b16 a[60:61],v12 offset:12352
ds_read_b64_tr_b16 a[62:63],v12 offset:13120
s_branch ld_17
lw_19:
ds_read_b64_tr_b16 v[136:137],v12 offset:0
ds_read_b64_tr_b16 v[138:139],v12 offset:768
ds_read_b64_tr_b16 v[140:141],v12 offset:12288
ds_read_b64_tr_b16 v[142:143],v12 offset:13056
ds_read_b64_tr_b16 v[144:145],v12 offset:32
ds_read_b64_tr_b16 v[146:147],v12 offset:800
ds_read_b64_tr_b16 v[148:149],v12 offset:12320
ds_read_b64_tr_b16 v[150:151],v12 offset:13088
ds_read_b64_tr_b16 v[152:153],v12 offset:64
ds_read_b64_tr_b16 v[154:155],v12 offset:832
ds_read_b64_tr_b16 v[156:157],v12 offset:12352
ds_read_b64_tr_b16 v[158:159],v12 offset:13120
s_branch ld_17
lw_20:
ds_read_b64_tr_b16 a[200:201],v12 offset:0
ds_read_b64_tr_b16 a[202:203],v12 offset:768
ds_read_b64_tr_b16 a[204:205],v12 offset:12288
ds_read_b64_tr_b16 a[206:207],v12 offset:13056
ds_read_b64_tr_b16 a[208:209],v12 offset:32
ds_read_b64_tr_b16 a[210:211],v12 offset:800
ds_read_b64_tr_b16 a[212:213],v12 offset:12320
ds_read_b64_tr_b16 a[214:215],v12 offset:13088
ds_read_b64_tr_b16 a[216:217],v12 offset:64
ds_read_b64_tr_b16 a[218:219],v12 offset:832
ds_read_b64_tr_b16 a[220:221],v12 offset:12352
ds_read_b64_tr_b16 a[222:223],v12 offset:13120
s_branch ld_17
lw_21:
ds_read_b64_tr_b16 a[120:121],v12 offset:0
ds_read_b64_tr_b16 a[122:123],v12 offset:768
ds_read_b64_tr_b16 a[124:125],v12 offset:12288
ds_read_b64_tr_b16 a[126:127],v12 offset:13056
ds_read_b64_tr_b16 a[128:129],v12 offset:32
ds_read_b64_tr_b16 a[130:131],v12 offset:800
ds_read_b64_tr_b16 a[132:133],v12 offset:12320
ds_read_b64_tr_b16 a[134:135],v12 offset:13088
ds_read_b64_tr_b16 a[136:137],v12 offset:64
ds_read_b64_tr_b16 a[138:139],v12 offset:832
ds_read_b64_tr_b16 a[140:141],v12 offset:12352
ds_read_b64_tr_b16 a[142:143],v12 offset:13120
ld_17:
s_waitcnt lgkmcnt(0)
s_waitcnt vmcnt(24)
s_barrier
s_add_u32 s60,s75,s73
s_add_u32 m0,s77,49152
s_add_u32 s61,s60,3145728
buffer_load_dwordx4 v104,s[4:7],s61 offen lds
s_add_u32 m0,s77,50176
s_add_u32 s61,s60,3145728
buffer_load_dwordx4 v105,s[4:7],s61 offen lds
s_add_u32 m0,s77,51200
s_add_u32 s61,s60,3145728
buffer_load_dwordx4 v106,s[4:7],s61 offen lds
s_add_u32 m0,s77,52224
s_add_u32 s61,s60,3244032
buffer_load_dwordx4 v104,s[4:7],s61 offen lds
s_add_u32 m0,s77,53248
s_add_u32 s61,s60,3244032
buffer_load_dwordx4 v105,s[4:7],s61 offen lds
s_add_u32 m0,s77,54272
s_add_u32 s61,s60,3244032
buffer_load_dwordx4 v106,s[4:7],s61 offen lds
v_add_u32 v12,73728,v107
s_cmp_eq_u32 s46,1
s_cbranch_scc1 lw_24
s_cmp_eq_u32 s46,2
s_cbranch_scc1 lw_25
s_cmp_eq_u32 s46,3
s_cbranch_scc1 lw_26
lw_23:
ds_read_b64_tr_b16 a[64:65],v12 offset:0
ds_read_b64_tr_b16 a[66:67],v12 offset:768
ds_read_b64_tr_b16 a[68:69],v12 offset:12288
ds_read_b64_tr_b16 a[70:71],v12 offset:13056
ds_read_b64_tr_b16 a[72:73],v12 offset:32
ds_read_b64_tr_b16 a[74:75],v12 offset:800
ds_read_b64_tr_b16 a[76:77],v12 offset:12320
ds_read_b64_tr_b16 a[78:79],v12 offset:13088
ds_read_b64_tr_b16 v[32:33],v12 offset:64
ds_read_b64_tr_b16 v[34:35],v12 offset:832
ds_read_b64_tr_b16 v[36:37],v12 offset:12352
ds_read_b64_tr_b16 v[38:39],v12 offset:13120
s_branch ld_22
lw_24:
ds_read_b64_tr_b16 v[160:161],v12 offset:0
ds_read_b64_tr_b16 v[162:163],v12 offset:768
ds_read_b64_tr_b16 v[164:165],v12 offset:12288
ds_read_b64_tr_b16 v[166:167],v12 offset:13056
ds_read_b64_tr_b16 v[168:169],v12 offset:32
ds_read_b64_tr_b16 v[170:171],v12 offset:800
ds_read_b64_tr_b16 v[172:173],v12 offset:12320
ds_read_b64_tr_b16 v[174:175],v12 offset:13088
ds_read_b64_tr_b16 v[80:81],v12 offset:64
ds_read_b64_tr_b16 v[82:83],v12 offset:832
ds_read_b64_tr_b16 v[84:85],v12 offset:12352
ds_read_b64_tr_b16 v[86:87],v12 offset:13120
s_branch ld_22
lw_25:
ds_read_b64_tr_b16 a[224:225],v12 offset:0
ds_read_b64_tr_b16 a[226:227],v12 offset:768
ds_read_b64_tr_b16 a[228:229],v12 offset:12288
ds_read_b64_tr_b16 a[230:231],v12 offset:13056
ds_read_b64_tr_b16 a[232:233],v12 offset:32
ds_read_b64_tr_b16 a[234:235],v12 offset:800
ds_read_b64_tr_b16 a[236:237],v12 offset:12320
ds_read_b64_tr_b16 a[238:239],v12 offset:13088
ds_read_b64_tr_b16 v[64:65],v12 offset:64
ds_read_b64_tr_b16 v[66:67],v12 offset:832
ds_read_b64_tr_b16 v[68:69],v12 offset:12352
ds_read_b64_tr_b16 v[70:71],v12 offset:13120
s_branch ld_22
lw_26:
ds_read_b64_tr_b16 a[144:145],v12 offset:0
ds_read_b64_tr_b16 a[146:147],v12 offset:768
ds_read_b64_tr_b16 a[148:149],v12 offset:12288
ds_read_b64_tr_b16 a[150:151],v12 offset:13056
ds_read_b64_tr_b16 a[152:153],v12 offset:32
ds_read_b64_tr_b16 a[154:155],v12 offset:800
ds_read_b64_tr_b16 a[156:157],v12 offset:12320
ds_read_b64_tr_b16 a[158:159],v12 offset:13088
ds_read_b64_tr_b16 v[48:49],v12 offset:64
ds_read_b64_tr_b16 v[50:51],v12 offset:832
ds_read_b64_tr_b16 v[52:53],v12 offset:12352
ds_read_b64_tr_b16 v[54:55],v12 offset:13120
ld_22:
s_waitcnt lgkmcnt(0)
s_waitcnt vmcnt(24)
s_barrier
s_add_u32 s60,s75,s74
s_add_u32 m0,s77,73728
s_add_u32 s61,s60,3145728
buffer_load_dwordx4 v104,s[52:55],s61 offen lds
s_add_u32 m0,s77,74752
s_add_u32 s61,s60,3145728
buffer_load_dwordx4 v105,s[52:55],s61 offen lds
s_add_u32 m0,s77,75776
s_add_u32 s61,s60,3145728
buffer_load_dwordx4 v106,s[52:55],s61 offen lds
s_add_u32 m0,s77,76800
s_add_u32 s61,s60,3244032
buffer_load_dwordx4 v104,s[52:55],s61 offen lds
s_add_u32 m0,s77,77824
s_add_u32 s61,s60,3244032
buffer_load_dwordx4 v105,s[52:55],s61 offen lds
s_add_u32 m0,s77,78848
s_add_u32 s61,s60,3244032
buffer_load_dwordx4 v106,s[52:55],s61 offen lds
v_add_u32 v12,98304,v107
s_cmp_eq_u32 s46,1
s_cbranch_scc1 lw_29
s_cmp_eq_u32 s46,2
s_cbranch_scc1 lw_30
s_cmp_eq_u32 s46,3
s_cbranch_scc1 lw_31
lw_28:
ds_read_b64_tr_b16 a[80:81],v12 offset:0
ds_read_b64_tr_b16 a[82:83],v12 offset:768
ds_read_b64_tr_b16 a[84:85],v12 offset:12288
ds_read_b64_tr_b16 a[86:87],v12 offset:13056
ds_read_b64_tr_b16 a[88:89],v12 offset:32
ds_read_b64_tr_b16 a[90:91],v12 offset:800
ds_read_b64_tr_b16 a[92:93],v12 offset:12320
ds_read_b64_tr_b16 a[94:95],v12 offset:13088
ds_read_b64_tr_b16 a[96:97],v12 offset:64
ds_read_b64_tr_b16 a[98:99],v12 offset:832
ds_read_b64_tr_b16 a[100:101],v12 offset:12352
ds_read_b64_tr_b16 a[102:103],v12 offset:13120
s_branch ld_27
lw_29:
ds_read_b64_tr_b16 a[0:1],v12 offset:0
ds_read_b64_tr_b16 a[2:3],v12 offset:768
ds_read_b64_tr_b16 a[4:5],v12 offset:12288
ds_read_b64_tr_b16 a[6:7],v12 offset:13056
ds_read_b64_tr_b16 a[8:9],v12 offset:32
ds_read_b64_tr_b16 a[10:11],v12 offset:800
ds_read_b64_tr_b16 a[12:13],v12 offset:12320
ds_read_b64_tr_b16 a[14:15],v12 offset:13088
ds_read_b64_tr_b16 a[16:17],v12 offset:64
ds_read_b64_tr_b16 a[18:19],v12 offset:832
ds_read_b64_tr_b16 a[20:21],v12 offset:12352
ds_read_b64_tr_b16 a[22:23],v12 offset:13120
s_branch ld_27
lw_30:
ds_read_b64_tr_b16 a[240:241],v12 offset:0
ds_read_b64_tr_b16 a[242:243],v12 offset:768
ds_read_b64_tr_b16 a[244:245],v12 offset:12288
ds_read_b64_tr_b16 a[246:247],v12 offset:13056
ds_read_b64_tr_b16 a[248:249],v12 offset:32
ds_read_b64_tr_b16 a[250:251],v12 offset:800
ds_read_b64_tr_b16 a[252:253],v12 offset:12320
ds_read_b64_tr_b16 a[254:255],v12 offset:13088
ds_read_b64_tr_b16 v[112:113],v12 offset:64
ds_read_b64_tr_b16 v[114:115],v12 offset:832
ds_read_b64_tr_b16 v[116:117],v12 offset:12352
ds_read_b64_tr_b16 v[118:119],v12 offset:13120
s_branch ld_27
lw_31:
ds_read_b64_tr_b16 a[160:161],v12 offset:0
ds_read_b64_tr_b16 a[162:163],v12 offset:768
ds_read_b64_tr_b16 a[164:165],v12 offset:12288
ds_read_b64_tr_b16 a[166:167],v12 offset:13056
ds_read_b64_tr_b16 a[168:169],v12 offset:32
ds_read_b64_tr_b16 a[170:171],v12 offset:800
ds_read_b64_tr_b16 a[172:173],v12 offset:12320
ds_read_b64_tr_b16 a[174:175],v12 offset:13088
ds_read_b64_tr_b16 a[176:177],v12 offset:64
ds_read_b64_tr_b16 a[178:179],v12 offset:832
ds_read_b64_tr_b16 a[180:181],v12 offset:12352
ds_read_b64_tr_b16 a[182:183],v12 offset:13120
ld_27:
s_waitcnt lgkmcnt(0)
s_waitcnt vmcnt(24)
s_barrier
s_add_u32 s60,s75,s73
s_add_u32 m0,s77,98304
s_add_u32 s61,s60,3932160
buffer_load_dwordx4 v104,s[4:7],s61 offen lds
s_add_u32 m0,s77,99328
s_add_u32 s61,s60,3932160
buffer_load_dwordx4 v105,s[4:7],s61 offen lds
s_add_u32 m0,s77,100352
s_add_u32 s61,s60,3932160
buffer_load_dwordx4 v106,s[4:7],s61 offen lds
s_add_u32 m0,s77,101376
s_add_u32 s61,s60,4030464
buffer_load_dwordx4 v104,s[4:7],s61 offen lds
s_add_u32 m0,s77,102400
s_add_u32 s61,s60,4030464
buffer_load_dwordx4 v105,s[4:7],s61 offen lds
s_add_u32 m0,s77,103424
s_add_u32 s61,s60,4030464
buffer_load_dwordx4 v106,s[4:7],s61 offen lds
v_add_u32 v12,122880,v107
s_cmp_eq_u32 s46,1
s_cbranch_scc1 lw_34
s_cmp_eq_u32 s46,2
s_cbranch_scc1 lw_35
s_cmp_eq_u32 s46,3
s_cbranch_scc1 lw_36
lw_33:
ds_read_b64_tr_b16 a[104:105],v12 offset:0
ds_read_b64_tr_b16 a[106:107],v12 offset:768
ds_read_b64_tr_b16 a[108:109],v12 offset:12288
ds_read_b64_tr_b16 a[110:111],v12 offset:13056
ds_read_b64_tr_b16 a[112:113],v12 offset:32
ds_read_b64_tr_b16 a[114:115],v12 offset:800
ds_read_b64_tr_b16 a[116:117],v12 offset:12320
ds_read_b64_tr_b16 a[118:119],v12 offset:13088
ds_read_b64_tr_b16 v[40:41],v12 offset:64
ds_read_b64_tr_b16 v[42:43],v12 offset:832
ds_read_b64_tr_b16 v[44:45],v12 offset:12352
ds_read_b64_tr_b16 v[46:47],v12 offset:13120
s_branch ld_32
lw_34:
ds_read_b64_tr_b16 a[24:25],v12 offset:0
ds_read_b64_tr_b16 a[26:27],v12 offset:768
ds_read_b64_tr_b16 a[28:29],v12 offset:12288
ds_read_b64_tr_b16 a[30:31],v12 offset:13056
ds_read_b64_tr_b16 a[32:33],v12 offset:32
ds_read_b64_tr_b16 a[34:35],v12 offset:800
ds_read_b64_tr_b16 a[36:37],v12 offset:12320
ds_read_b64_tr_b16 a[38:39],v12 offset:13088
ds_read_b64_tr_b16 v[24:25],v12 offset:64
ds_read_b64_tr_b16 v[26:27],v12 offset:832
ds_read_b64_tr_b16 v[28:29],v12 offset:12352
ds_read_b64_tr_b16 v[30:31],v12 offset:13120
s_branch ld_32
lw_35:
ds_read_b64_tr_b16 v[120:121],v12 offset:0
ds_read_b64_tr_b16 v[122:123],v12 offset:768
ds_read_b64_tr_b16 v[124:125],v12 offset:12288
ds_read_b64_tr_b16 v[126:127],v12 offset:13056
ds_read_b64_tr_b16 v[128:129],v12 offset:32
ds_read_b64_tr_b16 v[130:131],v12 offset:800
ds_read_b64_tr_b16 v[132:133],v12 offset:12320
ds_read_b64_tr_b16 v[134:135],v12 offset:13088
ds_read_b64_tr_b16 v[72:73],v12 offset:64
ds_read_b64_tr_b16 v[74:75],v12 offset:832
ds_read_b64_tr_b16 v[76:77],v12 offset:12352
ds_read_b64_tr_b16 v[78:79],v12 offset:13120
s_branch ld_32
lw_36:
ds_read_b64_tr_b16 a[184:185],v12 offset:0
ds_read_b64_tr_b16 a[186:187],v12 offset:768
ds_read_b64_tr_b16 a[188:189],v12 offset:12288
ds_read_b64_tr_b16 a[190:191],v12 offset:13056
ds_read_b64_tr_b16 a[192:193],v12 offset:32
ds_read_b64_tr_b16 a[194:195],v12 offset:800
ds_read_b64_tr_b16 a[196:197],v12 offset:12320
ds_read_b64_tr_b16 a[198:199],v12 offset:13088
ds_read_b64_tr_b16 v[56:57],v12 offset:64
ds_read_b64_tr_b16 v[58:59],v12 offset:832
ds_read_b64_tr_b16 v[60:61],v12 offset:12352
ds_read_b64_tr_b16 v[62:63],v12 offset:13120
ld_32:
s_waitcnt lgkmcnt(0)
s_waitcnt vmcnt(24)
s_barrier
s_add_u32 s60,s75,s74
s_add_u32 m0,s77,122880
s_add_u32 s61,s60,3932160
buffer_load_dwordx4 v104,s[52:55],s61 offen lds
s_add_u32 m0,s77,123904
s_add_u32 s61,s60,3932160
buffer_load_dwordx4 v105,s[52:55],s61 offen lds
s_add_u32 m0,s77,124928
s_add_u32 s61,s60,3932160
buffer_load_dwordx4 v106,s[52:55],s61 offen lds
s_add_u32 m0,s77,125952
s_add_u32 s61,s60,4030464
buffer_load_dwordx4 v104,s[52:55],s61 offen lds
s_add_u32 m0,s77,126976
s_add_u32 s61,s60,4030464
buffer_load_dwordx4 v105,s[52:55],s61 offen lds
s_add_u32 m0,s77,128000
s_add_u32 s61,s60,4030464
buffer_load_dwordx4 v106,s[52:55],s61 offen lds
v_add_u32 v12,0,v107
s_cmp_eq_u32 s46,1
s_cbranch_scc1 lw_39
s_cmp_eq_u32 s46,2
s_cbranch_scc1 lw_40
s_cmp_eq_u32 s46,3
s_cbranch_scc1 lw_41
lw_38:
ds_read_b64_tr_b16 a[120:121],v12 offset:0
ds_read_b64_tr_b16 a[122:123],v12 offset:768
ds_read_b64_tr_b16 a[124:125],v12 offset:12288
ds_read_b64_tr_b16 a[126:127],v12 offset:13056
ds_read_b64_tr_b16 a[128:129],v12 offset:32
ds_read_b64_tr_b16 a[130:131],v12 offset:800
ds_read_b64_tr_b16 a[132:133],v12 offset:12320
ds_read_b64_tr_b16 a[134:135],v12 offset:13088
ds_read_b64_tr_b16 a[136:137],v12 offset:64
ds_read_b64_tr_b16 a[138:139],v12 offset:832
ds_read_b64_tr_b16 a[140:141],v12 offset:12352
ds_read_b64_tr_b16 a[142:143],v12 offset:13120
s_branch ld_37
lw_39:
ds_read_b64_tr_b16 a[40:41],v12 offset:0
ds_read_b64_tr_b16 a[42:43],v12 offset:768
ds_read_b64_tr_b16 a[44:45],v12 offset:12288
ds_read_b64_tr_b16 a[46:47],v12 offset:13056
ds_read_b64_tr_b16 a[48:49],v12 offset:32
ds_read_b64_tr_b16 a[50:51],v12 offset:800
ds_read_b64_tr_b16 a[52:53],v12 offset:12320
ds_read_b64_tr_b16 a[54:55],v12 offset:13088
ds_read_b64_tr_b16 a[56:57],v12 offset:64
ds_read_b64_tr_b16 a[58:59],v12 offset:832
ds_read_b64_tr_b16 a[60:61],v12 offset:12352
ds_read_b64_tr_b16 a[62:63],v12 offset:13120
s_branch ld_37
lw_40:
ds_read_b64_tr_b16 v[136:137],v12 offset:0
ds_read_b64_tr_b16 v[138:139],v12 offset:768
ds_read_b64_tr_b16 v[140:141],v12 offset:12288
ds_read_b64_tr_b16 v[142:143],v12 offset:13056
ds_read_b64_tr_b16 v[144:145],v12 offset:32
ds_read_b64_tr_b16 v[146:147],v12 offset:800
ds_read_b64_tr_b16 v[148:149],v12 offset:12320
ds_read_b64_tr_b16 v[150:151],v12 offset:13088
ds_read_b64_tr_b16 v[152:153],v12 offset:64
ds_read_b64_tr_b16 v[154:155],v12 offset:832
ds_read_b64_tr_b16 v[156:157],v12 offset:12352
ds_read_b64_tr_b16 v[158:159],v12 offset:13120
s_branch ld_37
lw_41:
ds_read_b64_tr_b16 a[200:201],v12 offset:0
ds_read_b64_tr_b16 a[202:203],v12 offset:768
ds_read_b64_tr_b16 a[204:205],v12 offset:12288
ds_read_b64_tr_b16 a[206:207],v12 offset:13056
ds_read_b64_tr_b16 a[208:209],v12 offset:32
ds_read_b64_tr_b16 a[210:211],v12 offset:800
ds_read_b64_tr_b16 a[212:213],v12 offset:12320
ds_read_b64_tr_b16 a[214:215],v12 offset:13088
ds_read_b64_tr_b16 a[216:217],v12 offset:64
ds_read_b64_tr_b16 a[218:219],v12 offset:832
ds_read_b64_tr_b16 a[220:221],v12 offset:12352
ds_read_b64_tr_b16 a[222:223],v12 offset:13120
ld_37:
s_waitcnt lgkmcnt(0)
s_waitcnt vmcnt(24)
s_barrier
s_add_u32 s60,s75,s73
s_add_u32 m0,s77,0
s_add_u32 s61,s60,4718592
buffer_load_dwordx4 v104,s[4:7],s61 offen lds
s_add_u32 m0,s77,1024
s_add_u32 s61,s60,4718592
buffer_load_dwordx4 v105,s[4:7],s61 offen lds
s_add_u32 m0,s77,2048
s_add_u32 s61,s60,4718592
buffer_load_dwordx4 v106,s[4:7],s61 offen lds
s_add_u32 m0,s77,3072
s_add_u32 s61,s60,4816896
buffer_load_dwordx4 v104,s[4:7],s61 offen lds
s_add_u32 m0,s77,4096
s_add_u32 s61,s60,4816896
buffer_load_dwordx4 v105,s[4:7],s61 offen lds
s_add_u32 m0,s77,5120
s_add_u32 s61,s60,4816896
buffer_load_dwordx4 v106,s[4:7],s61 offen lds
v_add_u32 v12,24576,v107
s_cmp_eq_u32 s46,1
s_cbranch_scc1 lw_44
s_cmp_eq_u32 s46,2
s_cbranch_scc1 lw_45
s_cmp_eq_u32 s46,3
s_cbranch_scc1 lw_46
lw_43:
ds_read_b64_tr_b16 a[144:145],v12 offset:0
ds_read_b64_tr_b16 a[146:147],v12 offset:768
ds_read_b64_tr_b16 a[148:149],v12 offset:12288
ds_read_b64_tr_b16 a[150:151],v12 offset:13056
ds_read_b64_tr_b16 a[152:153],v12 offset:32
ds_read_b64_tr_b16 a[154:155],v12 offset:800
ds_read_b64_tr_b16 a[156:157],v12 offset:12320
ds_read_b64_tr_b16 a[158:159],v12 offset:13088
ds_read_b64_tr_b16 v[48:49],v12 offset:64
ds_read_b64_tr_b16 v[50:51],v12 offset:832
ds_read_b64_tr_b16 v[52:53],v12 offset:12352
ds_read_b64_tr_b16 v[54:55],v12 offset:13120
s_branch ld_42
lw_44:
ds_read_b64_tr_b16 a[64:65],v12 offset:0
ds_read_b64_tr_b16 a[66:67],v12 offset:768
ds_read_b64_tr_b16 a[68:69],v12 offset:12288
ds_read_b64_tr_b16 a[70:71],v12 offset:13056
ds_read_b64_tr_b16 a[72:73],v12 offset:32
ds_read_b64_tr_b16 a[74:75],v12 offset:800
ds_read_b64_tr_b16 a[76:77],v12 offset:12320
ds_read_b64_tr_b16 a[78:79],v12 offset:13088
ds_read_b64_tr_b16 v[32:33],v12 offset:64
ds_read_b64_tr_b16 v[34:35],v12 offset:832
ds_read_b64_tr_b16 v[36:37],v12 offset:12352
ds_read_b64_tr_b16 v[38:39],v12 offset:13120
s_branch ld_42
lw_45:
ds_read_b64_tr_b16 v[160:161],v12 offset:0
ds_read_b64_tr_b16 v[162:163],v12 offset:768
ds_read_b64_tr_b16 v[164:165],v12 offset:12288
ds_read_b64_tr_b16 v[166:167],v12 offset:13056
ds_read_b64_tr_b16 v[168:169],v12 offset:32
ds_read_b64_tr_b16 v[170:171],v12 offset:800
ds_read_b64_tr_b16 v[172:173],v12 offset:12320
ds_read_b64_tr_b16 v[174:175],v12 offset:13088
ds_read_b64_tr_b16 v[80:81],v12 offset:64
ds_read_b64_tr_b16 v[82:83],v12 offset:832
ds_read_b64_tr_b16 v[84:85],v12 offset:12352
ds_read_b64_tr_b16 v[86:87],v12 offset:13120
s_branch ld_42
lw_46:
ds_read_b64_tr_b16 a[224:225],v12 offset:0
ds_read_b64_tr_b16 a[226:227],v12 offset:768
ds_read_b64_tr_b16 a[228:229],v12 offset:12288
ds_read_b64_tr_b16 a[230:231],v12 offset:13056
ds_read_b64_tr_b16 a[232:233],v12 offset:32
ds_read_b64_tr_b16 a[234:235],v12 offset:800
ds_read_b64_tr_b16 a[236:237],v12 offset:12320
ds_read_b64_tr_b16 a[238:239],v12 offset:13088
ds_read_b64_tr_b16 v[64:65],v12 offset:64
ds_read_b64_tr_b16 v[66:67],v12 offset:832
ds_read_b64_tr_b16 v[68:69],v12 offset:12352
ds_read_b64_tr_b16 v[70:71],v12 offset:13120
ld_42:
s_waitcnt lgkmcnt(0)
s_waitcnt vmcnt(24)
s_barrier
s_add_u32 s60,s75,s74
s_add_u32 m0,s77,24576
s_add_u32 s61,s60,4718592
buffer_load_dwordx4 v104,s[52:55],s61 offen lds
s_add_u32 m0,s77,25600
s_add_u32 s61,s60,4718592
buffer_load_dwordx4 v105,s[52:55],s61 offen lds
s_add_u32 m0,s77,26624
s_add_u32 s61,s60,4718592
buffer_load_dwordx4 v106,s[52:55],s61 offen lds
s_add_u32 m0,s77,27648
s_add_u32 s61,s60,4816896
buffer_load_dwordx4 v104,s[52:55],s61 offen lds
s_add_u32 m0,s77,28672
s_add_u32 s61,s60,4816896
buffer_load_dwordx4 v105,s[52:55],s61 offen lds
s_add_u32 m0,s77,29696
s_add_u32 s61,s60,4816896
buffer_load_dwordx4 v106,s[52:55],s61 offen lds
v_add_u32 v12,49152,v107
s_cmp_eq_u32 s46,1
s_cbranch_scc1 lw_49
s_cmp_eq_u32 s46,2
s_cbranch_scc1 lw_50
s_cmp_eq_u32 s46,3
s_cbranch_scc1 lw_51
lw_48:
ds_read_b64_tr_b16 a[160:161],v12 offset:0
ds_read_b64_tr_b16 a[162:163],v12 offset:768
ds_read_b64_tr_b16 a[164:165],v12 offset:12288
ds_read_b64_tr_b16 a[166:167],v12 offset:13056
ds_read_b64_tr_b16 a[168:169],v12 offset:32
ds_read_b64_tr_b16 a[170:171],v12 offset:800
ds_read_b64_tr_b16 a[172:173],v12 offset:12320
ds_read_b64_tr_b16 a[174:175],v12 offset:13088
ds_read_b64_tr_b16 a[176:177],v12 offset:64
ds_read_b64_tr_b16 a[178:179],v12 offset:832
ds_read_b64_tr_b16 a[180:181],v12 offset:12352
ds_read_b64_tr_b16 a[182:183],v12 offset:13120
s_branch ld_47
lw_49:
ds_read_b64_tr_b16 a[80:81],v12 offset:0
ds_read_b64_tr_b16 a[82:83],v12 offset:768
ds_read_b64_tr_b16 a[84:85],v12 offset:12288
ds_read_b64_tr_b16 a[86:87],v12 offset:13056
ds_read_b64_tr_b16 a[88:89],v12 offset:32
ds_read_b64_tr_b16 a[90:91],v12 offset:800
ds_read_b64_tr_b16 a[92:93],v12 offset:12320
ds_read_b64_tr_b16 a[94:95],v12 offset:13088
ds_read_b64_tr_b16 a[96:97],v12 offset:64
ds_read_b64_tr_b16 a[98:99],v12 offset:832
ds_read_b64_tr_b16 a[100:101],v12 offset:12352
ds_read_b64_tr_b16 a[102:103],v12 offset:13120
s_branch ld_47
lw_50:
ds_read_b64_tr_b16 a[0:1],v12 offset:0
ds_read_b64_tr_b16 a[2:3],v12 offset:768
ds_read_b64_tr_b16 a[4:5],v12 offset:12288
ds_read_b64_tr_b16 a[6:7],v12 offset:13056
ds_read_b64_tr_b16 a[8:9],v12 offset:32
ds_read_b64_tr_b16 a[10:11],v12 offset:800
ds_read_b64_tr_b16 a[12:13],v12 offset:12320
ds_read_b64_tr_b16 a[14:15],v12 offset:13088
ds_read_b64_tr_b16 a[16:17],v12 offset:64
ds_read_b64_tr_b16 a[18:19],v12 offset:832
ds_read_b64_tr_b16 a[20:21],v12 offset:12352
ds_read_b64_tr_b16 a[22:23],v12 offset:13120
s_branch ld_47
lw_51:
ds_read_b64_tr_b16 a[240:241],v12 offset:0
ds_read_b64_tr_b16 a[242:243],v12 offset:768
ds_read_b64_tr_b16 a[244:245],v12 offset:12288
ds_read_b64_tr_b16 a[246:247],v12 offset:13056
ds_read_b64_tr_b16 a[248:249],v12 offset:32
ds_read_b64_tr_b16 a[250:251],v12 offset:800
ds_read_b64_tr_b16 a[252:253],v12 offset:12320
ds_read_b64_tr_b16 a[254:255],v12 offset:13088
ds_read_b64_tr_b16 v[112:113],v12 offset:64
ds_read_b64_tr_b16 v[114:115],v12 offset:832
ds_read_b64_tr_b16 v[116:117],v12 offset:12352
ds_read_b64_tr_b16 v[118:119],v12 offset:13120
ld_47:
s_waitcnt lgkmcnt(0)
s_waitcnt vmcnt(24)
s_barrier
s_add_u32 s60,s75,s73
s_add_u32 m0,s77,49152
s_add_u32 s61,s60,5505024
buffer_load_dwordx4 v104,s[4:7],s61 offen lds
s_add_u32 m0,s77,50176
s_add_u32 s61,s60,5505024
buffer_load_dwordx4 v105,s[4:7],s61 offen lds
s_add_u32 m0,s77,51200
s_add_u32 s61,s60,5505024
buffer_load_dwordx4 v106,s[4:7],s61 offen lds
s_add_u32 m0,s77,52224
s_add_u32 s61,s60,5603328
buffer_load_dwordx4 v104,s[4:7],s61 offen lds
s_add_u32 m0,s77,53248
s_add_u32 s61,s60,5603328
buffer_load_dwordx4 v105,s[4:7],s61 offen lds
s_add_u32 m0,s77,54272
s_add_u32 s61,s60,5603328
buffer_load_dwordx4 v106,s[4:7],s61 offen lds
v_add_u32 v12,73728,v107
s_cmp_eq_u32 s46,1
s_cbranch_scc1 lw_54
s_cmp_eq_u32 s46,2
s_cbranch_scc1 lw_55
s_cmp_eq_u32 s46,3
s_cbranch_scc1 lw_56
lw_53:
ds_read_b64_tr_b16 a[184:185],v12 offset:0
ds_read_b64_tr_b16 a[186:187],v12 offset:768
ds_read_b64_tr_b16 a[188:189],v12 offset:12288
ds_read_b64_tr_b16 a[190:191],v12 offset:13056
ds_read_b64_tr_b16 a[192:193],v12 offset:32
ds_read_b64_tr_b16 a[194:195],v12 offset:800
ds_read_b64_tr_b16 a[196:197],v12 offset:12320
ds_read_b64_tr_b16 a[198:199],v12 offset:13088
ds_read_b64_tr_b16 v[56:57],v12 offset:64
ds_read_b64_tr_b16 v[58:59],v12 offset:832
ds_read_b64_tr_b16 v[60:61],v12 offset:12352
ds_read_b64_tr_b16 v[62:63],v12 offset:13120
s_branch ld_52
lw_54:
ds_read_b64_tr_b16 a[104:105],v12 offset:0
ds_read_b64_tr_b16 a[106:107],v12 offset:768
ds_read_b64_tr_b16 a[108:109],v12 offset:12288
ds_read_b64_tr_b16 a[110:111],v12 offset:13056
ds_read_b64_tr_b16 a[112:113],v12 offset:32
ds_read_b64_tr_b16 a[114:115],v12 offset:800
ds_read_b64_tr_b16 a[116:117],v12 offset:12320
ds_read_b64_tr_b16 a[118:119],v12 offset:13088
ds_read_b64_tr_b16 v[40:41],v12 offset:64
ds_read_b64_tr_b16 v[42:43],v12 offset:832
ds_read_b64_tr_b16 v[44:45],v12 offset:12352
ds_read_b64_tr_b16 v[46:47],v12 offset:13120
s_branch ld_52
lw_55:
ds_read_b64_tr_b16 a[24:25],v12 offset:0
ds_read_b64_tr_b16 a[26:27],v12 offset:768
ds_read_b64_tr_b16 a[28:29],v12 offset:12288
ds_read_b64_tr_b16 a[30:31],v12 offset:13056
ds_read_b64_tr_b16 a[32:33],v12 offset:32
ds_read_b64_tr_b16 a[34:35],v12 offset:800
ds_read_b64_tr_b16 a[36:37],v12 offset:12320
ds_read_b64_tr_b16 a[38:39],v12 offset:13088
ds_read_b64_tr_b16 v[24:25],v12 offset:64
ds_read_b64_tr_b16 v[26:27],v12 offset:832
ds_read_b64_tr_b16 v[28:29],v12 offset:12352
ds_read_b64_tr_b16 v[30:31],v12 offset:13120
s_branch ld_52
lw_56:
ds_read_b64_tr_b16 v[120:121],v12 offset:0
ds_read_b64_tr_b16 v[122:123],v12 offset:768
ds_read_b64_tr_b16 v[124:125],v12 offset:12288
ds_read_b64_tr_b16 v[126:127],v12 offset:13056
ds_read_b64_tr_b16 v[128:129],v12 offset:32
ds_read_b64_tr_b16 v[130:131],v12 offset:800
ds_read_b64_tr_b16 v[132:133],v12 offset:12320
ds_read_b64_tr_b16 v[134:135],v12 offset:13088
ds_read_b64_tr_b16 v[72:73],v12 offset:64
ds_read_b64_tr_b16 v[74:75],v12 offset:832
ds_read_b64_tr_b16 v[76:77],v12 offset:12352
ds_read_b64_tr_b16 v[78:79],v12 offset:13120
ld_52:
s_waitcnt lgkmcnt(0)
s_waitcnt vmcnt(24)
s_barrier
s_add_u32 s60,s75,s74
s_add_u32 m0,s77,73728
s_add_u32 s61,s60,5505024
buffer_load_dwordx4 v104,s[52:55],s61 offen lds
s_add_u32 m0,s77,74752
s_add_u32 s61,s60,5505024
buffer_load_dwordx4 v105,s[52:55],s61 offen lds
s_add_u32 m0,s77,75776
s_add_u32 s61,s60,5505024
buffer_load_dwordx4 v106,s[52:55],s61 offen lds
s_add_u32 m0,s77,76800
s_add_u32 s61,s60,5603328
buffer_load_dwordx4 v104,s[52:55],s61 offen lds
s_add_u32 m0,s77,77824
s_add_u32 s61,s60,5603328
buffer_load_dwordx4 v105,s[52:55],s61 offen lds
s_add_u32 m0,s77,78848
s_add_u32 s61,s60,5603328
buffer_load_dwordx4 v106,s[52:55],s61 offen lds
v_add_u32 v12,98304,v107
s_cmp_eq_u32 s46,1
s_cbranch_scc1 lw_59
s_cmp_eq_u32 s46,2
s_cbranch_scc1 lw_60
s_cmp_eq_u32 s46,3
s_cbranch_scc1 lw_61
lw_58:
ds_read_b64_tr_b16 a[200:201],v12 offset:0
ds_read_b64_tr_b16 a[202:203],v12 offset:768
ds_read_b64_tr_b16 a[204:205],v12 offset:12288
ds_read_b64_tr_b16 a[206:207],v12 offset:13056
ds_read_b64_tr_b16 a[208:209],v12 offset:32
ds_read_b64_tr_b16 a[210:211],v12 offset:800
ds_read_b64_tr_b16 a[212:213],v12 offset:12320
ds_read_b64_tr_b16 a[214:215],v12 offset:13088
ds_read_b64_tr_b16 a[216:217],v12 offset:64
ds_read_b64_tr_b16 a[218:219],v12 offset:832
ds_read_b64_tr_b16 a[220:221],v12 offset:12352
ds_read_b64_tr_b16 a[222:223],v12 offset:13120
s_branch ld_57
lw_59:
ds_read_b64_tr_b16 a[120:121],v12 offset:0
ds_read_b64_tr_b16 a[122:123],v12 offset:768
ds_read_b64_tr_b16 a[124:125],v12 offset:12288
ds_read_b64_tr_b16 a[126:127],v12 offset:13056
ds_read_b64_tr_b16 a[128:129],v12 offset:32
ds_read_b64_tr_b16 a[130:131],v12 offset:800
ds_read_b64_tr_b16 a[132:133],v12 offset:12320
ds_read_b64_tr_b16 a[134:135],v12 offset:13088
ds_read_b64_tr_b16 a[136:137],v12 offset:64
ds_read_b64_tr_b16 a[138:139],v12 offset:832
ds_read_b64_tr_b16 a[140:141],v12 offset:12352
ds_read_b64_tr_b16 a[142:143],v12 offset:13120
s_branch ld_57
lw_60:
ds_read_b64_tr_b16 a[40:41],v12 offset:0
ds_read_b64_tr_b16 a[42:43],v12 offset:768
ds_read_b64_tr_b16 a[44:45],v12 offset:12288
ds_read_b64_tr_b16 a[46:47],v12 offset:13056
ds_read_b64_tr_b16 a[48:49],v12 offset:32
ds_read_b64_tr_b16 a[50:51],v12 offset:800
ds_read_b64_tr_b16 a[52:53],v12 offset:12320
ds_read_b64_tr_b16 a[54:55],v12 offset:13088
ds_read_b64_tr_b16 a[56:57],v12 offset:64
ds_read_b64_tr_b16 a[58:59],v12 offset:832
ds_read_b64_tr_b16 a[60:61],v12 offset:12352
ds_read_b64_tr_b16 a[62:63],v12 offset:13120
s_branch ld_57
lw_61:
ds_read_b64_tr_b16 v[136:137],v12 offset:0
ds_read_b64_tr_b16 v[138:139],v12 offset:768
ds_read_b64_tr_b16 v[140:141],v12 offset:12288
ds_read_b64_tr_b16 v[142:143],v12 offset:13056
ds_read_b64_tr_b16 v[144:145],v12 offset:32
ds_read_b64_tr_b16 v[146:147],v12 offset:800
ds_read_b64_tr_b16 v[148:149],v12 offset:12320
ds_read_b64_tr_b16 v[150:151],v12 offset:13088
ds_read_b64_tr_b16 v[152:153],v12 offset:64
ds_read_b64_tr_b16 v[154:155],v12 offset:832
ds_read_b64_tr_b16 v[156:157],v12 offset:12352
ds_read_b64_tr_b16 v[158:159],v12 offset:13120
ld_57:
s_waitcnt lgkmcnt(0)
s_waitcnt vmcnt(24)
s_barrier
s_add_u32 s60,s76,s73
s_add_u32 m0,s77,98304
s_add_u32 s61,s60,6291456
buffer_load_dwordx4 v104,s[4:7],s61 offen lds
s_add_u32 m0,s77,99328
s_add_u32 s61,s60,6291456
buffer_load_dwordx4 v105,s[4:7],s61 offen lds
s_add_u32 m0,s77,100352
s_add_u32 s61,s60,6291456
buffer_load_dwordx4 v106,s[4:7],s61 offen lds
s_add_u32 m0,s77,101376
s_add_u32 s61,s60,6389760
buffer_load_dwordx4 v104,s[4:7],s61 offen lds
s_add_u32 m0,s77,102400
s_add_u32 s61,s60,6389760
buffer_load_dwordx4 v105,s[4:7],s61 offen lds
s_add_u32 m0,s77,103424
s_add_u32 s61,s60,6389760
buffer_load_dwordx4 v106,s[4:7],s61 offen lds
v_add_u32 v12,122880,v107
s_cmp_eq_u32 s46,1
s_cbranch_scc1 lw_64
s_cmp_eq_u32 s46,2
s_cbranch_scc1 lw_65
s_cmp_eq_u32 s46,3
s_cbranch_scc1 lw_66
lw_63:
ds_read_b64_tr_b16 a[224:225],v12 offset:0
ds_read_b64_tr_b16 a[226:227],v12 offset:768
ds_read_b64_tr_b16 a[228:229],v12 offset:12288
ds_read_b64_tr_b16 a[230:231],v12 offset:13056
ds_read_b64_tr_b16 a[232:233],v12 offset:32
ds_read_b64_tr_b16 a[234:235],v12 offset:800
ds_read_b64_tr_b16 a[236:237],v12 offset:12320
ds_read_b64_tr_b16 a[238:239],v12 offset:13088
ds_read_b64_tr_b16 v[64:65],v12 offset:64
ds_read_b64_tr_b16 v[66:67],v12 offset:832
ds_read_b64_tr_b16 v[68:69],v12 offset:12352
ds_read_b64_tr_b16 v[70:71],v12 offset:13120
s_branch ld_62
lw_64:
ds_read_b64_tr_b16 a[144:145],v12 offset:0
ds_read_b64_tr_b16 a[146:147],v12 offset:768
ds_read_b64_tr_b16 a[148:149],v12 offset:12288
ds_read_b64_tr_b16 a[150:151],v12 offset:13056
ds_read_b64_tr_b16 a[152:153],v12 offset:32
ds_read_b64_tr_b16 a[154:155],v12 offset:800
ds_read_b64_tr_b16 a[156:157],v12 offset:12320
ds_read_b64_tr_b16 a[158:159],v12 offset:13088
ds_read_b64_tr_b16 v[48:49],v12 offset:64
ds_read_b64_tr_b16 v[50:51],v12 offset:832
ds_read_b64_tr_b16 v[52:53],v12 offset:12352
ds_read_b64_tr_b16 v[54:55],v12 offset:13120
s_branch ld_62
lw_65:
ds_read_b64_tr_b16 a[64:65],v12 offset:0
ds_read_b64_tr_b16 a[66:67],v12 offset:768
ds_read_b64_tr_b16 a[68:69],v12 offset:12288
ds_read_b64_tr_b16 a[70:71],v12 offset:13056
ds_read_b64_tr_b16 a[72:73],v12 offset:32
ds_read_b64_tr_b16 a[74:75],v12 offset:800
ds_read_b64_tr_b16 a[76:77],v12 offset:12320
ds_read_b64_tr_b16 a[78:79],v12 offset:13088
ds_read_b64_tr_b16 v[32:33],v12 offset:64
ds_read_b64_tr_b16 v[34:35],v12 offset:832
ds_read_b64_tr_b16 v[36:37],v12 offset:12352
ds_read_b64_tr_b16 v[38:39],v12 offset:13120
s_branch ld_62
lw_66:
ds_read_b64_tr_b16 v[160:161],v12 offset:0
ds_read_b64_tr_b16 v[162:163],v12 offset:768
ds_read_b64_tr_b16 v[164:165],v12 offset:12288
ds_read_b64_tr_b16 v[166:167],v12 offset:13056
ds_read_b64_tr_b16 v[168:169],v12 offset:32
ds_read_b64_tr_b16 v[170:171],v12 offset:800
ds_read_b64_tr_b16 v[172:173],v12 offset:12320
ds_read_b64_tr_b16 v[174:175],v12 offset:13088
ds_read_b64_tr_b16 v[80:81],v12 offset:64
ds_read_b64_tr_b16 v[82:83],v12 offset:832
ds_read_b64_tr_b16 v[84:85],v12 offset:12352
ds_read_b64_tr_b16 v[86:87],v12 offset:13120
ld_62:
s_waitcnt lgkmcnt(0)
s_waitcnt vmcnt(24)
s_barrier
s_add_u32 s60,s76,s74
s_add_u32 m0,s77,122880
s_add_u32 s61,s60,6291456
buffer_load_dwordx4 v104,s[52:55],s61 offen lds
s_add_u32 m0,s77,123904
s_add_u32 s61,s60,6291456
buffer_load_dwordx4 v105,s[52:55],s61 offen lds
s_add_u32 m0,s77,124928
s_add_u32 s61,s60,6291456
buffer_load_dwordx4 v106,s[52:55],s61 offen lds
s_add_u32 m0,s77,125952
s_add_u32 s61,s60,6389760
buffer_load_dwordx4 v104,s[52:55],s61 offen lds
s_add_u32 m0,s77,126976
s_add_u32 s61,s60,6389760
buffer_load_dwordx4 v105,s[52:55],s61 offen lds
s_add_u32 m0,s77,128000
s_add_u32 s61,s60,6389760
buffer_load_dwordx4 v106,s[52:55],s61 offen lds
v_add_u32 v12,0,v107
s_cmp_eq_u32 s46,1
s_cbranch_scc1 lw_69
s_cmp_eq_u32 s46,2
s_cbranch_scc1 lw_70
s_cmp_eq_u32 s46,3
s_cbranch_scc1 lw_71
lw_68:
ds_read_b64_tr_b16 a[240:241],v12 offset:0
ds_read_b64_tr_b16 a[242:243],v12 offset:768
ds_read_b64_tr_b16 a[244:245],v12 offset:12288
ds_read_b64_tr_b16 a[246:247],v12 offset:13056
ds_read_b64_tr_b16 a[248:249],v12 offset:32
ds_read_b64_tr_b16 a[250:251],v12 offset:800
ds_read_b64_tr_b16 a[252:253],v12 offset:12320
ds_read_b64_tr_b16 a[254:255],v12 offset:13088
ds_read_b64_tr_b16 v[112:113],v12 offset:64
ds_read_b64_tr_b16 v[114:115],v12 offset:832
ds_read_b64_tr_b16 v[116:117],v12 offset:12352
ds_read_b64_tr_b16 v[118:119],v12 offset:13120
s_branch ld_67
lw_69:
ds_read_b64_tr_b16 a[160:161],v12 offset:0
ds_read_b64_tr_b16 a[162:163],v12 offset:768
ds_read_b64_tr_b16 a[164:165],v12 offset:12288
ds_read_b64_tr_b16 a[166:167],v12 offset:13056
ds_read_b64_tr_b16 a[168:169],v12 offset:32
ds_read_b64_tr_b16 a[170:171],v12 offset:800
ds_read_b64_tr_b16 a[172:173],v12 offset:12320
ds_read_b64_tr_b16 a[174:175],v12 offset:13088
ds_read_b64_tr_b16 a[176:177],v12 offset:64
ds_read_b64_tr_b16 a[178:179],v12 offset:832
ds_read_b64_tr_b16 a[180:181],v12 offset:12352
ds_read_b64_tr_b16 a[182:183],v12 offset:13120
s_branch ld_67
lw_70:
ds_read_b64_tr_b16 a[80:81],v12 offset:0
ds_read_b64_tr_b16 a[82:83],v12 offset:768
ds_read_b64_tr_b16 a[84:85],v12 offset:12288
ds_read_b64_tr_b16 a[86:87],v12 offset:13056
ds_read_b64_tr_b16 a[88:89],v12 offset:32
ds_read_b64_tr_b16 a[90:91],v12 offset:800
ds_read_b64_tr_b16 a[92:93],v12 offset:12320
ds_read_b64_tr_b16 a[94:95],v12 offset:13088
ds_read_b64_tr_b16 a[96:97],v12 offset:64
ds_read_b64_tr_b16 a[98:99],v12 offset:832
ds_read_b64_tr_b16 a[100:101],v12 offset:12352
ds_read_b64_tr_b16 a[102:103],v12 offset:13120
s_branch ld_67
lw_71:
ds_read_b64_tr_b16 a[0:1],v12 offset:0
ds_read_b64_tr_b16 a[2:3],v12 offset:768
ds_read_b64_tr_b16 a[4:5],v12 offset:12288
ds_read_b64_tr_b16 a[6:7],v12 offset:13056
ds_read_b64_tr_b16 a[8:9],v12 offset:32
ds_read_b64_tr_b16 a[10:11],v12 offset:800
ds_read_b64_tr_b16 a[12:13],v12 offset:12320
ds_read_b64_tr_b16 a[14:15],v12 offset:13088
ds_read_b64_tr_b16 a[16:17],v12 offset:64
ds_read_b64_tr_b16 a[18:19],v12 offset:832
ds_read_b64_tr_b16 a[20:21],v12 offset:12352
ds_read_b64_tr_b16 a[22:23],v12 offset:13120
ld_67:
s_waitcnt lgkmcnt(0)
s_waitcnt vmcnt(24)
s_barrier
s_add_u32 s60,s76,s73
s_add_u32 m0,s77,0
s_add_u32 s61,s60,7077888
buffer_load_dwordx4 v104,s[4:7],s61 offen lds
s_add_u32 m0,s77,1024
s_add_u32 s61,s60,7077888
buffer_load_dwordx4 v105,s[4:7],s61 offen lds
s_add_u32 m0,s77,2048
s_add_u32 s61,s60,7077888
buffer_load_dwordx4 v106,s[4:7],s61 offen lds
s_add_u32 m0,s77,3072
s_add_u32 s61,s60,7176192
buffer_load_dwordx4 v104,s[4:7],s61 offen lds
s_add_u32 m0,s77,4096
s_add_u32 s61,s60,7176192
buffer_load_dwordx4 v105,s[4:7],s61 offen lds
s_add_u32 m0,s77,5120
s_add_u32 s61,s60,7176192
buffer_load_dwordx4 v106,s[4:7],s61 offen lds
v_add_u32 v12,24576,v107
s_cmp_eq_u32 s46,1
s_cbranch_scc1 lw_74
s_cmp_eq_u32 s46,2
s_cbranch_scc1 lw_75
s_cmp_eq_u32 s46,3
s_cbranch_scc1 lw_76
lw_73:
ds_read_b64_tr_b16 v[120:121],v12 offset:0
ds_read_b64_tr_b16 v[122:123],v12 offset:768
ds_read_b64_tr_b16 v[124:125],v12 offset:12288
ds_read_b64_tr_b16 v[126:127],v12 offset:13056
ds_read_b64_tr_b16 v[128:129],v12 offset:32
ds_read_b64_tr_b16 v[130:131],v12 offset:800
ds_read_b64_tr_b16 v[132:133],v12 offset:12320
ds_read_b64_tr_b16 v[134:135],v12 offset:13088
ds_read_b64_tr_b16 v[72:73],v12 offset:64
ds_read_b64_tr_b16 v[74:75],v12 offset:832
ds_read_b64_tr_b16 v[76:77],v12 offset:12352
ds_read_b64_tr_b16 v[78:79],v12 offset:13120
s_branch ld_72
lw_74:
ds_read_b64_tr_b16 a[184:185],v12 offset:0
ds_read_b64_tr_b16 a[186:187],v12 offset:768
ds_read_b64_tr_b16 a[188:189],v12 offset:12288
ds_read_b64_tr_b16 a[190:191],v12 offset:13056
ds_read_b64_tr_b16 a[192:193],v12 offset:32
ds_read_b64_tr_b16 a[194:195],v12 offset:800
ds_read_b64_tr_b16 a[196:197],v12 offset:12320
ds_read_b64_tr_b16 a[198:199],v12 offset:13088
ds_read_b64_tr_b16 v[56:57],v12 offset:64
ds_read_b64_tr_b16 v[58:59],v12 offset:832
ds_read_b64_tr_b16 v[60:61],v12 offset:12352
ds_read_b64_tr_b16 v[62:63],v12 offset:13120
s_branch ld_72
lw_75:
ds_read_b64_tr_b16 a[104:105],v12 offset:0
ds_read_b64_tr_b16 a[106:107],v12 offset:768
ds_read_b64_tr_b16 a[108:109],v12 offset:12288
ds_read_b64_tr_b16 a[110:111],v12 offset:13056
ds_read_b64_tr_b16 a[112:113],v12 offset:32
ds_read_b64_tr_b16 a[114:115],v12 offset:800
ds_read_b64_tr_b16 a[116:117],v12 offset:12320
ds_read_b64_tr_b16 a[118:119],v12 offset:13088
ds_read_b64_tr_b16 v[40:41],v12 offset:64
ds_read_b64_tr_b16 v[42:43],v12 offset:832
ds_read_b64_tr_b16 v[44:45],v12 offset:12352
ds_read_b64_tr_b16 v[46:47],v12 offset:13120
s_branch ld_72
lw_76:
ds_read_b64_tr_b16 a[24:25],v12 offset:0
ds_read_b64_tr_b16 a[26:27],v12 offset:768
ds_read_b64_tr_b16 a[28:29],v12 offset:12288
ds_read_b64_tr_b16 a[30:31],v12 offset:13056
ds_read_b64_tr_b16 a[32:33],v12 offset:32
ds_read_b64_tr_b16 a[34:35],v12 offset:800
ds_read_b64_tr_b16 a[36:37],v12 offset:12320
ds_read_b64_tr_b16 a[38:39],v12 offset:13088
ds_read_b64_tr_b16 v[24:25],v12 offset:64
ds_read_b64_tr_b16 v[26:27],v12 offset:832
ds_read_b64_tr_b16 v[28:29],v12 offset:12352
ds_read_b64_tr_b16 v[30:31],v12 offset:13120
ld_72:
s_waitcnt lgkmcnt(0)
s_waitcnt vmcnt(24)
s_barrier
s_add_u32 s60,s76,s74
s_add_u32 m0,s77,24576
s_add_u32 s61,s60,7077888
buffer_load_dwordx4 v104,s[52:55],s61 offen lds
s_add_u32 m0,s77,25600
s_add_u32 s61,s60,7077888
buffer_load_dwordx4 v105,s[52:55],s61 offen lds
s_add_u32 m0,s77,26624
s_add_u32 s61,s60,7077888
buffer_load_dwordx4 v106,s[52:55],s61 offen lds
s_add_u32 m0,s77,27648
s_add_u32 s61,s60,7176192
buffer_load_dwordx4 v104,s[52:55],s61 offen lds
s_add_u32 m0,s77,28672
s_add_u32 s61,s60,7176192
buffer_load_dwordx4 v105,s[52:55],s61 offen lds
s_add_u32 m0,s77,29696
s_add_u32 s61,s60,7176192
buffer_load_dwordx4 v106,s[52:55],s61 offen lds
v_add_u32 v12,49152,v107
s_cmp_eq_u32 s46,1
s_cbranch_scc1 lw_79
s_cmp_eq_u32 s46,2
s_cbranch_scc1 lw_80
s_cmp_eq_u32 s46,3
s_cbranch_scc1 lw_81
lw_78:
ds_read_b64_tr_b16 v[136:137],v12 offset:0
ds_read_b64_tr_b16 v[138:139],v12 offset:768
ds_read_b64_tr_b16 v[140:141],v12 offset:12288
ds_read_b64_tr_b16 v[142:143],v12 offset:13056
ds_read_b64_tr_b16 v[144:145],v12 offset:32
ds_read_b64_tr_b16 v[146:147],v12 offset:800
ds_read_b64_tr_b16 v[148:149],v12 offset:12320
ds_read_b64_tr_b16 v[150:151],v12 offset:13088
ds_read_b64_tr_b16 v[152:153],v12 offset:64
ds_read_b64_tr_b16 v[154:155],v12 offset:832
ds_read_b64_tr_b16 v[156:157],v12 offset:12352
ds_read_b64_tr_b16 v[158:159],v12 offset:13120
s_branch ld_77
lw_79:
ds_read_b64_tr_b16 a[200:201],v12 offset:0
ds_read_b64_tr_b16 a[202:203],v12 offset:768
ds_read_b64_tr_b16 a[204:205],v12 offset:12288
ds_read_b64_tr_b16 a[206:207],v12 offset:13056
ds_read_b64_tr_b16 a[208:209],v12 offset:32
ds_read_b64_tr_b16 a[210:211],v12 offset:800
ds_read_b64_tr_b16 a[212:213],v12 offset:12320
ds_read_b64_tr_b16 a[214:215],v12 offset:13088
ds_read_b64_tr_b16 a[216:217],v12 offset:64
ds_read_b64_tr_b16 a[218:219],v12 offset:832
ds_read_b64_tr_b16 a[220:221],v12 offset:12352
ds_read_b64_tr_b16 a[222:223],v12 offset:13120
s_branch ld_77
lw_80:
ds_read_b64_tr_b16 a[120:121],v12 offset:0
ds_read_b64_tr_b16 a[122:123],v12 offset:768
ds_read_b64_tr_b16 a[124:125],v12 offset:12288
ds_read_b64_tr_b16 a[126:127],v12 offset:13056
ds_read_b64_tr_b16 a[128:129],v12 offset:32
ds_read_b64_tr_b16 a[130:131],v12 offset:800
ds_read_b64_tr_b16 a[132:133],v12 offset:12320
ds_read_b64_tr_b16 a[134:135],v12 offset:13088
ds_read_b64_tr_b16 a[136:137],v12 offset:64
ds_read_b64_tr_b16 a[138:139],v12 offset:832
ds_read_b64_tr_b16 a[140:141],v12 offset:12352
ds_read_b64_tr_b16 a[142:143],v12 offset:13120
s_branch ld_77
lw_81:
ds_read_b64_tr_b16 a[40:41],v12 offset:0
ds_read_b64_tr_b16 a[42:43],v12 offset:768
ds_read_b64_tr_b16 a[44:45],v12 offset:12288
ds_read_b64_tr_b16 a[46:47],v12 offset:13056
ds_read_b64_tr_b16 a[48:49],v12 offset:32
ds_read_b64_tr_b16 a[50:51],v12 offset:800
ds_read_b64_tr_b16 a[52:53],v12 offset:12320
ds_read_b64_tr_b16 a[54:55],v12 offset:13088
ds_read_b64_tr_b16 a[56:57],v12 offset:64
ds_read_b64_tr_b16 a[58:59],v12 offset:832
ds_read_b64_tr_b16 a[60:61],v12 offset:12352
ds_read_b64_tr_b16 a[62:63],v12 offset:13120
ld_77:
s_waitcnt lgkmcnt(0)
s_waitcnt vmcnt(24)
s_barrier
v_add_u32 v12,73728,v107
s_cmp_eq_u32 s46,1
s_cbranch_scc1 lw_84
s_cmp_eq_u32 s46,2
s_cbranch_scc1 lw_85
s_cmp_eq_u32 s46,3
s_cbranch_scc1 lw_86
lw_83:
ds_read_b64_tr_b16 v[160:161],v12 offset:0
ds_read_b64_tr_b16 v[162:163],v12 offset:768
ds_read_b64_tr_b16 v[164:165],v12 offset:12288
ds_read_b64_tr_b16 v[166:167],v12 offset:13056
ds_read_b64_tr_b16 v[168:169],v12 offset:32
ds_read_b64_tr_b16 v[170:171],v12 offset:800
ds_read_b64_tr_b16 v[172:173],v12 offset:12320
ds_read_b64_tr_b16 v[174:175],v12 offset:13088
ds_read_b64_tr_b16 v[80:81],v12 offset:64
ds_read_b64_tr_b16 v[82:83],v12 offset:832
ds_read_b64_tr_b16 v[84:85],v12 offset:12352
ds_read_b64_tr_b16 v[86:87],v12 offset:13120
s_branch ld_82
lw_84:
ds_read_b64_tr_b16 a[224:225],v12 offset:0
ds_read_b64_tr_b16 a[226:227],v12 offset:768
ds_read_b64_tr_b16 a[228:229],v12 offset:12288
ds_read_b64_tr_b16 a[230:231],v12 offset:13056
ds_read_b64_tr_b16 a[232:233],v12 offset:32
ds_read_b64_tr_b16 a[234:235],v12 offset:800
ds_read_b64_tr_b16 a[236:237],v12 offset:12320
ds_read_b64_tr_b16 a[238:239],v12 offset:13088
ds_read_b64_tr_b16 v[64:65],v12 offset:64
ds_read_b64_tr_b16 v[66:67],v12 offset:832
ds_read_b64_tr_b16 v[68:69],v12 offset:12352
ds_read_b64_tr_b16 v[70:71],v12 offset:13120
s_branch ld_82
lw_85:
ds_read_b64_tr_b16 a[144:145],v12 offset:0
ds_read_b64_tr_b16 a[146:147],v12 offset:768
ds_read_b64_tr_b16 a[148:149],v12 offset:12288
ds_read_b64_tr_b16 a[150:151],v12 offset:13056
ds_read_b64_tr_b16 a[152:153],v12 offset:32
ds_read_b64_tr_b16 a[154:155],v12 offset:800
ds_read_b64_tr_b16 a[156:157],v12 offset:12320
ds_read_b64_tr_b16 a[158:159],v12 offset:13088
ds_read_b64_tr_b16 v[48:49],v12 offset:64
ds_read_b64_tr_b16 v[50:51],v12 offset:832
ds_read_b64_tr_b16 v[52:53],v12 offset:12352
ds_read_b64_tr_b16 v[54:55],v12 offset:13120
s_branch ld_82
lw_86:
ds_read_b64_tr_b16 a[64:65],v12 offset:0
ds_read_b64_tr_b16 a[66:67],v12 offset:768
ds_read_b64_tr_b16 a[68:69],v12 offset:12288
ds_read_b64_tr_b16 a[70:71],v12 offset:13056
ds_read_b64_tr_b16 a[72:73],v12 offset:32
ds_read_b64_tr_b16 a[74:75],v12 offset:800
ds_read_b64_tr_b16 a[76:77],v12 offset:12320
ds_read_b64_tr_b16 a[78:79],v12 offset:13088
ds_read_b64_tr_b16 v[32:33],v12 offset:64
ds_read_b64_tr_b16 v[34:35],v12 offset:832
ds_read_b64_tr_b16 v[36:37],v12 offset:12352
ds_read_b64_tr_b16 v[38:39],v12 offset:13120
ld_82:
s_waitcnt lgkmcnt(0)
s_waitcnt vmcnt(18)
s_barrier
v_add_u32 v12,98304,v107
ds_read_b64_tr_b16 v[176:177],v12 offset:0
ds_read_b64_tr_b16 v[178:179],v12 offset:768
ds_read_b64_tr_b16 v[180:181],v12 offset:12288
ds_read_b64_tr_b16 v[182:183],v12 offset:13056
ds_read_b64_tr_b16 v[184:185],v12 offset:32
ds_read_b64_tr_b16 v[186:187],v12 offset:800
ds_read_b64_tr_b16 v[188:189],v12 offset:12320
ds_read_b64_tr_b16 v[190:191],v12 offset:13088
ds_read_b64_tr_b16 v[192:193],v12 offset:64
ds_read_b64_tr_b16 v[194:195],v12 offset:832
ds_read_b64_tr_b16 v[196:197],v12 offset:12352
ds_read_b64_tr_b16 v[198:199],v12 offset:13120
s_waitcnt lgkmcnt(0)
s_waitcnt vmcnt(12)
s_barrier
v_add_u32 v12,122880,v107
ds_read_b64_tr_b16 v[200:201],v12 offset:0
ds_read_b64_tr_b16 v[202:203],v12 offset:768
ds_read_b64_tr_b16 v[204:205],v12 offset:12288
ds_read_b64_tr_b16 v[206:207],v12 offset:13056
ds_read_b64_tr_b16 v[208:209],v12 offset:32
ds_read_b64_tr_b16 v[210:211],v12 offset:800
ds_read_b64_tr_b16 v[212:213],v12 offset:12320
ds_read_b64_tr_b16 v[214:215],v12 offset:13088
ds_read_b64_tr_b16 v[88:89],v12 offset:64
ds_read_b64_tr_b16 v[90:91],v12 offset:832
ds_read_b64_tr_b16 v[92:93],v12 offset:12352
ds_read_b64_tr_b16 v[94:95],v12 offset:13120
s_waitcnt lgkmcnt(0)
s_waitcnt vmcnt(6)
s_barrier
v_add_u32 v12,0,v107
ds_read_b64_tr_b16 v[216:217],v12 offset:0
ds_read_b64_tr_b16 v[218:219],v12 offset:768
ds_read_b64_tr_b16 v[220:221],v12 offset:12288
ds_read_b64_tr_b16 v[222:223],v12 offset:13056
ds_read_b64_tr_b16 v[224:225],v12 offset:32
ds_read_b64_tr_b16 v[226:227],v12 offset:800
ds_read_b64_tr_b16 v[228:229],v12 offset:12320
ds_read_b64_tr_b16 v[230:231],v12 offset:13088
ds_read_b64_tr_b16 v[232:233],v12 offset:64
ds_read_b64_tr_b16 v[234:235],v12 offset:832
ds_read_b64_tr_b16 v[236:237],v12 offset:12352
ds_read_b64_tr_b16 v[238:239],v12 offset:13120
s_waitcnt lgkmcnt(0)
s_waitcnt vmcnt(0)
s_barrier
v_add_u32 v12,24576,v107
ds_read_b64_tr_b16 v[240:241],v12 offset:0
ds_read_b64_tr_b16 v[242:243],v12 offset:768
ds_read_b64_tr_b16 v[244:245],v12 offset:12288
ds_read_b64_tr_b16 v[246:247],v12 offset:13056
ds_read_b64_tr_b16 v[248:249],v12 offset:32
ds_read_b64_tr_b16 v[250:251],v12 offset:800
ds_read_b64_tr_b16 v[252:253],v12 offset:12320
ds_read_b64_tr_b16 v[254:255],v12 offset:13088
ds_read_b64_tr_b16 v[96:97],v12 offset:64
ds_read_b64_tr_b16 v[98:99],v12 offset:832
ds_read_b64_tr_b16 v[100:101],v12 offset:12352
ds_read_b64_tr_b16 v[102:103],v12 offset:13120
s_waitcnt lgkmcnt(0)
s_barrier
ds_write_b128 v21,v[24:27] offset:0
ds_write_b128 v21,v[28:31] offset:1024
ds_write_b128 v21,v[32:35] offset:2048
ds_write_b128 v21,v[36:39] offset:3072
ds_write_b128 v21,v[40:43] offset:4096
ds_write_b128 v21,v[44:47] offset:5120
ds_write_b128 v21,v[48:51] offset:6144
ds_write_b128 v21,v[52:55] offset:7168
ds_write_b128 v21,v[56:59] offset:8192
ds_write_b128 v21,v[60:63] offset:9216
ds_write_b128 v21,v[64:67] offset:10240
ds_write_b128 v21,v[68:71] offset:11264
ds_write_b128 v21,v[72:75] offset:12288
ds_write_b128 v21,v[76:79] offset:13312
ds_write_b128 v21,v[80:83] offset:14336
ds_write_b128 v21,v[84:87] offset:15360
ds_write_b128 v21,v[88:91] offset:16384
ds_write_b128 v21,v[92:95] offset:17408
ds_write_b128 v21,v[96:99] offset:18432
ds_write_b128 v21,v[100:103] offset:19456
s_waitcnt lgkmcnt(0)
v_add_u32 v59,139264,v1
s_barrier
s_lshl_b32 s3,s49,2
v_mov_b32 v13,s3
s_nop 1
ibw_87:
buffer_load_dword v12,v13,s[12:15],0 offen sc1
s_waitcnt vmcnt(0)
v_cmp_ne_u32 vcc,256,v12
s_nop 0
s_cbranch_vccz ok_88
s_sleep 8
s_sub_u32 s47,s47,1
s_cbranch_scc1 ABORT
s_branch ibw_87
ok_88:
s_cmp_lg_u32 s49,0
s_cbranch_scc1 ibok_89
v_and_b32 v13,7,v0
v_lshlrev_b32 v13,2,v13
buffer_load_dword v12,v13,s[12:15],0 offen offset:32 sc1
s_waitcnt vmcnt(0)
v_cmp_ne_u32 vcc,32,v12
s_nop 0
s_cbranch_vccz ibok_89
s_barrier
s_mov_b32 s49,1
s_mov_b32 s3,s2
s_load_dwordx16 s[16:31],s[0:1],0
s_load_dwordx8 s[32:39],s[0:1],64
s_waitcnt lgkmcnt(0)
s_branch DISPATCH
ibok_89:
v_mov_b32 v13,192
buffer_load_dword v12,v13,s[12:15],0 offen sc1
s_waitcnt vmcnt(0)
v_readfirstlane_b32 s60,v12
s_cmp_gt_i32 s60,0
s_cselect_b32 s60,0x2000,0
s_add_u32 s83,s83,s60
s_mul_i32 s6,s46,2048
v_sub_u32 v18,v23,v22
v_add_u32 v18,v18,v1
v_add_u32 v18,8192,v18
s_mov_b32 s37,0x3f80
s_mov_b32 s81,0x3f800000
s_add_u32 s6,s6,s82
s_mov_b32 s7,0
s_add_u32 s7,s7,s82
s_add_u32 s7,s7,950272
s_mov_b32 s50,0
s_mov_b32 s4,0
s_mov_b32 s5,0
s_mov_b32 s78,2147483648
s_mov_b32 s79,2147483648
s_mov_b32 s30,2147483648
s_sub_u32 s60,s4,s5
s_cmp_gt_i32 s60,13
s_cselect_b32 s51,1,0
s_cmp_eq_u32 s4,64
s_cselect_b32 s51,1,s51
s_cmp_eq_u32 s51,0
s_cselect_b32 s52,s4,s5
s_addc_u32 s4,s4,0
s_add_u32 s5,s5,s51
s_and_b32 s60,s52,1
s_lshl2_add_u32 s60,s51,s60
s_lshl_b32 s68,s60,16
s_add_u32 s68,s68,s83
s_mul_i32 s59,s60,20480
s_add_u32 s59,s59,s6
s_lshl_b32 s69,s51,9
s_add_u32 s69,s69,s7
s_bfe_u32 s57,s52,65537
s_add_u32 s58,s52,1
s_cmp_lg_u32 s36,0
s_cbranch_scc1 CV_START
s_cmp_eq_u32 s46,3
s_cbranch_scc1 CH_START
s_lshl_b32 s60,s46,2
s_add_u32 s60,s60,147456
v_mov_b32 v20,s60
v_mov_b32 v12,0
ds_write_b32 v20,v12
v_add_u32 v58,106496,v1
v_mov_b32 v9,147468
s_lshl_b32 s85,s46,12
s_add_u32 s84,s84,s85
s_add_u32 s74,s85,81920
s_add_u32 s75,s74,s74
s_add_u32 s75,s75,24576
s_mul_i32 s60,s29,3
s_add_u32 s60,s60,s46
v_lshlrev_b32 v13,7,v0
s_add_u32 s61,s60,0
s_min_u32 s61,s61,115
s_lshl_b32 s61,s61,13
s_add_u32 s61,s61,s82
buffer_load_dword v14,v13,s[8:11],s61 offen sc1
s_add_u32 s61,s60,48
s_min_u32 s61,s61,115
s_lshl_b32 s61,s61,13
s_add_u32 s61,s61,s82
buffer_load_dword v14,v13,s[8:11],s61 offen sc1
s_add_u32 s61,s60,96
s_min_u32 s61,s61,115
s_lshl_b32 s61,s61,13
s_add_u32 s61,s61,s82
buffer_load_dword v14,v13,s[8:11],s61 offen sc1
s_waitcnt vmcnt(0)
s_mov_b64 vcc,-1
s_waitcnt lgkmcnt(0)
v_mov_b32 v10,0
v_mov_b32 v11,0
v_mov_b32 v24,0
v_mov_b32 v25,0
v_mov_b32 v26,0
v_mov_b32 v27,0
v_mov_b32 v28,0
v_mov_b32 v29,0
v_mov_b32 v30,0
v_mov_b32 v31,0
v_mov_b32 v32,0
v_mov_b32 v33,0
v_mov_b32 v34,0
v_mov_b32 v35,0
v_mov_b32 v36,0
v_mov_b32 v37,0
v_mov_b32 v38,0
v_mov_b32 v39,0
v_mov_b32 v40,0
v_mov_b32 v41,0
v_mov_b32 v42,0
v_mov_b32 v43,0
v_mov_b32 v44,0
v_mov_b32 v45,0
v_mov_b32 v46,0
v_mov_b32 v47,0
s_cmp_lg_u32 s49,0
s_cbranch_scc1 CS_LOOP_S
CS_LOOP_F:
s_barrier
buffer_load_dwordx2 v[80:81],v18,s[8:11],s59 offen sc1
buffer_load_dwordx4 v[72:75],v1,s[8:11],s59 offen sc1
buffer_load_dwordx4 v[76:79],v1,s[8:11],s59 offen offset:1024 sc1
s_cbranch_vccz fj_92f
s_waitcnt vmcnt(2)
s_sleep 3
fj_92f:
buffer_load_dwordx2 v[90:91],v18,s[8:11],s68 offen sc1
buffer_load_dwordx4 v[82:85],v1,s[8:11],s68 offen sc1
buffer_load_dwordx4 v[86:89],v1,s[8:11],s68 offen offset:1024 sc1
v_mfma_f32_32x32x8_bf16 v[24:39],v[10:11],v[10:11],0
v_mfma_f32_16x16x16_bf16 v[40:43],v[10:11],v[10:11],0
v_mfma_f32_16x16x16_bf16 v[44:47],v[10:11],v[10:11],0
fj_92:
fa_90:
s_waitcnt vmcnt(5)
v_lshlrev_b32 v108,16,v80
v_and_b32 v109,0xffff0000,v80
v_lshlrev_b32 v110,16,v81
v_and_b32 v111,0xffff0000,v81
s_waitcnt vmcnt(4)
v_lshlrev_b32 v92,16,v72
v_and_b32 v93,0xffff0000,v72
v_lshlrev_b32 v94,16,v73
v_and_b32 v95,0xffff0000,v73
v_lshlrev_b32 v96,16,v74
v_and_b32 v97,0xffff0000,v74
v_lshlrev_b32 v98,16,v75
v_and_b32 v99,0xffff0000,v75
s_waitcnt vmcnt(3)
v_lshlrev_b32 v100,16,v76
v_and_b32 v101,0xffff0000,v76
v_lshlrev_b32 v102,16,v77
v_and_b32 v103,0xffff0000,v77
v_lshlrev_b32 v104,16,v78
v_and_b32 v105,0xffff0000,v78
v_lshlrev_b32 v106,16,v79
v_and_b32 v107,0xffff0000,v79
s_waitcnt vmcnt(2)
v_dot2c_f32_bf16 v108,s37,v90
v_dot2c_f32_bf16 v109,s81,v90
v_dot2c_f32_bf16 v110,s37,v91
v_dot2c_f32_bf16 v111,s81,v91
v_bitop3_b32 v16,v80,v90,s57 bitop3:0x7e
v_cvt_pk_bf16_f32 v56,v108,v109
s_nop 0
v_cvt_pk_bf16_f32 v57,v110,v111
ds_write_b64 v23,v[56:57]
s_waitcnt vmcnt(1)
v_dot2c_f32_bf16 v92,s37,v82
v_dot2c_f32_bf16 v93,s81,v82
v_dot2c_f32_bf16 v94,s37,v83
v_dot2c_f32_bf16 v95,s81,v83
v_dot2c_f32_bf16 v96,s37,v84
v_dot2c_f32_bf16 v97,s81,v84
v_dot2c_f32_bf16 v98,s37,v85
v_dot2c_f32_bf16 v99,s81,v85
v_bitop3_b32 v17,v72,v82,s57 bitop3:0x7e
v_or_b32 v16,v16,v17
v_cvt_pk_bf16_f32 v48,v92,v93
v_cvt_pk_bf16_f32 v49,v94,v95
v_cvt_pk_bf16_f32 v50,v96,v97
v_cvt_pk_bf16_f32 v51,v98,v99
ds_write_b128 v22,v[48:51] offset:0
s_waitcnt vmcnt(0)
v_dot2c_f32_bf16 v100,s37,v86
v_dot2c_f32_bf16 v101,s81,v86
v_dot2c_f32_bf16 v102,s37,v87
v_dot2c_f32_bf16 v103,s81,v87
v_dot2c_f32_bf16 v104,s37,v88
v_dot2c_f32_bf16 v105,s81,v88
v_dot2c_f32_bf16 v106,s37,v89
v_dot2c_f32_bf16 v107,s81,v89
v_bitop3_b32 v17,v76,v86,s57 bitop3:0x7e
v_bitop3_b32 v16,v16,v17,1 bitop3:0xa8
v_cmp_ne_u32 vcc,0,v16
v_cvt_pk_bf16_f32 v52,v100,v101
v_cvt_pk_bf16_f32 v53,v102,v103
v_cvt_pk_bf16_f32 v54,v104,v105
v_cvt_pk_bf16_f32 v55,v106,v107
ds_write_b128 v22,v[52:55] offset:1024
s_cbranch_vccnz fr_91
fj_92g:
v_smfmac_f32_16x16x64_bf16 v[24:27],v[48:51],a[0:7],v2
ds_read_b128 v[72:75],v21 offset:0
v_xor_b32 v58,57344,v58
v_smfmac_f32_16x16x64_bf16 v[28:31],v[48:51],a[8:15],v2
ds_read_b128 v[76:79],v21 offset:1024
s_sub_u32 s60,s4,s5
v_smfmac_f32_16x16x64_bf16 v[32:35],v[48:51],a[16:23],v2
ds_read_b128 v[80:83],v21 offset:2048
s_cmp_gt_i32 s60,13
v_smfmac_f32_16x16x64_bf16 v[36:39],v[48:51],a[24:31],v2
ds_read_b128 v[84:87],v21 offset:3072
s_cselect_b32 s53,1,0
s_waitcnt lgkmcnt(4)
s_barrier
v_smfmac_f32_16x16x64_bf16 v[40:43],v[48:51],a[32:39],v2
ds_read_b128 v[60:63],v3 offset:0
s_cmp_eq_u32 s4,64
v_smfmac_f32_16x16x64_bf16 v[24:27],v[52:55],a[40:47],v2
ds_read_b128 v[64:67],v3 offset:1024
s_cselect_b32 s53,1,s53
v_smfmac_f32_16x16x64_bf16 v[28:31],v[52:55],a[48:55],v2
ds_read_b128 v[68:71],v4 offset:0
s_cmp_eq_u32 s53,0
v_smfmac_f32_16x16x64_bf16 v[32:35],v[52:55],a[56:63],v2
s_cselect_b32 s54,s4,s5
s_addc_u32 s4,s4,0
s_add_u32 s5,s5,s53
v_smfmac_f32_16x16x64_bf16 v[36:39],v[52:55],a[64:71],v2
s_mul_i32 s73,s54,393216
s_add_u32 s73,s73,s84
s_sub_u32 s74,s75,s74
v_smfmac_f32_16x16x64_bf16 v[40:43],v[52:55],a[72:79],v2
s_mov_b32 m0,s74
s_and_b32 s60,s52,1
s_waitcnt lgkmcnt(5)
v_smfmac_f32_16x16x64_bf16 v[44:47],v[48:51],v[72:79],v2
ds_read_b128 v[72:75],v21 offset:4096
s_waitcnt lgkmcnt(4)
v_smfmac_f32_16x16x64_bf16 v[44:47],v[52:55],v[80:87],v2
ds_read_b128 v[76:79],v21 offset:5120
s_waitcnt lgkmcnt(4)
v_smfmac_f32_16x16x64_bf16 v[24:27],v[60:63],a[80:87],v2
ds_read_b128 v[80:83],v21 offset:6144
s_lshl2_add_u32 s60,s51,s60
v_smfmac_f32_16x16x64_bf16 v[28:31],v[60:63],a[88:95],v2
ds_read_b128 v[84:87],v21 offset:7168
s_mul_i32 s60,s60,49152
v_smfmac_f32_16x16x64_bf16 v[32:35],v[60:63],a[96:103],v2
s_add_u32 s71,s60,s34
s_add_u32 s70,s60,s33
s_lshl_b32 s60,s51,9
v_smfmac_f32_16x16x64_bf16 v[36:39],v[60:63],a[104:111],v2
s_add_u32 s72,s60,s35
buffer_load_dwordx4 v1,s[8:11],s73 offen sc1 lds
v_smfmac_f32_16x16x64_bf16 v[40:43],v[60:63],a[112:119],v2
buffer_load_dwordx4 v1,s[8:11],s73 offen offset:1024 sc1 lds
s_waitcnt lgkmcnt(2)
v_smfmac_f32_16x16x64_bf16 v[44:47],v[60:63],v[72:79],v2
ds_read_b128 v[60:63],v4 offset:1024
v_smfmac_f32_16x16x64_bf16 v[24:27],v[64:67],a[120:127],v2
ds_read_b128 v[72:75],v21 offset:8192
v_smfmac_f32_16x16x64_bf16 v[28:31],v[64:67],a[128:135],v2
ds_read_b128 v[76:79],v21 offset:9216
v_smfmac_f32_16x16x64_bf16 v[32:35],v[64:67],a[136:143],v2
buffer_load_dwordx4 v1,s[8:11],s73 offen offset:2048 sc1 lds
v_smfmac_f32_16x16x64_bf16 v[36:39],v[64:67],a[144:151],v2
buffer_load_dwordx4 v1,s[8:11],s73 offen offset:3072 sc1 lds
v_add_u32 v17,s85,v58
v_smfmac_f32_16x16x64_bf16 v[40:43],v[64:67],a[152:159],v2
v_mov_b32 v16,s58
s_and_b32 s60,s54,1
s_waitcnt lgkmcnt(3)
v_smfmac_f32_16x16x64_bf16 v[44:47],v[64:67],v[80:87],v2
ds_read_b128 v[64:67],v5 offset:0
s_lshl2_add_u32 s60,s53,s60
v_smfmac_f32_16x16x64_bf16 v[24:27],v[68:71],a[160:167],v2
ds_read_b128 v[80:83],v21 offset:10240
s_lshl_b32 s68,s60,16
v_smfmac_f32_16x16x64_bf16 v[28:31],v[68:71],a[168:175],v2
ds_read_b128 v[84:87],v21 offset:11264
s_add_u32 s68,s68,s83
v_smfmac_f32_16x16x64_bf16 v[32:35],v[68:71],a[176:183],v2
s_mul_i32 s59,s60,20480
s_add_u32 s59,s59,s6
s_lshl_b32 s69,s53,9
v_smfmac_f32_16x16x64_bf16 v[36:39],v[68:71],a[184:191],v2
s_add_u32 s69,s69,s7
s_bfe_u32 s31,s54,65537
s_add_u32 s32,s54,1
v_smfmac_f32_16x16x64_bf16 v[40:43],v[68:71],a[192:199],v2
s_add_u32 s50,s50,1
s_mov_b32 s51,s53
s_waitcnt lgkmcnt(3)
v_smfmac_f32_16x16x64_bf16 v[44:47],v[68:71],v[72:79],v2
ds_read_b128 v[68:71],v5 offset:1024
s_mov_b32 s52,s54
v_smfmac_f32_16x16x64_bf16 v[24:27],v[60:63],a[200:207],v2
ds_read_b128 v[72:75],v21 offset:12288
s_mov_b32 s58,s32
v_smfmac_f32_16x16x64_bf16 v[28:31],v[60:63],a[208:215],v2
ds_read_b128 v[76:79],v21 offset:13312
s_mov_b64 vcc,s[88:89]
v_smfmac_f32_16x16x64_bf16 v[32:35],v[60:63],a[216:223],v2
ds_read_b128 v[48:51],v58 offset:0
v_smfmac_f32_16x16x64_bf16 v[36:39],v[60:63],a[224:231],v2
v_smfmac_f32_16x16x64_bf16 v[40:43],v[60:63],a[232:239],v2
ds_read_b128 v[52:55],v58 offset:1024
s_waitcnt lgkmcnt(5)
v_smfmac_f32_16x16x64_bf16 v[44:47],v[60:63],v[80:87],v2
ds_read_b128 v[60:63],v59 offset:0
v_smfmac_f32_16x16x64_bf16 v[24:27],v[64:67],a[240:247],v2
ds_read_b128 v[80:83],v21 offset:14336
v_smfmac_f32_16x16x64_bf16 v[28:31],v[64:67],a[248:255],v2
ds_read_b128 v[84:87],v21 offset:15360
v_smfmac_f32_16x16x64_bf16 v[32:35],v[64:67],v[112:119],v2
ds_read_b128 v[88:91],v58 offset:2048
v_smfmac_f32_16x16x64_bf16 v[36:39],v[64:67],v[120:127],v2
v_smfmac_f32_16x16x64_bf16 v[40:43],v[64:67],v[128:135],v2
ds_read_b128 v[92:95],v58 offset:3072
s_waitcnt lgkmcnt(7)
v_smfmac_f32_16x16x64_bf16 v[44:47],v[64:67],v[72:79],v2
ds_read_b128 v[64:67],v59 offset:1024
v_smfmac_f32_16x16x64_bf16 v[24:27],v[68:71],v[136:143],v2
ds_read_b128 v[72:75],v21 offset:16384
v_smfmac_f32_16x16x64_bf16 v[28:31],v[68:71],v[144:151],v2
ds_read_b128 v[76:79],v21 offset:17408
v_smfmac_f32_16x16x64_bf16 v[32:35],v[68:71],v[152:159],v2
ds_read_b128 v[96:99],v58 offset:4096
v_smfmac_f32_16x16x64_bf16 v[36:39],v[68:71],v[160:167],v2
v_smfmac_f32_16x16x64_bf16 v[40:43],v[68:71],v[168:175],v2
ds_read_b128 v[100:103],v58 offset:5120
s_waitcnt lgkmcnt(7)
v_smfmac_f32_16x16x64_bf16 v[44:47],v[68:71],v[80:87],v2
ds_read_b128 v[80:83],v21 offset:18432
v_smfmac_f32_16x16x64_bf16 v[24:27],v[60:63],v[176:183],v2
ds_read_b128 v[84:87],v21 offset:19456
v_smfmac_f32_16x16x64_bf16 v[36:39],v[60:63],v[200:207],v2
ds_read_b128 v[104:107],v58 offset:6144
s_waitcnt lgkmcnt(7)
v_smfmac_f32_16x16x64_bf16 v[24:27],v[64:67],v[216:223],v2
v_smfmac_f32_16x16x64_bf16 v[36:39],v[64:67],v[240:247],v2
ds_read_b128 v[108:111],v58 offset:7168
v_smfmac_f32_16x16x64_bf16 v[28:31],v[60:63],v[184:191],v2
v_smfmac_f32_16x16x64_bf16 v[40:43],v[60:63],v[208:215],v2
v_add_f32 v24,v24,v25
v_smfmac_f32_16x16x64_bf16 v[28:31],v[64:67],v[224:231],v2
v_add_f32 v26,v26,v27
v_smfmac_f32_16x16x64_bf16 v[40:43],v[64:67],v[248:255],v2
v_add_f32 v36,v36,v37
v_smfmac_f32_16x16x64_bf16 v[32:35],v[60:63],v[192:199],v2
v_add_f32 v38,v38,v39
s_waitcnt lgkmcnt(6)
v_smfmac_f32_16x16x64_bf16 v[44:47],v[60:63],v[72:79],v2
v_cvt_pk_bf16_f32 v37,v24,v26
v_smfmac_f32_16x16x64_bf16 v[32:35],v[64:67],v[232:239],v2
v_cvt_pk_bf16_f32 v36,v36,v38
s_waitcnt lgkmcnt(2)
v_smfmac_f32_16x16x64_bf16 v[44:47],v[64:67],v[80:87],v2
ds_write_b64 v6,v[36:37] offset:0
v_add_f32 v28,v28,v29
v_add_f32 v30,v30,v31
v_add_f32 v40,v40,v41
v_add_f32 v42,v42,v43
v_cvt_pk_bf16_f32 v41,v28,v30
v_cvt_pk_bf16_f32 v40,v40,v42
ds_write_b64 v6,v[40:41] offset:512
v_add_f32 v32,v32,v33
v_add_f32 v34,v34,v35
v_add_f32 v44,v44,v45
v_add_f32 v46,v46,v47
v_cvt_pk_bf16_f32 v45,v32,v34
v_cvt_pk_bf16_f32 v44,v44,v46
ds_write_b64 v6,v[44:45] offset:1024
ds_read_b128 v[72:75],v58 offset:8192
ds_read_b128 v[76:79],v58 offset:9216
s_waitcnt lgkmcnt(2)
s_barrier
ds_read_b64_tr_b16 v[24:25],v7 offset:0
ds_read_b64_tr_b16 v[26:27],v7 offset:512
ds_read_b64_tr_b16 v[28:29],v7 offset:1024
ds_read_b64_tr_b16 v[30:31],v7 offset:1536
ds_read_b64_tr_b16 v[32:33],v7 offset:2048
ds_read_b64_tr_b16 v[34:35],v7 offset:2560
ds_read_b64_tr_b16 v[36:37],v7 offset:3072
ds_read_b64_tr_b16 v[38:39],v7 offset:3584
s_waitcnt lgkmcnt(6)
v_mfma_f32_16x16x32_bf16 v[60:63],v[48:51],v[24:27],0
ds_read_b64_tr_b16 v[40:41],v7 offset:4096
v_mfma_f32_16x16x32_bf16 v[64:67],v[52:55],v[24:27],0
ds_read_b64_tr_b16 v[42:43],v7 offset:4608
v_mfma_f32_16x16x32_bf16 v[68:71],v[24:27],v[24:27],0
ds_read_b128 v[80:83],v58 offset:10240
s_waitcnt lgkmcnt(7)
v_mfma_f32_16x16x32_bf16 v[60:63],v[88:91],v[28:31],v[60:63]
ds_read_b128 v[84:87],v58 offset:11264
v_mfma_f32_16x16x32_bf16 v[64:67],v[92:95],v[28:31],v[64:67]
ds_read_b64_tr_b16 v[44:45],v7 offset:5120
v_mfma_f32_16x16x32_bf16 v[68:71],v[28:31],v[28:31],v[68:71]
ds_read_b64_tr_b16 v[46:47],v7 offset:5632
s_waitcnt lgkmcnt(8)
v_mfma_f32_16x16x32_bf16 v[60:63],v[96:99],v[32:35],v[60:63]
ds_read_b128 v[24:27],v17 offset:12288
v_mfma_f32_16x16x32_bf16 v[64:67],v[100:103],v[32:35],v[64:67]
ds_read_b128 v[28:31],v17 offset:13312
v_mfma_f32_16x16x32_bf16 v[68:71],v[32:35],v[32:35],v[68:71]
s_waitcnt lgkmcnt(8)
v_mfma_f32_16x16x32_bf16 v[60:63],v[104:107],v[36:39],v[60:63]
ds_read_b128 v[32:35],v17 offset:14336
v_mfma_f32_16x16x32_bf16 v[64:67],v[108:111],v[36:39],v[64:67]
v_mfma_f32_16x16x32_bf16 v[68:71],v[36:39],v[36:39],v[68:71]
s_waitcnt lgkmcnt(7)
v_mfma_f32_16x16x32_bf16 v[60:63],v[72:75],v[40:43],v[60:63]
ds_read_b128 v[36:39],v17 offset:15360
v_mfma_f32_16x16x32_bf16 v[64:67],v[76:79],v[40:43],v[64:67]
v_mfma_f32_16x16x32_bf16 v[68:71],v[40:43],v[40:43],v[68:71]
s_waitcnt lgkmcnt(4)
v_mfma_f32_16x16x32_bf16 v[60:63],v[80:83],v[44:47],v[60:63]
v_mfma_f32_16x16x32_bf16 v[64:67],v[84:87],v[44:47],v[64:67]
buffer_load_dwordx4 v[48:51],v1,s[8:11],s71 offen sc1
v_mfma_f32_16x16x32_bf16 v[68:71],v[44:47],v[44:47],v[68:71]
s_nop 4
v_cndmask_b32_dpp v60,v64,v60,vcc quad_perm:[2,3,2,3] row_mask:0xf bank_mask:0xf
v_cndmask_b32_dpp v61,v65,v61,vcc quad_perm:[2,3,2,3] row_mask:0xf bank_mask:0xf
v_cndmask_b32_dpp v62,v66,v62,vcc quad_perm:[2,3,2,3] row_mask:0xf bank_mask:0xf
v_cndmask_b32_dpp v63,v67,v63,vcc quad_perm:[2,3,2,3] row_mask:0xf bank_mask:0xf
v_max3_f32 v12,v60,v61,v62
v_cndmask_b32_dpp v68,v69,v68,vcc quad_perm:[2,3,2,3] row_mask:0xf bank_mask:0xf
v_max3_f32 v12,v12,v63,v68
s_nop 1
v_max_f32_dpp v13,v12,v12 quad_perm:[2,3,0,1] row_mask:0xf bank_mask:0xf
v_max_f32_dpp v12,v12,v12 quad_perm:[2,3,0,1] row_mask:0xf bank_mask:0xf
s_nop 1
v_permlane32_swap_b32 v12,v13
v_max_f32 v15,v12,v13
v_max_f32 v12,v12,v13
s_mov_b64 exec,1
buffer_store_dword v16,v1,s[8:11],s72 offen
s_mov_b64 exec,-1
v_permlane16_swap_b32 v12,v15
v_max_f32 v12,v12,v15
v_mul_f32 v12,s87,v12
v_fma_f32 v60,v60,s87,-v12
v_fma_f32 v61,v61,s87,-v12
v_fma_f32 v62,v62,s87,-v12
v_fma_f32 v63,v63,s87,-v12
v_fma_f32 v68,v68,s87,-v12
v_exp_f32 v60,v60
v_exp_f32 v61,v61
v_exp_f32 v62,v62
v_exp_f32 v63,v63
v_exp_f32 v68,v68
v_cvt_pk_bf16_f32 v70,v60,v61
v_cvt_pk_bf16_f32 v71,v62,v63
v_cndmask_b32 v46,v70,v10,vcc
v_cndmask_b32 v47,v71,v10,vcc
v_cndmask_b32_dpp v44,v70,v10,vcc quad_perm:[2,3,0,1] row_mask:0xf bank_mask:0xf
v_cndmask_b32_dpp v45,v71,v10,vcc quad_perm:[2,3,0,1] row_mask:0xf bank_mask:0xf
s_mov_b64 vcc,s[90:91]
s_waitcnt lgkmcnt(0)
v_cndmask_b32 v40,v70,v10,vcc
v_mfma_f32_16x16x32_bf16 v[64:67],v[28:31],v[44:47],0
v_cndmask_b32 v41,v71,v10,vcc
v_cndmask_b32_dpp v42,v70,v10,vcc quad_perm:[2,3,0,1] row_mask:0xf bank_mask:0xf
v_mfma_f32_16x16x32_bf16 v[52:55],v[36:39],v[44:47],0
v_cndmask_b32_dpp v43,v71,v10,vcc quad_perm:[2,3,0,1] row_mask:0xf bank_mask:0xf
v_mov_b32_dpp v14,v68 quad_perm:[2,3,0,1] row_mask:0xf bank_mask:0xf
v_add_f32 v12,v60,v61
v_mfma_f32_16x16x32_bf16 v[64:67],v[24:27],v[40:43],v[64:67]
v_cvt_pk_bf16_f32 v56,v68,v14
v_cvt_pk_bf16_f32 v57,v14,v68
v_mfma_f32_16x16x32_bf16 v[52:55],v[32:35],v[40:43],v[52:55]
v_cndmask_b32 v56,v56,v10,vcc
v_cndmask_b32 v57,v10,v57,vcc
ds_read_b32 v0,v9
v_add_f32 v13,v62,v63
v_add_f32 v12,v12,v68
v_add_f32 v12,v12,v13
s_waitcnt vmcnt(1)
v_bitop3_b32 v17,v48,v50,s57 bitop3:0x7e
v_add_f32_dpp v13,v12,v12 quad_perm:[2,3,0,1] row_mask:0xf bank_mask:0xf
v_and_b32 v17,1,v17
v_add_f32_dpp v12,v12,v12 quad_perm:[2,3,0,1] row_mask:0xf bank_mask:0xf
v_cmp_ne_u32 vcc,0,v17
s_cbranch_vccnz vb_93
vo_94:
v_mfma_f32_16x16x16_bf16 v[64:67],v[48:49],v[56:57],v[64:67]
v_permlane32_swap_b32 v12,v13
v_add_f32 v15,v12,v13
v_mfma_f32_16x16x16_bf16 v[52:55],v[50:51],v[56:57],v[52:55]
v_add_f32 v12,v12,v13
s_nop 1
v_permlane16_swap_b32 v12,v15
v_add_f32 v12,v12,v15
v_rcp_f32 v12,v12
s_nop 0
v_mul_f32 v64,v64,v12
v_mul_f32 v65,v65,v12
v_mul_f32 v66,v66,v12
v_mul_f32 v67,v67,v12
v_mul_f32 v52,v52,v12
v_mul_f32 v53,v53,v12
v_mul_f32 v54,v54,v12
v_mul_f32 v55,v55,v12
v_cvt_pk_bf16_f32 v48,v64,v65
v_cvt_pk_bf16_f32 v49,v66,v67
v_cvt_pk_bf16_f32 v50,v52,v53
v_cvt_pk_bf16_f32 v51,v54,v55
v_and_or_b32 v48,v48,-2,s57
buffer_store_dwordx4 v[48:51],v8,s[8:11],s70 offen
s_mov_b32 s57,s31
v_mov_b32 v12,s50
s_waitcnt lgkmcnt(0)
v_cmp_ne_u32 vcc,s50,v0
ds_write_b32 v20,v12
s_cmp_lt_u32 s50,128
s_cbranch_scc1 CS_LOOP_F
s_branch CS_DONE
fr_91:
v_bitop3_b32 v12,v72,v76,s57 bitop3:0x7e
v_bitop3_b32 v13,v80,v80,s57 bitop3:0x7e
v_xor_b32 v14,s57,v80
v_or3_b32 v12,v12,v13,v14
v_and_b32 v12,1,v12
v_cmp_ne_u32 vcc,0,v12
s_cbranch_vccz sk_95
buffer_load_dwordx2 v[80:81],v18,s[8:11],s59 offen sc1
buffer_load_dwordx4 v[72:75],v1,s[8:11],s59 offen sc1
buffer_load_dwordx4 v[76:79],v1,s[8:11],s59 offen offset:1024 sc1
sk_95:
buffer_load_dwordx2 v[90:91],v18,s[8:11],s68 offen sc1
buffer_load_dwordx4 v[82:85],v1,s[8:11],s68 offen sc1
buffer_load_dwordx4 v[86:89],v1,s[8:11],s68 offen offset:1024 sc1
s_sub_u32 s47,s47,1
s_cbranch_scc1 ABORT
s_waitcnt lgkmcnt(0)
s_branch fa_90
vb_93:
s_sub_u32 s47,s47,1
s_cbranch_scc1 ABORT
buffer_load_dwordx4 v[48:51],v1,s[8:11],s71 offen sc1
s_waitcnt vmcnt(0)
v_bitop3_b32 v17,v48,v50,s57 bitop3:0x7e
v_and_b32 v17,1,v17
v_cmp_ne_u32 vcc,0,v17
s_nop 0
s_cbranch_vccnz vb_93
s_branch vo_94
CS_LOOP_S:
s_barrier
buffer_load_dwordx2 v[80:81],v18,s[8:11],s59 offen sc1
buffer_load_dwordx4 v[72:75],v1,s[8:11],s59 offen sc1
buffer_load_dwordx4 v[76:79],v1,s[8:11],s59 offen offset:1024 sc1
s_cbranch_vccz fj_98f
s_waitcnt vmcnt(2)
s_sleep 3
fj_98f:
buffer_load_dwordx2 v[90:91],v18,s[8:11],s68 offen sc1
buffer_load_dwordx4 v[82:85],v1,s[8:11],s68 offen sc1
buffer_load_dwordx4 v[86:89],v1,s[8:11],s68 offen offset:1024 sc1
v_mfma_f32_32x32x8_bf16 v[24:39],v[10:11],v[10:11],0
v_mfma_f32_16x16x16_bf16 v[40:43],v[10:11],v[10:11],0
v_mfma_f32_16x16x16_bf16 v[44:47],v[10:11],v[10:11],0
fj_98:
fa_96:
s_waitcnt vmcnt(5)
v_lshlrev_b32 v108,16,v80
v_and_b32 v109,0xffff0000,v80
v_lshlrev_b32 v110,16,v81
v_and_b32 v111,0xffff0000,v81
s_waitcnt vmcnt(4)
v_lshlrev_b32 v92,16,v72
v_and_b32 v93,0xffff0000,v72
v_lshlrev_b32 v94,16,v73
v_and_b32 v95,0xffff0000,v73
v_lshlrev_b32 v96,16,v74
v_and_b32 v97,0xffff0000,v74
v_lshlrev_b32 v98,16,v75
v_and_b32 v99,0xffff0000,v75
s_waitcnt vmcnt(3)
v_lshlrev_b32 v100,16,v76
v_and_b32 v101,0xffff0000,v76
v_lshlrev_b32 v102,16,v77
v_and_b32 v103,0xffff0000,v77
v_lshlrev_b32 v104,16,v78
v_and_b32 v105,0xffff0000,v78
v_lshlrev_b32 v106,16,v79
v_and_b32 v107,0xffff0000,v79
s_waitcnt vmcnt(2)
v_dot2c_f32_bf16 v108,s37,v90
v_dot2c_f32_bf16 v109,s81,v90
v_dot2c_f32_bf16 v110,s37,v91
v_dot2c_f32_bf16 v111,s81,v91
v_bitop3_b32 v16,v80,v90,s57 bitop3:0x7e
v_cvt_pk_bf16_f32 v56,v108,v109
s_nop 0
v_cvt_pk_bf16_f32 v57,v110,v111
ds_write_b64 v23,v[56:57]
s_waitcnt vmcnt(1)
v_dot2c_f32_bf16 v92,s37,v82
v_dot2c_f32_bf16 v93,s81,v82
v_dot2c_f32_bf16 v94,s37,v83
v_dot2c_f32_bf16 v95,s81,v83
v_dot2c_f32_bf16 v96,s37,v84
v_dot2c_f32_bf16 v97,s81,v84
v_dot2c_f32_bf16 v98,s37,v85
v_dot2c_f32_bf16 v99,s81,v85
v_bitop3_b32 v17,v72,v82,s57 bitop3:0x7e
v_or_b32 v16,v16,v17
v_cvt_pk_bf16_f32 v48,v92,v93
v_cvt_pk_bf16_f32 v49,v94,v95
v_cvt_pk_bf16_f32 v50,v96,v97
v_cvt_pk_bf16_f32 v51,v98,v99
ds_write_b128 v22,v[48:51] offset:0
s_waitcnt vmcnt(0)
v_dot2c_f32_bf16 v100,s37,v86
v_dot2c_f32_bf16 v101,s81,v86
v_dot2c_f32_bf16 v102,s37,v87
v_dot2c_f32_bf16 v103,s81,v87
v_dot2c_f32_bf16 v104,s37,v88
v_dot2c_f32_bf16 v105,s81,v88
v_dot2c_f32_bf16 v106,s37,v89
v_dot2c_f32_bf16 v107,s81,v89
v_bitop3_b32 v17,v76,v86,s57 bitop3:0x7e
v_bitop3_b32 v16,v16,v17,1 bitop3:0xa8
v_cmp_ne_u32 vcc,0,v16
v_cvt_pk_bf16_f32 v52,v100,v101
v_cvt_pk_bf16_f32 v53,v102,v103
v_cvt_pk_bf16_f32 v54,v104,v105
v_cvt_pk_bf16_f32 v55,v106,v107
ds_write_b128 v22,v[52:55] offset:1024
s_cbranch_vccnz fr_97
fj_98g:
v_smfmac_f32_16x16x64_bf16 v[24:27],v[48:51],a[0:7],v2
ds_read_b128 v[72:75],v21 offset:0
v_xor_b32 v58,57344,v58
v_smfmac_f32_16x16x64_bf16 v[28:31],v[48:51],a[8:15],v2
ds_read_b128 v[76:79],v21 offset:1024
s_sub_u32 s60,s4,s5
v_smfmac_f32_16x16x64_bf16 v[32:35],v[48:51],a[16:23],v2
ds_read_b128 v[80:83],v21 offset:2048
s_cmp_gt_i32 s60,13
v_smfmac_f32_16x16x64_bf16 v[36:39],v[48:51],a[24:31],v2
ds_read_b128 v[84:87],v21 offset:3072
s_cselect_b32 s53,1,0
s_waitcnt lgkmcnt(4)
s_barrier
v_smfmac_f32_16x16x64_bf16 v[40:43],v[48:51],a[32:39],v2
ds_read_b128 v[60:63],v3 offset:0
s_cmp_eq_u32 s4,64
v_smfmac_f32_16x16x64_bf16 v[24:27],v[52:55],a[40:47],v2
ds_read_b128 v[64:67],v3 offset:1024
s_cselect_b32 s53,1,s53
v_smfmac_f32_16x16x64_bf16 v[28:31],v[52:55],a[48:55],v2
ds_read_b128 v[68:71],v4 offset:0
s_cmp_eq_u32 s53,0
v_smfmac_f32_16x16x64_bf16 v[32:35],v[52:55],a[56:63],v2
s_cselect_b32 s54,s4,s5
s_addc_u32 s4,s4,0
s_add_u32 s5,s5,s53
v_smfmac_f32_16x16x64_bf16 v[36:39],v[52:55],a[64:71],v2
s_mul_i32 s73,s54,393216
s_add_u32 s73,s73,s84
s_sub_u32 s74,s75,s74
v_smfmac_f32_16x16x64_bf16 v[40:43],v[52:55],a[72:79],v2
s_mov_b32 m0,s74
s_and_b32 s60,s52,1
s_waitcnt lgkmcnt(5)
v_smfmac_f32_16x16x64_bf16 v[44:47],v[48:51],v[72:79],v2
ds_read_b128 v[72:75],v21 offset:4096
s_waitcnt lgkmcnt(4)
v_smfmac_f32_16x16x64_bf16 v[44:47],v[52:55],v[80:87],v2
ds_read_b128 v[76:79],v21 offset:5120
s_waitcnt lgkmcnt(4)
v_smfmac_f32_16x16x64_bf16 v[24:27],v[60:63],a[80:87],v2
ds_read_b128 v[80:83],v21 offset:6144
s_lshl2_add_u32 s60,s51,s60
v_smfmac_f32_16x16x64_bf16 v[28:31],v[60:63],a[88:95],v2
ds_read_b128 v[84:87],v21 offset:7168
s_mul_i32 s60,s60,49152
v_smfmac_f32_16x16x64_bf16 v[32:35],v[60:63],a[96:103],v2
s_add_u32 s71,s60,s34
s_add_u32 s70,s60,s33
s_lshl_b32 s60,s51,9
v_smfmac_f32_16x16x64_bf16 v[36:39],v[60:63],a[104:111],v2
s_add_u32 s72,s60,s35
buffer_load_dwordx4 v1,s[8:11],s73 offen sc1 lds
v_smfmac_f32_16x16x64_bf16 v[40:43],v[60:63],a[112:119],v2
buffer_load_dwordx4 v1,s[8:11],s73 offen offset:1024 sc1 lds
s_waitcnt lgkmcnt(2)
v_smfmac_f32_16x16x64_bf16 v[44:47],v[60:63],v[72:79],v2
ds_read_b128 v[60:63],v4 offset:1024
v_smfmac_f32_16x16x64_bf16 v[24:27],v[64:67],a[120:127],v2
ds_read_b128 v[72:75],v21 offset:8192
v_smfmac_f32_16x16x64_bf16 v[28:31],v[64:67],a[128:135],v2
ds_read_b128 v[76:79],v21 offset:9216
v_smfmac_f32_16x16x64_bf16 v[32:35],v[64:67],a[136:143],v2
buffer_load_dwordx4 v1,s[8:11],s73 offen offset:2048 sc1 lds
v_smfmac_f32_16x16x64_bf16 v[36:39],v[64:67],a[144:151],v2
buffer_load_dwordx4 v1,s[8:11],s73 offen offset:3072 sc1 lds
v_add_u32 v17,s85,v58
v_smfmac_f32_16x16x64_bf16 v[40:43],v[64:67],a[152:159],v2
v_mov_b32 v16,s58
s_and_b32 s60,s54,1
s_waitcnt lgkmcnt(3)
v_smfmac_f32_16x16x64_bf16 v[44:47],v[64:67],v[80:87],v2
ds_read_b128 v[64:67],v5 offset:0
s_lshl2_add_u32 s60,s53,s60
v_smfmac_f32_16x16x64_bf16 v[24:27],v[68:71],a[160:167],v2
ds_read_b128 v[80:83],v21 offset:10240
s_lshl_b32 s68,s60,16
v_smfmac_f32_16x16x64_bf16 v[28:31],v[68:71],a[168:175],v2
ds_read_b128 v[84:87],v21 offset:11264
s_add_u32 s68,s68,s83
v_smfmac_f32_16x16x64_bf16 v[32:35],v[68:71],a[176:183],v2
s_mul_i32 s59,s60,20480
s_add_u32 s59,s59,s6
s_lshl_b32 s69,s53,9
v_smfmac_f32_16x16x64_bf16 v[36:39],v[68:71],a[184:191],v2
s_add_u32 s69,s69,s7
s_bfe_u32 s31,s54,65537
s_add_u32 s32,s54,1
v_smfmac_f32_16x16x64_bf16 v[40:43],v[68:71],a[192:199],v2
s_add_u32 s50,s50,1
s_mov_b32 s51,s53
s_waitcnt lgkmcnt(3)
v_smfmac_f32_16x16x64_bf16 v[44:47],v[68:71],v[72:79],v2
ds_read_b128 v[68:71],v5 offset:1024
s_mov_b32 s52,s54
v_smfmac_f32_16x16x64_bf16 v[24:27],v[60:63],a[200:207],v2
ds_read_b128 v[72:75],v21 offset:12288
s_mov_b32 s58,s32
v_smfmac_f32_16x16x64_bf16 v[28:31],v[60:63],a[208:215],v2
ds_read_b128 v[76:79],v21 offset:13312
s_mov_b64 vcc,s[88:89]
v_smfmac_f32_16x16x64_bf16 v[32:35],v[60:63],a[216:223],v2
ds_read_b128 v[48:51],v58 offset:0
v_smfmac_f32_16x16x64_bf16 v[36:39],v[60:63],a[224:231],v2
v_smfmac_f32_16x16x64_bf16 v[40:43],v[60:63],a[232:239],v2
ds_read_b128 v[52:55],v58 offset:1024
s_waitcnt lgkmcnt(5)
v_smfmac_f32_16x16x64_bf16 v[44:47],v[60:63],v[80:87],v2
ds_read_b128 v[60:63],v59 offset:0
v_smfmac_f32_16x16x64_bf16 v[24:27],v[64:67],a[240:247],v2
ds_read_b128 v[80:83],v21 offset:14336
v_smfmac_f32_16x16x64_bf16 v[28:31],v[64:67],a[248:255],v2
ds_read_b128 v[84:87],v21 offset:15360
v_smfmac_f32_16x16x64_bf16 v[32:35],v[64:67],v[112:119],v2
ds_read_b128 v[88:91],v58 offset:2048
v_smfmac_f32_16x16x64_bf16 v[36:39],v[64:67],v[120:127],v2
v_smfmac_f32_16x16x64_bf16 v[40:43],v[64:67],v[128:135],v2
ds_read_b128 v[92:95],v58 offset:3072
s_waitcnt lgkmcnt(7)
v_smfmac_f32_16x16x64_bf16 v[44:47],v[64:67],v[72:79],v2
ds_read_b128 v[64:67],v59 offset:1024
v_smfmac_f32_16x16x64_bf16 v[24:27],v[68:71],v[136:143],v2
ds_read_b128 v[72:75],v21 offset:16384
v_smfmac_f32_16x16x64_bf16 v[28:31],v[68:71],v[144:151],v2
ds_read_b128 v[76:79],v21 offset:17408
v_smfmac_f32_16x16x64_bf16 v[32:35],v[68:71],v[152:159],v2
ds_read_b128 v[96:99],v58 offset:4096
v_smfmac_f32_16x16x64_bf16 v[36:39],v[68:71],v[160:167],v2
v_smfmac_f32_16x16x64_bf16 v[40:43],v[68:71],v[168:175],v2
ds_read_b128 v[100:103],v58 offset:5120
s_waitcnt lgkmcnt(7)
v_smfmac_f32_16x16x64_bf16 v[44:47],v[68:71],v[80:87],v2
ds_read_b128 v[80:83],v21 offset:18432
v_smfmac_f32_16x16x64_bf16 v[24:27],v[60:63],v[176:183],v2
ds_read_b128 v[84:87],v21 offset:19456
v_smfmac_f32_16x16x64_bf16 v[36:39],v[60:63],v[200:207],v2
ds_read_b128 v[104:107],v58 offset:6144
s_waitcnt lgkmcnt(7)
v_smfmac_f32_16x16x64_bf16 v[24:27],v[64:67],v[216:223],v2
v_smfmac_f32_16x16x64_bf16 v[36:39],v[64:67],v[240:247],v2
ds_read_b128 v[108:111],v58 offset:7168
v_smfmac_f32_16x16x64_bf16 v[28:31],v[60:63],v[184:191],v2
v_smfmac_f32_16x16x64_bf16 v[40:43],v[60:63],v[208:215],v2
v_add_f32 v24,v24,v25
v_smfmac_f32_16x16x64_bf16 v[28:31],v[64:67],v[224:231],v2
v_add_f32 v26,v26,v27
v_smfmac_f32_16x16x64_bf16 v[40:43],v[64:67],v[248:255],v2
v_add_f32 v36,v36,v37
v_smfmac_f32_16x16x64_bf16 v[32:35],v[60:63],v[192:199],v2
v_add_f32 v38,v38,v39
s_waitcnt lgkmcnt(6)
v_smfmac_f32_16x16x64_bf16 v[44:47],v[60:63],v[72:79],v2
v_cvt_pk_bf16_f32 v37,v24,v26
v_smfmac_f32_16x16x64_bf16 v[32:35],v[64:67],v[232:239],v2
v_cvt_pk_bf16_f32 v36,v36,v38
s_waitcnt lgkmcnt(2)
v_smfmac_f32_16x16x64_bf16 v[44:47],v[64:67],v[80:87],v2
ds_write_b64 v6,v[36:37] offset:0
v_add_f32 v28,v28,v29
v_add_f32 v30,v30,v31
v_add_f32 v40,v40,v41
v_add_f32 v42,v42,v43
v_cvt_pk_bf16_f32 v41,v28,v30
v_cvt_pk_bf16_f32 v40,v40,v42
ds_write_b64 v6,v[40:41] offset:512
v_add_f32 v32,v32,v33
v_add_f32 v34,v34,v35
v_add_f32 v44,v44,v45
v_add_f32 v46,v46,v47
v_cvt_pk_bf16_f32 v45,v32,v34
v_cvt_pk_bf16_f32 v44,v44,v46
ds_write_b64 v6,v[44:45] offset:1024
ds_read_b128 v[72:75],v58 offset:8192
ds_read_b128 v[76:79],v58 offset:9216
s_waitcnt lgkmcnt(2)
s_barrier
ds_read_b64_tr_b16 v[24:25],v7 offset:0
ds_read_b64_tr_b16 v[26:27],v7 offset:512
ds_read_b64_tr_b16 v[28:29],v7 offset:1024
ds_read_b64_tr_b16 v[30:31],v7 offset:1536
ds_read_b64_tr_b16 v[32:33],v7 offset:2048
ds_read_b64_tr_b16 v[34:35],v7 offset:2560
ds_read_b64_tr_b16 v[36:37],v7 offset:3072
ds_read_b64_tr_b16 v[38:39],v7 offset:3584
s_waitcnt lgkmcnt(6)
v_mfma_f32_16x16x32_bf16 v[60:63],v[48:51],v[24:27],0
ds_read_b64_tr_b16 v[40:41],v7 offset:4096
v_mfma_f32_16x16x32_bf16 v[64:67],v[52:55],v[24:27],0
ds_read_b64_tr_b16 v[42:43],v7 offset:4608
v_mfma_f32_16x16x32_bf16 v[68:71],v[24:27],v[24:27],0
ds_read_b128 v[80:83],v58 offset:10240
s_waitcnt lgkmcnt(7)
v_mfma_f32_16x16x32_bf16 v[60:63],v[88:91],v[28:31],v[60:63]
ds_read_b128 v[84:87],v58 offset:11264
v_mfma_f32_16x16x32_bf16 v[64:67],v[92:95],v[28:31],v[64:67]
ds_read_b64_tr_b16 v[44:45],v7 offset:5120
v_mfma_f32_16x16x32_bf16 v[68:71],v[28:31],v[28:31],v[68:71]
ds_read_b64_tr_b16 v[46:47],v7 offset:5632
s_waitcnt lgkmcnt(8)
v_mfma_f32_16x16x32_bf16 v[60:63],v[96:99],v[32:35],v[60:63]
ds_read_b128 v[24:27],v17 offset:12288
v_mfma_f32_16x16x32_bf16 v[64:67],v[100:103],v[32:35],v[64:67]
ds_read_b128 v[28:31],v17 offset:13312
v_mfma_f32_16x16x32_bf16 v[68:71],v[32:35],v[32:35],v[68:71]
s_waitcnt lgkmcnt(8)
v_mfma_f32_16x16x32_bf16 v[60:63],v[104:107],v[36:39],v[60:63]
ds_read_b128 v[32:35],v17 offset:14336
v_mfma_f32_16x16x32_bf16 v[64:67],v[108:111],v[36:39],v[64:67]
v_mfma_f32_16x16x32_bf16 v[68:71],v[36:39],v[36:39],v[68:71]
s_waitcnt lgkmcnt(7)
v_mfma_f32_16x16x32_bf16 v[60:63],v[72:75],v[40:43],v[60:63]
ds_read_b128 v[36:39],v17 offset:15360
v_mfma_f32_16x16x32_bf16 v[64:67],v[76:79],v[40:43],v[64:67]
v_mfma_f32_16x16x32_bf16 v[68:71],v[40:43],v[40:43],v[68:71]
s_waitcnt lgkmcnt(4)
v_mfma_f32_16x16x32_bf16 v[60:63],v[80:83],v[44:47],v[60:63]
v_mfma_f32_16x16x32_bf16 v[64:67],v[84:87],v[44:47],v[64:67]
buffer_load_dwordx4 v[48:51],v1,s[8:11],s71 offen sc1
v_mfma_f32_16x16x32_bf16 v[68:71],v[44:47],v[44:47],v[68:71]
s_nop 4
v_cndmask_b32_dpp v60,v64,v60,vcc quad_perm:[2,3,2,3] row_mask:0xf bank_mask:0xf
v_cndmask_b32_dpp v61,v65,v61,vcc quad_perm:[2,3,2,3] row_mask:0xf bank_mask:0xf
v_cndmask_b32_dpp v62,v66,v62,vcc quad_perm:[2,3,2,3] row_mask:0xf bank_mask:0xf
v_cndmask_b32_dpp v63,v67,v63,vcc quad_perm:[2,3,2,3] row_mask:0xf bank_mask:0xf
v_max3_f32 v12,v60,v61,v62
v_cndmask_b32_dpp v68,v69,v68,vcc quad_perm:[2,3,2,3] row_mask:0xf bank_mask:0xf
v_max3_f32 v12,v12,v63,v68
s_nop 1
v_max_f32_dpp v13,v12,v12 quad_perm:[2,3,0,1] row_mask:0xf bank_mask:0xf
v_max_f32_dpp v12,v12,v12 quad_perm:[2,3,0,1] row_mask:0xf bank_mask:0xf
s_nop 1
v_permlane32_swap_b32 v12,v13
v_max_f32 v15,v12,v13
v_max_f32 v12,v12,v13
s_mov_b64 exec,1
buffer_store_dword v16,v1,s[8:11],s72 offen sc1
s_mov_b64 exec,-1
v_permlane16_swap_b32 v12,v15
v_max_f32 v12,v12,v15
v_mul_f32 v12,s87,v12
v_fma_f32 v60,v60,s87,-v12
v_fma_f32 v61,v61,s87,-v12
v_fma_f32 v62,v62,s87,-v12
v_fma_f32 v63,v63,s87,-v12
v_fma_f32 v68,v68,s87,-v12
v_exp_f32 v60,v60
v_exp_f32 v61,v61
v_exp_f32 v62,v62
v_exp_f32 v63,v63
v_exp_f32 v68,v68
v_cvt_pk_bf16_f32 v70,v60,v61
v_cvt_pk_bf16_f32 v71,v62,v63
v_cndmask_b32 v46,v70,v10,vcc
v_cndmask_b32 v47,v71,v10,vcc
v_cndmask_b32_dpp v44,v70,v10,vcc quad_perm:[2,3,0,1] row_mask:0xf bank_mask:0xf
v_cndmask_b32_dpp v45,v71,v10,vcc quad_perm:[2,3,0,1] row_mask:0xf bank_mask:0xf
s_mov_b64 vcc,s[90:91]
s_waitcnt lgkmcnt(0)
v_cndmask_b32 v40,v70,v10,vcc
v_mfma_f32_16x16x32_bf16 v[64:67],v[28:31],v[44:47],0
v_cndmask_b32 v41,v71,v10,vcc
v_cndmask_b32_dpp v42,v70,v10,vcc quad_perm:[2,3,0,1] row_mask:0xf bank_mask:0xf
v_mfma_f32_16x16x32_bf16 v[52:55],v[36:39],v[44:47],0
v_cndmask_b32_dpp v43,v71,v10,vcc quad_perm:[2,3,0,1] row_mask:0xf bank_mask:0xf
v_mov_b32_dpp v14,v68 quad_perm:[2,3,0,1] row_mask:0xf bank_mask:0xf
v_add_f32 v12,v60,v61
v_mfma_f32_16x16x32_bf16 v[64:67],v[24:27],v[40:43],v[64:67]
v_cvt_pk_bf16_f32 v56,v68,v14
v_cvt_pk_bf16_f32 v57,v14,v68
v_mfma_f32_16x16x32_bf16 v[52:55],v[32:35],v[40:43],v[52:55]
v_cndmask_b32 v56,v56,v10,vcc
v_cndmask_b32 v57,v10,v57,vcc
ds_read_b32 v0,v9
v_add_f32 v13,v62,v63
v_add_f32 v12,v12,v68
v_add_f32 v12,v12,v13
s_waitcnt vmcnt(1)
v_bitop3_b32 v17,v48,v50,s57 bitop3:0x7e
v_add_f32_dpp v13,v12,v12 quad_perm:[2,3,0,1] row_mask:0xf bank_mask:0xf
v_and_b32 v17,1,v17
v_add_f32_dpp v12,v12,v12 quad_perm:[2,3,0,1] row_mask:0xf bank_mask:0xf
v_cmp_ne_u32 vcc,0,v17
s_cbranch_vccnz vb_99
vo_100:
v_mfma_f32_16x16x16_bf16 v[64:67],v[48:49],v[56:57],v[64:67]
v_permlane32_swap_b32 v12,v13
v_add_f32 v15,v12,v13
v_mfma_f32_16x16x16_bf16 v[52:55],v[50:51],v[56:57],v[52:55]
v_add_f32 v12,v12,v13
s_nop 1
v_permlane16_swap_b32 v12,v15
v_add_f32 v12,v12,v15
v_rcp_f32 v12,v12
s_nop 0
v_mul_f32 v64,v64,v12
v_mul_f32 v65,v65,v12
v_mul_f32 v66,v66,v12
v_mul_f32 v67,v67,v12
v_mul_f32 v52,v52,v12
v_mul_f32 v53,v53,v12
v_mul_f32 v54,v54,v12
v_mul_f32 v55,v55,v12
v_cvt_pk_bf16_f32 v48,v64,v65
v_cvt_pk_bf16_f32 v49,v66,v67
v_cvt_pk_bf16_f32 v50,v52,v53
v_cvt_pk_bf16_f32 v51,v54,v55
v_and_or_b32 v48,v48,-2,s57
buffer_store_dwordx4 v[48:51],v8,s[8:11],s70 offen sc1
s_mov_b32 s57,s31
v_mov_b32 v12,s50
s_waitcnt lgkmcnt(0)
v_cmp_ne_u32 vcc,s50,v0
ds_write_b32 v20,v12
s_cmp_lt_u32 s50,128
s_cbranch_scc1 CS_LOOP_S
s_branch CS_DONE
fr_97:
v_bitop3_b32 v12,v72,v76,s57 bitop3:0x7e
v_bitop3_b32 v13,v80,v80,s57 bitop3:0x7e
v_xor_b32 v14,s57,v80
v_or3_b32 v12,v12,v13,v14
v_and_b32 v12,1,v12
v_cmp_ne_u32 vcc,0,v12
s_cbranch_vccz sk_101
buffer_load_dwordx2 v[80:81],v18,s[8:11],s59 offen sc1
buffer_load_dwordx4 v[72:75],v1,s[8:11],s59 offen sc1
buffer_load_dwordx4 v[76:79],v1,s[8:11],s59 offen offset:1024 sc1
sk_101:
buffer_load_dwordx2 v[90:91],v18,s[8:11],s68 offen sc1
buffer_load_dwordx4 v[82:85],v1,s[8:11],s68 offen sc1
buffer_load_dwordx4 v[86:89],v1,s[8:11],s68 offen offset:1024 sc1
s_sub_u32 s47,s47,1
s_cbranch_scc1 ABORT
s_waitcnt lgkmcnt(0)
s_branch fa_96
vb_99:
s_sub_u32 s47,s47,1
s_cbranch_scc1 ABORT
buffer_load_dwordx4 v[48:51],v1,s[8:11],s71 offen sc1
s_waitcnt vmcnt(0)
v_bitop3_b32 v17,v48,v50,s57 bitop3:0x7e
v_and_b32 v17,1,v17
v_cmp_ne_u32 vcc,0,v17
s_nop 0
s_cbranch_vccnz vb_99
s_branch vo_100
CH_START:
s_sub_u32 s60,s4,s5
s_cmp_gt_i32 s60,13
s_cselect_b32 s53,1,0
s_cmp_eq_u32 s4,64
s_cselect_b32 s53,1,s53
s_cmp_eq_u32 s53,0
s_cselect_b32 s54,s4,s5
s_addc_u32 s4,s4,0
s_add_u32 s5,s5,s53
s_sub_u32 s60,s4,s5
s_cmp_gt_i32 s60,13
s_cselect_b32 s55,1,0
s_cmp_eq_u32 s4,64
s_cselect_b32 s55,1,s55
s_cmp_eq_u32 s55,0
s_cselect_b32 s56,s4,s5
s_addc_u32 s4,s4,0
s_add_u32 s5,s5,s55
s_mov_b32 s74,81920
s_mul_i32 s73,s52,393216
s_add_u32 s73,s73,s84
s_lshl_b32 s75,s51,6
s_add_u32 s75,s75,s52
s_lshl_b32 s75,s75,9
s_add_u32 s75,s75,131072
fl_102:
buffer_load_dword v12,v9,s[8:11],s75 offen sc1
s_waitcnt vmcnt(0)
v_cmp_eq_u32 vcc,0,v12
s_nop 0
s_cbranch_vccz ok_103
s_sleep 1
s_sub_u32 s47,s47,1
s_cbranch_scc1 ABORT
s_branch fl_102
ok_103:
s_add_u32 m0,s74,0
s_add_u32 s67,s73,0
buffer_load_dwordx4 v1,s[8:11],s67 offen sc1 lds
buffer_load_dwordx4 v1,s[8:11],s67 offen offset:1024 sc1 lds
buffer_load_dwordx4 v1,s[8:11],s67 offen offset:2048 sc1 lds
buffer_load_dwordx4 v1,s[8:11],s67 offen offset:3072 sc1 lds
s_add_u32 m0,s74,4096
s_add_u32 s67,s73,4096
buffer_load_dwordx4 v1,s[8:11],s67 offen sc1 lds
buffer_load_dwordx4 v1,s[8:11],s67 offen offset:1024 sc1 lds
buffer_load_dwordx4 v1,s[8:11],s67 offen offset:2048 sc1 lds
buffer_load_dwordx4 v1,s[8:11],s67 offen offset:3072 sc1 lds
s_add_u32 m0,s74,8192
s_add_u32 s67,s73,8192
buffer_load_dwordx4 v1,s[8:11],s67 offen sc1 lds
buffer_load_dwordx4 v1,s[8:11],s67 offen offset:1024 sc1 lds
buffer_load_dwordx4 v1,s[8:11],s67 offen offset:2048 sc1 lds
buffer_load_dwordx4 v1,s[8:11],s67 offen offset:3072 sc1 lds
s_add_u32 m0,s74,12288
s_add_u32 s67,s73,25165824
buffer_load_dwordx4 v1,s[8:11],s67 offen sc1 lds
buffer_load_dwordx4 v1,s[8:11],s67 offen offset:1024 sc1 lds
buffer_load_dwordx4 v1,s[8:11],s67 offen offset:2048 sc1 lds
buffer_load_dwordx4 v1,s[8:11],s67 offen offset:3072 sc1 lds
s_add_u32 m0,s74,16384
s_add_u32 s67,s73,25169920
buffer_load_dwordx4 v1,s[8:11],s67 offen sc1 lds
buffer_load_dwordx4 v1,s[8:11],s67 offen offset:1024 sc1 lds
buffer_load_dwordx4 v1,s[8:11],s67 offen offset:2048 sc1 lds
buffer_load_dwordx4 v1,s[8:11],s67 offen offset:3072 sc1 lds
s_add_u32 m0,s74,20480
s_add_u32 s67,s73,25174016
buffer_load_dwordx4 v1,s[8:11],s67 offen sc1 lds
buffer_load_dwordx4 v1,s[8:11],s67 offen offset:1024 sc1 lds
buffer_load_dwordx4 v1,s[8:11],s67 offen offset:2048 sc1 lds
buffer_load_dwordx4 v1,s[8:11],s67 offen offset:3072 sc1 lds
s_mov_b32 s74,106496
s_mul_i32 s73,s54,393216
s_add_u32 s73,s73,s84
s_lshl_b32 s75,s53,6
s_add_u32 s75,s75,s54
s_lshl_b32 s75,s75,9
s_add_u32 s75,s75,131072
s_lshl_b32 s76,s55,6
s_add_u32 s76,s76,s56
s_lshl_b32 s76,s76,9
s_add_u32 s76,s76,131072
s_mov_b32 s77,1
v_min_u32 v8,2,v0
v_lshlrev_b32 v8,2,v8
v_add_u32 v8,147456,v8
v_mov_b32 v58,147468
s_mov_b32 s80,0
v_mov_b32 v24,0
v_mov_b32 v25,0
v_mov_b32 v26,0
v_mov_b32 v27,0
v_mov_b32 v28,0
v_mov_b32 v29,0
v_mov_b32 v30,0
v_mov_b32 v31,0
v_mov_b32 v32,0
v_mov_b32 v33,0
v_mov_b32 v34,0
v_mov_b32 v35,0
v_mov_b32 v36,0
v_mov_b32 v37,0
v_mov_b32 v38,0
v_mov_b32 v39,0
v_mov_b32 v40,0
v_mov_b32 v41,0
v_mov_b32 v42,0
v_mov_b32 v43,0
v_mov_b32 v44,0
v_mov_b32 v45,0
v_mov_b32 v46,0
v_mov_b32 v47,0
s_nop 1
CH_LOOP:
v_mov_b32 v14,s50
s_nop 1
db_107:
buffer_load_dword v12,v11,s[8:11],s69 offen sc1
s_waitcnt vmcnt(0)
v_cmp_gt_u32 vcc,s58,v12
s_cbranch_vccz dbok_108
s_sub_u32 s47,s47,1
s_cbranch_scc1 ABORT
s_branch db_107
dbok_108:
ds_write_b32 v58,v14
buffer_load_dwordx2 v[68:69],v18,s[8:11],s59 offen sc1
buffer_load_dwordx4 v[60:63],v1,s[8:11],s59 offen sc1
buffer_load_dwordx4 v[64:67],v1,s[8:11],s59 offen offset:1024 sc1
s_barrier
s_waitcnt vmcnt(2)
s_sleep 3
fj_106f:
buffer_load_dwordx2 v[78:79],v18,s[8:11],s68 offen sc1
buffer_load_dwordx4 v[70:73],v1,s[8:11],s68 offen sc1
buffer_load_dwordx4 v[74:77],v1,s[8:11],s68 offen offset:1024 sc1
s_mov_b64 vcc,s[90:91]
ds_read_b64_tr_b16 v[100:101],v7 offset:0
ds_read_b64_tr_b16 v[102:103],v7 offset:512
ds_read_b64_tr_b16 v[48:49],v7 offset:1024
ds_read_b64_tr_b16 v[50:51],v7 offset:1536
ds_read_b64_tr_b16 v[104:105],v7 offset:2048
ds_read_b64_tr_b16 v[106:107],v7 offset:2560
ds_read_b64_tr_b16 v[52:53],v7 offset:3072
ds_read_b64_tr_b16 v[54:55],v7 offset:3584
ds_read_b64_tr_b16 v[108:109],v7 offset:4096
ds_read_b64_tr_b16 v[110:111],v7 offset:4608
ds_read_b64_tr_b16 v[12:13],v7 offset:5120
ds_read_b64_tr_b16 v[14:15],v7 offset:5632
s_waitcnt lgkmcnt(8)
v_cndmask_b32_dpp v100,v48,v100,vcc quad_perm:[0,1,0,1] row_mask:0xf bank_mask:0xf
v_cndmask_b32_dpp v101,v49,v101,vcc quad_perm:[0,1,0,1] row_mask:0xf bank_mask:0xf
v_cndmask_b32_dpp v102,v50,v102,vcc quad_perm:[0,1,0,1] row_mask:0xf bank_mask:0xf
v_cndmask_b32_dpp v103,v51,v103,vcc quad_perm:[0,1,0,1] row_mask:0xf bank_mask:0xf
s_waitcnt lgkmcnt(4)
v_cndmask_b32_dpp v104,v52,v104,vcc quad_perm:[0,1,0,1] row_mask:0xf bank_mask:0xf
v_cndmask_b32_dpp v105,v53,v105,vcc quad_perm:[0,1,0,1] row_mask:0xf bank_mask:0xf
v_cndmask_b32_dpp v106,v54,v106,vcc quad_perm:[0,1,0,1] row_mask:0xf bank_mask:0xf
v_cndmask_b32_dpp v107,v55,v107,vcc quad_perm:[0,1,0,1] row_mask:0xf bank_mask:0xf
s_waitcnt lgkmcnt(0)
v_cndmask_b32_dpp v108,v12,v108,vcc quad_perm:[0,1,0,1] row_mask:0xf bank_mask:0xf
v_cndmask_b32_dpp v109,v13,v109,vcc quad_perm:[0,1,0,1] row_mask:0xf bank_mask:0xf
v_cndmask_b32_dpp v110,v14,v110,vcc quad_perm:[0,1,0,1] row_mask:0xf bank_mask:0xf
v_cndmask_b32_dpp v111,v15,v111,vcc quad_perm:[0,1,0,1] row_mask:0xf bank_mask:0xf
fj_106:
fa_104:
s_waitcnt vmcnt(5)
v_lshlrev_b32 v96,16,v68
v_and_b32 v97,0xffff0000,v68
v_lshlrev_b32 v98,16,v69
v_and_b32 v99,0xffff0000,v69
s_waitcnt vmcnt(4)
v_lshlrev_b32 v80,16,v60
v_and_b32 v81,0xffff0000,v60
v_lshlrev_b32 v82,16,v61
v_and_b32 v83,0xffff0000,v61
v_lshlrev_b32 v84,16,v62
v_and_b32 v85,0xffff0000,v62
v_lshlrev_b32 v86,16,v63
v_and_b32 v87,0xffff0000,v63
s_waitcnt vmcnt(3)
v_lshlrev_b32 v88,16,v64
v_and_b32 v89,0xffff0000,v64
v_lshlrev_b32 v90,16,v65
v_and_b32 v91,0xffff0000,v65
v_lshlrev_b32 v92,16,v66
v_and_b32 v93,0xffff0000,v66
v_lshlrev_b32 v94,16,v67
v_and_b32 v95,0xffff0000,v67
s_waitcnt vmcnt(2)
v_dot2c_f32_bf16 v96,s37,v78
v_dot2c_f32_bf16 v97,s81,v78
v_dot2c_f32_bf16 v98,s37,v79
v_dot2c_f32_bf16 v99,s81,v79
v_bitop3_b32 v16,v68,v78,s57 bitop3:0x7e
v_cvt_pk_bf16_f32 v56,v96,v97
s_nop 0
v_cvt_pk_bf16_f32 v57,v98,v99
ds_write_b64 v23,v[56:57]
s_waitcnt vmcnt(1)
v_dot2c_f32_bf16 v80,s37,v70
v_dot2c_f32_bf16 v81,s81,v70
v_dot2c_f32_bf16 v82,s37,v71
v_dot2c_f32_bf16 v83,s81,v71
v_dot2c_f32_bf16 v84,s37,v72
v_dot2c_f32_bf16 v85,s81,v72
v_dot2c_f32_bf16 v86,s37,v73
v_dot2c_f32_bf16 v87,s81,v73
v_bitop3_b32 v17,v60,v70,s57 bitop3:0x7e
v_or_b32 v16,v16,v17
v_cvt_pk_bf16_f32 v48,v80,v81
v_cvt_pk_bf16_f32 v49,v82,v83
v_cvt_pk_bf16_f32 v50,v84,v85
v_cvt_pk_bf16_f32 v51,v86,v87
ds_write_b128 v22,v[48:51] offset:0
s_waitcnt vmcnt(0)
v_dot2c_f32_bf16 v88,s37,v74
v_dot2c_f32_bf16 v89,s81,v74
v_dot2c_f32_bf16 v90,s37,v75
v_dot2c_f32_bf16 v91,s81,v75
v_dot2c_f32_bf16 v92,s37,v76
v_dot2c_f32_bf16 v93,s81,v76
v_dot2c_f32_bf16 v94,s37,v77
v_dot2c_f32_bf16 v95,s81,v77
v_bitop3_b32 v17,v64,v74,s57 bitop3:0x7e
v_bitop3_b32 v16,v16,v17,1 bitop3:0xa8
v_cmp_ne_u32 vcc,0,v16
v_cvt_pk_bf16_f32 v52,v88,v89
v_cvt_pk_bf16_f32 v53,v90,v91
v_cvt_pk_bf16_f32 v54,v92,v93
v_cvt_pk_bf16_f32 v55,v94,v95
ds_write_b128 v22,v[52:55] offset:1024
s_cbranch_vccnz fr_105
fj_106g:
v_smfmac_f32_16x16x64_bf16 v[24:27],v[48:51],a[0:7],v2
ds_read_b128 v[72:75],v21 offset:0
s_and_b32 s60,s54,1
v_smfmac_f32_16x16x64_bf16 v[28:31],v[48:51],a[8:15],v2
ds_read_b128 v[76:79],v21 offset:1024
s_lshl2_add_u32 s60,s53,s60
v_smfmac_f32_16x16x64_bf16 v[32:35],v[48:51],a[16:23],v2
ds_read_b128 v[80:83],v21 offset:2048
s_lshl_b32 s68,s60,16
v_smfmac_f32_16x16x64_bf16 v[36:39],v[48:51],a[24:31],v2
ds_read_b128 v[84:87],v21 offset:3072
s_add_u32 s68,s68,s83
s_waitcnt lgkmcnt(4)
s_barrier
v_smfmac_f32_16x16x64_bf16 v[40:43],v[48:51],a[32:39],v2
ds_read_b128 v[60:63],v3 offset:0
s_mul_i32 s59,s60,20480
v_smfmac_f32_16x16x64_bf16 v[24:27],v[52:55],a[40:47],v2
ds_read_b128 v[64:67],v3 offset:1024
s_add_u32 s59,s59,s6
v_smfmac_f32_16x16x64_bf16 v[28:31],v[52:55],a[48:55],v2
ds_read_b128 v[68:71],v4 offset:0
s_lshl_b32 s69,s53,9
v_smfmac_f32_16x16x64_bf16 v[32:35],v[52:55],a[56:63],v2
s_add_u32 m0,s74,12288
s_add_u32 s67,s73,25165824
s_add_u32 s69,s69,s7
v_smfmac_f32_16x16x64_bf16 v[36:39],v[52:55],a[64:71],v2
buffer_load_dwordx4 v1,s[8:11],s67 offen sc1 lds
s_bfe_u32 s31,s54,65537
v_smfmac_f32_16x16x64_bf16 v[40:43],v[52:55],a[72:79],v2
buffer_load_dwordx4 v1,s[8:11],s67 offen offset:1024 sc1 lds
s_waitcnt lgkmcnt(5)
v_smfmac_f32_16x16x64_bf16 v[44:47],v[48:51],v[72:79],v2
ds_read_b128 v[72:75],v21 offset:4096
s_waitcnt lgkmcnt(4)
v_smfmac_f32_16x16x64_bf16 v[44:47],v[52:55],v[80:87],v2
ds_read_b128 v[76:79],v21 offset:5120
s_waitcnt lgkmcnt(4)
v_smfmac_f32_16x16x64_bf16 v[24:27],v[60:63],a[80:87],v2
ds_read_b128 v[80:83],v21 offset:6144
s_add_u32 s32,s54,1
v_smfmac_f32_16x16x64_bf16 v[28:31],v[60:63],a[88:95],v2
ds_read_b128 v[84:87],v21 offset:7168
v_smfmac_f32_16x16x64_bf16 v[32:35],v[60:63],a[96:103],v2
buffer_load_dwordx4 v1,s[8:11],s67 offen offset:2048 sc1 lds
v_smfmac_f32_16x16x64_bf16 v[36:39],v[60:63],a[104:111],v2
buffer_load_dwordx4 v1,s[8:11],s67 offen offset:3072 sc1 lds
v_smfmac_f32_16x16x64_bf16 v[40:43],v[60:63],a[112:119],v2
s_add_u32 m0,s74,16384
s_add_u32 s67,s73,25169920
s_waitcnt lgkmcnt(2)
v_smfmac_f32_16x16x64_bf16 v[44:47],v[60:63],v[72:79],v2
ds_read_b128 v[60:63],v4 offset:1024
v_smfmac_f32_16x16x64_bf16 v[24:27],v[64:67],a[120:127],v2
ds_read_b128 v[72:75],v21 offset:8192
v_smfmac_f32_16x16x64_bf16 v[28:31],v[64:67],a[128:135],v2
ds_read_b128 v[76:79],v21 offset:9216
v_smfmac_f32_16x16x64_bf16 v[32:35],v[64:67],a[136:143],v2
v_mov_b32 v17,1
buffer_load_dwordx4 v1,s[8:11],s67 offen sc1 lds
v_smfmac_f32_16x16x64_bf16 v[36:39],v[64:67],a[144:151],v2
s_mov_b64 exec,1
buffer_store_dword v17,v1,s[8:11],s79 offen sc1
s_mov_b64 exec,-1
v_smfmac_f32_16x16x64_bf16 v[40:43],v[64:67],a[152:159],v2
buffer_store_dwordx4 v[100:103],v20,s[8:11],s78 offen sc1
s_waitcnt lgkmcnt(3)
v_smfmac_f32_16x16x64_bf16 v[44:47],v[64:67],v[80:87],v2
ds_read_b128 v[64:67],v5 offset:0
v_smfmac_f32_16x16x64_bf16 v[24:27],v[68:71],a[160:167],v2
ds_read_b128 v[80:83],v21 offset:10240
v_smfmac_f32_16x16x64_bf16 v[28:31],v[68:71],a[168:175],v2
ds_read_b128 v[84:87],v21 offset:11264
v_smfmac_f32_16x16x64_bf16 v[32:35],v[68:71],a[176:183],v2
buffer_store_dwordx4 v[104:107],v20,s[8:11],s78 offen offset:1024 sc1
v_smfmac_f32_16x16x64_bf16 v[36:39],v[68:71],a[184:191],v2
buffer_store_dwordx4 v[108:111],v20,s[8:11],s78 offen offset:2048 sc1
s_and_b32 s79,s78,2147483648
v_smfmac_f32_16x16x64_bf16 v[40:43],v[68:71],a[192:199],v2
s_or_b32 s79,s79,s30
s_mov_b32 s78,2147483648
s_waitcnt lgkmcnt(3)
v_smfmac_f32_16x16x64_bf16 v[44:47],v[68:71],v[72:79],v2
ds_read_b128 v[68:71],v5 offset:1024
v_smfmac_f32_16x16x64_bf16 v[24:27],v[60:63],a[200:207],v2
ds_read_b128 v[72:75],v21 offset:12288
v_smfmac_f32_16x16x64_bf16 v[28:31],v[60:63],a[208:215],v2
ds_read_b128 v[76:79],v21 offset:13312
v_smfmac_f32_16x16x64_bf16 v[32:35],v[60:63],a[216:223],v2
buffer_load_dword v10,v9,s[8:11],s76 offen sc1
v_smfmac_f32_16x16x64_bf16 v[36:39],v[60:63],a[224:231],v2
buffer_load_dwordx4 v1,s[8:11],s67 offen offset:1024 sc1 lds
v_smfmac_f32_16x16x64_bf16 v[40:43],v[60:63],a[232:239],v2
buffer_load_dwordx4 v1,s[8:11],s67 offen offset:2048 sc1 lds
s_waitcnt lgkmcnt(3)
v_smfmac_f32_16x16x64_bf16 v[44:47],v[60:63],v[80:87],v2
ds_read_b128 v[60:63],v59 offset:0
v_smfmac_f32_16x16x64_bf16 v[24:27],v[64:67],a[240:247],v2
ds_read_b128 v[80:83],v21 offset:14336
v_smfmac_f32_16x16x64_bf16 v[28:31],v[64:67],a[248:255],v2
ds_read_b128 v[84:87],v21 offset:15360
v_smfmac_f32_16x16x64_bf16 v[32:35],v[64:67],v[112:119],v2
buffer_load_dwordx4 v1,s[8:11],s67 offen offset:3072 sc1 lds
v_smfmac_f32_16x16x64_bf16 v[36:39],v[64:67],v[120:127],v2
s_add_u32 m0,s74,20480
s_add_u32 s67,s73,25174016
v_smfmac_f32_16x16x64_bf16 v[40:43],v[64:67],v[128:135],v2
buffer_load_dwordx4 v1,s[8:11],s67 offen sc1 lds
s_waitcnt lgkmcnt(3)
v_smfmac_f32_16x16x64_bf16 v[44:47],v[64:67],v[72:79],v2
ds_read_b128 v[64:67],v59 offset:1024
v_smfmac_f32_16x16x64_bf16 v[24:27],v[68:71],v[136:143],v2
ds_read_b128 v[72:75],v21 offset:16384
v_smfmac_f32_16x16x64_bf16 v[28:31],v[68:71],v[144:151],v2
ds_read_b128 v[76:79],v21 offset:17408
v_smfmac_f32_16x16x64_bf16 v[32:35],v[68:71],v[152:159],v2
buffer_load_dwordx4 v1,s[8:11],s67 offen offset:1024 sc1 lds
v_smfmac_f32_16x16x64_bf16 v[36:39],v[68:71],v[160:167],v2
buffer_load_dwordx4 v1,s[8:11],s67 offen offset:2048 sc1 lds
v_smfmac_f32_16x16x64_bf16 v[40:43],v[68:71],v[168:175],v2
buffer_load_dwordx4 v1,s[8:11],s67 offen offset:3072 sc1 lds
s_waitcnt lgkmcnt(3)
v_smfmac_f32_16x16x64_bf16 v[44:47],v[68:71],v[80:87],v2
ds_read_b128 v[80:83],v21 offset:18432
v_smfmac_f32_16x16x64_bf16 v[24:27],v[60:63],v[176:183],v2
ds_read_b128 v[84:87],v21 offset:19456
v_smfmac_f32_16x16x64_bf16 v[36:39],v[60:63],v[200:207],v2
s_waitcnt lgkmcnt(4)
v_smfmac_f32_16x16x64_bf16 v[24:27],v[64:67],v[216:223],v2
v_smfmac_f32_16x16x64_bf16 v[36:39],v[64:67],v[240:247],v2
v_smfmac_f32_16x16x64_bf16 v[28:31],v[60:63],v[184:191],v2
v_smfmac_f32_16x16x64_bf16 v[40:43],v[60:63],v[208:215],v2
v_add_f32 v24,v24,v25
v_smfmac_f32_16x16x64_bf16 v[28:31],v[64:67],v[224:231],v2
v_add_f32 v26,v26,v27
v_smfmac_f32_16x16x64_bf16 v[40:43],v[64:67],v[248:255],v2
v_add_f32 v36,v36,v37
v_smfmac_f32_16x16x64_bf16 v[32:35],v[60:63],v[192:199],v2
v_add_f32 v38,v38,v39
s_waitcnt lgkmcnt(2)
v_smfmac_f32_16x16x64_bf16 v[44:47],v[60:63],v[72:79],v2
v_cvt_pk_bf16_f32 v37,v24,v26
v_smfmac_f32_16x16x64_bf16 v[32:35],v[64:67],v[232:239],v2
v_cvt_pk_bf16_f32 v36,v36,v38
s_waitcnt lgkmcnt(0)
v_smfmac_f32_16x16x64_bf16 v[44:47],v[64:67],v[80:87],v2
ds_write_b64 v6,v[36:37] offset:0
v_add_f32 v28,v28,v29
v_add_f32 v30,v30,v31
v_add_f32 v40,v40,v41
v_add_f32 v42,v42,v43
v_cvt_pk_bf16_f32 v41,v28,v30
v_cvt_pk_bf16_f32 v40,v40,v42
ds_write_b64 v6,v[40:41] offset:512
v_add_f32 v32,v32,v33
v_add_f32 v34,v34,v35
v_add_f32 v44,v44,v45
v_add_f32 v46,v46,v47
v_cvt_pk_bf16_f32 v45,v32,v34
v_cvt_pk_bf16_f32 v44,v44,v46
ds_write_b64 v6,v[44:45] offset:1024
s_waitcnt lgkmcnt(0)
s_barrier
buffer_load_dword v16,v11,s[8:11],s69 offen sc1
s_lshl_b32 s60,s51,6
s_add_u32 s60,s60,s52
s_mul_i32 s78,s60,196608
s_add_u32 s78,s78,s85
s_lshl_b32 s60,s60,10
s_add_u32 s30,s60,s86
s_cmp_ge_u32 s54,63
s_cselect_b32 s77,0,s77
s_cmp_eq_u32 s53,s51
s_cselect_b32 s60,1,s77
s_cmp_eq_u32 s60,0
s_cbranch_scc0 h1_109
h2_110:
s_add_u32 s50,s50,1
s_mov_b32 s51,s53
s_mov_b32 s52,s54
s_mov_b32 s57,s31
s_mov_b32 s58,s32
s_mov_b32 s53,s55
s_mov_b32 s54,s56
s_mov_b32 s75,s76
s_sub_u32 s60,s4,s5
s_cmp_gt_i32 s60,13
s_cselect_b32 s55,1,0
s_cmp_eq_u32 s4,64
s_cselect_b32 s55,1,s55
s_cmp_eq_u32 s55,0
s_cselect_b32 s56,s4,s5
s_addc_u32 s4,s4,0
s_add_u32 s5,s5,s55
s_lshl_b32 s76,s55,6
s_add_u32 s76,s76,s56
s_lshl_b32 s76,s76,9
s_add_u32 s76,s76,131072
s_mul_i32 s73,s54,393216
s_add_u32 s73,s73,s84
s_xor_b32 s74,s74,57344
v_mov_b32 v24,0
v_mov_b32 v25,0
v_mov_b32 v26,0
v_mov_b32 v27,0
v_mov_b32 v28,0
v_mov_b32 v29,0
v_mov_b32 v30,0
v_mov_b32 v31,0
v_mov_b32 v32,0
v_mov_b32 v33,0
v_mov_b32 v34,0
v_mov_b32 v35,0
v_mov_b32 v36,0
v_mov_b32 v37,0
v_mov_b32 v38,0
v_mov_b32 v39,0
v_mov_b32 v40,0
v_mov_b32 v41,0
v_mov_b32 v42,0
v_mov_b32 v43,0
v_mov_b32 v44,0
v_mov_b32 v45,0
v_mov_b32 v46,0
v_mov_b32 v47,0
s_waitcnt vmcnt(0)
v_cmp_eq_u32 vcc,0,v10
s_cmp_lg_u64 vcc,0
s_cselect_b32 s77,1,0
v_cmp_gt_u32 vcc,s58,v16
s_nop 0
s_cbranch_vccz CH_RUNG
s_cmp_lt_u32 s50,128
s_cbranch_scc1 CH_LOOP
s_branch CS_DONE
h1_109:
s_mov_b64 vcc,s[90:91]
ds_read_b64_tr_b16 v[100:101],v7 offset:0
ds_read_b64_tr_b16 v[102:103],v7 offset:512
ds_read_b64_tr_b16 v[48:49],v7 offset:1024
ds_read_b64_tr_b16 v[50:51],v7 offset:1536
ds_read_b64_tr_b16 v[104:105],v7 offset:2048
ds_read_b64_tr_b16 v[106:107],v7 offset:2560
ds_read_b64_tr_b16 v[52:53],v7 offset:3072
ds_read_b64_tr_b16 v[54:55],v7 offset:3584
ds_read_b64_tr_b16 v[108:109],v7 offset:4096
ds_read_b64_tr_b16 v[110:111],v7 offset:4608
ds_read_b64_tr_b16 v[12:13],v7 offset:5120
ds_read_b64_tr_b16 v[14:15],v7 offset:5632
s_waitcnt lgkmcnt(8)
v_cndmask_b32_dpp v100,v48,v100,vcc quad_perm:[0,1,0,1] row_mask:0xf bank_mask:0xf
v_cndmask_b32_dpp v101,v49,v101,vcc quad_perm:[0,1,0,1] row_mask:0xf bank_mask:0xf
v_cndmask_b32_dpp v102,v50,v102,vcc quad_perm:[0,1,0,1] row_mask:0xf bank_mask:0xf
v_cndmask_b32_dpp v103,v51,v103,vcc quad_perm:[0,1,0,1] row_mask:0xf bank_mask:0xf
s_waitcnt lgkmcnt(4)
v_cndmask_b32_dpp v104,v52,v104,vcc quad_perm:[0,1,0,1] row_mask:0xf bank_mask:0xf
v_cndmask_b32_dpp v105,v53,v105,vcc quad_perm:[0,1,0,1] row_mask:0xf bank_mask:0xf
v_cndmask_b32_dpp v106,v54,v106,vcc quad_perm:[0,1,0,1] row_mask:0xf bank_mask:0xf
v_cndmask_b32_dpp v107,v55,v107,vcc quad_perm:[0,1,0,1] row_mask:0xf bank_mask:0xf
s_waitcnt lgkmcnt(0)
v_cndmask_b32_dpp v108,v12,v108,vcc quad_perm:[0,1,0,1] row_mask:0xf bank_mask:0xf
v_cndmask_b32_dpp v109,v13,v109,vcc quad_perm:[0,1,0,1] row_mask:0xf bank_mask:0xf
v_cndmask_b32_dpp v110,v14,v110,vcc quad_perm:[0,1,0,1] row_mask:0xf bank_mask:0xf
v_cndmask_b32_dpp v111,v15,v111,vcc quad_perm:[0,1,0,1] row_mask:0xf bank_mask:0xf
s_cmp_eq_u32 s50,127
s_cbranch_scc1 sp_111x
sp_111:
ds_read_b32 v12,v8
s_waitcnt lgkmcnt(0)
v_cmp_ge_u32 vcc,s50,v12
s_nop 0
s_cbranch_vccz ok_112
s_sleep 1
s_sub_u32 s47,s47,1
s_cbranch_scc1 ABORT
s_branch sp_111
ok_112:
sp_111x:
s_waitcnt vmcnt(0)
s_cmp_ge_u32 s79,2147483648
s_cbranch_scc1 pf_113
v_mov_b32 v17,1
s_mov_b64 exec,1
buffer_store_dword v17,v1,s[8:11],s79 offen sc1
s_mov_b64 exec,-1
s_mov_b32 s79,2147483648
pf_113:
s_cmp_eq_u32 s78,2147483648
s_cbranch_scc1 pk_114
buffer_store_dwordx4 v[100:103],v20,s[8:11],s78 offen sc1
buffer_store_dwordx4 v[104:107],v20,s[8:11],s78 offen offset:1024 sc1
buffer_store_dwordx4 v[108:111],v20,s[8:11],s78 offen offset:2048 sc1
s_mov_b32 s79,s30
s_mov_b32 s78,2147483648
pk_114:
s_waitcnt vmcnt(0)
s_cmp_ge_u32 s79,2147483648
s_cbranch_scc1 pf_115
v_mov_b32 v17,1
s_mov_b64 exec,1
buffer_store_dword v17,v1,s[8:11],s79 offen sc1
s_mov_b64 exec,-1
s_mov_b32 s79,2147483648
pf_115:
s_cmp_eq_u32 s77,0
s_cbranch_scc1 h2_110
fl_116:
buffer_load_dword v12,v9,s[8:11],s75 offen sc1
s_waitcnt vmcnt(0)
v_cmp_eq_u32 vcc,0,v12
s_nop 0
s_cbranch_vccz ok_117
s_sleep 1
s_sub_u32 s47,s47,1
s_cbranch_scc1 ABORT
s_branch fl_116
ok_117:
s_add_u32 m0,s74,0
s_add_u32 s67,s73,0
buffer_load_dwordx4 v1,s[8:11],s67 offen sc1 lds
buffer_load_dwordx4 v1,s[8:11],s67 offen offset:1024 sc1 lds
buffer_load_dwordx4 v1,s[8:11],s67 offen offset:2048 sc1 lds
buffer_load_dwordx4 v1,s[8:11],s67 offen offset:3072 sc1 lds
s_add_u32 m0,s74,4096
s_add_u32 s67,s73,4096
buffer_load_dwordx4 v1,s[8:11],s67 offen sc1 lds
buffer_load_dwordx4 v1,s[8:11],s67 offen offset:1024 sc1 lds
buffer_load_dwordx4 v1,s[8:11],s67 offen offset:2048 sc1 lds
buffer_load_dwordx4 v1,s[8:11],s67 offen offset:3072 sc1 lds
s_add_u32 m0,s74,8192
s_add_u32 s67,s73,8192
buffer_load_dwordx4 v1,s[8:11],s67 offen sc1 lds
buffer_load_dwordx4 v1,s[8:11],s67 offen offset:1024 sc1 lds
buffer_load_dwordx4 v1,s[8:11],s67 offen offset:2048 sc1 lds
buffer_load_dwordx4 v1,s[8:11],s67 offen offset:3072 sc1 lds
s_add_u32 m0,s74,12288
s_add_u32 s67,s73,25165824
buffer_load_dwordx4 v1,s[8:11],s67 offen sc1 lds
buffer_load_dwordx4 v1,s[8:11],s67 offen offset:1024 sc1 lds
buffer_load_dwordx4 v1,s[8:11],s67 offen offset:2048 sc1 lds
buffer_load_dwordx4 v1,s[8:11],s67 offen offset:3072 sc1 lds
s_add_u32 m0,s74,16384
s_add_u32 s67,s73,25169920
buffer_load_dwordx4 v1,s[8:11],s67 offen sc1 lds
buffer_load_dwordx4 v1,s[8:11],s67 offen offset:1024 sc1 lds
buffer_load_dwordx4 v1,s[8:11],s67 offen offset:2048 sc1 lds
buffer_load_dwordx4 v1,s[8:11],s67 offen offset:3072 sc1 lds
s_add_u32 m0,s74,20480
s_add_u32 s67,s73,25174016
buffer_load_dwordx4 v1,s[8:11],s67 offen sc1 lds
buffer_load_dwordx4 v1,s[8:11],s67 offen offset:1024 sc1 lds
buffer_load_dwordx4 v1,s[8:11],s67 offen offset:2048 sc1 lds
buffer_load_dwordx4 v1,s[8:11],s67 offen offset:3072 sc1 lds
s_branch h2_110
fr_105:
v_bitop3_b32 v12,v60,v64,s57 bitop3:0x7e
v_bitop3_b32 v13,v68,v68,s57 bitop3:0x7e
v_xor_b32 v14,s57,v68
v_or3_b32 v12,v12,v13,v14
v_and_b32 v12,1,v12
v_cmp_ne_u32 vcc,0,v12
s_cbranch_vccz sk_118
buffer_load_dwordx2 v[68:69],v18,s[8:11],s59 offen sc1
buffer_load_dwordx4 v[60:63],v1,s[8:11],s59 offen sc1
buffer_load_dwordx4 v[64:67],v1,s[8:11],s59 offen offset:1024 sc1
sk_118:
buffer_load_dwordx2 v[78:79],v18,s[8:11],s68 offen sc1
buffer_load_dwordx4 v[70:73],v1,s[8:11],s68 offen sc1
buffer_load_dwordx4 v[74:77],v1,s[8:11],s68 offen offset:1024 sc1
s_sub_u32 s47,s47,1
s_cbranch_scc1 ABORT
s_waitcnt lgkmcnt(0)
s_branch fa_104
CH_RUNG:
v_mov_b32 v14,s50
ds_write_b32 v58,v14
buffer_load_dwordx2 v[68:69],v18,s[8:11],s59 offen sc1
buffer_load_dwordx4 v[60:63],v1,s[8:11],s59 offen sc1
buffer_load_dwordx4 v[64:67],v1,s[8:11],s59 offen offset:1024 sc1
fj_106e:
buffer_load_dwordx2 v[78:79],v18,s[8:11],s68 offen sc1
buffer_load_dwordx4 v[70:73],v1,s[8:11],s68 offen sc1
buffer_load_dwordx4 v[74:77],v1,s[8:11],s68 offen offset:1024 sc1
s_mov_b64 vcc,s[90:91]
ds_read_b64_tr_b16 v[100:101],v7 offset:0
ds_read_b64_tr_b16 v[102:103],v7 offset:512
ds_read_b64_tr_b16 v[48:49],v7 offset:1024
ds_read_b64_tr_b16 v[50:51],v7 offset:1536
ds_read_b64_tr_b16 v[104:105],v7 offset:2048
ds_read_b64_tr_b16 v[106:107],v7 offset:2560
ds_read_b64_tr_b16 v[52:53],v7 offset:3072
ds_read_b64_tr_b16 v[54:55],v7 offset:3584
ds_read_b64_tr_b16 v[108:109],v7 offset:4096
ds_read_b64_tr_b16 v[110:111],v7 offset:4608
ds_read_b64_tr_b16 v[12:13],v7 offset:5120
ds_read_b64_tr_b16 v[14:15],v7 offset:5632
s_waitcnt lgkmcnt(8)
v_cndmask_b32_dpp v100,v48,v100,vcc quad_perm:[0,1,0,1] row_mask:0xf bank_mask:0xf
v_cndmask_b32_dpp v101,v49,v101,vcc quad_perm:[0,1,0,1] row_mask:0xf bank_mask:0xf
v_cndmask_b32_dpp v102,v50,v102,vcc quad_perm:[0,1,0,1] row_mask:0xf bank_mask:0xf
v_cndmask_b32_dpp v103,v51,v103,vcc quad_perm:[0,1,0,1] row_mask:0xf bank_mask:0xf
s_waitcnt lgkmcnt(4)
v_cndmask_b32_dpp v104,v52,v104,vcc quad_perm:[0,1,0,1] row_mask:0xf bank_mask:0xf
v_cndmask_b32_dpp v105,v53,v105,vcc quad_perm:[0,1,0,1] row_mask:0xf bank_mask:0xf
v_cndmask_b32_dpp v106,v54,v106,vcc quad_perm:[0,1,0,1] row_mask:0xf bank_mask:0xf
v_cndmask_b32_dpp v107,v55,v107,vcc quad_perm:[0,1,0,1] row_mask:0xf bank_mask:0xf
s_waitcnt lgkmcnt(0)
v_cndmask_b32_dpp v108,v12,v108,vcc quad_perm:[0,1,0,1] row_mask:0xf bank_mask:0xf
v_cndmask_b32_dpp v109,v13,v109,vcc quad_perm:[0,1,0,1] row_mask:0xf bank_mask:0xf
v_cndmask_b32_dpp v110,v14,v110,vcc quad_perm:[0,1,0,1] row_mask:0xf bank_mask:0xf
v_cndmask_b32_dpp v111,v15,v111,vcc quad_perm:[0,1,0,1] row_mask:0xf bank_mask:0xf
s_barrier
s_branch fj_106
CS_DONE:
v_lshrrev_b32 v0,4,v1
s_add_u32 s61,s48,0
s_endpgm
CV_START:
s_and_b32 s60,s46,1
s_lshl1_add_u32 s60,s49,s60
s_cmp_eq_u32 s60,1
s_cbranch_scc1 CV_LOOP_F1
s_cmp_eq_u32 s60,2
s_cbranch_scc1 CV_LOOP_S0
s_cmp_eq_u32 s60,3
s_cbranch_scc1 CV_LOOP_S1
CV_LOOP_F0:
v_mov_b32 v24,0
v_mov_b32 v25,0
v_mov_b32 v26,0
v_mov_b32 v27,0
v_mov_b32 v28,0
v_mov_b32 v29,0
v_mov_b32 v30,0
v_mov_b32 v31,0
v_mov_b32 v32,0
v_mov_b32 v33,0
v_mov_b32 v34,0
v_mov_b32 v35,0
v_mov_b32 v36,0
v_mov_b32 v37,0
v_mov_b32 v38,0
v_mov_b32 v39,0
v_mov_b32 v40,0
v_mov_b32 v41,0
v_mov_b32 v42,0
v_mov_b32 v43,0
v_mov_b32 v44,0
v_mov_b32 v45,0
v_mov_b32 v46,0
v_mov_b32 v47,0
s_cmp_lg_u32 s46,0
s_cbranch_scc1 np_122
db_123:
buffer_load_dword v12,v11,s[8:11],s69 offen sc1
s_waitcnt vmcnt(0)
v_cmp_gt_u32 vcc,s58,v12
s_cbranch_vccz dbok_124
s_sub_u32 s47,s47,1
s_cbranch_scc1 ABORT
s_branch db_123
dbok_124:
np_122:
s_barrier
buffer_load_dwordx2 v[68:69],v18,s[8:11],s59 offen sc1
buffer_load_dwordx4 v[60:63],v1,s[8:11],s59 offen sc1
buffer_load_dwordx4 v[64:67],v1,s[8:11],s59 offen offset:1024 sc1
s_waitcnt vmcnt(2)
s_sleep 3
fj_121f:
buffer_load_dwordx2 v[78:79],v18,s[8:11],s68 offen sc1
buffer_load_dwordx4 v[70:73],v1,s[8:11],s68 offen sc1
buffer_load_dwordx4 v[74:77],v1,s[8:11],s68 offen offset:1024 sc1
fj_121:
fa_119:
s_waitcnt vmcnt(5)
v_lshlrev_b32 v96,16,v68
v_and_b32 v97,0xffff0000,v68
v_lshlrev_b32 v98,16,v69
v_and_b32 v99,0xffff0000,v69
s_waitcnt vmcnt(4)
v_lshlrev_b32 v80,16,v60
v_and_b32 v81,0xffff0000,v60
v_lshlrev_b32 v82,16,v61
v_and_b32 v83,0xffff0000,v61
v_lshlrev_b32 v84,16,v62
v_and_b32 v85,0xffff0000,v62
v_lshlrev_b32 v86,16,v63
v_and_b32 v87,0xffff0000,v63
s_waitcnt vmcnt(3)
v_lshlrev_b32 v88,16,v64
v_and_b32 v89,0xffff0000,v64
v_lshlrev_b32 v90,16,v65
v_and_b32 v91,0xffff0000,v65
v_lshlrev_b32 v92,16,v66
v_and_b32 v93,0xffff0000,v66
v_lshlrev_b32 v94,16,v67
v_and_b32 v95,0xffff0000,v67
s_waitcnt vmcnt(2)
v_dot2c_f32_bf16 v96,s37,v78
v_dot2c_f32_bf16 v97,s81,v78
v_dot2c_f32_bf16 v98,s37,v79
v_dot2c_f32_bf16 v99,s81,v79
v_bitop3_b32 v16,v68,v78,s57 bitop3:0x7e
v_cvt_pk_bf16_f32 v56,v96,v97
s_nop 0
v_cvt_pk_bf16_f32 v57,v98,v99
ds_write_b64 v23,v[56:57]
s_waitcnt vmcnt(1)
v_dot2c_f32_bf16 v80,s37,v70
v_dot2c_f32_bf16 v81,s81,v70
v_dot2c_f32_bf16 v82,s37,v71
v_dot2c_f32_bf16 v83,s81,v71
v_dot2c_f32_bf16 v84,s37,v72
v_dot2c_f32_bf16 v85,s81,v72
v_dot2c_f32_bf16 v86,s37,v73
v_dot2c_f32_bf16 v87,s81,v73
v_bitop3_b32 v17,v60,v70,s57 bitop3:0x7e
v_or_b32 v16,v16,v17
v_cvt_pk_bf16_f32 v48,v80,v81
v_cvt_pk_bf16_f32 v49,v82,v83
v_cvt_pk_bf16_f32 v50,v84,v85
v_cvt_pk_bf16_f32 v51,v86,v87
ds_write_b128 v22,v[48:51] offset:0
s_waitcnt vmcnt(0)
v_dot2c_f32_bf16 v88,s37,v74
v_dot2c_f32_bf16 v89,s81,v74
v_dot2c_f32_bf16 v90,s37,v75
v_dot2c_f32_bf16 v91,s81,v75
v_dot2c_f32_bf16 v92,s37,v76
v_dot2c_f32_bf16 v93,s81,v76
v_dot2c_f32_bf16 v94,s37,v77
v_dot2c_f32_bf16 v95,s81,v77
v_bitop3_b32 v17,v64,v74,s57 bitop3:0x7e
v_bitop3_b32 v16,v16,v17,1 bitop3:0xa8
v_cmp_ne_u32 vcc,0,v16
v_cvt_pk_bf16_f32 v52,v88,v89
v_cvt_pk_bf16_f32 v53,v90,v91
v_cvt_pk_bf16_f32 v54,v92,v93
v_cvt_pk_bf16_f32 v55,v94,v95
ds_write_b128 v22,v[52:55] offset:1024
s_cbranch_vccnz fr_120
fj_121g:
v_smfmac_f32_16x16x64_bf16 v[24:27],v[48:51],a[0:7],v2
ds_read_b128 v[72:75],v21 offset:0
s_and_b32 s60,s52,1
v_smfmac_f32_16x16x64_bf16 v[28:31],v[48:51],a[8:15],v2
ds_read_b128 v[76:79],v21 offset:1024
s_lshl2_add_u32 s60,s51,s60
v_smfmac_f32_16x16x64_bf16 v[32:35],v[48:51],a[16:23],v2
ds_read_b128 v[80:83],v21 offset:2048
s_mul_i32 s60,s60,49152
v_smfmac_f32_16x16x64_bf16 v[36:39],v[48:51],a[24:31],v2
ds_read_b128 v[84:87],v21 offset:3072
s_add_u32 s71,s60,s34
s_waitcnt lgkmcnt(4)
s_barrier
v_smfmac_f32_16x16x64_bf16 v[40:43],v[48:51],a[32:39],v2
ds_read_b128 v[60:63],v3 offset:0
v_smfmac_f32_16x16x64_bf16 v[24:27],v[52:55],a[40:47],v2
ds_read_b128 v[64:67],v3 offset:1024
v_mov_b32 v17,1
v_smfmac_f32_16x16x64_bf16 v[28:31],v[52:55],a[48:55],v2
ds_read_b128 v[68:71],v4 offset:0
v_smfmac_f32_16x16x64_bf16 v[32:35],v[52:55],a[56:63],v2
s_mov_b64 exec,1
buffer_store_dword v17,v1,s[8:11],s79 offen sc1
s_mov_b64 exec,-1
v_smfmac_f32_16x16x64_bf16 v[36:39],v[52:55],a[64:71],v2
buffer_store_dwordx4 v[100:103],v6,s[8:11],s78 offen sc1
v_smfmac_f32_16x16x64_bf16 v[40:43],v[52:55],a[72:79],v2
buffer_store_dwordx2 v[104:105],v7,s[8:11],s78 offen sc1
s_waitcnt lgkmcnt(5)
v_smfmac_f32_16x16x64_bf16 v[44:47],v[48:51],v[72:79],v2
ds_read_b128 v[72:75],v21 offset:4096
s_waitcnt lgkmcnt(4)
v_smfmac_f32_16x16x64_bf16 v[44:47],v[52:55],v[80:87],v2
ds_read_b128 v[76:79],v21 offset:5120
s_waitcnt lgkmcnt(4)
v_smfmac_f32_16x16x64_bf16 v[24:27],v[60:63],a[80:87],v2
ds_read_b128 v[80:83],v21 offset:6144
s_and_b32 s79,s78,2147483648
v_smfmac_f32_16x16x64_bf16 v[28:31],v[60:63],a[88:95],v2
ds_read_b128 v[84:87],v21 offset:7168
s_or_b32 s79,s79,s30
v_smfmac_f32_16x16x64_bf16 v[32:35],v[60:63],a[96:103],v2
s_mov_b32 s78,2147483648
v_smfmac_f32_16x16x64_bf16 v[36:39],v[60:63],a[104:111],v2
v_smfmac_f32_16x16x64_bf16 v[40:43],v[60:63],a[112:119],v2
s_waitcnt lgkmcnt(2)
v_smfmac_f32_16x16x64_bf16 v[44:47],v[60:63],v[72:79],v2
ds_read_b128 v[60:63],v4 offset:1024
v_smfmac_f32_16x16x64_bf16 v[24:27],v[64:67],a[120:127],v2
ds_read_b128 v[72:75],v21 offset:8192
v_smfmac_f32_16x16x64_bf16 v[28:31],v[64:67],a[128:135],v2
ds_read_b128 v[76:79],v21 offset:9216
v_smfmac_f32_16x16x64_bf16 v[32:35],v[64:67],a[136:143],v2
v_smfmac_f32_16x16x64_bf16 v[36:39],v[64:67],a[144:151],v2
v_smfmac_f32_16x16x64_bf16 v[40:43],v[64:67],a[152:159],v2
s_waitcnt lgkmcnt(3)
v_smfmac_f32_16x16x64_bf16 v[44:47],v[64:67],v[80:87],v2
ds_read_b128 v[64:67],v5 offset:0
v_smfmac_f32_16x16x64_bf16 v[24:27],v[68:71],a[160:167],v2
ds_read_b128 v[80:83],v21 offset:10240
v_smfmac_f32_16x16x64_bf16 v[28:31],v[68:71],a[168:175],v2
ds_read_b128 v[84:87],v21 offset:11264
v_smfmac_f32_16x16x64_bf16 v[32:35],v[68:71],a[176:183],v2
v_smfmac_f32_16x16x64_bf16 v[36:39],v[68:71],a[184:191],v2
v_smfmac_f32_16x16x64_bf16 v[40:43],v[68:71],a[192:199],v2
s_waitcnt lgkmcnt(3)
v_smfmac_f32_16x16x64_bf16 v[44:47],v[68:71],v[72:79],v2
ds_read_b128 v[68:71],v5 offset:1024
v_smfmac_f32_16x16x64_bf16 v[24:27],v[60:63],a[200:207],v2
ds_read_b128 v[72:75],v21 offset:12288
v_smfmac_f32_16x16x64_bf16 v[28:31],v[60:63],a[208:215],v2
ds_read_b128 v[76:79],v21 offset:13312
v_smfmac_f32_16x16x64_bf16 v[32:35],v[60:63],a[216:223],v2
v_smfmac_f32_16x16x64_bf16 v[36:39],v[60:63],a[224:231],v2
v_smfmac_f32_16x16x64_bf16 v[40:43],v[60:63],a[232:239],v2
s_waitcnt lgkmcnt(3)
v_smfmac_f32_16x16x64_bf16 v[44:47],v[60:63],v[80:87],v2
ds_read_b128 v[60:63],v59 offset:0
v_smfmac_f32_16x16x64_bf16 v[24:27],v[64:67],a[240:247],v2
ds_read_b128 v[80:83],v21 offset:14336
v_smfmac_f32_16x16x64_bf16 v[28:31],v[64:67],a[248:255],v2
ds_read_b128 v[84:87],v21 offset:15360
v_smfmac_f32_16x16x64_bf16 v[32:35],v[64:67],v[112:119],v2
v_smfmac_f32_16x16x64_bf16 v[36:39],v[64:67],v[120:127],v2
v_smfmac_f32_16x16x64_bf16 v[40:43],v[64:67],v[128:135],v2
s_waitcnt lgkmcnt(3)
v_smfmac_f32_16x16x64_bf16 v[44:47],v[64:67],v[72:79],v2
ds_read_b128 v[64:67],v59 offset:1024
v_smfmac_f32_16x16x64_bf16 v[24:27],v[68:71],v[136:143],v2
ds_read_b128 v[72:75],v21 offset:16384
v_smfmac_f32_16x16x64_bf16 v[28:31],v[68:71],v[144:151],v2
ds_read_b128 v[76:79],v21 offset:17408
v_smfmac_f32_16x16x64_bf16 v[32:35],v[68:71],v[152:159],v2
v_smfmac_f32_16x16x64_bf16 v[36:39],v[68:71],v[160:167],v2
v_smfmac_f32_16x16x64_bf16 v[40:43],v[68:71],v[168:175],v2
s_waitcnt lgkmcnt(3)
v_smfmac_f32_16x16x64_bf16 v[44:47],v[68:71],v[80:87],v2
ds_read_b128 v[80:83],v21 offset:18432
v_smfmac_f32_16x16x64_bf16 v[24:27],v[60:63],v[176:183],v2
ds_read_b128 v[84:87],v21 offset:19456
v_smfmac_f32_16x16x64_bf16 v[28:31],v[60:63],v[184:191],v2
s_waitcnt lgkmcnt(4)
v_smfmac_f32_16x16x64_bf16 v[24:27],v[64:67],v[216:223],v2
v_smfmac_f32_16x16x64_bf16 v[28:31],v[64:67],v[224:231],v2
v_smfmac_f32_16x16x64_bf16 v[32:35],v[60:63],v[192:199],v2
v_smfmac_f32_16x16x64_bf16 v[36:39],v[60:63],v[200:207],v2
v_add_f32 v24,v24,v25
v_smfmac_f32_16x16x64_bf16 v[32:35],v[64:67],v[232:239],v2
v_add_f32 v26,v26,v27
v_smfmac_f32_16x16x64_bf16 v[36:39],v[64:67],v[240:247],v2
v_add_f32 v28,v28,v29
v_smfmac_f32_16x16x64_bf16 v[40:43],v[60:63],v[208:215],v2
v_add_f32 v30,v30,v31
s_waitcnt lgkmcnt(2)
v_smfmac_f32_16x16x64_bf16 v[44:47],v[60:63],v[72:79],v2
v_cvt_pk_bf16_f32 v100,v24,v26
v_smfmac_f32_16x16x64_bf16 v[40:43],v[64:67],v[248:255],v2
v_cvt_pk_bf16_f32 v101,v28,v30
s_waitcnt lgkmcnt(0)
v_smfmac_f32_16x16x64_bf16 v[44:47],v[64:67],v[80:87],v2
v_and_or_b32 v100,v100,-2,s57
v_add_f32 v32,v32,v33
v_add_f32 v34,v34,v35
v_add_f32 v36,v36,v37
v_add_f32 v38,v38,v39
v_cvt_pk_bf16_f32 v102,v32,v34
v_cvt_pk_bf16_f32 v103,v36,v38
v_and_or_b32 v102,v102,-2,s57
buffer_store_dwordx4 v[100:103],v6,s[8:11],s71 offen
v_add_f32 v40,v40,v41
v_add_f32 v42,v42,v43
v_add_f32 v44,v44,v45
v_add_f32 v46,v46,v47
v_cvt_pk_bf16_f32 v104,v40,v42
v_cvt_pk_bf16_f32 v105,v44,v46
v_and_or_b32 v104,v104,-2,s57
buffer_store_dwordx2 v[104:105],v7,s[8:11],s71 offen
s_lshl_b32 s60,s51,6
s_add_u32 s60,s60,s52
s_mul_i32 s78,s60,196608
s_add_u32 s78,s78,s85
s_lshl_b32 s60,s60,10
s_add_u32 s30,s60,s86
s_sub_u32 s60,s4,s5
s_cmp_gt_i32 s60,13
s_cselect_b32 s53,1,0
s_cmp_eq_u32 s4,64
s_cselect_b32 s53,1,s53
s_cmp_eq_u32 s53,0
s_cselect_b32 s54,s4,s5
s_addc_u32 s4,s4,0
s_add_u32 s5,s5,s53
s_and_b32 s60,s54,1
s_lshl2_add_u32 s60,s53,s60
s_lshl_b32 s68,s60,16
s_add_u32 s68,s68,s83
s_mul_i32 s59,s60,20480
s_add_u32 s59,s59,s6
s_lshl_b32 s69,s53,9
s_add_u32 s69,s69,s7
s_bfe_u32 s31,s54,65537
s_add_u32 s32,s54,1
s_cmp_lg_u32 s53,s51
s_cbranch_scc1 nx_125
s_waitcnt vmcnt(0)
s_cmp_ge_u32 s79,2147483648
s_cbranch_scc1 pf_126
v_mov_b32 v17,1
s_mov_b64 exec,1
buffer_store_dword v17,v1,s[8:11],s79 offen sc1
s_mov_b64 exec,-1
s_mov_b32 s79,2147483648
pf_126:
s_cmp_eq_u32 s78,2147483648
s_cbranch_scc1 pk_127
buffer_store_dwordx4 v[100:103],v6,s[8:11],s78 offen sc1
buffer_store_dwordx2 v[104:105],v7,s[8:11],s78 offen sc1
s_mov_b32 s79,s30
s_mov_b32 s78,2147483648
pk_127:
s_waitcnt vmcnt(0)
s_cmp_ge_u32 s79,2147483648
s_cbranch_scc1 pf_128
v_mov_b32 v17,1
s_mov_b64 exec,1
buffer_store_dword v17,v1,s[8:11],s79 offen sc1
s_mov_b64 exec,-1
s_mov_b32 s79,2147483648
pf_128:
nx_125:
s_add_u32 s50,s50,1
s_mov_b32 s51,s53
s_mov_b32 s52,s54
s_mov_b32 s57,s31
s_mov_b32 s58,s32
s_cmp_lt_u32 s50,128
s_cbranch_scc1 CV_LOOP_F0
s_branch CV_DONE
fr_120:
v_bitop3_b32 v12,v60,v64,s57 bitop3:0x7e
v_bitop3_b32 v13,v68,v68,s57 bitop3:0x7e
v_xor_b32 v14,s57,v68
v_or3_b32 v12,v12,v13,v14
v_and_b32 v12,1,v12
v_cmp_ne_u32 vcc,0,v12
s_cbranch_vccz sk_129
buffer_load_dwordx2 v[68:69],v18,s[8:11],s59 offen sc1
buffer_load_dwordx4 v[60:63],v1,s[8:11],s59 offen sc1
buffer_load_dwordx4 v[64:67],v1,s[8:11],s59 offen offset:1024 sc1
sk_129:
buffer_load_dwordx2 v[78:79],v18,s[8:11],s68 offen sc1
buffer_load_dwordx4 v[70:73],v1,s[8:11],s68 offen sc1
buffer_load_dwordx4 v[74:77],v1,s[8:11],s68 offen offset:1024 sc1
s_sub_u32 s47,s47,1
s_cbranch_scc1 ABORT
s_waitcnt lgkmcnt(0)
s_branch fa_119
CV_LOOP_F1:
v_mov_b32 v24,0
v_mov_b32 v25,0
v_mov_b32 v26,0
v_mov_b32 v27,0
v_mov_b32 v28,0
v_mov_b32 v29,0
v_mov_b32 v30,0
v_mov_b32 v31,0
v_mov_b32 v32,0
v_mov_b32 v33,0
v_mov_b32 v34,0
v_mov_b32 v35,0
v_mov_b32 v36,0
v_mov_b32 v37,0
v_mov_b32 v38,0
v_mov_b32 v39,0
v_mov_b32 v40,0
v_mov_b32 v41,0
v_mov_b32 v42,0
v_mov_b32 v43,0
v_mov_b32 v44,0
v_mov_b32 v45,0
v_mov_b32 v46,0
v_mov_b32 v47,0
s_barrier
buffer_load_dwordx2 v[68:69],v18,s[8:11],s59 offen sc1
buffer_load_dwordx4 v[60:63],v1,s[8:11],s59 offen sc1
buffer_load_dwordx4 v[64:67],v1,s[8:11],s59 offen offset:1024 sc1
s_waitcnt vmcnt(2)
s_sleep 3
fj_132f:
buffer_load_dwordx2 v[78:79],v18,s[8:11],s68 offen sc1
buffer_load_dwordx4 v[70:73],v1,s[8:11],s68 offen sc1
buffer_load_dwordx4 v[74:77],v1,s[8:11],s68 offen offset:1024 sc1
fj_132:
fa_130:
s_waitcnt vmcnt(5)
v_lshlrev_b32 v96,16,v68
v_and_b32 v97,0xffff0000,v68
v_lshlrev_b32 v98,16,v69
v_and_b32 v99,0xffff0000,v69
s_waitcnt vmcnt(4)
v_lshlrev_b32 v80,16,v60
v_and_b32 v81,0xffff0000,v60
v_lshlrev_b32 v82,16,v61
v_and_b32 v83,0xffff0000,v61
v_lshlrev_b32 v84,16,v62
v_and_b32 v85,0xffff0000,v62
v_lshlrev_b32 v86,16,v63
v_and_b32 v87,0xffff0000,v63
s_waitcnt vmcnt(3)
v_lshlrev_b32 v88,16,v64
v_and_b32 v89,0xffff0000,v64
v_lshlrev_b32 v90,16,v65
v_and_b32 v91,0xffff0000,v65
v_lshlrev_b32 v92,16,v66
v_and_b32 v93,0xffff0000,v66
v_lshlrev_b32 v94,16,v67
v_and_b32 v95,0xffff0000,v67
s_waitcnt vmcnt(2)
v_dot2c_f32_bf16 v96,s37,v78
v_dot2c_f32_bf16 v97,s81,v78
v_dot2c_f32_bf16 v98,s37,v79
v_dot2c_f32_bf16 v99,s81,v79
v_bitop3_b32 v16,v68,v78,s57 bitop3:0x7e
v_cvt_pk_bf16_f32 v56,v96,v97
s_nop 0
v_cvt_pk_bf16_f32 v57,v98,v99
ds_write_b64 v23,v[56:57]
s_waitcnt vmcnt(1)
v_dot2c_f32_bf16 v80,s37,v70
v_dot2c_f32_bf16 v81,s81,v70
v_dot2c_f32_bf16 v82,s37,v71
v_dot2c_f32_bf16 v83,s81,v71
v_dot2c_f32_bf16 v84,s37,v72
v_dot2c_f32_bf16 v85,s81,v72
v_dot2c_f32_bf16 v86,s37,v73
v_dot2c_f32_bf16 v87,s81,v73
v_bitop3_b32 v17,v60,v70,s57 bitop3:0x7e
v_or_b32 v16,v16,v17
v_cvt_pk_bf16_f32 v48,v80,v81
v_cvt_pk_bf16_f32 v49,v82,v83
v_cvt_pk_bf16_f32 v50,v84,v85
v_cvt_pk_bf16_f32 v51,v86,v87
ds_write_b128 v22,v[48:51] offset:0
s_waitcnt vmcnt(0)
v_dot2c_f32_bf16 v88,s37,v74
v_dot2c_f32_bf16 v89,s81,v74
v_dot2c_f32_bf16 v90,s37,v75
v_dot2c_f32_bf16 v91,s81,v75
v_dot2c_f32_bf16 v92,s37,v76
v_dot2c_f32_bf16 v93,s81,v76
v_dot2c_f32_bf16 v94,s37,v77
v_dot2c_f32_bf16 v95,s81,v77
v_bitop3_b32 v17,v64,v74,s57 bitop3:0x7e
v_bitop3_b32 v16,v16,v17,1 bitop3:0xa8
v_cmp_ne_u32 vcc,0,v16
v_cvt_pk_bf16_f32 v52,v88,v89
v_cvt_pk_bf16_f32 v53,v90,v91
v_cvt_pk_bf16_f32 v54,v92,v93
v_cvt_pk_bf16_f32 v55,v94,v95
ds_write_b128 v22,v[52:55] offset:1024
s_cbranch_vccnz fr_131
fj_132g:
v_smfmac_f32_16x16x64_bf16 v[24:27],v[48:51],a[0:7],v2
ds_read_b128 v[72:75],v21 offset:0
s_and_b32 s60,s52,1
v_smfmac_f32_16x16x64_bf16 v[28:31],v[48:51],a[8:15],v2
ds_read_b128 v[76:79],v21 offset:1024
s_lshl2_add_u32 s60,s51,s60
v_smfmac_f32_16x16x64_bf16 v[32:35],v[48:51],a[16:23],v2
ds_read_b128 v[80:83],v21 offset:2048
s_mul_i32 s60,s60,49152
v_smfmac_f32_16x16x64_bf16 v[36:39],v[48:51],a[24:31],v2
ds_read_b128 v[84:87],v21 offset:3072
s_add_u32 s71,s60,s34
s_waitcnt lgkmcnt(4)
s_barrier
v_smfmac_f32_16x16x64_bf16 v[40:43],v[48:51],a[32:39],v2
ds_read_b128 v[60:63],v3 offset:0
v_smfmac_f32_16x16x64_bf16 v[24:27],v[52:55],a[40:47],v2
ds_read_b128 v[64:67],v3 offset:1024
v_mov_b32 v17,1
v_smfmac_f32_16x16x64_bf16 v[28:31],v[52:55],a[48:55],v2
ds_read_b128 v[68:71],v4 offset:0
v_smfmac_f32_16x16x64_bf16 v[32:35],v[52:55],a[56:63],v2
s_mov_b64 exec,1
buffer_store_dword v17,v1,s[8:11],s79 offen sc1
s_mov_b64 exec,-1
v_smfmac_f32_16x16x64_bf16 v[36:39],v[52:55],a[64:71],v2
buffer_store_dwordx4 v[102:105],v6,s[8:11],s78 offen sc1
v_smfmac_f32_16x16x64_bf16 v[40:43],v[52:55],a[72:79],v2
buffer_store_dwordx2 v[100:101],v7,s[8:11],s78 offen sc1
s_waitcnt lgkmcnt(5)
v_smfmac_f32_16x16x64_bf16 v[44:47],v[48:51],v[72:79],v2
ds_read_b128 v[72:75],v21 offset:4096
s_waitcnt lgkmcnt(4)
v_smfmac_f32_16x16x64_bf16 v[44:47],v[52:55],v[80:87],v2
ds_read_b128 v[76:79],v21 offset:5120
s_waitcnt lgkmcnt(4)
v_smfmac_f32_16x16x64_bf16 v[24:27],v[60:63],a[80:87],v2
ds_read_b128 v[80:83],v21 offset:6144
s_and_b32 s79,s78,2147483648
v_smfmac_f32_16x16x64_bf16 v[28:31],v[60:63],a[88:95],v2
ds_read_b128 v[84:87],v21 offset:7168
s_or_b32 s79,s79,s30
v_smfmac_f32_16x16x64_bf16 v[32:35],v[60:63],a[96:103],v2
s_mov_b32 s78,2147483648
v_smfmac_f32_16x16x64_bf16 v[36:39],v[60:63],a[104:111],v2
v_smfmac_f32_16x16x64_bf16 v[40:43],v[60:63],a[112:119],v2
s_waitcnt lgkmcnt(2)
v_smfmac_f32_16x16x64_bf16 v[44:47],v[60:63],v[72:79],v2
ds_read_b128 v[60:63],v4 offset:1024
v_smfmac_f32_16x16x64_bf16 v[24:27],v[64:67],a[120:127],v2
ds_read_b128 v[72:75],v21 offset:8192
v_smfmac_f32_16x16x64_bf16 v[28:31],v[64:67],a[128:135],v2
ds_read_b128 v[76:79],v21 offset:9216
v_smfmac_f32_16x16x64_bf16 v[32:35],v[64:67],a[136:143],v2
v_smfmac_f32_16x16x64_bf16 v[36:39],v[64:67],a[144:151],v2
v_smfmac_f32_16x16x64_bf16 v[40:43],v[64:67],a[152:159],v2
s_waitcnt lgkmcnt(3)
v_smfmac_f32_16x16x64_bf16 v[44:47],v[64:67],v[80:87],v2
ds_read_b128 v[64:67],v5 offset:0
v_smfmac_f32_16x16x64_bf16 v[24:27],v[68:71],a[160:167],v2
ds_read_b128 v[80:83],v21 offset:10240
v_smfmac_f32_16x16x64_bf16 v[28:31],v[68:71],a[168:175],v2
ds_read_b128 v[84:87],v21 offset:11264
v_smfmac_f32_16x16x64_bf16 v[32:35],v[68:71],a[176:183],v2
v_smfmac_f32_16x16x64_bf16 v[36:39],v[68:71],a[184:191],v2
v_smfmac_f32_16x16x64_bf16 v[40:43],v[68:71],a[192:199],v2
s_waitcnt lgkmcnt(3)
v_smfmac_f32_16x16x64_bf16 v[44:47],v[68:71],v[72:79],v2
ds_read_b128 v[68:71],v5 offset:1024
v_smfmac_f32_16x16x64_bf16 v[24:27],v[60:63],a[200:207],v2
ds_read_b128 v[72:75],v21 offset:12288
v_smfmac_f32_16x16x64_bf16 v[28:31],v[60:63],a[208:215],v2
ds_read_b128 v[76:79],v21 offset:13312
v_smfmac_f32_16x16x64_bf16 v[32:35],v[60:63],a[216:223],v2
v_smfmac_f32_16x16x64_bf16 v[36:39],v[60:63],a[224:231],v2
v_smfmac_f32_16x16x64_bf16 v[40:43],v[60:63],a[232:239],v2
s_waitcnt lgkmcnt(3)
v_smfmac_f32_16x16x64_bf16 v[44:47],v[60:63],v[80:87],v2
ds_read_b128 v[60:63],v59 offset:0
v_smfmac_f32_16x16x64_bf16 v[24:27],v[64:67],a[240:247],v2
ds_read_b128 v[80:83],v21 offset:14336
v_smfmac_f32_16x16x64_bf16 v[28:31],v[64:67],a[248:255],v2
ds_read_b128 v[84:87],v21 offset:15360
v_smfmac_f32_16x16x64_bf16 v[32:35],v[64:67],v[112:119],v2
v_smfmac_f32_16x16x64_bf16 v[36:39],v[64:67],v[120:127],v2
v_smfmac_f32_16x16x64_bf16 v[40:43],v[64:67],v[128:135],v2
s_waitcnt lgkmcnt(3)
v_smfmac_f32_16x16x64_bf16 v[44:47],v[64:67],v[72:79],v2
ds_read_b128 v[64:67],v59 offset:1024
v_smfmac_f32_16x16x64_bf16 v[24:27],v[68:71],v[136:143],v2
ds_read_b128 v[72:75],v21 offset:16384
v_smfmac_f32_16x16x64_bf16 v[28:31],v[68:71],v[144:151],v2
ds_read_b128 v[76:79],v21 offset:17408
v_smfmac_f32_16x16x64_bf16 v[32:35],v[68:71],v[152:159],v2
v_smfmac_f32_16x16x64_bf16 v[36:39],v[68:71],v[160:167],v2
v_smfmac_f32_16x16x64_bf16 v[40:43],v[68:71],v[168:175],v2
s_waitcnt lgkmcnt(3)
v_smfmac_f32_16x16x64_bf16 v[44:47],v[68:71],v[80:87],v2
ds_read_b128 v[80:83],v21 offset:18432
v_smfmac_f32_16x16x64_bf16 v[24:27],v[60:63],v[176:183],v2
ds_read_b128 v[84:87],v21 offset:19456
v_smfmac_f32_16x16x64_bf16 v[28:31],v[60:63],v[184:191],v2
s_waitcnt lgkmcnt(4)
v_smfmac_f32_16x16x64_bf16 v[24:27],v[64:67],v[216:223],v2
v_smfmac_f32_16x16x64_bf16 v[28:31],v[64:67],v[224:231],v2
v_smfmac_f32_16x16x64_bf16 v[32:35],v[60:63],v[192:199],v2
v_smfmac_f32_16x16x64_bf16 v[36:39],v[60:63],v[200:207],v2
v_add_f32 v24,v24,v25
v_smfmac_f32_16x16x64_bf16 v[32:35],v[64:67],v[232:239],v2
v_add_f32 v26,v26,v27
v_smfmac_f32_16x16x64_bf16 v[36:39],v[64:67],v[240:247],v2
v_add_f32 v28,v28,v29
v_smfmac_f32_16x16x64_bf16 v[40:43],v[60:63],v[208:215],v2
v_add_f32 v30,v30,v31
s_waitcnt lgkmcnt(2)
v_smfmac_f32_16x16x64_bf16 v[44:47],v[60:63],v[72:79],v2
v_cvt_pk_bf16_f32 v100,v24,v26
v_smfmac_f32_16x16x64_bf16 v[40:43],v[64:67],v[248:255],v2
v_cvt_pk_bf16_f32 v101,v28,v30
s_waitcnt lgkmcnt(0)
v_smfmac_f32_16x16x64_bf16 v[44:47],v[64:67],v[80:87],v2
v_and_or_b32 v100,v100,-2,s57
buffer_store_dwordx2 v[100:101],v7,s[8:11],s71 offen
v_add_f32 v32,v32,v33
v_add_f32 v34,v34,v35
v_add_f32 v36,v36,v37
v_add_f32 v38,v38,v39
v_cvt_pk_bf16_f32 v102,v32,v34
v_cvt_pk_bf16_f32 v103,v36,v38
v_and_or_b32 v102,v102,-2,s57
v_add_f32 v40,v40,v41
v_add_f32 v42,v42,v43
v_add_f32 v44,v44,v45
v_add_f32 v46,v46,v47
v_cvt_pk_bf16_f32 v104,v40,v42
v_cvt_pk_bf16_f32 v105,v44,v46
v_and_or_b32 v104,v104,-2,s57
buffer_store_dwordx4 v[102:105],v6,s[8:11],s71 offen
s_lshl_b32 s60,s51,6
s_add_u32 s60,s60,s52
s_mul_i32 s78,s60,196608
s_add_u32 s78,s78,s85
s_lshl_b32 s60,s60,10
s_add_u32 s30,s60,s86
s_sub_u32 s60,s4,s5
s_cmp_gt_i32 s60,13
s_cselect_b32 s53,1,0
s_cmp_eq_u32 s4,64
s_cselect_b32 s53,1,s53
s_cmp_eq_u32 s53,0
s_cselect_b32 s54,s4,s5
s_addc_u32 s4,s4,0
s_add_u32 s5,s5,s53
s_and_b32 s60,s54,1
s_lshl2_add_u32 s60,s53,s60
s_lshl_b32 s68,s60,16
s_add_u32 s68,s68,s83
s_mul_i32 s59,s60,20480
s_add_u32 s59,s59,s6
s_lshl_b32 s69,s53,9
s_add_u32 s69,s69,s7
s_bfe_u32 s31,s54,65537
s_add_u32 s32,s54,1
s_cmp_lg_u32 s53,s51
s_cbranch_scc1 nx_133
s_waitcnt vmcnt(0)
s_cmp_ge_u32 s79,2147483648
s_cbranch_scc1 pf_134
v_mov_b32 v17,1
s_mov_b64 exec,1
buffer_store_dword v17,v1,s[8:11],s79 offen sc1
s_mov_b64 exec,-1
s_mov_b32 s79,2147483648
pf_134:
s_cmp_eq_u32 s78,2147483648
s_cbranch_scc1 pk_135
buffer_store_dwordx4 v[102:105],v6,s[8:11],s78 offen sc1
buffer_store_dwordx2 v[100:101],v7,s[8:11],s78 offen sc1
s_mov_b32 s79,s30
s_mov_b32 s78,2147483648
pk_135:
s_waitcnt vmcnt(0)
s_cmp_ge_u32 s79,2147483648
s_cbranch_scc1 pf_136
v_mov_b32 v17,1
s_mov_b64 exec,1
buffer_store_dword v17,v1,s[8:11],s79 offen sc1
s_mov_b64 exec,-1
s_mov_b32 s79,2147483648
pf_136:
nx_133:
s_add_u32 s50,s50,1
s_mov_b32 s51,s53
s_mov_b32 s52,s54
s_mov_b32 s57,s31
s_mov_b32 s58,s32
s_cmp_lt_u32 s50,128
s_cbranch_scc1 CV_LOOP_F1
s_branch CV_DONE
fr_131:
v_bitop3_b32 v12,v60,v64,s57 bitop3:0x7e
v_bitop3_b32 v13,v68,v68,s57 bitop3:0x7e
v_xor_b32 v14,s57,v68
v_or3_b32 v12,v12,v13,v14
v_and_b32 v12,1,v12
v_cmp_ne_u32 vcc,0,v12
s_cbranch_vccz sk_137
buffer_load_dwordx2 v[68:69],v18,s[8:11],s59 offen sc1
buffer_load_dwordx4 v[60:63],v1,s[8:11],s59 offen sc1
buffer_load_dwordx4 v[64:67],v1,s[8:11],s59 offen offset:1024 sc1
sk_137:
buffer_load_dwordx2 v[78:79],v18,s[8:11],s68 offen sc1
buffer_load_dwordx4 v[70:73],v1,s[8:11],s68 offen sc1
buffer_load_dwordx4 v[74:77],v1,s[8:11],s68 offen offset:1024 sc1
s_sub_u32 s47,s47,1
s_cbranch_scc1 ABORT
s_waitcnt lgkmcnt(0)
s_branch fa_130
CV_LOOP_S0:
v_mov_b32 v24,0
v_mov_b32 v25,0
v_mov_b32 v26,0
v_mov_b32 v27,0
v_mov_b32 v28,0
v_mov_b32 v29,0
v_mov_b32 v30,0
v_mov_b32 v31,0
v_mov_b32 v32,0
v_mov_b32 v33,0
v_mov_b32 v34,0
v_mov_b32 v35,0
v_mov_b32 v36,0
v_mov_b32 v37,0
v_mov_b32 v38,0
v_mov_b32 v39,0
v_mov_b32 v40,0
v_mov_b32 v41,0
v_mov_b32 v42,0
v_mov_b32 v43,0
v_mov_b32 v44,0
v_mov_b32 v45,0
v_mov_b32 v46,0
v_mov_b32 v47,0
s_cmp_lg_u32 s46,0
s_cbranch_scc1 np_141
db_142:
buffer_load_dword v12,v11,s[8:11],s69 offen sc1
s_waitcnt vmcnt(0)
v_cmp_gt_u32 vcc,s58,v12
s_cbranch_vccz dbok_143
s_sub_u32 s47,s47,1
s_cbranch_scc1 ABORT
s_branch db_142
dbok_143:
np_141:
s_barrier
buffer_load_dwordx2 v[68:69],v18,s[8:11],s59 offen sc1
buffer_load_dwordx4 v[60:63],v1,s[8:11],s59 offen sc1
buffer_load_dwordx4 v[64:67],v1,s[8:11],s59 offen offset:1024 sc1
s_waitcnt vmcnt(2)
s_sleep 3
fj_140f:
buffer_load_dwordx2 v[78:79],v18,s[8:11],s68 offen sc1
buffer_load_dwordx4 v[70:73],v1,s[8:11],s68 offen sc1
buffer_load_dwordx4 v[74:77],v1,s[8:11],s68 offen offset:1024 sc1
fj_140:
fa_138:
s_waitcnt vmcnt(5)
v_lshlrev_b32 v96,16,v68
v_and_b32 v97,0xffff0000,v68
v_lshlrev_b32 v98,16,v69
v_and_b32 v99,0xffff0000,v69
s_waitcnt vmcnt(4)
v_lshlrev_b32 v80,16,v60
v_and_b32 v81,0xffff0000,v60
v_lshlrev_b32 v82,16,v61
v_and_b32 v83,0xffff0000,v61
v_lshlrev_b32 v84,16,v62
v_and_b32 v85,0xffff0000,v62
v_lshlrev_b32 v86,16,v63
v_and_b32 v87,0xffff0000,v63
s_waitcnt vmcnt(3)
v_lshlrev_b32 v88,16,v64
v_and_b32 v89,0xffff0000,v64
v_lshlrev_b32 v90,16,v65
v_and_b32 v91,0xffff0000,v65
v_lshlrev_b32 v92,16,v66
v_and_b32 v93,0xffff0000,v66
v_lshlrev_b32 v94,16,v67
v_and_b32 v95,0xffff0000,v67
s_waitcnt vmcnt(2)
v_dot2c_f32_bf16 v96,s37,v78
v_dot2c_f32_bf16 v97,s81,v78
v_dot2c_f32_bf16 v98,s37,v79
v_dot2c_f32_bf16 v99,s81,v79
v_bitop3_b32 v16,v68,v78,s57 bitop3:0x7e
v_cvt_pk_bf16_f32 v56,v96,v97
s_nop 0
v_cvt_pk_bf16_f32 v57,v98,v99
ds_write_b64 v23,v[56:57]
s_waitcnt vmcnt(1)
v_dot2c_f32_bf16 v80,s37,v70
v_dot2c_f32_bf16 v81,s81,v70
v_dot2c_f32_bf16 v82,s37,v71
v_dot2c_f32_bf16 v83,s81,v71
v_dot2c_f32_bf16 v84,s37,v72
v_dot2c_f32_bf16 v85,s81,v72
v_dot2c_f32_bf16 v86,s37,v73
v_dot2c_f32_bf16 v87,s81,v73
v_bitop3_b32 v17,v60,v70,s57 bitop3:0x7e
v_or_b32 v16,v16,v17
v_cvt_pk_bf16_f32 v48,v80,v81
v_cvt_pk_bf16_f32 v49,v82,v83
v_cvt_pk_bf16_f32 v50,v84,v85
v_cvt_pk_bf16_f32 v51,v86,v87
ds_write_b128 v22,v[48:51] offset:0
s_waitcnt vmcnt(0)
v_dot2c_f32_bf16 v88,s37,v74
v_dot2c_f32_bf16 v89,s81,v74
v_dot2c_f32_bf16 v90,s37,v75
v_dot2c_f32_bf16 v91,s81,v75
v_dot2c_f32_bf16 v92,s37,v76
v_dot2c_f32_bf16 v93,s81,v76
v_dot2c_f32_bf16 v94,s37,v77
v_dot2c_f32_bf16 v95,s81,v77
v_bitop3_b32 v17,v64,v74,s57 bitop3:0x7e
v_bitop3_b32 v16,v16,v17,1 bitop3:0xa8
v_cmp_ne_u32 vcc,0,v16
v_cvt_pk_bf16_f32 v52,v88,v89
v_cvt_pk_bf16_f32 v53,v90,v91
v_cvt_pk_bf16_f32 v54,v92,v93
v_cvt_pk_bf16_f32 v55,v94,v95
ds_write_b128 v22,v[52:55] offset:1024
s_cbranch_vccnz fr_139
fj_140g:
v_smfmac_f32_16x16x64_bf16 v[24:27],v[48:51],a[0:7],v2
ds_read_b128 v[72:75],v21 offset:0
s_and_b32 s60,s52,1
v_smfmac_f32_16x16x64_bf16 v[28:31],v[48:51],a[8:15],v2
ds_read_b128 v[76:79],v21 offset:1024
s_lshl2_add_u32 s60,s51,s60
v_smfmac_f32_16x16x64_bf16 v[32:35],v[48:51],a[16:23],v2
ds_read_b128 v[80:83],v21 offset:2048
s_mul_i32 s60,s60,49152
v_smfmac_f32_16x16x64_bf16 v[36:39],v[48:51],a[24:31],v2
ds_read_b128 v[84:87],v21 offset:3072
s_add_u32 s71,s60,s34
s_waitcnt lgkmcnt(4)
s_barrier
v_smfmac_f32_16x16x64_bf16 v[40:43],v[48:51],a[32:39],v2
ds_read_b128 v[60:63],v3 offset:0
v_smfmac_f32_16x16x64_bf16 v[24:27],v[52:55],a[40:47],v2
ds_read_b128 v[64:67],v3 offset:1024
v_mov_b32 v17,1
v_smfmac_f32_16x16x64_bf16 v[28:31],v[52:55],a[48:55],v2
ds_read_b128 v[68:71],v4 offset:0
v_smfmac_f32_16x16x64_bf16 v[32:35],v[52:55],a[56:63],v2
s_mov_b64 exec,1
buffer_store_dword v17,v1,s[8:11],s79 offen sc1
s_mov_b64 exec,-1
v_smfmac_f32_16x16x64_bf16 v[36:39],v[52:55],a[64:71],v2
buffer_store_dwordx4 v[100:103],v6,s[8:11],s78 offen sc1
v_smfmac_f32_16x16x64_bf16 v[40:43],v[52:55],a[72:79],v2
buffer_store_dwordx2 v[104:105],v7,s[8:11],s78 offen sc1
s_waitcnt lgkmcnt(5)
v_smfmac_f32_16x16x64_bf16 v[44:47],v[48:51],v[72:79],v2
ds_read_b128 v[72:75],v21 offset:4096
s_waitcnt lgkmcnt(4)
v_smfmac_f32_16x16x64_bf16 v[44:47],v[52:55],v[80:87],v2
ds_read_b128 v[76:79],v21 offset:5120
s_waitcnt lgkmcnt(4)
v_smfmac_f32_16x16x64_bf16 v[24:27],v[60:63],a[80:87],v2
ds_read_b128 v[80:83],v21 offset:6144
s_and_b32 s79,s78,2147483648
v_smfmac_f32_16x16x64_bf16 v[28:31],v[60:63],a[88:95],v2
ds_read_b128 v[84:87],v21 offset:7168
s_or_b32 s79,s79,s30
v_smfmac_f32_16x16x64_bf16 v[32:35],v[60:63],a[96:103],v2
s_mov_b32 s78,2147483648
v_smfmac_f32_16x16x64_bf16 v[36:39],v[60:63],a[104:111],v2
v_smfmac_f32_16x16x64_bf16 v[40:43],v[60:63],a[112:119],v2
s_waitcnt lgkmcnt(2)
v_smfmac_f32_16x16x64_bf16 v[44:47],v[60:63],v[72:79],v2
ds_read_b128 v[60:63],v4 offset:1024
v_smfmac_f32_16x16x64_bf16 v[24:27],v[64:67],a[120:127],v2
ds_read_b128 v[72:75],v21 offset:8192
v_smfmac_f32_16x16x64_bf16 v[28:31],v[64:67],a[128:135],v2
ds_read_b128 v[76:79],v21 offset:9216
v_smfmac_f32_16x16x64_bf16 v[32:35],v[64:67],a[136:143],v2
v_smfmac_f32_16x16x64_bf16 v[36:39],v[64:67],a[144:151],v2
v_smfmac_f32_16x16x64_bf16 v[40:43],v[64:67],a[152:159],v2
s_waitcnt lgkmcnt(3)
v_smfmac_f32_16x16x64_bf16 v[44:47],v[64:67],v[80:87],v2
ds_read_b128 v[64:67],v5 offset:0
v_smfmac_f32_16x16x64_bf16 v[24:27],v[68:71],a[160:167],v2
ds_read_b128 v[80:83],v21 offset:10240
v_smfmac_f32_16x16x64_bf16 v[28:31],v[68:71],a[168:175],v2
ds_read_b128 v[84:87],v21 offset:11264
v_smfmac_f32_16x16x64_bf16 v[32:35],v[68:71],a[176:183],v2
v_smfmac_f32_16x16x64_bf16 v[36:39],v[68:71],a[184:191],v2
v_smfmac_f32_16x16x64_bf16 v[40:43],v[68:71],a[192:199],v2
s_waitcnt lgkmcnt(3)
v_smfmac_f32_16x16x64_bf16 v[44:47],v[68:71],v[72:79],v2
ds_read_b128 v[68:71],v5 offset:1024
v_smfmac_f32_16x16x64_bf16 v[24:27],v[60:63],a[200:207],v2
ds_read_b128 v[72:75],v21 offset:12288
v_smfmac_f32_16x16x64_bf16 v[28:31],v[60:63],a[208:215],v2
ds_read_b128 v[76:79],v21 offset:13312
v_smfmac_f32_16x16x64_bf16 v[32:35],v[60:63],a[216:223],v2
v_smfmac_f32_16x16x64_bf16 v[36:39],v[60:63],a[224:231],v2
v_smfmac_f32_16x16x64_bf16 v[40:43],v[60:63],a[232:239],v2
s_waitcnt lgkmcnt(3)
v_smfmac_f32_16x16x64_bf16 v[44:47],v[60:63],v[80:87],v2
ds_read_b128 v[60:63],v59 offset:0
v_smfmac_f32_16x16x64_bf16 v[24:27],v[64:67],a[240:247],v2
ds_read_b128 v[80:83],v21 offset:14336
v_smfmac_f32_16x16x64_bf16 v[28:31],v[64:67],a[248:255],v2
ds_read_b128 v[84:87],v21 offset:15360
v_smfmac_f32_16x16x64_bf16 v[32:35],v[64:67],v[112:119],v2
v_smfmac_f32_16x16x64_bf16 v[36:39],v[64:67],v[120:127],v2
v_smfmac_f32_16x16x64_bf16 v[40:43],v[64:67],v[128:135],v2
s_waitcnt lgkmcnt(3)
v_smfmac_f32_16x16x64_bf16 v[44:47],v[64:67],v[72:79],v2
ds_read_b128 v[64:67],v59 offset:1024
v_smfmac_f32_16x16x64_bf16 v[24:27],v[68:71],v[136:143],v2
ds_read_b128 v[72:75],v21 offset:16384
v_smfmac_f32_16x16x64_bf16 v[28:31],v[68:71],v[144:151],v2
ds_read_b128 v[76:79],v21 offset:17408
v_smfmac_f32_16x16x64_bf16 v[32:35],v[68:71],v[152:159],v2
v_smfmac_f32_16x16x64_bf16 v[36:39],v[68:71],v[160:167],v2
v_smfmac_f32_16x16x64_bf16 v[40:43],v[68:71],v[168:175],v2
s_waitcnt lgkmcnt(3)
v_smfmac_f32_16x16x64_bf16 v[44:47],v[68:71],v[80:87],v2
ds_read_b128 v[80:83],v21 offset:18432
v_smfmac_f32_16x16x64_bf16 v[24:27],v[60:63],v[176:183],v2
ds_read_b128 v[84:87],v21 offset:19456
v_smfmac_f32_16x16x64_bf16 v[28:31],v[60:63],v[184:191],v2
s_waitcnt lgkmcnt(4)
v_smfmac_f32_16x16x64_bf16 v[24:27],v[64:67],v[216:223],v2
v_smfmac_f32_16x16x64_bf16 v[28:31],v[64:67],v[224:231],v2
v_smfmac_f32_16x16x64_bf16 v[32:35],v[60:63],v[192:199],v2
v_smfmac_f32_16x16x64_bf16 v[36:39],v[60:63],v[200:207],v2
v_add_f32 v24,v24,v25
v_smfmac_f32_16x16x64_bf16 v[32:35],v[64:67],v[232:239],v2
v_add_f32 v26,v26,v27
v_smfmac_f32_16x16x64_bf16 v[36:39],v[64:67],v[240:247],v2
v_add_f32 v28,v28,v29
v_smfmac_f32_16x16x64_bf16 v[40:43],v[60:63],v[208:215],v2
v_add_f32 v30,v30,v31
s_waitcnt lgkmcnt(2)
v_smfmac_f32_16x16x64_bf16 v[44:47],v[60:63],v[72:79],v2
v_cvt_pk_bf16_f32 v100,v24,v26
v_smfmac_f32_16x16x64_bf16 v[40:43],v[64:67],v[248:255],v2
v_cvt_pk_bf16_f32 v101,v28,v30
s_waitcnt lgkmcnt(0)
v_smfmac_f32_16x16x64_bf16 v[44:47],v[64:67],v[80:87],v2
v_and_or_b32 v100,v100,-2,s57
v_add_f32 v32,v32,v33
v_add_f32 v34,v34,v35
v_add_f32 v36,v36,v37
v_add_f32 v38,v38,v39
v_cvt_pk_bf16_f32 v102,v32,v34
v_cvt_pk_bf16_f32 v103,v36,v38
v_and_or_b32 v102,v102,-2,s57
buffer_store_dwordx4 v[100:103],v6,s[8:11],s71 offen sc1
v_add_f32 v40,v40,v41
v_add_f32 v42,v42,v43
v_add_f32 v44,v44,v45
v_add_f32 v46,v46,v47
v_cvt_pk_bf16_f32 v104,v40,v42
v_cvt_pk_bf16_f32 v105,v44,v46
v_and_or_b32 v104,v104,-2,s57
buffer_store_dwordx2 v[104:105],v7,s[8:11],s71 offen sc1
s_lshl_b32 s60,s51,6
s_add_u32 s60,s60,s52
s_mul_i32 s78,s60,196608
s_add_u32 s78,s78,s85
s_lshl_b32 s60,s60,10
s_add_u32 s30,s60,s86
s_sub_u32 s60,s4,s5
s_cmp_gt_i32 s60,13
s_cselect_b32 s53,1,0
s_cmp_eq_u32 s4,64
s_cselect_b32 s53,1,s53
s_cmp_eq_u32 s53,0
s_cselect_b32 s54,s4,s5
s_addc_u32 s4,s4,0
s_add_u32 s5,s5,s53
s_and_b32 s60,s54,1
s_lshl2_add_u32 s60,s53,s60
s_lshl_b32 s68,s60,16
s_add_u32 s68,s68,s83
s_mul_i32 s59,s60,20480
s_add_u32 s59,s59,s6
s_lshl_b32 s69,s53,9
s_add_u32 s69,s69,s7
s_bfe_u32 s31,s54,65537
s_add_u32 s32,s54,1
s_cmp_lg_u32 s53,s51
s_cbranch_scc1 nx_144
s_waitcnt vmcnt(0)
s_cmp_ge_u32 s79,2147483648
s_cbranch_scc1 pf_145
v_mov_b32 v17,1
s_mov_b64 exec,1
buffer_store_dword v17,v1,s[8:11],s79 offen sc1
s_mov_b64 exec,-1
s_mov_b32 s79,2147483648
pf_145:
s_cmp_eq_u32 s78,2147483648
s_cbranch_scc1 pk_146
buffer_store_dwordx4 v[100:103],v6,s[8:11],s78 offen sc1
buffer_store_dwordx2 v[104:105],v7,s[8:11],s78 offen sc1
s_mov_b32 s79,s30
s_mov_b32 s78,2147483648
pk_146:
s_waitcnt vmcnt(0)
s_cmp_ge_u32 s79,2147483648
s_cbranch_scc1 pf_147
v_mov_b32 v17,1
s_mov_b64 exec,1
buffer_store_dword v17,v1,s[8:11],s79 offen sc1
s_mov_b64 exec,-1
s_mov_b32 s79,2147483648
pf_147:
nx_144:
s_add_u32 s50,s50,1
s_mov_b32 s51,s53
s_mov_b32 s52,s54
s_mov_b32 s57,s31
s_mov_b32 s58,s32
s_cmp_lt_u32 s50,128
s_cbranch_scc1 CV_LOOP_S0
s_branch CV_DONE
fr_139:
v_bitop3_b32 v12,v60,v64,s57 bitop3:0x7e
v_bitop3_b32 v13,v68,v68,s57 bitop3:0x7e
v_xor_b32 v14,s57,v68
v_or3_b32 v12,v12,v13,v14
v_and_b32 v12,1,v12
v_cmp_ne_u32 vcc,0,v12
s_cbranch_vccz sk_148
buffer_load_dwordx2 v[68:69],v18,s[8:11],s59 offen sc1
buffer_load_dwordx4 v[60:63],v1,s[8:11],s59 offen sc1
buffer_load_dwordx4 v[64:67],v1,s[8:11],s59 offen offset:1024 sc1
sk_148:
buffer_load_dwordx2 v[78:79],v18,s[8:11],s68 offen sc1
buffer_load_dwordx4 v[70:73],v1,s[8:11],s68 offen sc1
buffer_load_dwordx4 v[74:77],v1,s[8:11],s68 offen offset:1024 sc1
s_sub_u32 s47,s47,1
s_cbranch_scc1 ABORT
s_waitcnt lgkmcnt(0)
s_branch fa_138
CV_LOOP_S1:
v_mov_b32 v24,0
v_mov_b32 v25,0
v_mov_b32 v26,0
v_mov_b32 v27,0
v_mov_b32 v28,0
v_mov_b32 v29,0
v_mov_b32 v30,0
v_mov_b32 v31,0
v_mov_b32 v32,0
v_mov_b32 v33,0
v_mov_b32 v34,0
v_mov_b32 v35,0
v_mov_b32 v36,0
v_mov_b32 v37,0
v_mov_b32 v38,0
v_mov_b32 v39,0
v_mov_b32 v40,0
v_mov_b32 v41,0
v_mov_b32 v42,0
v_mov_b32 v43,0
v_mov_b32 v44,0
v_mov_b32 v45,0
v_mov_b32 v46,0
v_mov_b32 v47,0
s_barrier
buffer_load_dwordx2 v[68:69],v18,s[8:11],s59 offen sc1
buffer_load_dwordx4 v[60:63],v1,s[8:11],s59 offen sc1
buffer_load_dwordx4 v[64:67],v1,s[8:11],s59 offen offset:1024 sc1
s_waitcnt vmcnt(2)
s_sleep 3
fj_151f:
buffer_load_dwordx2 v[78:79],v18,s[8:11],s68 offen sc1
buffer_load_dwordx4 v[70:73],v1,s[8:11],s68 offen sc1
buffer_load_dwordx4 v[74:77],v1,s[8:11],s68 offen offset:1024 sc1
fj_151:
fa_149:
s_waitcnt vmcnt(5)
v_lshlrev_b32 v96,16,v68
v_and_b32 v97,0xffff0000,v68
v_lshlrev_b32 v98,16,v69
v_and_b32 v99,0xffff0000,v69
s_waitcnt vmcnt(4)
v_lshlrev_b32 v80,16,v60
v_and_b32 v81,0xffff0000,v60
v_lshlrev_b32 v82,16,v61
v_and_b32 v83,0xffff0000,v61
v_lshlrev_b32 v84,16,v62
v_and_b32 v85,0xffff0000,v62
v_lshlrev_b32 v86,16,v63
v_and_b32 v87,0xffff0000,v63
s_waitcnt vmcnt(3)
v_lshlrev_b32 v88,16,v64
v_and_b32 v89,0xffff0000,v64
v_lshlrev_b32 v90,16,v65
v_and_b32 v91,0xffff0000,v65
v_lshlrev_b32 v92,16,v66
v_and_b32 v93,0xffff0000,v66
v_lshlrev_b32 v94,16,v67
v_and_b32 v95,0xffff0000,v67
s_waitcnt vmcnt(2)
v_dot2c_f32_bf16 v96,s37,v78
v_dot2c_f32_bf16 v97,s81,v78
v_dot2c_f32_bf16 v98,s37,v79
v_dot2c_f32_bf16 v99,s81,v79
v_bitop3_b32 v16,v68,v78,s57 bitop3:0x7e
v_cvt_pk_bf16_f32 v56,v96,v97
s_nop 0
v_cvt_pk_bf16_f32 v57,v98,v99
ds_write_b64 v23,v[56:57]
s_waitcnt vmcnt(1)
v_dot2c_f32_bf16 v80,s37,v70
v_dot2c_f32_bf16 v81,s81,v70
v_dot2c_f32_bf16 v82,s37,v71
v_dot2c_f32_bf16 v83,s81,v71
v_dot2c_f32_bf16 v84,s37,v72
v_dot2c_f32_bf16 v85,s81,v72
v_dot2c_f32_bf16 v86,s37,v73
v_dot2c_f32_bf16 v87,s81,v73
v_bitop3_b32 v17,v60,v70,s57 bitop3:0x7e
v_or_b32 v16,v16,v17
v_cvt_pk_bf16_f32 v48,v80,v81
v_cvt_pk_bf16_f32 v49,v82,v83
v_cvt_pk_bf16_f32 v50,v84,v85
v_cvt_pk_bf16_f32 v51,v86,v87
ds_write_b128 v22,v[48:51] offset:0
s_waitcnt vmcnt(0)
v_dot2c_f32_bf16 v88,s37,v74
v_dot2c_f32_bf16 v89,s81,v74
v_dot2c_f32_bf16 v90,s37,v75
v_dot2c_f32_bf16 v91,s81,v75
v_dot2c_f32_bf16 v92,s37,v76
v_dot2c_f32_bf16 v93,s81,v76
v_dot2c_f32_bf16 v94,s37,v77
v_dot2c_f32_bf16 v95,s81,v77
v_bitop3_b32 v17,v64,v74,s57 bitop3:0x7e
v_bitop3_b32 v16,v16,v17,1 bitop3:0xa8
v_cmp_ne_u32 vcc,0,v16
v_cvt_pk_bf16_f32 v52,v88,v89
v_cvt_pk_bf16_f32 v53,v90,v91
v_cvt_pk_bf16_f32 v54,v92,v93
v_cvt_pk_bf16_f32 v55,v94,v95
ds_write_b128 v22,v[52:55] offset:1024
s_cbranch_vccnz fr_150
fj_151g:
v_smfmac_f32_16x16x64_bf16 v[24:27],v[48:51],a[0:7],v2
ds_read_b128 v[72:75],v21 offset:0
s_and_b32 s60,s52,1
v_smfmac_f32_16x16x64_bf16 v[28:31],v[48:51],a[8:15],v2
ds_read_b128 v[76:79],v21 offset:1024
s_lshl2_add_u32 s60,s51,s60
v_smfmac_f32_16x16x64_bf16 v[32:35],v[48:51],a[16:23],v2
ds_read_b128 v[80:83],v21 offset:2048
s_mul_i32 s60,s60,49152
v_smfmac_f32_16x16x64_bf16 v[36:39],v[48:51],a[24:31],v2
ds_read_b128 v[84:87],v21 offset:3072
s_add_u32 s71,s60,s34
s_waitcnt lgkmcnt(4)
s_barrier
v_smfmac_f32_16x16x64_bf16 v[40:43],v[48:51],a[32:39],v2
ds_read_b128 v[60:63],v3 offset:0
v_smfmac_f32_16x16x64_bf16 v[24:27],v[52:55],a[40:47],v2
ds_read_b128 v[64:67],v3 offset:1024
v_mov_b32 v17,1
v_smfmac_f32_16x16x64_bf16 v[28:31],v[52:55],a[48:55],v2
ds_read_b128 v[68:71],v4 offset:0
v_smfmac_f32_16x16x64_bf16 v[32:35],v[52:55],a[56:63],v2
s_mov_b64 exec,1
buffer_store_dword v17,v1,s[8:11],s79 offen sc1
s_mov_b64 exec,-1
v_smfmac_f32_16x16x64_bf16 v[36:39],v[52:55],a[64:71],v2
buffer_store_dwordx4 v[102:105],v6,s[8:11],s78 offen sc1
v_smfmac_f32_16x16x64_bf16 v[40:43],v[52:55],a[72:79],v2
buffer_store_dwordx2 v[100:101],v7,s[8:11],s78 offen sc1
s_waitcnt lgkmcnt(5)
v_smfmac_f32_16x16x64_bf16 v[44:47],v[48:51],v[72:79],v2
ds_read_b128 v[72:75],v21 offset:4096
s_waitcnt lgkmcnt(4)
v_smfmac_f32_16x16x64_bf16 v[44:47],v[52:55],v[80:87],v2
ds_read_b128 v[76:79],v21 offset:5120
s_waitcnt lgkmcnt(4)
v_smfmac_f32_16x16x64_bf16 v[24:27],v[60:63],a[80:87],v2
ds_read_b128 v[80:83],v21 offset:6144
s_and_b32 s79,s78,2147483648
v_smfmac_f32_16x16x64_bf16 v[28:31],v[60:63],a[88:95],v2
ds_read_b128 v[84:87],v21 offset:7168
s_or_b32 s79,s79,s30
v_smfmac_f32_16x16x64_bf16 v[32:35],v[60:63],a[96:103],v2
s_mov_b32 s78,2147483648
v_smfmac_f32_16x16x64_bf16 v[36:39],v[60:63],a[104:111],v2
v_smfmac_f32_16x16x64_bf16 v[40:43],v[60:63],a[112:119],v2
s_waitcnt lgkmcnt(2)
v_smfmac_f32_16x16x64_bf16 v[44:47],v[60:63],v[72:79],v2
ds_read_b128 v[60:63],v4 offset:1024
v_smfmac_f32_16x16x64_bf16 v[24:27],v[64:67],a[120:127],v2
ds_read_b128 v[72:75],v21 offset:8192
v_smfmac_f32_16x16x64_bf16 v[28:31],v[64:67],a[128:135],v2
ds_read_b128 v[76:79],v21 offset:9216
v_smfmac_f32_16x16x64_bf16 v[32:35],v[64:67],a[136:143],v2
v_smfmac_f32_16x16x64_bf16 v[36:39],v[64:67],a[144:151],v2
v_smfmac_f32_16x16x64_bf16 v[40:43],v[64:67],a[152:159],v2
s_waitcnt lgkmcnt(3)
v_smfmac_f32_16x16x64_bf16 v[44:47],v[64:67],v[80:87],v2
ds_read_b128 v[64:67],v5 offset:0
v_smfmac_f32_16x16x64_bf16 v[24:27],v[68:71],a[160:167],v2
ds_read_b128 v[80:83],v21 offset:10240
v_smfmac_f32_16x16x64_bf16 v[28:31],v[68:71],a[168:175],v2
ds_read_b128 v[84:87],v21 offset:11264
v_smfmac_f32_16x16x64_bf16 v[32:35],v[68:71],a[176:183],v2
v_smfmac_f32_16x16x64_bf16 v[36:39],v[68:71],a[184:191],v2
v_smfmac_f32_16x16x64_bf16 v[40:43],v[68:71],a[192:199],v2
s_waitcnt lgkmcnt(3)
v_smfmac_f32_16x16x64_bf16 v[44:47],v[68:71],v[72:79],v2
ds_read_b128 v[68:71],v5 offset:1024
v_smfmac_f32_16x16x64_bf16 v[24:27],v[60:63],a[200:207],v2
ds_read_b128 v[72:75],v21 offset:12288
v_smfmac_f32_16x16x64_bf16 v[28:31],v[60:63],a[208:215],v2
ds_read_b128 v[76:79],v21 offset:13312
v_smfmac_f32_16x16x64_bf16 v[32:35],v[60:63],a[216:223],v2
v_smfmac_f32_16x16x64_bf16 v[36:39],v[60:63],a[224:231],v2
v_smfmac_f32_16x16x64_bf16 v[40:43],v[60:63],a[232:239],v2
s_waitcnt lgkmcnt(3)
v_smfmac_f32_16x16x64_bf16 v[44:47],v[60:63],v[80:87],v2
ds_read_b128 v[60:63],v59 offset:0
v_smfmac_f32_16x16x64_bf16 v[24:27],v[64:67],a[240:247],v2
ds_read_b128 v[80:83],v21 offset:14336
v_smfmac_f32_16x16x64_bf16 v[28:31],v[64:67],a[248:255],v2
ds_read_b128 v[84:87],v21 offset:15360
v_smfmac_f32_16x16x64_bf16 v[32:35],v[64:67],v[112:119],v2
v_smfmac_f32_16x16x64_bf16 v[36:39],v[64:67],v[120:127],v2
v_smfmac_f32_16x16x64_bf16 v[40:43],v[64:67],v[128:135],v2
s_waitcnt lgkmcnt(3)
v_smfmac_f32_16x16x64_bf16 v[44:47],v[64:67],v[72:79],v2
ds_read_b128 v[64:67],v59 offset:1024
v_smfmac_f32_16x16x64_bf16 v[24:27],v[68:71],v[136:143],v2
ds_read_b128 v[72:75],v21 offset:16384
v_smfmac_f32_16x16x64_bf16 v[28:31],v[68:71],v[144:151],v2
ds_read_b128 v[76:79],v21 offset:17408
v_smfmac_f32_16x16x64_bf16 v[32:35],v[68:71],v[152:159],v2
v_smfmac_f32_16x16x64_bf16 v[36:39],v[68:71],v[160:167],v2
v_smfmac_f32_16x16x64_bf16 v[40:43],v[68:71],v[168:175],v2
s_waitcnt lgkmcnt(3)
v_smfmac_f32_16x16x64_bf16 v[44:47],v[68:71],v[80:87],v2
ds_read_b128 v[80:83],v21 offset:18432
v_smfmac_f32_16x16x64_bf16 v[24:27],v[60:63],v[176:183],v2
ds_read_b128 v[84:87],v21 offset:19456
v_smfmac_f32_16x16x64_bf16 v[28:31],v[60:63],v[184:191],v2
s_waitcnt lgkmcnt(4)
v_smfmac_f32_16x16x64_bf16 v[24:27],v[64:67],v[216:223],v2
v_smfmac_f32_16x16x64_bf16 v[28:31],v[64:67],v[224:231],v2
v_smfmac_f32_16x16x64_bf16 v[32:35],v[60:63],v[192:199],v2
v_smfmac_f32_16x16x64_bf16 v[36:39],v[60:63],v[200:207],v2
v_add_f32 v24,v24,v25
v_smfmac_f32_16x16x64_bf16 v[32:35],v[64:67],v[232:239],v2
v_add_f32 v26,v26,v27
v_smfmac_f32_16x16x64_bf16 v[36:39],v[64:67],v[240:247],v2
v_add_f32 v28,v28,v29
v_smfmac_f32_16x16x64_bf16 v[40:43],v[60:63],v[208:215],v2
v_add_f32 v30,v30,v31
s_waitcnt lgkmcnt(2)
v_smfmac_f32_16x16x64_bf16 v[44:47],v[60:63],v[72:79],v2
v_cvt_pk_bf16_f32 v100,v24,v26
v_smfmac_f32_16x16x64_bf16 v[40:43],v[64:67],v[248:255],v2
v_cvt_pk_bf16_f32 v101,v28,v30
s_waitcnt lgkmcnt(0)
v_smfmac_f32_16x16x64_bf16 v[44:47],v[64:67],v[80:87],v2
v_and_or_b32 v100,v100,-2,s57
buffer_store_dwordx2 v[100:101],v7,s[8:11],s71 offen sc1
v_add_f32 v32,v32,v33
v_add_f32 v34,v34,v35
v_add_f32 v36,v36,v37
v_add_f32 v38,v38,v39
v_cvt_pk_bf16_f32 v102,v32,v34
v_cvt_pk_bf16_f32 v103,v36,v38
v_and_or_b32 v102,v102,-2,s57
v_add_f32 v40,v40,v41
v_add_f32 v42,v42,v43
v_add_f32 v44,v44,v45
v_add_f32 v46,v46,v47
v_cvt_pk_bf16_f32 v104,v40,v42
v_cvt_pk_bf16_f32 v105,v44,v46
v_and_or_b32 v104,v104,-2,s57
buffer_store_dwordx4 v[102:105],v6,s[8:11],s71 offen sc1
s_lshl_b32 s60,s51,6
s_add_u32 s60,s60,s52
s_mul_i32 s78,s60,196608
s_add_u32 s78,s78,s85
s_lshl_b32 s60,s60,10
s_add_u32 s30,s60,s86
s_sub_u32 s60,s4,s5
s_cmp_gt_i32 s60,13
s_cselect_b32 s53,1,0
s_cmp_eq_u32 s4,64
s_cselect_b32 s53,1,s53
s_cmp_eq_u32 s53,0
s_cselect_b32 s54,s4,s5
s_addc_u32 s4,s4,0
s_add_u32 s5,s5,s53
s_and_b32 s60,s54,1
s_lshl2_add_u32 s60,s53,s60
s_lshl_b32 s68,s60,16
s_add_u32 s68,s68,s83
s_mul_i32 s59,s60,20480
s_add_u32 s59,s59,s6
s_lshl_b32 s69,s53,9
s_add_u32 s69,s69,s7
s_bfe_u32 s31,s54,65537
s_add_u32 s32,s54,1
s_cmp_lg_u32 s53,s51
s_cbranch_scc1 nx_152
s_waitcnt vmcnt(0)
s_cmp_ge_u32 s79,2147483648
s_cbranch_scc1 pf_153
v_mov_b32 v17,1
s_mov_b64 exec,1
buffer_store_dword v17,v1,s[8:11],s79 offen sc1
s_mov_b64 exec,-1
s_mov_b32 s79,2147483648
pf_153:
s_cmp_eq_u32 s78,2147483648
s_cbranch_scc1 pk_154
buffer_store_dwordx4 v[102:105],v6,s[8:11],s78 offen sc1
buffer_store_dwordx2 v[100:101],v7,s[8:11],s78 offen sc1
s_mov_b32 s79,s30
s_mov_b32 s78,2147483648
pk_154:
s_waitcnt vmcnt(0)
s_cmp_ge_u32 s79,2147483648
s_cbranch_scc1 pf_155
v_mov_b32 v17,1
s_mov_b64 exec,1
buffer_store_dword v17,v1,s[8:11],s79 offen sc1
s_mov_b64 exec,-1
s_mov_b32 s79,2147483648
pf_155:
nx_152:
s_add_u32 s50,s50,1
s_mov_b32 s51,s53
s_mov_b32 s52,s54
s_mov_b32 s57,s31
s_mov_b32 s58,s32
s_cmp_lt_u32 s50,128
s_cbranch_scc1 CV_LOOP_S1
s_branch CV_DONE
fr_150:
v_bitop3_b32 v12,v60,v64,s57 bitop3:0x7e
v_bitop3_b32 v13,v68,v68,s57 bitop3:0x7e
v_xor_b32 v14,s57,v68
v_or3_b32 v12,v12,v13,v14
v_and_b32 v12,1,v12
v_cmp_ne_u32 vcc,0,v12
s_cbranch_vccz sk_156
buffer_load_dwordx2 v[68:69],v18,s[8:11],s59 offen sc1
buffer_load_dwordx4 v[60:63],v1,s[8:11],s59 offen sc1
buffer_load_dwordx4 v[64:67],v1,s[8:11],s59 offen offset:1024 sc1
sk_156:
buffer_load_dwordx2 v[78:79],v18,s[8:11],s68 offen sc1
buffer_load_dwordx4 v[70:73],v1,s[8:11],s68 offen sc1
buffer_load_dwordx4 v[74:77],v1,s[8:11],s68 offen offset:1024 sc1
s_sub_u32 s47,s47,1
s_cbranch_scc1 ABORT
s_waitcnt lgkmcnt(0)
s_branch fa_149
CV_DONE:
s_add_u32 s61,s48,32
s_endpgm
ROLE_CW:
s_lshr_b32 s28,s48,3
s_and_b32 s29,s48,7
s_mul_i32 s82,s28,2097152
s_add_u32 s82,s82,2097152
v_lshlrev_b32 v1,4,v0
v_and_b32 v12,1,v0
v_mul_u32_u24 v2,0xaaaa,v12
v_or_b32 v2,0x4444,v2
v_lshrrev_b32 v14,4,v0
v_and_b32 v15,15,v0
v_min_u32 v3,11,v15
v_lshlrev_b32 v3,2,v3
v_lshl_add_u32 v3,v14,7,v3
s_mul_i32 s60,s46,24576
v_add_u32 v4,s60,v1
v_mul_u32_u24 v5,704,v14
v_and_b32 v12,3,v15
v_lshl_add_u32 v5,v12,2,v5
v_bfe_u32 v12,v15,2,1
v_lshl_add_u32 v5,v12,5,v5
v_bfe_u32 v12,v15,3,1
v_lshl_add_u32 v5,v12,4,v5
s_mul_i32 s60,s46,2816
s_add_u32 s60,s60,98304
v_add_u32 v5,s60,v5
s_mul_i32 s60,s46,24
s_min_u32 s60,s60,64
s_cmp_lt_u32 s46,2
s_cselect_b32 s61,23,15
s_mov_b32 s88,0xffff
s_cselect_b32 s88,0xffffff,s88
s_mov_b32 s89,0
v_and_b32 v12,31,v0
v_min_u32 v12,s61,v12
v_add_u32 v12,s60,v12
v_lshrrev_b32 v13,5,v0
v_lshl_add_u32 v12,v12,1,v13
v_bfe_u32 v13,v12,2,3
v_mul_u32_u24 v6,352,v13
v_mul_u32_u24 v17,1280,v13
v_lshrrev_b32 v13,5,v12
v_lshl_add_u32 v6,v13,6,v6
v_lshl_add_u32 v17,v13,5,v17
v_and_b32 v13,3,v12
v_lshl_add_u32 v17,v13,3,v17
v_and_b32 v13,1,v12
v_lshl_add_u32 v6,v13,5,v6
v_bfe_u32 v13,v12,1,1
v_lshl_add_u32 v6,v13,4,v6
v_add_u32 v6,98304,v6
s_mul_i32 s60,s29,1280
v_lshlrev_b32 v9,3,v12
v_add_u32 v9,s60,v9
v_lshrrev_b32 v13,13,v9
v_lshl_add_u32 v9,v13,13,v9
v_xor_b32 v10,1,v12
v_or_b32 v10,v10,v13
v_and_b32 v10,1,v10
s_mov_b32 s4,s18
s_mov_b32 s5,s19
s_mov_b32 s6,10240
s_mov_b32 s7,0x20000
s_mul_i32 s60,s29,160
buffer_load_dwordx2 v[32:33],v17,s[4:7],s60 offen
s_mul_i32 s84,s29,0
s_add_u32 s84,s84,s82
s_lshl_b32 s83,s28,19
s_lshr_b32 s60,s29,1
s_and_b32 s61,s29,1
s_mul_i32 s62,s61,0
s_add_u32 s83,s83,s62
s_add_u32 s83,s83,10485760
s_lshl_b32 s85,s60,7
s_lshl_b32 s61,s61,2
s_add_u32 s61,s61,s46
s_lshl_b32 s61,s61,2
s_add_u32 s85,s85,s61
s_add_u32 s85,s85,s82
s_add_u32 s85,s85,950272
s_mul_i32 s33,s46,12288
s_add_u32 s33,s33,s82
s_add_u32 s33,s33,163840
s_mov_b32 s35,0
s_add_u32 s35,s35,s82
s_add_u32 s35,s35,951296
s_cmp_eq_u32 s28,0
s_cselect_b32 s63,0xffff0000,0
s_waitcnt vmcnt(0)
s_cselect_b64 vcc,-1,0
v_bfi_b32 v36,v10,0,v32
v_lshlrev_b32 v34,16,v32
v_lshlrev_b32 v35,16,v36
v_sub_f32 v34,v34,v35
v_lshrrev_b32 v34,16,v34
v_and_b32 v34,-2,v34
v_cndmask_b32 v36,v34,v36,vcc
v_cndmask_b32 v37,0,v33,vcc
s_nop 0
v_permlane32_swap_b32 v36,v38
v_permlane32_swap_b32 v37,v39
v_mov_b32 v40,-1
v_mov_b32 v41,-1
v_mov_b32 v42,-1
v_mov_b32 v43,-1
v_mov_b32 v44,1
s_mov_b64 exec,s[88:89]
s_add_u32 s60,s83,0
buffer_store_dwordx4 v[36:39],v9,s[8:11],s60 offen sc1
s_add_u32 s60,s83,8192
buffer_store_dwordx4 v[36:39],v9,s[8:11],s60 offen sc1
s_add_u32 s60,s83,65536
buffer_store_dwordx4 v[40:43],v9,s[8:11],s60 offen sc1
s_add_u32 s60,s83,73728
buffer_store_dwordx4 v[40:43],v9,s[8:11],s60 offen sc1
s_add_u32 s60,s83,131072
buffer_store_dwordx4 v[40:43],v9,s[8:11],s60 offen sc1
s_add_u32 s60,s83,139264
buffer_store_dwordx4 v[40:43],v9,s[8:11],s60 offen sc1
s_add_u32 s60,s83,196608
buffer_store_dwordx4 v[40:43],v9,s[8:11],s60 offen sc1
s_add_u32 s60,s83,204800
buffer_store_dwordx4 v[40:43],v9,s[8:11],s60 offen sc1
s_add_u32 s60,s83,262144
buffer_store_dwordx4 v[36:39],v9,s[8:11],s60 offen sc1
s_add_u32 s60,s83,270336
buffer_store_dwordx4 v[36:39],v9,s[8:11],s60 offen sc1
s_add_u32 s60,s83,327680
buffer_store_dwordx4 v[40:43],v9,s[8:11],s60 offen sc1
s_add_u32 s60,s83,335872
buffer_store_dwordx4 v[40:43],v9,s[8:11],s60 offen sc1
s_add_u32 s60,s83,393216
buffer_store_dwordx4 v[40:43],v9,s[8:11],s60 offen sc1
s_add_u32 s60,s83,401408
buffer_store_dwordx4 v[40:43],v9,s[8:11],s60 offen sc1
s_add_u32 s60,s83,458752
buffer_store_dwordx4 v[40:43],v9,s[8:11],s60 offen sc1
s_add_u32 s60,s83,466944
buffer_store_dwordx4 v[40:43],v9,s[8:11],s60 offen sc1
s_cmp_lg_u32 s49,0
s_cbranch_scc1 ls_157
s_add_u32 s60,s84,0
buffer_store_dwordx4 v[36:39],v9,s[8:11],s60 offen
s_add_u32 s60,s84,20480
buffer_store_dwordx4 v[40:43],v9,s[8:11],s60 offen
s_add_u32 s60,s84,40960
buffer_store_dwordx4 v[40:43],v9,s[8:11],s60 offen
s_add_u32 s60,s84,61440
buffer_store_dwordx4 v[40:43],v9,s[8:11],s60 offen
s_add_u32 s60,s84,81920
buffer_store_dwordx4 v[36:39],v9,s[8:11],s60 offen
s_add_u32 s60,s84,102400
buffer_store_dwordx4 v[40:43],v9,s[8:11],s60 offen
s_add_u32 s60,s84,122880
buffer_store_dwordx4 v[40:43],v9,s[8:11],s60 offen
s_add_u32 s60,s84,143360
buffer_store_dwordx4 v[40:43],v9,s[8:11],s60 offen
s_mov_b64 exec,1
buffer_store_dword v44,v1,s[8:11],s85 offen
buffer_store_dword v44,v1,s[8:11],s85 offen offset:512
s_branch ls_158
ls_157:
s_add_u32 s60,s84,0
buffer_store_dwordx4 v[36:39],v9,s[8:11],s60 offen sc1
s_add_u32 s60,s84,20480
buffer_store_dwordx4 v[40:43],v9,s[8:11],s60 offen sc1
s_add_u32 s60,s84,40960
buffer_store_dwordx4 v[40:43],v9,s[8:11],s60 offen sc1
s_add_u32 s60,s84,61440
buffer_store_dwordx4 v[40:43],v9,s[8:11],s60 offen sc1
s_add_u32 s60,s84,81920
buffer_store_dwordx4 v[36:39],v9,s[8:11],s60 offen sc1
s_add_u32 s60,s84,102400
buffer_store_dwordx4 v[40:43],v9,s[8:11],s60 offen sc1
s_add_u32 s60,s84,122880
buffer_store_dwordx4 v[40:43],v9,s[8:11],s60 offen sc1
s_add_u32 s60,s84,143360
buffer_store_dwordx4 v[40:43],v9,s[8:11],s60 offen sc1
s_mov_b64 exec,1
buffer_store_dword v44,v1,s[8:11],s85 offen sc1
buffer_store_dword v44,v1,s[8:11],s85 offen offset:512 sc1
ls_158:
s_mov_b64 exec,-1
s_waitcnt vmcnt(0)
s_barrier
s_cmp_lg_u32 s46,0
s_cbranch_scc1 arr_159
v_mov_b32 v12,1
s_lshl_b32 s3,s49,2
v_mov_b32 v13,s3
s_mov_b64 exec,1
buffer_atomic_add v12,v13,s[12:15],0 offen sc1
s_mov_b64 exec,-1
arr_159:
s_mov_b32 s4,s26
s_mov_b32 s5,s27
s_mov_b32 s6,7864320
s_mov_b32 s7,0x20000
s_lshl_b32 s60,s28,2
s_add_u32 s60,s60,s46
s_mul_i32 s73,s60,983040
s_mul_i32 s60,s29,160
s_add_u32 s73,s73,s60
s_mul_i32 s74,s46,40960
v_add_u32 v12,0,v0
v_mul_u32_u24 v13,6554,v12
v_lshrrev_b32 v13,16,v13
v_mul_u32_u24 v16,10,v13
v_sub_u32 v12,v12,v16
v_mul_u32_u24 v20,1280,v13
v_lshl_add_u32 v20,v12,4,v20
v_add_u32 v12,64,v0
v_mul_u32_u24 v13,6554,v12
v_lshrrev_b32 v13,16,v13
v_mul_u32_u24 v16,10,v13
v_sub_u32 v12,v12,v16
v_mul_u32_u24 v21,1280,v13
v_lshl_add_u32 v21,v12,4,v21
v_add_u32 v12,128,v0
v_mul_u32_u24 v13,6554,v12
v_lshrrev_b32 v13,16,v13
v_mul_u32_u24 v16,10,v13
v_sub_u32 v12,v12,v16
v_mul_u32_u24 v22,1280,v13
v_lshl_add_u32 v22,v12,4,v22
v_add_u32 v12,192,v0
v_mul_u32_u24 v13,6554,v12
v_lshrrev_b32 v13,16,v13
v_mul_u32_u24 v16,10,v13
v_sub_u32 v12,v12,v16
v_mul_u32_u24 v23,1280,v13
v_lshl_add_u32 v23,v12,4,v23
v_add_u32 v12,256,v0
v_mul_u32_u24 v13,6554,v12
v_lshrrev_b32 v13,16,v13
v_mul_u32_u24 v16,10,v13
v_sub_u32 v12,v12,v16
v_mul_u32_u24 v24,1280,v13
v_lshl_add_u32 v24,v12,4,v24
v_add_u32 v12,320,v0
v_mul_u32_u24 v13,6554,v12
v_lshrrev_b32 v13,16,v13
v_mul_u32_u24 v16,10,v13
v_sub_u32 v12,v12,v16
v_mul_u32_u24 v25,1280,v13
v_lshl_add_u32 v25,v12,4,v25
v_add_u32 v12,384,v0
v_mul_u32_u24 v13,6554,v12
v_lshrrev_b32 v13,16,v13
v_mul_u32_u24 v16,10,v13
v_sub_u32 v12,v12,v16
v_mul_u32_u24 v26,1280,v13
v_lshl_add_u32 v26,v12,4,v26
v_add_u32 v12,448,v0
v_mul_u32_u24 v13,6554,v12
v_lshrrev_b32 v13,16,v13
v_mul_u32_u24 v16,10,v13
v_sub_u32 v12,v12,v16
v_mul_u32_u24 v27,1280,v13
v_lshl_add_u32 v27,v12,4,v27
v_add_u32 v12,512,v0
v_mul_u32_u24 v13,6554,v12
v_lshrrev_b32 v13,16,v13
v_mul_u32_u24 v16,10,v13
v_sub_u32 v12,v12,v16
v_mul_u32_u24 v28,1280,v13
v_lshl_add_u32 v28,v12,4,v28
v_add_u32 v12,576,v0
v_mul_u32_u24 v13,6554,v12
v_lshrrev_b32 v13,16,v13
v_mul_u32_u24 v16,10,v13
v_sub_u32 v12,v12,v16
v_mul_u32_u24 v29,1280,v13
v_lshl_add_u32 v29,v12,4,v29
v_lshrrev_b32 v14,4,v0
v_and_b32 v12,1,v14
v_lshlrev_b32 v12,5,v12
v_lshrrev_b32 v13,1,v14
v_lshl_add_u32 v12,v13,2,v12
v_bfe_u32 v13,v0,2,1
v_add_u32 v12,v12,v13
v_bfe_u32 v13,v0,3,1
v_lshl_add_u32 v12,v13,4,v12
v_mul_u32_u24 v30,160,v12
v_and_b32 v13,3,v0
v_lshl_add_u32 v30,v13,3,v30
v_add_u32 v30,s74,v30
s_add_u32 s61,s73,0
s_add_u32 m0,s74,0
s_nop 0
buffer_load_dwordx4 v20,s[4:7],s61 offen lds
s_add_u32 m0,s74,1024
s_nop 0
buffer_load_dwordx4 v21,s[4:7],s61 offen lds
s_add_u32 m0,s74,2048
s_nop 0
buffer_load_dwordx4 v22,s[4:7],s61 offen lds
s_add_u32 m0,s74,3072
s_nop 0
buffer_load_dwordx4 v23,s[4:7],s61 offen lds
s_add_u32 m0,s74,4096
s_nop 0
buffer_load_dwordx4 v24,s[4:7],s61 offen lds
s_add_u32 m0,s74,5120
s_nop 0
buffer_load_dwordx4 v25,s[4:7],s61 offen lds
s_add_u32 m0,s74,6144
s_nop 0
buffer_load_dwordx4 v26,s[4:7],s61 offen lds
s_add_u32 m0,s74,7168
s_nop 0
buffer_load_dwordx4 v27,s[4:7],s61 offen lds
s_add_u32 m0,s74,8192
s_nop 0
buffer_load_dwordx4 v28,s[4:7],s61 offen lds
s_add_u32 m0,s74,9216
s_nop 0
buffer_load_dwordx4 v29,s[4:7],s61 offen lds
s_add_u32 s61,s73,81920
s_add_u32 m0,s74,10240
s_nop 0
buffer_load_dwordx4 v20,s[4:7],s61 offen lds
s_add_u32 m0,s74,11264
s_nop 0
buffer_load_dwordx4 v21,s[4:7],s61 offen lds
s_add_u32 m0,s74,12288
s_nop 0
buffer_load_dwordx4 v22,s[4:7],s61 offen lds
s_add_u32 m0,s74,13312
s_nop 0
buffer_load_dwordx4 v23,s[4:7],s61 offen lds
s_add_u32 m0,s74,14336
s_nop 0
buffer_load_dwordx4 v24,s[4:7],s61 offen lds
s_add_u32 m0,s74,15360
s_nop 0
buffer_load_dwordx4 v25,s[4:7],s61 offen lds
s_add_u32 m0,s74,16384
s_nop 0
buffer_load_dwordx4 v26,s[4:7],s61 offen lds
s_add_u32 m0,s74,17408
s_nop 0
buffer_load_dwordx4 v27,s[4:7],s61 offen lds
s_add_u32 m0,s74,18432
s_nop 0
buffer_load_dwordx4 v28,s[4:7],s61 offen lds
s_add_u32 m0,s74,19456
s_nop 0
buffer_load_dwordx4 v29,s[4:7],s61 offen lds
s_add_u32 s61,s73,163840
s_add_u32 m0,s74,20480
s_nop 0
buffer_load_dwordx4 v20,s[4:7],s61 offen lds
s_add_u32 m0,s74,21504
s_nop 0
buffer_load_dwordx4 v21,s[4:7],s61 offen lds
s_add_u32 m0,s74,22528
s_nop 0
buffer_load_dwordx4 v22,s[4:7],s61 offen lds
s_add_u32 m0,s74,23552
s_nop 0
buffer_load_dwordx4 v23,s[4:7],s61 offen lds
s_add_u32 m0,s74,24576
s_nop 0
buffer_load_dwordx4 v24,s[4:7],s61 offen lds
s_add_u32 m0,s74,25600
s_nop 0
buffer_load_dwordx4 v25,s[4:7],s61 offen lds
s_add_u32 m0,s74,26624
s_nop 0
buffer_load_dwordx4 v26,s[4:7],s61 offen lds
s_add_u32 m0,s74,27648
s_nop 0
buffer_load_dwordx4 v27,s[4:7],s61 offen lds
s_add_u32 m0,s74,28672
s_nop 0
buffer_load_dwordx4 v28,s[4:7],s61 offen lds
s_add_u32 m0,s74,29696
s_nop 0
buffer_load_dwordx4 v29,s[4:7],s61 offen lds
s_add_u32 s61,s73,245760
s_add_u32 m0,s74,30720
s_nop 0
buffer_load_dwordx4 v20,s[4:7],s61 offen lds
s_add_u32 m0,s74,31744
s_nop 0
buffer_load_dwordx4 v21,s[4:7],s61 offen lds
s_add_u32 m0,s74,32768
s_nop 0
buffer_load_dwordx4 v22,s[4:7],s61 offen lds
s_add_u32 m0,s74,33792
s_nop 0
buffer_load_dwordx4 v23,s[4:7],s61 offen lds
s_add_u32 m0,s74,34816
s_nop 0
buffer_load_dwordx4 v24,s[4:7],s61 offen lds
s_add_u32 m0,s74,35840
s_nop 0
buffer_load_dwordx4 v25,s[4:7],s61 offen lds
s_add_u32 m0,s74,36864
s_nop 0
buffer_load_dwordx4 v26,s[4:7],s61 offen lds
s_add_u32 m0,s74,37888
s_nop 0
buffer_load_dwordx4 v27,s[4:7],s61 offen lds
s_add_u32 m0,s74,38912
s_nop 0
buffer_load_dwordx4 v28,s[4:7],s61 offen lds
s_add_u32 m0,s74,39936
s_nop 0
buffer_load_dwordx4 v29,s[4:7],s61 offen lds
s_waitcnt vmcnt(30)
ds_read_b64_tr_b16 a[0:1],v30 offset:0
ds_read_b64_tr_b16 a[2:3],v30 offset:320
ds_read_b64_tr_b16 a[4:5],v30 offset:1280
ds_read_b64_tr_b16 a[6:7],v30 offset:1600
ds_read_b64_tr_b16 a[8:9],v30 offset:32
ds_read_b64_tr_b16 a[10:11],v30 offset:352
ds_read_b64_tr_b16 a[12:13],v30 offset:1312
ds_read_b64_tr_b16 a[14:15],v30 offset:1632
ds_read_b64_tr_b16 a[16:17],v30 offset:64
ds_read_b64_tr_b16 a[18:19],v30 offset:384
ds_read_b64_tr_b16 a[20:21],v30 offset:1344
ds_read_b64_tr_b16 a[22:23],v30 offset:1664
s_waitcnt lgkmcnt(4)
ds_read_b64_tr_b16 a[24:25],v30 offset:96
ds_read_b64_tr_b16 a[26:27],v30 offset:416
ds_read_b64_tr_b16 a[28:29],v30 offset:1376
ds_read_b64_tr_b16 a[30:31],v30 offset:1696
ds_read_b64_tr_b16 v[32:33],v30 offset:128
ds_read_b64_tr_b16 v[34:35],v30 offset:448
ds_read_b64_tr_b16 v[36:37],v30 offset:1408
ds_read_b64_tr_b16 v[38:39],v30 offset:1728
s_waitcnt lgkmcnt(0)
s_add_u32 s61,s73,327680
s_add_u32 m0,s74,0
s_nop 0
buffer_load_dwordx4 v20,s[4:7],s61 offen lds
s_add_u32 m0,s74,1024
s_nop 0
buffer_load_dwordx4 v21,s[4:7],s61 offen lds
s_add_u32 m0,s74,2048
s_nop 0
buffer_load_dwordx4 v22,s[4:7],s61 offen lds
s_add_u32 m0,s74,3072
s_nop 0
buffer_load_dwordx4 v23,s[4:7],s61 offen lds
s_add_u32 m0,s74,4096
s_nop 0
buffer_load_dwordx4 v24,s[4:7],s61 offen lds
s_add_u32 m0,s74,5120
s_nop 0
buffer_load_dwordx4 v25,s[4:7],s61 offen lds
s_add_u32 m0,s74,6144
s_nop 0
buffer_load_dwordx4 v26,s[4:7],s61 offen lds
s_add_u32 m0,s74,7168
s_nop 0
buffer_load_dwordx4 v27,s[4:7],s61 offen lds
s_add_u32 m0,s74,8192
s_nop 0
buffer_load_dwordx4 v28,s[4:7],s61 offen lds
s_add_u32 m0,s74,9216
s_nop 0
buffer_load_dwordx4 v29,s[4:7],s61 offen lds
s_waitcnt vmcnt(30)
ds_read_b64_tr_b16 a[32:33],v30 offset:10240
ds_read_b64_tr_b16 a[34:35],v30 offset:10560
ds_read_b64_tr_b16 a[36:37],v30 offset:11520
ds_read_b64_tr_b16 a[38:39],v30 offset:11840
ds_read_b64_tr_b16 a[40:41],v30 offset:10272
ds_read_b64_tr_b16 a[42:43],v30 offset:10592
ds_read_b64_tr_b16 a[44:45],v30 offset:11552
ds_read_b64_tr_b16 a[46:47],v30 offset:11872
ds_read_b64_tr_b16 a[48:49],v30 offset:10304
ds_read_b64_tr_b16 a[50:51],v30 offset:10624
ds_read_b64_tr_b16 a[52:53],v30 offset:11584
ds_read_b64_tr_b16 a[54:55],v30 offset:11904
s_waitcnt lgkmcnt(4)
ds_read_b64_tr_b16 a[56:57],v30 offset:10336
ds_read_b64_tr_b16 a[58:59],v30 offset:10656
ds_read_b64_tr_b16 a[60:61],v30 offset:11616
ds_read_b64_tr_b16 a[62:63],v30 offset:11936
ds_read_b64_tr_b16 v[40:41],v30 offset:10368
ds_read_b64_tr_b16 v[42:43],v30 offset:10688
ds_read_b64_tr_b16 v[44:45],v30 offset:11648
ds_read_b64_tr_b16 v[46:47],v30 offset:11968
s_waitcnt lgkmcnt(0)
s_add_u32 s61,s73,409600
s_add_u32 m0,s74,10240
s_nop 0
buffer_load_dwordx4 v20,s[4:7],s61 offen lds
s_add_u32 m0,s74,11264
s_nop 0
buffer_load_dwordx4 v21,s[4:7],s61 offen lds
s_add_u32 m0,s74,12288
s_nop 0
buffer_load_dwordx4 v22,s[4:7],s61 offen lds
s_add_u32 m0,s74,13312
s_nop 0
buffer_load_dwordx4 v23,s[4:7],s61 offen lds
s_add_u32 m0,s74,14336
s_nop 0
buffer_load_dwordx4 v24,s[4:7],s61 offen lds
s_add_u32 m0,s74,15360
s_nop 0
buffer_load_dwordx4 v25,s[4:7],s61 offen lds
s_add_u32 m0,s74,16384
s_nop 0
buffer_load_dwordx4 v26,s[4:7],s61 offen lds
s_add_u32 m0,s74,17408
s_nop 0
buffer_load_dwordx4 v27,s[4:7],s61 offen lds
s_add_u32 m0,s74,18432
s_nop 0
buffer_load_dwordx4 v28,s[4:7],s61 offen lds
s_add_u32 m0,s74,19456
s_nop 0
buffer_load_dwordx4 v29,s[4:7],s61 offen lds
s_waitcnt vmcnt(30)
ds_read_b64_tr_b16 a[64:65],v30 offset:20480
ds_read_b64_tr_b16 a[66:67],v30 offset:20800
ds_read_b64_tr_b16 a[68:69],v30 offset:21760
ds_read_b64_tr_b16 a[70:71],v30 offset:22080
ds_read_b64_tr_b16 a[72:73],v30 offset:20512
ds_read_b64_tr_b16 a[74:75],v30 offset:20832
ds_read_b64_tr_b16 a[76:77],v30 offset:21792
ds_read_b64_tr_b16 a[78:79],v30 offset:22112
ds_read_b64_tr_b16 a[80:81],v30 offset:20544
ds_read_b64_tr_b16 a[82:83],v30 offset:20864
ds_read_b64_tr_b16 a[84:85],v30 offset:21824
ds_read_b64_tr_b16 a[86:87],v30 offset:22144
s_waitcnt lgkmcnt(4)
ds_read_b64_tr_b16 a[88:89],v30 offset:20576
ds_read_b64_tr_b16 a[90:91],v30 offset:20896
ds_read_b64_tr_b16 a[92:93],v30 offset:21856
ds_read_b64_tr_b16 a[94:95],v30 offset:22176
ds_read_b64_tr_b16 v[48:49],v30 offset:20608
ds_read_b64_tr_b16 v[50:51],v30 offset:20928
ds_read_b64_tr_b16 v[52:53],v30 offset:21888
ds_read_b64_tr_b16 v[54:55],v30 offset:22208
s_waitcnt lgkmcnt(0)
s_add_u32 s61,s73,491520
s_add_u32 m0,s74,20480
s_nop 0
buffer_load_dwordx4 v20,s[4:7],s61 offen lds
s_add_u32 m0,s74,21504
s_nop 0
buffer_load_dwordx4 v21,s[4:7],s61 offen lds
s_add_u32 m0,s74,22528
s_nop 0
buffer_load_dwordx4 v22,s[4:7],s61 offen lds
s_add_u32 m0,s74,23552
s_nop 0
buffer_load_dwordx4 v23,s[4:7],s61 offen lds
s_add_u32 m0,s74,24576
s_nop 0
buffer_load_dwordx4 v24,s[4:7],s61 offen lds
s_add_u32 m0,s74,25600
s_nop 0
buffer_load_dwordx4 v25,s[4:7],s61 offen lds
s_add_u32 m0,s74,26624
s_nop 0
buffer_load_dwordx4 v26,s[4:7],s61 offen lds
s_add_u32 m0,s74,27648
s_nop 0
buffer_load_dwordx4 v27,s[4:7],s61 offen lds
s_add_u32 m0,s74,28672
s_nop 0
buffer_load_dwordx4 v28,s[4:7],s61 offen lds
s_add_u32 m0,s74,29696
s_nop 0
buffer_load_dwordx4 v29,s[4:7],s61 offen lds
s_waitcnt vmcnt(30)
ds_read_b64_tr_b16 a[96:97],v30 offset:30720
ds_read_b64_tr_b16 a[98:99],v30 offset:31040
ds_read_b64_tr_b16 a[100:101],v30 offset:32000
ds_read_b64_tr_b16 a[102:103],v30 offset:32320
ds_read_b64_tr_b16 a[104:105],v30 offset:30752
ds_read_b64_tr_b16 a[106:107],v30 offset:31072
ds_read_b64_tr_b16 a[108:109],v30 offset:32032
ds_read_b64_tr_b16 a[110:111],v30 offset:32352
ds_read_b64_tr_b16 a[112:113],v30 offset:30784
ds_read_b64_tr_b16 a[114:115],v30 offset:31104
ds_read_b64_tr_b16 a[116:117],v30 offset:32064
ds_read_b64_tr_b16 a[118:119],v30 offset:32384
s_waitcnt lgkmcnt(4)
ds_read_b64_tr_b16 a[120:121],v30 offset:30816
ds_read_b64_tr_b16 a[122:123],v30 offset:31136
ds_read_b64_tr_b16 a[124:125],v30 offset:32096
ds_read_b64_tr_b16 a[126:127],v30 offset:32416
ds_read_b64_tr_b16 v[56:57],v30 offset:30848
ds_read_b64_tr_b16 v[58:59],v30 offset:31168
ds_read_b64_tr_b16 v[60:61],v30 offset:32128
ds_read_b64_tr_b16 v[62:63],v30 offset:32448
s_waitcnt lgkmcnt(0)
s_add_u32 s61,s73,573440
s_add_u32 m0,s74,30720
s_nop 0
buffer_load_dwordx4 v20,s[4:7],s61 offen lds
s_add_u32 m0,s74,31744
s_nop 0
buffer_load_dwordx4 v21,s[4:7],s61 offen lds
s_add_u32 m0,s74,32768
s_nop 0
buffer_load_dwordx4 v22,s[4:7],s61 offen lds
s_add_u32 m0,s74,33792
s_nop 0
buffer_load_dwordx4 v23,s[4:7],s61 offen lds
s_add_u32 m0,s74,34816
s_nop 0
buffer_load_dwordx4 v24,s[4:7],s61 offen lds
s_add_u32 m0,s74,35840
s_nop 0
buffer_load_dwordx4 v25,s[4:7],s61 offen lds
s_add_u32 m0,s74,36864
s_nop 0
buffer_load_dwordx4 v26,s[4:7],s61 offen lds
s_add_u32 m0,s74,37888
s_nop 0
buffer_load_dwordx4 v27,s[4:7],s61 offen lds
s_add_u32 m0,s74,38912
s_nop 0
buffer_load_dwordx4 v28,s[4:7],s61 offen lds
s_add_u32 m0,s74,39936
s_nop 0
buffer_load_dwordx4 v29,s[4:7],s61 offen lds
s_waitcnt vmcnt(30)
ds_read_b64_tr_b16 a[128:129],v30 offset:0
ds_read_b64_tr_b16 a[130:131],v30 offset:320
ds_read_b64_tr_b16 a[132:133],v30 offset:1280
ds_read_b64_tr_b16 a[134:135],v30 offset:1600
ds_read_b64_tr_b16 a[136:137],v30 offset:32
ds_read_b64_tr_b16 a[138:139],v30 offset:352
ds_read_b64_tr_b16 a[140:141],v30 offset:1312
ds_read_b64_tr_b16 a[142:143],v30 offset:1632
ds_read_b64_tr_b16 a[144:145],v30 offset:64
ds_read_b64_tr_b16 a[146:147],v30 offset:384
ds_read_b64_tr_b16 a[148:149],v30 offset:1344
ds_read_b64_tr_b16 a[150:151],v30 offset:1664
s_waitcnt lgkmcnt(4)
ds_read_b64_tr_b16 a[152:153],v30 offset:96
ds_read_b64_tr_b16 a[154:155],v30 offset:416
ds_read_b64_tr_b16 a[156:157],v30 offset:1376
ds_read_b64_tr_b16 a[158:159],v30 offset:1696
ds_read_b64_tr_b16 v[64:65],v30 offset:128
ds_read_b64_tr_b16 v[66:67],v30 offset:448
ds_read_b64_tr_b16 v[68:69],v30 offset:1408
ds_read_b64_tr_b16 v[70:71],v30 offset:1728
s_waitcnt lgkmcnt(0)
s_add_u32 s61,s73,655360
s_add_u32 m0,s74,0
s_nop 0
buffer_load_dwordx4 v20,s[4:7],s61 offen lds
s_add_u32 m0,s74,1024
s_nop 0
buffer_load_dwordx4 v21,s[4:7],s61 offen lds
s_add_u32 m0,s74,2048
s_nop 0
buffer_load_dwordx4 v22,s[4:7],s61 offen lds
s_add_u32 m0,s74,3072
s_nop 0
buffer_load_dwordx4 v23,s[4:7],s61 offen lds
s_add_u32 m0,s74,4096
s_nop 0
buffer_load_dwordx4 v24,s[4:7],s61 offen lds
s_add_u32 m0,s74,5120
s_nop 0
buffer_load_dwordx4 v25,s[4:7],s61 offen lds
s_add_u32 m0,s74,6144
s_nop 0
buffer_load_dwordx4 v26,s[4:7],s61 offen lds
s_add_u32 m0,s74,7168
s_nop 0
buffer_load_dwordx4 v27,s[4:7],s61 offen lds
s_add_u32 m0,s74,8192
s_nop 0
buffer_load_dwordx4 v28,s[4:7],s61 offen lds
s_add_u32 m0,s74,9216
s_nop 0
buffer_load_dwordx4 v29,s[4:7],s61 offen lds
s_waitcnt vmcnt(30)
ds_read_b64_tr_b16 a[160:161],v30 offset:10240
ds_read_b64_tr_b16 a[162:163],v30 offset:10560
ds_read_b64_tr_b16 a[164:165],v30 offset:11520
ds_read_b64_tr_b16 a[166:167],v30 offset:11840
ds_read_b64_tr_b16 a[168:169],v30 offset:10272
ds_read_b64_tr_b16 a[170:171],v30 offset:10592
ds_read_b64_tr_b16 a[172:173],v30 offset:11552
ds_read_b64_tr_b16 a[174:175],v30 offset:11872
ds_read_b64_tr_b16 a[176:177],v30 offset:10304
ds_read_b64_tr_b16 a[178:179],v30 offset:10624
ds_read_b64_tr_b16 a[180:181],v30 offset:11584
ds_read_b64_tr_b16 a[182:183],v30 offset:11904
s_waitcnt lgkmcnt(4)
ds_read_b64_tr_b16 a[184:185],v30 offset:10336
ds_read_b64_tr_b16 a[186:187],v30 offset:10656
ds_read_b64_tr_b16 a[188:189],v30 offset:11616
ds_read_b64_tr_b16 a[190:191],v30 offset:11936
ds_read_b64_tr_b16 v[72:73],v30 offset:10368
ds_read_b64_tr_b16 v[74:75],v30 offset:10688
ds_read_b64_tr_b16 v[76:77],v30 offset:11648
ds_read_b64_tr_b16 v[78:79],v30 offset:11968
s_waitcnt lgkmcnt(0)
s_add_u32 s61,s73,737280
s_add_u32 m0,s74,10240
s_nop 0
buffer_load_dwordx4 v20,s[4:7],s61 offen lds
s_add_u32 m0,s74,11264
s_nop 0
buffer_load_dwordx4 v21,s[4:7],s61 offen lds
s_add_u32 m0,s74,12288
s_nop 0
buffer_load_dwordx4 v22,s[4:7],s61 offen lds
s_add_u32 m0,s74,13312
s_nop 0
buffer_load_dwordx4 v23,s[4:7],s61 offen lds
s_add_u32 m0,s74,14336
s_nop 0
buffer_load_dwordx4 v24,s[4:7],s61 offen lds
s_add_u32 m0,s74,15360
s_nop 0
buffer_load_dwordx4 v25,s[4:7],s61 offen lds
s_add_u32 m0,s74,16384
s_nop 0
buffer_load_dwordx4 v26,s[4:7],s61 offen lds
s_add_u32 m0,s74,17408
s_nop 0
buffer_load_dwordx4 v27,s[4:7],s61 offen lds
s_add_u32 m0,s74,18432
s_nop 0
buffer_load_dwordx4 v28,s[4:7],s61 offen lds
s_add_u32 m0,s74,19456
s_nop 0
buffer_load_dwordx4 v29,s[4:7],s61 offen lds
s_waitcnt vmcnt(30)
ds_read_b64_tr_b16 a[192:193],v30 offset:20480
ds_read_b64_tr_b16 a[194:195],v30 offset:20800
ds_read_b64_tr_b16 a[196:197],v30 offset:21760
ds_read_b64_tr_b16 a[198:199],v30 offset:22080
ds_read_b64_tr_b16 a[200:201],v30 offset:20512
ds_read_b64_tr_b16 a[202:203],v30 offset:20832
ds_read_b64_tr_b16 a[204:205],v30 offset:21792
ds_read_b64_tr_b16 a[206:207],v30 offset:22112
ds_read_b64_tr_b16 a[208:209],v30 offset:20544
ds_read_b64_tr_b16 a[210:211],v30 offset:20864
ds_read_b64_tr_b16 a[212:213],v30 offset:21824
ds_read_b64_tr_b16 a[214:215],v30 offset:22144
s_waitcnt lgkmcnt(4)
ds_read_b64_tr_b16 a[216:217],v30 offset:20576
ds_read_b64_tr_b16 a[218:219],v30 offset:20896
ds_read_b64_tr_b16 a[220:221],v30 offset:21856
ds_read_b64_tr_b16 a[222:223],v30 offset:22176
ds_read_b64_tr_b16 v[80:81],v30 offset:20608
ds_read_b64_tr_b16 v[82:83],v30 offset:20928
ds_read_b64_tr_b16 v[84:85],v30 offset:21888
ds_read_b64_tr_b16 v[86:87],v30 offset:22208
s_waitcnt lgkmcnt(0)
s_add_u32 s61,s73,819200
s_add_u32 m0,s74,20480
s_nop 0
buffer_load_dwordx4 v20,s[4:7],s61 offen lds
s_add_u32 m0,s74,21504
s_nop 0
buffer_load_dwordx4 v21,s[4:7],s61 offen lds
s_add_u32 m0,s74,22528
s_nop 0
buffer_load_dwordx4 v22,s[4:7],s61 offen lds
s_add_u32 m0,s74,23552
s_nop 0
buffer_load_dwordx4 v23,s[4:7],s61 offen lds
s_add_u32 m0,s74,24576
s_nop 0
buffer_load_dwordx4 v24,s[4:7],s61 offen lds
s_add_u32 m0,s74,25600
s_nop 0
buffer_load_dwordx4 v25,s[4:7],s61 offen lds
s_add_u32 m0,s74,26624
s_nop 0
buffer_load_dwordx4 v26,s[4:7],s61 offen lds
s_add_u32 m0,s74,27648
s_nop 0
buffer_load_dwordx4 v27,s[4:7],s61 offen lds
s_add_u32 m0,s74,28672
s_nop 0
buffer_load_dwordx4 v28,s[4:7],s61 offen lds
s_add_u32 m0,s74,29696
s_nop 0
buffer_load_dwordx4 v29,s[4:7],s61 offen lds
s_waitcnt vmcnt(30)
ds_read_b64_tr_b16 a[224:225],v30 offset:30720
ds_read_b64_tr_b16 a[226:227],v30 offset:31040
ds_read_b64_tr_b16 a[228:229],v30 offset:32000
ds_read_b64_tr_b16 a[230:231],v30 offset:32320
ds_read_b64_tr_b16 a[232:233],v30 offset:30752
ds_read_b64_tr_b16 a[234:235],v30 offset:31072
ds_read_b64_tr_b16 a[236:237],v30 offset:32032
ds_read_b64_tr_b16 a[238:239],v30 offset:32352
ds_read_b64_tr_b16 a[240:241],v30 offset:30784
ds_read_b64_tr_b16 a[242:243],v30 offset:31104
ds_read_b64_tr_b16 a[244:245],v30 offset:32064
ds_read_b64_tr_b16 a[246:247],v30 offset:32384
s_waitcnt lgkmcnt(4)
ds_read_b64_tr_b16 a[248:249],v30 offset:30816
ds_read_b64_tr_b16 a[250:251],v30 offset:31136
ds_read_b64_tr_b16 a[252:253],v30 offset:32096
ds_read_b64_tr_b16 a[254:255],v30 offset:32416
ds_read_b64_tr_b16 v[88:89],v30 offset:30848
ds_read_b64_tr_b16 v[90:91],v30 offset:31168
ds_read_b64_tr_b16 v[92:93],v30 offset:32128
ds_read_b64_tr_b16 v[94:95],v30 offset:32448
s_waitcnt lgkmcnt(0)
s_add_u32 s61,s73,901120
s_add_u32 m0,s74,30720
s_nop 0
buffer_load_dwordx4 v20,s[4:7],s61 offen lds
s_add_u32 m0,s74,31744
s_nop 0
buffer_load_dwordx4 v21,s[4:7],s61 offen lds
s_add_u32 m0,s74,32768
s_nop 0
buffer_load_dwordx4 v22,s[4:7],s61 offen lds
s_add_u32 m0,s74,33792
s_nop 0
buffer_load_dwordx4 v23,s[4:7],s61 offen lds
s_add_u32 m0,s74,34816
s_nop 0
buffer_load_dwordx4 v24,s[4:7],s61 offen lds
s_add_u32 m0,s74,35840
s_nop 0
buffer_load_dwordx4 v25,s[4:7],s61 offen lds
s_add_u32 m0,s74,36864
s_nop 0
buffer_load_dwordx4 v26,s[4:7],s61 offen lds
s_add_u32 m0,s74,37888
s_nop 0
buffer_load_dwordx4 v27,s[4:7],s61 offen lds
s_add_u32 m0,s74,38912
s_nop 0
buffer_load_dwordx4 v28,s[4:7],s61 offen lds
s_add_u32 m0,s74,39936
s_nop 0
buffer_load_dwordx4 v29,s[4:7],s61 offen lds
s_waitcnt vmcnt(30)
ds_read_b64_tr_b16 v[128:129],v30 offset:0
ds_read_b64_tr_b16 v[130:131],v30 offset:320
ds_read_b64_tr_b16 v[132:133],v30 offset:1280
ds_read_b64_tr_b16 v[134:135],v30 offset:1600
ds_read_b64_tr_b16 v[136:137],v30 offset:32
ds_read_b64_tr_b16 v[138:139],v30 offset:352
ds_read_b64_tr_b16 v[140:141],v30 offset:1312
ds_read_b64_tr_b16 v[142:143],v30 offset:1632
ds_read_b64_tr_b16 v[144:145],v30 offset:64
ds_read_b64_tr_b16 v[146:147],v30 offset:384
ds_read_b64_tr_b16 v[148:149],v30 offset:1344
ds_read_b64_tr_b16 v[150:151],v30 offset:1664
s_waitcnt lgkmcnt(4)
ds_read_b64_tr_b16 v[152:153],v30 offset:96
ds_read_b64_tr_b16 v[154:155],v30 offset:416
ds_read_b64_tr_b16 v[156:157],v30 offset:1376
ds_read_b64_tr_b16 v[158:159],v30 offset:1696
ds_read_b64_tr_b16 v[96:97],v30 offset:128
ds_read_b64_tr_b16 v[98:99],v30 offset:448
ds_read_b64_tr_b16 v[100:101],v30 offset:1408
ds_read_b64_tr_b16 v[102:103],v30 offset:1728
s_waitcnt lgkmcnt(0)
s_waitcnt vmcnt(20)
ds_read_b64_tr_b16 v[160:161],v30 offset:10240
ds_read_b64_tr_b16 v[162:163],v30 offset:10560
ds_read_b64_tr_b16 v[164:165],v30 offset:11520
ds_read_b64_tr_b16 v[166:167],v30 offset:11840
ds_read_b64_tr_b16 v[168:169],v30 offset:10272
ds_read_b64_tr_b16 v[170:171],v30 offset:10592
ds_read_b64_tr_b16 v[172:173],v30 offset:11552
ds_read_b64_tr_b16 v[174:175],v30 offset:11872
ds_read_b64_tr_b16 v[176:177],v30 offset:10304
ds_read_b64_tr_b16 v[178:179],v30 offset:10624
ds_read_b64_tr_b16 v[180:181],v30 offset:11584
ds_read_b64_tr_b16 v[182:183],v30 offset:11904
s_waitcnt lgkmcnt(4)
ds_read_b64_tr_b16 v[184:185],v30 offset:10336
ds_read_b64_tr_b16 v[186:187],v30 offset:10656
ds_read_b64_tr_b16 v[188:189],v30 offset:11616
ds_read_b64_tr_b16 v[190:191],v30 offset:11936
ds_read_b64_tr_b16 v[104:105],v30 offset:10368
ds_read_b64_tr_b16 v[106:107],v30 offset:10688
ds_read_b64_tr_b16 v[108:109],v30 offset:11648
ds_read_b64_tr_b16 v[110:111],v30 offset:11968
s_waitcnt lgkmcnt(0)
s_waitcnt vmcnt(10)
ds_read_b64_tr_b16 v[192:193],v30 offset:20480
ds_read_b64_tr_b16 v[194:195],v30 offset:20800
ds_read_b64_tr_b16 v[196:197],v30 offset:21760
ds_read_b64_tr_b16 v[198:199],v30 offset:22080
ds_read_b64_tr_b16 v[200:201],v30 offset:20512
ds_read_b64_tr_b16 v[202:203],v30 offset:20832
ds_read_b64_tr_b16 v[204:205],v30 offset:21792
ds_read_b64_tr_b16 v[206:207],v30 offset:22112
ds_read_b64_tr_b16 v[208:209],v30 offset:20544
ds_read_b64_tr_b16 v[210:211],v30 offset:20864
ds_read_b64_tr_b16 v[212:213],v30 offset:21824
ds_read_b64_tr_b16 v[214:215],v30 offset:22144
s_waitcnt lgkmcnt(4)
ds_read_b64_tr_b16 v[216:217],v30 offset:20576
ds_read_b64_tr_b16 v[218:219],v30 offset:20896
ds_read_b64_tr_b16 v[220:221],v30 offset:21856
ds_read_b64_tr_b16 v[222:223],v30 offset:22176
ds_read_b64_tr_b16 v[112:113],v30 offset:20608
ds_read_b64_tr_b16 v[114:115],v30 offset:20928
ds_read_b64_tr_b16 v[116:117],v30 offset:21888
ds_read_b64_tr_b16 v[118:119],v30 offset:22208
s_waitcnt lgkmcnt(0)
s_waitcnt vmcnt(0)
ds_read_b64_tr_b16 v[224:225],v30 offset:30720
ds_read_b64_tr_b16 v[226:227],v30 offset:31040
ds_read_b64_tr_b16 v[228:229],v30 offset:32000
ds_read_b64_tr_b16 v[230:231],v30 offset:32320
ds_read_b64_tr_b16 v[232:233],v30 offset:30752
ds_read_b64_tr_b16 v[234:235],v30 offset:31072
ds_read_b64_tr_b16 v[236:237],v30 offset:32032
ds_read_b64_tr_b16 v[238:239],v30 offset:32352
ds_read_b64_tr_b16 v[240:241],v30 offset:30784
ds_read_b64_tr_b16 v[242:243],v30 offset:31104
ds_read_b64_tr_b16 v[244:245],v30 offset:32064
ds_read_b64_tr_b16 v[246:247],v30 offset:32384
s_waitcnt lgkmcnt(4)
ds_read_b64_tr_b16 v[248:249],v30 offset:30816
ds_read_b64_tr_b16 v[250:251],v30 offset:31136
ds_read_b64_tr_b16 v[252:253],v30 offset:32096
ds_read_b64_tr_b16 v[254:255],v30 offset:32416
ds_read_b64_tr_b16 v[120:121],v30 offset:30848
ds_read_b64_tr_b16 v[122:123],v30 offset:31168
ds_read_b64_tr_b16 v[124:125],v30 offset:32128
ds_read_b64_tr_b16 v[126:127],v30 offset:32448
s_waitcnt lgkmcnt(0)
s_barrier
ds_write_b128 v4,v[32:35] offset:0
ds_write_b128 v4,v[36:39] offset:1024
ds_write_b128 v4,v[40:43] offset:2048
ds_write_b128 v4,v[44:47] offset:3072
ds_write_b128 v4,v[48:51] offset:4096
ds_write_b128 v4,v[52:55] offset:5120
ds_write_b128 v4,v[56:59] offset:6144
ds_write_b128 v4,v[60:63] offset:7168
s_waitcnt lgkmcnt(0)
ds_write_b128 v4,v[64:67] offset:8192
ds_write_b128 v4,v[68:71] offset:9216
ds_write_b128 v4,v[72:75] offset:10240
ds_write_b128 v4,v[76:79] offset:11264
ds_write_b128 v4,v[80:83] offset:12288
ds_write_b128 v4,v[84:87] offset:13312
ds_write_b128 v4,v[88:91] offset:14336
ds_write_b128 v4,v[92:95] offset:15360
s_waitcnt lgkmcnt(0)
ds_write_b128 v4,v[96:99] offset:16384
ds_write_b128 v4,v[100:103] offset:17408
ds_write_b128 v4,v[104:107] offset:18432
ds_write_b128 v4,v[108:111] offset:19456
ds_write_b128 v4,v[112:115] offset:20480
ds_write_b128 v4,v[116:119] offset:21504
ds_write_b128 v4,v[120:123] offset:22528
ds_write_b128 v4,v[124:127] offset:23552
s_waitcnt lgkmcnt(0)
s_barrier
s_lshl_b32 s3,s49,2
v_mov_b32 v13,s3
s_nop 1
ibw_160:
buffer_load_dword v12,v13,s[12:15],0 offen sc1
s_waitcnt vmcnt(0)
v_cmp_ne_u32 vcc,256,v12
s_nop 0
s_cbranch_vccz ok_161
s_sleep 8
s_sub_u32 s47,s47,1
s_cbranch_scc1 ABORT
s_branch ibw_160
ok_161:
s_cmp_lg_u32 s49,0
s_cbranch_scc1 ibok_162
v_and_b32 v13,7,v0
v_lshlrev_b32 v13,2,v13
buffer_load_dword v12,v13,s[12:15],0 offen offset:32 sc1
s_waitcnt vmcnt(0)
v_cmp_ne_u32 vcc,32,v12
s_nop 0
s_cbranch_vccz ibok_162
s_barrier
s_mov_b32 s49,1
s_mov_b32 s3,s2
s_load_dwordx16 s[16:31],s[0:1],0
s_load_dwordx8 s[32:39],s[0:1],64
s_waitcnt lgkmcnt(0)
s_branch DISPATCH
ibok_162:
v_mov_b32 v13,192
buffer_load_dword v12,v13,s[12:15],0 offen sc1
s_waitcnt vmcnt(0)
v_readfirstlane_b32 s60,v12
s_cmp_gt_i32 s60,0
s_cselect_b32 s60,0x2000,0
s_add_u32 s83,s83,s60
s_mov_b32 s50,0
s_mov_b32 s77,0
s_cmp_lg_u32 s49,0
s_cbranch_scc1 CW_LOOP_S
CW_LOOP_F:
s_sub_u32 s60,s50,13
s_lshr_b32 s52,s60,1
s_and_b32 s51,s60,1
s_cmp_eq_u32 s51,0
s_cselect_b32 s61,13,0
s_add_u32 s52,s52,s61
s_sub_u32 s61,s60,51
s_cmp_ge_u32 s60,102
s_cselect_b32 s52,s61,s52
s_cselect_b32 s51,1,s51
s_cmp_lt_u32 s50,13
s_cselect_b32 s52,s50,s52
s_cselect_b32 s51,0,s51
s_cmp_eq_u32 s52,63
s_cbranch_scc1 CW_NEXT_F
s_add_u32 s58,s52,1
s_lshl_b32 s61,s51,9
s_add_u32 s72,s61,s35
s_add_u32 s69,s61,s85
s_lshl_b32 s61,s51,2
s_and_b32 s60,s52,1
s_add_u32 s60,s60,s61
s_mul_i32 s70,s60,49152
s_add_u32 s70,s70,s33
s_add_u32 s71,s70,4096
s_add_u32 s80,s70,8192
s_bfe_u32 s57,s52,65537
s_bfe_u32 s31,s58,65537
s_and_b32 s60,s58,1
s_add_u32 s60,s60,s61
s_mul_i32 s59,s60,20480
s_add_u32 s59,s59,s84
s_lshl_b32 s68,s60,16
s_add_u32 s68,s68,s83
s_xor_b32 s77,s77,11264
v_add_u32 v7,s77,v5
v_add_u32 v8,s77,v6
s_add_u32 s60,s52,2
v_mov_b32 v16,s60
v_mov_b32 v80,0
v_mov_b32 v81,0
v_mov_b32 v82,0
v_mov_b32 v83,0
v_mov_b32 v84,0
v_mov_b32 v85,0
v_mov_b32 v86,0
v_mov_b32 v87,0
v_mov_b32 v88,0
v_mov_b32 v89,0
v_mov_b32 v90,0
v_mov_b32 v91,0
v_mov_b32 v92,0
v_mov_b32 v93,0
v_mov_b32 v94,0
v_mov_b32 v95,0
v_mov_b32 v96,0
v_mov_b32 v97,0
v_mov_b32 v98,0
v_mov_b32 v99,0
ds_read_b128 v[100:103],v4 offset:0
ds_read_b128 v[104:107],v4 offset:1024
ds_read_b128 v[108:111],v4 offset:2048
ds_read_b128 v[112:115],v4 offset:3072
s_cmp_lg_u32 s46,0
s_cbranch_scc1 np_163
db_164:
buffer_load_dword v12,v3,s[8:11],s72 offen sc1
s_waitcnt vmcnt(0)
v_cmp_gt_u32 vcc,s58,v12
s_cbranch_vccz dbok_165
s_sub_u32 s47,s47,1
s_cbranch_scc1 ABORT
s_branch db_164
dbok_165:
np_163:
s_barrier
buffer_load_dwordx4 v[32:35],v1,s[8:11],s70 offen sc1
s_nop 7
buffer_load_dwordx4 v[36:39],v1,s[8:11],s70 offen offset:1024 sc1
s_nop 7
buffer_load_dwordx4 v[40:43],v1,s[8:11],s70 offen offset:2048 sc1
s_nop 7
buffer_load_dwordx4 v[44:47],v1,s[8:11],s70 offen offset:3072 sc1
s_nop 7
buffer_load_dwordx4 v[48:51],v1,s[8:11],s71 offen sc1
s_waitcnt vmcnt(4)
v_and_b32 v12,1,v32
v_cmp_ne_u32 vcc,s57,v12
s_cbranch_vccnz ws_166
wg_175:
v_smfmac_f32_16x16x64_bf16 v[80:83],v[32:35],a[0:7],v2
buffer_load_dwordx4 v[52:55],v1,s[8:11],s71 offen offset:1024 sc1
v_smfmac_f32_16x16x64_bf16 v[84:87],v[32:35],a[8:15],v2
s_waitcnt vmcnt(4)
v_and_b32 v12,1,v36
v_smfmac_f32_16x16x64_bf16 v[88:91],v[32:35],a[16:23],v2
v_cmp_ne_u32 vcc,s57,v12
v_smfmac_f32_16x16x64_bf16 v[92:95],v[32:35],a[24:31],v2
s_waitcnt lgkmcnt(2)
v_smfmac_f32_16x16x64_bf16 v[96:99],v[32:35],v[100:107],v2
s_cbranch_vccnz ws_167
wg_176:
v_smfmac_f32_16x16x64_bf16 v[80:83],v[36:39],a[32:39],v2
buffer_load_dwordx4 v[56:59],v1,s[8:11],s71 offen offset:2048 sc1
v_smfmac_f32_16x16x64_bf16 v[84:87],v[36:39],a[40:47],v2
s_waitcnt vmcnt(4)
v_and_b32 v12,1,v40
v_smfmac_f32_16x16x64_bf16 v[88:91],v[36:39],a[48:55],v2
v_cmp_ne_u32 vcc,s57,v12
ds_read_b128 v[100:103],v4 offset:4096
v_smfmac_f32_16x16x64_bf16 v[92:95],v[36:39],a[56:63],v2
ds_read_b128 v[104:107],v4 offset:5120
s_waitcnt lgkmcnt(2)
v_smfmac_f32_16x16x64_bf16 v[96:99],v[36:39],v[108:115],v2
s_cbranch_vccnz ws_168
wg_177:
v_smfmac_f32_16x16x64_bf16 v[80:83],v[40:43],a[64:71],v2
buffer_load_dwordx4 v[60:63],v1,s[8:11],s71 offen offset:3072 sc1
v_smfmac_f32_16x16x64_bf16 v[84:87],v[40:43],a[72:79],v2
s_waitcnt vmcnt(4)
v_and_b32 v12,1,v44
v_smfmac_f32_16x16x64_bf16 v[88:91],v[40:43],a[80:87],v2
v_cmp_ne_u32 vcc,s57,v12
ds_read_b128 v[108:111],v4 offset:6144
v_smfmac_f32_16x16x64_bf16 v[92:95],v[40:43],a[88:95],v2
ds_read_b128 v[112:115],v4 offset:7168
s_waitcnt lgkmcnt(2)
v_smfmac_f32_16x16x64_bf16 v[96:99],v[40:43],v[100:107],v2
s_cbranch_vccnz ws_169
wg_178:
v_smfmac_f32_16x16x64_bf16 v[80:83],v[44:47],a[96:103],v2
buffer_load_dwordx4 v[64:67],v1,s[8:11],s80 offen sc1
v_smfmac_f32_16x16x64_bf16 v[84:87],v[44:47],a[104:111],v2
s_waitcnt vmcnt(4)
v_and_b32 v12,1,v48
v_smfmac_f32_16x16x64_bf16 v[88:91],v[44:47],a[112:119],v2
v_cmp_ne_u32 vcc,s57,v12
ds_read_b128 v[100:103],v4 offset:8192
v_smfmac_f32_16x16x64_bf16 v[92:95],v[44:47],a[120:127],v2
ds_read_b128 v[104:107],v4 offset:9216
s_waitcnt lgkmcnt(2)
v_smfmac_f32_16x16x64_bf16 v[96:99],v[44:47],v[108:115],v2
s_cbranch_vccnz ws_170
wg_179:
v_smfmac_f32_16x16x64_bf16 v[80:83],v[48:51],a[128:135],v2
buffer_load_dwordx4 v[68:71],v1,s[8:11],s80 offen offset:1024 sc1
v_smfmac_f32_16x16x64_bf16 v[84:87],v[48:51],a[136:143],v2
s_waitcnt vmcnt(4)
v_and_b32 v12,1,v52
v_smfmac_f32_16x16x64_bf16 v[88:91],v[48:51],a[144:151],v2
v_cmp_ne_u32 vcc,s57,v12
ds_read_b128 v[108:111],v4 offset:10240
v_smfmac_f32_16x16x64_bf16 v[92:95],v[48:51],a[152:159],v2
ds_read_b128 v[112:115],v4 offset:11264
s_waitcnt lgkmcnt(2)
v_smfmac_f32_16x16x64_bf16 v[96:99],v[48:51],v[100:107],v2
s_cbranch_vccnz ws_171
wg_180:
v_smfmac_f32_16x16x64_bf16 v[80:83],v[52:55],a[160:167],v2
s_waitcnt vmcnt(2)
v_bitop3_b32 v12,v56,v60,s57 bitop3:0x7e
v_smfmac_f32_16x16x64_bf16 v[84:87],v[52:55],a[168:175],v2
v_and_b32 v12,1,v12
buffer_load_dwordx4 v[72:75],v1,s[8:11],s80 offen offset:2048 sc1
v_smfmac_f32_16x16x64_bf16 v[88:91],v[52:55],a[176:183],v2
v_cmp_ne_u32 vcc,0,v12
ds_read_b128 v[100:103],v4 offset:12288
v_smfmac_f32_16x16x64_bf16 v[92:95],v[52:55],a[184:191],v2
ds_read_b128 v[104:107],v4 offset:13312
s_waitcnt lgkmcnt(2)
v_smfmac_f32_16x16x64_bf16 v[96:99],v[52:55],v[108:115],v2
s_cbranch_vccnz ws_172
wg_181:
v_smfmac_f32_16x16x64_bf16 v[80:83],v[56:59],a[192:199],v2
buffer_load_dwordx4 v[76:79],v1,s[8:11],s80 offen offset:3072 sc1
v_smfmac_f32_16x16x64_bf16 v[84:87],v[56:59],a[200:207],v2
ds_read_b128 v[108:111],v4 offset:14336
v_smfmac_f32_16x16x64_bf16 v[88:91],v[56:59],a[208:215],v2
ds_read_b128 v[112:115],v4 offset:15360
v_smfmac_f32_16x16x64_bf16 v[92:95],v[56:59],a[216:223],v2
s_waitcnt lgkmcnt(2)
v_smfmac_f32_16x16x64_bf16 v[96:99],v[56:59],v[100:107],v2
ds_read_b128 v[100:103],v4 offset:16384
v_smfmac_f32_16x16x64_bf16 v[80:83],v[60:63],a[224:231],v2
s_waitcnt vmcnt(2)
v_bitop3_b32 v12,v64,v68,s57 bitop3:0x7e
v_smfmac_f32_16x16x64_bf16 v[84:87],v[60:63],a[232:239],v2
v_and_b32 v12,1,v12
ds_read_b128 v[104:107],v4 offset:17408
v_smfmac_f32_16x16x64_bf16 v[88:91],v[60:63],a[240:247],v2
v_cmp_ne_u32 vcc,0,v12
v_smfmac_f32_16x16x64_bf16 v[92:95],v[60:63],a[248:255],v2
s_waitcnt lgkmcnt(2)
v_smfmac_f32_16x16x64_bf16 v[96:99],v[60:63],v[108:115],v2
s_cbranch_vccnz ws_173
wg_182:
v_smfmac_f32_16x16x64_bf16 v[80:83],v[64:67],v[128:135],v2
ds_read_b128 v[108:111],v4 offset:18432
v_smfmac_f32_16x16x64_bf16 v[84:87],v[64:67],v[136:143],v2
ds_read_b128 v[112:115],v4 offset:19456
v_smfmac_f32_16x16x64_bf16 v[88:91],v[64:67],v[144:151],v2
v_smfmac_f32_16x16x64_bf16 v[92:95],v[64:67],v[152:159],v2
s_waitcnt lgkmcnt(2)
v_smfmac_f32_16x16x64_bf16 v[96:99],v[64:67],v[100:107],v2
ds_read_b128 v[100:103],v4 offset:20480
v_smfmac_f32_16x16x64_bf16 v[80:83],v[68:71],v[160:167],v2
s_waitcnt vmcnt(0)
v_bitop3_b32 v12,v72,v76,s57 bitop3:0x7e
v_smfmac_f32_16x16x64_bf16 v[84:87],v[68:71],v[168:175],v2
v_and_b32 v12,1,v12
ds_read_b128 v[104:107],v4 offset:21504
v_smfmac_f32_16x16x64_bf16 v[88:91],v[68:71],v[176:183],v2
v_cmp_ne_u32 vcc,0,v12
v_smfmac_f32_16x16x64_bf16 v[92:95],v[68:71],v[184:191],v2
s_waitcnt lgkmcnt(2)
v_smfmac_f32_16x16x64_bf16 v[96:99],v[68:71],v[108:115],v2
s_cbranch_vccnz ws_174
wg_183:
v_smfmac_f32_16x16x64_bf16 v[80:83],v[72:75],v[192:199],v2
ds_read_b128 v[108:111],v4 offset:22528
v_smfmac_f32_16x16x64_bf16 v[80:83],v[76:79],v[224:231],v2
ds_read_b128 v[112:115],v4 offset:23552
v_smfmac_f32_16x16x64_bf16 v[84:87],v[72:75],v[200:207],v2
v_smfmac_f32_16x16x64_bf16 v[84:87],v[76:79],v[232:239],v2
v_smfmac_f32_16x16x64_bf16 v[88:91],v[72:75],v[208:215],v2
v_add_f32 v80,v80,v81
v_smfmac_f32_16x16x64_bf16 v[88:91],v[76:79],v[240:247],v2
v_add_f32 v82,v82,v83
ds_write2_b32 v7,v80,v82 offset0:0 offset1:88
v_smfmac_f32_16x16x64_bf16 v[92:95],v[72:75],v[216:223],v2
v_add_f32 v84,v84,v85
v_smfmac_f32_16x16x64_bf16 v[92:95],v[76:79],v[248:255],v2
v_add_f32 v86,v86,v87
s_waitcnt lgkmcnt(3)
v_smfmac_f32_16x16x64_bf16 v[96:99],v[72:75],v[100:107],v2
ds_write2_b32 v7,v84,v86 offset0:16 offset1:104
s_waitcnt lgkmcnt(2)
v_smfmac_f32_16x16x64_bf16 v[96:99],v[76:79],v[108:115],v2
v_add_f32 v88,v88,v89
v_add_f32 v90,v90,v91
ds_write2_b32 v7,v88,v90 offset0:32 offset1:120
v_add_f32 v92,v92,v93
v_add_f32 v94,v94,v95
ds_write2_b32 v7,v92,v94 offset0:48 offset1:136
s_nop 1
v_add_f32 v96,v96,v97
v_add_f32 v98,v98,v99
ds_write2_b32 v7,v96,v98 offset0:64 offset1:152
s_waitcnt lgkmcnt(0)
s_barrier
ds_read_b128 v[32:35],v8 offset:0
ds_read_b128 v[36:39],v8 offset:2816
ds_read_b128 v[40:43],v8 offset:5632
ds_read_b128 v[44:47],v8 offset:8448
s_mov_b64 exec,1
buffer_store_dword v16,v1,s[8:11],s69 offen
s_mov_b64 exec,-1
s_waitcnt lgkmcnt(2)
v_pk_add_f32 v[32:33],v[32:33],v[36:37]
v_pk_add_f32 v[34:35],v[34:35],v[38:39]
s_waitcnt lgkmcnt(0)
v_pk_add_f32 v[40:41],v[40:41],v[44:45]
v_pk_add_f32 v[42:43],v[42:43],v[46:47]
v_pk_add_f32 v[32:33],v[32:33],v[40:41]
v_pk_add_f32 v[34:35],v[34:35],v[42:43]
v_cvt_pk_bf16_f32 v32,v32,v33
v_cvt_pk_bf16_f32 v33,v34,v35
v_bfi_b32 v32,v10,s31,v32
s_nop 0
v_permlane32_swap_b32 v33,v35
v_permlane32_swap_b32 v32,v34
s_mov_b64 exec,s[88:89]
buffer_store_dwordx4 v[32:35],v9,s[8:11],s59 offen
s_barrier
buffer_store_dwordx4 v[32:35],v9,s[8:11],s68 offen sc1
s_mov_b64 exec,-1
s_nop 0
CW_NEXT_F:
s_add_u32 s50,s50,1
s_cmp_lt_u32 s50,128
s_cbranch_scc1 CW_LOOP_F
s_branch CW_DONE
ws_166:
buffer_load_dwordx4 v[32:35],v1,s[8:11],s70 offen sc1
buffer_load_dwordx4 v[36:39],v1,s[8:11],s70 offen offset:1024 sc1
buffer_load_dwordx4 v[40:43],v1,s[8:11],s70 offen offset:2048 sc1
buffer_load_dwordx4 v[44:47],v1,s[8:11],s70 offen offset:3072 sc1
buffer_load_dwordx4 v[48:51],v1,s[8:11],s71 offen sc1
s_sub_u32 s47,s47,1
s_cbranch_scc1 ABORT
s_waitcnt vmcnt(4)
v_and_b32 v12,1,v32
v_cmp_ne_u32 vcc,s57,v12
s_nop 0
s_cbranch_vccnz ws_166
s_branch wg_175
ws_167:
buffer_load_dwordx4 v[36:39],v1,s[8:11],s70 offen offset:1024 sc1
buffer_load_dwordx4 v[40:43],v1,s[8:11],s70 offen offset:2048 sc1
buffer_load_dwordx4 v[44:47],v1,s[8:11],s70 offen offset:3072 sc1
buffer_load_dwordx4 v[48:51],v1,s[8:11],s71 offen sc1
buffer_load_dwordx4 v[52:55],v1,s[8:11],s71 offen offset:1024 sc1
s_sub_u32 s47,s47,1
s_cbranch_scc1 ABORT
s_waitcnt vmcnt(4)
v_and_b32 v12,1,v36
v_cmp_ne_u32 vcc,s57,v12
s_nop 0
s_cbranch_vccnz ws_167
s_branch wg_176
ws_168:
buffer_load_dwordx4 v[40:43],v1,s[8:11],s70 offen offset:2048 sc1
buffer_load_dwordx4 v[44:47],v1,s[8:11],s70 offen offset:3072 sc1
buffer_load_dwordx4 v[48:51],v1,s[8:11],s71 offen sc1
buffer_load_dwordx4 v[52:55],v1,s[8:11],s71 offen offset:1024 sc1
buffer_load_dwordx4 v[56:59],v1,s[8:11],s71 offen offset:2048 sc1
s_sub_u32 s47,s47,1
s_cbranch_scc1 ABORT
s_waitcnt vmcnt(4)
v_and_b32 v12,1,v40
v_cmp_ne_u32 vcc,s57,v12
s_nop 0
s_cbranch_vccnz ws_168
s_branch wg_177
ws_169:
buffer_load_dwordx4 v[44:47],v1,s[8:11],s70 offen offset:3072 sc1
buffer_load_dwordx4 v[48:51],v1,s[8:11],s71 offen sc1
buffer_load_dwordx4 v[52:55],v1,s[8:11],s71 offen offset:1024 sc1
buffer_load_dwordx4 v[56:59],v1,s[8:11],s71 offen offset:2048 sc1
buffer_load_dwordx4 v[60:63],v1,s[8:11],s71 offen offset:3072 sc1
s_sub_u32 s47,s47,1
s_cbranch_scc1 ABORT
s_waitcnt vmcnt(4)
v_and_b32 v12,1,v44
v_cmp_ne_u32 vcc,s57,v12
s_nop 0
s_cbranch_vccnz ws_169
s_branch wg_178
ws_170:
buffer_load_dwordx4 v[48:51],v1,s[8:11],s71 offen sc1
buffer_load_dwordx4 v[52:55],v1,s[8:11],s71 offen offset:1024 sc1
buffer_load_dwordx4 v[56:59],v1,s[8:11],s71 offen offset:2048 sc1
buffer_load_dwordx4 v[60:63],v1,s[8:11],s71 offen offset:3072 sc1
buffer_load_dwordx4 v[64:67],v1,s[8:11],s80 offen sc1
s_sub_u32 s47,s47,1
s_cbranch_scc1 ABORT
s_waitcnt vmcnt(4)
v_and_b32 v12,1,v48
v_cmp_ne_u32 vcc,s57,v12
s_nop 0
s_cbranch_vccnz ws_170
s_branch wg_179
ws_171:
buffer_load_dwordx4 v[52:55],v1,s[8:11],s71 offen offset:1024 sc1
buffer_load_dwordx4 v[56:59],v1,s[8:11],s71 offen offset:2048 sc1
buffer_load_dwordx4 v[60:63],v1,s[8:11],s71 offen offset:3072 sc1
buffer_load_dwordx4 v[64:67],v1,s[8:11],s80 offen sc1
buffer_load_dwordx4 v[68:71],v1,s[8:11],s80 offen offset:1024 sc1
s_sub_u32 s47,s47,1
s_cbranch_scc1 ABORT
s_waitcnt vmcnt(4)
v_and_b32 v12,1,v52
v_cmp_ne_u32 vcc,s57,v12
s_nop 0
s_cbranch_vccnz ws_171
s_branch wg_180
ws_172:
buffer_load_dwordx4 v[56:59],v1,s[8:11],s71 offen offset:2048 sc1
buffer_load_dwordx4 v[60:63],v1,s[8:11],s71 offen offset:3072 sc1
buffer_load_dwordx4 v[64:67],v1,s[8:11],s80 offen sc1
buffer_load_dwordx4 v[68:71],v1,s[8:11],s80 offen offset:1024 sc1
buffer_load_dwordx4 v[72:75],v1,s[8:11],s80 offen offset:2048 sc1
s_sub_u32 s47,s47,1
s_cbranch_scc1 ABORT
s_waitcnt vmcnt(3)
v_bitop3_b32 v12,v56,v60,s57 bitop3:0x7e
v_and_b32 v12,1,v12
v_cmp_ne_u32 vcc,0,v12
s_nop 0
s_cbranch_vccnz ws_172
s_branch wg_181
ws_173:
buffer_load_dwordx4 v[64:67],v1,s[8:11],s80 offen sc1
buffer_load_dwordx4 v[68:71],v1,s[8:11],s80 offen offset:1024 sc1
buffer_load_dwordx4 v[72:75],v1,s[8:11],s80 offen offset:2048 sc1
buffer_load_dwordx4 v[76:79],v1,s[8:11],s80 offen offset:3072 sc1
s_sub_u32 s47,s47,1
s_cbranch_scc1 ABORT
s_waitcnt vmcnt(2)
v_bitop3_b32 v12,v64,v68,s57 bitop3:0x7e
v_and_b32 v12,1,v12
v_cmp_ne_u32 vcc,0,v12
s_nop 0
s_cbranch_vccnz ws_173
s_branch wg_182
ws_174:
buffer_load_dwordx4 v[72:75],v1,s[8:11],s80 offen offset:2048 sc1
buffer_load_dwordx4 v[76:79],v1,s[8:11],s80 offen offset:3072 sc1
s_sub_u32 s47,s47,1
s_cbranch_scc1 ABORT
s_waitcnt vmcnt(0)
v_bitop3_b32 v12,v72,v76,s57 bitop3:0x7e
v_and_b32 v12,1,v12
v_cmp_ne_u32 vcc,0,v12
s_nop 0
s_cbranch_vccnz ws_174
s_branch wg_183
CW_LOOP_S:
s_sub_u32 s60,s50,13
s_lshr_b32 s52,s60,1
s_and_b32 s51,s60,1
s_cmp_eq_u32 s51,0
s_cselect_b32 s61,13,0
s_add_u32 s52,s52,s61
s_sub_u32 s61,s60,51
s_cmp_ge_u32 s60,102
s_cselect_b32 s52,s61,s52
s_cselect_b32 s51,1,s51
s_cmp_lt_u32 s50,13
s_cselect_b32 s52,s50,s52
s_cselect_b32 s51,0,s51
s_cmp_eq_u32 s52,63
s_cbranch_scc1 CW_NEXT_S
s_add_u32 s58,s52,1
s_lshl_b32 s61,s51,9
s_add_u32 s72,s61,s35
s_add_u32 s69,s61,s85
s_lshl_b32 s61,s51,2
s_and_b32 s60,s52,1
s_add_u32 s60,s60,s61
s_mul_i32 s70,s60,49152
s_add_u32 s70,s70,s33
s_add_u32 s71,s70,4096
s_add_u32 s80,s70,8192
s_bfe_u32 s57,s52,65537
s_bfe_u32 s31,s58,65537
s_and_b32 s60,s58,1
s_add_u32 s60,s60,s61
s_mul_i32 s59,s60,20480
s_add_u32 s59,s59,s84
s_lshl_b32 s68,s60,16
s_add_u32 s68,s68,s83
s_xor_b32 s77,s77,11264
v_add_u32 v7,s77,v5
v_add_u32 v8,s77,v6
s_add_u32 s60,s52,2
v_mov_b32 v16,s60
v_mov_b32 v80,0
v_mov_b32 v81,0
v_mov_b32 v82,0
v_mov_b32 v83,0
v_mov_b32 v84,0
v_mov_b32 v85,0
v_mov_b32 v86,0
v_mov_b32 v87,0
v_mov_b32 v88,0
v_mov_b32 v89,0
v_mov_b32 v90,0
v_mov_b32 v91,0
v_mov_b32 v92,0
v_mov_b32 v93,0
v_mov_b32 v94,0
v_mov_b32 v95,0
v_mov_b32 v96,0
v_mov_b32 v97,0
v_mov_b32 v98,0
v_mov_b32 v99,0
ds_read_b128 v[100:103],v4 offset:0
ds_read_b128 v[104:107],v4 offset:1024
ds_read_b128 v[108:111],v4 offset:2048
ds_read_b128 v[112:115],v4 offset:3072
s_cmp_lg_u32 s46,0
s_cbranch_scc1 np_184
db_185:
buffer_load_dword v12,v3,s[8:11],s72 offen sc1
s_waitcnt vmcnt(0)
v_cmp_gt_u32 vcc,s58,v12
s_cbranch_vccz dbok_186
s_sub_u32 s47,s47,1
s_cbranch_scc1 ABORT
s_branch db_185
dbok_186:
np_184:
s_barrier
buffer_load_dwordx4 v[32:35],v1,s[8:11],s70 offen sc1
s_nop 7
buffer_load_dwordx4 v[36:39],v1,s[8:11],s70 offen offset:1024 sc1
s_nop 7
buffer_load_dwordx4 v[40:43],v1,s[8:11],s70 offen offset:2048 sc1
s_nop 7
buffer_load_dwordx4 v[44:47],v1,s[8:11],s70 offen offset:3072 sc1
s_nop 7
buffer_load_dwordx4 v[48:51],v1,s[8:11],s71 offen sc1
s_waitcnt vmcnt(4)
v_and_b32 v12,1,v32
v_cmp_ne_u32 vcc,s57,v12
s_cbranch_vccnz ws_187
wg_196:
v_smfmac_f32_16x16x64_bf16 v[80:83],v[32:35],a[0:7],v2
buffer_load_dwordx4 v[52:55],v1,s[8:11],s71 offen offset:1024 sc1
v_smfmac_f32_16x16x64_bf16 v[84:87],v[32:35],a[8:15],v2
s_waitcnt vmcnt(4)
v_and_b32 v12,1,v36
v_smfmac_f32_16x16x64_bf16 v[88:91],v[32:35],a[16:23],v2
v_cmp_ne_u32 vcc,s57,v12
v_smfmac_f32_16x16x64_bf16 v[92:95],v[32:35],a[24:31],v2
s_waitcnt lgkmcnt(2)
v_smfmac_f32_16x16x64_bf16 v[96:99],v[32:35],v[100:107],v2
s_cbranch_vccnz ws_188
wg_197:
v_smfmac_f32_16x16x64_bf16 v[80:83],v[36:39],a[32:39],v2
buffer_load_dwordx4 v[56:59],v1,s[8:11],s71 offen offset:2048 sc1
v_smfmac_f32_16x16x64_bf16 v[84:87],v[36:39],a[40:47],v2
s_waitcnt vmcnt(4)
v_and_b32 v12,1,v40
v_smfmac_f32_16x16x64_bf16 v[88:91],v[36:39],a[48:55],v2
v_cmp_ne_u32 vcc,s57,v12
ds_read_b128 v[100:103],v4 offset:4096
v_smfmac_f32_16x16x64_bf16 v[92:95],v[36:39],a[56:63],v2
ds_read_b128 v[104:107],v4 offset:5120
s_waitcnt lgkmcnt(2)
v_smfmac_f32_16x16x64_bf16 v[96:99],v[36:39],v[108:115],v2
s_cbranch_vccnz ws_189
wg_198:
v_smfmac_f32_16x16x64_bf16 v[80:83],v[40:43],a[64:71],v2
buffer_load_dwordx4 v[60:63],v1,s[8:11],s71 offen offset:3072 sc1
v_smfmac_f32_16x16x64_bf16 v[84:87],v[40:43],a[72:79],v2
s_waitcnt vmcnt(4)
v_and_b32 v12,1,v44
v_smfmac_f32_16x16x64_bf16 v[88:91],v[40:43],a[80:87],v2
v_cmp_ne_u32 vcc,s57,v12
ds_read_b128 v[108:111],v4 offset:6144
v_smfmac_f32_16x16x64_bf16 v[92:95],v[40:43],a[88:95],v2
ds_read_b128 v[112:115],v4 offset:7168
s_waitcnt lgkmcnt(2)
v_smfmac_f32_16x16x64_bf16 v[96:99],v[40:43],v[100:107],v2
s_cbranch_vccnz ws_190
wg_199:
v_smfmac_f32_16x16x64_bf16 v[80:83],v[44:47],a[96:103],v2
buffer_load_dwordx4 v[64:67],v1,s[8:11],s80 offen sc1
v_smfmac_f32_16x16x64_bf16 v[84:87],v[44:47],a[104:111],v2
s_waitcnt vmcnt(4)
v_and_b32 v12,1,v48
v_smfmac_f32_16x16x64_bf16 v[88:91],v[44:47],a[112:119],v2
v_cmp_ne_u32 vcc,s57,v12
ds_read_b128 v[100:103],v4 offset:8192
v_smfmac_f32_16x16x64_bf16 v[92:95],v[44:47],a[120:127],v2
ds_read_b128 v[104:107],v4 offset:9216
s_waitcnt lgkmcnt(2)
v_smfmac_f32_16x16x64_bf16 v[96:99],v[44:47],v[108:115],v2
s_cbranch_vccnz ws_191
wg_200:
v_smfmac_f32_16x16x64_bf16 v[80:83],v[48:51],a[128:135],v2
buffer_load_dwordx4 v[68:71],v1,s[8:11],s80 offen offset:1024 sc1
v_smfmac_f32_16x16x64_bf16 v[84:87],v[48:51],a[136:143],v2
s_waitcnt vmcnt(4)
v_and_b32 v12,1,v52
v_smfmac_f32_16x16x64_bf16 v[88:91],v[48:51],a[144:151],v2
v_cmp_ne_u32 vcc,s57,v12
ds_read_b128 v[108:111],v4 offset:10240
v_smfmac_f32_16x16x64_bf16 v[92:95],v[48:51],a[152:159],v2
ds_read_b128 v[112:115],v4 offset:11264
s_waitcnt lgkmcnt(2)
v_smfmac_f32_16x16x64_bf16 v[96:99],v[48:51],v[100:107],v2
s_cbranch_vccnz ws_192
wg_201:
v_smfmac_f32_16x16x64_bf16 v[80:83],v[52:55],a[160:167],v2
s_waitcnt vmcnt(2)
v_bitop3_b32 v12,v56,v60,s57 bitop3:0x7e
v_smfmac_f32_16x16x64_bf16 v[84:87],v[52:55],a[168:175],v2
v_and_b32 v12,1,v12
buffer_load_dwordx4 v[72:75],v1,s[8:11],s80 offen offset:2048 sc1
v_smfmac_f32_16x16x64_bf16 v[88:91],v[52:55],a[176:183],v2
v_cmp_ne_u32 vcc,0,v12
ds_read_b128 v[100:103],v4 offset:12288
v_smfmac_f32_16x16x64_bf16 v[92:95],v[52:55],a[184:191],v2
ds_read_b128 v[104:107],v4 offset:13312
s_waitcnt lgkmcnt(2)
v_smfmac_f32_16x16x64_bf16 v[96:99],v[52:55],v[108:115],v2
s_cbranch_vccnz ws_193
wg_202:
v_smfmac_f32_16x16x64_bf16 v[80:83],v[56:59],a[192:199],v2
buffer_load_dwordx4 v[76:79],v1,s[8:11],s80 offen offset:3072 sc1
v_smfmac_f32_16x16x64_bf16 v[84:87],v[56:59],a[200:207],v2
ds_read_b128 v[108:111],v4 offset:14336
v_smfmac_f32_16x16x64_bf16 v[88:91],v[56:59],a[208:215],v2
ds_read_b128 v[112:115],v4 offset:15360
v_smfmac_f32_16x16x64_bf16 v[92:95],v[56:59],a[216:223],v2
s_waitcnt lgkmcnt(2)
v_smfmac_f32_16x16x64_bf16 v[96:99],v[56:59],v[100:107],v2
ds_read_b128 v[100:103],v4 offset:16384
v_smfmac_f32_16x16x64_bf16 v[80:83],v[60:63],a[224:231],v2
s_waitcnt vmcnt(2)
v_bitop3_b32 v12,v64,v68,s57 bitop3:0x7e
v_smfmac_f32_16x16x64_bf16 v[84:87],v[60:63],a[232:239],v2
v_and_b32 v12,1,v12
ds_read_b128 v[104:107],v4 offset:17408
v_smfmac_f32_16x16x64_bf16 v[88:91],v[60:63],a[240:247],v2
v_cmp_ne_u32 vcc,0,v12
v_smfmac_f32_16x16x64_bf16 v[92:95],v[60:63],a[248:255],v2
s_waitcnt lgkmcnt(2)
v_smfmac_f32_16x16x64_bf16 v[96:99],v[60:63],v[108:115],v2
s_cbranch_vccnz ws_194
wg_203:
v_smfmac_f32_16x16x64_bf16 v[80:83],v[64:67],v[128:135],v2
ds_read_b128 v[108:111],v4 offset:18432
v_smfmac_f32_16x16x64_bf16 v[84:87],v[64:67],v[136:143],v2
ds_read_b128 v[112:115],v4 offset:19456
v_smfmac_f32_16x16x64_bf16 v[88:91],v[64:67],v[144:151],v2
v_smfmac_f32_16x16x64_bf16 v[92:95],v[64:67],v[152:159],v2
s_waitcnt lgkmcnt(2)
v_smfmac_f32_16x16x64_bf16 v[96:99],v[64:67],v[100:107],v2
ds_read_b128 v[100:103],v4 offset:20480
v_smfmac_f32_16x16x64_bf16 v[80:83],v[68:71],v[160:167],v2
s_waitcnt vmcnt(0)
v_bitop3_b32 v12,v72,v76,s57 bitop3:0x7e
v_smfmac_f32_16x16x64_bf16 v[84:87],v[68:71],v[168:175],v2
v_and_b32 v12,1,v12
ds_read_b128 v[104:107],v4 offset:21504
v_smfmac_f32_16x16x64_bf16 v[88:91],v[68:71],v[176:183],v2
v_cmp_ne_u32 vcc,0,v12
v_smfmac_f32_16x16x64_bf16 v[92:95],v[68:71],v[184:191],v2
s_waitcnt lgkmcnt(2)
v_smfmac_f32_16x16x64_bf16 v[96:99],v[68:71],v[108:115],v2
s_cbranch_vccnz ws_195
wg_204:
v_smfmac_f32_16x16x64_bf16 v[80:83],v[72:75],v[192:199],v2
ds_read_b128 v[108:111],v4 offset:22528
v_smfmac_f32_16x16x64_bf16 v[80:83],v[76:79],v[224:231],v2
ds_read_b128 v[112:115],v4 offset:23552
v_smfmac_f32_16x16x64_bf16 v[84:87],v[72:75],v[200:207],v2
v_smfmac_f32_16x16x64_bf16 v[84:87],v[76:79],v[232:239],v2
v_smfmac_f32_16x16x64_bf16 v[88:91],v[72:75],v[208:215],v2
v_add_f32 v80,v80,v81
v_smfmac_f32_16x16x64_bf16 v[88:91],v[76:79],v[240:247],v2
v_add_f32 v82,v82,v83
ds_write2_b32 v7,v80,v82 offset0:0 offset1:88
v_smfmac_f32_16x16x64_bf16 v[92:95],v[72:75],v[216:223],v2
v_add_f32 v84,v84,v85
v_smfmac_f32_16x16x64_bf16 v[92:95],v[76:79],v[248:255],v2
v_add_f32 v86,v86,v87
s_waitcnt lgkmcnt(3)
v_smfmac_f32_16x16x64_bf16 v[96:99],v[72:75],v[100:107],v2
ds_write2_b32 v7,v84,v86 offset0:16 offset1:104
s_waitcnt lgkmcnt(2)
v_smfmac_f32_16x16x64_bf16 v[96:99],v[76:79],v[108:115],v2
v_add_f32 v88,v88,v89
v_add_f32 v90,v90,v91
ds_write2_b32 v7,v88,v90 offset0:32 offset1:120
v_add_f32 v92,v92,v93
v_add_f32 v94,v94,v95
ds_write2_b32 v7,v92,v94 offset0:48 offset1:136
s_nop 1
v_add_f32 v96,v96,v97
v_add_f32 v98,v98,v99
ds_write2_b32 v7,v96,v98 offset0:64 offset1:152
s_waitcnt lgkmcnt(0)
s_barrier
ds_read_b128 v[32:35],v8 offset:0
ds_read_b128 v[36:39],v8 offset:2816
ds_read_b128 v[40:43],v8 offset:5632
ds_read_b128 v[44:47],v8 offset:8448
s_mov_b64 exec,1
buffer_store_dword v16,v1,s[8:11],s69 offen sc1
s_mov_b64 exec,-1
s_waitcnt lgkmcnt(2)
v_pk_add_f32 v[32:33],v[32:33],v[36:37]
v_pk_add_f32 v[34:35],v[34:35],v[38:39]
s_waitcnt lgkmcnt(0)
v_pk_add_f32 v[40:41],v[40:41],v[44:45]
v_pk_add_f32 v[42:43],v[42:43],v[46:47]
v_pk_add_f32 v[32:33],v[32:33],v[40:41]
v_pk_add_f32 v[34:35],v[34:35],v[42:43]
v_cvt_pk_bf16_f32 v32,v32,v33
v_cvt_pk_bf16_f32 v33,v34,v35
v_bfi_b32 v32,v10,s31,v32
s_nop 0
v_permlane32_swap_b32 v33,v35
v_permlane32_swap_b32 v32,v34
s_mov_b64 exec,s[88:89]
buffer_store_dwordx4 v[32:35],v9,s[8:11],s59 offen sc1
s_barrier
buffer_store_dwordx4 v[32:35],v9,s[8:11],s68 offen sc1
s_mov_b64 exec,-1
s_nop 0
CW_NEXT_S:
s_add_u32 s50,s50,1
s_cmp_lt_u32 s50,128
s_cbranch_scc1 CW_LOOP_S
s_branch CW_DONE
ws_187:
buffer_load_dwordx4 v[32:35],v1,s[8:11],s70 offen sc1
buffer_load_dwordx4 v[36:39],v1,s[8:11],s70 offen offset:1024 sc1
buffer_load_dwordx4 v[40:43],v1,s[8:11],s70 offen offset:2048 sc1
buffer_load_dwordx4 v[44:47],v1,s[8:11],s70 offen offset:3072 sc1
buffer_load_dwordx4 v[48:51],v1,s[8:11],s71 offen sc1
s_sub_u32 s47,s47,1
s_cbranch_scc1 ABORT
s_waitcnt vmcnt(4)
v_and_b32 v12,1,v32
v_cmp_ne_u32 vcc,s57,v12
s_nop 0
s_cbranch_vccnz ws_187
s_branch wg_196
ws_188:
buffer_load_dwordx4 v[36:39],v1,s[8:11],s70 offen offset:1024 sc1
buffer_load_dwordx4 v[40:43],v1,s[8:11],s70 offen offset:2048 sc1
buffer_load_dwordx4 v[44:47],v1,s[8:11],s70 offen offset:3072 sc1
buffer_load_dwordx4 v[48:51],v1,s[8:11],s71 offen sc1
buffer_load_dwordx4 v[52:55],v1,s[8:11],s71 offen offset:1024 sc1
s_sub_u32 s47,s47,1
s_cbranch_scc1 ABORT
s_waitcnt vmcnt(4)
v_and_b32 v12,1,v36
v_cmp_ne_u32 vcc,s57,v12
s_nop 0
s_cbranch_vccnz ws_188
s_branch wg_197
ws_189:
buffer_load_dwordx4 v[40:43],v1,s[8:11],s70 offen offset:2048 sc1
buffer_load_dwordx4 v[44:47],v1,s[8:11],s70 offen offset:3072 sc1
buffer_load_dwordx4 v[48:51],v1,s[8:11],s71 offen sc1
buffer_load_dwordx4 v[52:55],v1,s[8:11],s71 offen offset:1024 sc1
buffer_load_dwordx4 v[56:59],v1,s[8:11],s71 offen offset:2048 sc1
s_sub_u32 s47,s47,1
s_cbranch_scc1 ABORT
s_waitcnt vmcnt(4)
v_and_b32 v12,1,v40
v_cmp_ne_u32 vcc,s57,v12
s_nop 0
s_cbranch_vccnz ws_189
s_branch wg_198
ws_190:
buffer_load_dwordx4 v[44:47],v1,s[8:11],s70 offen offset:3072 sc1
buffer_load_dwordx4 v[48:51],v1,s[8:11],s71 offen sc1
buffer_load_dwordx4 v[52:55],v1,s[8:11],s71 offen offset:1024 sc1
buffer_load_dwordx4 v[56:59],v1,s[8:11],s71 offen offset:2048 sc1
buffer_load_dwordx4 v[60:63],v1,s[8:11],s71 offen offset:3072 sc1
s_sub_u32 s47,s47,1
s_cbranch_scc1 ABORT
s_waitcnt vmcnt(4)
v_and_b32 v12,1,v44
v_cmp_ne_u32 vcc,s57,v12
s_nop 0
s_cbranch_vccnz ws_190
s_branch wg_199
ws_191:
buffer_load_dwordx4 v[48:51],v1,s[8:11],s71 offen sc1
buffer_load_dwordx4 v[52:55],v1,s[8:11],s71 offen offset:1024 sc1
buffer_load_dwordx4 v[56:59],v1,s[8:11],s71 offen offset:2048 sc1
buffer_load_dwordx4 v[60:63],v1,s[8:11],s71 offen offset:3072 sc1
buffer_load_dwordx4 v[64:67],v1,s[8:11],s80 offen sc1
s_sub_u32 s47,s47,1
s_cbranch_scc1 ABORT
s_waitcnt vmcnt(4)
v_and_b32 v12,1,v48
v_cmp_ne_u32 vcc,s57,v12
s_nop 0
s_cbranch_vccnz ws_191
s_branch wg_200
ws_192:
buffer_load_dwordx4 v[52:55],v1,s[8:11],s71 offen offset:1024 sc1
buffer_load_dwordx4 v[56:59],v1,s[8:11],s71 offen offset:2048 sc1
buffer_load_dwordx4 v[60:63],v1,s[8:11],s71 offen offset:3072 sc1
buffer_load_dwordx4 v[64:67],v1,s[8:11],s80 offen sc1
buffer_load_dwordx4 v[68:71],v1,s[8:11],s80 offen offset:1024 sc1
s_sub_u32 s47,s47,1
s_cbranch_scc1 ABORT
s_waitcnt vmcnt(4)
v_and_b32 v12,1,v52
v_cmp_ne_u32 vcc,s57,v12
s_nop 0
s_cbranch_vccnz ws_192
s_branch wg_201
ws_193:
buffer_load_dwordx4 v[56:59],v1,s[8:11],s71 offen offset:2048 sc1
buffer_load_dwordx4 v[60:63],v1,s[8:11],s71 offen offset:3072 sc1
buffer_load_dwordx4 v[64:67],v1,s[8:11],s80 offen sc1
buffer_load_dwordx4 v[68:71],v1,s[8:11],s80 offen offset:1024 sc1
buffer_load_dwordx4 v[72:75],v1,s[8:11],s80 offen offset:2048 sc1
s_sub_u32 s47,s47,1
s_cbranch_scc1 ABORT
s_waitcnt vmcnt(3)
v_bitop3_b32 v12,v56,v60,s57 bitop3:0x7e
v_and_b32 v12,1,v12
v_cmp_ne_u32 vcc,0,v12
s_nop 0
s_cbranch_vccnz ws_193
s_branch wg_202
ws_194:
buffer_load_dwordx4 v[64:67],v1,s[8:11],s80 offen sc1
buffer_load_dwordx4 v[68:71],v1,s[8:11],s80 offen offset:1024 sc1
buffer_load_dwordx4 v[72:75],v1,s[8:11],s80 offen offset:2048 sc1
buffer_load_dwordx4 v[76:79],v1,s[8:11],s80 offen offset:3072 sc1
s_sub_u32 s47,s47,1
s_cbranch_scc1 ABORT
s_waitcnt vmcnt(2)
v_bitop3_b32 v12,v64,v68,s57 bitop3:0x7e
v_and_b32 v12,1,v12
v_cmp_ne_u32 vcc,0,v12
s_nop 0
s_cbranch_vccnz ws_194
s_branch wg_203
ws_195:
buffer_load_dwordx4 v[72:75],v1,s[8:11],s80 offen offset:2048 sc1
buffer_load_dwordx4 v[76:79],v1,s[8:11],s80 offen offset:3072 sc1
s_sub_u32 s47,s47,1
s_cbranch_scc1 ABORT
s_waitcnt vmcnt(0)
v_bitop3_b32 v12,v72,v76,s57 bitop3:0x7e
v_and_b32 v12,1,v12
v_cmp_ne_u32 vcc,0,v12
s_nop 0
s_cbranch_vccnz ws_195
s_branch wg_204
CW_DONE:
s_add_u32 s61,s48,48
s_endpgm
DISPATCH:
s_sub_u32 s48,s3,0
s_cmp_lt_u32 s3,16
s_cbranch_scc1 ROLE_CS
s_sub_u32 s48,s3,16
s_cmp_lt_u32 s3,24
s_cbranch_scc1 ROLE_CV
s_sub_u32 s48,s3,24
s_cmp_lt_u32 s3,32
s_cbranch_scc1 ROLE_CW
s_sub_u32 s48,s3,16
s_cmp_lt_u32 s3,48
s_cbranch_scc1 ROLE_CS
s_sub_u32 s48,s3,40
s_cmp_lt_u32 s3,56
s_cbranch_scc1 ROLE_CV
s_sub_u32 s48,s3,48
s_cmp_lt_u32 s3,64
s_cbranch_scc1 ROLE_CW
s_sub_u32 s48,s3,64
s_cmp_lt_u32 s3,74
s_cbranch_scc1 ROLE_W4
s_sub_u32 s48,s3,74
s_cmp_lt_u32 s3,79
s_cbranch_scc1 ROLE_W1
s_sub_u32 s48,s3,79
s_cmp_lt_u32 s3,91
s_cbranch_scc1 ROLE_W3
s_sub_u32 s48,s3,91
s_cmp_lt_u32 s3,96
s_cbranch_scc1 ROLE_W2
s_sub_u32 s48,s3,96
s_cmp_lt_u32 s3,104
s_cbranch_scc1 ROLE_QKVQ
s_sub_u32 s48,s3,104
s_cmp_lt_u32 s3,112
s_cbranch_scc1 ROLE_QKVV
s_sub_u32 s48,s3,112
s_cmp_lt_u32 s3,128
s_cbranch_scc1 ROLE_R1
s_sub_u32 s48,s3,128
s_cmp_lt_u32 s3,138
s_cbranch_scc1 ROLE_WO
s_sub_u32 s48,s3,138
s_cmp_lt_u32 s3,146
s_cbranch_scc1 ROLE_ATT
s_sub_u32 s48,s3,138
s_cmp_lt_u32 s3,156
s_cbranch_scc1 ROLE_QKVQ
s_sub_u32 s48,s3,148
s_cmp_lt_u32 s3,160
s_cbranch_scc1 ROLE_QKVV
s_sub_u32 s48,s3,150
s_cmp_lt_u32 s3,170
s_cbranch_scc1 ROLE_WO
s_sub_u32 s48,s3,162
s_cmp_lt_u32 s3,178
s_cbranch_scc1 ROLE_ATT
s_sub_u32 s48,s3,160
s_cmp_lt_u32 s3,188
s_cbranch_scc1 ROLE_QKVQ
s_sub_u32 s48,s3,176
s_cmp_lt_u32 s3,192
s_cbranch_scc1 ROLE_QKVV
s_sub_u32 s48,s3,172
s_cmp_lt_u32 s3,202
s_cbranch_scc1 ROLE_WO
s_sub_u32 s48,s3,186
s_cmp_lt_u32 s3,210
s_cbranch_scc1 ROLE_ATT
s_sub_u32 s48,s3,182
s_cmp_lt_u32 s3,220
s_cbranch_scc1 ROLE_QKVQ
s_sub_u32 s48,s3,204
s_cmp_lt_u32 s3,224
s_cbranch_scc1 ROLE_QKVV
s_sub_u32 s48,s3,194
s_cmp_lt_u32 s3,234
s_cbranch_scc1 ROLE_WO
s_sub_u32 s48,s3,210
s_cmp_lt_u32 s3,242
s_cbranch_scc1 ROLE_ATT
s_sub_u32 s48,s3,204
s_cmp_lt_u32 s3,252
s_cbranch_scc1 ROLE_QKVQ
s_sub_u32 s48,s3,232
s_cmp_lt_u32 s3,256
s_cbranch_scc1 ROLE_QKVV
s_branch ROLE_SPARE
EXIT:
s_endpgm
ABORT:
s_mov_b64 exec,1
v_mov_b32 v1,s2
v_add_u32 v1,0x10000,v1
v_mov_b32 v2,8
buffer_store_dword v1,v2,s[12:15],0 offen
s_endpgm
ROLE_SPARE:
s_waitcnt vmcnt(0)
s_barrier
s_cmp_lg_u32 s46,0
s_cbranch_scc1 arr_205
v_mov_b32 v12,1
s_lshl_b32 s3,s49,2
v_mov_b32 v13,s3
s_mov_b64 exec,1
buffer_atomic_add v12,v13,s[12:15],0 offen sc1
s_mov_b64 exec,-1
arr_205:
s_lshl_b32 s3,s49,2
v_mov_b32 v13,s3
s_nop 1
ibw_206:
buffer_load_dword v12,v13,s[12:15],0 offen sc1
s_waitcnt vmcnt(0)
v_cmp_ne_u32 vcc,256,v12
s_nop 0
s_cbranch_vccz ok_207
s_sleep 8
s_sub_u32 s47,s47,1
s_cbranch_scc1 ABORT
s_branch ibw_206
ok_207:
s_cmp_lg_u32 s49,0
s_cbranch_scc1 ibok_208
v_and_b32 v13,7,v0
v_lshlrev_b32 v13,2,v13
buffer_load_dword v12,v13,s[12:15],0 offen offset:32 sc1
s_waitcnt vmcnt(0)
v_cmp_ne_u32 vcc,32,v12
s_nop 0
s_cbranch_vccz ibok_208
s_barrier
s_mov_b32 s49,1
s_mov_b32 s3,s2
s_load_dwordx16 s[16:31],s[0:1],0
s_load_dwordx8 s[32:39],s[0:1],64
s_waitcnt lgkmcnt(0)
s_branch DISPATCH
ibok_208:
s_endpgm
ROLE_QKVQ:
v_lshlrev_b32 v1,4,v0
v_mov_b32 v5,1
s_lshl_b32 s56,s48,2
s_add_u32 s56,s56,s46
v_bfe_u32 v6,v0,2,2
v_lshrrev_b32 v7,4,v0
v_add_u32 v7,v6,v7
v_and_b32 v7,3,v7
v_and_b32 v15,3,v0
v_lshlrev_b32 v15,4,v15
v_lshl_add_u32 v15,v7,6,v15
v_lshl_add_u32 v15,v6,8,v15
v_lshrrev_b32 v6,5,v0
v_bfe_u32 v7,v0,4,1
v_lshlrev_b32 v16,10,v7
v_bfe_u32 v7,v0,2,2
v_lshl_add_u32 v16,v7,8,v16
v_add_u32 v6,v6,v7
v_and_b32 v6,3,v6
v_lshl_add_u32 v16,v6,6,v16
v_and_b32 v6,3,v0
v_lshl_add_u32 v16,v6,4,v16
v_add_u32 v18,46080,v16
v_lshrrev_b32 v6,5,v0
v_bfe_u32 v7,v0,4,1
v_lshlrev_b32 v20,10,v7
v_lshl_add_u32 v20,v6,8,v20
v_and_b32 v6,15,v0
v_lshl_add_u32 v20,v6,4,v20
v_lshrrev_b32 v6,5,v0
v_add_u32 v6,2,v6
v_bfe_u32 v7,v0,4,1
v_lshlrev_b32 v17,10,v7
v_bfe_u32 v7,v0,2,2
v_lshl_add_u32 v17,v7,8,v17
v_add_u32 v6,v6,v7
v_and_b32 v6,3,v6
v_lshl_add_u32 v17,v6,6,v17
v_and_b32 v6,3,v0
v_lshl_add_u32 v17,v6,4,v17
v_add_u32 v19,46080,v17
v_lshrrev_b32 v6,5,v0
v_add_u32 v6,2,v6
v_bfe_u32 v7,v0,4,1
v_lshlrev_b32 v21,10,v7
v_lshl_add_u32 v21,v6,8,v21
v_and_b32 v6,15,v0
v_lshl_add_u32 v21,v6,4,v21
s_cmp_ge_u32 s48,24
s_cselect_b32 s68,1,0
s_mul_i32 s60,s68,96
s_sub_u32 s69,s56,s60
s_mul_i32 s70,s68,50331648
s_add_u32 s70,s70,74448896
s_mul_i32 s60,s68,65536
s_sub_u32 s71,131072,s60
s_lshl_b32 s60,s69,12
s_add_u32 s70,s70,s60
v_lshrrev_b32 v6,5,v0
v_mul_u32_u24 v188,2560,v6
v_and_b32 v6,31,v0
v_lshl_add_u32 v188,v6,3,v188
v_add_u32 v188,0xa000,v188
v_min_u32 v4,7,v0
v_lshlrev_b32 v4,2,v4
v_min_u32 v2,39,v0
v_lshlrev_b32 v2,2,v2
v_mov_b32 v12,93184
s_waitcnt vmcnt(0)
s_barrier
s_cmp_lg_u32 s46,0
s_cbranch_scc1 arr_209
v_mov_b32 v6,1
s_lshl_b32 s3,s49,2
v_mov_b32 v7,s3
s_mov_b64 exec,1
buffer_atomic_add v6,v7,s[12:15],0 offen sc1
s_mov_b64 exec,-1
arr_209:
s_lshl_b32 s58,s69,7
s_mul_i32 s63,s46,40960
s_cmp_eq_u32 s68,0
s_cselect_b32 s4,s22,s20
s_cselect_b32 s5,s23,s21
s_mov_b32 s6,7864320
s_mov_b32 s7,0x20000
v_lshrrev_b32 v9,3,v0
s_mov_b32 s64,12288
v_mul_lo_u32 v9,v9,s64
v_and_b32 v10,7,v0
v_lshl_add_u32 v6,v10,4,v9
s_add_u32 m0,s63,0
s_add_u32 s65,s58,0
buffer_load_dwordx4 v6,s[4:7],s65 offen lds
s_add_u32 m0,s63,1024
s_add_u32 s65,s58,98304
buffer_load_dwordx4 v6,s[4:7],s65 offen lds
s_add_u32 m0,s63,2048
s_add_u32 s65,s58,196608
buffer_load_dwordx4 v6,s[4:7],s65 offen lds
s_add_u32 m0,s63,3072
s_add_u32 s65,s58,294912
buffer_load_dwordx4 v6,s[4:7],s65 offen lds
s_add_u32 m0,s63,4096
s_add_u32 s65,s58,393216
buffer_load_dwordx4 v6,s[4:7],s65 offen lds
s_add_u32 m0,s63,5120
s_add_u32 s65,s58,491520
buffer_load_dwordx4 v6,s[4:7],s65 offen lds
s_add_u32 m0,s63,6144
s_add_u32 s65,s58,589824
buffer_load_dwordx4 v6,s[4:7],s65 offen lds
s_add_u32 m0,s63,7168
s_add_u32 s65,s58,688128
buffer_load_dwordx4 v6,s[4:7],s65 offen lds
s_add_u32 m0,s63,8192
s_add_u32 s65,s58,786432
buffer_load_dwordx4 v6,s[4:7],s65 offen lds
s_add_u32 m0,s63,9216
s_add_u32 s65,s58,884736
buffer_load_dwordx4 v6,s[4:7],s65 offen lds
s_add_u32 m0,s63,10240
s_add_u32 s65,s58,983040
buffer_load_dwordx4 v6,s[4:7],s65 offen lds
s_add_u32 m0,s63,11264
s_add_u32 s65,s58,1081344
buffer_load_dwordx4 v6,s[4:7],s65 offen lds
s_add_u32 m0,s63,12288
s_add_u32 s65,s58,1179648
buffer_load_dwordx4 v6,s[4:7],s65 offen lds
s_add_u32 m0,s63,13312
s_add_u32 s65,s58,1277952
buffer_load_dwordx4 v6,s[4:7],s65 offen lds
s_add_u32 m0,s63,14336
s_add_u32 s65,s58,1376256
buffer_load_dwordx4 v6,s[4:7],s65 offen lds
s_add_u32 m0,s63,15360
s_add_u32 s65,s58,1474560
buffer_load_dwordx4 v6,s[4:7],s65 offen lds
s_add_u32 m0,s63,16384
s_add_u32 s65,s58,1572864
buffer_load_dwordx4 v6,s[4:7],s65 offen lds
s_add_u32 m0,s63,17408
s_add_u32 s65,s58,1671168
buffer_load_dwordx4 v6,s[4:7],s65 offen lds
s_add_u32 m0,s63,18432
s_add_u32 s65,s58,1769472
buffer_load_dwordx4 v6,s[4:7],s65 offen lds
s_add_u32 m0,s63,19456
s_add_u32 s65,s58,1867776
buffer_load_dwordx4 v6,s[4:7],s65 offen lds
s_add_u32 m0,s63,20480
s_add_u32 s65,s58,1966080
buffer_load_dwordx4 v6,s[4:7],s65 offen lds
s_add_u32 m0,s63,21504
s_add_u32 s65,s58,2064384
buffer_load_dwordx4 v6,s[4:7],s65 offen lds
s_add_u32 m0,s63,22528
s_add_u32 s65,s58,2162688
buffer_load_dwordx4 v6,s[4:7],s65 offen lds
s_add_u32 m0,s63,23552
s_add_u32 s65,s58,2260992
buffer_load_dwordx4 v6,s[4:7],s65 offen lds
s_add_u32 m0,s63,24576
s_add_u32 s65,s58,2359296
buffer_load_dwordx4 v6,s[4:7],s65 offen lds
s_add_u32 m0,s63,25600
s_add_u32 s65,s58,2457600
buffer_load_dwordx4 v6,s[4:7],s65 offen lds
s_add_u32 m0,s63,26624
s_add_u32 s65,s58,2555904
buffer_load_dwordx4 v6,s[4:7],s65 offen lds
s_add_u32 m0,s63,27648
s_add_u32 s65,s58,2654208
buffer_load_dwordx4 v6,s[4:7],s65 offen lds
s_add_u32 m0,s63,28672
s_add_u32 s65,s58,2752512
buffer_load_dwordx4 v6,s[4:7],s65 offen lds
s_add_u32 m0,s63,29696
s_add_u32 s65,s58,2850816
buffer_load_dwordx4 v6,s[4:7],s65 offen lds
s_add_u32 m0,s63,30720
s_add_u32 s65,s58,2949120
buffer_load_dwordx4 v6,s[4:7],s65 offen lds
s_add_u32 m0,s63,31744
s_add_u32 s65,s58,3047424
buffer_load_dwordx4 v6,s[4:7],s65 offen lds
s_add_u32 m0,s63,32768
s_add_u32 s65,s58,3145728
buffer_load_dwordx4 v6,s[4:7],s65 offen lds
s_add_u32 m0,s63,33792
s_add_u32 s65,s58,3244032
buffer_load_dwordx4 v6,s[4:7],s65 offen lds
s_add_u32 m0,s63,34816
s_add_u32 s65,s58,3342336
buffer_load_dwordx4 v6,s[4:7],s65 offen lds
s_add_u32 m0,s63,35840
s_add_u32 s65,s58,3440640
buffer_load_dwordx4 v6,s[4:7],s65 offen lds
s_add_u32 m0,s63,36864
s_add_u32 s65,s58,3538944
buffer_load_dwordx4 v6,s[4:7],s65 offen lds
s_add_u32 m0,s63,37888
s_add_u32 s65,s58,3637248
buffer_load_dwordx4 v6,s[4:7],s65 offen lds
s_add_u32 m0,s63,38912
s_add_u32 s65,s58,3735552
buffer_load_dwordx4 v6,s[4:7],s65 offen lds
s_add_u32 m0,s63,39936
s_add_u32 s65,s58,3833856
buffer_load_dwordx4 v6,s[4:7],s65 offen lds
s_waitcnt vmcnt(20)
v_bfe_u32 v9,v0,2,2
v_lshrrev_b32 v10,5,v0
v_lshl_add_u32 v9,v10,2,v9
v_mul_u32_u24 v9,128,v9
v_and_b32 v10,1,v0
v_lshl_add_u32 v9,v10,3,v9
v_bfe_u32 v10,v0,1,1
v_lshl_add_u32 v9,v10,5,v9
v_bfe_u32 v10,v0,4,1
v_lshl_add_u32 v9,v10,4,v9
v_add_u32 v7,s63,v9
ds_read_b64_tr_b16 a[0:1],v7 offset:0
ds_read_b64_tr_b16 a[2:3],v7 offset:2048
ds_read_b64_tr_b16 a[4:5],v7 offset:1024
ds_read_b64_tr_b16 a[6:7],v7 offset:3072
ds_read_b64_tr_b16 a[160:161],v7 offset:64
ds_read_b64_tr_b16 a[162:163],v7 offset:2112
ds_read_b64_tr_b16 a[164:165],v7 offset:1088
ds_read_b64_tr_b16 a[166:167],v7 offset:3136
ds_read_b64_tr_b16 a[8:9],v7 offset:4096
ds_read_b64_tr_b16 a[10:11],v7 offset:6144
ds_read_b64_tr_b16 a[12:13],v7 offset:5120
ds_read_b64_tr_b16 a[14:15],v7 offset:7168
s_waitcnt lgkmcnt(4)
ds_read_b64_tr_b16 a[168:169],v7 offset:4160
ds_read_b64_tr_b16 a[170:171],v7 offset:6208
ds_read_b64_tr_b16 a[172:173],v7 offset:5184
ds_read_b64_tr_b16 a[174:175],v7 offset:7232
ds_read_b64_tr_b16 a[16:17],v7 offset:8192
ds_read_b64_tr_b16 a[18:19],v7 offset:10240
ds_read_b64_tr_b16 a[20:21],v7 offset:9216
ds_read_b64_tr_b16 a[22:23],v7 offset:11264
ds_read_b64_tr_b16 a[176:177],v7 offset:8256
ds_read_b64_tr_b16 a[178:179],v7 offset:10304
ds_read_b64_tr_b16 a[180:181],v7 offset:9280
ds_read_b64_tr_b16 a[182:183],v7 offset:11328
s_waitcnt lgkmcnt(4)
ds_read_b64_tr_b16 a[24:25],v7 offset:12288
ds_read_b64_tr_b16 a[26:27],v7 offset:14336
ds_read_b64_tr_b16 a[28:29],v7 offset:13312
ds_read_b64_tr_b16 a[30:31],v7 offset:15360
ds_read_b64_tr_b16 a[184:185],v7 offset:12352
ds_read_b64_tr_b16 a[186:187],v7 offset:14400
ds_read_b64_tr_b16 a[188:189],v7 offset:13376
ds_read_b64_tr_b16 a[190:191],v7 offset:15424
ds_read_b64_tr_b16 a[32:33],v7 offset:16384
ds_read_b64_tr_b16 a[34:35],v7 offset:18432
ds_read_b64_tr_b16 a[36:37],v7 offset:17408
ds_read_b64_tr_b16 a[38:39],v7 offset:19456
s_waitcnt lgkmcnt(4)
ds_read_b64_tr_b16 a[192:193],v7 offset:16448
ds_read_b64_tr_b16 a[194:195],v7 offset:18496
ds_read_b64_tr_b16 a[196:197],v7 offset:17472
ds_read_b64_tr_b16 a[198:199],v7 offset:19520
s_waitcnt lgkmcnt(0)
s_add_u32 m0,s63,0
s_add_u32 s65,s58,3932160
buffer_load_dwordx4 v6,s[4:7],s65 offen lds
s_add_u32 m0,s63,1024
s_add_u32 s65,s58,4030464
buffer_load_dwordx4 v6,s[4:7],s65 offen lds
s_add_u32 m0,s63,2048
s_add_u32 s65,s58,4128768
buffer_load_dwordx4 v6,s[4:7],s65 offen lds
s_add_u32 m0,s63,3072
s_add_u32 s65,s58,4227072
buffer_load_dwordx4 v6,s[4:7],s65 offen lds
s_add_u32 m0,s63,4096
s_add_u32 s65,s58,4325376
buffer_load_dwordx4 v6,s[4:7],s65 offen lds
s_add_u32 m0,s63,5120
s_add_u32 s65,s58,4423680
buffer_load_dwordx4 v6,s[4:7],s65 offen lds
s_add_u32 m0,s63,6144
s_add_u32 s65,s58,4521984
buffer_load_dwordx4 v6,s[4:7],s65 offen lds
s_add_u32 m0,s63,7168
s_add_u32 s65,s58,4620288
buffer_load_dwordx4 v6,s[4:7],s65 offen lds
s_add_u32 m0,s63,8192
s_add_u32 s65,s58,4718592
buffer_load_dwordx4 v6,s[4:7],s65 offen lds
s_add_u32 m0,s63,9216
s_add_u32 s65,s58,4816896
buffer_load_dwordx4 v6,s[4:7],s65 offen lds
s_add_u32 m0,s63,10240
s_add_u32 s65,s58,4915200
buffer_load_dwordx4 v6,s[4:7],s65 offen lds
s_add_u32 m0,s63,11264
s_add_u32 s65,s58,5013504
buffer_load_dwordx4 v6,s[4:7],s65 offen lds
s_add_u32 m0,s63,12288
s_add_u32 s65,s58,5111808
buffer_load_dwordx4 v6,s[4:7],s65 offen lds
s_add_u32 m0,s63,13312
s_add_u32 s65,s58,5210112
buffer_load_dwordx4 v6,s[4:7],s65 offen lds
s_add_u32 m0,s63,14336
s_add_u32 s65,s58,5308416
buffer_load_dwordx4 v6,s[4:7],s65 offen lds
s_add_u32 m0,s63,15360
s_add_u32 s65,s58,5406720
buffer_load_dwordx4 v6,s[4:7],s65 offen lds
s_add_u32 m0,s63,16384
s_add_u32 s65,s58,5505024
buffer_load_dwordx4 v6,s[4:7],s65 offen lds
s_add_u32 m0,s63,17408
s_add_u32 s65,s58,5603328
buffer_load_dwordx4 v6,s[4:7],s65 offen lds
s_add_u32 m0,s63,18432
s_add_u32 s65,s58,5701632
buffer_load_dwordx4 v6,s[4:7],s65 offen lds
s_add_u32 m0,s63,19456
s_add_u32 s65,s58,5799936
buffer_load_dwordx4 v6,s[4:7],s65 offen lds
s_waitcnt vmcnt(20)
v_bfe_u32 v9,v0,2,2
v_lshrrev_b32 v10,5,v0
v_lshl_add_u32 v9,v10,2,v9
v_mul_u32_u24 v9,128,v9
v_and_b32 v10,1,v0
v_lshl_add_u32 v9,v10,3,v9
v_bfe_u32 v10,v0,1,1
v_lshl_add_u32 v9,v10,5,v9
v_bfe_u32 v10,v0,4,1
v_lshl_add_u32 v9,v10,4,v9
v_add_u32 v7,s63,v9
ds_read_b64_tr_b16 a[40:41],v7 offset:20480
ds_read_b64_tr_b16 a[42:43],v7 offset:22528
ds_read_b64_tr_b16 a[44:45],v7 offset:21504
ds_read_b64_tr_b16 a[46:47],v7 offset:23552
ds_read_b64_tr_b16 a[200:201],v7 offset:20544
ds_read_b64_tr_b16 a[202:203],v7 offset:22592
ds_read_b64_tr_b16 a[204:205],v7 offset:21568
ds_read_b64_tr_b16 a[206:207],v7 offset:23616
ds_read_b64_tr_b16 a[48:49],v7 offset:24576
ds_read_b64_tr_b16 a[50:51],v7 offset:26624
ds_read_b64_tr_b16 a[52:53],v7 offset:25600
ds_read_b64_tr_b16 a[54:55],v7 offset:27648
s_waitcnt lgkmcnt(4)
ds_read_b64_tr_b16 a[208:209],v7 offset:24640
ds_read_b64_tr_b16 a[210:211],v7 offset:26688
ds_read_b64_tr_b16 a[212:213],v7 offset:25664
ds_read_b64_tr_b16 a[214:215],v7 offset:27712
ds_read_b64_tr_b16 a[56:57],v7 offset:28672
ds_read_b64_tr_b16 a[58:59],v7 offset:30720
ds_read_b64_tr_b16 a[60:61],v7 offset:29696
ds_read_b64_tr_b16 a[62:63],v7 offset:31744
ds_read_b64_tr_b16 a[216:217],v7 offset:28736
ds_read_b64_tr_b16 a[218:219],v7 offset:30784
ds_read_b64_tr_b16 a[220:221],v7 offset:29760
ds_read_b64_tr_b16 a[222:223],v7 offset:31808
s_waitcnt lgkmcnt(4)
ds_read_b64_tr_b16 a[64:65],v7 offset:32768
ds_read_b64_tr_b16 a[66:67],v7 offset:34816
ds_read_b64_tr_b16 a[68:69],v7 offset:33792
ds_read_b64_tr_b16 a[70:71],v7 offset:35840
ds_read_b64_tr_b16 a[224:225],v7 offset:32832
ds_read_b64_tr_b16 a[226:227],v7 offset:34880
ds_read_b64_tr_b16 a[228:229],v7 offset:33856
ds_read_b64_tr_b16 a[230:231],v7 offset:35904
ds_read_b64_tr_b16 a[72:73],v7 offset:36864
ds_read_b64_tr_b16 a[74:75],v7 offset:38912
ds_read_b64_tr_b16 a[76:77],v7 offset:37888
ds_read_b64_tr_b16 a[78:79],v7 offset:39936
s_waitcnt lgkmcnt(4)
ds_read_b64_tr_b16 a[232:233],v7 offset:36928
ds_read_b64_tr_b16 a[234:235],v7 offset:38976
ds_read_b64_tr_b16 a[236:237],v7 offset:37952
ds_read_b64_tr_b16 a[238:239],v7 offset:40000
s_waitcnt lgkmcnt(0)
s_add_u32 m0,s63,20480
s_add_u32 s65,s58,5898240
buffer_load_dwordx4 v6,s[4:7],s65 offen lds
s_add_u32 m0,s63,21504
s_add_u32 s65,s58,5996544
buffer_load_dwordx4 v6,s[4:7],s65 offen lds
s_add_u32 m0,s63,22528
s_add_u32 s65,s58,6094848
buffer_load_dwordx4 v6,s[4:7],s65 offen lds
s_add_u32 m0,s63,23552
s_add_u32 s65,s58,6193152
buffer_load_dwordx4 v6,s[4:7],s65 offen lds
s_add_u32 m0,s63,24576
s_add_u32 s65,s58,6291456
buffer_load_dwordx4 v6,s[4:7],s65 offen lds
s_add_u32 m0,s63,25600
s_add_u32 s65,s58,6389760
buffer_load_dwordx4 v6,s[4:7],s65 offen lds
s_add_u32 m0,s63,26624
s_add_u32 s65,s58,6488064
buffer_load_dwordx4 v6,s[4:7],s65 offen lds
s_add_u32 m0,s63,27648
s_add_u32 s65,s58,6586368
buffer_load_dwordx4 v6,s[4:7],s65 offen lds
s_add_u32 m0,s63,28672
s_add_u32 s65,s58,6684672
buffer_load_dwordx4 v6,s[4:7],s65 offen lds
s_add_u32 m0,s63,29696
s_add_u32 s65,s58,6782976
buffer_load_dwordx4 v6,s[4:7],s65 offen lds
s_add_u32 m0,s63,30720
s_add_u32 s65,s58,6881280
buffer_load_dwordx4 v6,s[4:7],s65 offen lds
s_add_u32 m0,s63,31744
s_add_u32 s65,s58,6979584
buffer_load_dwordx4 v6,s[4:7],s65 offen lds
s_add_u32 m0,s63,32768
s_add_u32 s65,s58,7077888
buffer_load_dwordx4 v6,s[4:7],s65 offen lds
s_add_u32 m0,s63,33792
s_add_u32 s65,s58,7176192
buffer_load_dwordx4 v6,s[4:7],s65 offen lds
s_add_u32 m0,s63,34816
s_add_u32 s65,s58,7274496
buffer_load_dwordx4 v6,s[4:7],s65 offen lds
s_add_u32 m0,s63,35840
s_add_u32 s65,s58,7372800
buffer_load_dwordx4 v6,s[4:7],s65 offen lds
s_add_u32 m0,s63,36864
s_add_u32 s65,s58,7471104
buffer_load_dwordx4 v6,s[4:7],s65 offen lds
s_add_u32 m0,s63,37888
s_add_u32 s65,s58,7569408
buffer_load_dwordx4 v6,s[4:7],s65 offen lds
s_add_u32 m0,s63,38912
s_add_u32 s65,s58,7667712
buffer_load_dwordx4 v6,s[4:7],s65 offen lds
s_add_u32 m0,s63,39936
s_add_u32 s65,s58,7766016
buffer_load_dwordx4 v6,s[4:7],s65 offen lds
s_waitcnt vmcnt(20)
v_bfe_u32 v9,v0,2,2
v_lshrrev_b32 v10,5,v0
v_lshl_add_u32 v9,v10,2,v9
v_mul_u32_u24 v9,128,v9
v_and_b32 v10,1,v0
v_lshl_add_u32 v9,v10,3,v9
v_bfe_u32 v10,v0,1,1
v_lshl_add_u32 v9,v10,5,v9
v_bfe_u32 v10,v0,4,1
v_lshl_add_u32 v9,v10,4,v9
v_add_u32 v7,s63,v9
ds_read_b64_tr_b16 a[80:81],v7 offset:0
ds_read_b64_tr_b16 a[82:83],v7 offset:2048
ds_read_b64_tr_b16 a[84:85],v7 offset:1024
ds_read_b64_tr_b16 a[86:87],v7 offset:3072
ds_read_b64_tr_b16 a[240:241],v7 offset:64
ds_read_b64_tr_b16 a[242:243],v7 offset:2112
ds_read_b64_tr_b16 a[244:245],v7 offset:1088
ds_read_b64_tr_b16 a[246:247],v7 offset:3136
ds_read_b64_tr_b16 a[88:89],v7 offset:4096
ds_read_b64_tr_b16 a[90:91],v7 offset:6144
ds_read_b64_tr_b16 a[92:93],v7 offset:5120
ds_read_b64_tr_b16 a[94:95],v7 offset:7168
s_waitcnt lgkmcnt(4)
ds_read_b64_tr_b16 a[248:249],v7 offset:4160
ds_read_b64_tr_b16 a[250:251],v7 offset:6208
ds_read_b64_tr_b16 a[252:253],v7 offset:5184
ds_read_b64_tr_b16 a[254:255],v7 offset:7232
ds_read_b64_tr_b16 a[96:97],v7 offset:8192
ds_read_b64_tr_b16 a[98:99],v7 offset:10240
ds_read_b64_tr_b16 a[100:101],v7 offset:9216
ds_read_b64_tr_b16 a[102:103],v7 offset:11264
ds_read_b64_tr_b16 v[192:193],v7 offset:8256
ds_read_b64_tr_b16 v[194:195],v7 offset:10304
ds_read_b64_tr_b16 v[196:197],v7 offset:9280
ds_read_b64_tr_b16 v[198:199],v7 offset:11328
s_waitcnt lgkmcnt(4)
ds_read_b64_tr_b16 a[104:105],v7 offset:12288
ds_read_b64_tr_b16 a[106:107],v7 offset:14336
ds_read_b64_tr_b16 a[108:109],v7 offset:13312
ds_read_b64_tr_b16 a[110:111],v7 offset:15360
ds_read_b64_tr_b16 v[200:201],v7 offset:12352
ds_read_b64_tr_b16 v[202:203],v7 offset:14400
ds_read_b64_tr_b16 v[204:205],v7 offset:13376
ds_read_b64_tr_b16 v[206:207],v7 offset:15424
ds_read_b64_tr_b16 a[112:113],v7 offset:16384
ds_read_b64_tr_b16 a[114:115],v7 offset:18432
ds_read_b64_tr_b16 a[116:117],v7 offset:17408
ds_read_b64_tr_b16 a[118:119],v7 offset:19456
s_waitcnt lgkmcnt(4)
ds_read_b64_tr_b16 v[208:209],v7 offset:16448
ds_read_b64_tr_b16 v[210:211],v7 offset:18496
ds_read_b64_tr_b16 v[212:213],v7 offset:17472
ds_read_b64_tr_b16 v[214:215],v7 offset:19520
s_waitcnt lgkmcnt(0)
s_waitcnt vmcnt(0)
v_bfe_u32 v9,v0,2,2
v_lshrrev_b32 v10,5,v0
v_lshl_add_u32 v9,v10,2,v9
v_mul_u32_u24 v9,128,v9
v_and_b32 v10,1,v0
v_lshl_add_u32 v9,v10,3,v9
v_bfe_u32 v10,v0,1,1
v_lshl_add_u32 v9,v10,5,v9
v_bfe_u32 v10,v0,4,1
v_lshl_add_u32 v9,v10,4,v9
v_add_u32 v7,s63,v9
ds_read_b64_tr_b16 a[120:121],v7 offset:20480
ds_read_b64_tr_b16 a[122:123],v7 offset:22528
ds_read_b64_tr_b16 a[124:125],v7 offset:21504
ds_read_b64_tr_b16 a[126:127],v7 offset:23552
ds_read_b64_tr_b16 v[216:217],v7 offset:20544
ds_read_b64_tr_b16 v[218:219],v7 offset:22592
ds_read_b64_tr_b16 v[220:221],v7 offset:21568
ds_read_b64_tr_b16 v[222:223],v7 offset:23616
ds_read_b64_tr_b16 a[128:129],v7 offset:24576
ds_read_b64_tr_b16 a[130:131],v7 offset:26624
ds_read_b64_tr_b16 a[132:133],v7 offset:25600
ds_read_b64_tr_b16 a[134:135],v7 offset:27648
s_waitcnt lgkmcnt(4)
ds_read_b64_tr_b16 v[224:225],v7 offset:24640
ds_read_b64_tr_b16 v[226:227],v7 offset:26688
ds_read_b64_tr_b16 v[228:229],v7 offset:25664
ds_read_b64_tr_b16 v[230:231],v7 offset:27712
ds_read_b64_tr_b16 a[136:137],v7 offset:28672
ds_read_b64_tr_b16 a[138:139],v7 offset:30720
ds_read_b64_tr_b16 a[140:141],v7 offset:29696
ds_read_b64_tr_b16 a[142:143],v7 offset:31744
ds_read_b64_tr_b16 v[232:233],v7 offset:28736
ds_read_b64_tr_b16 v[234:235],v7 offset:30784
ds_read_b64_tr_b16 v[236:237],v7 offset:29760
ds_read_b64_tr_b16 v[238:239],v7 offset:31808
s_waitcnt lgkmcnt(4)
ds_read_b64_tr_b16 a[144:145],v7 offset:32768
ds_read_b64_tr_b16 a[146:147],v7 offset:34816
ds_read_b64_tr_b16 a[148:149],v7 offset:33792
ds_read_b64_tr_b16 a[150:151],v7 offset:35840
ds_read_b64_tr_b16 v[240:241],v7 offset:32832
ds_read_b64_tr_b16 v[242:243],v7 offset:34880
ds_read_b64_tr_b16 v[244:245],v7 offset:33856
ds_read_b64_tr_b16 v[246:247],v7 offset:35904
ds_read_b64_tr_b16 a[152:153],v7 offset:36864
ds_read_b64_tr_b16 a[154:155],v7 offset:38912
ds_read_b64_tr_b16 a[156:157],v7 offset:37888
ds_read_b64_tr_b16 a[158:159],v7 offset:39936
s_waitcnt lgkmcnt(4)
ds_read_b64_tr_b16 v[248:249],v7 offset:36928
ds_read_b64_tr_b16 v[250:251],v7 offset:38976
ds_read_b64_tr_b16 v[252:253],v7 offset:37952
ds_read_b64_tr_b16 v[254:255],v7 offset:40000
s_waitcnt lgkmcnt(0)
v_mov_b32 v24,0x3f803f80
v_mov_b32 v25,0x3f803f80
v_mov_b32 v26,0x3f803f80
v_mov_b32 v27,0x3f803f80
s_nop 1
v_mfma_f32_32x32x16_bf16 v[120:135],a[0:3],v[24:27],0
v_mfma_f32_32x32x16_bf16 v[136:151],a[160:163],v[24:27],0
v_mfma_f32_32x32x16_bf16 v[120:135],a[4:7],v[24:27],v[120:135]
v_mfma_f32_32x32x16_bf16 v[136:151],a[164:167],v[24:27],v[136:151]
v_mfma_f32_32x32x16_bf16 v[120:135],a[8:11],v[24:27],v[120:135]
v_mfma_f32_32x32x16_bf16 v[136:151],a[168:171],v[24:27],v[136:151]
v_mfma_f32_32x32x16_bf16 v[120:135],a[12:15],v[24:27],v[120:135]
v_mfma_f32_32x32x16_bf16 v[136:151],a[172:175],v[24:27],v[136:151]
v_mfma_f32_32x32x16_bf16 v[120:135],a[16:19],v[24:27],v[120:135]
v_mfma_f32_32x32x16_bf16 v[136:151],a[176:179],v[24:27],v[136:151]
v_mfma_f32_32x32x16_bf16 v[120:135],a[20:23],v[24:27],v[120:135]
v_mfma_f32_32x32x16_bf16 v[136:151],a[180:183],v[24:27],v[136:151]
v_mfma_f32_32x32x16_bf16 v[120:135],a[24:27],v[24:27],v[120:135]
v_mfma_f32_32x32x16_bf16 v[136:151],a[184:187],v[24:27],v[136:151]
v_mfma_f32_32x32x16_bf16 v[120:135],a[28:31],v[24:27],v[120:135]
v_mfma_f32_32x32x16_bf16 v[136:151],a[188:191],v[24:27],v[136:151]
v_mfma_f32_32x32x16_bf16 v[120:135],a[32:35],v[24:27],v[120:135]
v_mfma_f32_32x32x16_bf16 v[136:151],a[192:195],v[24:27],v[136:151]
v_mfma_f32_32x32x16_bf16 v[120:135],a[36:39],v[24:27],v[120:135]
v_mfma_f32_32x32x16_bf16 v[136:151],a[196:199],v[24:27],v[136:151]
v_mfma_f32_32x32x16_bf16 v[120:135],a[40:43],v[24:27],v[120:135]
v_mfma_f32_32x32x16_bf16 v[136:151],a[200:203],v[24:27],v[136:151]
v_mfma_f32_32x32x16_bf16 v[120:135],a[44:47],v[24:27],v[120:135]
v_mfma_f32_32x32x16_bf16 v[136:151],a[204:207],v[24:27],v[136:151]
v_mfma_f32_32x32x16_bf16 v[120:135],a[48:51],v[24:27],v[120:135]
v_mfma_f32_32x32x16_bf16 v[136:151],a[208:211],v[24:27],v[136:151]
v_mfma_f32_32x32x16_bf16 v[120:135],a[52:55],v[24:27],v[120:135]
v_mfma_f32_32x32x16_bf16 v[136:151],a[212:215],v[24:27],v[136:151]
v_mfma_f32_32x32x16_bf16 v[120:135],a[56:59],v[24:27],v[120:135]
v_mfma_f32_32x32x16_bf16 v[136:151],a[216:219],v[24:27],v[136:151]
v_mfma_f32_32x32x16_bf16 v[120:135],a[60:63],v[24:27],v[120:135]
v_mfma_f32_32x32x16_bf16 v[136:151],a[220:223],v[24:27],v[136:151]
v_mfma_f32_32x32x16_bf16 v[120:135],a[64:67],v[24:27],v[120:135]
v_mfma_f32_32x32x16_bf16 v[136:151],a[224:227],v[24:27],v[136:151]
v_mfma_f32_32x32x16_bf16 v[120:135],a[68:71],v[24:27],v[120:135]
v_mfma_f32_32x32x16_bf16 v[136:151],a[228:231],v[24:27],v[136:151]
v_mfma_f32_32x32x16_bf16 v[120:135],a[72:75],v[24:27],v[120:135]
v_mfma_f32_32x32x16_bf16 v[136:151],a[232:235],v[24:27],v[136:151]
v_mfma_f32_32x32x16_bf16 v[120:135],a[76:79],v[24:27],v[120:135]
v_mfma_f32_32x32x16_bf16 v[136:151],a[236:239],v[24:27],v[136:151]
v_mfma_f32_32x32x16_bf16 v[120:135],a[80:83],v[24:27],v[120:135]
v_mfma_f32_32x32x16_bf16 v[136:151],a[240:243],v[24:27],v[136:151]
v_mfma_f32_32x32x16_bf16 v[120:135],a[84:87],v[24:27],v[120:135]
v_mfma_f32_32x32x16_bf16 v[136:151],a[244:247],v[24:27],v[136:151]
v_mfma_f32_32x32x16_bf16 v[120:135],a[88:91],v[24:27],v[120:135]
v_mfma_f32_32x32x16_bf16 v[136:151],a[248:251],v[24:27],v[136:151]
v_mfma_f32_32x32x16_bf16 v[120:135],a[92:95],v[24:27],v[120:135]
v_mfma_f32_32x32x16_bf16 v[136:151],a[252:255],v[24:27],v[136:151]
v_mfma_f32_32x32x16_bf16 v[120:135],a[96:99],v[24:27],v[120:135]
v_mfma_f32_32x32x16_bf16 v[136:151],v[192:195],v[24:27],v[136:151]
v_mfma_f32_32x32x16_bf16 v[120:135],a[100:103],v[24:27],v[120:135]
v_mfma_f32_32x32x16_bf16 v[136:151],v[196:199],v[24:27],v[136:151]
v_mfma_f32_32x32x16_bf16 v[120:135],a[104:107],v[24:27],v[120:135]
v_mfma_f32_32x32x16_bf16 v[136:151],v[200:203],v[24:27],v[136:151]
v_mfma_f32_32x32x16_bf16 v[120:135],a[108:111],v[24:27],v[120:135]
v_mfma_f32_32x32x16_bf16 v[136:151],v[204:207],v[24:27],v[136:151]
v_mfma_f32_32x32x16_bf16 v[120:135],a[112:115],v[24:27],v[120:135]
v_mfma_f32_32x32x16_bf16 v[136:151],v[208:211],v[24:27],v[136:151]
v_mfma_f32_32x32x16_bf16 v[120:135],a[116:119],v[24:27],v[120:135]
v_mfma_f32_32x32x16_bf16 v[136:151],v[212:215],v[24:27],v[136:151]
v_mfma_f32_32x32x16_bf16 v[120:135],a[120:123],v[24:27],v[120:135]
v_mfma_f32_32x32x16_bf16 v[136:151],v[216:219],v[24:27],v[136:151]
v_mfma_f32_32x32x16_bf16 v[120:135],a[124:127],v[24:27],v[120:135]
v_mfma_f32_32x32x16_bf16 v[136:151],v[220:223],v[24:27],v[136:151]
v_mfma_f32_32x32x16_bf16 v[120:135],a[128:131],v[24:27],v[120:135]
v_mfma_f32_32x32x16_bf16 v[136:151],v[224:227],v[24:27],v[136:151]
v_mfma_f32_32x32x16_bf16 v[120:135],a[132:135],v[24:27],v[120:135]
v_mfma_f32_32x32x16_bf16 v[136:151],v[228:231],v[24:27],v[136:151]
v_mfma_f32_32x32x16_bf16 v[120:135],a[136:139],v[24:27],v[120:135]
v_mfma_f32_32x32x16_bf16 v[136:151],v[232:235],v[24:27],v[136:151]
v_mfma_f32_32x32x16_bf16 v[120:135],a[140:143],v[24:27],v[120:135]
v_mfma_f32_32x32x16_bf16 v[136:151],v[236:239],v[24:27],v[136:151]
v_mfma_f32_32x32x16_bf16 v[120:135],a[144:147],v[24:27],v[120:135]
v_mfma_f32_32x32x16_bf16 v[136:151],v[240:243],v[24:27],v[136:151]
v_mfma_f32_32x32x16_bf16 v[120:135],a[148:151],v[24:27],v[120:135]
v_mfma_f32_32x32x16_bf16 v[136:151],v[244:247],v[24:27],v[136:151]
v_mfma_f32_32x32x16_bf16 v[120:135],a[152:155],v[24:27],v[120:135]
v_mfma_f32_32x32x16_bf16 v[136:151],v[248:251],v[24:27],v[136:151]
v_mfma_f32_32x32x16_bf16 v[120:135],a[156:159],v[24:27],v[120:135]
v_mfma_f32_32x32x16_bf16 v[136:151],v[252:255],v[24:27],v[136:151]
s_barrier
s_lshl_b32 s3,s49,2
v_mov_b32 v7,s3
s_nop 8
ibw_210:
buffer_load_dword v6,v7,s[12:15],0 offen sc1
s_waitcnt vmcnt(0)
v_cmp_ne_u32 vcc,256,v6
s_nop 0
s_cbranch_vccz ok_211
s_sleep 8
s_sub_u32 s47,s47,1
s_cbranch_scc1 ABORT
s_branch ibw_210
ok_211:
s_cmp_lg_u32 s49,0
s_cbranch_scc1 ibok_212
v_and_b32 v7,7,v0
v_lshlrev_b32 v7,2,v7
buffer_load_dword v6,v7,s[12:15],0 offen offset:32 sc1
s_waitcnt vmcnt(0)
v_cmp_ne_u32 vcc,32,v6
s_nop 0
s_cbranch_vccz ibok_212
s_barrier
s_mov_b32 s49,1
s_mov_b32 s3,s2
s_load_dwordx16 s[16:31],s[0:1],0
s_load_dwordx8 s[32:39],s[0:1],64
s_waitcnt lgkmcnt(0)
s_branch DISPATCH
ibok_212:
s_mov_b32 s50,0
s_mov_b32 s32,0
s_mov_b32 s57,0
s_mov_b32 s59,2147483648
s_mov_b32 s82,2147483648
s_mov_b32 s39,2147483648
v_mov_b32 v22,94208
s_mov_b32 s72,0
s_mov_b32 s73,0
s_mov_b32 s78,0
s_mov_b32 s79,0
s_cmp_eq_u32 s46,0
s_cselect_b32 s40,0,2147483648
s_lshl_b32 s60,s46,3
v_add_u32 v13,s60,v22
s_mov_b32 s83,s100
s_lshl_b32 s41,s78,9
s_add_u32 s41,s41,s40
s_lshl_b32 s35,s79,9
s_add_u32 s35,s35,s40
s_add_u32 s35,s35,32768
s_branch QKVQ_COLD0
QKVQ_B0:
s_waitcnt lgkmcnt(3)
v_mfma_f32_32x32x16_bf16 v[56:71],a[0:3],v[24:27],0
ds_read_b128 v[44:47],v17 offset:4096
v_add_u32 v189,s57,v188
v_mfma_f32_32x32x16_bf16 v[72:87],a[160:163],v[24:27],0
v_add_u32 v8,0x800,v189
s_sub_u32 s66,46080,s57
s_lshl_b32 s60,s33,6
s_add_u32 s60,s60,s34
s_mul_i32 s60,s60,46080
s_add_u32 s60,s60,s37
v_mfma_f32_32x32x16_bf16 v[56:71],a[4:7],v[28:31],v[56:71]
ds_read_b128 v[48:51],v16 offset:6144
ds_read2_b64 v[156:159],v189 offset0:0 offset1:32
s_add_u32 s60,s60,206569472
s_lshl_b32 s62,s46,10
v_mfma_f32_32x32x16_bf16 v[72:87],a[164:167],v[28:31],v[72:87]
ds_read2_b64 v[160:163],v189 offset0:64 offset1:96
s_add_u32 s62,s62,40960
s_add_u32 m0,s66,s62
s_add_u32 s63,s60,s62
s_waitcnt lgkmcnt(5)
v_mfma_f32_32x32x16_bf16 v[56:71],a[8:11],v[32:35],v[56:71]
ds_read_b128 v[52:55],v17 offset:6144
ds_read2_b64 v[164:167],v189 offset0:128 offset1:160
buffer_load_dwordx4 v1,s[8:11],s63 offen sc1 lds
v_mfma_f32_32x32x16_bf16 v[72:87],a[168:171],v[32:35],v[72:87]
ds_read2_b64 v[168:171],v189 offset0:192 offset1:224
s_add_u32 m0,s66,45056
s_add_u32 s63,s60,45056
s_mul_i32 s74,s73,393216
s_add_u32 s74,s74,s39
v_mfma_f32_32x32x16_bf16 v[56:71],a[12:15],v[36:39],v[56:71]
ds_read_b128 v[24:27],v16 offset:8192
ds_read2_b64 v[172:175],v8 offset0:0 offset1:32
s_add_u32 s74,s74,s70
v_fma_f32 v88,-v176,v120,v88
v_mfma_f32_32x32x16_bf16 v[72:87],a[172:175],v[36:39],v[72:87]
buffer_load_dwordx4 v1,s[8:11],s63 offen sc1 lds
s_mul_i32 s61,s46,10240
s_add_u32 s60,s60,s61
s_add_u32 s61,s61,s66
s_waitcnt lgkmcnt(8)
v_mfma_f32_32x32x16_bf16 v[56:71],a[16:19],v[40:43],v[56:71]
ds_read_b128 v[28:31],v17 offset:8192
s_add_u32 m0,s61,0
s_add_u32 s63,s60,0
v_fma_f32 v89,-v176,v121,v89
v_fma_f32 v90,-v176,v122,v90
v_mfma_f32_32x32x16_bf16 v[72:87],a[176:179],v[40:43],v[72:87]
v_fma_f32 v91,-v176,v123,v91
v_fma_f32 v92,-v176,v124,v92
v_fma_f32 v93,-v176,v125,v93
v_fma_f32 v94,-v176,v126,v94
v_fma_f32 v95,-v176,v127,v95
v_mfma_f32_32x32x16_bf16 v[56:71],a[20:23],v[44:47],v[56:71]
ds_read_b128 v[32:35],v16 offset:10240
buffer_load_dwordx4 v1,s[8:11],s63 offen sc1 lds
v_mul_f32 v88,v88,v177
v_mul_f32 v89,v89,v177
v_mfma_f32_32x32x16_bf16 v[72:87],a[180:183],v[44:47],v[72:87]
v_mul_f32 v90,v90,v177
v_mul_f32 v91,v91,v177
v_mul_f32 v92,v92,v177
v_mul_f32 v93,v93,v177
v_mul_f32 v94,v94,v177
s_waitcnt lgkmcnt(6)
v_mfma_f32_32x32x16_bf16 v[56:71],a[24:27],v[48:51],v[56:71]
ds_read_b128 v[36:39],v17 offset:10240
v_mul_f32 v95,v95,v177
v_cvt_pk_bf16_f32 v180,v88,v89
v_cvt_pk_bf16_f32 v181,v90,v91
v_cvt_pk_bf16_f32 v182,v92,v93
v_mfma_f32_32x32x16_bf16 v[72:87],a[184:187],v[48:51],v[72:87]
buffer_load_dwordx4 v1,s[8:11],s63 offen offset:1024 sc1 lds
v_cvt_pk_bf16_f32 v183,v94,v95
buffer_store_dwordx4 v[180:183],v20,s[8:11],s74 offen sc1
v_fma_f32 v96,-v176,v128,v96
v_mfma_f32_32x32x16_bf16 v[56:71],a[28:31],v[52:55],v[56:71]
ds_read_b128 v[40:43],v16 offset:12288
v_fma_f32 v97,-v176,v129,v97
v_fma_f32 v98,-v176,v130,v98
v_fma_f32 v99,-v176,v131,v99
v_fma_f32 v100,-v176,v132,v100
v_mfma_f32_32x32x16_bf16 v[72:87],a[188:191],v[52:55],v[72:87]
v_fma_f32 v101,-v176,v133,v101
v_fma_f32 v102,-v176,v134,v102
v_fma_f32 v103,-v176,v135,v103
v_mul_f32 v96,v96,v177
v_mul_f32 v97,v97,v177
s_waitcnt lgkmcnt(3)
v_mfma_f32_32x32x16_bf16 v[56:71],a[32:35],v[24:27],v[56:71]
ds_read_b128 v[44:47],v17 offset:12288
buffer_load_dwordx4 v1,s[8:11],s63 offen offset:2048 sc1 lds
v_mul_f32 v98,v98,v177
v_mul_f32 v99,v99,v177
v_mfma_f32_32x32x16_bf16 v[72:87],a[192:195],v[24:27],v[72:87]
v_mul_f32 v100,v100,v177
v_mul_f32 v101,v101,v177
v_mul_f32 v102,v102,v177
v_mul_f32 v103,v103,v177
v_cvt_pk_bf16_f32 v184,v96,v97
v_mfma_f32_32x32x16_bf16 v[56:71],a[36:39],v[28:31],v[56:71]
ds_read_b128 v[48:51],v16 offset:14336
v_cvt_pk_bf16_f32 v185,v98,v99
v_cvt_pk_bf16_f32 v186,v100,v101
v_cvt_pk_bf16_f32 v187,v102,v103
v_mfma_f32_32x32x16_bf16 v[72:87],a[196:199],v[28:31],v[72:87]
buffer_load_dwordx4 v1,s[8:11],s63 offen offset:3072 sc1 lds
s_add_u32 m0,s61,4096
s_add_u32 s63,s60,4096
s_waitcnt lgkmcnt(3)
v_mfma_f32_32x32x16_bf16 v[56:71],a[40:43],v[32:35],v[56:71]
ds_read_b128 v[52:55],v17 offset:14336
buffer_store_dwordx4 v[184:187],v21,s[8:11],s74 offen sc1
v_fma_f32 v104,-v176,v136,v104
v_fma_f32 v105,-v176,v137,v105
v_mfma_f32_32x32x16_bf16 v[72:87],a[200:203],v[32:35],v[72:87]
v_fma_f32 v106,-v176,v138,v106
v_fma_f32 v107,-v176,v139,v107
v_fma_f32 v108,-v176,v140,v108
v_fma_f32 v109,-v176,v141,v109
v_fma_f32 v110,-v176,v142,v110
v_mfma_f32_32x32x16_bf16 v[56:71],a[44:47],v[36:39],v[56:71]
ds_read_b128 v[24:27],v16 offset:16384
buffer_load_dwordx4 v1,s[8:11],s63 offen sc1 lds
v_fma_f32 v111,-v176,v143,v111
v_mul_f32 v104,v104,v177
v_mfma_f32_32x32x16_bf16 v[72:87],a[204:207],v[36:39],v[72:87]
v_mul_f32 v105,v105,v177
v_mul_f32 v106,v106,v177
v_mul_f32 v107,v107,v177
v_mul_f32 v108,v108,v177
v_mul_f32 v109,v109,v177
s_waitcnt lgkmcnt(3)
v_mfma_f32_32x32x16_bf16 v[56:71],a[48:51],v[40:43],v[56:71]
ds_read_b128 v[28:31],v17 offset:16384
v_mul_f32 v110,v110,v177
v_mul_f32 v111,v111,v177
v_cvt_pk_bf16_f32 v180,v104,v105
v_cvt_pk_bf16_f32 v181,v106,v107
v_mfma_f32_32x32x16_bf16 v[72:87],a[208:211],v[40:43],v[72:87]
buffer_load_dwordx4 v1,s[8:11],s63 offen offset:1024 sc1 lds
v_cvt_pk_bf16_f32 v182,v108,v109
v_cvt_pk_bf16_f32 v183,v110,v111
buffer_store_dwordx4 v[180:183],v20,s[8:11],s74 offen offset:2048 sc1
v_mfma_f32_32x32x16_bf16 v[56:71],a[52:55],v[44:47],v[56:71]
ds_read_b128 v[32:35],v16 offset:18432
v_fma_f32 v112,-v176,v144,v112
v_fma_f32 v113,-v176,v145,v113
v_fma_f32 v114,-v176,v146,v114
v_fma_f32 v115,-v176,v147,v115
v_mfma_f32_32x32x16_bf16 v[72:87],a[212:215],v[44:47],v[72:87]
v_fma_f32 v116,-v176,v148,v116
v_fma_f32 v117,-v176,v149,v117
v_fma_f32 v118,-v176,v150,v118
v_fma_f32 v119,-v176,v151,v119
v_mul_f32 v112,v112,v177
s_waitcnt lgkmcnt(3)
v_mfma_f32_32x32x16_bf16 v[56:71],a[56:59],v[48:51],v[56:71]
ds_read_b128 v[36:39],v17 offset:18432
buffer_load_dwordx4 v1,s[8:11],s63 offen offset:2048 sc1 lds
v_mul_f32 v113,v113,v177
v_mul_f32 v114,v114,v177
v_mfma_f32_32x32x16_bf16 v[72:87],a[216:219],v[48:51],v[72:87]
v_mul_f32 v115,v115,v177
v_mul_f32 v116,v116,v177
v_mul_f32 v117,v117,v177
v_mul_f32 v118,v118,v177
v_mul_f32 v119,v119,v177
v_mfma_f32_32x32x16_bf16 v[56:71],a[60:63],v[52:55],v[56:71]
ds_read_b128 v[40:43],v16 offset:20480
s_waitcnt vmcnt(12)
s_mov_b64 exec,1
buffer_store_dword v5,v1,s[8:11],s59 offen sc1
s_mov_b64 exec,-1
s_mov_b32 s59,2147483648
v_mfma_f32_32x32x16_bf16 v[72:87],a[220:223],v[52:55],v[72:87]
buffer_load_dwordx4 v1,s[8:11],s63 offen offset:3072 sc1 lds
s_add_u32 m0,s61,8192
s_add_u32 s63,s60,8192
v_cvt_pk_bf16_f32 v184,v112,v113
s_waitcnt lgkmcnt(3)
v_mfma_f32_32x32x16_bf16 v[56:71],a[64:67],v[24:27],v[56:71]
ds_read_b128 v[44:47],v17 offset:20480
v_cvt_pk_bf16_f32 v185,v114,v115
v_cvt_pk_bf16_f32 v186,v116,v117
v_cvt_pk_bf16_f32 v187,v118,v119
v_mfma_f32_32x32x16_bf16 v[72:87],a[224:227],v[24:27],v[72:87]
buffer_store_dwordx4 v[184:187],v21,s[8:11],s74 offen offset:2048 sc1
s_lshl_b32 s82,s72,6
s_add_u32 s82,s82,s73
s_lshl_b32 s82,s82,9
s_add_u32 s82,s82,s71
v_mfma_f32_32x32x16_bf16 v[56:71],a[68:71],v[28:31],v[56:71]
ds_read_b128 v[48:51],v16 offset:22528
buffer_load_dwordx4 v1,s[8:11],s63 offen sc1 lds
s_lshl_b32 s75,s69,2
s_add_u32 s82,s82,s75
v_mfma_f32_32x32x16_bf16 v[72:87],a[228:231],v[28:31],v[72:87]
s_add_u32 s82,s82,s39
v_add_f32 v156,v156,v166
v_add_f32 v157,v157,v167
v_add_f32 v158,v158,v168
s_waitcnt lgkmcnt(3)
v_mfma_f32_32x32x16_bf16 v[56:71],a[72:75],v[32:35],v[56:71]
ds_read_b128 v[52:55],v17 offset:22528
v_add_f32 v159,v159,v169
v_add_f32 v160,v160,v170
v_add_f32 v161,v161,v171
v_add_f32 v162,v162,v172
v_mfma_f32_32x32x16_bf16 v[72:87],a[232:235],v[32:35],v[72:87]
buffer_load_dwordx4 v1,s[8:11],s63 offen offset:1024 sc1 lds
s_mov_b32 s53,s33
s_mov_b32 s54,s34
s_add_u32 s79,s79,s33
s_or_b32 s60,s37,s33
v_mfma_f32_32x32x16_bf16 v[56:71],a[76:79],v[36:39],v[56:71]
ds_read_b128 v[24:27],v16 offset:24576
s_cmp_eq_u32 s60,0
s_addc_u32 s78,s78,0
s_lshl_b32 s41,s78,9
s_add_u32 s41,s41,s40
v_mfma_f32_32x32x16_bf16 v[72:87],a[236:239],v[36:39],v[72:87]
s_lshl_b32 s35,s79,9
s_add_u32 s35,s35,s40
s_add_u32 s35,s35,32768
v_add_f32 v163,v163,v173
v_add_f32 v164,v164,v174
s_waitcnt lgkmcnt(3)
v_mfma_f32_32x32x16_bf16 v[56:71],a[80:83],v[40:43],v[56:71]
ds_read_b128 v[28:31],v17 offset:24576
v_add_f32 v165,v165,v175
v_add_f32 v156,v156,v158
v_add_f32 v157,v157,v159
v_add_f32 v160,v160,v162
v_mfma_f32_32x32x16_bf16 v[72:87],a[240:243],v[40:43],v[72:87]
v_add_f32 v161,v161,v163
v_add_f32 v156,v156,v160
v_add_f32 v157,v157,v161
v_add_f32 v156,v156,v164
v_add_f32 v157,v157,v165
v_mfma_f32_32x32x16_bf16 v[56:71],a[84:87],v[44:47],v[56:71]
ds_read_b128 v[32:35],v16 offset:26624
v_mov_b32 v158,v156
v_mov_b32 v159,v157
s_nop 0
v_permlane32_swap_b32 v156,v158
v_permlane32_swap_b32 v157,v159
v_mfma_f32_32x32x16_bf16 v[72:87],a[244:247],v[44:47],v[72:87]
v_add_f32 v176,v156,v158
v_add_f32 v177,v157,v159
v_mul_f32 v176,0x3acccccd,v176
v_mul_f32 v177,0x3acccccd,v177
v_fma_f32 v177,-v176,v176,v177
s_waitcnt lgkmcnt(3)
v_mfma_f32_32x32x16_bf16 v[56:71],a[88:91],v[48:51],v[56:71]
ds_read_b128 v[36:39],v17 offset:26624
buffer_load_dword v3,v2,s[8:11],s35 offen sc1
buffer_load_dword v14,v4,s[8:11],s41 offen sc1
v_mfma_f32_32x32x16_bf16 v[72:87],a[248:251],v[48:51],v[72:87]
v_max_f32 v177,0,v177
v_cvt_pk_bf16_f32 v8,v176,v177
v_lshlrev_b32 v176,16,v8
v_and_b32 v177,0xffff0000,v8
v_add_f32 v177,0x3727c5ac,v177
v_mfma_f32_32x32x16_bf16 v[56:71],a[92:95],v[52:55],v[56:71]
ds_read_b128 v[40:43],v16 offset:28672
v_cvt_pk_bf16_f32 v8,v177,v177
v_lshlrev_b32 v177,16,v8
v_sqrt_f32 v177,v177
v_mfma_f32_32x32x16_bf16 v[72:87],a[252:255],v[52:55],v[72:87]
v_cvt_pk_bf16_f32 v8,v177,v177
v_lshlrev_b32 v177,16,v8
v_rcp_f32 v177,v177
s_waitcnt lgkmcnt(3)
v_mfma_f32_32x32x16_bf16 v[56:71],a[96:99],v[24:27],v[56:71]
ds_read_b128 v[44:47],v17 offset:28672
s_cmp_eq_u32 s51,0
s_cselect_b64 s[76:77],-1,0
v_cndmask_b32 v176,v176,0,s[76:77]
v_cndmask_b32 v177,v177,1.0,s[76:77]
v_mfma_f32_32x32x16_bf16 v[72:87],v[192:195],v[24:27],v[72:87]
s_mov_b32 s72,s51
s_mov_b32 s73,s52
v_mfma_f32_32x32x16_bf16 v[56:71],a[100:103],v[28:31],v[56:71]
ds_read_b128 v[48:51],v16 offset:30720
v_mfma_f32_32x32x16_bf16 v[72:87],v[196:199],v[28:31],v[72:87]
s_waitcnt lgkmcnt(3)
v_mfma_f32_32x32x16_bf16 v[56:71],a[104:107],v[32:35],v[56:71]
ds_read_b128 v[52:55],v17 offset:30720
v_mfma_f32_32x32x16_bf16 v[72:87],v[200:203],v[32:35],v[72:87]
v_mfma_f32_32x32x16_bf16 v[56:71],a[108:111],v[36:39],v[56:71]
ds_read_b128 v[24:27],v16 offset:32768
v_mfma_f32_32x32x16_bf16 v[72:87],v[204:207],v[36:39],v[72:87]
s_waitcnt lgkmcnt(3)
v_mfma_f32_32x32x16_bf16 v[56:71],a[112:115],v[40:43],v[56:71]
ds_read_b128 v[28:31],v17 offset:32768
v_mfma_f32_32x32x16_bf16 v[72:87],v[208:211],v[40:43],v[72:87]
v_mfma_f32_32x32x16_bf16 v[56:71],a[116:119],v[44:47],v[56:71]
ds_read_b128 v[32:35],v16 offset:34816
s_waitcnt vmcnt(4)
s_mov_b64 exec,1
buffer_store_dword v5,v1,s[8:11],s82 offen sc1
s_mov_b64 exec,-1
s_mov_b32 s82,2147483648
v_mfma_f32_32x32x16_bf16 v[72:87],v[212:215],v[44:47],v[72:87]
s_waitcnt lgkmcnt(3)
v_mfma_f32_32x32x16_bf16 v[56:71],a[120:123],v[48:51],v[56:71]
ds_read_b128 v[36:39],v17 offset:34816
v_mfma_f32_32x32x16_bf16 v[72:87],v[216:219],v[48:51],v[72:87]
v_mfma_f32_32x32x16_bf16 v[56:71],a[124:127],v[52:55],v[56:71]
ds_read_b128 v[40:43],v16 offset:36864
s_waitcnt vmcnt(1)
v_cmp_eq_u32 vcc,0,v14
s_cmp_eq_u64 vcc,0
s_cselect_b32 s36,0,2147483648
v_mfma_f32_32x32x16_bf16 v[72:87],v[220:223],v[52:55],v[72:87]
v_cmp_eq_u32 vcc,0,v3
s_cmp_lt_u32 s78,64
s_cselect_b32 s36,s36,2147483648
s_cmp_eq_u64 vcc,0
s_cselect_b32 s60,1,s36
s_waitcnt lgkmcnt(3)
v_mfma_f32_32x32x16_bf16 v[56:71],a[128:131],v[24:27],v[56:71]
ds_read_b128 v[44:47],v17 offset:36864
s_cmp_lt_u32 s79,64
s_cselect_b32 s60,s60,s36
s_sub_u32 s61,s78,s79
s_or_b32 s61,s61,s36
v_mfma_f32_32x32x16_bf16 v[72:87],v[224:227],v[24:27],v[72:87]
s_cmp_lt_u32 s61,16
s_cselect_b32 s36,0,s60
v_mov_b32 v23,s36
ds_write_b32 v13,v23
v_mfma_f32_32x32x16_bf16 v[56:71],a[132:135],v[28:31],v[56:71]
ds_read_b128 v[48:51],v16 offset:38912
v_mfma_f32_32x32x16_bf16 v[72:87],v[228:231],v[28:31],v[72:87]
s_waitcnt lgkmcnt(4)
v_mfma_f32_32x32x16_bf16 v[56:71],a[136:139],v[32:35],v[56:71]
ds_read_b128 v[52:55],v17 offset:38912
v_mfma_f32_32x32x16_bf16 v[72:87],v[232:235],v[32:35],v[72:87]
s_waitcnt lgkmcnt(2)
s_barrier
ds_read_b32 v23,v22
v_mfma_f32_32x32x16_bf16 v[56:71],a[140:143],v[36:39],v[56:71]
ds_read_b128 v[24:27],v18 offset:0
s_cmp_lt_u32 s50,2
s_cselect_b32 s42,1,0
s_or_b32 s42,s42,s37
s_mov_b32 s39,0
v_mfma_f32_32x32x16_bf16 v[72:87],v[236:239],v[36:39],v[72:87]
s_add_u32 s50,s50,1
s_sub_u32 s57,46080,s57
s_mov_b32 s51,s53
s_mov_b32 s52,s54
v_mfma_f32_32x32x16_bf16 v[56:71],a[144:147],v[40:43],v[56:71]
ds_read_b128 v[28:31],v19 offset:0
v_mfma_f32_32x32x16_bf16 v[72:87],v[240:243],v[40:43],v[72:87]
v_mfma_f32_32x32x16_bf16 v[56:71],a[148:151],v[44:47],v[56:71]
ds_read_b128 v[32:35],v18 offset:2048
s_waitcnt lgkmcnt(3)
v_readfirstlane_b32 s38,v23
s_and_b32 s37,s38,2147483648
v_mfma_f32_32x32x16_bf16 v[72:87],v[244:247],v[44:47],v[72:87]
s_and_b32 s33,s38,1
s_cselect_b32 s34,s79,s78
s_cmp_lg_u32 s42,0
v_mfma_f32_32x32x16_bf16 v[56:71],a[152:155],v[48:51],v[56:71]
ds_read_b128 v[36:39],v19 offset:2048
v_mfma_f32_32x32x16_bf16 v[72:87],v[248:251],v[48:51],v[72:87]
v_mfma_f32_32x32x16_bf16 v[56:71],a[156:159],v[52:55],v[56:71]
ds_read_b128 v[40:43],v18 offset:4096
v_mfma_f32_32x32x16_bf16 v[72:87],v[252:255],v[52:55],v[72:87]
s_cbranch_scc1 QKVQ_S0
QKVQ_B1:
s_waitcnt lgkmcnt(3)
v_mfma_f32_32x32x16_bf16 v[88:103],a[0:3],v[24:27],0
ds_read_b128 v[44:47],v19 offset:4096
v_add_u32 v189,s57,v188
v_mfma_f32_32x32x16_bf16 v[104:119],a[160:163],v[24:27],0
v_add_u32 v8,0x800,v189
s_sub_u32 s66,46080,s57
s_lshl_b32 s60,s33,6
s_add_u32 s60,s60,s34
s_mul_i32 s60,s60,46080
s_add_u32 s60,s60,s37
v_mfma_f32_32x32x16_bf16 v[88:103],a[4:7],v[28:31],v[88:103]
ds_read_b128 v[48:51],v18 offset:6144
ds_read2_b64 v[156:159],v189 offset0:0 offset1:32
s_add_u32 s60,s60,206569472
s_lshl_b32 s62,s46,10
v_mfma_f32_32x32x16_bf16 v[104:119],a[164:167],v[28:31],v[104:119]
ds_read2_b64 v[160:163],v189 offset0:64 offset1:96
s_add_u32 s62,s62,40960
s_add_u32 m0,s66,s62
s_add_u32 s63,s60,s62
s_waitcnt lgkmcnt(5)
v_mfma_f32_32x32x16_bf16 v[88:103],a[8:11],v[32:35],v[88:103]
ds_read_b128 v[52:55],v19 offset:6144
ds_read2_b64 v[164:167],v189 offset0:128 offset1:160
buffer_load_dwordx4 v1,s[8:11],s63 offen sc1 lds
v_mfma_f32_32x32x16_bf16 v[104:119],a[168:171],v[32:35],v[104:119]
ds_read2_b64 v[168:171],v189 offset0:192 offset1:224
s_add_u32 m0,s66,45056
s_add_u32 s63,s60,45056
s_mul_i32 s74,s73,393216
s_add_u32 s74,s74,s39
v_mfma_f32_32x32x16_bf16 v[88:103],a[12:15],v[36:39],v[88:103]
ds_read_b128 v[24:27],v18 offset:8192
ds_read2_b64 v[172:175],v8 offset0:0 offset1:32
s_add_u32 s74,s74,s70
v_fma_f32 v56,-v176,v120,v56
v_mfma_f32_32x32x16_bf16 v[104:119],a[172:175],v[36:39],v[104:119]
buffer_load_dwordx4 v1,s[8:11],s63 offen sc1 lds
s_mul_i32 s61,s46,10240
s_add_u32 s60,s60,s61
s_add_u32 s61,s61,s66
s_waitcnt lgkmcnt(8)
v_mfma_f32_32x32x16_bf16 v[88:103],a[16:19],v[40:43],v[88:103]
ds_read_b128 v[28:31],v19 offset:8192
s_add_u32 m0,s61,0
s_add_u32 s63,s60,0
v_fma_f32 v57,-v176,v121,v57
v_fma_f32 v58,-v176,v122,v58
v_mfma_f32_32x32x16_bf16 v[104:119],a[176:179],v[40:43],v[104:119]
v_fma_f32 v59,-v176,v123,v59
v_fma_f32 v60,-v176,v124,v60
v_fma_f32 v61,-v176,v125,v61
v_fma_f32 v62,-v176,v126,v62
v_fma_f32 v63,-v176,v127,v63
v_mfma_f32_32x32x16_bf16 v[88:103],a[20:23],v[44:47],v[88:103]
ds_read_b128 v[32:35],v18 offset:10240
buffer_load_dwordx4 v1,s[8:11],s63 offen sc1 lds
v_mul_f32 v56,v56,v177
v_mul_f32 v57,v57,v177
v_mfma_f32_32x32x16_bf16 v[104:119],a[180:183],v[44:47],v[104:119]
v_mul_f32 v58,v58,v177
v_mul_f32 v59,v59,v177
v_mul_f32 v60,v60,v177
v_mul_f32 v61,v61,v177
v_mul_f32 v62,v62,v177
s_waitcnt lgkmcnt(6)
v_mfma_f32_32x32x16_bf16 v[88:103],a[24:27],v[48:51],v[88:103]
ds_read_b128 v[36:39],v19 offset:10240
v_mul_f32 v63,v63,v177
v_cvt_pk_bf16_f32 v180,v56,v57
v_cvt_pk_bf16_f32 v181,v58,v59
v_cvt_pk_bf16_f32 v182,v60,v61
v_mfma_f32_32x32x16_bf16 v[104:119],a[184:187],v[48:51],v[104:119]
buffer_load_dwordx4 v1,s[8:11],s63 offen offset:1024 sc1 lds
v_cvt_pk_bf16_f32 v183,v62,v63
buffer_store_dwordx4 v[180:183],v20,s[8:11],s74 offen sc1
v_fma_f32 v64,-v176,v128,v64
v_mfma_f32_32x32x16_bf16 v[88:103],a[28:31],v[52:55],v[88:103]
ds_read_b128 v[40:43],v18 offset:12288
v_fma_f32 v65,-v176,v129,v65
v_fma_f32 v66,-v176,v130,v66
v_fma_f32 v67,-v176,v131,v67
v_fma_f32 v68,-v176,v132,v68
v_mfma_f32_32x32x16_bf16 v[104:119],a[188:191],v[52:55],v[104:119]
v_fma_f32 v69,-v176,v133,v69
v_fma_f32 v70,-v176,v134,v70
v_fma_f32 v71,-v176,v135,v71
v_mul_f32 v64,v64,v177
v_mul_f32 v65,v65,v177
s_waitcnt lgkmcnt(3)
v_mfma_f32_32x32x16_bf16 v[88:103],a[32:35],v[24:27],v[88:103]
ds_read_b128 v[44:47],v19 offset:12288
buffer_load_dwordx4 v1,s[8:11],s63 offen offset:2048 sc1 lds
v_mul_f32 v66,v66,v177
v_mul_f32 v67,v67,v177
v_mfma_f32_32x32x16_bf16 v[104:119],a[192:195],v[24:27],v[104:119]
v_mul_f32 v68,v68,v177
v_mul_f32 v69,v69,v177
v_mul_f32 v70,v70,v177
v_mul_f32 v71,v71,v177
v_cvt_pk_bf16_f32 v184,v64,v65
v_mfma_f32_32x32x16_bf16 v[88:103],a[36:39],v[28:31],v[88:103]
ds_read_b128 v[48:51],v18 offset:14336
v_cvt_pk_bf16_f32 v185,v66,v67
v_cvt_pk_bf16_f32 v186,v68,v69
v_cvt_pk_bf16_f32 v187,v70,v71
v_mfma_f32_32x32x16_bf16 v[104:119],a[196:199],v[28:31],v[104:119]
buffer_load_dwordx4 v1,s[8:11],s63 offen offset:3072 sc1 lds
s_add_u32 m0,s61,4096
s_add_u32 s63,s60,4096
s_waitcnt lgkmcnt(3)
v_mfma_f32_32x32x16_bf16 v[88:103],a[40:43],v[32:35],v[88:103]
ds_read_b128 v[52:55],v19 offset:14336
buffer_store_dwordx4 v[184:187],v21,s[8:11],s74 offen sc1
v_fma_f32 v72,-v176,v136,v72
v_fma_f32 v73,-v176,v137,v73
v_mfma_f32_32x32x16_bf16 v[104:119],a[200:203],v[32:35],v[104:119]
v_fma_f32 v74,-v176,v138,v74
v_fma_f32 v75,-v176,v139,v75
v_fma_f32 v76,-v176,v140,v76
v_fma_f32 v77,-v176,v141,v77
v_fma_f32 v78,-v176,v142,v78
v_mfma_f32_32x32x16_bf16 v[88:103],a[44:47],v[36:39],v[88:103]
ds_read_b128 v[24:27],v18 offset:16384
buffer_load_dwordx4 v1,s[8:11],s63 offen sc1 lds
v_fma_f32 v79,-v176,v143,v79
v_mul_f32 v72,v72,v177
v_mfma_f32_32x32x16_bf16 v[104:119],a[204:207],v[36:39],v[104:119]
v_mul_f32 v73,v73,v177
v_mul_f32 v74,v74,v177
v_mul_f32 v75,v75,v177
v_mul_f32 v76,v76,v177
v_mul_f32 v77,v77,v177
s_waitcnt lgkmcnt(3)
v_mfma_f32_32x32x16_bf16 v[88:103],a[48:51],v[40:43],v[88:103]
ds_read_b128 v[28:31],v19 offset:16384
v_mul_f32 v78,v78,v177
v_mul_f32 v79,v79,v177
v_cvt_pk_bf16_f32 v180,v72,v73
v_cvt_pk_bf16_f32 v181,v74,v75
v_mfma_f32_32x32x16_bf16 v[104:119],a[208:211],v[40:43],v[104:119]
buffer_load_dwordx4 v1,s[8:11],s63 offen offset:1024 sc1 lds
v_cvt_pk_bf16_f32 v182,v76,v77
v_cvt_pk_bf16_f32 v183,v78,v79
buffer_store_dwordx4 v[180:183],v20,s[8:11],s74 offen offset:2048 sc1
v_mfma_f32_32x32x16_bf16 v[88:103],a[52:55],v[44:47],v[88:103]
ds_read_b128 v[32:35],v18 offset:18432
v_fma_f32 v80,-v176,v144,v80
v_fma_f32 v81,-v176,v145,v81
v_fma_f32 v82,-v176,v146,v82
v_fma_f32 v83,-v176,v147,v83
v_mfma_f32_32x32x16_bf16 v[104:119],a[212:215],v[44:47],v[104:119]
v_fma_f32 v84,-v176,v148,v84
v_fma_f32 v85,-v176,v149,v85
v_fma_f32 v86,-v176,v150,v86
v_fma_f32 v87,-v176,v151,v87
v_mul_f32 v80,v80,v177
s_waitcnt lgkmcnt(3)
v_mfma_f32_32x32x16_bf16 v[88:103],a[56:59],v[48:51],v[88:103]
ds_read_b128 v[36:39],v19 offset:18432
buffer_load_dwordx4 v1,s[8:11],s63 offen offset:2048 sc1 lds
v_mul_f32 v81,v81,v177
v_mul_f32 v82,v82,v177
v_mfma_f32_32x32x16_bf16 v[104:119],a[216:219],v[48:51],v[104:119]
v_mul_f32 v83,v83,v177
v_mul_f32 v84,v84,v177
v_mul_f32 v85,v85,v177
v_mul_f32 v86,v86,v177
v_mul_f32 v87,v87,v177
v_mfma_f32_32x32x16_bf16 v[88:103],a[60:63],v[52:55],v[88:103]
ds_read_b128 v[40:43],v18 offset:20480
s_waitcnt vmcnt(12)
s_mov_b64 exec,1
buffer_store_dword v5,v1,s[8:11],s59 offen sc1
s_mov_b64 exec,-1
s_mov_b32 s59,2147483648
v_mfma_f32_32x32x16_bf16 v[104:119],a[220:223],v[52:55],v[104:119]
buffer_load_dwordx4 v1,s[8:11],s63 offen offset:3072 sc1 lds
s_add_u32 m0,s61,8192
s_add_u32 s63,s60,8192
v_cvt_pk_bf16_f32 v184,v80,v81
s_waitcnt lgkmcnt(3)
v_mfma_f32_32x32x16_bf16 v[88:103],a[64:67],v[24:27],v[88:103]
ds_read_b128 v[44:47],v19 offset:20480
v_cvt_pk_bf16_f32 v185,v82,v83
v_cvt_pk_bf16_f32 v186,v84,v85
v_cvt_pk_bf16_f32 v187,v86,v87
v_mfma_f32_32x32x16_bf16 v[104:119],a[224:227],v[24:27],v[104:119]
buffer_store_dwordx4 v[184:187],v21,s[8:11],s74 offen offset:2048 sc1
s_lshl_b32 s82,s72,6
s_add_u32 s82,s82,s73
s_lshl_b32 s82,s82,9
s_add_u32 s82,s82,s71
v_mfma_f32_32x32x16_bf16 v[88:103],a[68:71],v[28:31],v[88:103]
ds_read_b128 v[48:51],v18 offset:22528
buffer_load_dwordx4 v1,s[8:11],s63 offen sc1 lds
s_lshl_b32 s75,s69,2
s_add_u32 s82,s82,s75
v_mfma_f32_32x32x16_bf16 v[104:119],a[228:231],v[28:31],v[104:119]
s_add_u32 s82,s82,s39
v_add_f32 v156,v156,v166
v_add_f32 v157,v157,v167
v_add_f32 v158,v158,v168
s_waitcnt lgkmcnt(3)
v_mfma_f32_32x32x16_bf16 v[88:103],a[72:75],v[32:35],v[88:103]
ds_read_b128 v[52:55],v19 offset:22528
v_add_f32 v159,v159,v169
v_add_f32 v160,v160,v170
v_add_f32 v161,v161,v171
v_add_f32 v162,v162,v172
v_mfma_f32_32x32x16_bf16 v[104:119],a[232:235],v[32:35],v[104:119]
buffer_load_dwordx4 v1,s[8:11],s63 offen offset:1024 sc1 lds
s_mov_b32 s53,s33
s_mov_b32 s54,s34
s_add_u32 s79,s79,s33
s_or_b32 s60,s37,s33
v_mfma_f32_32x32x16_bf16 v[88:103],a[76:79],v[36:39],v[88:103]
ds_read_b128 v[24:27],v18 offset:24576
s_cmp_eq_u32 s60,0
s_addc_u32 s78,s78,0
s_lshl_b32 s41,s78,9
s_add_u32 s41,s41,s40
v_mfma_f32_32x32x16_bf16 v[104:119],a[236:239],v[36:39],v[104:119]
s_lshl_b32 s35,s79,9
s_add_u32 s35,s35,s40
s_add_u32 s35,s35,32768
v_add_f32 v163,v163,v173
v_add_f32 v164,v164,v174
s_waitcnt lgkmcnt(3)
v_mfma_f32_32x32x16_bf16 v[88:103],a[80:83],v[40:43],v[88:103]
ds_read_b128 v[28:31],v19 offset:24576
v_add_f32 v165,v165,v175
v_add_f32 v156,v156,v158
v_add_f32 v157,v157,v159
v_add_f32 v160,v160,v162
v_mfma_f32_32x32x16_bf16 v[104:119],a[240:243],v[40:43],v[104:119]
v_add_f32 v161,v161,v163
v_add_f32 v156,v156,v160
v_add_f32 v157,v157,v161
v_add_f32 v156,v156,v164
v_add_f32 v157,v157,v165
v_mfma_f32_32x32x16_bf16 v[88:103],a[84:87],v[44:47],v[88:103]
ds_read_b128 v[32:35],v18 offset:26624
v_mov_b32 v158,v156
v_mov_b32 v159,v157
s_nop 0
v_permlane32_swap_b32 v156,v158
v_permlane32_swap_b32 v157,v159
v_mfma_f32_32x32x16_bf16 v[104:119],a[244:247],v[44:47],v[104:119]
v_add_f32 v176,v156,v158
v_add_f32 v177,v157,v159
v_mul_f32 v176,0x3acccccd,v176
v_mul_f32 v177,0x3acccccd,v177
v_fma_f32 v177,-v176,v176,v177
s_waitcnt lgkmcnt(3)
v_mfma_f32_32x32x16_bf16 v[88:103],a[88:91],v[48:51],v[88:103]
ds_read_b128 v[36:39],v19 offset:26624
buffer_load_dword v3,v2,s[8:11],s35 offen sc1
buffer_load_dword v14,v4,s[8:11],s41 offen sc1
v_mfma_f32_32x32x16_bf16 v[104:119],a[248:251],v[48:51],v[104:119]
v_max_f32 v177,0,v177
v_cvt_pk_bf16_f32 v8,v176,v177
v_lshlrev_b32 v176,16,v8
v_and_b32 v177,0xffff0000,v8
v_add_f32 v177,0x3727c5ac,v177
v_mfma_f32_32x32x16_bf16 v[88:103],a[92:95],v[52:55],v[88:103]
ds_read_b128 v[40:43],v18 offset:28672
v_cvt_pk_bf16_f32 v8,v177,v177
v_lshlrev_b32 v177,16,v8
v_sqrt_f32 v177,v177
v_mfma_f32_32x32x16_bf16 v[104:119],a[252:255],v[52:55],v[104:119]
v_cvt_pk_bf16_f32 v8,v177,v177
v_lshlrev_b32 v177,16,v8
v_rcp_f32 v177,v177
s_waitcnt lgkmcnt(3)
v_mfma_f32_32x32x16_bf16 v[88:103],a[96:99],v[24:27],v[88:103]
ds_read_b128 v[44:47],v19 offset:28672
s_cmp_eq_u32 s51,0
s_cselect_b64 s[76:77],-1,0
v_cndmask_b32 v176,v176,0,s[76:77]
v_cndmask_b32 v177,v177,1.0,s[76:77]
v_mfma_f32_32x32x16_bf16 v[104:119],v[192:195],v[24:27],v[104:119]
s_mov_b32 s72,s51
s_mov_b32 s73,s52
v_mfma_f32_32x32x16_bf16 v[88:103],a[100:103],v[28:31],v[88:103]
ds_read_b128 v[48:51],v18 offset:30720
v_mfma_f32_32x32x16_bf16 v[104:119],v[196:199],v[28:31],v[104:119]
s_waitcnt lgkmcnt(3)
v_mfma_f32_32x32x16_bf16 v[88:103],a[104:107],v[32:35],v[88:103]
ds_read_b128 v[52:55],v19 offset:30720
v_mfma_f32_32x32x16_bf16 v[104:119],v[200:203],v[32:35],v[104:119]
v_mfma_f32_32x32x16_bf16 v[88:103],a[108:111],v[36:39],v[88:103]
ds_read_b128 v[24:27],v18 offset:32768
v_mfma_f32_32x32x16_bf16 v[104:119],v[204:207],v[36:39],v[104:119]
s_waitcnt lgkmcnt(3)
v_mfma_f32_32x32x16_bf16 v[88:103],a[112:115],v[40:43],v[88:103]
ds_read_b128 v[28:31],v19 offset:32768
v_mfma_f32_32x32x16_bf16 v[104:119],v[208:211],v[40:43],v[104:119]
v_mfma_f32_32x32x16_bf16 v[88:103],a[116:119],v[44:47],v[88:103]
ds_read_b128 v[32:35],v18 offset:34816
s_waitcnt vmcnt(4)
s_mov_b64 exec,1
buffer_store_dword v5,v1,s[8:11],s82 offen sc1
s_mov_b64 exec,-1
s_mov_b32 s82,2147483648
v_mfma_f32_32x32x16_bf16 v[104:119],v[212:215],v[44:47],v[104:119]
s_waitcnt lgkmcnt(3)
v_mfma_f32_32x32x16_bf16 v[88:103],a[120:123],v[48:51],v[88:103]
ds_read_b128 v[36:39],v19 offset:34816
v_mfma_f32_32x32x16_bf16 v[104:119],v[216:219],v[48:51],v[104:119]
v_mfma_f32_32x32x16_bf16 v[88:103],a[124:127],v[52:55],v[88:103]
ds_read_b128 v[40:43],v18 offset:36864
s_waitcnt vmcnt(1)
v_cmp_eq_u32 vcc,0,v14
s_cmp_eq_u64 vcc,0
s_cselect_b32 s36,0,2147483648
v_mfma_f32_32x32x16_bf16 v[104:119],v[220:223],v[52:55],v[104:119]
v_cmp_eq_u32 vcc,0,v3
s_cmp_lt_u32 s78,64
s_cselect_b32 s36,s36,2147483648
s_cmp_eq_u64 vcc,0
s_cselect_b32 s60,1,s36
s_waitcnt lgkmcnt(3)
v_mfma_f32_32x32x16_bf16 v[88:103],a[128:131],v[24:27],v[88:103]
ds_read_b128 v[44:47],v19 offset:36864
s_cmp_lt_u32 s79,64
s_cselect_b32 s60,s60,s36
s_sub_u32 s61,s78,s79
s_or_b32 s61,s61,s36
v_mfma_f32_32x32x16_bf16 v[104:119],v[224:227],v[24:27],v[104:119]
s_cmp_lt_u32 s61,16
s_cselect_b32 s36,0,s60
v_mov_b32 v23,s36
ds_write_b32 v13,v23
v_mfma_f32_32x32x16_bf16 v[88:103],a[132:135],v[28:31],v[88:103]
ds_read_b128 v[48:51],v18 offset:38912
v_mfma_f32_32x32x16_bf16 v[104:119],v[228:231],v[28:31],v[104:119]
s_waitcnt lgkmcnt(4)
v_mfma_f32_32x32x16_bf16 v[88:103],a[136:139],v[32:35],v[88:103]
ds_read_b128 v[52:55],v19 offset:38912
v_mfma_f32_32x32x16_bf16 v[104:119],v[232:235],v[32:35],v[104:119]
s_waitcnt lgkmcnt(2)
s_barrier
ds_read_b32 v23,v22
v_mfma_f32_32x32x16_bf16 v[88:103],a[140:143],v[36:39],v[88:103]
ds_read_b128 v[24:27],v16 offset:0
s_cmp_lt_u32 s50,2
s_cselect_b32 s42,1,0
s_or_b32 s42,s42,s37
s_mov_b32 s39,0
v_mfma_f32_32x32x16_bf16 v[104:119],v[236:239],v[36:39],v[104:119]
s_add_u32 s50,s50,1
s_sub_u32 s57,46080,s57
s_mov_b32 s51,s53
s_mov_b32 s52,s54
v_mfma_f32_32x32x16_bf16 v[88:103],a[144:147],v[40:43],v[88:103]
ds_read_b128 v[28:31],v17 offset:0
v_mfma_f32_32x32x16_bf16 v[104:119],v[240:243],v[40:43],v[104:119]
v_mfma_f32_32x32x16_bf16 v[88:103],a[148:151],v[44:47],v[88:103]
ds_read_b128 v[32:35],v16 offset:2048
s_waitcnt lgkmcnt(3)
v_readfirstlane_b32 s38,v23
s_and_b32 s37,s38,2147483648
v_mfma_f32_32x32x16_bf16 v[104:119],v[244:247],v[44:47],v[104:119]
s_and_b32 s33,s38,1
s_cselect_b32 s34,s79,s78
s_cmp_lg_u32 s42,0
v_mfma_f32_32x32x16_bf16 v[88:103],a[152:155],v[48:51],v[88:103]
ds_read_b128 v[36:39],v17 offset:2048
v_mfma_f32_32x32x16_bf16 v[104:119],v[248:251],v[48:51],v[104:119]
v_mfma_f32_32x32x16_bf16 v[88:103],a[156:159],v[52:55],v[88:103]
ds_read_b128 v[40:43],v16 offset:4096
v_mfma_f32_32x32x16_bf16 v[104:119],v[252:255],v[52:55],v[104:119]
s_cbranch_scc0 QKVQ_B0
s_branch QKVQ_S1
s_nop 9
QKVQ_S0:
s_mov_b32 s55,0
s_cmp_lt_u32 s42,2
s_cbranch_scc1 nt_213
s_mov_b32 s55,2
s_cmp_lg_u32 s37,0
s_cbranch_scc1 nt_213
s_mov_b32 s55,1
s_lshl_b32 s60,s33,6
s_add_u32 s60,s60,s34
s_mul_i32 s60,s60,46080
s_add_u32 s60,s60,206569472
s_lshl_b32 s62,s46,10
s_add_u32 s62,s62,40960
s_add_u32 m0,s57,s62
s_add_u32 s63,s60,s62
buffer_load_dwordx4 v1,s[8:11],s63 offen sc1 lds
s_add_u32 m0,s57,45056
s_add_u32 s63,s60,45056
buffer_load_dwordx4 v1,s[8:11],s63 offen sc1 lds
s_mul_i32 s61,s46,10240
s_add_u32 s60,s60,s61
s_add_u32 s61,s61,s57
s_add_u32 m0,s61,0
s_add_u32 s63,s60,0
buffer_load_dwordx4 v1,s[8:11],s63 offen sc1 lds
buffer_load_dwordx4 v1,s[8:11],s63 offen offset:1024 sc1 lds
buffer_load_dwordx4 v1,s[8:11],s63 offen offset:2048 sc1 lds
buffer_load_dwordx4 v1,s[8:11],s63 offen offset:3072 sc1 lds
s_add_u32 m0,s61,4096
s_add_u32 s63,s60,4096
buffer_load_dwordx4 v1,s[8:11],s63 offen sc1 lds
buffer_load_dwordx4 v1,s[8:11],s63 offen offset:1024 sc1 lds
buffer_load_dwordx4 v1,s[8:11],s63 offen offset:2048 sc1 lds
buffer_load_dwordx4 v1,s[8:11],s63 offen offset:3072 sc1 lds
s_add_u32 m0,s61,8192
s_add_u32 s63,s60,8192
buffer_load_dwordx4 v1,s[8:11],s63 offen sc1 lds
buffer_load_dwordx4 v1,s[8:11],s63 offen offset:1024 sc1 lds
nt_213:
s_nop 4
s_mul_i32 s74,s73,393216
s_add_u32 s74,s74,s39
s_add_u32 s74,s74,s70
v_fma_f32 v56,-v176,v120,v56
v_fma_f32 v57,-v176,v121,v57
v_fma_f32 v58,-v176,v122,v58
v_fma_f32 v59,-v176,v123,v59
v_fma_f32 v60,-v176,v124,v60
v_fma_f32 v61,-v176,v125,v61
v_fma_f32 v62,-v176,v126,v62
v_fma_f32 v63,-v176,v127,v63
v_mul_f32 v56,v56,v177
v_mul_f32 v57,v57,v177
v_mul_f32 v58,v58,v177
v_mul_f32 v59,v59,v177
v_mul_f32 v60,v60,v177
v_mul_f32 v61,v61,v177
v_mul_f32 v62,v62,v177
v_mul_f32 v63,v63,v177
v_cvt_pk_bf16_f32 v180,v56,v57
v_cvt_pk_bf16_f32 v181,v58,v59
v_cvt_pk_bf16_f32 v182,v60,v61
v_cvt_pk_bf16_f32 v183,v62,v63
buffer_store_dwordx4 v[180:183],v20,s[8:11],s74 offen sc1
v_fma_f32 v64,-v176,v128,v64
v_fma_f32 v65,-v176,v129,v65
v_fma_f32 v66,-v176,v130,v66
v_fma_f32 v67,-v176,v131,v67
v_fma_f32 v68,-v176,v132,v68
v_fma_f32 v69,-v176,v133,v69
v_fma_f32 v70,-v176,v134,v70
v_fma_f32 v71,-v176,v135,v71
v_mul_f32 v64,v64,v177
v_mul_f32 v65,v65,v177
v_mul_f32 v66,v66,v177
v_mul_f32 v67,v67,v177
v_mul_f32 v68,v68,v177
v_mul_f32 v69,v69,v177
v_mul_f32 v70,v70,v177
v_mul_f32 v71,v71,v177
v_cvt_pk_bf16_f32 v184,v64,v65
v_cvt_pk_bf16_f32 v185,v66,v67
v_cvt_pk_bf16_f32 v186,v68,v69
v_cvt_pk_bf16_f32 v187,v70,v71
buffer_store_dwordx4 v[184:187],v21,s[8:11],s74 offen sc1
v_fma_f32 v72,-v176,v136,v72
v_fma_f32 v73,-v176,v137,v73
v_fma_f32 v74,-v176,v138,v74
v_fma_f32 v75,-v176,v139,v75
v_fma_f32 v76,-v176,v140,v76
v_fma_f32 v77,-v176,v141,v77
v_fma_f32 v78,-v176,v142,v78
v_fma_f32 v79,-v176,v143,v79
v_mul_f32 v72,v72,v177
v_mul_f32 v73,v73,v177
v_mul_f32 v74,v74,v177
v_mul_f32 v75,v75,v177
v_mul_f32 v76,v76,v177
v_mul_f32 v77,v77,v177
v_mul_f32 v78,v78,v177
v_mul_f32 v79,v79,v177
v_cvt_pk_bf16_f32 v180,v72,v73
v_cvt_pk_bf16_f32 v181,v74,v75
v_cvt_pk_bf16_f32 v182,v76,v77
v_cvt_pk_bf16_f32 v183,v78,v79
buffer_store_dwordx4 v[180:183],v20,s[8:11],s74 offen offset:2048 sc1
v_fma_f32 v80,-v176,v144,v80
v_fma_f32 v81,-v176,v145,v81
v_fma_f32 v82,-v176,v146,v82
v_fma_f32 v83,-v176,v147,v83
v_fma_f32 v84,-v176,v148,v84
v_fma_f32 v85,-v176,v149,v85
v_fma_f32 v86,-v176,v150,v86
v_fma_f32 v87,-v176,v151,v87
v_mul_f32 v80,v80,v177
v_mul_f32 v81,v81,v177
v_mul_f32 v82,v82,v177
v_mul_f32 v83,v83,v177
v_mul_f32 v84,v84,v177
v_mul_f32 v85,v85,v177
v_mul_f32 v86,v86,v177
v_mul_f32 v87,v87,v177
v_cvt_pk_bf16_f32 v184,v80,v81
v_cvt_pk_bf16_f32 v185,v82,v83
v_cvt_pk_bf16_f32 v186,v84,v85
v_cvt_pk_bf16_f32 v187,v86,v87
buffer_store_dwordx4 v[184:187],v21,s[8:11],s74 offen offset:2048 sc1
s_lshl_b32 s82,s72,6
s_add_u32 s82,s82,s73
s_lshl_b32 s82,s82,9
s_add_u32 s82,s82,s71
s_lshl_b32 s75,s69,2
s_add_u32 s82,s82,s75
s_add_u32 s82,s82,s39
s_mov_b32 s59,s82
s_mov_b32 s82,2147483648
s_mov_b32 s39,2147483648
s_cmp_eq_u32 s55,0
s_cbranch_scc1 QKVQ_B1
s_cmp_eq_u32 s55,1
s_cbranch_scc1 QKVQ_CD1
s_waitcnt vmcnt(0)
s_mov_b64 exec,1
buffer_store_dword v5,v1,s[8:11],s59 offen sc1
s_mov_b64 exec,-1
s_mov_b32 s59,2147483648
s_cmp_eq_u32 s50,128
s_cbranch_scc1 QKVQ_END
s_branch QKVQ_COLD1
QKVQ_COLD0:
s_cmp_lg_u32 s46,0
s_cbranch_scc1 cp_214
ct_215:
buffer_load_dword v3,v2,s[8:11],s35 offen sc1
buffer_load_dword v14,v4,s[8:11],s41 offen sc1
s_waitcnt vmcnt(0)
v_cmp_eq_u32 vcc,0,v14
s_cmp_eq_u64 vcc,0
s_cselect_b32 s36,0,2147483648
v_cmp_eq_u32 vcc,0,v3
s_cmp_lt_u32 s78,64
s_cselect_b32 s36,s36,2147483648
s_cmp_eq_u64 vcc,0
s_cselect_b32 s60,1,s36
s_cmp_lt_u32 s79,64
s_cselect_b32 s60,s60,s36
s_sub_u32 s61,s78,s79
s_or_b32 s61,s61,s36
s_cmp_lt_u32 s61,16
s_cselect_b32 s36,0,s60
v_mov_b32 v23,s36
s_cmp_lt_u32 s36,2
s_cbranch_scc1 ct_215x
s_sleep 3
s_sub_u32 s47,s47,1
s_cbranch_scc1 ABORT
s_branch ct_215
ct_215x:
ds_write_b32 v22,v23 offset:4
s_waitcnt lgkmcnt(0)
cp_214:
s_barrier
ds_read_b32 v23,v22 offset:4
s_waitcnt lgkmcnt(0)
v_readfirstlane_b32 s38,v23
s_and_b32 s38,s38,1
s_and_b32 s37,s38,2147483648
s_and_b32 s33,s38,1
s_cselect_b32 s34,s79,s78
s_lshl_b32 s60,s33,6
s_add_u32 s60,s60,s34
s_mul_i32 s60,s60,46080
s_add_u32 s60,s60,206569472
s_lshl_b32 s62,s46,10
s_add_u32 s62,s62,40960
s_add_u32 m0,s57,s62
s_add_u32 s63,s60,s62
buffer_load_dwordx4 v1,s[8:11],s63 offen sc1 lds
s_add_u32 m0,s57,45056
s_add_u32 s63,s60,45056
buffer_load_dwordx4 v1,s[8:11],s63 offen sc1 lds
s_mul_i32 s61,s46,10240
s_add_u32 s60,s60,s61
s_add_u32 s61,s61,s57
s_add_u32 m0,s61,0
s_add_u32 s63,s60,0
buffer_load_dwordx4 v1,s[8:11],s63 offen sc1 lds
buffer_load_dwordx4 v1,s[8:11],s63 offen offset:1024 sc1 lds
buffer_load_dwordx4 v1,s[8:11],s63 offen offset:2048 sc1 lds
buffer_load_dwordx4 v1,s[8:11],s63 offen offset:3072 sc1 lds
s_add_u32 m0,s61,4096
s_add_u32 s63,s60,4096
buffer_load_dwordx4 v1,s[8:11],s63 offen sc1 lds
buffer_load_dwordx4 v1,s[8:11],s63 offen offset:1024 sc1 lds
buffer_load_dwordx4 v1,s[8:11],s63 offen offset:2048 sc1 lds
buffer_load_dwordx4 v1,s[8:11],s63 offen offset:3072 sc1 lds
s_add_u32 m0,s61,8192
s_add_u32 s63,s60,8192
buffer_load_dwordx4 v1,s[8:11],s63 offen sc1 lds
buffer_load_dwordx4 v1,s[8:11],s63 offen offset:1024 sc1 lds
QKVQ_CD0:
s_mov_b32 s51,s33
s_mov_b32 s52,s34
s_mov_b32 s53,s33
s_mov_b32 s54,s34
s_add_u32 s79,s79,s33
s_or_b32 s60,s37,s33
s_cmp_eq_u32 s60,0
s_addc_u32 s78,s78,0
s_lshl_b32 s41,s78,9
s_add_u32 s41,s41,s40
s_lshl_b32 s35,s79,9
s_add_u32 s35,s35,s40
s_add_u32 s35,s35,32768
buffer_load_dword v3,v2,s[8:11],s35 offen sc1
buffer_load_dword v14,v4,s[8:11],s41 offen sc1
s_waitcnt vmcnt(0)
s_mov_b64 exec,1
buffer_store_dword v5,v1,s[8:11],s59 offen sc1
s_mov_b64 exec,-1
s_mov_b32 s59,2147483648
v_cmp_eq_u32 vcc,0,v14
s_cmp_eq_u64 vcc,0
s_cselect_b32 s36,0,2147483648
v_cmp_eq_u32 vcc,0,v3
s_cmp_lt_u32 s78,64
s_cselect_b32 s36,s36,2147483648
s_cmp_eq_u64 vcc,0
s_cselect_b32 s60,1,s36
s_cmp_lt_u32 s79,64
s_cselect_b32 s60,s60,s36
s_sub_u32 s61,s78,s79
s_or_b32 s61,s61,s36
s_cmp_lt_u32 s61,16
s_cselect_b32 s36,0,s60
v_mov_b32 v23,s36
ds_write_b32 v13,v23
s_waitcnt lgkmcnt(0)
s_barrier
ds_read_b32 v23,v22
ds_read_b128 v[24:27],v16 offset:0
ds_read_b128 v[28:31],v17 offset:0
ds_read_b128 v[32:35],v16 offset:2048
ds_read_b128 v[36:39],v17 offset:2048
ds_read_b128 v[40:43],v16 offset:4096
s_waitcnt lgkmcnt(5)
v_readfirstlane_b32 s38,v23
s_and_b32 s37,s38,2147483648
s_and_b32 s33,s38,1
s_cselect_b32 s34,s79,s78
s_nop 0
s_branch QKVQ_B0
QKVQ_S1:
s_mov_b32 s55,0
s_cmp_lt_u32 s42,2
s_cbranch_scc1 nt_216
s_mov_b32 s55,2
s_cmp_lg_u32 s37,0
s_cbranch_scc1 nt_216
s_mov_b32 s55,1
s_lshl_b32 s60,s33,6
s_add_u32 s60,s60,s34
s_mul_i32 s60,s60,46080
s_add_u32 s60,s60,206569472
s_lshl_b32 s62,s46,10
s_add_u32 s62,s62,40960
s_add_u32 m0,s57,s62
s_add_u32 s63,s60,s62
buffer_load_dwordx4 v1,s[8:11],s63 offen sc1 lds
s_add_u32 m0,s57,45056
s_add_u32 s63,s60,45056
buffer_load_dwordx4 v1,s[8:11],s63 offen sc1 lds
s_mul_i32 s61,s46,10240
s_add_u32 s60,s60,s61
s_add_u32 s61,s61,s57
s_add_u32 m0,s61,0
s_add_u32 s63,s60,0
buffer_load_dwordx4 v1,s[8:11],s63 offen sc1 lds
buffer_load_dwordx4 v1,s[8:11],s63 offen offset:1024 sc1 lds
buffer_load_dwordx4 v1,s[8:11],s63 offen offset:2048 sc1 lds
buffer_load_dwordx4 v1,s[8:11],s63 offen offset:3072 sc1 lds
s_add_u32 m0,s61,4096
s_add_u32 s63,s60,4096
buffer_load_dwordx4 v1,s[8:11],s63 offen sc1 lds
buffer_load_dwordx4 v1,s[8:11],s63 offen offset:1024 sc1 lds
buffer_load_dwordx4 v1,s[8:11],s63 offen offset:2048 sc1 lds
buffer_load_dwordx4 v1,s[8:11],s63 offen offset:3072 sc1 lds
s_add_u32 m0,s61,8192
s_add_u32 s63,s60,8192
buffer_load_dwordx4 v1,s[8:11],s63 offen sc1 lds
buffer_load_dwordx4 v1,s[8:11],s63 offen offset:1024 sc1 lds
nt_216:
s_nop 4
s_mul_i32 s74,s73,393216
s_add_u32 s74,s74,s39
s_add_u32 s74,s74,s70
v_fma_f32 v88,-v176,v120,v88
v_fma_f32 v89,-v176,v121,v89
v_fma_f32 v90,-v176,v122,v90
v_fma_f32 v91,-v176,v123,v91
v_fma_f32 v92,-v176,v124,v92
v_fma_f32 v93,-v176,v125,v93
v_fma_f32 v94,-v176,v126,v94
v_fma_f32 v95,-v176,v127,v95
v_mul_f32 v88,v88,v177
v_mul_f32 v89,v89,v177
v_mul_f32 v90,v90,v177
v_mul_f32 v91,v91,v177
v_mul_f32 v92,v92,v177
v_mul_f32 v93,v93,v177
v_mul_f32 v94,v94,v177
v_mul_f32 v95,v95,v177
v_cvt_pk_bf16_f32 v180,v88,v89
v_cvt_pk_bf16_f32 v181,v90,v91
v_cvt_pk_bf16_f32 v182,v92,v93
v_cvt_pk_bf16_f32 v183,v94,v95
buffer_store_dwordx4 v[180:183],v20,s[8:11],s74 offen sc1
v_fma_f32 v96,-v176,v128,v96
v_fma_f32 v97,-v176,v129,v97
v_fma_f32 v98,-v176,v130,v98
v_fma_f32 v99,-v176,v131,v99
v_fma_f32 v100,-v176,v132,v100
v_fma_f32 v101,-v176,v133,v101
v_fma_f32 v102,-v176,v134,v102
v_fma_f32 v103,-v176,v135,v103
v_mul_f32 v96,v96,v177
v_mul_f32 v97,v97,v177
v_mul_f32 v98,v98,v177
v_mul_f32 v99,v99,v177
v_mul_f32 v100,v100,v177
v_mul_f32 v101,v101,v177
v_mul_f32 v102,v102,v177
v_mul_f32 v103,v103,v177
v_cvt_pk_bf16_f32 v184,v96,v97
v_cvt_pk_bf16_f32 v185,v98,v99
v_cvt_pk_bf16_f32 v186,v100,v101
v_cvt_pk_bf16_f32 v187,v102,v103
buffer_store_dwordx4 v[184:187],v21,s[8:11],s74 offen sc1
v_fma_f32 v104,-v176,v136,v104
v_fma_f32 v105,-v176,v137,v105
v_fma_f32 v106,-v176,v138,v106
v_fma_f32 v107,-v176,v139,v107
v_fma_f32 v108,-v176,v140,v108
v_fma_f32 v109,-v176,v141,v109
v_fma_f32 v110,-v176,v142,v110
v_fma_f32 v111,-v176,v143,v111
v_mul_f32 v104,v104,v177
v_mul_f32 v105,v105,v177
v_mul_f32 v106,v106,v177
v_mul_f32 v107,v107,v177
v_mul_f32 v108,v108,v177
v_mul_f32 v109,v109,v177
v_mul_f32 v110,v110,v177
v_mul_f32 v111,v111,v177
v_cvt_pk_bf16_f32 v180,v104,v105
v_cvt_pk_bf16_f32 v181,v106,v107
v_cvt_pk_bf16_f32 v182,v108,v109
v_cvt_pk_bf16_f32 v183,v110,v111
buffer_store_dwordx4 v[180:183],v20,s[8:11],s74 offen offset:2048 sc1
v_fma_f32 v112,-v176,v144,v112
v_fma_f32 v113,-v176,v145,v113
v_fma_f32 v114,-v176,v146,v114
v_fma_f32 v115,-v176,v147,v115
v_fma_f32 v116,-v176,v148,v116
v_fma_f32 v117,-v176,v149,v117
v_fma_f32 v118,-v176,v150,v118
v_fma_f32 v119,-v176,v151,v119
v_mul_f32 v112,v112,v177
v_mul_f32 v113,v113,v177
v_mul_f32 v114,v114,v177
v_mul_f32 v115,v115,v177
v_mul_f32 v116,v116,v177
v_mul_f32 v117,v117,v177
v_mul_f32 v118,v118,v177
v_mul_f32 v119,v119,v177
v_cvt_pk_bf16_f32 v184,v112,v113
v_cvt_pk_bf16_f32 v185,v114,v115
v_cvt_pk_bf16_f32 v186,v116,v117
v_cvt_pk_bf16_f32 v187,v118,v119
buffer_store_dwordx4 v[184:187],v21,s[8:11],s74 offen offset:2048 sc1
s_lshl_b32 s82,s72,6
s_add_u32 s82,s82,s73
s_lshl_b32 s82,s82,9
s_add_u32 s82,s82,s71
s_lshl_b32 s75,s69,2
s_add_u32 s82,s82,s75
s_add_u32 s82,s82,s39
s_mov_b32 s59,s82
s_mov_b32 s82,2147483648
s_mov_b32 s39,2147483648
s_cmp_eq_u32 s55,0
s_cbranch_scc1 QKVQ_B0
s_cmp_eq_u32 s55,1
s_cbranch_scc1 QKVQ_CD0
s_waitcnt vmcnt(0)
s_mov_b64 exec,1
buffer_store_dword v5,v1,s[8:11],s59 offen sc1
s_mov_b64 exec,-1
s_mov_b32 s59,2147483648
s_cmp_eq_u32 s50,128
s_cbranch_scc1 QKVQ_END
s_branch QKVQ_COLD0
QKVQ_COLD1:
s_cmp_lg_u32 s46,0
s_cbranch_scc1 cp_217
ct_218:
buffer_load_dword v3,v2,s[8:11],s35 offen sc1
buffer_load_dword v14,v4,s[8:11],s41 offen sc1
s_waitcnt vmcnt(0)
v_cmp_eq_u32 vcc,0,v14
s_cmp_eq_u64 vcc,0
s_cselect_b32 s36,0,2147483648
v_cmp_eq_u32 vcc,0,v3
s_cmp_lt_u32 s78,64
s_cselect_b32 s36,s36,2147483648
s_cmp_eq_u64 vcc,0
s_cselect_b32 s60,1,s36
s_cmp_lt_u32 s79,64
s_cselect_b32 s60,s60,s36
s_sub_u32 s61,s78,s79
s_or_b32 s61,s61,s36
s_cmp_lt_u32 s61,16
s_cselect_b32 s36,0,s60
v_mov_b32 v23,s36
s_cmp_lt_u32 s36,2
s_cbranch_scc1 ct_218x
s_sleep 3
s_sub_u32 s47,s47,1
s_cbranch_scc1 ABORT
s_branch ct_218
ct_218x:
ds_write_b32 v22,v23 offset:4
s_waitcnt lgkmcnt(0)
cp_217:
s_barrier
ds_read_b32 v23,v22 offset:4
s_waitcnt lgkmcnt(0)
v_readfirstlane_b32 s38,v23
s_and_b32 s38,s38,1
s_and_b32 s37,s38,2147483648
s_and_b32 s33,s38,1
s_cselect_b32 s34,s79,s78
s_lshl_b32 s60,s33,6
s_add_u32 s60,s60,s34
s_mul_i32 s60,s60,46080
s_add_u32 s60,s60,206569472
s_lshl_b32 s62,s46,10
s_add_u32 s62,s62,40960
s_add_u32 m0,s57,s62
s_add_u32 s63,s60,s62
buffer_load_dwordx4 v1,s[8:11],s63 offen sc1 lds
s_add_u32 m0,s57,45056
s_add_u32 s63,s60,45056
buffer_load_dwordx4 v1,s[8:11],s63 offen sc1 lds
s_mul_i32 s61,s46,10240
s_add_u32 s60,s60,s61
s_add_u32 s61,s61,s57
s_add_u32 m0,s61,0
s_add_u32 s63,s60,0
buffer_load_dwordx4 v1,s[8:11],s63 offen sc1 lds
buffer_load_dwordx4 v1,s[8:11],s63 offen offset:1024 sc1 lds
buffer_load_dwordx4 v1,s[8:11],s63 offen offset:2048 sc1 lds
buffer_load_dwordx4 v1,s[8:11],s63 offen offset:3072 sc1 lds
s_add_u32 m0,s61,4096
s_add_u32 s63,s60,4096
buffer_load_dwordx4 v1,s[8:11],s63 offen sc1 lds
buffer_load_dwordx4 v1,s[8:11],s63 offen offset:1024 sc1 lds
buffer_load_dwordx4 v1,s[8:11],s63 offen offset:2048 sc1 lds
buffer_load_dwordx4 v1,s[8:11],s63 offen offset:3072 sc1 lds
s_add_u32 m0,s61,8192
s_add_u32 s63,s60,8192
buffer_load_dwordx4 v1,s[8:11],s63 offen sc1 lds
buffer_load_dwordx4 v1,s[8:11],s63 offen offset:1024 sc1 lds
QKVQ_CD1:
s_mov_b32 s51,s33
s_mov_b32 s52,s34
s_mov_b32 s53,s33
s_mov_b32 s54,s34
s_add_u32 s79,s79,s33
s_or_b32 s60,s37,s33
s_cmp_eq_u32 s60,0
s_addc_u32 s78,s78,0
s_lshl_b32 s41,s78,9
s_add_u32 s41,s41,s40
s_lshl_b32 s35,s79,9
s_add_u32 s35,s35,s40
s_add_u32 s35,s35,32768
buffer_load_dword v3,v2,s[8:11],s35 offen sc1
buffer_load_dword v14,v4,s[8:11],s41 offen sc1
s_waitcnt vmcnt(0)
s_mov_b64 exec,1
buffer_store_dword v5,v1,s[8:11],s59 offen sc1
s_mov_b64 exec,-1
s_mov_b32 s59,2147483648
v_cmp_eq_u32 vcc,0,v14
s_cmp_eq_u64 vcc,0
s_cselect_b32 s36,0,2147483648
v_cmp_eq_u32 vcc,0,v3
s_cmp_lt_u32 s78,64
s_cselect_b32 s36,s36,2147483648
s_cmp_eq_u64 vcc,0
s_cselect_b32 s60,1,s36
s_cmp_lt_u32 s79,64
s_cselect_b32 s60,s60,s36
s_sub_u32 s61,s78,s79
s_or_b32 s61,s61,s36
s_cmp_lt_u32 s61,16
s_cselect_b32 s36,0,s60
v_mov_b32 v23,s36
ds_write_b32 v13,v23
s_waitcnt lgkmcnt(0)
s_barrier
ds_read_b32 v23,v22
ds_read_b128 v[24:27],v18 offset:0
ds_read_b128 v[28:31],v19 offset:0
ds_read_b128 v[32:35],v18 offset:2048
ds_read_b128 v[36:39],v19 offset:2048
ds_read_b128 v[40:43],v18 offset:4096
s_waitcnt lgkmcnt(5)
v_readfirstlane_b32 s38,v23
s_and_b32 s37,s38,2147483648
s_and_b32 s33,s38,1
s_cselect_b32 s34,s79,s78
s_nop 0
s_branch QKVQ_B1
QKVQ_END:
s_endpgm
ROLE_QKVV:
v_lshlrev_b32 v1,4,v0
v_mov_b32 v5,1
s_lshl_b32 s56,s48,2
s_add_u32 s56,s56,s46
v_bfe_u32 v6,v0,2,2
v_lshrrev_b32 v7,4,v0
v_add_u32 v7,v6,v7
v_and_b32 v7,3,v7
v_and_b32 v15,3,v0
v_lshlrev_b32 v15,4,v15
v_lshl_add_u32 v15,v7,6,v15
v_lshl_add_u32 v15,v6,8,v15
v_lshrrev_b32 v6,5,v0
v_bfe_u32 v7,v0,4,1
v_lshlrev_b32 v16,10,v7
v_bfe_u32 v7,v0,2,2
v_lshl_add_u32 v16,v7,8,v16
v_add_u32 v6,v6,v7
v_and_b32 v6,3,v6
v_lshl_add_u32 v16,v6,6,v16
v_and_b32 v6,3,v0
v_lshl_add_u32 v16,v6,4,v16
v_add_u32 v18,46080,v16
v_lshrrev_b32 v6,5,v0
v_bfe_u32 v7,v0,4,1
v_lshlrev_b32 v20,10,v7
v_lshl_add_u32 v20,v6,8,v20
v_and_b32 v6,15,v0
v_lshl_add_u32 v20,v6,4,v20
v_lshrrev_b32 v6,5,v0
v_add_u32 v6,2,v6
v_bfe_u32 v7,v0,4,1
v_lshlrev_b32 v17,10,v7
v_bfe_u32 v7,v0,2,2
v_lshl_add_u32 v17,v7,8,v17
v_add_u32 v6,v6,v7
v_and_b32 v6,3,v6
v_lshl_add_u32 v17,v6,6,v17
v_and_b32 v6,3,v0
v_lshl_add_u32 v17,v6,4,v17
v_add_u32 v19,46080,v17
v_lshrrev_b32 v6,5,v0
v_add_u32 v6,2,v6
v_bfe_u32 v7,v0,4,1
v_lshlrev_b32 v21,10,v7
v_lshl_add_u32 v21,v6,8,v21
v_and_b32 v6,15,v0
v_lshl_add_u32 v21,v6,4,v21
s_mov_b32 s69,s56
s_mov_b32 s70,99614720
s_mov_b32 s71,196608
s_lshl_b32 s60,s69,12
s_add_u32 s70,s70,s60
v_lshrrev_b32 v6,5,v0
v_mul_u32_u24 v188,2560,v6
v_and_b32 v6,31,v0
v_lshl_add_u32 v188,v6,3,v188
v_add_u32 v188,0xa000,v188
v_min_u32 v4,7,v0
v_lshlrev_b32 v4,2,v4
v_min_u32 v2,39,v0
v_lshlrev_b32 v2,2,v2
v_mov_b32 v12,93184
s_lshl_b32 s60,s46,8
s_add_u32 s60,s60,92160
v_and_b32 v6,31,v0
v_lshlrev_b32 v190,3,v6
v_add_u32 v190,s60,v190
v_lshrrev_b32 v6,5,v0
v_lshlrev_b32 v191,5,v6
v_add_u32 v191,s60,v191
s_waitcnt vmcnt(0)
s_barrier
s_cmp_lg_u32 s46,0
s_cbranch_scc1 arr_219
v_mov_b32 v6,1
s_lshl_b32 s3,s49,2
v_mov_b32 v7,s3
s_mov_b64 exec,1
buffer_atomic_add v6,v7,s[12:15],0 offen sc1
s_mov_b64 exec,-1
arr_219:
s_lshl_b32 s58,s69,7
s_mul_i32 s63,s46,40960
s_mov_b32 s4,s24
s_mov_b32 s5,s25
s_mov_b32 s6,7864320
s_mov_b32 s7,0x20000
v_lshrrev_b32 v9,3,v0
s_mov_b32 s64,12288
v_mul_lo_u32 v9,v9,s64
v_and_b32 v10,7,v0
v_lshl_add_u32 v6,v10,4,v9
s_add_u32 m0,s63,0
s_add_u32 s65,s58,0
buffer_load_dwordx4 v6,s[4:7],s65 offen lds
s_add_u32 m0,s63,1024
s_add_u32 s65,s58,98304
buffer_load_dwordx4 v6,s[4:7],s65 offen lds
s_add_u32 m0,s63,2048
s_add_u32 s65,s58,196608
buffer_load_dwordx4 v6,s[4:7],s65 offen lds
s_add_u32 m0,s63,3072
s_add_u32 s65,s58,294912
buffer_load_dwordx4 v6,s[4:7],s65 offen lds
s_add_u32 m0,s63,4096
s_add_u32 s65,s58,393216
buffer_load_dwordx4 v6,s[4:7],s65 offen lds
s_add_u32 m0,s63,5120
s_add_u32 s65,s58,491520
buffer_load_dwordx4 v6,s[4:7],s65 offen lds
s_add_u32 m0,s63,6144
s_add_u32 s65,s58,589824
buffer_load_dwordx4 v6,s[4:7],s65 offen lds
s_add_u32 m0,s63,7168
s_add_u32 s65,s58,688128
buffer_load_dwordx4 v6,s[4:7],s65 offen lds
s_add_u32 m0,s63,8192
s_add_u32 s65,s58,786432
buffer_load_dwordx4 v6,s[4:7],s65 offen lds
s_add_u32 m0,s63,9216
s_add_u32 s65,s58,884736
buffer_load_dwordx4 v6,s[4:7],s65 offen lds
s_add_u32 m0,s63,10240
s_add_u32 s65,s58,983040
buffer_load_dwordx4 v6,s[4:7],s65 offen lds
s_add_u32 m0,s63,11264
s_add_u32 s65,s58,1081344
buffer_load_dwordx4 v6,s[4:7],s65 offen lds
s_add_u32 m0,s63,12288
s_add_u32 s65,s58,1179648
buffer_load_dwordx4 v6,s[4:7],s65 offen lds
s_add_u32 m0,s63,13312
s_add_u32 s65,s58,1277952
buffer_load_dwordx4 v6,s[4:7],s65 offen lds
s_add_u32 m0,s63,14336
s_add_u32 s65,s58,1376256
buffer_load_dwordx4 v6,s[4:7],s65 offen lds
s_add_u32 m0,s63,15360
s_add_u32 s65,s58,1474560
buffer_load_dwordx4 v6,s[4:7],s65 offen lds
s_add_u32 m0,s63,16384
s_add_u32 s65,s58,1572864
buffer_load_dwordx4 v6,s[4:7],s65 offen lds
s_add_u32 m0,s63,17408
s_add_u32 s65,s58,1671168
buffer_load_dwordx4 v6,s[4:7],s65 offen lds
s_add_u32 m0,s63,18432
s_add_u32 s65,s58,1769472
buffer_load_dwordx4 v6,s[4:7],s65 offen lds
s_add_u32 m0,s63,19456
s_add_u32 s65,s58,1867776
buffer_load_dwordx4 v6,s[4:7],s65 offen lds
s_add_u32 m0,s63,20480
s_add_u32 s65,s58,1966080
buffer_load_dwordx4 v6,s[4:7],s65 offen lds
s_add_u32 m0,s63,21504
s_add_u32 s65,s58,2064384
buffer_load_dwordx4 v6,s[4:7],s65 offen lds
s_add_u32 m0,s63,22528
s_add_u32 s65,s58,2162688
buffer_load_dwordx4 v6,s[4:7],s65 offen lds
s_add_u32 m0,s63,23552
s_add_u32 s65,s58,2260992
buffer_load_dwordx4 v6,s[4:7],s65 offen lds
s_add_u32 m0,s63,24576
s_add_u32 s65,s58,2359296
buffer_load_dwordx4 v6,s[4:7],s65 offen lds
s_add_u32 m0,s63,25600
s_add_u32 s65,s58,2457600
buffer_load_dwordx4 v6,s[4:7],s65 offen lds
s_add_u32 m0,s63,26624
s_add_u32 s65,s58,2555904
buffer_load_dwordx4 v6,s[4:7],s65 offen lds
s_add_u32 m0,s63,27648
s_add_u32 s65,s58,2654208
buffer_load_dwordx4 v6,s[4:7],s65 offen lds
s_add_u32 m0,s63,28672
s_add_u32 s65,s58,2752512
buffer_load_dwordx4 v6,s[4:7],s65 offen lds
s_add_u32 m0,s63,29696
s_add_u32 s65,s58,2850816
buffer_load_dwordx4 v6,s[4:7],s65 offen lds
s_add_u32 m0,s63,30720
s_add_u32 s65,s58,2949120
buffer_load_dwordx4 v6,s[4:7],s65 offen lds
s_add_u32 m0,s63,31744
s_add_u32 s65,s58,3047424
buffer_load_dwordx4 v6,s[4:7],s65 offen lds
s_add_u32 m0,s63,32768
s_add_u32 s65,s58,3145728
buffer_load_dwordx4 v6,s[4:7],s65 offen lds
s_add_u32 m0,s63,33792
s_add_u32 s65,s58,3244032
buffer_load_dwordx4 v6,s[4:7],s65 offen lds
s_add_u32 m0,s63,34816
s_add_u32 s65,s58,3342336
buffer_load_dwordx4 v6,s[4:7],s65 offen lds
s_add_u32 m0,s63,35840
s_add_u32 s65,s58,3440640
buffer_load_dwordx4 v6,s[4:7],s65 offen lds
s_add_u32 m0,s63,36864
s_add_u32 s65,s58,3538944
buffer_load_dwordx4 v6,s[4:7],s65 offen lds
s_add_u32 m0,s63,37888
s_add_u32 s65,s58,3637248
buffer_load_dwordx4 v6,s[4:7],s65 offen lds
s_add_u32 m0,s63,38912
s_add_u32 s65,s58,3735552
buffer_load_dwordx4 v6,s[4:7],s65 offen lds
s_add_u32 m0,s63,39936
s_add_u32 s65,s58,3833856
buffer_load_dwordx4 v6,s[4:7],s65 offen lds
s_waitcnt vmcnt(20)
v_bfe_u32 v9,v0,2,2
v_lshrrev_b32 v10,5,v0
v_lshl_add_u32 v9,v10,2,v9
v_mul_u32_u24 v9,128,v9
v_and_b32 v10,1,v0
v_lshl_add_u32 v9,v10,3,v9
v_bfe_u32 v10,v0,1,1
v_lshl_add_u32 v9,v10,4,v9
v_bfe_u32 v10,v0,4,1
v_lshl_add_u32 v9,v10,5,v9
v_add_u32 v7,s63,v9
ds_read_b64_tr_b16 a[0:1],v7 offset:0
ds_read_b64_tr_b16 a[2:3],v7 offset:2048
ds_read_b64_tr_b16 a[4:5],v7 offset:1024
ds_read_b64_tr_b16 a[6:7],v7 offset:3072
ds_read_b64_tr_b16 a[160:161],v7 offset:64
ds_read_b64_tr_b16 a[162:163],v7 offset:2112
ds_read_b64_tr_b16 a[164:165],v7 offset:1088
ds_read_b64_tr_b16 a[166:167],v7 offset:3136
ds_read_b64_tr_b16 a[8:9],v7 offset:4096
ds_read_b64_tr_b16 a[10:11],v7 offset:6144
ds_read_b64_tr_b16 a[12:13],v7 offset:5120
ds_read_b64_tr_b16 a[14:15],v7 offset:7168
s_waitcnt lgkmcnt(4)
ds_read_b64_tr_b16 a[168:169],v7 offset:4160
ds_read_b64_tr_b16 a[170:171],v7 offset:6208
ds_read_b64_tr_b16 a[172:173],v7 offset:5184
ds_read_b64_tr_b16 a[174:175],v7 offset:7232
ds_read_b64_tr_b16 a[16:17],v7 offset:8192
ds_read_b64_tr_b16 a[18:19],v7 offset:10240
ds_read_b64_tr_b16 a[20:21],v7 offset:9216
ds_read_b64_tr_b16 a[22:23],v7 offset:11264
ds_read_b64_tr_b16 a[176:177],v7 offset:8256
ds_read_b64_tr_b16 a[178:179],v7 offset:10304
ds_read_b64_tr_b16 a[180:181],v7 offset:9280
ds_read_b64_tr_b16 a[182:183],v7 offset:11328
s_waitcnt lgkmcnt(4)
ds_read_b64_tr_b16 a[24:25],v7 offset:12288
ds_read_b64_tr_b16 a[26:27],v7 offset:14336
ds_read_b64_tr_b16 a[28:29],v7 offset:13312
ds_read_b64_tr_b16 a[30:31],v7 offset:15360
ds_read_b64_tr_b16 a[184:185],v7 offset:12352
ds_read_b64_tr_b16 a[186:187],v7 offset:14400
ds_read_b64_tr_b16 a[188:189],v7 offset:13376
ds_read_b64_tr_b16 a[190:191],v7 offset:15424
ds_read_b64_tr_b16 a[32:33],v7 offset:16384
ds_read_b64_tr_b16 a[34:35],v7 offset:18432
ds_read_b64_tr_b16 a[36:37],v7 offset:17408
ds_read_b64_tr_b16 a[38:39],v7 offset:19456
s_waitcnt lgkmcnt(4)
ds_read_b64_tr_b16 a[192:193],v7 offset:16448
ds_read_b64_tr_b16 a[194:195],v7 offset:18496
ds_read_b64_tr_b16 a[196:197],v7 offset:17472
ds_read_b64_tr_b16 a[198:199],v7 offset:19520
s_waitcnt lgkmcnt(0)
s_add_u32 m0,s63,0
s_add_u32 s65,s58,3932160
buffer_load_dwordx4 v6,s[4:7],s65 offen lds
s_add_u32 m0,s63,1024
s_add_u32 s65,s58,4030464
buffer_load_dwordx4 v6,s[4:7],s65 offen lds
s_add_u32 m0,s63,2048
s_add_u32 s65,s58,4128768
buffer_load_dwordx4 v6,s[4:7],s65 offen lds
s_add_u32 m0,s63,3072
s_add_u32 s65,s58,4227072
buffer_load_dwordx4 v6,s[4:7],s65 offen lds
s_add_u32 m0,s63,4096
s_add_u32 s65,s58,4325376
buffer_load_dwordx4 v6,s[4:7],s65 offen lds
s_add_u32 m0,s63,5120
s_add_u32 s65,s58,4423680
buffer_load_dwordx4 v6,s[4:7],s65 offen lds
s_add_u32 m0,s63,6144
s_add_u32 s65,s58,4521984
buffer_load_dwordx4 v6,s[4:7],s65 offen lds
s_add_u32 m0,s63,7168
s_add_u32 s65,s58,4620288
buffer_load_dwordx4 v6,s[4:7],s65 offen lds
s_add_u32 m0,s63,8192
s_add_u32 s65,s58,4718592
buffer_load_dwordx4 v6,s[4:7],s65 offen lds
s_add_u32 m0,s63,9216
s_add_u32 s65,s58,4816896
buffer_load_dwordx4 v6,s[4:7],s65 offen lds
s_add_u32 m0,s63,10240
s_add_u32 s65,s58,4915200
buffer_load_dwordx4 v6,s[4:7],s65 offen lds
s_add_u32 m0,s63,11264
s_add_u32 s65,s58,5013504
buffer_load_dwordx4 v6,s[4:7],s65 offen lds
s_add_u32 m0,s63,12288
s_add_u32 s65,s58,5111808
buffer_load_dwordx4 v6,s[4:7],s65 offen lds
s_add_u32 m0,s63,13312
s_add_u32 s65,s58,5210112
buffer_load_dwordx4 v6,s[4:7],s65 offen lds
s_add_u32 m0,s63,14336
s_add_u32 s65,s58,5308416
buffer_load_dwordx4 v6,s[4:7],s65 offen lds
s_add_u32 m0,s63,15360
s_add_u32 s65,s58,5406720
buffer_load_dwordx4 v6,s[4:7],s65 offen lds
s_add_u32 m0,s63,16384
s_add_u32 s65,s58,5505024
buffer_load_dwordx4 v6,s[4:7],s65 offen lds
s_add_u32 m0,s63,17408
s_add_u32 s65,s58,5603328
buffer_load_dwordx4 v6,s[4:7],s65 offen lds
s_add_u32 m0,s63,18432
s_add_u32 s65,s58,5701632
buffer_load_dwordx4 v6,s[4:7],s65 offen lds
s_add_u32 m0,s63,19456
s_add_u32 s65,s58,5799936
buffer_load_dwordx4 v6,s[4:7],s65 offen lds
s_waitcnt vmcnt(20)
v_bfe_u32 v9,v0,2,2
v_lshrrev_b32 v10,5,v0
v_lshl_add_u32 v9,v10,2,v9
v_mul_u32_u24 v9,128,v9
v_and_b32 v10,1,v0
v_lshl_add_u32 v9,v10,3,v9
v_bfe_u32 v10,v0,1,1
v_lshl_add_u32 v9,v10,4,v9
v_bfe_u32 v10,v0,4,1
v_lshl_add_u32 v9,v10,5,v9
v_add_u32 v7,s63,v9
ds_read_b64_tr_b16 a[40:41],v7 offset:20480
ds_read_b64_tr_b16 a[42:43],v7 offset:22528
ds_read_b64_tr_b16 a[44:45],v7 offset:21504
ds_read_b64_tr_b16 a[46:47],v7 offset:23552
ds_read_b64_tr_b16 a[200:201],v7 offset:20544
ds_read_b64_tr_b16 a[202:203],v7 offset:22592
ds_read_b64_tr_b16 a[204:205],v7 offset:21568
ds_read_b64_tr_b16 a[206:207],v7 offset:23616
ds_read_b64_tr_b16 a[48:49],v7 offset:24576
ds_read_b64_tr_b16 a[50:51],v7 offset:26624
ds_read_b64_tr_b16 a[52:53],v7 offset:25600
ds_read_b64_tr_b16 a[54:55],v7 offset:27648
s_waitcnt lgkmcnt(4)
ds_read_b64_tr_b16 a[208:209],v7 offset:24640
ds_read_b64_tr_b16 a[210:211],v7 offset:26688
ds_read_b64_tr_b16 a[212:213],v7 offset:25664
ds_read_b64_tr_b16 a[214:215],v7 offset:27712
ds_read_b64_tr_b16 a[56:57],v7 offset:28672
ds_read_b64_tr_b16 a[58:59],v7 offset:30720
ds_read_b64_tr_b16 a[60:61],v7 offset:29696
ds_read_b64_tr_b16 a[62:63],v7 offset:31744
ds_read_b64_tr_b16 a[216:217],v7 offset:28736
ds_read_b64_tr_b16 a[218:219],v7 offset:30784
ds_read_b64_tr_b16 a[220:221],v7 offset:29760
ds_read_b64_tr_b16 a[222:223],v7 offset:31808
s_waitcnt lgkmcnt(4)
ds_read_b64_tr_b16 a[64:65],v7 offset:32768
ds_read_b64_tr_b16 a[66:67],v7 offset:34816
ds_read_b64_tr_b16 a[68:69],v7 offset:33792
ds_read_b64_tr_b16 a[70:71],v7 offset:35840
ds_read_b64_tr_b16 a[224:225],v7 offset:32832
ds_read_b64_tr_b16 a[226:227],v7 offset:34880
ds_read_b64_tr_b16 a[228:229],v7 offset:33856
ds_read_b64_tr_b16 a[230:231],v7 offset:35904
ds_read_b64_tr_b16 a[72:73],v7 offset:36864
ds_read_b64_tr_b16 a[74:75],v7 offset:38912
ds_read_b64_tr_b16 a[76:77],v7 offset:37888
ds_read_b64_tr_b16 a[78:79],v7 offset:39936
s_waitcnt lgkmcnt(4)
ds_read_b64_tr_b16 a[232:233],v7 offset:36928
ds_read_b64_tr_b16 a[234:235],v7 offset:38976
ds_read_b64_tr_b16 a[236:237],v7 offset:37952
ds_read_b64_tr_b16 a[238:239],v7 offset:40000
s_waitcnt lgkmcnt(0)
s_add_u32 m0,s63,20480
s_add_u32 s65,s58,5898240
buffer_load_dwordx4 v6,s[4:7],s65 offen lds
s_add_u32 m0,s63,21504
s_add_u32 s65,s58,5996544
buffer_load_dwordx4 v6,s[4:7],s65 offen lds
s_add_u32 m0,s63,22528
s_add_u32 s65,s58,6094848
buffer_load_dwordx4 v6,s[4:7],s65 offen lds
s_add_u32 m0,s63,23552
s_add_u32 s65,s58,6193152
buffer_load_dwordx4 v6,s[4:7],s65 offen lds
s_add_u32 m0,s63,24576
s_add_u32 s65,s58,6291456
buffer_load_dwordx4 v6,s[4:7],s65 offen lds
s_add_u32 m0,s63,25600
s_add_u32 s65,s58,6389760
buffer_load_dwordx4 v6,s[4:7],s65 offen lds
s_add_u32 m0,s63,26624
s_add_u32 s65,s58,6488064
buffer_load_dwordx4 v6,s[4:7],s65 offen lds
s_add_u32 m0,s63,27648
s_add_u32 s65,s58,6586368
buffer_load_dwordx4 v6,s[4:7],s65 offen lds
s_add_u32 m0,s63,28672
s_add_u32 s65,s58,6684672
buffer_load_dwordx4 v6,s[4:7],s65 offen lds
s_add_u32 m0,s63,29696
s_add_u32 s65,s58,6782976
buffer_load_dwordx4 v6,s[4:7],s65 offen lds
s_add_u32 m0,s63,30720
s_add_u32 s65,s58,6881280
buffer_load_dwordx4 v6,s[4:7],s65 offen lds
s_add_u32 m0,s63,31744
s_add_u32 s65,s58,6979584
buffer_load_dwordx4 v6,s[4:7],s65 offen lds
s_add_u32 m0,s63,32768
s_add_u32 s65,s58,7077888
buffer_load_dwordx4 v6,s[4:7],s65 offen lds
s_add_u32 m0,s63,33792
s_add_u32 s65,s58,7176192
buffer_load_dwordx4 v6,s[4:7],s65 offen lds
s_add_u32 m0,s63,34816
s_add_u32 s65,s58,7274496
buffer_load_dwordx4 v6,s[4:7],s65 offen lds
s_add_u32 m0,s63,35840
s_add_u32 s65,s58,7372800
buffer_load_dwordx4 v6,s[4:7],s65 offen lds
s_add_u32 m0,s63,36864
s_add_u32 s65,s58,7471104
buffer_load_dwordx4 v6,s[4:7],s65 offen lds
s_add_u32 m0,s63,37888
s_add_u32 s65,s58,7569408
buffer_load_dwordx4 v6,s[4:7],s65 offen lds
s_add_u32 m0,s63,38912
s_add_u32 s65,s58,7667712
buffer_load_dwordx4 v6,s[4:7],s65 offen lds
s_add_u32 m0,s63,39936
s_add_u32 s65,s58,7766016
buffer_load_dwordx4 v6,s[4:7],s65 offen lds
s_waitcnt vmcnt(20)
v_bfe_u32 v9,v0,2,2
v_lshrrev_b32 v10,5,v0
v_lshl_add_u32 v9,v10,2,v9
v_mul_u32_u24 v9,128,v9
v_and_b32 v10,1,v0
v_lshl_add_u32 v9,v10,3,v9
v_bfe_u32 v10,v0,1,1
v_lshl_add_u32 v9,v10,4,v9
v_bfe_u32 v10,v0,4,1
v_lshl_add_u32 v9,v10,5,v9
v_add_u32 v7,s63,v9
ds_read_b64_tr_b16 a[80:81],v7 offset:0
ds_read_b64_tr_b16 a[82:83],v7 offset:2048
ds_read_b64_tr_b16 a[84:85],v7 offset:1024
ds_read_b64_tr_b16 a[86:87],v7 offset:3072
ds_read_b64_tr_b16 a[240:241],v7 offset:64
ds_read_b64_tr_b16 a[242:243],v7 offset:2112
ds_read_b64_tr_b16 a[244:245],v7 offset:1088
ds_read_b64_tr_b16 a[246:247],v7 offset:3136
ds_read_b64_tr_b16 a[88:89],v7 offset:4096
ds_read_b64_tr_b16 a[90:91],v7 offset:6144
ds_read_b64_tr_b16 a[92:93],v7 offset:5120
ds_read_b64_tr_b16 a[94:95],v7 offset:7168
s_waitcnt lgkmcnt(4)
ds_read_b64_tr_b16 a[248:249],v7 offset:4160
ds_read_b64_tr_b16 a[250:251],v7 offset:6208
ds_read_b64_tr_b16 a[252:253],v7 offset:5184
ds_read_b64_tr_b16 a[254:255],v7 offset:7232
ds_read_b64_tr_b16 a[96:97],v7 offset:8192
ds_read_b64_tr_b16 a[98:99],v7 offset:10240
ds_read_b64_tr_b16 a[100:101],v7 offset:9216
ds_read_b64_tr_b16 a[102:103],v7 offset:11264
ds_read_b64_tr_b16 v[192:193],v7 offset:8256
ds_read_b64_tr_b16 v[194:195],v7 offset:10304
ds_read_b64_tr_b16 v[196:197],v7 offset:9280
ds_read_b64_tr_b16 v[198:199],v7 offset:11328
s_waitcnt lgkmcnt(4)
ds_read_b64_tr_b16 a[104:105],v7 offset:12288
ds_read_b64_tr_b16 a[106:107],v7 offset:14336
ds_read_b64_tr_b16 a[108:109],v7 offset:13312
ds_read_b64_tr_b16 a[110:111],v7 offset:15360
ds_read_b64_tr_b16 v[200:201],v7 offset:12352
ds_read_b64_tr_b16 v[202:203],v7 offset:14400
ds_read_b64_tr_b16 v[204:205],v7 offset:13376
ds_read_b64_tr_b16 v[206:207],v7 offset:15424
ds_read_b64_tr_b16 a[112:113],v7 offset:16384
ds_read_b64_tr_b16 a[114:115],v7 offset:18432
ds_read_b64_tr_b16 a[116:117],v7 offset:17408
ds_read_b64_tr_b16 a[118:119],v7 offset:19456
s_waitcnt lgkmcnt(4)
ds_read_b64_tr_b16 v[208:209],v7 offset:16448
ds_read_b64_tr_b16 v[210:211],v7 offset:18496
ds_read_b64_tr_b16 v[212:213],v7 offset:17472
ds_read_b64_tr_b16 v[214:215],v7 offset:19520
s_waitcnt lgkmcnt(0)
s_waitcnt vmcnt(0)
v_bfe_u32 v9,v0,2,2
v_lshrrev_b32 v10,5,v0
v_lshl_add_u32 v9,v10,2,v9
v_mul_u32_u24 v9,128,v9
v_and_b32 v10,1,v0
v_lshl_add_u32 v9,v10,3,v9
v_bfe_u32 v10,v0,1,1
v_lshl_add_u32 v9,v10,4,v9
v_bfe_u32 v10,v0,4,1
v_lshl_add_u32 v9,v10,5,v9
v_add_u32 v7,s63,v9
ds_read_b64_tr_b16 a[120:121],v7 offset:20480
ds_read_b64_tr_b16 a[122:123],v7 offset:22528
ds_read_b64_tr_b16 a[124:125],v7 offset:21504
ds_read_b64_tr_b16 a[126:127],v7 offset:23552
ds_read_b64_tr_b16 v[216:217],v7 offset:20544
ds_read_b64_tr_b16 v[218:219],v7 offset:22592
ds_read_b64_tr_b16 v[220:221],v7 offset:21568
ds_read_b64_tr_b16 v[222:223],v7 offset:23616
ds_read_b64_tr_b16 a[128:129],v7 offset:24576
ds_read_b64_tr_b16 a[130:131],v7 offset:26624
ds_read_b64_tr_b16 a[132:133],v7 offset:25600
ds_read_b64_tr_b16 a[134:135],v7 offset:27648
s_waitcnt lgkmcnt(4)
ds_read_b64_tr_b16 v[224:225],v7 offset:24640
ds_read_b64_tr_b16 v[226:227],v7 offset:26688
ds_read_b64_tr_b16 v[228:229],v7 offset:25664
ds_read_b64_tr_b16 v[230:231],v7 offset:27712
ds_read_b64_tr_b16 a[136:137],v7 offset:28672
ds_read_b64_tr_b16 a[138:139],v7 offset:30720
ds_read_b64_tr_b16 a[140:141],v7 offset:29696
ds_read_b64_tr_b16 a[142:143],v7 offset:31744
ds_read_b64_tr_b16 v[232:233],v7 offset:28736
ds_read_b64_tr_b16 v[234:235],v7 offset:30784
ds_read_b64_tr_b16 v[236:237],v7 offset:29760
ds_read_b64_tr_b16 v[238:239],v7 offset:31808
s_waitcnt lgkmcnt(4)
ds_read_b64_tr_b16 a[144:145],v7 offset:32768
ds_read_b64_tr_b16 a[146:147],v7 offset:34816
ds_read_b64_tr_b16 a[148:149],v7 offset:33792
ds_read_b64_tr_b16 a[150:151],v7 offset:35840
ds_read_b64_tr_b16 v[240:241],v7 offset:32832
ds_read_b64_tr_b16 v[242:243],v7 offset:34880
ds_read_b64_tr_b16 v[244:245],v7 offset:33856
ds_read_b64_tr_b16 v[246:247],v7 offset:35904
ds_read_b64_tr_b16 a[152:153],v7 offset:36864
ds_read_b64_tr_b16 a[154:155],v7 offset:38912
ds_read_b64_tr_b16 a[156:157],v7 offset:37888
ds_read_b64_tr_b16 a[158:159],v7 offset:39936
s_waitcnt lgkmcnt(4)
ds_read_b64_tr_b16 v[248:249],v7 offset:36928
ds_read_b64_tr_b16 v[250:251],v7 offset:38976
ds_read_b64_tr_b16 v[252:253],v7 offset:37952
ds_read_b64_tr_b16 v[254:255],v7 offset:40000
s_waitcnt lgkmcnt(0)
v_mov_b32 v24,0x3f803f80
v_mov_b32 v25,0x3f803f80
v_mov_b32 v26,0x3f803f80
v_mov_b32 v27,0x3f803f80
s_nop 1
v_mfma_f32_32x32x16_bf16 v[56:71],v[24:27],a[0:3],0
v_mfma_f32_32x32x16_bf16 v[72:87],v[24:27],a[160:163],0
v_mfma_f32_32x32x16_bf16 v[56:71],v[24:27],a[4:7],v[56:71]
v_mfma_f32_32x32x16_bf16 v[72:87],v[24:27],a[164:167],v[72:87]
v_mfma_f32_32x32x16_bf16 v[56:71],v[24:27],a[8:11],v[56:71]
v_mfma_f32_32x32x16_bf16 v[72:87],v[24:27],a[168:171],v[72:87]
v_mfma_f32_32x32x16_bf16 v[56:71],v[24:27],a[12:15],v[56:71]
v_mfma_f32_32x32x16_bf16 v[72:87],v[24:27],a[172:175],v[72:87]
v_mfma_f32_32x32x16_bf16 v[56:71],v[24:27],a[16:19],v[56:71]
v_mfma_f32_32x32x16_bf16 v[72:87],v[24:27],a[176:179],v[72:87]
v_mfma_f32_32x32x16_bf16 v[56:71],v[24:27],a[20:23],v[56:71]
v_mfma_f32_32x32x16_bf16 v[72:87],v[24:27],a[180:183],v[72:87]
v_mfma_f32_32x32x16_bf16 v[56:71],v[24:27],a[24:27],v[56:71]
v_mfma_f32_32x32x16_bf16 v[72:87],v[24:27],a[184:187],v[72:87]
v_mfma_f32_32x32x16_bf16 v[56:71],v[24:27],a[28:31],v[56:71]
v_mfma_f32_32x32x16_bf16 v[72:87],v[24:27],a[188:191],v[72:87]
v_mfma_f32_32x32x16_bf16 v[56:71],v[24:27],a[32:35],v[56:71]
v_mfma_f32_32x32x16_bf16 v[72:87],v[24:27],a[192:195],v[72:87]
v_mfma_f32_32x32x16_bf16 v[56:71],v[24:27],a[36:39],v[56:71]
v_mfma_f32_32x32x16_bf16 v[72:87],v[24:27],a[196:199],v[72:87]
v_mfma_f32_32x32x16_bf16 v[56:71],v[24:27],a[40:43],v[56:71]
v_mfma_f32_32x32x16_bf16 v[72:87],v[24:27],a[200:203],v[72:87]
v_mfma_f32_32x32x16_bf16 v[56:71],v[24:27],a[44:47],v[56:71]
v_mfma_f32_32x32x16_bf16 v[72:87],v[24:27],a[204:207],v[72:87]
v_mfma_f32_32x32x16_bf16 v[56:71],v[24:27],a[48:51],v[56:71]
v_mfma_f32_32x32x16_bf16 v[72:87],v[24:27],a[208:211],v[72:87]
v_mfma_f32_32x32x16_bf16 v[56:71],v[24:27],a[52:55],v[56:71]
v_mfma_f32_32x32x16_bf16 v[72:87],v[24:27],a[212:215],v[72:87]
v_mfma_f32_32x32x16_bf16 v[56:71],v[24:27],a[56:59],v[56:71]
v_mfma_f32_32x32x16_bf16 v[72:87],v[24:27],a[216:219],v[72:87]
v_mfma_f32_32x32x16_bf16 v[56:71],v[24:27],a[60:63],v[56:71]
v_mfma_f32_32x32x16_bf16 v[72:87],v[24:27],a[220:223],v[72:87]
v_mfma_f32_32x32x16_bf16 v[56:71],v[24:27],a[64:67],v[56:71]
v_mfma_f32_32x32x16_bf16 v[72:87],v[24:27],a[224:227],v[72:87]
v_mfma_f32_32x32x16_bf16 v[56:71],v[24:27],a[68:71],v[56:71]
v_mfma_f32_32x32x16_bf16 v[72:87],v[24:27],a[228:231],v[72:87]
v_mfma_f32_32x32x16_bf16 v[56:71],v[24:27],a[72:75],v[56:71]
v_mfma_f32_32x32x16_bf16 v[72:87],v[24:27],a[232:235],v[72:87]
v_mfma_f32_32x32x16_bf16 v[56:71],v[24:27],a[76:79],v[56:71]
v_mfma_f32_32x32x16_bf16 v[72:87],v[24:27],a[236:239],v[72:87]
v_mfma_f32_32x32x16_bf16 v[56:71],v[24:27],a[80:83],v[56:71]
v_mfma_f32_32x32x16_bf16 v[72:87],v[24:27],a[240:243],v[72:87]
v_mfma_f32_32x32x16_bf16 v[56:71],v[24:27],a[84:87],v[56:71]
v_mfma_f32_32x32x16_bf16 v[72:87],v[24:27],a[244:247],v[72:87]
v_mfma_f32_32x32x16_bf16 v[56:71],v[24:27],a[88:91],v[56:71]
v_mfma_f32_32x32x16_bf16 v[72:87],v[24:27],a[248:251],v[72:87]
v_mfma_f32_32x32x16_bf16 v[56:71],v[24:27],a[92:95],v[56:71]
v_mfma_f32_32x32x16_bf16 v[72:87],v[24:27],a[252:255],v[72:87]
v_mfma_f32_32x32x16_bf16 v[56:71],v[24:27],a[96:99],v[56:71]
v_mfma_f32_32x32x16_bf16 v[72:87],v[24:27],v[192:195],v[72:87]
v_mfma_f32_32x32x16_bf16 v[56:71],v[24:27],a[100:103],v[56:71]
v_mfma_f32_32x32x16_bf16 v[72:87],v[24:27],v[196:199],v[72:87]
v_mfma_f32_32x32x16_bf16 v[56:71],v[24:27],a[104:107],v[56:71]
v_mfma_f32_32x32x16_bf16 v[72:87],v[24:27],v[200:203],v[72:87]
v_mfma_f32_32x32x16_bf16 v[56:71],v[24:27],a[108:111],v[56:71]
v_mfma_f32_32x32x16_bf16 v[72:87],v[24:27],v[204:207],v[72:87]
v_mfma_f32_32x32x16_bf16 v[56:71],v[24:27],a[112:115],v[56:71]
v_mfma_f32_32x32x16_bf16 v[72:87],v[24:27],v[208:211],v[72:87]
v_mfma_f32_32x32x16_bf16 v[56:71],v[24:27],a[116:119],v[56:71]
v_mfma_f32_32x32x16_bf16 v[72:87],v[24:27],v[212:215],v[72:87]
v_mfma_f32_32x32x16_bf16 v[56:71],v[24:27],a[120:123],v[56:71]
v_mfma_f32_32x32x16_bf16 v[72:87],v[24:27],v[216:219],v[72:87]
v_mfma_f32_32x32x16_bf16 v[56:71],v[24:27],a[124:127],v[56:71]
v_mfma_f32_32x32x16_bf16 v[72:87],v[24:27],v[220:223],v[72:87]
v_mfma_f32_32x32x16_bf16 v[56:71],v[24:27],a[128:131],v[56:71]
v_mfma_f32_32x32x16_bf16 v[72:87],v[24:27],v[224:227],v[72:87]
v_mfma_f32_32x32x16_bf16 v[56:71],v[24:27],a[132:135],v[56:71]
v_mfma_f32_32x32x16_bf16 v[72:87],v[24:27],v[228:231],v[72:87]
v_mfma_f32_32x32x16_bf16 v[56:71],v[24:27],a[136:139],v[56:71]
v_mfma_f32_32x32x16_bf16 v[72:87],v[24:27],v[232:235],v[72:87]
v_mfma_f32_32x32x16_bf16 v[56:71],v[24:27],a[140:143],v[56:71]
v_mfma_f32_32x32x16_bf16 v[72:87],v[24:27],v[236:239],v[72:87]
v_mfma_f32_32x32x16_bf16 v[56:71],v[24:27],a[144:147],v[56:71]
v_mfma_f32_32x32x16_bf16 v[72:87],v[24:27],v[240:243],v[72:87]
v_mfma_f32_32x32x16_bf16 v[56:71],v[24:27],a[148:151],v[56:71]
v_mfma_f32_32x32x16_bf16 v[72:87],v[24:27],v[244:247],v[72:87]
v_mfma_f32_32x32x16_bf16 v[56:71],v[24:27],a[152:155],v[56:71]
v_mfma_f32_32x32x16_bf16 v[72:87],v[24:27],v[248:251],v[72:87]
v_mfma_f32_32x32x16_bf16 v[56:71],v[24:27],a[156:159],v[56:71]
v_mfma_f32_32x32x16_bf16 v[72:87],v[24:27],v[252:255],v[72:87]
s_nop 4
v_mov_b32 v120,v56
s_nop 5
v_mov_b32 v121,v72
s_barrier
s_lshl_b32 s3,s49,2
v_mov_b32 v7,s3
s_nop 1
ibw_220:
buffer_load_dword v6,v7,s[12:15],0 offen sc1
s_waitcnt vmcnt(0)
v_cmp_ne_u32 vcc,256,v6
s_nop 0
s_cbranch_vccz ok_221
s_sleep 8
s_sub_u32 s47,s47,1
s_cbranch_scc1 ABORT
s_branch ibw_220
ok_221:
s_cmp_lg_u32 s49,0
s_cbranch_scc1 ibok_222
v_and_b32 v7,7,v0
v_lshlrev_b32 v7,2,v7
buffer_load_dword v6,v7,s[12:15],0 offen offset:32 sc1
s_waitcnt vmcnt(0)
v_cmp_ne_u32 vcc,32,v6
s_nop 0
s_cbranch_vccz ibok_222
s_barrier
s_mov_b32 s49,1
s_mov_b32 s3,s2
s_load_dwordx16 s[16:31],s[0:1],0
s_load_dwordx8 s[32:39],s[0:1],64
s_waitcnt lgkmcnt(0)
s_branch DISPATCH
ibok_222:
s_mov_b32 s50,0
s_mov_b32 s32,0
s_mov_b32 s57,0
s_mov_b32 s59,2147483648
s_mov_b32 s82,2147483648
s_mov_b32 s39,2147483648
v_mov_b32 v22,94208
s_mov_b32 s72,0
s_mov_b32 s73,0
s_mov_b32 s78,0
s_mov_b32 s79,0
s_cmp_eq_u32 s46,0
s_cselect_b32 s40,0,2147483648
s_lshl_b32 s60,s46,3
v_add_u32 v13,s60,v22
s_mov_b32 s83,s100
s_lshl_b32 s41,s78,9
s_add_u32 s41,s41,s40
s_lshl_b32 s35,s79,9
s_add_u32 s35,s35,s40
s_add_u32 s35,s35,32768
s_branch QKVV_COLD0
QKVV_B0:
s_waitcnt lgkmcnt(3)
v_mfma_f32_32x32x16_bf16 v[56:71],v[24:27],a[0:3],0
ds_read_b128 v[44:47],v17 offset:4096
v_add_u32 v189,s57,v188
v_mfma_f32_32x32x16_bf16 v[72:87],v[24:27],a[160:163],0
v_add_u32 v8,0x800,v189
s_sub_u32 s66,46080,s57
s_lshl_b32 s60,s33,6
s_add_u32 s60,s60,s34
s_mul_i32 s60,s60,46080
s_add_u32 s60,s60,s37
v_mfma_f32_32x32x16_bf16 v[56:71],v[28:31],a[4:7],v[56:71]
ds_read_b128 v[48:51],v16 offset:6144
ds_read2_b64 v[156:159],v189 offset0:0 offset1:32
s_add_u32 s60,s60,206569472
s_lshl_b32 s62,s46,10
v_mfma_f32_32x32x16_bf16 v[72:87],v[28:31],a[164:167],v[72:87]
ds_read2_b64 v[160:163],v189 offset0:64 offset1:96
s_add_u32 s62,s62,40960
s_add_u32 m0,s66,s62
s_add_u32 s63,s60,s62
s_waitcnt lgkmcnt(5)
v_mfma_f32_32x32x16_bf16 v[56:71],v[32:35],a[8:11],v[56:71]
ds_read_b128 v[52:55],v17 offset:6144
ds_read2_b64 v[164:167],v189 offset0:128 offset1:160
buffer_load_dwordx4 v1,s[8:11],s63 offen sc1 lds
v_mfma_f32_32x32x16_bf16 v[72:87],v[32:35],a[168:171],v[72:87]
ds_read2_b64 v[168:171],v189 offset0:192 offset1:224
s_add_u32 m0,s66,45056
s_add_u32 s63,s60,45056
s_mul_i32 s74,s73,393216
s_add_u32 s74,s74,s39
v_mfma_f32_32x32x16_bf16 v[56:71],v[36:39],a[12:15],v[56:71]
ds_read_b128 v[24:27],v16 offset:8192
ds_read2_b64 v[172:175],v8 offset0:0 offset1:32
s_add_u32 s74,s74,s70
v_fma_f32 v88,-v124,v120,v88
v_mfma_f32_32x32x16_bf16 v[72:87],v[36:39],a[172:175],v[72:87]
buffer_load_dwordx4 v1,s[8:11],s63 offen sc1 lds
s_mul_i32 s61,s46,10240
s_add_u32 s60,s60,s61
s_add_u32 s61,s61,s66
s_waitcnt lgkmcnt(8)
v_mfma_f32_32x32x16_bf16 v[56:71],v[40:43],a[16:19],v[56:71]
ds_read_b128 v[28:31],v17 offset:8192
s_add_u32 m0,s61,0
s_add_u32 s63,s60,0
v_fma_f32 v89,-v126,v120,v89
v_fma_f32 v90,-v128,v120,v90
v_mfma_f32_32x32x16_bf16 v[72:87],v[40:43],a[176:179],v[72:87]
v_fma_f32 v91,-v130,v120,v91
v_fma_f32 v96,-v140,v120,v96
v_fma_f32 v97,-v142,v120,v97
v_fma_f32 v98,-v144,v120,v98
v_fma_f32 v99,-v146,v120,v99
v_mfma_f32_32x32x16_bf16 v[56:71],v[44:47],a[20:23],v[56:71]
ds_read_b128 v[32:35],v16 offset:10240
buffer_load_dwordx4 v1,s[8:11],s63 offen sc1 lds
v_mul_f32 v88,v88,v125
v_mul_f32 v89,v89,v127
v_mfma_f32_32x32x16_bf16 v[72:87],v[44:47],a[180:183],v[72:87]
v_mul_f32 v90,v90,v129
v_mul_f32 v91,v91,v131
v_mul_f32 v96,v96,v141
v_mul_f32 v97,v97,v143
v_mul_f32 v98,v98,v145
s_waitcnt lgkmcnt(6)
v_mfma_f32_32x32x16_bf16 v[56:71],v[48:51],a[24:27],v[56:71]
ds_read_b128 v[36:39],v17 offset:10240
v_mul_f32 v99,v99,v147
v_cvt_pk_bf16_f32 v180,v88,v89
v_cvt_pk_bf16_f32 v181,v90,v91
v_cvt_pk_bf16_f32 v182,v96,v97
v_mfma_f32_32x32x16_bf16 v[72:87],v[48:51],a[184:187],v[72:87]
buffer_load_dwordx4 v1,s[8:11],s63 offen offset:1024 sc1 lds
v_cvt_pk_bf16_f32 v183,v98,v99
buffer_store_dwordx4 v[180:183],v20,s[8:11],s74 offen sc1
v_fma_f32 v92,-v132,v120,v92
v_mfma_f32_32x32x16_bf16 v[56:71],v[52:55],a[28:31],v[56:71]
ds_read_b128 v[40:43],v16 offset:12288
v_fma_f32 v93,-v134,v120,v93
v_fma_f32 v94,-v136,v120,v94
v_fma_f32 v95,-v138,v120,v95
v_fma_f32 v100,-v148,v120,v100
v_mfma_f32_32x32x16_bf16 v[72:87],v[52:55],a[188:191],v[72:87]
v_fma_f32 v101,-v150,v120,v101
v_fma_f32 v102,-v152,v120,v102
v_fma_f32 v103,-v154,v120,v103
v_mul_f32 v92,v92,v133
v_mul_f32 v93,v93,v135
s_waitcnt lgkmcnt(3)
v_mfma_f32_32x32x16_bf16 v[56:71],v[24:27],a[32:35],v[56:71]
ds_read_b128 v[44:47],v17 offset:12288
buffer_load_dwordx4 v1,s[8:11],s63 offen offset:2048 sc1 lds
v_mul_f32 v94,v94,v137
v_mul_f32 v95,v95,v139
v_mfma_f32_32x32x16_bf16 v[72:87],v[24:27],a[192:195],v[72:87]
v_mul_f32 v100,v100,v149
v_mul_f32 v101,v101,v151
v_mul_f32 v102,v102,v153
v_mul_f32 v103,v103,v155
v_cvt_pk_bf16_f32 v184,v92,v93
v_mfma_f32_32x32x16_bf16 v[56:71],v[28:31],a[36:39],v[56:71]
ds_read_b128 v[48:51],v16 offset:14336
v_cvt_pk_bf16_f32 v185,v94,v95
v_cvt_pk_bf16_f32 v186,v100,v101
v_cvt_pk_bf16_f32 v187,v102,v103
v_mfma_f32_32x32x16_bf16 v[72:87],v[28:31],a[196:199],v[72:87]
buffer_load_dwordx4 v1,s[8:11],s63 offen offset:3072 sc1 lds
s_add_u32 m0,s61,4096
s_add_u32 s63,s60,4096
s_waitcnt lgkmcnt(3)
v_mfma_f32_32x32x16_bf16 v[56:71],v[32:35],a[40:43],v[56:71]
ds_read_b128 v[52:55],v17 offset:14336
buffer_store_dwordx4 v[184:187],v21,s[8:11],s74 offen sc1
v_fma_f32 v104,-v124,v121,v104
v_fma_f32 v105,-v126,v121,v105
v_mfma_f32_32x32x16_bf16 v[72:87],v[32:35],a[200:203],v[72:87]
v_fma_f32 v106,-v128,v121,v106
v_fma_f32 v107,-v130,v121,v107
v_fma_f32 v112,-v140,v121,v112
v_fma_f32 v113,-v142,v121,v113
v_fma_f32 v114,-v144,v121,v114
v_mfma_f32_32x32x16_bf16 v[56:71],v[36:39],a[44:47],v[56:71]
ds_read_b128 v[24:27],v16 offset:16384
buffer_load_dwordx4 v1,s[8:11],s63 offen sc1 lds
v_fma_f32 v115,-v146,v121,v115
v_mul_f32 v104,v104,v125
v_mfma_f32_32x32x16_bf16 v[72:87],v[36:39],a[204:207],v[72:87]
v_mul_f32 v105,v105,v127
v_mul_f32 v106,v106,v129
v_mul_f32 v107,v107,v131
v_mul_f32 v112,v112,v141
v_mul_f32 v113,v113,v143
s_waitcnt lgkmcnt(3)
v_mfma_f32_32x32x16_bf16 v[56:71],v[40:43],a[48:51],v[56:71]
ds_read_b128 v[28:31],v17 offset:16384
v_mul_f32 v114,v114,v145
v_mul_f32 v115,v115,v147
v_cvt_pk_bf16_f32 v180,v104,v105
v_cvt_pk_bf16_f32 v181,v106,v107
v_mfma_f32_32x32x16_bf16 v[72:87],v[40:43],a[208:211],v[72:87]
buffer_load_dwordx4 v1,s[8:11],s63 offen offset:1024 sc1 lds
v_cvt_pk_bf16_f32 v182,v112,v113
v_cvt_pk_bf16_f32 v183,v114,v115
buffer_store_dwordx4 v[180:183],v20,s[8:11],s74 offen offset:2048 sc1
v_mfma_f32_32x32x16_bf16 v[56:71],v[44:47],a[52:55],v[56:71]
ds_read_b128 v[32:35],v16 offset:18432
v_fma_f32 v108,-v132,v121,v108
v_fma_f32 v109,-v134,v121,v109
v_fma_f32 v110,-v136,v121,v110
v_fma_f32 v111,-v138,v121,v111
v_mfma_f32_32x32x16_bf16 v[72:87],v[44:47],a[212:215],v[72:87]
v_fma_f32 v116,-v148,v121,v116
v_fma_f32 v117,-v150,v121,v117
v_fma_f32 v118,-v152,v121,v118
v_fma_f32 v119,-v154,v121,v119
v_mul_f32 v108,v108,v133
s_waitcnt lgkmcnt(3)
v_mfma_f32_32x32x16_bf16 v[56:71],v[48:51],a[56:59],v[56:71]
ds_read_b128 v[36:39],v17 offset:18432
buffer_load_dwordx4 v1,s[8:11],s63 offen offset:2048 sc1 lds
v_mul_f32 v109,v109,v135
v_mul_f32 v110,v110,v137
v_mfma_f32_32x32x16_bf16 v[72:87],v[48:51],a[216:219],v[72:87]
v_mul_f32 v111,v111,v139
v_mul_f32 v116,v116,v149
v_mul_f32 v117,v117,v151
v_mul_f32 v118,v118,v153
v_mul_f32 v119,v119,v155
v_mfma_f32_32x32x16_bf16 v[56:71],v[52:55],a[60:63],v[56:71]
ds_read_b128 v[40:43],v16 offset:20480
s_waitcnt vmcnt(12)
s_mov_b64 exec,1
buffer_store_dword v5,v1,s[8:11],s59 offen sc1
s_mov_b64 exec,-1
s_mov_b32 s59,2147483648
v_mfma_f32_32x32x16_bf16 v[72:87],v[52:55],a[220:223],v[72:87]
buffer_load_dwordx4 v1,s[8:11],s63 offen offset:3072 sc1 lds
s_add_u32 m0,s61,8192
s_add_u32 s63,s60,8192
v_cvt_pk_bf16_f32 v184,v108,v109
s_waitcnt lgkmcnt(3)
v_mfma_f32_32x32x16_bf16 v[56:71],v[24:27],a[64:67],v[56:71]
ds_read_b128 v[44:47],v17 offset:20480
v_cvt_pk_bf16_f32 v185,v110,v111
v_cvt_pk_bf16_f32 v186,v116,v117
v_cvt_pk_bf16_f32 v187,v118,v119
v_mfma_f32_32x32x16_bf16 v[72:87],v[24:27],a[224:227],v[72:87]
buffer_store_dwordx4 v[184:187],v21,s[8:11],s74 offen offset:2048 sc1
s_lshl_b32 s82,s72,6
s_add_u32 s82,s82,s73
s_lshl_b32 s82,s82,9
s_add_u32 s82,s82,s71
v_mfma_f32_32x32x16_bf16 v[56:71],v[28:31],a[68:71],v[56:71]
ds_read_b128 v[48:51],v16 offset:22528
buffer_load_dwordx4 v1,s[8:11],s63 offen sc1 lds
s_lshl_b32 s75,s69,2
s_add_u32 s82,s82,s75
v_mfma_f32_32x32x16_bf16 v[72:87],v[28:31],a[228:231],v[72:87]
s_add_u32 s82,s82,s39
v_add_f32 v156,v156,v166
v_add_f32 v157,v157,v167
v_add_f32 v158,v158,v168
s_waitcnt lgkmcnt(3)
v_mfma_f32_32x32x16_bf16 v[56:71],v[32:35],a[72:75],v[56:71]
ds_read_b128 v[52:55],v17 offset:22528
v_add_f32 v159,v159,v169
v_add_f32 v160,v160,v170
v_add_f32 v161,v161,v171
v_add_f32 v162,v162,v172
v_mfma_f32_32x32x16_bf16 v[72:87],v[32:35],a[232:235],v[72:87]
buffer_load_dwordx4 v1,s[8:11],s63 offen offset:1024 sc1 lds
s_mov_b32 s53,s33
s_mov_b32 s54,s34
s_add_u32 s79,s79,s33
s_or_b32 s60,s37,s33
v_mfma_f32_32x32x16_bf16 v[56:71],v[36:39],a[76:79],v[56:71]
ds_read_b128 v[24:27],v16 offset:24576
s_cmp_eq_u32 s60,0
s_addc_u32 s78,s78,0
s_lshl_b32 s41,s78,9
s_add_u32 s41,s41,s40
v_mfma_f32_32x32x16_bf16 v[72:87],v[36:39],a[236:239],v[72:87]
s_lshl_b32 s35,s79,9
s_add_u32 s35,s35,s40
s_add_u32 s35,s35,32768
v_add_f32 v163,v163,v173
v_add_f32 v164,v164,v174
s_waitcnt lgkmcnt(3)
v_mfma_f32_32x32x16_bf16 v[56:71],v[40:43],a[80:83],v[56:71]
ds_read_b128 v[28:31],v17 offset:24576
v_add_f32 v165,v165,v175
v_add_f32 v156,v156,v158
v_add_f32 v157,v157,v159
v_add_f32 v160,v160,v162
v_mfma_f32_32x32x16_bf16 v[72:87],v[40:43],a[240:243],v[72:87]
v_add_f32 v161,v161,v163
v_add_f32 v156,v156,v160
v_add_f32 v157,v157,v161
v_add_f32 v156,v156,v164
v_add_f32 v157,v157,v165
v_mfma_f32_32x32x16_bf16 v[56:71],v[44:47],a[84:87],v[56:71]
ds_read_b128 v[32:35],v16 offset:26624
v_mov_b32 v158,v156
v_mov_b32 v159,v157
s_nop 0
v_permlane32_swap_b32 v156,v158
v_permlane32_swap_b32 v157,v159
v_mfma_f32_32x32x16_bf16 v[72:87],v[44:47],a[244:247],v[72:87]
v_add_f32 v176,v156,v158
v_add_f32 v177,v157,v159
v_mul_f32 v176,0x3acccccd,v176
v_mul_f32 v177,0x3acccccd,v177
v_fma_f32 v177,-v176,v176,v177
s_waitcnt lgkmcnt(3)
v_mfma_f32_32x32x16_bf16 v[56:71],v[48:51],a[88:91],v[56:71]
ds_read_b128 v[36:39],v17 offset:26624
buffer_load_dword v3,v2,s[8:11],s35 offen sc1
buffer_load_dword v14,v4,s[8:11],s41 offen sc1
v_mfma_f32_32x32x16_bf16 v[72:87],v[48:51],a[248:251],v[72:87]
v_max_f32 v177,0,v177
v_cvt_pk_bf16_f32 v8,v176,v177
v_lshlrev_b32 v176,16,v8
v_and_b32 v177,0xffff0000,v8
v_add_f32 v177,0x3727c5ac,v177
v_mfma_f32_32x32x16_bf16 v[56:71],v[52:55],a[92:95],v[56:71]
ds_read_b128 v[40:43],v16 offset:28672
v_cvt_pk_bf16_f32 v8,v177,v177
v_lshlrev_b32 v177,16,v8
v_sqrt_f32 v177,v177
v_mfma_f32_32x32x16_bf16 v[72:87],v[52:55],a[252:255],v[72:87]
v_cvt_pk_bf16_f32 v8,v177,v177
v_lshlrev_b32 v177,16,v8
v_rcp_f32 v177,v177
s_waitcnt lgkmcnt(3)
v_mfma_f32_32x32x16_bf16 v[56:71],v[24:27],a[96:99],v[56:71]
ds_read_b128 v[44:47],v17 offset:28672
s_cmp_eq_u32 s51,0
s_cselect_b64 s[76:77],-1,0
v_cndmask_b32 v176,v176,0,s[76:77]
v_cndmask_b32 v177,v177,1.0,s[76:77]
v_mfma_f32_32x32x16_bf16 v[72:87],v[24:27],v[192:195],v[72:87]
s_mov_b32 s72,s51
s_mov_b32 s73,s52
ds_write_b64 v190,v[176:177]
ds_read_b128 v[124:127],v191 offset:0
v_mfma_f32_32x32x16_bf16 v[56:71],v[28:31],a[100:103],v[56:71]
ds_read_b128 v[48:51],v16 offset:30720
ds_read_b128 v[128:131],v191 offset:16
ds_read_b128 v[132:135],v191 offset:64
v_mfma_f32_32x32x16_bf16 v[72:87],v[28:31],v[196:199],v[72:87]
ds_read_b128 v[136:139],v191 offset:80
ds_read_b128 v[140:143],v191 offset:128
s_waitcnt lgkmcnt(9)
v_mfma_f32_32x32x16_bf16 v[56:71],v[32:35],a[104:107],v[56:71]
ds_read_b128 v[52:55],v17 offset:30720
ds_read_b128 v[144:147],v191 offset:144
ds_read_b128 v[148:151],v191 offset:192
v_mfma_f32_32x32x16_bf16 v[72:87],v[32:35],v[200:203],v[72:87]
ds_read_b128 v[152:155],v191 offset:208
v_mfma_f32_32x32x16_bf16 v[56:71],v[36:39],a[108:111],v[56:71]
ds_read_b128 v[24:27],v16 offset:32768
v_mfma_f32_32x32x16_bf16 v[72:87],v[36:39],v[204:207],v[72:87]
s_waitcnt lgkmcnt(12)
v_mfma_f32_32x32x16_bf16 v[56:71],v[40:43],a[112:115],v[56:71]
ds_read_b128 v[28:31],v17 offset:32768
v_mfma_f32_32x32x16_bf16 v[72:87],v[40:43],v[208:211],v[72:87]
v_mfma_f32_32x32x16_bf16 v[56:71],v[44:47],a[116:119],v[56:71]
ds_read_b128 v[32:35],v16 offset:34816
s_waitcnt vmcnt(4)
s_mov_b64 exec,1
buffer_store_dword v5,v1,s[8:11],s82 offen sc1
s_mov_b64 exec,-1
s_mov_b32 s82,2147483648
v_mfma_f32_32x32x16_bf16 v[72:87],v[44:47],v[212:215],v[72:87]
s_waitcnt lgkmcnt(6)
v_mfma_f32_32x32x16_bf16 v[56:71],v[48:51],a[120:123],v[56:71]
ds_read_b128 v[36:39],v17 offset:34816
v_mfma_f32_32x32x16_bf16 v[72:87],v[48:51],v[216:219],v[72:87]
v_mfma_f32_32x32x16_bf16 v[56:71],v[52:55],a[124:127],v[56:71]
ds_read_b128 v[40:43],v16 offset:36864
s_waitcnt vmcnt(1)
v_cmp_eq_u32 vcc,0,v14
s_cmp_eq_u64 vcc,0
s_cselect_b32 s36,0,2147483648
v_mfma_f32_32x32x16_bf16 v[72:87],v[52:55],v[220:223],v[72:87]
v_cmp_eq_u32 vcc,0,v3
s_cmp_lt_u32 s78,64
s_cselect_b32 s36,s36,2147483648
s_cmp_eq_u64 vcc,0
s_cselect_b32 s60,1,s36
s_waitcnt lgkmcnt(3)
v_mfma_f32_32x32x16_bf16 v[56:71],v[24:27],a[128:131],v[56:71]
ds_read_b128 v[44:47],v17 offset:36864
s_cmp_lt_u32 s79,64
s_cselect_b32 s60,s60,s36
s_sub_u32 s61,s78,s79
s_or_b32 s61,s61,s36
v_mfma_f32_32x32x16_bf16 v[72:87],v[24:27],v[224:227],v[72:87]
s_cmp_lt_u32 s61,16
s_cselect_b32 s36,0,s60
v_mov_b32 v23,s36
ds_write_b32 v13,v23
v_mfma_f32_32x32x16_bf16 v[56:71],v[28:31],a[132:135],v[56:71]
ds_read_b128 v[48:51],v16 offset:38912
v_mfma_f32_32x32x16_bf16 v[72:87],v[28:31],v[228:231],v[72:87]
s_waitcnt lgkmcnt(4)
v_mfma_f32_32x32x16_bf16 v[56:71],v[32:35],a[136:139],v[56:71]
ds_read_b128 v[52:55],v17 offset:38912
v_mfma_f32_32x32x16_bf16 v[72:87],v[32:35],v[232:235],v[72:87]
s_waitcnt lgkmcnt(2)
s_barrier
ds_read_b32 v23,v22
v_mfma_f32_32x32x16_bf16 v[56:71],v[36:39],a[140:143],v[56:71]
ds_read_b128 v[24:27],v18 offset:0
s_cmp_lt_u32 s50,2
s_cselect_b32 s42,1,0
s_or_b32 s42,s42,s37
s_mov_b32 s39,0
v_mfma_f32_32x32x16_bf16 v[72:87],v[36:39],v[236:239],v[72:87]
s_add_u32 s50,s50,1
s_sub_u32 s57,46080,s57
s_mov_b32 s51,s53
s_mov_b32 s52,s54
v_mfma_f32_32x32x16_bf16 v[56:71],v[40:43],a[144:147],v[56:71]
ds_read_b128 v[28:31],v19 offset:0
v_mfma_f32_32x32x16_bf16 v[72:87],v[40:43],v[240:243],v[72:87]
v_mfma_f32_32x32x16_bf16 v[56:71],v[44:47],a[148:151],v[56:71]
ds_read_b128 v[32:35],v18 offset:2048
s_waitcnt lgkmcnt(3)
v_readfirstlane_b32 s38,v23
s_and_b32 s37,s38,2147483648
v_mfma_f32_32x32x16_bf16 v[72:87],v[44:47],v[244:247],v[72:87]
s_and_b32 s33,s38,1
s_cselect_b32 s34,s79,s78
s_cmp_lg_u32 s42,0
v_mfma_f32_32x32x16_bf16 v[56:71],v[48:51],a[152:155],v[56:71]
ds_read_b128 v[36:39],v19 offset:2048
v_mfma_f32_32x32x16_bf16 v[72:87],v[48:51],v[248:251],v[72:87]
v_mfma_f32_32x32x16_bf16 v[56:71],v[52:55],a[156:159],v[56:71]
ds_read_b128 v[40:43],v18 offset:4096
v_mfma_f32_32x32x16_bf16 v[72:87],v[52:55],v[252:255],v[72:87]
s_cbranch_scc1 QKVV_S0
QKVV_B1:
s_waitcnt lgkmcnt(3)
v_mfma_f32_32x32x16_bf16 v[88:103],v[24:27],a[0:3],0
ds_read_b128 v[44:47],v19 offset:4096
v_add_u32 v189,s57,v188
v_mfma_f32_32x32x16_bf16 v[104:119],v[24:27],a[160:163],0
v_add_u32 v8,0x800,v189
s_sub_u32 s66,46080,s57
s_lshl_b32 s60,s33,6
s_add_u32 s60,s60,s34
s_mul_i32 s60,s60,46080
s_add_u32 s60,s60,s37
v_mfma_f32_32x32x16_bf16 v[88:103],v[28:31],a[4:7],v[88:103]
ds_read_b128 v[48:51],v18 offset:6144
ds_read2_b64 v[156:159],v189 offset0:0 offset1:32
s_add_u32 s60,s60,206569472
s_lshl_b32 s62,s46,10
v_mfma_f32_32x32x16_bf16 v[104:119],v[28:31],a[164:167],v[104:119]
ds_read2_b64 v[160:163],v189 offset0:64 offset1:96
s_add_u32 s62,s62,40960
s_add_u32 m0,s66,s62
s_add_u32 s63,s60,s62
s_waitcnt lgkmcnt(5)
v_mfma_f32_32x32x16_bf16 v[88:103],v[32:35],a[8:11],v[88:103]
ds_read_b128 v[52:55],v19 offset:6144
ds_read2_b64 v[164:167],v189 offset0:128 offset1:160
buffer_load_dwordx4 v1,s[8:11],s63 offen sc1 lds
v_mfma_f32_32x32x16_bf16 v[104:119],v[32:35],a[168:171],v[104:119]
ds_read2_b64 v[168:171],v189 offset0:192 offset1:224
s_add_u32 m0,s66,45056
s_add_u32 s63,s60,45056
s_mul_i32 s74,s73,393216
s_add_u32 s74,s74,s39
v_mfma_f32_32x32x16_bf16 v[88:103],v[36:39],a[12:15],v[88:103]
ds_read_b128 v[24:27],v18 offset:8192
ds_read2_b64 v[172:175],v8 offset0:0 offset1:32
s_add_u32 s74,s74,s70
v_fma_f32 v56,-v124,v120,v56
v_mfma_f32_32x32x16_bf16 v[104:119],v[36:39],a[172:175],v[104:119]
buffer_load_dwordx4 v1,s[8:11],s63 offen sc1 lds
s_mul_i32 s61,s46,10240
s_add_u32 s60,s60,s61
s_add_u32 s61,s61,s66
s_waitcnt lgkmcnt(8)
v_mfma_f32_32x32x16_bf16 v[88:103],v[40:43],a[16:19],v[88:103]
ds_read_b128 v[28:31],v19 offset:8192
s_add_u32 m0,s61,0
s_add_u32 s63,s60,0
v_fma_f32 v57,-v126,v120,v57
v_fma_f32 v58,-v128,v120,v58
v_mfma_f32_32x32x16_bf16 v[104:119],v[40:43],a[176:179],v[104:119]
v_fma_f32 v59,-v130,v120,v59
v_fma_f32 v64,-v140,v120,v64
v_fma_f32 v65,-v142,v120,v65
v_fma_f32 v66,-v144,v120,v66
v_fma_f32 v67,-v146,v120,v67
v_mfma_f32_32x32x16_bf16 v[88:103],v[44:47],a[20:23],v[88:103]
ds_read_b128 v[32:35],v18 offset:10240
buffer_load_dwordx4 v1,s[8:11],s63 offen sc1 lds
v_mul_f32 v56,v56,v125
v_mul_f32 v57,v57,v127
v_mfma_f32_32x32x16_bf16 v[104:119],v[44:47],a[180:183],v[104:119]
v_mul_f32 v58,v58,v129
v_mul_f32 v59,v59,v131
v_mul_f32 v64,v64,v141
v_mul_f32 v65,v65,v143
v_mul_f32 v66,v66,v145
s_waitcnt lgkmcnt(6)
v_mfma_f32_32x32x16_bf16 v[88:103],v[48:51],a[24:27],v[88:103]
ds_read_b128 v[36:39],v19 offset:10240
v_mul_f32 v67,v67,v147
v_cvt_pk_bf16_f32 v180,v56,v57
v_cvt_pk_bf16_f32 v181,v58,v59
v_cvt_pk_bf16_f32 v182,v64,v65
v_mfma_f32_32x32x16_bf16 v[104:119],v[48:51],a[184:187],v[104:119]
buffer_load_dwordx4 v1,s[8:11],s63 offen offset:1024 sc1 lds
v_cvt_pk_bf16_f32 v183,v66,v67
buffer_store_dwordx4 v[180:183],v20,s[8:11],s74 offen sc1
v_fma_f32 v60,-v132,v120,v60
v_mfma_f32_32x32x16_bf16 v[88:103],v[52:55],a[28:31],v[88:103]
ds_read_b128 v[40:43],v18 offset:12288
v_fma_f32 v61,-v134,v120,v61
v_fma_f32 v62,-v136,v120,v62
v_fma_f32 v63,-v138,v120,v63
v_fma_f32 v68,-v148,v120,v68
v_mfma_f32_32x32x16_bf16 v[104:119],v[52:55],a[188:191],v[104:119]
v_fma_f32 v69,-v150,v120,v69
v_fma_f32 v70,-v152,v120,v70
v_fma_f32 v71,-v154,v120,v71
v_mul_f32 v60,v60,v133
v_mul_f32 v61,v61,v135
s_waitcnt lgkmcnt(3)
v_mfma_f32_32x32x16_bf16 v[88:103],v[24:27],a[32:35],v[88:103]
ds_read_b128 v[44:47],v19 offset:12288
buffer_load_dwordx4 v1,s[8:11],s63 offen offset:2048 sc1 lds
v_mul_f32 v62,v62,v137
v_mul_f32 v63,v63,v139
v_mfma_f32_32x32x16_bf16 v[104:119],v[24:27],a[192:195],v[104:119]
v_mul_f32 v68,v68,v149
v_mul_f32 v69,v69,v151
v_mul_f32 v70,v70,v153
v_mul_f32 v71,v71,v155
v_cvt_pk_bf16_f32 v184,v60,v61
v_mfma_f32_32x32x16_bf16 v[88:103],v[28:31],a[36:39],v[88:103]
ds_read_b128 v[48:51],v18 offset:14336
v_cvt_pk_bf16_f32 v185,v62,v63
v_cvt_pk_bf16_f32 v186,v68,v69
v_cvt_pk_bf16_f32 v187,v70,v71
v_mfma_f32_32x32x16_bf16 v[104:119],v[28:31],a[196:199],v[104:119]
buffer_load_dwordx4 v1,s[8:11],s63 offen offset:3072 sc1 lds
s_add_u32 m0,s61,4096
s_add_u32 s63,s60,4096
s_waitcnt lgkmcnt(3)
v_mfma_f32_32x32x16_bf16 v[88:103],v[32:35],a[40:43],v[88:103]
ds_read_b128 v[52:55],v19 offset:14336
buffer_store_dwordx4 v[184:187],v21,s[8:11],s74 offen sc1
v_fma_f32 v72,-v124,v121,v72
v_fma_f32 v73,-v126,v121,v73
v_mfma_f32_32x32x16_bf16 v[104:119],v[32:35],a[200:203],v[104:119]
v_fma_f32 v74,-v128,v121,v74
v_fma_f32 v75,-v130,v121,v75
v_fma_f32 v80,-v140,v121,v80
v_fma_f32 v81,-v142,v121,v81
v_fma_f32 v82,-v144,v121,v82
v_mfma_f32_32x32x16_bf16 v[88:103],v[36:39],a[44:47],v[88:103]
ds_read_b128 v[24:27],v18 offset:16384
buffer_load_dwordx4 v1,s[8:11],s63 offen sc1 lds
v_fma_f32 v83,-v146,v121,v83
v_mul_f32 v72,v72,v125
v_mfma_f32_32x32x16_bf16 v[104:119],v[36:39],a[204:207],v[104:119]
v_mul_f32 v73,v73,v127
v_mul_f32 v74,v74,v129
v_mul_f32 v75,v75,v131
v_mul_f32 v80,v80,v141
v_mul_f32 v81,v81,v143
s_waitcnt lgkmcnt(3)
v_mfma_f32_32x32x16_bf16 v[88:103],v[40:43],a[48:51],v[88:103]
ds_read_b128 v[28:31],v19 offset:16384
v_mul_f32 v82,v82,v145
v_mul_f32 v83,v83,v147
v_cvt_pk_bf16_f32 v180,v72,v73
v_cvt_pk_bf16_f32 v181,v74,v75
v_mfma_f32_32x32x16_bf16 v[104:119],v[40:43],a[208:211],v[104:119]
buffer_load_dwordx4 v1,s[8:11],s63 offen offset:1024 sc1 lds
v_cvt_pk_bf16_f32 v182,v80,v81
v_cvt_pk_bf16_f32 v183,v82,v83
buffer_store_dwordx4 v[180:183],v20,s[8:11],s74 offen offset:2048 sc1
v_mfma_f32_32x32x16_bf16 v[88:103],v[44:47],a[52:55],v[88:103]
ds_read_b128 v[32:35],v18 offset:18432
v_fma_f32 v76,-v132,v121,v76
v_fma_f32 v77,-v134,v121,v77
v_fma_f32 v78,-v136,v121,v78
v_fma_f32 v79,-v138,v121,v79
v_mfma_f32_32x32x16_bf16 v[104:119],v[44:47],a[212:215],v[104:119]
v_fma_f32 v84,-v148,v121,v84
v_fma_f32 v85,-v150,v121,v85
v_fma_f32 v86,-v152,v121,v86
v_fma_f32 v87,-v154,v121,v87
v_mul_f32 v76,v76,v133
s_waitcnt lgkmcnt(3)
v_mfma_f32_32x32x16_bf16 v[88:103],v[48:51],a[56:59],v[88:103]
ds_read_b128 v[36:39],v19 offset:18432
buffer_load_dwordx4 v1,s[8:11],s63 offen offset:2048 sc1 lds
v_mul_f32 v77,v77,v135
v_mul_f32 v78,v78,v137
v_mfma_f32_32x32x16_bf16 v[104:119],v[48:51],a[216:219],v[104:119]
v_mul_f32 v79,v79,v139
v_mul_f32 v84,v84,v149
v_mul_f32 v85,v85,v151
v_mul_f32 v86,v86,v153
v_mul_f32 v87,v87,v155
v_mfma_f32_32x32x16_bf16 v[88:103],v[52:55],a[60:63],v[88:103]
ds_read_b128 v[40:43],v18 offset:20480
s_waitcnt vmcnt(12)
s_mov_b64 exec,1
buffer_store_dword v5,v1,s[8:11],s59 offen sc1
s_mov_b64 exec,-1
s_mov_b32 s59,2147483648
v_mfma_f32_32x32x16_bf16 v[104:119],v[52:55],a[220:223],v[104:119]
buffer_load_dwordx4 v1,s[8:11],s63 offen offset:3072 sc1 lds
s_add_u32 m0,s61,8192
s_add_u32 s63,s60,8192
v_cvt_pk_bf16_f32 v184,v76,v77
s_waitcnt lgkmcnt(3)
v_mfma_f32_32x32x16_bf16 v[88:103],v[24:27],a[64:67],v[88:103]
ds_read_b128 v[44:47],v19 offset:20480
v_cvt_pk_bf16_f32 v185,v78,v79
v_cvt_pk_bf16_f32 v186,v84,v85
v_cvt_pk_bf16_f32 v187,v86,v87
v_mfma_f32_32x32x16_bf16 v[104:119],v[24:27],a[224:227],v[104:119]
buffer_store_dwordx4 v[184:187],v21,s[8:11],s74 offen offset:2048 sc1
s_lshl_b32 s82,s72,6
s_add_u32 s82,s82,s73
s_lshl_b32 s82,s82,9
s_add_u32 s82,s82,s71
v_mfma_f32_32x32x16_bf16 v[88:103],v[28:31],a[68:71],v[88:103]
ds_read_b128 v[48:51],v18 offset:22528
buffer_load_dwordx4 v1,s[8:11],s63 offen sc1 lds
s_lshl_b32 s75,s69,2
s_add_u32 s82,s82,s75
v_mfma_f32_32x32x16_bf16 v[104:119],v[28:31],a[228:231],v[104:119]
s_add_u32 s82,s82,s39
v_add_f32 v156,v156,v166
v_add_f32 v157,v157,v167
v_add_f32 v158,v158,v168
s_waitcnt lgkmcnt(3)
v_mfma_f32_32x32x16_bf16 v[88:103],v[32:35],a[72:75],v[88:103]
ds_read_b128 v[52:55],v19 offset:22528
v_add_f32 v159,v159,v169
v_add_f32 v160,v160,v170
v_add_f32 v161,v161,v171
v_add_f32 v162,v162,v172
v_mfma_f32_32x32x16_bf16 v[104:119],v[32:35],a[232:235],v[104:119]
buffer_load_dwordx4 v1,s[8:11],s63 offen offset:1024 sc1 lds
s_mov_b32 s53,s33
s_mov_b32 s54,s34
s_add_u32 s79,s79,s33
s_or_b32 s60,s37,s33
v_mfma_f32_32x32x16_bf16 v[88:103],v[36:39],a[76:79],v[88:103]
ds_read_b128 v[24:27],v18 offset:24576
s_cmp_eq_u32 s60,0
s_addc_u32 s78,s78,0
s_lshl_b32 s41,s78,9
s_add_u32 s41,s41,s40
v_mfma_f32_32x32x16_bf16 v[104:119],v[36:39],a[236:239],v[104:119]
s_lshl_b32 s35,s79,9
s_add_u32 s35,s35,s40
s_add_u32 s35,s35,32768
v_add_f32 v163,v163,v173
v_add_f32 v164,v164,v174
s_waitcnt lgkmcnt(3)
v_mfma_f32_32x32x16_bf16 v[88:103],v[40:43],a[80:83],v[88:103]
ds_read_b128 v[28:31],v19 offset:24576
v_add_f32 v165,v165,v175
v_add_f32 v156,v156,v158
v_add_f32 v157,v157,v159
v_add_f32 v160,v160,v162
v_mfma_f32_32x32x16_bf16 v[104:119],v[40:43],a[240:243],v[104:119]
v_add_f32 v161,v161,v163
v_add_f32 v156,v156,v160
v_add_f32 v157,v157,v161
v_add_f32 v156,v156,v164
v_add_f32 v157,v157,v165
v_mfma_f32_32x32x16_bf16 v[88:103],v[44:47],a[84:87],v[88:103]
ds_read_b128 v[32:35],v18 offset:26624
v_mov_b32 v158,v156
v_mov_b32 v159,v157
s_nop 0
v_permlane32_swap_b32 v156,v158
v_permlane32_swap_b32 v157,v159
v_mfma_f32_32x32x16_bf16 v[104:119],v[44:47],a[244:247],v[104:119]
v_add_f32 v176,v156,v158
v_add_f32 v177,v157,v159
v_mul_f32 v176,0x3acccccd,v176
v_mul_f32 v177,0x3acccccd,v177
v_fma_f32 v177,-v176,v176,v177
s_waitcnt lgkmcnt(3)
v_mfma_f32_32x32x16_bf16 v[88:103],v[48:51],a[88:91],v[88:103]
ds_read_b128 v[36:39],v19 offset:26624
buffer_load_dword v3,v2,s[8:11],s35 offen sc1
buffer_load_dword v14,v4,s[8:11],s41 offen sc1
v_mfma_f32_32x32x16_bf16 v[104:119],v[48:51],a[248:251],v[104:119]
v_max_f32 v177,0,v177
v_cvt_pk_bf16_f32 v8,v176,v177
v_lshlrev_b32 v176,16,v8
v_and_b32 v177,0xffff0000,v8
v_add_f32 v177,0x3727c5ac,v177
v_mfma_f32_32x32x16_bf16 v[88:103],v[52:55],a[92:95],v[88:103]
ds_read_b128 v[40:43],v18 offset:28672
v_cvt_pk_bf16_f32 v8,v177,v177
v_lshlrev_b32 v177,16,v8
v_sqrt_f32 v177,v177
v_mfma_f32_32x32x16_bf16 v[104:119],v[52:55],a[252:255],v[104:119]
v_cvt_pk_bf16_f32 v8,v177,v177
v_lshlrev_b32 v177,16,v8
v_rcp_f32 v177,v177
s_waitcnt lgkmcnt(3)
v_mfma_f32_32x32x16_bf16 v[88:103],v[24:27],a[96:99],v[88:103]
ds_read_b128 v[44:47],v19 offset:28672
s_cmp_eq_u32 s51,0
s_cselect_b64 s[76:77],-1,0
v_cndmask_b32 v176,v176,0,s[76:77]
v_cndmask_b32 v177,v177,1.0,s[76:77]
v_mfma_f32_32x32x16_bf16 v[104:119],v[24:27],v[192:195],v[104:119]
s_mov_b32 s72,s51
s_mov_b32 s73,s52
ds_write_b64 v190,v[176:177]
ds_read_b128 v[124:127],v191 offset:0
v_mfma_f32_32x32x16_bf16 v[88:103],v[28:31],a[100:103],v[88:103]
ds_read_b128 v[48:51],v18 offset:30720
ds_read_b128 v[128:131],v191 offset:16
ds_read_b128 v[132:135],v191 offset:64
v_mfma_f32_32x32x16_bf16 v[104:119],v[28:31],v[196:199],v[104:119]
ds_read_b128 v[136:139],v191 offset:80
ds_read_b128 v[140:143],v191 offset:128
s_waitcnt lgkmcnt(9)
v_mfma_f32_32x32x16_bf16 v[88:103],v[32:35],a[104:107],v[88:103]
ds_read_b128 v[52:55],v19 offset:30720
ds_read_b128 v[144:147],v191 offset:144
ds_read_b128 v[148:151],v191 offset:192
v_mfma_f32_32x32x16_bf16 v[104:119],v[32:35],v[200:203],v[104:119]
ds_read_b128 v[152:155],v191 offset:208
v_mfma_f32_32x32x16_bf16 v[88:103],v[36:39],a[108:111],v[88:103]
ds_read_b128 v[24:27],v18 offset:32768
v_mfma_f32_32x32x16_bf16 v[104:119],v[36:39],v[204:207],v[104:119]
s_waitcnt lgkmcnt(12)
v_mfma_f32_32x32x16_bf16 v[88:103],v[40:43],a[112:115],v[88:103]
ds_read_b128 v[28:31],v19 offset:32768
v_mfma_f32_32x32x16_bf16 v[104:119],v[40:43],v[208:211],v[104:119]
v_mfma_f32_32x32x16_bf16 v[88:103],v[44:47],a[116:119],v[88:103]
ds_read_b128 v[32:35],v18 offset:34816
s_waitcnt vmcnt(4)
s_mov_b64 exec,1
buffer_store_dword v5,v1,s[8:11],s82 offen sc1
s_mov_b64 exec,-1
s_mov_b32 s82,2147483648
v_mfma_f32_32x32x16_bf16 v[104:119],v[44:47],v[212:215],v[104:119]
s_waitcnt lgkmcnt(6)
v_mfma_f32_32x32x16_bf16 v[88:103],v[48:51],a[120:123],v[88:103]
ds_read_b128 v[36:39],v19 offset:34816
v_mfma_f32_32x32x16_bf16 v[104:119],v[48:51],v[216:219],v[104:119]
v_mfma_f32_32x32x16_bf16 v[88:103],v[52:55],a[124:127],v[88:103]
ds_read_b128 v[40:43],v18 offset:36864
s_waitcnt vmcnt(1)
v_cmp_eq_u32 vcc,0,v14
s_cmp_eq_u64 vcc,0
s_cselect_b32 s36,0,2147483648
v_mfma_f32_32x32x16_bf16 v[104:119],v[52:55],v[220:223],v[104:119]
v_cmp_eq_u32 vcc,0,v3
s_cmp_lt_u32 s78,64
s_cselect_b32 s36,s36,2147483648
s_cmp_eq_u64 vcc,0
s_cselect_b32 s60,1,s36
s_waitcnt lgkmcnt(3)
v_mfma_f32_32x32x16_bf16 v[88:103],v[24:27],a[128:131],v[88:103]
ds_read_b128 v[44:47],v19 offset:36864
s_cmp_lt_u32 s79,64
s_cselect_b32 s60,s60,s36
s_sub_u32 s61,s78,s79
s_or_b32 s61,s61,s36
v_mfma_f32_32x32x16_bf16 v[104:119],v[24:27],v[224:227],v[104:119]
s_cmp_lt_u32 s61,16
s_cselect_b32 s36,0,s60
v_mov_b32 v23,s36
ds_write_b32 v13,v23
v_mfma_f32_32x32x16_bf16 v[88:103],v[28:31],a[132:135],v[88:103]
ds_read_b128 v[48:51],v18 offset:38912
v_mfma_f32_32x32x16_bf16 v[104:119],v[28:31],v[228:231],v[104:119]
s_waitcnt lgkmcnt(4)
v_mfma_f32_32x32x16_bf16 v[88:103],v[32:35],a[136:139],v[88:103]
ds_read_b128 v[52:55],v19 offset:38912
v_mfma_f32_32x32x16_bf16 v[104:119],v[32:35],v[232:235],v[104:119]
s_waitcnt lgkmcnt(2)
s_barrier
ds_read_b32 v23,v22
v_mfma_f32_32x32x16_bf16 v[88:103],v[36:39],a[140:143],v[88:103]
ds_read_b128 v[24:27],v16 offset:0
s_cmp_lt_u32 s50,2
s_cselect_b32 s42,1,0
s_or_b32 s42,s42,s37
s_mov_b32 s39,0
v_mfma_f32_32x32x16_bf16 v[104:119],v[36:39],v[236:239],v[104:119]
s_add_u32 s50,s50,1
s_sub_u32 s57,46080,s57
s_mov_b32 s51,s53
s_mov_b32 s52,s54
v_mfma_f32_32x32x16_bf16 v[88:103],v[40:43],a[144:147],v[88:103]
ds_read_b128 v[28:31],v17 offset:0
v_mfma_f32_32x32x16_bf16 v[104:119],v[40:43],v[240:243],v[104:119]
v_mfma_f32_32x32x16_bf16 v[88:103],v[44:47],a[148:151],v[88:103]
ds_read_b128 v[32:35],v16 offset:2048
s_waitcnt lgkmcnt(3)
v_readfirstlane_b32 s38,v23
s_and_b32 s37,s38,2147483648
v_mfma_f32_32x32x16_bf16 v[104:119],v[44:47],v[244:247],v[104:119]
s_and_b32 s33,s38,1
s_cselect_b32 s34,s79,s78
s_cmp_lg_u32 s42,0
v_mfma_f32_32x32x16_bf16 v[88:103],v[48:51],a[152:155],v[88:103]
ds_read_b128 v[36:39],v17 offset:2048
v_mfma_f32_32x32x16_bf16 v[104:119],v[48:51],v[248:251],v[104:119]
v_mfma_f32_32x32x16_bf16 v[88:103],v[52:55],a[156:159],v[88:103]
ds_read_b128 v[40:43],v16 offset:4096
v_mfma_f32_32x32x16_bf16 v[104:119],v[52:55],v[252:255],v[104:119]
s_cbranch_scc0 QKVV_B0
s_branch QKVV_S1
s_nop 9
QKVV_S0:
s_mov_b32 s55,0
s_cmp_lt_u32 s42,2
s_cbranch_scc1 nt_223
s_mov_b32 s55,2
s_cmp_lg_u32 s37,0
s_cbranch_scc1 nt_223
s_mov_b32 s55,1
s_lshl_b32 s60,s33,6
s_add_u32 s60,s60,s34
s_mul_i32 s60,s60,46080
s_add_u32 s60,s60,206569472
s_lshl_b32 s62,s46,10
s_add_u32 s62,s62,40960
s_add_u32 m0,s57,s62
s_add_u32 s63,s60,s62
buffer_load_dwordx4 v1,s[8:11],s63 offen sc1 lds
s_add_u32 m0,s57,45056
s_add_u32 s63,s60,45056
buffer_load_dwordx4 v1,s[8:11],s63 offen sc1 lds
s_mul_i32 s61,s46,10240
s_add_u32 s60,s60,s61
s_add_u32 s61,s61,s57
s_add_u32 m0,s61,0
s_add_u32 s63,s60,0
buffer_load_dwordx4 v1,s[8:11],s63 offen sc1 lds
buffer_load_dwordx4 v1,s[8:11],s63 offen offset:1024 sc1 lds
buffer_load_dwordx4 v1,s[8:11],s63 offen offset:2048 sc1 lds
buffer_load_dwordx4 v1,s[8:11],s63 offen offset:3072 sc1 lds
s_add_u32 m0,s61,4096
s_add_u32 s63,s60,4096
buffer_load_dwordx4 v1,s[8:11],s63 offen sc1 lds
buffer_load_dwordx4 v1,s[8:11],s63 offen offset:1024 sc1 lds
buffer_load_dwordx4 v1,s[8:11],s63 offen offset:2048 sc1 lds
buffer_load_dwordx4 v1,s[8:11],s63 offen offset:3072 sc1 lds
s_add_u32 m0,s61,8192
s_add_u32 s63,s60,8192
buffer_load_dwordx4 v1,s[8:11],s63 offen sc1 lds
buffer_load_dwordx4 v1,s[8:11],s63 offen offset:1024 sc1 lds
nt_223:
s_nop 4
s_mul_i32 s74,s73,393216
s_add_u32 s74,s74,s39
s_add_u32 s74,s74,s70
v_fma_f32 v56,-v124,v120,v56
v_fma_f32 v57,-v126,v120,v57
v_fma_f32 v58,-v128,v120,v58
v_fma_f32 v59,-v130,v120,v59
v_fma_f32 v64,-v140,v120,v64
v_fma_f32 v65,-v142,v120,v65
v_fma_f32 v66,-v144,v120,v66
v_fma_f32 v67,-v146,v120,v67
v_mul_f32 v56,v56,v125
v_mul_f32 v57,v57,v127
v_mul_f32 v58,v58,v129
v_mul_f32 v59,v59,v131
v_mul_f32 v64,v64,v141
v_mul_f32 v65,v65,v143
v_mul_f32 v66,v66,v145
v_mul_f32 v67,v67,v147
v_cvt_pk_bf16_f32 v180,v56,v57
v_cvt_pk_bf16_f32 v181,v58,v59
v_cvt_pk_bf16_f32 v182,v64,v65
v_cvt_pk_bf16_f32 v183,v66,v67
buffer_store_dwordx4 v[180:183],v20,s[8:11],s74 offen sc1
v_fma_f32 v60,-v132,v120,v60
v_fma_f32 v61,-v134,v120,v61
v_fma_f32 v62,-v136,v120,v62
v_fma_f32 v63,-v138,v120,v63
v_fma_f32 v68,-v148,v120,v68
v_fma_f32 v69,-v150,v120,v69
v_fma_f32 v70,-v152,v120,v70
v_fma_f32 v71,-v154,v120,v71
v_mul_f32 v60,v60,v133
v_mul_f32 v61,v61,v135
v_mul_f32 v62,v62,v137
v_mul_f32 v63,v63,v139
v_mul_f32 v68,v68,v149
v_mul_f32 v69,v69,v151
v_mul_f32 v70,v70,v153
v_mul_f32 v71,v71,v155
v_cvt_pk_bf16_f32 v184,v60,v61
v_cvt_pk_bf16_f32 v185,v62,v63
v_cvt_pk_bf16_f32 v186,v68,v69
v_cvt_pk_bf16_f32 v187,v70,v71
buffer_store_dwordx4 v[184:187],v21,s[8:11],s74 offen sc1
v_fma_f32 v72,-v124,v121,v72
v_fma_f32 v73,-v126,v121,v73
v_fma_f32 v74,-v128,v121,v74
v_fma_f32 v75,-v130,v121,v75
v_fma_f32 v80,-v140,v121,v80
v_fma_f32 v81,-v142,v121,v81
v_fma_f32 v82,-v144,v121,v82
v_fma_f32 v83,-v146,v121,v83
v_mul_f32 v72,v72,v125
v_mul_f32 v73,v73,v127
v_mul_f32 v74,v74,v129
v_mul_f32 v75,v75,v131
v_mul_f32 v80,v80,v141
v_mul_f32 v81,v81,v143
v_mul_f32 v82,v82,v145
v_mul_f32 v83,v83,v147
v_cvt_pk_bf16_f32 v180,v72,v73
v_cvt_pk_bf16_f32 v181,v74,v75
v_cvt_pk_bf16_f32 v182,v80,v81
v_cvt_pk_bf16_f32 v183,v82,v83
buffer_store_dwordx4 v[180:183],v20,s[8:11],s74 offen offset:2048 sc1
v_fma_f32 v76,-v132,v121,v76
v_fma_f32 v77,-v134,v121,v77
v_fma_f32 v78,-v136,v121,v78
v_fma_f32 v79,-v138,v121,v79
v_fma_f32 v84,-v148,v121,v84
v_fma_f32 v85,-v150,v121,v85
v_fma_f32 v86,-v152,v121,v86
v_fma_f32 v87,-v154,v121,v87
v_mul_f32 v76,v76,v133
v_mul_f32 v77,v77,v135
v_mul_f32 v78,v78,v137
v_mul_f32 v79,v79,v139
v_mul_f32 v84,v84,v149
v_mul_f32 v85,v85,v151
v_mul_f32 v86,v86,v153
v_mul_f32 v87,v87,v155
v_cvt_pk_bf16_f32 v184,v76,v77
v_cvt_pk_bf16_f32 v185,v78,v79
v_cvt_pk_bf16_f32 v186,v84,v85
v_cvt_pk_bf16_f32 v187,v86,v87
buffer_store_dwordx4 v[184:187],v21,s[8:11],s74 offen offset:2048 sc1
s_lshl_b32 s82,s72,6
s_add_u32 s82,s82,s73
s_lshl_b32 s82,s82,9
s_add_u32 s82,s82,s71
s_lshl_b32 s75,s69,2
s_add_u32 s82,s82,s75
s_add_u32 s82,s82,s39
s_mov_b32 s59,s82
s_mov_b32 s82,2147483648
s_mov_b32 s39,2147483648
s_cmp_eq_u32 s55,0
s_cbranch_scc1 QKVV_B1
s_cmp_eq_u32 s55,1
s_cbranch_scc1 QKVV_CD1
s_waitcnt vmcnt(0)
s_mov_b64 exec,1
buffer_store_dword v5,v1,s[8:11],s59 offen sc1
s_mov_b64 exec,-1
s_mov_b32 s59,2147483648
s_cmp_eq_u32 s50,128
s_cbranch_scc1 QKVV_END
s_branch QKVV_COLD1
QKVV_COLD0:
s_cmp_lg_u32 s46,0
s_cbranch_scc1 cp_224
ct_225:
buffer_load_dword v3,v2,s[8:11],s35 offen sc1
buffer_load_dword v14,v4,s[8:11],s41 offen sc1
s_waitcnt vmcnt(0)
v_cmp_eq_u32 vcc,0,v14
s_cmp_eq_u64 vcc,0
s_cselect_b32 s36,0,2147483648
v_cmp_eq_u32 vcc,0,v3
s_cmp_lt_u32 s78,64
s_cselect_b32 s36,s36,2147483648
s_cmp_eq_u64 vcc,0
s_cselect_b32 s60,1,s36
s_cmp_lt_u32 s79,64
s_cselect_b32 s60,s60,s36
s_sub_u32 s61,s78,s79
s_or_b32 s61,s61,s36
s_cmp_lt_u32 s61,16
s_cselect_b32 s36,0,s60
v_mov_b32 v23,s36
s_cmp_lt_u32 s36,2
s_cbranch_scc1 ct_225x
s_sleep 3
s_sub_u32 s47,s47,1
s_cbranch_scc1 ABORT
s_branch ct_225
ct_225x:
ds_write_b32 v22,v23 offset:4
s_waitcnt lgkmcnt(0)
cp_224:
s_barrier
ds_read_b32 v23,v22 offset:4
s_waitcnt lgkmcnt(0)
v_readfirstlane_b32 s38,v23
s_and_b32 s38,s38,1
s_and_b32 s37,s38,2147483648
s_and_b32 s33,s38,1
s_cselect_b32 s34,s79,s78
s_lshl_b32 s60,s33,6
s_add_u32 s60,s60,s34
s_mul_i32 s60,s60,46080
s_add_u32 s60,s60,206569472
s_lshl_b32 s62,s46,10
s_add_u32 s62,s62,40960
s_add_u32 m0,s57,s62
s_add_u32 s63,s60,s62
buffer_load_dwordx4 v1,s[8:11],s63 offen sc1 lds
s_add_u32 m0,s57,45056
s_add_u32 s63,s60,45056
buffer_load_dwordx4 v1,s[8:11],s63 offen sc1 lds
s_mul_i32 s61,s46,10240
s_add_u32 s60,s60,s61
s_add_u32 s61,s61,s57
s_add_u32 m0,s61,0
s_add_u32 s63,s60,0
buffer_load_dwordx4 v1,s[8:11],s63 offen sc1 lds
buffer_load_dwordx4 v1,s[8:11],s63 offen offset:1024 sc1 lds
buffer_load_dwordx4 v1,s[8:11],s63 offen offset:2048 sc1 lds
buffer_load_dwordx4 v1,s[8:11],s63 offen offset:3072 sc1 lds
s_add_u32 m0,s61,4096
s_add_u32 s63,s60,4096
buffer_load_dwordx4 v1,s[8:11],s63 offen sc1 lds
buffer_load_dwordx4 v1,s[8:11],s63 offen offset:1024 sc1 lds
buffer_load_dwordx4 v1,s[8:11],s63 offen offset:2048 sc1 lds
buffer_load_dwordx4 v1,s[8:11],s63 offen offset:3072 sc1 lds
s_add_u32 m0,s61,8192
s_add_u32 s63,s60,8192
buffer_load_dwordx4 v1,s[8:11],s63 offen sc1 lds
buffer_load_dwordx4 v1,s[8:11],s63 offen offset:1024 sc1 lds
QKVV_CD0:
s_mov_b32 s51,s33
s_mov_b32 s52,s34
s_mov_b32 s53,s33
s_mov_b32 s54,s34
s_add_u32 s79,s79,s33
s_or_b32 s60,s37,s33
s_cmp_eq_u32 s60,0
s_addc_u32 s78,s78,0
s_lshl_b32 s41,s78,9
s_add_u32 s41,s41,s40
s_lshl_b32 s35,s79,9
s_add_u32 s35,s35,s40
s_add_u32 s35,s35,32768
buffer_load_dword v3,v2,s[8:11],s35 offen sc1
buffer_load_dword v14,v4,s[8:11],s41 offen sc1
s_waitcnt vmcnt(0)
s_mov_b64 exec,1
buffer_store_dword v5,v1,s[8:11],s59 offen sc1
s_mov_b64 exec,-1
s_mov_b32 s59,2147483648
v_cmp_eq_u32 vcc,0,v14
s_cmp_eq_u64 vcc,0
s_cselect_b32 s36,0,2147483648
v_cmp_eq_u32 vcc,0,v3
s_cmp_lt_u32 s78,64
s_cselect_b32 s36,s36,2147483648
s_cmp_eq_u64 vcc,0
s_cselect_b32 s60,1,s36
s_cmp_lt_u32 s79,64
s_cselect_b32 s60,s60,s36
s_sub_u32 s61,s78,s79
s_or_b32 s61,s61,s36
s_cmp_lt_u32 s61,16
s_cselect_b32 s36,0,s60
v_mov_b32 v23,s36
ds_write_b32 v13,v23
s_waitcnt lgkmcnt(0)
s_barrier
ds_read_b32 v23,v22
ds_read_b128 v[24:27],v16 offset:0
ds_read_b128 v[28:31],v17 offset:0
ds_read_b128 v[32:35],v16 offset:2048
ds_read_b128 v[36:39],v17 offset:2048
ds_read_b128 v[40:43],v16 offset:4096
s_waitcnt lgkmcnt(5)
v_readfirstlane_b32 s38,v23
s_and_b32 s37,s38,2147483648
s_and_b32 s33,s38,1
s_cselect_b32 s34,s79,s78
s_nop 0
s_branch QKVV_B0
QKVV_S1:
s_mov_b32 s55,0
s_cmp_lt_u32 s42,2
s_cbranch_scc1 nt_226
s_mov_b32 s55,2
s_cmp_lg_u32 s37,0
s_cbranch_scc1 nt_226
s_mov_b32 s55,1
s_lshl_b32 s60,s33,6
s_add_u32 s60,s60,s34
s_mul_i32 s60,s60,46080
s_add_u32 s60,s60,206569472
s_lshl_b32 s62,s46,10
s_add_u32 s62,s62,40960
s_add_u32 m0,s57,s62
s_add_u32 s63,s60,s62
buffer_load_dwordx4 v1,s[8:11],s63 offen sc1 lds
s_add_u32 m0,s57,45056
s_add_u32 s63,s60,45056
buffer_load_dwordx4 v1,s[8:11],s63 offen sc1 lds
s_mul_i32 s61,s46,10240
s_add_u32 s60,s60,s61
s_add_u32 s61,s61,s57
s_add_u32 m0,s61,0
s_add_u32 s63,s60,0
buffer_load_dwordx4 v1,s[8:11],s63 offen sc1 lds
buffer_load_dwordx4 v1,s[8:11],s63 offen offset:1024 sc1 lds
buffer_load_dwordx4 v1,s[8:11],s63 offen offset:2048 sc1 lds
buffer_load_dwordx4 v1,s[8:11],s63 offen offset:3072 sc1 lds
s_add_u32 m0,s61,4096
s_add_u32 s63,s60,4096
buffer_load_dwordx4 v1,s[8:11],s63 offen sc1 lds
buffer_load_dwordx4 v1,s[8:11],s63 offen offset:1024 sc1 lds
buffer_load_dwordx4 v1,s[8:11],s63 offen offset:2048 sc1 lds
buffer_load_dwordx4 v1,s[8:11],s63 offen offset:3072 sc1 lds
s_add_u32 m0,s61,8192
s_add_u32 s63,s60,8192
buffer_load_dwordx4 v1,s[8:11],s63 offen sc1 lds
buffer_load_dwordx4 v1,s[8:11],s63 offen offset:1024 sc1 lds
nt_226:
s_nop 4
s_mul_i32 s74,s73,393216
s_add_u32 s74,s74,s39
s_add_u32 s74,s74,s70
v_fma_f32 v88,-v124,v120,v88
v_fma_f32 v89,-v126,v120,v89
v_fma_f32 v90,-v128,v120,v90
v_fma_f32 v91,-v130,v120,v91
v_fma_f32 v96,-v140,v120,v96
v_fma_f32 v97,-v142,v120,v97
v_fma_f32 v98,-v144,v120,v98
v_fma_f32 v99,-v146,v120,v99
v_mul_f32 v88,v88,v125
v_mul_f32 v89,v89,v127
v_mul_f32 v90,v90,v129
v_mul_f32 v91,v91,v131
v_mul_f32 v96,v96,v141
v_mul_f32 v97,v97,v143
v_mul_f32 v98,v98,v145
v_mul_f32 v99,v99,v147
v_cvt_pk_bf16_f32 v180,v88,v89
v_cvt_pk_bf16_f32 v181,v90,v91
v_cvt_pk_bf16_f32 v182,v96,v97
v_cvt_pk_bf16_f32 v183,v98,v99
buffer_store_dwordx4 v[180:183],v20,s[8:11],s74 offen sc1
v_fma_f32 v92,-v132,v120,v92
v_fma_f32 v93,-v134,v120,v93
v_fma_f32 v94,-v136,v120,v94
v_fma_f32 v95,-v138,v120,v95
v_fma_f32 v100,-v148,v120,v100
v_fma_f32 v101,-v150,v120,v101
v_fma_f32 v102,-v152,v120,v102
v_fma_f32 v103,-v154,v120,v103
v_mul_f32 v92,v92,v133
v_mul_f32 v93,v93,v135
v_mul_f32 v94,v94,v137
v_mul_f32 v95,v95,v139
v_mul_f32 v100,v100,v149
v_mul_f32 v101,v101,v151
v_mul_f32 v102,v102,v153
v_mul_f32 v103,v103,v155
v_cvt_pk_bf16_f32 v184,v92,v93
v_cvt_pk_bf16_f32 v185,v94,v95
v_cvt_pk_bf16_f32 v186,v100,v101
v_cvt_pk_bf16_f32 v187,v102,v103
buffer_store_dwordx4 v[184:187],v21,s[8:11],s74 offen sc1
v_fma_f32 v104,-v124,v121,v104
v_fma_f32 v105,-v126,v121,v105
v_fma_f32 v106,-v128,v121,v106
v_fma_f32 v107,-v130,v121,v107
v_fma_f32 v112,-v140,v121,v112
v_fma_f32 v113,-v142,v121,v113
v_fma_f32 v114,-v144,v121,v114
v_fma_f32 v115,-v146,v121,v115
v_mul_f32 v104,v104,v125
v_mul_f32 v105,v105,v127
v_mul_f32 v106,v106,v129
v_mul_f32 v107,v107,v131
v_mul_f32 v112,v112,v141
v_mul_f32 v113,v113,v143
v_mul_f32 v114,v114,v145
v_mul_f32 v115,v115,v147
v_cvt_pk_bf16_f32 v180,v104,v105
v_cvt_pk_bf16_f32 v181,v106,v107
v_cvt_pk_bf16_f32 v182,v112,v113
v_cvt_pk_bf16_f32 v183,v114,v115
buffer_store_dwordx4 v[180:183],v20,s[8:11],s74 offen offset:2048 sc1
v_fma_f32 v108,-v132,v121,v108
v_fma_f32 v109,-v134,v121,v109
v_fma_f32 v110,-v136,v121,v110
v_fma_f32 v111,-v138,v121,v111
v_fma_f32 v116,-v148,v121,v116
v_fma_f32 v117,-v150,v121,v117
v_fma_f32 v118,-v152,v121,v118
v_fma_f32 v119,-v154,v121,v119
v_mul_f32 v108,v108,v133
v_mul_f32 v109,v109,v135
v_mul_f32 v110,v110,v137
v_mul_f32 v111,v111,v139
v_mul_f32 v116,v116,v149
v_mul_f32 v117,v117,v151
v_mul_f32 v118,v118,v153
v_mul_f32 v119,v119,v155
v_cvt_pk_bf16_f32 v184,v108,v109
v_cvt_pk_bf16_f32 v185,v110,v111
v_cvt_pk_bf16_f32 v186,v116,v117
v_cvt_pk_bf16_f32 v187,v118,v119
buffer_store_dwordx4 v[184:187],v21,s[8:11],s74 offen offset:2048 sc1
s_lshl_b32 s82,s72,6
s_add_u32 s82,s82,s73
s_lshl_b32 s82,s82,9
s_add_u32 s82,s82,s71
s_lshl_b32 s75,s69,2
s_add_u32 s82,s82,s75
s_add_u32 s82,s82,s39
s_mov_b32 s59,s82
s_mov_b32 s82,2147483648
s_mov_b32 s39,2147483648
s_cmp_eq_u32 s55,0
s_cbranch_scc1 QKVV_B0
s_cmp_eq_u32 s55,1
s_cbranch_scc1 QKVV_CD0
s_waitcnt vmcnt(0)
s_mov_b64 exec,1
buffer_store_dword v5,v1,s[8:11],s59 offen sc1
s_mov_b64 exec,-1
s_mov_b32 s59,2147483648
s_cmp_eq_u32 s50,128
s_cbranch_scc1 QKVV_END
s_branch QKVV_COLD0
QKVV_COLD1:
s_cmp_lg_u32 s46,0
s_cbranch_scc1 cp_227
ct_228:
buffer_load_dword v3,v2,s[8:11],s35 offen sc1
buffer_load_dword v14,v4,s[8:11],s41 offen sc1
s_waitcnt vmcnt(0)
v_cmp_eq_u32 vcc,0,v14
s_cmp_eq_u64 vcc,0
s_cselect_b32 s36,0,2147483648
v_cmp_eq_u32 vcc,0,v3
s_cmp_lt_u32 s78,64
s_cselect_b32 s36,s36,2147483648
s_cmp_eq_u64 vcc,0
s_cselect_b32 s60,1,s36
s_cmp_lt_u32 s79,64
s_cselect_b32 s60,s60,s36
s_sub_u32 s61,s78,s79
s_or_b32 s61,s61,s36
s_cmp_lt_u32 s61,16
s_cselect_b32 s36,0,s60
v_mov_b32 v23,s36
s_cmp_lt_u32 s36,2
s_cbranch_scc1 ct_228x
s_sleep 3
s_sub_u32 s47,s47,1
s_cbranch_scc1 ABORT
s_branch ct_228
ct_228x:
ds_write_b32 v22,v23 offset:4
s_waitcnt lgkmcnt(0)
cp_227:
s_barrier
ds_read_b32 v23,v22 offset:4
s_waitcnt lgkmcnt(0)
v_readfirstlane_b32 s38,v23
s_and_b32 s38,s38,1
s_and_b32 s37,s38,2147483648
s_and_b32 s33,s38,1
s_cselect_b32 s34,s79,s78
s_lshl_b32 s60,s33,6
s_add_u32 s60,s60,s34
s_mul_i32 s60,s60,46080
s_add_u32 s60,s60,206569472
s_lshl_b32 s62,s46,10
s_add_u32 s62,s62,40960
s_add_u32 m0,s57,s62
s_add_u32 s63,s60,s62
buffer_load_dwordx4 v1,s[8:11],s63 offen sc1 lds
s_add_u32 m0,s57,45056
s_add_u32 s63,s60,45056
buffer_load_dwordx4 v1,s[8:11],s63 offen sc1 lds
s_mul_i32 s61,s46,10240
s_add_u32 s60,s60,s61
s_add_u32 s61,s61,s57
s_add_u32 m0,s61,0
s_add_u32 s63,s60,0
buffer_load_dwordx4 v1,s[8:11],s63 offen sc1 lds
buffer_load_dwordx4 v1,s[8:11],s63 offen offset:1024 sc1 lds
buffer_load_dwordx4 v1,s[8:11],s63 offen offset:2048 sc1 lds
buffer_load_dwordx4 v1,s[8:11],s63 offen offset:3072 sc1 lds
s_add_u32 m0,s61,4096
s_add_u32 s63,s60,4096
buffer_load_dwordx4 v1,s[8:11],s63 offen sc1 lds
buffer_load_dwordx4 v1,s[8:11],s63 offen offset:1024 sc1 lds
buffer_load_dwordx4 v1,s[8:11],s63 offen offset:2048 sc1 lds
buffer_load_dwordx4 v1,s[8:11],s63 offen offset:3072 sc1 lds
s_add_u32 m0,s61,8192
s_add_u32 s63,s60,8192
buffer_load_dwordx4 v1,s[8:11],s63 offen sc1 lds
buffer_load_dwordx4 v1,s[8:11],s63 offen offset:1024 sc1 lds
QKVV_CD1:
s_mov_b32 s51,s33
s_mov_b32 s52,s34
s_mov_b32 s53,s33
s_mov_b32 s54,s34
s_add_u32 s79,s79,s33
s_or_b32 s60,s37,s33
s_cmp_eq_u32 s60,0
s_addc_u32 s78,s78,0
s_lshl_b32 s41,s78,9
s_add_u32 s41,s41,s40
s_lshl_b32 s35,s79,9
s_add_u32 s35,s35,s40
s_add_u32 s35,s35,32768
buffer_load_dword v3,v2,s[8:11],s35 offen sc1
buffer_load_dword v14,v4,s[8:11],s41 offen sc1
s_waitcnt vmcnt(0)
s_mov_b64 exec,1
buffer_store_dword v5,v1,s[8:11],s59 offen sc1
s_mov_b64 exec,-1
s_mov_b32 s59,2147483648
v_cmp_eq_u32 vcc,0,v14
s_cmp_eq_u64 vcc,0
s_cselect_b32 s36,0,2147483648
v_cmp_eq_u32 vcc,0,v3
s_cmp_lt_u32 s78,64
s_cselect_b32 s36,s36,2147483648
s_cmp_eq_u64 vcc,0
s_cselect_b32 s60,1,s36
s_cmp_lt_u32 s79,64
s_cselect_b32 s60,s60,s36
s_sub_u32 s61,s78,s79
s_or_b32 s61,s61,s36
s_cmp_lt_u32 s61,16
s_cselect_b32 s36,0,s60
v_mov_b32 v23,s36
ds_write_b32 v13,v23
s_waitcnt lgkmcnt(0)
s_barrier
ds_read_b32 v23,v22
ds_read_b128 v[24:27],v18 offset:0
ds_read_b128 v[28:31],v19 offset:0
ds_read_b128 v[32:35],v18 offset:2048
ds_read_b128 v[36:39],v19 offset:2048
ds_read_b128 v[40:43],v18 offset:4096
s_waitcnt lgkmcnt(5)
v_readfirstlane_b32 s38,v23
s_and_b32 s37,s38,2147483648
s_and_b32 s33,s38,1
s_cselect_b32 s34,s79,s78
s_nop 0
s_branch QKVV_B1
QKVV_END:
s_endpgm
ROLE_ATT:
v_lshlrev_b32 v1,4,v0
v_mov_b32 v5,1
s_lshl_b32 s56,s48,2
s_add_u32 s56,s56,s46
v_bfe_u32 v6,v0,2,2
v_lshrrev_b32 v7,4,v0
v_add_u32 v7,v6,v7
v_and_b32 v7,3,v7
v_and_b32 v15,3,v0
v_lshlrev_b32 v15,4,v15
v_lshl_add_u32 v15,v7,6,v15
v_lshl_add_u32 v15,v6,8,v15
s_mov_b32 s68,s48
s_and_b32 s51,s46,1
s_lshr_b32 s86,s46,1
s_lshr_b32 s87,s68,3
s_lshl_b32 s87,s87,5
s_and_b32 s60,s68,7
s_add_u32 s87,s87,s60
v_lshlrev_b32 v229,3,v0
v_and_b32 v229,0x300,v1
v_add_u32 v229,v229,v1
v_mov_b32 v230,0xff800000
s_mov_b32 s80,-1
s_mov_b32 s81,0
s_mov_b32 s84,0x3d93cd3a
s_mov_b32 s85,0x3fb8aa3b
v_min_u32 v6,8,v0
v_mul_u32_u24 v7,86,v6
v_lshrrev_b32 v7,8,v7
v_mul_u32_u24 v8,3,v7
v_sub_u32 v6,v6,v8
s_mul_i32 s60,s68,3
v_add_u32 v6,s60,v6
v_lshlrev_b32 v2,2,v6
v_lshl_add_u32 v2,v7,16,v2
v_min_u32 v228,2,v0
v_lshlrev_b32 v228,2,v228
v_lshrrev_b32 v6,4,v0
v_lshlrev_b32 v6,2,v6
v_and_b32 v7,15,v0
v_add_u32 v8,0,v6
v_cmp_le_u32 s[72:73],v8,v7
v_add_u32 v8,1,v6
v_cmp_le_u32 s[74:75],v8,v7
v_add_u32 v8,2,v6
v_cmp_le_u32 s[76:77],v8,v7
v_add_u32 v8,3,v6
v_cmp_le_u32 s[78:79],v8,v7
s_mul_i32 s71,s68,12288
s_mul_i32 s60,s51,13
s_mul_i32 s69,s60,589824
s_mul_i32 s61,s68,18432
s_add_u32 s69,s69,s61
s_mul_i32 s61,s51,9216
s_add_u32 s69,s69,s61
s_add_u32 s69,s69,24120320
s_mul_i32 s70,s60,2048
s_lshl_b32 s61,s68,6
s_add_u32 s70,s70,s61
s_add_u32 s70,s70,688128
s_mul_i32 s69,s51,12582912
s_mul_i32 s61,s68,6144
s_add_u32 s69,s69,s61
s_add_u32 s69,s69,24117248
s_mul_i32 s70,s51,65536
s_lshl_b32 s61,s68,5
s_add_u32 s70,s70,s61
s_add_u32 s70,s70,688128
s_waitcnt vmcnt(0)
s_barrier
s_cmp_lg_u32 s46,0
s_cbranch_scc1 arr_229
v_mov_b32 v6,1
s_lshl_b32 s3,s49,2
v_mov_b32 v7,s3
s_mov_b64 exec,1
buffer_atomic_add v6,v7,s[12:15],0 offen sc1
s_mov_b64 exec,-1
arr_229:
s_mov_b32 s66,s56
s_and_b32 s53,s66,7
s_lshr_b32 s54,s66,3
v_lshrrev_b32 v6,4,v0
v_bfe_u32 v7,v0,2,2
v_and_b32 v8,3,v0
s_and_b32 s61,s53,3
s_lshl_b32 s60,s53,8
v_lshlrev_b32 v132,11,v6
v_lshrrev_b32 v9,1,v6
v_lshlrev_b32 v132,11,v9
v_and_b32 v9,1,v6
v_lshl_add_u32 v132,v9,12,v132
v_add_u32 v9,s61,v7
v_and_b32 v9,3,v9
v_lshl_add_u32 v132,v9,6,v132
v_lshl_add_u32 v132,v8,4,v132
v_add_u32 v132,s60,v132
s_lshl_b32 s60,s53,2
v_add_u32 v9,s60,v8
v_mul_u32_u24 v133,1280,v9
v_lshl_add_u32 v133,v6,5,v133
v_lshl_add_u32 v133,v7,3,v133
s_mov_b32 s4,s16
s_mov_b32 s5,s17
s_mov_b32 s6,2621440
s_mov_b32 s7,0x20000
s_mov_b32 s55,0
s_mul_i32 s62,s54,40960
buffer_load_dwordx2 v[32:33],v133,s[4:7],s62 offen offset:0
buffer_load_dwordx2 v[34:35],v133,s[4:7],s62 offen offset:128
buffer_load_dwordx2 v[36:37],v133,s[4:7],s62 offen offset:256
buffer_load_dwordx2 v[38:39],v133,s[4:7],s62 offen offset:384
buffer_load_dwordx2 v[40:41],v133,s[4:7],s62 offen offset:512
buffer_load_dwordx2 v[42:43],v133,s[4:7],s62 offen offset:640
buffer_load_dwordx2 v[44:45],v133,s[4:7],s62 offen offset:768
buffer_load_dwordx2 v[46:47],v133,s[4:7],s62 offen offset:896
buffer_load_dwordx2 v[48:49],v133,s[4:7],s62 offen offset:1024
buffer_load_dwordx2 v[50:51],v133,s[4:7],s62 offen offset:1152
s_add_u32 s66,s54,16
s_min_u32 s66,s66,63
s_mul_i32 s62,s66,40960
buffer_load_dwordx2 v[52:53],v133,s[4:7],s62 offen offset:0
buffer_load_dwordx2 v[54:55],v133,s[4:7],s62 offen offset:128
buffer_load_dwordx2 v[56:57],v133,s[4:7],s62 offen offset:256
buffer_load_dwordx2 v[58:59],v133,s[4:7],s62 offen offset:384
buffer_load_dwordx2 v[60:61],v133,s[4:7],s62 offen offset:512
buffer_load_dwordx2 v[62:63],v133,s[4:7],s62 offen offset:640
buffer_load_dwordx2 v[64:65],v133,s[4:7],s62 offen offset:768
buffer_load_dwordx2 v[66:67],v133,s[4:7],s62 offen offset:896
buffer_load_dwordx2 v[68:69],v133,s[4:7],s62 offen offset:1024
buffer_load_dwordx2 v[70:71],v133,s[4:7],s62 offen offset:1152
s_mul_i32 s64,s54,40960
s_add_u32 s64,s64,234749952
s_mul_i32 s65,s54,46080
s_add_u32 s65,s65,206569472
s_waitcnt vmcnt(10)
v_lshlrev_b32 v72,16,v32
v_and_b32 v73,0xffff0000,v32
v_lshlrev_b32 v74,16,v33
v_and_b32 v75,0xffff0000,v33
v_lshlrev_b32 v76,16,v34
v_and_b32 v77,0xffff0000,v34
v_lshlrev_b32 v78,16,v35
v_and_b32 v79,0xffff0000,v35
v_lshlrev_b32 v80,16,v36
v_and_b32 v81,0xffff0000,v36
v_lshlrev_b32 v82,16,v37
v_and_b32 v83,0xffff0000,v37
v_lshlrev_b32 v84,16,v38
v_and_b32 v85,0xffff0000,v38
v_lshlrev_b32 v86,16,v39
v_and_b32 v87,0xffff0000,v39
v_lshlrev_b32 v88,16,v40
v_and_b32 v89,0xffff0000,v40
v_lshlrev_b32 v90,16,v41
v_and_b32 v91,0xffff0000,v41
v_lshlrev_b32 v92,16,v42
v_and_b32 v93,0xffff0000,v42
v_lshlrev_b32 v94,16,v43
v_and_b32 v95,0xffff0000,v43
v_lshlrev_b32 v96,16,v44
v_and_b32 v97,0xffff0000,v44
v_lshlrev_b32 v98,16,v45
v_and_b32 v99,0xffff0000,v45
v_lshlrev_b32 v100,16,v46
v_and_b32 v101,0xffff0000,v46
v_lshlrev_b32 v102,16,v47
v_and_b32 v103,0xffff0000,v47
v_lshlrev_b32 v104,16,v48
v_and_b32 v105,0xffff0000,v48
v_lshlrev_b32 v106,16,v49
v_and_b32 v107,0xffff0000,v49
v_lshlrev_b32 v108,16,v50
v_and_b32 v109,0xffff0000,v50
v_lshlrev_b32 v110,16,v51
v_and_b32 v111,0xffff0000,v51
v_pk_add_f32 v[28:29],v[72:73],v[74:75]
v_pk_mul_f32 v[26:27],v[72:73],v[72:73]
v_pk_fma_f32 v[26:27],v[74:75],v[74:75],v[26:27]
v_pk_add_f32 v[28:29],v[28:29],v[76:77]
v_pk_fma_f32 v[26:27],v[76:77],v[76:77],v[26:27]
v_pk_add_f32 v[28:29],v[28:29],v[78:79]
v_pk_fma_f32 v[26:27],v[78:79],v[78:79],v[26:27]
v_pk_add_f32 v[28:29],v[28:29],v[80:81]
v_pk_fma_f32 v[26:27],v[80:81],v[80:81],v[26:27]
v_pk_add_f32 v[28:29],v[28:29],v[82:83]
v_pk_fma_f32 v[26:27],v[82:83],v[82:83],v[26:27]
v_pk_add_f32 v[28:29],v[28:29],v[84:85]
v_pk_fma_f32 v[26:27],v[84:85],v[84:85],v[26:27]
v_pk_add_f32 v[28:29],v[28:29],v[86:87]
v_pk_fma_f32 v[26:27],v[86:87],v[86:87],v[26:27]
v_pk_add_f32 v[28:29],v[28:29],v[88:89]
v_pk_fma_f32 v[26:27],v[88:89],v[88:89],v[26:27]
v_pk_add_f32 v[28:29],v[28:29],v[90:91]
v_pk_fma_f32 v[26:27],v[90:91],v[90:91],v[26:27]
v_pk_add_f32 v[28:29],v[28:29],v[92:93]
v_pk_fma_f32 v[26:27],v[92:93],v[92:93],v[26:27]
v_pk_add_f32 v[28:29],v[28:29],v[94:95]
v_pk_fma_f32 v[26:27],v[94:95],v[94:95],v[26:27]
v_pk_add_f32 v[28:29],v[28:29],v[96:97]
v_pk_fma_f32 v[26:27],v[96:97],v[96:97],v[26:27]
v_pk_add_f32 v[28:29],v[28:29],v[98:99]
v_pk_fma_f32 v[26:27],v[98:99],v[98:99],v[26:27]
v_pk_add_f32 v[28:29],v[28:29],v[100:101]
v_pk_fma_f32 v[26:27],v[100:101],v[100:101],v[26:27]
v_pk_add_f32 v[28:29],v[28:29],v[102:103]
v_pk_fma_f32 v[26:27],v[102:103],v[102:103],v[26:27]
v_pk_add_f32 v[28:29],v[28:29],v[104:105]
v_pk_fma_f32 v[26:27],v[104:105],v[104:105],v[26:27]
v_pk_add_f32 v[28:29],v[28:29],v[106:107]
v_pk_fma_f32 v[26:27],v[106:107],v[106:107],v[26:27]
v_pk_add_f32 v[28:29],v[28:29],v[108:109]
v_pk_fma_f32 v[26:27],v[108:109],v[108:109],v[26:27]
v_pk_add_f32 v[28:29],v[28:29],v[110:111]
v_pk_fma_f32 v[26:27],v[110:111],v[110:111],v[26:27]
v_add_f32 v24,v28,v29
v_add_f32 v25,v26,v27
s_nop 0
v_add_f32_dpp v24,v24,v24 row_ror:4 row_mask:0xf bank_mask:0xf
v_add_f32_dpp v25,v25,v25 row_ror:4 row_mask:0xf bank_mask:0xf
s_nop 0
v_add_f32_dpp v24,v24,v24 row_ror:8 row_mask:0xf bank_mask:0xf
v_add_f32_dpp v25,v25,v25 row_ror:8 row_mask:0xf bank_mask:0xf
v_mov_b32 v26,v24
v_mov_b32 v27,v25
s_nop 0
v_permlane32_swap_b32 v24,v26
v_permlane32_swap_b32 v25,v27
v_add_f32 v24,v24,v26
v_add_f32 v25,v25,v27
v_mov_b32 v26,v24
v_mov_b32 v27,v25
s_nop 0
v_permlane16_swap_b32 v24,v26
v_permlane16_swap_b32 v25,v27
v_add_f32 v24,v24,v26
v_add_f32 v25,v25,v27
v_mul_f32 v24,0x3acccccd,v24
v_mul_f32 v25,0x3acccccd,v25
v_fma_f32 v25,-v24,v24,v25
v_max_f32 v25,0,v25
v_cvt_pk_bf16_f32 v6,v24,v25
v_lshlrev_b32 v24,16,v6
v_and_b32 v25,0xffff0000,v6
v_add_f32 v25,0x3727c5ac,v25
v_cvt_pk_bf16_f32 v6,v25,v25
v_lshlrev_b32 v25,16,v6
v_sqrt_f32 v25,v25
s_nop 0
v_cvt_pk_bf16_f32 v6,v25,v25
v_lshlrev_b32 v25,16,v6
v_rcp_f32 v25,v25
s_nop 0
v_pk_add_f32 v[72:73],v[72:73],v[24:25] op_sel_hi:[1,0] neg_lo:[0,1] neg_hi:[0,1]
v_pk_add_f32 v[74:75],v[74:75],v[24:25] op_sel_hi:[1,0] neg_lo:[0,1] neg_hi:[0,1]
v_pk_add_f32 v[76:77],v[76:77],v[24:25] op_sel_hi:[1,0] neg_lo:[0,1] neg_hi:[0,1]
v_pk_add_f32 v[78:79],v[78:79],v[24:25] op_sel_hi:[1,0] neg_lo:[0,1] neg_hi:[0,1]
v_pk_add_f32 v[80:81],v[80:81],v[24:25] op_sel_hi:[1,0] neg_lo:[0,1] neg_hi:[0,1]
v_pk_add_f32 v[82:83],v[82:83],v[24:25] op_sel_hi:[1,0] neg_lo:[0,1] neg_hi:[0,1]
v_pk_add_f32 v[84:85],v[84:85],v[24:25] op_sel_hi:[1,0] neg_lo:[0,1] neg_hi:[0,1]
v_pk_add_f32 v[86:87],v[86:87],v[24:25] op_sel_hi:[1,0] neg_lo:[0,1] neg_hi:[0,1]
v_pk_add_f32 v[88:89],v[88:89],v[24:25] op_sel_hi:[1,0] neg_lo:[0,1] neg_hi:[0,1]
v_pk_add_f32 v[90:91],v[90:91],v[24:25] op_sel_hi:[1,0] neg_lo:[0,1] neg_hi:[0,1]
v_pk_add_f32 v[92:93],v[92:93],v[24:25] op_sel_hi:[1,0] neg_lo:[0,1] neg_hi:[0,1]
v_pk_add_f32 v[94:95],v[94:95],v[24:25] op_sel_hi:[1,0] neg_lo:[0,1] neg_hi:[0,1]
v_pk_add_f32 v[96:97],v[96:97],v[24:25] op_sel_hi:[1,0] neg_lo:[0,1] neg_hi:[0,1]
v_pk_add_f32 v[98:99],v[98:99],v[24:25] op_sel_hi:[1,0] neg_lo:[0,1] neg_hi:[0,1]
v_pk_add_f32 v[100:101],v[100:101],v[24:25] op_sel_hi:[1,0] neg_lo:[0,1] neg_hi:[0,1]
v_pk_add_f32 v[102:103],v[102:103],v[24:25] op_sel_hi:[1,0] neg_lo:[0,1] neg_hi:[0,1]
v_pk_add_f32 v[104:105],v[104:105],v[24:25] op_sel_hi:[1,0] neg_lo:[0,1] neg_hi:[0,1]
v_pk_add_f32 v[106:107],v[106:107],v[24:25] op_sel_hi:[1,0] neg_lo:[0,1] neg_hi:[0,1]
v_pk_add_f32 v[108:109],v[108:109],v[24:25] op_sel_hi:[1,0] neg_lo:[0,1] neg_hi:[0,1]
v_pk_add_f32 v[110:111],v[110:111],v[24:25] op_sel_hi:[1,0] neg_lo:[0,1] neg_hi:[0,1]
v_cvt_pk_bf16_f32 v6,v72,v73
v_lshlrev_b32 v72,16,v6
v_and_b32 v73,0xffff0000,v6
v_cvt_pk_bf16_f32 v8,v74,v75
v_lshlrev_b32 v74,16,v8
v_and_b32 v75,0xffff0000,v8
v_cvt_pk_bf16_f32 v6,v76,v77
v_lshlrev_b32 v76,16,v6
v_and_b32 v77,0xffff0000,v6
v_cvt_pk_bf16_f32 v8,v78,v79
v_lshlrev_b32 v78,16,v8
v_and_b32 v79,0xffff0000,v8
v_cvt_pk_bf16_f32 v6,v80,v81
v_lshlrev_b32 v80,16,v6
v_and_b32 v81,0xffff0000,v6
v_cvt_pk_bf16_f32 v8,v82,v83
v_lshlrev_b32 v82,16,v8
v_and_b32 v83,0xffff0000,v8
v_cvt_pk_bf16_f32 v6,v84,v85
v_lshlrev_b32 v84,16,v6
v_and_b32 v85,0xffff0000,v6
v_cvt_pk_bf16_f32 v8,v86,v87
v_lshlrev_b32 v86,16,v8
v_and_b32 v87,0xffff0000,v8
v_cvt_pk_bf16_f32 v6,v88,v89
v_lshlrev_b32 v88,16,v6
v_and_b32 v89,0xffff0000,v6
v_cvt_pk_bf16_f32 v8,v90,v91
v_lshlrev_b32 v90,16,v8
v_and_b32 v91,0xffff0000,v8
v_cvt_pk_bf16_f32 v6,v92,v93
v_lshlrev_b32 v92,16,v6
v_and_b32 v93,0xffff0000,v6
v_cvt_pk_bf16_f32 v8,v94,v95
v_lshlrev_b32 v94,16,v8
v_and_b32 v95,0xffff0000,v8
v_cvt_pk_bf16_f32 v6,v96,v97
v_lshlrev_b32 v96,16,v6
v_and_b32 v97,0xffff0000,v6
v_cvt_pk_bf16_f32 v8,v98,v99
v_lshlrev_b32 v98,16,v8
v_and_b32 v99,0xffff0000,v8
v_cvt_pk_bf16_f32 v6,v100,v101
v_lshlrev_b32 v100,16,v6
v_and_b32 v101,0xffff0000,v6
v_cvt_pk_bf16_f32 v8,v102,v103
v_lshlrev_b32 v102,16,v8
v_and_b32 v103,0xffff0000,v8
v_cvt_pk_bf16_f32 v6,v104,v105
v_lshlrev_b32 v104,16,v6
v_and_b32 v105,0xffff0000,v6
v_cvt_pk_bf16_f32 v8,v106,v107
v_lshlrev_b32 v106,16,v8
v_and_b32 v107,0xffff0000,v8
v_cvt_pk_bf16_f32 v6,v108,v109
v_lshlrev_b32 v108,16,v6
v_and_b32 v109,0xffff0000,v6
v_cvt_pk_bf16_f32 v8,v110,v111
v_lshlrev_b32 v110,16,v8
v_and_b32 v111,0xffff0000,v8
v_pk_mul_f32 v[72:73],v[72:73],v[24:25] op_sel:[0,1] op_sel_hi:[1,1]
v_pk_mul_f32 v[74:75],v[74:75],v[24:25] op_sel:[0,1] op_sel_hi:[1,1]
v_pk_mul_f32 v[76:77],v[76:77],v[24:25] op_sel:[0,1] op_sel_hi:[1,1]
v_pk_mul_f32 v[78:79],v[78:79],v[24:25] op_sel:[0,1] op_sel_hi:[1,1]
v_pk_mul_f32 v[80:81],v[80:81],v[24:25] op_sel:[0,1] op_sel_hi:[1,1]
v_pk_mul_f32 v[82:83],v[82:83],v[24:25] op_sel:[0,1] op_sel_hi:[1,1]
v_pk_mul_f32 v[84:85],v[84:85],v[24:25] op_sel:[0,1] op_sel_hi:[1,1]
v_pk_mul_f32 v[86:87],v[86:87],v[24:25] op_sel:[0,1] op_sel_hi:[1,1]
v_pk_mul_f32 v[88:89],v[88:89],v[24:25] op_sel:[0,1] op_sel_hi:[1,1]
v_pk_mul_f32 v[90:91],v[90:91],v[24:25] op_sel:[0,1] op_sel_hi:[1,1]
v_pk_mul_f32 v[92:93],v[92:93],v[24:25] op_sel:[0,1] op_sel_hi:[1,1]
v_pk_mul_f32 v[94:95],v[94:95],v[24:25] op_sel:[0,1] op_sel_hi:[1,1]
v_pk_mul_f32 v[96:97],v[96:97],v[24:25] op_sel:[0,1] op_sel_hi:[1,1]
v_pk_mul_f32 v[98:99],v[98:99],v[24:25] op_sel:[0,1] op_sel_hi:[1,1]
v_pk_mul_f32 v[100:101],v[100:101],v[24:25] op_sel:[0,1] op_sel_hi:[1,1]
v_pk_mul_f32 v[102:103],v[102:103],v[24:25] op_sel:[0,1] op_sel_hi:[1,1]
v_pk_mul_f32 v[104:105],v[104:105],v[24:25] op_sel:[0,1] op_sel_hi:[1,1]
v_pk_mul_f32 v[106:107],v[106:107],v[24:25] op_sel:[0,1] op_sel_hi:[1,1]
v_pk_mul_f32 v[108:109],v[108:109],v[24:25] op_sel:[0,1] op_sel_hi:[1,1]
v_pk_mul_f32 v[110:111],v[110:111],v[24:25] op_sel:[0,1] op_sel_hi:[1,1]
v_cvt_pk_bf16_f32 v112,v72,v73
v_lshlrev_b32 v72,16,v112
v_and_b32 v73,0xffff0000,v112
v_cvt_pk_bf16_f32 v113,v74,v75
v_lshlrev_b32 v74,16,v113
v_and_b32 v75,0xffff0000,v113
v_cvt_pk_bf16_f32 v114,v76,v77
v_lshlrev_b32 v76,16,v114
v_and_b32 v77,0xffff0000,v114
v_cvt_pk_bf16_f32 v115,v78,v79
v_lshlrev_b32 v78,16,v115
v_and_b32 v79,0xffff0000,v115
v_cvt_pk_bf16_f32 v116,v80,v81
v_lshlrev_b32 v80,16,v116
v_and_b32 v81,0xffff0000,v116
v_cvt_pk_bf16_f32 v117,v82,v83
v_lshlrev_b32 v82,16,v117
v_and_b32 v83,0xffff0000,v117
v_cvt_pk_bf16_f32 v118,v84,v85
v_lshlrev_b32 v84,16,v118
v_and_b32 v85,0xffff0000,v118
v_cvt_pk_bf16_f32 v119,v86,v87
v_lshlrev_b32 v86,16,v119
v_and_b32 v87,0xffff0000,v119
v_cvt_pk_bf16_f32 v120,v88,v89
v_lshlrev_b32 v88,16,v120
v_and_b32 v89,0xffff0000,v120
v_cvt_pk_bf16_f32 v121,v90,v91
v_lshlrev_b32 v90,16,v121
v_and_b32 v91,0xffff0000,v121
v_cvt_pk_bf16_f32 v122,v92,v93
v_lshlrev_b32 v92,16,v122
v_and_b32 v93,0xffff0000,v122
v_cvt_pk_bf16_f32 v123,v94,v95
v_lshlrev_b32 v94,16,v123
v_and_b32 v95,0xffff0000,v123
v_cvt_pk_bf16_f32 v124,v96,v97
v_lshlrev_b32 v96,16,v124
v_and_b32 v97,0xffff0000,v124
v_cvt_pk_bf16_f32 v125,v98,v99
v_lshlrev_b32 v98,16,v125
v_and_b32 v99,0xffff0000,v125
v_cvt_pk_bf16_f32 v126,v100,v101
v_lshlrev_b32 v100,16,v126
v_and_b32 v101,0xffff0000,v126
v_cvt_pk_bf16_f32 v127,v102,v103
v_lshlrev_b32 v102,16,v127
v_and_b32 v103,0xffff0000,v127
v_cvt_pk_bf16_f32 v128,v104,v105
v_lshlrev_b32 v104,16,v128
v_and_b32 v105,0xffff0000,v128
v_cvt_pk_bf16_f32 v129,v106,v107
v_lshlrev_b32 v106,16,v129
v_and_b32 v107,0xffff0000,v129
v_cvt_pk_bf16_f32 v130,v108,v109
v_lshlrev_b32 v108,16,v130
v_and_b32 v109,0xffff0000,v130
v_cvt_pk_bf16_f32 v131,v110,v111
v_lshlrev_b32 v110,16,v131
v_and_b32 v111,0xffff0000,v131
s_add_u32 s63,s65,0
v_permlane16_swap_b32 v112,v114
v_permlane16_swap_b32 v113,v115
buffer_store_dwordx4 v[112:115],v132,s[8:11],s63 offen sc1
s_add_u32 s63,s65,8192
v_permlane16_swap_b32 v116,v118
v_permlane16_swap_b32 v117,v119
buffer_store_dwordx4 v[116:119],v132,s[8:11],s63 offen sc1
s_add_u32 s63,s65,16384
v_permlane16_swap_b32 v120,v122
v_permlane16_swap_b32 v121,v123
buffer_store_dwordx4 v[120:123],v132,s[8:11],s63 offen sc1
s_add_u32 s63,s65,24576
v_permlane16_swap_b32 v124,v126
v_permlane16_swap_b32 v125,v127
buffer_store_dwordx4 v[124:127],v132,s[8:11],s63 offen sc1
s_add_u32 s63,s65,32768
v_permlane16_swap_b32 v128,v130
v_permlane16_swap_b32 v129,v131
buffer_store_dwordx4 v[128:131],v132,s[8:11],s63 offen sc1
s_add_u32 s63,s64,0
v_permlane16_swap_b32 v32,v34
v_permlane16_swap_b32 v33,v35
buffer_store_dwordx4 v[32:35],v132,s[8:11],s63 offen sc1
s_add_u32 s63,s64,8192
v_permlane16_swap_b32 v36,v38
v_permlane16_swap_b32 v37,v39
buffer_store_dwordx4 v[36:39],v132,s[8:11],s63 offen sc1
s_add_u32 s63,s64,16384
v_permlane16_swap_b32 v40,v42
v_permlane16_swap_b32 v41,v43
buffer_store_dwordx4 v[40:43],v132,s[8:11],s63 offen sc1
s_add_u32 s63,s64,24576
v_permlane16_swap_b32 v44,v46
v_permlane16_swap_b32 v45,v47
buffer_store_dwordx4 v[44:47],v132,s[8:11],s63 offen sc1
s_add_u32 s63,s64,32768
v_permlane16_swap_b32 v48,v50
v_permlane16_swap_b32 v49,v51
buffer_store_dwordx4 v[48:51],v132,s[8:11],s63 offen sc1
s_lshl_b32 s82,s55,6
s_add_u32 s82,s82,s54
s_lshl_b32 s82,s82,9
s_add_u32 s82,s82,0
s_lshl_b32 s61,s53,2
s_add_u32 s82,s82,s61
s_add_u32 s54,s54,16
s_lshl_b32 s3,s49,2
v_mov_b32 v7,s3
s_nop 1
ibw_230:
buffer_load_dword v6,v7,s[12:15],0 offen sc1
s_waitcnt vmcnt(0)
v_cmp_ne_u32 vcc,256,v6
s_nop 0
s_cbranch_vccz ok_231
s_sleep 8
s_sub_u32 s47,s47,1
s_cbranch_scc1 ABORT
s_branch ibw_230
ok_231:
s_cmp_lg_u32 s49,0
s_cbranch_scc1 ibok_232
v_and_b32 v7,7,v0
v_lshlrev_b32 v7,2,v7
buffer_load_dword v6,v7,s[12:15],0 offen offset:32 sc1
s_waitcnt vmcnt(0)
v_cmp_ne_u32 vcc,32,v6
s_nop 0
s_cbranch_vccz ibok_232
s_barrier
s_mov_b32 s49,1
s_mov_b32 s3,s2
s_load_dwordx16 s[16:31],s[0:1],0
s_load_dwordx8 s[32:39],s[0:1],64
s_waitcnt lgkmcnt(0)
s_branch DISPATCH
ibok_232:
s_mov_b64 exec,1
buffer_store_dword v5,v1,s[8:11],s82 offen sc1
s_mov_b64 exec,-1
s_add_u32 s66,s54,16
s_min_u32 s66,s66,63
s_mul_i32 s62,s66,40960
buffer_load_dwordx2 v[32:33],v133,s[4:7],s62 offen offset:0
buffer_load_dwordx2 v[34:35],v133,s[4:7],s62 offen offset:128
buffer_load_dwordx2 v[36:37],v133,s[4:7],s62 offen offset:256
buffer_load_dwordx2 v[38:39],v133,s[4:7],s62 offen offset:384
buffer_load_dwordx2 v[40:41],v133,s[4:7],s62 offen offset:512
buffer_load_dwordx2 v[42:43],v133,s[4:7],s62 offen offset:640
buffer_load_dwordx2 v[44:45],v133,s[4:7],s62 offen offset:768
buffer_load_dwordx2 v[46:47],v133,s[4:7],s62 offen offset:896
buffer_load_dwordx2 v[48:49],v133,s[4:7],s62 offen offset:1024
buffer_load_dwordx2 v[50:51],v133,s[4:7],s62 offen offset:1152
s_mul_i32 s64,s54,40960
s_add_u32 s64,s64,234749952
s_mul_i32 s65,s54,46080
s_add_u32 s65,s65,206569472
s_waitcnt vmcnt(10)
v_lshlrev_b32 v72,16,v52
v_and_b32 v73,0xffff0000,v52
v_lshlrev_b32 v74,16,v53
v_and_b32 v75,0xffff0000,v53
v_lshlrev_b32 v76,16,v54
v_and_b32 v77,0xffff0000,v54
v_lshlrev_b32 v78,16,v55
v_and_b32 v79,0xffff0000,v55
v_lshlrev_b32 v80,16,v56
v_and_b32 v81,0xffff0000,v56
v_lshlrev_b32 v82,16,v57
v_and_b32 v83,0xffff0000,v57
v_lshlrev_b32 v84,16,v58
v_and_b32 v85,0xffff0000,v58
v_lshlrev_b32 v86,16,v59
v_and_b32 v87,0xffff0000,v59
v_lshlrev_b32 v88,16,v60
v_and_b32 v89,0xffff0000,v60
v_lshlrev_b32 v90,16,v61
v_and_b32 v91,0xffff0000,v61
v_lshlrev_b32 v92,16,v62
v_and_b32 v93,0xffff0000,v62
v_lshlrev_b32 v94,16,v63
v_and_b32 v95,0xffff0000,v63
v_lshlrev_b32 v96,16,v64
v_and_b32 v97,0xffff0000,v64
v_lshlrev_b32 v98,16,v65
v_and_b32 v99,0xffff0000,v65
v_lshlrev_b32 v100,16,v66
v_and_b32 v101,0xffff0000,v66
v_lshlrev_b32 v102,16,v67
v_and_b32 v103,0xffff0000,v67
v_lshlrev_b32 v104,16,v68
v_and_b32 v105,0xffff0000,v68
v_lshlrev_b32 v106,16,v69
v_and_b32 v107,0xffff0000,v69
v_lshlrev_b32 v108,16,v70
v_and_b32 v109,0xffff0000,v70
v_lshlrev_b32 v110,16,v71
v_and_b32 v111,0xffff0000,v71
v_pk_add_f32 v[28:29],v[72:73],v[74:75]
v_pk_mul_f32 v[26:27],v[72:73],v[72:73]
v_pk_fma_f32 v[26:27],v[74:75],v[74:75],v[26:27]
v_pk_add_f32 v[28:29],v[28:29],v[76:77]
v_pk_fma_f32 v[26:27],v[76:77],v[76:77],v[26:27]
v_pk_add_f32 v[28:29],v[28:29],v[78:79]
v_pk_fma_f32 v[26:27],v[78:79],v[78:79],v[26:27]
v_pk_add_f32 v[28:29],v[28:29],v[80:81]
v_pk_fma_f32 v[26:27],v[80:81],v[80:81],v[26:27]
v_pk_add_f32 v[28:29],v[28:29],v[82:83]
v_pk_fma_f32 v[26:27],v[82:83],v[82:83],v[26:27]
v_pk_add_f32 v[28:29],v[28:29],v[84:85]
v_pk_fma_f32 v[26:27],v[84:85],v[84:85],v[26:27]
v_pk_add_f32 v[28:29],v[28:29],v[86:87]
v_pk_fma_f32 v[26:27],v[86:87],v[86:87],v[26:27]
v_pk_add_f32 v[28:29],v[28:29],v[88:89]
v_pk_fma_f32 v[26:27],v[88:89],v[88:89],v[26:27]
v_pk_add_f32 v[28:29],v[28:29],v[90:91]
v_pk_fma_f32 v[26:27],v[90:91],v[90:91],v[26:27]
v_pk_add_f32 v[28:29],v[28:29],v[92:93]
v_pk_fma_f32 v[26:27],v[92:93],v[92:93],v[26:27]
v_pk_add_f32 v[28:29],v[28:29],v[94:95]
v_pk_fma_f32 v[26:27],v[94:95],v[94:95],v[26:27]
v_pk_add_f32 v[28:29],v[28:29],v[96:97]
v_pk_fma_f32 v[26:27],v[96:97],v[96:97],v[26:27]
v_pk_add_f32 v[28:29],v[28:29],v[98:99]
v_pk_fma_f32 v[26:27],v[98:99],v[98:99],v[26:27]
v_pk_add_f32 v[28:29],v[28:29],v[100:101]
v_pk_fma_f32 v[26:27],v[100:101],v[100:101],v[26:27]
v_pk_add_f32 v[28:29],v[28:29],v[102:103]
v_pk_fma_f32 v[26:27],v[102:103],v[102:103],v[26:27]
v_pk_add_f32 v[28:29],v[28:29],v[104:105]
v_pk_fma_f32 v[26:27],v[104:105],v[104:105],v[26:27]
v_pk_add_f32 v[28:29],v[28:29],v[106:107]
v_pk_fma_f32 v[26:27],v[106:107],v[106:107],v[26:27]
v_pk_add_f32 v[28:29],v[28:29],v[108:109]
v_pk_fma_f32 v[26:27],v[108:109],v[108:109],v[26:27]
v_pk_add_f32 v[28:29],v[28:29],v[110:111]
v_pk_fma_f32 v[26:27],v[110:111],v[110:111],v[26:27]
v_add_f32 v24,v28,v29
v_add_f32 v25,v26,v27
s_nop 0
v_add_f32_dpp v24,v24,v24 row_ror:4 row_mask:0xf bank_mask:0xf
v_add_f32_dpp v25,v25,v25 row_ror:4 row_mask:0xf bank_mask:0xf
s_nop 0
v_add_f32_dpp v24,v24,v24 row_ror:8 row_mask:0xf bank_mask:0xf
v_add_f32_dpp v25,v25,v25 row_ror:8 row_mask:0xf bank_mask:0xf
v_mov_b32 v26,v24
v_mov_b32 v27,v25
s_nop 0
v_permlane32_swap_b32 v24,v26
v_permlane32_swap_b32 v25,v27
v_add_f32 v24,v24,v26
v_add_f32 v25,v25,v27
v_mov_b32 v26,v24
v_mov_b32 v27,v25
s_nop 0
v_permlane16_swap_b32 v24,v26
v_permlane16_swap_b32 v25,v27
v_add_f32 v24,v24,v26
v_add_f32 v25,v25,v27
v_mul_f32 v24,0x3acccccd,v24
v_mul_f32 v25,0x3acccccd,v25
v_fma_f32 v25,-v24,v24,v25
v_max_f32 v25,0,v25
v_cvt_pk_bf16_f32 v6,v24,v25
v_lshlrev_b32 v24,16,v6
v_and_b32 v25,0xffff0000,v6
v_add_f32 v25,0x3727c5ac,v25
v_cvt_pk_bf16_f32 v6,v25,v25
v_lshlrev_b32 v25,16,v6
v_sqrt_f32 v25,v25
s_nop 0
v_cvt_pk_bf16_f32 v6,v25,v25
v_lshlrev_b32 v25,16,v6
v_rcp_f32 v25,v25
s_nop 0
v_pk_add_f32 v[72:73],v[72:73],v[24:25] op_sel_hi:[1,0] neg_lo:[0,1] neg_hi:[0,1]
v_pk_add_f32 v[74:75],v[74:75],v[24:25] op_sel_hi:[1,0] neg_lo:[0,1] neg_hi:[0,1]
v_pk_add_f32 v[76:77],v[76:77],v[24:25] op_sel_hi:[1,0] neg_lo:[0,1] neg_hi:[0,1]
v_pk_add_f32 v[78:79],v[78:79],v[24:25] op_sel_hi:[1,0] neg_lo:[0,1] neg_hi:[0,1]
v_pk_add_f32 v[80:81],v[80:81],v[24:25] op_sel_hi:[1,0] neg_lo:[0,1] neg_hi:[0,1]
v_pk_add_f32 v[82:83],v[82:83],v[24:25] op_sel_hi:[1,0] neg_lo:[0,1] neg_hi:[0,1]
v_pk_add_f32 v[84:85],v[84:85],v[24:25] op_sel_hi:[1,0] neg_lo:[0,1] neg_hi:[0,1]
v_pk_add_f32 v[86:87],v[86:87],v[24:25] op_sel_hi:[1,0] neg_lo:[0,1] neg_hi:[0,1]
v_pk_add_f32 v[88:89],v[88:89],v[24:25] op_sel_hi:[1,0] neg_lo:[0,1] neg_hi:[0,1]
v_pk_add_f32 v[90:91],v[90:91],v[24:25] op_sel_hi:[1,0] neg_lo:[0,1] neg_hi:[0,1]
v_pk_add_f32 v[92:93],v[92:93],v[24:25] op_sel_hi:[1,0] neg_lo:[0,1] neg_hi:[0,1]
v_pk_add_f32 v[94:95],v[94:95],v[24:25] op_sel_hi:[1,0] neg_lo:[0,1] neg_hi:[0,1]
v_pk_add_f32 v[96:97],v[96:97],v[24:25] op_sel_hi:[1,0] neg_lo:[0,1] neg_hi:[0,1]
v_pk_add_f32 v[98:99],v[98:99],v[24:25] op_sel_hi:[1,0] neg_lo:[0,1] neg_hi:[0,1]
v_pk_add_f32 v[100:101],v[100:101],v[24:25] op_sel_hi:[1,0] neg_lo:[0,1] neg_hi:[0,1]
v_pk_add_f32 v[102:103],v[102:103],v[24:25] op_sel_hi:[1,0] neg_lo:[0,1] neg_hi:[0,1]
v_pk_add_f32 v[104:105],v[104:105],v[24:25] op_sel_hi:[1,0] neg_lo:[0,1] neg_hi:[0,1]
v_pk_add_f32 v[106:107],v[106:107],v[24:25] op_sel_hi:[1,0] neg_lo:[0,1] neg_hi:[0,1]
v_pk_add_f32 v[108:109],v[108:109],v[24:25] op_sel_hi:[1,0] neg_lo:[0,1] neg_hi:[0,1]
v_pk_add_f32 v[110:111],v[110:111],v[24:25] op_sel_hi:[1,0] neg_lo:[0,1] neg_hi:[0,1]
v_cvt_pk_bf16_f32 v6,v72,v73
v_lshlrev_b32 v72,16,v6
v_and_b32 v73,0xffff0000,v6
v_cvt_pk_bf16_f32 v8,v74,v75
v_lshlrev_b32 v74,16,v8
v_and_b32 v75,0xffff0000,v8
v_cvt_pk_bf16_f32 v6,v76,v77
v_lshlrev_b32 v76,16,v6
v_and_b32 v77,0xffff0000,v6
v_cvt_pk_bf16_f32 v8,v78,v79
v_lshlrev_b32 v78,16,v8
v_and_b32 v79,0xffff0000,v8
v_cvt_pk_bf16_f32 v6,v80,v81
v_lshlrev_b32 v80,16,v6
v_and_b32 v81,0xffff0000,v6
v_cvt_pk_bf16_f32 v8,v82,v83
v_lshlrev_b32 v82,16,v8
v_and_b32 v83,0xffff0000,v8
v_cvt_pk_bf16_f32 v6,v84,v85
v_lshlrev_b32 v84,16,v6
v_and_b32 v85,0xffff0000,v6
v_cvt_pk_bf16_f32 v8,v86,v87
v_lshlrev_b32 v86,16,v8
v_and_b32 v87,0xffff0000,v8
v_cvt_pk_bf16_f32 v6,v88,v89
v_lshlrev_b32 v88,16,v6
v_and_b32 v89,0xffff0000,v6
v_cvt_pk_bf16_f32 v8,v90,v91
v_lshlrev_b32 v90,16,v8
v_and_b32 v91,0xffff0000,v8
v_cvt_pk_bf16_f32 v6,v92,v93
v_lshlrev_b32 v92,16,v6
v_and_b32 v93,0xffff0000,v6
v_cvt_pk_bf16_f32 v8,v94,v95
v_lshlrev_b32 v94,16,v8
v_and_b32 v95,0xffff0000,v8
v_cvt_pk_bf16_f32 v6,v96,v97
v_lshlrev_b32 v96,16,v6
v_and_b32 v97,0xffff0000,v6
v_cvt_pk_bf16_f32 v8,v98,v99
v_lshlrev_b32 v98,16,v8
v_and_b32 v99,0xffff0000,v8
v_cvt_pk_bf16_f32 v6,v100,v101
v_lshlrev_b32 v100,16,v6
v_and_b32 v101,0xffff0000,v6
v_cvt_pk_bf16_f32 v8,v102,v103
v_lshlrev_b32 v102,16,v8
v_and_b32 v103,0xffff0000,v8
v_cvt_pk_bf16_f32 v6,v104,v105
v_lshlrev_b32 v104,16,v6
v_and_b32 v105,0xffff0000,v6
v_cvt_pk_bf16_f32 v8,v106,v107
v_lshlrev_b32 v106,16,v8
v_and_b32 v107,0xffff0000,v8
v_cvt_pk_bf16_f32 v6,v108,v109
v_lshlrev_b32 v108,16,v6
v_and_b32 v109,0xffff0000,v6
v_cvt_pk_bf16_f32 v8,v110,v111
v_lshlrev_b32 v110,16,v8
v_and_b32 v111,0xffff0000,v8
v_pk_mul_f32 v[72:73],v[72:73],v[24:25] op_sel:[0,1] op_sel_hi:[1,1]
v_pk_mul_f32 v[74:75],v[74:75],v[24:25] op_sel:[0,1] op_sel_hi:[1,1]
v_pk_mul_f32 v[76:77],v[76:77],v[24:25] op_sel:[0,1] op_sel_hi:[1,1]
v_pk_mul_f32 v[78:79],v[78:79],v[24:25] op_sel:[0,1] op_sel_hi:[1,1]
v_pk_mul_f32 v[80:81],v[80:81],v[24:25] op_sel:[0,1] op_sel_hi:[1,1]
v_pk_mul_f32 v[82:83],v[82:83],v[24:25] op_sel:[0,1] op_sel_hi:[1,1]
v_pk_mul_f32 v[84:85],v[84:85],v[24:25] op_sel:[0,1] op_sel_hi:[1,1]
v_pk_mul_f32 v[86:87],v[86:87],v[24:25] op_sel:[0,1] op_sel_hi:[1,1]
v_pk_mul_f32 v[88:89],v[88:89],v[24:25] op_sel:[0,1] op_sel_hi:[1,1]
v_pk_mul_f32 v[90:91],v[90:91],v[24:25] op_sel:[0,1] op_sel_hi:[1,1]
v_pk_mul_f32 v[92:93],v[92:93],v[24:25] op_sel:[0,1] op_sel_hi:[1,1]
v_pk_mul_f32 v[94:95],v[94:95],v[24:25] op_sel:[0,1] op_sel_hi:[1,1]
v_pk_mul_f32 v[96:97],v[96:97],v[24:25] op_sel:[0,1] op_sel_hi:[1,1]
v_pk_mul_f32 v[98:99],v[98:99],v[24:25] op_sel:[0,1] op_sel_hi:[1,1]
v_pk_mul_f32 v[100:101],v[100:101],v[24:25] op_sel:[0,1] op_sel_hi:[1,1]
v_pk_mul_f32 v[102:103],v[102:103],v[24:25] op_sel:[0,1] op_sel_hi:[1,1]
v_pk_mul_f32 v[104:105],v[104:105],v[24:25] op_sel:[0,1] op_sel_hi:[1,1]
v_pk_mul_f32 v[106:107],v[106:107],v[24:25] op_sel:[0,1] op_sel_hi:[1,1]
v_pk_mul_f32 v[108:109],v[108:109],v[24:25] op_sel:[0,1] op_sel_hi:[1,1]
v_pk_mul_f32 v[110:111],v[110:111],v[24:25] op_sel:[0,1] op_sel_hi:[1,1]
v_cvt_pk_bf16_f32 v112,v72,v73
v_lshlrev_b32 v72,16,v112
v_and_b32 v73,0xffff0000,v112
v_cvt_pk_bf16_f32 v113,v74,v75
v_lshlrev_b32 v74,16,v113
v_and_b32 v75,0xffff0000,v113
v_cvt_pk_bf16_f32 v114,v76,v77
v_lshlrev_b32 v76,16,v114
v_and_b32 v77,0xffff0000,v114
v_cvt_pk_bf16_f32 v115,v78,v79
v_lshlrev_b32 v78,16,v115
v_and_b32 v79,0xffff0000,v115
v_cvt_pk_bf16_f32 v116,v80,v81
v_lshlrev_b32 v80,16,v116
v_and_b32 v81,0xffff0000,v116
v_cvt_pk_bf16_f32 v117,v82,v83
v_lshlrev_b32 v82,16,v117
v_and_b32 v83,0xffff0000,v117
v_cvt_pk_bf16_f32 v118,v84,v85
v_lshlrev_b32 v84,16,v118
v_and_b32 v85,0xffff0000,v118
v_cvt_pk_bf16_f32 v119,v86,v87
v_lshlrev_b32 v86,16,v119
v_and_b32 v87,0xffff0000,v119
v_cvt_pk_bf16_f32 v120,v88,v89
v_lshlrev_b32 v88,16,v120
v_and_b32 v89,0xffff0000,v120
v_cvt_pk_bf16_f32 v121,v90,v91
v_lshlrev_b32 v90,16,v121
v_and_b32 v91,0xffff0000,v121
v_cvt_pk_bf16_f32 v122,v92,v93
v_lshlrev_b32 v92,16,v122
v_and_b32 v93,0xffff0000,v122
v_cvt_pk_bf16_f32 v123,v94,v95
v_lshlrev_b32 v94,16,v123
v_and_b32 v95,0xffff0000,v123
v_cvt_pk_bf16_f32 v124,v96,v97
v_lshlrev_b32 v96,16,v124
v_and_b32 v97,0xffff0000,v124
v_cvt_pk_bf16_f32 v125,v98,v99
v_lshlrev_b32 v98,16,v125
v_and_b32 v99,0xffff0000,v125
v_cvt_pk_bf16_f32 v126,v100,v101
v_lshlrev_b32 v100,16,v126
v_and_b32 v101,0xffff0000,v126
v_cvt_pk_bf16_f32 v127,v102,v103
v_lshlrev_b32 v102,16,v127
v_and_b32 v103,0xffff0000,v127
v_cvt_pk_bf16_f32 v128,v104,v105
v_lshlrev_b32 v104,16,v128
v_and_b32 v105,0xffff0000,v128
v_cvt_pk_bf16_f32 v129,v106,v107
v_lshlrev_b32 v106,16,v129
v_and_b32 v107,0xffff0000,v129
v_cvt_pk_bf16_f32 v130,v108,v109
v_lshlrev_b32 v108,16,v130
v_and_b32 v109,0xffff0000,v130
v_cvt_pk_bf16_f32 v131,v110,v111
v_lshlrev_b32 v110,16,v131
v_and_b32 v111,0xffff0000,v131
s_add_u32 s63,s65,0
v_permlane16_swap_b32 v112,v114
v_permlane16_swap_b32 v113,v115
buffer_store_dwordx4 v[112:115],v132,s[8:11],s63 offen sc1
s_add_u32 s63,s65,8192
v_permlane16_swap_b32 v116,v118
v_permlane16_swap_b32 v117,v119
buffer_store_dwordx4 v[116:119],v132,s[8:11],s63 offen sc1
s_add_u32 s63,s65,16384
v_permlane16_swap_b32 v120,v122
v_permlane16_swap_b32 v121,v123
buffer_store_dwordx4 v[120:123],v132,s[8:11],s63 offen sc1
s_add_u32 s63,s65,24576
v_permlane16_swap_b32 v124,v126
v_permlane16_swap_b32 v125,v127
buffer_store_dwordx4 v[124:127],v132,s[8:11],s63 offen sc1
s_add_u32 s63,s65,32768
v_permlane16_swap_b32 v128,v130
v_permlane16_swap_b32 v129,v131
buffer_store_dwordx4 v[128:131],v132,s[8:11],s63 offen sc1
s_add_u32 s63,s64,0
v_permlane16_swap_b32 v52,v54
v_permlane16_swap_b32 v53,v55
buffer_store_dwordx4 v[52:55],v132,s[8:11],s63 offen sc1
s_add_u32 s63,s64,8192
v_permlane16_swap_b32 v56,v58
v_permlane16_swap_b32 v57,v59
buffer_store_dwordx4 v[56:59],v132,s[8:11],s63 offen sc1
s_add_u32 s63,s64,16384
v_permlane16_swap_b32 v60,v62
v_permlane16_swap_b32 v61,v63
buffer_store_dwordx4 v[60:63],v132,s[8:11],s63 offen sc1
s_add_u32 s63,s64,24576
v_permlane16_swap_b32 v64,v66
v_permlane16_swap_b32 v65,v67
buffer_store_dwordx4 v[64:67],v132,s[8:11],s63 offen sc1
s_add_u32 s63,s64,32768
v_permlane16_swap_b32 v68,v70
v_permlane16_swap_b32 v69,v71
buffer_store_dwordx4 v[68:71],v132,s[8:11],s63 offen sc1
s_lshl_b32 s82,s55,6
s_add_u32 s82,s82,s54
s_lshl_b32 s82,s82,9
s_add_u32 s82,s82,0
s_lshl_b32 s61,s53,2
s_add_u32 s82,s82,s61
s_add_u32 s54,s54,16
R0_LOOPA:
s_add_u32 s66,s54,16
s_min_u32 s66,s66,63
s_mul_i32 s62,s66,40960
buffer_load_dwordx2 v[52:53],v133,s[4:7],s62 offen offset:0
buffer_load_dwordx2 v[54:55],v133,s[4:7],s62 offen offset:128
buffer_load_dwordx2 v[56:57],v133,s[4:7],s62 offen offset:256
buffer_load_dwordx2 v[58:59],v133,s[4:7],s62 offen offset:384
buffer_load_dwordx2 v[60:61],v133,s[4:7],s62 offen offset:512
buffer_load_dwordx2 v[62:63],v133,s[4:7],s62 offen offset:640
buffer_load_dwordx2 v[64:65],v133,s[4:7],s62 offen offset:768
buffer_load_dwordx2 v[66:67],v133,s[4:7],s62 offen offset:896
buffer_load_dwordx2 v[68:69],v133,s[4:7],s62 offen offset:1024
buffer_load_dwordx2 v[70:71],v133,s[4:7],s62 offen offset:1152
s_mul_i32 s64,s54,40960
s_add_u32 s64,s64,234749952
s_mul_i32 s65,s54,46080
s_add_u32 s65,s65,206569472
s_waitcnt vmcnt(10)
s_mov_b64 exec,1
buffer_store_dword v5,v1,s[8:11],s82 offen sc1
s_mov_b64 exec,-1
v_lshlrev_b32 v72,16,v32
v_and_b32 v73,0xffff0000,v32
v_lshlrev_b32 v74,16,v33
v_and_b32 v75,0xffff0000,v33
v_lshlrev_b32 v76,16,v34
v_and_b32 v77,0xffff0000,v34
v_lshlrev_b32 v78,16,v35
v_and_b32 v79,0xffff0000,v35
v_lshlrev_b32 v80,16,v36
v_and_b32 v81,0xffff0000,v36
v_lshlrev_b32 v82,16,v37
v_and_b32 v83,0xffff0000,v37
v_lshlrev_b32 v84,16,v38
v_and_b32 v85,0xffff0000,v38
v_lshlrev_b32 v86,16,v39
v_and_b32 v87,0xffff0000,v39
v_lshlrev_b32 v88,16,v40
v_and_b32 v89,0xffff0000,v40
v_lshlrev_b32 v90,16,v41
v_and_b32 v91,0xffff0000,v41
v_lshlrev_b32 v92,16,v42
v_and_b32 v93,0xffff0000,v42
v_lshlrev_b32 v94,16,v43
v_and_b32 v95,0xffff0000,v43
v_lshlrev_b32 v96,16,v44
v_and_b32 v97,0xffff0000,v44
v_lshlrev_b32 v98,16,v45
v_and_b32 v99,0xffff0000,v45
v_lshlrev_b32 v100,16,v46
v_and_b32 v101,0xffff0000,v46
v_lshlrev_b32 v102,16,v47
v_and_b32 v103,0xffff0000,v47
v_lshlrev_b32 v104,16,v48
v_and_b32 v105,0xffff0000,v48
v_lshlrev_b32 v106,16,v49
v_and_b32 v107,0xffff0000,v49
v_lshlrev_b32 v108,16,v50
v_and_b32 v109,0xffff0000,v50
v_lshlrev_b32 v110,16,v51
v_and_b32 v111,0xffff0000,v51
v_pk_add_f32 v[28:29],v[72:73],v[74:75]
v_pk_mul_f32 v[26:27],v[72:73],v[72:73]
v_pk_fma_f32 v[26:27],v[74:75],v[74:75],v[26:27]
v_pk_add_f32 v[28:29],v[28:29],v[76:77]
v_pk_fma_f32 v[26:27],v[76:77],v[76:77],v[26:27]
v_pk_add_f32 v[28:29],v[28:29],v[78:79]
v_pk_fma_f32 v[26:27],v[78:79],v[78:79],v[26:27]
v_pk_add_f32 v[28:29],v[28:29],v[80:81]
v_pk_fma_f32 v[26:27],v[80:81],v[80:81],v[26:27]
v_pk_add_f32 v[28:29],v[28:29],v[82:83]
v_pk_fma_f32 v[26:27],v[82:83],v[82:83],v[26:27]
v_pk_add_f32 v[28:29],v[28:29],v[84:85]
v_pk_fma_f32 v[26:27],v[84:85],v[84:85],v[26:27]
v_pk_add_f32 v[28:29],v[28:29],v[86:87]
v_pk_fma_f32 v[26:27],v[86:87],v[86:87],v[26:27]
v_pk_add_f32 v[28:29],v[28:29],v[88:89]
v_pk_fma_f32 v[26:27],v[88:89],v[88:89],v[26:27]
v_pk_add_f32 v[28:29],v[28:29],v[90:91]
v_pk_fma_f32 v[26:27],v[90:91],v[90:91],v[26:27]
v_pk_add_f32 v[28:29],v[28:29],v[92:93]
v_pk_fma_f32 v[26:27],v[92:93],v[92:93],v[26:27]
v_pk_add_f32 v[28:29],v[28:29],v[94:95]
v_pk_fma_f32 v[26:27],v[94:95],v[94:95],v[26:27]
v_pk_add_f32 v[28:29],v[28:29],v[96:97]
v_pk_fma_f32 v[26:27],v[96:97],v[96:97],v[26:27]
v_pk_add_f32 v[28:29],v[28:29],v[98:99]
v_pk_fma_f32 v[26:27],v[98:99],v[98:99],v[26:27]
v_pk_add_f32 v[28:29],v[28:29],v[100:101]
v_pk_fma_f32 v[26:27],v[100:101],v[100:101],v[26:27]
v_pk_add_f32 v[28:29],v[28:29],v[102:103]
v_pk_fma_f32 v[26:27],v[102:103],v[102:103],v[26:27]
v_pk_add_f32 v[28:29],v[28:29],v[104:105]
v_pk_fma_f32 v[26:27],v[104:105],v[104:105],v[26:27]
v_pk_add_f32 v[28:29],v[28:29],v[106:107]
v_pk_fma_f32 v[26:27],v[106:107],v[106:107],v[26:27]
v_pk_add_f32 v[28:29],v[28:29],v[108:109]
v_pk_fma_f32 v[26:27],v[108:109],v[108:109],v[26:27]
v_pk_add_f32 v[28:29],v[28:29],v[110:111]
v_pk_fma_f32 v[26:27],v[110:111],v[110:111],v[26:27]
v_add_f32 v24,v28,v29
v_add_f32 v25,v26,v27
s_nop 0
v_add_f32_dpp v24,v24,v24 row_ror:4 row_mask:0xf bank_mask:0xf
v_add_f32_dpp v25,v25,v25 row_ror:4 row_mask:0xf bank_mask:0xf
s_nop 0
v_add_f32_dpp v24,v24,v24 row_ror:8 row_mask:0xf bank_mask:0xf
v_add_f32_dpp v25,v25,v25 row_ror:8 row_mask:0xf bank_mask:0xf
v_mov_b32 v26,v24
v_mov_b32 v27,v25
s_nop 0
v_permlane32_swap_b32 v24,v26
v_permlane32_swap_b32 v25,v27
v_add_f32 v24,v24,v26
v_add_f32 v25,v25,v27
v_mov_b32 v26,v24
v_mov_b32 v27,v25
s_nop 0
v_permlane16_swap_b32 v24,v26
v_permlane16_swap_b32 v25,v27
v_add_f32 v24,v24,v26
v_add_f32 v25,v25,v27
v_mul_f32 v24,0x3acccccd,v24
v_mul_f32 v25,0x3acccccd,v25
v_fma_f32 v25,-v24,v24,v25
v_max_f32 v25,0,v25
v_cvt_pk_bf16_f32 v6,v24,v25
v_lshlrev_b32 v24,16,v6
v_and_b32 v25,0xffff0000,v6
v_add_f32 v25,0x3727c5ac,v25
v_cvt_pk_bf16_f32 v6,v25,v25
v_lshlrev_b32 v25,16,v6
v_sqrt_f32 v25,v25
s_nop 0
v_cvt_pk_bf16_f32 v6,v25,v25
v_lshlrev_b32 v25,16,v6
v_rcp_f32 v25,v25
s_nop 0
v_pk_add_f32 v[72:73],v[72:73],v[24:25] op_sel_hi:[1,0] neg_lo:[0,1] neg_hi:[0,1]
v_pk_add_f32 v[74:75],v[74:75],v[24:25] op_sel_hi:[1,0] neg_lo:[0,1] neg_hi:[0,1]
v_pk_add_f32 v[76:77],v[76:77],v[24:25] op_sel_hi:[1,0] neg_lo:[0,1] neg_hi:[0,1]
v_pk_add_f32 v[78:79],v[78:79],v[24:25] op_sel_hi:[1,0] neg_lo:[0,1] neg_hi:[0,1]
v_pk_add_f32 v[80:81],v[80:81],v[24:25] op_sel_hi:[1,0] neg_lo:[0,1] neg_hi:[0,1]
v_pk_add_f32 v[82:83],v[82:83],v[24:25] op_sel_hi:[1,0] neg_lo:[0,1] neg_hi:[0,1]
v_pk_add_f32 v[84:85],v[84:85],v[24:25] op_sel_hi:[1,0] neg_lo:[0,1] neg_hi:[0,1]
v_pk_add_f32 v[86:87],v[86:87],v[24:25] op_sel_hi:[1,0] neg_lo:[0,1] neg_hi:[0,1]
v_pk_add_f32 v[88:89],v[88:89],v[24:25] op_sel_hi:[1,0] neg_lo:[0,1] neg_hi:[0,1]
v_pk_add_f32 v[90:91],v[90:91],v[24:25] op_sel_hi:[1,0] neg_lo:[0,1] neg_hi:[0,1]
v_pk_add_f32 v[92:93],v[92:93],v[24:25] op_sel_hi:[1,0] neg_lo:[0,1] neg_hi:[0,1]
v_pk_add_f32 v[94:95],v[94:95],v[24:25] op_sel_hi:[1,0] neg_lo:[0,1] neg_hi:[0,1]
v_pk_add_f32 v[96:97],v[96:97],v[24:25] op_sel_hi:[1,0] neg_lo:[0,1] neg_hi:[0,1]
v_pk_add_f32 v[98:99],v[98:99],v[24:25] op_sel_hi:[1,0] neg_lo:[0,1] neg_hi:[0,1]
v_pk_add_f32 v[100:101],v[100:101],v[24:25] op_sel_hi:[1,0] neg_lo:[0,1] neg_hi:[0,1]
v_pk_add_f32 v[102:103],v[102:103],v[24:25] op_sel_hi:[1,0] neg_lo:[0,1] neg_hi:[0,1]
v_pk_add_f32 v[104:105],v[104:105],v[24:25] op_sel_hi:[1,0] neg_lo:[0,1] neg_hi:[0,1]
v_pk_add_f32 v[106:107],v[106:107],v[24:25] op_sel_hi:[1,0] neg_lo:[0,1] neg_hi:[0,1]
v_pk_add_f32 v[108:109],v[108:109],v[24:25] op_sel_hi:[1,0] neg_lo:[0,1] neg_hi:[0,1]
v_pk_add_f32 v[110:111],v[110:111],v[24:25] op_sel_hi:[1,0] neg_lo:[0,1] neg_hi:[0,1]
v_cvt_pk_bf16_f32 v6,v72,v73
v_lshlrev_b32 v72,16,v6
v_and_b32 v73,0xffff0000,v6
v_cvt_pk_bf16_f32 v8,v74,v75
v_lshlrev_b32 v74,16,v8
v_and_b32 v75,0xffff0000,v8
v_cvt_pk_bf16_f32 v6,v76,v77
v_lshlrev_b32 v76,16,v6
v_and_b32 v77,0xffff0000,v6
v_cvt_pk_bf16_f32 v8,v78,v79
v_lshlrev_b32 v78,16,v8
v_and_b32 v79,0xffff0000,v8
v_cvt_pk_bf16_f32 v6,v80,v81
v_lshlrev_b32 v80,16,v6
v_and_b32 v81,0xffff0000,v6
v_cvt_pk_bf16_f32 v8,v82,v83
v_lshlrev_b32 v82,16,v8
v_and_b32 v83,0xffff0000,v8
v_cvt_pk_bf16_f32 v6,v84,v85
v_lshlrev_b32 v84,16,v6
v_and_b32 v85,0xffff0000,v6
v_cvt_pk_bf16_f32 v8,v86,v87
v_lshlrev_b32 v86,16,v8
v_and_b32 v87,0xffff0000,v8
v_cvt_pk_bf16_f32 v6,v88,v89
v_lshlrev_b32 v88,16,v6
v_and_b32 v89,0xffff0000,v6
v_cvt_pk_bf16_f32 v8,v90,v91
v_lshlrev_b32 v90,16,v8
v_and_b32 v91,0xffff0000,v8
v_cvt_pk_bf16_f32 v6,v92,v93
v_lshlrev_b32 v92,16,v6
v_and_b32 v93,0xffff0000,v6
v_cvt_pk_bf16_f32 v8,v94,v95
v_lshlrev_b32 v94,16,v8
v_and_b32 v95,0xffff0000,v8
v_cvt_pk_bf16_f32 v6,v96,v97
v_lshlrev_b32 v96,16,v6
v_and_b32 v97,0xffff0000,v6
v_cvt_pk_bf16_f32 v8,v98,v99
v_lshlrev_b32 v98,16,v8
v_and_b32 v99,0xffff0000,v8
v_cvt_pk_bf16_f32 v6,v100,v101
v_lshlrev_b32 v100,16,v6
v_and_b32 v101,0xffff0000,v6
v_cvt_pk_bf16_f32 v8,v102,v103
v_lshlrev_b32 v102,16,v8
v_and_b32 v103,0xffff0000,v8
v_cvt_pk_bf16_f32 v6,v104,v105
v_lshlrev_b32 v104,16,v6
v_and_b32 v105,0xffff0000,v6
v_cvt_pk_bf16_f32 v8,v106,v107
v_lshlrev_b32 v106,16,v8
v_and_b32 v107,0xffff0000,v8
v_cvt_pk_bf16_f32 v6,v108,v109
v_lshlrev_b32 v108,16,v6
v_and_b32 v109,0xffff0000,v6
v_cvt_pk_bf16_f32 v8,v110,v111
v_lshlrev_b32 v110,16,v8
v_and_b32 v111,0xffff0000,v8
v_pk_mul_f32 v[72:73],v[72:73],v[24:25] op_sel:[0,1] op_sel_hi:[1,1]
v_pk_mul_f32 v[74:75],v[74:75],v[24:25] op_sel:[0,1] op_sel_hi:[1,1]
v_pk_mul_f32 v[76:77],v[76:77],v[24:25] op_sel:[0,1] op_sel_hi:[1,1]
v_pk_mul_f32 v[78:79],v[78:79],v[24:25] op_sel:[0,1] op_sel_hi:[1,1]
v_pk_mul_f32 v[80:81],v[80:81],v[24:25] op_sel:[0,1] op_sel_hi:[1,1]
v_pk_mul_f32 v[82:83],v[82:83],v[24:25] op_sel:[0,1] op_sel_hi:[1,1]
v_pk_mul_f32 v[84:85],v[84:85],v[24:25] op_sel:[0,1] op_sel_hi:[1,1]
v_pk_mul_f32 v[86:87],v[86:87],v[24:25] op_sel:[0,1] op_sel_hi:[1,1]
v_pk_mul_f32 v[88:89],v[88:89],v[24:25] op_sel:[0,1] op_sel_hi:[1,1]
v_pk_mul_f32 v[90:91],v[90:91],v[24:25] op_sel:[0,1] op_sel_hi:[1,1]
v_pk_mul_f32 v[92:93],v[92:93],v[24:25] op_sel:[0,1] op_sel_hi:[1,1]
v_pk_mul_f32 v[94:95],v[94:95],v[24:25] op_sel:[0,1] op_sel_hi:[1,1]
v_pk_mul_f32 v[96:97],v[96:97],v[24:25] op_sel:[0,1] op_sel_hi:[1,1]
v_pk_mul_f32 v[98:99],v[98:99],v[24:25] op_sel:[0,1] op_sel_hi:[1,1]
v_pk_mul_f32 v[100:101],v[100:101],v[24:25] op_sel:[0,1] op_sel_hi:[1,1]
v_pk_mul_f32 v[102:103],v[102:103],v[24:25] op_sel:[0,1] op_sel_hi:[1,1]
v_pk_mul_f32 v[104:105],v[104:105],v[24:25] op_sel:[0,1] op_sel_hi:[1,1]
v_pk_mul_f32 v[106:107],v[106:107],v[24:25] op_sel:[0,1] op_sel_hi:[1,1]
v_pk_mul_f32 v[108:109],v[108:109],v[24:25] op_sel:[0,1] op_sel_hi:[1,1]
v_pk_mul_f32 v[110:111],v[110:111],v[24:25] op_sel:[0,1] op_sel_hi:[1,1]
v_cvt_pk_bf16_f32 v112,v72,v73
v_lshlrev_b32 v72,16,v112
v_and_b32 v73,0xffff0000,v112
v_cvt_pk_bf16_f32 v113,v74,v75
v_lshlrev_b32 v74,16,v113
v_and_b32 v75,0xffff0000,v113
v_cvt_pk_bf16_f32 v114,v76,v77
v_lshlrev_b32 v76,16,v114
v_and_b32 v77,0xffff0000,v114
v_cvt_pk_bf16_f32 v115,v78,v79
v_lshlrev_b32 v78,16,v115
v_and_b32 v79,0xffff0000,v115
v_cvt_pk_bf16_f32 v116,v80,v81
v_lshlrev_b32 v80,16,v116
v_and_b32 v81,0xffff0000,v116
v_cvt_pk_bf16_f32 v117,v82,v83
v_lshlrev_b32 v82,16,v117
v_and_b32 v83,0xffff0000,v117
v_cvt_pk_bf16_f32 v118,v84,v85
v_lshlrev_b32 v84,16,v118
v_and_b32 v85,0xffff0000,v118
v_cvt_pk_bf16_f32 v119,v86,v87
v_lshlrev_b32 v86,16,v119
v_and_b32 v87,0xffff0000,v119
v_cvt_pk_bf16_f32 v120,v88,v89
v_lshlrev_b32 v88,16,v120
v_and_b32 v89,0xffff0000,v120
v_cvt_pk_bf16_f32 v121,v90,v91
v_lshlrev_b32 v90,16,v121
v_and_b32 v91,0xffff0000,v121
v_cvt_pk_bf16_f32 v122,v92,v93
v_lshlrev_b32 v92,16,v122
v_and_b32 v93,0xffff0000,v122
v_cvt_pk_bf16_f32 v123,v94,v95
v_lshlrev_b32 v94,16,v123
v_and_b32 v95,0xffff0000,v123
v_cvt_pk_bf16_f32 v124,v96,v97
v_lshlrev_b32 v96,16,v124
v_and_b32 v97,0xffff0000,v124
v_cvt_pk_bf16_f32 v125,v98,v99
v_lshlrev_b32 v98,16,v125
v_and_b32 v99,0xffff0000,v125
v_cvt_pk_bf16_f32 v126,v100,v101
v_lshlrev_b32 v100,16,v126
v_and_b32 v101,0xffff0000,v126
v_cvt_pk_bf16_f32 v127,v102,v103
v_lshlrev_b32 v102,16,v127
v_and_b32 v103,0xffff0000,v127
v_cvt_pk_bf16_f32 v128,v104,v105
v_lshlrev_b32 v104,16,v128
v_and_b32 v105,0xffff0000,v128
v_cvt_pk_bf16_f32 v129,v106,v107
v_lshlrev_b32 v106,16,v129
v_and_b32 v107,0xffff0000,v129
v_cvt_pk_bf16_f32 v130,v108,v109
v_lshlrev_b32 v108,16,v130
v_and_b32 v109,0xffff0000,v130
v_cvt_pk_bf16_f32 v131,v110,v111
v_lshlrev_b32 v110,16,v131
v_and_b32 v111,0xffff0000,v131
s_add_u32 s63,s65,0
v_permlane16_swap_b32 v112,v114
v_permlane16_swap_b32 v113,v115
buffer_store_dwordx4 v[112:115],v132,s[8:11],s63 offen sc1
s_add_u32 s63,s65,8192
v_permlane16_swap_b32 v116,v118
v_permlane16_swap_b32 v117,v119
buffer_store_dwordx4 v[116:119],v132,s[8:11],s63 offen sc1
s_add_u32 s63,s65,16384
v_permlane16_swap_b32 v120,v122
v_permlane16_swap_b32 v121,v123
buffer_store_dwordx4 v[120:123],v132,s[8:11],s63 offen sc1
s_add_u32 s63,s65,24576
v_permlane16_swap_b32 v124,v126
v_permlane16_swap_b32 v125,v127
buffer_store_dwordx4 v[124:127],v132,s[8:11],s63 offen sc1
s_add_u32 s63,s65,32768
v_permlane16_swap_b32 v128,v130
v_permlane16_swap_b32 v129,v131
buffer_store_dwordx4 v[128:131],v132,s[8:11],s63 offen sc1
s_add_u32 s63,s64,0
v_permlane16_swap_b32 v32,v34
v_permlane16_swap_b32 v33,v35
buffer_store_dwordx4 v[32:35],v132,s[8:11],s63 offen sc1
s_add_u32 s63,s64,8192
v_permlane16_swap_b32 v36,v38
v_permlane16_swap_b32 v37,v39
buffer_store_dwordx4 v[36:39],v132,s[8:11],s63 offen sc1
s_add_u32 s63,s64,16384
v_permlane16_swap_b32 v40,v42
v_permlane16_swap_b32 v41,v43
buffer_store_dwordx4 v[40:43],v132,s[8:11],s63 offen sc1
s_add_u32 s63,s64,24576
v_permlane16_swap_b32 v44,v46
v_permlane16_swap_b32 v45,v47
buffer_store_dwordx4 v[44:47],v132,s[8:11],s63 offen sc1
s_add_u32 s63,s64,32768
v_permlane16_swap_b32 v48,v50
v_permlane16_swap_b32 v49,v51
buffer_store_dwordx4 v[48:51],v132,s[8:11],s63 offen sc1
s_lshl_b32 s82,s55,6
s_add_u32 s82,s82,s54
s_lshl_b32 s82,s82,9
s_add_u32 s82,s82,0
s_lshl_b32 s61,s53,2
s_add_u32 s82,s82,s61
s_add_u32 s54,s54,16
s_cmp_ge_u32 s54,64
s_cbranch_scc1 R0_ENDA
s_add_u32 s66,s54,16
s_min_u32 s66,s66,63
s_mul_i32 s62,s66,40960
buffer_load_dwordx2 v[32:33],v133,s[4:7],s62 offen offset:0
buffer_load_dwordx2 v[34:35],v133,s[4:7],s62 offen offset:128
buffer_load_dwordx2 v[36:37],v133,s[4:7],s62 offen offset:256
buffer_load_dwordx2 v[38:39],v133,s[4:7],s62 offen offset:384
buffer_load_dwordx2 v[40:41],v133,s[4:7],s62 offen offset:512
buffer_load_dwordx2 v[42:43],v133,s[4:7],s62 offen offset:640
buffer_load_dwordx2 v[44:45],v133,s[4:7],s62 offen offset:768
buffer_load_dwordx2 v[46:47],v133,s[4:7],s62 offen offset:896
buffer_load_dwordx2 v[48:49],v133,s[4:7],s62 offen offset:1024
buffer_load_dwordx2 v[50:51],v133,s[4:7],s62 offen offset:1152
s_mul_i32 s64,s54,40960
s_add_u32 s64,s64,234749952
s_mul_i32 s65,s54,46080
s_add_u32 s65,s65,206569472
s_waitcnt vmcnt(10)
s_mov_b64 exec,1
buffer_store_dword v5,v1,s[8:11],s82 offen sc1
s_mov_b64 exec,-1
v_lshlrev_b32 v72,16,v52
v_and_b32 v73,0xffff0000,v52
v_lshlrev_b32 v74,16,v53
v_and_b32 v75,0xffff0000,v53
v_lshlrev_b32 v76,16,v54
v_and_b32 v77,0xffff0000,v54
v_lshlrev_b32 v78,16,v55
v_and_b32 v79,0xffff0000,v55
v_lshlrev_b32 v80,16,v56
v_and_b32 v81,0xffff0000,v56
v_lshlrev_b32 v82,16,v57
v_and_b32 v83,0xffff0000,v57
v_lshlrev_b32 v84,16,v58
v_and_b32 v85,0xffff0000,v58
v_lshlrev_b32 v86,16,v59
v_and_b32 v87,0xffff0000,v59
v_lshlrev_b32 v88,16,v60
v_and_b32 v89,0xffff0000,v60
v_lshlrev_b32 v90,16,v61
v_and_b32 v91,0xffff0000,v61
v_lshlrev_b32 v92,16,v62
v_and_b32 v93,0xffff0000,v62
v_lshlrev_b32 v94,16,v63
v_and_b32 v95,0xffff0000,v63
v_lshlrev_b32 v96,16,v64
v_and_b32 v97,0xffff0000,v64
v_lshlrev_b32 v98,16,v65
v_and_b32 v99,0xffff0000,v65
v_lshlrev_b32 v100,16,v66
v_and_b32 v101,0xffff0000,v66
v_lshlrev_b32 v102,16,v67
v_and_b32 v103,0xffff0000,v67
v_lshlrev_b32 v104,16,v68
v_and_b32 v105,0xffff0000,v68
v_lshlrev_b32 v106,16,v69
v_and_b32 v107,0xffff0000,v69
v_lshlrev_b32 v108,16,v70
v_and_b32 v109,0xffff0000,v70
v_lshlrev_b32 v110,16,v71
v_and_b32 v111,0xffff0000,v71
v_pk_add_f32 v[28:29],v[72:73],v[74:75]
v_pk_mul_f32 v[26:27],v[72:73],v[72:73]
v_pk_fma_f32 v[26:27],v[74:75],v[74:75],v[26:27]
v_pk_add_f32 v[28:29],v[28:29],v[76:77]
v_pk_fma_f32 v[26:27],v[76:77],v[76:77],v[26:27]
v_pk_add_f32 v[28:29],v[28:29],v[78:79]
v_pk_fma_f32 v[26:27],v[78:79],v[78:79],v[26:27]
v_pk_add_f32 v[28:29],v[28:29],v[80:81]
v_pk_fma_f32 v[26:27],v[80:81],v[80:81],v[26:27]
v_pk_add_f32 v[28:29],v[28:29],v[82:83]
v_pk_fma_f32 v[26:27],v[82:83],v[82:83],v[26:27]
v_pk_add_f32 v[28:29],v[28:29],v[84:85]
v_pk_fma_f32 v[26:27],v[84:85],v[84:85],v[26:27]
v_pk_add_f32 v[28:29],v[28:29],v[86:87]
v_pk_fma_f32 v[26:27],v[86:87],v[86:87],v[26:27]
v_pk_add_f32 v[28:29],v[28:29],v[88:89]
v_pk_fma_f32 v[26:27],v[88:89],v[88:89],v[26:27]
v_pk_add_f32 v[28:29],v[28:29],v[90:91]
v_pk_fma_f32 v[26:27],v[90:91],v[90:91],v[26:27]
v_pk_add_f32 v[28:29],v[28:29],v[92:93]
v_pk_fma_f32 v[26:27],v[92:93],v[92:93],v[26:27]
v_pk_add_f32 v[28:29],v[28:29],v[94:95]
v_pk_fma_f32 v[26:27],v[94:95],v[94:95],v[26:27]
v_pk_add_f32 v[28:29],v[28:29],v[96:97]
v_pk_fma_f32 v[26:27],v[96:97],v[96:97],v[26:27]
v_pk_add_f32 v[28:29],v[28:29],v[98:99]
v_pk_fma_f32 v[26:27],v[98:99],v[98:99],v[26:27]
v_pk_add_f32 v[28:29],v[28:29],v[100:101]
v_pk_fma_f32 v[26:27],v[100:101],v[100:101],v[26:27]
v_pk_add_f32 v[28:29],v[28:29],v[102:103]
v_pk_fma_f32 v[26:27],v[102:103],v[102:103],v[26:27]
v_pk_add_f32 v[28:29],v[28:29],v[104:105]
v_pk_fma_f32 v[26:27],v[104:105],v[104:105],v[26:27]
v_pk_add_f32 v[28:29],v[28:29],v[106:107]
v_pk_fma_f32 v[26:27],v[106:107],v[106:107],v[26:27]
v_pk_add_f32 v[28:29],v[28:29],v[108:109]
v_pk_fma_f32 v[26:27],v[108:109],v[108:109],v[26:27]
v_pk_add_f32 v[28:29],v[28:29],v[110:111]
v_pk_fma_f32 v[26:27],v[110:111],v[110:111],v[26:27]
v_add_f32 v24,v28,v29
v_add_f32 v25,v26,v27
s_nop 0
v_add_f32_dpp v24,v24,v24 row_ror:4 row_mask:0xf bank_mask:0xf
v_add_f32_dpp v25,v25,v25 row_ror:4 row_mask:0xf bank_mask:0xf
s_nop 0
v_add_f32_dpp v24,v24,v24 row_ror:8 row_mask:0xf bank_mask:0xf
v_add_f32_dpp v25,v25,v25 row_ror:8 row_mask:0xf bank_mask:0xf
v_mov_b32 v26,v24
v_mov_b32 v27,v25
s_nop 0
v_permlane32_swap_b32 v24,v26
v_permlane32_swap_b32 v25,v27
v_add_f32 v24,v24,v26
v_add_f32 v25,v25,v27
v_mov_b32 v26,v24
v_mov_b32 v27,v25
s_nop 0
v_permlane16_swap_b32 v24,v26
v_permlane16_swap_b32 v25,v27
v_add_f32 v24,v24,v26
v_add_f32 v25,v25,v27
v_mul_f32 v24,0x3acccccd,v24
v_mul_f32 v25,0x3acccccd,v25
v_fma_f32 v25,-v24,v24,v25
v_max_f32 v25,0,v25
v_cvt_pk_bf16_f32 v6,v24,v25
v_lshlrev_b32 v24,16,v6
v_and_b32 v25,0xffff0000,v6
v_add_f32 v25,0x3727c5ac,v25
v_cvt_pk_bf16_f32 v6,v25,v25
v_lshlrev_b32 v25,16,v6
v_sqrt_f32 v25,v25
s_nop 0
v_cvt_pk_bf16_f32 v6,v25,v25
v_lshlrev_b32 v25,16,v6
v_rcp_f32 v25,v25
s_nop 0
v_pk_add_f32 v[72:73],v[72:73],v[24:25] op_sel_hi:[1,0] neg_lo:[0,1] neg_hi:[0,1]
v_pk_add_f32 v[74:75],v[74:75],v[24:25] op_sel_hi:[1,0] neg_lo:[0,1] neg_hi:[0,1]
v_pk_add_f32 v[76:77],v[76:77],v[24:25] op_sel_hi:[1,0] neg_lo:[0,1] neg_hi:[0,1]
v_pk_add_f32 v[78:79],v[78:79],v[24:25] op_sel_hi:[1,0] neg_lo:[0,1] neg_hi:[0,1]
v_pk_add_f32 v[80:81],v[80:81],v[24:25] op_sel_hi:[1,0] neg_lo:[0,1] neg_hi:[0,1]
v_pk_add_f32 v[82:83],v[82:83],v[24:25] op_sel_hi:[1,0] neg_lo:[0,1] neg_hi:[0,1]
v_pk_add_f32 v[84:85],v[84:85],v[24:25] op_sel_hi:[1,0] neg_lo:[0,1] neg_hi:[0,1]
v_pk_add_f32 v[86:87],v[86:87],v[24:25] op_sel_hi:[1,0] neg_lo:[0,1] neg_hi:[0,1]
v_pk_add_f32 v[88:89],v[88:89],v[24:25] op_sel_hi:[1,0] neg_lo:[0,1] neg_hi:[0,1]
v_pk_add_f32 v[90:91],v[90:91],v[24:25] op_sel_hi:[1,0] neg_lo:[0,1] neg_hi:[0,1]
v_pk_add_f32 v[92:93],v[92:93],v[24:25] op_sel_hi:[1,0] neg_lo:[0,1] neg_hi:[0,1]
v_pk_add_f32 v[94:95],v[94:95],v[24:25] op_sel_hi:[1,0] neg_lo:[0,1] neg_hi:[0,1]
v_pk_add_f32 v[96:97],v[96:97],v[24:25] op_sel_hi:[1,0] neg_lo:[0,1] neg_hi:[0,1]
v_pk_add_f32 v[98:99],v[98:99],v[24:25] op_sel_hi:[1,0] neg_lo:[0,1] neg_hi:[0,1]
v_pk_add_f32 v[100:101],v[100:101],v[24:25] op_sel_hi:[1,0] neg_lo:[0,1] neg_hi:[0,1]
v_pk_add_f32 v[102:103],v[102:103],v[24:25] op_sel_hi:[1,0] neg_lo:[0,1] neg_hi:[0,1]
v_pk_add_f32 v[104:105],v[104:105],v[24:25] op_sel_hi:[1,0] neg_lo:[0,1] neg_hi:[0,1]
v_pk_add_f32 v[106:107],v[106:107],v[24:25] op_sel_hi:[1,0] neg_lo:[0,1] neg_hi:[0,1]
v_pk_add_f32 v[108:109],v[108:109],v[24:25] op_sel_hi:[1,0] neg_lo:[0,1] neg_hi:[0,1]
v_pk_add_f32 v[110:111],v[110:111],v[24:25] op_sel_hi:[1,0] neg_lo:[0,1] neg_hi:[0,1]
v_cvt_pk_bf16_f32 v6,v72,v73
v_lshlrev_b32 v72,16,v6
v_and_b32 v73,0xffff0000,v6
v_cvt_pk_bf16_f32 v8,v74,v75
v_lshlrev_b32 v74,16,v8
v_and_b32 v75,0xffff0000,v8
v_cvt_pk_bf16_f32 v6,v76,v77
v_lshlrev_b32 v76,16,v6
v_and_b32 v77,0xffff0000,v6
v_cvt_pk_bf16_f32 v8,v78,v79
v_lshlrev_b32 v78,16,v8
v_and_b32 v79,0xffff0000,v8
v_cvt_pk_bf16_f32 v6,v80,v81
v_lshlrev_b32 v80,16,v6
v_and_b32 v81,0xffff0000,v6
v_cvt_pk_bf16_f32 v8,v82,v83
v_lshlrev_b32 v82,16,v8
v_and_b32 v83,0xffff0000,v8
v_cvt_pk_bf16_f32 v6,v84,v85
v_lshlrev_b32 v84,16,v6
v_and_b32 v85,0xffff0000,v6
v_cvt_pk_bf16_f32 v8,v86,v87
v_lshlrev_b32 v86,16,v8
v_and_b32 v87,0xffff0000,v8
v_cvt_pk_bf16_f32 v6,v88,v89
v_lshlrev_b32 v88,16,v6
v_and_b32 v89,0xffff0000,v6
v_cvt_pk_bf16_f32 v8,v90,v91
v_lshlrev_b32 v90,16,v8
v_and_b32 v91,0xffff0000,v8
v_cvt_pk_bf16_f32 v6,v92,v93
v_lshlrev_b32 v92,16,v6
v_and_b32 v93,0xffff0000,v6
v_cvt_pk_bf16_f32 v8,v94,v95
v_lshlrev_b32 v94,16,v8
v_and_b32 v95,0xffff0000,v8
v_cvt_pk_bf16_f32 v6,v96,v97
v_lshlrev_b32 v96,16,v6
v_and_b32 v97,0xffff0000,v6
v_cvt_pk_bf16_f32 v8,v98,v99
v_lshlrev_b32 v98,16,v8
v_and_b32 v99,0xffff0000,v8
v_cvt_pk_bf16_f32 v6,v100,v101
v_lshlrev_b32 v100,16,v6
v_and_b32 v101,0xffff0000,v6
v_cvt_pk_bf16_f32 v8,v102,v103
v_lshlrev_b32 v102,16,v8
v_and_b32 v103,0xffff0000,v8
v_cvt_pk_bf16_f32 v6,v104,v105
v_lshlrev_b32 v104,16,v6
v_and_b32 v105,0xffff0000,v6
v_cvt_pk_bf16_f32 v8,v106,v107
v_lshlrev_b32 v106,16,v8
v_and_b32 v107,0xffff0000,v8
v_cvt_pk_bf16_f32 v6,v108,v109
v_lshlrev_b32 v108,16,v6
v_and_b32 v109,0xffff0000,v6
v_cvt_pk_bf16_f32 v8,v110,v111
v_lshlrev_b32 v110,16,v8
v_and_b32 v111,0xffff0000,v8
v_pk_mul_f32 v[72:73],v[72:73],v[24:25] op_sel:[0,1] op_sel_hi:[1,1]
v_pk_mul_f32 v[74:75],v[74:75],v[24:25] op_sel:[0,1] op_sel_hi:[1,1]
v_pk_mul_f32 v[76:77],v[76:77],v[24:25] op_sel:[0,1] op_sel_hi:[1,1]
v_pk_mul_f32 v[78:79],v[78:79],v[24:25] op_sel:[0,1] op_sel_hi:[1,1]
v_pk_mul_f32 v[80:81],v[80:81],v[24:25] op_sel:[0,1] op_sel_hi:[1,1]
v_pk_mul_f32 v[82:83],v[82:83],v[24:25] op_sel:[0,1] op_sel_hi:[1,1]
v_pk_mul_f32 v[84:85],v[84:85],v[24:25] op_sel:[0,1] op_sel_hi:[1,1]
v_pk_mul_f32 v[86:87],v[86:87],v[24:25] op_sel:[0,1] op_sel_hi:[1,1]
v_pk_mul_f32 v[88:89],v[88:89],v[24:25] op_sel:[0,1] op_sel_hi:[1,1]
v_pk_mul_f32 v[90:91],v[90:91],v[24:25] op_sel:[0,1] op_sel_hi:[1,1]
v_pk_mul_f32 v[92:93],v[92:93],v[24:25] op_sel:[0,1] op_sel_hi:[1,1]
v_pk_mul_f32 v[94:95],v[94:95],v[24:25] op_sel:[0,1] op_sel_hi:[1,1]
v_pk_mul_f32 v[96:97],v[96:97],v[24:25] op_sel:[0,1] op_sel_hi:[1,1]
v_pk_mul_f32 v[98:99],v[98:99],v[24:25] op_sel:[0,1] op_sel_hi:[1,1]
v_pk_mul_f32 v[100:101],v[100:101],v[24:25] op_sel:[0,1] op_sel_hi:[1,1]
v_pk_mul_f32 v[102:103],v[102:103],v[24:25] op_sel:[0,1] op_sel_hi:[1,1]
v_pk_mul_f32 v[104:105],v[104:105],v[24:25] op_sel:[0,1] op_sel_hi:[1,1]
v_pk_mul_f32 v[106:107],v[106:107],v[24:25] op_sel:[0,1] op_sel_hi:[1,1]
v_pk_mul_f32 v[108:109],v[108:109],v[24:25] op_sel:[0,1] op_sel_hi:[1,1]
v_pk_mul_f32 v[110:111],v[110:111],v[24:25] op_sel:[0,1] op_sel_hi:[1,1]
v_cvt_pk_bf16_f32 v112,v72,v73
v_lshlrev_b32 v72,16,v112
v_and_b32 v73,0xffff0000,v112
v_cvt_pk_bf16_f32 v113,v74,v75
v_lshlrev_b32 v74,16,v113
v_and_b32 v75,0xffff0000,v113
v_cvt_pk_bf16_f32 v114,v76,v77
v_lshlrev_b32 v76,16,v114
v_and_b32 v77,0xffff0000,v114
v_cvt_pk_bf16_f32 v115,v78,v79
v_lshlrev_b32 v78,16,v115
v_and_b32 v79,0xffff0000,v115
v_cvt_pk_bf16_f32 v116,v80,v81
v_lshlrev_b32 v80,16,v116
v_and_b32 v81,0xffff0000,v116
v_cvt_pk_bf16_f32 v117,v82,v83
v_lshlrev_b32 v82,16,v117
v_and_b32 v83,0xffff0000,v117
v_cvt_pk_bf16_f32 v118,v84,v85
v_lshlrev_b32 v84,16,v118
v_and_b32 v85,0xffff0000,v118
v_cvt_pk_bf16_f32 v119,v86,v87
v_lshlrev_b32 v86,16,v119
v_and_b32 v87,0xffff0000,v119
v_cvt_pk_bf16_f32 v120,v88,v89
v_lshlrev_b32 v88,16,v120
v_and_b32 v89,0xffff0000,v120
v_cvt_pk_bf16_f32 v121,v90,v91
v_lshlrev_b32 v90,16,v121
v_and_b32 v91,0xffff0000,v121
v_cvt_pk_bf16_f32 v122,v92,v93
v_lshlrev_b32 v92,16,v122
v_and_b32 v93,0xffff0000,v122
v_cvt_pk_bf16_f32 v123,v94,v95
v_lshlrev_b32 v94,16,v123
v_and_b32 v95,0xffff0000,v123
v_cvt_pk_bf16_f32 v124,v96,v97
v_lshlrev_b32 v96,16,v124
v_and_b32 v97,0xffff0000,v124
v_cvt_pk_bf16_f32 v125,v98,v99
v_lshlrev_b32 v98,16,v125
v_and_b32 v99,0xffff0000,v125
v_cvt_pk_bf16_f32 v126,v100,v101
v_lshlrev_b32 v100,16,v126
v_and_b32 v101,0xffff0000,v126
v_cvt_pk_bf16_f32 v127,v102,v103
v_lshlrev_b32 v102,16,v127
v_and_b32 v103,0xffff0000,v127
v_cvt_pk_bf16_f32 v128,v104,v105
v_lshlrev_b32 v104,16,v128
v_and_b32 v105,0xffff0000,v128
v_cvt_pk_bf16_f32 v129,v106,v107
v_lshlrev_b32 v106,16,v129
v_and_b32 v107,0xffff0000,v129
v_cvt_pk_bf16_f32 v130,v108,v109
v_lshlrev_b32 v108,16,v130
v_and_b32 v109,0xffff0000,v130
v_cvt_pk_bf16_f32 v131,v110,v111
v_lshlrev_b32 v110,16,v131
v_and_b32 v111,0xffff0000,v131
s_add_u32 s63,s65,0
v_permlane16_swap_b32 v112,v114
v_permlane16_swap_b32 v113,v115
buffer_store_dwordx4 v[112:115],v132,s[8:11],s63 offen sc1
s_add_u32 s63,s65,8192
v_permlane16_swap_b32 v116,v118
v_permlane16_swap_b32 v117,v119
buffer_store_dwordx4 v[116:119],v132,s[8:11],s63 offen sc1
s_add_u32 s63,s65,16384
v_permlane16_swap_b32 v120,v122
v_permlane16_swap_b32 v121,v123
buffer_store_dwordx4 v[120:123],v132,s[8:11],s63 offen sc1
s_add_u32 s63,s65,24576
v_permlane16_swap_b32 v124,v126
v_permlane16_swap_b32 v125,v127
buffer_store_dwordx4 v[124:127],v132,s[8:11],s63 offen sc1
s_add_u32 s63,s65,32768
v_permlane16_swap_b32 v128,v130
v_permlane16_swap_b32 v129,v131
buffer_store_dwordx4 v[128:131],v132,s[8:11],s63 offen sc1
s_add_u32 s63,s64,0
v_permlane16_swap_b32 v52,v54
v_permlane16_swap_b32 v53,v55
buffer_store_dwordx4 v[52:55],v132,s[8:11],s63 offen sc1
s_add_u32 s63,s64,8192
v_permlane16_swap_b32 v56,v58
v_permlane16_swap_b32 v57,v59
buffer_store_dwordx4 v[56:59],v132,s[8:11],s63 offen sc1
s_add_u32 s63,s64,16384
v_permlane16_swap_b32 v60,v62
v_permlane16_swap_b32 v61,v63
buffer_store_dwordx4 v[60:63],v132,s[8:11],s63 offen sc1
s_add_u32 s63,s64,24576
v_permlane16_swap_b32 v64,v66
v_permlane16_swap_b32 v65,v67
buffer_store_dwordx4 v[64:67],v132,s[8:11],s63 offen sc1
s_add_u32 s63,s64,32768
v_permlane16_swap_b32 v68,v70
v_permlane16_swap_b32 v69,v71
buffer_store_dwordx4 v[68:71],v132,s[8:11],s63 offen sc1
s_lshl_b32 s82,s55,6
s_add_u32 s82,s82,s54
s_lshl_b32 s82,s82,9
s_add_u32 s82,s82,0
s_lshl_b32 s61,s53,2
s_add_u32 s82,s82,s61
s_add_u32 s54,s54,16
s_cmp_lt_u32 s54,64
s_cbranch_scc1 R0_LOOPA
R0_ENDA:
s_waitcnt vmcnt(0)
s_mov_b64 exec,1
buffer_store_dword v5,v1,s[8:11],s82 offen sc1
s_mov_b64 exec,-1
s_mov_b32 s52,s86
s_mul_i32 s60,s86,196608
s_add_u32 s69,s69,s60
s_mul_i32 s60,s86,1024
s_add_u32 s70,s70,s60
v_mov_b32 v231,0
s_mov_b32 s83,s100
s_nop 0
ATT_LOOP:
s_lshl_b32 s67,s51,6
s_add_u32 s67,s67,s52
s_lshl_b32 s67,s67,9
s_add_u32 s67,s67,65536
s_mul_i32 s66,s52,393216
s_add_u32 s66,s66,s71
v_cmp_eq_u32 vcc,0,v231
s_nop 0
s_cbranch_vccz ATT_RDY
fb_233:
buffer_load_dword v3,v2,s[8:11],s67 offen sc1
s_waitcnt vmcnt(0)
v_cmp_eq_u32 vcc,0,v3
s_nop 0
s_cbranch_vccz ok_234
s_sleep 20
s_sub_u32 s47,s47,1
s_cbranch_scc1 ABORT
s_branch fb_233
ok_234:
ATT_RDY:
s_add_u32 s63,s66,124780544
buffer_load_dwordx4 v[16:19],v1,s[8:11],s63 offen sc1
buffer_load_dwordx4 v[20:23],v1,s[8:11],s63 offen offset:1024 sc1
buffer_load_dwordx4 v[24:27],v1,s[8:11],s63 offen offset:2048 sc1
buffer_load_dwordx4 v[28:31],v1,s[8:11],s63 offen offset:3072 sc1
s_add_u32 s63,s66,124784640
buffer_load_dwordx4 v[32:35],v1,s[8:11],s63 offen sc1
buffer_load_dwordx4 v[36:39],v1,s[8:11],s63 offen offset:1024 sc1
buffer_load_dwordx4 v[40:43],v1,s[8:11],s63 offen offset:2048 sc1
buffer_load_dwordx4 v[44:47],v1,s[8:11],s63 offen offset:3072 sc1
s_add_u32 s63,s66,124788736
buffer_load_dwordx4 v[48:51],v1,s[8:11],s63 offen sc1
buffer_load_dwordx4 v[52:55],v1,s[8:11],s63 offen offset:1024 sc1
buffer_load_dwordx4 v[56:59],v1,s[8:11],s63 offen offset:2048 sc1
buffer_load_dwordx4 v[60:63],v1,s[8:11],s63 offen offset:3072 sc1
s_add_u32 s63,s66,74448896
buffer_load_dwordx4 v[64:67],v1,s[8:11],s63 offen sc1
buffer_load_dwordx4 v[68:71],v1,s[8:11],s63 offen offset:1024 sc1
buffer_load_dwordx4 v[72:75],v1,s[8:11],s63 offen offset:2048 sc1
buffer_load_dwordx4 v[76:79],v1,s[8:11],s63 offen offset:3072 sc1
s_add_u32 s63,s66,74452992
buffer_load_dwordx4 v[80:83],v1,s[8:11],s63 offen sc1
buffer_load_dwordx4 v[84:87],v1,s[8:11],s63 offen offset:1024 sc1
buffer_load_dwordx4 v[88:91],v1,s[8:11],s63 offen offset:2048 sc1
buffer_load_dwordx4 v[92:95],v1,s[8:11],s63 offen offset:3072 sc1
s_add_u32 s63,s66,74457088
buffer_load_dwordx4 v[96:99],v1,s[8:11],s63 offen sc1
buffer_load_dwordx4 v[100:103],v1,s[8:11],s63 offen offset:1024 sc1
buffer_load_dwordx4 v[104:107],v1,s[8:11],s63 offen offset:2048 sc1
buffer_load_dwordx4 v[108:111],v1,s[8:11],s63 offen offset:3072 sc1
s_add_u32 s63,s66,99614720
buffer_load_dwordx4 v[112:115],v1,s[8:11],s63 offen sc1
buffer_load_dwordx4 v[116:119],v1,s[8:11],s63 offen offset:1024 sc1
buffer_load_dwordx4 v[120:123],v1,s[8:11],s63 offen offset:2048 sc1
buffer_load_dwordx4 v[124:127],v1,s[8:11],s63 offen offset:3072 sc1
s_add_u32 s63,s66,99618816
buffer_load_dwordx4 v[128:131],v1,s[8:11],s63 offen sc1
buffer_load_dwordx4 v[132:135],v1,s[8:11],s63 offen offset:1024 sc1
buffer_load_dwordx4 v[136:139],v1,s[8:11],s63 offen offset:2048 sc1
buffer_load_dwordx4 v[140:143],v1,s[8:11],s63 offen offset:3072 sc1
s_add_u32 s63,s66,99622912
buffer_load_dwordx4 v[144:147],v1,s[8:11],s63 offen sc1
buffer_load_dwordx4 v[148:151],v1,s[8:11],s63 offen offset:1024 sc1
buffer_load_dwordx4 v[152:155],v1,s[8:11],s63 offen offset:2048 sc1
buffer_load_dwordx4 v[156:159],v1,s[8:11],s63 offen offset:3072 sc1
v_lshlrev_b32 v232,7,v0
s_add_u32 s63,s66,149946368
buffer_load_dword v233,v232,s[8:11],s63 offen sc1
s_add_u32 s63,s66,149950464
buffer_load_dword v233,v232,s[8:11],s63 offen sc1
s_waitcnt vmcnt(14)
v_mfma_f32_16x16x32_bf16 v[184:187],v[64:67],v[16:19],0
v_mfma_f32_16x16x32_bf16 v[188:191],v[64:67],v[20:23],0
v_mfma_f32_16x16x32_bf16 v[192:195],v[68:71],v[20:23],0
v_mfma_f32_16x16x32_bf16 v[184:187],v[72:75],v[24:27],v[184:187]
v_mfma_f32_16x16x32_bf16 v[188:191],v[72:75],v[28:31],v[188:191]
v_mfma_f32_16x16x32_bf16 v[192:195],v[76:79],v[28:31],v[192:195]
v_mfma_f32_16x16x32_bf16 v[184:187],v[80:83],v[32:35],v[184:187]
v_mfma_f32_16x16x32_bf16 v[188:191],v[80:83],v[36:39],v[188:191]
v_mfma_f32_16x16x32_bf16 v[192:195],v[84:87],v[36:39],v[192:195]
v_mfma_f32_16x16x32_bf16 v[184:187],v[88:91],v[40:43],v[184:187]
v_mfma_f32_16x16x32_bf16 v[188:191],v[88:91],v[44:47],v[188:191]
v_mfma_f32_16x16x32_bf16 v[192:195],v[92:95],v[44:47],v[192:195]
v_mfma_f32_16x16x32_bf16 v[184:187],v[96:99],v[48:51],v[184:187]
v_mfma_f32_16x16x32_bf16 v[188:191],v[96:99],v[52:55],v[188:191]
v_mfma_f32_16x16x32_bf16 v[192:195],v[100:103],v[52:55],v[192:195]
v_mfma_f32_16x16x32_bf16 v[184:187],v[104:107],v[56:59],v[184:187]
v_mfma_f32_16x16x32_bf16 v[188:191],v[104:107],v[60:63],v[188:191]
v_mfma_f32_16x16x32_bf16 v[192:195],v[108:111],v[60:63],v[192:195]
s_nop 1
v_cvt_pk_bf16_f32 v6,v184,v185
v_lshlrev_b32 v184,16,v6
v_and_b32 v185,0xffff0000,v6
v_cvt_pk_bf16_f32 v6,v186,v187
v_lshlrev_b32 v186,16,v6
v_and_b32 v187,0xffff0000,v6
v_cvt_pk_bf16_f32 v6,v188,v189
v_lshlrev_b32 v188,16,v6
v_and_b32 v189,0xffff0000,v6
v_cvt_pk_bf16_f32 v6,v190,v191
v_lshlrev_b32 v190,16,v6
v_and_b32 v191,0xffff0000,v6
v_cvt_pk_bf16_f32 v6,v192,v193
v_lshlrev_b32 v192,16,v6
v_and_b32 v193,0xffff0000,v6
v_cvt_pk_bf16_f32 v6,v194,v195
v_lshlrev_b32 v194,16,v6
v_and_b32 v195,0xffff0000,v6
v_mul_f32 v184,s84,v184
v_mul_f32 v185,s84,v185
v_mul_f32 v186,s84,v186
v_mul_f32 v187,s84,v187
v_mul_f32 v188,s84,v188
v_mul_f32 v189,s84,v189
v_mul_f32 v190,s84,v190
v_mul_f32 v191,s84,v191
v_mul_f32 v192,s84,v192
v_mul_f32 v193,s84,v193
v_mul_f32 v194,s84,v194
v_mul_f32 v195,s84,v195
v_cvt_pk_bf16_f32 v6,v184,v185
v_lshlrev_b32 v184,16,v6
v_and_b32 v185,0xffff0000,v6
v_cvt_pk_bf16_f32 v6,v186,v187
v_lshlrev_b32 v186,16,v6
v_and_b32 v187,0xffff0000,v6
v_cvt_pk_bf16_f32 v6,v188,v189
v_lshlrev_b32 v188,16,v6
v_and_b32 v189,0xffff0000,v6
v_cvt_pk_bf16_f32 v6,v190,v191
v_lshlrev_b32 v190,16,v6
v_and_b32 v191,0xffff0000,v6
v_cvt_pk_bf16_f32 v6,v192,v193
v_lshlrev_b32 v192,16,v6
v_and_b32 v193,0xffff0000,v6
v_cvt_pk_bf16_f32 v6,v194,v195
v_lshlrev_b32 v194,16,v6
v_and_b32 v195,0xffff0000,v6
v_cndmask_b32 v184,v230,v184,s[72:73]
v_cndmask_b32 v185,v230,v185,s[74:75]
v_cndmask_b32 v186,v230,v186,s[76:77]
v_cndmask_b32 v187,v230,v187,s[78:79]
v_cndmask_b32 v192,v230,v192,s[72:73]
v_cndmask_b32 v193,v230,v193,s[74:75]
v_cndmask_b32 v194,v230,v194,s[76:77]
v_cndmask_b32 v195,v230,v195,s[78:79]
s_nop 1
fb_235:
buffer_load_dword v3,v228,s[8:11],s70 offen sc1
s_waitcnt vmcnt(0)
v_cmp_eq_u32 vcc,0,v3
s_nop 0
s_cbranch_vccz ok_236
s_sleep 4
s_sub_u32 s47,s47,1
s_cbranch_scc1 ABORT
s_branch fb_235
ok_236:
buffer_load_dwordx4 v[160:163],v1,s[8:11],s69 offen sc1
buffer_load_dwordx4 v[164:167],v1,s[8:11],s69 offen offset:1024 sc1
buffer_load_dwordx4 v[168:171],v1,s[8:11],s69 offen offset:2048 sc1
s_add_u32 s63,s69,3072
buffer_load_dwordx4 v[172:175],v1,s[8:11],s63 offen sc1
buffer_load_dwordx4 v[176:179],v1,s[8:11],s63 offen offset:1024 sc1
buffer_load_dwordx4 v[180:183],v1,s[8:11],s63 offen offset:2048 sc1
buffer_load_dword v231,v2,s[8:11],s67 offen offset:1024 sc1
s_waitcnt vmcnt(4)
v_mfma_f32_16x16x32_bf16 v[196:199],v[160:163],v[16:19],0
v_mfma_f32_16x16x32_bf16 v[200:203],v[160:163],v[24:27],0
v_mfma_f32_16x16x32_bf16 v[204:207],v[160:163],v[20:23],0
v_mfma_f32_16x16x32_bf16 v[208:211],v[160:163],v[28:31],0
v_mfma_f32_16x16x32_bf16 v[196:199],v[164:167],v[32:35],v[196:199]
v_mfma_f32_16x16x32_bf16 v[200:203],v[164:167],v[40:43],v[200:203]
v_mfma_f32_16x16x32_bf16 v[204:207],v[164:167],v[36:39],v[204:207]
v_mfma_f32_16x16x32_bf16 v[208:211],v[164:167],v[44:47],v[208:211]
v_mfma_f32_16x16x32_bf16 v[196:199],v[168:171],v[48:51],v[196:199]
v_mfma_f32_16x16x32_bf16 v[200:203],v[168:171],v[56:59],v[200:203]
v_mfma_f32_16x16x32_bf16 v[204:207],v[168:171],v[52:55],v[204:207]
v_mfma_f32_16x16x32_bf16 v[208:211],v[168:171],v[60:63],v[208:211]
v_permlane32_swap_b32 v196,v197
s_nop 0
v_permlane32_swap_b32 v200,v201
v_permlane32_swap_b32 v198,v199
v_permlane32_swap_b32 v202,v203
v_add_f32 v196,v196,v201
v_add_f32 v197,v198,v203
v_permlane32_swap_b32 v204,v205
v_permlane32_swap_b32 v208,v209
v_permlane32_swap_b32 v206,v207
v_permlane32_swap_b32 v210,v211
v_add_f32 v204,v204,v209
v_add_f32 v205,v206,v211
v_cvt_pk_bf16_f32 v6,v196,v197
v_lshlrev_b32 v196,16,v6
v_and_b32 v197,0xffff0000,v6
v_cvt_pk_bf16_f32 v6,v204,v205
v_lshlrev_b32 v204,16,v6
v_and_b32 v205,0xffff0000,v6
v_mul_f32 v196,s84,v196
v_mul_f32 v197,s84,v197
v_mul_f32 v204,s84,v204
v_mul_f32 v205,s84,v205
v_cvt_pk_bf16_f32 v6,v196,v197
v_lshlrev_b32 v196,16,v6
v_and_b32 v197,0xffff0000,v6
v_cvt_pk_bf16_f32 v6,v204,v205
v_lshlrev_b32 v204,16,v6
v_and_b32 v205,0xffff0000,v6
v_max3_f32 v6,v184,v185,v186
v_max3_f32 v6,v6,v187,v196
v_max_f32 v6,v6,v197
v_mov_b32 v7,v6
s_nop 1
v_permlane32_swap_b32 v6,v7
v_max_f32 v6,v6,v7
v_mov_b32 v7,v6
s_nop 1
v_permlane16_swap_b32 v6,v7
v_max_f32 v6,v6,v7
v_mul_f32 v6,s85,v6
v_fma_f32 v184,v184,s85,-v6
v_fma_f32 v185,v185,s85,-v6
v_fma_f32 v186,v186,s85,-v6
v_fma_f32 v187,v187,s85,-v6
v_fma_f32 v196,v196,s85,-v6
v_fma_f32 v197,v197,s85,-v6
v_exp_f32 v184,v184
v_exp_f32 v185,v185
v_exp_f32 v186,v186
v_exp_f32 v187,v187
v_exp_f32 v196,v196
v_exp_f32 v197,v197
v_add_f32 v6,v184,v185
v_add_f32 v6,v6,v186
v_add_f32 v6,v6,v187
v_add_f32 v6,v6,v196
v_add_f32 v6,v6,v197
v_mov_b32 v7,v6
s_nop 1
v_permlane32_swap_b32 v6,v7
v_add_f32 v6,v6,v7
v_mov_b32 v7,v6
s_nop 1
v_permlane16_swap_b32 v6,v7
v_add_f32 v6,v6,v7
v_rcp_f32 v6,v6
s_nop 0
v_mul_f32 v184,v184,v6
v_mul_f32 v185,v185,v6
v_mul_f32 v186,v186,v6
v_mul_f32 v187,v187,v6
v_mul_f32 v196,v196,v6
v_mul_f32 v197,v197,v6
v_cvt_pk_bf16_f32 v212,v184,v185
v_cvt_pk_bf16_f32 v213,v186,v187
v_mov_b32 v214,0
v_mov_b32 v215,0
v_cvt_pk_bf16_f32 v216,v196,v197
v_mov_b32 v217,0
v_mov_b32 v218,0
v_cvt_pk_bf16_f32 v219,v196,v197
v_max3_f32 v8,v188,v189,v190
v_max3_f32 v8,v8,v191,v192
v_max3_f32 v8,v8,v193,v194
v_max3_f32 v8,v8,v195,v204
v_max_f32 v8,v8,v205
v_mov_b32 v9,v8
s_nop 1
v_permlane32_swap_b32 v8,v9
v_max_f32 v8,v8,v9
v_mov_b32 v9,v8
s_nop 1
v_permlane16_swap_b32 v8,v9
v_max_f32 v8,v8,v9
v_mul_f32 v8,s85,v8
v_fma_f32 v188,v188,s85,-v8
v_fma_f32 v189,v189,s85,-v8
v_fma_f32 v190,v190,s85,-v8
v_fma_f32 v191,v191,s85,-v8
v_fma_f32 v192,v192,s85,-v8
v_fma_f32 v193,v193,s85,-v8
v_fma_f32 v194,v194,s85,-v8
v_fma_f32 v195,v195,s85,-v8
v_fma_f32 v204,v204,s85,-v8
v_fma_f32 v205,v205,s85,-v8
v_exp_f32 v188,v188
v_exp_f32 v189,v189
v_exp_f32 v190,v190
v_exp_f32 v191,v191
v_exp_f32 v192,v192
v_exp_f32 v193,v193
v_exp_f32 v194,v194
v_exp_f32 v195,v195
v_exp_f32 v204,v204
v_exp_f32 v205,v205
v_add_f32 v8,v188,v189
v_add_f32 v8,v8,v190
v_add_f32 v8,v8,v191
v_add_f32 v8,v8,v192
v_add_f32 v8,v8,v193
v_add_f32 v8,v8,v194
v_add_f32 v8,v8,v195
v_add_f32 v8,v8,v204
v_add_f32 v8,v8,v205
v_mov_b32 v9,v8
s_nop 1
v_permlane32_swap_b32 v8,v9
v_add_f32 v8,v8,v9
v_mov_b32 v9,v8
s_nop 1
v_permlane16_swap_b32 v8,v9
v_add_f32 v8,v8,v9
v_rcp_f32 v8,v8
s_nop 0
v_mul_f32 v188,v188,v8
v_mul_f32 v189,v189,v8
v_mul_f32 v190,v190,v8
v_mul_f32 v191,v191,v8
v_mul_f32 v192,v192,v8
v_mul_f32 v193,v193,v8
v_mul_f32 v194,v194,v8
v_mul_f32 v195,v195,v8
v_mul_f32 v204,v204,v8
v_mul_f32 v205,v205,v8
v_cvt_pk_bf16_f32 v220,v188,v189
v_cvt_pk_bf16_f32 v221,v190,v191
v_cvt_pk_bf16_f32 v222,v192,v193
v_cvt_pk_bf16_f32 v223,v194,v195
v_cvt_pk_bf16_f32 v224,v204,v205
v_mov_b32 v225,0
v_mov_b32 v226,0
v_cvt_pk_bf16_f32 v227,v204,v205
s_waitcnt vmcnt(1)
s_add_u32 s66,s66,149946368
v_mfma_f32_16x16x32_bf16 v[16:19],v[112:115],v[212:215],0
v_mfma_f32_16x16x32_bf16 v[20:23],v[116:119],v[212:215],0
v_mfma_f32_16x16x32_bf16 v[24:27],v[120:123],v[212:215],0
v_mfma_f32_16x16x32_bf16 v[28:31],v[124:127],v[212:215],0
v_mfma_f32_16x16x32_bf16 v[32:35],v[128:131],v[212:215],0
v_mfma_f32_16x16x32_bf16 v[36:39],v[132:135],v[212:215],0
v_mfma_f32_16x16x32_bf16 v[40:43],v[136:139],v[212:215],0
v_mfma_f32_16x16x32_bf16 v[44:47],v[140:143],v[212:215],0
v_mfma_f32_16x16x32_bf16 v[48:51],v[144:147],v[212:215],0
v_mfma_f32_16x16x32_bf16 v[52:55],v[148:151],v[212:215],0
v_mfma_f32_16x16x32_bf16 v[56:59],v[152:155],v[212:215],0
v_mfma_f32_16x16x32_bf16 v[60:63],v[156:159],v[212:215],0
v_mfma_f32_16x16x16_bf16 v[16:19],v[172:173],v[216:217],v[16:19]
v_mfma_f32_16x16x16_bf16 v[20:23],v[172:173],v[218:219],v[20:23]
v_mfma_f32_16x16x16_bf16 v[24:27],v[174:175],v[216:217],v[24:27]
v_mfma_f32_16x16x16_bf16 v[28:31],v[174:175],v[218:219],v[28:31]
v_mfma_f32_16x16x16_bf16 v[32:35],v[176:177],v[216:217],v[32:35]
v_mfma_f32_16x16x16_bf16 v[36:39],v[176:177],v[218:219],v[36:39]
v_mfma_f32_16x16x16_bf16 v[40:43],v[178:179],v[216:217],v[40:43]
v_mfma_f32_16x16x16_bf16 v[44:47],v[178:179],v[218:219],v[44:47]
v_mfma_f32_16x16x16_bf16 v[48:51],v[180:181],v[216:217],v[48:51]
v_mfma_f32_16x16x16_bf16 v[52:55],v[180:181],v[218:219],v[52:55]
v_mfma_f32_16x16x16_bf16 v[56:59],v[182:183],v[216:217],v[56:59]
v_mfma_f32_16x16x16_bf16 v[60:63],v[182:183],v[218:219],v[60:63]
v_mfma_f32_16x16x32_bf16 v[64:67],v[112:115],v[220:223],0
v_mfma_f32_16x16x32_bf16 v[68:71],v[116:119],v[220:223],0
v_mfma_f32_16x16x32_bf16 v[72:75],v[120:123],v[220:223],0
v_mfma_f32_16x16x32_bf16 v[76:79],v[124:127],v[220:223],0
v_mfma_f32_16x16x32_bf16 v[80:83],v[128:131],v[220:223],0
v_mfma_f32_16x16x32_bf16 v[84:87],v[132:135],v[220:223],0
v_mfma_f32_16x16x32_bf16 v[88:91],v[136:139],v[220:223],0
v_mfma_f32_16x16x32_bf16 v[92:95],v[140:143],v[220:223],0
v_mfma_f32_16x16x32_bf16 v[96:99],v[144:147],v[220:223],0
v_mfma_f32_16x16x32_bf16 v[100:103],v[148:151],v[220:223],0
v_mfma_f32_16x16x32_bf16 v[104:107],v[152:155],v[220:223],0
v_mfma_f32_16x16x32_bf16 v[108:111],v[156:159],v[220:223],0
v_mfma_f32_16x16x16_bf16 v[64:67],v[172:173],v[224:225],v[64:67]
v_mfma_f32_16x16x16_bf16 v[68:71],v[172:173],v[226:227],v[68:71]
v_mfma_f32_16x16x16_bf16 v[72:75],v[174:175],v[224:225],v[72:75]
v_mfma_f32_16x16x16_bf16 v[76:79],v[174:175],v[226:227],v[76:79]
v_mfma_f32_16x16x16_bf16 v[80:83],v[176:177],v[224:225],v[80:83]
v_mfma_f32_16x16x16_bf16 v[84:87],v[176:177],v[226:227],v[84:87]
v_mfma_f32_16x16x16_bf16 v[88:91],v[178:179],v[224:225],v[88:91]
v_mfma_f32_16x16x16_bf16 v[92:95],v[178:179],v[226:227],v[92:95]
v_mfma_f32_16x16x16_bf16 v[96:99],v[180:181],v[224:225],v[96:99]
v_mfma_f32_16x16x16_bf16 v[100:103],v[180:181],v[226:227],v[100:103]
v_mfma_f32_16x16x16_bf16 v[104:107],v[182:183],v[224:225],v[104:107]
v_mfma_f32_16x16x16_bf16 v[108:111],v[182:183],v[226:227],v[108:111]
s_cmp_lg_u32 s49,0
s_nop 5
s_cbranch_scc1 ATT_OS
v_cvt_pk_bf16_f32 v232,v16,v17
v_cvt_pk_bf16_f32 v233,v18,v19
v_cvt_pk_bf16_f32 v234,v20,v21
v_cvt_pk_bf16_f32 v235,v22,v23
s_add_u32 s63,s66,0
buffer_store_dwordx4 v[232:235],v229,s[8:11],s63 offen offset:0
v_cvt_pk_bf16_f32 v236,v24,v25
v_cvt_pk_bf16_f32 v237,v26,v27
v_cvt_pk_bf16_f32 v238,v28,v29
v_cvt_pk_bf16_f32 v239,v30,v31
buffer_store_dwordx4 v[236:239],v229,s[8:11],s63 offen offset:2048
v_cvt_pk_bf16_f32 v232,v32,v33
v_cvt_pk_bf16_f32 v233,v34,v35
v_cvt_pk_bf16_f32 v234,v36,v37
v_cvt_pk_bf16_f32 v235,v38,v39
s_add_u32 s63,s66,4096
buffer_store_dwordx4 v[232:235],v229,s[8:11],s63 offen offset:0
v_cvt_pk_bf16_f32 v236,v40,v41
v_cvt_pk_bf16_f32 v237,v42,v43
v_cvt_pk_bf16_f32 v238,v44,v45
v_cvt_pk_bf16_f32 v239,v46,v47
buffer_store_dwordx4 v[236:239],v229,s[8:11],s63 offen offset:2048
v_cvt_pk_bf16_f32 v232,v48,v49
v_cvt_pk_bf16_f32 v233,v50,v51
v_cvt_pk_bf16_f32 v234,v52,v53
v_cvt_pk_bf16_f32 v235,v54,v55
s_add_u32 s63,s66,8192
buffer_store_dwordx4 v[232:235],v229,s[8:11],s63 offen offset:0
v_cvt_pk_bf16_f32 v236,v56,v57
v_cvt_pk_bf16_f32 v237,v58,v59
v_cvt_pk_bf16_f32 v238,v60,v61
v_cvt_pk_bf16_f32 v239,v62,v63
buffer_store_dwordx4 v[236:239],v229,s[8:11],s63 offen offset:2048
v_cvt_pk_bf16_f32 v232,v64,v65
v_cvt_pk_bf16_f32 v233,v66,v67
v_cvt_pk_bf16_f32 v234,v68,v69
v_cvt_pk_bf16_f32 v235,v70,v71
s_add_u32 s63,s66,256
buffer_store_dwordx4 v[232:235],v229,s[8:11],s63 offen offset:0
v_cvt_pk_bf16_f32 v236,v72,v73
v_cvt_pk_bf16_f32 v237,v74,v75
v_cvt_pk_bf16_f32 v238,v76,v77
v_cvt_pk_bf16_f32 v239,v78,v79
buffer_store_dwordx4 v[236:239],v229,s[8:11],s63 offen offset:2048
v_cvt_pk_bf16_f32 v232,v80,v81
v_cvt_pk_bf16_f32 v233,v82,v83
v_cvt_pk_bf16_f32 v234,v84,v85
v_cvt_pk_bf16_f32 v235,v86,v87
s_add_u32 s63,s66,4352
buffer_store_dwordx4 v[232:235],v229,s[8:11],s63 offen offset:0
v_cvt_pk_bf16_f32 v236,v88,v89
v_cvt_pk_bf16_f32 v237,v90,v91
v_cvt_pk_bf16_f32 v238,v92,v93
v_cvt_pk_bf16_f32 v239,v94,v95
buffer_store_dwordx4 v[236:239],v229,s[8:11],s63 offen offset:2048
v_cvt_pk_bf16_f32 v232,v96,v97
v_cvt_pk_bf16_f32 v233,v98,v99
v_cvt_pk_bf16_f32 v234,v100,v101
v_cvt_pk_bf16_f32 v235,v102,v103
s_add_u32 s63,s66,8448
buffer_store_dwordx4 v[232:235],v229,s[8:11],s63 offen offset:0
v_cvt_pk_bf16_f32 v236,v104,v105
v_cvt_pk_bf16_f32 v237,v106,v107
v_cvt_pk_bf16_f32 v238,v108,v109
v_cvt_pk_bf16_f32 v239,v110,v111
buffer_store_dwordx4 v[236:239],v229,s[8:11],s63 offen offset:2048
s_lshl_b32 s60,s51,6
s_add_u32 s60,s60,s52
s_lshl_b32 s60,s60,9
s_add_u32 s60,s60,262144
s_lshl_b32 s61,s87,2
s_add_u32 s60,s60,s61
s_waitcnt vmcnt(0)
s_mov_b64 exec,1
buffer_store_dword v5,v1,s[8:11],s60 offen
s_mov_b64 exec,-1
s_branch ATT_OJ
ATT_OS:
v_cvt_pk_bf16_f32 v232,v16,v17
v_cvt_pk_bf16_f32 v233,v18,v19
v_cvt_pk_bf16_f32 v234,v20,v21
v_cvt_pk_bf16_f32 v235,v22,v23
s_add_u32 s63,s66,0
buffer_store_dwordx4 v[232:235],v229,s[8:11],s63 offen sc1
v_cvt_pk_bf16_f32 v236,v24,v25
v_cvt_pk_bf16_f32 v237,v26,v27
v_cvt_pk_bf16_f32 v238,v28,v29
v_cvt_pk_bf16_f32 v239,v30,v31
buffer_store_dwordx4 v[236:239],v229,s[8:11],s63 offen offset:2048 sc1
v_cvt_pk_bf16_f32 v232,v32,v33
v_cvt_pk_bf16_f32 v233,v34,v35
v_cvt_pk_bf16_f32 v234,v36,v37
v_cvt_pk_bf16_f32 v235,v38,v39
s_add_u32 s63,s66,4096
buffer_store_dwordx4 v[232:235],v229,s[8:11],s63 offen sc1
v_cvt_pk_bf16_f32 v236,v40,v41
v_cvt_pk_bf16_f32 v237,v42,v43
v_cvt_pk_bf16_f32 v238,v44,v45
v_cvt_pk_bf16_f32 v239,v46,v47
buffer_store_dwordx4 v[236:239],v229,s[8:11],s63 offen offset:2048 sc1
v_cvt_pk_bf16_f32 v232,v48,v49
v_cvt_pk_bf16_f32 v233,v50,v51
v_cvt_pk_bf16_f32 v234,v52,v53
v_cvt_pk_bf16_f32 v235,v54,v55
s_add_u32 s63,s66,8192
buffer_store_dwordx4 v[232:235],v229,s[8:11],s63 offen sc1
v_cvt_pk_bf16_f32 v236,v56,v57
v_cvt_pk_bf16_f32 v237,v58,v59
v_cvt_pk_bf16_f32 v238,v60,v61
v_cvt_pk_bf16_f32 v239,v62,v63
buffer_store_dwordx4 v[236:239],v229,s[8:11],s63 offen offset:2048 sc1
v_cvt_pk_bf16_f32 v232,v64,v65
v_cvt_pk_bf16_f32 v233,v66,v67
v_cvt_pk_bf16_f32 v234,v68,v69
v_cvt_pk_bf16_f32 v235,v70,v71
s_add_u32 s63,s66,256
buffer_store_dwordx4 v[232:235],v229,s[8:11],s63 offen sc1
v_cvt_pk_bf16_f32 v236,v72,v73
v_cvt_pk_bf16_f32 v237,v74,v75
v_cvt_pk_bf16_f32 v238,v76,v77
v_cvt_pk_bf16_f32 v239,v78,v79
buffer_store_dwordx4 v[236:239],v229,s[8:11],s63 offen offset:2048 sc1
v_cvt_pk_bf16_f32 v232,v80,v81
v_cvt_pk_bf16_f32 v233,v82,v83
v_cvt_pk_bf16_f32 v234,v84,v85
v_cvt_pk_bf16_f32 v235,v86,v87
s_add_u32 s63,s66,4352
buffer_store_dwordx4 v[232:235],v229,s[8:11],s63 offen sc1
v_cvt_pk_bf16_f32 v236,v88,v89
v_cvt_pk_bf16_f32 v237,v90,v91
v_cvt_pk_bf16_f32 v238,v92,v93
v_cvt_pk_bf16_f32 v239,v94,v95
buffer_store_dwordx4 v[236:239],v229,s[8:11],s63 offen offset:2048 sc1
v_cvt_pk_bf16_f32 v232,v96,v97
v_cvt_pk_bf16_f32 v233,v98,v99
v_cvt_pk_bf16_f32 v234,v100,v101
v_cvt_pk_bf16_f32 v235,v102,v103
s_add_u32 s63,s66,8448
buffer_store_dwordx4 v[232:235],v229,s[8:11],s63 offen sc1
v_cvt_pk_bf16_f32 v236,v104,v105
v_cvt_pk_bf16_f32 v237,v106,v107
v_cvt_pk_bf16_f32 v238,v108,v109
v_cvt_pk_bf16_f32 v239,v110,v111
buffer_store_dwordx4 v[236:239],v229,s[8:11],s63 offen offset:2048 sc1
s_lshl_b32 s60,s51,6
s_add_u32 s60,s60,s52
s_lshl_b32 s60,s60,9
s_add_u32 s60,s60,262144
s_lshl_b32 s61,s87,2
s_add_u32 s60,s60,s61
s_waitcnt vmcnt(0)
s_mov_b64 exec,1
buffer_store_dword v5,v1,s[8:11],s60 offen sc1
s_mov_b64 exec,-1
ATT_OJ:
s_add_u32 s69,s69,393216
s_add_u32 s70,s70,2048
s_add_u32 s52,s52,2
s_cmp_lt_u32 s52,64
s_cbranch_scc1 ATT_LOOP
s_endpgm
ROLE_WO:
v_lshlrev_b32 v1,4,v0
v_mov_b32 v5,1
s_lshl_b32 s56,s48,2
s_add_u32 s56,s56,s46
v_bfe_u32 v6,v0,2,2
v_lshrrev_b32 v7,4,v0
v_add_u32 v7,v6,v7
v_and_b32 v7,3,v7
v_and_b32 v15,3,v0
v_lshlrev_b32 v15,4,v15
v_lshl_add_u32 v15,v7,6,v15
v_lshl_add_u32 v15,v6,8,v15
v_lshrrev_b32 v6,5,v0
v_bfe_u32 v7,v0,4,1
v_lshlrev_b32 v208,10,v7
v_lshl_add_u32 v208,v6,8,v208
v_and_b32 v6,15,v0
v_lshl_add_u32 v208,v6,4,v208
v_lshrrev_b32 v6,5,v0
v_add_u32 v6,2,v6
v_bfe_u32 v7,v0,4,1
v_lshlrev_b32 v209,10,v7
v_lshl_add_u32 v209,v6,8,v209
v_and_b32 v6,15,v0
v_lshl_add_u32 v209,v6,4,v209
s_mul_i32 s64,s48,6554
s_lshr_b32 s64,s64,16
s_mul_i32 s60,s64,10
s_sub_u32 s65,s48,s60
v_min_u32 v2,1,v0
s_lshl_b32 s60,s64,4
s_add_u32 s60,s60,s46
s_lshl_b32 s60,s60,1
v_add_u32 v2,s60,v2
v_lshlrev_b32 v2,2,v2
s_and_b32 s60,s46,1
s_lshl_b32 s68,s65,1
s_add_u32 s68,s68,s60
s_lshr_b32 s69,s46,1
s_mul_i32 s71,s46,24576
s_mul_i32 s58,s46,491520
s_lshl_b32 s61,s65,7
s_add_u32 s58,s58,s61
s_mul_i32 s61,s64,1966080
s_add_u32 s58,s58,s61
s_mul_i32 s61,s64,98304
s_add_u32 s71,s71,s61
s_add_u32 s71,s71,149946368
v_bfe_u32 v6,v0,2,2
v_mul_u32_u24 v205,10240,v6
v_and_b32 v6,3,v0
v_lshl_add_u32 v205,v6,4,v205
v_lshrrev_b32 v6,4,v0
v_lshl_add_u32 v205,v6,6,v205
s_mul_i32 s74,s64,81920
s_mul_i32 s61,s69,40960
s_add_u32 s74,s74,s61
s_lshl_b32 s61,s68,9
s_add_u32 s74,s74,s61
s_add_u32 s74,s74,175112192
s_lshl1_add_u32 s75,s48,s60
s_lshl_b32 s75,s75,2
s_mul_i32 s61,s69,320
s_add_u32 s75,s75,s61
s_add_u32 s75,s75,819200
v_bfe_u32 v6,v0,4,1
v_lshlrev_b32 v206,14,v6
v_lshrrev_b32 v6,5,v0
v_lshl_add_u32 v206,v6,8,v206
v_and_b32 v6,15,v0
v_lshl_add_u32 v206,v6,4,v206
s_lshl_b32 s60,s46,11
v_add_u32 v206,s60,v206
s_lshl_b32 s60,s46,13
v_add_u32 v207,s60,v1
s_waitcnt vmcnt(0)
s_barrier
s_cmp_lg_u32 s46,0
s_cbranch_scc1 arr_237
v_mov_b32 v6,1
s_lshl_b32 s3,s49,2
v_mov_b32 v7,s3
s_mov_b64 exec,1
buffer_atomic_add v6,v7,s[12:15],0 offen sc1
s_mov_b64 exec,-1
arr_237:
s_mul_i32 s63,s46,40960
s_mov_b32 s4,s26
s_mov_b32 s5,s27
s_mov_b32 s6,7864320
s_mov_b32 s7,0x20000
v_lshrrev_b32 v9,3,v0
s_mov_b32 s64,1280
v_mul_lo_u32 v9,v9,s64
v_and_b32 v10,7,v0
v_lshl_add_u32 v6,v10,4,v9
s_add_u32 m0,s63,0
s_add_u32 s65,s58,0
buffer_load_dwordx4 v6,s[4:7],s65 offen lds
s_add_u32 m0,s63,1024
s_add_u32 s65,s58,10240
buffer_load_dwordx4 v6,s[4:7],s65 offen lds
s_add_u32 m0,s63,2048
s_add_u32 s65,s58,20480
buffer_load_dwordx4 v6,s[4:7],s65 offen lds
s_add_u32 m0,s63,3072
s_add_u32 s65,s58,30720
buffer_load_dwordx4 v6,s[4:7],s65 offen lds
s_add_u32 m0,s63,4096
s_add_u32 s65,s58,40960
buffer_load_dwordx4 v6,s[4:7],s65 offen lds
s_add_u32 m0,s63,5120
s_add_u32 s65,s58,51200
buffer_load_dwordx4 v6,s[4:7],s65 offen lds
s_add_u32 m0,s63,6144
s_add_u32 s65,s58,61440
buffer_load_dwordx4 v6,s[4:7],s65 offen lds
s_add_u32 m0,s63,7168
s_add_u32 s65,s58,71680
buffer_load_dwordx4 v6,s[4:7],s65 offen lds
s_add_u32 m0,s63,8192
s_add_u32 s65,s58,81920
buffer_load_dwordx4 v6,s[4:7],s65 offen lds
s_add_u32 m0,s63,9216
s_add_u32 s65,s58,92160
buffer_load_dwordx4 v6,s[4:7],s65 offen lds
s_add_u32 m0,s63,10240
s_add_u32 s65,s58,102400
buffer_load_dwordx4 v6,s[4:7],s65 offen lds
s_add_u32 m0,s63,11264
s_add_u32 s65,s58,112640
buffer_load_dwordx4 v6,s[4:7],s65 offen lds
s_add_u32 m0,s63,12288
s_add_u32 s65,s58,122880
buffer_load_dwordx4 v6,s[4:7],s65 offen lds
s_add_u32 m0,s63,13312
s_add_u32 s65,s58,133120
buffer_load_dwordx4 v6,s[4:7],s65 offen lds
s_add_u32 m0,s63,14336
s_add_u32 s65,s58,143360
buffer_load_dwordx4 v6,s[4:7],s65 offen lds
s_add_u32 m0,s63,15360
s_add_u32 s65,s58,153600
buffer_load_dwordx4 v6,s[4:7],s65 offen lds
s_add_u32 m0,s63,16384
s_add_u32 s65,s58,163840
buffer_load_dwordx4 v6,s[4:7],s65 offen lds
s_add_u32 m0,s63,17408
s_add_u32 s65,s58,174080
buffer_load_dwordx4 v6,s[4:7],s65 offen lds
s_add_u32 m0,s63,18432
s_add_u32 s65,s58,184320
buffer_load_dwordx4 v6,s[4:7],s65 offen lds
s_add_u32 m0,s63,19456
s_add_u32 s65,s58,194560
buffer_load_dwordx4 v6,s[4:7],s65 offen lds
s_add_u32 m0,s63,20480
s_add_u32 s65,s58,204800
buffer_load_dwordx4 v6,s[4:7],s65 offen lds
s_add_u32 m0,s63,21504
s_add_u32 s65,s58,215040
buffer_load_dwordx4 v6,s[4:7],s65 offen lds
s_add_u32 m0,s63,22528
s_add_u32 s65,s58,225280
buffer_load_dwordx4 v6,s[4:7],s65 offen lds
s_add_u32 m0,s63,23552
s_add_u32 s65,s58,235520
buffer_load_dwordx4 v6,s[4:7],s65 offen lds
s_add_u32 m0,s63,24576
s_add_u32 s65,s58,245760
buffer_load_dwordx4 v6,s[4:7],s65 offen lds
s_add_u32 m0,s63,25600
s_add_u32 s65,s58,256000
buffer_load_dwordx4 v6,s[4:7],s65 offen lds
s_add_u32 m0,s63,26624
s_add_u32 s65,s58,266240
buffer_load_dwordx4 v6,s[4:7],s65 offen lds
s_add_u32 m0,s63,27648
s_add_u32 s65,s58,276480
buffer_load_dwordx4 v6,s[4:7],s65 offen lds
s_add_u32 m0,s63,28672
s_add_u32 s65,s58,286720
buffer_load_dwordx4 v6,s[4:7],s65 offen lds
s_add_u32 m0,s63,29696
s_add_u32 s65,s58,296960
buffer_load_dwordx4 v6,s[4:7],s65 offen lds
s_add_u32 m0,s63,30720
s_add_u32 s65,s58,307200
buffer_load_dwordx4 v6,s[4:7],s65 offen lds
s_add_u32 m0,s63,31744
s_add_u32 s65,s58,317440
buffer_load_dwordx4 v6,s[4:7],s65 offen lds
s_add_u32 m0,s63,32768
s_add_u32 s65,s58,327680
buffer_load_dwordx4 v6,s[4:7],s65 offen lds
s_add_u32 m0,s63,33792
s_add_u32 s65,s58,337920
buffer_load_dwordx4 v6,s[4:7],s65 offen lds
s_add_u32 m0,s63,34816
s_add_u32 s65,s58,348160
buffer_load_dwordx4 v6,s[4:7],s65 offen lds
s_add_u32 m0,s63,35840
s_add_u32 s65,s58,358400
buffer_load_dwordx4 v6,s[4:7],s65 offen lds
s_add_u32 m0,s63,36864
s_add_u32 s65,s58,368640
buffer_load_dwordx4 v6,s[4:7],s65 offen lds
s_add_u32 m0,s63,37888
s_add_u32 s65,s58,378880
buffer_load_dwordx4 v6,s[4:7],s65 offen lds
s_add_u32 m0,s63,38912
s_add_u32 s65,s58,389120
buffer_load_dwordx4 v6,s[4:7],s65 offen lds
s_add_u32 m0,s63,39936
s_add_u32 s65,s58,399360
buffer_load_dwordx4 v6,s[4:7],s65 offen lds
s_waitcnt vmcnt(20)
v_bfe_u32 v9,v0,2,2
v_lshrrev_b32 v10,5,v0
v_lshl_add_u32 v9,v10,2,v9
v_mul_u32_u24 v9,128,v9
v_and_b32 v10,1,v0
v_lshl_add_u32 v9,v10,3,v9
v_bfe_u32 v10,v0,1,1
v_lshl_add_u32 v9,v10,5,v9
v_bfe_u32 v10,v0,4,1
v_lshl_add_u32 v9,v10,4,v9
v_add_u32 v7,s63,v9
ds_read_b64_tr_b16 a[0:1],v7 offset:0
ds_read_b64_tr_b16 a[2:3],v7 offset:2048
ds_read_b64_tr_b16 a[4:5],v7 offset:1024
ds_read_b64_tr_b16 a[6:7],v7 offset:3072
ds_read_b64_tr_b16 a[96:97],v7 offset:64
ds_read_b64_tr_b16 a[98:99],v7 offset:2112
ds_read_b64_tr_b16 a[100:101],v7 offset:1088
ds_read_b64_tr_b16 a[102:103],v7 offset:3136
ds_read_b64_tr_b16 a[8:9],v7 offset:4096
ds_read_b64_tr_b16 a[10:11],v7 offset:6144
ds_read_b64_tr_b16 a[12:13],v7 offset:5120
ds_read_b64_tr_b16 a[14:15],v7 offset:7168
s_waitcnt lgkmcnt(4)
ds_read_b64_tr_b16 a[104:105],v7 offset:4160
ds_read_b64_tr_b16 a[106:107],v7 offset:6208
ds_read_b64_tr_b16 a[108:109],v7 offset:5184
ds_read_b64_tr_b16 a[110:111],v7 offset:7232
ds_read_b64_tr_b16 a[16:17],v7 offset:8192
ds_read_b64_tr_b16 a[18:19],v7 offset:10240
ds_read_b64_tr_b16 a[20:21],v7 offset:9216
ds_read_b64_tr_b16 a[22:23],v7 offset:11264
ds_read_b64_tr_b16 a[112:113],v7 offset:8256
ds_read_b64_tr_b16 a[114:115],v7 offset:10304
ds_read_b64_tr_b16 a[116:117],v7 offset:9280
ds_read_b64_tr_b16 a[118:119],v7 offset:11328
s_waitcnt lgkmcnt(4)
ds_read_b64_tr_b16 a[24:25],v7 offset:12288
ds_read_b64_tr_b16 a[26:27],v7 offset:14336
ds_read_b64_tr_b16 a[28:29],v7 offset:13312
ds_read_b64_tr_b16 a[30:31],v7 offset:15360
ds_read_b64_tr_b16 a[120:121],v7 offset:12352
ds_read_b64_tr_b16 a[122:123],v7 offset:14400
ds_read_b64_tr_b16 a[124:125],v7 offset:13376
ds_read_b64_tr_b16 a[126:127],v7 offset:15424
ds_read_b64_tr_b16 a[32:33],v7 offset:16384
ds_read_b64_tr_b16 a[34:35],v7 offset:18432
ds_read_b64_tr_b16 a[36:37],v7 offset:17408
ds_read_b64_tr_b16 a[38:39],v7 offset:19456
s_waitcnt lgkmcnt(4)
ds_read_b64_tr_b16 a[128:129],v7 offset:16448
ds_read_b64_tr_b16 a[130:131],v7 offset:18496
ds_read_b64_tr_b16 a[132:133],v7 offset:17472
ds_read_b64_tr_b16 a[134:135],v7 offset:19520
s_waitcnt lgkmcnt(0)
s_add_u32 m0,s63,0
s_add_u32 s65,s58,409600
buffer_load_dwordx4 v6,s[4:7],s65 offen lds
s_add_u32 m0,s63,1024
s_add_u32 s65,s58,419840
buffer_load_dwordx4 v6,s[4:7],s65 offen lds
s_add_u32 m0,s63,2048
s_add_u32 s65,s58,430080
buffer_load_dwordx4 v6,s[4:7],s65 offen lds
s_add_u32 m0,s63,3072
s_add_u32 s65,s58,440320
buffer_load_dwordx4 v6,s[4:7],s65 offen lds
s_add_u32 m0,s63,4096
s_add_u32 s65,s58,450560
buffer_load_dwordx4 v6,s[4:7],s65 offen lds
s_add_u32 m0,s63,5120
s_add_u32 s65,s58,460800
buffer_load_dwordx4 v6,s[4:7],s65 offen lds
s_add_u32 m0,s63,6144
s_add_u32 s65,s58,471040
buffer_load_dwordx4 v6,s[4:7],s65 offen lds
s_add_u32 m0,s63,7168
s_add_u32 s65,s58,481280
buffer_load_dwordx4 v6,s[4:7],s65 offen lds
s_waitcnt vmcnt(8)
v_bfe_u32 v9,v0,2,2
v_lshrrev_b32 v10,5,v0
v_lshl_add_u32 v9,v10,2,v9
v_mul_u32_u24 v9,128,v9
v_and_b32 v10,1,v0
v_lshl_add_u32 v9,v10,3,v9
v_bfe_u32 v10,v0,1,1
v_lshl_add_u32 v9,v10,5,v9
v_bfe_u32 v10,v0,4,1
v_lshl_add_u32 v9,v10,4,v9
v_add_u32 v7,s63,v9
ds_read_b64_tr_b16 a[40:41],v7 offset:20480
ds_read_b64_tr_b16 a[42:43],v7 offset:22528
ds_read_b64_tr_b16 a[44:45],v7 offset:21504
ds_read_b64_tr_b16 a[46:47],v7 offset:23552
ds_read_b64_tr_b16 a[136:137],v7 offset:20544
ds_read_b64_tr_b16 a[138:139],v7 offset:22592
ds_read_b64_tr_b16 a[140:141],v7 offset:21568
ds_read_b64_tr_b16 a[142:143],v7 offset:23616
ds_read_b64_tr_b16 a[48:49],v7 offset:24576
ds_read_b64_tr_b16 a[50:51],v7 offset:26624
ds_read_b64_tr_b16 a[52:53],v7 offset:25600
ds_read_b64_tr_b16 a[54:55],v7 offset:27648
s_waitcnt lgkmcnt(4)
ds_read_b64_tr_b16 a[144:145],v7 offset:24640
ds_read_b64_tr_b16 a[146:147],v7 offset:26688
ds_read_b64_tr_b16 a[148:149],v7 offset:25664
ds_read_b64_tr_b16 a[150:151],v7 offset:27712
ds_read_b64_tr_b16 a[56:57],v7 offset:28672
ds_read_b64_tr_b16 a[58:59],v7 offset:30720
ds_read_b64_tr_b16 a[60:61],v7 offset:29696
ds_read_b64_tr_b16 a[62:63],v7 offset:31744
ds_read_b64_tr_b16 a[152:153],v7 offset:28736
ds_read_b64_tr_b16 a[154:155],v7 offset:30784
ds_read_b64_tr_b16 a[156:157],v7 offset:29760
ds_read_b64_tr_b16 a[158:159],v7 offset:31808
s_waitcnt lgkmcnt(4)
ds_read_b64_tr_b16 a[64:65],v7 offset:32768
ds_read_b64_tr_b16 a[66:67],v7 offset:34816
ds_read_b64_tr_b16 a[68:69],v7 offset:33792
ds_read_b64_tr_b16 a[70:71],v7 offset:35840
ds_read_b64_tr_b16 a[160:161],v7 offset:32832
ds_read_b64_tr_b16 a[162:163],v7 offset:34880
ds_read_b64_tr_b16 a[164:165],v7 offset:33856
ds_read_b64_tr_b16 a[166:167],v7 offset:35904
ds_read_b64_tr_b16 a[72:73],v7 offset:36864
ds_read_b64_tr_b16 a[74:75],v7 offset:38912
ds_read_b64_tr_b16 a[76:77],v7 offset:37888
ds_read_b64_tr_b16 a[78:79],v7 offset:39936
s_waitcnt lgkmcnt(4)
ds_read_b64_tr_b16 a[168:169],v7 offset:36928
ds_read_b64_tr_b16 a[170:171],v7 offset:38976
ds_read_b64_tr_b16 a[172:173],v7 offset:37952
ds_read_b64_tr_b16 a[174:175],v7 offset:40000
s_waitcnt lgkmcnt(0)
s_waitcnt vmcnt(0)
v_bfe_u32 v9,v0,2,2
v_lshrrev_b32 v10,5,v0
v_lshl_add_u32 v9,v10,2,v9
v_mul_u32_u24 v9,128,v9
v_and_b32 v10,1,v0
v_lshl_add_u32 v9,v10,3,v9
v_bfe_u32 v10,v0,1,1
v_lshl_add_u32 v9,v10,5,v9
v_bfe_u32 v10,v0,4,1
v_lshl_add_u32 v9,v10,4,v9
v_add_u32 v7,s63,v9
ds_read_b64_tr_b16 a[80:81],v7 offset:0
ds_read_b64_tr_b16 a[82:83],v7 offset:2048
ds_read_b64_tr_b16 a[84:85],v7 offset:1024
ds_read_b64_tr_b16 a[86:87],v7 offset:3072
ds_read_b64_tr_b16 a[176:177],v7 offset:64
ds_read_b64_tr_b16 a[178:179],v7 offset:2112
ds_read_b64_tr_b16 a[180:181],v7 offset:1088
ds_read_b64_tr_b16 a[182:183],v7 offset:3136
ds_read_b64_tr_b16 a[88:89],v7 offset:4096
ds_read_b64_tr_b16 a[90:91],v7 offset:6144
ds_read_b64_tr_b16 a[92:93],v7 offset:5120
ds_read_b64_tr_b16 a[94:95],v7 offset:7168
s_waitcnt lgkmcnt(4)
ds_read_b64_tr_b16 a[184:185],v7 offset:4160
ds_read_b64_tr_b16 a[186:187],v7 offset:6208
ds_read_b64_tr_b16 a[188:189],v7 offset:5184
ds_read_b64_tr_b16 a[190:191],v7 offset:7232
s_waitcnt lgkmcnt(0)
s_barrier
s_lshl_b32 s3,s49,2
v_mov_b32 v7,s3
s_nop 1
ibw_238:
buffer_load_dword v6,v7,s[12:15],0 offen sc1
s_waitcnt vmcnt(0)
v_cmp_ne_u32 vcc,256,v6
s_nop 0
s_cbranch_vccz ok_239
s_sleep 8
s_sub_u32 s47,s47,1
s_cbranch_scc1 ABORT
s_branch ibw_238
ok_239:
s_cmp_lg_u32 s49,0
s_cbranch_scc1 ibok_240
v_and_b32 v7,7,v0
v_lshlrev_b32 v7,2,v7
buffer_load_dword v6,v7,s[12:15],0 offen offset:32 sc1
s_waitcnt vmcnt(0)
v_cmp_ne_u32 vcc,32,v6
s_nop 0
s_cbranch_vccz ibok_240
s_barrier
s_mov_b32 s49,1
s_mov_b32 s3,s2
s_load_dwordx16 s[16:31],s[0:1],0
s_load_dwordx8 s[32:39],s[0:1],64
s_waitcnt lgkmcnt(0)
s_branch DISPATCH
ibok_240:
s_mov_b32 s83,s100
s_mov_b32 s32,0
s_mov_b32 s59,2147483648
s_min_u32 s62,s32,127
s_sub_u32 s60,s62,13
s_lshr_b32 s34,s60,1
s_and_b32 s33,s60,1
s_cmp_eq_u32 s33,0
s_cselect_b32 s61,13,0
s_add_u32 s34,s34,s61
s_sub_u32 s61,s60,51
s_cmp_ge_u32 s60,102
s_cselect_b32 s34,s61,s34
s_cselect_b32 s33,1,s33
s_cmp_lt_u32 s62,13
s_cselect_b32 s34,s62,s34
s_cselect_b32 s33,0,s33
s_lshl_b32 s35,s33,6
s_add_u32 s35,s35,s34
s_lshl_b32 s35,s35,9
s_add_u32 s35,s35,262144
s_mul_i32 s73,s34,393216
s_add_u32 s73,s73,s71
WO_COLD:
fb_241:
buffer_load_dword v3,v2,s[8:11],s35 offen sc1
s_waitcnt vmcnt(0)
v_cmp_eq_u32 vcc,0,v3
s_nop 0
s_cbranch_vccz ok_242
s_sleep 1
s_sub_u32 s47,s47,1
s_cbranch_scc1 ABORT
s_branch fb_241
ok_242:
s_add_u32 s63,s73,0
buffer_load_dwordx4 v[16:19],v1,s[8:11],s63 offen sc1
s_nop 7
buffer_load_dwordx4 v[20:23],v1,s[8:11],s63 offen offset:1024 sc1
s_nop 7
buffer_load_dwordx4 v[24:27],v1,s[8:11],s63 offen offset:2048 sc1
s_nop 7
buffer_load_dwordx4 v[28:31],v1,s[8:11],s63 offen offset:3072 sc1
s_nop 7
s_add_u32 s63,s73,4096
buffer_load_dwordx4 v[32:35],v1,s[8:11],s63 offen sc1
s_nop 7
buffer_load_dwordx4 v[36:39],v1,s[8:11],s63 offen offset:1024 sc1
WO_C:
s_mov_b32 s51,s33
s_mov_b32 s52,s34
s_mov_b32 s72,s73
s_add_u32 s32,s32,1
s_waitcnt vmcnt(5)
v_mfma_f32_32x32x16_bf16 v[112:127],a[0:3],v[16:19],0
s_add_u32 s63,s72,4096
buffer_load_dwordx4 v[40:43],v1,s[8:11],s63 offen offset:2048 sc1
s_min_u32 s62,s32,127
s_sub_u32 s60,s62,13
s_lshr_b32 s34,s60,1
v_mfma_f32_32x32x16_bf16 v[128:143],a[96:99],v[16:19],0
s_and_b32 s33,s60,1
s_cmp_eq_u32 s33,0
s_cselect_b32 s61,13,0
s_add_u32 s34,s34,s61
s_sub_u32 s61,s60,51
v_xor_b32 v206,0x8000,v206
s_waitcnt vmcnt(5)
v_mfma_f32_32x32x16_bf16 v[112:127],a[4:7],v[20:23],v[112:127]
buffer_load_dwordx4 v[44:47],v1,s[8:11],s63 offen offset:3072 sc1
s_add_u32 s63,s72,8192
s_cmp_ge_u32 s60,102
s_cselect_b32 s34,s61,s34
s_cselect_b32 s33,1,s33
v_mfma_f32_32x32x16_bf16 v[128:143],a[100:103],v[20:23],v[128:143]
s_cmp_lt_u32 s62,13
s_cselect_b32 s34,s62,s34
s_cselect_b32 s33,0,s33
s_lshl_b32 s35,s33,6
s_add_u32 s35,s35,s34
s_lshl_b32 s35,s35,9
s_waitcnt vmcnt(5)
v_mfma_f32_32x32x16_bf16 v[112:127],a[8:11],v[24:27],v[112:127]
buffer_load_dwordx4 v[48:51],v1,s[8:11],s63 offen sc1
s_add_u32 s35,s35,262144
s_mul_i32 s73,s34,393216
s_add_u32 s73,s73,s71
v_xor_b32 v207,0x8000,v207
v_mfma_f32_32x32x16_bf16 v[128:143],a[104:107],v[24:27],v[128:143]
s_mul_i32 s40,s52,491520
s_add_u32 s40,s40,s74
s_lshl_b32 s65,s51,6
s_add_u32 s65,s65,s52
s_mul_i32 s65,s65,640
s_add_u32 s42,s65,s75
s_waitcnt vmcnt(5)
v_mfma_f32_32x32x16_bf16 v[112:127],a[12:15],v[28:31],v[112:127]
buffer_load_dwordx4 v[52:55],v1,s[8:11],s63 offen offset:1024 sc1
v_mfma_f32_32x32x16_bf16 v[128:143],a[108:111],v[28:31],v[128:143]
s_waitcnt vmcnt(5)
v_mfma_f32_32x32x16_bf16 v[112:127],a[16:19],v[32:35],v[112:127]
buffer_load_dwordx4 v[56:59],v1,s[8:11],s63 offen offset:2048 sc1
v_mfma_f32_32x32x16_bf16 v[128:143],a[112:115],v[32:35],v[128:143]
s_waitcnt vmcnt(5)
v_mfma_f32_32x32x16_bf16 v[112:127],a[20:23],v[36:39],v[112:127]
buffer_load_dwordx4 v[60:63],v1,s[8:11],s63 offen offset:3072 sc1
s_add_u32 s63,s72,12288
v_mfma_f32_32x32x16_bf16 v[128:143],a[116:119],v[36:39],v[128:143]
s_waitcnt vmcnt(5)
v_mfma_f32_32x32x16_bf16 v[112:127],a[24:27],v[40:43],v[112:127]
buffer_load_dwordx4 v[64:67],v1,s[8:11],s63 offen sc1
v_mfma_f32_32x32x16_bf16 v[128:143],a[120:123],v[40:43],v[128:143]
s_waitcnt vmcnt(5)
v_mfma_f32_32x32x16_bf16 v[112:127],a[28:31],v[44:47],v[112:127]
buffer_load_dwordx4 v[68:71],v1,s[8:11],s63 offen offset:1024 sc1
v_mfma_f32_32x32x16_bf16 v[128:143],a[124:127],v[44:47],v[128:143]
s_waitcnt vmcnt(5)
v_mfma_f32_32x32x16_bf16 v[112:127],a[32:35],v[48:51],v[112:127]
buffer_load_dwordx4 v[72:75],v1,s[8:11],s63 offen offset:2048 sc1
v_mfma_f32_32x32x16_bf16 v[128:143],a[128:131],v[48:51],v[128:143]
s_waitcnt vmcnt(5)
v_mfma_f32_32x32x16_bf16 v[112:127],a[36:39],v[52:55],v[112:127]
buffer_load_dwordx4 v[76:79],v1,s[8:11],s63 offen offset:3072 sc1
s_add_u32 s63,s72,16384
v_mfma_f32_32x32x16_bf16 v[128:143],a[132:135],v[52:55],v[128:143]
s_waitcnt vmcnt(5)
v_mfma_f32_32x32x16_bf16 v[112:127],a[40:43],v[56:59],v[112:127]
buffer_load_dwordx4 v[80:83],v1,s[8:11],s63 offen sc1
v_mfma_f32_32x32x16_bf16 v[128:143],a[136:139],v[56:59],v[128:143]
buffer_load_dword v3,v2,s[8:11],s35 offen sc1
s_waitcnt vmcnt(6)
v_mfma_f32_32x32x16_bf16 v[112:127],a[44:47],v[60:63],v[112:127]
buffer_load_dwordx4 v[84:87],v1,s[8:11],s63 offen offset:1024 sc1
v_mfma_f32_32x32x16_bf16 v[128:143],a[140:143],v[60:63],v[128:143]
s_waitcnt vmcnt(6)
v_mfma_f32_32x32x16_bf16 v[112:127],a[48:51],v[64:67],v[112:127]
buffer_load_dwordx4 v[88:91],v1,s[8:11],s63 offen offset:2048 sc1
v_mfma_f32_32x32x16_bf16 v[128:143],a[144:147],v[64:67],v[128:143]
s_waitcnt vmcnt(6)
v_mfma_f32_32x32x16_bf16 v[112:127],a[52:55],v[68:71],v[112:127]
buffer_load_dwordx4 v[92:95],v1,s[8:11],s63 offen offset:3072 sc1
s_add_u32 s63,s72,20480
v_mfma_f32_32x32x16_bf16 v[128:143],a[148:151],v[68:71],v[128:143]
s_waitcnt vmcnt(6)
v_mfma_f32_32x32x16_bf16 v[112:127],a[56:59],v[72:75],v[112:127]
buffer_load_dwordx4 v[96:99],v1,s[8:11],s63 offen sc1
v_mfma_f32_32x32x16_bf16 v[128:143],a[152:155],v[72:75],v[128:143]
s_waitcnt vmcnt(6)
v_mfma_f32_32x32x16_bf16 v[112:127],a[60:63],v[76:79],v[112:127]
buffer_load_dwordx4 v[100:103],v1,s[8:11],s63 offen offset:1024 sc1
v_mfma_f32_32x32x16_bf16 v[128:143],a[156:159],v[76:79],v[128:143]
s_waitcnt vmcnt(6)
v_mfma_f32_32x32x16_bf16 v[112:127],a[64:67],v[80:83],v[112:127]
buffer_load_dwordx4 v[104:107],v1,s[8:11],s63 offen offset:2048 sc1
v_mfma_f32_32x32x16_bf16 v[128:143],a[160:163],v[80:83],v[128:143]
s_waitcnt vmcnt(6)
v_cmp_eq_u32 vcc,0,v3
s_cmp_eq_u64 vcc,0
s_cselect_b32 s37,0,2147483648
s_cmp_lt_u32 s32,128
s_cselect_b32 s37,s37,2147483648
s_waitcnt vmcnt(5)
v_mfma_f32_32x32x16_bf16 v[112:127],a[68:71],v[84:87],v[112:127]
buffer_load_dwordx4 v[108:111],v1,s[8:11],s63 offen offset:3072 sc1
s_add_u32 s67,s73,s37
s_add_u32 s63,s67,0
buffer_load_dwordx4 v[16:19],v1,s[8:11],s63 offen sc1
v_mfma_f32_32x32x16_bf16 v[128:143],a[164:167],v[84:87],v[128:143]
s_waitcnt vmcnt(6)
v_mfma_f32_32x32x16_bf16 v[112:127],a[72:75],v[88:91],v[112:127]
buffer_load_dwordx4 v[20:23],v1,s[8:11],s63 offen offset:1024 sc1
v_mfma_f32_32x32x16_bf16 v[128:143],a[168:171],v[88:91],v[128:143]
s_waitcnt vmcnt(6)
v_mfma_f32_32x32x16_bf16 v[112:127],a[76:79],v[92:95],v[112:127]
buffer_load_dwordx4 v[24:27],v1,s[8:11],s63 offen offset:2048 sc1
buffer_load_dword v3,v2,s[8:11],s35 offen sc1
v_mfma_f32_32x32x16_bf16 v[128:143],a[172:175],v[92:95],v[128:143]
s_waitcnt vmcnt(7)
v_mfma_f32_32x32x16_bf16 v[112:127],a[80:83],v[96:99],v[112:127]
buffer_load_dwordx4 v[28:31],v1,s[8:11],s63 offen offset:3072 sc1
s_add_u32 s63,s67,4096
s_waitcnt vmcnt(7)
v_mfma_f32_32x32x16_bf16 v[112:127],a[84:87],v[100:103],v[112:127]
s_waitcnt vmcnt(6)
v_mfma_f32_32x32x16_bf16 v[112:127],a[88:91],v[104:107],v[112:127]
buffer_load_dwordx4 v[32:35],v1,s[8:11],s63 offen sc1
s_waitcnt vmcnt(6)
v_mfma_f32_32x32x16_bf16 v[112:127],a[92:95],v[108:111],v[112:127]
v_mfma_f32_32x32x16_bf16 v[128:143],a[176:179],v[96:99],v[128:143]
buffer_load_dwordx4 v[36:39],v1,s[8:11],s63 offen offset:1024 sc1
v_mfma_f32_32x32x16_bf16 v[128:143],a[180:183],v[100:103],v[128:143]
ds_write_b128 v206,v[112:115] offset:0
ds_write_b128 v206,v[116:119] offset:1024
ds_write_b128 v206,v[120:123] offset:512
v_mfma_f32_32x32x16_bf16 v[128:143],a[184:187],v[104:107],v[128:143]
ds_write_b128 v206,v[124:127] offset:1536
v_mfma_f32_32x32x16_bf16 v[128:143],a[188:191],v[108:111],v[128:143]
s_mov_b32 s55,6
s_cmp_eq_u32 s37,0
s_cbranch_scc1 ep_243
s_waitcnt vmcnt(3)
v_cmp_eq_u32 vcc,0,v3
s_cmp_eq_u64 vcc,0
s_cselect_b32 s37,0,2147483648
s_cmp_lt_u32 s32,128
s_cselect_b32 s37,s37,2147483648
s_mov_b32 s55,0
ep_243:
s_nop 8
ds_write_b128 v206,v[128:131] offset:8192
ds_write_b128 v206,v[132:135] offset:9216
ds_write_b128 v206,v[136:139] offset:8704
ds_write_b128 v206,v[140:143] offset:9728
s_branch WO_E
WO_W:
s_mov_b32 s51,s33
s_mov_b32 s52,s34
s_mov_b32 s72,s73
s_add_u32 s32,s32,1
s_waitcnt vmcnt(11)
v_mfma_f32_32x32x16_bf16 v[112:127],a[0:3],v[16:19],0
s_add_u32 s63,s72,12288
buffer_load_dwordx4 v[64:67],v1,s[8:11],s63 offen sc1
s_min_u32 s62,s32,127
s_sub_u32 s60,s62,13
s_lshr_b32 s34,s60,1
v_mfma_f32_32x32x16_bf16 v[128:143],a[96:99],v[16:19],0
s_and_b32 s33,s60,1
s_cmp_eq_u32 s33,0
s_cselect_b32 s61,13,0
s_add_u32 s34,s34,s61
s_sub_u32 s61,s60,51
v_xor_b32 v206,0x8000,v206
s_waitcnt vmcnt(11)
v_mfma_f32_32x32x16_bf16 v[112:127],a[4:7],v[20:23],v[112:127]
buffer_load_dwordx4 v[68:71],v1,s[8:11],s63 offen offset:1024 sc1
s_cmp_ge_u32 s60,102
s_cselect_b32 s34,s61,s34
s_cselect_b32 s33,1,s33
v_xor_b32 v207,0x8000,v207
v_mfma_f32_32x32x16_bf16 v[128:143],a[100:103],v[20:23],v[128:143]
s_cmp_lt_u32 s62,13
s_cselect_b32 s34,s62,s34
s_cselect_b32 s33,0,s33
s_lshl_b32 s35,s33,6
s_add_u32 s35,s35,s34
s_lshl_b32 s35,s35,9
s_waitcnt vmcnt(11)
v_mfma_f32_32x32x16_bf16 v[112:127],a[8:11],v[24:27],v[112:127]
buffer_load_dwordx4 v[72:75],v1,s[8:11],s63 offen offset:2048 sc1
s_add_u32 s35,s35,262144
s_mul_i32 s73,s34,393216
s_add_u32 s73,s73,s71
s_mul_i32 s40,s52,491520
v_mfma_f32_32x32x16_bf16 v[128:143],a[104:107],v[24:27],v[128:143]
s_add_u32 s40,s40,s74
s_lshl_b32 s65,s51,6
s_add_u32 s65,s65,s52
s_mul_i32 s65,s65,640
s_add_u32 s42,s65,s75
s_waitcnt vmcnt(11)
v_mfma_f32_32x32x16_bf16 v[112:127],a[12:15],v[28:31],v[112:127]
buffer_load_dwordx4 v[76:79],v1,s[8:11],s63 offen offset:3072 sc1
s_add_u32 s63,s72,16384
v_mfma_f32_32x32x16_bf16 v[128:143],a[108:111],v[28:31],v[128:143]
s_waitcnt vmcnt(11)
v_mfma_f32_32x32x16_bf16 v[112:127],a[16:19],v[32:35],v[112:127]
buffer_load_dwordx4 v[80:83],v1,s[8:11],s63 offen sc1
v_mfma_f32_32x32x16_bf16 v[128:143],a[112:115],v[32:35],v[128:143]
buffer_load_dword v3,v2,s[8:11],s35 offen sc1
s_waitcnt vmcnt(12)
v_mfma_f32_32x32x16_bf16 v[112:127],a[20:23],v[36:39],v[112:127]
buffer_load_dwordx4 v[84:87],v1,s[8:11],s63 offen offset:1024 sc1
v_mfma_f32_32x32x16_bf16 v[128:143],a[116:119],v[36:39],v[128:143]
s_waitcnt vmcnt(12)
v_mfma_f32_32x32x16_bf16 v[112:127],a[24:27],v[40:43],v[112:127]
buffer_load_dwordx4 v[88:91],v1,s[8:11],s63 offen offset:2048 sc1
v_mfma_f32_32x32x16_bf16 v[128:143],a[120:123],v[40:43],v[128:143]
s_waitcnt vmcnt(12)
v_mfma_f32_32x32x16_bf16 v[112:127],a[28:31],v[44:47],v[112:127]
buffer_load_dwordx4 v[92:95],v1,s[8:11],s63 offen offset:3072 sc1
s_add_u32 s63,s72,20480
v_mfma_f32_32x32x16_bf16 v[128:143],a[124:127],v[44:47],v[128:143]
s_waitcnt vmcnt(12)
v_mfma_f32_32x32x16_bf16 v[112:127],a[32:35],v[48:51],v[112:127]
buffer_load_dwordx4 v[96:99],v1,s[8:11],s63 offen sc1
v_mfma_f32_32x32x16_bf16 v[128:143],a[128:131],v[48:51],v[128:143]
s_waitcnt vmcnt(12)
v_mfma_f32_32x32x16_bf16 v[112:127],a[36:39],v[52:55],v[112:127]
buffer_load_dwordx4 v[100:103],v1,s[8:11],s63 offen offset:1024 sc1
v_mfma_f32_32x32x16_bf16 v[128:143],a[132:135],v[52:55],v[128:143]
s_waitcnt vmcnt(12)
v_mfma_f32_32x32x16_bf16 v[112:127],a[40:43],v[56:59],v[112:127]
buffer_load_dwordx4 v[104:107],v1,s[8:11],s63 offen offset:2048 sc1
v_mfma_f32_32x32x16_bf16 v[128:143],a[136:139],v[56:59],v[128:143]
s_waitcnt vmcnt(11)
s_mov_b64 exec,1
buffer_store_dword v5,v1,s[8:11],s59 offen sc1
s_mov_b64 exec,-1
s_mov_b32 s59,2147483648
v_mfma_f32_32x32x16_bf16 v[112:127],a[44:47],v[60:63],v[112:127]
buffer_load_dwordx4 v[108:111],v1,s[8:11],s63 offen offset:3072 sc1
s_waitcnt vmcnt(8)
v_cmp_eq_u32 vcc,0,v3
s_cmp_eq_u64 vcc,0
s_cselect_b32 s37,0,2147483648
v_mfma_f32_32x32x16_bf16 v[128:143],a[140:143],v[60:63],v[128:143]
s_cmp_lt_u32 s32,128
s_cselect_b32 s37,s37,2147483648
s_add_u32 s67,s73,s37
s_add_u32 s63,s67,0
buffer_load_dwordx4 v[16:19],v1,s[8:11],s63 offen sc1
v_mfma_f32_32x32x16_bf16 v[112:127],a[48:51],v[64:67],v[112:127]
v_mfma_f32_32x32x16_bf16 v[128:143],a[144:147],v[64:67],v[128:143]
buffer_load_dwordx4 v[20:23],v1,s[8:11],s63 offen offset:1024 sc1
v_mfma_f32_32x32x16_bf16 v[112:127],a[52:55],v[68:71],v[112:127]
v_mfma_f32_32x32x16_bf16 v[128:143],a[148:151],v[68:71],v[128:143]
buffer_load_dwordx4 v[24:27],v1,s[8:11],s63 offen offset:2048 sc1
v_mfma_f32_32x32x16_bf16 v[112:127],a[56:59],v[72:75],v[112:127]
v_mfma_f32_32x32x16_bf16 v[128:143],a[152:155],v[72:75],v[128:143]
buffer_load_dwordx4 v[28:31],v1,s[8:11],s63 offen offset:3072 sc1
s_add_u32 s63,s67,4096
v_mfma_f32_32x32x16_bf16 v[112:127],a[60:63],v[76:79],v[112:127]
v_mfma_f32_32x32x16_bf16 v[128:143],a[156:159],v[76:79],v[128:143]
buffer_load_dwordx4 v[32:35],v1,s[8:11],s63 offen sc1
v_mfma_f32_32x32x16_bf16 v[112:127],a[64:67],v[80:83],v[112:127]
v_mfma_f32_32x32x16_bf16 v[128:143],a[160:163],v[80:83],v[128:143]
buffer_load_dwordx4 v[36:39],v1,s[8:11],s63 offen offset:1024 sc1
s_waitcnt vmcnt(13)
v_mfma_f32_32x32x16_bf16 v[112:127],a[68:71],v[84:87],v[112:127]
v_mfma_f32_32x32x16_bf16 v[128:143],a[164:167],v[84:87],v[128:143]
buffer_load_dwordx4 v[40:43],v1,s[8:11],s63 offen offset:2048 sc1
s_waitcnt vmcnt(13)
v_mfma_f32_32x32x16_bf16 v[112:127],a[72:75],v[88:91],v[112:127]
v_mfma_f32_32x32x16_bf16 v[128:143],a[168:171],v[88:91],v[128:143]
buffer_load_dwordx4 v[44:47],v1,s[8:11],s63 offen offset:3072 sc1
s_add_u32 s63,s67,8192
s_waitcnt vmcnt(13)
v_mfma_f32_32x32x16_bf16 v[112:127],a[76:79],v[92:95],v[112:127]
buffer_load_dword v3,v2,s[8:11],s35 offen sc1
v_mfma_f32_32x32x16_bf16 v[128:143],a[172:175],v[92:95],v[128:143]
buffer_load_dwordx4 v[48:51],v1,s[8:11],s63 offen sc1
s_waitcnt vmcnt(14)
v_mfma_f32_32x32x16_bf16 v[112:127],a[80:83],v[96:99],v[112:127]
s_waitcnt vmcnt(13)
v_mfma_f32_32x32x16_bf16 v[112:127],a[84:87],v[100:103],v[112:127]
buffer_load_dwordx4 v[52:55],v1,s[8:11],s63 offen offset:1024 sc1
s_waitcnt vmcnt(13)
v_mfma_f32_32x32x16_bf16 v[112:127],a[88:91],v[104:107],v[112:127]
s_waitcnt vmcnt(11)
v_mfma_f32_32x32x16_bf16 v[112:127],a[92:95],v[108:111],v[112:127]
buffer_load_dwordx4 v[56:59],v1,s[8:11],s63 offen offset:2048 sc1
v_mfma_f32_32x32x16_bf16 v[128:143],a[176:179],v[96:99],v[128:143]
v_mfma_f32_32x32x16_bf16 v[128:143],a[180:183],v[100:103],v[128:143]
buffer_load_dwordx4 v[60:63],v1,s[8:11],s63 offen offset:3072 sc1
ds_write_b128 v206,v[112:115] offset:0
ds_write_b128 v206,v[116:119] offset:1024
v_mfma_f32_32x32x16_bf16 v[128:143],a[184:187],v[104:107],v[128:143]
ds_write_b128 v206,v[120:123] offset:512
ds_write_b128 v206,v[124:127] offset:1536
v_mfma_f32_32x32x16_bf16 v[128:143],a[188:191],v[108:111],v[128:143]
s_mov_b32 s55,12
s_cmp_eq_u32 s37,0
s_cbranch_scc1 ep_244
s_waitcnt vmcnt(4)
v_cmp_eq_u32 vcc,0,v3
s_cmp_eq_u64 vcc,0
s_cselect_b32 s37,0,2147483648
s_cmp_lt_u32 s32,128
s_cselect_b32 s37,s37,2147483648
s_mov_b32 s55,0
ep_244:
s_nop 8
ds_write_b128 v206,v[128:131] offset:8192
ds_write_b128 v206,v[132:135] offset:9216
ds_write_b128 v206,v[136:139] offset:8704
ds_write_b128 v206,v[140:143] offset:9728
WO_E:
s_cmp_lg_u32 s37,0
s_cbranch_scc1 e2_245
s_cmp_eq_u32 s55,12
s_cbranch_scc1 e2_245
s_cmp_eq_u32 s55,6
s_cbranch_scc1 e2_245c
s_add_u32 s63,s73,0
buffer_load_dwordx4 v[16:19],v1,s[8:11],s63 offen sc1
buffer_load_dwordx4 v[20:23],v1,s[8:11],s63 offen offset:1024 sc1
buffer_load_dwordx4 v[24:27],v1,s[8:11],s63 offen offset:2048 sc1
buffer_load_dwordx4 v[28:31],v1,s[8:11],s63 offen offset:3072 sc1
s_add_u32 s63,s73,4096
buffer_load_dwordx4 v[32:35],v1,s[8:11],s63 offen sc1
buffer_load_dwordx4 v[36:39],v1,s[8:11],s63 offen offset:1024 sc1
e2_245c:
s_add_u32 s63,s73,4096
buffer_load_dwordx4 v[40:43],v1,s[8:11],s63 offen offset:2048 sc1
buffer_load_dwordx4 v[44:47],v1,s[8:11],s63 offen offset:3072 sc1
s_add_u32 s63,s73,8192
buffer_load_dwordx4 v[48:51],v1,s[8:11],s63 offen sc1
buffer_load_dwordx4 v[52:55],v1,s[8:11],s63 offen offset:1024 sc1
buffer_load_dwordx4 v[56:59],v1,s[8:11],s63 offen offset:2048 sc1
buffer_load_dwordx4 v[60:63],v1,s[8:11],s63 offen offset:3072 sc1
e2_245:
s_waitcnt lgkmcnt(0)
s_barrier
ds_read_b128 v[144:147],v207 offset:0
ds_read_b128 v[148:151],v207 offset:1024
ds_read_b128 v[152:155],v207 offset:2048
ds_read_b128 v[156:159],v207 offset:3072
ds_read_b128 v[160:163],v207 offset:4096
ds_read_b128 v[164:167],v207 offset:5120
ds_read_b128 v[168:171],v207 offset:6144
ds_read_b128 v[172:175],v207 offset:7168
s_waitcnt lgkmcnt(4)
v_pk_add_f32 v[144:145],v[144:145],v[152:153]
v_pk_add_f32 v[146:147],v[146:147],v[154:155]
v_pk_add_f32 v[148:149],v[148:149],v[156:157]
v_pk_add_f32 v[150:151],v[150:151],v[158:159]
s_waitcnt lgkmcnt(0)
v_pk_add_f32 v[160:161],v[160:161],v[168:169]
v_pk_add_f32 v[162:163],v[162:163],v[170:171]
v_pk_add_f32 v[164:165],v[164:165],v[172:173]
v_pk_add_f32 v[166:167],v[166:167],v[174:175]
v_pk_add_f32 v[144:145],v[144:145],v[160:161]
v_pk_add_f32 v[146:147],v[146:147],v[162:163]
v_pk_add_f32 v[148:149],v[148:149],v[164:165]
v_pk_add_f32 v[150:151],v[150:151],v[166:167]
buffer_store_dwordx4 v[144:147],v205,s[8:11],s40 offen sc1
buffer_store_dwordx4 v[148:151],v205,s[8:11],s40 offen offset:256 sc1
s_mov_b32 s59,s42
s_cmp_eq_u32 s37,0
s_cbranch_scc1 WO_W
s_waitcnt vmcnt(0)
s_mov_b64 exec,1
buffer_store_dword v5,v1,s[8:11],s59 offen sc1
s_mov_b64 exec,-1
s_mov_b32 s59,2147483648
s_cmp_lt_u32 s32,128
s_cbranch_scc1 WO_COLD
s_endpgm
ROLE_R1:
s_lshr_b32 s80,s48,3
s_and_b32 s48,s48,7
v_lshlrev_b32 v1,4,v0
v_mov_b32 v5,1
s_lshl_b32 s56,s48,2
s_add_u32 s56,s56,s46
v_bfe_u32 v6,v0,2,2
v_lshrrev_b32 v7,4,v0
v_add_u32 v7,v6,v7
v_and_b32 v7,3,v7
v_and_b32 v15,3,v0
v_lshlrev_b32 v15,4,v15
v_lshl_add_u32 v15,v7,6,v15
v_lshl_add_u32 v15,v6,8,v15
v_lshrrev_b32 v6,4,v0
v_bfe_u32 v7,v0,2,2
v_and_b32 v8,3,v0
s_lshr_b32 s60,s48,2
s_lshl_b32 s70,s60,10
s_and_b32 s61,s48,3
s_lshl_b32 s60,s61,8
s_add_u32 s70,s70,s60
v_lshrrev_b32 v9,1,v6
v_lshlrev_b32 v18,11,v9
v_add_u32 v9,s61,v7
v_and_b32 v9,3,v9
v_lshl_add_u32 v18,v9,6,v18
v_lshl_add_u32 v18,v8,4,v18
v_add_u32 v18,s70,v18
v_and_b32 v9,1,v6
v_lshl_add_u32 v16,v9,3,v18
v_lshl_add_u32 v17,v9,14,v18
s_lshl_b32 s60,s48,2
v_add_u32 v9,s60,v8
v_mul_u32_u24 v19,1280,v9
v_lshl_add_u32 v19,v6,5,v19
v_lshl_add_u32 v19,v7,3,v19
v_lshlrev_b32 v21,5,v8
s_lshl_b32 s60,s46,3
v_add_u32 v20,s60,v21
v_min_u32 v2,39,v0
v_lshlrev_b32 v2,3,v2
s_lshr_b32 s60,s48,2
s_mul_i32 s60,s60,320
v_add_u32 v2,s60,v2
s_cmp_lt_u32 s46,2
s_cselect_b32 s68,0,2147483648
s_cselect_b32 s69,1.0,0
s_waitcnt vmcnt(0)
s_barrier
s_cmp_lg_u32 s46,0
s_cbranch_scc1 arr_246
v_mov_b32 v6,1
s_lshl_b32 s3,s49,2
v_mov_b32 v7,s3
s_mov_b64 exec,1
buffer_atomic_add v6,v7,s[12:15],0 offen sc1
s_mov_b64 exec,-1
arr_246:
s_lshl_b32 s3,s49,2
v_mov_b32 v7,s3
s_nop 1
ibw_247:
buffer_load_dword v6,v7,s[12:15],0 offen sc1
s_waitcnt vmcnt(0)
v_cmp_ne_u32 vcc,256,v6
s_nop 0
s_cbranch_vccz ok_248
s_sleep 8
s_sub_u32 s47,s47,1
s_cbranch_scc1 ABORT
s_branch ibw_247
ok_248:
s_cmp_lg_u32 s49,0
s_cbranch_scc1 ibok_249
v_and_b32 v7,7,v0
v_lshlrev_b32 v7,2,v7
buffer_load_dword v6,v7,s[12:15],0 offen offset:32 sc1
s_waitcnt vmcnt(0)
v_cmp_ne_u32 vcc,32,v6
s_nop 0
s_cbranch_vccz ibok_249
s_barrier
s_mov_b32 s49,1
s_mov_b32 s3,s2
s_load_dwordx16 s[16:31],s[0:1],0
s_load_dwordx8 s[32:39],s[0:1],64
s_waitcnt lgkmcnt(0)
s_branch DISPATCH
ibok_249:
R1_GO:
s_mov_b32 s83,s100
s_mov_b32 s50,64
s_mov_b32 s55,1
s_mov_b32 s59,1600000
v_mov_b32 v238,1024
v_mov_b32 v239,0
ds_write_b32 v238,v239
s_waitcnt lgkmcnt(0)
s_barrier
s_mov_b32 s82,-1
v_mov_b32 v40,0
v_mov_b32 v41,0
v_mov_b32 v42,0
v_mov_b32 v43,0
v_mov_b32 v52,0
v_mov_b32 v53,0
v_mov_b32 v54,0
v_mov_b32 v55,0
v_mov_b32 v64,0
v_mov_b32 v65,0
v_mov_b32 v66,0
v_mov_b32 v67,0
v_mov_b32 v76,0
v_mov_b32 v77,0
v_mov_b32 v78,0
v_mov_b32 v79,0
v_mov_b32 v108,0
v_mov_b32 v109,0
v_mov_b32 v120,0
v_mov_b32 v121,0
v_mov_b32 v122,0
v_mov_b32 v123,0
v_mov_b32 v132,0
v_mov_b32 v133,0
v_mov_b32 v134,0
v_mov_b32 v135,0
v_mov_b32 v144,0
v_mov_b32 v145,0
v_mov_b32 v146,0
v_mov_b32 v147,0
v_mov_b32 v156,0
v_mov_b32 v157,0
v_mov_b32 v158,0
v_mov_b32 v159,0
v_mov_b32 v188,0
v_mov_b32 v189,0
s_mov_b32 s51,s80
s_sub_u32 s52,s50,64
s_lshl_b32 s67,s51,6
s_add_u32 s67,s67,s52
s_mul_i32 s67,s67,640
s_add_u32 s67,s67,819200
fb_250:
buffer_load_dwordx2 v[236:237],v2,s[8:11],s67 offen sc1
s_waitcnt vmcnt(0)
v_min_u32 v236,v236,v237
v_cmp_eq_u32 vcc,0,v236
s_nop 0
s_cbranch_vccz ok_251
s_sleep 20
s_sub_u32 s47,s47,1
s_cbranch_scc1 ABORT
s_branch fb_250
ok_251:
s_mul_i32 s66,s52,491520
s_mul_i32 s60,s48,10240
s_add_u32 s66,s66,s60
s_lshl_b32 s60,s46,10
s_add_u32 s66,s66,s60
s_add_u32 s66,s66,175112192
s_mul_i32 s60,s52,40960
s_add_u32 s60,s60,234749952
s_mul_i32 s61,s52,46080
s_add_u32 s61,s61,209518592
s_cmp_eq_u32 s51,0
s_cselect_b32 s65,s60,s61
s_lshl_b32 s60,s46,12
s_add_u32 s65,s65,s60
s_cmp_lt_u32 s46,2
s_cbranch_scc1 g2_252
v_mov_b32 v40,0
v_mov_b32 v41,0
v_mov_b32 v42,0
v_mov_b32 v43,0
s_nop 0
s_branch g3_253
g2_252:
s_add_u32 s63,s65,32768
buffer_load_dwordx2 v[108:109],v16,s[8:11],s63 offen sc1
s_add_u32 s63,s66,8192
buffer_load_dwordx4 v[40:43],v1,s[8:11],s63 offen sc1
s_add_u32 s63,s66,90112
buffer_load_dwordx4 v[52:55],v1,s[8:11],s63 offen sc1
s_add_u32 s63,s66,172032
buffer_load_dwordx4 v[64:67],v1,s[8:11],s63 offen sc1
s_add_u32 s63,s66,253952
buffer_load_dwordx4 v[76:79],v1,s[8:11],s63 offen sc1
g3_253:
s_add_u32 s63,s65,0
buffer_load_dwordx2 v[104:105],v16,s[8:11],s63 offen sc1
s_add_u32 s63,s65,16384
buffer_load_dwordx2 v[106:107],v16,s[8:11],s63 offen sc1
s_add_u32 s63,s66,0
buffer_load_dwordx4 v[32:35],v1,s[8:11],s63 offen sc1
s_add_u32 s63,s66,4096
buffer_load_dwordx4 v[36:39],v1,s[8:11],s63 offen sc1
s_add_u32 s63,s66,81920
buffer_load_dwordx4 v[44:47],v1,s[8:11],s63 offen sc1
s_add_u32 s63,s66,86016
buffer_load_dwordx4 v[48:51],v1,s[8:11],s63 offen sc1
s_add_u32 s63,s66,163840
buffer_load_dwordx4 v[56:59],v1,s[8:11],s63 offen sc1
s_add_u32 s63,s66,167936
buffer_load_dwordx4 v[60:63],v1,s[8:11],s63 offen sc1
s_add_u32 s63,s66,245760
buffer_load_dwordx4 v[68:71],v1,s[8:11],s63 offen sc1
s_add_u32 s63,s66,249856
buffer_load_dwordx4 v[72:75],v1,s[8:11],s63 offen sc1
R1_A:
s_add_u32 s66,s50,1
s_min_u32 s66,s66,127
s_mov_b32 s53,s80
s_sub_u32 s54,s66,64
s_lshl_b32 s67,s53,6
s_add_u32 s67,s67,s54
s_mul_i32 s67,s67,640
s_add_u32 s67,s67,819200
s_lshl_b32 s60,s51,6
s_add_u32 s60,s60,s52
s_mul_i32 s71,s60,40960
s_mul_i32 s73,s60,5120
s_lshl_b32 s60,s46,12
s_add_u32 s71,s71,s60
s_add_u32 s72,s71,32768
s_add_u32 s72,s72,s68
s_cmp_eq_u32 s55,0
s_cbranch_scc1 r1p_254
s_waitcnt vmcnt(8)
v_lshlrev_b32 v192,16,v104
v_and_b32 v193,0xffff0000,v104
v_lshlrev_b32 v194,16,v105
v_and_b32 v195,0xffff0000,v105
v_lshlrev_b32 v196,16,v106
v_and_b32 v197,0xffff0000,v106
v_lshlrev_b32 v198,16,v107
v_and_b32 v199,0xffff0000,v107
v_lshlrev_b32 v200,16,v108
v_and_b32 v201,0xffff0000,v108
v_lshlrev_b32 v202,16,v109
v_and_b32 v203,0xffff0000,v109
s_waitcnt vmcnt(4)
v_pk_add_f32 v[32:33],v[32:33],v[44:45]
v_pk_add_f32 v[34:35],v[34:35],v[46:47]
v_pk_add_f32 v[36:37],v[36:37],v[48:49]
v_pk_add_f32 v[38:39],v[38:39],v[50:51]
v_pk_add_f32 v[40:41],v[40:41],v[52:53]
v_pk_add_f32 v[42:43],v[42:43],v[54:55]
s_waitcnt vmcnt(2)
v_pk_add_f32 v[32:33],v[32:33],v[56:57]
v_pk_add_f32 v[34:35],v[34:35],v[58:59]
v_pk_add_f32 v[36:37],v[36:37],v[60:61]
v_pk_add_f32 v[38:39],v[38:39],v[62:63]
v_pk_add_f32 v[40:41],v[40:41],v[64:65]
v_pk_add_f32 v[42:43],v[42:43],v[66:67]
s_waitcnt vmcnt(0)
v_pk_add_f32 v[32:33],v[32:33],v[68:69]
v_pk_add_f32 v[34:35],v[34:35],v[70:71]
v_pk_add_f32 v[36:37],v[36:37],v[72:73]
v_pk_add_f32 v[38:39],v[38:39],v[74:75]
v_pk_add_f32 v[40:41],v[40:41],v[76:77]
v_pk_add_f32 v[42:43],v[42:43],v[78:79]
s_nop 0
s_branch r1j_255
r1p_254:
s_waitcnt vmcnt(9)
v_lshlrev_b32 v192,16,v104
v_and_b32 v193,0xffff0000,v104
v_lshlrev_b32 v194,16,v105
v_and_b32 v195,0xffff0000,v105
v_lshlrev_b32 v196,16,v106
v_and_b32 v197,0xffff0000,v106
v_lshlrev_b32 v198,16,v107
v_and_b32 v199,0xffff0000,v107
v_lshlrev_b32 v200,16,v108
v_and_b32 v201,0xffff0000,v108
v_lshlrev_b32 v202,16,v109
v_and_b32 v203,0xffff0000,v109
s_waitcnt vmcnt(5)
v_pk_add_f32 v[32:33],v[32:33],v[44:45]
v_pk_add_f32 v[34:35],v[34:35],v[46:47]
v_pk_add_f32 v[36:37],v[36:37],v[48:49]
v_pk_add_f32 v[38:39],v[38:39],v[50:51]
v_pk_add_f32 v[40:41],v[40:41],v[52:53]
v_pk_add_f32 v[42:43],v[42:43],v[54:55]
s_waitcnt vmcnt(3)
v_pk_add_f32 v[32:33],v[32:33],v[56:57]
v_pk_add_f32 v[34:35],v[34:35],v[58:59]
v_pk_add_f32 v[36:37],v[36:37],v[60:61]
v_pk_add_f32 v[38:39],v[38:39],v[62:63]
v_pk_add_f32 v[40:41],v[40:41],v[64:65]
v_pk_add_f32 v[42:43],v[42:43],v[66:67]
s_waitcnt vmcnt(1)
v_pk_add_f32 v[32:33],v[32:33],v[68:69]
v_pk_add_f32 v[34:35],v[34:35],v[70:71]
v_pk_add_f32 v[36:37],v[36:37],v[72:73]
v_pk_add_f32 v[38:39],v[38:39],v[74:75]
v_pk_add_f32 v[40:41],v[40:41],v[76:77]
v_pk_add_f32 v[42:43],v[42:43],v[78:79]
s_nop 1
r1j_255:
v_cvt_pk_bf16_f32 v6,v32,v33
v_lshlrev_b32 v32,16,v6
v_and_b32 v33,0xffff0000,v6
v_cvt_pk_bf16_f32 v6,v34,v35
v_lshlrev_b32 v34,16,v6
v_and_b32 v35,0xffff0000,v6
v_cvt_pk_bf16_f32 v6,v36,v37
v_lshlrev_b32 v36,16,v6
v_and_b32 v37,0xffff0000,v6
v_cvt_pk_bf16_f32 v6,v38,v39
v_lshlrev_b32 v38,16,v6
v_and_b32 v39,0xffff0000,v6
v_cvt_pk_bf16_f32 v6,v40,v41
v_lshlrev_b32 v40,16,v6
v_and_b32 v41,0xffff0000,v6
v_cvt_pk_bf16_f32 v6,v42,v43
v_lshlrev_b32 v42,16,v6
v_and_b32 v43,0xffff0000,v6
v_pk_add_f32 v[32:33],v[32:33],v[192:193]
v_pk_add_f32 v[34:35],v[34:35],v[194:195]
v_pk_add_f32 v[36:37],v[36:37],v[196:197]
v_pk_add_f32 v[38:39],v[38:39],v[198:199]
v_pk_add_f32 v[40:41],v[40:41],v[200:201]
v_pk_add_f32 v[42:43],v[42:43],v[202:203]
v_cvt_pk_bf16_f32 v204,v32,v33
v_lshlrev_b32 v32,16,v204
v_and_b32 v33,0xffff0000,v204
v_cvt_pk_bf16_f32 v205,v34,v35
v_lshlrev_b32 v34,16,v205
v_and_b32 v35,0xffff0000,v205
v_cvt_pk_bf16_f32 v206,v36,v37
v_lshlrev_b32 v36,16,v206
v_and_b32 v37,0xffff0000,v206
v_cvt_pk_bf16_f32 v207,v38,v39
v_lshlrev_b32 v38,16,v207
v_and_b32 v39,0xffff0000,v207
v_cvt_pk_bf16_f32 v208,v40,v41
v_lshlrev_b32 v40,16,v208
v_and_b32 v41,0xffff0000,v208
v_cvt_pk_bf16_f32 v209,v42,v43
v_lshlrev_b32 v42,16,v209
v_and_b32 v43,0xffff0000,v209
v_pk_add_f32 v[28:29],v[32:33],v[34:35]
v_pk_mul_f32 v[26:27],v[32:33],v[32:33]
v_pk_fma_f32 v[26:27],v[34:35],v[34:35],v[26:27]
v_pk_add_f32 v[28:29],v[28:29],v[36:37]
v_pk_fma_f32 v[26:27],v[36:37],v[36:37],v[26:27]
v_pk_add_f32 v[28:29],v[28:29],v[38:39]
v_pk_fma_f32 v[26:27],v[38:39],v[38:39],v[26:27]
v_pk_add_f32 v[28:29],v[28:29],v[40:41]
v_pk_fma_f32 v[26:27],v[40:41],v[40:41],v[26:27]
v_pk_add_f32 v[28:29],v[28:29],v[42:43]
v_pk_fma_f32 v[26:27],v[42:43],v[42:43],v[26:27]
v_add_f32 v24,v28,v29
v_add_f32 v25,v26,v27
s_nop 0
v_add_f32_dpp v24,v24,v24 row_ror:4 row_mask:0xf bank_mask:0xf
v_add_f32_dpp v25,v25,v25 row_ror:4 row_mask:0xf bank_mask:0xf
s_nop 0
v_add_f32_dpp v24,v24,v24 row_ror:8 row_mask:0xf bank_mask:0xf
v_add_f32_dpp v25,v25,v25 row_ror:8 row_mask:0xf bank_mask:0xf
v_mov_b32 v26,v24
v_mov_b32 v27,v25
s_nop 0
v_permlane32_swap_b32 v24,v26
v_permlane32_swap_b32 v25,v27
v_add_f32 v24,v24,v26
v_add_f32 v25,v25,v27
v_mov_b32 v26,v24
v_mov_b32 v27,v25
s_nop 0
v_permlane16_swap_b32 v24,v26
v_permlane16_swap_b32 v25,v27
v_add_f32 v24,v24,v26
v_add_f32 v25,v25,v27
ds_write_b64 v20,v[24:25] offset:0
s_waitcnt lgkmcnt(0)
s_barrier
ds_read_b128 v[228:231],v21 offset:0
ds_read_b128 v[232:235],v21 offset:16
buffer_load_dwordx2 v[236:237],v2,s[8:11],s67 offen sc1
v_mov_b32 v210,v208
v_mov_b32 v211,v209
s_add_u32 s63,s71,218365952
v_permlane16_swap_b32 v204,v206
v_permlane16_swap_b32 v205,v207
buffer_store_dwordx4 v[204:207],v17,s[8:11],s63 offen sc1
s_add_u32 s63,s72,218365952
v_permlane16_swap_b32 v208,v210
v_permlane16_swap_b32 v209,v211
buffer_store_dwordx4 v[208:211],v18,s[8:11],s63 offen sc1
s_waitcnt lgkmcnt(0)
v_pk_add_f32 v[228:229],v[228:229],v[230:231]
v_pk_add_f32 v[232:233],v[232:233],v[234:235]
v_pk_add_f32 v[24:25],v[228:229],v[232:233]
v_mul_f32 v24,0x3acccccd,v24
v_mul_f32 v25,0x3acccccd,v25
v_fma_f32 v25,-v24,v24,v25
v_max_f32 v25,0,v25
v_mov_b32 v28,v24
v_mov_b32 v29,v25
v_cvt_pk_bf16_f32 v6,v24,v25
v_lshlrev_b32 v24,16,v6
v_and_b32 v25,0xffff0000,v6
v_add_f32 v25,0x3727c5ac,v25
v_cvt_pk_bf16_f32 v6,v25,v25
v_lshlrev_b32 v25,16,v6
v_sqrt_f32 v25,v25
s_nop 0
v_cvt_pk_bf16_f32 v6,v25,v25
v_lshlrev_b32 v25,16,v6
v_rcp_f32 v25,v25
s_nop 0
v_pk_add_f32 v[32:33],v[32:33],v[24:25] op_sel_hi:[1,0] neg_lo:[0,1] neg_hi:[0,1]
v_pk_add_f32 v[34:35],v[34:35],v[24:25] op_sel_hi:[1,0] neg_lo:[0,1] neg_hi:[0,1]
v_pk_add_f32 v[36:37],v[36:37],v[24:25] op_sel_hi:[1,0] neg_lo:[0,1] neg_hi:[0,1]
v_pk_add_f32 v[38:39],v[38:39],v[24:25] op_sel_hi:[1,0] neg_lo:[0,1] neg_hi:[0,1]
v_pk_add_f32 v[40:41],v[40:41],v[24:25] op_sel_hi:[1,0] neg_lo:[0,1] neg_hi:[0,1]
v_pk_add_f32 v[42:43],v[42:43],v[24:25] op_sel_hi:[1,0] neg_lo:[0,1] neg_hi:[0,1]
v_cvt_pk_bf16_f32 v6,v32,v33
v_lshlrev_b32 v32,16,v6
v_and_b32 v33,0xffff0000,v6
v_cvt_pk_bf16_f32 v8,v34,v35
v_lshlrev_b32 v34,16,v8
v_and_b32 v35,0xffff0000,v8
v_cvt_pk_bf16_f32 v6,v36,v37
v_lshlrev_b32 v36,16,v6
v_and_b32 v37,0xffff0000,v6
v_cvt_pk_bf16_f32 v8,v38,v39
v_lshlrev_b32 v38,16,v8
v_and_b32 v39,0xffff0000,v8
v_cvt_pk_bf16_f32 v6,v40,v41
v_lshlrev_b32 v40,16,v6
v_and_b32 v41,0xffff0000,v6
v_cvt_pk_bf16_f32 v8,v42,v43
v_lshlrev_b32 v42,16,v8
v_and_b32 v43,0xffff0000,v8
v_pk_mul_f32 v[32:33],v[32:33],v[24:25] op_sel:[0,1] op_sel_hi:[1,1]
v_pk_mul_f32 v[34:35],v[34:35],v[24:25] op_sel:[0,1] op_sel_hi:[1,1]
v_pk_mul_f32 v[36:37],v[36:37],v[24:25] op_sel:[0,1] op_sel_hi:[1,1]
v_pk_mul_f32 v[38:39],v[38:39],v[24:25] op_sel:[0,1] op_sel_hi:[1,1]
v_pk_mul_f32 v[40:41],v[40:41],v[24:25] op_sel:[0,1] op_sel_hi:[1,1]
v_pk_mul_f32 v[42:43],v[42:43],v[24:25] op_sel:[0,1] op_sel_hi:[1,1]
v_cvt_pk_bf16_f32 v212,v32,v33
v_lshlrev_b32 v32,16,v212
v_and_b32 v33,0xffff0000,v212
v_cvt_pk_bf16_f32 v213,v34,v35
v_lshlrev_b32 v34,16,v213
v_and_b32 v35,0xffff0000,v213
v_cvt_pk_bf16_f32 v214,v36,v37
v_lshlrev_b32 v36,16,v214
v_and_b32 v37,0xffff0000,v214
v_cvt_pk_bf16_f32 v215,v38,v39
v_lshlrev_b32 v38,16,v215
v_and_b32 v39,0xffff0000,v215
v_cvt_pk_bf16_f32 v216,v40,v41
v_lshlrev_b32 v40,16,v216
v_and_b32 v41,0xffff0000,v216
v_cvt_pk_bf16_f32 v217,v42,v43
v_lshlrev_b32 v42,16,v217
v_and_b32 v43,0xffff0000,v217
v_mov_b32 v218,v216
v_mov_b32 v219,v217
s_add_u32 s63,s71,223608832
s_add_u32 s63,s63,s73
v_permlane16_swap_b32 v212,v214
v_permlane16_swap_b32 v213,v215
buffer_store_dwordx4 v[212:215],v17,s[8:11],s63 offen sc1
s_add_u32 s63,s72,223608832
s_add_u32 s63,s63,s73
v_permlane16_swap_b32 v216,v218
v_permlane16_swap_b32 v217,v219
buffer_store_dwordx4 v[216:219],v18,s[8:11],s63 offen sc1
v_sub_f32 v28,v28,v24
v_mul_f32 v29,v29,v25
v_mul_f32 v28,v28,v25
v_mul_f32 v29,v29,v25
v_cvt_pk_bf16_f32 v6,v28,v29
v_lshlrev_b32 v28,16,v6
v_and_b32 v29,0xffff0000,v6
v_add_f32 v29,0x3727c5ac,v29
v_cvt_pk_bf16_f32 v6,v29,v29
v_lshlrev_b32 v29,16,v6
v_sqrt_f32 v29,v29
s_nop 0
v_cvt_pk_bf16_f32 v6,v29,v29
v_lshlrev_b32 v29,16,v6
v_rcp_f32 v29,v29
s_lshl_b32 s60,s46,12
s_sub_u32 s63,s71,s60
s_add_u32 s63,s63,s73
s_lshl_b32 s60,s48,5
s_add_u32 s63,s63,s60
s_add_u32 s63,s63,223649792
v_lshlrev_b32 v6,3,v0
s_cmp_lg_u32 s46,3
s_cbranch_scc1 zs_256
s_mov_b64 exec,15
buffer_store_dwordx2 v[28:29],v6,s[8:11],s63 offen sc1
s_mov_b64 exec,-1
zs_256:
s_lshl_b32 s82,s51,6
s_add_u32 s82,s82,s52
s_lshl_b32 s82,s82,9
s_add_u32 s82,s82,393216
s_lshl_b32 s61,s56,2
s_add_u32 s82,s82,s61
s_add_u32 s50,s50,1
s_cmp_eq_u32 s50,128
s_cbranch_scc1 R1_END
s_mov_b32 s51,s53
s_mov_b32 s52,s54
s_waitcnt vmcnt(4)
v_min_u32 v236,v236,v237
v_cmp_eq_u32 vcc,0,v236
s_nop 0
s_cbranch_vccnz nr_257
s_add_u32 s60,s50,0
v_mov_b32 v239,s60
ds_write_b32 v238,v239
s_mul_i32 s66,s52,491520
s_mul_i32 s60,s48,10240
s_add_u32 s66,s66,s60
s_lshl_b32 s60,s46,10
s_add_u32 s66,s66,s60
s_add_u32 s66,s66,175112192
s_mul_i32 s60,s52,40960
s_add_u32 s60,s60,234749952
s_mul_i32 s61,s52,46080
s_add_u32 s61,s61,209518592
s_cmp_eq_u32 s51,0
s_cselect_b32 s65,s60,s61
s_lshl_b32 s60,s46,12
s_add_u32 s65,s65,s60
s_cmp_lt_u32 s46,2
s_cbranch_scc1 g2_258
v_mov_b32 v120,0
v_mov_b32 v121,0
v_mov_b32 v122,0
v_mov_b32 v123,0
s_nop 0
s_branch g3_259
g2_258:
s_add_u32 s63,s65,32768
buffer_load_dwordx2 v[188:189],v16,s[8:11],s63 offen sc1
s_add_u32 s63,s66,8192
buffer_load_dwordx4 v[120:123],v1,s[8:11],s63 offen sc1
s_add_u32 s63,s66,90112
buffer_load_dwordx4 v[132:135],v1,s[8:11],s63 offen sc1
s_add_u32 s63,s66,172032
buffer_load_dwordx4 v[144:147],v1,s[8:11],s63 offen sc1
s_add_u32 s63,s66,253952
buffer_load_dwordx4 v[156:159],v1,s[8:11],s63 offen sc1
g3_259:
s_add_u32 s63,s65,0
buffer_load_dwordx2 v[184:185],v16,s[8:11],s63 offen sc1
s_add_u32 s63,s65,16384
buffer_load_dwordx2 v[186:187],v16,s[8:11],s63 offen sc1
s_add_u32 s63,s66,0
buffer_load_dwordx4 v[112:115],v1,s[8:11],s63 offen sc1
s_add_u32 s63,s66,4096
buffer_load_dwordx4 v[116:119],v1,s[8:11],s63 offen sc1
s_add_u32 s63,s66,81920
buffer_load_dwordx4 v[124:127],v1,s[8:11],s63 offen sc1
s_add_u32 s63,s66,86016
buffer_load_dwordx4 v[128:131],v1,s[8:11],s63 offen sc1
s_add_u32 s63,s66,163840
buffer_load_dwordx4 v[136:139],v1,s[8:11],s63 offen sc1
s_add_u32 s63,s66,167936
buffer_load_dwordx4 v[140:143],v1,s[8:11],s63 offen sc1
s_add_u32 s63,s66,245760
buffer_load_dwordx4 v[148:151],v1,s[8:11],s63 offen sc1
s_add_u32 s63,s66,249856
buffer_load_dwordx4 v[152:155],v1,s[8:11],s63 offen sc1
s_waitcnt vmcnt(10)
s_mov_b64 exec,1
buffer_store_dword v5,v1,s[8:11],s82 offen sc1
s_mov_b64 exec,-1
s_mov_b32 s55,0
s_branch R1_B
nr_257:
s_mov_b32 s55,1
s_waitcnt vmcnt(0)
s_mov_b64 exec,1
buffer_store_dword v5,v1,s[8:11],s82 offen sc1
s_mov_b64 exec,-1
s_mov_b32 s82,-1
s_lshl_b32 s67,s51,6
s_add_u32 s67,s67,s52
s_mul_i32 s67,s67,640
s_add_u32 s67,s67,819200
s_cmp_lg_u32 s46,0
s_cbranch_scc1 wo_260
fb_262:
buffer_load_dwordx2 v[236:237],v2,s[8:11],s67 offen sc1
s_waitcnt vmcnt(0)
v_min_u32 v236,v236,v237
v_cmp_eq_u32 vcc,0,v236
s_nop 0
s_cbranch_vccz ok_263
s_sleep 3
s_sub_u32 s47,s47,1
s_cbranch_scc1 ABORT
s_branch fb_262
ok_263:
s_add_u32 s60,s50,0
v_mov_b32 v239,s60
ds_write_b32 v238,v239
s_branch wd_261
wo_260:
ds_read_b32 v239,v238
s_waitcnt lgkmcnt(0)
v_cmp_gt_u32 vcc,s50,v239
s_nop 0
s_cbranch_vccz wd_261
s_sleep 1
s_sub_u32 s59,s59,1
s_cbranch_scc1 ABORT
s_branch wo_260
wd_261:
s_mul_i32 s66,s52,491520
s_mul_i32 s60,s48,10240
s_add_u32 s66,s66,s60
s_lshl_b32 s60,s46,10
s_add_u32 s66,s66,s60
s_add_u32 s66,s66,175112192
s_mul_i32 s60,s52,40960
s_add_u32 s60,s60,234749952
s_mul_i32 s61,s52,46080
s_add_u32 s61,s61,209518592
s_cmp_eq_u32 s51,0
s_cselect_b32 s65,s60,s61
s_lshl_b32 s60,s46,12
s_add_u32 s65,s65,s60
s_cmp_lt_u32 s46,2
s_cbranch_scc1 g2_264
v_mov_b32 v120,0
v_mov_b32 v121,0
v_mov_b32 v122,0
v_mov_b32 v123,0
s_nop 0
s_branch g3_265
g2_264:
s_add_u32 s63,s65,32768
buffer_load_dwordx2 v[188:189],v16,s[8:11],s63 offen sc1
s_add_u32 s63,s66,8192
buffer_load_dwordx4 v[120:123],v1,s[8:11],s63 offen sc1
s_add_u32 s63,s66,90112
buffer_load_dwordx4 v[132:135],v1,s[8:11],s63 offen sc1
s_add_u32 s63,s66,172032
buffer_load_dwordx4 v[144:147],v1,s[8:11],s63 offen sc1
s_add_u32 s63,s66,253952
buffer_load_dwordx4 v[156:159],v1,s[8:11],s63 offen sc1
g3_265:
s_add_u32 s63,s65,0
buffer_load_dwordx2 v[184:185],v16,s[8:11],s63 offen sc1
s_add_u32 s63,s65,16384
buffer_load_dwordx2 v[186:187],v16,s[8:11],s63 offen sc1
s_add_u32 s63,s66,0
buffer_load_dwordx4 v[112:115],v1,s[8:11],s63 offen sc1
s_add_u32 s63,s66,4096
buffer_load_dwordx4 v[116:119],v1,s[8:11],s63 offen sc1
s_add_u32 s63,s66,81920
buffer_load_dwordx4 v[124:127],v1,s[8:11],s63 offen sc1
s_add_u32 s63,s66,86016
buffer_load_dwordx4 v[128:131],v1,s[8:11],s63 offen sc1
s_add_u32 s63,s66,163840
buffer_load_dwordx4 v[136:139],v1,s[8:11],s63 offen sc1
s_add_u32 s63,s66,167936
buffer_load_dwordx4 v[140:143],v1,s[8:11],s63 offen sc1
s_add_u32 s63,s66,245760
buffer_load_dwordx4 v[148:151],v1,s[8:11],s63 offen sc1
s_add_u32 s63,s66,249856
buffer_load_dwordx4 v[152:155],v1,s[8:11],s63 offen sc1
s_branch R1_B
R1_B:
s_add_u32 s66,s50,1
s_min_u32 s66,s66,127
s_mov_b32 s53,s80
s_sub_u32 s54,s66,64
s_lshl_b32 s67,s53,6
s_add_u32 s67,s67,s54
s_mul_i32 s67,s67,640
s_add_u32 s67,s67,819200
s_lshl_b32 s60,s51,6
s_add_u32 s60,s60,s52
s_mul_i32 s71,s60,40960
s_mul_i32 s73,s60,5120
s_lshl_b32 s60,s46,12
s_add_u32 s71,s71,s60
s_add_u32 s72,s71,32768
s_add_u32 s72,s72,s68
s_cmp_eq_u32 s55,0
s_cbranch_scc1 r1p_266
s_waitcnt vmcnt(8)
v_lshlrev_b32 v192,16,v184
v_and_b32 v193,0xffff0000,v184
v_lshlrev_b32 v194,16,v185
v_and_b32 v195,0xffff0000,v185
v_lshlrev_b32 v196,16,v186
v_and_b32 v197,0xffff0000,v186
v_lshlrev_b32 v198,16,v187
v_and_b32 v199,0xffff0000,v187
v_lshlrev_b32 v200,16,v188
v_and_b32 v201,0xffff0000,v188
v_lshlrev_b32 v202,16,v189
v_and_b32 v203,0xffff0000,v189
s_waitcnt vmcnt(4)
v_pk_add_f32 v[112:113],v[112:113],v[124:125]
v_pk_add_f32 v[114:115],v[114:115],v[126:127]
v_pk_add_f32 v[116:117],v[116:117],v[128:129]
v_pk_add_f32 v[118:119],v[118:119],v[130:131]
v_pk_add_f32 v[120:121],v[120:121],v[132:133]
v_pk_add_f32 v[122:123],v[122:123],v[134:135]
s_waitcnt vmcnt(2)
v_pk_add_f32 v[112:113],v[112:113],v[136:137]
v_pk_add_f32 v[114:115],v[114:115],v[138:139]
v_pk_add_f32 v[116:117],v[116:117],v[140:141]
v_pk_add_f32 v[118:119],v[118:119],v[142:143]
v_pk_add_f32 v[120:121],v[120:121],v[144:145]
v_pk_add_f32 v[122:123],v[122:123],v[146:147]
s_waitcnt vmcnt(0)
v_pk_add_f32 v[112:113],v[112:113],v[148:149]
v_pk_add_f32 v[114:115],v[114:115],v[150:151]
v_pk_add_f32 v[116:117],v[116:117],v[152:153]
v_pk_add_f32 v[118:119],v[118:119],v[154:155]
v_pk_add_f32 v[120:121],v[120:121],v[156:157]
v_pk_add_f32 v[122:123],v[122:123],v[158:159]
s_nop 0
s_branch r1j_267
r1p_266:
s_waitcnt vmcnt(9)
v_lshlrev_b32 v192,16,v184
v_and_b32 v193,0xffff0000,v184
v_lshlrev_b32 v194,16,v185
v_and_b32 v195,0xffff0000,v185
v_lshlrev_b32 v196,16,v186
v_and_b32 v197,0xffff0000,v186
v_lshlrev_b32 v198,16,v187
v_and_b32 v199,0xffff0000,v187
v_lshlrev_b32 v200,16,v188
v_and_b32 v201,0xffff0000,v188
v_lshlrev_b32 v202,16,v189
v_and_b32 v203,0xffff0000,v189
s_waitcnt vmcnt(5)
v_pk_add_f32 v[112:113],v[112:113],v[124:125]
v_pk_add_f32 v[114:115],v[114:115],v[126:127]
v_pk_add_f32 v[116:117],v[116:117],v[128:129]
v_pk_add_f32 v[118:119],v[118:119],v[130:131]
v_pk_add_f32 v[120:121],v[120:121],v[132:133]
v_pk_add_f32 v[122:123],v[122:123],v[134:135]
s_waitcnt vmcnt(3)
v_pk_add_f32 v[112:113],v[112:113],v[136:137]
v_pk_add_f32 v[114:115],v[114:115],v[138:139]
v_pk_add_f32 v[116:117],v[116:117],v[140:141]
v_pk_add_f32 v[118:119],v[118:119],v[142:143]
v_pk_add_f32 v[120:121],v[120:121],v[144:145]
v_pk_add_f32 v[122:123],v[122:123],v[146:147]
s_waitcnt vmcnt(1)
v_pk_add_f32 v[112:113],v[112:113],v[148:149]
v_pk_add_f32 v[114:115],v[114:115],v[150:151]
v_pk_add_f32 v[116:117],v[116:117],v[152:153]
v_pk_add_f32 v[118:119],v[118:119],v[154:155]
v_pk_add_f32 v[120:121],v[120:121],v[156:157]
v_pk_add_f32 v[122:123],v[122:123],v[158:159]
s_nop 1
r1j_267:
v_cvt_pk_bf16_f32 v6,v112,v113
v_lshlrev_b32 v112,16,v6
v_and_b32 v113,0xffff0000,v6
v_cvt_pk_bf16_f32 v6,v114,v115
v_lshlrev_b32 v114,16,v6
v_and_b32 v115,0xffff0000,v6
v_cvt_pk_bf16_f32 v6,v116,v117
v_lshlrev_b32 v116,16,v6
v_and_b32 v117,0xffff0000,v6
v_cvt_pk_bf16_f32 v6,v118,v119
v_lshlrev_b32 v118,16,v6
v_and_b32 v119,0xffff0000,v6
v_cvt_pk_bf16_f32 v6,v120,v121
v_lshlrev_b32 v120,16,v6
v_and_b32 v121,0xffff0000,v6
v_cvt_pk_bf16_f32 v6,v122,v123
v_lshlrev_b32 v122,16,v6
v_and_b32 v123,0xffff0000,v6
v_pk_add_f32 v[112:113],v[112:113],v[192:193]
v_pk_add_f32 v[114:115],v[114:115],v[194:195]
v_pk_add_f32 v[116:117],v[116:117],v[196:197]
v_pk_add_f32 v[118:119],v[118:119],v[198:199]
v_pk_add_f32 v[120:121],v[120:121],v[200:201]
v_pk_add_f32 v[122:123],v[122:123],v[202:203]
v_cvt_pk_bf16_f32 v204,v112,v113
v_lshlrev_b32 v112,16,v204
v_and_b32 v113,0xffff0000,v204
v_cvt_pk_bf16_f32 v205,v114,v115
v_lshlrev_b32 v114,16,v205
v_and_b32 v115,0xffff0000,v205
v_cvt_pk_bf16_f32 v206,v116,v117
v_lshlrev_b32 v116,16,v206
v_and_b32 v117,0xffff0000,v206
v_cvt_pk_bf16_f32 v207,v118,v119
v_lshlrev_b32 v118,16,v207
v_and_b32 v119,0xffff0000,v207
v_cvt_pk_bf16_f32 v208,v120,v121
v_lshlrev_b32 v120,16,v208
v_and_b32 v121,0xffff0000,v208
v_cvt_pk_bf16_f32 v209,v122,v123
v_lshlrev_b32 v122,16,v209
v_and_b32 v123,0xffff0000,v209
v_pk_add_f32 v[28:29],v[112:113],v[114:115]
v_pk_mul_f32 v[26:27],v[112:113],v[112:113]
v_pk_fma_f32 v[26:27],v[114:115],v[114:115],v[26:27]
v_pk_add_f32 v[28:29],v[28:29],v[116:117]
v_pk_fma_f32 v[26:27],v[116:117],v[116:117],v[26:27]
v_pk_add_f32 v[28:29],v[28:29],v[118:119]
v_pk_fma_f32 v[26:27],v[118:119],v[118:119],v[26:27]
v_pk_add_f32 v[28:29],v[28:29],v[120:121]
v_pk_fma_f32 v[26:27],v[120:121],v[120:121],v[26:27]
v_pk_add_f32 v[28:29],v[28:29],v[122:123]
v_pk_fma_f32 v[26:27],v[122:123],v[122:123],v[26:27]
v_add_f32 v24,v28,v29
v_add_f32 v25,v26,v27
s_nop 0
v_add_f32_dpp v24,v24,v24 row_ror:4 row_mask:0xf bank_mask:0xf
v_add_f32_dpp v25,v25,v25 row_ror:4 row_mask:0xf bank_mask:0xf
s_nop 0
v_add_f32_dpp v24,v24,v24 row_ror:8 row_mask:0xf bank_mask:0xf
v_add_f32_dpp v25,v25,v25 row_ror:8 row_mask:0xf bank_mask:0xf
v_mov_b32 v26,v24
v_mov_b32 v27,v25
s_nop 0
v_permlane32_swap_b32 v24,v26
v_permlane32_swap_b32 v25,v27
v_add_f32 v24,v24,v26
v_add_f32 v25,v25,v27
v_mov_b32 v26,v24
v_mov_b32 v27,v25
s_nop 0
v_permlane16_swap_b32 v24,v26
v_permlane16_swap_b32 v25,v27
v_add_f32 v24,v24,v26
v_add_f32 v25,v25,v27
ds_write_b64 v20,v[24:25] offset:128
s_waitcnt lgkmcnt(0)
s_barrier
ds_read_b128 v[228:231],v21 offset:128
ds_read_b128 v[232:235],v21 offset:144
buffer_load_dwordx2 v[236:237],v2,s[8:11],s67 offen sc1
v_mov_b32 v210,v208
v_mov_b32 v211,v209
s_add_u32 s63,s71,218365952
v_permlane16_swap_b32 v204,v206
v_permlane16_swap_b32 v205,v207
buffer_store_dwordx4 v[204:207],v17,s[8:11],s63 offen sc1
s_add_u32 s63,s72,218365952
v_permlane16_swap_b32 v208,v210
v_permlane16_swap_b32 v209,v211
buffer_store_dwordx4 v[208:211],v18,s[8:11],s63 offen sc1
s_waitcnt lgkmcnt(0)
v_pk_add_f32 v[228:229],v[228:229],v[230:231]
v_pk_add_f32 v[232:233],v[232:233],v[234:235]
v_pk_add_f32 v[24:25],v[228:229],v[232:233]
v_mul_f32 v24,0x3acccccd,v24
v_mul_f32 v25,0x3acccccd,v25
v_fma_f32 v25,-v24,v24,v25
v_max_f32 v25,0,v25
v_mov_b32 v28,v24
v_mov_b32 v29,v25
v_cvt_pk_bf16_f32 v6,v24,v25
v_lshlrev_b32 v24,16,v6
v_and_b32 v25,0xffff0000,v6
v_add_f32 v25,0x3727c5ac,v25
v_cvt_pk_bf16_f32 v6,v25,v25
v_lshlrev_b32 v25,16,v6
v_sqrt_f32 v25,v25
s_nop 0
v_cvt_pk_bf16_f32 v6,v25,v25
v_lshlrev_b32 v25,16,v6
v_rcp_f32 v25,v25
s_nop 0
v_pk_add_f32 v[112:113],v[112:113],v[24:25] op_sel_hi:[1,0] neg_lo:[0,1] neg_hi:[0,1]
v_pk_add_f32 v[114:115],v[114:115],v[24:25] op_sel_hi:[1,0] neg_lo:[0,1] neg_hi:[0,1]
v_pk_add_f32 v[116:117],v[116:117],v[24:25] op_sel_hi:[1,0] neg_lo:[0,1] neg_hi:[0,1]
v_pk_add_f32 v[118:119],v[118:119],v[24:25] op_sel_hi:[1,0] neg_lo:[0,1] neg_hi:[0,1]
v_pk_add_f32 v[120:121],v[120:121],v[24:25] op_sel_hi:[1,0] neg_lo:[0,1] neg_hi:[0,1]
v_pk_add_f32 v[122:123],v[122:123],v[24:25] op_sel_hi:[1,0] neg_lo:[0,1] neg_hi:[0,1]
v_cvt_pk_bf16_f32 v6,v112,v113
v_lshlrev_b32 v112,16,v6
v_and_b32 v113,0xffff0000,v6
v_cvt_pk_bf16_f32 v8,v114,v115
v_lshlrev_b32 v114,16,v8
v_and_b32 v115,0xffff0000,v8
v_cvt_pk_bf16_f32 v6,v116,v117
v_lshlrev_b32 v116,16,v6
v_and_b32 v117,0xffff0000,v6
v_cvt_pk_bf16_f32 v8,v118,v119
v_lshlrev_b32 v118,16,v8
v_and_b32 v119,0xffff0000,v8
v_cvt_pk_bf16_f32 v6,v120,v121
v_lshlrev_b32 v120,16,v6
v_and_b32 v121,0xffff0000,v6
v_cvt_pk_bf16_f32 v8,v122,v123
v_lshlrev_b32 v122,16,v8
v_and_b32 v123,0xffff0000,v8
v_pk_mul_f32 v[112:113],v[112:113],v[24:25] op_sel:[0,1] op_sel_hi:[1,1]
v_pk_mul_f32 v[114:115],v[114:115],v[24:25] op_sel:[0,1] op_sel_hi:[1,1]
v_pk_mul_f32 v[116:117],v[116:117],v[24:25] op_sel:[0,1] op_sel_hi:[1,1]
v_pk_mul_f32 v[118:119],v[118:119],v[24:25] op_sel:[0,1] op_sel_hi:[1,1]
v_pk_mul_f32 v[120:121],v[120:121],v[24:25] op_sel:[0,1] op_sel_hi:[1,1]
v_pk_mul_f32 v[122:123],v[122:123],v[24:25] op_sel:[0,1] op_sel_hi:[1,1]
v_cvt_pk_bf16_f32 v212,v112,v113
v_lshlrev_b32 v112,16,v212
v_and_b32 v113,0xffff0000,v212
v_cvt_pk_bf16_f32 v213,v114,v115
v_lshlrev_b32 v114,16,v213
v_and_b32 v115,0xffff0000,v213
v_cvt_pk_bf16_f32 v214,v116,v117
v_lshlrev_b32 v116,16,v214
v_and_b32 v117,0xffff0000,v214
v_cvt_pk_bf16_f32 v215,v118,v119
v_lshlrev_b32 v118,16,v215
v_and_b32 v119,0xffff0000,v215
v_cvt_pk_bf16_f32 v216,v120,v121
v_lshlrev_b32 v120,16,v216
v_and_b32 v121,0xffff0000,v216
v_cvt_pk_bf16_f32 v217,v122,v123
v_lshlrev_b32 v122,16,v217
v_and_b32 v123,0xffff0000,v217
v_mov_b32 v218,v216
v_mov_b32 v219,v217
s_add_u32 s63,s71,223608832
s_add_u32 s63,s63,s73
v_permlane16_swap_b32 v212,v214
v_permlane16_swap_b32 v213,v215
buffer_store_dwordx4 v[212:215],v17,s[8:11],s63 offen sc1
s_add_u32 s63,s72,223608832
s_add_u32 s63,s63,s73
v_permlane16_swap_b32 v216,v218
v_permlane16_swap_b32 v217,v219
buffer_store_dwordx4 v[216:219],v18,s[8:11],s63 offen sc1
v_sub_f32 v28,v28,v24
v_mul_f32 v29,v29,v25
v_mul_f32 v28,v28,v25
v_mul_f32 v29,v29,v25
v_cvt_pk_bf16_f32 v6,v28,v29
v_lshlrev_b32 v28,16,v6
v_and_b32 v29,0xffff0000,v6
v_add_f32 v29,0x3727c5ac,v29
v_cvt_pk_bf16_f32 v6,v29,v29
v_lshlrev_b32 v29,16,v6
v_sqrt_f32 v29,v29
s_nop 0
v_cvt_pk_bf16_f32 v6,v29,v29
v_lshlrev_b32 v29,16,v6
v_rcp_f32 v29,v29
s_lshl_b32 s60,s46,12
s_sub_u32 s63,s71,s60
s_add_u32 s63,s63,s73
s_lshl_b32 s60,s48,5
s_add_u32 s63,s63,s60
s_add_u32 s63,s63,223649792
v_lshlrev_b32 v6,3,v0
s_cmp_lg_u32 s46,3
s_cbranch_scc1 zs_268
s_mov_b64 exec,15
buffer_store_dwordx2 v[28:29],v6,s[8:11],s63 offen sc1
s_mov_b64 exec,-1
zs_268:
s_lshl_b32 s82,s51,6
s_add_u32 s82,s82,s52
s_lshl_b32 s82,s82,9
s_add_u32 s82,s82,393216
s_lshl_b32 s61,s56,2
s_add_u32 s82,s82,s61
s_add_u32 s50,s50,1
s_cmp_eq_u32 s50,128
s_cbranch_scc1 R1_END
s_mov_b32 s51,s53
s_mov_b32 s52,s54
s_waitcnt vmcnt(4)
v_min_u32 v236,v236,v237
v_cmp_eq_u32 vcc,0,v236
s_nop 0
s_cbranch_vccnz nr_269
s_add_u32 s60,s50,0
v_mov_b32 v239,s60
ds_write_b32 v238,v239
s_mul_i32 s66,s52,491520
s_mul_i32 s60,s48,10240
s_add_u32 s66,s66,s60
s_lshl_b32 s60,s46,10
s_add_u32 s66,s66,s60
s_add_u32 s66,s66,175112192
s_mul_i32 s60,s52,40960
s_add_u32 s60,s60,234749952
s_mul_i32 s61,s52,46080
s_add_u32 s61,s61,209518592
s_cmp_eq_u32 s51,0
s_cselect_b32 s65,s60,s61
s_lshl_b32 s60,s46,12
s_add_u32 s65,s65,s60
s_cmp_lt_u32 s46,2
s_cbranch_scc1 g2_270
v_mov_b32 v40,0
v_mov_b32 v41,0
v_mov_b32 v42,0
v_mov_b32 v43,0
s_nop 0
s_branch g3_271
g2_270:
s_add_u32 s63,s65,32768
buffer_load_dwordx2 v[108:109],v16,s[8:11],s63 offen sc1
s_add_u32 s63,s66,8192
buffer_load_dwordx4 v[40:43],v1,s[8:11],s63 offen sc1
s_add_u32 s63,s66,90112
buffer_load_dwordx4 v[52:55],v1,s[8:11],s63 offen sc1
s_add_u32 s63,s66,172032
buffer_load_dwordx4 v[64:67],v1,s[8:11],s63 offen sc1
s_add_u32 s63,s66,253952
buffer_load_dwordx4 v[76:79],v1,s[8:11],s63 offen sc1
g3_271:
s_add_u32 s63,s65,0
buffer_load_dwordx2 v[104:105],v16,s[8:11],s63 offen sc1
s_add_u32 s63,s65,16384
buffer_load_dwordx2 v[106:107],v16,s[8:11],s63 offen sc1
s_add_u32 s63,s66,0
buffer_load_dwordx4 v[32:35],v1,s[8:11],s63 offen sc1
s_add_u32 s63,s66,4096
buffer_load_dwordx4 v[36:39],v1,s[8:11],s63 offen sc1
s_add_u32 s63,s66,81920
buffer_load_dwordx4 v[44:47],v1,s[8:11],s63 offen sc1
s_add_u32 s63,s66,86016
buffer_load_dwordx4 v[48:51],v1,s[8:11],s63 offen sc1
s_add_u32 s63,s66,163840
buffer_load_dwordx4 v[56:59],v1,s[8:11],s63 offen sc1
s_add_u32 s63,s66,167936
buffer_load_dwordx4 v[60:63],v1,s[8:11],s63 offen sc1
s_add_u32 s63,s66,245760
buffer_load_dwordx4 v[68:71],v1,s[8:11],s63 offen sc1
s_add_u32 s63,s66,249856
buffer_load_dwordx4 v[72:75],v1,s[8:11],s63 offen sc1
s_waitcnt vmcnt(10)
s_mov_b64 exec,1
buffer_store_dword v5,v1,s[8:11],s82 offen sc1
s_mov_b64 exec,-1
s_mov_b32 s55,0
s_branch R1_A
nr_269:
s_mov_b32 s55,1
s_waitcnt vmcnt(0)
s_mov_b64 exec,1
buffer_store_dword v5,v1,s[8:11],s82 offen sc1
s_mov_b64 exec,-1
s_mov_b32 s82,-1
s_lshl_b32 s67,s51,6
s_add_u32 s67,s67,s52
s_mul_i32 s67,s67,640
s_add_u32 s67,s67,819200
s_cmp_lg_u32 s46,0
s_cbranch_scc1 wo_272
fb_274:
buffer_load_dwordx2 v[236:237],v2,s[8:11],s67 offen sc1
s_waitcnt vmcnt(0)
v_min_u32 v236,v236,v237
v_cmp_eq_u32 vcc,0,v236
s_nop 0
s_cbranch_vccz ok_275
s_sleep 3
s_sub_u32 s47,s47,1
s_cbranch_scc1 ABORT
s_branch fb_274
ok_275:
s_add_u32 s60,s50,0
v_mov_b32 v239,s60
ds_write_b32 v238,v239
s_branch wd_273
wo_272:
ds_read_b32 v239,v238
s_waitcnt lgkmcnt(0)
v_cmp_gt_u32 vcc,s50,v239
s_nop 0
s_cbranch_vccz wd_273
s_sleep 1
s_sub_u32 s59,s59,1
s_cbranch_scc1 ABORT
s_branch wo_272
wd_273:
s_mul_i32 s66,s52,491520
s_mul_i32 s60,s48,10240
s_add_u32 s66,s66,s60
s_lshl_b32 s60,s46,10
s_add_u32 s66,s66,s60
s_add_u32 s66,s66,175112192
s_mul_i32 s60,s52,40960
s_add_u32 s60,s60,234749952
s_mul_i32 s61,s52,46080
s_add_u32 s61,s61,209518592
s_cmp_eq_u32 s51,0
s_cselect_b32 s65,s60,s61
s_lshl_b32 s60,s46,12
s_add_u32 s65,s65,s60
s_cmp_lt_u32 s46,2
s_cbranch_scc1 g2_276
v_mov_b32 v40,0
v_mov_b32 v41,0
v_mov_b32 v42,0
v_mov_b32 v43,0
s_nop 0
s_branch g3_277
g2_276:
s_add_u32 s63,s65,32768
buffer_load_dwordx2 v[108:109],v16,s[8:11],s63 offen sc1
s_add_u32 s63,s66,8192
buffer_load_dwordx4 v[40:43],v1,s[8:11],s63 offen sc1
s_add_u32 s63,s66,90112
buffer_load_dwordx4 v[52:55],v1,s[8:11],s63 offen sc1
s_add_u32 s63,s66,172032
buffer_load_dwordx4 v[64:67],v1,s[8:11],s63 offen sc1
s_add_u32 s63,s66,253952
buffer_load_dwordx4 v[76:79],v1,s[8:11],s63 offen sc1
g3_277:
s_add_u32 s63,s65,0
buffer_load_dwordx2 v[104:105],v16,s[8:11],s63 offen sc1
s_add_u32 s63,s65,16384
buffer_load_dwordx2 v[106:107],v16,s[8:11],s63 offen sc1
s_add_u32 s63,s66,0
buffer_load_dwordx4 v[32:35],v1,s[8:11],s63 offen sc1
s_add_u32 s63,s66,4096
buffer_load_dwordx4 v[36:39],v1,s[8:11],s63 offen sc1
s_add_u32 s63,s66,81920
buffer_load_dwordx4 v[44:47],v1,s[8:11],s63 offen sc1
s_add_u32 s63,s66,86016
buffer_load_dwordx4 v[48:51],v1,s[8:11],s63 offen sc1
s_add_u32 s63,s66,163840
buffer_load_dwordx4 v[56:59],v1,s[8:11],s63 offen sc1
s_add_u32 s63,s66,167936
buffer_load_dwordx4 v[60:63],v1,s[8:11],s63 offen sc1
s_add_u32 s63,s66,245760
buffer_load_dwordx4 v[68:71],v1,s[8:11],s63 offen sc1
s_add_u32 s63,s66,249856
buffer_load_dwordx4 v[72:75],v1,s[8:11],s63 offen sc1
s_branch R1_A
R1_END:
s_waitcnt vmcnt(0)
s_mov_b64 exec,1
buffer_store_dword v5,v1,s[8:11],s82 offen sc1
s_mov_b64 exec,-1
s_endpgm
ROLE_W1:
v_lshlrev_b32 v1,4,v0
v_mov_b32 v5,1
s_lshl_b32 s56,s48,2
s_add_u32 s56,s56,s46
v_bfe_u32 v6,v0,2,2
v_lshrrev_b32 v7,4,v0
v_add_u32 v7,v6,v7
v_and_b32 v7,3,v7
v_and_b32 v15,3,v0
v_lshlrev_b32 v15,4,v15
v_lshl_add_u32 v15,v7,6,v15
v_lshl_add_u32 v15,v6,8,v15
v_lshrrev_b32 v6,5,v0
v_bfe_u32 v7,v0,4,1
v_lshlrev_b32 v16,10,v7
v_bfe_u32 v7,v0,2,2
v_lshl_add_u32 v16,v7,8,v16
v_add_u32 v6,v6,v7
v_and_b32 v6,3,v6
v_lshl_add_u32 v16,v6,6,v16
v_and_b32 v6,3,v0
v_lshl_add_u32 v16,v6,4,v16
v_add_u32 v18,46080,v16
v_lshrrev_b32 v6,5,v0
v_bfe_u32 v7,v0,4,1
v_lshlrev_b32 v20,10,v7
v_lshl_add_u32 v20,v6,8,v20
v_and_b32 v6,15,v0
v_lshl_add_u32 v20,v6,4,v20
v_lshrrev_b32 v6,5,v0
v_add_u32 v6,2,v6
v_bfe_u32 v7,v0,4,1
v_lshlrev_b32 v17,10,v7
v_bfe_u32 v7,v0,2,2
v_lshl_add_u32 v17,v7,8,v17
v_add_u32 v6,v6,v7
v_and_b32 v6,3,v6
v_lshl_add_u32 v17,v6,6,v17
v_and_b32 v6,3,v0
v_lshl_add_u32 v17,v6,4,v17
v_add_u32 v19,46080,v17
v_lshrrev_b32 v6,5,v0
v_add_u32 v6,2,v6
v_bfe_u32 v7,v0,4,1
v_lshlrev_b32 v21,10,v7
v_lshl_add_u32 v21,v6,8,v21
v_and_b32 v6,15,v0
v_lshl_add_u32 v21,v6,4,v21
v_min_u32 v2,31,v0
v_lshlrev_b32 v2,2,v2
v_mov_b32 v112,0xc0135761
v_mov_b32 v113,0xbdd2d3e8
s_mov_b32 s68,0xbdd2d3e8
v_mov_b32 v116,0
v_mov_b32 v117,0
v_mov_b32 v118,0
v_mov_b32 v119,0
s_lshl_b32 s60,s56,11
s_add_u32 s61,s60,237699072
buffer_store_dwordx4 v[116:119],v1,s[8:11],s61 offen sc1
buffer_store_dwordx4 v[116:119],v1,s[8:11],s61 offen offset:1024 sc1
s_add_u32 s61,s60,238067712
buffer_store_dwordx4 v[116:119],v1,s[8:11],s61 offen sc1
buffer_store_dwordx4 v[116:119],v1,s[8:11],s61 offen offset:1024 sc1
s_waitcnt vmcnt(0)
s_barrier
s_cmp_lg_u32 s46,0
s_cbranch_scc1 arr_278
v_mov_b32 v6,1
s_lshl_b32 s3,s49,2
v_mov_b32 v7,s3
s_mov_b64 exec,1
buffer_atomic_add v6,v7,s[12:15],0 offen sc1
s_mov_b64 exec,-1
arr_278:
s_lshl_b32 s58,s56,6
s_mul_i32 s63,s46,40960
s_mov_b32 s4,s32
s_mov_b32 s5,s33
s_mov_b32 s6,819200
s_mov_b32 s7,0x20000
v_lshrrev_b32 v9,2,v0
s_mov_b32 s64,1280
v_mul_lo_u32 v9,v9,s64
v_and_b32 v10,3,v0
v_lshl_add_u32 v6,v10,4,v9
s_add_u32 m0,s63,0
s_add_u32 s65,s58,0
buffer_load_dwordx4 v6,s[4:7],s65 offen lds
s_add_u32 m0,s63,1024
s_add_u32 s65,s58,20480
buffer_load_dwordx4 v6,s[4:7],s65 offen lds
s_add_u32 m0,s63,2048
s_add_u32 s65,s58,40960
buffer_load_dwordx4 v6,s[4:7],s65 offen lds
s_add_u32 m0,s63,3072
s_add_u32 s65,s58,61440
buffer_load_dwordx4 v6,s[4:7],s65 offen lds
s_add_u32 m0,s63,4096
s_add_u32 s65,s58,81920
buffer_load_dwordx4 v6,s[4:7],s65 offen lds
s_add_u32 m0,s63,5120
s_add_u32 s65,s58,102400
buffer_load_dwordx4 v6,s[4:7],s65 offen lds
s_add_u32 m0,s63,6144
s_add_u32 s65,s58,122880
buffer_load_dwordx4 v6,s[4:7],s65 offen lds
s_add_u32 m0,s63,7168
s_add_u32 s65,s58,143360
buffer_load_dwordx4 v6,s[4:7],s65 offen lds
s_add_u32 m0,s63,8192
s_add_u32 s65,s58,163840
buffer_load_dwordx4 v6,s[4:7],s65 offen lds
s_add_u32 m0,s63,9216
s_add_u32 s65,s58,184320
buffer_load_dwordx4 v6,s[4:7],s65 offen lds
s_add_u32 m0,s63,10240
s_add_u32 s65,s58,204800
buffer_load_dwordx4 v6,s[4:7],s65 offen lds
s_add_u32 m0,s63,11264
s_add_u32 s65,s58,225280
buffer_load_dwordx4 v6,s[4:7],s65 offen lds
s_add_u32 m0,s63,12288
s_add_u32 s65,s58,245760
buffer_load_dwordx4 v6,s[4:7],s65 offen lds
s_add_u32 m0,s63,13312
s_add_u32 s65,s58,266240
buffer_load_dwordx4 v6,s[4:7],s65 offen lds
s_add_u32 m0,s63,14336
s_add_u32 s65,s58,286720
buffer_load_dwordx4 v6,s[4:7],s65 offen lds
s_add_u32 m0,s63,15360
s_add_u32 s65,s58,307200
buffer_load_dwordx4 v6,s[4:7],s65 offen lds
s_add_u32 m0,s63,16384
s_add_u32 s65,s58,327680
buffer_load_dwordx4 v6,s[4:7],s65 offen lds
s_add_u32 m0,s63,17408
s_add_u32 s65,s58,348160
buffer_load_dwordx4 v6,s[4:7],s65 offen lds
s_add_u32 m0,s63,18432
s_add_u32 s65,s58,368640
buffer_load_dwordx4 v6,s[4:7],s65 offen lds
s_add_u32 m0,s63,19456
s_add_u32 s65,s58,389120
buffer_load_dwordx4 v6,s[4:7],s65 offen lds
s_add_u32 m0,s63,20480
s_add_u32 s65,s58,409600
buffer_load_dwordx4 v6,s[4:7],s65 offen lds
s_add_u32 m0,s63,21504
s_add_u32 s65,s58,430080
buffer_load_dwordx4 v6,s[4:7],s65 offen lds
s_add_u32 m0,s63,22528
s_add_u32 s65,s58,450560
buffer_load_dwordx4 v6,s[4:7],s65 offen lds
s_add_u32 m0,s63,23552
s_add_u32 s65,s58,471040
buffer_load_dwordx4 v6,s[4:7],s65 offen lds
s_add_u32 m0,s63,24576
s_add_u32 s65,s58,491520
buffer_load_dwordx4 v6,s[4:7],s65 offen lds
s_add_u32 m0,s63,25600
s_add_u32 s65,s58,512000
buffer_load_dwordx4 v6,s[4:7],s65 offen lds
s_add_u32 m0,s63,26624
s_add_u32 s65,s58,532480
buffer_load_dwordx4 v6,s[4:7],s65 offen lds
s_add_u32 m0,s63,27648
s_add_u32 s65,s58,552960
buffer_load_dwordx4 v6,s[4:7],s65 offen lds
s_add_u32 m0,s63,28672
s_add_u32 s65,s58,573440
buffer_load_dwordx4 v6,s[4:7],s65 offen lds
s_add_u32 m0,s63,29696
s_add_u32 s65,s58,593920
buffer_load_dwordx4 v6,s[4:7],s65 offen lds
s_add_u32 m0,s63,30720
s_add_u32 s65,s58,614400
buffer_load_dwordx4 v6,s[4:7],s65 offen lds
s_add_u32 m0,s63,31744
s_add_u32 s65,s58,634880
buffer_load_dwordx4 v6,s[4:7],s65 offen lds
s_add_u32 m0,s63,32768
s_add_u32 s65,s58,655360
buffer_load_dwordx4 v6,s[4:7],s65 offen lds
s_add_u32 m0,s63,33792
s_add_u32 s65,s58,675840
buffer_load_dwordx4 v6,s[4:7],s65 offen lds
s_add_u32 m0,s63,34816
s_add_u32 s65,s58,696320
buffer_load_dwordx4 v6,s[4:7],s65 offen lds
s_add_u32 m0,s63,35840
s_add_u32 s65,s58,716800
buffer_load_dwordx4 v6,s[4:7],s65 offen lds
s_add_u32 m0,s63,36864
s_add_u32 s65,s58,737280
buffer_load_dwordx4 v6,s[4:7],s65 offen lds
s_add_u32 m0,s63,37888
s_add_u32 s65,s58,757760
buffer_load_dwordx4 v6,s[4:7],s65 offen lds
s_add_u32 m0,s63,38912
s_add_u32 s65,s58,778240
buffer_load_dwordx4 v6,s[4:7],s65 offen lds
s_add_u32 m0,s63,39936
s_add_u32 s65,s58,798720
buffer_load_dwordx4 v6,s[4:7],s65 offen lds
s_waitcnt vmcnt(20)
v_bfe_u32 v9,v0,2,2
v_lshrrev_b32 v10,5,v0
v_lshl_add_u32 v9,v10,2,v9
v_mul_u32_u24 v9,64,v9
v_and_b32 v10,1,v0
v_lshl_add_u32 v9,v10,3,v9
v_bfe_u32 v10,v0,1,1
v_lshl_add_u32 v9,v10,5,v9
v_bfe_u32 v10,v0,4,1
v_lshl_add_u32 v9,v10,4,v9
v_add_u32 v7,s63,v9
ds_read_b64_tr_b16 a[0:1],v7 offset:0
ds_read_b64_tr_b16 a[2:3],v7 offset:1024
ds_read_b64_tr_b16 a[4:5],v7 offset:512
ds_read_b64_tr_b16 a[6:7],v7 offset:1536
ds_read_b64_tr_b16 a[8:9],v7 offset:2048
ds_read_b64_tr_b16 a[10:11],v7 offset:3072
ds_read_b64_tr_b16 a[12:13],v7 offset:2560
ds_read_b64_tr_b16 a[14:15],v7 offset:3584
ds_read_b64_tr_b16 a[16:17],v7 offset:4096
ds_read_b64_tr_b16 a[18:19],v7 offset:5120
ds_read_b64_tr_b16 a[20:21],v7 offset:4608
ds_read_b64_tr_b16 a[22:23],v7 offset:5632
s_waitcnt lgkmcnt(4)
ds_read_b64_tr_b16 a[24:25],v7 offset:6144
ds_read_b64_tr_b16 a[26:27],v7 offset:7168
ds_read_b64_tr_b16 a[28:29],v7 offset:6656
ds_read_b64_tr_b16 a[30:31],v7 offset:7680
ds_read_b64_tr_b16 a[32:33],v7 offset:8192
ds_read_b64_tr_b16 a[34:35],v7 offset:9216
ds_read_b64_tr_b16 a[36:37],v7 offset:8704
ds_read_b64_tr_b16 a[38:39],v7 offset:9728
ds_read_b64_tr_b16 a[40:41],v7 offset:10240
ds_read_b64_tr_b16 a[42:43],v7 offset:11264
ds_read_b64_tr_b16 a[44:45],v7 offset:10752
ds_read_b64_tr_b16 a[46:47],v7 offset:11776
s_waitcnt lgkmcnt(4)
ds_read_b64_tr_b16 a[48:49],v7 offset:12288
ds_read_b64_tr_b16 a[50:51],v7 offset:13312
ds_read_b64_tr_b16 a[52:53],v7 offset:12800
ds_read_b64_tr_b16 a[54:55],v7 offset:13824
ds_read_b64_tr_b16 a[56:57],v7 offset:14336
ds_read_b64_tr_b16 a[58:59],v7 offset:15360
ds_read_b64_tr_b16 a[60:61],v7 offset:14848
ds_read_b64_tr_b16 a[62:63],v7 offset:15872
ds_read_b64_tr_b16 a[64:65],v7 offset:16384
ds_read_b64_tr_b16 a[66:67],v7 offset:17408
ds_read_b64_tr_b16 a[68:69],v7 offset:16896
ds_read_b64_tr_b16 a[70:71],v7 offset:17920
s_waitcnt lgkmcnt(4)
ds_read_b64_tr_b16 a[72:73],v7 offset:18432
ds_read_b64_tr_b16 a[74:75],v7 offset:19456
ds_read_b64_tr_b16 a[76:77],v7 offset:18944
ds_read_b64_tr_b16 a[78:79],v7 offset:19968
s_waitcnt lgkmcnt(0)
s_waitcnt vmcnt(0)
v_bfe_u32 v9,v0,2,2
v_lshrrev_b32 v10,5,v0
v_lshl_add_u32 v9,v10,2,v9
v_mul_u32_u24 v9,64,v9
v_and_b32 v10,1,v0
v_lshl_add_u32 v9,v10,3,v9
v_bfe_u32 v10,v0,1,1
v_lshl_add_u32 v9,v10,5,v9
v_bfe_u32 v10,v0,4,1
v_lshl_add_u32 v9,v10,4,v9
v_add_u32 v7,s63,v9
ds_read_b64_tr_b16 a[80:81],v7 offset:20480
ds_read_b64_tr_b16 a[82:83],v7 offset:21504
ds_read_b64_tr_b16 a[84:85],v7 offset:20992
ds_read_b64_tr_b16 a[86:87],v7 offset:22016
ds_read_b64_tr_b16 a[88:89],v7 offset:22528
ds_read_b64_tr_b16 a[90:91],v7 offset:23552
ds_read_b64_tr_b16 a[92:93],v7 offset:23040
ds_read_b64_tr_b16 a[94:95],v7 offset:24064
ds_read_b64_tr_b16 a[96:97],v7 offset:24576
ds_read_b64_tr_b16 a[98:99],v7 offset:25600
ds_read_b64_tr_b16 a[100:101],v7 offset:25088
ds_read_b64_tr_b16 a[102:103],v7 offset:26112
s_waitcnt lgkmcnt(4)
ds_read_b64_tr_b16 a[104:105],v7 offset:26624
ds_read_b64_tr_b16 a[106:107],v7 offset:27648
ds_read_b64_tr_b16 a[108:109],v7 offset:27136
ds_read_b64_tr_b16 a[110:111],v7 offset:28160
ds_read_b64_tr_b16 a[112:113],v7 offset:28672
ds_read_b64_tr_b16 a[114:115],v7 offset:29696
ds_read_b64_tr_b16 a[116:117],v7 offset:29184
ds_read_b64_tr_b16 a[118:119],v7 offset:30208
ds_read_b64_tr_b16 a[120:121],v7 offset:30720
ds_read_b64_tr_b16 a[122:123],v7 offset:31744
ds_read_b64_tr_b16 a[124:125],v7 offset:31232
ds_read_b64_tr_b16 a[126:127],v7 offset:32256
s_waitcnt lgkmcnt(4)
ds_read_b64_tr_b16 a[128:129],v7 offset:32768
ds_read_b64_tr_b16 a[130:131],v7 offset:33792
ds_read_b64_tr_b16 a[132:133],v7 offset:33280
ds_read_b64_tr_b16 a[134:135],v7 offset:34304
ds_read_b64_tr_b16 a[136:137],v7 offset:34816
ds_read_b64_tr_b16 a[138:139],v7 offset:35840
ds_read_b64_tr_b16 a[140:141],v7 offset:35328
ds_read_b64_tr_b16 a[142:143],v7 offset:36352
ds_read_b64_tr_b16 a[144:145],v7 offset:36864
ds_read_b64_tr_b16 a[146:147],v7 offset:37888
ds_read_b64_tr_b16 a[148:149],v7 offset:37376
ds_read_b64_tr_b16 a[150:151],v7 offset:38400
s_waitcnt lgkmcnt(4)
ds_read_b64_tr_b16 a[152:153],v7 offset:38912
ds_read_b64_tr_b16 a[154:155],v7 offset:39936
ds_read_b64_tr_b16 a[156:157],v7 offset:39424
ds_read_b64_tr_b16 a[158:159],v7 offset:40448
s_waitcnt lgkmcnt(0)
v_mov_b32 v24,0x3f803f80
v_mov_b32 v25,0x3f803f80
v_mov_b32 v26,0x3f803f80
v_mov_b32 v27,0x3f803f80
s_nop 1
v_mfma_f32_32x32x16_bf16 v[144:159],a[0:3],v[24:27],0
v_mfma_f32_32x32x16_bf16 v[144:159],a[4:7],v[24:27],v[144:159]
v_mfma_f32_32x32x16_bf16 v[144:159],a[8:11],v[24:27],v[144:159]
v_mfma_f32_32x32x16_bf16 v[144:159],a[12:15],v[24:27],v[144:159]
v_mfma_f32_32x32x16_bf16 v[144:159],a[16:19],v[24:27],v[144:159]
v_mfma_f32_32x32x16_bf16 v[144:159],a[20:23],v[24:27],v[144:159]
v_mfma_f32_32x32x16_bf16 v[144:159],a[24:27],v[24:27],v[144:159]
v_mfma_f32_32x32x16_bf16 v[144:159],a[28:31],v[24:27],v[144:159]
v_mfma_f32_32x32x16_bf16 v[144:159],a[32:35],v[24:27],v[144:159]
v_mfma_f32_32x32x16_bf16 v[144:159],a[36:39],v[24:27],v[144:159]
v_mfma_f32_32x32x16_bf16 v[144:159],a[40:43],v[24:27],v[144:159]
v_mfma_f32_32x32x16_bf16 v[144:159],a[44:47],v[24:27],v[144:159]
v_mfma_f32_32x32x16_bf16 v[144:159],a[48:51],v[24:27],v[144:159]
v_mfma_f32_32x32x16_bf16 v[144:159],a[52:55],v[24:27],v[144:159]
v_mfma_f32_32x32x16_bf16 v[144:159],a[56:59],v[24:27],v[144:159]
v_mfma_f32_32x32x16_bf16 v[144:159],a[60:63],v[24:27],v[144:159]
v_mfma_f32_32x32x16_bf16 v[144:159],a[64:67],v[24:27],v[144:159]
v_mfma_f32_32x32x16_bf16 v[144:159],a[68:71],v[24:27],v[144:159]
v_mfma_f32_32x32x16_bf16 v[144:159],a[72:75],v[24:27],v[144:159]
v_mfma_f32_32x32x16_bf16 v[144:159],a[76:79],v[24:27],v[144:159]
v_mfma_f32_32x32x16_bf16 v[144:159],a[80:83],v[24:27],v[144:159]
v_mfma_f32_32x32x16_bf16 v[144:159],a[84:87],v[24:27],v[144:159]
v_mfma_f32_32x32x16_bf16 v[144:159],a[88:91],v[24:27],v[144:159]
v_mfma_f32_32x32x16_bf16 v[144:159],a[92:95],v[24:27],v[144:159]
v_mfma_f32_32x32x16_bf16 v[144:159],a[96:99],v[24:27],v[144:159]
v_mfma_f32_32x32x16_bf16 v[144:159],a[100:103],v[24:27],v[144:159]
v_mfma_f32_32x32x16_bf16 v[144:159],a[104:107],v[24:27],v[144:159]
v_mfma_f32_32x32x16_bf16 v[144:159],a[108:111],v[24:27],v[144:159]
v_mfma_f32_32x32x16_bf16 v[144:159],a[112:115],v[24:27],v[144:159]
v_mfma_f32_32x32x16_bf16 v[144:159],a[116:119],v[24:27],v[144:159]
v_mfma_f32_32x32x16_bf16 v[144:159],a[120:123],v[24:27],v[144:159]
v_mfma_f32_32x32x16_bf16 v[144:159],a[124:127],v[24:27],v[144:159]
v_mfma_f32_32x32x16_bf16 v[144:159],a[128:131],v[24:27],v[144:159]
v_mfma_f32_32x32x16_bf16 v[144:159],a[132:135],v[24:27],v[144:159]
v_mfma_f32_32x32x16_bf16 v[144:159],a[136:139],v[24:27],v[144:159]
v_mfma_f32_32x32x16_bf16 v[144:159],a[140:143],v[24:27],v[144:159]
v_mfma_f32_32x32x16_bf16 v[144:159],a[144:147],v[24:27],v[144:159]
v_mfma_f32_32x32x16_bf16 v[144:159],a[148:151],v[24:27],v[144:159]
v_mfma_f32_32x32x16_bf16 v[144:159],a[152:155],v[24:27],v[144:159]
v_mfma_f32_32x32x16_bf16 v[144:159],a[156:159],v[24:27],v[144:159]
v_and_b32 v182,31,v0
v_lshlrev_b32 v182,3,v182
v_add_u32 v182,0xa000,v182
s_barrier
s_lshl_b32 s3,s49,2
v_mov_b32 v7,s3
s_nop 5
ibw_279:
buffer_load_dword v6,v7,s[12:15],0 offen sc1
s_waitcnt vmcnt(0)
v_cmp_ne_u32 vcc,256,v6
s_nop 0
s_cbranch_vccz ok_280
s_sleep 8
s_sub_u32 s47,s47,1
s_cbranch_scc1 ABORT
s_branch ibw_279
ok_280:
s_cmp_lg_u32 s49,0
s_cbranch_scc1 ibok_281
v_and_b32 v7,7,v0
v_lshlrev_b32 v7,2,v7
buffer_load_dword v6,v7,s[12:15],0 offen offset:32 sc1
s_waitcnt vmcnt(0)
v_cmp_ne_u32 vcc,32,v6
s_nop 0
s_cbranch_vccz ibok_281
s_barrier
s_mov_b32 s49,1
s_mov_b32 s3,s2
s_load_dwordx16 s[16:31],s[0:1],0
s_load_dwordx8 s[32:39],s[0:1],64
s_waitcnt lgkmcnt(0)
s_branch DISPATCH
ibok_281:
s_mov_b32 s50,0
s_mov_b32 s32,0
s_mov_b32 s57,0
s_mov_b32 s59,2147483648
s_mov_b32 s82,2147483648
s_mov_b32 s39,2147483648
v_mov_b32 v22,94208
v_lshl_add_u32 v22,v0,2,v22
v_mov_b32 v23,0
ds_write_b32 v22,v23
s_mov_b32 s39,1600000
v_and_b32 v72,15,v0
v_lshlrev_b32 v72,7,v72
v_min_u32 v6,51,v0
v_lshlrev_b32 v6,2,v6
v_add_u32 v2,0,v6
v_add_u32 v7,127360,v6
v_cmp_gt_u32 s[78:79],32,v0
s_nop 1
v_cndmask_b32 v2,v7,v2,s[78:79]
s_mov_b32 s51,0
s_mov_b32 s52,0
s_mul_i32 s62,s51,9
s_and_b32 s63,s52,7
s_add_u32 s62,s62,s63
s_mul_i32 s62,s62,40960
s_add_u32 s62,s62,237371392
s_lshl_b32 s63,s56,11
s_add_u32 s62,s62,s63
buffer_load_dword v73,v72,s[8:11],s62 offen sc1
s_mov_b32 s51,0
s_mov_b32 s52,1
s_mul_i32 s62,s51,9
s_and_b32 s63,s52,7
s_add_u32 s62,s62,s63
s_mul_i32 s62,s62,40960
s_add_u32 s62,s62,237371392
s_lshl_b32 s63,s56,11
s_add_u32 s62,s62,s63
buffer_load_dword v73,v72,s[8:11],s62 offen sc1
s_mov_b32 s51,0
s_mov_b32 s52,2
s_mul_i32 s62,s51,9
s_and_b32 s63,s52,7
s_add_u32 s62,s62,s63
s_mul_i32 s62,s62,40960
s_add_u32 s62,s62,237371392
s_lshl_b32 s63,s56,11
s_add_u32 s62,s62,s63
buffer_load_dword v73,v72,s[8:11],s62 offen sc1
s_mov_b32 s51,0
s_mov_b32 s52,3
s_mul_i32 s62,s51,9
s_and_b32 s63,s52,7
s_add_u32 s62,s62,s63
s_mul_i32 s62,s62,40960
s_add_u32 s62,s62,237371392
s_lshl_b32 s63,s56,11
s_add_u32 s62,s62,s63
buffer_load_dword v73,v72,s[8:11],s62 offen sc1
s_mov_b32 s51,0
s_mov_b32 s52,4
s_mul_i32 s62,s51,9
s_and_b32 s63,s52,7
s_add_u32 s62,s62,s63
s_mul_i32 s62,s62,40960
s_add_u32 s62,s62,237371392
s_lshl_b32 s63,s56,11
s_add_u32 s62,s62,s63
buffer_load_dword v73,v72,s[8:11],s62 offen sc1
s_mov_b32 s51,0
s_mov_b32 s52,5
s_mul_i32 s62,s51,9
s_and_b32 s63,s52,7
s_add_u32 s62,s62,s63
s_mul_i32 s62,s62,40960
s_add_u32 s62,s62,237371392
s_lshl_b32 s63,s56,11
s_add_u32 s62,s62,s63
buffer_load_dword v73,v72,s[8:11],s62 offen sc1
s_mov_b32 s51,0
s_mov_b32 s52,6
s_mul_i32 s62,s51,9
s_and_b32 s63,s52,7
s_add_u32 s62,s62,s63
s_mul_i32 s62,s62,40960
s_add_u32 s62,s62,237371392
s_lshl_b32 s63,s56,11
s_add_u32 s62,s62,s63
buffer_load_dword v73,v72,s[8:11],s62 offen sc1
s_mov_b32 s51,0
s_mov_b32 s52,7
s_mul_i32 s62,s51,9
s_and_b32 s63,s52,7
s_add_u32 s62,s62,s63
s_mul_i32 s62,s62,40960
s_add_u32 s62,s62,237371392
s_lshl_b32 s63,s56,11
s_add_u32 s62,s62,s63
buffer_load_dword v73,v72,s[8:11],s62 offen sc1
s_mov_b32 s51,1
s_mov_b32 s52,0
s_mul_i32 s62,s51,9
s_and_b32 s63,s52,7
s_add_u32 s62,s62,s63
s_mul_i32 s62,s62,40960
s_add_u32 s62,s62,237371392
s_lshl_b32 s63,s56,11
s_add_u32 s62,s62,s63
buffer_load_dword v73,v72,s[8:11],s62 offen sc1
s_mov_b32 s51,1
s_mov_b32 s52,1
s_mul_i32 s62,s51,9
s_and_b32 s63,s52,7
s_add_u32 s62,s62,s63
s_mul_i32 s62,s62,40960
s_add_u32 s62,s62,237371392
s_lshl_b32 s63,s56,11
s_add_u32 s62,s62,s63
buffer_load_dword v73,v72,s[8:11],s62 offen sc1
s_mov_b32 s51,1
s_mov_b32 s52,2
s_mul_i32 s62,s51,9
s_and_b32 s63,s52,7
s_add_u32 s62,s62,s63
s_mul_i32 s62,s62,40960
s_add_u32 s62,s62,237371392
s_lshl_b32 s63,s56,11
s_add_u32 s62,s62,s63
buffer_load_dword v73,v72,s[8:11],s62 offen sc1
s_mov_b32 s51,1
s_mov_b32 s52,3
s_mul_i32 s62,s51,9
s_and_b32 s63,s52,7
s_add_u32 s62,s62,s63
s_mul_i32 s62,s62,40960
s_add_u32 s62,s62,237371392
s_lshl_b32 s63,s56,11
s_add_u32 s62,s62,s63
buffer_load_dword v73,v72,s[8:11],s62 offen sc1
s_mov_b32 s51,1
s_mov_b32 s52,4
s_mul_i32 s62,s51,9
s_and_b32 s63,s52,7
s_add_u32 s62,s62,s63
s_mul_i32 s62,s62,40960
s_add_u32 s62,s62,237371392
s_lshl_b32 s63,s56,11
s_add_u32 s62,s62,s63
buffer_load_dword v73,v72,s[8:11],s62 offen sc1
s_mov_b32 s51,1
s_mov_b32 s52,5
s_mul_i32 s62,s51,9
s_and_b32 s63,s52,7
s_add_u32 s62,s62,s63
s_mul_i32 s62,s62,40960
s_add_u32 s62,s62,237371392
s_lshl_b32 s63,s56,11
s_add_u32 s62,s62,s63
buffer_load_dword v73,v72,s[8:11],s62 offen sc1
s_mov_b32 s51,1
s_mov_b32 s52,6
s_mul_i32 s62,s51,9
s_and_b32 s63,s52,7
s_add_u32 s62,s62,s63
s_mul_i32 s62,s62,40960
s_add_u32 s62,s62,237371392
s_lshl_b32 s63,s56,11
s_add_u32 s62,s62,s63
buffer_load_dword v73,v72,s[8:11],s62 offen sc1
s_mov_b32 s51,1
s_mov_b32 s52,7
s_mul_i32 s62,s51,9
s_and_b32 s63,s52,7
s_add_u32 s62,s62,s63
s_mul_i32 s62,s62,40960
s_add_u32 s62,s62,237371392
s_lshl_b32 s63,s56,11
s_add_u32 s62,s62,s63
buffer_load_dword v73,v72,s[8:11],s62 offen sc1
s_waitcnt vmcnt(0)
s_waitcnt lgkmcnt(0)
s_barrier
s_mov_b32 s83,s100
s_min_u32 s62,s32,127
s_sub_u32 s60,s62,13
s_lshr_b32 s34,s60,1
s_and_b32 s33,s60,1
s_cmp_eq_u32 s33,0
s_cselect_b32 s61,13,0
s_add_u32 s34,s34,s61
s_sub_u32 s61,s60,51
s_cmp_ge_u32 s60,102
s_cselect_b32 s34,s61,s34
s_cselect_b32 s33,1,s33
s_cmp_lt_u32 s62,13
s_cselect_b32 s34,s62,s34
s_cselect_b32 s33,0,s33
s_lshl_b32 s35,s33,6
s_add_u32 s35,s35,s34
s_lshl_b32 s35,s35,9
s_add_u32 s35,s35,393216
s_cmp_lt_u32 s34,7
s_cselect_b64 s[76:77],s[78:79],-1
s_sub_u32 s57,46080,s57
v_swap_b32 v16,v18
v_swap_b32 v17,v19
s_add_u32 s62,s32,1
s_min_u32 s62,s62,127
s_sub_u32 s60,s62,13
s_lshr_b32 s41,s60,1
s_and_b32 s40,s60,1
s_cmp_eq_u32 s40,0
s_cselect_b32 s61,13,0
s_add_u32 s41,s41,s61
s_sub_u32 s61,s60,51
s_cmp_ge_u32 s60,102
s_cselect_b32 s41,s61,s41
s_cselect_b32 s40,1,s40
s_cmp_lt_u32 s62,13
s_cselect_b32 s41,s62,s41
s_cselect_b32 s40,0,s40
s_lshl_b32 s42,s40,6
s_add_u32 s42,s42,s41
s_lshl_b32 s42,s42,9
s_add_u32 s42,s42,393216
s_cmp_lt_u32 s41,7
s_cselect_b64 s[80:81],s[78:79],-1
W1_COLD:
s_mov_b32 s37,0
s_cmp_lg_u32 s46,0
s_cbranch_scc1 wo_282
fb_284:
buffer_load_dword v3,v2,s[8:11],s35 offen sc1
s_waitcnt vmcnt(0)
v_cmp_eq_u32 vcc,0,v3
s_and_b64 vcc,vcc,s[76:77]
s_cbranch_scc0 ok_285
s_sleep 3
s_sub_u32 s47,s47,1
s_cbranch_scc1 ABORT
s_branch fb_284
ok_285:
W1_COLD2:
s_add_u32 s65,s32,1
s_or_b32 s65,s65,s37
v_mov_b32 v23,s65
ds_max_i32 v22,v23
s_branch wd_283
wo_282:
ds_read_b32 v23,v22
s_waitcnt lgkmcnt(0)
v_cmp_ge_u32 vcc,s32,v23
s_nop 0
s_cbranch_vccz wd_283
s_sleep 1
s_sub_u32 s39,s39,1
s_cbranch_scc1 ABORT
s_branch wo_282
wd_283:
s_sub_u32 s66,46080,s57
s_lshl_b32 s60,s33,6
s_add_u32 s60,s60,s34
s_mul_i32 s60,s60,46080
s_add_u32 s60,s60,s37
s_add_u32 s60,s60,223608832
s_mov_b32 s67,s60
s_mul_i32 s61,s46,10240
s_add_u32 s60,s60,s61
s_add_u32 s61,s61,s66
s_add_u32 m0,s61,0
s_add_u32 s63,s60,0
buffer_load_dwordx4 v1,s[8:11],s63 offen sc1 lds
buffer_load_dwordx4 v1,s[8:11],s63 offen offset:1024 sc1 lds
buffer_load_dwordx4 v1,s[8:11],s63 offen offset:2048 sc1 lds
buffer_load_dwordx4 v1,s[8:11],s63 offen offset:3072 sc1 lds
s_add_u32 m0,s61,4096
s_add_u32 s63,s60,4096
buffer_load_dwordx4 v1,s[8:11],s63 offen sc1 lds
buffer_load_dwordx4 v1,s[8:11],s63 offen offset:1024 sc1 lds
s_waitcnt vmcnt(6)
s_mov_b64 exec,1
s_cmp_lg_u32 s49,0
s_cbranch_scc0 ls_286
buffer_store_dword v5,v1,s[8:11],s59 offen sc1
s_branch ls_287
ls_286:
buffer_store_dword v5,v1,s[8:11],s59 offen
ls_287:
s_mov_b64 exec,-1
s_mov_b32 s59,2147483648
buffer_load_dwordx4 v1,s[8:11],s63 offen offset:2048 sc1 lds
buffer_load_dwordx4 v1,s[8:11],s63 offen offset:3072 sc1 lds
s_add_u32 m0,s61,8192
s_add_u32 s63,s60,8192
buffer_load_dwordx4 v1,s[8:11],s63 offen sc1 lds
buffer_load_dwordx4 v1,s[8:11],s63 offen offset:1024 sc1 lds
s_add_u32 m0,s66,40960
s_add_u32 s63,s67,40960
buffer_load_dwordx4 v1,s[8:11],s63 offen sc1 lds
s_mov_b32 s35,s42
buffer_load_dword v3,v2,s[8:11],s35 offen sc1
s_mov_b32 s53,s33
s_mov_b32 s54,s34
s_add_u32 s32,s32,1
s_mov_b32 s33,s40
s_mov_b32 s34,s41
s_mov_b64 s[76:77],s[80:81]
s_sub_u32 s57,46080,s57
v_swap_b32 v16,v18
v_swap_b32 v17,v19
s_mov_b32 s51,s53
s_mov_b32 s52,s54
s_mov_b32 s37,2147483648
s_waitcnt vmcnt(7)
s_branch W1_GO
W1_NEXT:
s_sub_u32 s57,46080,s57
v_swap_b32 v16,v18
v_swap_b32 v17,v19
s_mov_b32 s51,s53
s_mov_b32 s52,s54
s_waitcnt vmcnt(2)
v_cmp_eq_u32 vcc,0,v3
s_and_b64 vcc,vcc,s[76:77]
s_cselect_b32 s37,2147483648,0
s_cmp_lt_u32 s32,128
s_cselect_b32 s37,s37,2147483648
W1_GO:
s_barrier
ds_read_b128 v[24:27],v16 offset:0
ds_read_b128 v[28:31],v17 offset:0
ds_read_b128 v[32:35],v16 offset:10240
ds_read_b128 v[36:39],v17 offset:10240
ds_read_b128 v[40:43],v16 offset:20480
ds_read_b128 v[44:47],v17 offset:20480
ds_read_b128 v[48:51],v16 offset:30720
s_waitcnt lgkmcnt(6)
v_mfma_f32_32x32x16_bf16 v[56:71],a[0:3],v[24:27],0
ds_read_b128 v[52:55],v17 offset:30720
s_add_u32 s65,s32,1
s_or_b32 s65,s65,s37
v_mov_b32 v23,s65
s_waitcnt lgkmcnt(6)
v_mfma_f32_32x32x16_bf16 v[56:71],a[4:7],v[28:31],v[56:71]
ds_read_b128 v[24:27],v16 offset:2048
ds_max_i32 v22,v23
s_sub_u32 s66,46080,s57
s_waitcnt lgkmcnt(6)
v_mfma_f32_32x32x16_bf16 v[56:71],a[40:43],v[32:35],v[56:71]
ds_read_b128 v[28:31],v17 offset:2048
s_lshl_b32 s60,s33,6
s_add_u32 s60,s60,s34
s_mul_i32 s60,s60,46080
s_add_u32 s60,s60,s37
v_mfma_f32_32x32x16_bf16 v[56:71],a[44:47],v[36:39],v[56:71]
ds_read_b128 v[32:35],v16 offset:12288
s_add_u32 s60,s60,223608832
s_mov_b32 s67,s60
s_mul_i32 s61,s46,10240
s_waitcnt lgkmcnt(6)
v_mfma_f32_32x32x16_bf16 v[56:71],a[80:83],v[40:43],v[56:71]
ds_read_b128 v[36:39],v17 offset:12288
s_add_u32 s60,s60,s61
s_add_u32 s61,s61,s66
s_add_u32 m0,s61,0
s_add_u32 s63,s60,0
v_mfma_f32_32x32x16_bf16 v[56:71],a[84:87],v[44:47],v[56:71]
ds_read_b128 v[40:43],v16 offset:22528
buffer_load_dwordx4 v1,s[8:11],s63 offen sc1 lds
s_mul_i32 s71,s51,9
s_waitcnt lgkmcnt(6)
v_mfma_f32_32x32x16_bf16 v[56:71],a[120:123],v[48:51],v[56:71]
ds_read_b128 v[44:47],v17 offset:22528
s_and_b32 s72,s52,7
s_add_u32 s71,s71,s72
s_mul_i32 s71,s71,40960
s_add_u32 s71,s71,237371392
v_mfma_f32_32x32x16_bf16 v[56:71],a[124:127],v[52:55],v[56:71]
ds_read_b128 v[48:51],v16 offset:32768
s_lshl_b32 s72,s56,11
s_add_u32 s71,s71,s72
s_lshl_b32 s82,s51,6
s_waitcnt lgkmcnt(5)
v_mfma_f32_32x32x16_bf16 v[56:71],a[8:11],v[24:27],v[56:71]
ds_read_b128 v[52:55],v17 offset:32768
buffer_load_dwordx4 v1,s[8:11],s63 offen offset:1024 sc1 lds
s_add_u32 s82,s82,s52
s_lshl_b32 s82,s82,9
v_mfma_f32_32x32x16_bf16 v[56:71],a[12:15],v[28:31],v[56:71]
ds_read_b128 v[24:27],v16 offset:4096
s_add_u32 s82,s82,458752
s_lshl_b32 s70,s56,2
s_add_u32 s82,s82,s70
s_waitcnt lgkmcnt(5)
v_mfma_f32_32x32x16_bf16 v[56:71],a[48:51],v[32:35],v[56:71]
ds_read_b128 v[28:31],v17 offset:4096
buffer_load_dword v3,v2,s[8:11],s35 offen sc1
v_mfma_f32_32x32x16_bf16 v[56:71],a[52:55],v[36:39],v[56:71]
ds_read_b128 v[32:35],v16 offset:14336
buffer_load_dwordx4 v1,s[8:11],s63 offen offset:2048 sc1 lds
s_waitcnt lgkmcnt(5)
v_mfma_f32_32x32x16_bf16 v[56:71],a[88:91],v[40:43],v[56:71]
ds_read_b128 v[36:39],v17 offset:14336
s_waitcnt vmcnt(4)
s_mov_b64 exec,1
s_cmp_lg_u32 s49,0
s_cbranch_scc0 ls_288
buffer_store_dword v5,v1,s[8:11],s59 offen sc1
s_branch ls_289
ls_288:
buffer_store_dword v5,v1,s[8:11],s59 offen
ls_289:
s_mov_b64 exec,-1
s_mov_b32 s59,2147483648
v_mfma_f32_32x32x16_bf16 v[56:71],a[92:95],v[44:47],v[56:71]
ds_read_b128 v[40:43],v16 offset:24576
s_waitcnt lgkmcnt(5)
v_mfma_f32_32x32x16_bf16 v[56:71],a[128:131],v[48:51],v[56:71]
ds_read_b128 v[44:47],v17 offset:24576
buffer_load_dwordx4 v1,s[8:11],s63 offen offset:3072 sc1 lds
s_add_u32 m0,s61,4096
s_add_u32 s63,s60,4096
v_mfma_f32_32x32x16_bf16 v[56:71],a[132:135],v[52:55],v[56:71]
ds_read_b128 v[48:51],v16 offset:34816
s_waitcnt lgkmcnt(5)
v_mfma_f32_32x32x16_bf16 v[56:71],a[16:19],v[24:27],v[56:71]
ds_read_b128 v[52:55],v17 offset:34816
s_barrier
v_mfma_f32_32x32x16_bf16 v[56:71],a[20:23],v[28:31],v[56:71]
ds_read_b128 v[24:27],v16 offset:6144
v_add_u32 v183,s57,v182
buffer_load_dwordx4 v1,s[8:11],s63 offen sc1 lds
s_waitcnt lgkmcnt(5)
v_mfma_f32_32x32x16_bf16 v[56:71],a[56:59],v[32:35],v[56:71]
ds_read_b128 v[28:31],v17 offset:6144
ds_read_b64 v[180:181],v183
v_mfma_f32_32x32x16_bf16 v[56:71],a[60:63],v[36:39],v[56:71]
ds_read_b128 v[32:35],v16 offset:16384
s_waitcnt lgkmcnt(6)
v_mfma_f32_32x32x16_bf16 v[56:71],a[96:99],v[40:43],v[56:71]
ds_read_b128 v[36:39],v17 offset:16384
buffer_load_dwordx4 v1,s[8:11],s63 offen offset:1024 sc1 lds
v_mfma_f32_32x32x16_bf16 v[56:71],a[100:103],v[44:47],v[56:71]
ds_read_b128 v[40:43],v16 offset:26624
s_waitcnt lgkmcnt(6)
v_mfma_f32_32x32x16_bf16 v[56:71],a[136:139],v[48:51],v[56:71]
ds_read_b128 v[44:47],v17 offset:26624
v_mfma_f32_32x32x16_bf16 v[56:71],a[140:143],v[52:55],v[56:71]
ds_read_b128 v[48:51],v16 offset:36864
buffer_load_dwordx4 v1,s[8:11],s63 offen offset:2048 sc1 lds
s_waitcnt lgkmcnt(6)
v_mfma_f32_32x32x16_bf16 v[56:71],a[24:27],v[24:27],v[56:71]
ds_read_b128 v[52:55],v17 offset:36864
v_mfma_f32_32x32x16_bf16 v[56:71],a[28:31],v[28:31],v[56:71]
ds_read_b128 v[24:27],v16 offset:8192
s_waitcnt lgkmcnt(5)
v_mfma_f32_32x32x16_bf16 v[56:71],a[64:67],v[32:35],v[56:71]
ds_read_b128 v[28:31],v17 offset:8192
buffer_load_dwordx4 v1,s[8:11],s63 offen offset:3072 sc1 lds
s_add_u32 m0,s61,8192
s_add_u32 s63,s60,8192
v_mfma_f32_32x32x16_bf16 v[56:71],a[68:71],v[36:39],v[56:71]
ds_read_b128 v[32:35],v16 offset:18432
s_waitcnt lgkmcnt(5)
v_mfma_f32_32x32x16_bf16 v[56:71],a[104:107],v[40:43],v[56:71]
ds_read_b128 v[36:39],v17 offset:18432
v_mfma_f32_32x32x16_bf16 v[56:71],a[108:111],v[44:47],v[56:71]
ds_read_b128 v[40:43],v16 offset:28672
buffer_load_dwordx4 v1,s[8:11],s63 offen sc1 lds
s_waitcnt lgkmcnt(5)
v_mfma_f32_32x32x16_bf16 v[56:71],a[144:147],v[48:51],v[56:71]
ds_read_b128 v[44:47],v17 offset:28672
v_mfma_f32_32x32x16_bf16 v[56:71],a[148:151],v[52:55],v[56:71]
ds_read_b128 v[48:51],v16 offset:38912
s_waitcnt lgkmcnt(5)
v_mfma_f32_32x32x16_bf16 v[56:71],a[32:35],v[24:27],v[56:71]
ds_read_b128 v[52:55],v17 offset:38912
buffer_load_dwordx4 v1,s[8:11],s63 offen offset:1024 sc1 lds
s_add_u32 m0,s66,40960
s_add_u32 s63,s67,40960
v_mfma_f32_32x32x16_bf16 v[56:71],a[36:39],v[28:31],v[56:71]
s_waitcnt lgkmcnt(4)
v_mfma_f32_32x32x16_bf16 v[56:71],a[72:75],v[32:35],v[56:71]
v_mfma_f32_32x32x16_bf16 v[56:71],a[76:79],v[36:39],v[56:71]
buffer_load_dwordx4 v1,s[8:11],s63 offen sc1 lds
s_add_u32 s62,s32,1
s_min_u32 s62,s62,127
s_sub_u32 s60,s62,13
s_waitcnt lgkmcnt(2)
v_mfma_f32_32x32x16_bf16 v[56:71],a[112:115],v[40:43],v[56:71]
s_lshr_b32 s41,s60,1
s_and_b32 s40,s60,1
s_cmp_eq_u32 s40,0
s_cselect_b32 s61,13,0
s_add_u32 s41,s41,s61
s_sub_u32 s61,s60,51
v_mfma_f32_32x32x16_bf16 v[56:71],a[116:119],v[44:47],v[56:71]
s_cmp_ge_u32 s60,102
s_cselect_b32 s41,s61,s41
s_cselect_b32 s40,1,s40
s_waitcnt lgkmcnt(0)
v_mfma_f32_32x32x16_bf16 v[56:71],a[152:155],v[48:51],v[56:71]
s_cmp_lt_u32 s62,13
s_cselect_b32 s41,s62,s41
s_cselect_b32 s40,0,s40
s_lshl_b32 s42,s40,6
s_add_u32 s42,s42,s41
s_lshl_b32 s42,s42,9
v_mfma_f32_32x32x16_bf16 v[56:71],a[156:159],v[52:55],v[56:71]
s_add_u32 s42,s42,393216
s_cmp_lt_u32 s41,7
s_cselect_b64 s[80:81],s[78:79],-1
s_cmp_eq_u32 s37,0
s_cbranch_scc0 sec_292
s_mov_b32 s35,s42
buffer_load_dword v3,v2,s[8:11],s35 offen sc1
s_mov_b32 s53,s33
s_mov_b32 s54,s34
s_add_u32 s32,s32,1
s_mov_b32 s33,s40
s_mov_b32 s34,s41
s_mov_b64 s[76:77],s[80:81]
s_nop 2
ep_290:
v_pk_fma_f32 v[56:57],v[144:145],v[180:181],v[56:57] op_sel_hi:[1,0,1] neg_lo:[0,1,0] neg_hi:[0,1,0]
v_pk_fma_f32 v[58:59],v[146:147],v[180:181],v[58:59] op_sel_hi:[1,0,1] neg_lo:[0,1,0] neg_hi:[0,1,0]
v_pk_fma_f32 v[60:61],v[148:149],v[180:181],v[60:61] op_sel_hi:[1,0,1] neg_lo:[0,1,0] neg_hi:[0,1,0]
v_pk_fma_f32 v[62:63],v[150:151],v[180:181],v[62:63] op_sel_hi:[1,0,1] neg_lo:[0,1,0] neg_hi:[0,1,0]
v_pk_fma_f32 v[64:65],v[152:153],v[180:181],v[64:65] op_sel_hi:[1,0,1] neg_lo:[0,1,0] neg_hi:[0,1,0]
v_pk_fma_f32 v[66:67],v[154:155],v[180:181],v[66:67] op_sel_hi:[1,0,1] neg_lo:[0,1,0] neg_hi:[0,1,0]
v_pk_fma_f32 v[68:69],v[156:157],v[180:181],v[68:69] op_sel_hi:[1,0,1] neg_lo:[0,1,0] neg_hi:[0,1,0]
v_pk_fma_f32 v[70:71],v[158:159],v[180:181],v[70:71] op_sel_hi:[1,0,1] neg_lo:[0,1,0] neg_hi:[0,1,0]
v_pk_mul_f32 v[56:57],v[56:57],v[180:181] op_sel:[0,1] op_sel_hi:[1,1]
v_pk_mul_f32 v[58:59],v[58:59],v[180:181] op_sel:[0,1] op_sel_hi:[1,1]
v_pk_mul_f32 v[60:61],v[60:61],v[180:181] op_sel:[0,1] op_sel_hi:[1,1]
v_pk_mul_f32 v[62:63],v[62:63],v[180:181] op_sel:[0,1] op_sel_hi:[1,1]
v_pk_mul_f32 v[64:65],v[64:65],v[180:181] op_sel:[0,1] op_sel_hi:[1,1]
v_pk_mul_f32 v[66:67],v[66:67],v[180:181] op_sel:[0,1] op_sel_hi:[1,1]
v_pk_mul_f32 v[68:69],v[68:69],v[180:181] op_sel:[0,1] op_sel_hi:[1,1]
v_pk_mul_f32 v[70:71],v[70:71],v[180:181] op_sel:[0,1] op_sel_hi:[1,1]
v_cvt_pk_bf16_f32 v140,v56,v57
v_lshlrev_b32 v56,16,v140
v_and_b32 v57,0xffff0000,v140
v_cvt_pk_bf16_f32 v140,v58,v59
v_lshlrev_b32 v58,16,v140
v_and_b32 v59,0xffff0000,v140
v_cvt_pk_bf16_f32 v140,v60,v61
v_lshlrev_b32 v60,16,v140
v_and_b32 v61,0xffff0000,v140
v_cvt_pk_bf16_f32 v140,v62,v63
v_lshlrev_b32 v62,16,v140
v_and_b32 v63,0xffff0000,v140
v_cvt_pk_bf16_f32 v140,v64,v65
v_lshlrev_b32 v64,16,v140
v_and_b32 v65,0xffff0000,v140
v_cvt_pk_bf16_f32 v140,v66,v67
v_lshlrev_b32 v66,16,v140
v_and_b32 v67,0xffff0000,v140
v_cvt_pk_bf16_f32 v140,v68,v69
v_lshlrev_b32 v68,16,v140
v_and_b32 v69,0xffff0000,v140
v_cvt_pk_bf16_f32 v140,v70,v71
v_lshlrev_b32 v70,16,v140
v_and_b32 v71,0xffff0000,v140
v_pk_mul_f32 v[124:125],v[56:57],v[56:57]
v_pk_mul_f32 v[126:127],v[58:59],v[58:59]
v_pk_mul_f32 v[128:129],v[60:61],v[60:61]
v_pk_mul_f32 v[130:131],v[62:63],v[62:63]
v_pk_mul_f32 v[132:133],v[64:65],v[64:65]
v_pk_mul_f32 v[134:135],v[66:67],v[66:67]
v_pk_mul_f32 v[136:137],v[68:69],v[68:69]
v_pk_mul_f32 v[138:139],v[70:71],v[70:71]
v_pk_fma_f32 v[124:125],v[124:125],v[112:113],v[112:113] op_sel:[0,1,0] op_sel_hi:[1,1,0]
v_pk_fma_f32 v[126:127],v[126:127],v[112:113],v[112:113] op_sel:[0,1,0] op_sel_hi:[1,1,0]
v_pk_fma_f32 v[128:129],v[128:129],v[112:113],v[112:113] op_sel:[0,1,0] op_sel_hi:[1,1,0]
v_pk_fma_f32 v[130:131],v[130:131],v[112:113],v[112:113] op_sel:[0,1,0] op_sel_hi:[1,1,0]
v_pk_fma_f32 v[132:133],v[132:133],v[112:113],v[112:113] op_sel:[0,1,0] op_sel_hi:[1,1,0]
v_pk_fma_f32 v[134:135],v[134:135],v[112:113],v[112:113] op_sel:[0,1,0] op_sel_hi:[1,1,0]
v_pk_fma_f32 v[136:137],v[136:137],v[112:113],v[112:113] op_sel:[0,1,0] op_sel_hi:[1,1,0]
v_pk_fma_f32 v[138:139],v[138:139],v[112:113],v[112:113] op_sel:[0,1,0] op_sel_hi:[1,1,0]
v_pk_mul_f32 v[124:125],v[124:125],v[56:57]
v_pk_mul_f32 v[126:127],v[126:127],v[58:59]
v_pk_mul_f32 v[128:129],v[128:129],v[60:61]
v_pk_mul_f32 v[130:131],v[130:131],v[62:63]
v_pk_mul_f32 v[132:133],v[132:133],v[64:65]
v_pk_mul_f32 v[134:135],v[134:135],v[66:67]
v_pk_mul_f32 v[136:137],v[136:137],v[68:69]
v_pk_mul_f32 v[138:139],v[138:139],v[70:71]
v_exp_f32 v124,v124
v_exp_f32 v125,v125
v_exp_f32 v126,v126
v_exp_f32 v127,v127
v_exp_f32 v128,v128
v_exp_f32 v129,v129
v_exp_f32 v130,v130
v_exp_f32 v131,v131
v_exp_f32 v132,v132
v_exp_f32 v133,v133
v_exp_f32 v134,v134
v_exp_f32 v135,v135
v_exp_f32 v136,v136
v_exp_f32 v137,v137
v_exp_f32 v138,v138
v_exp_f32 v139,v139
v_pk_add_f32 v[124:125],v[124:125],1.0 op_sel_hi:[1,0]
v_pk_add_f32 v[126:127],v[126:127],1.0 op_sel_hi:[1,0]
v_pk_add_f32 v[128:129],v[128:129],1.0 op_sel_hi:[1,0]
v_pk_add_f32 v[130:131],v[130:131],1.0 op_sel_hi:[1,0]
v_pk_add_f32 v[132:133],v[132:133],1.0 op_sel_hi:[1,0]
v_pk_add_f32 v[134:135],v[134:135],1.0 op_sel_hi:[1,0]
v_pk_add_f32 v[136:137],v[136:137],1.0 op_sel_hi:[1,0]
v_pk_add_f32 v[138:139],v[138:139],1.0 op_sel_hi:[1,0]
v_rcp_f32 v124,v124
v_rcp_f32 v125,v125
v_rcp_f32 v126,v126
v_rcp_f32 v127,v127
v_rcp_f32 v128,v128
v_rcp_f32 v129,v129
v_rcp_f32 v130,v130
v_rcp_f32 v131,v131
v_rcp_f32 v132,v132
v_rcp_f32 v133,v133
v_rcp_f32 v134,v134
v_rcp_f32 v135,v135
v_rcp_f32 v136,v136
v_rcp_f32 v137,v137
v_rcp_f32 v138,v138
v_rcp_f32 v139,v139
v_pk_mul_f32 v[56:57],v[56:57],v[124:125]
v_pk_mul_f32 v[58:59],v[58:59],v[126:127]
v_pk_mul_f32 v[60:61],v[60:61],v[128:129]
v_pk_mul_f32 v[62:63],v[62:63],v[130:131]
v_pk_mul_f32 v[64:65],v[64:65],v[132:133]
v_pk_mul_f32 v[66:67],v[66:67],v[134:135]
v_pk_mul_f32 v[68:69],v[68:69],v[136:137]
v_pk_mul_f32 v[70:71],v[70:71],v[138:139]
v_cvt_pk_bf16_f32 v116,v56,v57
v_cvt_pk_bf16_f32 v117,v58,v59
v_cvt_pk_bf16_f32 v118,v60,v61
v_cvt_pk_bf16_f32 v119,v62,v63
v_cvt_pk_bf16_f32 v120,v64,v65
v_cvt_pk_bf16_f32 v121,v66,v67
v_cvt_pk_bf16_f32 v122,v68,v69
v_cvt_pk_bf16_f32 v123,v70,v71
s_cmp_lg_u32 s49,0
s_cbranch_scc0 ls_293
buffer_store_dwordx4 v[116:119],v20,s[8:11],s71 offen sc1
buffer_store_dwordx4 v[120:123],v21,s[8:11],s71 offen sc1
s_branch ls_294
ls_293:
buffer_store_dwordx4 v[116:119],v20,s[8:11],s71 offen
buffer_store_dwordx4 v[120:123],v21,s[8:11],s71 offen
ls_294:
s_mov_b32 s59,s82
s_cmp_eq_u32 s37,0
s_cbranch_scc1 W1_NEXT
s_waitcnt vmcnt(2)
v_cmp_eq_u32 vcc,0,v3
s_and_b64 vcc,vcc,s[76:77]
s_cselect_b32 s37,2147483648,0
s_cmp_lt_u32 s32,128
s_cselect_b32 s37,s37,2147483648
s_cmp_eq_u32 s37,0
s_cbranch_scc1 W1_COLD2
s_waitcnt vmcnt(0)
s_mov_b64 exec,1
s_cmp_lg_u32 s49,0
s_cbranch_scc0 ls_295
buffer_store_dword v5,v1,s[8:11],s59 offen sc1
s_branch ls_296
ls_295:
buffer_store_dword v5,v1,s[8:11],s59 offen
ls_296:
s_mov_b64 exec,-1
s_mov_b32 s59,2147483648
s_cmp_lt_u32 s32,128
s_cbranch_scc1 W1_COLD
s_branch W1_END
sec_292:
s_waitcnt vmcnt(10)
v_cmp_eq_u32 vcc,0,v3
s_and_b64 vcc,vcc,s[76:77]
s_cselect_b32 s37,2147483648,0
s_cmp_lt_u32 s32,128
s_cselect_b32 s37,s37,2147483648
s_cmp_lg_u32 s37,0
s_cbranch_scc1 nr_291
s_add_u32 s65,s32,1
s_or_b32 s65,s65,s37
v_mov_b32 v23,s65
ds_max_i32 v22,v23
s_sub_u32 s66,46080,s57
s_lshl_b32 s60,s33,6
s_add_u32 s60,s60,s34
s_mul_i32 s60,s60,46080
s_add_u32 s60,s60,s37
s_add_u32 s60,s60,223608832
s_mov_b32 s67,s60
s_mul_i32 s61,s46,10240
s_add_u32 s60,s60,s61
s_add_u32 s61,s61,s66
s_add_u32 m0,s61,0
s_add_u32 s63,s60,0
buffer_load_dwordx4 v1,s[8:11],s63 offen sc1 lds
v_pk_fma_f32 v[56:57],v[144:145],v[180:181],v[56:57] op_sel_hi:[1,0,1] neg_lo:[0,1,0] neg_hi:[0,1,0]
v_pk_fma_f32 v[58:59],v[146:147],v[180:181],v[58:59] op_sel_hi:[1,0,1] neg_lo:[0,1,0] neg_hi:[0,1,0]
v_pk_fma_f32 v[60:61],v[148:149],v[180:181],v[60:61] op_sel_hi:[1,0,1] neg_lo:[0,1,0] neg_hi:[0,1,0]
v_pk_fma_f32 v[62:63],v[150:151],v[180:181],v[62:63] op_sel_hi:[1,0,1] neg_lo:[0,1,0] neg_hi:[0,1,0]
v_pk_fma_f32 v[64:65],v[152:153],v[180:181],v[64:65] op_sel_hi:[1,0,1] neg_lo:[0,1,0] neg_hi:[0,1,0]
v_pk_fma_f32 v[66:67],v[154:155],v[180:181],v[66:67] op_sel_hi:[1,0,1] neg_lo:[0,1,0] neg_hi:[0,1,0]
v_pk_fma_f32 v[68:69],v[156:157],v[180:181],v[68:69] op_sel_hi:[1,0,1] neg_lo:[0,1,0] neg_hi:[0,1,0]
v_pk_fma_f32 v[70:71],v[158:159],v[180:181],v[70:71] op_sel_hi:[1,0,1] neg_lo:[0,1,0] neg_hi:[0,1,0]
v_pk_mul_f32 v[56:57],v[56:57],v[180:181] op_sel:[0,1] op_sel_hi:[1,1]
buffer_load_dwordx4 v1,s[8:11],s63 offen offset:1024 sc1 lds
v_pk_mul_f32 v[58:59],v[58:59],v[180:181] op_sel:[0,1] op_sel_hi:[1,1]
v_pk_mul_f32 v[60:61],v[60:61],v[180:181] op_sel:[0,1] op_sel_hi:[1,1]
v_pk_mul_f32 v[62:63],v[62:63],v[180:181] op_sel:[0,1] op_sel_hi:[1,1]
v_pk_mul_f32 v[64:65],v[64:65],v[180:181] op_sel:[0,1] op_sel_hi:[1,1]
v_pk_mul_f32 v[66:67],v[66:67],v[180:181] op_sel:[0,1] op_sel_hi:[1,1]
v_pk_mul_f32 v[68:69],v[68:69],v[180:181] op_sel:[0,1] op_sel_hi:[1,1]
v_pk_mul_f32 v[70:71],v[70:71],v[180:181] op_sel:[0,1] op_sel_hi:[1,1]
v_cvt_pk_bf16_f32 v140,v56,v57
v_lshlrev_b32 v56,16,v140
buffer_load_dwordx4 v1,s[8:11],s63 offen offset:2048 sc1 lds
v_and_b32 v57,0xffff0000,v140
v_cvt_pk_bf16_f32 v140,v58,v59
v_lshlrev_b32 v58,16,v140
v_and_b32 v59,0xffff0000,v140
v_cvt_pk_bf16_f32 v140,v60,v61
v_lshlrev_b32 v60,16,v140
v_and_b32 v61,0xffff0000,v140
v_cvt_pk_bf16_f32 v140,v62,v63
v_lshlrev_b32 v62,16,v140
buffer_load_dwordx4 v1,s[8:11],s63 offen offset:3072 sc1 lds
v_and_b32 v63,0xffff0000,v140
v_cvt_pk_bf16_f32 v140,v64,v65
v_lshlrev_b32 v64,16,v140
v_and_b32 v65,0xffff0000,v140
v_cvt_pk_bf16_f32 v140,v66,v67
v_lshlrev_b32 v66,16,v140
v_and_b32 v67,0xffff0000,v140
v_cvt_pk_bf16_f32 v140,v68,v69
v_lshlrev_b32 v68,16,v140
s_add_u32 m0,s61,4096
s_add_u32 s63,s60,4096
buffer_load_dwordx4 v1,s[8:11],s63 offen sc1 lds
v_and_b32 v69,0xffff0000,v140
v_cvt_pk_bf16_f32 v140,v70,v71
v_lshlrev_b32 v70,16,v140
v_and_b32 v71,0xffff0000,v140
v_pk_mul_f32 v[124:125],v[56:57],v[56:57]
v_pk_mul_f32 v[126:127],v[58:59],v[58:59]
v_pk_mul_f32 v[128:129],v[60:61],v[60:61]
v_pk_mul_f32 v[130:131],v[62:63],v[62:63]
v_pk_mul_f32 v[132:133],v[64:65],v[64:65]
buffer_load_dwordx4 v1,s[8:11],s63 offen offset:1024 sc1 lds
v_pk_mul_f32 v[134:135],v[66:67],v[66:67]
v_pk_mul_f32 v[136:137],v[68:69],v[68:69]
v_pk_mul_f32 v[138:139],v[70:71],v[70:71]
v_pk_fma_f32 v[124:125],v[124:125],v[112:113],v[112:113] op_sel:[0,1,0] op_sel_hi:[1,1,0]
v_pk_fma_f32 v[126:127],v[126:127],v[112:113],v[112:113] op_sel:[0,1,0] op_sel_hi:[1,1,0]
v_pk_fma_f32 v[128:129],v[128:129],v[112:113],v[112:113] op_sel:[0,1,0] op_sel_hi:[1,1,0]
v_pk_fma_f32 v[130:131],v[130:131],v[112:113],v[112:113] op_sel:[0,1,0] op_sel_hi:[1,1,0]
v_pk_fma_f32 v[132:133],v[132:133],v[112:113],v[112:113] op_sel:[0,1,0] op_sel_hi:[1,1,0]
v_pk_fma_f32 v[134:135],v[134:135],v[112:113],v[112:113] op_sel:[0,1,0] op_sel_hi:[1,1,0]
buffer_load_dwordx4 v1,s[8:11],s63 offen offset:2048 sc1 lds
v_pk_fma_f32 v[136:137],v[136:137],v[112:113],v[112:113] op_sel:[0,1,0] op_sel_hi:[1,1,0]
v_pk_fma_f32 v[138:139],v[138:139],v[112:113],v[112:113] op_sel:[0,1,0] op_sel_hi:[1,1,0]
v_pk_mul_f32 v[124:125],v[124:125],v[56:57]
v_pk_mul_f32 v[126:127],v[126:127],v[58:59]
v_pk_mul_f32 v[128:129],v[128:129],v[60:61]
v_pk_mul_f32 v[130:131],v[130:131],v[62:63]
v_pk_mul_f32 v[132:133],v[132:133],v[64:65]
v_pk_mul_f32 v[134:135],v[134:135],v[66:67]
v_pk_mul_f32 v[136:137],v[136:137],v[68:69]
buffer_load_dwordx4 v1,s[8:11],s63 offen offset:3072 sc1 lds
v_pk_mul_f32 v[138:139],v[138:139],v[70:71]
v_exp_f32 v124,v124
v_exp_f32 v125,v125
v_exp_f32 v126,v126
v_exp_f32 v127,v127
v_exp_f32 v128,v128
v_exp_f32 v129,v129
v_exp_f32 v130,v130
v_exp_f32 v131,v131
s_add_u32 m0,s61,8192
s_add_u32 s63,s60,8192
buffer_load_dwordx4 v1,s[8:11],s63 offen sc1 lds
v_exp_f32 v132,v132
v_exp_f32 v133,v133
v_exp_f32 v134,v134
v_exp_f32 v135,v135
v_exp_f32 v136,v136
v_exp_f32 v137,v137
v_exp_f32 v138,v138
v_exp_f32 v139,v139
v_pk_add_f32 v[124:125],v[124:125],1.0 op_sel_hi:[1,0]
buffer_load_dwordx4 v1,s[8:11],s63 offen offset:1024 sc1 lds
v_pk_add_f32 v[126:127],v[126:127],1.0 op_sel_hi:[1,0]
v_pk_add_f32 v[128:129],v[128:129],1.0 op_sel_hi:[1,0]
v_pk_add_f32 v[130:131],v[130:131],1.0 op_sel_hi:[1,0]
v_pk_add_f32 v[132:133],v[132:133],1.0 op_sel_hi:[1,0]
v_pk_add_f32 v[134:135],v[134:135],1.0 op_sel_hi:[1,0]
v_pk_add_f32 v[136:137],v[136:137],1.0 op_sel_hi:[1,0]
v_pk_add_f32 v[138:139],v[138:139],1.0 op_sel_hi:[1,0]
v_rcp_f32 v124,v124
v_rcp_f32 v125,v125
s_add_u32 m0,s66,40960
s_add_u32 s63,s67,40960
buffer_load_dwordx4 v1,s[8:11],s63 offen sc1 lds
v_rcp_f32 v126,v126
v_rcp_f32 v127,v127
v_rcp_f32 v128,v128
v_rcp_f32 v129,v129
v_rcp_f32 v130,v130
v_rcp_f32 v131,v131
v_rcp_f32 v132,v132
v_rcp_f32 v133,v133
v_rcp_f32 v134,v134
s_mov_b32 s35,s42
buffer_load_dword v3,v2,s[8:11],s35 offen sc1
s_mov_b32 s53,s33
s_mov_b32 s54,s34
s_add_u32 s32,s32,1
s_mov_b32 s33,s40
s_mov_b32 s34,s41
s_mov_b64 s[76:77],s[80:81]
v_rcp_f32 v135,v135
v_rcp_f32 v136,v136
v_rcp_f32 v137,v137
v_rcp_f32 v138,v138
v_rcp_f32 v139,v139
v_pk_mul_f32 v[56:57],v[56:57],v[124:125]
v_pk_mul_f32 v[58:59],v[58:59],v[126:127]
v_pk_mul_f32 v[60:61],v[60:61],v[128:129]
v_pk_mul_f32 v[62:63],v[62:63],v[130:131]
v_pk_mul_f32 v[64:65],v[64:65],v[132:133]
v_pk_mul_f32 v[66:67],v[66:67],v[134:135]
v_pk_mul_f32 v[68:69],v[68:69],v[136:137]
v_pk_mul_f32 v[70:71],v[70:71],v[138:139]
v_cvt_pk_bf16_f32 v116,v56,v57
v_cvt_pk_bf16_f32 v117,v58,v59
v_cvt_pk_bf16_f32 v118,v60,v61
v_cvt_pk_bf16_f32 v119,v62,v63
v_cvt_pk_bf16_f32 v120,v64,v65
v_cvt_pk_bf16_f32 v121,v66,v67
v_cvt_pk_bf16_f32 v122,v68,v69
v_cvt_pk_bf16_f32 v123,v70,v71
s_cmp_lg_u32 s49,0
s_cbranch_scc0 ls_297
buffer_store_dwordx4 v[116:119],v20,s[8:11],s71 offen sc1
buffer_store_dwordx4 v[120:123],v21,s[8:11],s71 offen sc1
s_branch ls_298
ls_297:
buffer_store_dwordx4 v[116:119],v20,s[8:11],s71 offen
buffer_store_dwordx4 v[120:123],v21,s[8:11],s71 offen
ls_298:
s_mov_b32 s59,s82
s_branch W1_NEXT
nr_291:
buffer_load_dword v3,v2,s[8:11],s35 offen sc1
s_branch ep_290
W1_END:
s_endpgm
ROLE_W2:
v_lshlrev_b32 v1,4,v0
v_mov_b32 v5,1
s_lshl_b32 s56,s48,2
s_add_u32 s56,s56,s46
v_bfe_u32 v6,v0,2,2
v_lshrrev_b32 v7,4,v0
v_add_u32 v7,v6,v7
v_and_b32 v7,3,v7
v_and_b32 v15,3,v0
v_lshlrev_b32 v15,4,v15
v_lshl_add_u32 v15,v7,6,v15
v_lshl_add_u32 v15,v6,8,v15
v_lshrrev_b32 v6,5,v0
v_bfe_u32 v7,v0,4,1
v_lshlrev_b32 v16,10,v7
v_lshl_add_u32 v16,v6,8,v16
v_and_b32 v6,15,v0
v_lshl_add_u32 v16,v6,4,v16
v_add_u32 v18,40960,v16
v_lshrrev_b32 v6,5,v0
v_bfe_u32 v7,v0,4,1
v_lshlrev_b32 v20,10,v7
v_lshl_add_u32 v20,v6,8,v20
v_and_b32 v6,15,v0
v_lshl_add_u32 v20,v6,4,v20
v_lshrrev_b32 v6,5,v0
v_add_u32 v6,2,v6
v_bfe_u32 v7,v0,4,1
v_lshlrev_b32 v17,10,v7
v_lshl_add_u32 v17,v6,8,v17
v_and_b32 v6,15,v0
v_lshl_add_u32 v17,v6,4,v17
v_add_u32 v19,40960,v17
v_lshrrev_b32 v6,5,v0
v_add_u32 v6,2,v6
v_bfe_u32 v7,v0,4,1
v_lshlrev_b32 v21,10,v7
v_lshl_add_u32 v21,v6,8,v21
v_and_b32 v6,15,v0
v_lshl_add_u32 v21,v6,4,v21
v_min_u32 v2,19,v0
v_lshlrev_b32 v2,2,v2
s_lshr_b32 s60,s46,1
s_add_u32 s60,s60,1
s_sub_u32 s61,32,s60
s_add_u32 s60,s60,32
s_bitcmp1_b32 s46,0
s_cselect_b32 s60,s60,s61
v_and_b32 v6,15,v0
v_add_u32 v6,s60,v6
v_lshrrev_b32 v7,5,v6
v_mul_u32_u24 v112,40960,v7
v_bfe_u32 v7,v6,4,1
v_lshl_add_u32 v112,v7,10,v112
v_and_b32 v7,15,v6
v_lshl_add_u32 v112,v7,4,v112
v_lshrrev_b32 v7,4,v0
v_lshl_add_u32 v112,v7,8,v112
v_and_b32 v6,15,v0
v_add_u32 v6,s60,v6
v_add_u32 v6,16,v6
v_lshrrev_b32 v7,5,v6
v_mul_u32_u24 v113,40960,v7
v_bfe_u32 v7,v6,4,1
v_lshl_add_u32 v113,v7,10,v113
v_and_b32 v7,15,v6
v_lshl_add_u32 v113,v7,4,v113
v_lshrrev_b32 v7,4,v0
v_lshl_add_u32 v113,v7,8,v113
v_lshrrev_b32 v6,5,v0
v_and_b32 v7,15,v0
v_lshlrev_b32 v114,3,v7
v_lshl_add_u32 v114,v6,7,v114
v_and_b32 v114,31,v0
v_lshlrev_b32 v114,3,v114
v_lshrrev_b32 v6,5,v0
v_bfe_u32 v7,v0,4,1
v_lshlrev_b32 v116,10,v7
v_bfe_u32 v7,v0,2,2
v_lshl_add_u32 v116,v7,8,v116
v_add_u32 v6,v6,v7
v_and_b32 v6,3,v6
v_lshl_add_u32 v116,v6,6,v116
v_and_b32 v6,3,v0
v_lshl_add_u32 v116,v6,4,v116
v_lshrrev_b32 v6,5,v0
v_add_u32 v6,2,v6
v_bfe_u32 v7,v0,4,1
v_lshlrev_b32 v117,10,v7
v_bfe_u32 v7,v0,2,2
v_lshl_add_u32 v117,v7,8,v117
v_add_u32 v6,v6,v7
v_and_b32 v6,3,v6
v_lshl_add_u32 v117,v6,6,v117
v_and_b32 v6,3,v0
v_lshl_add_u32 v117,v6,4,v117
v_subrev_u32 v6,40960,v112
v_cmp_gt_u32 vcc,40960,v6
s_nop 1
v_cndmask_b32 v78,0,1,vcc
v_xor_b32 v76,1,v78
v_and_b32 v74,2047,v112
v_subrev_u32 v6,40960,v113
v_cmp_gt_u32 vcc,40960,v6
s_nop 1
v_cndmask_b32 v79,0,1,vcc
v_xor_b32 v77,1,v79
v_and_b32 v75,2047,v113
s_and_b32 s68,s46,1
s_lshl_b32 s68,s68,1
s_sub_u32 s68,s68,1
s_waitcnt vmcnt(0)
s_barrier
s_cmp_lg_u32 s46,0
s_cbranch_scc1 arr_299
v_mov_b32 v6,1
s_lshl_b32 s3,s49,2
v_mov_b32 v7,s3
s_mov_b64 exec,1
buffer_atomic_add v6,v7,s[12:15],0 offen sc1
s_mov_b64 exec,-1
arr_299:
s_lshl_b32 s58,s56,6
s_mul_i32 s63,s46,40960
s_mov_b32 s4,s34
s_mov_b32 s5,s35
s_mov_b32 s6,819200
s_mov_b32 s7,0x20000
v_lshrrev_b32 v9,2,v0
s_mov_b32 s64,1280
v_mul_lo_u32 v9,v9,s64
v_and_b32 v10,3,v0
v_lshl_add_u32 v6,v10,4,v9
s_add_u32 m0,s63,0
s_add_u32 s65,s58,0
buffer_load_dwordx4 v6,s[4:7],s65 offen lds
s_add_u32 m0,s63,1024
s_add_u32 s65,s58,20480
buffer_load_dwordx4 v6,s[4:7],s65 offen lds
s_add_u32 m0,s63,2048
s_add_u32 s65,s58,40960
buffer_load_dwordx4 v6,s[4:7],s65 offen lds
s_add_u32 m0,s63,3072
s_add_u32 s65,s58,61440
buffer_load_dwordx4 v6,s[4:7],s65 offen lds
s_add_u32 m0,s63,4096
s_add_u32 s65,s58,81920
buffer_load_dwordx4 v6,s[4:7],s65 offen lds
s_add_u32 m0,s63,5120
s_add_u32 s65,s58,102400
buffer_load_dwordx4 v6,s[4:7],s65 offen lds
s_add_u32 m0,s63,6144
s_add_u32 s65,s58,122880
buffer_load_dwordx4 v6,s[4:7],s65 offen lds
s_add_u32 m0,s63,7168
s_add_u32 s65,s58,143360
buffer_load_dwordx4 v6,s[4:7],s65 offen lds
s_add_u32 m0,s63,8192
s_add_u32 s65,s58,163840
buffer_load_dwordx4 v6,s[4:7],s65 offen lds
s_add_u32 m0,s63,9216
s_add_u32 s65,s58,184320
buffer_load_dwordx4 v6,s[4:7],s65 offen lds
s_add_u32 m0,s63,10240
s_add_u32 s65,s58,204800
buffer_load_dwordx4 v6,s[4:7],s65 offen lds
s_add_u32 m0,s63,11264
s_add_u32 s65,s58,225280
buffer_load_dwordx4 v6,s[4:7],s65 offen lds
s_add_u32 m0,s63,12288
s_add_u32 s65,s58,245760
buffer_load_dwordx4 v6,s[4:7],s65 offen lds
s_add_u32 m0,s63,13312
s_add_u32 s65,s58,266240
buffer_load_dwordx4 v6,s[4:7],s65 offen lds
s_add_u32 m0,s63,14336
s_add_u32 s65,s58,286720
buffer_load_dwordx4 v6,s[4:7],s65 offen lds
s_add_u32 m0,s63,15360
s_add_u32 s65,s58,307200
buffer_load_dwordx4 v6,s[4:7],s65 offen lds
s_add_u32 m0,s63,16384
s_add_u32 s65,s58,327680
buffer_load_dwordx4 v6,s[4:7],s65 offen lds
s_add_u32 m0,s63,17408
s_add_u32 s65,s58,348160
buffer_load_dwordx4 v6,s[4:7],s65 offen lds
s_add_u32 m0,s63,18432
s_add_u32 s65,s58,368640
buffer_load_dwordx4 v6,s[4:7],s65 offen lds
s_add_u32 m0,s63,19456
s_add_u32 s65,s58,389120
buffer_load_dwordx4 v6,s[4:7],s65 offen lds
s_add_u32 m0,s63,20480
s_add_u32 s65,s58,409600
buffer_load_dwordx4 v6,s[4:7],s65 offen lds
s_add_u32 m0,s63,21504
s_add_u32 s65,s58,430080
buffer_load_dwordx4 v6,s[4:7],s65 offen lds
s_add_u32 m0,s63,22528
s_add_u32 s65,s58,450560
buffer_load_dwordx4 v6,s[4:7],s65 offen lds
s_add_u32 m0,s63,23552
s_add_u32 s65,s58,471040
buffer_load_dwordx4 v6,s[4:7],s65 offen lds
s_add_u32 m0,s63,24576
s_add_u32 s65,s58,491520
buffer_load_dwordx4 v6,s[4:7],s65 offen lds
s_add_u32 m0,s63,25600
s_add_u32 s65,s58,512000
buffer_load_dwordx4 v6,s[4:7],s65 offen lds
s_add_u32 m0,s63,26624
s_add_u32 s65,s58,532480
buffer_load_dwordx4 v6,s[4:7],s65 offen lds
s_add_u32 m0,s63,27648
s_add_u32 s65,s58,552960
buffer_load_dwordx4 v6,s[4:7],s65 offen lds
s_add_u32 m0,s63,28672
s_add_u32 s65,s58,573440
buffer_load_dwordx4 v6,s[4:7],s65 offen lds
s_add_u32 m0,s63,29696
s_add_u32 s65,s58,593920
buffer_load_dwordx4 v6,s[4:7],s65 offen lds
s_add_u32 m0,s63,30720
s_add_u32 s65,s58,614400
buffer_load_dwordx4 v6,s[4:7],s65 offen lds
s_add_u32 m0,s63,31744
s_add_u32 s65,s58,634880
buffer_load_dwordx4 v6,s[4:7],s65 offen lds
s_add_u32 m0,s63,32768
s_add_u32 s65,s58,655360
buffer_load_dwordx4 v6,s[4:7],s65 offen lds
s_add_u32 m0,s63,33792
s_add_u32 s65,s58,675840
buffer_load_dwordx4 v6,s[4:7],s65 offen lds
s_add_u32 m0,s63,34816
s_add_u32 s65,s58,696320
buffer_load_dwordx4 v6,s[4:7],s65 offen lds
s_add_u32 m0,s63,35840
s_add_u32 s65,s58,716800
buffer_load_dwordx4 v6,s[4:7],s65 offen lds
s_add_u32 m0,s63,36864
s_add_u32 s65,s58,737280
buffer_load_dwordx4 v6,s[4:7],s65 offen lds
s_add_u32 m0,s63,37888
s_add_u32 s65,s58,757760
buffer_load_dwordx4 v6,s[4:7],s65 offen lds
s_add_u32 m0,s63,38912
s_add_u32 s65,s58,778240
buffer_load_dwordx4 v6,s[4:7],s65 offen lds
s_add_u32 m0,s63,39936
s_add_u32 s65,s58,798720
buffer_load_dwordx4 v6,s[4:7],s65 offen lds
s_waitcnt vmcnt(20)
v_bfe_u32 v9,v0,2,2
v_lshrrev_b32 v10,5,v0
v_lshl_add_u32 v9,v10,2,v9
v_mul_u32_u24 v9,64,v9
v_and_b32 v10,1,v0
v_lshl_add_u32 v9,v10,3,v9
v_bfe_u32 v10,v0,1,1
v_lshl_add_u32 v9,v10,5,v9
v_bfe_u32 v10,v0,4,1
v_lshl_add_u32 v9,v10,4,v9
v_add_u32 v7,s63,v9
ds_read_b64_tr_b16 a[0:1],v7 offset:0
ds_read_b64_tr_b16 a[2:3],v7 offset:1024
ds_read_b64_tr_b16 a[4:5],v7 offset:512
ds_read_b64_tr_b16 a[6:7],v7 offset:1536
ds_read_b64_tr_b16 a[8:9],v7 offset:2048
ds_read_b64_tr_b16 a[10:11],v7 offset:3072
ds_read_b64_tr_b16 a[12:13],v7 offset:2560
ds_read_b64_tr_b16 a[14:15],v7 offset:3584
ds_read_b64_tr_b16 a[16:17],v7 offset:4096
ds_read_b64_tr_b16 a[18:19],v7 offset:5120
ds_read_b64_tr_b16 a[20:21],v7 offset:4608
ds_read_b64_tr_b16 a[22:23],v7 offset:5632
s_waitcnt lgkmcnt(4)
ds_read_b64_tr_b16 a[24:25],v7 offset:6144
ds_read_b64_tr_b16 a[26:27],v7 offset:7168
ds_read_b64_tr_b16 a[28:29],v7 offset:6656
ds_read_b64_tr_b16 a[30:31],v7 offset:7680
ds_read_b64_tr_b16 a[32:33],v7 offset:8192
ds_read_b64_tr_b16 a[34:35],v7 offset:9216
ds_read_b64_tr_b16 a[36:37],v7 offset:8704
ds_read_b64_tr_b16 a[38:39],v7 offset:9728
ds_read_b64_tr_b16 a[40:41],v7 offset:10240
ds_read_b64_tr_b16 a[42:43],v7 offset:11264
ds_read_b64_tr_b16 a[44:45],v7 offset:10752
ds_read_b64_tr_b16 a[46:47],v7 offset:11776
s_waitcnt lgkmcnt(4)
ds_read_b64_tr_b16 a[48:49],v7 offset:12288
ds_read_b64_tr_b16 a[50:51],v7 offset:13312
ds_read_b64_tr_b16 a[52:53],v7 offset:12800
ds_read_b64_tr_b16 a[54:55],v7 offset:13824
ds_read_b64_tr_b16 a[56:57],v7 offset:14336
ds_read_b64_tr_b16 a[58:59],v7 offset:15360
ds_read_b64_tr_b16 a[60:61],v7 offset:14848
ds_read_b64_tr_b16 a[62:63],v7 offset:15872
ds_read_b64_tr_b16 a[64:65],v7 offset:16384
ds_read_b64_tr_b16 a[66:67],v7 offset:17408
ds_read_b64_tr_b16 a[68:69],v7 offset:16896
ds_read_b64_tr_b16 a[70:71],v7 offset:17920
s_waitcnt lgkmcnt(4)
ds_read_b64_tr_b16 a[72:73],v7 offset:18432
ds_read_b64_tr_b16 a[74:75],v7 offset:19456
ds_read_b64_tr_b16 a[76:77],v7 offset:18944
ds_read_b64_tr_b16 a[78:79],v7 offset:19968
s_waitcnt lgkmcnt(0)
s_waitcnt vmcnt(0)
v_bfe_u32 v9,v0,2,2
v_lshrrev_b32 v10,5,v0
v_lshl_add_u32 v9,v10,2,v9
v_mul_u32_u24 v9,64,v9
v_and_b32 v10,1,v0
v_lshl_add_u32 v9,v10,3,v9
v_bfe_u32 v10,v0,1,1
v_lshl_add_u32 v9,v10,5,v9
v_bfe_u32 v10,v0,4,1
v_lshl_add_u32 v9,v10,4,v9
v_add_u32 v7,s63,v9
ds_read_b64_tr_b16 a[80:81],v7 offset:20480
ds_read_b64_tr_b16 a[82:83],v7 offset:21504
ds_read_b64_tr_b16 a[84:85],v7 offset:20992
ds_read_b64_tr_b16 a[86:87],v7 offset:22016
ds_read_b64_tr_b16 a[88:89],v7 offset:22528
ds_read_b64_tr_b16 a[90:91],v7 offset:23552
ds_read_b64_tr_b16 a[92:93],v7 offset:23040
ds_read_b64_tr_b16 a[94:95],v7 offset:24064
ds_read_b64_tr_b16 a[96:97],v7 offset:24576
ds_read_b64_tr_b16 a[98:99],v7 offset:25600
ds_read_b64_tr_b16 a[100:101],v7 offset:25088
ds_read_b64_tr_b16 a[102:103],v7 offset:26112
s_waitcnt lgkmcnt(4)
ds_read_b64_tr_b16 a[104:105],v7 offset:26624
ds_read_b64_tr_b16 a[106:107],v7 offset:27648
ds_read_b64_tr_b16 a[108:109],v7 offset:27136
ds_read_b64_tr_b16 a[110:111],v7 offset:28160
ds_read_b64_tr_b16 a[112:113],v7 offset:28672
ds_read_b64_tr_b16 a[114:115],v7 offset:29696
ds_read_b64_tr_b16 a[116:117],v7 offset:29184
ds_read_b64_tr_b16 a[118:119],v7 offset:30208
ds_read_b64_tr_b16 a[120:121],v7 offset:30720
ds_read_b64_tr_b16 a[122:123],v7 offset:31744
ds_read_b64_tr_b16 a[124:125],v7 offset:31232
ds_read_b64_tr_b16 a[126:127],v7 offset:32256
s_waitcnt lgkmcnt(4)
ds_read_b64_tr_b16 a[128:129],v7 offset:32768
ds_read_b64_tr_b16 a[130:131],v7 offset:33792
ds_read_b64_tr_b16 a[132:133],v7 offset:33280
ds_read_b64_tr_b16 a[134:135],v7 offset:34304
ds_read_b64_tr_b16 a[136:137],v7 offset:34816
ds_read_b64_tr_b16 a[138:139],v7 offset:35840
ds_read_b64_tr_b16 a[140:141],v7 offset:35328
ds_read_b64_tr_b16 a[142:143],v7 offset:36352
ds_read_b64_tr_b16 a[144:145],v7 offset:36864
ds_read_b64_tr_b16 a[146:147],v7 offset:37888
ds_read_b64_tr_b16 a[148:149],v7 offset:37376
ds_read_b64_tr_b16 a[150:151],v7 offset:38400
s_waitcnt lgkmcnt(4)
ds_read_b64_tr_b16 a[152:153],v7 offset:38912
ds_read_b64_tr_b16 a[154:155],v7 offset:39936
ds_read_b64_tr_b16 a[156:157],v7 offset:39424
ds_read_b64_tr_b16 a[158:159],v7 offset:40448
s_waitcnt lgkmcnt(0)
s_barrier
s_lshl_b32 s3,s49,2
v_mov_b32 v7,s3
s_nop 1
ibw_300:
buffer_load_dword v6,v7,s[12:15],0 offen sc1
s_waitcnt vmcnt(0)
v_cmp_ne_u32 vcc,256,v6
s_nop 0
s_cbranch_vccz ok_301
s_sleep 8
s_sub_u32 s47,s47,1
s_cbranch_scc1 ABORT
s_branch ibw_300
ok_301:
s_cmp_lg_u32 s49,0
s_cbranch_scc1 ibok_302
v_and_b32 v7,7,v0
v_lshlrev_b32 v7,2,v7
buffer_load_dword v6,v7,s[12:15],0 offen offset:32 sc1
s_waitcnt vmcnt(0)
v_cmp_ne_u32 vcc,32,v6
s_nop 0
s_cbranch_vccz ibok_302
s_barrier
s_mov_b32 s49,1
s_mov_b32 s3,s2
s_load_dwordx16 s[16:31],s[0:1],0
s_load_dwordx8 s[32:39],s[0:1],64
s_waitcnt lgkmcnt(0)
s_branch DISPATCH
ibok_302:
s_mov_b32 s50,0
s_mov_b32 s32,0
s_mov_b32 s57,0
s_mov_b32 s59,2147483648
s_mov_b32 s82,2147483648
s_mov_b32 s39,2147483648
v_mov_b32 v22,83968
v_lshl_add_u32 v22,v0,2,v22
v_mov_b32 v23,0
ds_write_b32 v22,v23
s_mov_b32 s39,1600000
v_and_b32 v72,15,v0
v_lshlrev_b32 v72,7,v72
s_mul_i32 s60,s56,-1792
s_add_u32 s60,s60,40960
v_and_b32 v6,128,v72
v_add_u32 v6,s60,v6
v_cmp_lt_u32 vcc,15,v0
s_nop 1
v_cndmask_b32 v72,v72,v6,vcc
v_min_u32 v6,59,v0
v_lshlrev_b32 v6,2,v6
v_add_u32 v2,135168,v6
v_add_u32 v7,-80,v6
v_cmp_gt_u32 s[78:79],20,v0
s_nop 1
v_cndmask_b32 v2,v7,v2,s[78:79]
s_mov_b32 s51,0
s_mov_b32 s52,0
s_mul_i32 s62,s51,8
s_and_b32 s63,s52,7
s_add_u32 s62,s62,s63
s_mul_i32 s62,s62,46080
s_add_u32 s62,s62,212467712
s_lshl_b32 s63,s56,11
s_add_u32 s62,s62,s63
buffer_load_dword v73,v72,s[8:11],s62 offen sc1
s_mov_b32 s51,0
s_mov_b32 s52,1
s_mul_i32 s62,s51,8
s_and_b32 s63,s52,7
s_add_u32 s62,s62,s63
s_mul_i32 s62,s62,46080
s_add_u32 s62,s62,212467712
s_lshl_b32 s63,s56,11
s_add_u32 s62,s62,s63
buffer_load_dword v73,v72,s[8:11],s62 offen sc1
s_mov_b32 s51,0
s_mov_b32 s52,2
s_mul_i32 s62,s51,8
s_and_b32 s63,s52,7
s_add_u32 s62,s62,s63
s_mul_i32 s62,s62,46080
s_add_u32 s62,s62,212467712
s_lshl_b32 s63,s56,11
s_add_u32 s62,s62,s63
buffer_load_dword v73,v72,s[8:11],s62 offen sc1
s_mov_b32 s51,0
s_mov_b32 s52,3
s_mul_i32 s62,s51,8
s_and_b32 s63,s52,7
s_add_u32 s62,s62,s63
s_mul_i32 s62,s62,46080
s_add_u32 s62,s62,212467712
s_lshl_b32 s63,s56,11
s_add_u32 s62,s62,s63
buffer_load_dword v73,v72,s[8:11],s62 offen sc1
s_mov_b32 s51,0
s_mov_b32 s52,4
s_mul_i32 s62,s51,8
s_and_b32 s63,s52,7
s_add_u32 s62,s62,s63
s_mul_i32 s62,s62,46080
s_add_u32 s62,s62,212467712
s_lshl_b32 s63,s56,11
s_add_u32 s62,s62,s63
buffer_load_dword v73,v72,s[8:11],s62 offen sc1
s_mov_b32 s51,0
s_mov_b32 s52,5
s_mul_i32 s62,s51,8
s_and_b32 s63,s52,7
s_add_u32 s62,s62,s63
s_mul_i32 s62,s62,46080
s_add_u32 s62,s62,212467712
s_lshl_b32 s63,s56,11
s_add_u32 s62,s62,s63
buffer_load_dword v73,v72,s[8:11],s62 offen sc1
s_mov_b32 s51,0
s_mov_b32 s52,6
s_mul_i32 s62,s51,8
s_and_b32 s63,s52,7
s_add_u32 s62,s62,s63
s_mul_i32 s62,s62,46080
s_add_u32 s62,s62,212467712
s_lshl_b32 s63,s56,11
s_add_u32 s62,s62,s63
buffer_load_dword v73,v72,s[8:11],s62 offen sc1
s_mov_b32 s51,0
s_mov_b32 s52,7
s_mul_i32 s62,s51,8
s_and_b32 s63,s52,7
s_add_u32 s62,s62,s63
s_mul_i32 s62,s62,46080
s_add_u32 s62,s62,212467712
s_lshl_b32 s63,s56,11
s_add_u32 s62,s62,s63
buffer_load_dword v73,v72,s[8:11],s62 offen sc1
s_mov_b32 s51,1
s_mov_b32 s52,0
s_mul_i32 s62,s51,8
s_and_b32 s63,s52,7
s_add_u32 s62,s62,s63
s_mul_i32 s62,s62,46080
s_add_u32 s62,s62,212467712
s_lshl_b32 s63,s56,11
s_add_u32 s62,s62,s63
buffer_load_dword v73,v72,s[8:11],s62 offen sc1
s_mov_b32 s51,1
s_mov_b32 s52,1
s_mul_i32 s62,s51,8
s_and_b32 s63,s52,7
s_add_u32 s62,s62,s63
s_mul_i32 s62,s62,46080
s_add_u32 s62,s62,212467712
s_lshl_b32 s63,s56,11
s_add_u32 s62,s62,s63
buffer_load_dword v73,v72,s[8:11],s62 offen sc1
s_mov_b32 s51,1
s_mov_b32 s52,2
s_mul_i32 s62,s51,8
s_and_b32 s63,s52,7
s_add_u32 s62,s62,s63
s_mul_i32 s62,s62,46080
s_add_u32 s62,s62,212467712
s_lshl_b32 s63,s56,11
s_add_u32 s62,s62,s63
buffer_load_dword v73,v72,s[8:11],s62 offen sc1
s_mov_b32 s51,1
s_mov_b32 s52,3
s_mul_i32 s62,s51,8
s_and_b32 s63,s52,7
s_add_u32 s62,s62,s63
s_mul_i32 s62,s62,46080
s_add_u32 s62,s62,212467712
s_lshl_b32 s63,s56,11
s_add_u32 s62,s62,s63
buffer_load_dword v73,v72,s[8:11],s62 offen sc1
s_mov_b32 s51,1
s_mov_b32 s52,4
s_mul_i32 s62,s51,8
s_and_b32 s63,s52,7
s_add_u32 s62,s62,s63
s_mul_i32 s62,s62,46080
s_add_u32 s62,s62,212467712
s_lshl_b32 s63,s56,11
s_add_u32 s62,s62,s63
buffer_load_dword v73,v72,s[8:11],s62 offen sc1
s_mov_b32 s51,1
s_mov_b32 s52,5
s_mul_i32 s62,s51,8
s_and_b32 s63,s52,7
s_add_u32 s62,s62,s63
s_mul_i32 s62,s62,46080
s_add_u32 s62,s62,212467712
s_lshl_b32 s63,s56,11
s_add_u32 s62,s62,s63
buffer_load_dword v73,v72,s[8:11],s62 offen sc1
s_mov_b32 s51,1
s_mov_b32 s52,6
s_mul_i32 s62,s51,8
s_and_b32 s63,s52,7
s_add_u32 s62,s62,s63
s_mul_i32 s62,s62,46080
s_add_u32 s62,s62,212467712
s_lshl_b32 s63,s56,11
s_add_u32 s62,s62,s63
buffer_load_dword v73,v72,s[8:11],s62 offen sc1
s_mov_b32 s51,1
s_mov_b32 s52,7
s_mul_i32 s62,s51,8
s_and_b32 s63,s52,7
s_add_u32 s62,s62,s63
s_mul_i32 s62,s62,46080
s_add_u32 s62,s62,212467712
s_lshl_b32 s63,s56,11
s_add_u32 s62,s62,s63
buffer_load_dword v73,v72,s[8:11],s62 offen sc1
s_waitcnt vmcnt(0)
s_waitcnt lgkmcnt(0)
s_barrier
s_mov_b32 s83,s100
s_min_u32 s62,s32,127
s_sub_u32 s60,s62,13
s_lshr_b32 s34,s60,1
s_and_b32 s33,s60,1
s_cmp_eq_u32 s33,0
s_cselect_b32 s61,13,0
s_add_u32 s34,s34,s61
s_sub_u32 s61,s60,51
s_cmp_ge_u32 s60,102
s_cselect_b32 s34,s61,s34
s_cselect_b32 s33,1,s33
s_cmp_lt_u32 s62,13
s_cselect_b32 s34,s62,s34
s_cselect_b32 s33,0,s33
s_add_u32 s60,s34,1
s_min_u32 s60,s60,63
s_lshl_b32 s35,s33,6
s_add_u32 s35,s35,s60
s_lshl_b32 s35,s35,9
s_add_u32 s35,s35,323584
s_cmp_lt_u32 s60,8
s_cselect_b64 s[76:77],s[78:79],-1
s_sub_u32 s57,40960,s57
v_swap_b32 v16,v18
v_swap_b32 v17,v19
s_add_u32 s62,s32,1
s_min_u32 s62,s62,127
s_sub_u32 s60,s62,13
s_lshr_b32 s41,s60,1
s_and_b32 s40,s60,1
s_cmp_eq_u32 s40,0
s_cselect_b32 s61,13,0
s_add_u32 s41,s41,s61
s_sub_u32 s61,s60,51
s_cmp_ge_u32 s60,102
s_cselect_b32 s41,s61,s41
s_cselect_b32 s40,1,s40
s_cmp_lt_u32 s62,13
s_cselect_b32 s41,s62,s41
s_cselect_b32 s40,0,s40
s_add_u32 s60,s41,1
s_min_u32 s60,s60,63
s_lshl_b32 s42,s40,6
s_add_u32 s42,s42,s60
s_lshl_b32 s42,s42,9
s_add_u32 s42,s42,323584
s_cmp_lt_u32 s60,8
s_cselect_b64 s[80:81],s[78:79],-1
W2_COLD:
s_mov_b32 s37,0
fb_303:
buffer_load_dword v3,v2,s[8:11],s35 offen sc1
s_waitcnt vmcnt(0)
v_cmp_eq_u32 vcc,0,v3
s_and_b64 vcc,vcc,s[76:77]
s_cbranch_scc0 ok_304
s_sleep 1
s_sub_u32 s47,s47,1
s_cbranch_scc1 ABORT
s_branch fb_303
ok_304:
W2_COLD2:
s_sub_u32 s66,40960,s57
s_add_u32 s61,s34,s68
s_and_b32 s62,s61,7
s_cmp_lt_u32 s61,64
s_cselect_b32 s62,s62,8
s_mul_i32 s62,s62,40960
s_and_b32 s61,s34,7
s_mul_i32 s61,s61,40960
v_mad_u32_u24 v112,v76,s62,v74
v_mad_u32_u24 v112,v78,s61,v112
v_mad_u32_u24 v113,v77,s62,v75
v_mad_u32_u24 v113,v79,s61,v113
s_mov_b32 s60,s33
s_mul_i32 s60,s60,368640
s_add_u32 s60,s60,s37
s_mul_i32 s61,s46,10240
s_add_u32 s60,s60,s61
s_add_u32 s60,s60,237371392
s_add_u32 s61,s61,s66
s_add_u32 m0,s61,0
s_add_u32 s63,s60,0
buffer_load_dwordx4 v112,s[8:11],s63 offen sc1 lds
s_add_u32 m0,s61,1024
s_nop 0
buffer_load_dwordx4 v113,s[8:11],s63 offen sc1 lds
s_add_u32 m0,s61,2048
s_add_u32 s63,s60,2048
buffer_load_dwordx4 v112,s[8:11],s63 offen sc1 lds
s_add_u32 m0,s61,3072
s_nop 0
buffer_load_dwordx4 v113,s[8:11],s63 offen sc1 lds
s_add_u32 m0,s61,4096
s_add_u32 s63,s60,4096
buffer_load_dwordx4 v112,s[8:11],s63 offen sc1 lds
s_add_u32 m0,s61,5120
s_nop 0
buffer_load_dwordx4 v113,s[8:11],s63 offen sc1 lds
s_waitcnt vmcnt(5)
s_mov_b64 exec,1
s_cmp_lg_u32 s49,0
s_cbranch_scc0 ls_305
buffer_store_dword v5,v1,s[8:11],s59 offen sc1
s_branch ls_306
ls_305:
buffer_store_dword v5,v1,s[8:11],s59 offen
ls_306:
s_mov_b64 exec,-1
s_mov_b32 s59,2147483648
s_add_u32 m0,s61,6144
s_add_u32 s63,s60,6144
buffer_load_dwordx4 v112,s[8:11],s63 offen sc1 lds
s_add_u32 m0,s61,7168
s_nop 0
buffer_load_dwordx4 v113,s[8:11],s63 offen sc1 lds
s_add_u32 m0,s61,8192
s_add_u32 s63,s60,8192
buffer_load_dwordx4 v112,s[8:11],s63 offen sc1 lds
s_add_u32 m0,s61,9216
s_nop 0
buffer_load_dwordx4 v113,s[8:11],s63 offen sc1 lds
s_mov_b32 s35,s42
s_mov_b32 s53,s33
s_mov_b32 s54,s34
s_add_u32 s32,s32,1
s_mov_b32 s33,s40
s_mov_b32 s34,s41
s_mov_b64 s[76:77],s[80:81]
s_sub_u32 s57,40960,s57
v_swap_b32 v16,v18
v_swap_b32 v17,v19
s_mov_b32 s51,s53
s_mov_b32 s52,s54
s_waitcnt vmcnt(5)
s_branch W2_GO
W2_NEXT:
s_sub_u32 s57,40960,s57
v_swap_b32 v16,v18
v_swap_b32 v17,v19
s_mov_b32 s51,s53
s_mov_b32 s52,s54
s_waitcnt vmcnt(3)
W2_GO:
s_barrier
ds_read_b128 v[24:27],v16 offset:0
ds_read_b128 v[28:31],v17 offset:0
ds_read_b128 v[32:35],v16 offset:10240
ds_read_b128 v[36:39],v17 offset:10240
ds_read_b128 v[40:43],v16 offset:20480
ds_read_b128 v[44:47],v17 offset:20480
ds_read_b128 v[48:51],v16 offset:30720
buffer_load_dword v3,v2,s[8:11],s35 offen sc1
s_waitcnt lgkmcnt(6)
v_mfma_f32_32x32x16_bf16 v[56:71],a[0:3],v[24:27],0
ds_read_b128 v[52:55],v17 offset:30720
s_lshl_b32 s60,s51,6
s_add_u32 s60,s60,s52
s_mul_i32 s60,s60,46080
s_waitcnt lgkmcnt(6)
v_mfma_f32_32x32x16_bf16 v[56:71],a[4:7],v[28:31],v[56:71]
ds_read_b128 v[24:27],v16 offset:2048
s_lshl_b32 s61,s56,11
s_add_u32 s60,s60,s61
s_add_u32 s60,s60,223608832
s_waitcnt lgkmcnt(5)
v_mfma_f32_32x32x16_bf16 v[56:71],a[40:43],v[32:35],v[56:71]
ds_read_b128 v[28:31],v17 offset:2048
buffer_load_dwordx4 v[120:123],v116,s[8:11],s60 offen sc1
buffer_load_dwordx4 v[124:127],v117,s[8:11],s60 offen sc1
v_mfma_f32_32x32x16_bf16 v[56:71],a[44:47],v[36:39],v[56:71]
ds_read_b128 v[32:35],v16 offset:12288
s_add_u32 s62,s32,1
s_min_u32 s62,s62,127
s_sub_u32 s60,s62,13
s_waitcnt lgkmcnt(5)
v_mfma_f32_32x32x16_bf16 v[56:71],a[80:83],v[40:43],v[56:71]
ds_read_b128 v[36:39],v17 offset:12288
s_lshr_b32 s41,s60,1
s_and_b32 s40,s60,1
s_cmp_eq_u32 s40,0
s_cselect_b32 s61,13,0
v_mfma_f32_32x32x16_bf16 v[56:71],a[84:87],v[44:47],v[56:71]
ds_read_b128 v[40:43],v16 offset:22528
s_add_u32 s41,s41,s61
s_sub_u32 s61,s60,51
s_mul_i32 s71,s51,8
s_waitcnt lgkmcnt(5)
v_mfma_f32_32x32x16_bf16 v[56:71],a[120:123],v[48:51],v[56:71]
ds_read_b128 v[44:47],v17 offset:22528
s_cmp_ge_u32 s60,102
s_cselect_b32 s41,s61,s41
s_cselect_b32 s40,1,s40
s_and_b32 s72,s52,7
v_mfma_f32_32x32x16_bf16 v[56:71],a[124:127],v[52:55],v[56:71]
ds_read_b128 v[48:51],v16 offset:32768
s_cmp_lt_u32 s62,13
s_cselect_b32 s41,s62,s41
s_cselect_b32 s40,0,s40
s_waitcnt lgkmcnt(5)
v_mfma_f32_32x32x16_bf16 v[56:71],a[8:11],v[24:27],v[56:71]
ds_read_b128 v[52:55],v17 offset:32768
s_add_u32 s60,s41,1
s_min_u32 s60,s60,63
s_lshl_b32 s42,s40,6
s_add_u32 s42,s42,s60
v_mfma_f32_32x32x16_bf16 v[56:71],a[12:15],v[28:31],v[56:71]
ds_read_b128 v[24:27],v16 offset:4096
s_lshl_b32 s42,s42,9
s_add_u32 s42,s42,323584
s_add_u32 s71,s71,s72
s_waitcnt lgkmcnt(5)
v_mfma_f32_32x32x16_bf16 v[56:71],a[48:51],v[32:35],v[56:71]
ds_read_b128 v[28:31],v17 offset:4096
s_cmp_lt_u32 s60,8
s_cselect_b64 s[80:81],s[78:79],-1
s_mul_i32 s71,s71,46080
s_add_u32 s71,s71,212467712
v_mfma_f32_32x32x16_bf16 v[56:71],a[52:55],v[36:39],v[56:71]
ds_read_b128 v[32:35],v16 offset:14336
s_lshl_b32 s72,s56,8
s_add_u32 s72,s72,s71
s_add_u32 s72,s72,40960
s_waitcnt lgkmcnt(5)
v_mfma_f32_32x32x16_bf16 v[56:71],a[88:91],v[40:43],v[56:71]
ds_read_b128 v[36:39],v17 offset:14336
s_waitcnt vmcnt(2)
s_mov_b64 exec,1
s_cmp_lg_u32 s49,0
s_cbranch_scc0 ls_307
buffer_store_dword v5,v1,s[8:11],s59 offen sc1
s_branch ls_308
ls_307:
buffer_store_dword v5,v1,s[8:11],s59 offen
ls_308:
s_mov_b64 exec,-1
s_mov_b32 s59,2147483648
v_mfma_f32_32x32x16_bf16 v[56:71],a[92:95],v[44:47],v[56:71]
ds_read_b128 v[40:43],v16 offset:24576
v_cmp_eq_u32 vcc,0,v3
s_and_b64 vcc,vcc,s[76:77]
s_cselect_b32 s37,2147483648,0
s_waitcnt lgkmcnt(5)
v_mfma_f32_32x32x16_bf16 v[56:71],a[128:131],v[48:51],v[56:71]
ds_read_b128 v[44:47],v17 offset:24576
s_cmp_lt_u32 s32,128
s_cselect_b32 s37,s37,2147483648
s_sub_u32 s66,40960,s57
s_add_u32 s61,s34,s68
v_mfma_f32_32x32x16_bf16 v[56:71],a[132:135],v[52:55],v[56:71]
ds_read_b128 v[48:51],v16 offset:34816
s_and_b32 s62,s61,7
s_cmp_lt_u32 s61,64
s_cselect_b32 s62,s62,8
s_waitcnt lgkmcnt(5)
v_mfma_f32_32x32x16_bf16 v[56:71],a[16:19],v[24:27],v[56:71]
ds_read_b128 v[52:55],v17 offset:34816
s_mul_i32 s62,s62,40960
s_and_b32 s61,s34,7
s_mul_i32 s61,s61,40960
v_mad_u32_u24 v112,v76,s62,v74
s_barrier
v_mfma_f32_32x32x16_bf16 v[56:71],a[20:23],v[28:31],v[56:71]
ds_read_b128 v[24:27],v16 offset:6144
v_mad_u32_u24 v112,v78,s61,v112
v_mad_u32_u24 v113,v77,s62,v75
v_mad_u32_u24 v113,v79,s61,v113
s_waitcnt lgkmcnt(5)
v_mfma_f32_32x32x16_bf16 v[56:71],a[56:59],v[32:35],v[56:71]
ds_read_b128 v[28:31],v17 offset:6144
s_mov_b32 s60,s33
s_mul_i32 s60,s60,368640
s_add_u32 s60,s60,s37
s_mul_i32 s61,s46,10240
v_mfma_f32_32x32x16_bf16 v[56:71],a[60:63],v[36:39],v[56:71]
ds_read_b128 v[32:35],v16 offset:16384
s_add_u32 s60,s60,s61
s_add_u32 s60,s60,237371392
s_add_u32 s61,s61,s66
s_waitcnt lgkmcnt(5)
v_mfma_f32_32x32x16_bf16 v[56:71],a[96:99],v[40:43],v[56:71]
ds_read_b128 v[36:39],v17 offset:16384
s_add_u32 m0,s61,0
s_add_u32 s63,s60,0
buffer_load_dwordx4 v112,s[8:11],s63 offen sc1 lds
v_mfma_f32_32x32x16_bf16 v[56:71],a[100:103],v[44:47],v[56:71]
ds_read_b128 v[40:43],v16 offset:26624
s_add_u32 m0,s61,1024
s_lshl_b32 s73,s56,11
s_add_u32 s71,s71,s73
s_waitcnt lgkmcnt(5)
v_mfma_f32_32x32x16_bf16 v[56:71],a[136:139],v[48:51],v[56:71]
ds_read_b128 v[44:47],v17 offset:26624
buffer_load_dwordx4 v113,s[8:11],s63 offen sc1 lds
s_add_u32 m0,s61,2048
s_add_u32 s63,s60,2048
v_mfma_f32_32x32x16_bf16 v[56:71],a[140:143],v[52:55],v[56:71]
ds_read_b128 v[48:51],v16 offset:36864
s_lshl_b32 s82,s51,6
s_add_u32 s82,s82,s52
s_lshl_b32 s82,s82,9
s_waitcnt lgkmcnt(5)
v_mfma_f32_32x32x16_bf16 v[56:71],a[24:27],v[24:27],v[56:71]
ds_read_b128 v[52:55],v17 offset:36864
buffer_load_dwordx4 v112,s[8:11],s63 offen sc1 lds
s_add_u32 m0,s61,3072
s_add_u32 s82,s82,524288
v_mfma_f32_32x32x16_bf16 v[56:71],a[28:31],v[28:31],v[56:71]
ds_read_b128 v[24:27],v16 offset:8192
s_lshl_b32 s70,s56,2
s_add_u32 s82,s82,s70
s_waitcnt lgkmcnt(5)
v_mfma_f32_32x32x16_bf16 v[56:71],a[64:67],v[32:35],v[56:71]
ds_read_b128 v[28:31],v17 offset:8192
buffer_load_dwordx4 v113,s[8:11],s63 offen sc1 lds
s_add_u32 m0,s61,4096
s_add_u32 s63,s60,4096
v_mfma_f32_32x32x16_bf16 v[56:71],a[68:71],v[36:39],v[56:71]
ds_read_b128 v[32:35],v16 offset:18432
s_waitcnt lgkmcnt(5)
v_mfma_f32_32x32x16_bf16 v[56:71],a[104:107],v[40:43],v[56:71]
ds_read_b128 v[36:39],v17 offset:18432
buffer_load_dwordx4 v112,s[8:11],s63 offen sc1 lds
s_add_u32 m0,s61,5120
v_mfma_f32_32x32x16_bf16 v[56:71],a[108:111],v[44:47],v[56:71]
ds_read_b128 v[40:43],v16 offset:28672
s_waitcnt lgkmcnt(5)
v_mfma_f32_32x32x16_bf16 v[56:71],a[144:147],v[48:51],v[56:71]
ds_read_b128 v[44:47],v17 offset:28672
buffer_load_dword v3,v2,s[8:11],s35 offen sc1
v_mfma_f32_32x32x16_bf16 v[56:71],a[148:151],v[52:55],v[56:71]
ds_read_b128 v[48:51],v16 offset:38912
buffer_load_dwordx4 v113,s[8:11],s63 offen sc1 lds
s_add_u32 m0,s61,6144
s_waitcnt lgkmcnt(5)
v_mfma_f32_32x32x16_bf16 v[56:71],a[32:35],v[24:27],v[56:71]
ds_read_b128 v[52:55],v17 offset:38912
s_add_u32 s63,s60,6144
v_mfma_f32_32x32x16_bf16 v[56:71],a[36:39],v[28:31],v[56:71]
buffer_load_dwordx4 v112,s[8:11],s63 offen sc1 lds
s_add_u32 m0,s61,7168
s_waitcnt lgkmcnt(4)
v_mfma_f32_32x32x16_bf16 v[56:71],a[72:75],v[32:35],v[56:71]
v_mfma_f32_32x32x16_bf16 v[56:71],a[76:79],v[36:39],v[56:71]
buffer_load_dwordx4 v113,s[8:11],s63 offen sc1 lds
s_add_u32 m0,s61,8192
s_add_u32 s63,s60,8192
s_waitcnt lgkmcnt(2)
v_mfma_f32_32x32x16_bf16 v[56:71],a[112:115],v[40:43],v[56:71]
v_mfma_f32_32x32x16_bf16 v[56:71],a[116:119],v[44:47],v[56:71]
buffer_load_dwordx4 v112,s[8:11],s63 offen sc1 lds
s_add_u32 m0,s61,9216
s_waitcnt lgkmcnt(0)
v_mfma_f32_32x32x16_bf16 v[56:71],a[152:155],v[48:51],v[56:71]
v_mfma_f32_32x32x16_bf16 v[56:71],a[156:159],v[52:55],v[56:71]
buffer_load_dwordx4 v113,s[8:11],s63 offen sc1 lds
s_waitcnt vmcnt(12)
v_lshlrev_b32 v128,16,v120
v_and_b32 v129,0xffff0000,v120
v_lshlrev_b32 v130,16,v121
v_and_b32 v131,0xffff0000,v121
v_lshlrev_b32 v132,16,v122
v_and_b32 v133,0xffff0000,v122
v_lshlrev_b32 v134,16,v123
v_and_b32 v135,0xffff0000,v123
v_lshlrev_b32 v136,16,v124
v_and_b32 v137,0xffff0000,v124
v_lshlrev_b32 v138,16,v125
v_and_b32 v139,0xffff0000,v125
v_lshlrev_b32 v140,16,v126
v_and_b32 v141,0xffff0000,v126
v_lshlrev_b32 v142,16,v127
v_and_b32 v143,0xffff0000,v127
s_cmp_eq_u32 s37,0
s_cbranch_scc0 sec_311
s_mov_b32 s35,s42
s_mov_b32 s53,s33
s_mov_b32 s54,s34
s_add_u32 s32,s32,1
s_mov_b32 s33,s40
s_mov_b32 s34,s41
s_mov_b64 s[76:77],s[80:81]
s_nop 2
ep_309:
v_cvt_pk_bf16_f32 v6,v56,v57
v_lshlrev_b32 v56,16,v6
v_and_b32 v57,0xffff0000,v6
v_cvt_pk_bf16_f32 v6,v58,v59
v_lshlrev_b32 v58,16,v6
v_and_b32 v59,0xffff0000,v6
v_cvt_pk_bf16_f32 v6,v60,v61
v_lshlrev_b32 v60,16,v6
v_and_b32 v61,0xffff0000,v6
v_cvt_pk_bf16_f32 v6,v62,v63
v_lshlrev_b32 v62,16,v6
v_and_b32 v63,0xffff0000,v6
v_cvt_pk_bf16_f32 v6,v64,v65
v_lshlrev_b32 v64,16,v6
v_and_b32 v65,0xffff0000,v6
v_cvt_pk_bf16_f32 v6,v66,v67
v_lshlrev_b32 v66,16,v6
v_and_b32 v67,0xffff0000,v6
v_cvt_pk_bf16_f32 v6,v68,v69
v_lshlrev_b32 v68,16,v6
v_and_b32 v69,0xffff0000,v6
v_cvt_pk_bf16_f32 v6,v70,v71
v_lshlrev_b32 v70,16,v6
v_and_b32 v71,0xffff0000,v6
v_pk_add_f32 v[56:57],v[56:57],v[128:129]
v_pk_add_f32 v[58:59],v[58:59],v[130:131]
v_pk_add_f32 v[60:61],v[60:61],v[132:133]
v_pk_add_f32 v[62:63],v[62:63],v[134:135]
v_pk_add_f32 v[64:65],v[64:65],v[136:137]
v_pk_add_f32 v[66:67],v[66:67],v[138:139]
v_pk_add_f32 v[68:69],v[68:69],v[140:141]
v_pk_add_f32 v[70:71],v[70:71],v[142:143]
v_cvt_pk_bf16_f32 v144,v56,v57
v_lshlrev_b32 v56,16,v144
v_and_b32 v57,0xffff0000,v144
v_cvt_pk_bf16_f32 v145,v58,v59
v_lshlrev_b32 v58,16,v145
v_and_b32 v59,0xffff0000,v145
v_cvt_pk_bf16_f32 v146,v60,v61
v_lshlrev_b32 v60,16,v146
v_and_b32 v61,0xffff0000,v146
v_cvt_pk_bf16_f32 v147,v62,v63
v_lshlrev_b32 v62,16,v147
v_and_b32 v63,0xffff0000,v147
v_cvt_pk_bf16_f32 v148,v64,v65
v_lshlrev_b32 v64,16,v148
v_and_b32 v65,0xffff0000,v148
v_cvt_pk_bf16_f32 v149,v66,v67
v_lshlrev_b32 v66,16,v149
v_and_b32 v67,0xffff0000,v149
v_cvt_pk_bf16_f32 v150,v68,v69
v_lshlrev_b32 v68,16,v150
v_and_b32 v69,0xffff0000,v150
v_cvt_pk_bf16_f32 v151,v70,v71
v_lshlrev_b32 v70,16,v151
v_and_b32 v71,0xffff0000,v151
s_cmp_lg_u32 s49,0
s_cbranch_scc0 ls_312
buffer_store_dwordx4 v[144:147],v20,s[8:11],s71 offen sc1
buffer_store_dwordx4 v[148:151],v21,s[8:11],s71 offen sc1
s_branch ls_313
ls_312:
buffer_store_dwordx4 v[144:147],v20,s[8:11],s71 offen
buffer_store_dwordx4 v[148:151],v21,s[8:11],s71 offen
ls_313:
v_pk_add_f32 v[6:7],v[56:57],v[58:59]
v_pk_mul_f32 v[8:9],v[56:57],v[56:57]
v_pk_fma_f32 v[8:9],v[58:59],v[58:59],v[8:9]
v_pk_add_f32 v[6:7],v[6:7],v[60:61]
v_pk_fma_f32 v[8:9],v[60:61],v[60:61],v[8:9]
v_pk_add_f32 v[6:7],v[6:7],v[62:63]
v_pk_fma_f32 v[8:9],v[62:63],v[62:63],v[8:9]
v_pk_add_f32 v[6:7],v[6:7],v[64:65]
v_pk_fma_f32 v[8:9],v[64:65],v[64:65],v[8:9]
v_pk_add_f32 v[6:7],v[6:7],v[66:67]
v_pk_fma_f32 v[8:9],v[66:67],v[66:67],v[8:9]
v_pk_add_f32 v[6:7],v[6:7],v[68:69]
v_pk_fma_f32 v[8:9],v[68:69],v[68:69],v[8:9]
v_pk_add_f32 v[6:7],v[6:7],v[70:71]
v_pk_fma_f32 v[8:9],v[70:71],v[70:71],v[8:9]
v_add_f32 v6,v6,v7
v_add_f32 v7,v8,v9
v_mov_b32 v8,v6
v_mov_b32 v9,v7
s_nop 0
v_permlane32_swap_b32 v6,v8
v_permlane32_swap_b32 v7,v9
v_pk_add_f32 v[6:7],v[6:7],v[8:9]
s_mov_b32 exec_hi,0
s_cmp_lg_u32 s49,0
s_cbranch_scc0 ls_314
buffer_store_dwordx2 v[6:7],v114,s[8:11],s72 offen sc1
s_branch ls_315
ls_314:
buffer_store_dwordx2 v[6:7],v114,s[8:11],s72 offen
ls_315:
s_mov_b32 exec_hi,-1
s_mov_b32 s59,s82
s_cmp_eq_u32 s37,0
s_cbranch_scc1 W2_NEXT
s_waitcnt vmcnt(3)
v_cmp_eq_u32 vcc,0,v3
s_and_b64 vcc,vcc,s[76:77]
s_cselect_b32 s37,2147483648,0
s_cmp_lt_u32 s32,128
s_cselect_b32 s37,s37,2147483648
s_cmp_eq_u32 s37,0
s_cbranch_scc1 W2_COLD2
s_waitcnt vmcnt(0)
s_mov_b64 exec,1
s_cmp_lg_u32 s49,0
s_cbranch_scc0 ls_316
buffer_store_dword v5,v1,s[8:11],s59 offen sc1
s_branch ls_317
ls_316:
buffer_store_dword v5,v1,s[8:11],s59 offen
ls_317:
s_mov_b64 exec,-1
s_mov_b32 s59,2147483648
s_cmp_lt_u32 s32,128
s_cbranch_scc1 W2_COLD
s_branch W2_END
sec_311:
s_waitcnt vmcnt(5)
v_cmp_eq_u32 vcc,0,v3
s_and_b64 vcc,vcc,s[76:77]
s_cselect_b32 s37,2147483648,0
s_cmp_lt_u32 s32,128
s_cselect_b32 s37,s37,2147483648
s_cmp_lg_u32 s37,0
s_cbranch_scc1 nr_310
s_sub_u32 s66,40960,s57
s_add_u32 s61,s34,s68
s_and_b32 s62,s61,7
s_cmp_lt_u32 s61,64
s_cselect_b32 s62,s62,8
s_mul_i32 s62,s62,40960
s_and_b32 s61,s34,7
s_mul_i32 s61,s61,40960
v_mad_u32_u24 v112,v76,s62,v74
v_mad_u32_u24 v112,v78,s61,v112
v_mad_u32_u24 v113,v77,s62,v75
v_mad_u32_u24 v113,v79,s61,v113
s_mov_b32 s60,s33
s_mul_i32 s60,s60,368640
s_add_u32 s60,s60,s37
s_mul_i32 s61,s46,10240
s_add_u32 s60,s60,s61
s_add_u32 s60,s60,237371392
s_add_u32 s61,s61,s66
s_add_u32 m0,s61,0
s_add_u32 s63,s60,0
buffer_load_dwordx4 v112,s[8:11],s63 offen sc1 lds
v_cvt_pk_bf16_f32 v6,v56,v57
v_lshlrev_b32 v56,16,v6
v_and_b32 v57,0xffff0000,v6
v_cvt_pk_bf16_f32 v6,v58,v59
s_add_u32 m0,s61,1024
s_nop 0
buffer_load_dwordx4 v113,s[8:11],s63 offen sc1 lds
v_lshlrev_b32 v58,16,v6
v_and_b32 v59,0xffff0000,v6
v_cvt_pk_bf16_f32 v6,v60,v61
v_lshlrev_b32 v60,16,v6
s_add_u32 m0,s61,2048
s_add_u32 s63,s60,2048
buffer_load_dwordx4 v112,s[8:11],s63 offen sc1 lds
v_and_b32 v61,0xffff0000,v6
v_cvt_pk_bf16_f32 v6,v62,v63
v_lshlrev_b32 v62,16,v6
v_and_b32 v63,0xffff0000,v6
s_add_u32 m0,s61,3072
s_nop 0
buffer_load_dwordx4 v113,s[8:11],s63 offen sc1 lds
v_cvt_pk_bf16_f32 v6,v64,v65
v_lshlrev_b32 v64,16,v6
v_and_b32 v65,0xffff0000,v6
v_cvt_pk_bf16_f32 v6,v66,v67
s_add_u32 m0,s61,4096
s_add_u32 s63,s60,4096
buffer_load_dwordx4 v112,s[8:11],s63 offen sc1 lds
v_lshlrev_b32 v66,16,v6
v_and_b32 v67,0xffff0000,v6
v_cvt_pk_bf16_f32 v6,v68,v69
v_lshlrev_b32 v68,16,v6
s_add_u32 m0,s61,5120
s_nop 0
buffer_load_dwordx4 v113,s[8:11],s63 offen sc1 lds
v_and_b32 v69,0xffff0000,v6
v_cvt_pk_bf16_f32 v6,v70,v71
v_lshlrev_b32 v70,16,v6
v_and_b32 v71,0xffff0000,v6
s_add_u32 m0,s61,6144
s_add_u32 s63,s60,6144
buffer_load_dwordx4 v112,s[8:11],s63 offen sc1 lds
v_pk_add_f32 v[56:57],v[56:57],v[128:129]
v_pk_add_f32 v[58:59],v[58:59],v[130:131]
v_pk_add_f32 v[60:61],v[60:61],v[132:133]
v_pk_add_f32 v[62:63],v[62:63],v[134:135]
s_add_u32 m0,s61,7168
s_nop 0
buffer_load_dwordx4 v113,s[8:11],s63 offen sc1 lds
v_pk_add_f32 v[64:65],v[64:65],v[136:137]
v_pk_add_f32 v[66:67],v[66:67],v[138:139]
v_pk_add_f32 v[68:69],v[68:69],v[140:141]
v_pk_add_f32 v[70:71],v[70:71],v[142:143]
s_add_u32 m0,s61,8192
s_add_u32 s63,s60,8192
buffer_load_dwordx4 v112,s[8:11],s63 offen sc1 lds
v_cvt_pk_bf16_f32 v144,v56,v57
v_lshlrev_b32 v56,16,v144
v_and_b32 v57,0xffff0000,v144
v_cvt_pk_bf16_f32 v145,v58,v59
s_add_u32 m0,s61,9216
s_nop 0
buffer_load_dwordx4 v113,s[8:11],s63 offen sc1 lds
v_lshlrev_b32 v58,16,v145
v_and_b32 v59,0xffff0000,v145
v_cvt_pk_bf16_f32 v146,v60,v61
v_lshlrev_b32 v60,16,v146
s_mov_b32 s35,s42
s_mov_b32 s53,s33
s_mov_b32 s54,s34
s_add_u32 s32,s32,1
s_mov_b32 s33,s40
s_mov_b32 s34,s41
s_mov_b64 s[76:77],s[80:81]
v_and_b32 v61,0xffff0000,v146
v_cvt_pk_bf16_f32 v147,v62,v63
v_lshlrev_b32 v62,16,v147
v_and_b32 v63,0xffff0000,v147
v_cvt_pk_bf16_f32 v148,v64,v65
v_lshlrev_b32 v64,16,v148
v_and_b32 v65,0xffff0000,v148
v_cvt_pk_bf16_f32 v149,v66,v67
v_lshlrev_b32 v66,16,v149
v_and_b32 v67,0xffff0000,v149
v_cvt_pk_bf16_f32 v150,v68,v69
v_lshlrev_b32 v68,16,v150
v_and_b32 v69,0xffff0000,v150
v_cvt_pk_bf16_f32 v151,v70,v71
v_lshlrev_b32 v70,16,v151
v_and_b32 v71,0xffff0000,v151
s_cmp_lg_u32 s49,0
s_cbranch_scc0 ls_318
buffer_store_dwordx4 v[144:147],v20,s[8:11],s71 offen sc1
buffer_store_dwordx4 v[148:151],v21,s[8:11],s71 offen sc1
s_branch ls_319
ls_318:
buffer_store_dwordx4 v[144:147],v20,s[8:11],s71 offen
buffer_store_dwordx4 v[148:151],v21,s[8:11],s71 offen
ls_319:
v_pk_add_f32 v[6:7],v[56:57],v[58:59]
v_pk_mul_f32 v[8:9],v[56:57],v[56:57]
v_pk_fma_f32 v[8:9],v[58:59],v[58:59],v[8:9]
v_pk_add_f32 v[6:7],v[6:7],v[60:61]
v_pk_fma_f32 v[8:9],v[60:61],v[60:61],v[8:9]
v_pk_add_f32 v[6:7],v[6:7],v[62:63]
v_pk_fma_f32 v[8:9],v[62:63],v[62:63],v[8:9]
v_pk_add_f32 v[6:7],v[6:7],v[64:65]
v_pk_fma_f32 v[8:9],v[64:65],v[64:65],v[8:9]
v_pk_add_f32 v[6:7],v[6:7],v[66:67]
v_pk_fma_f32 v[8:9],v[66:67],v[66:67],v[8:9]
v_pk_add_f32 v[6:7],v[6:7],v[68:69]
v_pk_fma_f32 v[8:9],v[68:69],v[68:69],v[8:9]
v_pk_add_f32 v[6:7],v[6:7],v[70:71]
v_pk_fma_f32 v[8:9],v[70:71],v[70:71],v[8:9]
v_add_f32 v6,v6,v7
v_add_f32 v7,v8,v9
v_mov_b32 v8,v6
v_mov_b32 v9,v7
s_nop 0
v_permlane32_swap_b32 v6,v8
v_permlane32_swap_b32 v7,v9
v_pk_add_f32 v[6:7],v[6:7],v[8:9]
s_mov_b32 exec_hi,0
s_cmp_lg_u32 s49,0
s_cbranch_scc0 ls_320
buffer_store_dwordx2 v[6:7],v114,s[8:11],s72 offen sc1
s_branch ls_321
ls_320:
buffer_store_dwordx2 v[6:7],v114,s[8:11],s72 offen
ls_321:
s_mov_b32 exec_hi,-1
s_mov_b32 s59,s82
s_branch W2_NEXT
nr_310:
buffer_load_dword v3,v2,s[8:11],s35 offen sc1
s_branch ep_309
W2_END:
s_endpgm
ROLE_W3:
v_lshlrev_b32 v1,4,v0
v_mov_b32 v5,1
s_lshl_b32 s56,s48,2
s_add_u32 s56,s56,s46
v_bfe_u32 v6,v0,2,2
v_lshrrev_b32 v7,4,v0
v_add_u32 v7,v6,v7
v_and_b32 v7,3,v7
v_and_b32 v15,3,v0
v_lshlrev_b32 v15,4,v15
v_lshl_add_u32 v15,v7,6,v15
v_lshl_add_u32 v15,v6,8,v15
v_lshrrev_b32 v6,5,v0
v_bfe_u32 v7,v0,4,1
v_lshlrev_b32 v16,10,v7
v_lshl_add_u32 v16,v6,8,v16
v_and_b32 v6,15,v0
v_lshl_add_u32 v16,v6,4,v16
v_add_u32 v18,46080,v16
v_lshrrev_b32 v6,5,v0
v_bfe_u32 v7,v0,4,1
v_lshlrev_b32 v20,10,v7
v_lshl_add_u32 v20,v6,8,v20
v_and_b32 v6,15,v0
v_lshl_add_u32 v20,v6,4,v20
v_lshrrev_b32 v6,5,v0
v_add_u32 v6,2,v6
v_bfe_u32 v7,v0,4,1
v_lshlrev_b32 v17,10,v7
v_lshl_add_u32 v17,v6,8,v17
v_and_b32 v6,15,v0
v_lshl_add_u32 v17,v6,4,v17
v_add_u32 v19,46080,v17
v_lshrrev_b32 v6,5,v0
v_add_u32 v6,2,v6
v_bfe_u32 v7,v0,4,1
v_lshlrev_b32 v21,10,v7
v_lshl_add_u32 v21,v6,8,v21
v_and_b32 v6,15,v0
v_lshl_add_u32 v21,v6,4,v21
v_min_u32 v2,19,v0
v_lshlrev_b32 v2,2,v2
v_mov_b32 v112,0xc0135761
v_mov_b32 v113,0xbdd2d3e8
s_mov_b32 s68,0xbdd2d3e8
v_lshrrev_b32 v6,5,v0
v_mul_u32_u24 v182,2560,v6
v_and_b32 v6,31,v0
v_lshl_add_u32 v182,v6,3,v182
v_add_u32 v182,0xa000,v182
v_mov_b32 v20,v1
v_add_u32 v21,1024,v1
s_waitcnt vmcnt(0)
s_barrier
s_cmp_lg_u32 s46,0
s_cbranch_scc1 arr_322
v_mov_b32 v6,1
s_lshl_b32 s3,s49,2
v_mov_b32 v7,s3
s_mov_b64 exec,1
buffer_atomic_add v6,v7,s[12:15],0 offen sc1
s_mov_b64 exec,-1
arr_322:
s_lshl_b32 s58,s56,6
s_mul_i32 s63,s46,40960
s_mov_b32 s4,s36
s_mov_b32 s5,s37
s_mov_b32 s6,1966080
s_mov_b32 s7,0x20000
v_lshrrev_b32 v9,2,v0
s_mov_b32 s64,3072
v_mul_lo_u32 v9,v9,s64
v_and_b32 v10,3,v0
v_lshl_add_u32 v6,v10,4,v9
s_add_u32 m0,s63,0
s_add_u32 s65,s58,0
buffer_load_dwordx4 v6,s[4:7],s65 offen lds
s_add_u32 m0,s63,1024
s_add_u32 s65,s58,49152
buffer_load_dwordx4 v6,s[4:7],s65 offen lds
s_add_u32 m0,s63,2048
s_add_u32 s65,s58,98304
buffer_load_dwordx4 v6,s[4:7],s65 offen lds
s_add_u32 m0,s63,3072
s_add_u32 s65,s58,147456
buffer_load_dwordx4 v6,s[4:7],s65 offen lds
s_add_u32 m0,s63,4096
s_add_u32 s65,s58,196608
buffer_load_dwordx4 v6,s[4:7],s65 offen lds
s_add_u32 m0,s63,5120
s_add_u32 s65,s58,245760
buffer_load_dwordx4 v6,s[4:7],s65 offen lds
s_add_u32 m0,s63,6144
s_add_u32 s65,s58,294912
buffer_load_dwordx4 v6,s[4:7],s65 offen lds
s_add_u32 m0,s63,7168
s_add_u32 s65,s58,344064
buffer_load_dwordx4 v6,s[4:7],s65 offen lds
s_add_u32 m0,s63,8192
s_add_u32 s65,s58,393216
buffer_load_dwordx4 v6,s[4:7],s65 offen lds
s_add_u32 m0,s63,9216
s_add_u32 s65,s58,442368
buffer_load_dwordx4 v6,s[4:7],s65 offen lds
s_add_u32 m0,s63,10240
s_add_u32 s65,s58,491520
buffer_load_dwordx4 v6,s[4:7],s65 offen lds
s_add_u32 m0,s63,11264
s_add_u32 s65,s58,540672
buffer_load_dwordx4 v6,s[4:7],s65 offen lds
s_add_u32 m0,s63,12288
s_add_u32 s65,s58,589824
buffer_load_dwordx4 v6,s[4:7],s65 offen lds
s_add_u32 m0,s63,13312
s_add_u32 s65,s58,638976
buffer_load_dwordx4 v6,s[4:7],s65 offen lds
s_add_u32 m0,s63,14336
s_add_u32 s65,s58,688128
buffer_load_dwordx4 v6,s[4:7],s65 offen lds
s_add_u32 m0,s63,15360
s_add_u32 s65,s58,737280
buffer_load_dwordx4 v6,s[4:7],s65 offen lds
s_add_u32 m0,s63,16384
s_add_u32 s65,s58,786432
buffer_load_dwordx4 v6,s[4:7],s65 offen lds
s_add_u32 m0,s63,17408
s_add_u32 s65,s58,835584
buffer_load_dwordx4 v6,s[4:7],s65 offen lds
s_add_u32 m0,s63,18432
s_add_u32 s65,s58,884736
buffer_load_dwordx4 v6,s[4:7],s65 offen lds
s_add_u32 m0,s63,19456
s_add_u32 s65,s58,933888
buffer_load_dwordx4 v6,s[4:7],s65 offen lds
s_add_u32 m0,s63,20480
s_add_u32 s65,s58,983040
buffer_load_dwordx4 v6,s[4:7],s65 offen lds
s_add_u32 m0,s63,21504
s_add_u32 s65,s58,1032192
buffer_load_dwordx4 v6,s[4:7],s65 offen lds
s_add_u32 m0,s63,22528
s_add_u32 s65,s58,1081344
buffer_load_dwordx4 v6,s[4:7],s65 offen lds
s_add_u32 m0,s63,23552
s_add_u32 s65,s58,1130496
buffer_load_dwordx4 v6,s[4:7],s65 offen lds
s_add_u32 m0,s63,24576
s_add_u32 s65,s58,1179648
buffer_load_dwordx4 v6,s[4:7],s65 offen lds
s_add_u32 m0,s63,25600
s_add_u32 s65,s58,1228800
buffer_load_dwordx4 v6,s[4:7],s65 offen lds
s_add_u32 m0,s63,26624
s_add_u32 s65,s58,1277952
buffer_load_dwordx4 v6,s[4:7],s65 offen lds
s_add_u32 m0,s63,27648
s_add_u32 s65,s58,1327104
buffer_load_dwordx4 v6,s[4:7],s65 offen lds
s_add_u32 m0,s63,28672
s_add_u32 s65,s58,1376256
buffer_load_dwordx4 v6,s[4:7],s65 offen lds
s_add_u32 m0,s63,29696
s_add_u32 s65,s58,1425408
buffer_load_dwordx4 v6,s[4:7],s65 offen lds
s_add_u32 m0,s63,30720
s_add_u32 s65,s58,1474560
buffer_load_dwordx4 v6,s[4:7],s65 offen lds
s_add_u32 m0,s63,31744
s_add_u32 s65,s58,1523712
buffer_load_dwordx4 v6,s[4:7],s65 offen lds
s_add_u32 m0,s63,32768
s_add_u32 s65,s58,1572864
buffer_load_dwordx4 v6,s[4:7],s65 offen lds
s_add_u32 m0,s63,33792
s_add_u32 s65,s58,1622016
buffer_load_dwordx4 v6,s[4:7],s65 offen lds
s_add_u32 m0,s63,34816
s_add_u32 s65,s58,1671168
buffer_load_dwordx4 v6,s[4:7],s65 offen lds
s_add_u32 m0,s63,35840
s_add_u32 s65,s58,1720320
buffer_load_dwordx4 v6,s[4:7],s65 offen lds
s_add_u32 m0,s63,36864
s_add_u32 s65,s58,1769472
buffer_load_dwordx4 v6,s[4:7],s65 offen lds
s_add_u32 m0,s63,37888
s_add_u32 s65,s58,1818624
buffer_load_dwordx4 v6,s[4:7],s65 offen lds
s_add_u32 m0,s63,38912
s_add_u32 s65,s58,1867776
buffer_load_dwordx4 v6,s[4:7],s65 offen lds
s_add_u32 m0,s63,39936
s_add_u32 s65,s58,1916928
buffer_load_dwordx4 v6,s[4:7],s65 offen lds
s_waitcnt vmcnt(20)
v_bfe_u32 v9,v0,2,2
v_lshrrev_b32 v10,5,v0
v_lshl_add_u32 v9,v10,2,v9
v_mul_u32_u24 v9,64,v9
v_and_b32 v10,1,v0
v_lshl_add_u32 v9,v10,3,v9
v_bfe_u32 v10,v0,1,1
v_lshl_add_u32 v9,v10,5,v9
v_bfe_u32 v10,v0,4,1
v_lshl_add_u32 v9,v10,4,v9
v_add_u32 v7,s63,v9
ds_read_b64_tr_b16 a[0:1],v7 offset:0
ds_read_b64_tr_b16 a[2:3],v7 offset:1024
ds_read_b64_tr_b16 a[4:5],v7 offset:512
ds_read_b64_tr_b16 a[6:7],v7 offset:1536
ds_read_b64_tr_b16 a[8:9],v7 offset:2048
ds_read_b64_tr_b16 a[10:11],v7 offset:3072
ds_read_b64_tr_b16 a[12:13],v7 offset:2560
ds_read_b64_tr_b16 a[14:15],v7 offset:3584
ds_read_b64_tr_b16 a[16:17],v7 offset:4096
ds_read_b64_tr_b16 a[18:19],v7 offset:5120
ds_read_b64_tr_b16 a[20:21],v7 offset:4608
ds_read_b64_tr_b16 a[22:23],v7 offset:5632
s_waitcnt lgkmcnt(4)
ds_read_b64_tr_b16 a[24:25],v7 offset:6144
ds_read_b64_tr_b16 a[26:27],v7 offset:7168
ds_read_b64_tr_b16 a[28:29],v7 offset:6656
ds_read_b64_tr_b16 a[30:31],v7 offset:7680
ds_read_b64_tr_b16 a[32:33],v7 offset:8192
ds_read_b64_tr_b16 a[34:35],v7 offset:9216
ds_read_b64_tr_b16 a[36:37],v7 offset:8704
ds_read_b64_tr_b16 a[38:39],v7 offset:9728
ds_read_b64_tr_b16 a[40:41],v7 offset:10240
ds_read_b64_tr_b16 a[42:43],v7 offset:11264
ds_read_b64_tr_b16 a[44:45],v7 offset:10752
ds_read_b64_tr_b16 a[46:47],v7 offset:11776
s_waitcnt lgkmcnt(4)
ds_read_b64_tr_b16 a[48:49],v7 offset:12288
ds_read_b64_tr_b16 a[50:51],v7 offset:13312
ds_read_b64_tr_b16 a[52:53],v7 offset:12800
ds_read_b64_tr_b16 a[54:55],v7 offset:13824
ds_read_b64_tr_b16 a[56:57],v7 offset:14336
ds_read_b64_tr_b16 a[58:59],v7 offset:15360
ds_read_b64_tr_b16 a[60:61],v7 offset:14848
ds_read_b64_tr_b16 a[62:63],v7 offset:15872
ds_read_b64_tr_b16 a[64:65],v7 offset:16384
ds_read_b64_tr_b16 a[66:67],v7 offset:17408
ds_read_b64_tr_b16 a[68:69],v7 offset:16896
ds_read_b64_tr_b16 a[70:71],v7 offset:17920
s_waitcnt lgkmcnt(4)
ds_read_b64_tr_b16 a[72:73],v7 offset:18432
ds_read_b64_tr_b16 a[74:75],v7 offset:19456
ds_read_b64_tr_b16 a[76:77],v7 offset:18944
ds_read_b64_tr_b16 a[78:79],v7 offset:19968
s_waitcnt lgkmcnt(0)
s_waitcnt vmcnt(0)
v_bfe_u32 v9,v0,2,2
v_lshrrev_b32 v10,5,v0
v_lshl_add_u32 v9,v10,2,v9
v_mul_u32_u24 v9,64,v9
v_and_b32 v10,1,v0
v_lshl_add_u32 v9,v10,3,v9
v_bfe_u32 v10,v0,1,1
v_lshl_add_u32 v9,v10,5,v9
v_bfe_u32 v10,v0,4,1
v_lshl_add_u32 v9,v10,4,v9
v_add_u32 v7,s63,v9
ds_read_b64_tr_b16 a[80:81],v7 offset:20480
ds_read_b64_tr_b16 a[82:83],v7 offset:21504
ds_read_b64_tr_b16 a[84:85],v7 offset:20992
ds_read_b64_tr_b16 a[86:87],v7 offset:22016
ds_read_b64_tr_b16 a[88:89],v7 offset:22528
ds_read_b64_tr_b16 a[90:91],v7 offset:23552
ds_read_b64_tr_b16 a[92:93],v7 offset:23040
ds_read_b64_tr_b16 a[94:95],v7 offset:24064
ds_read_b64_tr_b16 a[96:97],v7 offset:24576
ds_read_b64_tr_b16 a[98:99],v7 offset:25600
ds_read_b64_tr_b16 a[100:101],v7 offset:25088
ds_read_b64_tr_b16 a[102:103],v7 offset:26112
s_waitcnt lgkmcnt(4)
ds_read_b64_tr_b16 a[104:105],v7 offset:26624
ds_read_b64_tr_b16 a[106:107],v7 offset:27648
ds_read_b64_tr_b16 a[108:109],v7 offset:27136
ds_read_b64_tr_b16 a[110:111],v7 offset:28160
ds_read_b64_tr_b16 a[112:113],v7 offset:28672
ds_read_b64_tr_b16 a[114:115],v7 offset:29696
ds_read_b64_tr_b16 a[116:117],v7 offset:29184
ds_read_b64_tr_b16 a[118:119],v7 offset:30208
ds_read_b64_tr_b16 a[120:121],v7 offset:30720
ds_read_b64_tr_b16 a[122:123],v7 offset:31744
ds_read_b64_tr_b16 a[124:125],v7 offset:31232
ds_read_b64_tr_b16 a[126:127],v7 offset:32256
s_waitcnt lgkmcnt(4)
ds_read_b64_tr_b16 a[128:129],v7 offset:32768
ds_read_b64_tr_b16 a[130:131],v7 offset:33792
ds_read_b64_tr_b16 a[132:133],v7 offset:33280
ds_read_b64_tr_b16 a[134:135],v7 offset:34304
ds_read_b64_tr_b16 a[136:137],v7 offset:34816
ds_read_b64_tr_b16 a[138:139],v7 offset:35840
ds_read_b64_tr_b16 a[140:141],v7 offset:35328
ds_read_b64_tr_b16 a[142:143],v7 offset:36352
ds_read_b64_tr_b16 a[144:145],v7 offset:36864
ds_read_b64_tr_b16 a[146:147],v7 offset:37888
ds_read_b64_tr_b16 a[148:149],v7 offset:37376
ds_read_b64_tr_b16 a[150:151],v7 offset:38400
s_waitcnt lgkmcnt(4)
ds_read_b64_tr_b16 a[152:153],v7 offset:38912
ds_read_b64_tr_b16 a[154:155],v7 offset:39936
ds_read_b64_tr_b16 a[156:157],v7 offset:39424
ds_read_b64_tr_b16 a[158:159],v7 offset:40448
s_waitcnt lgkmcnt(0)
v_mov_b32 v24,0x3f803f80
v_mov_b32 v25,0x3f803f80
v_mov_b32 v26,0x3f803f80
v_mov_b32 v27,0x3f803f80
s_nop 1
v_mfma_f32_32x32x16_bf16 v[144:159],a[0:3],v[24:27],0
v_mfma_f32_32x32x16_bf16 v[144:159],a[4:7],v[24:27],v[144:159]
v_mfma_f32_32x32x16_bf16 v[144:159],a[8:11],v[24:27],v[144:159]
v_mfma_f32_32x32x16_bf16 v[144:159],a[12:15],v[24:27],v[144:159]
v_mfma_f32_32x32x16_bf16 v[144:159],a[16:19],v[24:27],v[144:159]
v_mfma_f32_32x32x16_bf16 v[144:159],a[20:23],v[24:27],v[144:159]
v_mfma_f32_32x32x16_bf16 v[144:159],a[24:27],v[24:27],v[144:159]
v_mfma_f32_32x32x16_bf16 v[144:159],a[28:31],v[24:27],v[144:159]
v_mfma_f32_32x32x16_bf16 v[144:159],a[32:35],v[24:27],v[144:159]
v_mfma_f32_32x32x16_bf16 v[144:159],a[36:39],v[24:27],v[144:159]
v_mfma_f32_32x32x16_bf16 v[144:159],a[40:43],v[24:27],v[144:159]
v_mfma_f32_32x32x16_bf16 v[144:159],a[44:47],v[24:27],v[144:159]
v_mfma_f32_32x32x16_bf16 v[144:159],a[48:51],v[24:27],v[144:159]
v_mfma_f32_32x32x16_bf16 v[144:159],a[52:55],v[24:27],v[144:159]
v_mfma_f32_32x32x16_bf16 v[144:159],a[56:59],v[24:27],v[144:159]
v_mfma_f32_32x32x16_bf16 v[144:159],a[60:63],v[24:27],v[144:159]
v_mfma_f32_32x32x16_bf16 v[144:159],a[64:67],v[24:27],v[144:159]
v_mfma_f32_32x32x16_bf16 v[144:159],a[68:71],v[24:27],v[144:159]
v_mfma_f32_32x32x16_bf16 v[144:159],a[72:75],v[24:27],v[144:159]
v_mfma_f32_32x32x16_bf16 v[144:159],a[76:79],v[24:27],v[144:159]
v_mfma_f32_32x32x16_bf16 v[144:159],a[80:83],v[24:27],v[144:159]
v_mfma_f32_32x32x16_bf16 v[144:159],a[84:87],v[24:27],v[144:159]
v_mfma_f32_32x32x16_bf16 v[144:159],a[88:91],v[24:27],v[144:159]
v_mfma_f32_32x32x16_bf16 v[144:159],a[92:95],v[24:27],v[144:159]
v_mfma_f32_32x32x16_bf16 v[144:159],a[96:99],v[24:27],v[144:159]
v_mfma_f32_32x32x16_bf16 v[144:159],a[100:103],v[24:27],v[144:159]
v_mfma_f32_32x32x16_bf16 v[144:159],a[104:107],v[24:27],v[144:159]
v_mfma_f32_32x32x16_bf16 v[144:159],a[108:111],v[24:27],v[144:159]
v_mfma_f32_32x32x16_bf16 v[144:159],a[112:115],v[24:27],v[144:159]
v_mfma_f32_32x32x16_bf16 v[144:159],a[116:119],v[24:27],v[144:159]
v_mfma_f32_32x32x16_bf16 v[144:159],a[120:123],v[24:27],v[144:159]
v_mfma_f32_32x32x16_bf16 v[144:159],a[124:127],v[24:27],v[144:159]
v_mfma_f32_32x32x16_bf16 v[144:159],a[128:131],v[24:27],v[144:159]
v_mfma_f32_32x32x16_bf16 v[144:159],a[132:135],v[24:27],v[144:159]
v_mfma_f32_32x32x16_bf16 v[144:159],a[136:139],v[24:27],v[144:159]
v_mfma_f32_32x32x16_bf16 v[144:159],a[140:143],v[24:27],v[144:159]
v_mfma_f32_32x32x16_bf16 v[144:159],a[144:147],v[24:27],v[144:159]
v_mfma_f32_32x32x16_bf16 v[144:159],a[148:151],v[24:27],v[144:159]
v_mfma_f32_32x32x16_bf16 v[144:159],a[152:155],v[24:27],v[144:159]
v_mfma_f32_32x32x16_bf16 v[144:159],a[156:159],v[24:27],v[144:159]
s_barrier
s_lshl_b32 s3,s49,2
v_mov_b32 v7,s3
s_nop 8
ibw_323:
buffer_load_dword v6,v7,s[12:15],0 offen sc1
s_waitcnt vmcnt(0)
v_cmp_ne_u32 vcc,256,v6
s_nop 0
s_cbranch_vccz ok_324
s_sleep 8
s_sub_u32 s47,s47,1
s_cbranch_scc1 ABORT
s_branch ibw_323
ok_324:
s_cmp_lg_u32 s49,0
s_cbranch_scc1 ibok_325
v_and_b32 v7,7,v0
v_lshlrev_b32 v7,2,v7
buffer_load_dword v6,v7,s[12:15],0 offen offset:32 sc1
s_waitcnt vmcnt(0)
v_cmp_ne_u32 vcc,32,v6
s_nop 0
s_cbranch_vccz ibok_325
s_barrier
s_mov_b32 s49,1
s_mov_b32 s3,s2
s_load_dwordx16 s[16:31],s[0:1],0
s_load_dwordx8 s[32:39],s[0:1],64
s_waitcnt lgkmcnt(0)
s_branch DISPATCH
ibok_325:
s_mov_b32 s50,0
s_mov_b32 s32,0
s_mov_b32 s57,0
s_mov_b32 s59,2147483648
s_mov_b32 s82,2147483648
s_mov_b32 s39,2147483648
v_mov_b32 v22,94208
v_lshl_add_u32 v22,v0,2,v22
v_mov_b32 v23,0
ds_write_b32 v22,v23
s_mov_b32 s39,1600000
v_and_b32 v72,15,v0
v_lshlrev_b32 v72,7,v72
v_min_u32 v6,59,v0
v_lshlrev_b32 v6,2,v6
v_add_u32 v2,198656,v6
v_add_u32 v7,-80,v6
v_cmp_gt_u32 s[78:79],20,v0
s_nop 1
v_cndmask_b32 v2,v7,v2,s[78:79]
s_mov_b32 s51,0
s_mov_b32 s52,0
s_mul_i32 s62,s51,4
s_and_b32 s63,s52,3
s_add_u32 s62,s62,s63
s_mul_i32 s62,s62,98304
s_add_u32 s62,s62,242778112
s_lshl_b32 s63,s56,11
s_add_u32 s62,s62,s63
buffer_load_dword v73,v72,s[8:11],s62 offen sc1
s_mov_b32 s51,0
s_mov_b32 s52,1
s_mul_i32 s62,s51,4
s_and_b32 s63,s52,3
s_add_u32 s62,s62,s63
s_mul_i32 s62,s62,98304
s_add_u32 s62,s62,242778112
s_lshl_b32 s63,s56,11
s_add_u32 s62,s62,s63
buffer_load_dword v73,v72,s[8:11],s62 offen sc1
s_mov_b32 s51,0
s_mov_b32 s52,2
s_mul_i32 s62,s51,4
s_and_b32 s63,s52,3
s_add_u32 s62,s62,s63
s_mul_i32 s62,s62,98304
s_add_u32 s62,s62,242778112
s_lshl_b32 s63,s56,11
s_add_u32 s62,s62,s63
buffer_load_dword v73,v72,s[8:11],s62 offen sc1
s_mov_b32 s51,0
s_mov_b32 s52,3
s_mul_i32 s62,s51,4
s_and_b32 s63,s52,3
s_add_u32 s62,s62,s63
s_mul_i32 s62,s62,98304
s_add_u32 s62,s62,242778112
s_lshl_b32 s63,s56,11
s_add_u32 s62,s62,s63
buffer_load_dword v73,v72,s[8:11],s62 offen sc1
s_mov_b32 s51,1
s_mov_b32 s52,0
s_mul_i32 s62,s51,4
s_and_b32 s63,s52,3
s_add_u32 s62,s62,s63
s_mul_i32 s62,s62,98304
s_add_u32 s62,s62,242778112
s_lshl_b32 s63,s56,11
s_add_u32 s62,s62,s63
buffer_load_dword v73,v72,s[8:11],s62 offen sc1
s_mov_b32 s51,1
s_mov_b32 s52,1
s_mul_i32 s62,s51,4
s_and_b32 s63,s52,3
s_add_u32 s62,s62,s63
s_mul_i32 s62,s62,98304
s_add_u32 s62,s62,242778112
s_lshl_b32 s63,s56,11
s_add_u32 s62,s62,s63
buffer_load_dword v73,v72,s[8:11],s62 offen sc1
s_mov_b32 s51,1
s_mov_b32 s52,2
s_mul_i32 s62,s51,4
s_and_b32 s63,s52,3
s_add_u32 s62,s62,s63
s_mul_i32 s62,s62,98304
s_add_u32 s62,s62,242778112
s_lshl_b32 s63,s56,11
s_add_u32 s62,s62,s63
buffer_load_dword v73,v72,s[8:11],s62 offen sc1
s_mov_b32 s51,1
s_mov_b32 s52,3
s_mul_i32 s62,s51,4
s_and_b32 s63,s52,3
s_add_u32 s62,s62,s63
s_mul_i32 s62,s62,98304
s_add_u32 s62,s62,242778112
s_lshl_b32 s63,s56,11
s_add_u32 s62,s62,s63
buffer_load_dword v73,v72,s[8:11],s62 offen sc1
s_waitcnt vmcnt(0)
s_waitcnt lgkmcnt(0)
s_barrier
s_mov_b32 s83,s100
s_min_u32 s62,s32,127
s_sub_u32 s60,s62,13
s_lshr_b32 s34,s60,1
s_and_b32 s33,s60,1
s_cmp_eq_u32 s33,0
s_cselect_b32 s61,13,0
s_add_u32 s34,s34,s61
s_sub_u32 s61,s60,51
s_cmp_ge_u32 s60,102
s_cselect_b32 s34,s61,s34
s_cselect_b32 s33,1,s33
s_cmp_lt_u32 s62,13
s_cselect_b32 s34,s62,s34
s_cselect_b32 s33,0,s33
s_lshl_b32 s35,s33,6
s_add_u32 s35,s35,s34
s_lshl_b32 s35,s35,9
s_add_u32 s35,s35,325632
s_cmp_lt_u32 s34,4
s_cselect_b64 s[76:77],s[78:79],-1
s_sub_u32 s57,46080,s57
v_swap_b32 v16,v18
v_swap_b32 v17,v19
s_add_u32 s62,s32,1
s_min_u32 s62,s62,127
s_sub_u32 s60,s62,13
s_lshr_b32 s41,s60,1
s_and_b32 s40,s60,1
s_cmp_eq_u32 s40,0
s_cselect_b32 s61,13,0
s_add_u32 s41,s41,s61
s_sub_u32 s61,s60,51
s_cmp_ge_u32 s60,102
s_cselect_b32 s41,s61,s41
s_cselect_b32 s40,1,s40
s_cmp_lt_u32 s62,13
s_cselect_b32 s41,s62,s41
s_cselect_b32 s40,0,s40
s_lshl_b32 s42,s40,6
s_add_u32 s42,s42,s41
s_lshl_b32 s42,s42,9
s_add_u32 s42,s42,325632
s_cmp_lt_u32 s41,4
s_cselect_b64 s[80:81],s[78:79],-1
W3_COLD:
s_mov_b32 s37,0
fb_326:
buffer_load_dword v3,v2,s[8:11],s35 offen sc1
s_waitcnt vmcnt(0)
v_cmp_eq_u32 vcc,0,v3
s_and_b64 vcc,vcc,s[76:77]
s_cbranch_scc0 ok_327
s_sleep 1
s_sub_u32 s47,s47,1
s_cbranch_scc1 ABORT
s_branch fb_326
ok_327:
W3_COLD2:
s_sub_u32 s66,46080,s57
s_mul_i32 s60,s33,8
s_and_b32 s61,s34,7
s_add_u32 s60,s60,s61
s_mul_i32 s60,s60,46080
s_add_u32 s60,s60,s37
s_add_u32 s60,s60,212467712
s_mov_b32 s67,s60
s_mul_i32 s61,s46,10240
s_add_u32 s60,s60,s61
s_add_u32 s61,s61,s66
s_add_u32 m0,s61,0
s_add_u32 s63,s60,0
buffer_load_dwordx4 v1,s[8:11],s63 offen sc1 lds
buffer_load_dwordx4 v1,s[8:11],s63 offen offset:1024 sc1 lds
buffer_load_dwordx4 v1,s[8:11],s63 offen offset:2048 sc1 lds
buffer_load_dwordx4 v1,s[8:11],s63 offen offset:3072 sc1 lds
s_add_u32 m0,s61,4096
s_add_u32 s63,s60,4096
buffer_load_dwordx4 v1,s[8:11],s63 offen sc1 lds
buffer_load_dwordx4 v1,s[8:11],s63 offen offset:1024 sc1 lds
s_waitcnt vmcnt(5)
s_mov_b64 exec,1
s_cmp_lg_u32 s49,0
s_cbranch_scc0 ls_328
buffer_store_dword v5,v1,s[8:11],s59 offen sc1
s_branch ls_329
ls_328:
buffer_store_dword v5,v1,s[8:11],s59 offen
ls_329:
s_mov_b64 exec,-1
s_mov_b32 s59,2147483648
buffer_load_dwordx4 v1,s[8:11],s63 offen offset:2048 sc1 lds
buffer_load_dwordx4 v1,s[8:11],s63 offen offset:3072 sc1 lds
s_add_u32 m0,s61,8192
s_add_u32 s63,s60,8192
buffer_load_dwordx4 v1,s[8:11],s63 offen sc1 lds
buffer_load_dwordx4 v1,s[8:11],s63 offen offset:1024 sc1 lds
s_lshl_b32 s62,s46,10
s_add_u32 s62,s62,40960
s_add_u32 m0,s66,s62
s_add_u32 s63,s67,s62
buffer_load_dwordx4 v1,s[8:11],s63 offen sc1 lds
s_add_u32 m0,s66,45056
s_add_u32 s63,s67,45056
buffer_load_dwordx4 v1,s[8:11],s63 offen sc1 lds
s_mov_b32 s35,s42
s_mov_b32 s53,s33
s_mov_b32 s54,s34
s_add_u32 s32,s32,1
s_mov_b32 s33,s40
s_mov_b32 s34,s41
s_mov_b64 s[76:77],s[80:81]
s_sub_u32 s57,46080,s57
v_swap_b32 v16,v18
v_swap_b32 v17,v19
s_mov_b32 s51,s53
s_mov_b32 s52,s54
s_waitcnt vmcnt(7)
s_branch W3_GO
W3_NEXT:
s_sub_u32 s57,46080,s57
v_swap_b32 v16,v18
v_swap_b32 v17,v19
s_mov_b32 s51,s53
s_mov_b32 s52,s54
s_waitcnt vmcnt(2)
W3_GO:
s_barrier
ds_read_b128 v[24:27],v16 offset:0
ds_read_b128 v[28:31],v17 offset:0
ds_read_b128 v[32:35],v16 offset:10240
ds_read_b128 v[36:39],v17 offset:10240
ds_read_b128 v[40:43],v16 offset:20480
ds_read_b128 v[44:47],v17 offset:20480
ds_read_b128 v[48:51],v16 offset:30720
buffer_load_dword v3,v2,s[8:11],s35 offen sc1
s_waitcnt lgkmcnt(6)
v_mfma_f32_32x32x16_bf16 v[56:71],a[0:3],v[24:27],0
ds_read_b128 v[52:55],v17 offset:30720
s_add_u32 s62,s32,1
s_min_u32 s62,s62,127
s_sub_u32 s60,s62,13
s_waitcnt lgkmcnt(6)
v_mfma_f32_32x32x16_bf16 v[56:71],a[4:7],v[28:31],v[56:71]
ds_read_b128 v[24:27],v16 offset:2048
s_lshr_b32 s41,s60,1
s_and_b32 s40,s60,1
s_mul_i32 s71,s51,4
s_waitcnt lgkmcnt(5)
v_mfma_f32_32x32x16_bf16 v[56:71],a[40:43],v[32:35],v[56:71]
ds_read_b128 v[28:31],v17 offset:2048
s_cmp_eq_u32 s40,0
s_cselect_b32 s61,13,0
s_add_u32 s41,s41,s61
s_sub_u32 s61,s60,51
v_mfma_f32_32x32x16_bf16 v[56:71],a[44:47],v[36:39],v[56:71]
ds_read_b128 v[32:35],v16 offset:12288
s_cmp_ge_u32 s60,102
s_cselect_b32 s41,s61,s41
s_cselect_b32 s40,1,s40
s_waitcnt lgkmcnt(5)
v_mfma_f32_32x32x16_bf16 v[56:71],a[80:83],v[40:43],v[56:71]
ds_read_b128 v[36:39],v17 offset:12288
s_cmp_lt_u32 s62,13
s_cselect_b32 s41,s62,s41
s_cselect_b32 s40,0,s40
s_lshl_b32 s42,s40,6
v_mfma_f32_32x32x16_bf16 v[56:71],a[84:87],v[44:47],v[56:71]
ds_read_b128 v[40:43],v16 offset:22528
s_add_u32 s42,s42,s41
s_lshl_b32 s42,s42,9
s_add_u32 s42,s42,325632
s_waitcnt lgkmcnt(5)
v_mfma_f32_32x32x16_bf16 v[56:71],a[120:123],v[48:51],v[56:71]
ds_read_b128 v[44:47],v17 offset:22528
s_cmp_lt_u32 s41,4
s_cselect_b64 s[80:81],s[78:79],-1
s_and_b32 s72,s52,3
s_add_u32 s71,s71,s72
v_mfma_f32_32x32x16_bf16 v[56:71],a[124:127],v[52:55],v[56:71]
ds_read_b128 v[48:51],v16 offset:32768
s_mul_i32 s71,s71,98304
s_add_u32 s71,s71,242778112
s_lshl_b32 s72,s56,11
s_waitcnt lgkmcnt(5)
v_mfma_f32_32x32x16_bf16 v[56:71],a[8:11],v[24:27],v[56:71]
ds_read_b128 v[52:55],v17 offset:32768
s_add_u32 s71,s71,s72
s_lshl_b32 s82,s51,6
s_add_u32 s82,s82,s52
s_lshl_b32 s82,s82,9
v_mfma_f32_32x32x16_bf16 v[56:71],a[12:15],v[28:31],v[56:71]
ds_read_b128 v[24:27],v16 offset:4096
s_add_u32 s82,s82,589824
s_lshl_b32 s70,s56,2
s_add_u32 s82,s82,s70
s_waitcnt lgkmcnt(5)
v_mfma_f32_32x32x16_bf16 v[56:71],a[48:51],v[32:35],v[56:71]
ds_read_b128 v[28:31],v17 offset:4096
v_mfma_f32_32x32x16_bf16 v[56:71],a[52:55],v[36:39],v[56:71]
ds_read_b128 v[32:35],v16 offset:14336
s_waitcnt lgkmcnt(5)
v_mfma_f32_32x32x16_bf16 v[56:71],a[88:91],v[40:43],v[56:71]
ds_read_b128 v[36:39],v17 offset:14336
s_waitcnt vmcnt(0)
s_mov_b64 exec,1
s_cmp_lg_u32 s49,0
s_cbranch_scc0 ls_330
buffer_store_dword v5,v1,s[8:11],s59 offen sc1
s_branch ls_331
ls_330:
buffer_store_dword v5,v1,s[8:11],s59 offen
ls_331:
s_mov_b64 exec,-1
s_mov_b32 s59,2147483648
v_mfma_f32_32x32x16_bf16 v[56:71],a[92:95],v[44:47],v[56:71]
ds_read_b128 v[40:43],v16 offset:24576
v_cmp_eq_u32 vcc,0,v3
s_and_b64 vcc,vcc,s[76:77]
s_cselect_b32 s37,2147483648,0
s_waitcnt lgkmcnt(5)
v_mfma_f32_32x32x16_bf16 v[56:71],a[128:131],v[48:51],v[56:71]
ds_read_b128 v[44:47],v17 offset:24576
s_cmp_lt_u32 s32,128
s_cselect_b32 s37,s37,2147483648
s_sub_u32 s66,46080,s57
s_mul_i32 s60,s33,8
v_mfma_f32_32x32x16_bf16 v[56:71],a[132:135],v[52:55],v[56:71]
ds_read_b128 v[48:51],v16 offset:34816
s_and_b32 s61,s34,7
s_add_u32 s60,s60,s61
s_mul_i32 s60,s60,46080
s_waitcnt lgkmcnt(5)
v_mfma_f32_32x32x16_bf16 v[56:71],a[16:19],v[24:27],v[56:71]
ds_read_b128 v[52:55],v17 offset:34816
s_add_u32 s60,s60,s37
s_add_u32 s60,s60,212467712
s_mov_b32 s67,s60
s_mul_i32 s61,s46,10240
s_barrier
v_mfma_f32_32x32x16_bf16 v[56:71],a[20:23],v[28:31],v[56:71]
ds_read_b128 v[24:27],v16 offset:6144
v_add_u32 v183,s57,v182
s_add_u32 s60,s60,s61
s_add_u32 s61,s61,s66
s_waitcnt lgkmcnt(5)
v_mfma_f32_32x32x16_bf16 v[56:71],a[56:59],v[32:35],v[56:71]
ds_read_b128 v[28:31],v17 offset:6144
v_add_u32 v8,0x800,v183
s_add_u32 m0,s61,0
s_add_u32 s63,s60,0
v_mfma_f32_32x32x16_bf16 v[56:71],a[60:63],v[36:39],v[56:71]
ds_read_b128 v[32:35],v16 offset:16384
ds_read2_b64 v[160:163],v183 offset0:0 offset1:32
s_waitcnt lgkmcnt(6)
v_mfma_f32_32x32x16_bf16 v[56:71],a[96:99],v[40:43],v[56:71]
ds_read_b128 v[36:39],v17 offset:16384
ds_read2_b64 v[164:167],v183 offset0:64 offset1:96
buffer_load_dwordx4 v1,s[8:11],s63 offen sc1 lds
v_mfma_f32_32x32x16_bf16 v[56:71],a[100:103],v[44:47],v[56:71]
ds_read_b128 v[40:43],v16 offset:26624
ds_read2_b64 v[168:171],v183 offset0:128 offset1:160
s_waitcnt lgkmcnt(8)
v_mfma_f32_32x32x16_bf16 v[56:71],a[136:139],v[48:51],v[56:71]
ds_read_b128 v[44:47],v17 offset:26624
ds_read2_b64 v[172:175],v183 offset0:192 offset1:224
buffer_load_dwordx4 v1,s[8:11],s63 offen offset:1024 sc1 lds
v_mfma_f32_32x32x16_bf16 v[56:71],a[140:143],v[52:55],v[56:71]
ds_read_b128 v[48:51],v16 offset:36864
ds_read2_b64 v[176:179],v8 offset0:0 offset1:32
s_waitcnt lgkmcnt(10)
v_mfma_f32_32x32x16_bf16 v[56:71],a[24:27],v[24:27],v[56:71]
ds_read_b128 v[52:55],v17 offset:36864
buffer_load_dwordx4 v1,s[8:11],s63 offen offset:2048 sc1 lds
v_mfma_f32_32x32x16_bf16 v[56:71],a[28:31],v[28:31],v[56:71]
ds_read_b128 v[24:27],v16 offset:8192
s_waitcnt lgkmcnt(9)
v_mfma_f32_32x32x16_bf16 v[56:71],a[64:67],v[32:35],v[56:71]
ds_read_b128 v[28:31],v17 offset:8192
buffer_load_dwordx4 v1,s[8:11],s63 offen offset:3072 sc1 lds
s_add_u32 m0,s61,4096
s_add_u32 s63,s60,4096
v_mfma_f32_32x32x16_bf16 v[56:71],a[68:71],v[36:39],v[56:71]
ds_read_b128 v[32:35],v16 offset:18432
s_waitcnt lgkmcnt(4)
v_add_f32 v160,v160,v170
v_add_f32 v161,v161,v171
v_mfma_f32_32x32x16_bf16 v[56:71],a[104:107],v[40:43],v[56:71]
ds_read_b128 v[36:39],v17 offset:18432
buffer_load_dwordx4 v1,s[8:11],s63 offen sc1 lds
v_add_f32 v162,v162,v172
v_add_f32 v163,v163,v173
v_mfma_f32_32x32x16_bf16 v[56:71],a[108:111],v[44:47],v[56:71]
ds_read_b128 v[40:43],v16 offset:28672
v_add_f32 v164,v164,v174
v_add_f32 v165,v165,v175
v_add_f32 v166,v166,v176
s_waitcnt lgkmcnt(5)
v_mfma_f32_32x32x16_bf16 v[56:71],a[144:147],v[48:51],v[56:71]
ds_read_b128 v[44:47],v17 offset:28672
buffer_load_dword v3,v2,s[8:11],s35 offen sc1
v_add_f32 v167,v167,v177
v_mfma_f32_32x32x16_bf16 v[56:71],a[148:151],v[52:55],v[56:71]
ds_read_b128 v[48:51],v16 offset:38912
buffer_load_dwordx4 v1,s[8:11],s63 offen offset:1024 sc1 lds
v_add_f32 v168,v168,v178
s_waitcnt lgkmcnt(5)
v_mfma_f32_32x32x16_bf16 v[56:71],a[32:35],v[24:27],v[56:71]
ds_read_b128 v[52:55],v17 offset:38912
v_add_f32 v169,v169,v179
v_add_f32 v160,v160,v162
v_add_f32 v161,v161,v163
v_add_f32 v164,v164,v166
v_mfma_f32_32x32x16_bf16 v[56:71],a[36:39],v[28:31],v[56:71]
buffer_load_dwordx4 v1,s[8:11],s63 offen offset:2048 sc1 lds
v_add_f32 v165,v165,v167
v_add_f32 v160,v160,v164
v_add_f32 v161,v161,v165
s_waitcnt lgkmcnt(4)
v_mfma_f32_32x32x16_bf16 v[56:71],a[72:75],v[32:35],v[56:71]
v_add_f32 v160,v160,v168
v_add_f32 v161,v161,v169
v_mov_b32 v162,v160
v_mov_b32 v163,v161
s_nop 0
v_permlane32_swap_b32 v160,v162
v_mfma_f32_32x32x16_bf16 v[56:71],a[76:79],v[36:39],v[56:71]
buffer_load_dwordx4 v1,s[8:11],s63 offen offset:3072 sc1 lds
s_add_u32 m0,s61,8192
s_add_u32 s63,s60,8192
v_permlane32_swap_b32 v161,v163
s_waitcnt lgkmcnt(2)
v_mfma_f32_32x32x16_bf16 v[56:71],a[112:115],v[40:43],v[56:71]
v_add_f32 v180,v160,v162
v_add_f32 v181,v161,v163
v_mul_f32 v180,0x3acccccd,v180
v_mul_f32 v181,0x3acccccd,v181
v_fma_f32 v181,-v180,v180,v181
v_mfma_f32_32x32x16_bf16 v[56:71],a[116:119],v[44:47],v[56:71]
buffer_load_dwordx4 v1,s[8:11],s63 offen sc1 lds
v_max_f32 v181,0,v181
v_cvt_pk_bf16_f32 v8,v180,v181
v_lshlrev_b32 v180,16,v8
s_waitcnt lgkmcnt(0)
v_mfma_f32_32x32x16_bf16 v[56:71],a[152:155],v[48:51],v[56:71]
v_and_b32 v181,0xffff0000,v8
v_add_f32 v181,0x3727c5ac,v181
v_cvt_pk_bf16_f32 v8,v181,v181
v_lshlrev_b32 v181,16,v8
v_sqrt_f32 v181,v181
v_mfma_f32_32x32x16_bf16 v[56:71],a[156:159],v[52:55],v[56:71]
buffer_load_dwordx4 v1,s[8:11],s63 offen offset:1024 sc1 lds
s_lshl_b32 s62,s46,10
s_add_u32 s62,s62,40960
s_add_u32 m0,s66,s62
s_add_u32 s63,s67,s62
buffer_load_dwordx4 v1,s[8:11],s63 offen sc1 lds
s_add_u32 m0,s66,45056
s_add_u32 s63,s67,45056
buffer_load_dwordx4 v1,s[8:11],s63 offen sc1 lds
v_cvt_pk_bf16_f32 v8,v181,v181
v_lshlrev_b32 v181,16,v8
v_rcp_f32 v181,v181
s_cmp_eq_u32 s37,0
s_cbranch_scc0 sec_334
s_mov_b32 s35,s42
s_mov_b32 s53,s33
s_mov_b32 s54,s34
s_add_u32 s32,s32,1
s_mov_b32 s33,s40
s_mov_b32 s34,s41
s_mov_b64 s[76:77],s[80:81]
s_nop 2
ep_332:
v_pk_fma_f32 v[56:57],v[144:145],v[180:181],v[56:57] op_sel_hi:[1,0,1] neg_lo:[0,1,0] neg_hi:[0,1,0]
v_pk_fma_f32 v[58:59],v[146:147],v[180:181],v[58:59] op_sel_hi:[1,0,1] neg_lo:[0,1,0] neg_hi:[0,1,0]
v_pk_fma_f32 v[60:61],v[148:149],v[180:181],v[60:61] op_sel_hi:[1,0,1] neg_lo:[0,1,0] neg_hi:[0,1,0]
v_pk_fma_f32 v[62:63],v[150:151],v[180:181],v[62:63] op_sel_hi:[1,0,1] neg_lo:[0,1,0] neg_hi:[0,1,0]
v_pk_fma_f32 v[64:65],v[152:153],v[180:181],v[64:65] op_sel_hi:[1,0,1] neg_lo:[0,1,0] neg_hi:[0,1,0]
v_pk_fma_f32 v[66:67],v[154:155],v[180:181],v[66:67] op_sel_hi:[1,0,1] neg_lo:[0,1,0] neg_hi:[0,1,0]
v_pk_fma_f32 v[68:69],v[156:157],v[180:181],v[68:69] op_sel_hi:[1,0,1] neg_lo:[0,1,0] neg_hi:[0,1,0]
v_pk_fma_f32 v[70:71],v[158:159],v[180:181],v[70:71] op_sel_hi:[1,0,1] neg_lo:[0,1,0] neg_hi:[0,1,0]
v_pk_mul_f32 v[56:57],v[56:57],v[180:181] op_sel:[0,1] op_sel_hi:[1,1]
v_pk_mul_f32 v[58:59],v[58:59],v[180:181] op_sel:[0,1] op_sel_hi:[1,1]
v_pk_mul_f32 v[60:61],v[60:61],v[180:181] op_sel:[0,1] op_sel_hi:[1,1]
v_pk_mul_f32 v[62:63],v[62:63],v[180:181] op_sel:[0,1] op_sel_hi:[1,1]
v_pk_mul_f32 v[64:65],v[64:65],v[180:181] op_sel:[0,1] op_sel_hi:[1,1]
v_pk_mul_f32 v[66:67],v[66:67],v[180:181] op_sel:[0,1] op_sel_hi:[1,1]
v_pk_mul_f32 v[68:69],v[68:69],v[180:181] op_sel:[0,1] op_sel_hi:[1,1]
v_pk_mul_f32 v[70:71],v[70:71],v[180:181] op_sel:[0,1] op_sel_hi:[1,1]
v_cvt_pk_bf16_f32 v140,v56,v57
v_lshlrev_b32 v56,16,v140
v_and_b32 v57,0xffff0000,v140
v_cvt_pk_bf16_f32 v140,v58,v59
v_lshlrev_b32 v58,16,v140
v_and_b32 v59,0xffff0000,v140
v_cvt_pk_bf16_f32 v140,v60,v61
v_lshlrev_b32 v60,16,v140
v_and_b32 v61,0xffff0000,v140
v_cvt_pk_bf16_f32 v140,v62,v63
v_lshlrev_b32 v62,16,v140
v_and_b32 v63,0xffff0000,v140
v_cvt_pk_bf16_f32 v140,v64,v65
v_lshlrev_b32 v64,16,v140
v_and_b32 v65,0xffff0000,v140
v_cvt_pk_bf16_f32 v140,v66,v67
v_lshlrev_b32 v66,16,v140
v_and_b32 v67,0xffff0000,v140
v_cvt_pk_bf16_f32 v140,v68,v69
v_lshlrev_b32 v68,16,v140
v_and_b32 v69,0xffff0000,v140
v_cvt_pk_bf16_f32 v140,v70,v71
v_lshlrev_b32 v70,16,v140
v_and_b32 v71,0xffff0000,v140
v_pk_mul_f32 v[124:125],v[56:57],v[56:57]
v_pk_mul_f32 v[126:127],v[58:59],v[58:59]
v_pk_mul_f32 v[128:129],v[60:61],v[60:61]
v_pk_mul_f32 v[130:131],v[62:63],v[62:63]
v_pk_mul_f32 v[132:133],v[64:65],v[64:65]
v_pk_mul_f32 v[134:135],v[66:67],v[66:67]
v_pk_mul_f32 v[136:137],v[68:69],v[68:69]
v_pk_mul_f32 v[138:139],v[70:71],v[70:71]
v_pk_fma_f32 v[124:125],v[124:125],v[112:113],v[112:113] op_sel:[0,1,0] op_sel_hi:[1,1,0]
v_pk_fma_f32 v[126:127],v[126:127],v[112:113],v[112:113] op_sel:[0,1,0] op_sel_hi:[1,1,0]
v_pk_fma_f32 v[128:129],v[128:129],v[112:113],v[112:113] op_sel:[0,1,0] op_sel_hi:[1,1,0]
v_pk_fma_f32 v[130:131],v[130:131],v[112:113],v[112:113] op_sel:[0,1,0] op_sel_hi:[1,1,0]
v_pk_fma_f32 v[132:133],v[132:133],v[112:113],v[112:113] op_sel:[0,1,0] op_sel_hi:[1,1,0]
v_pk_fma_f32 v[134:135],v[134:135],v[112:113],v[112:113] op_sel:[0,1,0] op_sel_hi:[1,1,0]
v_pk_fma_f32 v[136:137],v[136:137],v[112:113],v[112:113] op_sel:[0,1,0] op_sel_hi:[1,1,0]
v_pk_fma_f32 v[138:139],v[138:139],v[112:113],v[112:113] op_sel:[0,1,0] op_sel_hi:[1,1,0]
v_pk_mul_f32 v[124:125],v[124:125],v[56:57]
v_pk_mul_f32 v[126:127],v[126:127],v[58:59]
v_pk_mul_f32 v[128:129],v[128:129],v[60:61]
v_pk_mul_f32 v[130:131],v[130:131],v[62:63]
v_pk_mul_f32 v[132:133],v[132:133],v[64:65]
v_pk_mul_f32 v[134:135],v[134:135],v[66:67]
v_pk_mul_f32 v[136:137],v[136:137],v[68:69]
v_pk_mul_f32 v[138:139],v[138:139],v[70:71]
v_exp_f32 v124,v124
v_exp_f32 v125,v125
v_exp_f32 v126,v126
v_exp_f32 v127,v127
v_exp_f32 v128,v128
v_exp_f32 v129,v129
v_exp_f32 v130,v130
v_exp_f32 v131,v131
v_exp_f32 v132,v132
v_exp_f32 v133,v133
v_exp_f32 v134,v134
v_exp_f32 v135,v135
v_exp_f32 v136,v136
v_exp_f32 v137,v137
v_exp_f32 v138,v138
v_exp_f32 v139,v139
v_pk_add_f32 v[124:125],v[124:125],1.0 op_sel_hi:[1,0]
v_pk_add_f32 v[126:127],v[126:127],1.0 op_sel_hi:[1,0]
v_pk_add_f32 v[128:129],v[128:129],1.0 op_sel_hi:[1,0]
v_pk_add_f32 v[130:131],v[130:131],1.0 op_sel_hi:[1,0]
v_pk_add_f32 v[132:133],v[132:133],1.0 op_sel_hi:[1,0]
v_pk_add_f32 v[134:135],v[134:135],1.0 op_sel_hi:[1,0]
v_pk_add_f32 v[136:137],v[136:137],1.0 op_sel_hi:[1,0]
v_pk_add_f32 v[138:139],v[138:139],1.0 op_sel_hi:[1,0]
v_rcp_f32 v124,v124
v_rcp_f32 v125,v125
v_rcp_f32 v126,v126
v_rcp_f32 v127,v127
v_rcp_f32 v128,v128
v_rcp_f32 v129,v129
v_rcp_f32 v130,v130
v_rcp_f32 v131,v131
v_rcp_f32 v132,v132
v_rcp_f32 v133,v133
v_rcp_f32 v134,v134
v_rcp_f32 v135,v135
v_rcp_f32 v136,v136
v_rcp_f32 v137,v137
v_rcp_f32 v138,v138
v_rcp_f32 v139,v139
v_pk_mul_f32 v[56:57],v[56:57],v[124:125]
v_pk_mul_f32 v[58:59],v[58:59],v[126:127]
v_pk_mul_f32 v[60:61],v[60:61],v[128:129]
v_pk_mul_f32 v[62:63],v[62:63],v[130:131]
v_pk_mul_f32 v[64:65],v[64:65],v[132:133]
v_pk_mul_f32 v[66:67],v[66:67],v[134:135]
v_pk_mul_f32 v[68:69],v[68:69],v[136:137]
v_pk_mul_f32 v[70:71],v[70:71],v[138:139]
v_cvt_pk_bf16_f32 v116,v56,v57
v_cvt_pk_bf16_f32 v117,v58,v59
v_cvt_pk_bf16_f32 v118,v60,v61
v_cvt_pk_bf16_f32 v119,v62,v63
v_cvt_pk_bf16_f32 v120,v64,v65
v_cvt_pk_bf16_f32 v121,v66,v67
v_cvt_pk_bf16_f32 v122,v68,v69
v_cvt_pk_bf16_f32 v123,v70,v71
s_cmp_lg_u32 s49,0
s_cbranch_scc0 ls_335
buffer_store_dwordx4 v[116:119],v20,s[8:11],s71 offen sc1
buffer_store_dwordx4 v[120:123],v21,s[8:11],s71 offen sc1
s_branch ls_336
ls_335:
buffer_store_dwordx4 v[116:119],v20,s[8:11],s71 offen
buffer_store_dwordx4 v[120:123],v21,s[8:11],s71 offen
ls_336:
s_mov_b32 s59,s82
s_cmp_eq_u32 s37,0
s_cbranch_scc1 W3_NEXT
s_waitcnt vmcnt(2)
v_cmp_eq_u32 vcc,0,v3
s_and_b64 vcc,vcc,s[76:77]
s_cselect_b32 s37,2147483648,0
s_cmp_lt_u32 s32,128
s_cselect_b32 s37,s37,2147483648
s_cmp_eq_u32 s37,0
s_cbranch_scc1 W3_COLD2
s_waitcnt vmcnt(0)
s_mov_b64 exec,1
s_cmp_lg_u32 s49,0
s_cbranch_scc0 ls_337
buffer_store_dword v5,v1,s[8:11],s59 offen sc1
s_branch ls_338
ls_337:
buffer_store_dword v5,v1,s[8:11],s59 offen
ls_338:
s_mov_b64 exec,-1
s_mov_b32 s59,2147483648
s_cmp_lt_u32 s32,128
s_cbranch_scc1 W3_COLD
s_branch W3_END
sec_334:
s_waitcnt vmcnt(7)
v_cmp_eq_u32 vcc,0,v3
s_and_b64 vcc,vcc,s[76:77]
s_cselect_b32 s37,2147483648,0
s_cmp_lt_u32 s32,128
s_cselect_b32 s37,s37,2147483648
s_cmp_lg_u32 s37,0
s_cbranch_scc1 nr_333
s_sub_u32 s66,46080,s57
s_mul_i32 s60,s33,8
s_and_b32 s61,s34,7
s_add_u32 s60,s60,s61
s_mul_i32 s60,s60,46080
s_add_u32 s60,s60,s37
s_add_u32 s60,s60,212467712
s_mov_b32 s67,s60
s_mul_i32 s61,s46,10240
s_add_u32 s60,s60,s61
s_add_u32 s61,s61,s66
s_add_u32 m0,s61,0
s_add_u32 s63,s60,0
buffer_load_dwordx4 v1,s[8:11],s63 offen sc1 lds
v_pk_fma_f32 v[56:57],v[144:145],v[180:181],v[56:57] op_sel_hi:[1,0,1] neg_lo:[0,1,0] neg_hi:[0,1,0]
v_pk_fma_f32 v[58:59],v[146:147],v[180:181],v[58:59] op_sel_hi:[1,0,1] neg_lo:[0,1,0] neg_hi:[0,1,0]
v_pk_fma_f32 v[60:61],v[148:149],v[180:181],v[60:61] op_sel_hi:[1,0,1] neg_lo:[0,1,0] neg_hi:[0,1,0]
v_pk_fma_f32 v[62:63],v[150:151],v[180:181],v[62:63] op_sel_hi:[1,0,1] neg_lo:[0,1,0] neg_hi:[0,1,0]
v_pk_fma_f32 v[64:65],v[152:153],v[180:181],v[64:65] op_sel_hi:[1,0,1] neg_lo:[0,1,0] neg_hi:[0,1,0]
v_pk_fma_f32 v[66:67],v[154:155],v[180:181],v[66:67] op_sel_hi:[1,0,1] neg_lo:[0,1,0] neg_hi:[0,1,0]
v_pk_fma_f32 v[68:69],v[156:157],v[180:181],v[68:69] op_sel_hi:[1,0,1] neg_lo:[0,1,0] neg_hi:[0,1,0]
v_pk_fma_f32 v[70:71],v[158:159],v[180:181],v[70:71] op_sel_hi:[1,0,1] neg_lo:[0,1,0] neg_hi:[0,1,0]
buffer_load_dwordx4 v1,s[8:11],s63 offen offset:1024 sc1 lds
v_pk_mul_f32 v[56:57],v[56:57],v[180:181] op_sel:[0,1] op_sel_hi:[1,1]
v_pk_mul_f32 v[58:59],v[58:59],v[180:181] op_sel:[0,1] op_sel_hi:[1,1]
v_pk_mul_f32 v[60:61],v[60:61],v[180:181] op_sel:[0,1] op_sel_hi:[1,1]
v_pk_mul_f32 v[62:63],v[62:63],v[180:181] op_sel:[0,1] op_sel_hi:[1,1]
v_pk_mul_f32 v[64:65],v[64:65],v[180:181] op_sel:[0,1] op_sel_hi:[1,1]
v_pk_mul_f32 v[66:67],v[66:67],v[180:181] op_sel:[0,1] op_sel_hi:[1,1]
v_pk_mul_f32 v[68:69],v[68:69],v[180:181] op_sel:[0,1] op_sel_hi:[1,1]
v_pk_mul_f32 v[70:71],v[70:71],v[180:181] op_sel:[0,1] op_sel_hi:[1,1]
buffer_load_dwordx4 v1,s[8:11],s63 offen offset:2048 sc1 lds
v_cvt_pk_bf16_f32 v140,v56,v57
v_lshlrev_b32 v56,16,v140
v_and_b32 v57,0xffff0000,v140
v_cvt_pk_bf16_f32 v140,v58,v59
v_lshlrev_b32 v58,16,v140
v_and_b32 v59,0xffff0000,v140
v_cvt_pk_bf16_f32 v140,v60,v61
v_lshlrev_b32 v60,16,v140
buffer_load_dwordx4 v1,s[8:11],s63 offen offset:3072 sc1 lds
v_and_b32 v61,0xffff0000,v140
v_cvt_pk_bf16_f32 v140,v62,v63
v_lshlrev_b32 v62,16,v140
v_and_b32 v63,0xffff0000,v140
v_cvt_pk_bf16_f32 v140,v64,v65
v_lshlrev_b32 v64,16,v140
v_and_b32 v65,0xffff0000,v140
v_cvt_pk_bf16_f32 v140,v66,v67
s_add_u32 m0,s61,4096
s_add_u32 s63,s60,4096
buffer_load_dwordx4 v1,s[8:11],s63 offen sc1 lds
v_lshlrev_b32 v66,16,v140
v_and_b32 v67,0xffff0000,v140
v_cvt_pk_bf16_f32 v140,v68,v69
v_lshlrev_b32 v68,16,v140
v_and_b32 v69,0xffff0000,v140
v_cvt_pk_bf16_f32 v140,v70,v71
v_lshlrev_b32 v70,16,v140
v_and_b32 v71,0xffff0000,v140
buffer_load_dwordx4 v1,s[8:11],s63 offen offset:1024 sc1 lds
v_pk_mul_f32 v[124:125],v[56:57],v[56:57]
v_pk_mul_f32 v[126:127],v[58:59],v[58:59]
v_pk_mul_f32 v[128:129],v[60:61],v[60:61]
v_pk_mul_f32 v[130:131],v[62:63],v[62:63]
v_pk_mul_f32 v[132:133],v[64:65],v[64:65]
v_pk_mul_f32 v[134:135],v[66:67],v[66:67]
v_pk_mul_f32 v[136:137],v[68:69],v[68:69]
v_pk_mul_f32 v[138:139],v[70:71],v[70:71]
buffer_load_dwordx4 v1,s[8:11],s63 offen offset:2048 sc1 lds
v_pk_fma_f32 v[124:125],v[124:125],v[112:113],v[112:113] op_sel:[0,1,0] op_sel_hi:[1,1,0]
v_pk_fma_f32 v[126:127],v[126:127],v[112:113],v[112:113] op_sel:[0,1,0] op_sel_hi:[1,1,0]
v_pk_fma_f32 v[128:129],v[128:129],v[112:113],v[112:113] op_sel:[0,1,0] op_sel_hi:[1,1,0]
v_pk_fma_f32 v[130:131],v[130:131],v[112:113],v[112:113] op_sel:[0,1,0] op_sel_hi:[1,1,0]
v_pk_fma_f32 v[132:133],v[132:133],v[112:113],v[112:113] op_sel:[0,1,0] op_sel_hi:[1,1,0]
v_pk_fma_f32 v[134:135],v[134:135],v[112:113],v[112:113] op_sel:[0,1,0] op_sel_hi:[1,1,0]
v_pk_fma_f32 v[136:137],v[136:137],v[112:113],v[112:113] op_sel:[0,1,0] op_sel_hi:[1,1,0]
v_pk_fma_f32 v[138:139],v[138:139],v[112:113],v[112:113] op_sel:[0,1,0] op_sel_hi:[1,1,0]
buffer_load_dwordx4 v1,s[8:11],s63 offen offset:3072 sc1 lds
v_pk_mul_f32 v[124:125],v[124:125],v[56:57]
v_pk_mul_f32 v[126:127],v[126:127],v[58:59]
v_pk_mul_f32 v[128:129],v[128:129],v[60:61]
v_pk_mul_f32 v[130:131],v[130:131],v[62:63]
v_pk_mul_f32 v[132:133],v[132:133],v[64:65]
v_pk_mul_f32 v[134:135],v[134:135],v[66:67]
v_pk_mul_f32 v[136:137],v[136:137],v[68:69]
v_pk_mul_f32 v[138:139],v[138:139],v[70:71]
s_add_u32 m0,s61,8192
s_add_u32 s63,s60,8192
buffer_load_dwordx4 v1,s[8:11],s63 offen sc1 lds
v_exp_f32 v124,v124
v_exp_f32 v125,v125
v_exp_f32 v126,v126
v_exp_f32 v127,v127
v_exp_f32 v128,v128
v_exp_f32 v129,v129
v_exp_f32 v130,v130
v_exp_f32 v131,v131
buffer_load_dwordx4 v1,s[8:11],s63 offen offset:1024 sc1 lds
v_exp_f32 v132,v132
v_exp_f32 v133,v133
v_exp_f32 v134,v134
v_exp_f32 v135,v135
v_exp_f32 v136,v136
v_exp_f32 v137,v137
v_exp_f32 v138,v138
v_exp_f32 v139,v139
s_lshl_b32 s62,s46,10
s_add_u32 s62,s62,40960
s_add_u32 m0,s66,s62
s_add_u32 s63,s67,s62
buffer_load_dwordx4 v1,s[8:11],s63 offen sc1 lds
v_pk_add_f32 v[124:125],v[124:125],1.0 op_sel_hi:[1,0]
v_pk_add_f32 v[126:127],v[126:127],1.0 op_sel_hi:[1,0]
v_pk_add_f32 v[128:129],v[128:129],1.0 op_sel_hi:[1,0]
v_pk_add_f32 v[130:131],v[130:131],1.0 op_sel_hi:[1,0]
v_pk_add_f32 v[132:133],v[132:133],1.0 op_sel_hi:[1,0]
v_pk_add_f32 v[134:135],v[134:135],1.0 op_sel_hi:[1,0]
v_pk_add_f32 v[136:137],v[136:137],1.0 op_sel_hi:[1,0]
v_pk_add_f32 v[138:139],v[138:139],1.0 op_sel_hi:[1,0]
s_add_u32 m0,s66,45056
s_add_u32 s63,s67,45056
buffer_load_dwordx4 v1,s[8:11],s63 offen sc1 lds
v_rcp_f32 v124,v124
v_rcp_f32 v125,v125
v_rcp_f32 v126,v126
v_rcp_f32 v127,v127
v_rcp_f32 v128,v128
v_rcp_f32 v129,v129
v_rcp_f32 v130,v130
v_rcp_f32 v131,v131
s_mov_b32 s35,s42
s_mov_b32 s53,s33
s_mov_b32 s54,s34
s_add_u32 s32,s32,1
s_mov_b32 s33,s40
s_mov_b32 s34,s41
s_mov_b64 s[76:77],s[80:81]
v_rcp_f32 v132,v132
v_rcp_f32 v133,v133
v_rcp_f32 v134,v134
v_rcp_f32 v135,v135
v_rcp_f32 v136,v136
v_rcp_f32 v137,v137
v_rcp_f32 v138,v138
v_rcp_f32 v139,v139
v_pk_mul_f32 v[56:57],v[56:57],v[124:125]
v_pk_mul_f32 v[58:59],v[58:59],v[126:127]
v_pk_mul_f32 v[60:61],v[60:61],v[128:129]
v_pk_mul_f32 v[62:63],v[62:63],v[130:131]
v_pk_mul_f32 v[64:65],v[64:65],v[132:133]
v_pk_mul_f32 v[66:67],v[66:67],v[134:135]
v_pk_mul_f32 v[68:69],v[68:69],v[136:137]
v_pk_mul_f32 v[70:71],v[70:71],v[138:139]
v_cvt_pk_bf16_f32 v116,v56,v57
v_cvt_pk_bf16_f32 v117,v58,v59
v_cvt_pk_bf16_f32 v118,v60,v61
v_cvt_pk_bf16_f32 v119,v62,v63
v_cvt_pk_bf16_f32 v120,v64,v65
v_cvt_pk_bf16_f32 v121,v66,v67
v_cvt_pk_bf16_f32 v122,v68,v69
v_cvt_pk_bf16_f32 v123,v70,v71
s_cmp_lg_u32 s49,0
s_cbranch_scc0 ls_339
buffer_store_dwordx4 v[116:119],v20,s[8:11],s71 offen sc1
buffer_store_dwordx4 v[120:123],v21,s[8:11],s71 offen sc1
s_branch ls_340
ls_339:
buffer_store_dwordx4 v[116:119],v20,s[8:11],s71 offen
buffer_store_dwordx4 v[120:123],v21,s[8:11],s71 offen
ls_340:
s_mov_b32 s59,s82
s_branch W3_NEXT
nr_333:
buffer_load_dword v3,v2,s[8:11],s35 offen sc1
s_branch ep_332
W3_END:
s_endpgm
ROLE_W4:
v_lshlrev_b32 v1,4,v0
v_mov_b32 v5,1
s_lshl_b32 s56,s48,2
s_add_u32 s56,s56,s46
v_bfe_u32 v6,v0,2,2
v_lshrrev_b32 v7,4,v0
v_add_u32 v7,v6,v7
v_and_b32 v7,3,v7
v_and_b32 v15,3,v0
v_lshlrev_b32 v15,4,v15
v_lshl_add_u32 v15,v7,6,v15
v_lshl_add_u32 v15,v6,8,v15
v_lshrrev_b32 v6,5,v0
v_bfe_u32 v7,v0,4,1
v_lshlrev_b32 v208,10,v7
v_lshl_add_u32 v208,v6,8,v208
v_and_b32 v6,15,v0
v_lshl_add_u32 v208,v6,4,v208
v_lshrrev_b32 v6,5,v0
v_add_u32 v6,2,v6
v_bfe_u32 v7,v0,4,1
v_lshlrev_b32 v209,10,v7
v_lshl_add_u32 v209,v6,8,v209
v_and_b32 v6,15,v0
v_lshl_add_u32 v209,v6,4,v209
v_min_u32 v2,11,v0
s_mul_i32 s60,s46,12
v_add_u32 v2,s60,v2
v_lshlrev_b32 v2,2,v2
s_and_b32 s60,s46,1
s_lshl_b32 s68,s48,1
s_add_u32 s68,s68,s60
s_lshr_b32 s69,s46,1
s_mul_i32 s71,s46,24576
s_mul_i32 s58,s46,491520
s_lshl_b32 s61,s48,7
s_add_u32 s58,s58,s61
s_add_u32 s71,s71,242778112
v_and_b32 v6,15,v0
v_lshlrev_b32 v204,3,v6
s_lshl_b32 s60,s69,4
v_add_u32 v6,s60,v6
v_mul_u32_u24 v205,1280,v6
v_lshrrev_b32 v6,4,v0
v_lshl_add_u32 v205,v6,3,v205
s_lshl_b32 s60,s68,6
v_add_u32 v205,s60,v205
s_mov_b32 s76,s40
s_mov_b32 s77,s41
s_mov_b32 s78,2621440
s_mov_b32 s79,0x20000
s_lshl_b32 s70,s68,1
s_add_u32 s70,s70,s69
s_lshl_b32 s70,s70,10
v_bfe_u32 v6,v0,4,1
v_lshlrev_b32 v206,14,v6
v_lshrrev_b32 v6,5,v0
v_lshl_add_u32 v206,v6,8,v206
v_and_b32 v6,15,v0
v_lshl_add_u32 v206,v6,4,v206
s_lshl_b32 s60,s46,11
v_add_u32 v206,s60,v206
s_lshl_b32 s60,s46,13
v_add_u32 v207,s60,v1
s_waitcnt vmcnt(0)
s_barrier
s_cmp_lg_u32 s46,0
s_cbranch_scc1 arr_341
v_mov_b32 v6,1
s_lshl_b32 s3,s49,2
v_mov_b32 v7,s3
s_mov_b64 exec,1
buffer_atomic_add v6,v7,s[12:15],0 offen sc1
s_mov_b64 exec,-1
arr_341:
s_mul_i32 s63,s46,40960
s_mov_b32 s4,s38
s_mov_b32 s5,s39
s_mov_b32 s6,1966080
s_mov_b32 s7,0x20000
v_lshrrev_b32 v9,3,v0
s_mov_b32 s64,1280
v_mul_lo_u32 v9,v9,s64
v_and_b32 v10,7,v0
v_lshl_add_u32 v6,v10,4,v9
s_add_u32 m0,s63,0
s_add_u32 s65,s58,0
buffer_load_dwordx4 v6,s[4:7],s65 offen lds
s_add_u32 m0,s63,1024
s_add_u32 s65,s58,10240
buffer_load_dwordx4 v6,s[4:7],s65 offen lds
s_add_u32 m0,s63,2048
s_add_u32 s65,s58,20480
buffer_load_dwordx4 v6,s[4:7],s65 offen lds
s_add_u32 m0,s63,3072
s_add_u32 s65,s58,30720
buffer_load_dwordx4 v6,s[4:7],s65 offen lds
s_add_u32 m0,s63,4096
s_add_u32 s65,s58,40960
buffer_load_dwordx4 v6,s[4:7],s65 offen lds
s_add_u32 m0,s63,5120
s_add_u32 s65,s58,51200
buffer_load_dwordx4 v6,s[4:7],s65 offen lds
s_add_u32 m0,s63,6144
s_add_u32 s65,s58,61440
buffer_load_dwordx4 v6,s[4:7],s65 offen lds
s_add_u32 m0,s63,7168
s_add_u32 s65,s58,71680
buffer_load_dwordx4 v6,s[4:7],s65 offen lds
s_add_u32 m0,s63,8192
s_add_u32 s65,s58,81920
buffer_load_dwordx4 v6,s[4:7],s65 offen lds
s_add_u32 m0,s63,9216
s_add_u32 s65,s58,92160
buffer_load_dwordx4 v6,s[4:7],s65 offen lds
s_add_u32 m0,s63,10240
s_add_u32 s65,s58,102400
buffer_load_dwordx4 v6,s[4:7],s65 offen lds
s_add_u32 m0,s63,11264
s_add_u32 s65,s58,112640
buffer_load_dwordx4 v6,s[4:7],s65 offen lds
s_add_u32 m0,s63,12288
s_add_u32 s65,s58,122880
buffer_load_dwordx4 v6,s[4:7],s65 offen lds
s_add_u32 m0,s63,13312
s_add_u32 s65,s58,133120
buffer_load_dwordx4 v6,s[4:7],s65 offen lds
s_add_u32 m0,s63,14336
s_add_u32 s65,s58,143360
buffer_load_dwordx4 v6,s[4:7],s65 offen lds
s_add_u32 m0,s63,15360
s_add_u32 s65,s58,153600
buffer_load_dwordx4 v6,s[4:7],s65 offen lds
s_add_u32 m0,s63,16384
s_add_u32 s65,s58,163840
buffer_load_dwordx4 v6,s[4:7],s65 offen lds
s_add_u32 m0,s63,17408
s_add_u32 s65,s58,174080
buffer_load_dwordx4 v6,s[4:7],s65 offen lds
s_add_u32 m0,s63,18432
s_add_u32 s65,s58,184320
buffer_load_dwordx4 v6,s[4:7],s65 offen lds
s_add_u32 m0,s63,19456
s_add_u32 s65,s58,194560
buffer_load_dwordx4 v6,s[4:7],s65 offen lds
s_add_u32 m0,s63,20480
s_add_u32 s65,s58,204800
buffer_load_dwordx4 v6,s[4:7],s65 offen lds
s_add_u32 m0,s63,21504
s_add_u32 s65,s58,215040
buffer_load_dwordx4 v6,s[4:7],s65 offen lds
s_add_u32 m0,s63,22528
s_add_u32 s65,s58,225280
buffer_load_dwordx4 v6,s[4:7],s65 offen lds
s_add_u32 m0,s63,23552
s_add_u32 s65,s58,235520
buffer_load_dwordx4 v6,s[4:7],s65 offen lds
s_add_u32 m0,s63,24576
s_add_u32 s65,s58,245760
buffer_load_dwordx4 v6,s[4:7],s65 offen lds
s_add_u32 m0,s63,25600
s_add_u32 s65,s58,256000
buffer_load_dwordx4 v6,s[4:7],s65 offen lds
s_add_u32 m0,s63,26624
s_add_u32 s65,s58,266240
buffer_load_dwordx4 v6,s[4:7],s65 offen lds
s_add_u32 m0,s63,27648
s_add_u32 s65,s58,276480
buffer_load_dwordx4 v6,s[4:7],s65 offen lds
s_add_u32 m0,s63,28672
s_add_u32 s65,s58,286720
buffer_load_dwordx4 v6,s[4:7],s65 offen lds
s_add_u32 m0,s63,29696
s_add_u32 s65,s58,296960
buffer_load_dwordx4 v6,s[4:7],s65 offen lds
s_add_u32 m0,s63,30720
s_add_u32 s65,s58,307200
buffer_load_dwordx4 v6,s[4:7],s65 offen lds
s_add_u32 m0,s63,31744
s_add_u32 s65,s58,317440
buffer_load_dwordx4 v6,s[4:7],s65 offen lds
s_add_u32 m0,s63,32768
s_add_u32 s65,s58,327680
buffer_load_dwordx4 v6,s[4:7],s65 offen lds
s_add_u32 m0,s63,33792
s_add_u32 s65,s58,337920
buffer_load_dwordx4 v6,s[4:7],s65 offen lds
s_add_u32 m0,s63,34816
s_add_u32 s65,s58,348160
buffer_load_dwordx4 v6,s[4:7],s65 offen lds
s_add_u32 m0,s63,35840
s_add_u32 s65,s58,358400
buffer_load_dwordx4 v6,s[4:7],s65 offen lds
s_add_u32 m0,s63,36864
s_add_u32 s65,s58,368640
buffer_load_dwordx4 v6,s[4:7],s65 offen lds
s_add_u32 m0,s63,37888
s_add_u32 s65,s58,378880
buffer_load_dwordx4 v6,s[4:7],s65 offen lds
s_add_u32 m0,s63,38912
s_add_u32 s65,s58,389120
buffer_load_dwordx4 v6,s[4:7],s65 offen lds
s_add_u32 m0,s63,39936
s_add_u32 s65,s58,399360
buffer_load_dwordx4 v6,s[4:7],s65 offen lds
s_waitcnt vmcnt(20)
v_bfe_u32 v9,v0,2,2
v_lshrrev_b32 v10,5,v0
v_lshl_add_u32 v9,v10,2,v9
v_mul_u32_u24 v9,128,v9
v_and_b32 v10,1,v0
v_lshl_add_u32 v9,v10,3,v9
v_bfe_u32 v10,v0,1,1
v_lshl_add_u32 v9,v10,5,v9
v_bfe_u32 v10,v0,4,1
v_lshl_add_u32 v9,v10,4,v9
v_add_u32 v7,s63,v9
ds_read_b64_tr_b16 a[0:1],v7 offset:0
ds_read_b64_tr_b16 a[2:3],v7 offset:2048
ds_read_b64_tr_b16 a[4:5],v7 offset:1024
ds_read_b64_tr_b16 a[6:7],v7 offset:3072
ds_read_b64_tr_b16 a[96:97],v7 offset:64
ds_read_b64_tr_b16 a[98:99],v7 offset:2112
ds_read_b64_tr_b16 a[100:101],v7 offset:1088
ds_read_b64_tr_b16 a[102:103],v7 offset:3136
ds_read_b64_tr_b16 a[8:9],v7 offset:4096
ds_read_b64_tr_b16 a[10:11],v7 offset:6144
ds_read_b64_tr_b16 a[12:13],v7 offset:5120
ds_read_b64_tr_b16 a[14:15],v7 offset:7168
s_waitcnt lgkmcnt(4)
ds_read_b64_tr_b16 a[104:105],v7 offset:4160
ds_read_b64_tr_b16 a[106:107],v7 offset:6208
ds_read_b64_tr_b16 a[108:109],v7 offset:5184
ds_read_b64_tr_b16 a[110:111],v7 offset:7232
ds_read_b64_tr_b16 a[16:17],v7 offset:8192
ds_read_b64_tr_b16 a[18:19],v7 offset:10240
ds_read_b64_tr_b16 a[20:21],v7 offset:9216
ds_read_b64_tr_b16 a[22:23],v7 offset:11264
ds_read_b64_tr_b16 a[112:113],v7 offset:8256
ds_read_b64_tr_b16 a[114:115],v7 offset:10304
ds_read_b64_tr_b16 a[116:117],v7 offset:9280
ds_read_b64_tr_b16 a[118:119],v7 offset:11328
s_waitcnt lgkmcnt(4)
ds_read_b64_tr_b16 a[24:25],v7 offset:12288
ds_read_b64_tr_b16 a[26:27],v7 offset:14336
ds_read_b64_tr_b16 a[28:29],v7 offset:13312
ds_read_b64_tr_b16 a[30:31],v7 offset:15360
ds_read_b64_tr_b16 a[120:121],v7 offset:12352
ds_read_b64_tr_b16 a[122:123],v7 offset:14400
ds_read_b64_tr_b16 a[124:125],v7 offset:13376
ds_read_b64_tr_b16 a[126:127],v7 offset:15424
ds_read_b64_tr_b16 a[32:33],v7 offset:16384
ds_read_b64_tr_b16 a[34:35],v7 offset:18432
ds_read_b64_tr_b16 a[36:37],v7 offset:17408
ds_read_b64_tr_b16 a[38:39],v7 offset:19456
s_waitcnt lgkmcnt(4)
ds_read_b64_tr_b16 a[128:129],v7 offset:16448
ds_read_b64_tr_b16 a[130:131],v7 offset:18496
ds_read_b64_tr_b16 a[132:133],v7 offset:17472
ds_read_b64_tr_b16 a[134:135],v7 offset:19520
s_waitcnt lgkmcnt(0)
s_add_u32 m0,s63,0
s_add_u32 s65,s58,409600
buffer_load_dwordx4 v6,s[4:7],s65 offen lds
s_add_u32 m0,s63,1024
s_add_u32 s65,s58,419840
buffer_load_dwordx4 v6,s[4:7],s65 offen lds
s_add_u32 m0,s63,2048
s_add_u32 s65,s58,430080
buffer_load_dwordx4 v6,s[4:7],s65 offen lds
s_add_u32 m0,s63,3072
s_add_u32 s65,s58,440320
buffer_load_dwordx4 v6,s[4:7],s65 offen lds
s_add_u32 m0,s63,4096
s_add_u32 s65,s58,450560
buffer_load_dwordx4 v6,s[4:7],s65 offen lds
s_add_u32 m0,s63,5120
s_add_u32 s65,s58,460800
buffer_load_dwordx4 v6,s[4:7],s65 offen lds
s_add_u32 m0,s63,6144
s_add_u32 s65,s58,471040
buffer_load_dwordx4 v6,s[4:7],s65 offen lds
s_add_u32 m0,s63,7168
s_add_u32 s65,s58,481280
buffer_load_dwordx4 v6,s[4:7],s65 offen lds
s_waitcnt vmcnt(8)
v_bfe_u32 v9,v0,2,2
v_lshrrev_b32 v10,5,v0
v_lshl_add_u32 v9,v10,2,v9
v_mul_u32_u24 v9,128,v9
v_and_b32 v10,1,v0
v_lshl_add_u32 v9,v10,3,v9
v_bfe_u32 v10,v0,1,1
v_lshl_add_u32 v9,v10,5,v9
v_bfe_u32 v10,v0,4,1
v_lshl_add_u32 v9,v10,4,v9
v_add_u32 v7,s63,v9
ds_read_b64_tr_b16 a[40:41],v7 offset:20480
ds_read_b64_tr_b16 a[42:43],v7 offset:22528
ds_read_b64_tr_b16 a[44:45],v7 offset:21504
ds_read_b64_tr_b16 a[46:47],v7 offset:23552
ds_read_b64_tr_b16 a[136:137],v7 offset:20544
ds_read_b64_tr_b16 a[138:139],v7 offset:22592
ds_read_b64_tr_b16 a[140:141],v7 offset:21568
ds_read_b64_tr_b16 a[142:143],v7 offset:23616
ds_read_b64_tr_b16 a[48:49],v7 offset:24576
ds_read_b64_tr_b16 a[50:51],v7 offset:26624
ds_read_b64_tr_b16 a[52:53],v7 offset:25600
ds_read_b64_tr_b16 a[54:55],v7 offset:27648
s_waitcnt lgkmcnt(4)
ds_read_b64_tr_b16 a[144:145],v7 offset:24640
ds_read_b64_tr_b16 a[146:147],v7 offset:26688
ds_read_b64_tr_b16 a[148:149],v7 offset:25664
ds_read_b64_tr_b16 a[150:151],v7 offset:27712
ds_read_b64_tr_b16 a[56:57],v7 offset:28672
ds_read_b64_tr_b16 a[58:59],v7 offset:30720
ds_read_b64_tr_b16 a[60:61],v7 offset:29696
ds_read_b64_tr_b16 a[62:63],v7 offset:31744
ds_read_b64_tr_b16 a[152:153],v7 offset:28736
ds_read_b64_tr_b16 a[154:155],v7 offset:30784
ds_read_b64_tr_b16 a[156:157],v7 offset:29760
ds_read_b64_tr_b16 a[158:159],v7 offset:31808
s_waitcnt lgkmcnt(4)
ds_read_b64_tr_b16 a[64:65],v7 offset:32768
ds_read_b64_tr_b16 a[66:67],v7 offset:34816
ds_read_b64_tr_b16 a[68:69],v7 offset:33792
ds_read_b64_tr_b16 a[70:71],v7 offset:35840
ds_read_b64_tr_b16 a[160:161],v7 offset:32832
ds_read_b64_tr_b16 a[162:163],v7 offset:34880
ds_read_b64_tr_b16 a[164:165],v7 offset:33856
ds_read_b64_tr_b16 a[166:167],v7 offset:35904
ds_read_b64_tr_b16 a[72:73],v7 offset:36864
ds_read_b64_tr_b16 a[74:75],v7 offset:38912
ds_read_b64_tr_b16 a[76:77],v7 offset:37888
ds_read_b64_tr_b16 a[78:79],v7 offset:39936
s_waitcnt lgkmcnt(4)
ds_read_b64_tr_b16 a[168:169],v7 offset:36928
ds_read_b64_tr_b16 a[170:171],v7 offset:38976
ds_read_b64_tr_b16 a[172:173],v7 offset:37952
ds_read_b64_tr_b16 a[174:175],v7 offset:40000
s_waitcnt lgkmcnt(0)
s_waitcnt vmcnt(0)
v_bfe_u32 v9,v0,2,2
v_lshrrev_b32 v10,5,v0
v_lshl_add_u32 v9,v10,2,v9
v_mul_u32_u24 v9,128,v9
v_and_b32 v10,1,v0
v_lshl_add_u32 v9,v10,3,v9
v_bfe_u32 v10,v0,1,1
v_lshl_add_u32 v9,v10,5,v9
v_bfe_u32 v10,v0,4,1
v_lshl_add_u32 v9,v10,4,v9
v_add_u32 v7,s63,v9
ds_read_b64_tr_b16 a[80:81],v7 offset:0
ds_read_b64_tr_b16 a[82:83],v7 offset:2048
ds_read_b64_tr_b16 a[84:85],v7 offset:1024
ds_read_b64_tr_b16 a[86:87],v7 offset:3072
ds_read_b64_tr_b16 a[176:177],v7 offset:64
ds_read_b64_tr_b16 a[178:179],v7 offset:2112
ds_read_b64_tr_b16 a[180:181],v7 offset:1088
ds_read_b64_tr_b16 a[182:183],v7 offset:3136
ds_read_b64_tr_b16 a[88:89],v7 offset:4096
ds_read_b64_tr_b16 a[90:91],v7 offset:6144
ds_read_b64_tr_b16 a[92:93],v7 offset:5120
ds_read_b64_tr_b16 a[94:95],v7 offset:7168
s_waitcnt lgkmcnt(4)
ds_read_b64_tr_b16 a[184:185],v7 offset:4160
ds_read_b64_tr_b16 a[186:187],v7 offset:6208
ds_read_b64_tr_b16 a[188:189],v7 offset:5184
ds_read_b64_tr_b16 a[190:191],v7 offset:7232
s_waitcnt lgkmcnt(0)
s_barrier
s_lshl_b32 s3,s49,2
v_mov_b32 v7,s3
s_nop 1
ibw_342:
buffer_load_dword v6,v7,s[12:15],0 offen sc1
s_waitcnt vmcnt(0)
v_cmp_ne_u32 vcc,256,v6
s_nop 0
s_cbranch_vccz ok_343
s_sleep 8
s_sub_u32 s47,s47,1
s_cbranch_scc1 ABORT
s_branch ibw_342
ok_343:
s_cmp_lg_u32 s49,0
s_cbranch_scc1 ibok_344
v_and_b32 v7,7,v0
v_lshlrev_b32 v7,2,v7
buffer_load_dword v6,v7,s[12:15],0 offen offset:32 sc1
s_waitcnt vmcnt(0)
v_cmp_ne_u32 vcc,32,v6
s_nop 0
s_cbranch_vccz ibok_344
s_barrier
s_mov_b32 s49,1
s_mov_b32 s3,s2
s_load_dwordx16 s[16:31],s[0:1],0
s_load_dwordx8 s[32:39],s[0:1],64
s_waitcnt lgkmcnt(0)
s_branch DISPATCH
ibok_344:
s_mov_b32 s83,s100
s_mov_b32 s32,0
s_mov_b32 s59,2147483648
s_min_u32 s62,s32,127
s_sub_u32 s60,s62,13
s_lshr_b32 s34,s60,1
s_and_b32 s33,s60,1
s_cmp_eq_u32 s33,0
s_cselect_b32 s61,13,0
s_add_u32 s34,s34,s61
s_sub_u32 s61,s60,51
s_cmp_ge_u32 s60,102
s_cselect_b32 s34,s61,s34
s_cselect_b32 s33,1,s33
s_cmp_lt_u32 s62,13
s_cselect_b32 s34,s62,s34
s_cselect_b32 s33,0,s33
s_lshl_b32 s35,s33,6
s_add_u32 s35,s35,s34
s_lshl_b32 s35,s35,9
s_add_u32 s35,s35,589824
s_and_b32 s60,s34,3
s_lshl2_add_u32 s60,s33,s60
s_mul_i32 s73,s60,98304
s_add_u32 s73,s73,s71
W4_COLD:
fb_345:
buffer_load_dword v3,v2,s[8:11],s35 offen sc1
s_waitcnt vmcnt(0)
v_cmp_eq_u32 vcc,0,v3
s_nop 0
s_cbranch_vccz ok_346
s_sleep 1
s_sub_u32 s47,s47,1
s_cbranch_scc1 ABORT
s_branch fb_345
ok_346:
s_add_u32 s63,s73,0
buffer_load_dwordx4 v[16:19],v1,s[8:11],s63 offen sc1
s_nop 7
buffer_load_dwordx4 v[20:23],v1,s[8:11],s63 offen offset:1024 sc1
s_nop 7
buffer_load_dwordx4 v[24:27],v1,s[8:11],s63 offen offset:2048 sc1
s_nop 7
buffer_load_dwordx4 v[28:31],v1,s[8:11],s63 offen offset:3072 sc1
s_nop 7
s_add_u32 s63,s73,4096
buffer_load_dwordx4 v[32:35],v1,s[8:11],s63 offen sc1
s_nop 7
buffer_load_dwordx4 v[36:39],v1,s[8:11],s63 offen offset:1024 sc1
W4_C:
s_mov_b32 s51,s33
s_mov_b32 s52,s34
s_mov_b32 s72,s73
s_add_u32 s32,s32,1
s_waitcnt vmcnt(5)
v_mfma_f32_32x32x16_bf16 v[112:127],a[0:3],v[16:19],0
s_add_u32 s63,s72,4096
buffer_load_dwordx4 v[40:43],v1,s[8:11],s63 offen offset:2048 sc1
s_min_u32 s62,s32,127
s_sub_u32 s60,s62,13
s_lshr_b32 s34,s60,1
v_mfma_f32_32x32x16_bf16 v[128:143],a[96:99],v[16:19],0
s_and_b32 s33,s60,1
s_cmp_eq_u32 s33,0
s_cselect_b32 s61,13,0
s_add_u32 s34,s34,s61
s_sub_u32 s61,s60,51
v_xor_b32 v206,0x8000,v206
s_waitcnt vmcnt(5)
v_mfma_f32_32x32x16_bf16 v[112:127],a[4:7],v[20:23],v[112:127]
buffer_load_dwordx4 v[44:47],v1,s[8:11],s63 offen offset:3072 sc1
s_add_u32 s63,s72,8192
s_cmp_ge_u32 s60,102
s_cselect_b32 s34,s61,s34
s_cselect_b32 s33,1,s33
v_mfma_f32_32x32x16_bf16 v[128:143],a[100:103],v[20:23],v[128:143]
s_cmp_lt_u32 s62,13
s_cselect_b32 s34,s62,s34
s_cselect_b32 s33,0,s33
s_lshl_b32 s35,s33,6
s_add_u32 s35,s35,s34
s_lshl_b32 s35,s35,9
s_waitcnt vmcnt(5)
v_mfma_f32_32x32x16_bf16 v[112:127],a[8:11],v[24:27],v[112:127]
buffer_load_dwordx4 v[48:51],v1,s[8:11],s63 offen sc1
s_add_u32 s35,s35,589824
s_and_b32 s60,s34,3
s_lshl2_add_u32 s60,s33,s60
s_mul_i32 s73,s60,98304
v_mfma_f32_32x32x16_bf16 v[128:143],a[104:107],v[24:27],v[128:143]
s_add_u32 s73,s73,s71
v_xor_b32 v207,0x8000,v207
s_lshl_b32 s64,s51,6
s_add_u32 s64,s64,s52
s_and_b32 s65,s52,7
s_lshl3_add_u32 s65,s51,s65
s_waitcnt vmcnt(5)
v_mfma_f32_32x32x16_bf16 v[112:127],a[12:15],v[28:31],v[112:127]
buffer_load_dwordx4 v[52:55],v1,s[8:11],s63 offen offset:1024 sc1
s_mul_i32 s65,s65,46080
s_add_u32 s65,s65,s70
s_add_u32 s65,s65,212467712
v_mfma_f32_32x32x16_bf16 v[128:143],a[108:111],v[28:31],v[128:143]
buffer_load_dwordx4 v[176:179],v1,s[8:11],s65 offen sc1
s_mul_i32 s65,s64,40960
s_add_u32 s65,s65,s70
s_add_u32 s65,s65,218365952
s_lshl_b32 s82,s64,9
s_waitcnt vmcnt(6)
v_mfma_f32_32x32x16_bf16 v[112:127],a[16:19],v[32:35],v[112:127]
buffer_load_dwordx4 v[56:59],v1,s[8:11],s63 offen offset:2048 sc1
s_lshl2_add_u32 s82,s56,s82
s_add_u32 s42,s82,32768
s_add_u32 s82,s82,327680
s_mul_i32 s41,s52,46080
v_mfma_f32_32x32x16_bf16 v[128:143],a[112:115],v[32:35],v[128:143]
s_add_u32 s41,s41,209518592
s_add_u32 s40,s41,s70
s_lshr_b32 s64,s70,3
s_add_u32 s41,s41,s64
s_add_u32 s41,s41,40960
s_mul_i32 s64,s52,40960
s_waitcnt vmcnt(6)
v_mfma_f32_32x32x16_bf16 v[112:127],a[20:23],v[36:39],v[112:127]
buffer_load_dwordx4 v[60:63],v1,s[8:11],s63 offen offset:3072 sc1
s_add_u32 s63,s72,12288
s_cmp_lg_u32 s51,0
s_cselect_b32 s40,s64,s40
s_cselect_b32 s42,2147483648,s42
v_mfma_f32_32x32x16_bf16 v[128:143],a[116:119],v[36:39],v[128:143]
s_waitcnt vmcnt(6)
v_mfma_f32_32x32x16_bf16 v[112:127],a[24:27],v[40:43],v[112:127]
buffer_load_dwordx4 v[64:67],v1,s[8:11],s63 offen sc1
v_mfma_f32_32x32x16_bf16 v[128:143],a[120:123],v[40:43],v[128:143]
s_waitcnt vmcnt(6)
v_mfma_f32_32x32x16_bf16 v[112:127],a[28:31],v[44:47],v[112:127]
buffer_load_dwordx4 v[68:71],v1,s[8:11],s63 offen offset:1024 sc1
v_mfma_f32_32x32x16_bf16 v[128:143],a[124:127],v[44:47],v[128:143]
s_waitcnt vmcnt(6)
v_mfma_f32_32x32x16_bf16 v[112:127],a[32:35],v[48:51],v[112:127]
buffer_load_dwordx4 v[72:75],v1,s[8:11],s63 offen offset:2048 sc1
v_mfma_f32_32x32x16_bf16 v[128:143],a[128:131],v[48:51],v[128:143]
s_waitcnt vmcnt(6)
v_mfma_f32_32x32x16_bf16 v[112:127],a[36:39],v[52:55],v[112:127]
buffer_load_dwordx4 v[76:79],v1,s[8:11],s63 offen offset:3072 sc1
s_add_u32 s63,s72,16384
v_mfma_f32_32x32x16_bf16 v[128:143],a[132:135],v[52:55],v[128:143]
s_waitcnt vmcnt(5)
v_mfma_f32_32x32x16_bf16 v[112:127],a[40:43],v[56:59],v[112:127]
buffer_load_dwordx4 v[80:83],v1,s[8:11],s63 offen sc1
v_mfma_f32_32x32x16_bf16 v[128:143],a[136:139],v[56:59],v[128:143]
buffer_load_dword v3,v2,s[8:11],s35 offen sc1
s_waitcnt vmcnt(6)
v_mfma_f32_32x32x16_bf16 v[112:127],a[44:47],v[60:63],v[112:127]
buffer_load_dwordx4 v[84:87],v1,s[8:11],s63 offen offset:1024 sc1
v_mfma_f32_32x32x16_bf16 v[128:143],a[140:143],v[60:63],v[128:143]
s_waitcnt vmcnt(6)
v_mfma_f32_32x32x16_bf16 v[112:127],a[48:51],v[64:67],v[112:127]
buffer_load_dwordx4 v[88:91],v1,s[8:11],s63 offen offset:2048 sc1
v_mfma_f32_32x32x16_bf16 v[128:143],a[144:147],v[64:67],v[128:143]
s_waitcnt vmcnt(6)
v_mfma_f32_32x32x16_bf16 v[112:127],a[52:55],v[68:71],v[112:127]
buffer_load_dwordx4 v[92:95],v1,s[8:11],s63 offen offset:3072 sc1
s_add_u32 s63,s72,20480
v_mfma_f32_32x32x16_bf16 v[128:143],a[148:151],v[68:71],v[128:143]
s_waitcnt vmcnt(6)
v_mfma_f32_32x32x16_bf16 v[112:127],a[56:59],v[72:75],v[112:127]
buffer_load_dwordx4 v[96:99],v1,s[8:11],s63 offen sc1
v_mfma_f32_32x32x16_bf16 v[128:143],a[152:155],v[72:75],v[128:143]
s_waitcnt vmcnt(6)
v_mfma_f32_32x32x16_bf16 v[112:127],a[60:63],v[76:79],v[112:127]
buffer_load_dwordx4 v[100:103],v1,s[8:11],s63 offen offset:1024 sc1
v_mfma_f32_32x32x16_bf16 v[128:143],a[156:159],v[76:79],v[128:143]
s_waitcnt vmcnt(6)
v_mfma_f32_32x32x16_bf16 v[112:127],a[64:67],v[80:83],v[112:127]
buffer_load_dwordx4 v[104:107],v1,s[8:11],s63 offen offset:2048 sc1
v_mfma_f32_32x32x16_bf16 v[128:143],a[160:163],v[80:83],v[128:143]
s_waitcnt vmcnt(6)
v_cmp_eq_u32 vcc,0,v3
s_cmp_eq_u64 vcc,0
s_cselect_b32 s37,0,2147483648
s_cmp_lt_u32 s32,128
s_cselect_b32 s37,s37,2147483648
s_waitcnt vmcnt(5)
v_mfma_f32_32x32x16_bf16 v[112:127],a[68:71],v[84:87],v[112:127]
buffer_load_dwordx4 v[108:111],v1,s[8:11],s63 offen offset:3072 sc1
s_add_u32 s67,s73,s37
buffer_load_dwordx4 v[180:183],v15,s[8:11],s65 offen sc1
s_add_u32 s63,s67,0
v_mfma_f32_32x32x16_bf16 v[128:143],a[164:167],v[84:87],v[128:143]
buffer_load_dwordx4 v[16:19],v1,s[8:11],s63 offen sc1
s_waitcnt vmcnt(7)
v_mfma_f32_32x32x16_bf16 v[112:127],a[72:75],v[88:91],v[112:127]
v_lshlrev_b32 v184,16,v176
v_and_b32 v185,0xffff0000,v176
v_lshlrev_b32 v186,16,v177
v_and_b32 v187,0xffff0000,v177
v_lshlrev_b32 v188,16,v178
v_mfma_f32_32x32x16_bf16 v[128:143],a[168:171],v[88:91],v[128:143]
v_and_b32 v189,0xffff0000,v178
v_lshlrev_b32 v190,16,v179
v_and_b32 v191,0xffff0000,v179
buffer_load_dwordx4 v[20:23],v1,s[8:11],s63 offen offset:1024 sc1
s_waitcnt vmcnt(7)
v_mfma_f32_32x32x16_bf16 v[112:127],a[76:79],v[92:95],v[112:127]
buffer_load_dword v3,v2,s[8:11],s35 offen sc1
v_mfma_f32_32x32x16_bf16 v[128:143],a[172:175],v[92:95],v[128:143]
buffer_load_dwordx4 v[24:27],v1,s[8:11],s63 offen offset:2048 sc1
s_waitcnt vmcnt(8)
v_mfma_f32_32x32x16_bf16 v[112:127],a[80:83],v[96:99],v[112:127]
s_waitcnt vmcnt(7)
v_mfma_f32_32x32x16_bf16 v[112:127],a[84:87],v[100:103],v[112:127]
buffer_load_dwordx4 v[28:31],v1,s[8:11],s63 offen offset:3072 sc1
s_add_u32 s63,s67,4096
s_waitcnt vmcnt(7)
v_mfma_f32_32x32x16_bf16 v[112:127],a[88:91],v[104:107],v[112:127]
s_waitcnt vmcnt(6)
v_mfma_f32_32x32x16_bf16 v[112:127],a[92:95],v[108:111],v[112:127]
buffer_load_dwordx4 v[32:35],v1,s[8:11],s63 offen sc1
v_mfma_f32_32x32x16_bf16 v[128:143],a[176:179],v[96:99],v[128:143]
v_mfma_f32_32x32x16_bf16 v[128:143],a[180:183],v[100:103],v[128:143]
buffer_load_dwordx4 v[36:39],v1,s[8:11],s63 offen offset:1024 sc1
ds_write_b128 v206,v[112:115] offset:0
ds_write_b128 v206,v[116:119] offset:1024
v_mfma_f32_32x32x16_bf16 v[128:143],a[184:187],v[104:107],v[128:143]
ds_write_b128 v206,v[120:123] offset:512
ds_write_b128 v206,v[124:127] offset:1536
v_mfma_f32_32x32x16_bf16 v[128:143],a[188:191],v[108:111],v[128:143]
s_mov_b32 s55,6
s_cmp_eq_u32 s37,0
s_cbranch_scc1 ep_347
s_waitcnt vmcnt(4)
v_cmp_eq_u32 vcc,0,v3
s_cmp_eq_u64 vcc,0
s_cselect_b32 s37,0,2147483648
s_cmp_lt_u32 s32,128
s_cselect_b32 s37,s37,2147483648
s_mov_b32 s55,0
ep_347:
s_nop 8
ds_write_b128 v206,v[128:131] offset:8192
ds_write_b128 v206,v[132:135] offset:9216
ds_write_b128 v206,v[136:139] offset:8704
ds_write_b128 v206,v[140:143] offset:9728
s_waitcnt vmcnt(7)
s_mov_b64 exec,1
s_cmp_lg_u32 s49,0
s_cbranch_scc0 ls_348
buffer_store_dword v5,v1,s[8:11],s82 offen sc1
s_branch ls_349
ls_348:
buffer_store_dword v5,v1,s[8:11],s82 offen
ls_349:
s_mov_b64 exec,-1
v_lshlrev_b32 v192,16,v180
v_and_b32 v193,0xffff0000,v180
v_lshlrev_b32 v194,16,v181
v_and_b32 v195,0xffff0000,v181
v_lshlrev_b32 v196,16,v182
v_and_b32 v197,0xffff0000,v182
v_lshlrev_b32 v198,16,v183
v_and_b32 v199,0xffff0000,v183
s_nop 0
s_branch W4_E
W4_W:
s_mov_b32 s51,s33
s_mov_b32 s52,s34
s_mov_b32 s72,s73
s_add_u32 s32,s32,1
s_waitcnt vmcnt(11)
v_mfma_f32_32x32x16_bf16 v[112:127],a[0:3],v[16:19],0
s_add_u32 s63,s72,12288
buffer_load_dwordx4 v[64:67],v1,s[8:11],s63 offen sc1
s_min_u32 s62,s32,127
s_sub_u32 s60,s62,13
s_lshr_b32 s34,s60,1
v_mfma_f32_32x32x16_bf16 v[128:143],a[96:99],v[16:19],0
s_and_b32 s33,s60,1
s_cmp_eq_u32 s33,0
s_cselect_b32 s61,13,0
s_add_u32 s34,s34,s61
s_sub_u32 s61,s60,51
v_xor_b32 v206,0x8000,v206
s_waitcnt vmcnt(11)
v_mfma_f32_32x32x16_bf16 v[112:127],a[4:7],v[20:23],v[112:127]
buffer_load_dwordx4 v[68:71],v1,s[8:11],s63 offen offset:1024 sc1
s_cmp_ge_u32 s60,102
s_cselect_b32 s34,s61,s34
s_cselect_b32 s33,1,s33
v_xor_b32 v207,0x8000,v207
v_mfma_f32_32x32x16_bf16 v[128:143],a[100:103],v[20:23],v[128:143]
s_cmp_lt_u32 s62,13
s_cselect_b32 s34,s62,s34
s_cselect_b32 s33,0,s33
s_lshl_b32 s35,s33,6
s_add_u32 s35,s35,s34
s_lshl_b32 s35,s35,9
s_waitcnt vmcnt(11)
v_mfma_f32_32x32x16_bf16 v[112:127],a[8:11],v[24:27],v[112:127]
buffer_load_dwordx4 v[72:75],v1,s[8:11],s63 offen offset:2048 sc1
s_add_u32 s35,s35,589824
s_and_b32 s60,s34,3
s_lshl2_add_u32 s60,s33,s60
s_mul_i32 s73,s60,98304
v_mfma_f32_32x32x16_bf16 v[128:143],a[104:107],v[24:27],v[128:143]
s_add_u32 s73,s73,s71
s_lshl_b32 s64,s51,6
s_add_u32 s64,s64,s52
s_and_b32 s65,s52,7
s_lshl3_add_u32 s65,s51,s65
s_mul_i32 s65,s65,46080
s_waitcnt vmcnt(11)
v_mfma_f32_32x32x16_bf16 v[112:127],a[12:15],v[28:31],v[112:127]
buffer_load_dwordx4 v[76:79],v1,s[8:11],s63 offen offset:3072 sc1
s_add_u32 s63,s72,16384
s_add_u32 s65,s65,s70
s_add_u32 s65,s65,212467712
v_mfma_f32_32x32x16_bf16 v[128:143],a[108:111],v[28:31],v[128:143]
buffer_load_dwordx4 v[176:179],v1,s[8:11],s65 offen sc1
s_mul_i32 s65,s64,40960
s_add_u32 s65,s65,s70
s_add_u32 s65,s65,218365952
s_lshl_b32 s82,s64,9
s_waitcnt vmcnt(12)
v_mfma_f32_32x32x16_bf16 v[112:127],a[16:19],v[32:35],v[112:127]
buffer_load_dwordx4 v[80:83],v1,s[8:11],s63 offen sc1
s_lshl2_add_u32 s82,s56,s82
s_add_u32 s42,s82,32768
s_add_u32 s82,s82,327680
s_mul_i32 s41,s52,46080
v_mfma_f32_32x32x16_bf16 v[128:143],a[112:115],v[32:35],v[128:143]
buffer_load_dword v3,v2,s[8:11],s35 offen sc1
s_add_u32 s41,s41,209518592
s_add_u32 s40,s41,s70
s_lshr_b32 s64,s70,3
s_add_u32 s41,s41,s64
s_waitcnt vmcnt(13)
v_mfma_f32_32x32x16_bf16 v[112:127],a[20:23],v[36:39],v[112:127]
buffer_load_dwordx4 v[84:87],v1,s[8:11],s63 offen offset:1024 sc1
s_add_u32 s41,s41,40960
s_mul_i32 s64,s52,40960
v_mfma_f32_32x32x16_bf16 v[128:143],a[116:119],v[36:39],v[128:143]
s_cmp_lg_u32 s51,0
s_cselect_b32 s40,s64,s40
s_cselect_b32 s42,2147483648,s42
s_waitcnt vmcnt(13)
v_mfma_f32_32x32x16_bf16 v[112:127],a[24:27],v[40:43],v[112:127]
buffer_load_dwordx4 v[88:91],v1,s[8:11],s63 offen offset:2048 sc1
v_mfma_f32_32x32x16_bf16 v[128:143],a[120:123],v[40:43],v[128:143]
s_waitcnt vmcnt(13)
v_mfma_f32_32x32x16_bf16 v[112:127],a[28:31],v[44:47],v[112:127]
buffer_load_dwordx4 v[92:95],v1,s[8:11],s63 offen offset:3072 sc1
s_add_u32 s63,s72,20480
v_mfma_f32_32x32x16_bf16 v[128:143],a[124:127],v[44:47],v[128:143]
s_waitcnt vmcnt(13)
v_mfma_f32_32x32x16_bf16 v[112:127],a[32:35],v[48:51],v[112:127]
buffer_load_dwordx4 v[96:99],v1,s[8:11],s63 offen sc1
v_mfma_f32_32x32x16_bf16 v[128:143],a[128:131],v[48:51],v[128:143]
s_waitcnt vmcnt(13)
v_mfma_f32_32x32x16_bf16 v[112:127],a[36:39],v[52:55],v[112:127]
buffer_load_dwordx4 v[100:103],v1,s[8:11],s63 offen offset:1024 sc1
v_mfma_f32_32x32x16_bf16 v[128:143],a[132:135],v[52:55],v[128:143]
s_waitcnt vmcnt(13)
v_mfma_f32_32x32x16_bf16 v[112:127],a[40:43],v[56:59],v[112:127]
buffer_load_dwordx4 v[104:107],v1,s[8:11],s63 offen offset:2048 sc1
v_mfma_f32_32x32x16_bf16 v[128:143],a[136:139],v[56:59],v[128:143]
s_waitcnt vmcnt(12)
s_mov_b64 exec,1
buffer_store_dword v5,v1,s[8:11],s59 offen sc1
s_mov_b64 exec,-1
s_mov_b32 s59,2147483648
v_mfma_f32_32x32x16_bf16 v[112:127],a[44:47],v[60:63],v[112:127]
buffer_load_dwordx4 v[108:111],v1,s[8:11],s63 offen offset:3072 sc1
s_waitcnt vmcnt(8)
v_cmp_eq_u32 vcc,0,v3
s_cmp_eq_u64 vcc,0
s_cselect_b32 s37,0,2147483648
v_mfma_f32_32x32x16_bf16 v[128:143],a[140:143],v[60:63],v[128:143]
s_cmp_lt_u32 s32,128
s_cselect_b32 s37,s37,2147483648
s_add_u32 s67,s73,s37
buffer_load_dwordx4 v[180:183],v15,s[8:11],s65 offen sc1
s_add_u32 s63,s67,0
v_mfma_f32_32x32x16_bf16 v[112:127],a[48:51],v[64:67],v[112:127]
buffer_load_dwordx4 v[16:19],v1,s[8:11],s63 offen sc1
v_mfma_f32_32x32x16_bf16 v[128:143],a[144:147],v[64:67],v[128:143]
v_mfma_f32_32x32x16_bf16 v[112:127],a[52:55],v[68:71],v[112:127]
buffer_load_dwordx4 v[20:23],v1,s[8:11],s63 offen offset:1024 sc1
v_mfma_f32_32x32x16_bf16 v[128:143],a[148:151],v[68:71],v[128:143]
v_mfma_f32_32x32x16_bf16 v[112:127],a[56:59],v[72:75],v[112:127]
buffer_load_dwordx4 v[24:27],v1,s[8:11],s63 offen offset:2048 sc1
v_mfma_f32_32x32x16_bf16 v[128:143],a[152:155],v[72:75],v[128:143]
v_mfma_f32_32x32x16_bf16 v[112:127],a[60:63],v[76:79],v[112:127]
buffer_load_dwordx4 v[28:31],v1,s[8:11],s63 offen offset:3072 sc1
s_add_u32 s63,s67,4096
v_mfma_f32_32x32x16_bf16 v[128:143],a[156:159],v[76:79],v[128:143]
v_mfma_f32_32x32x16_bf16 v[112:127],a[64:67],v[80:83],v[112:127]
buffer_load_dwordx4 v[32:35],v1,s[8:11],s63 offen sc1
v_mfma_f32_32x32x16_bf16 v[128:143],a[160:163],v[80:83],v[128:143]
s_waitcnt vmcnt(13)
v_mfma_f32_32x32x16_bf16 v[112:127],a[68:71],v[84:87],v[112:127]
buffer_load_dwordx4 v[36:39],v1,s[8:11],s63 offen offset:1024 sc1
v_mfma_f32_32x32x16_bf16 v[128:143],a[164:167],v[84:87],v[128:143]
s_waitcnt vmcnt(13)
v_mfma_f32_32x32x16_bf16 v[112:127],a[72:75],v[88:91],v[112:127]
v_lshlrev_b32 v184,16,v176
v_and_b32 v185,0xffff0000,v176
v_lshlrev_b32 v186,16,v177
v_and_b32 v187,0xffff0000,v177
v_lshlrev_b32 v188,16,v178
v_mfma_f32_32x32x16_bf16 v[128:143],a[168:171],v[88:91],v[128:143]
v_and_b32 v189,0xffff0000,v178
v_lshlrev_b32 v190,16,v179
v_and_b32 v191,0xffff0000,v179
buffer_load_dwordx4 v[40:43],v1,s[8:11],s63 offen offset:2048 sc1
s_waitcnt vmcnt(13)
v_mfma_f32_32x32x16_bf16 v[112:127],a[76:79],v[92:95],v[112:127]
buffer_load_dword v3,v2,s[8:11],s35 offen sc1
v_mfma_f32_32x32x16_bf16 v[128:143],a[172:175],v[92:95],v[128:143]
buffer_load_dwordx4 v[44:47],v1,s[8:11],s63 offen offset:3072 sc1
s_add_u32 s63,s67,8192
s_waitcnt vmcnt(14)
v_mfma_f32_32x32x16_bf16 v[112:127],a[80:83],v[96:99],v[112:127]
s_waitcnt vmcnt(13)
v_mfma_f32_32x32x16_bf16 v[112:127],a[84:87],v[100:103],v[112:127]
buffer_load_dwordx4 v[48:51],v1,s[8:11],s63 offen sc1
s_waitcnt vmcnt(13)
v_mfma_f32_32x32x16_bf16 v[112:127],a[88:91],v[104:107],v[112:127]
s_waitcnt vmcnt(11)
v_mfma_f32_32x32x16_bf16 v[112:127],a[92:95],v[108:111],v[112:127]
buffer_load_dwordx4 v[52:55],v1,s[8:11],s63 offen offset:1024 sc1
v_mfma_f32_32x32x16_bf16 v[128:143],a[176:179],v[96:99],v[128:143]
v_mfma_f32_32x32x16_bf16 v[128:143],a[180:183],v[100:103],v[128:143]
buffer_load_dwordx4 v[56:59],v1,s[8:11],s63 offen offset:2048 sc1
ds_write_b128 v206,v[112:115] offset:0
ds_write_b128 v206,v[116:119] offset:1024
v_mfma_f32_32x32x16_bf16 v[128:143],a[184:187],v[104:107],v[128:143]
ds_write_b128 v206,v[120:123] offset:512
ds_write_b128 v206,v[124:127] offset:1536
v_mfma_f32_32x32x16_bf16 v[128:143],a[188:191],v[108:111],v[128:143]
buffer_load_dwordx4 v[60:63],v1,s[8:11],s63 offen offset:3072 sc1
s_mov_b32 s55,12
s_cmp_eq_u32 s37,0
s_cbranch_scc1 ep_350
s_waitcnt vmcnt(5)
v_cmp_eq_u32 vcc,0,v3
s_cmp_eq_u64 vcc,0
s_cselect_b32 s37,0,2147483648
s_cmp_lt_u32 s32,128
s_cselect_b32 s37,s37,2147483648
s_mov_b32 s55,0
ep_350:
s_nop 8
ds_write_b128 v206,v[128:131] offset:8192
ds_write_b128 v206,v[132:135] offset:9216
ds_write_b128 v206,v[136:139] offset:8704
ds_write_b128 v206,v[140:143] offset:9728
s_waitcnt vmcnt(13)
s_mov_b64 exec,1
s_cmp_lg_u32 s49,0
s_cbranch_scc0 ls_351
buffer_store_dword v5,v1,s[8:11],s82 offen sc1
s_branch ls_352
ls_351:
buffer_store_dword v5,v1,s[8:11],s82 offen
ls_352:
s_mov_b64 exec,-1
v_lshlrev_b32 v192,16,v180
v_and_b32 v193,0xffff0000,v180
v_lshlrev_b32 v194,16,v181
v_and_b32 v195,0xffff0000,v181
v_lshlrev_b32 v196,16,v182
v_and_b32 v197,0xffff0000,v182
v_lshlrev_b32 v198,16,v183
v_and_b32 v199,0xffff0000,v183
s_nop 1
W4_E:
s_cmp_lg_u32 s37,0
s_cbranch_scc1 e2_353
s_cmp_eq_u32 s55,12
s_cbranch_scc1 e2_353
s_cmp_eq_u32 s55,6
s_cbranch_scc1 e2_353c
s_add_u32 s63,s73,0
buffer_load_dwordx4 v[16:19],v1,s[8:11],s63 offen sc1
buffer_load_dwordx4 v[20:23],v1,s[8:11],s63 offen offset:1024 sc1
buffer_load_dwordx4 v[24:27],v1,s[8:11],s63 offen offset:2048 sc1
buffer_load_dwordx4 v[28:31],v1,s[8:11],s63 offen offset:3072 sc1
s_add_u32 s63,s73,4096
buffer_load_dwordx4 v[32:35],v1,s[8:11],s63 offen sc1
buffer_load_dwordx4 v[36:39],v1,s[8:11],s63 offen offset:1024 sc1
e2_353c:
s_add_u32 s63,s73,4096
buffer_load_dwordx4 v[40:43],v1,s[8:11],s63 offen offset:2048 sc1
buffer_load_dwordx4 v[44:47],v1,s[8:11],s63 offen offset:3072 sc1
s_add_u32 s63,s73,8192
buffer_load_dwordx4 v[48:51],v1,s[8:11],s63 offen sc1
buffer_load_dwordx4 v[52:55],v1,s[8:11],s63 offen offset:1024 sc1
buffer_load_dwordx4 v[56:59],v1,s[8:11],s63 offen offset:2048 sc1
buffer_load_dwordx4 v[60:63],v1,s[8:11],s63 offen offset:3072 sc1
e2_353:
s_waitcnt lgkmcnt(0)
s_barrier
ds_read_b128 v[144:147],v207 offset:0
ds_read_b128 v[148:151],v207 offset:1024
ds_read_b128 v[152:155],v207 offset:2048
ds_read_b128 v[156:159],v207 offset:3072
ds_read_b128 v[160:163],v207 offset:4096
ds_read_b128 v[164:167],v207 offset:5120
ds_read_b128 v[168:171],v207 offset:6144
ds_read_b128 v[172:175],v207 offset:7168
s_waitcnt lgkmcnt(4)
v_pk_add_f32 v[144:145],v[144:145],v[152:153]
v_pk_add_f32 v[146:147],v[146:147],v[154:155]
v_pk_add_f32 v[148:149],v[148:149],v[156:157]
v_pk_add_f32 v[150:151],v[150:151],v[158:159]
s_waitcnt lgkmcnt(0)
v_pk_add_f32 v[160:161],v[160:161],v[168:169]
v_pk_add_f32 v[162:163],v[162:163],v[170:171]
v_pk_add_f32 v[164:165],v[164:165],v[172:173]
v_pk_add_f32 v[166:167],v[166:167],v[174:175]
v_pk_add_f32 v[144:145],v[144:145],v[160:161]
v_pk_add_f32 v[146:147],v[146:147],v[162:163]
v_pk_add_f32 v[148:149],v[148:149],v[164:165]
v_pk_add_f32 v[150:151],v[150:151],v[166:167]
v_cvt_pk_bf16_f32 v6,v144,v145
v_lshlrev_b32 v144,16,v6
v_and_b32 v145,0xffff0000,v6
v_cvt_pk_bf16_f32 v6,v146,v147
v_lshlrev_b32 v146,16,v6
v_and_b32 v147,0xffff0000,v6
v_cvt_pk_bf16_f32 v6,v148,v149
v_lshlrev_b32 v148,16,v6
v_and_b32 v149,0xffff0000,v6
v_cvt_pk_bf16_f32 v6,v150,v151
v_lshlrev_b32 v150,16,v6
v_and_b32 v151,0xffff0000,v6
v_pk_add_f32 v[144:145],v[144:145],v[184:185]
v_pk_add_f32 v[146:147],v[146:147],v[186:187]
v_pk_add_f32 v[148:149],v[148:149],v[188:189]
v_pk_add_f32 v[150:151],v[150:151],v[190:191]
v_cvt_pk_bf16_f32 v6,v144,v145
v_lshlrev_b32 v144,16,v6
v_and_b32 v145,0xffff0000,v6
v_cvt_pk_bf16_f32 v6,v146,v147
v_lshlrev_b32 v146,16,v6
v_and_b32 v147,0xffff0000,v6
v_cvt_pk_bf16_f32 v6,v148,v149
v_lshlrev_b32 v148,16,v6
v_and_b32 v149,0xffff0000,v6
v_cvt_pk_bf16_f32 v6,v150,v151
v_lshlrev_b32 v150,16,v6
v_and_b32 v151,0xffff0000,v6
v_pk_add_f32 v[144:145],v[144:145],v[192:193]
v_pk_add_f32 v[146:147],v[146:147],v[194:195]
v_pk_add_f32 v[148:149],v[148:149],v[196:197]
v_pk_add_f32 v[150:151],v[150:151],v[198:199]
v_cvt_pk_bf16_f32 v200,v144,v145
v_cvt_pk_bf16_f32 v201,v146,v147
v_cvt_pk_bf16_f32 v202,v148,v149
v_cvt_pk_bf16_f32 v203,v150,v151
s_cmp_lg_u32 s51,0
s_cbranch_scc1 w4o_354
buffer_store_dwordx4 v[200:203],v15,s[8:11],s40 offen sc1
v_lshlrev_b32 v144,16,v200
v_and_b32 v145,0xffff0000,v200
v_lshlrev_b32 v146,16,v201
v_and_b32 v147,0xffff0000,v201
v_lshlrev_b32 v148,16,v202
v_and_b32 v149,0xffff0000,v202
v_lshlrev_b32 v150,16,v203
v_and_b32 v151,0xffff0000,v203
v_pk_add_f32 v[6:7],v[144:145],v[146:147]
v_pk_mul_f32 v[8:9],v[144:145],v[144:145]
v_pk_fma_f32 v[8:9],v[146:147],v[146:147],v[8:9]
v_pk_add_f32 v[6:7],v[6:7],v[148:149]
v_pk_fma_f32 v[8:9],v[148:149],v[148:149],v[8:9]
v_pk_add_f32 v[6:7],v[6:7],v[150:151]
v_pk_fma_f32 v[8:9],v[150:151],v[150:151],v[8:9]
v_add_f32 v6,v6,v7
v_add_f32 v7,v8,v9
s_nop 1
v_permlane32_swap_b32 v6,v7
v_add_f32 v6,v6,v7
v_mov_b32 v7,v6
s_nop 1
v_permlane16_swap_b32 v6,v7
v_add_f32 v6,v6,v7
v_mov_b32 v7,v6
s_nop 1
v_permlane32_swap_b32 v6,v7
s_mov_b64 exec,0xffff
buffer_store_dwordx2 v[6:7],v204,s[8:11],s41 offen sc1
s_mov_b64 exec,-1
s_branch w4n_355
w4o_354:
buffer_store_dwordx2 v[200:201],v205,s[76:79],s40 offen
buffer_store_dwordx2 v[202:203],v205,s[76:79],s40 offen offset:32
w4n_355:
s_mov_b32 s59,s42
s_cmp_eq_u32 s37,0
s_cbranch_scc1 W4_W
s_waitcnt vmcnt(0)
s_mov_b64 exec,1
buffer_store_dword v5,v1,s[8:11],s59 offen sc1
s_mov_b64 exec,-1
s_mov_b32 s59,2147483648
s_cmp_lt_u32 s32,128
s_cbranch_scc1 W4_COLD
s_endpgm
.section .rodata,"a"
.p2align 6
.amdhsa_kernel interleave_layers__memory_aug_recurrent_mem_tr__mixer_s_mlp__prompt_kernel
  .amdhsa_next_free_vgpr 512
  .amdhsa_next_free_sgpr 102
  .amdhsa_accum_offset 256
  .amdhsa_group_segment_fixed_size 0
  .amdhsa_kernarg_size 120
  .amdhsa_user_sgpr_count 2
  .amdhsa_user_sgpr_kernarg_segment_ptr 1
  .amdhsa_system_sgpr_workgroup_id_x 1
.end_amdhsa_kernel
```

```asm
; @launch grid=(256,1,1) block=(256,1,1) lds=163840
.amdgcn_target "amdgcn-amd-amdhsa--gfx950"
.text
.globl interleave_layers__memory_aug_recurrent_mem_tr__mixer_s_mlp__prompt_kernel
.p2align 8
.type interleave_layers__memory_aug_recurrent_mem_tr__mixer_s_mlp__prompt_kernel,@function
interleave_layers__memory_aug_recurrent_mem_tr__mixer_s_mlp__prompt_kernel:
s_cmp_ge_u32 s2,256
s_cbranch_scc1 EXIT
s_load_dwordx16 s[16:31],s[0:1],0
s_load_dwordx8 s[32:39],s[0:1],64
s_load_dwordx4 s[40:43],s[0:1],96
s_load_dwordx2 s[44:45],s[0:1],112
v_lshrrev_b32 v1,6,v0
v_and_b32 v0,63,v0
v_readfirstlane_b32 s46,v1
s_mov_b32 s47,200000
s_mov_b32 s49,0
s_getreg_b32 s4,hwreg(HW_REG_XCC_ID)
s_and_b32 s4,s4,7
s_waitcnt lgkmcnt(0)
s_mov_b32 s8,s44
s_mov_b32 s9,s45
s_mov_b32 s10,268435456
s_mov_b32 s11,0x20000
s_mov_b32 s12,s42
s_mov_b32 s13,s43
s_mov_b32 s14,256
s_mov_b32 s15,0x20000
v_lshlrev_b32 v1,4,v0
v_mov_b32 v4,0
v_mov_b32 v5,0
v_mov_b32 v6,0
v_mov_b32 v7,0
s_lshl_b32 s5,s2,2
s_add_u32 s5,s5,s46
s_lshl_b32 s5,s5,10
buffer_store_dwordx4 v[4:7],v1,s[8:11],s5 offen sc1
v_mov_b32 v2,0
s_cmp_lg_u32 s46,0
s_cbranch_scc1 TK_DONE
s_mov_b64 exec,1
v_mov_b32 v1,1
s_lshl_b32 s5,s4,2
v_mov_b32 v3,s5
buffer_atomic_add v1,v3,s[12:15],0 offen offset:32 sc0 sc1
s_waitcnt vmcnt(0)
v_readfirstlane_b32 s5,v1
s_lshl_b32 s6,s4,5
s_add_u32 s6,s6,s5
s_cmp_lt_u32 s5,32
s_cselect_b32 s6,s6,999
v_mov_b32 v1,s6
ds_write_b32 v2,v1
s_mov_b64 exec,-1
s_waitcnt lgkmcnt(0)
TK_DONE:
s_barrier
ds_read_b32 v1,v2
s_waitcnt lgkmcnt(0)
v_readfirstlane_b32 s3,v1
s_barrier
s_nop 2
s_branch DISPATCH
ROLE_CS:
s_lshr_b32 s28,s48,4
s_and_b32 s29,s48,15
s_mul_i32 s82,s28,2097152
s_add_u32 s82,s82,2097152
v_lshlrev_b32 v1,4,v0
v_and_b32 v12,1,v0
v_mul_u32_u24 v2,0xaaaa,v12
v_or_b32 v2,0x4444,v2
s_add_u32 s60,s46,1
s_and_b32 s60,s60,3
s_lshl_b32 s60,s60,11
s_add_u32 s60,s60,131072
v_add_u32 v3,s60,v1
s_add_u32 s60,s46,2
s_and_b32 s60,s60,3
s_lshl_b32 s60,s60,11
s_add_u32 s60,s60,131072
v_add_u32 v4,s60,v1
s_add_u32 s60,s46,3
s_and_b32 s60,s60,3
s_lshl_b32 s60,s60,11
s_add_u32 s60,s60,131072
v_add_u32 v5,s60,v1
v_add_u32 v59,139264,v1
s_lshl_b32 s60,s46,11
s_add_u32 s60,s60,131072
v_add_u32 v22,s60,v1
s_lshr_b32 s60,s46,1
s_lshl_b32 s60,s60,10
s_and_b32 s61,s46,1
s_lshl_b32 s61,s61,3
s_add_u32 s60,s60,s61
v_add_u32 v23,s60,v59
s_mul_i32 s60,s46,20480
v_add_u32 v21,s60,v1
v_and_b32 v11,7,v0
v_lshlrev_b32 v11,2,v11
v_bfe_u32 v12,v0,3,2
v_lshl_add_u32 v11,v12,7,v11
s_xor_b32 s60,s28,1
s_lshl_b32 s60,s60,19
s_lshl_b32 s61,s46,11
s_add_u32 s83,s60,s61
s_add_u32 s83,s83,10485760
s_mov_b32 s36,0
s_mov_b32 s88,0xcccccccc
s_mov_b32 s89,0xcccccccc
s_mov_b32 s90,0x33333333
s_mov_b32 s91,0x33333333
s_mov_b32 s87,0x3dd53b95
v_lshrrev_b32 v14,4,v0
v_and_b32 v15,15,v0
v_lshrrev_b32 v12,2,v15
v_add_u32 v12,v12,v14
v_and_b32 v12,3,v12
v_lshlrev_b32 v6,3,v12
v_lshl_add_u32 v6,v15,5,v6
s_mul_i32 s60,s46,1536
s_add_u32 s60,s60,141312
v_add_u32 v6,s60,v6
v_add_u32 v12,v0,v14
v_and_b32 v12,3,v12
v_lshlrev_b32 v7,3,v12
v_lshrrev_b32 v12,2,v0
v_lshl_add_u32 v7,v12,5,v7
v_add_u32 v7,141312,v7
s_min_u32 s62,s46,2
v_lshrrev_b32 v12,2,v15
v_and_b32 v13,1,v15
v_lshl_add_u32 v12,v12,1,v13
v_bfe_u32 v13,v15,1,1
v_lshlrev_b32 v8,8,v14
v_lshl_add_u32 v8,v12,5,v8
v_xor_b32 v16,1,v13
v_lshl_add_u32 v8,v16,4,v8
v_lshlrev_b32 v20,8,v14
v_lshl_add_u32 v20,v13,7,v20
v_and_b32 v16,3,v12
v_lshl_add_u32 v20,v16,5,v20
v_lshrrev_b32 v16,2,v12
v_lshl_add_u32 v20,v16,4,v20
v_min_u32 v12,5,v0
s_mul_i32 s60,s48,3
v_add_u32 v9,s60,v12
v_lshlrev_b32 v9,2,v9
v_add_u32 v13,65524,v9
v_cmp_lt_u32 vcc,2,v12
s_nop 1
v_cndmask_b32 v9,v9,v13,vcc
s_mul_i32 s84,s48,12288
s_add_u32 s84,s84,74448896
s_mul_i32 s60,s29,3072
s_lshl_b32 s61,s62,10
s_add_u32 s60,s60,s61
s_add_u32 s60,s60,s82
s_add_u32 s33,s60,163840
s_add_u32 s34,s60,557056
s_mul_i32 s85,s48,6144
s_add_u32 s85,s85,24117248
s_lshl_b32 s86,s48,5
s_lshl_b32 s61,s62,2
s_add_u32 s86,s86,688128
s_lshr_b32 s60,s29,2
s_lshl_b32 s60,s60,7
s_and_b32 s63,s29,3
s_mul_i32 s63,s63,12
s_add_u32 s60,s60,s63
s_add_u32 s60,s60,s61
s_add_u32 s60,s60,s82
s_add_u32 s35,s60,951296
s_cmp_eq_u32 s46,3
s_cbranch_scc1 si_1
v_mov_b32 v12,-1
v_mov_b32 v13,0
s_cmp_lg_u32 s49,0
s_cbranch_scc1 ls_2
s_add_u32 s60,s33,0
buffer_store_dword v12,v1,s[8:11],s60 offen
s_add_u32 s60,s33,49152
buffer_store_dword v12,v1,s[8:11],s60 offen
s_add_u32 s60,s33,98304
buffer_store_dword v12,v1,s[8:11],s60 offen
s_add_u32 s60,s33,147456
buffer_store_dword v12,v1,s[8:11],s60 offen
s_add_u32 s60,s33,196608
buffer_store_dword v12,v1,s[8:11],s60 offen
s_add_u32 s60,s33,245760
buffer_store_dword v12,v1,s[8:11],s60 offen
s_add_u32 s60,s33,294912
buffer_store_dword v12,v1,s[8:11],s60 offen
s_add_u32 s60,s33,344064
buffer_store_dword v12,v1,s[8:11],s60 offen
s_mov_b64 exec,1
buffer_store_dword v13,v1,s[8:11],s35 offen
buffer_store_dword v13,v1,s[8:11],s35 offen offset:512
s_mov_b64 exec,-1
s_branch ls_3
ls_2:
s_add_u32 s60,s33,0
buffer_store_dword v12,v1,s[8:11],s60 offen sc1
s_add_u32 s60,s33,49152
buffer_store_dword v12,v1,s[8:11],s60 offen sc1
s_add_u32 s60,s33,98304
buffer_store_dword v12,v1,s[8:11],s60 offen sc1
s_add_u32 s60,s33,147456
buffer_store_dword v12,v1,s[8:11],s60 offen sc1
s_add_u32 s60,s33,196608
buffer_store_dword v12,v1,s[8:11],s60 offen sc1
s_add_u32 s60,s33,245760
buffer_store_dword v12,v1,s[8:11],s60 offen sc1
s_add_u32 s60,s33,294912
buffer_store_dword v12,v1,s[8:11],s60 offen sc1
s_add_u32 s60,s33,344064
buffer_store_dword v12,v1,s[8:11],s60 offen sc1
s_mov_b64 exec,1
buffer_store_dword v13,v1,s[8:11],s35 offen sc1
buffer_store_dword v13,v1,s[8:11],s35 offen offset:512 sc1
s_mov_b64 exec,-1
ls_3:
si_1:
s_mul_i32 s73,s48,384
s_mov_b32 s74,s73
v_add_u32 v12,0,v0
v_mul_u32_u24 v13,2731,v12
v_lshrrev_b32 v13,16,v13
v_mul_u32_u24 v16,24,v13
v_sub_u32 v12,v12,v16
v_mul_u32_u24 v104,12288,v13
v_lshl_add_u32 v104,v12,4,v104
v_add_u32 v12,64,v0
v_mul_u32_u24 v13,2731,v12
v_lshrrev_b32 v13,16,v13
v_mul_u32_u24 v16,24,v13
v_sub_u32 v12,v12,v16
v_mul_u32_u24 v105,12288,v13
v_lshl_add_u32 v105,v12,4,v105
v_add_u32 v12,128,v0
v_mul_u32_u24 v13,2731,v12
v_lshrrev_b32 v13,16,v13
v_mul_u32_u24 v16,24,v13
v_sub_u32 v12,v12,v16
v_mul_u32_u24 v106,12288,v13
v_lshl_add_u32 v106,v12,4,v106
s_mov_b32 s4,s20
s_mov_b32 s5,s21
s_mov_b32 s6,7864320
s_mov_b32 s7,0x20000
s_mov_b32 s52,s22
s_mov_b32 s53,s23
s_mov_b32 s54,7864320
s_mov_b32 s55,0x20000
s_branch SV_LOAD
ROLE_CV:
s_lshr_b32 s28,s48,3
s_and_b32 s29,s48,7
s_mul_i32 s82,s28,2097152
s_add_u32 s82,s82,2097152
v_lshlrev_b32 v1,4,v0
v_and_b32 v12,1,v0
v_mul_u32_u24 v2,0xaaaa,v12
v_or_b32 v2,0x4444,v2
s_add_u32 s60,s46,1
s_and_b32 s60,s60,3
s_lshl_b32 s60,s60,11
s_add_u32 s60,s60,131072
v_add_u32 v3,s60,v1
s_add_u32 s60,s46,2
s_and_b32 s60,s60,3
s_lshl_b32 s60,s60,11
s_add_u32 s60,s60,131072
v_add_u32 v4,s60,v1
s_add_u32 s60,s46,3
s_and_b32 s60,s60,3
s_lshl_b32 s60,s60,11
s_add_u32 s60,s60,131072
v_add_u32 v5,s60,v1
v_add_u32 v59,139264,v1
s_lshl_b32 s60,s46,11
s_add_u32 s60,s60,131072
v_add_u32 v22,s60,v1
s_lshr_b32 s60,s46,1
s_lshl_b32 s60,s60,10
s_and_b32 s61,s46,1
s_lshl_b32 s61,s61,3
s_add_u32 s60,s60,s61
v_add_u32 v23,s60,v59
s_mul_i32 s60,s46,20480
v_add_u32 v21,s60,v1
v_and_b32 v11,7,v0
v_lshlrev_b32 v11,2,v11
v_bfe_u32 v12,v0,3,2
v_lshl_add_u32 v11,v12,7,v11
s_xor_b32 s60,s28,1
s_lshl_b32 s60,s60,19
s_lshl_b32 s61,s46,11
s_add_u32 s83,s60,s61
s_add_u32 s83,s83,10485760
s_mov_b32 s36,1
v_mov_b32 v8,0
v_mov_b32 v9,0
v_mov_b32 v20,0
s_and_b32 s62,s46,1
s_lshl_b32 s60,s62,11
v_add_u32 v6,s60,v1
s_lshl_b32 s60,s62,3
s_add_u32 s60,s60,1024
v_add_u32 v7,s60,v1
s_lshr_b32 s61,s46,1
s_lshl_b32 s60,s29,1
s_add_u32 s60,s60,s61
s_mul_i32 s60,s60,3072
s_add_u32 s60,s60,s82
s_add_u32 s34,s60,557056
s_lshl_b32 s60,s48,1
s_add_u32 s60,s60,s61
s_mul_i32 s85,s60,6144
s_add_u32 s85,s85,24120320
s_lshl_b32 s86,s60,5
s_lshl_b32 s61,s62,2
s_add_u32 s86,s86,s61
s_add_u32 s86,s86,688132
v_mov_b32 v12,-1
v_mov_b32 v13,-1
v_mov_b32 v14,-1
v_mov_b32 v15,-1
s_cmp_lg_u32 s49,0
s_cbranch_scc1 ls_4
s_add_u32 s60,s34,0
buffer_store_dwordx4 v[12:15],v6,s[8:11],s60 offen
buffer_store_dwordx2 v[12:13],v7,s[8:11],s60 offen
s_add_u32 s60,s34,49152
buffer_store_dwordx4 v[12:15],v6,s[8:11],s60 offen
buffer_store_dwordx2 v[12:13],v7,s[8:11],s60 offen
s_add_u32 s60,s34,98304
buffer_store_dwordx4 v[12:15],v6,s[8:11],s60 offen
buffer_store_dwordx2 v[12:13],v7,s[8:11],s60 offen
s_add_u32 s60,s34,147456
buffer_store_dwordx4 v[12:15],v6,s[8:11],s60 offen
buffer_store_dwordx2 v[12:13],v7,s[8:11],s60 offen
s_add_u32 s60,s34,196608
buffer_store_dwordx4 v[12:15],v6,s[8:11],s60 offen
buffer_store_dwordx2 v[12:13],v7,s[8:11],s60 offen
s_add_u32 s60,s34,245760
buffer_store_dwordx4 v[12:15],v6,s[8:11],s60 offen
buffer_store_dwordx2 v[12:13],v7,s[8:11],s60 offen
s_add_u32 s60,s34,294912
buffer_store_dwordx4 v[12:15],v6,s[8:11],s60 offen
buffer_store_dwordx2 v[12:13],v7,s[8:11],s60 offen
s_add_u32 s60,s34,344064
buffer_store_dwordx4 v[12:15],v6,s[8:11],s60 offen
buffer_store_dwordx2 v[12:13],v7,s[8:11],s60 offen
s_branch ls_5
ls_4:
s_add_u32 s60,s34,0
buffer_store_dwordx4 v[12:15],v6,s[8:11],s60 offen sc1
buffer_store_dwordx2 v[12:13],v7,s[8:11],s60 offen sc1
s_add_u32 s60,s34,49152
buffer_store_dwordx4 v[12:15],v6,s[8:11],s60 offen sc1
buffer_store_dwordx2 v[12:13],v7,s[8:11],s60 offen sc1
s_add_u32 s60,s34,98304
buffer_store_dwordx4 v[12:15],v6,s[8:11],s60 offen sc1
buffer_store_dwordx2 v[12:13],v7,s[8:11],s60 offen sc1
s_add_u32 s60,s34,147456
buffer_store_dwordx4 v[12:15],v6,s[8:11],s60 offen sc1
buffer_store_dwordx2 v[12:13],v7,s[8:11],s60 offen sc1
s_add_u32 s60,s34,196608
buffer_store_dwordx4 v[12:15],v6,s[8:11],s60 offen sc1
buffer_store_dwordx2 v[12:13],v7,s[8:11],s60 offen sc1
s_add_u32 s60,s34,245760
buffer_store_dwordx4 v[12:15],v6,s[8:11],s60 offen sc1
buffer_store_dwordx2 v[12:13],v7,s[8:11],s60 offen sc1
s_add_u32 s60,s34,294912
buffer_store_dwordx4 v[12:15],v6,s[8:11],s60 offen sc1
buffer_store_dwordx2 v[12:13],v7,s[8:11],s60 offen sc1
s_add_u32 s60,s34,344064
buffer_store_dwordx4 v[12:15],v6,s[8:11],s60 offen sc1
buffer_store_dwordx2 v[12:13],v7,s[8:11],s60 offen sc1
s_nop 0
ls_5:
s_mul_i32 s73,s48,768
s_add_u32 s74,s73,96
v_add_u32 v12,0,v0
v_mul_u32_u24 v13,2731,v12
v_lshrrev_b32 v13,16,v13
v_mul_u32_u24 v16,24,v13
v_sub_u32 v12,v12,v16
v_mul_u32_u24 v104,12288,v13
v_lshl_add_u32 v104,v12,4,v104
v_mul_u32_u24 v13,43,v12
v_lshrrev_b32 v13,8,v13
v_mul_u32_u24 v13,96,v13
v_add_u32 v104,v104,v13
v_add_u32 v12,64,v0
v_mul_u32_u24 v13,2731,v12
v_lshrrev_b32 v13,16,v13
v_mul_u32_u24 v16,24,v13
v_sub_u32 v12,v12,v16
v_mul_u32_u24 v105,12288,v13
v_lshl_add_u32 v105,v12,4,v105
v_mul_u32_u24 v13,43,v12
v_lshrrev_b32 v13,8,v13
v_mul_u32_u24 v13,96,v13
v_add_u32 v105,v105,v13
v_add_u32 v12,128,v0
v_mul_u32_u24 v13,2731,v12
v_lshrrev_b32 v13,16,v13
v_mul_u32_u24 v16,24,v13
v_sub_u32 v12,v12,v16
v_mul_u32_u24 v106,12288,v13
v_lshl_add_u32 v106,v12,4,v106
v_mul_u32_u24 v13,43,v12
v_lshrrev_b32 v13,8,v13
v_mul_u32_u24 v13,96,v13
v_add_u32 v106,v106,v13
s_mov_b32 s4,s24
s_mov_b32 s5,s25
s_mov_b32 s6,7864320
s_mov_b32 s7,0x20000
s_mov_b32 s52,s24
s_mov_b32 s53,s25
s_mov_b32 s54,7864320
s_mov_b32 s55,0x20000
SV_LOAD:
s_waitcnt vmcnt(0)
s_barrier
s_cmp_lg_u32 s46,0
s_cbranch_scc1 arr_6
v_mov_b32 v12,1
s_lshl_b32 s3,s49,2
v_mov_b32 v13,s3
s_mov_b64 exec,1
buffer_atomic_add v12,v13,s[12:15],0 offen sc1
s_mov_b64 exec,-1
arr_6:
s_and_b32 s60,s46,1
s_mul_i32 s60,s60,196608
s_lshr_b32 s61,s46,1
s_mul_i32 s75,s61,393216
s_add_u32 s75,s75,s60
s_mul_i32 s76,s61,393216
s_add_u32 s76,s76,s60
s_mul_i32 s77,s46,6144
v_lshrrev_b32 v14,4,v0
v_and_b32 v15,15,v0
v_and_b32 v12,1,v14
v_lshlrev_b32 v12,2,v12
v_lshrrev_b32 v13,1,v14
v_lshl_add_u32 v12,v13,4,v12
v_bfe_u32 v13,v0,2,1
v_add_u32 v12,v12,v13
v_bfe_u32 v13,v0,3,1
v_lshl_add_u32 v12,v13,3,v12
v_mul_u32_u24 v107,384,v12
v_and_b32 v13,3,v0
v_lshl_add_u32 v107,v13,3,v107
s_mul_i32 s60,s46,96
v_add_u32 v107,s60,v107
s_add_u32 s60,s75,s73
s_add_u32 m0,s77,0
s_add_u32 s61,s60,0
buffer_load_dwordx4 v104,s[4:7],s61 offen lds
s_add_u32 m0,s77,1024
s_add_u32 s61,s60,0
buffer_load_dwordx4 v105,s[4:7],s61 offen lds
s_add_u32 m0,s77,2048
s_add_u32 s61,s60,0
buffer_load_dwordx4 v106,s[4:7],s61 offen lds
s_add_u32 m0,s77,3072
s_add_u32 s61,s60,98304
buffer_load_dwordx4 v104,s[4:7],s61 offen lds
s_add_u32 m0,s77,4096
s_add_u32 s61,s60,98304
buffer_load_dwordx4 v105,s[4:7],s61 offen lds
s_add_u32 m0,s77,5120
s_add_u32 s61,s60,98304
buffer_load_dwordx4 v106,s[4:7],s61 offen lds
s_add_u32 s60,s75,s74
s_add_u32 m0,s77,24576
s_add_u32 s61,s60,0
buffer_load_dwordx4 v104,s[52:55],s61 offen lds
s_add_u32 m0,s77,25600
s_add_u32 s61,s60,0
buffer_load_dwordx4 v105,s[52:55],s61 offen lds
s_add_u32 m0,s77,26624
s_add_u32 s61,s60,0
buffer_load_dwordx4 v106,s[52:55],s61 offen lds
s_add_u32 m0,s77,27648
s_add_u32 s61,s60,98304
buffer_load_dwordx4 v104,s[52:55],s61 offen lds
s_add_u32 m0,s77,28672
s_add_u32 s61,s60,98304
buffer_load_dwordx4 v105,s[52:55],s61 offen lds
s_add_u32 m0,s77,29696
s_add_u32 s61,s60,98304
buffer_load_dwordx4 v106,s[52:55],s61 offen lds
s_add_u32 s60,s75,s73
s_add_u32 m0,s77,49152
s_add_u32 s61,s60,786432
buffer_load_dwordx4 v104,s[4:7],s61 offen lds
s_add_u32 m0,s77,50176
s_add_u32 s61,s60,786432
buffer_load_dwordx4 v105,s[4:7],s61 offen lds
s_add_u32 m0,s77,51200
s_add_u32 s61,s60,786432
buffer_load_dwordx4 v106,s[4:7],s61 offen lds
s_add_u32 m0,s77,52224
s_add_u32 s61,s60,884736
buffer_load_dwordx4 v104,s[4:7],s61 offen lds
s_add_u32 m0,s77,53248
s_add_u32 s61,s60,884736
buffer_load_dwordx4 v105,s[4:7],s61 offen lds
s_add_u32 m0,s77,54272
s_add_u32 s61,s60,884736
buffer_load_dwordx4 v106,s[4:7],s61 offen lds
s_add_u32 s60,s75,s74
s_add_u32 m0,s77,73728
s_add_u32 s61,s60,786432
buffer_load_dwordx4 v104,s[52:55],s61 offen lds
s_add_u32 m0,s77,74752
s_add_u32 s61,s60,786432
buffer_load_dwordx4 v105,s[52:55],s61 offen lds
s_add_u32 m0,s77,75776
s_add_u32 s61,s60,786432
buffer_load_dwordx4 v106,s[52:55],s61 offen lds
s_add_u32 m0,s77,76800
s_add_u32 s61,s60,884736
buffer_load_dwordx4 v104,s[52:55],s61 offen lds
s_add_u32 m0,s77,77824
s_add_u32 s61,s60,884736
buffer_load_dwordx4 v105,s[52:55],s61 offen lds
s_add_u32 m0,s77,78848
s_add_u32 s61,s60,884736
buffer_load_dwordx4 v106,s[52:55],s61 offen lds
s_add_u32 s60,s75,s73
s_add_u32 m0,s77,98304
s_add_u32 s61,s60,1572864
buffer_load_dwordx4 v104,s[4:7],s61 offen lds
s_add_u32 m0,s77,99328
s_add_u32 s61,s60,1572864
buffer_load_dwordx4 v105,s[4:7],s61 offen lds
s_add_u32 m0,s77,100352
s_add_u32 s61,s60,1572864
buffer_load_dwordx4 v106,s[4:7],s61 offen lds
s_add_u32 m0,s77,101376
s_add_u32 s61,s60,1671168
buffer_load_dwordx4 v104,s[4:7],s61 offen lds
s_add_u32 m0,s77,102400
s_add_u32 s61,s60,1671168
buffer_load_dwordx4 v105,s[4:7],s61 offen lds
s_add_u32 m0,s77,103424
s_add_u32 s61,s60,1671168
buffer_load_dwordx4 v106,s[4:7],s61 offen lds
s_waitcnt vmcnt(24)
s_barrier
s_add_u32 s60,s75,s74
s_add_u32 m0,s77,122880
s_add_u32 s61,s60,1572864
buffer_load_dwordx4 v104,s[52:55],s61 offen lds
s_add_u32 m0,s77,123904
s_add_u32 s61,s60,1572864
buffer_load_dwordx4 v105,s[52:55],s61 offen lds
s_add_u32 m0,s77,124928
s_add_u32 s61,s60,1572864
buffer_load_dwordx4 v106,s[52:55],s61 offen lds
s_add_u32 m0,s77,125952
s_add_u32 s61,s60,1671168
buffer_load_dwordx4 v104,s[52:55],s61 offen lds
s_add_u32 m0,s77,126976
s_add_u32 s61,s60,1671168
buffer_load_dwordx4 v105,s[52:55],s61 offen lds
s_add_u32 m0,s77,128000
s_add_u32 s61,s60,1671168
buffer_load_dwordx4 v106,s[52:55],s61 offen lds
v_add_u32 v12,0,v107
s_cmp_eq_u32 s46,1
s_cbranch_scc1 lw_9
s_cmp_eq_u32 s46,2
s_cbranch_scc1 lw_10
s_cmp_eq_u32 s46,3
s_cbranch_scc1 lw_11
lw_8:
ds_read_b64_tr_b16 a[0:1],v12 offset:0
ds_read_b64_tr_b16 a[2:3],v12 offset:768
ds_read_b64_tr_b16 a[4:5],v12 offset:12288
ds_read_b64_tr_b16 a[6:7],v12 offset:13056
ds_read_b64_tr_b16 a[8:9],v12 offset:32
ds_read_b64_tr_b16 a[10:11],v12 offset:800
ds_read_b64_tr_b16 a[12:13],v12 offset:12320
ds_read_b64_tr_b16 a[14:15],v12 offset:13088
ds_read_b64_tr_b16 a[16:17],v12 offset:64
ds_read_b64_tr_b16 a[18:19],v12 offset:832
ds_read_b64_tr_b16 a[20:21],v12 offset:12352
ds_read_b64_tr_b16 a[22:23],v12 offset:13120
s_branch ld_7
lw_9:
ds_read_b64_tr_b16 a[240:241],v12 offset:0
ds_read_b64_tr_b16 a[242:243],v12 offset:768
ds_read_b64_tr_b16 a[244:245],v12 offset:12288
ds_read_b64_tr_b16 a[246:247],v12 offset:13056
ds_read_b64_tr_b16 a[248:249],v12 offset:32
ds_read_b64_tr_b16 a[250:251],v12 offset:800
ds_read_b64_tr_b16 a[252:253],v12 offset:12320
ds_read_b64_tr_b16 a[254:255],v12 offset:13088
ds_read_b64_tr_b16 v[112:113],v12 offset:64
ds_read_b64_tr_b16 v[114:115],v12 offset:832
ds_read_b64_tr_b16 v[116:117],v12 offset:12352
ds_read_b64_tr_b16 v[118:119],v12 offset:13120
s_branch ld_7
lw_10:
ds_read_b64_tr_b16 a[160:161],v12 offset:0
ds_read_b64_tr_b16 a[162:163],v12 offset:768
ds_read_b64_tr_b16 a[164:165],v12 offset:12288
ds_read_b64_tr_b16 a[166:167],v12 offset:13056
ds_read_b64_tr_b16 a[168:169],v12 offset:32
ds_read_b64_tr_b16 a[170:171],v12 offset:800
ds_read_b64_tr_b16 a[172:173],v12 offset:12320
ds_read_b64_tr_b16 a[174:175],v12 offset:13088
ds_read_b64_tr_b16 a[176:177],v12 offset:64
ds_read_b64_tr_b16 a[178:179],v12 offset:832
ds_read_b64_tr_b16 a[180:181],v12 offset:12352
ds_read_b64_tr_b16 a[182:183],v12 offset:13120
s_branch ld_7
lw_11:
ds_read_b64_tr_b16 a[80:81],v12 offset:0
ds_read_b64_tr_b16 a[82:83],v12 offset:768
ds_read_b64_tr_b16 a[84:85],v12 offset:12288
ds_read_b64_tr_b16 a[86:87],v12 offset:13056
ds_read_b64_tr_b16 a[88:89],v12 offset:32
ds_read_b64_tr_b16 a[90:91],v12 offset:800
ds_read_b64_tr_b16 a[92:93],v12 offset:12320
ds_read_b64_tr_b16 a[94:95],v12 offset:13088
ds_read_b64_tr_b16 a[96:97],v12 offset:64
ds_read_b64_tr_b16 a[98:99],v12 offset:832
ds_read_b64_tr_b16 a[100:101],v12 offset:12352
ds_read_b64_tr_b16 a[102:103],v12 offset:13120
ld_7:
s_waitcnt lgkmcnt(0)
s_waitcnt vmcnt(24)
s_barrier
s_add_u32 s60,s75,s73
s_add_u32 m0,s77,0
s_add_u32 s61,s60,2359296
buffer_load_dwordx4 v104,s[4:7],s61 offen lds
s_add_u32 m0,s77,1024
s_add_u32 s61,s60,2359296
buffer_load_dwordx4 v105,s[4:7],s61 offen lds
s_add_u32 m0,s77,2048
s_add_u32 s61,s60,2359296
buffer_load_dwordx4 v106,s[4:7],s61 offen lds
s_add_u32 m0,s77,3072
s_add_u32 s61,s60,2457600
buffer_load_dwordx4 v104,s[4:7],s61 offen lds
s_add_u32 m0,s77,4096
s_add_u32 s61,s60,2457600
buffer_load_dwordx4 v105,s[4:7],s61 offen lds
s_add_u32 m0,s77,5120
s_add_u32 s61,s60,2457600
buffer_load_dwordx4 v106,s[4:7],s61 offen lds
v_add_u32 v12,24576,v107
s_cmp_eq_u32 s46,1
s_cbranch_scc1 lw_14
s_cmp_eq_u32 s46,2
s_cbranch_scc1 lw_15
s_cmp_eq_u32 s46,3
s_cbranch_scc1 lw_16
lw_13:
ds_read_b64_tr_b16 a[24:25],v12 offset:0
ds_read_b64_tr_b16 a[26:27],v12 offset:768
ds_read_b64_tr_b16 a[28:29],v12 offset:12288
ds_read_b64_tr_b16 a[30:31],v12 offset:13056
ds_read_b64_tr_b16 a[32:33],v12 offset:32
ds_read_b64_tr_b16 a[34:35],v12 offset:800
ds_read_b64_tr_b16 a[36:37],v12 offset:12320
ds_read_b64_tr_b16 a[38:39],v12 offset:13088
ds_read_b64_tr_b16 v[24:25],v12 offset:64
ds_read_b64_tr_b16 v[26:27],v12 offset:832
ds_read_b64_tr_b16 v[28:29],v12 offset:12352
ds_read_b64_tr_b16 v[30:31],v12 offset:13120
s_branch ld_12
lw_14:
ds_read_b64_tr_b16 v[120:121],v12 offset:0
ds_read_b64_tr_b16 v[122:123],v12 offset:768
ds_read_b64_tr_b16 v[124:125],v12 offset:12288
ds_read_b64_tr_b16 v[126:127],v12 offset:13056
ds_read_b64_tr_b16 v[128:129],v12 offset:32
ds_read_b64_tr_b16 v[130:131],v12 offset:800
ds_read_b64_tr_b16 v[132:133],v12 offset:12320
ds_read_b64_tr_b16 v[134:135],v12 offset:13088
ds_read_b64_tr_b16 v[72:73],v12 offset:64
ds_read_b64_tr_b16 v[74:75],v12 offset:832
ds_read_b64_tr_b16 v[76:77],v12 offset:12352
ds_read_b64_tr_b16 v[78:79],v12 offset:13120
s_branch ld_12
lw_15:
ds_read_b64_tr_b16 a[184:185],v12 offset:0
ds_read_b64_tr_b16 a[186:187],v12 offset:768
ds_read_b64_tr_b16 a[188:189],v12 offset:12288
ds_read_b64_tr_b16 a[190:191],v12 offset:13056
ds_read_b64_tr_b16 a[192:193],v12 offset:32
ds_read_b64_tr_b16 a[194:195],v12 offset:800
ds_read_b64_tr_b16 a[196:197],v12 offset:12320
ds_read_b64_tr_b16 a[198:199],v12 offset:13088
ds_read_b64_tr_b16 v[56:57],v12 offset:64
ds_read_b64_tr_b16 v[58:59],v12 offset:832
ds_read_b64_tr_b16 v[60:61],v12 offset:12352
ds_read_b64_tr_b16 v[62:63],v12 offset:13120
s_branch ld_12
lw_16:
ds_read_b64_tr_b16 a[104:105],v12 offset:0
ds_read_b64_tr_b16 a[106:107],v12 offset:768
ds_read_b64_tr_b16 a[108:109],v12 offset:12288
ds_read_b64_tr_b16 a[110:111],v12 offset:13056
ds_read_b64_tr_b16 a[112:113],v12 offset:32
ds_read_b64_tr_b16 a[114:115],v12 offset:800
ds_read_b64_tr_b16 a[116:117],v12 offset:12320
ds_read_b64_tr_b16 a[118:119],v12 offset:13088
ds_read_b64_tr_b16 v[40:41],v12 offset:64
ds_read_b64_tr_b16 v[42:43],v12 offset:832
ds_read_b64_tr_b16 v[44:45],v12 offset:12352
ds_read_b64_tr_b16 v[46:47],v12 offset:13120
ld_12:
s_waitcnt lgkmcnt(0)
s_waitcnt vmcnt(24)
s_barrier
s_add_u32 s60,s75,s74
s_add_u32 m0,s77,24576
s_add_u32 s61,s60,2359296
buffer_load_dwordx4 v104,s[52:55],s61 offen lds
s_add_u32 m0,s77,25600
s_add_u32 s61,s60,2359296
buffer_load_dwordx4 v105,s[52:55],s61 offen lds
s_add_u32 m0,s77,26624
s_add_u32 s61,s60,2359296
buffer_load_dwordx4 v106,s[52:55],s61 offen lds
s_add_u32 m0,s77,27648
s_add_u32 s61,s60,2457600
buffer_load_dwordx4 v104,s[52:55],s61 offen lds
s_add_u32 m0,s77,28672
s_add_u32 s61,s60,2457600
buffer_load_dwordx4 v105,s[52:55],s61 offen lds
s_add_u32 m0,s77,29696
s_add_u32 s61,s60,2457600
buffer_load_dwordx4 v106,s[52:55],s61 offen lds
v_add_u32 v12,49152,v107
s_cmp_eq_u32 s46,1
s_cbranch_scc1 lw_19
s_cmp_eq_u32 s46,2
s_cbranch_scc1 lw_20
s_cmp_eq_u32 s46,3
s_cbranch_scc1 lw_21
lw_18:
ds_read_b64_tr_b16 a[40:41],v12 offset:0
ds_read_b64_tr_b16 a[42:43],v12 offset:768
ds_read_b64_tr_b16 a[44:45],v12 offset:12288
ds_read_b64_tr_b16 a[46:47],v12 offset:13056
ds_read_b64_tr_b16 a[48:49],v12 offset:32
ds_read_b64_tr_b16 a[50:51],v12 offset:800
ds_read_b64_tr_b16 a[52:53],v12 offset:12320
ds_read_b64_tr_b16 a[54:55],v12 offset:13088
ds_read_b64_tr_b16 a[56:57],v12 offset:64
ds_read_b64_tr_b16 a[58:59],v12 offset:832
ds_read_b64_tr_b16 a[60:61],v12 offset:12352
ds_read_b64_tr_b16 a[62:63],v12 offset:13120
s_branch ld_17
lw_19:
ds_read_b64_tr_b16 v[136:137],v12 offset:0
ds_read_b64_tr_b16 v[138:139],v12 offset:768
ds_read_b64_tr_b16 v[140:141],v12 offset:12288
ds_read_b64_tr_b16 v[142:143],v12 offset:13056
ds_read_b64_tr_b16 v[144:145],v12 offset:32
ds_read_b64_tr_b16 v[146:147],v12 offset:800
ds_read_b64_tr_b16 v[148:149],v12 offset:12320
ds_read_b64_tr_b16 v[150:151],v12 offset:13088
ds_read_b64_tr_b16 v[152:153],v12 offset:64
ds_read_b64_tr_b16 v[154:155],v12 offset:832
ds_read_b64_tr_b16 v[156:157],v12 offset:12352
ds_read_b64_tr_b16 v[158:159],v12 offset:13120
s_branch ld_17
lw_20:
ds_read_b64_tr_b16 a[200:201],v12 offset:0
ds_read_b64_tr_b16 a[202:203],v12 offset:768
ds_read_b64_tr_b16 a[204:205],v12 offset:12288
ds_read_b64_tr_b16 a[206:207],v12 offset:13056
ds_read_b64_tr_b16 a[208:209],v12 offset:32
ds_read_b64_tr_b16 a[210:211],v12 offset:800
ds_read_b64_tr_b16 a[212:213],v12 offset:12320
ds_read_b64_tr_b16 a[214:215],v12 offset:13088
ds_read_b64_tr_b16 a[216:217],v12 offset:64
ds_read_b64_tr_b16 a[218:219],v12 offset:832
ds_read_b64_tr_b16 a[220:221],v12 offset:12352
ds_read_b64_tr_b16 a[222:223],v12 offset:13120
s_branch ld_17
lw_21:
ds_read_b64_tr_b16 a[120:121],v12 offset:0
ds_read_b64_tr_b16 a[122:123],v12 offset:768
ds_read_b64_tr_b16 a[124:125],v12 offset:12288
ds_read_b64_tr_b16 a[126:127],v12 offset:13056
ds_read_b64_tr_b16 a[128:129],v12 offset:32
ds_read_b64_tr_b16 a[130:131],v12 offset:800
ds_read_b64_tr_b16 a[132:133],v12 offset:12320
ds_read_b64_tr_b16 a[134:135],v12 offset:13088
ds_read_b64_tr_b16 a[136:137],v12 offset:64
ds_read_b64_tr_b16 a[138:139],v12 offset:832
ds_read_b64_tr_b16 a[140:141],v12 offset:12352
ds_read_b64_tr_b16 a[142:143],v12 offset:13120
ld_17:
s_waitcnt lgkmcnt(0)
s_waitcnt vmcnt(24)
s_barrier
s_add_u32 s60,s75,s73
s_add_u32 m0,s77,49152
s_add_u32 s61,s60,3145728
buffer_load_dwordx4 v104,s[4:7],s61 offen lds
s_add_u32 m0,s77,50176
s_add_u32 s61,s60,3145728
buffer_load_dwordx4 v105,s[4:7],s61 offen lds
s_add_u32 m0,s77,51200
s_add_u32 s61,s60,3145728
buffer_load_dwordx4 v106,s[4:7],s61 offen lds
s_add_u32 m0,s77,52224
s_add_u32 s61,s60,3244032
buffer_load_dwordx4 v104,s[4:7],s61 offen lds
s_add_u32 m0,s77,53248
s_add_u32 s61,s60,3244032
buffer_load_dwordx4 v105,s[4:7],s61 offen lds
s_add_u32 m0,s77,54272
s_add_u32 s61,s60,3244032
buffer_load_dwordx4 v106,s[4:7],s61 offen lds
v_add_u32 v12,73728,v107
s_cmp_eq_u32 s46,1
s_cbranch_scc1 lw_24
s_cmp_eq_u32 s46,2
s_cbranch_scc1 lw_25
s_cmp_eq_u32 s46,3
s_cbranch_scc1 lw_26
lw_23:
ds_read_b64_tr_b16 a[64:65],v12 offset:0
ds_read_b64_tr_b16 a[66:67],v12 offset:768
ds_read_b64_tr_b16 a[68:69],v12 offset:12288
ds_read_b64_tr_b16 a[70:71],v12 offset:13056
ds_read_b64_tr_b16 a[72:73],v12 offset:32
ds_read_b64_tr_b16 a[74:75],v12 offset:800
ds_read_b64_tr_b16 a[76:77],v12 offset:12320
ds_read_b64_tr_b16 a[78:79],v12 offset:13088
ds_read_b64_tr_b16 v[32:33],v12 offset:64
ds_read_b64_tr_b16 v[34:35],v12 offset:832
ds_read_b64_tr_b16 v[36:37],v12 offset:12352
ds_read_b64_tr_b16 v[38:39],v12 offset:13120
s_branch ld_22
lw_24:
ds_read_b64_tr_b16 v[160:161],v12 offset:0
ds_read_b64_tr_b16 v[162:163],v12 offset:768
ds_read_b64_tr_b16 v[164:165],v12 offset:12288
ds_read_b64_tr_b16 v[166:167],v12 offset:13056
ds_read_b64_tr_b16 v[168:169],v12 offset:32
ds_read_b64_tr_b16 v[170:171],v12 offset:800
ds_read_b64_tr_b16 v[172:173],v12 offset:12320
ds_read_b64_tr_b16 v[174:175],v12 offset:13088
ds_read_b64_tr_b16 v[80:81],v12 offset:64
ds_read_b64_tr_b16 v[82:83],v12 offset:832
ds_read_b64_tr_b16 v[84:85],v12 offset:12352
ds_read_b64_tr_b16 v[86:87],v12 offset:13120
s_branch ld_22
lw_25:
ds_read_b64_tr_b16 a[224:225],v12 offset:0
ds_read_b64_tr_b16 a[226:227],v12 offset:768
ds_read_b64_tr_b16 a[228:229],v12 offset:12288
ds_read_b64_tr_b16 a[230:231],v12 offset:13056
ds_read_b64_tr_b16 a[232:233],v12 offset:32
ds_read_b64_tr_b16 a[234:235],v12 offset:800
ds_read_b64_tr_b16 a[236:237],v12 offset:12320
ds_read_b64_tr_b16 a[238:239],v12 offset:13088
ds_read_b64_tr_b16 v[64:65],v12 offset:64
ds_read_b64_tr_b16 v[66:67],v12 offset:832
ds_read_b64_tr_b16 v[68:69],v12 offset:12352
ds_read_b64_tr_b16 v[70:71],v12 offset:13120
s_branch ld_22
lw_26:
ds_read_b64_tr_b16 a[144:145],v12 offset:0
ds_read_b64_tr_b16 a[146:147],v12 offset:768
ds_read_b64_tr_b16 a[148:149],v12 offset:12288
ds_read_b64_tr_b16 a[150:151],v12 offset:13056
ds_read_b64_tr_b16 a[152:153],v12 offset:32
ds_read_b64_tr_b16 a[154:155],v12 offset:800
ds_read_b64_tr_b16 a[156:157],v12 offset:12320
ds_read_b64_tr_b16 a[158:159],v12 offset:13088
ds_read_b64_tr_b16 v[48:49],v12 offset:64
ds_read_b64_tr_b16 v[50:51],v12 offset:832
ds_read_b64_tr_b16 v[52:53],v12 offset:12352
ds_read_b64_tr_b16 v[54:55],v12 offset:13120
ld_22:
s_waitcnt lgkmcnt(0)
s_waitcnt vmcnt(24)
s_barrier
s_add_u32 s60,s75,s74
s_add_u32 m0,s77,73728
s_add_u32 s61,s60,3145728
buffer_load_dwordx4 v104,s[52:55],s61 offen lds
s_add_u32 m0,s77,74752
s_add_u32 s61,s60,3145728
buffer_load_dwordx4 v105,s[52:55],s61 offen lds
s_add_u32 m0,s77,75776
s_add_u32 s61,s60,3145728
buffer_load_dwordx4 v106,s[52:55],s61 offen lds
s_add_u32 m0,s77,76800
s_add_u32 s61,s60,3244032
buffer_load_dwordx4 v104,s[52:55],s61 offen lds
s_add_u32 m0,s77,77824
s_add_u32 s61,s60,3244032
buffer_load_dwordx4 v105,s[52:55],s61 offen lds
s_add_u32 m0,s77,78848
s_add_u32 s61,s60,3244032
buffer_load_dwordx4 v106,s[52:55],s61 offen lds
v_add_u32 v12,98304,v107
s_cmp_eq_u32 s46,1
s_cbranch_scc1 lw_29
s_cmp_eq_u32 s46,2
s_cbranch_scc1 lw_30
s_cmp_eq_u32 s46,3
s_cbranch_scc1 lw_31
lw_28:
ds_read_b64_tr_b16 a[80:81],v12 offset:0
ds_read_b64_tr_b16 a[82:83],v12 offset:768
ds_read_b64_tr_b16 a[84:85],v12 offset:12288
ds_read_b64_tr_b16 a[86:87],v12 offset:13056
ds_read_b64_tr_b16 a[88:89],v12 offset:32
ds_read_b64_tr_b16 a[90:91],v12 offset:800
ds_read_b64_tr_b16 a[92:93],v12 offset:12320
ds_read_b64_tr_b16 a[94:95],v12 offset:13088
ds_read_b64_tr_b16 a[96:97],v12 offset:64
ds_read_b64_tr_b16 a[98:99],v12 offset:832
ds_read_b64_tr_b16 a[100:101],v12 offset:12352
ds_read_b64_tr_b16 a[102:103],v12 offset:13120
s_branch ld_27
lw_29:
ds_read_b64_tr_b16 a[0:1],v12 offset:0
ds_read_b64_tr_b16 a[2:3],v12 offset:768
ds_read_b64_tr_b16 a[4:5],v12 offset:12288
ds_read_b64_tr_b16 a[6:7],v12 offset:13056
ds_read_b64_tr_b16 a[8:9],v12 offset:32
ds_read_b64_tr_b16 a[10:11],v12 offset:800
ds_read_b64_tr_b16 a[12:13],v12 offset:12320
ds_read_b64_tr_b16 a[14:15],v12 offset:13088
ds_read_b64_tr_b16 a[16:17],v12 offset:64
ds_read_b64_tr_b16 a[18:19],v12 offset:832
ds_read_b64_tr_b16 a[20:21],v12 offset:12352
ds_read_b64_tr_b16 a[22:23],v12 offset:13120
s_branch ld_27
lw_30:
ds_read_b64_tr_b16 a[240:241],v12 offset:0
ds_read_b64_tr_b16 a[242:243],v12 offset:768
ds_read_b64_tr_b16 a[244:245],v12 offset:12288
ds_read_b64_tr_b16 a[246:247],v12 offset:13056
ds_read_b64_tr_b16 a[248:249],v12 offset:32
ds_read_b64_tr_b16 a[250:251],v12 offset:800
ds_read_b64_tr_b16 a[252:253],v12 offset:12320
ds_read_b64_tr_b16 a[254:255],v12 offset:13088
ds_read_b64_tr_b16 v[112:113],v12 offset:64
ds_read_b64_tr_b16 v[114:115],v12 offset:832
ds_read_b64_tr_b16 v[116:117],v12 offset:12352
ds_read_b64_tr_b16 v[118:119],v12 offset:13120
s_branch ld_27
lw_31:
ds_read_b64_tr_b16 a[160:161],v12 offset:0
ds_read_b64_tr_b16 a[162:163],v12 offset:768
ds_read_b64_tr_b16 a[164:165],v12 offset:12288
ds_read_b64_tr_b16 a[166:167],v12 offset:13056
ds_read_b64_tr_b16 a[168:169],v12 offset:32
ds_read_b64_tr_b16 a[170:171],v12 offset:800
ds_read_b64_tr_b16 a[172:173],v12 offset:12320
ds_read_b64_tr_b16 a[174:175],v12 offset:13088
ds_read_b64_tr_b16 a[176:177],v12 offset:64
ds_read_b64_tr_b16 a[178:179],v12 offset:832
ds_read_b64_tr_b16 a[180:181],v12 offset:12352
ds_read_b64_tr_b16 a[182:183],v12 offset:13120
ld_27:
s_waitcnt lgkmcnt(0)
s_waitcnt vmcnt(24)
s_barrier
s_add_u32 s60,s75,s73
s_add_u32 m0,s77,98304
s_add_u32 s61,s60,3932160
buffer_load_dwordx4 v104,s[4:7],s61 offen lds
s_add_u32 m0,s77,99328
s_add_u32 s61,s60,3932160
buffer_load_dwordx4 v105,s[4:7],s61 offen lds
s_add_u32 m0,s77,100352
s_add_u32 s61,s60,3932160
buffer_load_dwordx4 v106,s[4:7],s61 offen lds
s_add_u32 m0,s77,101376
s_add_u32 s61,s60,4030464
buffer_load_dwordx4 v104,s[4:7],s61 offen lds
s_add_u32 m0,s77,102400
s_add_u32 s61,s60,4030464
buffer_load_dwordx4 v105,s[4:7],s61 offen lds
s_add_u32 m0,s77,103424
s_add_u32 s61,s60,4030464
buffer_load_dwordx4 v106,s[4:7],s61 offen lds
v_add_u32 v12,122880,v107
s_cmp_eq_u32 s46,1
s_cbranch_scc1 lw_34
s_cmp_eq_u32 s46,2
s_cbranch_scc1 lw_35
s_cmp_eq_u32 s46,3
s_cbranch_scc1 lw_36
lw_33:
ds_read_b64_tr_b16 a[104:105],v12 offset:0
ds_read_b64_tr_b16 a[106:107],v12 offset:768
ds_read_b64_tr_b16 a[108:109],v12 offset:12288
ds_read_b64_tr_b16 a[110:111],v12 offset:13056
ds_read_b64_tr_b16 a[112:113],v12 offset:32
ds_read_b64_tr_b16 a[114:115],v12 offset:800
ds_read_b64_tr_b16 a[116:117],v12 offset:12320
ds_read_b64_tr_b16 a[118:119],v12 offset:13088
ds_read_b64_tr_b16 v[40:41],v12 offset:64
ds_read_b64_tr_b16 v[42:43],v12 offset:832
ds_read_b64_tr_b16 v[44:45],v12 offset:12352
ds_read_b64_tr_b16 v[46:47],v12 offset:13120
s_branch ld_32
lw_34:
ds_read_b64_tr_b16 a[24:25],v12 offset:0
ds_read_b64_tr_b16 a[26:27],v12 offset:768
ds_read_b64_tr_b16 a[28:29],v12 offset:12288
ds_read_b64_tr_b16 a[30:31],v12 offset:13056
ds_read_b64_tr_b16 a[32:33],v12 offset:32
ds_read_b64_tr_b16 a[34:35],v12 offset:800
ds_read_b64_tr_b16 a[36:37],v12 offset:12320
ds_read_b64_tr_b16 a[38:39],v12 offset:13088
ds_read_b64_tr_b16 v[24:25],v12 offset:64
ds_read_b64_tr_b16 v[26:27],v12 offset:832
ds_read_b64_tr_b16 v[28:29],v12 offset:12352
ds_read_b64_tr_b16 v[30:31],v12 offset:13120
s_branch ld_32
lw_35:
ds_read_b64_tr_b16 v[120:121],v12 offset:0
ds_read_b64_tr_b16 v[122:123],v12 offset:768
ds_read_b64_tr_b16 v[124:125],v12 offset:12288
ds_read_b64_tr_b16 v[126:127],v12 offset:13056
ds_read_b64_tr_b16 v[128:129],v12 offset:32
ds_read_b64_tr_b16 v[130:131],v12 offset:800
ds_read_b64_tr_b16 v[132:133],v12 offset:12320
ds_read_b64_tr_b16 v[134:135],v12 offset:13088
ds_read_b64_tr_b16 v[72:73],v12 offset:64
ds_read_b64_tr_b16 v[74:75],v12 offset:832
ds_read_b64_tr_b16 v[76:77],v12 offset:12352
ds_read_b64_tr_b16 v[78:79],v12 offset:13120
s_branch ld_32
lw_36:
ds_read_b64_tr_b16 a[184:185],v12 offset:0
ds_read_b64_tr_b16 a[186:187],v12 offset:768
ds_read_b64_tr_b16 a[188:189],v12 offset:12288
ds_read_b64_tr_b16 a[190:191],v12 offset:13056
ds_read_b64_tr_b16 a[192:193],v12 offset:32
ds_read_b64_tr_b16 a[194:195],v12 offset:800
ds_read_b64_tr_b16 a[196:197],v12 offset:12320
ds_read_b64_tr_b16 a[198:199],v12 offset:13088
ds_read_b64_tr_b16 v[56:57],v12 offset:64
ds_read_b64_tr_b16 v[58:59],v12 offset:832
ds_read_b64_tr_b16 v[60:61],v12 offset:12352
ds_read_b64_tr_b16 v[62:63],v12 offset:13120
ld_32:
s_waitcnt lgkmcnt(0)
s_waitcnt vmcnt(24)
s_barrier
s_add_u32 s60,s75,s74
s_add_u32 m0,s77,122880
s_add_u32 s61,s60,3932160
buffer_load_dwordx4 v104,s[52:55],s61 offen lds
s_add_u32 m0,s77,123904
s_add_u32 s61,s60,3932160
buffer_load_dwordx4 v105,s[52:55],s61 offen lds
s_add_u32 m0,s77,124928
s_add_u32 s61,s60,3932160
buffer_load_dwordx4 v106,s[52:55],s61 offen lds
s_add_u32 m0,s77,125952
s_add_u32 s61,s60,4030464
buffer_load_dwordx4 v104,s[52:55],s61 offen lds
s_add_u32 m0,s77,126976
s_add_u32 s61,s60,4030464
buffer_load_dwordx4 v105,s[52:55],s61 offen lds
s_add_u32 m0,s77,128000
s_add_u32 s61,s60,4030464
buffer_load_dwordx4 v106,s[52:55],s61 offen lds
v_add_u32 v12,0,v107
s_cmp_eq_u32 s46,1
s_cbranch_scc1 lw_39
s_cmp_eq_u32 s46,2
s_cbranch_scc1 lw_40
s_cmp_eq_u32 s46,3
s_cbranch_scc1 lw_41
lw_38:
ds_read_b64_tr_b16 a[120:121],v12 offset:0
ds_read_b64_tr_b16 a[122:123],v12 offset:768
ds_read_b64_tr_b16 a[124:125],v12 offset:12288
ds_read_b64_tr_b16 a[126:127],v12 offset:13056
ds_read_b64_tr_b16 a[128:129],v12 offset:32
ds_read_b64_tr_b16 a[130:131],v12 offset:800
ds_read_b64_tr_b16 a[132:133],v12 offset:12320
ds_read_b64_tr_b16 a[134:135],v12 offset:13088
ds_read_b64_tr_b16 a[136:137],v12 offset:64
ds_read_b64_tr_b16 a[138:139],v12 offset:832
ds_read_b64_tr_b16 a[140:141],v12 offset:12352
ds_read_b64_tr_b16 a[142:143],v12 offset:13120
s_branch ld_37
lw_39:
ds_read_b64_tr_b16 a[40:41],v12 offset:0
ds_read_b64_tr_b16 a[42:43],v12 offset:768
ds_read_b64_tr_b16 a[44:45],v12 offset:12288
ds_read_b64_tr_b16 a[46:47],v12 offset:13056
ds_read_b64_tr_b16 a[48:49],v12 offset:32
ds_read_b64_tr_b16 a[50:51],v12 offset:800
ds_read_b64_tr_b16 a[52:53],v12 offset:12320
ds_read_b64_tr_b16 a[54:55],v12 offset:13088
ds_read_b64_tr_b16 a[56:57],v12 offset:64
ds_read_b64_tr_b16 a[58:59],v12 offset:832
ds_read_b64_tr_b16 a[60:61],v12 offset:12352
ds_read_b64_tr_b16 a[62:63],v12 offset:13120
s_branch ld_37
lw_40:
ds_read_b64_tr_b16 v[136:137],v12 offset:0
ds_read_b64_tr_b16 v[138:139],v12 offset:768
ds_read_b64_tr_b16 v[140:141],v12 offset:12288
ds_read_b64_tr_b16 v[142:143],v12 offset:13056
ds_read_b64_tr_b16 v[144:145],v12 offset:32
ds_read_b64_tr_b16 v[146:147],v12 offset:800
ds_read_b64_tr_b16 v[148:149],v12 offset:12320
ds_read_b64_tr_b16 v[150:151],v12 offset:13088
ds_read_b64_tr_b16 v[152:153],v12 offset:64
ds_read_b64_tr_b16 v[154:155],v12 offset:832
ds_read_b64_tr_b16 v[156:157],v12 offset:12352
ds_read_b64_tr_b16 v[158:159],v12 offset:13120
s_branch ld_37
lw_41:
ds_read_b64_tr_b16 a[200:201],v12 offset:0
ds_read_b64_tr_b16 a[202:203],v12 offset:768
ds_read_b64_tr_b16 a[204:205],v12 offset:12288
ds_read_b64_tr_b16 a[206:207],v12 offset:13056
ds_read_b64_tr_b16 a[208:209],v12 offset:32
ds_read_b64_tr_b16 a[210:211],v12 offset:800
ds_read_b64_tr_b16 a[212:213],v12 offset:12320
ds_read_b64_tr_b16 a[214:215],v12 offset:13088
ds_read_b64_tr_b16 a[216:217],v12 offset:64
ds_read_b64_tr_b16 a[218:219],v12 offset:832
ds_read_b64_tr_b16 a[220:221],v12 offset:12352
ds_read_b64_tr_b16 a[222:223],v12 offset:13120
ld_37:
s_waitcnt lgkmcnt(0)
s_waitcnt vmcnt(24)
s_barrier
s_add_u32 s60,s75,s73
s_add_u32 m0,s77,0
s_add_u32 s61,s60,4718592
buffer_load_dwordx4 v104,s[4:7],s61 offen lds
s_add_u32 m0,s77,1024
s_add_u32 s61,s60,4718592
buffer_load_dwordx4 v105,s[4:7],s61 offen lds
s_add_u32 m0,s77,2048
s_add_u32 s61,s60,4718592
buffer_load_dwordx4 v106,s[4:7],s61 offen lds
s_add_u32 m0,s77,3072
s_add_u32 s61,s60,4816896
buffer_load_dwordx4 v104,s[4:7],s61 offen lds
s_add_u32 m0,s77,4096
s_add_u32 s61,s60,4816896
buffer_load_dwordx4 v105,s[4:7],s61 offen lds
s_add_u32 m0,s77,5120
s_add_u32 s61,s60,4816896
buffer_load_dwordx4 v106,s[4:7],s61 offen lds
v_add_u32 v12,24576,v107
s_cmp_eq_u32 s46,1
s_cbranch_scc1 lw_44
s_cmp_eq_u32 s46,2
s_cbranch_scc1 lw_45
s_cmp_eq_u32 s46,3
s_cbranch_scc1 lw_46
lw_43:
ds_read_b64_tr_b16 a[144:145],v12 offset:0
ds_read_b64_tr_b16 a[146:147],v12 offset:768
ds_read_b64_tr_b16 a[148:149],v12 offset:12288
ds_read_b64_tr_b16 a[150:151],v12 offset:13056
ds_read_b64_tr_b16 a[152:153],v12 offset:32
ds_read_b64_tr_b16 a[154:155],v12 offset:800
ds_read_b64_tr_b16 a[156:157],v12 offset:12320
ds_read_b64_tr_b16 a[158:159],v12 offset:13088
ds_read_b64_tr_b16 v[48:49],v12 offset:64
ds_read_b64_tr_b16 v[50:51],v12 offset:832
ds_read_b64_tr_b16 v[52:53],v12 offset:12352
ds_read_b64_tr_b16 v[54:55],v12 offset:13120
s_branch ld_42
lw_44:
ds_read_b64_tr_b16 a[64:65],v12 offset:0
ds_read_b64_tr_b16 a[66:67],v12 offset:768
ds_read_b64_tr_b16 a[68:69],v12 offset:12288
ds_read_b64_tr_b16 a[70:71],v12 offset:13056
ds_read_b64_tr_b16 a[72:73],v12 offset:32
ds_read_b64_tr_b16 a[74:75],v12 offset:800
ds_read_b64_tr_b16 a[76:77],v12 offset:12320
ds_read_b64_tr_b16 a[78:79],v12 offset:13088
ds_read_b64_tr_b16 v[32:33],v12 offset:64
ds_read_b64_tr_b16 v[34:35],v12 offset:832
ds_read_b64_tr_b16 v[36:37],v12 offset:12352
ds_read_b64_tr_b16 v[38:39],v12 offset:13120
s_branch ld_42
lw_45:
ds_read_b64_tr_b16 v[160:161],v12 offset:0
ds_read_b64_tr_b16 v[162:163],v12 offset:768
ds_read_b64_tr_b16 v[164:165],v12 offset:12288
ds_read_b64_tr_b16 v[166:167],v12 offset:13056
ds_read_b64_tr_b16 v[168:169],v12 offset:32
ds_read_b64_tr_b16 v[170:171],v12 offset:800
ds_read_b64_tr_b16 v[172:173],v12 offset:12320
ds_read_b64_tr_b16 v[174:175],v12 offset:13088
ds_read_b64_tr_b16 v[80:81],v12 offset:64
ds_read_b64_tr_b16 v[82:83],v12 offset:832
ds_read_b64_tr_b16 v[84:85],v12 offset:12352
ds_read_b64_tr_b16 v[86:87],v12 offset:13120
s_branch ld_42
lw_46:
ds_read_b64_tr_b16 a[224:225],v12 offset:0
ds_read_b64_tr_b16 a[226:227],v12 offset:768
ds_read_b64_tr_b16 a[228:229],v12 offset:12288
ds_read_b64_tr_b16 a[230:231],v12 offset:13056
ds_read_b64_tr_b16 a[232:233],v12 offset:32
ds_read_b64_tr_b16 a[234:235],v12 offset:800
ds_read_b64_tr_b16 a[236:237],v12 offset:12320
ds_read_b64_tr_b16 a[238:239],v12 offset:13088
ds_read_b64_tr_b16 v[64:65],v12 offset:64
ds_read_b64_tr_b16 v[66:67],v12 offset:832
ds_read_b64_tr_b16 v[68:69],v12 offset:12352
ds_read_b64_tr_b16 v[70:71],v12 offset:13120
ld_42:
s_waitcnt lgkmcnt(0)
s_waitcnt vmcnt(24)
s_barrier
s_add_u32 s60,s75,s74
s_add_u32 m0,s77,24576
s_add_u32 s61,s60,4718592
buffer_load_dwordx4 v104,s[52:55],s61 offen lds
s_add_u32 m0,s77,25600
s_add_u32 s61,s60,4718592
buffer_load_dwordx4 v105,s[52:55],s61 offen lds
s_add_u32 m0,s77,26624
s_add_u32 s61,s60,4718592
buffer_load_dwordx4 v106,s[52:55],s61 offen lds
s_add_u32 m0,s77,27648
s_add_u32 s61,s60,4816896
buffer_load_dwordx4 v104,s[52:55],s61 offen lds
s_add_u32 m0,s77,28672
s_add_u32 s61,s60,4816896
buffer_load_dwordx4 v105,s[52:55],s61 offen lds
s_add_u32 m0,s77,29696
s_add_u32 s61,s60,4816896
buffer_load_dwordx4 v106,s[52:55],s61 offen lds
v_add_u32 v12,49152,v107
s_cmp_eq_u32 s46,1
s_cbranch_scc1 lw_49
s_cmp_eq_u32 s46,2
s_cbranch_scc1 lw_50
s_cmp_eq_u32 s46,3
s_cbranch_scc1 lw_51
lw_48:
ds_read_b64_tr_b16 a[160:161],v12 offset:0
ds_read_b64_tr_b16 a[162:163],v12 offset:768
ds_read_b64_tr_b16 a[164:165],v12 offset:12288
ds_read_b64_tr_b16 a[166:167],v12 offset:13056
ds_read_b64_tr_b16 a[168:169],v12 offset:32
ds_read_b64_tr_b16 a[170:171],v12 offset:800
ds_read_b64_tr_b16 a[172:173],v12 offset:12320
ds_read_b64_tr_b16 a[174:175],v12 offset:13088
ds_read_b64_tr_b16 a[176:177],v12 offset:64
ds_read_b64_tr_b16 a[178:179],v12 offset:832
ds_read_b64_tr_b16 a[180:181],v12 offset:12352
ds_read_b64_tr_b16 a[182:183],v12 offset:13120
s_branch ld_47
lw_49:
ds_read_b64_tr_b16 a[80:81],v12 offset:0
ds_read_b64_tr_b16 a[82:83],v12 offset:768
ds_read_b64_tr_b16 a[84:85],v12 offset:12288
ds_read_b64_tr_b16 a[86:87],v12 offset:13056
ds_read_b64_tr_b16 a[88:89],v12 offset:32
ds_read_b64_tr_b16 a[90:91],v12 offset:800
ds_read_b64_tr_b16 a[92:93],v12 offset:12320
ds_read_b64_tr_b16 a[94:95],v12 offset:13088
ds_read_b64_tr_b16 a[96:97],v12 offset:64
ds_read_b64_tr_b16 a[98:99],v12 offset:832
ds_read_b64_tr_b16 a[100:101],v12 offset:12352
ds_read_b64_tr_b16 a[102:103],v12 offset:13120
s_branch ld_47
lw_50:
ds_read_b64_tr_b16 a[0:1],v12 offset:0
ds_read_b64_tr_b16 a[2:3],v12 offset:768
ds_read_b64_tr_b16 a[4:5],v12 offset:12288
ds_read_b64_tr_b16 a[6:7],v12 offset:13056
ds_read_b64_tr_b16 a[8:9],v12 offset:32
ds_read_b64_tr_b16 a[10:11],v12 offset:800
ds_read_b64_tr_b16 a[12:13],v12 offset:12320
ds_read_b64_tr_b16 a[14:15],v12 offset:13088
ds_read_b64_tr_b16 a[16:17],v12 offset:64
ds_read_b64_tr_b16 a[18:19],v12 offset:832
ds_read_b64_tr_b16 a[20:21],v12 offset:12352
ds_read_b64_tr_b16 a[22:23],v12 offset:13120
s_branch ld_47
lw_51:
ds_read_b64_tr_b16 a[240:241],v12 offset:0
ds_read_b64_tr_b16 a[242:243],v12 offset:768
ds_read_b64_tr_b16 a[244:245],v12 offset:12288
ds_read_b64_tr_b16 a[246:247],v12 offset:13056
ds_read_b64_tr_b16 a[248:249],v12 offset:32
ds_read_b64_tr_b16 a[250:251],v12 offset:800
ds_read_b64_tr_b16 a[252:253],v12 offset:12320
ds_read_b64_tr_b16 a[254:255],v12 offset:13088
ds_read_b64_tr_b16 v[112:113],v12 offset:64
ds_read_b64_tr_b16 v[114:115],v12 offset:832
ds_read_b64_tr_b16 v[116:117],v12 offset:12352
ds_read_b64_tr_b16 v[118:119],v12 offset:13120
ld_47:
s_waitcnt lgkmcnt(0)
s_waitcnt vmcnt(24)
s_barrier
s_add_u32 s60,s75,s73
s_add_u32 m0,s77,49152
s_add_u32 s61,s60,5505024
buffer_load_dwordx4 v104,s[4:7],s61 offen lds
s_add_u32 m0,s77,50176
s_add_u32 s61,s60,5505024
buffer_load_dwordx4 v105,s[4:7],s61 offen lds
s_add_u32 m0,s77,51200
s_add_u32 s61,s60,5505024
buffer_load_dwordx4 v106,s[4:7],s61 offen lds
s_add_u32 m0,s77,52224
s_add_u32 s61,s60,5603328
buffer_load_dwordx4 v104,s[4:7],s61 offen lds
s_add_u32 m0,s77,53248
s_add_u32 s61,s60,5603328
buffer_load_dwordx4 v105,s[4:7],s61 offen lds
s_add_u32 m0,s77,54272
s_add_u32 s61,s60,5603328
buffer_load_dwordx4 v106,s[4:7],s61 offen lds
v_add_u32 v12,73728,v107
s_cmp_eq_u32 s46,1
s_cbranch_scc1 lw_54
s_cmp_eq_u32 s46,2
s_cbranch_scc1 lw_55
s_cmp_eq_u32 s46,3
s_cbranch_scc1 lw_56
lw_53:
ds_read_b64_tr_b16 a[184:185],v12 offset:0
ds_read_b64_tr_b16 a[186:187],v12 offset:768
ds_read_b64_tr_b16 a[188:189],v12 offset:12288
ds_read_b64_tr_b16 a[190:191],v12 offset:13056
ds_read_b64_tr_b16 a[192:193],v12 offset:32
ds_read_b64_tr_b16 a[194:195],v12 offset:800
ds_read_b64_tr_b16 a[196:197],v12 offset:12320
ds_read_b64_tr_b16 a[198:199],v12 offset:13088
ds_read_b64_tr_b16 v[56:57],v12 offset:64
ds_read_b64_tr_b16 v[58:59],v12 offset:832
ds_read_b64_tr_b16 v[60:61],v12 offset:12352
ds_read_b64_tr_b16 v[62:63],v12 offset:13120
s_branch ld_52
lw_54:
ds_read_b64_tr_b16 a[104:105],v12 offset:0
ds_read_b64_tr_b16 a[106:107],v12 offset:768
ds_read_b64_tr_b16 a[108:109],v12 offset:12288
ds_read_b64_tr_b16 a[110:111],v12 offset:13056
ds_read_b64_tr_b16 a[112:113],v12 offset:32
ds_read_b64_tr_b16 a[114:115],v12 offset:800
ds_read_b64_tr_b16 a[116:117],v12 offset:12320
ds_read_b64_tr_b16 a[118:119],v12 offset:13088
ds_read_b64_tr_b16 v[40:41],v12 offset:64
ds_read_b64_tr_b16 v[42:43],v12 offset:832
ds_read_b64_tr_b16 v[44:45],v12 offset:12352
ds_read_b64_tr_b16 v[46:47],v12 offset:13120
s_branch ld_52
lw_55:
ds_read_b64_tr_b16 a[24:25],v12 offset:0
ds_read_b64_tr_b16 a[26:27],v12 offset:768
ds_read_b64_tr_b16 a[28:29],v12 offset:12288
ds_read_b64_tr_b16 a[30:31],v12 offset:13056
ds_read_b64_tr_b16 a[32:33],v12 offset:32
ds_read_b64_tr_b16 a[34:35],v12 offset:800
ds_read_b64_tr_b16 a[36:37],v12 offset:12320
ds_read_b64_tr_b16 a[38:39],v12 offset:13088
ds_read_b64_tr_b16 v[24:25],v12 offset:64
ds_read_b64_tr_b16 v[26:27],v12 offset:832
ds_read_b64_tr_b16 v[28:29],v12 offset:12352
ds_read_b64_tr_b16 v[30:31],v12 offset:13120
s_branch ld_52
lw_56:
ds_read_b64_tr_b16 v[120:121],v12 offset:0
ds_read_b64_tr_b16 v[122:123],v12 offset:768
ds_read_b64_tr_b16 v[124:125],v12 offset:12288
ds_read_b64_tr_b16 v[126:127],v12 offset:13056
ds_read_b64_tr_b16 v[128:129],v12 offset:32
ds_read_b64_tr_b16 v[130:131],v12 offset:800
ds_read_b64_tr_b16 v[132:133],v12 offset:12320
ds_read_b64_tr_b16 v[134:135],v12 offset:13088
ds_read_b64_tr_b16 v[72:73],v12 offset:64
ds_read_b64_tr_b16 v[74:75],v12 offset:832
ds_read_b64_tr_b16 v[76:77],v12 offset:12352
ds_read_b64_tr_b16 v[78:79],v12 offset:13120
ld_52:
s_waitcnt lgkmcnt(0)
s_waitcnt vmcnt(24)
s_barrier
s_add_u32 s60,s75,s74
s_add_u32 m0,s77,73728
s_add_u32 s61,s60,5505024
buffer_load_dwordx4 v104,s[52:55],s61 offen lds
s_add_u32 m0,s77,74752
s_add_u32 s61,s60,5505024
buffer_load_dwordx4 v105,s[52:55],s61 offen lds
s_add_u32 m0,s77,75776
s_add_u32 s61,s60,5505024
buffer_load_dwordx4 v106,s[52:55],s61 offen lds
s_add_u32 m0,s77,76800
s_add_u32 s61,s60,5603328
buffer_load_dwordx4 v104,s[52:55],s61 offen lds
s_add_u32 m0,s77,77824
s_add_u32 s61,s60,5603328
buffer_load_dwordx4 v105,s[52:55],s61 offen lds
s_add_u32 m0,s77,78848
s_add_u32 s61,s60,5603328
buffer_load_dwordx4 v106,s[52:55],s61 offen lds
v_add_u32 v12,98304,v107
s_cmp_eq_u32 s46,1
s_cbranch_scc1 lw_59
s_cmp_eq_u32 s46,2
s_cbranch_scc1 lw_60
s_cmp_eq_u32 s46,3
s_cbranch_scc1 lw_61
lw_58:
ds_read_b64_tr_b16 a[200:201],v12 offset:0
ds_read_b64_tr_b16 a[202:203],v12 offset:768
ds_read_b64_tr_b16 a[204:205],v12 offset:12288
ds_read_b64_tr_b16 a[206:207],v12 offset:13056
ds_read_b64_tr_b16 a[208:209],v12 offset:32
ds_read_b64_tr_b16 a[210:211],v12 offset:800
ds_read_b64_tr_b16 a[212:213],v12 offset:12320
ds_read_b64_tr_b16 a[214:215],v12 offset:13088
ds_read_b64_tr_b16 a[216:217],v12 offset:64
ds_read_b64_tr_b16 a[218:219],v12 offset:832
ds_read_b64_tr_b16 a[220:221],v12 offset:12352
ds_read_b64_tr_b16 a[222:223],v12 offset:13120
s_branch ld_57
lw_59:
ds_read_b64_tr_b16 a[120:121],v12 offset:0
ds_read_b64_tr_b16 a[122:123],v12 offset:768
ds_read_b64_tr_b16 a[124:125],v12 offset:12288
ds_read_b64_tr_b16 a[126:127],v12 offset:13056
ds_read_b64_tr_b16 a[128:129],v12 offset:32
ds_read_b64_tr_b16 a[130:131],v12 offset:800
ds_read_b64_tr_b16 a[132:133],v12 offset:12320
ds_read_b64_tr_b16 a[134:135],v12 offset:13088
ds_read_b64_tr_b16 a[136:137],v12 offset:64
ds_read_b64_tr_b16 a[138:139],v12 offset:832
ds_read_b64_tr_b16 a[140:141],v12 offset:12352
ds_read_b64_tr_b16 a[142:143],v12 offset:13120
s_branch ld_57
lw_60:
ds_read_b64_tr_b16 a[40:41],v12 offset:0
ds_read_b64_tr_b16 a[42:43],v12 offset:768
ds_read_b64_tr_b16 a[44:45],v12 offset:12288
ds_read_b64_tr_b16 a[46:47],v12 offset:13056
ds_read_b64_tr_b16 a[48:49],v12 offset:32
ds_read_b64_tr_b16 a[50:51],v12 offset:800
ds_read_b64_tr_b16 a[52:53],v12 offset:12320
ds_read_b64_tr_b16 a[54:55],v12 offset:13088
ds_read_b64_tr_b16 a[56:57],v12 offset:64
ds_read_b64_tr_b16 a[58:59],v12 offset:832
ds_read_b64_tr_b16 a[60:61],v12 offset:12352
ds_read_b64_tr_b16 a[62:63],v12 offset:13120
s_branch ld_57
lw_61:
ds_read_b64_tr_b16 v[136:137],v12 offset:0
ds_read_b64_tr_b16 v[138:139],v12 offset:768
ds_read_b64_tr_b16 v[140:141],v12 offset:12288
ds_read_b64_tr_b16 v[142:143],v12 offset:13056
ds_read_b64_tr_b16 v[144:145],v12 offset:32
ds_read_b64_tr_b16 v[146:147],v12 offset:800
ds_read_b64_tr_b16 v[148:149],v12 offset:12320
ds_read_b64_tr_b16 v[150:151],v12 offset:13088
ds_read_b64_tr_b16 v[152:153],v12 offset:64
ds_read_b64_tr_b16 v[154:155],v12 offset:832
ds_read_b64_tr_b16 v[156:157],v12 offset:12352
ds_read_b64_tr_b16 v[158:159],v12 offset:13120
ld_57:
s_waitcnt lgkmcnt(0)
s_waitcnt vmcnt(24)
s_barrier
s_add_u32 s60,s76,s73
s_add_u32 m0,s77,98304
s_add_u32 s61,s60,6291456
buffer_load_dwordx4 v104,s[4:7],s61 offen lds
s_add_u32 m0,s77,99328
s_add_u32 s61,s60,6291456
buffer_load_dwordx4 v105,s[4:7],s61 offen lds
s_add_u32 m0,s77,100352
s_add_u32 s61,s60,6291456
buffer_load_dwordx4 v106,s[4:7],s61 offen lds
s_add_u32 m0,s77,101376
s_add_u32 s61,s60,6389760
buffer_load_dwordx4 v104,s[4:7],s61 offen lds
s_add_u32 m0,s77,102400
s_add_u32 s61,s60,6389760
buffer_load_dwordx4 v105,s[4:7],s61 offen lds
s_add_u32 m0,s77,103424
s_add_u32 s61,s60,6389760
buffer_load_dwordx4 v106,s[4:7],s61 offen lds
v_add_u32 v12,122880,v107
s_cmp_eq_u32 s46,1
s_cbranch_scc1 lw_64
s_cmp_eq_u32 s46,2
s_cbranch_scc1 lw_65
s_cmp_eq_u32 s46,3
s_cbranch_scc1 lw_66
lw_63:
ds_read_b64_tr_b16 a[224:225],v12 offset:0
ds_read_b64_tr_b16 a[226:227],v12 offset:768
ds_read_b64_tr_b16 a[228:229],v12 offset:12288
ds_read_b64_tr_b16 a[230:231],v12 offset:13056
ds_read_b64_tr_b16 a[232:233],v12 offset:32
ds_read_b64_tr_b16 a[234:235],v12 offset:800
ds_read_b64_tr_b16 a[236:237],v12 offset:12320
ds_read_b64_tr_b16 a[238:239],v12 offset:13088
ds_read_b64_tr_b16 v[64:65],v12 offset:64
ds_read_b64_tr_b16 v[66:67],v12 offset:832
ds_read_b64_tr_b16 v[68:69],v12 offset:12352
ds_read_b64_tr_b16 v[70:71],v12 offset:13120
s_branch ld_62
lw_64:
ds_read_b64_tr_b16 a[144:145],v12 offset:0
ds_read_b64_tr_b16 a[146:147],v12 offset:768
ds_read_b64_tr_b16 a[148:149],v12 offset:12288
ds_read_b64_tr_b16 a[150:151],v12 offset:13056
ds_read_b64_tr_b16 a[152:153],v12 offset:32
ds_read_b64_tr_b16 a[154:155],v12 offset:800
ds_read_b64_tr_b16 a[156:157],v12 offset:12320
ds_read_b64_tr_b16 a[158:159],v12 offset:13088
ds_read_b64_tr_b16 v[48:49],v12 offset:64
ds_read_b64_tr_b16 v[50:51],v12 offset:832
ds_read_b64_tr_b16 v[52:53],v12 offset:12352
ds_read_b64_tr_b16 v[54:55],v12 offset:13120
s_branch ld_62
lw_65:
ds_read_b64_tr_b16 a[64:65],v12 offset:0
ds_read_b64_tr_b16 a[66:67],v12 offset:768
ds_read_b64_tr_b16 a[68:69],v12 offset:12288
ds_read_b64_tr_b16 a[70:71],v12 offset:13056
ds_read_b64_tr_b16 a[72:73],v12 offset:32
ds_read_b64_tr_b16 a[74:75],v12 offset:800
ds_read_b64_tr_b16 a[76:77],v12 offset:12320
ds_read_b64_tr_b16 a[78:79],v12 offset:13088
ds_read_b64_tr_b16 v[32:33],v12 offset:64
ds_read_b64_tr_b16 v[34:35],v12 offset:832
ds_read_b64_tr_b16 v[36:37],v12 offset:12352
ds_read_b64_tr_b16 v[38:39],v12 offset:13120
s_branch ld_62
lw_66:
ds_read_b64_tr_b16 v[160:161],v12 offset:0
ds_read_b64_tr_b16 v[162:163],v12 offset:768
ds_read_b64_tr_b16 v[164:165],v12 offset:12288
ds_read_b64_tr_b16 v[166:167],v12 offset:13056
ds_read_b64_tr_b16 v[168:169],v12 offset:32
ds_read_b64_tr_b16 v[170:171],v12 offset:800
ds_read_b64_tr_b16 v[172:173],v12 offset:12320
ds_read_b64_tr_b16 v[174:175],v12 offset:13088
ds_read_b64_tr_b16 v[80:81],v12 offset:64
ds_read_b64_tr_b16 v[82:83],v12 offset:832
ds_read_b64_tr_b16 v[84:85],v12 offset:12352
ds_read_b64_tr_b16 v[86:87],v12 offset:13120
ld_62:
s_waitcnt lgkmcnt(0)
s_waitcnt vmcnt(24)
s_barrier
s_add_u32 s60,s76,s74
s_add_u32 m0,s77,122880
s_add_u32 s61,s60,6291456
buffer_load_dwordx4 v104,s[52:55],s61 offen lds
s_add_u32 m0,s77,123904
s_add_u32 s61,s60,6291456
buffer_load_dwordx4 v105,s[52:55],s61 offen lds
s_add_u32 m0,s77,124928
s_add_u32 s61,s60,6291456
buffer_load_dwordx4 v106,s[52:55],s61 offen lds
s_add_u32 m0,s77,125952
s_add_u32 s61,s60,6389760
buffer_load_dwordx4 v104,s[52:55],s61 offen lds
s_add_u32 m0,s77,126976
s_add_u32 s61,s60,6389760
buffer_load_dwordx4 v105,s[52:55],s61 offen lds
s_add_u32 m0,s77,128000
s_add_u32 s61,s60,6389760
buffer_load_dwordx4 v106,s[52:55],s61 offen lds
v_add_u32 v12,0,v107
s_cmp_eq_u32 s46,1
s_cbranch_scc1 lw_69
s_cmp_eq_u32 s46,2
s_cbranch_scc1 lw_70
s_cmp_eq_u32 s46,3
s_cbranch_scc1 lw_71
lw_68:
ds_read_b64_tr_b16 a[240:241],v12 offset:0
ds_read_b64_tr_b16 a[242:243],v12 offset:768
ds_read_b64_tr_b16 a[244:245],v12 offset:12288
ds_read_b64_tr_b16 a[246:247],v12 offset:13056
ds_read_b64_tr_b16 a[248:249],v12 offset:32
ds_read_b64_tr_b16 a[250:251],v12 offset:800
ds_read_b64_tr_b16 a[252:253],v12 offset:12320
ds_read_b64_tr_b16 a[254:255],v12 offset:13088
ds_read_b64_tr_b16 v[112:113],v12 offset:64
ds_read_b64_tr_b16 v[114:115],v12 offset:832
ds_read_b64_tr_b16 v[116:117],v12 offset:12352
ds_read_b64_tr_b16 v[118:119],v12 offset:13120
s_branch ld_67
lw_69:
ds_read_b64_tr_b16 a[160:161],v12 offset:0
ds_read_b64_tr_b16 a[162:163],v12 offset:768
ds_read_b64_tr_b16 a[164:165],v12 offset:12288
ds_read_b64_tr_b16 a[166:167],v12 offset:13056
ds_read_b64_tr_b16 a[168:169],v12 offset:32
ds_read_b64_tr_b16 a[170:171],v12 offset:800
ds_read_b64_tr_b16 a[172:173],v12 offset:12320
ds_read_b64_tr_b16 a[174:175],v12 offset:13088
ds_read_b64_tr_b16 a[176:177],v12 offset:64
ds_read_b64_tr_b16 a[178:179],v12 offset:832
ds_read_b64_tr_b16 a[180:181],v12 offset:12352
ds_read_b64_tr_b16 a[182:183],v12 offset:13120
s_branch ld_67
lw_70:
ds_read_b64_tr_b16 a[80:81],v12 offset:0
ds_read_b64_tr_b16 a[82:83],v12 offset:768
ds_read_b64_tr_b16 a[84:85],v12 offset:12288
ds_read_b64_tr_b16 a[86:87],v12 offset:13056
ds_read_b64_tr_b16 a[88:89],v12 offset:32
ds_read_b64_tr_b16 a[90:91],v12 offset:800
ds_read_b64_tr_b16 a[92:93],v12 offset:12320
ds_read_b64_tr_b16 a[94:95],v12 offset:13088
ds_read_b64_tr_b16 a[96:97],v12 offset:64
ds_read_b64_tr_b16 a[98:99],v12 offset:832
ds_read_b64_tr_b16 a[100:101],v12 offset:12352
ds_read_b64_tr_b16 a[102:103],v12 offset:13120
s_branch ld_67
lw_71:
ds_read_b64_tr_b16 a[0:1],v12 offset:0
ds_read_b64_tr_b16 a[2:3],v12 offset:768
ds_read_b64_tr_b16 a[4:5],v12 offset:12288
ds_read_b64_tr_b16 a[6:7],v12 offset:13056
ds_read_b64_tr_b16 a[8:9],v12 offset:32
ds_read_b64_tr_b16 a[10:11],v12 offset:800
ds_read_b64_tr_b16 a[12:13],v12 offset:12320
ds_read_b64_tr_b16 a[14:15],v12 offset:13088
ds_read_b64_tr_b16 a[16:17],v12 offset:64
ds_read_b64_tr_b16 a[18:19],v12 offset:832
ds_read_b64_tr_b16 a[20:21],v12 offset:12352
ds_read_b64_tr_b16 a[22:23],v12 offset:13120
ld_67:
s_waitcnt lgkmcnt(0)
s_waitcnt vmcnt(24)
s_barrier
s_add_u32 s60,s76,s73
s_add_u32 m0,s77,0
s_add_u32 s61,s60,7077888
buffer_load_dwordx4 v104,s[4:7],s61 offen lds
s_add_u32 m0,s77,1024
s_add_u32 s61,s60,7077888
buffer_load_dwordx4 v105,s[4:7],s61 offen lds
s_add_u32 m0,s77,2048
s_add_u32 s61,s60,7077888
buffer_load_dwordx4 v106,s[4:7],s61 offen lds
s_add_u32 m0,s77,3072
s_add_u32 s61,s60,7176192
buffer_load_dwordx4 v104,s[4:7],s61 offen lds
s_add_u32 m0,s77,4096
s_add_u32 s61,s60,7176192
buffer_load_dwordx4 v105,s[4:7],s61 offen lds
s_add_u32 m0,s77,5120
s_add_u32 s61,s60,7176192
buffer_load_dwordx4 v106,s[4:7],s61 offen lds
v_add_u32 v12,24576,v107
s_cmp_eq_u32 s46,1
s_cbranch_scc1 lw_74
s_cmp_eq_u32 s46,2
s_cbranch_scc1 lw_75
s_cmp_eq_u32 s46,3
s_cbranch_scc1 lw_76
lw_73:
ds_read_b64_tr_b16 v[120:121],v12 offset:0
ds_read_b64_tr_b16 v[122:123],v12 offset:768
ds_read_b64_tr_b16 v[124:125],v12 offset:12288
ds_read_b64_tr_b16 v[126:127],v12 offset:13056
ds_read_b64_tr_b16 v[128:129],v12 offset:32
ds_read_b64_tr_b16 v[130:131],v12 offset:800
ds_read_b64_tr_b16 v[132:133],v12 offset:12320
ds_read_b64_tr_b16 v[134:135],v12 offset:13088
ds_read_b64_tr_b16 v[72:73],v12 offset:64
ds_read_b64_tr_b16 v[74:75],v12 offset:832
ds_read_b64_tr_b16 v[76:77],v12 offset:12352
ds_read_b64_tr_b16 v[78:79],v12 offset:13120
s_branch ld_72
lw_74:
ds_read_b64_tr_b16 a[184:185],v12 offset:0
ds_read_b64_tr_b16 a[186:187],v12 offset:768
ds_read_b64_tr_b16 a[188:189],v12 offset:12288
ds_read_b64_tr_b16 a[190:191],v12 offset:13056
ds_read_b64_tr_b16 a[192:193],v12 offset:32
ds_read_b64_tr_b16 a[194:195],v12 offset:800
ds_read_b64_tr_b16 a[196:197],v12 offset:12320
ds_read_b64_tr_b16 a[198:199],v12 offset:13088
ds_read_b64_tr_b16 v[56:57],v12 offset:64
ds_read_b64_tr_b16 v[58:59],v12 offset:832
ds_read_b64_tr_b16 v[60:61],v12 offset:12352
ds_read_b64_tr_b16 v[62:63],v12 offset:13120
s_branch ld_72
lw_75:
ds_read_b64_tr_b16 a[104:105],v12 offset:0
ds_read_b64_tr_b16 a[106:107],v12 offset:768
ds_read_b64_tr_b16 a[108:109],v12 offset:12288
ds_read_b64_tr_b16 a[110:111],v12 offset:13056
ds_read_b64_tr_b16 a[112:113],v12 offset:32
ds_read_b64_tr_b16 a[114:115],v12 offset:800
ds_read_b64_tr_b16 a[116:117],v12 offset:12320
ds_read_b64_tr_b16 a[118:119],v12 offset:13088
ds_read_b64_tr_b16 v[40:41],v12 offset:64
ds_read_b64_tr_b16 v[42:43],v12 offset:832
ds_read_b64_tr_b16 v[44:45],v12 offset:12352
ds_read_b64_tr_b16 v[46:47],v12 offset:13120
s_branch ld_72
lw_76:
ds_read_b64_tr_b16 a[24:25],v12 offset:0
ds_read_b64_tr_b16 a[26:27],v12 offset:768
ds_read_b64_tr_b16 a[28:29],v12 offset:12288
ds_read_b64_tr_b16 a[30:31],v12 offset:13056
ds_read_b64_tr_b16 a[32:33],v12 offset:32
ds_read_b64_tr_b16 a[34:35],v12 offset:800
ds_read_b64_tr_b16 a[36:37],v12 offset:12320
ds_read_b64_tr_b16 a[38:39],v12 offset:13088
ds_read_b64_tr_b16 v[24:25],v12 offset:64
ds_read_b64_tr_b16 v[26:27],v12 offset:832
ds_read_b64_tr_b16 v[28:29],v12 offset:12352
ds_read_b64_tr_b16 v[30:31],v12 offset:13120
ld_72:
s_waitcnt lgkmcnt(0)
s_waitcnt vmcnt(24)
s_barrier
s_add_u32 s60,s76,s74
s_add_u32 m0,s77,24576
s_add_u32 s61,s60,7077888
buffer_load_dwordx4 v104,s[52:55],s61 offen lds
s_add_u32 m0,s77,25600
s_add_u32 s61,s60,7077888
buffer_load_dwordx4 v105,s[52:55],s61 offen lds
s_add_u32 m0,s77,26624
s_add_u32 s61,s60,7077888
buffer_load_dwordx4 v106,s[52:55],s61 offen lds
s_add_u32 m0,s77,27648
s_add_u32 s61,s60,7176192
buffer_load_dwordx4 v104,s[52:55],s61 offen lds
s_add_u32 m0,s77,28672
s_add_u32 s61,s60,7176192
buffer_load_dwordx4 v105,s[52:55],s61 offen lds
s_add_u32 m0,s77,29696
s_add_u32 s61,s60,7176192
buffer_load_dwordx4 v106,s[52:55],s61 offen lds
v_add_u32 v12,49152,v107
s_cmp_eq_u32 s46,1
s_cbranch_scc1 lw_79
s_cmp_eq_u32 s46,2
s_cbranch_scc1 lw_80
s_cmp_eq_u32 s46,3
s_cbranch_scc1 lw_81
lw_78:
ds_read_b64_tr_b16 v[136:137],v12 offset:0
ds_read_b64_tr_b16 v[138:139],v12 offset:768
ds_read_b64_tr_b16 v[140:141],v12 offset:12288
ds_read_b64_tr_b16 v[142:143],v12 offset:13056
ds_read_b64_tr_b16 v[144:145],v12 offset:32
ds_read_b64_tr_b16 v[146:147],v12 offset:800
ds_read_b64_tr_b16 v[148:149],v12 offset:12320
ds_read_b64_tr_b16 v[150:151],v12 offset:13088
ds_read_b64_tr_b16 v[152:153],v12 offset:64
ds_read_b64_tr_b16 v[154:155],v12 offset:832
ds_read_b64_tr_b16 v[156:157],v12 offset:12352
ds_read_b64_tr_b16 v[158:159],v12 offset:13120
s_branch ld_77
lw_79:
ds_read_b64_tr_b16 a[200:201],v12 offset:0
ds_read_b64_tr_b16 a[202:203],v12 offset:768
ds_read_b64_tr_b16 a[204:205],v12 offset:12288
ds_read_b64_tr_b16 a[206:207],v12 offset:13056
ds_read_b64_tr_b16 a[208:209],v12 offset:32
ds_read_b64_tr_b16 a[210:211],v12 offset:800
ds_read_b64_tr_b16 a[212:213],v12 offset:12320
ds_read_b64_tr_b16 a[214:215],v12 offset:13088
ds_read_b64_tr_b16 a[216:217],v12 offset:64
ds_read_b64_tr_b16 a[218:219],v12 offset:832
ds_read_b64_tr_b16 a[220:221],v12 offset:12352
ds_read_b64_tr_b16 a[222:223],v12 offset:13120
s_branch ld_77
lw_80:
ds_read_b64_tr_b16 a[120:121],v12 offset:0
ds_read_b64_tr_b16 a[122:123],v12 offset:768
ds_read_b64_tr_b16 a[124:125],v12 offset:12288
ds_read_b64_tr_b16 a[126:127],v12 offset:13056
ds_read_b64_tr_b16 a[128:129],v12 offset:32
ds_read_b64_tr_b16 a[130:131],v12 offset:800
ds_read_b64_tr_b16 a[132:133],v12 offset:12320
ds_read_b64_tr_b16 a[134:135],v12 offset:13088
ds_read_b64_tr_b16 a[136:137],v12 offset:64
ds_read_b64_tr_b16 a[138:139],v12 offset:832
ds_read_b64_tr_b16 a[140:141],v12 offset:12352
ds_read_b64_tr_b16 a[142:143],v12 offset:13120
s_branch ld_77
lw_81:
ds_read_b64_tr_b16 a[40:41],v12 offset:0
ds_read_b64_tr_b16 a[42:43],v12 offset:768
ds_read_b64_tr_b16 a[44:45],v12 offset:12288
ds_read_b64_tr_b16 a[46:47],v12 offset:13056
ds_read_b64_tr_b16 a[48:49],v12 offset:32
ds_read_b64_tr_b16 a[50:51],v12 offset:800
ds_read_b64_tr_b16 a[52:53],v12 offset:12320
ds_read_b64_tr_b16 a[54:55],v12 offset:13088
ds_read_b64_tr_b16 a[56:57],v12 offset:64
ds_read_b64_tr_b16 a[58:59],v12 offset:832
ds_read_b64_tr_b16 a[60:61],v12 offset:12352
ds_read_b64_tr_b16 a[62:63],v12 offset:13120
ld_77:
s_waitcnt lgkmcnt(0)
s_waitcnt vmcnt(24)
s_barrier
v_add_u32 v12,73728,v107
s_cmp_eq_u32 s46,1
s_cbranch_scc1 lw_84
s_cmp_eq_u32 s46,2
s_cbranch_scc1 lw_85
s_cmp_eq_u32 s46,3
s_cbranch_scc1 lw_86
lw_83:
ds_read_b64_tr_b16 v[160:161],v12 offset:0
ds_read_b64_tr_b16 v[162:163],v12 offset:768
ds_read_b64_tr_b16 v[164:165],v12 offset:12288
ds_read_b64_tr_b16 v[166:167],v12 offset:13056
ds_read_b64_tr_b16 v[168:169],v12 offset:32
ds_read_b64_tr_b16 v[170:171],v12 offset:800
ds_read_b64_tr_b16 v[172:173],v12 offset:12320
ds_read_b64_tr_b16 v[174:175],v12 offset:13088
ds_read_b64_tr_b16 v[80:81],v12 offset:64
ds_read_b64_tr_b16 v[82:83],v12 offset:832
ds_read_b64_tr_b16 v[84:85],v12 offset:12352
ds_read_b64_tr_b16 v[86:87],v12 offset:13120
s_branch ld_82
lw_84:
ds_read_b64_tr_b16 a[224:225],v12 offset:0
ds_read_b64_tr_b16 a[226:227],v12 offset:768
ds_read_b64_tr_b16 a[228:229],v12 offset:12288
ds_read_b64_tr_b16 a[230:231],v12 offset:13056
ds_read_b64_tr_b16 a[232:233],v12 offset:32
ds_read_b64_tr_b16 a[234:235],v12 offset:800
ds_read_b64_tr_b16 a[236:237],v12 offset:12320
ds_read_b64_tr_b16 a[238:239],v12 offset:13088
ds_read_b64_tr_b16 v[64:65],v12 offset:64
ds_read_b64_tr_b16 v[66:67],v12 offset:832
ds_read_b64_tr_b16 v[68:69],v12 offset:12352
ds_read_b64_tr_b16 v[70:71],v12 offset:13120
s_branch ld_82
lw_85:
ds_read_b64_tr_b16 a[144:145],v12 offset:0
ds_read_b64_tr_b16 a[146:147],v12 offset:768
ds_read_b64_tr_b16 a[148:149],v12 offset:12288
ds_read_b64_tr_b16 a[150:151],v12 offset:13056
ds_read_b64_tr_b16 a[152:153],v12 offset:32
ds_read_b64_tr_b16 a[154:155],v12 offset:800
ds_read_b64_tr_b16 a[156:157],v12 offset:12320
ds_read_b64_tr_b16 a[158:159],v12 offset:13088
ds_read_b64_tr_b16 v[48:49],v12 offset:64
ds_read_b64_tr_b16 v[50:51],v12 offset:832
ds_read_b64_tr_b16 v[52:53],v12 offset:12352
ds_read_b64_tr_b16 v[54:55],v12 offset:13120
s_branch ld_82
lw_86:
ds_read_b64_tr_b16 a[64:65],v12 offset:0
ds_read_b64_tr_b16 a[66:67],v12 offset:768
ds_read_b64_tr_b16 a[68:69],v12 offset:12288
ds_read_b64_tr_b16 a[70:71],v12 offset:13056
ds_read_b64_tr_b16 a[72:73],v12 offset:32
ds_read_b64_tr_b16 a[74:75],v12 offset:800
ds_read_b64_tr_b16 a[76:77],v12 offset:12320
ds_read_b64_tr_b16 a[78:79],v12 offset:13088
ds_read_b64_tr_b16 v[32:33],v12 offset:64
ds_read_b64_tr_b16 v[34:35],v12 offset:832
ds_read_b64_tr_b16 v[36:37],v12 offset:12352
ds_read_b64_tr_b16 v[38:39],v12 offset:13120
ld_82:
s_waitcnt lgkmcnt(0)
s_waitcnt vmcnt(18)
s_barrier
v_add_u32 v12,98304,v107
ds_read_b64_tr_b16 v[176:177],v12 offset:0
ds_read_b64_tr_b16 v[178:179],v12 offset:768
ds_read_b64_tr_b16 v[180:181],v12 offset:12288
ds_read_b64_tr_b16 v[182:183],v12 offset:13056
ds_read_b64_tr_b16 v[184:185],v12 offset:32
ds_read_b64_tr_b16 v[186:187],v12 offset:800
ds_read_b64_tr_b16 v[188:189],v12 offset:12320
ds_read_b64_tr_b16 v[190:191],v12 offset:13088
ds_read_b64_tr_b16 v[192:193],v12 offset:64
ds_read_b64_tr_b16 v[194:195],v12 offset:832
ds_read_b64_tr_b16 v[196:197],v12 offset:12352
ds_read_b64_tr_b16 v[198:199],v12 offset:13120
s_waitcnt lgkmcnt(0)
s_waitcnt vmcnt(12)
s_barrier
v_add_u32 v12,122880,v107
ds_read_b64_tr_b16 v[200:201],v12 offset:0
ds_read_b64_tr_b16 v[202:203],v12 offset:768
ds_read_b64_tr_b16 v[204:205],v12 offset:12288
ds_read_b64_tr_b16 v[206:207],v12 offset:13056
ds_read_b64_tr_b16 v[208:209],v12 offset:32
ds_read_b64_tr_b16 v[210:211],v12 offset:800
ds_read_b64_tr_b16 v[212:213],v12 offset:12320
ds_read_b64_tr_b16 v[214:215],v12 offset:13088
ds_read_b64_tr_b16 v[88:89],v12 offset:64
ds_read_b64_tr_b16 v[90:91],v12 offset:832
ds_read_b64_tr_b16 v[92:93],v12 offset:12352
ds_read_b64_tr_b16 v[94:95],v12 offset:13120
s_waitcnt lgkmcnt(0)
s_waitcnt vmcnt(6)
s_barrier
v_add_u32 v12,0,v107
ds_read_b64_tr_b16 v[216:217],v12 offset:0
ds_read_b64_tr_b16 v[218:219],v12 offset:768
ds_read_b64_tr_b16 v[220:221],v12 offset:12288
ds_read_b64_tr_b16 v[222:223],v12 offset:13056
ds_read_b64_tr_b16 v[224:225],v12 offset:32
ds_read_b64_tr_b16 v[226:227],v12 offset:800
ds_read_b64_tr_b16 v[228:229],v12 offset:12320
ds_read_b64_tr_b16 v[230:231],v12 offset:13088
ds_read_b64_tr_b16 v[232:233],v12 offset:64
ds_read_b64_tr_b16 v[234:235],v12 offset:832
ds_read_b64_tr_b16 v[236:237],v12 offset:12352
ds_read_b64_tr_b16 v[238:239],v12 offset:13120
s_waitcnt lgkmcnt(0)
s_waitcnt vmcnt(0)
s_barrier
v_add_u32 v12,24576,v107
ds_read_b64_tr_b16 v[240:241],v12 offset:0
ds_read_b64_tr_b16 v[242:243],v12 offset:768
ds_read_b64_tr_b16 v[244:245],v12 offset:12288
ds_read_b64_tr_b16 v[246:247],v12 offset:13056
ds_read_b64_tr_b16 v[248:249],v12 offset:32
ds_read_b64_tr_b16 v[250:251],v12 offset:800
ds_read_b64_tr_b16 v[252:253],v12 offset:12320
ds_read_b64_tr_b16 v[254:255],v12 offset:13088
ds_read_b64_tr_b16 v[96:97],v12 offset:64
ds_read_b64_tr_b16 v[98:99],v12 offset:832
ds_read_b64_tr_b16 v[100:101],v12 offset:12352
ds_read_b64_tr_b16 v[102:103],v12 offset:13120
s_waitcnt lgkmcnt(0)
s_barrier
ds_write_b128 v21,v[24:27] offset:0
ds_write_b128 v21,v[28:31] offset:1024
ds_write_b128 v21,v[32:35] offset:2048
ds_write_b128 v21,v[36:39] offset:3072
ds_write_b128 v21,v[40:43] offset:4096
ds_write_b128 v21,v[44:47] offset:5120
ds_write_b128 v21,v[48:51] offset:6144
ds_write_b128 v21,v[52:55] offset:7168
ds_write_b128 v21,v[56:59] offset:8192
ds_write_b128 v21,v[60:63] offset:9216
ds_write_b128 v21,v[64:67] offset:10240
ds_write_b128 v21,v[68:71] offset:11264
ds_write_b128 v21,v[72:75] offset:12288
ds_write_b128 v21,v[76:79] offset:13312
ds_write_b128 v21,v[80:83] offset:14336
ds_write_b128 v21,v[84:87] offset:15360
ds_write_b128 v21,v[88:91] offset:16384
ds_write_b128 v21,v[92:95] offset:17408
ds_write_b128 v21,v[96:99] offset:18432
ds_write_b128 v21,v[100:103] offset:19456
s_waitcnt lgkmcnt(0)
v_add_u32 v59,139264,v1
s_barrier
s_lshl_b32 s3,s49,2
v_mov_b32 v13,s3
s_nop 1
ibw_87:
buffer_load_dword v12,v13,s[12:15],0 offen sc1
s_waitcnt vmcnt(0)
v_cmp_ne_u32 vcc,256,v12
s_nop 0
s_cbranch_vccz ok_88
s_sleep 8
s_sub_u32 s47,s47,1
s_cbranch_scc1 ABORT
s_branch ibw_87
ok_88:
s_cmp_lg_u32 s49,0
s_cbranch_scc1 ibok_89
v_and_b32 v13,7,v0
v_lshlrev_b32 v13,2,v13
buffer_load_dword v12,v13,s[12:15],0 offen offset:32 sc1
s_waitcnt vmcnt(0)
v_cmp_ne_u32 vcc,32,v12
s_nop 0
s_cbranch_vccz ibok_89
s_barrier
s_mov_b32 s49,1
s_mov_b32 s3,s2
s_load_dwordx16 s[16:31],s[0:1],0
s_load_dwordx8 s[32:39],s[0:1],64
s_waitcnt lgkmcnt(0)
s_branch DISPATCH
ibok_89:
v_mov_b32 v13,192
s_cmp_lg_u32 s49,0
s_cbranch_scc1 vx_91
vw_90:
buffer_load_dword v12,v13,s[12:15],0 offen sc1
s_waitcnt vmcnt(0)
v_and_b32 v14,0xffff,v12
v_cmp_ne_u32 vcc,64,v14
s_nop 0
s_cbranch_vccz ok_92
s_sleep 4
s_sub_u32 s47,s47,1
s_cbranch_scc1 ABORT
s_branch vw_90
ok_92:
v_readfirstlane_b32 s60,v12
s_cmp_gt_u32 s60,2162688
s_cselect_b32 s60,0x2000,0
s_add_u32 s83,s83,s60
s_nop 1
vx_91:
s_mul_i32 s6,s46,2048
v_sub_u32 v18,v23,v22
v_add_u32 v18,v18,v1
v_add_u32 v18,8192,v18
s_mov_b32 s37,0x3f80
s_mov_b32 s81,0x3f800000
s_add_u32 s6,s6,s82
s_mov_b32 s7,0
s_add_u32 s7,s7,s82
s_add_u32 s7,s7,950272
s_mov_b32 s50,0
s_mov_b32 s4,0
s_mov_b32 s5,0
s_mov_b32 s78,2147483648
s_mov_b32 s79,2147483648
s_mov_b32 s30,2147483648
s_sub_u32 s60,s4,s5
s_cmp_gt_i32 s60,13
s_cselect_b32 s51,1,0
s_cmp_eq_u32 s4,64
s_cselect_b32 s51,1,s51
s_cmp_eq_u32 s51,0
s_cselect_b32 s52,s4,s5
s_addc_u32 s4,s4,0
s_add_u32 s5,s5,s51
s_and_b32 s60,s52,1
s_lshl2_add_u32 s60,s51,s60
s_lshl_b32 s68,s60,16
s_add_u32 s68,s68,s83
s_mul_i32 s59,s60,20480
s_add_u32 s59,s59,s6
s_lshl_b32 s69,s51,9
s_add_u32 s69,s69,s7
s_bfe_u32 s57,s52,65537
s_add_u32 s58,s52,1
s_cmp_lg_u32 s36,0
s_cbranch_scc1 CV_START
s_cmp_eq_u32 s46,3
s_cbranch_scc1 CH_START
s_lshl_b32 s60,s46,2
s_add_u32 s60,s60,147456
v_mov_b32 v20,s60
v_mov_b32 v12,0
ds_write_b32 v20,v12
v_add_u32 v58,106496,v1
v_mov_b32 v9,147468
s_lshl_b32 s85,s46,12
s_add_u32 s84,s84,s85
s_add_u32 s74,s85,81920
s_add_u32 s75,s74,s74
s_add_u32 s75,s75,24576
s_mul_i32 s60,s29,3
s_add_u32 s60,s60,s46
v_lshlrev_b32 v13,7,v0
s_add_u32 s61,s60,0
s_min_u32 s61,s61,115
s_lshl_b32 s61,s61,13
s_add_u32 s61,s61,s82
buffer_load_dword v14,v13,s[8:11],s61 offen sc1
s_add_u32 s61,s60,48
s_min_u32 s61,s61,115
s_lshl_b32 s61,s61,13
s_add_u32 s61,s61,s82
buffer_load_dword v14,v13,s[8:11],s61 offen sc1
s_add_u32 s61,s60,96
s_min_u32 s61,s61,115
s_lshl_b32 s61,s61,13
s_add_u32 s61,s61,s82
buffer_load_dword v14,v13,s[8:11],s61 offen sc1
s_waitcnt vmcnt(0)
s_mov_b64 vcc,-1
s_waitcnt lgkmcnt(0)
v_mov_b32 v10,0
v_mov_b32 v11,0
v_mov_b32 v24,0
v_mov_b32 v25,0
v_mov_b32 v26,0
v_mov_b32 v27,0
v_mov_b32 v28,0
v_mov_b32 v29,0
v_mov_b32 v30,0
v_mov_b32 v31,0
v_mov_b32 v32,0
v_mov_b32 v33,0
v_mov_b32 v34,0
v_mov_b32 v35,0
v_mov_b32 v36,0
v_mov_b32 v37,0
v_mov_b32 v38,0
v_mov_b32 v39,0
v_mov_b32 v40,0
v_mov_b32 v41,0
v_mov_b32 v42,0
v_mov_b32 v43,0
v_mov_b32 v44,0
v_mov_b32 v45,0
v_mov_b32 v46,0
v_mov_b32 v47,0
s_cmp_lg_u32 s49,0
s_cbranch_scc1 CS_LOOP_S
CS_LOOP_F:
s_barrier
buffer_load_dwordx2 v[80:81],v18,s[8:11],s59 offen sc1
buffer_load_dwordx4 v[72:75],v1,s[8:11],s59 offen sc1
buffer_load_dwordx4 v[76:79],v1,s[8:11],s59 offen offset:1024 sc1
s_cbranch_vccz fj_95f
s_waitcnt vmcnt(2)
s_sleep 3
fj_95f:
buffer_load_dwordx2 v[90:91],v18,s[8:11],s68 offen sc1
buffer_load_dwordx4 v[82:85],v1,s[8:11],s68 offen sc1
buffer_load_dwordx4 v[86:89],v1,s[8:11],s68 offen offset:1024 sc1
v_mfma_f32_32x32x8_bf16 v[24:39],v[10:11],v[10:11],0
v_mfma_f32_16x16x16_bf16 v[40:43],v[10:11],v[10:11],0
v_mfma_f32_16x16x16_bf16 v[44:47],v[10:11],v[10:11],0
fj_95:
fa_93:
s_waitcnt vmcnt(5)
v_lshlrev_b32 v108,16,v80
v_and_b32 v109,0xffff0000,v80
v_lshlrev_b32 v110,16,v81
v_and_b32 v111,0xffff0000,v81
s_waitcnt vmcnt(4)
v_lshlrev_b32 v92,16,v72
v_and_b32 v93,0xffff0000,v72
v_lshlrev_b32 v94,16,v73
v_and_b32 v95,0xffff0000,v73
v_lshlrev_b32 v96,16,v74
v_and_b32 v97,0xffff0000,v74
v_lshlrev_b32 v98,16,v75
v_and_b32 v99,0xffff0000,v75
s_waitcnt vmcnt(3)
v_lshlrev_b32 v100,16,v76
v_and_b32 v101,0xffff0000,v76
v_lshlrev_b32 v102,16,v77
v_and_b32 v103,0xffff0000,v77
v_lshlrev_b32 v104,16,v78
v_and_b32 v105,0xffff0000,v78
v_lshlrev_b32 v106,16,v79
v_and_b32 v107,0xffff0000,v79
s_waitcnt vmcnt(2)
v_dot2c_f32_bf16 v108,s37,v90
v_dot2c_f32_bf16 v109,s81,v90
v_dot2c_f32_bf16 v110,s37,v91
v_dot2c_f32_bf16 v111,s81,v91
v_bitop3_b32 v16,v80,v90,s57 bitop3:0x7e
v_cvt_pk_bf16_f32 v56,v108,v109
s_nop 0
v_cvt_pk_bf16_f32 v57,v110,v111
ds_write_b64 v23,v[56:57]
s_waitcnt vmcnt(1)
v_dot2c_f32_bf16 v92,s37,v82
v_dot2c_f32_bf16 v93,s81,v82
v_dot2c_f32_bf16 v94,s37,v83
v_dot2c_f32_bf16 v95,s81,v83
v_dot2c_f32_bf16 v96,s37,v84
v_dot2c_f32_bf16 v97,s81,v84
v_dot2c_f32_bf16 v98,s37,v85
v_dot2c_f32_bf16 v99,s81,v85
v_bitop3_b32 v17,v72,v82,s57 bitop3:0x7e
v_or_b32 v16,v16,v17
v_cvt_pk_bf16_f32 v48,v92,v93
v_cvt_pk_bf16_f32 v49,v94,v95
v_cvt_pk_bf16_f32 v50,v96,v97
v_cvt_pk_bf16_f32 v51,v98,v99
ds_write_b128 v22,v[48:51] offset:0
s_waitcnt vmcnt(0)
v_dot2c_f32_bf16 v100,s37,v86
v_dot2c_f32_bf16 v101,s81,v86
v_dot2c_f32_bf16 v102,s37,v87
v_dot2c_f32_bf16 v103,s81,v87
v_dot2c_f32_bf16 v104,s37,v88
v_dot2c_f32_bf16 v105,s81,v88
v_dot2c_f32_bf16 v106,s37,v89
v_dot2c_f32_bf16 v107,s81,v89
v_bitop3_b32 v17,v76,v86,s57 bitop3:0x7e
v_bitop3_b32 v16,v16,v17,1 bitop3:0xa8
v_cmp_ne_u32 vcc,0,v16
v_cvt_pk_bf16_f32 v52,v100,v101
v_cvt_pk_bf16_f32 v53,v102,v103
v_cvt_pk_bf16_f32 v54,v104,v105
v_cvt_pk_bf16_f32 v55,v106,v107
ds_write_b128 v22,v[52:55] offset:1024
s_cbranch_vccnz fr_94
fj_95g:
v_smfmac_f32_16x16x64_bf16 v[24:27],v[48:51],a[0:7],v2
ds_read_b128 v[72:75],v21 offset:0
v_xor_b32 v58,57344,v58
v_smfmac_f32_16x16x64_bf16 v[28:31],v[48:51],a[8:15],v2
ds_read_b128 v[76:79],v21 offset:1024
s_sub_u32 s60,s4,s5
v_smfmac_f32_16x16x64_bf16 v[32:35],v[48:51],a[16:23],v2
ds_read_b128 v[80:83],v21 offset:2048
s_cmp_gt_i32 s60,13
v_smfmac_f32_16x16x64_bf16 v[36:39],v[48:51],a[24:31],v2
ds_read_b128 v[84:87],v21 offset:3072
s_cselect_b32 s53,1,0
s_waitcnt lgkmcnt(4)
s_barrier
v_smfmac_f32_16x16x64_bf16 v[40:43],v[48:51],a[32:39],v2
ds_read_b128 v[60:63],v3 offset:0
s_cmp_eq_u32 s4,64
v_smfmac_f32_16x16x64_bf16 v[24:27],v[52:55],a[40:47],v2
ds_read_b128 v[64:67],v3 offset:1024
s_cselect_b32 s53,1,s53
v_smfmac_f32_16x16x64_bf16 v[28:31],v[52:55],a[48:55],v2
ds_read_b128 v[68:71],v4 offset:0
s_cmp_eq_u32 s53,0
v_smfmac_f32_16x16x64_bf16 v[32:35],v[52:55],a[56:63],v2
s_cselect_b32 s54,s4,s5
s_addc_u32 s4,s4,0
s_add_u32 s5,s5,s53
v_smfmac_f32_16x16x64_bf16 v[36:39],v[52:55],a[64:71],v2
s_mul_i32 s73,s54,393216
s_add_u32 s73,s73,s84
s_sub_u32 s74,s75,s74
v_smfmac_f32_16x16x64_bf16 v[40:43],v[52:55],a[72:79],v2
s_mov_b32 m0,s74
s_and_b32 s60,s52,1
s_waitcnt lgkmcnt(5)
v_smfmac_f32_16x16x64_bf16 v[44:47],v[48:51],v[72:79],v2
ds_read_b128 v[72:75],v21 offset:4096
s_waitcnt lgkmcnt(4)
v_smfmac_f32_16x16x64_bf16 v[44:47],v[52:55],v[80:87],v2
ds_read_b128 v[76:79],v21 offset:5120
s_waitcnt lgkmcnt(4)
v_smfmac_f32_16x16x64_bf16 v[24:27],v[60:63],a[80:87],v2
ds_read_b128 v[80:83],v21 offset:6144
s_lshl2_add_u32 s60,s51,s60
v_smfmac_f32_16x16x64_bf16 v[28:31],v[60:63],a[88:95],v2
ds_read_b128 v[84:87],v21 offset:7168
s_mul_i32 s60,s60,49152
v_smfmac_f32_16x16x64_bf16 v[32:35],v[60:63],a[96:103],v2
s_add_u32 s71,s60,s34
s_add_u32 s70,s60,s33
s_lshl_b32 s60,s51,9
v_smfmac_f32_16x16x64_bf16 v[36:39],v[60:63],a[104:111],v2
s_add_u32 s72,s60,s35
buffer_load_dwordx4 v1,s[8:11],s73 offen sc1 lds
v_smfmac_f32_16x16x64_bf16 v[40:43],v[60:63],a[112:119],v2
buffer_load_dwordx4 v1,s[8:11],s73 offen offset:1024 sc1 lds
s_waitcnt lgkmcnt(2)
v_smfmac_f32_16x16x64_bf16 v[44:47],v[60:63],v[72:79],v2
ds_read_b128 v[60:63],v4 offset:1024
v_smfmac_f32_16x16x64_bf16 v[24:27],v[64:67],a[120:127],v2
ds_read_b128 v[72:75],v21 offset:8192
v_smfmac_f32_16x16x64_bf16 v[28:31],v[64:67],a[128:135],v2
ds_read_b128 v[76:79],v21 offset:9216
v_smfmac_f32_16x16x64_bf16 v[32:35],v[64:67],a[136:143],v2
buffer_load_dwordx4 v1,s[8:11],s73 offen offset:2048 sc1 lds
v_smfmac_f32_16x16x64_bf16 v[36:39],v[64:67],a[144:151],v2
buffer_load_dwordx4 v1,s[8:11],s73 offen offset:3072 sc1 lds
v_add_u32 v17,s85,v58
v_smfmac_f32_16x16x64_bf16 v[40:43],v[64:67],a[152:159],v2
v_mov_b32 v16,s58
s_and_b32 s60,s54,1
s_waitcnt lgkmcnt(3)
v_smfmac_f32_16x16x64_bf16 v[44:47],v[64:67],v[80:87],v2
ds_read_b128 v[64:67],v5 offset:0
s_lshl2_add_u32 s60,s53,s60
v_smfmac_f32_16x16x64_bf16 v[24:27],v[68:71],a[160:167],v2
ds_read_b128 v[80:83],v21 offset:10240
s_lshl_b32 s68,s60,16
v_smfmac_f32_16x16x64_bf16 v[28:31],v[68:71],a[168:175],v2
ds_read_b128 v[84:87],v21 offset:11264
s_add_u32 s68,s68,s83
v_smfmac_f32_16x16x64_bf16 v[32:35],v[68:71],a[176:183],v2
s_mul_i32 s59,s60,20480
s_add_u32 s59,s59,s6
s_lshl_b32 s69,s53,9
v_smfmac_f32_16x16x64_bf16 v[36:39],v[68:71],a[184:191],v2
s_add_u32 s69,s69,s7
s_bfe_u32 s31,s54,65537
s_add_u32 s32,s54,1
v_smfmac_f32_16x16x64_bf16 v[40:43],v[68:71],a[192:199],v2
s_add_u32 s50,s50,1
s_mov_b32 s51,s53
s_waitcnt lgkmcnt(3)
v_smfmac_f32_16x16x64_bf16 v[44:47],v[68:71],v[72:79],v2
ds_read_b128 v[68:71],v5 offset:1024
s_mov_b32 s52,s54
v_smfmac_f32_16x16x64_bf16 v[24:27],v[60:63],a[200:207],v2
ds_read_b128 v[72:75],v21 offset:12288
s_mov_b32 s58,s32
v_smfmac_f32_16x16x64_bf16 v[28:31],v[60:63],a[208:215],v2
ds_read_b128 v[76:79],v21 offset:13312
s_mov_b64 vcc,s[88:89]
v_smfmac_f32_16x16x64_bf16 v[32:35],v[60:63],a[216:223],v2
ds_read_b128 v[48:51],v58 offset:0
v_smfmac_f32_16x16x64_bf16 v[36:39],v[60:63],a[224:231],v2
v_smfmac_f32_16x16x64_bf16 v[40:43],v[60:63],a[232:239],v2
ds_read_b128 v[52:55],v58 offset:1024
s_waitcnt lgkmcnt(5)
v_smfmac_f32_16x16x64_bf16 v[44:47],v[60:63],v[80:87],v2
ds_read_b128 v[60:63],v59 offset:0
v_smfmac_f32_16x16x64_bf16 v[24:27],v[64:67],a[240:247],v2
ds_read_b128 v[80:83],v21 offset:14336
v_smfmac_f32_16x16x64_bf16 v[28:31],v[64:67],a[248:255],v2
ds_read_b128 v[84:87],v21 offset:15360
v_smfmac_f32_16x16x64_bf16 v[32:35],v[64:67],v[112:119],v2
ds_read_b128 v[88:91],v58 offset:2048
v_smfmac_f32_16x16x64_bf16 v[36:39],v[64:67],v[120:127],v2
v_smfmac_f32_16x16x64_bf16 v[40:43],v[64:67],v[128:135],v2
ds_read_b128 v[92:95],v58 offset:3072
s_waitcnt lgkmcnt(7)
v_smfmac_f32_16x16x64_bf16 v[44:47],v[64:67],v[72:79],v2
ds_read_b128 v[64:67],v59 offset:1024
v_smfmac_f32_16x16x64_bf16 v[24:27],v[68:71],v[136:143],v2
ds_read_b128 v[72:75],v21 offset:16384
v_smfmac_f32_16x16x64_bf16 v[28:31],v[68:71],v[144:151],v2
ds_read_b128 v[76:79],v21 offset:17408
v_smfmac_f32_16x16x64_bf16 v[32:35],v[68:71],v[152:159],v2
ds_read_b128 v[96:99],v58 offset:4096
v_smfmac_f32_16x16x64_bf16 v[36:39],v[68:71],v[160:167],v2
v_smfmac_f32_16x16x64_bf16 v[40:43],v[68:71],v[168:175],v2
ds_read_b128 v[100:103],v58 offset:5120
s_waitcnt lgkmcnt(7)
v_smfmac_f32_16x16x64_bf16 v[44:47],v[68:71],v[80:87],v2
ds_read_b128 v[80:83],v21 offset:18432
v_smfmac_f32_16x16x64_bf16 v[24:27],v[60:63],v[176:183],v2
ds_read_b128 v[84:87],v21 offset:19456
v_smfmac_f32_16x16x64_bf16 v[36:39],v[60:63],v[200:207],v2
ds_read_b128 v[104:107],v58 offset:6144
s_waitcnt lgkmcnt(7)
v_smfmac_f32_16x16x64_bf16 v[24:27],v[64:67],v[216:223],v2
v_smfmac_f32_16x16x64_bf16 v[36:39],v[64:67],v[240:247],v2
ds_read_b128 v[108:111],v58 offset:7168
v_smfmac_f32_16x16x64_bf16 v[28:31],v[60:63],v[184:191],v2
v_smfmac_f32_16x16x64_bf16 v[40:43],v[60:63],v[208:215],v2
v_add_f32 v24,v24,v25
v_smfmac_f32_16x16x64_bf16 v[28:31],v[64:67],v[224:231],v2
v_add_f32 v26,v26,v27
v_smfmac_f32_16x16x64_bf16 v[40:43],v[64:67],v[248:255],v2
v_add_f32 v36,v36,v37
v_smfmac_f32_16x16x64_bf16 v[32:35],v[60:63],v[192:199],v2
v_add_f32 v38,v38,v39
s_waitcnt lgkmcnt(6)
v_smfmac_f32_16x16x64_bf16 v[44:47],v[60:63],v[72:79],v2
v_cvt_pk_bf16_f32 v37,v24,v26
v_smfmac_f32_16x16x64_bf16 v[32:35],v[64:67],v[232:239],v2
v_cvt_pk_bf16_f32 v36,v36,v38
s_waitcnt lgkmcnt(2)
v_smfmac_f32_16x16x64_bf16 v[44:47],v[64:67],v[80:87],v2
ds_write_b64 v6,v[36:37] offset:0
v_add_f32 v28,v28,v29
v_add_f32 v30,v30,v31
v_add_f32 v40,v40,v41
v_add_f32 v42,v42,v43
v_cvt_pk_bf16_f32 v41,v28,v30
v_cvt_pk_bf16_f32 v40,v40,v42
ds_write_b64 v6,v[40:41] offset:512
v_add_f32 v32,v32,v33
v_add_f32 v34,v34,v35
v_add_f32 v44,v44,v45
v_add_f32 v46,v46,v47
v_cvt_pk_bf16_f32 v45,v32,v34
v_cvt_pk_bf16_f32 v44,v44,v46
ds_write_b64 v6,v[44:45] offset:1024
ds_read_b128 v[72:75],v58 offset:8192
ds_read_b128 v[76:79],v58 offset:9216
s_waitcnt lgkmcnt(2)
s_barrier
ds_read_b64_tr_b16 v[24:25],v7 offset:0
ds_read_b64_tr_b16 v[26:27],v7 offset:512
ds_read_b64_tr_b16 v[28:29],v7 offset:1024
ds_read_b64_tr_b16 v[30:31],v7 offset:1536
ds_read_b64_tr_b16 v[32:33],v7 offset:2048
ds_read_b64_tr_b16 v[34:35],v7 offset:2560
ds_read_b64_tr_b16 v[36:37],v7 offset:3072
ds_read_b64_tr_b16 v[38:39],v7 offset:3584
s_waitcnt lgkmcnt(6)
v_mfma_f32_16x16x32_bf16 v[60:63],v[48:51],v[24:27],0
ds_read_b64_tr_b16 v[40:41],v7 offset:4096
v_mfma_f32_16x16x32_bf16 v[64:67],v[52:55],v[24:27],0
ds_read_b64_tr_b16 v[42:43],v7 offset:4608
v_mfma_f32_16x16x32_bf16 v[68:71],v[24:27],v[24:27],0
ds_read_b128 v[80:83],v58 offset:10240
s_waitcnt lgkmcnt(7)
v_mfma_f32_16x16x32_bf16 v[60:63],v[88:91],v[28:31],v[60:63]
ds_read_b128 v[84:87],v58 offset:11264
v_mfma_f32_16x16x32_bf16 v[64:67],v[92:95],v[28:31],v[64:67]
ds_read_b64_tr_b16 v[44:45],v7 offset:5120
v_mfma_f32_16x16x32_bf16 v[68:71],v[28:31],v[28:31],v[68:71]
ds_read_b64_tr_b16 v[46:47],v7 offset:5632
s_waitcnt lgkmcnt(8)
v_mfma_f32_16x16x32_bf16 v[60:63],v[96:99],v[32:35],v[60:63]
ds_read_b128 v[24:27],v17 offset:12288
v_mfma_f32_16x16x32_bf16 v[64:67],v[100:103],v[32:35],v[64:67]
ds_read_b128 v[28:31],v17 offset:13312
v_mfma_f32_16x16x32_bf16 v[68:71],v[32:35],v[32:35],v[68:71]
s_waitcnt lgkmcnt(8)
v_mfma_f32_16x16x32_bf16 v[60:63],v[104:107],v[36:39],v[60:63]
ds_read_b128 v[32:35],v17 offset:14336
v_mfma_f32_16x16x32_bf16 v[64:67],v[108:111],v[36:39],v[64:67]
v_mfma_f32_16x16x32_bf16 v[68:71],v[36:39],v[36:39],v[68:71]
s_waitcnt lgkmcnt(7)
v_mfma_f32_16x16x32_bf16 v[60:63],v[72:75],v[40:43],v[60:63]
ds_read_b128 v[36:39],v17 offset:15360
v_mfma_f32_16x16x32_bf16 v[64:67],v[76:79],v[40:43],v[64:67]
v_mfma_f32_16x16x32_bf16 v[68:71],v[40:43],v[40:43],v[68:71]
s_waitcnt lgkmcnt(4)
v_mfma_f32_16x16x32_bf16 v[60:63],v[80:83],v[44:47],v[60:63]
v_mfma_f32_16x16x32_bf16 v[64:67],v[84:87],v[44:47],v[64:67]
buffer_load_dwordx4 v[48:51],v1,s[8:11],s71 offen sc1
v_mfma_f32_16x16x32_bf16 v[68:71],v[44:47],v[44:47],v[68:71]
s_nop 4
v_cndmask_b32_dpp v60,v64,v60,vcc quad_perm:[2,3,2,3] row_mask:0xf bank_mask:0xf
v_cndmask_b32_dpp v61,v65,v61,vcc quad_perm:[2,3,2,3] row_mask:0xf bank_mask:0xf
v_cndmask_b32_dpp v62,v66,v62,vcc quad_perm:[2,3,2,3] row_mask:0xf bank_mask:0xf
v_cndmask_b32_dpp v63,v67,v63,vcc quad_perm:[2,3,2,3] row_mask:0xf bank_mask:0xf
v_max3_f32 v12,v60,v61,v62
v_cndmask_b32_dpp v68,v69,v68,vcc quad_perm:[2,3,2,3] row_mask:0xf bank_mask:0xf
v_max3_f32 v12,v12,v63,v68
s_nop 1
v_max_f32_dpp v13,v12,v12 quad_perm:[2,3,0,1] row_mask:0xf bank_mask:0xf
v_max_f32_dpp v12,v12,v12 quad_perm:[2,3,0,1] row_mask:0xf bank_mask:0xf
s_nop 1
v_permlane32_swap_b32 v12,v13
v_max_f32 v15,v12,v13
v_max_f32 v12,v12,v13
s_mov_b64 exec,1
buffer_store_dword v16,v1,s[8:11],s72 offen
s_mov_b64 exec,-1
v_permlane16_swap_b32 v12,v15
v_max_f32 v12,v12,v15
v_mul_f32 v12,s87,v12
v_fma_f32 v60,v60,s87,-v12
v_fma_f32 v61,v61,s87,-v12
v_fma_f32 v62,v62,s87,-v12
v_fma_f32 v63,v63,s87,-v12
v_fma_f32 v68,v68,s87,-v12
v_exp_f32 v60,v60
v_exp_f32 v61,v61
v_exp_f32 v62,v62
v_exp_f32 v63,v63
v_exp_f32 v68,v68
v_cvt_pk_bf16_f32 v70,v60,v61
v_cvt_pk_bf16_f32 v71,v62,v63
v_cndmask_b32 v46,v70,v10,vcc
v_cndmask_b32 v47,v71,v10,vcc
v_cndmask_b32_dpp v44,v70,v10,vcc quad_perm:[2,3,0,1] row_mask:0xf bank_mask:0xf
v_cndmask_b32_dpp v45,v71,v10,vcc quad_perm:[2,3,0,1] row_mask:0xf bank_mask:0xf
s_mov_b64 vcc,s[90:91]
s_waitcnt lgkmcnt(0)
v_cndmask_b32 v40,v70,v10,vcc
v_mfma_f32_16x16x32_bf16 v[64:67],v[28:31],v[44:47],0
v_cndmask_b32 v41,v71,v10,vcc
v_cndmask_b32_dpp v42,v70,v10,vcc quad_perm:[2,3,0,1] row_mask:0xf bank_mask:0xf
v_mfma_f32_16x16x32_bf16 v[52:55],v[36:39],v[44:47],0
v_cndmask_b32_dpp v43,v71,v10,vcc quad_perm:[2,3,0,1] row_mask:0xf bank_mask:0xf
v_mov_b32_dpp v14,v68 quad_perm:[2,3,0,1] row_mask:0xf bank_mask:0xf
v_add_f32 v12,v60,v61
v_mfma_f32_16x16x32_bf16 v[64:67],v[24:27],v[40:43],v[64:67]
v_cvt_pk_bf16_f32 v56,v68,v14
v_cvt_pk_bf16_f32 v57,v14,v68
v_mfma_f32_16x16x32_bf16 v[52:55],v[32:35],v[40:43],v[52:55]
v_cndmask_b32 v56,v56,v10,vcc
v_cndmask_b32 v57,v10,v57,vcc
ds_read_b32 v0,v9
v_add_f32 v13,v62,v63
v_add_f32 v12,v12,v68
v_add_f32 v12,v12,v13
s_waitcnt vmcnt(1)
v_bitop3_b32 v17,v48,v50,s57 bitop3:0x7e
v_add_f32_dpp v13,v12,v12 quad_perm:[2,3,0,1] row_mask:0xf bank_mask:0xf
v_and_b32 v17,1,v17
v_add_f32_dpp v12,v12,v12 quad_perm:[2,3,0,1] row_mask:0xf bank_mask:0xf
v_cmp_ne_u32 vcc,0,v17
s_cbranch_vccnz vb_96
vo_97:
v_mfma_f32_16x16x16_bf16 v[64:67],v[48:49],v[56:57],v[64:67]
v_permlane32_swap_b32 v12,v13
v_add_f32 v15,v12,v13
v_mfma_f32_16x16x16_bf16 v[52:55],v[50:51],v[56:57],v[52:55]
v_add_f32 v12,v12,v13
s_nop 1
v_permlane16_swap_b32 v12,v15
v_add_f32 v12,v12,v15
v_rcp_f32 v12,v12
s_nop 0
v_mul_f32 v64,v64,v12
v_mul_f32 v65,v65,v12
v_mul_f32 v66,v66,v12
v_mul_f32 v67,v67,v12
v_mul_f32 v52,v52,v12
v_mul_f32 v53,v53,v12
v_mul_f32 v54,v54,v12
v_mul_f32 v55,v55,v12
v_cvt_pk_bf16_f32 v48,v64,v65
v_cvt_pk_bf16_f32 v49,v66,v67
v_cvt_pk_bf16_f32 v50,v52,v53
v_cvt_pk_bf16_f32 v51,v54,v55
v_and_or_b32 v48,v48,-2,s57
buffer_store_dwordx4 v[48:51],v8,s[8:11],s70 offen
s_mov_b32 s57,s31
v_mov_b32 v12,s50
s_waitcnt lgkmcnt(0)
v_cmp_ne_u32 vcc,s50,v0
ds_write_b32 v20,v12
s_cmp_lt_u32 s50,128
s_cbranch_scc1 CS_LOOP_F
s_branch CS_DONE
fr_94:
v_bitop3_b32 v12,v72,v76,s57 bitop3:0x7e
v_bitop3_b32 v13,v80,v80,s57 bitop3:0x7e
v_xor_b32 v14,s57,v80
v_or3_b32 v12,v12,v13,v14
v_and_b32 v12,1,v12
v_cmp_ne_u32 vcc,0,v12
s_cbranch_vccz sk_98
buffer_load_dwordx2 v[80:81],v18,s[8:11],s59 offen sc1
buffer_load_dwordx4 v[72:75],v1,s[8:11],s59 offen sc1
buffer_load_dwordx4 v[76:79],v1,s[8:11],s59 offen offset:1024 sc1
sk_98:
buffer_load_dwordx2 v[90:91],v18,s[8:11],s68 offen sc1
buffer_load_dwordx4 v[82:85],v1,s[8:11],s68 offen sc1
buffer_load_dwordx4 v[86:89],v1,s[8:11],s68 offen offset:1024 sc1
s_sub_u32 s47,s47,1
s_cbranch_scc1 ABORT
s_waitcnt lgkmcnt(0)
s_branch fa_93
vb_96:
s_sub_u32 s47,s47,1
s_cbranch_scc1 ABORT
buffer_load_dwordx4 v[48:51],v1,s[8:11],s71 offen sc1
s_waitcnt vmcnt(0)
v_bitop3_b32 v17,v48,v50,s57 bitop3:0x7e
v_and_b32 v17,1,v17
v_cmp_ne_u32 vcc,0,v17
s_nop 0
s_cbranch_vccnz vb_96
s_branch vo_97
CS_LOOP_S:
s_barrier
buffer_load_dwordx2 v[80:81],v18,s[8:11],s59 offen sc1
buffer_load_dwordx4 v[72:75],v1,s[8:11],s59 offen sc1
buffer_load_dwordx4 v[76:79],v1,s[8:11],s59 offen offset:1024 sc1
s_cbranch_vccz fj_101f
s_waitcnt vmcnt(2)
s_sleep 3
fj_101f:
buffer_load_dwordx2 v[90:91],v18,s[8:11],s68 offen sc1
buffer_load_dwordx4 v[82:85],v1,s[8:11],s68 offen sc1
buffer_load_dwordx4 v[86:89],v1,s[8:11],s68 offen offset:1024 sc1
v_mfma_f32_32x32x8_bf16 v[24:39],v[10:11],v[10:11],0
v_mfma_f32_16x16x16_bf16 v[40:43],v[10:11],v[10:11],0
v_mfma_f32_16x16x16_bf16 v[44:47],v[10:11],v[10:11],0
fj_101:
fa_99:
s_waitcnt vmcnt(5)
v_lshlrev_b32 v108,16,v80
v_and_b32 v109,0xffff0000,v80
v_lshlrev_b32 v110,16,v81
v_and_b32 v111,0xffff0000,v81
s_waitcnt vmcnt(4)
v_lshlrev_b32 v92,16,v72
v_and_b32 v93,0xffff0000,v72
v_lshlrev_b32 v94,16,v73
v_and_b32 v95,0xffff0000,v73
v_lshlrev_b32 v96,16,v74
v_and_b32 v97,0xffff0000,v74
v_lshlrev_b32 v98,16,v75
v_and_b32 v99,0xffff0000,v75
s_waitcnt vmcnt(3)
v_lshlrev_b32 v100,16,v76
v_and_b32 v101,0xffff0000,v76
v_lshlrev_b32 v102,16,v77
v_and_b32 v103,0xffff0000,v77
v_lshlrev_b32 v104,16,v78
v_and_b32 v105,0xffff0000,v78
v_lshlrev_b32 v106,16,v79
v_and_b32 v107,0xffff0000,v79
s_waitcnt vmcnt(2)
v_dot2c_f32_bf16 v108,s37,v90
v_dot2c_f32_bf16 v109,s81,v90
v_dot2c_f32_bf16 v110,s37,v91
v_dot2c_f32_bf16 v111,s81,v91
v_bitop3_b32 v16,v80,v90,s57 bitop3:0x7e
v_cvt_pk_bf16_f32 v56,v108,v109
s_nop 0
v_cvt_pk_bf16_f32 v57,v110,v111
ds_write_b64 v23,v[56:57]
s_waitcnt vmcnt(1)
v_dot2c_f32_bf16 v92,s37,v82
v_dot2c_f32_bf16 v93,s81,v82
v_dot2c_f32_bf16 v94,s37,v83
v_dot2c_f32_bf16 v95,s81,v83
v_dot2c_f32_bf16 v96,s37,v84
v_dot2c_f32_bf16 v97,s81,v84
v_dot2c_f32_bf16 v98,s37,v85
v_dot2c_f32_bf16 v99,s81,v85
v_bitop3_b32 v17,v72,v82,s57 bitop3:0x7e
v_or_b32 v16,v16,v17
v_cvt_pk_bf16_f32 v48,v92,v93
v_cvt_pk_bf16_f32 v49,v94,v95
v_cvt_pk_bf16_f32 v50,v96,v97
v_cvt_pk_bf16_f32 v51,v98,v99
ds_write_b128 v22,v[48:51] offset:0
s_waitcnt vmcnt(0)
v_dot2c_f32_bf16 v100,s37,v86
v_dot2c_f32_bf16 v101,s81,v86
v_dot2c_f32_bf16 v102,s37,v87
v_dot2c_f32_bf16 v103,s81,v87
v_dot2c_f32_bf16 v104,s37,v88
v_dot2c_f32_bf16 v105,s81,v88
v_dot2c_f32_bf16 v106,s37,v89
v_dot2c_f32_bf16 v107,s81,v89
v_bitop3_b32 v17,v76,v86,s57 bitop3:0x7e
v_bitop3_b32 v16,v16,v17,1 bitop3:0xa8
v_cmp_ne_u32 vcc,0,v16
v_cvt_pk_bf16_f32 v52,v100,v101
v_cvt_pk_bf16_f32 v53,v102,v103
v_cvt_pk_bf16_f32 v54,v104,v105
v_cvt_pk_bf16_f32 v55,v106,v107
ds_write_b128 v22,v[52:55] offset:1024
s_cbranch_vccnz fr_100
fj_101g:
v_smfmac_f32_16x16x64_bf16 v[24:27],v[48:51],a[0:7],v2
ds_read_b128 v[72:75],v21 offset:0
v_xor_b32 v58,57344,v58
v_smfmac_f32_16x16x64_bf16 v[28:31],v[48:51],a[8:15],v2
ds_read_b128 v[76:79],v21 offset:1024
s_sub_u32 s60,s4,s5
v_smfmac_f32_16x16x64_bf16 v[32:35],v[48:51],a[16:23],v2
ds_read_b128 v[80:83],v21 offset:2048
s_cmp_gt_i32 s60,13
v_smfmac_f32_16x16x64_bf16 v[36:39],v[48:51],a[24:31],v2
ds_read_b128 v[84:87],v21 offset:3072
s_cselect_b32 s53,1,0
s_waitcnt lgkmcnt(4)
s_barrier
v_smfmac_f32_16x16x64_bf16 v[40:43],v[48:51],a[32:39],v2
ds_read_b128 v[60:63],v3 offset:0
s_cmp_eq_u32 s4,64
v_smfmac_f32_16x16x64_bf16 v[24:27],v[52:55],a[40:47],v2
ds_read_b128 v[64:67],v3 offset:1024
s_cselect_b32 s53,1,s53
v_smfmac_f32_16x16x64_bf16 v[28:31],v[52:55],a[48:55],v2
ds_read_b128 v[68:71],v4 offset:0
s_cmp_eq_u32 s53,0
v_smfmac_f32_16x16x64_bf16 v[32:35],v[52:55],a[56:63],v2
s_cselect_b32 s54,s4,s5
s_addc_u32 s4,s4,0
s_add_u32 s5,s5,s53
v_smfmac_f32_16x16x64_bf16 v[36:39],v[52:55],a[64:71],v2
s_mul_i32 s73,s54,393216
s_add_u32 s73,s73,s84
s_sub_u32 s74,s75,s74
v_smfmac_f32_16x16x64_bf16 v[40:43],v[52:55],a[72:79],v2
s_mov_b32 m0,s74
s_and_b32 s60,s52,1
s_waitcnt lgkmcnt(5)
v_smfmac_f32_16x16x64_bf16 v[44:47],v[48:51],v[72:79],v2
ds_read_b128 v[72:75],v21 offset:4096
s_waitcnt lgkmcnt(4)
v_smfmac_f32_16x16x64_bf16 v[44:47],v[52:55],v[80:87],v2
ds_read_b128 v[76:79],v21 offset:5120
s_waitcnt lgkmcnt(4)
v_smfmac_f32_16x16x64_bf16 v[24:27],v[60:63],a[80:87],v2
ds_read_b128 v[80:83],v21 offset:6144
s_lshl2_add_u32 s60,s51,s60
v_smfmac_f32_16x16x64_bf16 v[28:31],v[60:63],a[88:95],v2
ds_read_b128 v[84:87],v21 offset:7168
s_mul_i32 s60,s60,49152
v_smfmac_f32_16x16x64_bf16 v[32:35],v[60:63],a[96:103],v2
s_add_u32 s71,s60,s34
s_add_u32 s70,s60,s33
s_lshl_b32 s60,s51,9
v_smfmac_f32_16x16x64_bf16 v[36:39],v[60:63],a[104:111],v2
s_add_u32 s72,s60,s35
buffer_load_dwordx4 v1,s[8:11],s73 offen sc1 lds
v_smfmac_f32_16x16x64_bf16 v[40:43],v[60:63],a[112:119],v2
buffer_load_dwordx4 v1,s[8:11],s73 offen offset:1024 sc1 lds
s_waitcnt lgkmcnt(2)
v_smfmac_f32_16x16x64_bf16 v[44:47],v[60:63],v[72:79],v2
ds_read_b128 v[60:63],v4 offset:1024
v_smfmac_f32_16x16x64_bf16 v[24:27],v[64:67],a[120:127],v2
ds_read_b128 v[72:75],v21 offset:8192
v_smfmac_f32_16x16x64_bf16 v[28:31],v[64:67],a[128:135],v2
ds_read_b128 v[76:79],v21 offset:9216
v_smfmac_f32_16x16x64_bf16 v[32:35],v[64:67],a[136:143],v2
buffer_load_dwordx4 v1,s[8:11],s73 offen offset:2048 sc1 lds
v_smfmac_f32_16x16x64_bf16 v[36:39],v[64:67],a[144:151],v2
buffer_load_dwordx4 v1,s[8:11],s73 offen offset:3072 sc1 lds
v_add_u32 v17,s85,v58
v_smfmac_f32_16x16x64_bf16 v[40:43],v[64:67],a[152:159],v2
v_mov_b32 v16,s58
s_and_b32 s60,s54,1
s_waitcnt lgkmcnt(3)
v_smfmac_f32_16x16x64_bf16 v[44:47],v[64:67],v[80:87],v2
ds_read_b128 v[64:67],v5 offset:0
s_lshl2_add_u32 s60,s53,s60
v_smfmac_f32_16x16x64_bf16 v[24:27],v[68:71],a[160:167],v2
ds_read_b128 v[80:83],v21 offset:10240
s_lshl_b32 s68,s60,16
v_smfmac_f32_16x16x64_bf16 v[28:31],v[68:71],a[168:175],v2
ds_read_b128 v[84:87],v21 offset:11264
s_add_u32 s68,s68,s83
v_smfmac_f32_16x16x64_bf16 v[32:35],v[68:71],a[176:183],v2
s_mul_i32 s59,s60,20480
s_add_u32 s59,s59,s6
s_lshl_b32 s69,s53,9
v_smfmac_f32_16x16x64_bf16 v[36:39],v[68:71],a[184:191],v2
s_add_u32 s69,s69,s7
s_bfe_u32 s31,s54,65537
s_add_u32 s32,s54,1
v_smfmac_f32_16x16x64_bf16 v[40:43],v[68:71],a[192:199],v2
s_add_u32 s50,s50,1
s_mov_b32 s51,s53
s_waitcnt lgkmcnt(3)
v_smfmac_f32_16x16x64_bf16 v[44:47],v[68:71],v[72:79],v2
ds_read_b128 v[68:71],v5 offset:1024
s_mov_b32 s52,s54
v_smfmac_f32_16x16x64_bf16 v[24:27],v[60:63],a[200:207],v2
ds_read_b128 v[72:75],v21 offset:12288
s_mov_b32 s58,s32
v_smfmac_f32_16x16x64_bf16 v[28:31],v[60:63],a[208:215],v2
ds_read_b128 v[76:79],v21 offset:13312
s_mov_b64 vcc,s[88:89]
v_smfmac_f32_16x16x64_bf16 v[32:35],v[60:63],a[216:223],v2
ds_read_b128 v[48:51],v58 offset:0
v_smfmac_f32_16x16x64_bf16 v[36:39],v[60:63],a[224:231],v2
v_smfmac_f32_16x16x64_bf16 v[40:43],v[60:63],a[232:239],v2
ds_read_b128 v[52:55],v58 offset:1024
s_waitcnt lgkmcnt(5)
v_smfmac_f32_16x16x64_bf16 v[44:47],v[60:63],v[80:87],v2
ds_read_b128 v[60:63],v59 offset:0
v_smfmac_f32_16x16x64_bf16 v[24:27],v[64:67],a[240:247],v2
ds_read_b128 v[80:83],v21 offset:14336
v_smfmac_f32_16x16x64_bf16 v[28:31],v[64:67],a[248:255],v2
ds_read_b128 v[84:87],v21 offset:15360
v_smfmac_f32_16x16x64_bf16 v[32:35],v[64:67],v[112:119],v2
ds_read_b128 v[88:91],v58 offset:2048
v_smfmac_f32_16x16x64_bf16 v[36:39],v[64:67],v[120:127],v2
v_smfmac_f32_16x16x64_bf16 v[40:43],v[64:67],v[128:135],v2
ds_read_b128 v[92:95],v58 offset:3072
s_waitcnt lgkmcnt(7)
v_smfmac_f32_16x16x64_bf16 v[44:47],v[64:67],v[72:79],v2
ds_read_b128 v[64:67],v59 offset:1024
v_smfmac_f32_16x16x64_bf16 v[24:27],v[68:71],v[136:143],v2
ds_read_b128 v[72:75],v21 offset:16384
v_smfmac_f32_16x16x64_bf16 v[28:31],v[68:71],v[144:151],v2
ds_read_b128 v[76:79],v21 offset:17408
v_smfmac_f32_16x16x64_bf16 v[32:35],v[68:71],v[152:159],v2
ds_read_b128 v[96:99],v58 offset:4096
v_smfmac_f32_16x16x64_bf16 v[36:39],v[68:71],v[160:167],v2
v_smfmac_f32_16x16x64_bf16 v[40:43],v[68:71],v[168:175],v2
ds_read_b128 v[100:103],v58 offset:5120
s_waitcnt lgkmcnt(7)
v_smfmac_f32_16x16x64_bf16 v[44:47],v[68:71],v[80:87],v2
ds_read_b128 v[80:83],v21 offset:18432
v_smfmac_f32_16x16x64_bf16 v[24:27],v[60:63],v[176:183],v2
ds_read_b128 v[84:87],v21 offset:19456
v_smfmac_f32_16x16x64_bf16 v[36:39],v[60:63],v[200:207],v2
ds_read_b128 v[104:107],v58 offset:6144
s_waitcnt lgkmcnt(7)
v_smfmac_f32_16x16x64_bf16 v[24:27],v[64:67],v[216:223],v2
v_smfmac_f32_16x16x64_bf16 v[36:39],v[64:67],v[240:247],v2
ds_read_b128 v[108:111],v58 offset:7168
v_smfmac_f32_16x16x64_bf16 v[28:31],v[60:63],v[184:191],v2
v_smfmac_f32_16x16x64_bf16 v[40:43],v[60:63],v[208:215],v2
v_add_f32 v24,v24,v25
v_smfmac_f32_16x16x64_bf16 v[28:31],v[64:67],v[224:231],v2
v_add_f32 v26,v26,v27
v_smfmac_f32_16x16x64_bf16 v[40:43],v[64:67],v[248:255],v2
v_add_f32 v36,v36,v37
v_smfmac_f32_16x16x64_bf16 v[32:35],v[60:63],v[192:199],v2
v_add_f32 v38,v38,v39
s_waitcnt lgkmcnt(6)
v_smfmac_f32_16x16x64_bf16 v[44:47],v[60:63],v[72:79],v2
v_cvt_pk_bf16_f32 v37,v24,v26
v_smfmac_f32_16x16x64_bf16 v[32:35],v[64:67],v[232:239],v2
v_cvt_pk_bf16_f32 v36,v36,v38
s_waitcnt lgkmcnt(2)
v_smfmac_f32_16x16x64_bf16 v[44:47],v[64:67],v[80:87],v2
ds_write_b64 v6,v[36:37] offset:0
v_add_f32 v28,v28,v29
v_add_f32 v30,v30,v31
v_add_f32 v40,v40,v41
v_add_f32 v42,v42,v43
v_cvt_pk_bf16_f32 v41,v28,v30
v_cvt_pk_bf16_f32 v40,v40,v42
ds_write_b64 v6,v[40:41] offset:512
v_add_f32 v32,v32,v33
v_add_f32 v34,v34,v35
v_add_f32 v44,v44,v45
v_add_f32 v46,v46,v47
v_cvt_pk_bf16_f32 v45,v32,v34
v_cvt_pk_bf16_f32 v44,v44,v46
ds_write_b64 v6,v[44:45] offset:1024
ds_read_b128 v[72:75],v58 offset:8192
ds_read_b128 v[76:79],v58 offset:9216
s_waitcnt lgkmcnt(2)
s_barrier
ds_read_b64_tr_b16 v[24:25],v7 offset:0
ds_read_b64_tr_b16 v[26:27],v7 offset:512
ds_read_b64_tr_b16 v[28:29],v7 offset:1024
ds_read_b64_tr_b16 v[30:31],v7 offset:1536
ds_read_b64_tr_b16 v[32:33],v7 offset:2048
ds_read_b64_tr_b16 v[34:35],v7 offset:2560
ds_read_b64_tr_b16 v[36:37],v7 offset:3072
ds_read_b64_tr_b16 v[38:39],v7 offset:3584
s_waitcnt lgkmcnt(6)
v_mfma_f32_16x16x32_bf16 v[60:63],v[48:51],v[24:27],0
ds_read_b64_tr_b16 v[40:41],v7 offset:4096
v_mfma_f32_16x16x32_bf16 v[64:67],v[52:55],v[24:27],0
ds_read_b64_tr_b16 v[42:43],v7 offset:4608
v_mfma_f32_16x16x32_bf16 v[68:71],v[24:27],v[24:27],0
ds_read_b128 v[80:83],v58 offset:10240
s_waitcnt lgkmcnt(7)
v_mfma_f32_16x16x32_bf16 v[60:63],v[88:91],v[28:31],v[60:63]
ds_read_b128 v[84:87],v58 offset:11264
v_mfma_f32_16x16x32_bf16 v[64:67],v[92:95],v[28:31],v[64:67]
ds_read_b64_tr_b16 v[44:45],v7 offset:5120
v_mfma_f32_16x16x32_bf16 v[68:71],v[28:31],v[28:31],v[68:71]
ds_read_b64_tr_b16 v[46:47],v7 offset:5632
s_waitcnt lgkmcnt(8)
v_mfma_f32_16x16x32_bf16 v[60:63],v[96:99],v[32:35],v[60:63]
ds_read_b128 v[24:27],v17 offset:12288
v_mfma_f32_16x16x32_bf16 v[64:67],v[100:103],v[32:35],v[64:67]
ds_read_b128 v[28:31],v17 offset:13312
v_mfma_f32_16x16x32_bf16 v[68:71],v[32:35],v[32:35],v[68:71]
s_waitcnt lgkmcnt(8)
v_mfma_f32_16x16x32_bf16 v[60:63],v[104:107],v[36:39],v[60:63]
ds_read_b128 v[32:35],v17 offset:14336
v_mfma_f32_16x16x32_bf16 v[64:67],v[108:111],v[36:39],v[64:67]
v_mfma_f32_16x16x32_bf16 v[68:71],v[36:39],v[36:39],v[68:71]
s_waitcnt lgkmcnt(7)
v_mfma_f32_16x16x32_bf16 v[60:63],v[72:75],v[40:43],v[60:63]
ds_read_b128 v[36:39],v17 offset:15360
v_mfma_f32_16x16x32_bf16 v[64:67],v[76:79],v[40:43],v[64:67]
v_mfma_f32_16x16x32_bf16 v[68:71],v[40:43],v[40:43],v[68:71]
s_waitcnt lgkmcnt(4)
v_mfma_f32_16x16x32_bf16 v[60:63],v[80:83],v[44:47],v[60:63]
v_mfma_f32_16x16x32_bf16 v[64:67],v[84:87],v[44:47],v[64:67]
buffer_load_dwordx4 v[48:51],v1,s[8:11],s71 offen sc1
v_mfma_f32_16x16x32_bf16 v[68:71],v[44:47],v[44:47],v[68:71]
s_nop 4
v_cndmask_b32_dpp v60,v64,v60,vcc quad_perm:[2,3,2,3] row_mask:0xf bank_mask:0xf
v_cndmask_b32_dpp v61,v65,v61,vcc quad_perm:[2,3,2,3] row_mask:0xf bank_mask:0xf
v_cndmask_b32_dpp v62,v66,v62,vcc quad_perm:[2,3,2,3] row_mask:0xf bank_mask:0xf
v_cndmask_b32_dpp v63,v67,v63,vcc quad_perm:[2,3,2,3] row_mask:0xf bank_mask:0xf
v_max3_f32 v12,v60,v61,v62
v_cndmask_b32_dpp v68,v69,v68,vcc quad_perm:[2,3,2,3] row_mask:0xf bank_mask:0xf
v_max3_f32 v12,v12,v63,v68
s_nop 1
v_max_f32_dpp v13,v12,v12 quad_perm:[2,3,0,1] row_mask:0xf bank_mask:0xf
v_max_f32_dpp v12,v12,v12 quad_perm:[2,3,0,1] row_mask:0xf bank_mask:0xf
s_nop 1
v_permlane32_swap_b32 v12,v13
v_max_f32 v15,v12,v13
v_max_f32 v12,v12,v13
s_mov_b64 exec,1
buffer_store_dword v16,v1,s[8:11],s72 offen sc1
s_mov_b64 exec,-1
v_permlane16_swap_b32 v12,v15
v_max_f32 v12,v12,v15
v_mul_f32 v12,s87,v12
v_fma_f32 v60,v60,s87,-v12
v_fma_f32 v61,v61,s87,-v12
v_fma_f32 v62,v62,s87,-v12
v_fma_f32 v63,v63,s87,-v12
v_fma_f32 v68,v68,s87,-v12
v_exp_f32 v60,v60
v_exp_f32 v61,v61
v_exp_f32 v62,v62
v_exp_f32 v63,v63
v_exp_f32 v68,v68
v_cvt_pk_bf16_f32 v70,v60,v61
v_cvt_pk_bf16_f32 v71,v62,v63
v_cndmask_b32 v46,v70,v10,vcc
v_cndmask_b32 v47,v71,v10,vcc
v_cndmask_b32_dpp v44,v70,v10,vcc quad_perm:[2,3,0,1] row_mask:0xf bank_mask:0xf
v_cndmask_b32_dpp v45,v71,v10,vcc quad_perm:[2,3,0,1] row_mask:0xf bank_mask:0xf
s_mov_b64 vcc,s[90:91]
s_waitcnt lgkmcnt(0)
v_cndmask_b32 v40,v70,v10,vcc
v_mfma_f32_16x16x32_bf16 v[64:67],v[28:31],v[44:47],0
v_cndmask_b32 v41,v71,v10,vcc
v_cndmask_b32_dpp v42,v70,v10,vcc quad_perm:[2,3,0,1] row_mask:0xf bank_mask:0xf
v_mfma_f32_16x16x32_bf16 v[52:55],v[36:39],v[44:47],0
v_cndmask_b32_dpp v43,v71,v10,vcc quad_perm:[2,3,0,1] row_mask:0xf bank_mask:0xf
v_mov_b32_dpp v14,v68 quad_perm:[2,3,0,1] row_mask:0xf bank_mask:0xf
v_add_f32 v12,v60,v61
v_mfma_f32_16x16x32_bf16 v[64:67],v[24:27],v[40:43],v[64:67]
v_cvt_pk_bf16_f32 v56,v68,v14
v_cvt_pk_bf16_f32 v57,v14,v68
v_mfma_f32_16x16x32_bf16 v[52:55],v[32:35],v[40:43],v[52:55]
v_cndmask_b32 v56,v56,v10,vcc
v_cndmask_b32 v57,v10,v57,vcc
ds_read_b32 v0,v9
v_add_f32 v13,v62,v63
v_add_f32 v12,v12,v68
v_add_f32 v12,v12,v13
s_waitcnt vmcnt(1)
v_bitop3_b32 v17,v48,v50,s57 bitop3:0x7e
v_add_f32_dpp v13,v12,v12 quad_perm:[2,3,0,1] row_mask:0xf bank_mask:0xf
v_and_b32 v17,1,v17
v_add_f32_dpp v12,v12,v12 quad_perm:[2,3,0,1] row_mask:0xf bank_mask:0xf
v_cmp_ne_u32 vcc,0,v17
s_cbranch_vccnz vb_102
vo_103:
v_mfma_f32_16x16x16_bf16 v[64:67],v[48:49],v[56:57],v[64:67]
v_permlane32_swap_b32 v12,v13
v_add_f32 v15,v12,v13
v_mfma_f32_16x16x16_bf16 v[52:55],v[50:51],v[56:57],v[52:55]
v_add_f32 v12,v12,v13
s_nop 1
v_permlane16_swap_b32 v12,v15
v_add_f32 v12,v12,v15
v_rcp_f32 v12,v12
s_nop 0
v_mul_f32 v64,v64,v12
v_mul_f32 v65,v65,v12
v_mul_f32 v66,v66,v12
v_mul_f32 v67,v67,v12
v_mul_f32 v52,v52,v12
v_mul_f32 v53,v53,v12
v_mul_f32 v54,v54,v12
v_mul_f32 v55,v55,v12
v_cvt_pk_bf16_f32 v48,v64,v65
v_cvt_pk_bf16_f32 v49,v66,v67
v_cvt_pk_bf16_f32 v50,v52,v53
v_cvt_pk_bf16_f32 v51,v54,v55
v_and_or_b32 v48,v48,-2,s57
buffer_store_dwordx4 v[48:51],v8,s[8:11],s70 offen sc1
s_mov_b32 s57,s31
v_mov_b32 v12,s50
s_waitcnt lgkmcnt(0)
v_cmp_ne_u32 vcc,s50,v0
ds_write_b32 v20,v12
s_cmp_lt_u32 s50,128
s_cbranch_scc1 CS_LOOP_S
s_branch CS_DONE
fr_100:
v_bitop3_b32 v12,v72,v76,s57 bitop3:0x7e
v_bitop3_b32 v13,v80,v80,s57 bitop3:0x7e
v_xor_b32 v14,s57,v80
v_or3_b32 v12,v12,v13,v14
v_and_b32 v12,1,v12
v_cmp_ne_u32 vcc,0,v12
s_cbranch_vccz sk_104
buffer_load_dwordx2 v[80:81],v18,s[8:11],s59 offen sc1
buffer_load_dwordx4 v[72:75],v1,s[8:11],s59 offen sc1
buffer_load_dwordx4 v[76:79],v1,s[8:11],s59 offen offset:1024 sc1
sk_104:
buffer_load_dwordx2 v[90:91],v18,s[8:11],s68 offen sc1
buffer_load_dwordx4 v[82:85],v1,s[8:11],s68 offen sc1
buffer_load_dwordx4 v[86:89],v1,s[8:11],s68 offen offset:1024 sc1
s_sub_u32 s47,s47,1
s_cbranch_scc1 ABORT
s_waitcnt lgkmcnt(0)
s_branch fa_99
vb_102:
s_sub_u32 s47,s47,1
s_cbranch_scc1 ABORT
buffer_load_dwordx4 v[48:51],v1,s[8:11],s71 offen sc1
s_waitcnt vmcnt(0)
v_bitop3_b32 v17,v48,v50,s57 bitop3:0x7e
v_and_b32 v17,1,v17
v_cmp_ne_u32 vcc,0,v17
s_nop 0
s_cbranch_vccnz vb_102
s_branch vo_103
CH_START:
s_sub_u32 s60,s4,s5
s_cmp_gt_i32 s60,13
s_cselect_b32 s53,1,0
s_cmp_eq_u32 s4,64
s_cselect_b32 s53,1,s53
s_cmp_eq_u32 s53,0
s_cselect_b32 s54,s4,s5
s_addc_u32 s4,s4,0
s_add_u32 s5,s5,s53
s_sub_u32 s60,s4,s5
s_cmp_gt_i32 s60,13
s_cselect_b32 s55,1,0
s_cmp_eq_u32 s4,64
s_cselect_b32 s55,1,s55
s_cmp_eq_u32 s55,0
s_cselect_b32 s56,s4,s5
s_addc_u32 s4,s4,0
s_add_u32 s5,s5,s55
s_mov_b32 s74,81920
s_mul_i32 s73,s52,393216
s_add_u32 s73,s73,s84
s_lshl_b32 s75,s51,6
s_add_u32 s75,s75,s52
s_lshl_b32 s75,s75,9
s_add_u32 s75,s75,131072
fl_105:
buffer_load_dword v12,v9,s[8:11],s75 offen sc1
s_waitcnt vmcnt(0)
v_cmp_eq_u32 vcc,0,v12
s_nop 0
s_cbranch_vccz ok_106
s_sleep 1
s_sub_u32 s47,s47,1
s_cbranch_scc1 ABORT
s_branch fl_105
ok_106:
s_add_u32 m0,s74,0
s_add_u32 s67,s73,0
buffer_load_dwordx4 v1,s[8:11],s67 offen sc1 lds
buffer_load_dwordx4 v1,s[8:11],s67 offen offset:1024 sc1 lds
buffer_load_dwordx4 v1,s[8:11],s67 offen offset:2048 sc1 lds
buffer_load_dwordx4 v1,s[8:11],s67 offen offset:3072 sc1 lds
s_add_u32 m0,s74,4096
s_add_u32 s67,s73,4096
buffer_load_dwordx4 v1,s[8:11],s67 offen sc1 lds
buffer_load_dwordx4 v1,s[8:11],s67 offen offset:1024 sc1 lds
buffer_load_dwordx4 v1,s[8:11],s67 offen offset:2048 sc1 lds
buffer_load_dwordx4 v1,s[8:11],s67 offen offset:3072 sc1 lds
s_add_u32 m0,s74,8192
s_add_u32 s67,s73,8192
buffer_load_dwordx4 v1,s[8:11],s67 offen sc1 lds
buffer_load_dwordx4 v1,s[8:11],s67 offen offset:1024 sc1 lds
buffer_load_dwordx4 v1,s[8:11],s67 offen offset:2048 sc1 lds
buffer_load_dwordx4 v1,s[8:11],s67 offen offset:3072 sc1 lds
s_add_u32 m0,s74,12288
s_add_u32 s67,s73,25165824
buffer_load_dwordx4 v1,s[8:11],s67 offen sc1 lds
buffer_load_dwordx4 v1,s[8:11],s67 offen offset:1024 sc1 lds
buffer_load_dwordx4 v1,s[8:11],s67 offen offset:2048 sc1 lds
buffer_load_dwordx4 v1,s[8:11],s67 offen offset:3072 sc1 lds
s_add_u32 m0,s74,16384
s_add_u32 s67,s73,25169920
buffer_load_dwordx4 v1,s[8:11],s67 offen sc1 lds
buffer_load_dwordx4 v1,s[8:11],s67 offen offset:1024 sc1 lds
buffer_load_dwordx4 v1,s[8:11],s67 offen offset:2048 sc1 lds
buffer_load_dwordx4 v1,s[8:11],s67 offen offset:3072 sc1 lds
s_add_u32 m0,s74,20480
s_add_u32 s67,s73,25174016
buffer_load_dwordx4 v1,s[8:11],s67 offen sc1 lds
buffer_load_dwordx4 v1,s[8:11],s67 offen offset:1024 sc1 lds
buffer_load_dwordx4 v1,s[8:11],s67 offen offset:2048 sc1 lds
buffer_load_dwordx4 v1,s[8:11],s67 offen offset:3072 sc1 lds
s_mov_b32 s74,106496
s_mul_i32 s73,s54,393216
s_add_u32 s73,s73,s84
s_lshl_b32 s75,s53,6
s_add_u32 s75,s75,s54
s_lshl_b32 s75,s75,9
s_add_u32 s75,s75,131072
s_lshl_b32 s76,s55,6
s_add_u32 s76,s76,s56
s_lshl_b32 s76,s76,9
s_add_u32 s76,s76,131072
s_mov_b32 s77,1
v_min_u32 v8,2,v0
v_lshlrev_b32 v8,2,v8
v_add_u32 v8,147456,v8
v_mov_b32 v58,147468
s_mov_b32 s80,0
v_mov_b32 v24,0
v_mov_b32 v25,0
v_mov_b32 v26,0
v_mov_b32 v27,0
v_mov_b32 v28,0
v_mov_b32 v29,0
v_mov_b32 v30,0
v_mov_b32 v31,0
v_mov_b32 v32,0
v_mov_b32 v33,0
v_mov_b32 v34,0
v_mov_b32 v35,0
v_mov_b32 v36,0
v_mov_b32 v37,0
v_mov_b32 v38,0
v_mov_b32 v39,0
v_mov_b32 v40,0
v_mov_b32 v41,0
v_mov_b32 v42,0
v_mov_b32 v43,0
v_mov_b32 v44,0
v_mov_b32 v45,0
v_mov_b32 v46,0
v_mov_b32 v47,0
s_nop 1
CH_LOOP:
v_mov_b32 v14,s50
s_nop 1
db_110:
buffer_load_dword v12,v11,s[8:11],s69 offen sc1
s_waitcnt vmcnt(0)
v_cmp_gt_u32 vcc,s58,v12
s_cbranch_vccz dbok_111
s_sub_u32 s47,s47,1
s_cbranch_scc1 ABORT
s_branch db_110
dbok_111:
ds_write_b32 v58,v14
buffer_load_dwordx2 v[68:69],v18,s[8:11],s59 offen sc1
buffer_load_dwordx4 v[60:63],v1,s[8:11],s59 offen sc1
buffer_load_dwordx4 v[64:67],v1,s[8:11],s59 offen offset:1024 sc1
s_barrier
s_waitcnt vmcnt(2)
s_sleep 3
fj_109f:
buffer_load_dwordx2 v[78:79],v18,s[8:11],s68 offen sc1
buffer_load_dwordx4 v[70:73],v1,s[8:11],s68 offen sc1
buffer_load_dwordx4 v[74:77],v1,s[8:11],s68 offen offset:1024 sc1
s_mov_b64 vcc,s[90:91]
ds_read_b64_tr_b16 v[100:101],v7 offset:0
ds_read_b64_tr_b16 v[102:103],v7 offset:512
ds_read_b64_tr_b16 v[48:49],v7 offset:1024
ds_read_b64_tr_b16 v[50:51],v7 offset:1536
ds_read_b64_tr_b16 v[104:105],v7 offset:2048
ds_read_b64_tr_b16 v[106:107],v7 offset:2560
ds_read_b64_tr_b16 v[52:53],v7 offset:3072
ds_read_b64_tr_b16 v[54:55],v7 offset:3584
ds_read_b64_tr_b16 v[108:109],v7 offset:4096
ds_read_b64_tr_b16 v[110:111],v7 offset:4608
ds_read_b64_tr_b16 v[12:13],v7 offset:5120
ds_read_b64_tr_b16 v[14:15],v7 offset:5632
s_waitcnt lgkmcnt(8)
v_cndmask_b32_dpp v100,v48,v100,vcc quad_perm:[0,1,0,1] row_mask:0xf bank_mask:0xf
v_cndmask_b32_dpp v101,v49,v101,vcc quad_perm:[0,1,0,1] row_mask:0xf bank_mask:0xf
v_cndmask_b32_dpp v102,v50,v102,vcc quad_perm:[0,1,0,1] row_mask:0xf bank_mask:0xf
v_cndmask_b32_dpp v103,v51,v103,vcc quad_perm:[0,1,0,1] row_mask:0xf bank_mask:0xf
s_waitcnt lgkmcnt(4)
v_cndmask_b32_dpp v104,v52,v104,vcc quad_perm:[0,1,0,1] row_mask:0xf bank_mask:0xf
v_cndmask_b32_dpp v105,v53,v105,vcc quad_perm:[0,1,0,1] row_mask:0xf bank_mask:0xf
v_cndmask_b32_dpp v106,v54,v106,vcc quad_perm:[0,1,0,1] row_mask:0xf bank_mask:0xf
v_cndmask_b32_dpp v107,v55,v107,vcc quad_perm:[0,1,0,1] row_mask:0xf bank_mask:0xf
s_waitcnt lgkmcnt(0)
v_cndmask_b32_dpp v108,v12,v108,vcc quad_perm:[0,1,0,1] row_mask:0xf bank_mask:0xf
v_cndmask_b32_dpp v109,v13,v109,vcc quad_perm:[0,1,0,1] row_mask:0xf bank_mask:0xf
v_cndmask_b32_dpp v110,v14,v110,vcc quad_perm:[0,1,0,1] row_mask:0xf bank_mask:0xf
v_cndmask_b32_dpp v111,v15,v111,vcc quad_perm:[0,1,0,1] row_mask:0xf bank_mask:0xf
fj_109:
fa_107:
s_waitcnt vmcnt(5)
v_lshlrev_b32 v96,16,v68
v_and_b32 v97,0xffff0000,v68
v_lshlrev_b32 v98,16,v69
v_and_b32 v99,0xffff0000,v69
s_waitcnt vmcnt(4)
v_lshlrev_b32 v80,16,v60
v_and_b32 v81,0xffff0000,v60
v_lshlrev_b32 v82,16,v61
v_and_b32 v83,0xffff0000,v61
v_lshlrev_b32 v84,16,v62
v_and_b32 v85,0xffff0000,v62
v_lshlrev_b32 v86,16,v63
v_and_b32 v87,0xffff0000,v63
s_waitcnt vmcnt(3)
v_lshlrev_b32 v88,16,v64
v_and_b32 v89,0xffff0000,v64
v_lshlrev_b32 v90,16,v65
v_and_b32 v91,0xffff0000,v65
v_lshlrev_b32 v92,16,v66
v_and_b32 v93,0xffff0000,v66
v_lshlrev_b32 v94,16,v67
v_and_b32 v95,0xffff0000,v67
s_waitcnt vmcnt(2)
v_dot2c_f32_bf16 v96,s37,v78
v_dot2c_f32_bf16 v97,s81,v78
v_dot2c_f32_bf16 v98,s37,v79
v_dot2c_f32_bf16 v99,s81,v79
v_bitop3_b32 v16,v68,v78,s57 bitop3:0x7e
v_cvt_pk_bf16_f32 v56,v96,v97
s_nop 0
v_cvt_pk_bf16_f32 v57,v98,v99
ds_write_b64 v23,v[56:57]
s_waitcnt vmcnt(1)
v_dot2c_f32_bf16 v80,s37,v70
v_dot2c_f32_bf16 v81,s81,v70
v_dot2c_f32_bf16 v82,s37,v71
v_dot2c_f32_bf16 v83,s81,v71
v_dot2c_f32_bf16 v84,s37,v72
v_dot2c_f32_bf16 v85,s81,v72
v_dot2c_f32_bf16 v86,s37,v73
v_dot2c_f32_bf16 v87,s81,v73
v_bitop3_b32 v17,v60,v70,s57 bitop3:0x7e
v_or_b32 v16,v16,v17
v_cvt_pk_bf16_f32 v48,v80,v81
v_cvt_pk_bf16_f32 v49,v82,v83
v_cvt_pk_bf16_f32 v50,v84,v85
v_cvt_pk_bf16_f32 v51,v86,v87
ds_write_b128 v22,v[48:51] offset:0
s_waitcnt vmcnt(0)
v_dot2c_f32_bf16 v88,s37,v74
v_dot2c_f32_bf16 v89,s81,v74
v_dot2c_f32_bf16 v90,s37,v75
v_dot2c_f32_bf16 v91,s81,v75
v_dot2c_f32_bf16 v92,s37,v76
v_dot2c_f32_bf16 v93,s81,v76
v_dot2c_f32_bf16 v94,s37,v77
v_dot2c_f32_bf16 v95,s81,v77
v_bitop3_b32 v17,v64,v74,s57 bitop3:0x7e
v_bitop3_b32 v16,v16,v17,1 bitop3:0xa8
v_cmp_ne_u32 vcc,0,v16
v_cvt_pk_bf16_f32 v52,v88,v89
v_cvt_pk_bf16_f32 v53,v90,v91
v_cvt_pk_bf16_f32 v54,v92,v93
v_cvt_pk_bf16_f32 v55,v94,v95
ds_write_b128 v22,v[52:55] offset:1024
s_cbranch_vccnz fr_108
fj_109g:
v_smfmac_f32_16x16x64_bf16 v[24:27],v[48:51],a[0:7],v2
ds_read_b128 v[72:75],v21 offset:0
s_and_b32 s60,s54,1
v_smfmac_f32_16x16x64_bf16 v[28:31],v[48:51],a[8:15],v2
ds_read_b128 v[76:79],v21 offset:1024
s_lshl2_add_u32 s60,s53,s60
v_smfmac_f32_16x16x64_bf16 v[32:35],v[48:51],a[16:23],v2
ds_read_b128 v[80:83],v21 offset:2048
s_lshl_b32 s68,s60,16
v_smfmac_f32_16x16x64_bf16 v[36:39],v[48:51],a[24:31],v2
ds_read_b128 v[84:87],v21 offset:3072
s_add_u32 s68,s68,s83
s_waitcnt lgkmcnt(4)
s_barrier
v_smfmac_f32_16x16x64_bf16 v[40:43],v[48:51],a[32:39],v2
ds_read_b128 v[60:63],v3 offset:0
s_mul_i32 s59,s60,20480
v_smfmac_f32_16x16x64_bf16 v[24:27],v[52:55],a[40:47],v2
ds_read_b128 v[64:67],v3 offset:1024
s_add_u32 s59,s59,s6
v_smfmac_f32_16x16x64_bf16 v[28:31],v[52:55],a[48:55],v2
ds_read_b128 v[68:71],v4 offset:0
s_lshl_b32 s69,s53,9
v_smfmac_f32_16x16x64_bf16 v[32:35],v[52:55],a[56:63],v2
s_add_u32 m0,s74,12288
s_add_u32 s67,s73,25165824
s_add_u32 s69,s69,s7
v_smfmac_f32_16x16x64_bf16 v[36:39],v[52:55],a[64:71],v2
buffer_load_dwordx4 v1,s[8:11],s67 offen sc1 lds
s_bfe_u32 s31,s54,65537
v_smfmac_f32_16x16x64_bf16 v[40:43],v[52:55],a[72:79],v2
buffer_load_dwordx4 v1,s[8:11],s67 offen offset:1024 sc1 lds
s_waitcnt lgkmcnt(5)
v_smfmac_f32_16x16x64_bf16 v[44:47],v[48:51],v[72:79],v2
ds_read_b128 v[72:75],v21 offset:4096
s_waitcnt lgkmcnt(4)
v_smfmac_f32_16x16x64_bf16 v[44:47],v[52:55],v[80:87],v2
ds_read_b128 v[76:79],v21 offset:5120
s_waitcnt lgkmcnt(4)
v_smfmac_f32_16x16x64_bf16 v[24:27],v[60:63],a[80:87],v2
ds_read_b128 v[80:83],v21 offset:6144
s_add_u32 s32,s54,1
v_smfmac_f32_16x16x64_bf16 v[28:31],v[60:63],a[88:95],v2
ds_read_b128 v[84:87],v21 offset:7168
v_smfmac_f32_16x16x64_bf16 v[32:35],v[60:63],a[96:103],v2
buffer_load_dwordx4 v1,s[8:11],s67 offen offset:2048 sc1 lds
v_smfmac_f32_16x16x64_bf16 v[36:39],v[60:63],a[104:111],v2
buffer_load_dwordx4 v1,s[8:11],s67 offen offset:3072 sc1 lds
v_smfmac_f32_16x16x64_bf16 v[40:43],v[60:63],a[112:119],v2
s_add_u32 m0,s74,16384
s_add_u32 s67,s73,25169920
s_waitcnt lgkmcnt(2)
v_smfmac_f32_16x16x64_bf16 v[44:47],v[60:63],v[72:79],v2
ds_read_b128 v[60:63],v4 offset:1024
v_smfmac_f32_16x16x64_bf16 v[24:27],v[64:67],a[120:127],v2
ds_read_b128 v[72:75],v21 offset:8192
v_smfmac_f32_16x16x64_bf16 v[28:31],v[64:67],a[128:135],v2
ds_read_b128 v[76:79],v21 offset:9216
v_smfmac_f32_16x16x64_bf16 v[32:35],v[64:67],a[136:143],v2
v_mov_b32 v17,1
buffer_load_dwordx4 v1,s[8:11],s67 offen sc1 lds
v_smfmac_f32_16x16x64_bf16 v[36:39],v[64:67],a[144:151],v2
s_mov_b64 exec,1
buffer_store_dword v17,v1,s[8:11],s79 offen sc1
s_mov_b64 exec,-1
v_smfmac_f32_16x16x64_bf16 v[40:43],v[64:67],a[152:159],v2
buffer_store_dwordx4 v[100:103],v20,s[8:11],s78 offen sc1
s_waitcnt lgkmcnt(3)
v_smfmac_f32_16x16x64_bf16 v[44:47],v[64:67],v[80:87],v2
ds_read_b128 v[64:67],v5 offset:0
v_smfmac_f32_16x16x64_bf16 v[24:27],v[68:71],a[160:167],v2
ds_read_b128 v[80:83],v21 offset:10240
v_smfmac_f32_16x16x64_bf16 v[28:31],v[68:71],a[168:175],v2
ds_read_b128 v[84:87],v21 offset:11264
v_smfmac_f32_16x16x64_bf16 v[32:35],v[68:71],a[176:183],v2
buffer_store_dwordx4 v[104:107],v20,s[8:11],s78 offen offset:1024 sc1
v_smfmac_f32_16x16x64_bf16 v[36:39],v[68:71],a[184:191],v2
buffer_store_dwordx4 v[108:111],v20,s[8:11],s78 offen offset:2048 sc1
s_and_b32 s79,s78,2147483648
v_smfmac_f32_16x16x64_bf16 v[40:43],v[68:71],a[192:199],v2
s_or_b32 s79,s79,s30
s_mov_b32 s78,2147483648
s_waitcnt lgkmcnt(3)
v_smfmac_f32_16x16x64_bf16 v[44:47],v[68:71],v[72:79],v2
ds_read_b128 v[68:71],v5 offset:1024
v_smfmac_f32_16x16x64_bf16 v[24:27],v[60:63],a[200:207],v2
ds_read_b128 v[72:75],v21 offset:12288
v_smfmac_f32_16x16x64_bf16 v[28:31],v[60:63],a[208:215],v2
ds_read_b128 v[76:79],v21 offset:13312
v_smfmac_f32_16x16x64_bf16 v[32:35],v[60:63],a[216:223],v2
buffer_load_dword v10,v9,s[8:11],s76 offen sc1
v_smfmac_f32_16x16x64_bf16 v[36:39],v[60:63],a[224:231],v2
buffer_load_dwordx4 v1,s[8:11],s67 offen offset:1024 sc1 lds
v_smfmac_f32_16x16x64_bf16 v[40:43],v[60:63],a[232:239],v2
buffer_load_dwordx4 v1,s[8:11],s67 offen offset:2048 sc1 lds
s_waitcnt lgkmcnt(3)
v_smfmac_f32_16x16x64_bf16 v[44:47],v[60:63],v[80:87],v2
ds_read_b128 v[60:63],v59 offset:0
v_smfmac_f32_16x16x64_bf16 v[24:27],v[64:67],a[240:247],v2
ds_read_b128 v[80:83],v21 offset:14336
v_smfmac_f32_16x16x64_bf16 v[28:31],v[64:67],a[248:255],v2
ds_read_b128 v[84:87],v21 offset:15360
v_smfmac_f32_16x16x64_bf16 v[32:35],v[64:67],v[112:119],v2
buffer_load_dwordx4 v1,s[8:11],s67 offen offset:3072 sc1 lds
v_smfmac_f32_16x16x64_bf16 v[36:39],v[64:67],v[120:127],v2
s_add_u32 m0,s74,20480
s_add_u32 s67,s73,25174016
v_smfmac_f32_16x16x64_bf16 v[40:43],v[64:67],v[128:135],v2
buffer_load_dwordx4 v1,s[8:11],s67 offen sc1 lds
s_waitcnt lgkmcnt(3)
v_smfmac_f32_16x16x64_bf16 v[44:47],v[64:67],v[72:79],v2
ds_read_b128 v[64:67],v59 offset:1024
v_smfmac_f32_16x16x64_bf16 v[24:27],v[68:71],v[136:143],v2
ds_read_b128 v[72:75],v21 offset:16384
v_smfmac_f32_16x16x64_bf16 v[28:31],v[68:71],v[144:151],v2
ds_read_b128 v[76:79],v21 offset:17408
v_smfmac_f32_16x16x64_bf16 v[32:35],v[68:71],v[152:159],v2
buffer_load_dwordx4 v1,s[8:11],s67 offen offset:1024 sc1 lds
v_smfmac_f32_16x16x64_bf16 v[36:39],v[68:71],v[160:167],v2
buffer_load_dwordx4 v1,s[8:11],s67 offen offset:2048 sc1 lds
v_smfmac_f32_16x16x64_bf16 v[40:43],v[68:71],v[168:175],v2
buffer_load_dwordx4 v1,s[8:11],s67 offen offset:3072 sc1 lds
s_waitcnt lgkmcnt(3)
v_smfmac_f32_16x16x64_bf16 v[44:47],v[68:71],v[80:87],v2
ds_read_b128 v[80:83],v21 offset:18432
v_smfmac_f32_16x16x64_bf16 v[24:27],v[60:63],v[176:183],v2
ds_read_b128 v[84:87],v21 offset:19456
v_smfmac_f32_16x16x64_bf16 v[36:39],v[60:63],v[200:207],v2
s_waitcnt lgkmcnt(4)
v_smfmac_f32_16x16x64_bf16 v[24:27],v[64:67],v[216:223],v2
v_smfmac_f32_16x16x64_bf16 v[36:39],v[64:67],v[240:247],v2
v_smfmac_f32_16x16x64_bf16 v[28:31],v[60:63],v[184:191],v2
v_smfmac_f32_16x16x64_bf16 v[40:43],v[60:63],v[208:215],v2
v_add_f32 v24,v24,v25
v_smfmac_f32_16x16x64_bf16 v[28:31],v[64:67],v[224:231],v2
v_add_f32 v26,v26,v27
v_smfmac_f32_16x16x64_bf16 v[40:43],v[64:67],v[248:255],v2
v_add_f32 v36,v36,v37
v_smfmac_f32_16x16x64_bf16 v[32:35],v[60:63],v[192:199],v2
v_add_f32 v38,v38,v39
s_waitcnt lgkmcnt(2)
v_smfmac_f32_16x16x64_bf16 v[44:47],v[60:63],v[72:79],v2
v_cvt_pk_bf16_f32 v37,v24,v26
v_smfmac_f32_16x16x64_bf16 v[32:35],v[64:67],v[232:239],v2
v_cvt_pk_bf16_f32 v36,v36,v38
s_waitcnt lgkmcnt(0)
v_smfmac_f32_16x16x64_bf16 v[44:47],v[64:67],v[80:87],v2
ds_write_b64 v6,v[36:37] offset:0
v_add_f32 v28,v28,v29
v_add_f32 v30,v30,v31
v_add_f32 v40,v40,v41
v_add_f32 v42,v42,v43
v_cvt_pk_bf16_f32 v41,v28,v30
v_cvt_pk_bf16_f32 v40,v40,v42
ds_write_b64 v6,v[40:41] offset:512
v_add_f32 v32,v32,v33
v_add_f32 v34,v34,v35
v_add_f32 v44,v44,v45
v_add_f32 v46,v46,v47
v_cvt_pk_bf16_f32 v45,v32,v34
v_cvt_pk_bf16_f32 v44,v44,v46
ds_write_b64 v6,v[44:45] offset:1024
s_waitcnt lgkmcnt(0)
s_barrier
buffer_load_dword v16,v11,s[8:11],s69 offen sc1
s_lshl_b32 s60,s51,6
s_add_u32 s60,s60,s52
s_mul_i32 s78,s60,196608
s_add_u32 s78,s78,s85
s_lshl_b32 s60,s60,10
s_add_u32 s30,s60,s86
s_cmp_ge_u32 s54,63
s_cselect_b32 s77,0,s77
s_cmp_eq_u32 s53,s51
s_cselect_b32 s60,1,s77
s_cmp_eq_u32 s60,0
s_cbranch_scc0 h1_112
h2_113:
s_add_u32 s50,s50,1
s_mov_b32 s51,s53
s_mov_b32 s52,s54
s_mov_b32 s57,s31
s_mov_b32 s58,s32
s_mov_b32 s53,s55
s_mov_b32 s54,s56
s_mov_b32 s75,s76
s_sub_u32 s60,s4,s5
s_cmp_gt_i32 s60,13
s_cselect_b32 s55,1,0
s_cmp_eq_u32 s4,64
s_cselect_b32 s55,1,s55
s_cmp_eq_u32 s55,0
s_cselect_b32 s56,s4,s5
s_addc_u32 s4,s4,0
s_add_u32 s5,s5,s55
s_lshl_b32 s76,s55,6
s_add_u32 s76,s76,s56
s_lshl_b32 s76,s76,9
s_add_u32 s76,s76,131072
s_mul_i32 s73,s54,393216
s_add_u32 s73,s73,s84
s_xor_b32 s74,s74,57344
v_mov_b32 v24,0
v_mov_b32 v25,0
v_mov_b32 v26,0
v_mov_b32 v27,0
v_mov_b32 v28,0
v_mov_b32 v29,0
v_mov_b32 v30,0
v_mov_b32 v31,0
v_mov_b32 v32,0
v_mov_b32 v33,0
v_mov_b32 v34,0
v_mov_b32 v35,0
v_mov_b32 v36,0
v_mov_b32 v37,0
v_mov_b32 v38,0
v_mov_b32 v39,0
v_mov_b32 v40,0
v_mov_b32 v41,0
v_mov_b32 v42,0
v_mov_b32 v43,0
v_mov_b32 v44,0
v_mov_b32 v45,0
v_mov_b32 v46,0
v_mov_b32 v47,0
s_waitcnt vmcnt(0)
v_cmp_eq_u32 vcc,0,v10
s_cmp_lg_u64 vcc,0
s_cselect_b32 s77,1,0
v_cmp_gt_u32 vcc,s58,v16
s_nop 0
s_cbranch_vccz CH_RUNG
s_cmp_lt_u32 s50,128
s_cbranch_scc1 CH_LOOP
s_branch CS_DONE
h1_112:
s_mov_b64 vcc,s[90:91]
ds_read_b64_tr_b16 v[100:101],v7 offset:0
ds_read_b64_tr_b16 v[102:103],v7 offset:512
ds_read_b64_tr_b16 v[48:49],v7 offset:1024
ds_read_b64_tr_b16 v[50:51],v7 offset:1536
ds_read_b64_tr_b16 v[104:105],v7 offset:2048
ds_read_b64_tr_b16 v[106:107],v7 offset:2560
ds_read_b64_tr_b16 v[52:53],v7 offset:3072
ds_read_b64_tr_b16 v[54:55],v7 offset:3584
ds_read_b64_tr_b16 v[108:109],v7 offset:4096
ds_read_b64_tr_b16 v[110:111],v7 offset:4608
ds_read_b64_tr_b16 v[12:13],v7 offset:5120
ds_read_b64_tr_b16 v[14:15],v7 offset:5632
s_waitcnt lgkmcnt(8)
v_cndmask_b32_dpp v100,v48,v100,vcc quad_perm:[0,1,0,1] row_mask:0xf bank_mask:0xf
v_cndmask_b32_dpp v101,v49,v101,vcc quad_perm:[0,1,0,1] row_mask:0xf bank_mask:0xf
v_cndmask_b32_dpp v102,v50,v102,vcc quad_perm:[0,1,0,1] row_mask:0xf bank_mask:0xf
v_cndmask_b32_dpp v103,v51,v103,vcc quad_perm:[0,1,0,1] row_mask:0xf bank_mask:0xf
s_waitcnt lgkmcnt(4)
v_cndmask_b32_dpp v104,v52,v104,vcc quad_perm:[0,1,0,1] row_mask:0xf bank_mask:0xf
v_cndmask_b32_dpp v105,v53,v105,vcc quad_perm:[0,1,0,1] row_mask:0xf bank_mask:0xf
v_cndmask_b32_dpp v106,v54,v106,vcc quad_perm:[0,1,0,1] row_mask:0xf bank_mask:0xf
v_cndmask_b32_dpp v107,v55,v107,vcc quad_perm:[0,1,0,1] row_mask:0xf bank_mask:0xf
s_waitcnt lgkmcnt(0)
v_cndmask_b32_dpp v108,v12,v108,vcc quad_perm:[0,1,0,1] row_mask:0xf bank_mask:0xf
v_cndmask_b32_dpp v109,v13,v109,vcc quad_perm:[0,1,0,1] row_mask:0xf bank_mask:0xf
v_cndmask_b32_dpp v110,v14,v110,vcc quad_perm:[0,1,0,1] row_mask:0xf bank_mask:0xf
v_cndmask_b32_dpp v111,v15,v111,vcc quad_perm:[0,1,0,1] row_mask:0xf bank_mask:0xf
s_cmp_eq_u32 s50,127
s_cbranch_scc1 sp_114x
sp_114:
ds_read_b32 v12,v8
s_waitcnt lgkmcnt(0)
v_cmp_ge_u32 vcc,s50,v12
s_nop 0
s_cbranch_vccz ok_115
s_sleep 1
s_sub_u32 s47,s47,1
s_cbranch_scc1 ABORT
s_branch sp_114
ok_115:
sp_114x:
s_waitcnt vmcnt(0)
s_cmp_ge_u32 s79,2147483648
s_cbranch_scc1 pf_116
v_mov_b32 v17,1
s_mov_b64 exec,1
buffer_store_dword v17,v1,s[8:11],s79 offen sc1
s_mov_b64 exec,-1
s_mov_b32 s79,2147483648
pf_116:
s_cmp_eq_u32 s78,2147483648
s_cbranch_scc1 pk_117
buffer_store_dwordx4 v[100:103],v20,s[8:11],s78 offen sc1
buffer_store_dwordx4 v[104:107],v20,s[8:11],s78 offen offset:1024 sc1
buffer_store_dwordx4 v[108:111],v20,s[8:11],s78 offen offset:2048 sc1
s_mov_b32 s79,s30
s_mov_b32 s78,2147483648
pk_117:
s_waitcnt vmcnt(0)
s_cmp_ge_u32 s79,2147483648
s_cbranch_scc1 pf_118
v_mov_b32 v17,1
s_mov_b64 exec,1
buffer_store_dword v17,v1,s[8:11],s79 offen sc1
s_mov_b64 exec,-1
s_mov_b32 s79,2147483648
pf_118:
s_cmp_eq_u32 s77,0
s_cbranch_scc1 h2_113
fl_119:
buffer_load_dword v12,v9,s[8:11],s75 offen sc1
s_waitcnt vmcnt(0)
v_cmp_eq_u32 vcc,0,v12
s_nop 0
s_cbranch_vccz ok_120
s_sleep 1
s_sub_u32 s47,s47,1
s_cbranch_scc1 ABORT
s_branch fl_119
ok_120:
s_add_u32 m0,s74,0
s_add_u32 s67,s73,0
buffer_load_dwordx4 v1,s[8:11],s67 offen sc1 lds
buffer_load_dwordx4 v1,s[8:11],s67 offen offset:1024 sc1 lds
buffer_load_dwordx4 v1,s[8:11],s67 offen offset:2048 sc1 lds
buffer_load_dwordx4 v1,s[8:11],s67 offen offset:3072 sc1 lds
s_add_u32 m0,s74,4096
s_add_u32 s67,s73,4096
buffer_load_dwordx4 v1,s[8:11],s67 offen sc1 lds
buffer_load_dwordx4 v1,s[8:11],s67 offen offset:1024 sc1 lds
buffer_load_dwordx4 v1,s[8:11],s67 offen offset:2048 sc1 lds
buffer_load_dwordx4 v1,s[8:11],s67 offen offset:3072 sc1 lds
s_add_u32 m0,s74,8192
s_add_u32 s67,s73,8192
buffer_load_dwordx4 v1,s[8:11],s67 offen sc1 lds
buffer_load_dwordx4 v1,s[8:11],s67 offen offset:1024 sc1 lds
buffer_load_dwordx4 v1,s[8:11],s67 offen offset:2048 sc1 lds
buffer_load_dwordx4 v1,s[8:11],s67 offen offset:3072 sc1 lds
s_add_u32 m0,s74,12288
s_add_u32 s67,s73,25165824
buffer_load_dwordx4 v1,s[8:11],s67 offen sc1 lds
buffer_load_dwordx4 v1,s[8:11],s67 offen offset:1024 sc1 lds
buffer_load_dwordx4 v1,s[8:11],s67 offen offset:2048 sc1 lds
buffer_load_dwordx4 v1,s[8:11],s67 offen offset:3072 sc1 lds
s_add_u32 m0,s74,16384
s_add_u32 s67,s73,25169920
buffer_load_dwordx4 v1,s[8:11],s67 offen sc1 lds
buffer_load_dwordx4 v1,s[8:11],s67 offen offset:1024 sc1 lds
buffer_load_dwordx4 v1,s[8:11],s67 offen offset:2048 sc1 lds
buffer_load_dwordx4 v1,s[8:11],s67 offen offset:3072 sc1 lds
s_add_u32 m0,s74,20480
s_add_u32 s67,s73,25174016
buffer_load_dwordx4 v1,s[8:11],s67 offen sc1 lds
buffer_load_dwordx4 v1,s[8:11],s67 offen offset:1024 sc1 lds
buffer_load_dwordx4 v1,s[8:11],s67 offen offset:2048 sc1 lds
buffer_load_dwordx4 v1,s[8:11],s67 offen offset:3072 sc1 lds
s_branch h2_113
fr_108:
v_bitop3_b32 v12,v60,v64,s57 bitop3:0x7e
v_bitop3_b32 v13,v68,v68,s57 bitop3:0x7e
v_xor_b32 v14,s57,v68
v_or3_b32 v12,v12,v13,v14
v_and_b32 v12,1,v12
v_cmp_ne_u32 vcc,0,v12
s_cbranch_vccz sk_121
buffer_load_dwordx2 v[68:69],v18,s[8:11],s59 offen sc1
buffer_load_dwordx4 v[60:63],v1,s[8:11],s59 offen sc1
buffer_load_dwordx4 v[64:67],v1,s[8:11],s59 offen offset:1024 sc1
sk_121:
buffer_load_dwordx2 v[78:79],v18,s[8:11],s68 offen sc1
buffer_load_dwordx4 v[70:73],v1,s[8:11],s68 offen sc1
buffer_load_dwordx4 v[74:77],v1,s[8:11],s68 offen offset:1024 sc1
s_sub_u32 s47,s47,1
s_cbranch_scc1 ABORT
s_waitcnt lgkmcnt(0)
s_branch fa_107
CH_RUNG:
v_mov_b32 v14,s50
ds_write_b32 v58,v14
buffer_load_dwordx2 v[68:69],v18,s[8:11],s59 offen sc1
buffer_load_dwordx4 v[60:63],v1,s[8:11],s59 offen sc1
buffer_load_dwordx4 v[64:67],v1,s[8:11],s59 offen offset:1024 sc1
fj_109e:
buffer_load_dwordx2 v[78:79],v18,s[8:11],s68 offen sc1
buffer_load_dwordx4 v[70:73],v1,s[8:11],s68 offen sc1
buffer_load_dwordx4 v[74:77],v1,s[8:11],s68 offen offset:1024 sc1
s_mov_b64 vcc,s[90:91]
ds_read_b64_tr_b16 v[100:101],v7 offset:0
ds_read_b64_tr_b16 v[102:103],v7 offset:512
ds_read_b64_tr_b16 v[48:49],v7 offset:1024
ds_read_b64_tr_b16 v[50:51],v7 offset:1536
ds_read_b64_tr_b16 v[104:105],v7 offset:2048
ds_read_b64_tr_b16 v[106:107],v7 offset:2560
ds_read_b64_tr_b16 v[52:53],v7 offset:3072
ds_read_b64_tr_b16 v[54:55],v7 offset:3584
ds_read_b64_tr_b16 v[108:109],v7 offset:4096
ds_read_b64_tr_b16 v[110:111],v7 offset:4608
ds_read_b64_tr_b16 v[12:13],v7 offset:5120
ds_read_b64_tr_b16 v[14:15],v7 offset:5632
s_waitcnt lgkmcnt(8)
v_cndmask_b32_dpp v100,v48,v100,vcc quad_perm:[0,1,0,1] row_mask:0xf bank_mask:0xf
v_cndmask_b32_dpp v101,v49,v101,vcc quad_perm:[0,1,0,1] row_mask:0xf bank_mask:0xf
v_cndmask_b32_dpp v102,v50,v102,vcc quad_perm:[0,1,0,1] row_mask:0xf bank_mask:0xf
v_cndmask_b32_dpp v103,v51,v103,vcc quad_perm:[0,1,0,1] row_mask:0xf bank_mask:0xf
s_waitcnt lgkmcnt(4)
v_cndmask_b32_dpp v104,v52,v104,vcc quad_perm:[0,1,0,1] row_mask:0xf bank_mask:0xf
v_cndmask_b32_dpp v105,v53,v105,vcc quad_perm:[0,1,0,1] row_mask:0xf bank_mask:0xf
v_cndmask_b32_dpp v106,v54,v106,vcc quad_perm:[0,1,0,1] row_mask:0xf bank_mask:0xf
v_cndmask_b32_dpp v107,v55,v107,vcc quad_perm:[0,1,0,1] row_mask:0xf bank_mask:0xf
s_waitcnt lgkmcnt(0)
v_cndmask_b32_dpp v108,v12,v108,vcc quad_perm:[0,1,0,1] row_mask:0xf bank_mask:0xf
v_cndmask_b32_dpp v109,v13,v109,vcc quad_perm:[0,1,0,1] row_mask:0xf bank_mask:0xf
v_cndmask_b32_dpp v110,v14,v110,vcc quad_perm:[0,1,0,1] row_mask:0xf bank_mask:0xf
v_cndmask_b32_dpp v111,v15,v111,vcc quad_perm:[0,1,0,1] row_mask:0xf bank_mask:0xf
s_barrier
s_branch fj_109
CS_DONE:
v_lshrrev_b32 v0,4,v1
s_add_u32 s61,s48,0
s_endpgm
CV_START:
s_and_b32 s60,s46,1
s_lshl1_add_u32 s60,s49,s60
s_cmp_eq_u32 s60,1
s_cbranch_scc1 CV_LOOP_F1
s_cmp_eq_u32 s60,2
s_cbranch_scc1 CV_LOOP_S0
s_cmp_eq_u32 s60,3
s_cbranch_scc1 CV_LOOP_S1
CV_LOOP_F0:
v_mov_b32 v24,0
v_mov_b32 v25,0
v_mov_b32 v26,0
v_mov_b32 v27,0
v_mov_b32 v28,0
v_mov_b32 v29,0
v_mov_b32 v30,0
v_mov_b32 v31,0
v_mov_b32 v32,0
v_mov_b32 v33,0
v_mov_b32 v34,0
v_mov_b32 v35,0
v_mov_b32 v36,0
v_mov_b32 v37,0
v_mov_b32 v38,0
v_mov_b32 v39,0
v_mov_b32 v40,0
v_mov_b32 v41,0
v_mov_b32 v42,0
v_mov_b32 v43,0
v_mov_b32 v44,0
v_mov_b32 v45,0
v_mov_b32 v46,0
v_mov_b32 v47,0
s_cmp_lg_u32 s46,0
s_cbranch_scc1 np_125
db_126:
buffer_load_dword v12,v11,s[8:11],s69 offen sc1
s_waitcnt vmcnt(0)
v_cmp_gt_u32 vcc,s58,v12
s_cbranch_vccz dbok_127
s_sub_u32 s47,s47,1
s_cbranch_scc1 ABORT
s_branch db_126
dbok_127:
np_125:
s_barrier
buffer_load_dwordx2 v[68:69],v18,s[8:11],s59 offen sc1
buffer_load_dwordx4 v[60:63],v1,s[8:11],s59 offen sc1
buffer_load_dwordx4 v[64:67],v1,s[8:11],s59 offen offset:1024 sc1
s_waitcnt vmcnt(2)
s_sleep 3
fj_124f:
buffer_load_dwordx2 v[78:79],v18,s[8:11],s68 offen sc1
buffer_load_dwordx4 v[70:73],v1,s[8:11],s68 offen sc1
buffer_load_dwordx4 v[74:77],v1,s[8:11],s68 offen offset:1024 sc1
fj_124:
fa_122:
s_waitcnt vmcnt(5)
v_lshlrev_b32 v96,16,v68
v_and_b32 v97,0xffff0000,v68
v_lshlrev_b32 v98,16,v69
v_and_b32 v99,0xffff0000,v69
s_waitcnt vmcnt(4)
v_lshlrev_b32 v80,16,v60
v_and_b32 v81,0xffff0000,v60
v_lshlrev_b32 v82,16,v61
v_and_b32 v83,0xffff0000,v61
v_lshlrev_b32 v84,16,v62
v_and_b32 v85,0xffff0000,v62
v_lshlrev_b32 v86,16,v63
v_and_b32 v87,0xffff0000,v63
s_waitcnt vmcnt(3)
v_lshlrev_b32 v88,16,v64
v_and_b32 v89,0xffff0000,v64
v_lshlrev_b32 v90,16,v65
v_and_b32 v91,0xffff0000,v65
v_lshlrev_b32 v92,16,v66
v_and_b32 v93,0xffff0000,v66
v_lshlrev_b32 v94,16,v67
v_and_b32 v95,0xffff0000,v67
s_waitcnt vmcnt(2)
v_dot2c_f32_bf16 v96,s37,v78
v_dot2c_f32_bf16 v97,s81,v78
v_dot2c_f32_bf16 v98,s37,v79
v_dot2c_f32_bf16 v99,s81,v79
v_bitop3_b32 v16,v68,v78,s57 bitop3:0x7e
v_cvt_pk_bf16_f32 v56,v96,v97
s_nop 0
v_cvt_pk_bf16_f32 v57,v98,v99
ds_write_b64 v23,v[56:57]
s_waitcnt vmcnt(1)
v_dot2c_f32_bf16 v80,s37,v70
v_dot2c_f32_bf16 v81,s81,v70
v_dot2c_f32_bf16 v82,s37,v71
v_dot2c_f32_bf16 v83,s81,v71
v_dot2c_f32_bf16 v84,s37,v72
v_dot2c_f32_bf16 v85,s81,v72
v_dot2c_f32_bf16 v86,s37,v73
v_dot2c_f32_bf16 v87,s81,v73
v_bitop3_b32 v17,v60,v70,s57 bitop3:0x7e
v_or_b32 v16,v16,v17
v_cvt_pk_bf16_f32 v48,v80,v81
v_cvt_pk_bf16_f32 v49,v82,v83
v_cvt_pk_bf16_f32 v50,v84,v85
v_cvt_pk_bf16_f32 v51,v86,v87
ds_write_b128 v22,v[48:51] offset:0
s_waitcnt vmcnt(0)
v_dot2c_f32_bf16 v88,s37,v74
v_dot2c_f32_bf16 v89,s81,v74
v_dot2c_f32_bf16 v90,s37,v75
v_dot2c_f32_bf16 v91,s81,v75
v_dot2c_f32_bf16 v92,s37,v76
v_dot2c_f32_bf16 v93,s81,v76
v_dot2c_f32_bf16 v94,s37,v77
v_dot2c_f32_bf16 v95,s81,v77
v_bitop3_b32 v17,v64,v74,s57 bitop3:0x7e
v_bitop3_b32 v16,v16,v17,1 bitop3:0xa8
v_cmp_ne_u32 vcc,0,v16
v_cvt_pk_bf16_f32 v52,v88,v89
v_cvt_pk_bf16_f32 v53,v90,v91
v_cvt_pk_bf16_f32 v54,v92,v93
v_cvt_pk_bf16_f32 v55,v94,v95
ds_write_b128 v22,v[52:55] offset:1024
s_cbranch_vccnz fr_123
fj_124g:
v_smfmac_f32_16x16x64_bf16 v[24:27],v[48:51],a[0:7],v2
ds_read_b128 v[72:75],v21 offset:0
s_and_b32 s60,s52,1
v_smfmac_f32_16x16x64_bf16 v[28:31],v[48:51],a[8:15],v2
ds_read_b128 v[76:79],v21 offset:1024
s_lshl2_add_u32 s60,s51,s60
v_smfmac_f32_16x16x64_bf16 v[32:35],v[48:51],a[16:23],v2
ds_read_b128 v[80:83],v21 offset:2048
s_mul_i32 s60,s60,49152
v_smfmac_f32_16x16x64_bf16 v[36:39],v[48:51],a[24:31],v2
ds_read_b128 v[84:87],v21 offset:3072
s_add_u32 s71,s60,s34
s_waitcnt lgkmcnt(4)
s_barrier
v_smfmac_f32_16x16x64_bf16 v[40:43],v[48:51],a[32:39],v2
ds_read_b128 v[60:63],v3 offset:0
v_smfmac_f32_16x16x64_bf16 v[24:27],v[52:55],a[40:47],v2
ds_read_b128 v[64:67],v3 offset:1024
v_mov_b32 v17,1
v_smfmac_f32_16x16x64_bf16 v[28:31],v[52:55],a[48:55],v2
ds_read_b128 v[68:71],v4 offset:0
v_smfmac_f32_16x16x64_bf16 v[32:35],v[52:55],a[56:63],v2
s_mov_b64 exec,1
buffer_store_dword v17,v1,s[8:11],s79 offen sc1
s_mov_b64 exec,-1
v_smfmac_f32_16x16x64_bf16 v[36:39],v[52:55],a[64:71],v2
buffer_store_dwordx4 v[100:103],v6,s[8:11],s78 offen sc1
v_smfmac_f32_16x16x64_bf16 v[40:43],v[52:55],a[72:79],v2
buffer_store_dwordx2 v[104:105],v7,s[8:11],s78 offen sc1
s_waitcnt lgkmcnt(5)
v_smfmac_f32_16x16x64_bf16 v[44:47],v[48:51],v[72:79],v2
ds_read_b128 v[72:75],v21 offset:4096
s_waitcnt lgkmcnt(4)
v_smfmac_f32_16x16x64_bf16 v[44:47],v[52:55],v[80:87],v2
ds_read_b128 v[76:79],v21 offset:5120
s_waitcnt lgkmcnt(4)
v_smfmac_f32_16x16x64_bf16 v[24:27],v[60:63],a[80:87],v2
ds_read_b128 v[80:83],v21 offset:6144
s_and_b32 s79,s78,2147483648
v_smfmac_f32_16x16x64_bf16 v[28:31],v[60:63],a[88:95],v2
ds_read_b128 v[84:87],v21 offset:7168
s_or_b32 s79,s79,s30
v_smfmac_f32_16x16x64_bf16 v[32:35],v[60:63],a[96:103],v2
s_mov_b32 s78,2147483648
v_smfmac_f32_16x16x64_bf16 v[36:39],v[60:63],a[104:111],v2
v_smfmac_f32_16x16x64_bf16 v[40:43],v[60:63],a[112:119],v2
s_waitcnt lgkmcnt(2)
v_smfmac_f32_16x16x64_bf16 v[44:47],v[60:63],v[72:79],v2
ds_read_b128 v[60:63],v4 offset:1024
v_smfmac_f32_16x16x64_bf16 v[24:27],v[64:67],a[120:127],v2
ds_read_b128 v[72:75],v21 offset:8192
v_smfmac_f32_16x16x64_bf16 v[28:31],v[64:67],a[128:135],v2
ds_read_b128 v[76:79],v21 offset:9216
v_smfmac_f32_16x16x64_bf16 v[32:35],v[64:67],a[136:143],v2
v_smfmac_f32_16x16x64_bf16 v[36:39],v[64:67],a[144:151],v2
v_smfmac_f32_16x16x64_bf16 v[40:43],v[64:67],a[152:159],v2
s_waitcnt lgkmcnt(3)
v_smfmac_f32_16x16x64_bf16 v[44:47],v[64:67],v[80:87],v2
ds_read_b128 v[64:67],v5 offset:0
v_smfmac_f32_16x16x64_bf16 v[24:27],v[68:71],a[160:167],v2
ds_read_b128 v[80:83],v21 offset:10240
v_smfmac_f32_16x16x64_bf16 v[28:31],v[68:71],a[168:175],v2
ds_read_b128 v[84:87],v21 offset:11264
v_smfmac_f32_16x16x64_bf16 v[32:35],v[68:71],a[176:183],v2
v_smfmac_f32_16x16x64_bf16 v[36:39],v[68:71],a[184:191],v2
v_smfmac_f32_16x16x64_bf16 v[40:43],v[68:71],a[192:199],v2
s_waitcnt lgkmcnt(3)
v_smfmac_f32_16x16x64_bf16 v[44:47],v[68:71],v[72:79],v2
ds_read_b128 v[68:71],v5 offset:1024
v_smfmac_f32_16x16x64_bf16 v[24:27],v[60:63],a[200:207],v2
ds_read_b128 v[72:75],v21 offset:12288
v_smfmac_f32_16x16x64_bf16 v[28:31],v[60:63],a[208:215],v2
ds_read_b128 v[76:79],v21 offset:13312
v_smfmac_f32_16x16x64_bf16 v[32:35],v[60:63],a[216:223],v2
v_smfmac_f32_16x16x64_bf16 v[36:39],v[60:63],a[224:231],v2
v_smfmac_f32_16x16x64_bf16 v[40:43],v[60:63],a[232:239],v2
s_waitcnt lgkmcnt(3)
v_smfmac_f32_16x16x64_bf16 v[44:47],v[60:63],v[80:87],v2
ds_read_b128 v[60:63],v59 offset:0
v_smfmac_f32_16x16x64_bf16 v[24:27],v[64:67],a[240:247],v2
ds_read_b128 v[80:83],v21 offset:14336
v_smfmac_f32_16x16x64_bf16 v[28:31],v[64:67],a[248:255],v2
ds_read_b128 v[84:87],v21 offset:15360
v_smfmac_f32_16x16x64_bf16 v[32:35],v[64:67],v[112:119],v2
v_smfmac_f32_16x16x64_bf16 v[36:39],v[64:67],v[120:127],v2
v_smfmac_f32_16x16x64_bf16 v[40:43],v[64:67],v[128:135],v2
s_waitcnt lgkmcnt(3)
v_smfmac_f32_16x16x64_bf16 v[44:47],v[64:67],v[72:79],v2
ds_read_b128 v[64:67],v59 offset:1024
v_smfmac_f32_16x16x64_bf16 v[24:27],v[68:71],v[136:143],v2
ds_read_b128 v[72:75],v21 offset:16384
v_smfmac_f32_16x16x64_bf16 v[28:31],v[68:71],v[144:151],v2
ds_read_b128 v[76:79],v21 offset:17408
v_smfmac_f32_16x16x64_bf16 v[32:35],v[68:71],v[152:159],v2
v_smfmac_f32_16x16x64_bf16 v[36:39],v[68:71],v[160:167],v2
v_smfmac_f32_16x16x64_bf16 v[40:43],v[68:71],v[168:175],v2
s_waitcnt lgkmcnt(3)
v_smfmac_f32_16x16x64_bf16 v[44:47],v[68:71],v[80:87],v2
ds_read_b128 v[80:83],v21 offset:18432
v_smfmac_f32_16x16x64_bf16 v[24:27],v[60:63],v[176:183],v2
ds_read_b128 v[84:87],v21 offset:19456
v_smfmac_f32_16x16x64_bf16 v[28:31],v[60:63],v[184:191],v2
s_waitcnt lgkmcnt(4)
v_smfmac_f32_16x16x64_bf16 v[24:27],v[64:67],v[216:223],v2
v_smfmac_f32_16x16x64_bf16 v[28:31],v[64:67],v[224:231],v2
v_smfmac_f32_16x16x64_bf16 v[32:35],v[60:63],v[192:199],v2
v_smfmac_f32_16x16x64_bf16 v[36:39],v[60:63],v[200:207],v2
v_add_f32 v24,v24,v25
v_smfmac_f32_16x16x64_bf16 v[32:35],v[64:67],v[232:239],v2
v_add_f32 v26,v26,v27
v_smfmac_f32_16x16x64_bf16 v[36:39],v[64:67],v[240:247],v2
v_add_f32 v28,v28,v29
v_smfmac_f32_16x16x64_bf16 v[40:43],v[60:63],v[208:215],v2
v_add_f32 v30,v30,v31
s_waitcnt lgkmcnt(2)
v_smfmac_f32_16x16x64_bf16 v[44:47],v[60:63],v[72:79],v2
v_cvt_pk_bf16_f32 v100,v24,v26
v_smfmac_f32_16x16x64_bf16 v[40:43],v[64:67],v[248:255],v2
v_cvt_pk_bf16_f32 v101,v28,v30
s_waitcnt lgkmcnt(0)
v_smfmac_f32_16x16x64_bf16 v[44:47],v[64:67],v[80:87],v2
v_and_or_b32 v100,v100,-2,s57
v_add_f32 v32,v32,v33
v_add_f32 v34,v34,v35
v_add_f32 v36,v36,v37
v_add_f32 v38,v38,v39
v_cvt_pk_bf16_f32 v102,v32,v34
v_cvt_pk_bf16_f32 v103,v36,v38
v_and_or_b32 v102,v102,-2,s57
buffer_store_dwordx4 v[100:103],v6,s[8:11],s71 offen
v_add_f32 v40,v40,v41
v_add_f32 v42,v42,v43
v_add_f32 v44,v44,v45
v_add_f32 v46,v46,v47
v_cvt_pk_bf16_f32 v104,v40,v42
v_cvt_pk_bf16_f32 v105,v44,v46
v_and_or_b32 v104,v104,-2,s57
buffer_store_dwordx2 v[104:105],v7,s[8:11],s71 offen
s_lshl_b32 s60,s51,6
s_add_u32 s60,s60,s52
s_mul_i32 s78,s60,196608
s_add_u32 s78,s78,s85
s_lshl_b32 s60,s60,10
s_add_u32 s30,s60,s86
s_sub_u32 s60,s4,s5
s_cmp_gt_i32 s60,13
s_cselect_b32 s53,1,0
s_cmp_eq_u32 s4,64
s_cselect_b32 s53,1,s53
s_cmp_eq_u32 s53,0
s_cselect_b32 s54,s4,s5
s_addc_u32 s4,s4,0
s_add_u32 s5,s5,s53
s_and_b32 s60,s54,1
s_lshl2_add_u32 s60,s53,s60
s_lshl_b32 s68,s60,16
s_add_u32 s68,s68,s83
s_mul_i32 s59,s60,20480
s_add_u32 s59,s59,s6
s_lshl_b32 s69,s53,9
s_add_u32 s69,s69,s7
s_bfe_u32 s31,s54,65537
s_add_u32 s32,s54,1
s_cmp_lg_u32 s53,s51
s_cbranch_scc1 nx_128
s_waitcnt vmcnt(0)
s_cmp_ge_u32 s79,2147483648
s_cbranch_scc1 pf_129
v_mov_b32 v17,1
s_mov_b64 exec,1
buffer_store_dword v17,v1,s[8:11],s79 offen sc1
s_mov_b64 exec,-1
s_mov_b32 s79,2147483648
pf_129:
s_cmp_eq_u32 s78,2147483648
s_cbranch_scc1 pk_130
buffer_store_dwordx4 v[100:103],v6,s[8:11],s78 offen sc1
buffer_store_dwordx2 v[104:105],v7,s[8:11],s78 offen sc1
s_mov_b32 s79,s30
s_mov_b32 s78,2147483648
pk_130:
s_waitcnt vmcnt(0)
s_cmp_ge_u32 s79,2147483648
s_cbranch_scc1 pf_131
v_mov_b32 v17,1
s_mov_b64 exec,1
buffer_store_dword v17,v1,s[8:11],s79 offen sc1
s_mov_b64 exec,-1
s_mov_b32 s79,2147483648
pf_131:
nx_128:
s_add_u32 s50,s50,1
s_mov_b32 s51,s53
s_mov_b32 s52,s54
s_mov_b32 s57,s31
s_mov_b32 s58,s32
s_cmp_lt_u32 s50,128
s_cbranch_scc1 CV_LOOP_F0
s_branch CV_DONE
fr_123:
v_bitop3_b32 v12,v60,v64,s57 bitop3:0x7e
v_bitop3_b32 v13,v68,v68,s57 bitop3:0x7e
v_xor_b32 v14,s57,v68
v_or3_b32 v12,v12,v13,v14
v_and_b32 v12,1,v12
v_cmp_ne_u32 vcc,0,v12
s_cbranch_vccz sk_132
buffer_load_dwordx2 v[68:69],v18,s[8:11],s59 offen sc1
buffer_load_dwordx4 v[60:63],v1,s[8:11],s59 offen sc1
buffer_load_dwordx4 v[64:67],v1,s[8:11],s59 offen offset:1024 sc1
sk_132:
buffer_load_dwordx2 v[78:79],v18,s[8:11],s68 offen sc1
buffer_load_dwordx4 v[70:73],v1,s[8:11],s68 offen sc1
buffer_load_dwordx4 v[74:77],v1,s[8:11],s68 offen offset:1024 sc1
s_sub_u32 s47,s47,1
s_cbranch_scc1 ABORT
s_waitcnt lgkmcnt(0)
s_branch fa_122
CV_LOOP_F1:
v_mov_b32 v24,0
v_mov_b32 v25,0
v_mov_b32 v26,0
v_mov_b32 v27,0
v_mov_b32 v28,0
v_mov_b32 v29,0
v_mov_b32 v30,0
v_mov_b32 v31,0
v_mov_b32 v32,0
v_mov_b32 v33,0
v_mov_b32 v34,0
v_mov_b32 v35,0
v_mov_b32 v36,0
v_mov_b32 v37,0
v_mov_b32 v38,0
v_mov_b32 v39,0
v_mov_b32 v40,0
v_mov_b32 v41,0
v_mov_b32 v42,0
v_mov_b32 v43,0
v_mov_b32 v44,0
v_mov_b32 v45,0
v_mov_b32 v46,0
v_mov_b32 v47,0
s_barrier
buffer_load_dwordx2 v[68:69],v18,s[8:11],s59 offen sc1
buffer_load_dwordx4 v[60:63],v1,s[8:11],s59 offen sc1
buffer_load_dwordx4 v[64:67],v1,s[8:11],s59 offen offset:1024 sc1
s_waitcnt vmcnt(2)
s_sleep 3
fj_135f:
buffer_load_dwordx2 v[78:79],v18,s[8:11],s68 offen sc1
buffer_load_dwordx4 v[70:73],v1,s[8:11],s68 offen sc1
buffer_load_dwordx4 v[74:77],v1,s[8:11],s68 offen offset:1024 sc1
fj_135:
fa_133:
s_waitcnt vmcnt(5)
v_lshlrev_b32 v96,16,v68
v_and_b32 v97,0xffff0000,v68
v_lshlrev_b32 v98,16,v69
v_and_b32 v99,0xffff0000,v69
s_waitcnt vmcnt(4)
v_lshlrev_b32 v80,16,v60
v_and_b32 v81,0xffff0000,v60
v_lshlrev_b32 v82,16,v61
v_and_b32 v83,0xffff0000,v61
v_lshlrev_b32 v84,16,v62
v_and_b32 v85,0xffff0000,v62
v_lshlrev_b32 v86,16,v63
v_and_b32 v87,0xffff0000,v63
s_waitcnt vmcnt(3)
v_lshlrev_b32 v88,16,v64
v_and_b32 v89,0xffff0000,v64
v_lshlrev_b32 v90,16,v65
v_and_b32 v91,0xffff0000,v65
v_lshlrev_b32 v92,16,v66
v_and_b32 v93,0xffff0000,v66
v_lshlrev_b32 v94,16,v67
v_and_b32 v95,0xffff0000,v67
s_waitcnt vmcnt(2)
v_dot2c_f32_bf16 v96,s37,v78
v_dot2c_f32_bf16 v97,s81,v78
v_dot2c_f32_bf16 v98,s37,v79
v_dot2c_f32_bf16 v99,s81,v79
v_bitop3_b32 v16,v68,v78,s57 bitop3:0x7e
v_cvt_pk_bf16_f32 v56,v96,v97
s_nop 0
v_cvt_pk_bf16_f32 v57,v98,v99
ds_write_b64 v23,v[56:57]
s_waitcnt vmcnt(1)
v_dot2c_f32_bf16 v80,s37,v70
v_dot2c_f32_bf16 v81,s81,v70
v_dot2c_f32_bf16 v82,s37,v71
v_dot2c_f32_bf16 v83,s81,v71
v_dot2c_f32_bf16 v84,s37,v72
v_dot2c_f32_bf16 v85,s81,v72
v_dot2c_f32_bf16 v86,s37,v73
v_dot2c_f32_bf16 v87,s81,v73
v_bitop3_b32 v17,v60,v70,s57 bitop3:0x7e
v_or_b32 v16,v16,v17
v_cvt_pk_bf16_f32 v48,v80,v81
v_cvt_pk_bf16_f32 v49,v82,v83
v_cvt_pk_bf16_f32 v50,v84,v85
v_cvt_pk_bf16_f32 v51,v86,v87
ds_write_b128 v22,v[48:51] offset:0
s_waitcnt vmcnt(0)
v_dot2c_f32_bf16 v88,s37,v74
v_dot2c_f32_bf16 v89,s81,v74
v_dot2c_f32_bf16 v90,s37,v75
v_dot2c_f32_bf16 v91,s81,v75
v_dot2c_f32_bf16 v92,s37,v76
v_dot2c_f32_bf16 v93,s81,v76
v_dot2c_f32_bf16 v94,s37,v77
v_dot2c_f32_bf16 v95,s81,v77
v_bitop3_b32 v17,v64,v74,s57 bitop3:0x7e
v_bitop3_b32 v16,v16,v17,1 bitop3:0xa8
v_cmp_ne_u32 vcc,0,v16
v_cvt_pk_bf16_f32 v52,v88,v89
v_cvt_pk_bf16_f32 v53,v90,v91
v_cvt_pk_bf16_f32 v54,v92,v93
v_cvt_pk_bf16_f32 v55,v94,v95
ds_write_b128 v22,v[52:55] offset:1024
s_cbranch_vccnz fr_134
fj_135g:
v_smfmac_f32_16x16x64_bf16 v[24:27],v[48:51],a[0:7],v2
ds_read_b128 v[72:75],v21 offset:0
s_and_b32 s60,s52,1
v_smfmac_f32_16x16x64_bf16 v[28:31],v[48:51],a[8:15],v2
ds_read_b128 v[76:79],v21 offset:1024
s_lshl2_add_u32 s60,s51,s60
v_smfmac_f32_16x16x64_bf16 v[32:35],v[48:51],a[16:23],v2
ds_read_b128 v[80:83],v21 offset:2048
s_mul_i32 s60,s60,49152
v_smfmac_f32_16x16x64_bf16 v[36:39],v[48:51],a[24:31],v2
ds_read_b128 v[84:87],v21 offset:3072
s_add_u32 s71,s60,s34
s_waitcnt lgkmcnt(4)
s_barrier
v_smfmac_f32_16x16x64_bf16 v[40:43],v[48:51],a[32:39],v2
ds_read_b128 v[60:63],v3 offset:0
v_smfmac_f32_16x16x64_bf16 v[24:27],v[52:55],a[40:47],v2
ds_read_b128 v[64:67],v3 offset:1024
v_mov_b32 v17,1
v_smfmac_f32_16x16x64_bf16 v[28:31],v[52:55],a[48:55],v2
ds_read_b128 v[68:71],v4 offset:0
v_smfmac_f32_16x16x64_bf16 v[32:35],v[52:55],a[56:63],v2
s_mov_b64 exec,1
buffer_store_dword v17,v1,s[8:11],s79 offen sc1
s_mov_b64 exec,-1
v_smfmac_f32_16x16x64_bf16 v[36:39],v[52:55],a[64:71],v2
buffer_store_dwordx4 v[102:105],v6,s[8:11],s78 offen sc1
v_smfmac_f32_16x16x64_bf16 v[40:43],v[52:55],a[72:79],v2
buffer_store_dwordx2 v[100:101],v7,s[8:11],s78 offen sc1
s_waitcnt lgkmcnt(5)
v_smfmac_f32_16x16x64_bf16 v[44:47],v[48:51],v[72:79],v2
ds_read_b128 v[72:75],v21 offset:4096
s_waitcnt lgkmcnt(4)
v_smfmac_f32_16x16x64_bf16 v[44:47],v[52:55],v[80:87],v2
ds_read_b128 v[76:79],v21 offset:5120
s_waitcnt lgkmcnt(4)
v_smfmac_f32_16x16x64_bf16 v[24:27],v[60:63],a[80:87],v2
ds_read_b128 v[80:83],v21 offset:6144
s_and_b32 s79,s78,2147483648
v_smfmac_f32_16x16x64_bf16 v[28:31],v[60:63],a[88:95],v2
ds_read_b128 v[84:87],v21 offset:7168
s_or_b32 s79,s79,s30
v_smfmac_f32_16x16x64_bf16 v[32:35],v[60:63],a[96:103],v2
s_mov_b32 s78,2147483648
v_smfmac_f32_16x16x64_bf16 v[36:39],v[60:63],a[104:111],v2
v_smfmac_f32_16x16x64_bf16 v[40:43],v[60:63],a[112:119],v2
s_waitcnt lgkmcnt(2)
v_smfmac_f32_16x16x64_bf16 v[44:47],v[60:63],v[72:79],v2
ds_read_b128 v[60:63],v4 offset:1024
v_smfmac_f32_16x16x64_bf16 v[24:27],v[64:67],a[120:127],v2
ds_read_b128 v[72:75],v21 offset:8192
v_smfmac_f32_16x16x64_bf16 v[28:31],v[64:67],a[128:135],v2
ds_read_b128 v[76:79],v21 offset:9216
v_smfmac_f32_16x16x64_bf16 v[32:35],v[64:67],a[136:143],v2
v_smfmac_f32_16x16x64_bf16 v[36:39],v[64:67],a[144:151],v2
v_smfmac_f32_16x16x64_bf16 v[40:43],v[64:67],a[152:159],v2
s_waitcnt lgkmcnt(3)
v_smfmac_f32_16x16x64_bf16 v[44:47],v[64:67],v[80:87],v2
ds_read_b128 v[64:67],v5 offset:0
v_smfmac_f32_16x16x64_bf16 v[24:27],v[68:71],a[160:167],v2
ds_read_b128 v[80:83],v21 offset:10240
v_smfmac_f32_16x16x64_bf16 v[28:31],v[68:71],a[168:175],v2
ds_read_b128 v[84:87],v21 offset:11264
v_smfmac_f32_16x16x64_bf16 v[32:35],v[68:71],a[176:183],v2
v_smfmac_f32_16x16x64_bf16 v[36:39],v[68:71],a[184:191],v2
v_smfmac_f32_16x16x64_bf16 v[40:43],v[68:71],a[192:199],v2
s_waitcnt lgkmcnt(3)
v_smfmac_f32_16x16x64_bf16 v[44:47],v[68:71],v[72:79],v2
ds_read_b128 v[68:71],v5 offset:1024
v_smfmac_f32_16x16x64_bf16 v[24:27],v[60:63],a[200:207],v2
ds_read_b128 v[72:75],v21 offset:12288
v_smfmac_f32_16x16x64_bf16 v[28:31],v[60:63],a[208:215],v2
ds_read_b128 v[76:79],v21 offset:13312
v_smfmac_f32_16x16x64_bf16 v[32:35],v[60:63],a[216:223],v2
v_smfmac_f32_16x16x64_bf16 v[36:39],v[60:63],a[224:231],v2
v_smfmac_f32_16x16x64_bf16 v[40:43],v[60:63],a[232:239],v2
s_waitcnt lgkmcnt(3)
v_smfmac_f32_16x16x64_bf16 v[44:47],v[60:63],v[80:87],v2
ds_read_b128 v[60:63],v59 offset:0
v_smfmac_f32_16x16x64_bf16 v[24:27],v[64:67],a[240:247],v2
ds_read_b128 v[80:83],v21 offset:14336
v_smfmac_f32_16x16x64_bf16 v[28:31],v[64:67],a[248:255],v2
ds_read_b128 v[84:87],v21 offset:15360
v_smfmac_f32_16x16x64_bf16 v[32:35],v[64:67],v[112:119],v2
v_smfmac_f32_16x16x64_bf16 v[36:39],v[64:67],v[120:127],v2
v_smfmac_f32_16x16x64_bf16 v[40:43],v[64:67],v[128:135],v2
s_waitcnt lgkmcnt(3)
v_smfmac_f32_16x16x64_bf16 v[44:47],v[64:67],v[72:79],v2
ds_read_b128 v[64:67],v59 offset:1024
v_smfmac_f32_16x16x64_bf16 v[24:27],v[68:71],v[136:143],v2
ds_read_b128 v[72:75],v21 offset:16384
v_smfmac_f32_16x16x64_bf16 v[28:31],v[68:71],v[144:151],v2
ds_read_b128 v[76:79],v21 offset:17408
v_smfmac_f32_16x16x64_bf16 v[32:35],v[68:71],v[152:159],v2
v_smfmac_f32_16x16x64_bf16 v[36:39],v[68:71],v[160:167],v2
v_smfmac_f32_16x16x64_bf16 v[40:43],v[68:71],v[168:175],v2
s_waitcnt lgkmcnt(3)
v_smfmac_f32_16x16x64_bf16 v[44:47],v[68:71],v[80:87],v2
ds_read_b128 v[80:83],v21 offset:18432
v_smfmac_f32_16x16x64_bf16 v[24:27],v[60:63],v[176:183],v2
ds_read_b128 v[84:87],v21 offset:19456
v_smfmac_f32_16x16x64_bf16 v[28:31],v[60:63],v[184:191],v2
s_waitcnt lgkmcnt(4)
v_smfmac_f32_16x16x64_bf16 v[24:27],v[64:67],v[216:223],v2
v_smfmac_f32_16x16x64_bf16 v[28:31],v[64:67],v[224:231],v2
v_smfmac_f32_16x16x64_bf16 v[32:35],v[60:63],v[192:199],v2
v_smfmac_f32_16x16x64_bf16 v[36:39],v[60:63],v[200:207],v2
v_add_f32 v24,v24,v25
v_smfmac_f32_16x16x64_bf16 v[32:35],v[64:67],v[232:239],v2
v_add_f32 v26,v26,v27
v_smfmac_f32_16x16x64_bf16 v[36:39],v[64:67],v[240:247],v2
v_add_f32 v28,v28,v29
v_smfmac_f32_16x16x64_bf16 v[40:43],v[60:63],v[208:215],v2
v_add_f32 v30,v30,v31
s_waitcnt lgkmcnt(2)
v_smfmac_f32_16x16x64_bf16 v[44:47],v[60:63],v[72:79],v2
v_cvt_pk_bf16_f32 v100,v24,v26
v_smfmac_f32_16x16x64_bf16 v[40:43],v[64:67],v[248:255],v2
v_cvt_pk_bf16_f32 v101,v28,v30
s_waitcnt lgkmcnt(0)
v_smfmac_f32_16x16x64_bf16 v[44:47],v[64:67],v[80:87],v2
v_and_or_b32 v100,v100,-2,s57
buffer_store_dwordx2 v[100:101],v7,s[8:11],s71 offen
v_add_f32 v32,v32,v33
v_add_f32 v34,v34,v35
v_add_f32 v36,v36,v37
v_add_f32 v38,v38,v39
v_cvt_pk_bf16_f32 v102,v32,v34
v_cvt_pk_bf16_f32 v103,v36,v38
v_and_or_b32 v102,v102,-2,s57
v_add_f32 v40,v40,v41
v_add_f32 v42,v42,v43
v_add_f32 v44,v44,v45
v_add_f32 v46,v46,v47
v_cvt_pk_bf16_f32 v104,v40,v42
v_cvt_pk_bf16_f32 v105,v44,v46
v_and_or_b32 v104,v104,-2,s57
buffer_store_dwordx4 v[102:105],v6,s[8:11],s71 offen
s_lshl_b32 s60,s51,6
s_add_u32 s60,s60,s52
s_mul_i32 s78,s60,196608
s_add_u32 s78,s78,s85
s_lshl_b32 s60,s60,10
s_add_u32 s30,s60,s86
s_sub_u32 s60,s4,s5
s_cmp_gt_i32 s60,13
s_cselect_b32 s53,1,0
s_cmp_eq_u32 s4,64
s_cselect_b32 s53,1,s53
s_cmp_eq_u32 s53,0
s_cselect_b32 s54,s4,s5
s_addc_u32 s4,s4,0
s_add_u32 s5,s5,s53
s_and_b32 s60,s54,1
s_lshl2_add_u32 s60,s53,s60
s_lshl_b32 s68,s60,16
s_add_u32 s68,s68,s83
s_mul_i32 s59,s60,20480
s_add_u32 s59,s59,s6
s_lshl_b32 s69,s53,9
s_add_u32 s69,s69,s7
s_bfe_u32 s31,s54,65537
s_add_u32 s32,s54,1
s_cmp_lg_u32 s53,s51
s_cbranch_scc1 nx_136
s_waitcnt vmcnt(0)
s_cmp_ge_u32 s79,2147483648
s_cbranch_scc1 pf_137
v_mov_b32 v17,1
s_mov_b64 exec,1
buffer_store_dword v17,v1,s[8:11],s79 offen sc1
s_mov_b64 exec,-1
s_mov_b32 s79,2147483648
pf_137:
s_cmp_eq_u32 s78,2147483648
s_cbranch_scc1 pk_138
buffer_store_dwordx4 v[102:105],v6,s[8:11],s78 offen sc1
buffer_store_dwordx2 v[100:101],v7,s[8:11],s78 offen sc1
s_mov_b32 s79,s30
s_mov_b32 s78,2147483648
pk_138:
s_waitcnt vmcnt(0)
s_cmp_ge_u32 s79,2147483648
s_cbranch_scc1 pf_139
v_mov_b32 v17,1
s_mov_b64 exec,1
buffer_store_dword v17,v1,s[8:11],s79 offen sc1
s_mov_b64 exec,-1
s_mov_b32 s79,2147483648
pf_139:
nx_136:
s_add_u32 s50,s50,1
s_mov_b32 s51,s53
s_mov_b32 s52,s54
s_mov_b32 s57,s31
s_mov_b32 s58,s32
s_cmp_lt_u32 s50,128
s_cbranch_scc1 CV_LOOP_F1
s_branch CV_DONE
fr_134:
v_bitop3_b32 v12,v60,v64,s57 bitop3:0x7e
v_bitop3_b32 v13,v68,v68,s57 bitop3:0x7e
v_xor_b32 v14,s57,v68
v_or3_b32 v12,v12,v13,v14
v_and_b32 v12,1,v12
v_cmp_ne_u32 vcc,0,v12
s_cbranch_vccz sk_140
buffer_load_dwordx2 v[68:69],v18,s[8:11],s59 offen sc1
buffer_load_dwordx4 v[60:63],v1,s[8:11],s59 offen sc1
buffer_load_dwordx4 v[64:67],v1,s[8:11],s59 offen offset:1024 sc1
sk_140:
buffer_load_dwordx2 v[78:79],v18,s[8:11],s68 offen sc1
buffer_load_dwordx4 v[70:73],v1,s[8:11],s68 offen sc1
buffer_load_dwordx4 v[74:77],v1,s[8:11],s68 offen offset:1024 sc1
s_sub_u32 s47,s47,1
s_cbranch_scc1 ABORT
s_waitcnt lgkmcnt(0)
s_branch fa_133
CV_LOOP_S0:
v_mov_b32 v24,0
v_mov_b32 v25,0
v_mov_b32 v26,0
v_mov_b32 v27,0
v_mov_b32 v28,0
v_mov_b32 v29,0
v_mov_b32 v30,0
v_mov_b32 v31,0
v_mov_b32 v32,0
v_mov_b32 v33,0
v_mov_b32 v34,0
v_mov_b32 v35,0
v_mov_b32 v36,0
v_mov_b32 v37,0
v_mov_b32 v38,0
v_mov_b32 v39,0
v_mov_b32 v40,0
v_mov_b32 v41,0
v_mov_b32 v42,0
v_mov_b32 v43,0
v_mov_b32 v44,0
v_mov_b32 v45,0
v_mov_b32 v46,0
v_mov_b32 v47,0
s_cmp_lg_u32 s46,0
s_cbranch_scc1 np_144
db_145:
buffer_load_dword v12,v11,s[8:11],s69 offen sc1
s_waitcnt vmcnt(0)
v_cmp_gt_u32 vcc,s58,v12
s_cbranch_vccz dbok_146
s_sub_u32 s47,s47,1
s_cbranch_scc1 ABORT
s_branch db_145
dbok_146:
np_144:
s_barrier
buffer_load_dwordx2 v[68:69],v18,s[8:11],s59 offen sc1
buffer_load_dwordx4 v[60:63],v1,s[8:11],s59 offen sc1
buffer_load_dwordx4 v[64:67],v1,s[8:11],s59 offen offset:1024 sc1
s_waitcnt vmcnt(2)
s_sleep 3
fj_143f:
buffer_load_dwordx2 v[78:79],v18,s[8:11],s68 offen sc1
buffer_load_dwordx4 v[70:73],v1,s[8:11],s68 offen sc1
buffer_load_dwordx4 v[74:77],v1,s[8:11],s68 offen offset:1024 sc1
fj_143:
fa_141:
s_waitcnt vmcnt(5)
v_lshlrev_b32 v96,16,v68
v_and_b32 v97,0xffff0000,v68
v_lshlrev_b32 v98,16,v69
v_and_b32 v99,0xffff0000,v69
s_waitcnt vmcnt(4)
v_lshlrev_b32 v80,16,v60
v_and_b32 v81,0xffff0000,v60
v_lshlrev_b32 v82,16,v61
v_and_b32 v83,0xffff0000,v61
v_lshlrev_b32 v84,16,v62
v_and_b32 v85,0xffff0000,v62
v_lshlrev_b32 v86,16,v63
v_and_b32 v87,0xffff0000,v63
s_waitcnt vmcnt(3)
v_lshlrev_b32 v88,16,v64
v_and_b32 v89,0xffff0000,v64
v_lshlrev_b32 v90,16,v65
v_and_b32 v91,0xffff0000,v65
v_lshlrev_b32 v92,16,v66
v_and_b32 v93,0xffff0000,v66
v_lshlrev_b32 v94,16,v67
v_and_b32 v95,0xffff0000,v67
s_waitcnt vmcnt(2)
v_dot2c_f32_bf16 v96,s37,v78
v_dot2c_f32_bf16 v97,s81,v78
v_dot2c_f32_bf16 v98,s37,v79
v_dot2c_f32_bf16 v99,s81,v79
v_bitop3_b32 v16,v68,v78,s57 bitop3:0x7e
v_cvt_pk_bf16_f32 v56,v96,v97
s_nop 0
v_cvt_pk_bf16_f32 v57,v98,v99
ds_write_b64 v23,v[56:57]
s_waitcnt vmcnt(1)
v_dot2c_f32_bf16 v80,s37,v70
v_dot2c_f32_bf16 v81,s81,v70
v_dot2c_f32_bf16 v82,s37,v71
v_dot2c_f32_bf16 v83,s81,v71
v_dot2c_f32_bf16 v84,s37,v72
v_dot2c_f32_bf16 v85,s81,v72
v_dot2c_f32_bf16 v86,s37,v73
v_dot2c_f32_bf16 v87,s81,v73
v_bitop3_b32 v17,v60,v70,s57 bitop3:0x7e
v_or_b32 v16,v16,v17
v_cvt_pk_bf16_f32 v48,v80,v81
v_cvt_pk_bf16_f32 v49,v82,v83
v_cvt_pk_bf16_f32 v50,v84,v85
v_cvt_pk_bf16_f32 v51,v86,v87
ds_write_b128 v22,v[48:51] offset:0
s_waitcnt vmcnt(0)
v_dot2c_f32_bf16 v88,s37,v74
v_dot2c_f32_bf16 v89,s81,v74
v_dot2c_f32_bf16 v90,s37,v75
v_dot2c_f32_bf16 v91,s81,v75
v_dot2c_f32_bf16 v92,s37,v76
v_dot2c_f32_bf16 v93,s81,v76
v_dot2c_f32_bf16 v94,s37,v77
v_dot2c_f32_bf16 v95,s81,v77
v_bitop3_b32 v17,v64,v74,s57 bitop3:0x7e
v_bitop3_b32 v16,v16,v17,1 bitop3:0xa8
v_cmp_ne_u32 vcc,0,v16
v_cvt_pk_bf16_f32 v52,v88,v89
v_cvt_pk_bf16_f32 v53,v90,v91
v_cvt_pk_bf16_f32 v54,v92,v93
v_cvt_pk_bf16_f32 v55,v94,v95
ds_write_b128 v22,v[52:55] offset:1024
s_cbranch_vccnz fr_142
fj_143g:
v_smfmac_f32_16x16x64_bf16 v[24:27],v[48:51],a[0:7],v2
ds_read_b128 v[72:75],v21 offset:0
s_and_b32 s60,s52,1
v_smfmac_f32_16x16x64_bf16 v[28:31],v[48:51],a[8:15],v2
ds_read_b128 v[76:79],v21 offset:1024
s_lshl2_add_u32 s60,s51,s60
v_smfmac_f32_16x16x64_bf16 v[32:35],v[48:51],a[16:23],v2
ds_read_b128 v[80:83],v21 offset:2048
s_mul_i32 s60,s60,49152
v_smfmac_f32_16x16x64_bf16 v[36:39],v[48:51],a[24:31],v2
ds_read_b128 v[84:87],v21 offset:3072
s_add_u32 s71,s60,s34
s_waitcnt lgkmcnt(4)
s_barrier
v_smfmac_f32_16x16x64_bf16 v[40:43],v[48:51],a[32:39],v2
ds_read_b128 v[60:63],v3 offset:0
v_smfmac_f32_16x16x64_bf16 v[24:27],v[52:55],a[40:47],v2
ds_read_b128 v[64:67],v3 offset:1024
v_mov_b32 v17,1
v_smfmac_f32_16x16x64_bf16 v[28:31],v[52:55],a[48:55],v2
ds_read_b128 v[68:71],v4 offset:0
v_smfmac_f32_16x16x64_bf16 v[32:35],v[52:55],a[56:63],v2
s_mov_b64 exec,1
buffer_store_dword v17,v1,s[8:11],s79 offen sc1
s_mov_b64 exec,-1
v_smfmac_f32_16x16x64_bf16 v[36:39],v[52:55],a[64:71],v2
buffer_store_dwordx4 v[100:103],v6,s[8:11],s78 offen sc1
v_smfmac_f32_16x16x64_bf16 v[40:43],v[52:55],a[72:79],v2
buffer_store_dwordx2 v[104:105],v7,s[8:11],s78 offen sc1
s_waitcnt lgkmcnt(5)
v_smfmac_f32_16x16x64_bf16 v[44:47],v[48:51],v[72:79],v2
ds_read_b128 v[72:75],v21 offset:4096
s_waitcnt lgkmcnt(4)
v_smfmac_f32_16x16x64_bf16 v[44:47],v[52:55],v[80:87],v2
ds_read_b128 v[76:79],v21 offset:5120
s_waitcnt lgkmcnt(4)
v_smfmac_f32_16x16x64_bf16 v[24:27],v[60:63],a[80:87],v2
ds_read_b128 v[80:83],v21 offset:6144
s_and_b32 s79,s78,2147483648
v_smfmac_f32_16x16x64_bf16 v[28:31],v[60:63],a[88:95],v2
ds_read_b128 v[84:87],v21 offset:7168
s_or_b32 s79,s79,s30
v_smfmac_f32_16x16x64_bf16 v[32:35],v[60:63],a[96:103],v2
s_mov_b32 s78,2147483648
v_smfmac_f32_16x16x64_bf16 v[36:39],v[60:63],a[104:111],v2
v_smfmac_f32_16x16x64_bf16 v[40:43],v[60:63],a[112:119],v2
s_waitcnt lgkmcnt(2)
v_smfmac_f32_16x16x64_bf16 v[44:47],v[60:63],v[72:79],v2
ds_read_b128 v[60:63],v4 offset:1024
v_smfmac_f32_16x16x64_bf16 v[24:27],v[64:67],a[120:127],v2
ds_read_b128 v[72:75],v21 offset:8192
v_smfmac_f32_16x16x64_bf16 v[28:31],v[64:67],a[128:135],v2
ds_read_b128 v[76:79],v21 offset:9216
v_smfmac_f32_16x16x64_bf16 v[32:35],v[64:67],a[136:143],v2
v_smfmac_f32_16x16x64_bf16 v[36:39],v[64:67],a[144:151],v2
v_smfmac_f32_16x16x64_bf16 v[40:43],v[64:67],a[152:159],v2
s_waitcnt lgkmcnt(3)
v_smfmac_f32_16x16x64_bf16 v[44:47],v[64:67],v[80:87],v2
ds_read_b128 v[64:67],v5 offset:0
v_smfmac_f32_16x16x64_bf16 v[24:27],v[68:71],a[160:167],v2
ds_read_b128 v[80:83],v21 offset:10240
v_smfmac_f32_16x16x64_bf16 v[28:31],v[68:71],a[168:175],v2
ds_read_b128 v[84:87],v21 offset:11264
v_smfmac_f32_16x16x64_bf16 v[32:35],v[68:71],a[176:183],v2
v_smfmac_f32_16x16x64_bf16 v[36:39],v[68:71],a[184:191],v2
v_smfmac_f32_16x16x64_bf16 v[40:43],v[68:71],a[192:199],v2
s_waitcnt lgkmcnt(3)
v_smfmac_f32_16x16x64_bf16 v[44:47],v[68:71],v[72:79],v2
ds_read_b128 v[68:71],v5 offset:1024
v_smfmac_f32_16x16x64_bf16 v[24:27],v[60:63],a[200:207],v2
ds_read_b128 v[72:75],v21 offset:12288
v_smfmac_f32_16x16x64_bf16 v[28:31],v[60:63],a[208:215],v2
ds_read_b128 v[76:79],v21 offset:13312
v_smfmac_f32_16x16x64_bf16 v[32:35],v[60:63],a[216:223],v2
v_smfmac_f32_16x16x64_bf16 v[36:39],v[60:63],a[224:231],v2
v_smfmac_f32_16x16x64_bf16 v[40:43],v[60:63],a[232:239],v2
s_waitcnt lgkmcnt(3)
v_smfmac_f32_16x16x64_bf16 v[44:47],v[60:63],v[80:87],v2
ds_read_b128 v[60:63],v59 offset:0
v_smfmac_f32_16x16x64_bf16 v[24:27],v[64:67],a[240:247],v2
ds_read_b128 v[80:83],v21 offset:14336
v_smfmac_f32_16x16x64_bf16 v[28:31],v[64:67],a[248:255],v2
ds_read_b128 v[84:87],v21 offset:15360
v_smfmac_f32_16x16x64_bf16 v[32:35],v[64:67],v[112:119],v2
v_smfmac_f32_16x16x64_bf16 v[36:39],v[64:67],v[120:127],v2
v_smfmac_f32_16x16x64_bf16 v[40:43],v[64:67],v[128:135],v2
s_waitcnt lgkmcnt(3)
v_smfmac_f32_16x16x64_bf16 v[44:47],v[64:67],v[72:79],v2
ds_read_b128 v[64:67],v59 offset:1024
v_smfmac_f32_16x16x64_bf16 v[24:27],v[68:71],v[136:143],v2
ds_read_b128 v[72:75],v21 offset:16384
v_smfmac_f32_16x16x64_bf16 v[28:31],v[68:71],v[144:151],v2
ds_read_b128 v[76:79],v21 offset:17408
v_smfmac_f32_16x16x64_bf16 v[32:35],v[68:71],v[152:159],v2
v_smfmac_f32_16x16x64_bf16 v[36:39],v[68:71],v[160:167],v2
v_smfmac_f32_16x16x64_bf16 v[40:43],v[68:71],v[168:175],v2
s_waitcnt lgkmcnt(3)
v_smfmac_f32_16x16x64_bf16 v[44:47],v[68:71],v[80:87],v2
ds_read_b128 v[80:83],v21 offset:18432
v_smfmac_f32_16x16x64_bf16 v[24:27],v[60:63],v[176:183],v2
ds_read_b128 v[84:87],v21 offset:19456
v_smfmac_f32_16x16x64_bf16 v[28:31],v[60:63],v[184:191],v2
s_waitcnt lgkmcnt(4)
v_smfmac_f32_16x16x64_bf16 v[24:27],v[64:67],v[216:223],v2
v_smfmac_f32_16x16x64_bf16 v[28:31],v[64:67],v[224:231],v2
v_smfmac_f32_16x16x64_bf16 v[32:35],v[60:63],v[192:199],v2
v_smfmac_f32_16x16x64_bf16 v[36:39],v[60:63],v[200:207],v2
v_add_f32 v24,v24,v25
v_smfmac_f32_16x16x64_bf16 v[32:35],v[64:67],v[232:239],v2
v_add_f32 v26,v26,v27
v_smfmac_f32_16x16x64_bf16 v[36:39],v[64:67],v[240:247],v2
v_add_f32 v28,v28,v29
v_smfmac_f32_16x16x64_bf16 v[40:43],v[60:63],v[208:215],v2
v_add_f32 v30,v30,v31
s_waitcnt lgkmcnt(2)
v_smfmac_f32_16x16x64_bf16 v[44:47],v[60:63],v[72:79],v2
v_cvt_pk_bf16_f32 v100,v24,v26
v_smfmac_f32_16x16x64_bf16 v[40:43],v[64:67],v[248:255],v2
v_cvt_pk_bf16_f32 v101,v28,v30
s_waitcnt lgkmcnt(0)
v_smfmac_f32_16x16x64_bf16 v[44:47],v[64:67],v[80:87],v2
v_and_or_b32 v100,v100,-2,s57
v_add_f32 v32,v32,v33
v_add_f32 v34,v34,v35
v_add_f32 v36,v36,v37
v_add_f32 v38,v38,v39
v_cvt_pk_bf16_f32 v102,v32,v34
v_cvt_pk_bf16_f32 v103,v36,v38
v_and_or_b32 v102,v102,-2,s57
buffer_store_dwordx4 v[100:103],v6,s[8:11],s71 offen sc1
v_add_f32 v40,v40,v41
v_add_f32 v42,v42,v43
v_add_f32 v44,v44,v45
v_add_f32 v46,v46,v47
v_cvt_pk_bf16_f32 v104,v40,v42
v_cvt_pk_bf16_f32 v105,v44,v46
v_and_or_b32 v104,v104,-2,s57
buffer_store_dwordx2 v[104:105],v7,s[8:11],s71 offen sc1
s_lshl_b32 s60,s51,6
s_add_u32 s60,s60,s52
s_mul_i32 s78,s60,196608
s_add_u32 s78,s78,s85
s_lshl_b32 s60,s60,10
s_add_u32 s30,s60,s86
s_sub_u32 s60,s4,s5
s_cmp_gt_i32 s60,13
s_cselect_b32 s53,1,0
s_cmp_eq_u32 s4,64
s_cselect_b32 s53,1,s53
s_cmp_eq_u32 s53,0
s_cselect_b32 s54,s4,s5
s_addc_u32 s4,s4,0
s_add_u32 s5,s5,s53
s_and_b32 s60,s54,1
s_lshl2_add_u32 s60,s53,s60
s_lshl_b32 s68,s60,16
s_add_u32 s68,s68,s83
s_mul_i32 s59,s60,20480
s_add_u32 s59,s59,s6
s_lshl_b32 s69,s53,9
s_add_u32 s69,s69,s7
s_bfe_u32 s31,s54,65537
s_add_u32 s32,s54,1
s_cmp_lg_u32 s53,s51
s_cbranch_scc1 nx_147
s_waitcnt vmcnt(0)
s_cmp_ge_u32 s79,2147483648
s_cbranch_scc1 pf_148
v_mov_b32 v17,1
s_mov_b64 exec,1
buffer_store_dword v17,v1,s[8:11],s79 offen sc1
s_mov_b64 exec,-1
s_mov_b32 s79,2147483648
pf_148:
s_cmp_eq_u32 s78,2147483648
s_cbranch_scc1 pk_149
buffer_store_dwordx4 v[100:103],v6,s[8:11],s78 offen sc1
buffer_store_dwordx2 v[104:105],v7,s[8:11],s78 offen sc1
s_mov_b32 s79,s30
s_mov_b32 s78,2147483648
pk_149:
s_waitcnt vmcnt(0)
s_cmp_ge_u32 s79,2147483648
s_cbranch_scc1 pf_150
v_mov_b32 v17,1
s_mov_b64 exec,1
buffer_store_dword v17,v1,s[8:11],s79 offen sc1
s_mov_b64 exec,-1
s_mov_b32 s79,2147483648
pf_150:
nx_147:
s_add_u32 s50,s50,1
s_mov_b32 s51,s53
s_mov_b32 s52,s54
s_mov_b32 s57,s31
s_mov_b32 s58,s32
s_cmp_lt_u32 s50,128
s_cbranch_scc1 CV_LOOP_S0
s_branch CV_DONE
fr_142:
v_bitop3_b32 v12,v60,v64,s57 bitop3:0x7e
v_bitop3_b32 v13,v68,v68,s57 bitop3:0x7e
v_xor_b32 v14,s57,v68
v_or3_b32 v12,v12,v13,v14
v_and_b32 v12,1,v12
v_cmp_ne_u32 vcc,0,v12
s_cbranch_vccz sk_151
buffer_load_dwordx2 v[68:69],v18,s[8:11],s59 offen sc1
buffer_load_dwordx4 v[60:63],v1,s[8:11],s59 offen sc1
buffer_load_dwordx4 v[64:67],v1,s[8:11],s59 offen offset:1024 sc1
sk_151:
buffer_load_dwordx2 v[78:79],v18,s[8:11],s68 offen sc1
buffer_load_dwordx4 v[70:73],v1,s[8:11],s68 offen sc1
buffer_load_dwordx4 v[74:77],v1,s[8:11],s68 offen offset:1024 sc1
s_sub_u32 s47,s47,1
s_cbranch_scc1 ABORT
s_waitcnt lgkmcnt(0)
s_branch fa_141
CV_LOOP_S1:
v_mov_b32 v24,0
v_mov_b32 v25,0
v_mov_b32 v26,0
v_mov_b32 v27,0
v_mov_b32 v28,0
v_mov_b32 v29,0
v_mov_b32 v30,0
v_mov_b32 v31,0
v_mov_b32 v32,0
v_mov_b32 v33,0
v_mov_b32 v34,0
v_mov_b32 v35,0
v_mov_b32 v36,0
v_mov_b32 v37,0
v_mov_b32 v38,0
v_mov_b32 v39,0
v_mov_b32 v40,0
v_mov_b32 v41,0
v_mov_b32 v42,0
v_mov_b32 v43,0
v_mov_b32 v44,0
v_mov_b32 v45,0
v_mov_b32 v46,0
v_mov_b32 v47,0
s_barrier
buffer_load_dwordx2 v[68:69],v18,s[8:11],s59 offen sc1
buffer_load_dwordx4 v[60:63],v1,s[8:11],s59 offen sc1
buffer_load_dwordx4 v[64:67],v1,s[8:11],s59 offen offset:1024 sc1
s_waitcnt vmcnt(2)
s_sleep 3
fj_154f:
buffer_load_dwordx2 v[78:79],v18,s[8:11],s68 offen sc1
buffer_load_dwordx4 v[70:73],v1,s[8:11],s68 offen sc1
buffer_load_dwordx4 v[74:77],v1,s[8:11],s68 offen offset:1024 sc1
fj_154:
fa_152:
s_waitcnt vmcnt(5)
v_lshlrev_b32 v96,16,v68
v_and_b32 v97,0xffff0000,v68
v_lshlrev_b32 v98,16,v69
v_and_b32 v99,0xffff0000,v69
s_waitcnt vmcnt(4)
v_lshlrev_b32 v80,16,v60
v_and_b32 v81,0xffff0000,v60
v_lshlrev_b32 v82,16,v61
v_and_b32 v83,0xffff0000,v61
v_lshlrev_b32 v84,16,v62
v_and_b32 v85,0xffff0000,v62
v_lshlrev_b32 v86,16,v63
v_and_b32 v87,0xffff0000,v63
s_waitcnt vmcnt(3)
v_lshlrev_b32 v88,16,v64
v_and_b32 v89,0xffff0000,v64
v_lshlrev_b32 v90,16,v65
v_and_b32 v91,0xffff0000,v65
v_lshlrev_b32 v92,16,v66
v_and_b32 v93,0xffff0000,v66
v_lshlrev_b32 v94,16,v67
v_and_b32 v95,0xffff0000,v67
s_waitcnt vmcnt(2)
v_dot2c_f32_bf16 v96,s37,v78
v_dot2c_f32_bf16 v97,s81,v78
v_dot2c_f32_bf16 v98,s37,v79
v_dot2c_f32_bf16 v99,s81,v79
v_bitop3_b32 v16,v68,v78,s57 bitop3:0x7e
v_cvt_pk_bf16_f32 v56,v96,v97
s_nop 0
v_cvt_pk_bf16_f32 v57,v98,v99
ds_write_b64 v23,v[56:57]
s_waitcnt vmcnt(1)
v_dot2c_f32_bf16 v80,s37,v70
v_dot2c_f32_bf16 v81,s81,v70
v_dot2c_f32_bf16 v82,s37,v71
v_dot2c_f32_bf16 v83,s81,v71
v_dot2c_f32_bf16 v84,s37,v72
v_dot2c_f32_bf16 v85,s81,v72
v_dot2c_f32_bf16 v86,s37,v73
v_dot2c_f32_bf16 v87,s81,v73
v_bitop3_b32 v17,v60,v70,s57 bitop3:0x7e
v_or_b32 v16,v16,v17
v_cvt_pk_bf16_f32 v48,v80,v81
v_cvt_pk_bf16_f32 v49,v82,v83
v_cvt_pk_bf16_f32 v50,v84,v85
v_cvt_pk_bf16_f32 v51,v86,v87
ds_write_b128 v22,v[48:51] offset:0
s_waitcnt vmcnt(0)
v_dot2c_f32_bf16 v88,s37,v74
v_dot2c_f32_bf16 v89,s81,v74
v_dot2c_f32_bf16 v90,s37,v75
v_dot2c_f32_bf16 v91,s81,v75
v_dot2c_f32_bf16 v92,s37,v76
v_dot2c_f32_bf16 v93,s81,v76
v_dot2c_f32_bf16 v94,s37,v77
v_dot2c_f32_bf16 v95,s81,v77
v_bitop3_b32 v17,v64,v74,s57 bitop3:0x7e
v_bitop3_b32 v16,v16,v17,1 bitop3:0xa8
v_cmp_ne_u32 vcc,0,v16
v_cvt_pk_bf16_f32 v52,v88,v89
v_cvt_pk_bf16_f32 v53,v90,v91
v_cvt_pk_bf16_f32 v54,v92,v93
v_cvt_pk_bf16_f32 v55,v94,v95
ds_write_b128 v22,v[52:55] offset:1024
s_cbranch_vccnz fr_153
fj_154g:
v_smfmac_f32_16x16x64_bf16 v[24:27],v[48:51],a[0:7],v2
ds_read_b128 v[72:75],v21 offset:0
s_and_b32 s60,s52,1
v_smfmac_f32_16x16x64_bf16 v[28:31],v[48:51],a[8:15],v2
ds_read_b128 v[76:79],v21 offset:1024
s_lshl2_add_u32 s60,s51,s60
v_smfmac_f32_16x16x64_bf16 v[32:35],v[48:51],a[16:23],v2
ds_read_b128 v[80:83],v21 offset:2048
s_mul_i32 s60,s60,49152
v_smfmac_f32_16x16x64_bf16 v[36:39],v[48:51],a[24:31],v2
ds_read_b128 v[84:87],v21 offset:3072
s_add_u32 s71,s60,s34
s_waitcnt lgkmcnt(4)
s_barrier
v_smfmac_f32_16x16x64_bf16 v[40:43],v[48:51],a[32:39],v2
ds_read_b128 v[60:63],v3 offset:0
v_smfmac_f32_16x16x64_bf16 v[24:27],v[52:55],a[40:47],v2
ds_read_b128 v[64:67],v3 offset:1024
v_mov_b32 v17,1
v_smfmac_f32_16x16x64_bf16 v[28:31],v[52:55],a[48:55],v2
ds_read_b128 v[68:71],v4 offset:0
v_smfmac_f32_16x16x64_bf16 v[32:35],v[52:55],a[56:63],v2
s_mov_b64 exec,1
buffer_store_dword v17,v1,s[8:11],s79 offen sc1
s_mov_b64 exec,-1
v_smfmac_f32_16x16x64_bf16 v[36:39],v[52:55],a[64:71],v2
buffer_store_dwordx4 v[102:105],v6,s[8:11],s78 offen sc1
v_smfmac_f32_16x16x64_bf16 v[40:43],v[52:55],a[72:79],v2
buffer_store_dwordx2 v[100:101],v7,s[8:11],s78 offen sc1
s_waitcnt lgkmcnt(5)
v_smfmac_f32_16x16x64_bf16 v[44:47],v[48:51],v[72:79],v2
ds_read_b128 v[72:75],v21 offset:4096
s_waitcnt lgkmcnt(4)
v_smfmac_f32_16x16x64_bf16 v[44:47],v[52:55],v[80:87],v2
ds_read_b128 v[76:79],v21 offset:5120
s_waitcnt lgkmcnt(4)
v_smfmac_f32_16x16x64_bf16 v[24:27],v[60:63],a[80:87],v2
ds_read_b128 v[80:83],v21 offset:6144
s_and_b32 s79,s78,2147483648
v_smfmac_f32_16x16x64_bf16 v[28:31],v[60:63],a[88:95],v2
ds_read_b128 v[84:87],v21 offset:7168
s_or_b32 s79,s79,s30
v_smfmac_f32_16x16x64_bf16 v[32:35],v[60:63],a[96:103],v2
s_mov_b32 s78,2147483648
v_smfmac_f32_16x16x64_bf16 v[36:39],v[60:63],a[104:111],v2
v_smfmac_f32_16x16x64_bf16 v[40:43],v[60:63],a[112:119],v2
s_waitcnt lgkmcnt(2)
v_smfmac_f32_16x16x64_bf16 v[44:47],v[60:63],v[72:79],v2
ds_read_b128 v[60:63],v4 offset:1024
v_smfmac_f32_16x16x64_bf16 v[24:27],v[64:67],a[120:127],v2
ds_read_b128 v[72:75],v21 offset:8192
v_smfmac_f32_16x16x64_bf16 v[28:31],v[64:67],a[128:135],v2
ds_read_b128 v[76:79],v21 offset:9216
v_smfmac_f32_16x16x64_bf16 v[32:35],v[64:67],a[136:143],v2
v_smfmac_f32_16x16x64_bf16 v[36:39],v[64:67],a[144:151],v2
v_smfmac_f32_16x16x64_bf16 v[40:43],v[64:67],a[152:159],v2
s_waitcnt lgkmcnt(3)
v_smfmac_f32_16x16x64_bf16 v[44:47],v[64:67],v[80:87],v2
ds_read_b128 v[64:67],v5 offset:0
v_smfmac_f32_16x16x64_bf16 v[24:27],v[68:71],a[160:167],v2
ds_read_b128 v[80:83],v21 offset:10240
v_smfmac_f32_16x16x64_bf16 v[28:31],v[68:71],a[168:175],v2
ds_read_b128 v[84:87],v21 offset:11264
v_smfmac_f32_16x16x64_bf16 v[32:35],v[68:71],a[176:183],v2
v_smfmac_f32_16x16x64_bf16 v[36:39],v[68:71],a[184:191],v2
v_smfmac_f32_16x16x64_bf16 v[40:43],v[68:71],a[192:199],v2
s_waitcnt lgkmcnt(3)
v_smfmac_f32_16x16x64_bf16 v[44:47],v[68:71],v[72:79],v2
ds_read_b128 v[68:71],v5 offset:1024
v_smfmac_f32_16x16x64_bf16 v[24:27],v[60:63],a[200:207],v2
ds_read_b128 v[72:75],v21 offset:12288
v_smfmac_f32_16x16x64_bf16 v[28:31],v[60:63],a[208:215],v2
ds_read_b128 v[76:79],v21 offset:13312
v_smfmac_f32_16x16x64_bf16 v[32:35],v[60:63],a[216:223],v2
v_smfmac_f32_16x16x64_bf16 v[36:39],v[60:63],a[224:231],v2
v_smfmac_f32_16x16x64_bf16 v[40:43],v[60:63],a[232:239],v2
s_waitcnt lgkmcnt(3)
v_smfmac_f32_16x16x64_bf16 v[44:47],v[60:63],v[80:87],v2
ds_read_b128 v[60:63],v59 offset:0
v_smfmac_f32_16x16x64_bf16 v[24:27],v[64:67],a[240:247],v2
ds_read_b128 v[80:83],v21 offset:14336
v_smfmac_f32_16x16x64_bf16 v[28:31],v[64:67],a[248:255],v2
ds_read_b128 v[84:87],v21 offset:15360
v_smfmac_f32_16x16x64_bf16 v[32:35],v[64:67],v[112:119],v2
v_smfmac_f32_16x16x64_bf16 v[36:39],v[64:67],v[120:127],v2
v_smfmac_f32_16x16x64_bf16 v[40:43],v[64:67],v[128:135],v2
s_waitcnt lgkmcnt(3)
v_smfmac_f32_16x16x64_bf16 v[44:47],v[64:67],v[72:79],v2
ds_read_b128 v[64:67],v59 offset:1024
v_smfmac_f32_16x16x64_bf16 v[24:27],v[68:71],v[136:143],v2
ds_read_b128 v[72:75],v21 offset:16384
v_smfmac_f32_16x16x64_bf16 v[28:31],v[68:71],v[144:151],v2
ds_read_b128 v[76:79],v21 offset:17408
v_smfmac_f32_16x16x64_bf16 v[32:35],v[68:71],v[152:159],v2
v_smfmac_f32_16x16x64_bf16 v[36:39],v[68:71],v[160:167],v2
v_smfmac_f32_16x16x64_bf16 v[40:43],v[68:71],v[168:175],v2
s_waitcnt lgkmcnt(3)
v_smfmac_f32_16x16x64_bf16 v[44:47],v[68:71],v[80:87],v2
ds_read_b128 v[80:83],v21 offset:18432
v_smfmac_f32_16x16x64_bf16 v[24:27],v[60:63],v[176:183],v2
ds_read_b128 v[84:87],v21 offset:19456
v_smfmac_f32_16x16x64_bf16 v[28:31],v[60:63],v[184:191],v2
s_waitcnt lgkmcnt(4)
v_smfmac_f32_16x16x64_bf16 v[24:27],v[64:67],v[216:223],v2
v_smfmac_f32_16x16x64_bf16 v[28:31],v[64:67],v[224:231],v2
v_smfmac_f32_16x16x64_bf16 v[32:35],v[60:63],v[192:199],v2
v_smfmac_f32_16x16x64_bf16 v[36:39],v[60:63],v[200:207],v2
v_add_f32 v24,v24,v25
v_smfmac_f32_16x16x64_bf16 v[32:35],v[64:67],v[232:239],v2
v_add_f32 v26,v26,v27
v_smfmac_f32_16x16x64_bf16 v[36:39],v[64:67],v[240:247],v2
v_add_f32 v28,v28,v29
v_smfmac_f32_16x16x64_bf16 v[40:43],v[60:63],v[208:215],v2
v_add_f32 v30,v30,v31
s_waitcnt lgkmcnt(2)
v_smfmac_f32_16x16x64_bf16 v[44:47],v[60:63],v[72:79],v2
v_cvt_pk_bf16_f32 v100,v24,v26
v_smfmac_f32_16x16x64_bf16 v[40:43],v[64:67],v[248:255],v2
v_cvt_pk_bf16_f32 v101,v28,v30
s_waitcnt lgkmcnt(0)
v_smfmac_f32_16x16x64_bf16 v[44:47],v[64:67],v[80:87],v2
v_and_or_b32 v100,v100,-2,s57
buffer_store_dwordx2 v[100:101],v7,s[8:11],s71 offen sc1
v_add_f32 v32,v32,v33
v_add_f32 v34,v34,v35
v_add_f32 v36,v36,v37
v_add_f32 v38,v38,v39
v_cvt_pk_bf16_f32 v102,v32,v34
v_cvt_pk_bf16_f32 v103,v36,v38
v_and_or_b32 v102,v102,-2,s57
v_add_f32 v40,v40,v41
v_add_f32 v42,v42,v43
v_add_f32 v44,v44,v45
v_add_f32 v46,v46,v47
v_cvt_pk_bf16_f32 v104,v40,v42
v_cvt_pk_bf16_f32 v105,v44,v46
v_and_or_b32 v104,v104,-2,s57
buffer_store_dwordx4 v[102:105],v6,s[8:11],s71 offen sc1
s_lshl_b32 s60,s51,6
s_add_u32 s60,s60,s52
s_mul_i32 s78,s60,196608
s_add_u32 s78,s78,s85
s_lshl_b32 s60,s60,10
s_add_u32 s30,s60,s86
s_sub_u32 s60,s4,s5
s_cmp_gt_i32 s60,13
s_cselect_b32 s53,1,0
s_cmp_eq_u32 s4,64
s_cselect_b32 s53,1,s53
s_cmp_eq_u32 s53,0
s_cselect_b32 s54,s4,s5
s_addc_u32 s4,s4,0
s_add_u32 s5,s5,s53
s_and_b32 s60,s54,1
s_lshl2_add_u32 s60,s53,s60
s_lshl_b32 s68,s60,16
s_add_u32 s68,s68,s83
s_mul_i32 s59,s60,20480
s_add_u32 s59,s59,s6
s_lshl_b32 s69,s53,9
s_add_u32 s69,s69,s7
s_bfe_u32 s31,s54,65537
s_add_u32 s32,s54,1
s_cmp_lg_u32 s53,s51
s_cbranch_scc1 nx_155
s_waitcnt vmcnt(0)
s_cmp_ge_u32 s79,2147483648
s_cbranch_scc1 pf_156
v_mov_b32 v17,1
s_mov_b64 exec,1
buffer_store_dword v17,v1,s[8:11],s79 offen sc1
s_mov_b64 exec,-1
s_mov_b32 s79,2147483648
pf_156:
s_cmp_eq_u32 s78,2147483648
s_cbranch_scc1 pk_157
buffer_store_dwordx4 v[102:105],v6,s[8:11],s78 offen sc1
buffer_store_dwordx2 v[100:101],v7,s[8:11],s78 offen sc1
s_mov_b32 s79,s30
s_mov_b32 s78,2147483648
pk_157:
s_waitcnt vmcnt(0)
s_cmp_ge_u32 s79,2147483648
s_cbranch_scc1 pf_158
v_mov_b32 v17,1
s_mov_b64 exec,1
buffer_store_dword v17,v1,s[8:11],s79 offen sc1
s_mov_b64 exec,-1
s_mov_b32 s79,2147483648
pf_158:
nx_155:
s_add_u32 s50,s50,1
s_mov_b32 s51,s53
s_mov_b32 s52,s54
s_mov_b32 s57,s31
s_mov_b32 s58,s32
s_cmp_lt_u32 s50,128
s_cbranch_scc1 CV_LOOP_S1
s_branch CV_DONE
fr_153:
v_bitop3_b32 v12,v60,v64,s57 bitop3:0x7e
v_bitop3_b32 v13,v68,v68,s57 bitop3:0x7e
v_xor_b32 v14,s57,v68
v_or3_b32 v12,v12,v13,v14
v_and_b32 v12,1,v12
v_cmp_ne_u32 vcc,0,v12
s_cbranch_vccz sk_159
buffer_load_dwordx2 v[68:69],v18,s[8:11],s59 offen sc1
buffer_load_dwordx4 v[60:63],v1,s[8:11],s59 offen sc1
buffer_load_dwordx4 v[64:67],v1,s[8:11],s59 offen offset:1024 sc1
sk_159:
buffer_load_dwordx2 v[78:79],v18,s[8:11],s68 offen sc1
buffer_load_dwordx4 v[70:73],v1,s[8:11],s68 offen sc1
buffer_load_dwordx4 v[74:77],v1,s[8:11],s68 offen offset:1024 sc1
s_sub_u32 s47,s47,1
s_cbranch_scc1 ABORT
s_waitcnt lgkmcnt(0)
s_branch fa_152
CV_DONE:
s_add_u32 s61,s48,32
s_endpgm
ROLE_CW:
s_lshr_b32 s28,s48,3
s_and_b32 s29,s48,7
s_mul_i32 s82,s28,2097152
s_add_u32 s82,s82,2097152
v_lshlrev_b32 v1,4,v0
v_and_b32 v12,1,v0
v_mul_u32_u24 v2,0xaaaa,v12
v_or_b32 v2,0x4444,v2
v_lshrrev_b32 v14,4,v0
v_and_b32 v15,15,v0
v_min_u32 v3,11,v15
v_lshlrev_b32 v3,2,v3
v_lshl_add_u32 v3,v14,7,v3
s_mul_i32 s60,s46,24576
v_add_u32 v4,s60,v1
v_mul_u32_u24 v5,704,v14
v_and_b32 v12,3,v15
v_lshl_add_u32 v5,v12,2,v5
v_bfe_u32 v12,v15,2,1
v_lshl_add_u32 v5,v12,5,v5
v_bfe_u32 v12,v15,3,1
v_lshl_add_u32 v5,v12,4,v5
s_mul_i32 s60,s46,2816
s_add_u32 s60,s60,98304
v_add_u32 v5,s60,v5
s_mul_i32 s60,s46,24
s_min_u32 s60,s60,64
s_cmp_lt_u32 s46,2
s_cselect_b32 s61,23,15
s_mov_b32 s88,0xffff
s_cselect_b32 s88,0xffffff,s88
s_mov_b32 s89,0
v_and_b32 v12,31,v0
v_min_u32 v12,s61,v12
v_add_u32 v12,s60,v12
v_lshrrev_b32 v13,5,v0
v_lshl_add_u32 v12,v12,1,v13
v_bfe_u32 v13,v12,2,3
v_mul_u32_u24 v6,352,v13
v_mul_u32_u24 v17,1280,v13
v_lshrrev_b32 v13,5,v12
v_lshl_add_u32 v6,v13,6,v6
v_lshl_add_u32 v17,v13,5,v17
v_and_b32 v13,3,v12
v_lshl_add_u32 v17,v13,3,v17
v_and_b32 v13,1,v12
v_lshl_add_u32 v6,v13,5,v6
v_bfe_u32 v13,v12,1,1
v_lshl_add_u32 v6,v13,4,v6
v_add_u32 v6,98304,v6
s_mul_i32 s60,s29,1280
v_lshlrev_b32 v9,3,v12
v_add_u32 v9,s60,v9
v_lshrrev_b32 v13,13,v9
v_lshl_add_u32 v9,v13,13,v9
v_xor_b32 v10,1,v12
v_or_b32 v10,v10,v13
v_and_b32 v10,1,v10
s_mov_b32 s4,s18
s_mov_b32 s5,s19
s_mov_b32 s6,10240
s_mov_b32 s7,0x20000
s_mul_i32 s60,s29,160
buffer_load_dwordx2 v[32:33],v17,s[4:7],s60 offen
s_mul_i32 s84,s29,0
s_add_u32 s84,s84,s82
s_lshl_b32 s83,s28,19
s_lshr_b32 s60,s29,1
s_and_b32 s61,s29,1
s_mul_i32 s62,s61,0
s_add_u32 s83,s83,s62
s_add_u32 s83,s83,10485760
s_lshl_b32 s85,s60,7
s_lshl_b32 s61,s61,2
s_add_u32 s61,s61,s46
s_lshl_b32 s61,s61,2
s_add_u32 s85,s85,s61
s_add_u32 s85,s85,s82
s_add_u32 s85,s85,950272
s_mul_i32 s33,s46,12288
s_add_u32 s33,s33,s82
s_add_u32 s33,s33,163840
s_mov_b32 s35,0
s_add_u32 s35,s35,s82
s_add_u32 s35,s35,951296
s_cmp_eq_u32 s28,0
s_cselect_b32 s63,0xffff0000,0
s_waitcnt vmcnt(0)
s_cselect_b64 vcc,-1,0
v_bfi_b32 v36,v10,0,v32
v_lshlrev_b32 v34,16,v32
v_lshlrev_b32 v35,16,v36
v_sub_f32 v34,v34,v35
v_lshrrev_b32 v34,16,v34
v_and_b32 v34,-2,v34
v_cndmask_b32 v36,v34,v36,vcc
v_cndmask_b32 v37,0,v33,vcc
s_nop 0
v_permlane32_swap_b32 v36,v38
v_permlane32_swap_b32 v37,v39
v_mov_b32 v40,-1
v_mov_b32 v41,-1
v_mov_b32 v42,-1
v_mov_b32 v43,-1
v_mov_b32 v44,1
s_mov_b64 exec,s[88:89]
s_add_u32 s60,s83,0
buffer_store_dwordx4 v[36:39],v9,s[8:11],s60 offen sc1
s_add_u32 s60,s83,8192
buffer_store_dwordx4 v[36:39],v9,s[8:11],s60 offen sc1
s_add_u32 s60,s83,65536
buffer_store_dwordx4 v[40:43],v9,s[8:11],s60 offen sc1
s_add_u32 s60,s83,73728
buffer_store_dwordx4 v[40:43],v9,s[8:11],s60 offen sc1
s_add_u32 s60,s83,131072
buffer_store_dwordx4 v[40:43],v9,s[8:11],s60 offen sc1
s_add_u32 s60,s83,139264
buffer_store_dwordx4 v[40:43],v9,s[8:11],s60 offen sc1
s_add_u32 s60,s83,196608
buffer_store_dwordx4 v[40:43],v9,s[8:11],s60 offen sc1
s_add_u32 s60,s83,204800
buffer_store_dwordx4 v[40:43],v9,s[8:11],s60 offen sc1
s_add_u32 s60,s83,262144
buffer_store_dwordx4 v[36:39],v9,s[8:11],s60 offen sc1
s_add_u32 s60,s83,270336
buffer_store_dwordx4 v[36:39],v9,s[8:11],s60 offen sc1
s_add_u32 s60,s83,327680
buffer_store_dwordx4 v[40:43],v9,s[8:11],s60 offen sc1
s_add_u32 s60,s83,335872
buffer_store_dwordx4 v[40:43],v9,s[8:11],s60 offen sc1
s_add_u32 s60,s83,393216
buffer_store_dwordx4 v[40:43],v9,s[8:11],s60 offen sc1
s_add_u32 s60,s83,401408
buffer_store_dwordx4 v[40:43],v9,s[8:11],s60 offen sc1
s_add_u32 s60,s83,458752
buffer_store_dwordx4 v[40:43],v9,s[8:11],s60 offen sc1
s_add_u32 s60,s83,466944
buffer_store_dwordx4 v[40:43],v9,s[8:11],s60 offen sc1
s_cmp_lg_u32 s49,0
s_cbranch_scc1 ls_160
s_add_u32 s60,s84,0
buffer_store_dwordx4 v[36:39],v9,s[8:11],s60 offen
s_add_u32 s60,s84,20480
buffer_store_dwordx4 v[40:43],v9,s[8:11],s60 offen
s_add_u32 s60,s84,40960
buffer_store_dwordx4 v[40:43],v9,s[8:11],s60 offen
s_add_u32 s60,s84,61440
buffer_store_dwordx4 v[40:43],v9,s[8:11],s60 offen
s_add_u32 s60,s84,81920
buffer_store_dwordx4 v[36:39],v9,s[8:11],s60 offen
s_add_u32 s60,s84,102400
buffer_store_dwordx4 v[40:43],v9,s[8:11],s60 offen
s_add_u32 s60,s84,122880
buffer_store_dwordx4 v[40:43],v9,s[8:11],s60 offen
s_add_u32 s60,s84,143360
buffer_store_dwordx4 v[40:43],v9,s[8:11],s60 offen
s_mov_b64 exec,1
buffer_store_dword v44,v1,s[8:11],s85 offen
buffer_store_dword v44,v1,s[8:11],s85 offen offset:512
s_branch ls_161
ls_160:
s_add_u32 s60,s84,0
buffer_store_dwordx4 v[36:39],v9,s[8:11],s60 offen sc1
s_add_u32 s60,s84,20480
buffer_store_dwordx4 v[40:43],v9,s[8:11],s60 offen sc1
s_add_u32 s60,s84,40960
buffer_store_dwordx4 v[40:43],v9,s[8:11],s60 offen sc1
s_add_u32 s60,s84,61440
buffer_store_dwordx4 v[40:43],v9,s[8:11],s60 offen sc1
s_add_u32 s60,s84,81920
buffer_store_dwordx4 v[36:39],v9,s[8:11],s60 offen sc1
s_add_u32 s60,s84,102400
buffer_store_dwordx4 v[40:43],v9,s[8:11],s60 offen sc1
s_add_u32 s60,s84,122880
buffer_store_dwordx4 v[40:43],v9,s[8:11],s60 offen sc1
s_add_u32 s60,s84,143360
buffer_store_dwordx4 v[40:43],v9,s[8:11],s60 offen sc1
s_mov_b64 exec,1
buffer_store_dword v44,v1,s[8:11],s85 offen sc1
buffer_store_dword v44,v1,s[8:11],s85 offen offset:512 sc1
ls_161:
s_mov_b64 exec,-1
s_waitcnt vmcnt(0)
s_barrier
s_cmp_lg_u32 s46,0
s_cbranch_scc1 arr_162
v_mov_b32 v12,1
s_lshl_b32 s3,s49,2
v_mov_b32 v13,s3
s_mov_b64 exec,1
buffer_atomic_add v12,v13,s[12:15],0 offen sc1
s_mov_b64 exec,-1
arr_162:
s_mov_b32 s4,s26
s_mov_b32 s5,s27
s_mov_b32 s6,7864320
s_mov_b32 s7,0x20000
s_lshl_b32 s60,s28,2
s_add_u32 s60,s60,s46
s_mul_i32 s73,s60,983040
s_mul_i32 s60,s29,160
s_add_u32 s73,s73,s60
s_mul_i32 s74,s46,40960
v_add_u32 v12,0,v0
v_mul_u32_u24 v13,6554,v12
v_lshrrev_b32 v13,16,v13
v_mul_u32_u24 v16,10,v13
v_sub_u32 v12,v12,v16
v_mul_u32_u24 v20,1280,v13
v_lshl_add_u32 v20,v12,4,v20
v_add_u32 v12,64,v0
v_mul_u32_u24 v13,6554,v12
v_lshrrev_b32 v13,16,v13
v_mul_u32_u24 v16,10,v13
v_sub_u32 v12,v12,v16
v_mul_u32_u24 v21,1280,v13
v_lshl_add_u32 v21,v12,4,v21
v_add_u32 v12,128,v0
v_mul_u32_u24 v13,6554,v12
v_lshrrev_b32 v13,16,v13
v_mul_u32_u24 v16,10,v13
v_sub_u32 v12,v12,v16
v_mul_u32_u24 v22,1280,v13
v_lshl_add_u32 v22,v12,4,v22
v_add_u32 v12,192,v0
v_mul_u32_u24 v13,6554,v12
v_lshrrev_b32 v13,16,v13
v_mul_u32_u24 v16,10,v13
v_sub_u32 v12,v12,v16
v_mul_u32_u24 v23,1280,v13
v_lshl_add_u32 v23,v12,4,v23
v_add_u32 v12,256,v0
v_mul_u32_u24 v13,6554,v12
v_lshrrev_b32 v13,16,v13
v_mul_u32_u24 v16,10,v13
v_sub_u32 v12,v12,v16
v_mul_u32_u24 v24,1280,v13
v_lshl_add_u32 v24,v12,4,v24
v_add_u32 v12,320,v0
v_mul_u32_u24 v13,6554,v12
v_lshrrev_b32 v13,16,v13
v_mul_u32_u24 v16,10,v13
v_sub_u32 v12,v12,v16
v_mul_u32_u24 v25,1280,v13
v_lshl_add_u32 v25,v12,4,v25
v_add_u32 v12,384,v0
v_mul_u32_u24 v13,6554,v12
v_lshrrev_b32 v13,16,v13
v_mul_u32_u24 v16,10,v13
v_sub_u32 v12,v12,v16
v_mul_u32_u24 v26,1280,v13
v_lshl_add_u32 v26,v12,4,v26
v_add_u32 v12,448,v0
v_mul_u32_u24 v13,6554,v12
v_lshrrev_b32 v13,16,v13
v_mul_u32_u24 v16,10,v13
v_sub_u32 v12,v12,v16
v_mul_u32_u24 v27,1280,v13
v_lshl_add_u32 v27,v12,4,v27
v_add_u32 v12,512,v0
v_mul_u32_u24 v13,6554,v12
v_lshrrev_b32 v13,16,v13
v_mul_u32_u24 v16,10,v13
v_sub_u32 v12,v12,v16
v_mul_u32_u24 v28,1280,v13
v_lshl_add_u32 v28,v12,4,v28
v_add_u32 v12,576,v0
v_mul_u32_u24 v13,6554,v12
v_lshrrev_b32 v13,16,v13
v_mul_u32_u24 v16,10,v13
v_sub_u32 v12,v12,v16
v_mul_u32_u24 v29,1280,v13
v_lshl_add_u32 v29,v12,4,v29
v_lshrrev_b32 v14,4,v0
v_and_b32 v12,1,v14
v_lshlrev_b32 v12,5,v12
v_lshrrev_b32 v13,1,v14
v_lshl_add_u32 v12,v13,2,v12
v_bfe_u32 v13,v0,2,1
v_add_u32 v12,v12,v13
v_bfe_u32 v13,v0,3,1
v_lshl_add_u32 v12,v13,4,v12
v_mul_u32_u24 v30,160,v12
v_and_b32 v13,3,v0
v_lshl_add_u32 v30,v13,3,v30
v_add_u32 v30,s74,v30
s_add_u32 s61,s73,0
s_add_u32 m0,s74,0
s_nop 0
buffer_load_dwordx4 v20,s[4:7],s61 offen lds
s_add_u32 m0,s74,1024
s_nop 0
buffer_load_dwordx4 v21,s[4:7],s61 offen lds
s_add_u32 m0,s74,2048
s_nop 0
buffer_load_dwordx4 v22,s[4:7],s61 offen lds
s_add_u32 m0,s74,3072
s_nop 0
buffer_load_dwordx4 v23,s[4:7],s61 offen lds
s_add_u32 m0,s74,4096
s_nop 0
buffer_load_dwordx4 v24,s[4:7],s61 offen lds
s_add_u32 m0,s74,5120
s_nop 0
buffer_load_dwordx4 v25,s[4:7],s61 offen lds
s_add_u32 m0,s74,6144
s_nop 0
buffer_load_dwordx4 v26,s[4:7],s61 offen lds
s_add_u32 m0,s74,7168
s_nop 0
buffer_load_dwordx4 v27,s[4:7],s61 offen lds
s_add_u32 m0,s74,8192
s_nop 0
buffer_load_dwordx4 v28,s[4:7],s61 offen lds
s_add_u32 m0,s74,9216
s_nop 0
buffer_load_dwordx4 v29,s[4:7],s61 offen lds
s_add_u32 s61,s73,81920
s_add_u32 m0,s74,10240
s_nop 0
buffer_load_dwordx4 v20,s[4:7],s61 offen lds
s_add_u32 m0,s74,11264
s_nop 0
buffer_load_dwordx4 v21,s[4:7],s61 offen lds
s_add_u32 m0,s74,12288
s_nop 0
buffer_load_dwordx4 v22,s[4:7],s61 offen lds
s_add_u32 m0,s74,13312
s_nop 0
buffer_load_dwordx4 v23,s[4:7],s61 offen lds
s_add_u32 m0,s74,14336
s_nop 0
buffer_load_dwordx4 v24,s[4:7],s61 offen lds
s_add_u32 m0,s74,15360
s_nop 0
buffer_load_dwordx4 v25,s[4:7],s61 offen lds
s_add_u32 m0,s74,16384
s_nop 0
buffer_load_dwordx4 v26,s[4:7],s61 offen lds
s_add_u32 m0,s74,17408
s_nop 0
buffer_load_dwordx4 v27,s[4:7],s61 offen lds
s_add_u32 m0,s74,18432
s_nop 0
buffer_load_dwordx4 v28,s[4:7],s61 offen lds
s_add_u32 m0,s74,19456
s_nop 0
buffer_load_dwordx4 v29,s[4:7],s61 offen lds
s_add_u32 s61,s73,163840
s_add_u32 m0,s74,20480
s_nop 0
buffer_load_dwordx4 v20,s[4:7],s61 offen lds
s_add_u32 m0,s74,21504
s_nop 0
buffer_load_dwordx4 v21,s[4:7],s61 offen lds
s_add_u32 m0,s74,22528
s_nop 0
buffer_load_dwordx4 v22,s[4:7],s61 offen lds
s_add_u32 m0,s74,23552
s_nop 0
buffer_load_dwordx4 v23,s[4:7],s61 offen lds
s_add_u32 m0,s74,24576
s_nop 0
buffer_load_dwordx4 v24,s[4:7],s61 offen lds
s_add_u32 m0,s74,25600
s_nop 0
buffer_load_dwordx4 v25,s[4:7],s61 offen lds
s_add_u32 m0,s74,26624
s_nop 0
buffer_load_dwordx4 v26,s[4:7],s61 offen lds
s_add_u32 m0,s74,27648
s_nop 0
buffer_load_dwordx4 v27,s[4:7],s61 offen lds
s_add_u32 m0,s74,28672
s_nop 0
buffer_load_dwordx4 v28,s[4:7],s61 offen lds
s_add_u32 m0,s74,29696
s_nop 0
buffer_load_dwordx4 v29,s[4:7],s61 offen lds
s_add_u32 s61,s73,245760
s_add_u32 m0,s74,30720
s_nop 0
buffer_load_dwordx4 v20,s[4:7],s61 offen lds
s_add_u32 m0,s74,31744
s_nop 0
buffer_load_dwordx4 v21,s[4:7],s61 offen lds
s_add_u32 m0,s74,32768
s_nop 0
buffer_load_dwordx4 v22,s[4:7],s61 offen lds
s_add_u32 m0,s74,33792
s_nop 0
buffer_load_dwordx4 v23,s[4:7],s61 offen lds
s_add_u32 m0,s74,34816
s_nop 0
buffer_load_dwordx4 v24,s[4:7],s61 offen lds
s_add_u32 m0,s74,35840
s_nop 0
buffer_load_dwordx4 v25,s[4:7],s61 offen lds
s_add_u32 m0,s74,36864
s_nop 0
buffer_load_dwordx4 v26,s[4:7],s61 offen lds
s_add_u32 m0,s74,37888
s_nop 0
buffer_load_dwordx4 v27,s[4:7],s61 offen lds
s_add_u32 m0,s74,38912
s_nop 0
buffer_load_dwordx4 v28,s[4:7],s61 offen lds
s_add_u32 m0,s74,39936
s_nop 0
buffer_load_dwordx4 v29,s[4:7],s61 offen lds
s_waitcnt vmcnt(30)
ds_read_b64_tr_b16 a[0:1],v30 offset:0
ds_read_b64_tr_b16 a[2:3],v30 offset:320
ds_read_b64_tr_b16 a[4:5],v30 offset:1280
ds_read_b64_tr_b16 a[6:7],v30 offset:1600
ds_read_b64_tr_b16 a[8:9],v30 offset:32
ds_read_b64_tr_b16 a[10:11],v30 offset:352
ds_read_b64_tr_b16 a[12:13],v30 offset:1312
ds_read_b64_tr_b16 a[14:15],v30 offset:1632
ds_read_b64_tr_b16 a[16:17],v30 offset:64
ds_read_b64_tr_b16 a[18:19],v30 offset:384
ds_read_b64_tr_b16 a[20:21],v30 offset:1344
ds_read_b64_tr_b16 a[22:23],v30 offset:1664
s_waitcnt lgkmcnt(4)
ds_read_b64_tr_b16 a[24:25],v30 offset:96
ds_read_b64_tr_b16 a[26:27],v30 offset:416
ds_read_b64_tr_b16 a[28:29],v30 offset:1376
ds_read_b64_tr_b16 a[30:31],v30 offset:1696
ds_read_b64_tr_b16 v[32:33],v30 offset:128
ds_read_b64_tr_b16 v[34:35],v30 offset:448
ds_read_b64_tr_b16 v[36:37],v30 offset:1408
ds_read_b64_tr_b16 v[38:39],v30 offset:1728
s_waitcnt lgkmcnt(0)
s_add_u32 s61,s73,327680
s_add_u32 m0,s74,0
s_nop 0
buffer_load_dwordx4 v20,s[4:7],s61 offen lds
s_add_u32 m0,s74,1024
s_nop 0
buffer_load_dwordx4 v21,s[4:7],s61 offen lds
s_add_u32 m0,s74,2048
s_nop 0
buffer_load_dwordx4 v22,s[4:7],s61 offen lds
s_add_u32 m0,s74,3072
s_nop 0
buffer_load_dwordx4 v23,s[4:7],s61 offen lds
s_add_u32 m0,s74,4096
s_nop 0
buffer_load_dwordx4 v24,s[4:7],s61 offen lds
s_add_u32 m0,s74,5120
s_nop 0
buffer_load_dwordx4 v25,s[4:7],s61 offen lds
s_add_u32 m0,s74,6144
s_nop 0
buffer_load_dwordx4 v26,s[4:7],s61 offen lds
s_add_u32 m0,s74,7168
s_nop 0
buffer_load_dwordx4 v27,s[4:7],s61 offen lds
s_add_u32 m0,s74,8192
s_nop 0
buffer_load_dwordx4 v28,s[4:7],s61 offen lds
s_add_u32 m0,s74,9216
s_nop 0
buffer_load_dwordx4 v29,s[4:7],s61 offen lds
s_waitcnt vmcnt(30)
ds_read_b64_tr_b16 a[32:33],v30 offset:10240
ds_read_b64_tr_b16 a[34:35],v30 offset:10560
ds_read_b64_tr_b16 a[36:37],v30 offset:11520
ds_read_b64_tr_b16 a[38:39],v30 offset:11840
ds_read_b64_tr_b16 a[40:41],v30 offset:10272
ds_read_b64_tr_b16 a[42:43],v30 offset:10592
ds_read_b64_tr_b16 a[44:45],v30 offset:11552
ds_read_b64_tr_b16 a[46:47],v30 offset:11872
ds_read_b64_tr_b16 a[48:49],v30 offset:10304
ds_read_b64_tr_b16 a[50:51],v30 offset:10624
ds_read_b64_tr_b16 a[52:53],v30 offset:11584
ds_read_b64_tr_b16 a[54:55],v30 offset:11904
s_waitcnt lgkmcnt(4)
ds_read_b64_tr_b16 a[56:57],v30 offset:10336
ds_read_b64_tr_b16 a[58:59],v30 offset:10656
ds_read_b64_tr_b16 a[60:61],v30 offset:11616
ds_read_b64_tr_b16 a[62:63],v30 offset:11936
ds_read_b64_tr_b16 v[40:41],v30 offset:10368
ds_read_b64_tr_b16 v[42:43],v30 offset:10688
ds_read_b64_tr_b16 v[44:45],v30 offset:11648
ds_read_b64_tr_b16 v[46:47],v30 offset:11968
s_waitcnt lgkmcnt(0)
s_add_u32 s61,s73,409600
s_add_u32 m0,s74,10240
s_nop 0
buffer_load_dwordx4 v20,s[4:7],s61 offen lds
s_add_u32 m0,s74,11264
s_nop 0
buffer_load_dwordx4 v21,s[4:7],s61 offen lds
s_add_u32 m0,s74,12288
s_nop 0
buffer_load_dwordx4 v22,s[4:7],s61 offen lds
s_add_u32 m0,s74,13312
s_nop 0
buffer_load_dwordx4 v23,s[4:7],s61 offen lds
s_add_u32 m0,s74,14336
s_nop 0
buffer_load_dwordx4 v24,s[4:7],s61 offen lds
s_add_u32 m0,s74,15360
s_nop 0
buffer_load_dwordx4 v25,s[4:7],s61 offen lds
s_add_u32 m0,s74,16384
s_nop 0
buffer_load_dwordx4 v26,s[4:7],s61 offen lds
s_add_u32 m0,s74,17408
s_nop 0
buffer_load_dwordx4 v27,s[4:7],s61 offen lds
s_add_u32 m0,s74,18432
s_nop 0
buffer_load_dwordx4 v28,s[4:7],s61 offen lds
s_add_u32 m0,s74,19456
s_nop 0
buffer_load_dwordx4 v29,s[4:7],s61 offen lds
s_waitcnt vmcnt(30)
ds_read_b64_tr_b16 a[64:65],v30 offset:20480
ds_read_b64_tr_b16 a[66:67],v30 offset:20800
ds_read_b64_tr_b16 a[68:69],v30 offset:21760
ds_read_b64_tr_b16 a[70:71],v30 offset:22080
ds_read_b64_tr_b16 a[72:73],v30 offset:20512
ds_read_b64_tr_b16 a[74:75],v30 offset:20832
ds_read_b64_tr_b16 a[76:77],v30 offset:21792
ds_read_b64_tr_b16 a[78:79],v30 offset:22112
ds_read_b64_tr_b16 a[80:81],v30 offset:20544
ds_read_b64_tr_b16 a[82:83],v30 offset:20864
ds_read_b64_tr_b16 a[84:85],v30 offset:21824
ds_read_b64_tr_b16 a[86:87],v30 offset:22144
s_waitcnt lgkmcnt(4)
ds_read_b64_tr_b16 a[88:89],v30 offset:20576
ds_read_b64_tr_b16 a[90:91],v30 offset:20896
ds_read_b64_tr_b16 a[92:93],v30 offset:21856
ds_read_b64_tr_b16 a[94:95],v30 offset:22176
ds_read_b64_tr_b16 v[48:49],v30 offset:20608
ds_read_b64_tr_b16 v[50:51],v30 offset:20928
ds_read_b64_tr_b16 v[52:53],v30 offset:21888
ds_read_b64_tr_b16 v[54:55],v30 offset:22208
s_waitcnt lgkmcnt(0)
s_add_u32 s61,s73,491520
s_add_u32 m0,s74,20480
s_nop 0
buffer_load_dwordx4 v20,s[4:7],s61 offen lds
s_add_u32 m0,s74,21504
s_nop 0
buffer_load_dwordx4 v21,s[4:7],s61 offen lds
s_add_u32 m0,s74,22528
s_nop 0
buffer_load_dwordx4 v22,s[4:7],s61 offen lds
s_add_u32 m0,s74,23552
s_nop 0
buffer_load_dwordx4 v23,s[4:7],s61 offen lds
s_add_u32 m0,s74,24576
s_nop 0
buffer_load_dwordx4 v24,s[4:7],s61 offen lds
s_add_u32 m0,s74,25600
s_nop 0
buffer_load_dwordx4 v25,s[4:7],s61 offen lds
s_add_u32 m0,s74,26624
s_nop 0
buffer_load_dwordx4 v26,s[4:7],s61 offen lds
s_add_u32 m0,s74,27648
s_nop 0
buffer_load_dwordx4 v27,s[4:7],s61 offen lds
s_add_u32 m0,s74,28672
s_nop 0
buffer_load_dwordx4 v28,s[4:7],s61 offen lds
s_add_u32 m0,s74,29696
s_nop 0
buffer_load_dwordx4 v29,s[4:7],s61 offen lds
s_waitcnt vmcnt(30)
ds_read_b64_tr_b16 a[96:97],v30 offset:30720
ds_read_b64_tr_b16 a[98:99],v30 offset:31040
ds_read_b64_tr_b16 a[100:101],v30 offset:32000
ds_read_b64_tr_b16 a[102:103],v30 offset:32320
ds_read_b64_tr_b16 a[104:105],v30 offset:30752
ds_read_b64_tr_b16 a[106:107],v30 offset:31072
ds_read_b64_tr_b16 a[108:109],v30 offset:32032
ds_read_b64_tr_b16 a[110:111],v30 offset:32352
ds_read_b64_tr_b16 a[112:113],v30 offset:30784
ds_read_b64_tr_b16 a[114:115],v30 offset:31104
ds_read_b64_tr_b16 a[116:117],v30 offset:32064
ds_read_b64_tr_b16 a[118:119],v30 offset:32384
s_waitcnt lgkmcnt(4)
ds_read_b64_tr_b16 a[120:121],v30 offset:30816
ds_read_b64_tr_b16 a[122:123],v30 offset:31136
ds_read_b64_tr_b16 a[124:125],v30 offset:32096
ds_read_b64_tr_b16 a[126:127],v30 offset:32416
ds_read_b64_tr_b16 v[56:57],v30 offset:30848
ds_read_b64_tr_b16 v[58:59],v30 offset:31168
ds_read_b64_tr_b16 v[60:61],v30 offset:32128
ds_read_b64_tr_b16 v[62:63],v30 offset:32448
s_waitcnt lgkmcnt(0)
s_add_u32 s61,s73,573440
s_add_u32 m0,s74,30720
s_nop 0
buffer_load_dwordx4 v20,s[4:7],s61 offen lds
s_add_u32 m0,s74,31744
s_nop 0
buffer_load_dwordx4 v21,s[4:7],s61 offen lds
s_add_u32 m0,s74,32768
s_nop 0
buffer_load_dwordx4 v22,s[4:7],s61 offen lds
s_add_u32 m0,s74,33792
s_nop 0
buffer_load_dwordx4 v23,s[4:7],s61 offen lds
s_add_u32 m0,s74,34816
s_nop 0
buffer_load_dwordx4 v24,s[4:7],s61 offen lds
s_add_u32 m0,s74,35840
s_nop 0
buffer_load_dwordx4 v25,s[4:7],s61 offen lds
s_add_u32 m0,s74,36864
s_nop 0
buffer_load_dwordx4 v26,s[4:7],s61 offen lds
s_add_u32 m0,s74,37888
s_nop 0
buffer_load_dwordx4 v27,s[4:7],s61 offen lds
s_add_u32 m0,s74,38912
s_nop 0
buffer_load_dwordx4 v28,s[4:7],s61 offen lds
s_add_u32 m0,s74,39936
s_nop 0
buffer_load_dwordx4 v29,s[4:7],s61 offen lds
s_waitcnt vmcnt(30)
ds_read_b64_tr_b16 a[128:129],v30 offset:0
ds_read_b64_tr_b16 a[130:131],v30 offset:320
ds_read_b64_tr_b16 a[132:133],v30 offset:1280
ds_read_b64_tr_b16 a[134:135],v30 offset:1600
ds_read_b64_tr_b16 a[136:137],v30 offset:32
ds_read_b64_tr_b16 a[138:139],v30 offset:352
ds_read_b64_tr_b16 a[140:141],v30 offset:1312
ds_read_b64_tr_b16 a[142:143],v30 offset:1632
ds_read_b64_tr_b16 a[144:145],v30 offset:64
ds_read_b64_tr_b16 a[146:147],v30 offset:384
ds_read_b64_tr_b16 a[148:149],v30 offset:1344
ds_read_b64_tr_b16 a[150:151],v30 offset:1664
s_waitcnt lgkmcnt(4)
ds_read_b64_tr_b16 a[152:153],v30 offset:96
ds_read_b64_tr_b16 a[154:155],v30 offset:416
ds_read_b64_tr_b16 a[156:157],v30 offset:1376
ds_read_b64_tr_b16 a[158:159],v30 offset:1696
ds_read_b64_tr_b16 v[64:65],v30 offset:128
ds_read_b64_tr_b16 v[66:67],v30 offset:448
ds_read_b64_tr_b16 v[68:69],v30 offset:1408
ds_read_b64_tr_b16 v[70:71],v30 offset:1728
s_waitcnt lgkmcnt(0)
s_add_u32 s61,s73,655360
s_add_u32 m0,s74,0
s_nop 0
buffer_load_dwordx4 v20,s[4:7],s61 offen lds
s_add_u32 m0,s74,1024
s_nop 0
buffer_load_dwordx4 v21,s[4:7],s61 offen lds
s_add_u32 m0,s74,2048
s_nop 0
buffer_load_dwordx4 v22,s[4:7],s61 offen lds
s_add_u32 m0,s74,3072
s_nop 0
buffer_load_dwordx4 v23,s[4:7],s61 offen lds
s_add_u32 m0,s74,4096
s_nop 0
buffer_load_dwordx4 v24,s[4:7],s61 offen lds
s_add_u32 m0,s74,5120
s_nop 0
buffer_load_dwordx4 v25,s[4:7],s61 offen lds
s_add_u32 m0,s74,6144
s_nop 0
buffer_load_dwordx4 v26,s[4:7],s61 offen lds
s_add_u32 m0,s74,7168
s_nop 0
buffer_load_dwordx4 v27,s[4:7],s61 offen lds
s_add_u32 m0,s74,8192
s_nop 0
buffer_load_dwordx4 v28,s[4:7],s61 offen lds
s_add_u32 m0,s74,9216
s_nop 0
buffer_load_dwordx4 v29,s[4:7],s61 offen lds
s_waitcnt vmcnt(30)
ds_read_b64_tr_b16 a[160:161],v30 offset:10240
ds_read_b64_tr_b16 a[162:163],v30 offset:10560
ds_read_b64_tr_b16 a[164:165],v30 offset:11520
ds_read_b64_tr_b16 a[166:167],v30 offset:11840
ds_read_b64_tr_b16 a[168:169],v30 offset:10272
ds_read_b64_tr_b16 a[170:171],v30 offset:10592
ds_read_b64_tr_b16 a[172:173],v30 offset:11552
ds_read_b64_tr_b16 a[174:175],v30 offset:11872
ds_read_b64_tr_b16 a[176:177],v30 offset:10304
ds_read_b64_tr_b16 a[178:179],v30 offset:10624
ds_read_b64_tr_b16 a[180:181],v30 offset:11584
ds_read_b64_tr_b16 a[182:183],v30 offset:11904
s_waitcnt lgkmcnt(4)
ds_read_b64_tr_b16 a[184:185],v30 offset:10336
ds_read_b64_tr_b16 a[186:187],v30 offset:10656
ds_read_b64_tr_b16 a[188:189],v30 offset:11616
ds_read_b64_tr_b16 a[190:191],v30 offset:11936
ds_read_b64_tr_b16 v[72:73],v30 offset:10368
ds_read_b64_tr_b16 v[74:75],v30 offset:10688
ds_read_b64_tr_b16 v[76:77],v30 offset:11648
ds_read_b64_tr_b16 v[78:79],v30 offset:11968
s_waitcnt lgkmcnt(0)
s_add_u32 s61,s73,737280
s_add_u32 m0,s74,10240
s_nop 0
buffer_load_dwordx4 v20,s[4:7],s61 offen lds
s_add_u32 m0,s74,11264
s_nop 0
buffer_load_dwordx4 v21,s[4:7],s61 offen lds
s_add_u32 m0,s74,12288
s_nop 0
buffer_load_dwordx4 v22,s[4:7],s61 offen lds
s_add_u32 m0,s74,13312
s_nop 0
buffer_load_dwordx4 v23,s[4:7],s61 offen lds
s_add_u32 m0,s74,14336
s_nop 0
buffer_load_dwordx4 v24,s[4:7],s61 offen lds
s_add_u32 m0,s74,15360
s_nop 0
buffer_load_dwordx4 v25,s[4:7],s61 offen lds
s_add_u32 m0,s74,16384
s_nop 0
buffer_load_dwordx4 v26,s[4:7],s61 offen lds
s_add_u32 m0,s74,17408
s_nop 0
buffer_load_dwordx4 v27,s[4:7],s61 offen lds
s_add_u32 m0,s74,18432
s_nop 0
buffer_load_dwordx4 v28,s[4:7],s61 offen lds
s_add_u32 m0,s74,19456
s_nop 0
buffer_load_dwordx4 v29,s[4:7],s61 offen lds
s_waitcnt vmcnt(30)
ds_read_b64_tr_b16 a[192:193],v30 offset:20480
ds_read_b64_tr_b16 a[194:195],v30 offset:20800
ds_read_b64_tr_b16 a[196:197],v30 offset:21760
ds_read_b64_tr_b16 a[198:199],v30 offset:22080
ds_read_b64_tr_b16 a[200:201],v30 offset:20512
ds_read_b64_tr_b16 a[202:203],v30 offset:20832
ds_read_b64_tr_b16 a[204:205],v30 offset:21792
ds_read_b64_tr_b16 a[206:207],v30 offset:22112
ds_read_b64_tr_b16 a[208:209],v30 offset:20544
ds_read_b64_tr_b16 a[210:211],v30 offset:20864
ds_read_b64_tr_b16 a[212:213],v30 offset:21824
ds_read_b64_tr_b16 a[214:215],v30 offset:22144
s_waitcnt lgkmcnt(4)
ds_read_b64_tr_b16 a[216:217],v30 offset:20576
ds_read_b64_tr_b16 a[218:219],v30 offset:20896
ds_read_b64_tr_b16 a[220:221],v30 offset:21856
ds_read_b64_tr_b16 a[222:223],v30 offset:22176
ds_read_b64_tr_b16 v[80:81],v30 offset:20608
ds_read_b64_tr_b16 v[82:83],v30 offset:20928
ds_read_b64_tr_b16 v[84:85],v30 offset:21888
ds_read_b64_tr_b16 v[86:87],v30 offset:22208
s_waitcnt lgkmcnt(0)
s_add_u32 s61,s73,819200
s_add_u32 m0,s74,20480
s_nop 0
buffer_load_dwordx4 v20,s[4:7],s61 offen lds
s_add_u32 m0,s74,21504
s_nop 0
buffer_load_dwordx4 v21,s[4:7],s61 offen lds
s_add_u32 m0,s74,22528
s_nop 0
buffer_load_dwordx4 v22,s[4:7],s61 offen lds
s_add_u32 m0,s74,23552
s_nop 0
buffer_load_dwordx4 v23,s[4:7],s61 offen lds
s_add_u32 m0,s74,24576
s_nop 0
buffer_load_dwordx4 v24,s[4:7],s61 offen lds
s_add_u32 m0,s74,25600
s_nop 0
buffer_load_dwordx4 v25,s[4:7],s61 offen lds
s_add_u32 m0,s74,26624
s_nop 0
buffer_load_dwordx4 v26,s[4:7],s61 offen lds
s_add_u32 m0,s74,27648
s_nop 0
buffer_load_dwordx4 v27,s[4:7],s61 offen lds
s_add_u32 m0,s74,28672
s_nop 0
buffer_load_dwordx4 v28,s[4:7],s61 offen lds
s_add_u32 m0,s74,29696
s_nop 0
buffer_load_dwordx4 v29,s[4:7],s61 offen lds
s_waitcnt vmcnt(30)
ds_read_b64_tr_b16 a[224:225],v30 offset:30720
ds_read_b64_tr_b16 a[226:227],v30 offset:31040
ds_read_b64_tr_b16 a[228:229],v30 offset:32000
ds_read_b64_tr_b16 a[230:231],v30 offset:32320
ds_read_b64_tr_b16 a[232:233],v30 offset:30752
ds_read_b64_tr_b16 a[234:235],v30 offset:31072
ds_read_b64_tr_b16 a[236:237],v30 offset:32032
ds_read_b64_tr_b16 a[238:239],v30 offset:32352
ds_read_b64_tr_b16 a[240:241],v30 offset:30784
ds_read_b64_tr_b16 a[242:243],v30 offset:31104
ds_read_b64_tr_b16 a[244:245],v30 offset:32064
ds_read_b64_tr_b16 a[246:247],v30 offset:32384
s_waitcnt lgkmcnt(4)
ds_read_b64_tr_b16 a[248:249],v30 offset:30816
ds_read_b64_tr_b16 a[250:251],v30 offset:31136
ds_read_b64_tr_b16 a[252:253],v30 offset:32096
ds_read_b64_tr_b16 a[254:255],v30 offset:32416
ds_read_b64_tr_b16 v[88:89],v30 offset:30848
ds_read_b64_tr_b16 v[90:91],v30 offset:31168
ds_read_b64_tr_b16 v[92:93],v30 offset:32128
ds_read_b64_tr_b16 v[94:95],v30 offset:32448
s_waitcnt lgkmcnt(0)
s_add_u32 s61,s73,901120
s_add_u32 m0,s74,30720
s_nop 0
buffer_load_dwordx4 v20,s[4:7],s61 offen lds
s_add_u32 m0,s74,31744
s_nop 0
buffer_load_dwordx4 v21,s[4:7],s61 offen lds
s_add_u32 m0,s74,32768
s_nop 0
buffer_load_dwordx4 v22,s[4:7],s61 offen lds
s_add_u32 m0,s74,33792
s_nop 0
buffer_load_dwordx4 v23,s[4:7],s61 offen lds
s_add_u32 m0,s74,34816
s_nop 0
buffer_load_dwordx4 v24,s[4:7],s61 offen lds
s_add_u32 m0,s74,35840
s_nop 0
buffer_load_dwordx4 v25,s[4:7],s61 offen lds
s_add_u32 m0,s74,36864
s_nop 0
buffer_load_dwordx4 v26,s[4:7],s61 offen lds
s_add_u32 m0,s74,37888
s_nop 0
buffer_load_dwordx4 v27,s[4:7],s61 offen lds
s_add_u32 m0,s74,38912
s_nop 0
buffer_load_dwordx4 v28,s[4:7],s61 offen lds
s_add_u32 m0,s74,39936
s_nop 0
buffer_load_dwordx4 v29,s[4:7],s61 offen lds
s_waitcnt vmcnt(30)
ds_read_b64_tr_b16 v[128:129],v30 offset:0
ds_read_b64_tr_b16 v[130:131],v30 offset:320
ds_read_b64_tr_b16 v[132:133],v30 offset:1280
ds_read_b64_tr_b16 v[134:135],v30 offset:1600
ds_read_b64_tr_b16 v[136:137],v30 offset:32
ds_read_b64_tr_b16 v[138:139],v30 offset:352
ds_read_b64_tr_b16 v[140:141],v30 offset:1312
ds_read_b64_tr_b16 v[142:143],v30 offset:1632
ds_read_b64_tr_b16 v[144:145],v30 offset:64
ds_read_b64_tr_b16 v[146:147],v30 offset:384
ds_read_b64_tr_b16 v[148:149],v30 offset:1344
ds_read_b64_tr_b16 v[150:151],v30 offset:1664
s_waitcnt lgkmcnt(4)
ds_read_b64_tr_b16 v[152:153],v30 offset:96
ds_read_b64_tr_b16 v[154:155],v30 offset:416
ds_read_b64_tr_b16 v[156:157],v30 offset:1376
ds_read_b64_tr_b16 v[158:159],v30 offset:1696
ds_read_b64_tr_b16 v[96:97],v30 offset:128
ds_read_b64_tr_b16 v[98:99],v30 offset:448
ds_read_b64_tr_b16 v[100:101],v30 offset:1408
ds_read_b64_tr_b16 v[102:103],v30 offset:1728
s_waitcnt lgkmcnt(0)
s_waitcnt vmcnt(20)
ds_read_b64_tr_b16 v[160:161],v30 offset:10240
ds_read_b64_tr_b16 v[162:163],v30 offset:10560
ds_read_b64_tr_b16 v[164:165],v30 offset:11520
ds_read_b64_tr_b16 v[166:167],v30 offset:11840
ds_read_b64_tr_b16 v[168:169],v30 offset:10272
ds_read_b64_tr_b16 v[170:171],v30 offset:10592
ds_read_b64_tr_b16 v[172:173],v30 offset:11552
ds_read_b64_tr_b16 v[174:175],v30 offset:11872
ds_read_b64_tr_b16 v[176:177],v30 offset:10304
ds_read_b64_tr_b16 v[178:179],v30 offset:10624
ds_read_b64_tr_b16 v[180:181],v30 offset:11584
ds_read_b64_tr_b16 v[182:183],v30 offset:11904
s_waitcnt lgkmcnt(4)
ds_read_b64_tr_b16 v[184:185],v30 offset:10336
ds_read_b64_tr_b16 v[186:187],v30 offset:10656
ds_read_b64_tr_b16 v[188:189],v30 offset:11616
ds_read_b64_tr_b16 v[190:191],v30 offset:11936
ds_read_b64_tr_b16 v[104:105],v30 offset:10368
ds_read_b64_tr_b16 v[106:107],v30 offset:10688
ds_read_b64_tr_b16 v[108:109],v30 offset:11648
ds_read_b64_tr_b16 v[110:111],v30 offset:11968
s_waitcnt lgkmcnt(0)
s_waitcnt vmcnt(10)
ds_read_b64_tr_b16 v[192:193],v30 offset:20480
ds_read_b64_tr_b16 v[194:195],v30 offset:20800
ds_read_b64_tr_b16 v[196:197],v30 offset:21760
ds_read_b64_tr_b16 v[198:199],v30 offset:22080
ds_read_b64_tr_b16 v[200:201],v30 offset:20512
ds_read_b64_tr_b16 v[202:203],v30 offset:20832
ds_read_b64_tr_b16 v[204:205],v30 offset:21792
ds_read_b64_tr_b16 v[206:207],v30 offset:22112
ds_read_b64_tr_b16 v[208:209],v30 offset:20544
ds_read_b64_tr_b16 v[210:211],v30 offset:20864
ds_read_b64_tr_b16 v[212:213],v30 offset:21824
ds_read_b64_tr_b16 v[214:215],v30 offset:22144
s_waitcnt lgkmcnt(4)
ds_read_b64_tr_b16 v[216:217],v30 offset:20576
ds_read_b64_tr_b16 v[218:219],v30 offset:20896
ds_read_b64_tr_b16 v[220:221],v30 offset:21856
ds_read_b64_tr_b16 v[222:223],v30 offset:22176
ds_read_b64_tr_b16 v[112:113],v30 offset:20608
ds_read_b64_tr_b16 v[114:115],v30 offset:20928
ds_read_b64_tr_b16 v[116:117],v30 offset:21888
ds_read_b64_tr_b16 v[118:119],v30 offset:22208
s_waitcnt lgkmcnt(0)
s_waitcnt vmcnt(0)
ds_read_b64_tr_b16 v[224:225],v30 offset:30720
ds_read_b64_tr_b16 v[226:227],v30 offset:31040
ds_read_b64_tr_b16 v[228:229],v30 offset:32000
ds_read_b64_tr_b16 v[230:231],v30 offset:32320
ds_read_b64_tr_b16 v[232:233],v30 offset:30752
ds_read_b64_tr_b16 v[234:235],v30 offset:31072
ds_read_b64_tr_b16 v[236:237],v30 offset:32032
ds_read_b64_tr_b16 v[238:239],v30 offset:32352
ds_read_b64_tr_b16 v[240:241],v30 offset:30784
ds_read_b64_tr_b16 v[242:243],v30 offset:31104
ds_read_b64_tr_b16 v[244:245],v30 offset:32064
ds_read_b64_tr_b16 v[246:247],v30 offset:32384
s_waitcnt lgkmcnt(4)
ds_read_b64_tr_b16 v[248:249],v30 offset:30816
ds_read_b64_tr_b16 v[250:251],v30 offset:31136
ds_read_b64_tr_b16 v[252:253],v30 offset:32096
ds_read_b64_tr_b16 v[254:255],v30 offset:32416
ds_read_b64_tr_b16 v[120:121],v30 offset:30848
ds_read_b64_tr_b16 v[122:123],v30 offset:31168
ds_read_b64_tr_b16 v[124:125],v30 offset:32128
ds_read_b64_tr_b16 v[126:127],v30 offset:32448
s_waitcnt lgkmcnt(0)
s_barrier
ds_write_b128 v4,v[32:35] offset:0
ds_write_b128 v4,v[36:39] offset:1024
ds_write_b128 v4,v[40:43] offset:2048
ds_write_b128 v4,v[44:47] offset:3072
ds_write_b128 v4,v[48:51] offset:4096
ds_write_b128 v4,v[52:55] offset:5120
ds_write_b128 v4,v[56:59] offset:6144
ds_write_b128 v4,v[60:63] offset:7168
s_waitcnt lgkmcnt(0)
ds_write_b128 v4,v[64:67] offset:8192
ds_write_b128 v4,v[68:71] offset:9216
ds_write_b128 v4,v[72:75] offset:10240
ds_write_b128 v4,v[76:79] offset:11264
ds_write_b128 v4,v[80:83] offset:12288
ds_write_b128 v4,v[84:87] offset:13312
ds_write_b128 v4,v[88:91] offset:14336
ds_write_b128 v4,v[92:95] offset:15360
s_waitcnt lgkmcnt(0)
ds_write_b128 v4,v[96:99] offset:16384
ds_write_b128 v4,v[100:103] offset:17408
ds_write_b128 v4,v[104:107] offset:18432
ds_write_b128 v4,v[108:111] offset:19456
ds_write_b128 v4,v[112:115] offset:20480
ds_write_b128 v4,v[116:119] offset:21504
ds_write_b128 v4,v[120:123] offset:22528
ds_write_b128 v4,v[124:127] offset:23552
s_waitcnt lgkmcnt(0)
s_barrier
s_lshl_b32 s3,s49,2
v_mov_b32 v13,s3
s_nop 1
ibw_163:
buffer_load_dword v12,v13,s[12:15],0 offen sc1
s_waitcnt vmcnt(0)
v_cmp_ne_u32 vcc,256,v12
s_nop 0
s_cbranch_vccz ok_164
s_sleep 8
s_sub_u32 s47,s47,1
s_cbranch_scc1 ABORT
s_branch ibw_163
ok_164:
s_cmp_lg_u32 s49,0
s_cbranch_scc1 ibok_165
v_and_b32 v13,7,v0
v_lshlrev_b32 v13,2,v13
buffer_load_dword v12,v13,s[12:15],0 offen offset:32 sc1
s_waitcnt vmcnt(0)
v_cmp_ne_u32 vcc,32,v12
s_nop 0
s_cbranch_vccz ibok_165
s_barrier
s_mov_b32 s49,1
s_mov_b32 s3,s2
s_load_dwordx16 s[16:31],s[0:1],0
s_load_dwordx8 s[32:39],s[0:1],64
s_waitcnt lgkmcnt(0)
s_branch DISPATCH
ibok_165:
v_mov_b32 v13,192
s_cmp_lg_u32 s49,0
s_cbranch_scc1 vx_167
vw_166:
buffer_load_dword v12,v13,s[12:15],0 offen sc1
s_waitcnt vmcnt(0)
v_and_b32 v14,0xffff,v12
v_cmp_ne_u32 vcc,64,v14
s_nop 0
s_cbranch_vccz ok_168
s_sleep 4
s_sub_u32 s47,s47,1
s_cbranch_scc1 ABORT
s_branch vw_166
ok_168:
v_readfirstlane_b32 s60,v12
s_cmp_gt_u32 s60,2162688
s_cselect_b32 s60,0x2000,0
s_add_u32 s83,s83,s60
s_nop 1
vx_167:
s_mov_b32 s50,0
s_mov_b32 s77,0
s_cmp_lg_u32 s49,0
s_cbranch_scc1 CW_LOOP_S
CW_LOOP_F:
s_sub_u32 s60,s50,13
s_lshr_b32 s52,s60,1
s_and_b32 s51,s60,1
s_cmp_eq_u32 s51,0
s_cselect_b32 s61,13,0
s_add_u32 s52,s52,s61
s_sub_u32 s61,s60,51
s_cmp_ge_u32 s60,102
s_cselect_b32 s52,s61,s52
s_cselect_b32 s51,1,s51
s_cmp_lt_u32 s50,13
s_cselect_b32 s52,s50,s52
s_cselect_b32 s51,0,s51
s_cmp_eq_u32 s52,63
s_cbranch_scc1 CW_NEXT_F
s_add_u32 s58,s52,1
s_lshl_b32 s61,s51,9
s_add_u32 s72,s61,s35
s_add_u32 s69,s61,s85
s_lshl_b32 s61,s51,2
s_and_b32 s60,s52,1
s_add_u32 s60,s60,s61
s_mul_i32 s70,s60,49152
s_add_u32 s70,s70,s33
s_add_u32 s71,s70,4096
s_add_u32 s80,s70,8192
s_bfe_u32 s57,s52,65537
s_bfe_u32 s31,s58,65537
s_and_b32 s60,s58,1
s_add_u32 s60,s60,s61
s_mul_i32 s59,s60,20480
s_add_u32 s59,s59,s84
s_lshl_b32 s68,s60,16
s_add_u32 s68,s68,s83
s_xor_b32 s77,s77,11264
v_add_u32 v7,s77,v5
v_add_u32 v8,s77,v6
s_add_u32 s60,s52,2
v_mov_b32 v16,s60
v_mov_b32 v80,0
v_mov_b32 v81,0
v_mov_b32 v82,0
v_mov_b32 v83,0
v_mov_b32 v84,0
v_mov_b32 v85,0
v_mov_b32 v86,0
v_mov_b32 v87,0
v_mov_b32 v88,0
v_mov_b32 v89,0
v_mov_b32 v90,0
v_mov_b32 v91,0
v_mov_b32 v92,0
v_mov_b32 v93,0
v_mov_b32 v94,0
v_mov_b32 v95,0
v_mov_b32 v96,0
v_mov_b32 v97,0
v_mov_b32 v98,0
v_mov_b32 v99,0
ds_read_b128 v[100:103],v4 offset:0
ds_read_b128 v[104:107],v4 offset:1024
ds_read_b128 v[108:111],v4 offset:2048
ds_read_b128 v[112:115],v4 offset:3072
s_cmp_lg_u32 s46,0
s_cbranch_scc1 np_169
db_170:
buffer_load_dword v12,v3,s[8:11],s72 offen sc1
s_waitcnt vmcnt(0)
v_cmp_gt_u32 vcc,s58,v12
s_cbranch_vccz dbok_171
s_sub_u32 s47,s47,1
s_cbranch_scc1 ABORT
s_branch db_170
dbok_171:
np_169:
s_barrier
buffer_load_dwordx4 v[32:35],v1,s[8:11],s70 offen sc1
s_nop 7
buffer_load_dwordx4 v[36:39],v1,s[8:11],s70 offen offset:1024 sc1
s_nop 7
buffer_load_dwordx4 v[40:43],v1,s[8:11],s70 offen offset:2048 sc1
s_nop 7
buffer_load_dwordx4 v[44:47],v1,s[8:11],s70 offen offset:3072 sc1
s_nop 7
buffer_load_dwordx4 v[48:51],v1,s[8:11],s71 offen sc1
s_waitcnt vmcnt(4)
v_and_b32 v12,1,v32
v_cmp_ne_u32 vcc,s57,v12
s_cbranch_vccnz ws_172
wg_181:
v_smfmac_f32_16x16x64_bf16 v[80:83],v[32:35],a[0:7],v2
buffer_load_dwordx4 v[52:55],v1,s[8:11],s71 offen offset:1024 sc1
v_smfmac_f32_16x16x64_bf16 v[84:87],v[32:35],a[8:15],v2
s_waitcnt vmcnt(4)
v_and_b32 v12,1,v36
v_smfmac_f32_16x16x64_bf16 v[88:91],v[32:35],a[16:23],v2
v_cmp_ne_u32 vcc,s57,v12
v_smfmac_f32_16x16x64_bf16 v[92:95],v[32:35],a[24:31],v2
s_waitcnt lgkmcnt(2)
v_smfmac_f32_16x16x64_bf16 v[96:99],v[32:35],v[100:107],v2
s_cbranch_vccnz ws_173
wg_182:
v_smfmac_f32_16x16x64_bf16 v[80:83],v[36:39],a[32:39],v2
buffer_load_dwordx4 v[56:59],v1,s[8:11],s71 offen offset:2048 sc1
v_smfmac_f32_16x16x64_bf16 v[84:87],v[36:39],a[40:47],v2
s_waitcnt vmcnt(4)
v_and_b32 v12,1,v40
v_smfmac_f32_16x16x64_bf16 v[88:91],v[36:39],a[48:55],v2
v_cmp_ne_u32 vcc,s57,v12
ds_read_b128 v[100:103],v4 offset:4096
v_smfmac_f32_16x16x64_bf16 v[92:95],v[36:39],a[56:63],v2
ds_read_b128 v[104:107],v4 offset:5120
s_waitcnt lgkmcnt(2)
v_smfmac_f32_16x16x64_bf16 v[96:99],v[36:39],v[108:115],v2
s_cbranch_vccnz ws_174
wg_183:
v_smfmac_f32_16x16x64_bf16 v[80:83],v[40:43],a[64:71],v2
buffer_load_dwordx4 v[60:63],v1,s[8:11],s71 offen offset:3072 sc1
v_smfmac_f32_16x16x64_bf16 v[84:87],v[40:43],a[72:79],v2
s_waitcnt vmcnt(4)
v_and_b32 v12,1,v44
v_smfmac_f32_16x16x64_bf16 v[88:91],v[40:43],a[80:87],v2
v_cmp_ne_u32 vcc,s57,v12
ds_read_b128 v[108:111],v4 offset:6144
v_smfmac_f32_16x16x64_bf16 v[92:95],v[40:43],a[88:95],v2
ds_read_b128 v[112:115],v4 offset:7168
s_waitcnt lgkmcnt(2)
v_smfmac_f32_16x16x64_bf16 v[96:99],v[40:43],v[100:107],v2
s_cbranch_vccnz ws_175
wg_184:
v_smfmac_f32_16x16x64_bf16 v[80:83],v[44:47],a[96:103],v2
buffer_load_dwordx4 v[64:67],v1,s[8:11],s80 offen sc1
v_smfmac_f32_16x16x64_bf16 v[84:87],v[44:47],a[104:111],v2
s_waitcnt vmcnt(4)
v_and_b32 v12,1,v48
v_smfmac_f32_16x16x64_bf16 v[88:91],v[44:47],a[112:119],v2
v_cmp_ne_u32 vcc,s57,v12
ds_read_b128 v[100:103],v4 offset:8192
v_smfmac_f32_16x16x64_bf16 v[92:95],v[44:47],a[120:127],v2
ds_read_b128 v[104:107],v4 offset:9216
s_waitcnt lgkmcnt(2)
v_smfmac_f32_16x16x64_bf16 v[96:99],v[44:47],v[108:115],v2
s_cbranch_vccnz ws_176
wg_185:
v_smfmac_f32_16x16x64_bf16 v[80:83],v[48:51],a[128:135],v2
buffer_load_dwordx4 v[68:71],v1,s[8:11],s80 offen offset:1024 sc1
v_smfmac_f32_16x16x64_bf16 v[84:87],v[48:51],a[136:143],v2
s_waitcnt vmcnt(4)
v_and_b32 v12,1,v52
v_smfmac_f32_16x16x64_bf16 v[88:91],v[48:51],a[144:151],v2
v_cmp_ne_u32 vcc,s57,v12
ds_read_b128 v[108:111],v4 offset:10240
v_smfmac_f32_16x16x64_bf16 v[92:95],v[48:51],a[152:159],v2
ds_read_b128 v[112:115],v4 offset:11264
s_waitcnt lgkmcnt(2)
v_smfmac_f32_16x16x64_bf16 v[96:99],v[48:51],v[100:107],v2
s_cbranch_vccnz ws_177
wg_186:
v_smfmac_f32_16x16x64_bf16 v[80:83],v[52:55],a[160:167],v2
s_waitcnt vmcnt(2)
v_bitop3_b32 v12,v56,v60,s57 bitop3:0x7e
v_smfmac_f32_16x16x64_bf16 v[84:87],v[52:55],a[168:175],v2
v_and_b32 v12,1,v12
buffer_load_dwordx4 v[72:75],v1,s[8:11],s80 offen offset:2048 sc1
v_smfmac_f32_16x16x64_bf16 v[88:91],v[52:55],a[176:183],v2
v_cmp_ne_u32 vcc,0,v12
ds_read_b128 v[100:103],v4 offset:12288
v_smfmac_f32_16x16x64_bf16 v[92:95],v[52:55],a[184:191],v2
ds_read_b128 v[104:107],v4 offset:13312
s_waitcnt lgkmcnt(2)
v_smfmac_f32_16x16x64_bf16 v[96:99],v[52:55],v[108:115],v2
s_cbranch_vccnz ws_178
wg_187:
v_smfmac_f32_16x16x64_bf16 v[80:83],v[56:59],a[192:199],v2
buffer_load_dwordx4 v[76:79],v1,s[8:11],s80 offen offset:3072 sc1
v_smfmac_f32_16x16x64_bf16 v[84:87],v[56:59],a[200:207],v2
ds_read_b128 v[108:111],v4 offset:14336
v_smfmac_f32_16x16x64_bf16 v[88:91],v[56:59],a[208:215],v2
ds_read_b128 v[112:115],v4 offset:15360
v_smfmac_f32_16x16x64_bf16 v[92:95],v[56:59],a[216:223],v2
s_waitcnt lgkmcnt(2)
v_smfmac_f32_16x16x64_bf16 v[96:99],v[56:59],v[100:107],v2
ds_read_b128 v[100:103],v4 offset:16384
v_smfmac_f32_16x16x64_bf16 v[80:83],v[60:63],a[224:231],v2
s_waitcnt vmcnt(2)
v_bitop3_b32 v12,v64,v68,s57 bitop3:0x7e
v_smfmac_f32_16x16x64_bf16 v[84:87],v[60:63],a[232:239],v2
v_and_b32 v12,1,v12
ds_read_b128 v[104:107],v4 offset:17408
v_smfmac_f32_16x16x64_bf16 v[88:91],v[60:63],a[240:247],v2
v_cmp_ne_u32 vcc,0,v12
v_smfmac_f32_16x16x64_bf16 v[92:95],v[60:63],a[248:255],v2
s_waitcnt lgkmcnt(2)
v_smfmac_f32_16x16x64_bf16 v[96:99],v[60:63],v[108:115],v2
s_cbranch_vccnz ws_179
wg_188:
v_smfmac_f32_16x16x64_bf16 v[80:83],v[64:67],v[128:135],v2
ds_read_b128 v[108:111],v4 offset:18432
v_smfmac_f32_16x16x64_bf16 v[84:87],v[64:67],v[136:143],v2
ds_read_b128 v[112:115],v4 offset:19456
v_smfmac_f32_16x16x64_bf16 v[88:91],v[64:67],v[144:151],v2
v_smfmac_f32_16x16x64_bf16 v[92:95],v[64:67],v[152:159],v2
s_waitcnt lgkmcnt(2)
v_smfmac_f32_16x16x64_bf16 v[96:99],v[64:67],v[100:107],v2
ds_read_b128 v[100:103],v4 offset:20480
v_smfmac_f32_16x16x64_bf16 v[80:83],v[68:71],v[160:167],v2
s_waitcnt vmcnt(0)
v_bitop3_b32 v12,v72,v76,s57 bitop3:0x7e
v_smfmac_f32_16x16x64_bf16 v[84:87],v[68:71],v[168:175],v2
v_and_b32 v12,1,v12
ds_read_b128 v[104:107],v4 offset:21504
v_smfmac_f32_16x16x64_bf16 v[88:91],v[68:71],v[176:183],v2
v_cmp_ne_u32 vcc,0,v12
v_smfmac_f32_16x16x64_bf16 v[92:95],v[68:71],v[184:191],v2
s_waitcnt lgkmcnt(2)
v_smfmac_f32_16x16x64_bf16 v[96:99],v[68:71],v[108:115],v2
s_cbranch_vccnz ws_180
wg_189:
v_smfmac_f32_16x16x64_bf16 v[80:83],v[72:75],v[192:199],v2
ds_read_b128 v[108:111],v4 offset:22528
v_smfmac_f32_16x16x64_bf16 v[80:83],v[76:79],v[224:231],v2
ds_read_b128 v[112:115],v4 offset:23552
v_smfmac_f32_16x16x64_bf16 v[84:87],v[72:75],v[200:207],v2
v_smfmac_f32_16x16x64_bf16 v[84:87],v[76:79],v[232:239],v2
v_smfmac_f32_16x16x64_bf16 v[88:91],v[72:75],v[208:215],v2
v_add_f32 v80,v80,v81
v_smfmac_f32_16x16x64_bf16 v[88:91],v[76:79],v[240:247],v2
v_add_f32 v82,v82,v83
ds_write2_b32 v7,v80,v82 offset0:0 offset1:88
v_smfmac_f32_16x16x64_bf16 v[92:95],v[72:75],v[216:223],v2
v_add_f32 v84,v84,v85
v_smfmac_f32_16x16x64_bf16 v[92:95],v[76:79],v[248:255],v2
v_add_f32 v86,v86,v87
s_waitcnt lgkmcnt(3)
v_smfmac_f32_16x16x64_bf16 v[96:99],v[72:75],v[100:107],v2
ds_write2_b32 v7,v84,v86 offset0:16 offset1:104
s_waitcnt lgkmcnt(2)
v_smfmac_f32_16x16x64_bf16 v[96:99],v[76:79],v[108:115],v2
v_add_f32 v88,v88,v89
v_add_f32 v90,v90,v91
ds_write2_b32 v7,v88,v90 offset0:32 offset1:120
v_add_f32 v92,v92,v93
v_add_f32 v94,v94,v95
ds_write2_b32 v7,v92,v94 offset0:48 offset1:136
s_nop 1
v_add_f32 v96,v96,v97
v_add_f32 v98,v98,v99
ds_write2_b32 v7,v96,v98 offset0:64 offset1:152
s_waitcnt lgkmcnt(0)
s_barrier
ds_read_b128 v[32:35],v8 offset:0
ds_read_b128 v[36:39],v8 offset:2816
ds_read_b128 v[40:43],v8 offset:5632
ds_read_b128 v[44:47],v8 offset:8448
s_mov_b64 exec,1
buffer_store_dword v16,v1,s[8:11],s69 offen
s_mov_b64 exec,-1
s_waitcnt lgkmcnt(2)
v_pk_add_f32 v[32:33],v[32:33],v[36:37]
v_pk_add_f32 v[34:35],v[34:35],v[38:39]
s_waitcnt lgkmcnt(0)
v_pk_add_f32 v[40:41],v[40:41],v[44:45]
v_pk_add_f32 v[42:43],v[42:43],v[46:47]
v_pk_add_f32 v[32:33],v[32:33],v[40:41]
v_pk_add_f32 v[34:35],v[34:35],v[42:43]
v_cvt_pk_bf16_f32 v32,v32,v33
v_cvt_pk_bf16_f32 v33,v34,v35
v_bfi_b32 v32,v10,s31,v32
s_nop 0
v_permlane32_swap_b32 v33,v35
v_permlane32_swap_b32 v32,v34
s_mov_b64 exec,s[88:89]
buffer_store_dwordx4 v[32:35],v9,s[8:11],s59 offen
s_barrier
buffer_store_dwordx4 v[32:35],v9,s[8:11],s68 offen sc1
s_mov_b64 exec,-1
s_nop 0
CW_NEXT_F:
s_add_u32 s50,s50,1
s_cmp_lt_u32 s50,128
s_cbranch_scc1 CW_LOOP_F
s_branch CW_DONE
ws_172:
buffer_load_dwordx4 v[32:35],v1,s[8:11],s70 offen sc1
buffer_load_dwordx4 v[36:39],v1,s[8:11],s70 offen offset:1024 sc1
buffer_load_dwordx4 v[40:43],v1,s[8:11],s70 offen offset:2048 sc1
buffer_load_dwordx4 v[44:47],v1,s[8:11],s70 offen offset:3072 sc1
buffer_load_dwordx4 v[48:51],v1,s[8:11],s71 offen sc1
s_sub_u32 s47,s47,1
s_cbranch_scc1 ABORT
s_waitcnt vmcnt(4)
v_and_b32 v12,1,v32
v_cmp_ne_u32 vcc,s57,v12
s_nop 0
s_cbranch_vccnz ws_172
s_branch wg_181
ws_173:
buffer_load_dwordx4 v[36:39],v1,s[8:11],s70 offen offset:1024 sc1
buffer_load_dwordx4 v[40:43],v1,s[8:11],s70 offen offset:2048 sc1
buffer_load_dwordx4 v[44:47],v1,s[8:11],s70 offen offset:3072 sc1
buffer_load_dwordx4 v[48:51],v1,s[8:11],s71 offen sc1
buffer_load_dwordx4 v[52:55],v1,s[8:11],s71 offen offset:1024 sc1
s_sub_u32 s47,s47,1
s_cbranch_scc1 ABORT
s_waitcnt vmcnt(4)
v_and_b32 v12,1,v36
v_cmp_ne_u32 vcc,s57,v12
s_nop 0
s_cbranch_vccnz ws_173
s_branch wg_182
ws_174:
buffer_load_dwordx4 v[40:43],v1,s[8:11],s70 offen offset:2048 sc1
buffer_load_dwordx4 v[44:47],v1,s[8:11],s70 offen offset:3072 sc1
buffer_load_dwordx4 v[48:51],v1,s[8:11],s71 offen sc1
buffer_load_dwordx4 v[52:55],v1,s[8:11],s71 offen offset:1024 sc1
buffer_load_dwordx4 v[56:59],v1,s[8:11],s71 offen offset:2048 sc1
s_sub_u32 s47,s47,1
s_cbranch_scc1 ABORT
s_waitcnt vmcnt(4)
v_and_b32 v12,1,v40
v_cmp_ne_u32 vcc,s57,v12
s_nop 0
s_cbranch_vccnz ws_174
s_branch wg_183
ws_175:
buffer_load_dwordx4 v[44:47],v1,s[8:11],s70 offen offset:3072 sc1
buffer_load_dwordx4 v[48:51],v1,s[8:11],s71 offen sc1
buffer_load_dwordx4 v[52:55],v1,s[8:11],s71 offen offset:1024 sc1
buffer_load_dwordx4 v[56:59],v1,s[8:11],s71 offen offset:2048 sc1
buffer_load_dwordx4 v[60:63],v1,s[8:11],s71 offen offset:3072 sc1
s_sub_u32 s47,s47,1
s_cbranch_scc1 ABORT
s_waitcnt vmcnt(4)
v_and_b32 v12,1,v44
v_cmp_ne_u32 vcc,s57,v12
s_nop 0
s_cbranch_vccnz ws_175
s_branch wg_184
ws_176:
buffer_load_dwordx4 v[48:51],v1,s[8:11],s71 offen sc1
buffer_load_dwordx4 v[52:55],v1,s[8:11],s71 offen offset:1024 sc1
buffer_load_dwordx4 v[56:59],v1,s[8:11],s71 offen offset:2048 sc1
buffer_load_dwordx4 v[60:63],v1,s[8:11],s71 offen offset:3072 sc1
buffer_load_dwordx4 v[64:67],v1,s[8:11],s80 offen sc1
s_sub_u32 s47,s47,1
s_cbranch_scc1 ABORT
s_waitcnt vmcnt(4)
v_and_b32 v12,1,v48
v_cmp_ne_u32 vcc,s57,v12
s_nop 0
s_cbranch_vccnz ws_176
s_branch wg_185
ws_177:
buffer_load_dwordx4 v[52:55],v1,s[8:11],s71 offen offset:1024 sc1
buffer_load_dwordx4 v[56:59],v1,s[8:11],s71 offen offset:2048 sc1
buffer_load_dwordx4 v[60:63],v1,s[8:11],s71 offen offset:3072 sc1
buffer_load_dwordx4 v[64:67],v1,s[8:11],s80 offen sc1
buffer_load_dwordx4 v[68:71],v1,s[8:11],s80 offen offset:1024 sc1
s_sub_u32 s47,s47,1
s_cbranch_scc1 ABORT
s_waitcnt vmcnt(4)
v_and_b32 v12,1,v52
v_cmp_ne_u32 vcc,s57,v12
s_nop 0
s_cbranch_vccnz ws_177
s_branch wg_186
ws_178:
buffer_load_dwordx4 v[56:59],v1,s[8:11],s71 offen offset:2048 sc1
buffer_load_dwordx4 v[60:63],v1,s[8:11],s71 offen offset:3072 sc1
buffer_load_dwordx4 v[64:67],v1,s[8:11],s80 offen sc1
buffer_load_dwordx4 v[68:71],v1,s[8:11],s80 offen offset:1024 sc1
buffer_load_dwordx4 v[72:75],v1,s[8:11],s80 offen offset:2048 sc1
s_sub_u32 s47,s47,1
s_cbranch_scc1 ABORT
s_waitcnt vmcnt(3)
v_bitop3_b32 v12,v56,v60,s57 bitop3:0x7e
v_and_b32 v12,1,v12
v_cmp_ne_u32 vcc,0,v12
s_nop 0
s_cbranch_vccnz ws_178
s_branch wg_187
ws_179:
buffer_load_dwordx4 v[64:67],v1,s[8:11],s80 offen sc1
buffer_load_dwordx4 v[68:71],v1,s[8:11],s80 offen offset:1024 sc1
buffer_load_dwordx4 v[72:75],v1,s[8:11],s80 offen offset:2048 sc1
buffer_load_dwordx4 v[76:79],v1,s[8:11],s80 offen offset:3072 sc1
s_sub_u32 s47,s47,1
s_cbranch_scc1 ABORT
s_waitcnt vmcnt(2)
v_bitop3_b32 v12,v64,v68,s57 bitop3:0x7e
v_and_b32 v12,1,v12
v_cmp_ne_u32 vcc,0,v12
s_nop 0
s_cbranch_vccnz ws_179
s_branch wg_188
ws_180:
buffer_load_dwordx4 v[72:75],v1,s[8:11],s80 offen offset:2048 sc1
buffer_load_dwordx4 v[76:79],v1,s[8:11],s80 offen offset:3072 sc1
s_sub_u32 s47,s47,1
s_cbranch_scc1 ABORT
s_waitcnt vmcnt(0)
v_bitop3_b32 v12,v72,v76,s57 bitop3:0x7e
v_and_b32 v12,1,v12
v_cmp_ne_u32 vcc,0,v12
s_nop 0
s_cbranch_vccnz ws_180
s_branch wg_189
CW_LOOP_S:
s_sub_u32 s60,s50,13
s_lshr_b32 s52,s60,1
s_and_b32 s51,s60,1
s_cmp_eq_u32 s51,0
s_cselect_b32 s61,13,0
s_add_u32 s52,s52,s61
s_sub_u32 s61,s60,51
s_cmp_ge_u32 s60,102
s_cselect_b32 s52,s61,s52
s_cselect_b32 s51,1,s51
s_cmp_lt_u32 s50,13
s_cselect_b32 s52,s50,s52
s_cselect_b32 s51,0,s51
s_cmp_eq_u32 s52,63
s_cbranch_scc1 CW_NEXT_S
s_add_u32 s58,s52,1
s_lshl_b32 s61,s51,9
s_add_u32 s72,s61,s35
s_add_u32 s69,s61,s85
s_lshl_b32 s61,s51,2
s_and_b32 s60,s52,1
s_add_u32 s60,s60,s61
s_mul_i32 s70,s60,49152
s_add_u32 s70,s70,s33
s_add_u32 s71,s70,4096
s_add_u32 s80,s70,8192
s_bfe_u32 s57,s52,65537
s_bfe_u32 s31,s58,65537
s_and_b32 s60,s58,1
s_add_u32 s60,s60,s61
s_mul_i32 s59,s60,20480
s_add_u32 s59,s59,s84
s_lshl_b32 s68,s60,16
s_add_u32 s68,s68,s83
s_xor_b32 s77,s77,11264
v_add_u32 v7,s77,v5
v_add_u32 v8,s77,v6
s_add_u32 s60,s52,2
v_mov_b32 v16,s60
v_mov_b32 v80,0
v_mov_b32 v81,0
v_mov_b32 v82,0
v_mov_b32 v83,0
v_mov_b32 v84,0
v_mov_b32 v85,0
v_mov_b32 v86,0
v_mov_b32 v87,0
v_mov_b32 v88,0
v_mov_b32 v89,0
v_mov_b32 v90,0
v_mov_b32 v91,0
v_mov_b32 v92,0
v_mov_b32 v93,0
v_mov_b32 v94,0
v_mov_b32 v95,0
v_mov_b32 v96,0
v_mov_b32 v97,0
v_mov_b32 v98,0
v_mov_b32 v99,0
ds_read_b128 v[100:103],v4 offset:0
ds_read_b128 v[104:107],v4 offset:1024
ds_read_b128 v[108:111],v4 offset:2048
ds_read_b128 v[112:115],v4 offset:3072
s_cmp_lg_u32 s46,0
s_cbranch_scc1 np_190
db_191:
buffer_load_dword v12,v3,s[8:11],s72 offen sc1
s_waitcnt vmcnt(0)
v_cmp_gt_u32 vcc,s58,v12
s_cbranch_vccz dbok_192
s_sub_u32 s47,s47,1
s_cbranch_scc1 ABORT
s_branch db_191
dbok_192:
np_190:
s_barrier
buffer_load_dwordx4 v[32:35],v1,s[8:11],s70 offen sc1
s_nop 7
buffer_load_dwordx4 v[36:39],v1,s[8:11],s70 offen offset:1024 sc1
s_nop 7
buffer_load_dwordx4 v[40:43],v1,s[8:11],s70 offen offset:2048 sc1
s_nop 7
buffer_load_dwordx4 v[44:47],v1,s[8:11],s70 offen offset:3072 sc1
s_nop 7
buffer_load_dwordx4 v[48:51],v1,s[8:11],s71 offen sc1
s_waitcnt vmcnt(4)
v_and_b32 v12,1,v32
v_cmp_ne_u32 vcc,s57,v12
s_cbranch_vccnz ws_193
wg_202:
v_smfmac_f32_16x16x64_bf16 v[80:83],v[32:35],a[0:7],v2
buffer_load_dwordx4 v[52:55],v1,s[8:11],s71 offen offset:1024 sc1
v_smfmac_f32_16x16x64_bf16 v[84:87],v[32:35],a[8:15],v2
s_waitcnt vmcnt(4)
v_and_b32 v12,1,v36
v_smfmac_f32_16x16x64_bf16 v[88:91],v[32:35],a[16:23],v2
v_cmp_ne_u32 vcc,s57,v12
v_smfmac_f32_16x16x64_bf16 v[92:95],v[32:35],a[24:31],v2
s_waitcnt lgkmcnt(2)
v_smfmac_f32_16x16x64_bf16 v[96:99],v[32:35],v[100:107],v2
s_cbranch_vccnz ws_194
wg_203:
v_smfmac_f32_16x16x64_bf16 v[80:83],v[36:39],a[32:39],v2
buffer_load_dwordx4 v[56:59],v1,s[8:11],s71 offen offset:2048 sc1
v_smfmac_f32_16x16x64_bf16 v[84:87],v[36:39],a[40:47],v2
s_waitcnt vmcnt(4)
v_and_b32 v12,1,v40
v_smfmac_f32_16x16x64_bf16 v[88:91],v[36:39],a[48:55],v2
v_cmp_ne_u32 vcc,s57,v12
ds_read_b128 v[100:103],v4 offset:4096
v_smfmac_f32_16x16x64_bf16 v[92:95],v[36:39],a[56:63],v2
ds_read_b128 v[104:107],v4 offset:5120
s_waitcnt lgkmcnt(2)
v_smfmac_f32_16x16x64_bf16 v[96:99],v[36:39],v[108:115],v2
s_cbranch_vccnz ws_195
wg_204:
v_smfmac_f32_16x16x64_bf16 v[80:83],v[40:43],a[64:71],v2
buffer_load_dwordx4 v[60:63],v1,s[8:11],s71 offen offset:3072 sc1
v_smfmac_f32_16x16x64_bf16 v[84:87],v[40:43],a[72:79],v2
s_waitcnt vmcnt(4)
v_and_b32 v12,1,v44
v_smfmac_f32_16x16x64_bf16 v[88:91],v[40:43],a[80:87],v2
v_cmp_ne_u32 vcc,s57,v12
ds_read_b128 v[108:111],v4 offset:6144
v_smfmac_f32_16x16x64_bf16 v[92:95],v[40:43],a[88:95],v2
ds_read_b128 v[112:115],v4 offset:7168
s_waitcnt lgkmcnt(2)
v_smfmac_f32_16x16x64_bf16 v[96:99],v[40:43],v[100:107],v2
s_cbranch_vccnz ws_196
wg_205:
v_smfmac_f32_16x16x64_bf16 v[80:83],v[44:47],a[96:103],v2
buffer_load_dwordx4 v[64:67],v1,s[8:11],s80 offen sc1
v_smfmac_f32_16x16x64_bf16 v[84:87],v[44:47],a[104:111],v2
s_waitcnt vmcnt(4)
v_and_b32 v12,1,v48
v_smfmac_f32_16x16x64_bf16 v[88:91],v[44:47],a[112:119],v2
v_cmp_ne_u32 vcc,s57,v12
ds_read_b128 v[100:103],v4 offset:8192
v_smfmac_f32_16x16x64_bf16 v[92:95],v[44:47],a[120:127],v2
ds_read_b128 v[104:107],v4 offset:9216
s_waitcnt lgkmcnt(2)
v_smfmac_f32_16x16x64_bf16 v[96:99],v[44:47],v[108:115],v2
s_cbranch_vccnz ws_197
wg_206:
v_smfmac_f32_16x16x64_bf16 v[80:83],v[48:51],a[128:135],v2
buffer_load_dwordx4 v[68:71],v1,s[8:11],s80 offen offset:1024 sc1
v_smfmac_f32_16x16x64_bf16 v[84:87],v[48:51],a[136:143],v2
s_waitcnt vmcnt(4)
v_and_b32 v12,1,v52
v_smfmac_f32_16x16x64_bf16 v[88:91],v[48:51],a[144:151],v2
v_cmp_ne_u32 vcc,s57,v12
ds_read_b128 v[108:111],v4 offset:10240
v_smfmac_f32_16x16x64_bf16 v[92:95],v[48:51],a[152:159],v2
ds_read_b128 v[112:115],v4 offset:11264
s_waitcnt lgkmcnt(2)
v_smfmac_f32_16x16x64_bf16 v[96:99],v[48:51],v[100:107],v2
s_cbranch_vccnz ws_198
wg_207:
v_smfmac_f32_16x16x64_bf16 v[80:83],v[52:55],a[160:167],v2
s_waitcnt vmcnt(2)
v_bitop3_b32 v12,v56,v60,s57 bitop3:0x7e
v_smfmac_f32_16x16x64_bf16 v[84:87],v[52:55],a[168:175],v2
v_and_b32 v12,1,v12
buffer_load_dwordx4 v[72:75],v1,s[8:11],s80 offen offset:2048 sc1
v_smfmac_f32_16x16x64_bf16 v[88:91],v[52:55],a[176:183],v2
v_cmp_ne_u32 vcc,0,v12
ds_read_b128 v[100:103],v4 offset:12288
v_smfmac_f32_16x16x64_bf16 v[92:95],v[52:55],a[184:191],v2
ds_read_b128 v[104:107],v4 offset:13312
s_waitcnt lgkmcnt(2)
v_smfmac_f32_16x16x64_bf16 v[96:99],v[52:55],v[108:115],v2
s_cbranch_vccnz ws_199
wg_208:
v_smfmac_f32_16x16x64_bf16 v[80:83],v[56:59],a[192:199],v2
buffer_load_dwordx4 v[76:79],v1,s[8:11],s80 offen offset:3072 sc1
v_smfmac_f32_16x16x64_bf16 v[84:87],v[56:59],a[200:207],v2
ds_read_b128 v[108:111],v4 offset:14336
v_smfmac_f32_16x16x64_bf16 v[88:91],v[56:59],a[208:215],v2
ds_read_b128 v[112:115],v4 offset:15360
v_smfmac_f32_16x16x64_bf16 v[92:95],v[56:59],a[216:223],v2
s_waitcnt lgkmcnt(2)
v_smfmac_f32_16x16x64_bf16 v[96:99],v[56:59],v[100:107],v2
ds_read_b128 v[100:103],v4 offset:16384
v_smfmac_f32_16x16x64_bf16 v[80:83],v[60:63],a[224:231],v2
s_waitcnt vmcnt(2)
v_bitop3_b32 v12,v64,v68,s57 bitop3:0x7e
v_smfmac_f32_16x16x64_bf16 v[84:87],v[60:63],a[232:239],v2
v_and_b32 v12,1,v12
ds_read_b128 v[104:107],v4 offset:17408
v_smfmac_f32_16x16x64_bf16 v[88:91],v[60:63],a[240:247],v2
v_cmp_ne_u32 vcc,0,v12
v_smfmac_f32_16x16x64_bf16 v[92:95],v[60:63],a[248:255],v2
s_waitcnt lgkmcnt(2)
v_smfmac_f32_16x16x64_bf16 v[96:99],v[60:63],v[108:115],v2
s_cbranch_vccnz ws_200
wg_209:
v_smfmac_f32_16x16x64_bf16 v[80:83],v[64:67],v[128:135],v2
ds_read_b128 v[108:111],v4 offset:18432
v_smfmac_f32_16x16x64_bf16 v[84:87],v[64:67],v[136:143],v2
ds_read_b128 v[112:115],v4 offset:19456
v_smfmac_f32_16x16x64_bf16 v[88:91],v[64:67],v[144:151],v2
v_smfmac_f32_16x16x64_bf16 v[92:95],v[64:67],v[152:159],v2
s_waitcnt lgkmcnt(2)
v_smfmac_f32_16x16x64_bf16 v[96:99],v[64:67],v[100:107],v2
ds_read_b128 v[100:103],v4 offset:20480
v_smfmac_f32_16x16x64_bf16 v[80:83],v[68:71],v[160:167],v2
s_waitcnt vmcnt(0)
v_bitop3_b32 v12,v72,v76,s57 bitop3:0x7e
v_smfmac_f32_16x16x64_bf16 v[84:87],v[68:71],v[168:175],v2
v_and_b32 v12,1,v12
ds_read_b128 v[104:107],v4 offset:21504
v_smfmac_f32_16x16x64_bf16 v[88:91],v[68:71],v[176:183],v2
v_cmp_ne_u32 vcc,0,v12
v_smfmac_f32_16x16x64_bf16 v[92:95],v[68:71],v[184:191],v2
s_waitcnt lgkmcnt(2)
v_smfmac_f32_16x16x64_bf16 v[96:99],v[68:71],v[108:115],v2
s_cbranch_vccnz ws_201
wg_210:
v_smfmac_f32_16x16x64_bf16 v[80:83],v[72:75],v[192:199],v2
ds_read_b128 v[108:111],v4 offset:22528
v_smfmac_f32_16x16x64_bf16 v[80:83],v[76:79],v[224:231],v2
ds_read_b128 v[112:115],v4 offset:23552
v_smfmac_f32_16x16x64_bf16 v[84:87],v[72:75],v[200:207],v2
v_smfmac_f32_16x16x64_bf16 v[84:87],v[76:79],v[232:239],v2
v_smfmac_f32_16x16x64_bf16 v[88:91],v[72:75],v[208:215],v2
v_add_f32 v80,v80,v81
v_smfmac_f32_16x16x64_bf16 v[88:91],v[76:79],v[240:247],v2
v_add_f32 v82,v82,v83
ds_write2_b32 v7,v80,v82 offset0:0 offset1:88
v_smfmac_f32_16x16x64_bf16 v[92:95],v[72:75],v[216:223],v2
v_add_f32 v84,v84,v85
v_smfmac_f32_16x16x64_bf16 v[92:95],v[76:79],v[248:255],v2
v_add_f32 v86,v86,v87
s_waitcnt lgkmcnt(3)
v_smfmac_f32_16x16x64_bf16 v[96:99],v[72:75],v[100:107],v2
ds_write2_b32 v7,v84,v86 offset0:16 offset1:104
s_waitcnt lgkmcnt(2)
v_smfmac_f32_16x16x64_bf16 v[96:99],v[76:79],v[108:115],v2
v_add_f32 v88,v88,v89
v_add_f32 v90,v90,v91
ds_write2_b32 v7,v88,v90 offset0:32 offset1:120
v_add_f32 v92,v92,v93
v_add_f32 v94,v94,v95
ds_write2_b32 v7,v92,v94 offset0:48 offset1:136
s_nop 1
v_add_f32 v96,v96,v97
v_add_f32 v98,v98,v99
ds_write2_b32 v7,v96,v98 offset0:64 offset1:152
s_waitcnt lgkmcnt(0)
s_barrier
ds_read_b128 v[32:35],v8 offset:0
ds_read_b128 v[36:39],v8 offset:2816
ds_read_b128 v[40:43],v8 offset:5632
ds_read_b128 v[44:47],v8 offset:8448
s_mov_b64 exec,1
buffer_store_dword v16,v1,s[8:11],s69 offen sc1
s_mov_b64 exec,-1
s_waitcnt lgkmcnt(2)
v_pk_add_f32 v[32:33],v[32:33],v[36:37]
v_pk_add_f32 v[34:35],v[34:35],v[38:39]
s_waitcnt lgkmcnt(0)
v_pk_add_f32 v[40:41],v[40:41],v[44:45]
v_pk_add_f32 v[42:43],v[42:43],v[46:47]
v_pk_add_f32 v[32:33],v[32:33],v[40:41]
v_pk_add_f32 v[34:35],v[34:35],v[42:43]
v_cvt_pk_bf16_f32 v32,v32,v33
v_cvt_pk_bf16_f32 v33,v34,v35
v_bfi_b32 v32,v10,s31,v32
s_nop 0
v_permlane32_swap_b32 v33,v35
v_permlane32_swap_b32 v32,v34
s_mov_b64 exec,s[88:89]
buffer_store_dwordx4 v[32:35],v9,s[8:11],s59 offen sc1
s_barrier
buffer_store_dwordx4 v[32:35],v9,s[8:11],s68 offen sc1
s_mov_b64 exec,-1
s_nop 0
CW_NEXT_S:
s_add_u32 s50,s50,1
s_cmp_lt_u32 s50,128
s_cbranch_scc1 CW_LOOP_S
s_branch CW_DONE
ws_193:
buffer_load_dwordx4 v[32:35],v1,s[8:11],s70 offen sc1
buffer_load_dwordx4 v[36:39],v1,s[8:11],s70 offen offset:1024 sc1
buffer_load_dwordx4 v[40:43],v1,s[8:11],s70 offen offset:2048 sc1
buffer_load_dwordx4 v[44:47],v1,s[8:11],s70 offen offset:3072 sc1
buffer_load_dwordx4 v[48:51],v1,s[8:11],s71 offen sc1
s_sub_u32 s47,s47,1
s_cbranch_scc1 ABORT
s_waitcnt vmcnt(4)
v_and_b32 v12,1,v32
v_cmp_ne_u32 vcc,s57,v12
s_nop 0
s_cbranch_vccnz ws_193
s_branch wg_202
ws_194:
buffer_load_dwordx4 v[36:39],v1,s[8:11],s70 offen offset:1024 sc1
buffer_load_dwordx4 v[40:43],v1,s[8:11],s70 offen offset:2048 sc1
buffer_load_dwordx4 v[44:47],v1,s[8:11],s70 offen offset:3072 sc1
buffer_load_dwordx4 v[48:51],v1,s[8:11],s71 offen sc1
buffer_load_dwordx4 v[52:55],v1,s[8:11],s71 offen offset:1024 sc1
s_sub_u32 s47,s47,1
s_cbranch_scc1 ABORT
s_waitcnt vmcnt(4)
v_and_b32 v12,1,v36
v_cmp_ne_u32 vcc,s57,v12
s_nop 0
s_cbranch_vccnz ws_194
s_branch wg_203
ws_195:
buffer_load_dwordx4 v[40:43],v1,s[8:11],s70 offen offset:2048 sc1
buffer_load_dwordx4 v[44:47],v1,s[8:11],s70 offen offset:3072 sc1
buffer_load_dwordx4 v[48:51],v1,s[8:11],s71 offen sc1
buffer_load_dwordx4 v[52:55],v1,s[8:11],s71 offen offset:1024 sc1
buffer_load_dwordx4 v[56:59],v1,s[8:11],s71 offen offset:2048 sc1
s_sub_u32 s47,s47,1
s_cbranch_scc1 ABORT
s_waitcnt vmcnt(4)
v_and_b32 v12,1,v40
v_cmp_ne_u32 vcc,s57,v12
s_nop 0
s_cbranch_vccnz ws_195
s_branch wg_204
ws_196:
buffer_load_dwordx4 v[44:47],v1,s[8:11],s70 offen offset:3072 sc1
buffer_load_dwordx4 v[48:51],v1,s[8:11],s71 offen sc1
buffer_load_dwordx4 v[52:55],v1,s[8:11],s71 offen offset:1024 sc1
buffer_load_dwordx4 v[56:59],v1,s[8:11],s71 offen offset:2048 sc1
buffer_load_dwordx4 v[60:63],v1,s[8:11],s71 offen offset:3072 sc1
s_sub_u32 s47,s47,1
s_cbranch_scc1 ABORT
s_waitcnt vmcnt(4)
v_and_b32 v12,1,v44
v_cmp_ne_u32 vcc,s57,v12
s_nop 0
s_cbranch_vccnz ws_196
s_branch wg_205
ws_197:
buffer_load_dwordx4 v[48:51],v1,s[8:11],s71 offen sc1
buffer_load_dwordx4 v[52:55],v1,s[8:11],s71 offen offset:1024 sc1
buffer_load_dwordx4 v[56:59],v1,s[8:11],s71 offen offset:2048 sc1
buffer_load_dwordx4 v[60:63],v1,s[8:11],s71 offen offset:3072 sc1
buffer_load_dwordx4 v[64:67],v1,s[8:11],s80 offen sc1
s_sub_u32 s47,s47,1
s_cbranch_scc1 ABORT
s_waitcnt vmcnt(4)
v_and_b32 v12,1,v48
v_cmp_ne_u32 vcc,s57,v12
s_nop 0
s_cbranch_vccnz ws_197
s_branch wg_206
ws_198:
buffer_load_dwordx4 v[52:55],v1,s[8:11],s71 offen offset:1024 sc1
buffer_load_dwordx4 v[56:59],v1,s[8:11],s71 offen offset:2048 sc1
buffer_load_dwordx4 v[60:63],v1,s[8:11],s71 offen offset:3072 sc1
buffer_load_dwordx4 v[64:67],v1,s[8:11],s80 offen sc1
buffer_load_dwordx4 v[68:71],v1,s[8:11],s80 offen offset:1024 sc1
s_sub_u32 s47,s47,1
s_cbranch_scc1 ABORT
s_waitcnt vmcnt(4)
v_and_b32 v12,1,v52
v_cmp_ne_u32 vcc,s57,v12
s_nop 0
s_cbranch_vccnz ws_198
s_branch wg_207
ws_199:
buffer_load_dwordx4 v[56:59],v1,s[8:11],s71 offen offset:2048 sc1
buffer_load_dwordx4 v[60:63],v1,s[8:11],s71 offen offset:3072 sc1
buffer_load_dwordx4 v[64:67],v1,s[8:11],s80 offen sc1
buffer_load_dwordx4 v[68:71],v1,s[8:11],s80 offen offset:1024 sc1
buffer_load_dwordx4 v[72:75],v1,s[8:11],s80 offen offset:2048 sc1
s_sub_u32 s47,s47,1
s_cbranch_scc1 ABORT
s_waitcnt vmcnt(3)
v_bitop3_b32 v12,v56,v60,s57 bitop3:0x7e
v_and_b32 v12,1,v12
v_cmp_ne_u32 vcc,0,v12
s_nop 0
s_cbranch_vccnz ws_199
s_branch wg_208
ws_200:
buffer_load_dwordx4 v[64:67],v1,s[8:11],s80 offen sc1
buffer_load_dwordx4 v[68:71],v1,s[8:11],s80 offen offset:1024 sc1
buffer_load_dwordx4 v[72:75],v1,s[8:11],s80 offen offset:2048 sc1
buffer_load_dwordx4 v[76:79],v1,s[8:11],s80 offen offset:3072 sc1
s_sub_u32 s47,s47,1
s_cbranch_scc1 ABORT
s_waitcnt vmcnt(2)
v_bitop3_b32 v12,v64,v68,s57 bitop3:0x7e
v_and_b32 v12,1,v12
v_cmp_ne_u32 vcc,0,v12
s_nop 0
s_cbranch_vccnz ws_200
s_branch wg_209
ws_201:
buffer_load_dwordx4 v[72:75],v1,s[8:11],s80 offen offset:2048 sc1
buffer_load_dwordx4 v[76:79],v1,s[8:11],s80 offen offset:3072 sc1
s_sub_u32 s47,s47,1
s_cbranch_scc1 ABORT
s_waitcnt vmcnt(0)
v_bitop3_b32 v12,v72,v76,s57 bitop3:0x7e
v_and_b32 v12,1,v12
v_cmp_ne_u32 vcc,0,v12
s_nop 0
s_cbranch_vccnz ws_201
s_branch wg_210
CW_DONE:
s_add_u32 s61,s48,48
s_endpgm
DISPATCH:
s_sub_u32 s48,s3,0
s_cmp_lt_u32 s3,16
s_cbranch_scc1 ROLE_CS
s_sub_u32 s48,s3,16
s_cmp_lt_u32 s3,24
s_cbranch_scc1 ROLE_CV
s_sub_u32 s48,s3,24
s_cmp_lt_u32 s3,32
s_cbranch_scc1 ROLE_CW
s_sub_u32 s48,s3,16
s_cmp_lt_u32 s3,48
s_cbranch_scc1 ROLE_CS
s_sub_u32 s48,s3,40
s_cmp_lt_u32 s3,56
s_cbranch_scc1 ROLE_CV
s_sub_u32 s48,s3,48
s_cmp_lt_u32 s3,64
s_cbranch_scc1 ROLE_CW
s_sub_u32 s48,s3,64
s_cmp_lt_u32 s3,74
s_cbranch_scc1 ROLE_W4
s_sub_u32 s48,s3,74
s_cmp_lt_u32 s3,79
s_cbranch_scc1 ROLE_W1
s_sub_u32 s48,s3,79
s_cmp_lt_u32 s3,91
s_cbranch_scc1 ROLE_W3
s_sub_u32 s48,s3,91
s_cmp_lt_u32 s3,96
s_cbranch_scc1 ROLE_W2
s_sub_u32 s48,s3,96
s_cmp_lt_u32 s3,104
s_cbranch_scc1 ROLE_QKVQ
s_sub_u32 s48,s3,104
s_cmp_lt_u32 s3,112
s_cbranch_scc1 ROLE_QKVV
s_sub_u32 s48,s3,112
s_cmp_lt_u32 s3,128
s_cbranch_scc1 ROLE_R1
s_sub_u32 s48,s3,128
s_cmp_lt_u32 s3,138
s_cbranch_scc1 ROLE_WO
s_sub_u32 s48,s3,138
s_cmp_lt_u32 s3,146
s_cbranch_scc1 ROLE_ATT
s_sub_u32 s48,s3,138
s_cmp_lt_u32 s3,156
s_cbranch_scc1 ROLE_QKVQ
s_sub_u32 s48,s3,148
s_cmp_lt_u32 s3,160
s_cbranch_scc1 ROLE_QKVV
s_sub_u32 s48,s3,150
s_cmp_lt_u32 s3,170
s_cbranch_scc1 ROLE_WO
s_sub_u32 s48,s3,162
s_cmp_lt_u32 s3,178
s_cbranch_scc1 ROLE_ATT
s_sub_u32 s48,s3,160
s_cmp_lt_u32 s3,188
s_cbranch_scc1 ROLE_QKVQ
s_sub_u32 s48,s3,176
s_cmp_lt_u32 s3,192
s_cbranch_scc1 ROLE_QKVV
s_sub_u32 s48,s3,172
s_cmp_lt_u32 s3,202
s_cbranch_scc1 ROLE_WO
s_sub_u32 s48,s3,186
s_cmp_lt_u32 s3,210
s_cbranch_scc1 ROLE_ATT
s_sub_u32 s48,s3,182
s_cmp_lt_u32 s3,220
s_cbranch_scc1 ROLE_QKVQ
s_sub_u32 s48,s3,204
s_cmp_lt_u32 s3,224
s_cbranch_scc1 ROLE_QKVV
s_sub_u32 s48,s3,194
s_cmp_lt_u32 s3,234
s_cbranch_scc1 ROLE_WO
s_sub_u32 s48,s3,210
s_cmp_lt_u32 s3,242
s_cbranch_scc1 ROLE_ATT
s_sub_u32 s48,s3,204
s_cmp_lt_u32 s3,252
s_cbranch_scc1 ROLE_QKVQ
s_sub_u32 s48,s3,232
s_cmp_lt_u32 s3,256
s_cbranch_scc1 ROLE_QKVV
s_branch ROLE_SPARE
EXIT:
s_endpgm
ABORT:
s_mov_b64 exec,1
v_mov_b32 v1,s2
v_add_u32 v1,0x10000,v1
v_mov_b32 v2,8
buffer_store_dword v1,v2,s[12:15],0 offen
s_endpgm
ROLE_SPARE:
s_waitcnt vmcnt(0)
s_barrier
s_cmp_lg_u32 s46,0
s_cbranch_scc1 arr_211
v_mov_b32 v12,1
s_lshl_b32 s3,s49,2
v_mov_b32 v13,s3
s_mov_b64 exec,1
buffer_atomic_add v12,v13,s[12:15],0 offen sc1
s_mov_b64 exec,-1
arr_211:
s_lshl_b32 s3,s49,2
v_mov_b32 v13,s3
s_nop 1
ibw_212:
buffer_load_dword v12,v13,s[12:15],0 offen sc1
s_waitcnt vmcnt(0)
v_cmp_ne_u32 vcc,256,v12
s_nop 0
s_cbranch_vccz ok_213
s_sleep 8
s_sub_u32 s47,s47,1
s_cbranch_scc1 ABORT
s_branch ibw_212
ok_213:
s_cmp_lg_u32 s49,0
s_cbranch_scc1 ibok_214
v_and_b32 v13,7,v0
v_lshlrev_b32 v13,2,v13
buffer_load_dword v12,v13,s[12:15],0 offen offset:32 sc1
s_waitcnt vmcnt(0)
v_cmp_ne_u32 vcc,32,v12
s_nop 0
s_cbranch_vccz ibok_214
s_barrier
s_mov_b32 s49,1
s_mov_b32 s3,s2
s_load_dwordx16 s[16:31],s[0:1],0
s_load_dwordx8 s[32:39],s[0:1],64
s_waitcnt lgkmcnt(0)
s_branch DISPATCH
ibok_214:
s_endpgm
ROLE_QKVQ:
v_lshlrev_b32 v1,4,v0
v_mov_b32 v5,1
s_lshl_b32 s56,s48,2
s_add_u32 s56,s56,s46
v_bfe_u32 v6,v0,2,2
v_lshrrev_b32 v7,4,v0
v_add_u32 v7,v6,v7
v_and_b32 v7,3,v7
v_and_b32 v15,3,v0
v_lshlrev_b32 v15,4,v15
v_lshl_add_u32 v15,v7,6,v15
v_lshl_add_u32 v15,v6,8,v15
v_lshrrev_b32 v6,5,v0
v_bfe_u32 v7,v0,4,1
v_lshlrev_b32 v16,10,v7
v_bfe_u32 v7,v0,2,2
v_lshl_add_u32 v16,v7,8,v16
v_add_u32 v6,v6,v7
v_and_b32 v6,3,v6
v_lshl_add_u32 v16,v6,6,v16
v_and_b32 v6,3,v0
v_lshl_add_u32 v16,v6,4,v16
v_add_u32 v18,46080,v16
v_lshrrev_b32 v6,5,v0
v_bfe_u32 v7,v0,4,1
v_lshlrev_b32 v20,10,v7
v_lshl_add_u32 v20,v6,8,v20
v_and_b32 v6,15,v0
v_lshl_add_u32 v20,v6,4,v20
v_lshrrev_b32 v6,5,v0
v_add_u32 v6,2,v6
v_bfe_u32 v7,v0,4,1
v_lshlrev_b32 v17,10,v7
v_bfe_u32 v7,v0,2,2
v_lshl_add_u32 v17,v7,8,v17
v_add_u32 v6,v6,v7
v_and_b32 v6,3,v6
v_lshl_add_u32 v17,v6,6,v17
v_and_b32 v6,3,v0
v_lshl_add_u32 v17,v6,4,v17
v_add_u32 v19,46080,v17
v_lshrrev_b32 v6,5,v0
v_add_u32 v6,2,v6
v_bfe_u32 v7,v0,4,1
v_lshlrev_b32 v21,10,v7
v_lshl_add_u32 v21,v6,8,v21
v_and_b32 v6,15,v0
v_lshl_add_u32 v21,v6,4,v21
s_cmp_ge_u32 s48,24
s_cselect_b32 s68,1,0
s_mul_i32 s60,s68,96
s_sub_u32 s69,s56,s60
s_mul_i32 s70,s68,50331648
s_add_u32 s70,s70,74448896
s_mul_i32 s60,s68,65536
s_sub_u32 s71,131072,s60
s_lshl_b32 s60,s69,12
s_add_u32 s70,s70,s60
v_lshrrev_b32 v6,5,v0
v_mul_u32_u24 v188,2560,v6
v_and_b32 v6,31,v0
v_lshl_add_u32 v188,v6,3,v188
v_add_u32 v188,0xa000,v188
v_min_u32 v4,7,v0
v_lshlrev_b32 v4,2,v4
v_min_u32 v2,39,v0
v_lshlrev_b32 v2,2,v2
v_mov_b32 v12,93184
s_waitcnt vmcnt(0)
s_barrier
s_cmp_lg_u32 s46,0
s_cbranch_scc1 arr_215
v_mov_b32 v6,1
s_lshl_b32 s3,s49,2
v_mov_b32 v7,s3
s_mov_b64 exec,1
buffer_atomic_add v6,v7,s[12:15],0 offen sc1
s_mov_b64 exec,-1
arr_215:
s_lshl_b32 s58,s69,7
s_mul_i32 s63,s46,40960
s_cmp_eq_u32 s68,0
s_cselect_b32 s4,s22,s20
s_cselect_b32 s5,s23,s21
s_mov_b32 s6,7864320
s_mov_b32 s7,0x20000
v_lshrrev_b32 v9,3,v0
s_mov_b32 s64,12288
v_mul_lo_u32 v9,v9,s64
v_and_b32 v10,7,v0
v_lshl_add_u32 v6,v10,4,v9
s_add_u32 m0,s63,0
s_add_u32 s65,s58,0
buffer_load_dwordx4 v6,s[4:7],s65 offen lds
s_add_u32 m0,s63,1024
s_add_u32 s65,s58,98304
buffer_load_dwordx4 v6,s[4:7],s65 offen lds
s_add_u32 m0,s63,2048
s_add_u32 s65,s58,196608
buffer_load_dwordx4 v6,s[4:7],s65 offen lds
s_add_u32 m0,s63,3072
s_add_u32 s65,s58,294912
buffer_load_dwordx4 v6,s[4:7],s65 offen lds
s_add_u32 m0,s63,4096
s_add_u32 s65,s58,393216
buffer_load_dwordx4 v6,s[4:7],s65 offen lds
s_add_u32 m0,s63,5120
s_add_u32 s65,s58,491520
buffer_load_dwordx4 v6,s[4:7],s65 offen lds
s_add_u32 m0,s63,6144
s_add_u32 s65,s58,589824
buffer_load_dwordx4 v6,s[4:7],s65 offen lds
s_add_u32 m0,s63,7168
s_add_u32 s65,s58,688128
buffer_load_dwordx4 v6,s[4:7],s65 offen lds
s_add_u32 m0,s63,8192
s_add_u32 s65,s58,786432
buffer_load_dwordx4 v6,s[4:7],s65 offen lds
s_add_u32 m0,s63,9216
s_add_u32 s65,s58,884736
buffer_load_dwordx4 v6,s[4:7],s65 offen lds
s_add_u32 m0,s63,10240
s_add_u32 s65,s58,983040
buffer_load_dwordx4 v6,s[4:7],s65 offen lds
s_add_u32 m0,s63,11264
s_add_u32 s65,s58,1081344
buffer_load_dwordx4 v6,s[4:7],s65 offen lds
s_add_u32 m0,s63,12288
s_add_u32 s65,s58,1179648
buffer_load_dwordx4 v6,s[4:7],s65 offen lds
s_add_u32 m0,s63,13312
s_add_u32 s65,s58,1277952
buffer_load_dwordx4 v6,s[4:7],s65 offen lds
s_add_u32 m0,s63,14336
s_add_u32 s65,s58,1376256
buffer_load_dwordx4 v6,s[4:7],s65 offen lds
s_add_u32 m0,s63,15360
s_add_u32 s65,s58,1474560
buffer_load_dwordx4 v6,s[4:7],s65 offen lds
s_add_u32 m0,s63,16384
s_add_u32 s65,s58,1572864
buffer_load_dwordx4 v6,s[4:7],s65 offen lds
s_add_u32 m0,s63,17408
s_add_u32 s65,s58,1671168
buffer_load_dwordx4 v6,s[4:7],s65 offen lds
s_add_u32 m0,s63,18432
s_add_u32 s65,s58,1769472
buffer_load_dwordx4 v6,s[4:7],s65 offen lds
s_add_u32 m0,s63,19456
s_add_u32 s65,s58,1867776
buffer_load_dwordx4 v6,s[4:7],s65 offen lds
s_add_u32 m0,s63,20480
s_add_u32 s65,s58,1966080
buffer_load_dwordx4 v6,s[4:7],s65 offen lds
s_add_u32 m0,s63,21504
s_add_u32 s65,s58,2064384
buffer_load_dwordx4 v6,s[4:7],s65 offen lds
s_add_u32 m0,s63,22528
s_add_u32 s65,s58,2162688
buffer_load_dwordx4 v6,s[4:7],s65 offen lds
s_add_u32 m0,s63,23552
s_add_u32 s65,s58,2260992
buffer_load_dwordx4 v6,s[4:7],s65 offen lds
s_add_u32 m0,s63,24576
s_add_u32 s65,s58,2359296
buffer_load_dwordx4 v6,s[4:7],s65 offen lds
s_add_u32 m0,s63,25600
s_add_u32 s65,s58,2457600
buffer_load_dwordx4 v6,s[4:7],s65 offen lds
s_add_u32 m0,s63,26624
s_add_u32 s65,s58,2555904
buffer_load_dwordx4 v6,s[4:7],s65 offen lds
s_add_u32 m0,s63,27648
s_add_u32 s65,s58,2654208
buffer_load_dwordx4 v6,s[4:7],s65 offen lds
s_add_u32 m0,s63,28672
s_add_u32 s65,s58,2752512
buffer_load_dwordx4 v6,s[4:7],s65 offen lds
s_add_u32 m0,s63,29696
s_add_u32 s65,s58,2850816
buffer_load_dwordx4 v6,s[4:7],s65 offen lds
s_add_u32 m0,s63,30720
s_add_u32 s65,s58,2949120
buffer_load_dwordx4 v6,s[4:7],s65 offen lds
s_add_u32 m0,s63,31744
s_add_u32 s65,s58,3047424
buffer_load_dwordx4 v6,s[4:7],s65 offen lds
s_add_u32 m0,s63,32768
s_add_u32 s65,s58,3145728
buffer_load_dwordx4 v6,s[4:7],s65 offen lds
s_add_u32 m0,s63,33792
s_add_u32 s65,s58,3244032
buffer_load_dwordx4 v6,s[4:7],s65 offen lds
s_add_u32 m0,s63,34816
s_add_u32 s65,s58,3342336
buffer_load_dwordx4 v6,s[4:7],s65 offen lds
s_add_u32 m0,s63,35840
s_add_u32 s65,s58,3440640
buffer_load_dwordx4 v6,s[4:7],s65 offen lds
s_add_u32 m0,s63,36864
s_add_u32 s65,s58,3538944
buffer_load_dwordx4 v6,s[4:7],s65 offen lds
s_add_u32 m0,s63,37888
s_add_u32 s65,s58,3637248
buffer_load_dwordx4 v6,s[4:7],s65 offen lds
s_add_u32 m0,s63,38912
s_add_u32 s65,s58,3735552
buffer_load_dwordx4 v6,s[4:7],s65 offen lds
s_add_u32 m0,s63,39936
s_add_u32 s65,s58,3833856
buffer_load_dwordx4 v6,s[4:7],s65 offen lds
s_waitcnt vmcnt(20)
v_bfe_u32 v9,v0,2,2
v_lshrrev_b32 v10,5,v0
v_lshl_add_u32 v9,v10,2,v9
v_mul_u32_u24 v9,128,v9
v_and_b32 v10,1,v0
v_lshl_add_u32 v9,v10,3,v9
v_bfe_u32 v10,v0,1,1
v_lshl_add_u32 v9,v10,5,v9
v_bfe_u32 v10,v0,4,1
v_lshl_add_u32 v9,v10,4,v9
v_add_u32 v7,s63,v9
ds_read_b64_tr_b16 a[0:1],v7 offset:0
ds_read_b64_tr_b16 a[2:3],v7 offset:2048
ds_read_b64_tr_b16 a[4:5],v7 offset:1024
ds_read_b64_tr_b16 a[6:7],v7 offset:3072
ds_read_b64_tr_b16 a[160:161],v7 offset:64
ds_read_b64_tr_b16 a[162:163],v7 offset:2112
ds_read_b64_tr_b16 a[164:165],v7 offset:1088
ds_read_b64_tr_b16 a[166:167],v7 offset:3136
ds_read_b64_tr_b16 a[8:9],v7 offset:4096
ds_read_b64_tr_b16 a[10:11],v7 offset:6144
ds_read_b64_tr_b16 a[12:13],v7 offset:5120
ds_read_b64_tr_b16 a[14:15],v7 offset:7168
s_waitcnt lgkmcnt(4)
ds_read_b64_tr_b16 a[168:169],v7 offset:4160
ds_read_b64_tr_b16 a[170:171],v7 offset:6208
ds_read_b64_tr_b16 a[172:173],v7 offset:5184
ds_read_b64_tr_b16 a[174:175],v7 offset:7232
ds_read_b64_tr_b16 a[16:17],v7 offset:8192
ds_read_b64_tr_b16 a[18:19],v7 offset:10240
ds_read_b64_tr_b16 a[20:21],v7 offset:9216
ds_read_b64_tr_b16 a[22:23],v7 offset:11264
ds_read_b64_tr_b16 a[176:177],v7 offset:8256
ds_read_b64_tr_b16 a[178:179],v7 offset:10304
ds_read_b64_tr_b16 a[180:181],v7 offset:9280
ds_read_b64_tr_b16 a[182:183],v7 offset:11328
s_waitcnt lgkmcnt(4)
ds_read_b64_tr_b16 a[24:25],v7 offset:12288
ds_read_b64_tr_b16 a[26:27],v7 offset:14336
ds_read_b64_tr_b16 a[28:29],v7 offset:13312
ds_read_b64_tr_b16 a[30:31],v7 offset:15360
ds_read_b64_tr_b16 a[184:185],v7 offset:12352
ds_read_b64_tr_b16 a[186:187],v7 offset:14400
ds_read_b64_tr_b16 a[188:189],v7 offset:13376
ds_read_b64_tr_b16 a[190:191],v7 offset:15424
ds_read_b64_tr_b16 a[32:33],v7 offset:16384
ds_read_b64_tr_b16 a[34:35],v7 offset:18432
ds_read_b64_tr_b16 a[36:37],v7 offset:17408
ds_read_b64_tr_b16 a[38:39],v7 offset:19456
s_waitcnt lgkmcnt(4)
ds_read_b64_tr_b16 a[192:193],v7 offset:16448
ds_read_b64_tr_b16 a[194:195],v7 offset:18496
ds_read_b64_tr_b16 a[196:197],v7 offset:17472
ds_read_b64_tr_b16 a[198:199],v7 offset:19520
s_waitcnt lgkmcnt(0)
s_add_u32 m0,s63,0
s_add_u32 s65,s58,3932160
buffer_load_dwordx4 v6,s[4:7],s65 offen lds
s_add_u32 m0,s63,1024
s_add_u32 s65,s58,4030464
buffer_load_dwordx4 v6,s[4:7],s65 offen lds
s_add_u32 m0,s63,2048
s_add_u32 s65,s58,4128768
buffer_load_dwordx4 v6,s[4:7],s65 offen lds
s_add_u32 m0,s63,3072
s_add_u32 s65,s58,4227072
buffer_load_dwordx4 v6,s[4:7],s65 offen lds
s_add_u32 m0,s63,4096
s_add_u32 s65,s58,4325376
buffer_load_dwordx4 v6,s[4:7],s65 offen lds
s_add_u32 m0,s63,5120
s_add_u32 s65,s58,4423680
buffer_load_dwordx4 v6,s[4:7],s65 offen lds
s_add_u32 m0,s63,6144
s_add_u32 s65,s58,4521984
buffer_load_dwordx4 v6,s[4:7],s65 offen lds
s_add_u32 m0,s63,7168
s_add_u32 s65,s58,4620288
buffer_load_dwordx4 v6,s[4:7],s65 offen lds
s_add_u32 m0,s63,8192
s_add_u32 s65,s58,4718592
buffer_load_dwordx4 v6,s[4:7],s65 offen lds
s_add_u32 m0,s63,9216
s_add_u32 s65,s58,4816896
buffer_load_dwordx4 v6,s[4:7],s65 offen lds
s_add_u32 m0,s63,10240
s_add_u32 s65,s58,4915200
buffer_load_dwordx4 v6,s[4:7],s65 offen lds
s_add_u32 m0,s63,11264
s_add_u32 s65,s58,5013504
buffer_load_dwordx4 v6,s[4:7],s65 offen lds
s_add_u32 m0,s63,12288
s_add_u32 s65,s58,5111808
buffer_load_dwordx4 v6,s[4:7],s65 offen lds
s_add_u32 m0,s63,13312
s_add_u32 s65,s58,5210112
buffer_load_dwordx4 v6,s[4:7],s65 offen lds
s_add_u32 m0,s63,14336
s_add_u32 s65,s58,5308416
buffer_load_dwordx4 v6,s[4:7],s65 offen lds
s_add_u32 m0,s63,15360
s_add_u32 s65,s58,5406720
buffer_load_dwordx4 v6,s[4:7],s65 offen lds
s_add_u32 m0,s63,16384
s_add_u32 s65,s58,5505024
buffer_load_dwordx4 v6,s[4:7],s65 offen lds
s_add_u32 m0,s63,17408
s_add_u32 s65,s58,5603328
buffer_load_dwordx4 v6,s[4:7],s65 offen lds
s_add_u32 m0,s63,18432
s_add_u32 s65,s58,5701632
buffer_load_dwordx4 v6,s[4:7],s65 offen lds
s_add_u32 m0,s63,19456
s_add_u32 s65,s58,5799936
buffer_load_dwordx4 v6,s[4:7],s65 offen lds
s_waitcnt vmcnt(20)
v_bfe_u32 v9,v0,2,2
v_lshrrev_b32 v10,5,v0
v_lshl_add_u32 v9,v10,2,v9
v_mul_u32_u24 v9,128,v9
v_and_b32 v10,1,v0
v_lshl_add_u32 v9,v10,3,v9
v_bfe_u32 v10,v0,1,1
v_lshl_add_u32 v9,v10,5,v9
v_bfe_u32 v10,v0,4,1
v_lshl_add_u32 v9,v10,4,v9
v_add_u32 v7,s63,v9
ds_read_b64_tr_b16 a[40:41],v7 offset:20480
ds_read_b64_tr_b16 a[42:43],v7 offset:22528
ds_read_b64_tr_b16 a[44:45],v7 offset:21504
ds_read_b64_tr_b16 a[46:47],v7 offset:23552
ds_read_b64_tr_b16 a[200:201],v7 offset:20544
ds_read_b64_tr_b16 a[202:203],v7 offset:22592
ds_read_b64_tr_b16 a[204:205],v7 offset:21568
ds_read_b64_tr_b16 a[206:207],v7 offset:23616
ds_read_b64_tr_b16 a[48:49],v7 offset:24576
ds_read_b64_tr_b16 a[50:51],v7 offset:26624
ds_read_b64_tr_b16 a[52:53],v7 offset:25600
ds_read_b64_tr_b16 a[54:55],v7 offset:27648
s_waitcnt lgkmcnt(4)
ds_read_b64_tr_b16 a[208:209],v7 offset:24640
ds_read_b64_tr_b16 a[210:211],v7 offset:26688
ds_read_b64_tr_b16 a[212:213],v7 offset:25664
ds_read_b64_tr_b16 a[214:215],v7 offset:27712
ds_read_b64_tr_b16 a[56:57],v7 offset:28672
ds_read_b64_tr_b16 a[58:59],v7 offset:30720
ds_read_b64_tr_b16 a[60:61],v7 offset:29696
ds_read_b64_tr_b16 a[62:63],v7 offset:31744
ds_read_b64_tr_b16 a[216:217],v7 offset:28736
ds_read_b64_tr_b16 a[218:219],v7 offset:30784
ds_read_b64_tr_b16 a[220:221],v7 offset:29760
ds_read_b64_tr_b16 a[222:223],v7 offset:31808
s_waitcnt lgkmcnt(4)
ds_read_b64_tr_b16 a[64:65],v7 offset:32768
ds_read_b64_tr_b16 a[66:67],v7 offset:34816
ds_read_b64_tr_b16 a[68:69],v7 offset:33792
ds_read_b64_tr_b16 a[70:71],v7 offset:35840
ds_read_b64_tr_b16 a[224:225],v7 offset:32832
ds_read_b64_tr_b16 a[226:227],v7 offset:34880
ds_read_b64_tr_b16 a[228:229],v7 offset:33856
ds_read_b64_tr_b16 a[230:231],v7 offset:35904
ds_read_b64_tr_b16 a[72:73],v7 offset:36864
ds_read_b64_tr_b16 a[74:75],v7 offset:38912
ds_read_b64_tr_b16 a[76:77],v7 offset:37888
ds_read_b64_tr_b16 a[78:79],v7 offset:39936
s_waitcnt lgkmcnt(4)
ds_read_b64_tr_b16 a[232:233],v7 offset:36928
ds_read_b64_tr_b16 a[234:235],v7 offset:38976
ds_read_b64_tr_b16 a[236:237],v7 offset:37952
ds_read_b64_tr_b16 a[238:239],v7 offset:40000
s_waitcnt lgkmcnt(0)
s_add_u32 m0,s63,20480
s_add_u32 s65,s58,5898240
buffer_load_dwordx4 v6,s[4:7],s65 offen lds
s_add_u32 m0,s63,21504
s_add_u32 s65,s58,5996544
buffer_load_dwordx4 v6,s[4:7],s65 offen lds
s_add_u32 m0,s63,22528
s_add_u32 s65,s58,6094848
buffer_load_dwordx4 v6,s[4:7],s65 offen lds
s_add_u32 m0,s63,23552
s_add_u32 s65,s58,6193152
buffer_load_dwordx4 v6,s[4:7],s65 offen lds
s_add_u32 m0,s63,24576
s_add_u32 s65,s58,6291456
buffer_load_dwordx4 v6,s[4:7],s65 offen lds
s_add_u32 m0,s63,25600
s_add_u32 s65,s58,6389760
buffer_load_dwordx4 v6,s[4:7],s65 offen lds
s_add_u32 m0,s63,26624
s_add_u32 s65,s58,6488064
buffer_load_dwordx4 v6,s[4:7],s65 offen lds
s_add_u32 m0,s63,27648
s_add_u32 s65,s58,6586368
buffer_load_dwordx4 v6,s[4:7],s65 offen lds
s_add_u32 m0,s63,28672
s_add_u32 s65,s58,6684672
buffer_load_dwordx4 v6,s[4:7],s65 offen lds
s_add_u32 m0,s63,29696
s_add_u32 s65,s58,6782976
buffer_load_dwordx4 v6,s[4:7],s65 offen lds
s_add_u32 m0,s63,30720
s_add_u32 s65,s58,6881280
buffer_load_dwordx4 v6,s[4:7],s65 offen lds
s_add_u32 m0,s63,31744
s_add_u32 s65,s58,6979584
buffer_load_dwordx4 v6,s[4:7],s65 offen lds
s_add_u32 m0,s63,32768
s_add_u32 s65,s58,7077888
buffer_load_dwordx4 v6,s[4:7],s65 offen lds
s_add_u32 m0,s63,33792
s_add_u32 s65,s58,7176192
buffer_load_dwordx4 v6,s[4:7],s65 offen lds
s_add_u32 m0,s63,34816
s_add_u32 s65,s58,7274496
buffer_load_dwordx4 v6,s[4:7],s65 offen lds
s_add_u32 m0,s63,35840
s_add_u32 s65,s58,7372800
buffer_load_dwordx4 v6,s[4:7],s65 offen lds
s_add_u32 m0,s63,36864
s_add_u32 s65,s58,7471104
buffer_load_dwordx4 v6,s[4:7],s65 offen lds
s_add_u32 m0,s63,37888
s_add_u32 s65,s58,7569408
buffer_load_dwordx4 v6,s[4:7],s65 offen lds
s_add_u32 m0,s63,38912
s_add_u32 s65,s58,7667712
buffer_load_dwordx4 v6,s[4:7],s65 offen lds
s_add_u32 m0,s63,39936
s_add_u32 s65,s58,7766016
buffer_load_dwordx4 v6,s[4:7],s65 offen lds
s_waitcnt vmcnt(20)
v_bfe_u32 v9,v0,2,2
v_lshrrev_b32 v10,5,v0
v_lshl_add_u32 v9,v10,2,v9
v_mul_u32_u24 v9,128,v9
v_and_b32 v10,1,v0
v_lshl_add_u32 v9,v10,3,v9
v_bfe_u32 v10,v0,1,1
v_lshl_add_u32 v9,v10,5,v9
v_bfe_u32 v10,v0,4,1
v_lshl_add_u32 v9,v10,4,v9
v_add_u32 v7,s63,v9
ds_read_b64_tr_b16 a[80:81],v7 offset:0
ds_read_b64_tr_b16 a[82:83],v7 offset:2048
ds_read_b64_tr_b16 a[84:85],v7 offset:1024
ds_read_b64_tr_b16 a[86:87],v7 offset:3072
ds_read_b64_tr_b16 a[240:241],v7 offset:64
ds_read_b64_tr_b16 a[242:243],v7 offset:2112
ds_read_b64_tr_b16 a[244:245],v7 offset:1088
ds_read_b64_tr_b16 a[246:247],v7 offset:3136
ds_read_b64_tr_b16 a[88:89],v7 offset:4096
ds_read_b64_tr_b16 a[90:91],v7 offset:6144
ds_read_b64_tr_b16 a[92:93],v7 offset:5120
ds_read_b64_tr_b16 a[94:95],v7 offset:7168
s_waitcnt lgkmcnt(4)
ds_read_b64_tr_b16 a[248:249],v7 offset:4160
ds_read_b64_tr_b16 a[250:251],v7 offset:6208
ds_read_b64_tr_b16 a[252:253],v7 offset:5184
ds_read_b64_tr_b16 a[254:255],v7 offset:7232
ds_read_b64_tr_b16 a[96:97],v7 offset:8192
ds_read_b64_tr_b16 a[98:99],v7 offset:10240
ds_read_b64_tr_b16 a[100:101],v7 offset:9216
ds_read_b64_tr_b16 a[102:103],v7 offset:11264
ds_read_b64_tr_b16 v[192:193],v7 offset:8256
ds_read_b64_tr_b16 v[194:195],v7 offset:10304
ds_read_b64_tr_b16 v[196:197],v7 offset:9280
ds_read_b64_tr_b16 v[198:199],v7 offset:11328
s_waitcnt lgkmcnt(4)
ds_read_b64_tr_b16 a[104:105],v7 offset:12288
ds_read_b64_tr_b16 a[106:107],v7 offset:14336
ds_read_b64_tr_b16 a[108:109],v7 offset:13312
ds_read_b64_tr_b16 a[110:111],v7 offset:15360
ds_read_b64_tr_b16 v[200:201],v7 offset:12352
ds_read_b64_tr_b16 v[202:203],v7 offset:14400
ds_read_b64_tr_b16 v[204:205],v7 offset:13376
ds_read_b64_tr_b16 v[206:207],v7 offset:15424
ds_read_b64_tr_b16 a[112:113],v7 offset:16384
ds_read_b64_tr_b16 a[114:115],v7 offset:18432
ds_read_b64_tr_b16 a[116:117],v7 offset:17408
ds_read_b64_tr_b16 a[118:119],v7 offset:19456
s_waitcnt lgkmcnt(4)
ds_read_b64_tr_b16 v[208:209],v7 offset:16448
ds_read_b64_tr_b16 v[210:211],v7 offset:18496
ds_read_b64_tr_b16 v[212:213],v7 offset:17472
ds_read_b64_tr_b16 v[214:215],v7 offset:19520
s_waitcnt lgkmcnt(0)
s_waitcnt vmcnt(0)
v_bfe_u32 v9,v0,2,2
v_lshrrev_b32 v10,5,v0
v_lshl_add_u32 v9,v10,2,v9
v_mul_u32_u24 v9,128,v9
v_and_b32 v10,1,v0
v_lshl_add_u32 v9,v10,3,v9
v_bfe_u32 v10,v0,1,1
v_lshl_add_u32 v9,v10,5,v9
v_bfe_u32 v10,v0,4,1
v_lshl_add_u32 v9,v10,4,v9
v_add_u32 v7,s63,v9
ds_read_b64_tr_b16 a[120:121],v7 offset:20480
ds_read_b64_tr_b16 a[122:123],v7 offset:22528
ds_read_b64_tr_b16 a[124:125],v7 offset:21504
ds_read_b64_tr_b16 a[126:127],v7 offset:23552
ds_read_b64_tr_b16 v[216:217],v7 offset:20544
ds_read_b64_tr_b16 v[218:219],v7 offset:22592
ds_read_b64_tr_b16 v[220:221],v7 offset:21568
ds_read_b64_tr_b16 v[222:223],v7 offset:23616
ds_read_b64_tr_b16 a[128:129],v7 offset:24576
ds_read_b64_tr_b16 a[130:131],v7 offset:26624
ds_read_b64_tr_b16 a[132:133],v7 offset:25600
ds_read_b64_tr_b16 a[134:135],v7 offset:27648
s_waitcnt lgkmcnt(4)
ds_read_b64_tr_b16 v[224:225],v7 offset:24640
ds_read_b64_tr_b16 v[226:227],v7 offset:26688
ds_read_b64_tr_b16 v[228:229],v7 offset:25664
ds_read_b64_tr_b16 v[230:231],v7 offset:27712
ds_read_b64_tr_b16 a[136:137],v7 offset:28672
ds_read_b64_tr_b16 a[138:139],v7 offset:30720
ds_read_b64_tr_b16 a[140:141],v7 offset:29696
ds_read_b64_tr_b16 a[142:143],v7 offset:31744
ds_read_b64_tr_b16 v[232:233],v7 offset:28736
ds_read_b64_tr_b16 v[234:235],v7 offset:30784
ds_read_b64_tr_b16 v[236:237],v7 offset:29760
ds_read_b64_tr_b16 v[238:239],v7 offset:31808
s_waitcnt lgkmcnt(4)
ds_read_b64_tr_b16 a[144:145],v7 offset:32768
ds_read_b64_tr_b16 a[146:147],v7 offset:34816
ds_read_b64_tr_b16 a[148:149],v7 offset:33792
ds_read_b64_tr_b16 a[150:151],v7 offset:35840
ds_read_b64_tr_b16 v[240:241],v7 offset:32832
ds_read_b64_tr_b16 v[242:243],v7 offset:34880
ds_read_b64_tr_b16 v[244:245],v7 offset:33856
ds_read_b64_tr_b16 v[246:247],v7 offset:35904
ds_read_b64_tr_b16 a[152:153],v7 offset:36864
ds_read_b64_tr_b16 a[154:155],v7 offset:38912
ds_read_b64_tr_b16 a[156:157],v7 offset:37888
ds_read_b64_tr_b16 a[158:159],v7 offset:39936
s_waitcnt lgkmcnt(4)
ds_read_b64_tr_b16 v[248:249],v7 offset:36928
ds_read_b64_tr_b16 v[250:251],v7 offset:38976
ds_read_b64_tr_b16 v[252:253],v7 offset:37952
ds_read_b64_tr_b16 v[254:255],v7 offset:40000
s_waitcnt lgkmcnt(0)
v_mov_b32 v24,0x3f803f80
v_mov_b32 v25,0x3f803f80
v_mov_b32 v26,0x3f803f80
v_mov_b32 v27,0x3f803f80
s_nop 1
v_mfma_f32_32x32x16_bf16 v[120:135],a[0:3],v[24:27],0
v_mfma_f32_32x32x16_bf16 v[136:151],a[160:163],v[24:27],0
v_mfma_f32_32x32x16_bf16 v[120:135],a[4:7],v[24:27],v[120:135]
v_mfma_f32_32x32x16_bf16 v[136:151],a[164:167],v[24:27],v[136:151]
v_mfma_f32_32x32x16_bf16 v[120:135],a[8:11],v[24:27],v[120:135]
v_mfma_f32_32x32x16_bf16 v[136:151],a[168:171],v[24:27],v[136:151]
v_mfma_f32_32x32x16_bf16 v[120:135],a[12:15],v[24:27],v[120:135]
v_mfma_f32_32x32x16_bf16 v[136:151],a[172:175],v[24:27],v[136:151]
v_mfma_f32_32x32x16_bf16 v[120:135],a[16:19],v[24:27],v[120:135]
v_mfma_f32_32x32x16_bf16 v[136:151],a[176:179],v[24:27],v[136:151]
v_mfma_f32_32x32x16_bf16 v[120:135],a[20:23],v[24:27],v[120:135]
v_mfma_f32_32x32x16_bf16 v[136:151],a[180:183],v[24:27],v[136:151]
v_mfma_f32_32x32x16_bf16 v[120:135],a[24:27],v[24:27],v[120:135]
v_mfma_f32_32x32x16_bf16 v[136:151],a[184:187],v[24:27],v[136:151]
v_mfma_f32_32x32x16_bf16 v[120:135],a[28:31],v[24:27],v[120:135]
v_mfma_f32_32x32x16_bf16 v[136:151],a[188:191],v[24:27],v[136:151]
v_mfma_f32_32x32x16_bf16 v[120:135],a[32:35],v[24:27],v[120:135]
v_mfma_f32_32x32x16_bf16 v[136:151],a[192:195],v[24:27],v[136:151]
v_mfma_f32_32x32x16_bf16 v[120:135],a[36:39],v[24:27],v[120:135]
v_mfma_f32_32x32x16_bf16 v[136:151],a[196:199],v[24:27],v[136:151]
v_mfma_f32_32x32x16_bf16 v[120:135],a[40:43],v[24:27],v[120:135]
v_mfma_f32_32x32x16_bf16 v[136:151],a[200:203],v[24:27],v[136:151]
v_mfma_f32_32x32x16_bf16 v[120:135],a[44:47],v[24:27],v[120:135]
v_mfma_f32_32x32x16_bf16 v[136:151],a[204:207],v[24:27],v[136:151]
v_mfma_f32_32x32x16_bf16 v[120:135],a[48:51],v[24:27],v[120:135]
v_mfma_f32_32x32x16_bf16 v[136:151],a[208:211],v[24:27],v[136:151]
v_mfma_f32_32x32x16_bf16 v[120:135],a[52:55],v[24:27],v[120:135]
v_mfma_f32_32x32x16_bf16 v[136:151],a[212:215],v[24:27],v[136:151]
v_mfma_f32_32x32x16_bf16 v[120:135],a[56:59],v[24:27],v[120:135]
v_mfma_f32_32x32x16_bf16 v[136:151],a[216:219],v[24:27],v[136:151]
v_mfma_f32_32x32x16_bf16 v[120:135],a[60:63],v[24:27],v[120:135]
v_mfma_f32_32x32x16_bf16 v[136:151],a[220:223],v[24:27],v[136:151]
v_mfma_f32_32x32x16_bf16 v[120:135],a[64:67],v[24:27],v[120:135]
v_mfma_f32_32x32x16_bf16 v[136:151],a[224:227],v[24:27],v[136:151]
v_mfma_f32_32x32x16_bf16 v[120:135],a[68:71],v[24:27],v[120:135]
v_mfma_f32_32x32x16_bf16 v[136:151],a[228:231],v[24:27],v[136:151]
v_mfma_f32_32x32x16_bf16 v[120:135],a[72:75],v[24:27],v[120:135]
v_mfma_f32_32x32x16_bf16 v[136:151],a[232:235],v[24:27],v[136:151]
v_mfma_f32_32x32x16_bf16 v[120:135],a[76:79],v[24:27],v[120:135]
v_mfma_f32_32x32x16_bf16 v[136:151],a[236:239],v[24:27],v[136:151]
v_mfma_f32_32x32x16_bf16 v[120:135],a[80:83],v[24:27],v[120:135]
v_mfma_f32_32x32x16_bf16 v[136:151],a[240:243],v[24:27],v[136:151]
v_mfma_f32_32x32x16_bf16 v[120:135],a[84:87],v[24:27],v[120:135]
v_mfma_f32_32x32x16_bf16 v[136:151],a[244:247],v[24:27],v[136:151]
v_mfma_f32_32x32x16_bf16 v[120:135],a[88:91],v[24:27],v[120:135]
v_mfma_f32_32x32x16_bf16 v[136:151],a[248:251],v[24:27],v[136:151]
v_mfma_f32_32x32x16_bf16 v[120:135],a[92:95],v[24:27],v[120:135]
v_mfma_f32_32x32x16_bf16 v[136:151],a[252:255],v[24:27],v[136:151]
v_mfma_f32_32x32x16_bf16 v[120:135],a[96:99],v[24:27],v[120:135]
v_mfma_f32_32x32x16_bf16 v[136:151],v[192:195],v[24:27],v[136:151]
v_mfma_f32_32x32x16_bf16 v[120:135],a[100:103],v[24:27],v[120:135]
v_mfma_f32_32x32x16_bf16 v[136:151],v[196:199],v[24:27],v[136:151]
v_mfma_f32_32x32x16_bf16 v[120:135],a[104:107],v[24:27],v[120:135]
v_mfma_f32_32x32x16_bf16 v[136:151],v[200:203],v[24:27],v[136:151]
v_mfma_f32_32x32x16_bf16 v[120:135],a[108:111],v[24:27],v[120:135]
v_mfma_f32_32x32x16_bf16 v[136:151],v[204:207],v[24:27],v[136:151]
v_mfma_f32_32x32x16_bf16 v[120:135],a[112:115],v[24:27],v[120:135]
v_mfma_f32_32x32x16_bf16 v[136:151],v[208:211],v[24:27],v[136:151]
v_mfma_f32_32x32x16_bf16 v[120:135],a[116:119],v[24:27],v[120:135]
v_mfma_f32_32x32x16_bf16 v[136:151],v[212:215],v[24:27],v[136:151]
v_mfma_f32_32x32x16_bf16 v[120:135],a[120:123],v[24:27],v[120:135]
v_mfma_f32_32x32x16_bf16 v[136:151],v[216:219],v[24:27],v[136:151]
v_mfma_f32_32x32x16_bf16 v[120:135],a[124:127],v[24:27],v[120:135]
v_mfma_f32_32x32x16_bf16 v[136:151],v[220:223],v[24:27],v[136:151]
v_mfma_f32_32x32x16_bf16 v[120:135],a[128:131],v[24:27],v[120:135]
v_mfma_f32_32x32x16_bf16 v[136:151],v[224:227],v[24:27],v[136:151]
v_mfma_f32_32x32x16_bf16 v[120:135],a[132:135],v[24:27],v[120:135]
v_mfma_f32_32x32x16_bf16 v[136:151],v[228:231],v[24:27],v[136:151]
v_mfma_f32_32x32x16_bf16 v[120:135],a[136:139],v[24:27],v[120:135]
v_mfma_f32_32x32x16_bf16 v[136:151],v[232:235],v[24:27],v[136:151]
v_mfma_f32_32x32x16_bf16 v[120:135],a[140:143],v[24:27],v[120:135]
v_mfma_f32_32x32x16_bf16 v[136:151],v[236:239],v[24:27],v[136:151]
v_mfma_f32_32x32x16_bf16 v[120:135],a[144:147],v[24:27],v[120:135]
v_mfma_f32_32x32x16_bf16 v[136:151],v[240:243],v[24:27],v[136:151]
v_mfma_f32_32x32x16_bf16 v[120:135],a[148:151],v[24:27],v[120:135]
v_mfma_f32_32x32x16_bf16 v[136:151],v[244:247],v[24:27],v[136:151]
v_mfma_f32_32x32x16_bf16 v[120:135],a[152:155],v[24:27],v[120:135]
v_mfma_f32_32x32x16_bf16 v[136:151],v[248:251],v[24:27],v[136:151]
v_mfma_f32_32x32x16_bf16 v[120:135],a[156:159],v[24:27],v[120:135]
v_mfma_f32_32x32x16_bf16 v[136:151],v[252:255],v[24:27],v[136:151]
s_barrier
s_lshl_b32 s3,s49,2
v_mov_b32 v7,s3
s_nop 8
ibw_216:
buffer_load_dword v6,v7,s[12:15],0 offen sc1
s_waitcnt vmcnt(0)
v_cmp_ne_u32 vcc,256,v6
s_nop 0
s_cbranch_vccz ok_217
s_sleep 8
s_sub_u32 s47,s47,1
s_cbranch_scc1 ABORT
s_branch ibw_216
ok_217:
s_cmp_lg_u32 s49,0
s_cbranch_scc1 ibok_218
v_and_b32 v7,7,v0
v_lshlrev_b32 v7,2,v7
buffer_load_dword v6,v7,s[12:15],0 offen offset:32 sc1
s_waitcnt vmcnt(0)
v_cmp_ne_u32 vcc,32,v6
s_nop 0
s_cbranch_vccz ibok_218
s_barrier
s_mov_b32 s49,1
s_mov_b32 s3,s2
s_load_dwordx16 s[16:31],s[0:1],0
s_load_dwordx8 s[32:39],s[0:1],64
s_waitcnt lgkmcnt(0)
s_branch DISPATCH
ibok_218:
s_mov_b32 s50,0
s_mov_b32 s32,0
s_mov_b32 s57,0
s_mov_b32 s59,2147483648
s_mov_b32 s82,2147483648
s_mov_b32 s39,2147483648
v_mov_b32 v22,94208
s_mov_b32 s72,0
s_mov_b32 s73,0
s_mov_b32 s78,0
s_mov_b32 s79,0
s_cmp_eq_u32 s46,0
s_cselect_b32 s40,0,2147483648
s_lshl_b32 s60,s46,3
v_add_u32 v13,s60,v22
s_mov_b32 s83,s100
s_lshl_b32 s41,s78,9
s_add_u32 s41,s41,s40
s_lshl_b32 s35,s79,9
s_add_u32 s35,s35,s40
s_add_u32 s35,s35,32768
s_branch QKVQ_COLD0
QKVQ_B0:
s_waitcnt lgkmcnt(3)
v_mfma_f32_32x32x16_bf16 v[56:71],a[0:3],v[24:27],0
ds_read_b128 v[44:47],v17 offset:4096
v_add_u32 v189,s57,v188
v_mfma_f32_32x32x16_bf16 v[72:87],a[160:163],v[24:27],0
v_add_u32 v8,0x800,v189
s_sub_u32 s66,46080,s57
s_lshl_b32 s60,s33,6
s_add_u32 s60,s60,s34
s_mul_i32 s60,s60,46080
s_add_u32 s60,s60,s37
v_mfma_f32_32x32x16_bf16 v[56:71],a[4:7],v[28:31],v[56:71]
ds_read_b128 v[48:51],v16 offset:6144
ds_read2_b64 v[156:159],v189 offset0:0 offset1:32
s_add_u32 s60,s60,206569472
s_lshl_b32 s62,s46,10
v_mfma_f32_32x32x16_bf16 v[72:87],a[164:167],v[28:31],v[72:87]
ds_read2_b64 v[160:163],v189 offset0:64 offset1:96
s_add_u32 s62,s62,40960
s_add_u32 m0,s66,s62
s_add_u32 s63,s60,s62
s_waitcnt lgkmcnt(5)
v_mfma_f32_32x32x16_bf16 v[56:71],a[8:11],v[32:35],v[56:71]
ds_read_b128 v[52:55],v17 offset:6144
ds_read2_b64 v[164:167],v189 offset0:128 offset1:160
buffer_load_dwordx4 v1,s[8:11],s63 offen sc1 lds
v_mfma_f32_32x32x16_bf16 v[72:87],a[168:171],v[32:35],v[72:87]
ds_read2_b64 v[168:171],v189 offset0:192 offset1:224
s_add_u32 m0,s66,45056
s_add_u32 s63,s60,45056
s_mul_i32 s74,s73,393216
s_add_u32 s74,s74,s39
v_mfma_f32_32x32x16_bf16 v[56:71],a[12:15],v[36:39],v[56:71]
ds_read_b128 v[24:27],v16 offset:8192
ds_read2_b64 v[172:175],v8 offset0:0 offset1:32
s_add_u32 s74,s74,s70
v_fma_f32 v88,-v176,v120,v88
v_mfma_f32_32x32x16_bf16 v[72:87],a[172:175],v[36:39],v[72:87]
buffer_load_dwordx4 v1,s[8:11],s63 offen sc1 lds
s_mul_i32 s61,s46,10240
s_add_u32 s60,s60,s61
s_add_u32 s61,s61,s66
s_waitcnt lgkmcnt(8)
v_mfma_f32_32x32x16_bf16 v[56:71],a[16:19],v[40:43],v[56:71]
ds_read_b128 v[28:31],v17 offset:8192
s_add_u32 m0,s61,0
s_add_u32 s63,s60,0
v_fma_f32 v89,-v176,v121,v89
v_fma_f32 v90,-v176,v122,v90
v_mfma_f32_32x32x16_bf16 v[72:87],a[176:179],v[40:43],v[72:87]
v_fma_f32 v91,-v176,v123,v91
v_fma_f32 v92,-v176,v124,v92
v_fma_f32 v93,-v176,v125,v93
v_fma_f32 v94,-v176,v126,v94
v_fma_f32 v95,-v176,v127,v95
v_mfma_f32_32x32x16_bf16 v[56:71],a[20:23],v[44:47],v[56:71]
ds_read_b128 v[32:35],v16 offset:10240
buffer_load_dwordx4 v1,s[8:11],s63 offen sc1 lds
v_mul_f32 v88,v88,v177
v_mul_f32 v89,v89,v177
v_mfma_f32_32x32x16_bf16 v[72:87],a[180:183],v[44:47],v[72:87]
v_mul_f32 v90,v90,v177
v_mul_f32 v91,v91,v177
v_mul_f32 v92,v92,v177
v_mul_f32 v93,v93,v177
v_mul_f32 v94,v94,v177
s_waitcnt lgkmcnt(6)
v_mfma_f32_32x32x16_bf16 v[56:71],a[24:27],v[48:51],v[56:71]
ds_read_b128 v[36:39],v17 offset:10240
v_mul_f32 v95,v95,v177
v_cvt_pk_bf16_f32 v180,v88,v89
v_cvt_pk_bf16_f32 v181,v90,v91
v_cvt_pk_bf16_f32 v182,v92,v93
v_mfma_f32_32x32x16_bf16 v[72:87],a[184:187],v[48:51],v[72:87]
buffer_load_dwordx4 v1,s[8:11],s63 offen offset:1024 sc1 lds
v_cvt_pk_bf16_f32 v183,v94,v95
buffer_store_dwordx4 v[180:183],v20,s[8:11],s74 offen sc1
v_fma_f32 v96,-v176,v128,v96
v_mfma_f32_32x32x16_bf16 v[56:71],a[28:31],v[52:55],v[56:71]
ds_read_b128 v[40:43],v16 offset:12288
v_fma_f32 v97,-v176,v129,v97
v_fma_f32 v98,-v176,v130,v98
v_fma_f32 v99,-v176,v131,v99
v_fma_f32 v100,-v176,v132,v100
v_mfma_f32_32x32x16_bf16 v[72:87],a[188:191],v[52:55],v[72:87]
v_fma_f32 v101,-v176,v133,v101
v_fma_f32 v102,-v176,v134,v102
v_fma_f32 v103,-v176,v135,v103
v_mul_f32 v96,v96,v177
v_mul_f32 v97,v97,v177
s_waitcnt lgkmcnt(3)
v_mfma_f32_32x32x16_bf16 v[56:71],a[32:35],v[24:27],v[56:71]
ds_read_b128 v[44:47],v17 offset:12288
buffer_load_dwordx4 v1,s[8:11],s63 offen offset:2048 sc1 lds
v_mul_f32 v98,v98,v177
v_mul_f32 v99,v99,v177
v_mfma_f32_32x32x16_bf16 v[72:87],a[192:195],v[24:27],v[72:87]
v_mul_f32 v100,v100,v177
v_mul_f32 v101,v101,v177
v_mul_f32 v102,v102,v177
v_mul_f32 v103,v103,v177
v_cvt_pk_bf16_f32 v184,v96,v97
v_mfma_f32_32x32x16_bf16 v[56:71],a[36:39],v[28:31],v[56:71]
ds_read_b128 v[48:51],v16 offset:14336
v_cvt_pk_bf16_f32 v185,v98,v99
v_cvt_pk_bf16_f32 v186,v100,v101
v_cvt_pk_bf16_f32 v187,v102,v103
v_mfma_f32_32x32x16_bf16 v[72:87],a[196:199],v[28:31],v[72:87]
buffer_load_dwordx4 v1,s[8:11],s63 offen offset:3072 sc1 lds
s_add_u32 m0,s61,4096
s_add_u32 s63,s60,4096
s_waitcnt lgkmcnt(3)
v_mfma_f32_32x32x16_bf16 v[56:71],a[40:43],v[32:35],v[56:71]
ds_read_b128 v[52:55],v17 offset:14336
buffer_store_dwordx4 v[184:187],v21,s[8:11],s74 offen sc1
v_fma_f32 v104,-v176,v136,v104
v_fma_f32 v105,-v176,v137,v105
v_mfma_f32_32x32x16_bf16 v[72:87],a[200:203],v[32:35],v[72:87]
v_fma_f32 v106,-v176,v138,v106
v_fma_f32 v107,-v176,v139,v107
v_fma_f32 v108,-v176,v140,v108
v_fma_f32 v109,-v176,v141,v109
v_fma_f32 v110,-v176,v142,v110
v_mfma_f32_32x32x16_bf16 v[56:71],a[44:47],v[36:39],v[56:71]
ds_read_b128 v[24:27],v16 offset:16384
buffer_load_dwordx4 v1,s[8:11],s63 offen sc1 lds
v_fma_f32 v111,-v176,v143,v111
v_mul_f32 v104,v104,v177
v_mfma_f32_32x32x16_bf16 v[72:87],a[204:207],v[36:39],v[72:87]
v_mul_f32 v105,v105,v177
v_mul_f32 v106,v106,v177
v_mul_f32 v107,v107,v177
v_mul_f32 v108,v108,v177
v_mul_f32 v109,v109,v177
s_waitcnt lgkmcnt(3)
v_mfma_f32_32x32x16_bf16 v[56:71],a[48:51],v[40:43],v[56:71]
ds_read_b128 v[28:31],v17 offset:16384
v_mul_f32 v110,v110,v177
v_mul_f32 v111,v111,v177
v_cvt_pk_bf16_f32 v180,v104,v105
v_cvt_pk_bf16_f32 v181,v106,v107
v_mfma_f32_32x32x16_bf16 v[72:87],a[208:211],v[40:43],v[72:87]
buffer_load_dwordx4 v1,s[8:11],s63 offen offset:1024 sc1 lds
v_cvt_pk_bf16_f32 v182,v108,v109
v_cvt_pk_bf16_f32 v183,v110,v111
buffer_store_dwordx4 v[180:183],v20,s[8:11],s74 offen offset:2048 sc1
v_mfma_f32_32x32x16_bf16 v[56:71],a[52:55],v[44:47],v[56:71]
ds_read_b128 v[32:35],v16 offset:18432
v_fma_f32 v112,-v176,v144,v112
v_fma_f32 v113,-v176,v145,v113
v_fma_f32 v114,-v176,v146,v114
v_fma_f32 v115,-v176,v147,v115
v_mfma_f32_32x32x16_bf16 v[72:87],a[212:215],v[44:47],v[72:87]
v_fma_f32 v116,-v176,v148,v116
v_fma_f32 v117,-v176,v149,v117
v_fma_f32 v118,-v176,v150,v118
v_fma_f32 v119,-v176,v151,v119
v_mul_f32 v112,v112,v177
s_waitcnt lgkmcnt(3)
v_mfma_f32_32x32x16_bf16 v[56:71],a[56:59],v[48:51],v[56:71]
ds_read_b128 v[36:39],v17 offset:18432
buffer_load_dwordx4 v1,s[8:11],s63 offen offset:2048 sc1 lds
v_mul_f32 v113,v113,v177
v_mul_f32 v114,v114,v177
v_mfma_f32_32x32x16_bf16 v[72:87],a[216:219],v[48:51],v[72:87]
v_mul_f32 v115,v115,v177
v_mul_f32 v116,v116,v177
v_mul_f32 v117,v117,v177
v_mul_f32 v118,v118,v177
v_mul_f32 v119,v119,v177
v_mfma_f32_32x32x16_bf16 v[56:71],a[60:63],v[52:55],v[56:71]
ds_read_b128 v[40:43],v16 offset:20480
s_waitcnt vmcnt(12)
s_mov_b64 exec,1
buffer_store_dword v5,v1,s[8:11],s59 offen sc1
s_mov_b64 exec,-1
s_mov_b32 s59,2147483648
v_mfma_f32_32x32x16_bf16 v[72:87],a[220:223],v[52:55],v[72:87]
buffer_load_dwordx4 v1,s[8:11],s63 offen offset:3072 sc1 lds
s_add_u32 m0,s61,8192
s_add_u32 s63,s60,8192
v_cvt_pk_bf16_f32 v184,v112,v113
s_waitcnt lgkmcnt(3)
v_mfma_f32_32x32x16_bf16 v[56:71],a[64:67],v[24:27],v[56:71]
ds_read_b128 v[44:47],v17 offset:20480
v_cvt_pk_bf16_f32 v185,v114,v115
v_cvt_pk_bf16_f32 v186,v116,v117
v_cvt_pk_bf16_f32 v187,v118,v119
v_mfma_f32_32x32x16_bf16 v[72:87],a[224:227],v[24:27],v[72:87]
buffer_store_dwordx4 v[184:187],v21,s[8:11],s74 offen offset:2048 sc1
s_lshl_b32 s82,s72,6
s_add_u32 s82,s82,s73
s_lshl_b32 s82,s82,9
s_add_u32 s82,s82,s71
v_mfma_f32_32x32x16_bf16 v[56:71],a[68:71],v[28:31],v[56:71]
ds_read_b128 v[48:51],v16 offset:22528
buffer_load_dwordx4 v1,s[8:11],s63 offen sc1 lds
s_lshl_b32 s75,s69,2
s_add_u32 s82,s82,s75
v_mfma_f32_32x32x16_bf16 v[72:87],a[228:231],v[28:31],v[72:87]
s_add_u32 s82,s82,s39
v_add_f32 v156,v156,v166
v_add_f32 v157,v157,v167
v_add_f32 v158,v158,v168
s_waitcnt lgkmcnt(3)
v_mfma_f32_32x32x16_bf16 v[56:71],a[72:75],v[32:35],v[56:71]
ds_read_b128 v[52:55],v17 offset:22528
v_add_f32 v159,v159,v169
v_add_f32 v160,v160,v170
v_add_f32 v161,v161,v171
v_add_f32 v162,v162,v172
v_mfma_f32_32x32x16_bf16 v[72:87],a[232:235],v[32:35],v[72:87]
buffer_load_dwordx4 v1,s[8:11],s63 offen offset:1024 sc1 lds
s_mov_b32 s53,s33
s_mov_b32 s54,s34
s_add_u32 s79,s79,s33
s_or_b32 s60,s37,s33
v_mfma_f32_32x32x16_bf16 v[56:71],a[76:79],v[36:39],v[56:71]
ds_read_b128 v[24:27],v16 offset:24576
s_cmp_eq_u32 s60,0
s_addc_u32 s78,s78,0
s_lshl_b32 s41,s78,9
s_add_u32 s41,s41,s40
v_mfma_f32_32x32x16_bf16 v[72:87],a[236:239],v[36:39],v[72:87]
s_lshl_b32 s35,s79,9
s_add_u32 s35,s35,s40
s_add_u32 s35,s35,32768
v_add_f32 v163,v163,v173
v_add_f32 v164,v164,v174
s_waitcnt lgkmcnt(3)
v_mfma_f32_32x32x16_bf16 v[56:71],a[80:83],v[40:43],v[56:71]
ds_read_b128 v[28:31],v17 offset:24576
v_add_f32 v165,v165,v175
v_add_f32 v156,v156,v158
v_add_f32 v157,v157,v159
v_add_f32 v160,v160,v162
v_mfma_f32_32x32x16_bf16 v[72:87],a[240:243],v[40:43],v[72:87]
v_add_f32 v161,v161,v163
v_add_f32 v156,v156,v160
v_add_f32 v157,v157,v161
v_add_f32 v156,v156,v164
v_add_f32 v157,v157,v165
v_mfma_f32_32x32x16_bf16 v[56:71],a[84:87],v[44:47],v[56:71]
ds_read_b128 v[32:35],v16 offset:26624
v_mov_b32 v158,v156
v_mov_b32 v159,v157
s_nop 0
v_permlane32_swap_b32 v156,v158
v_permlane32_swap_b32 v157,v159
v_mfma_f32_32x32x16_bf16 v[72:87],a[244:247],v[44:47],v[72:87]
v_add_f32 v176,v156,v158
v_add_f32 v177,v157,v159
v_mul_f32 v176,0x3acccccd,v176
v_mul_f32 v177,0x3acccccd,v177
v_fma_f32 v177,-v176,v176,v177
s_waitcnt lgkmcnt(3)
v_mfma_f32_32x32x16_bf16 v[56:71],a[88:91],v[48:51],v[56:71]
ds_read_b128 v[36:39],v17 offset:26624
buffer_load_dword v3,v2,s[8:11],s35 offen sc1
buffer_load_dword v14,v4,s[8:11],s41 offen sc1
v_mfma_f32_32x32x16_bf16 v[72:87],a[248:251],v[48:51],v[72:87]
v_max_f32 v177,0,v177
v_cvt_pk_bf16_f32 v8,v176,v177
v_lshlrev_b32 v176,16,v8
v_and_b32 v177,0xffff0000,v8
v_add_f32 v177,0x3727c5ac,v177
v_mfma_f32_32x32x16_bf16 v[56:71],a[92:95],v[52:55],v[56:71]
ds_read_b128 v[40:43],v16 offset:28672
v_cvt_pk_bf16_f32 v8,v177,v177
v_lshlrev_b32 v177,16,v8
v_sqrt_f32 v177,v177
v_mfma_f32_32x32x16_bf16 v[72:87],a[252:255],v[52:55],v[72:87]
v_cvt_pk_bf16_f32 v8,v177,v177
v_lshlrev_b32 v177,16,v8
v_rcp_f32 v177,v177
s_waitcnt lgkmcnt(3)
v_mfma_f32_32x32x16_bf16 v[56:71],a[96:99],v[24:27],v[56:71]
ds_read_b128 v[44:47],v17 offset:28672
s_cmp_eq_u32 s51,0
s_cselect_b64 s[76:77],-1,0
v_cndmask_b32 v176,v176,0,s[76:77]
v_cndmask_b32 v177,v177,1.0,s[76:77]
v_mfma_f32_32x32x16_bf16 v[72:87],v[192:195],v[24:27],v[72:87]
s_mov_b32 s72,s51
s_mov_b32 s73,s52
v_mfma_f32_32x32x16_bf16 v[56:71],a[100:103],v[28:31],v[56:71]
ds_read_b128 v[48:51],v16 offset:30720
v_mfma_f32_32x32x16_bf16 v[72:87],v[196:199],v[28:31],v[72:87]
s_waitcnt lgkmcnt(3)
v_mfma_f32_32x32x16_bf16 v[56:71],a[104:107],v[32:35],v[56:71]
ds_read_b128 v[52:55],v17 offset:30720
v_mfma_f32_32x32x16_bf16 v[72:87],v[200:203],v[32:35],v[72:87]
v_mfma_f32_32x32x16_bf16 v[56:71],a[108:111],v[36:39],v[56:71]
ds_read_b128 v[24:27],v16 offset:32768
v_mfma_f32_32x32x16_bf16 v[72:87],v[204:207],v[36:39],v[72:87]
s_waitcnt lgkmcnt(3)
v_mfma_f32_32x32x16_bf16 v[56:71],a[112:115],v[40:43],v[56:71]
ds_read_b128 v[28:31],v17 offset:32768
v_mfma_f32_32x32x16_bf16 v[72:87],v[208:211],v[40:43],v[72:87]
v_mfma_f32_32x32x16_bf16 v[56:71],a[116:119],v[44:47],v[56:71]
ds_read_b128 v[32:35],v16 offset:34816
s_waitcnt vmcnt(4)
s_mov_b64 exec,1
buffer_store_dword v5,v1,s[8:11],s82 offen sc1
s_mov_b64 exec,-1
s_mov_b32 s82,2147483648
v_mfma_f32_32x32x16_bf16 v[72:87],v[212:215],v[44:47],v[72:87]
s_waitcnt lgkmcnt(3)
v_mfma_f32_32x32x16_bf16 v[56:71],a[120:123],v[48:51],v[56:71]
ds_read_b128 v[36:39],v17 offset:34816
v_mfma_f32_32x32x16_bf16 v[72:87],v[216:219],v[48:51],v[72:87]
v_mfma_f32_32x32x16_bf16 v[56:71],a[124:127],v[52:55],v[56:71]
ds_read_b128 v[40:43],v16 offset:36864
s_waitcnt vmcnt(1)
v_cmp_eq_u32 vcc,0,v14
s_cmp_eq_u64 vcc,0
s_cselect_b32 s36,0,2147483648
v_mfma_f32_32x32x16_bf16 v[72:87],v[220:223],v[52:55],v[72:87]
v_cmp_eq_u32 vcc,0,v3
s_cmp_lt_u32 s78,64
s_cselect_b32 s36,s36,2147483648
s_cmp_eq_u64 vcc,0
s_cselect_b32 s60,1,s36
s_waitcnt lgkmcnt(3)
v_mfma_f32_32x32x16_bf16 v[56:71],a[128:131],v[24:27],v[56:71]
ds_read_b128 v[44:47],v17 offset:36864
s_cmp_lt_u32 s79,64
s_cselect_b32 s60,s60,s36
s_sub_u32 s61,s78,s79
s_or_b32 s61,s61,s36
v_mfma_f32_32x32x16_bf16 v[72:87],v[224:227],v[24:27],v[72:87]
s_cmp_lt_u32 s61,16
s_cselect_b32 s36,0,s60
v_mov_b32 v23,s36
ds_write_b32 v13,v23
v_mfma_f32_32x32x16_bf16 v[56:71],a[132:135],v[28:31],v[56:71]
ds_read_b128 v[48:51],v16 offset:38912
v_mfma_f32_32x32x16_bf16 v[72:87],v[228:231],v[28:31],v[72:87]
s_waitcnt lgkmcnt(4)
v_mfma_f32_32x32x16_bf16 v[56:71],a[136:139],v[32:35],v[56:71]
ds_read_b128 v[52:55],v17 offset:38912
v_mfma_f32_32x32x16_bf16 v[72:87],v[232:235],v[32:35],v[72:87]
s_waitcnt lgkmcnt(2)
s_barrier
ds_read_b32 v23,v22
v_mfma_f32_32x32x16_bf16 v[56:71],a[140:143],v[36:39],v[56:71]
ds_read_b128 v[24:27],v18 offset:0
s_cmp_lt_u32 s50,2
s_cselect_b32 s42,1,0
s_or_b32 s42,s42,s37
s_mov_b32 s39,0
v_mfma_f32_32x32x16_bf16 v[72:87],v[236:239],v[36:39],v[72:87]
s_add_u32 s50,s50,1
s_sub_u32 s57,46080,s57
s_mov_b32 s51,s53
s_mov_b32 s52,s54
v_mfma_f32_32x32x16_bf16 v[56:71],a[144:147],v[40:43],v[56:71]
ds_read_b128 v[28:31],v19 offset:0
v_mfma_f32_32x32x16_bf16 v[72:87],v[240:243],v[40:43],v[72:87]
v_mfma_f32_32x32x16_bf16 v[56:71],a[148:151],v[44:47],v[56:71]
ds_read_b128 v[32:35],v18 offset:2048
s_waitcnt lgkmcnt(3)
v_readfirstlane_b32 s38,v23
s_and_b32 s37,s38,2147483648
v_mfma_f32_32x32x16_bf16 v[72:87],v[244:247],v[44:47],v[72:87]
s_and_b32 s33,s38,1
s_cselect_b32 s34,s79,s78
s_cmp_lg_u32 s42,0
v_mfma_f32_32x32x16_bf16 v[56:71],a[152:155],v[48:51],v[56:71]
ds_read_b128 v[36:39],v19 offset:2048
v_mfma_f32_32x32x16_bf16 v[72:87],v[248:251],v[48:51],v[72:87]
v_mfma_f32_32x32x16_bf16 v[56:71],a[156:159],v[52:55],v[56:71]
ds_read_b128 v[40:43],v18 offset:4096
v_mfma_f32_32x32x16_bf16 v[72:87],v[252:255],v[52:55],v[72:87]
s_cbranch_scc1 QKVQ_S0
QKVQ_B1:
s_waitcnt lgkmcnt(3)
v_mfma_f32_32x32x16_bf16 v[88:103],a[0:3],v[24:27],0
ds_read_b128 v[44:47],v19 offset:4096
v_add_u32 v189,s57,v188
v_mfma_f32_32x32x16_bf16 v[104:119],a[160:163],v[24:27],0
v_add_u32 v8,0x800,v189
s_sub_u32 s66,46080,s57
s_lshl_b32 s60,s33,6
s_add_u32 s60,s60,s34
s_mul_i32 s60,s60,46080
s_add_u32 s60,s60,s37
v_mfma_f32_32x32x16_bf16 v[88:103],a[4:7],v[28:31],v[88:103]
ds_read_b128 v[48:51],v18 offset:6144
ds_read2_b64 v[156:159],v189 offset0:0 offset1:32
s_add_u32 s60,s60,206569472
s_lshl_b32 s62,s46,10
v_mfma_f32_32x32x16_bf16 v[104:119],a[164:167],v[28:31],v[104:119]
ds_read2_b64 v[160:163],v189 offset0:64 offset1:96
s_add_u32 s62,s62,40960
s_add_u32 m0,s66,s62
s_add_u32 s63,s60,s62
s_waitcnt lgkmcnt(5)
v_mfma_f32_32x32x16_bf16 v[88:103],a[8:11],v[32:35],v[88:103]
ds_read_b128 v[52:55],v19 offset:6144
ds_read2_b64 v[164:167],v189 offset0:128 offset1:160
buffer_load_dwordx4 v1,s[8:11],s63 offen sc1 lds
v_mfma_f32_32x32x16_bf16 v[104:119],a[168:171],v[32:35],v[104:119]
ds_read2_b64 v[168:171],v189 offset0:192 offset1:224
s_add_u32 m0,s66,45056
s_add_u32 s63,s60,45056
s_mul_i32 s74,s73,393216
s_add_u32 s74,s74,s39
v_mfma_f32_32x32x16_bf16 v[88:103],a[12:15],v[36:39],v[88:103]
ds_read_b128 v[24:27],v18 offset:8192
ds_read2_b64 v[172:175],v8 offset0:0 offset1:32
s_add_u32 s74,s74,s70
v_fma_f32 v56,-v176,v120,v56
v_mfma_f32_32x32x16_bf16 v[104:119],a[172:175],v[36:39],v[104:119]
buffer_load_dwordx4 v1,s[8:11],s63 offen sc1 lds
s_mul_i32 s61,s46,10240
s_add_u32 s60,s60,s61
s_add_u32 s61,s61,s66
s_waitcnt lgkmcnt(8)
v_mfma_f32_32x32x16_bf16 v[88:103],a[16:19],v[40:43],v[88:103]
ds_read_b128 v[28:31],v19 offset:8192
s_add_u32 m0,s61,0
s_add_u32 s63,s60,0
v_fma_f32 v57,-v176,v121,v57
v_fma_f32 v58,-v176,v122,v58
v_mfma_f32_32x32x16_bf16 v[104:119],a[176:179],v[40:43],v[104:119]
v_fma_f32 v59,-v176,v123,v59
v_fma_f32 v60,-v176,v124,v60
v_fma_f32 v61,-v176,v125,v61
v_fma_f32 v62,-v176,v126,v62
v_fma_f32 v63,-v176,v127,v63
v_mfma_f32_32x32x16_bf16 v[88:103],a[20:23],v[44:47],v[88:103]
ds_read_b128 v[32:35],v18 offset:10240
buffer_load_dwordx4 v1,s[8:11],s63 offen sc1 lds
v_mul_f32 v56,v56,v177
v_mul_f32 v57,v57,v177
v_mfma_f32_32x32x16_bf16 v[104:119],a[180:183],v[44:47],v[104:119]
v_mul_f32 v58,v58,v177
v_mul_f32 v59,v59,v177
v_mul_f32 v60,v60,v177
v_mul_f32 v61,v61,v177
v_mul_f32 v62,v62,v177
s_waitcnt lgkmcnt(6)
v_mfma_f32_32x32x16_bf16 v[88:103],a[24:27],v[48:51],v[88:103]
ds_read_b128 v[36:39],v19 offset:10240
v_mul_f32 v63,v63,v177
v_cvt_pk_bf16_f32 v180,v56,v57
v_cvt_pk_bf16_f32 v181,v58,v59
v_cvt_pk_bf16_f32 v182,v60,v61
v_mfma_f32_32x32x16_bf16 v[104:119],a[184:187],v[48:51],v[104:119]
buffer_load_dwordx4 v1,s[8:11],s63 offen offset:1024 sc1 lds
v_cvt_pk_bf16_f32 v183,v62,v63
buffer_store_dwordx4 v[180:183],v20,s[8:11],s74 offen sc1
v_fma_f32 v64,-v176,v128,v64
v_mfma_f32_32x32x16_bf16 v[88:103],a[28:31],v[52:55],v[88:103]
ds_read_b128 v[40:43],v18 offset:12288
v_fma_f32 v65,-v176,v129,v65
v_fma_f32 v66,-v176,v130,v66
v_fma_f32 v67,-v176,v131,v67
v_fma_f32 v68,-v176,v132,v68
v_mfma_f32_32x32x16_bf16 v[104:119],a[188:191],v[52:55],v[104:119]
v_fma_f32 v69,-v176,v133,v69
v_fma_f32 v70,-v176,v134,v70
v_fma_f32 v71,-v176,v135,v71
v_mul_f32 v64,v64,v177
v_mul_f32 v65,v65,v177
s_waitcnt lgkmcnt(3)
v_mfma_f32_32x32x16_bf16 v[88:103],a[32:35],v[24:27],v[88:103]
ds_read_b128 v[44:47],v19 offset:12288
buffer_load_dwordx4 v1,s[8:11],s63 offen offset:2048 sc1 lds
v_mul_f32 v66,v66,v177
v_mul_f32 v67,v67,v177
v_mfma_f32_32x32x16_bf16 v[104:119],a[192:195],v[24:27],v[104:119]
v_mul_f32 v68,v68,v177
v_mul_f32 v69,v69,v177
v_mul_f32 v70,v70,v177
v_mul_f32 v71,v71,v177
v_cvt_pk_bf16_f32 v184,v64,v65
v_mfma_f32_32x32x16_bf16 v[88:103],a[36:39],v[28:31],v[88:103]
ds_read_b128 v[48:51],v18 offset:14336
v_cvt_pk_bf16_f32 v185,v66,v67
v_cvt_pk_bf16_f32 v186,v68,v69
v_cvt_pk_bf16_f32 v187,v70,v71
v_mfma_f32_32x32x16_bf16 v[104:119],a[196:199],v[28:31],v[104:119]
buffer_load_dwordx4 v1,s[8:11],s63 offen offset:3072 sc1 lds
s_add_u32 m0,s61,4096
s_add_u32 s63,s60,4096
s_waitcnt lgkmcnt(3)
v_mfma_f32_32x32x16_bf16 v[88:103],a[40:43],v[32:35],v[88:103]
ds_read_b128 v[52:55],v19 offset:14336
buffer_store_dwordx4 v[184:187],v21,s[8:11],s74 offen sc1
v_fma_f32 v72,-v176,v136,v72
v_fma_f32 v73,-v176,v137,v73
v_mfma_f32_32x32x16_bf16 v[104:119],a[200:203],v[32:35],v[104:119]
v_fma_f32 v74,-v176,v138,v74
v_fma_f32 v75,-v176,v139,v75
v_fma_f32 v76,-v176,v140,v76
v_fma_f32 v77,-v176,v141,v77
v_fma_f32 v78,-v176,v142,v78
v_mfma_f32_32x32x16_bf16 v[88:103],a[44:47],v[36:39],v[88:103]
ds_read_b128 v[24:27],v18 offset:16384
buffer_load_dwordx4 v1,s[8:11],s63 offen sc1 lds
v_fma_f32 v79,-v176,v143,v79
v_mul_f32 v72,v72,v177
v_mfma_f32_32x32x16_bf16 v[104:119],a[204:207],v[36:39],v[104:119]
v_mul_f32 v73,v73,v177
v_mul_f32 v74,v74,v177
v_mul_f32 v75,v75,v177
v_mul_f32 v76,v76,v177
v_mul_f32 v77,v77,v177
s_waitcnt lgkmcnt(3)
v_mfma_f32_32x32x16_bf16 v[88:103],a[48:51],v[40:43],v[88:103]
ds_read_b128 v[28:31],v19 offset:16384
v_mul_f32 v78,v78,v177
v_mul_f32 v79,v79,v177
v_cvt_pk_bf16_f32 v180,v72,v73
v_cvt_pk_bf16_f32 v181,v74,v75
v_mfma_f32_32x32x16_bf16 v[104:119],a[208:211],v[40:43],v[104:119]
buffer_load_dwordx4 v1,s[8:11],s63 offen offset:1024 sc1 lds
v_cvt_pk_bf16_f32 v182,v76,v77
v_cvt_pk_bf16_f32 v183,v78,v79
buffer_store_dwordx4 v[180:183],v20,s[8:11],s74 offen offset:2048 sc1
v_mfma_f32_32x32x16_bf16 v[88:103],a[52:55],v[44:47],v[88:103]
ds_read_b128 v[32:35],v18 offset:18432
v_fma_f32 v80,-v176,v144,v80
v_fma_f32 v81,-v176,v145,v81
v_fma_f32 v82,-v176,v146,v82
v_fma_f32 v83,-v176,v147,v83
v_mfma_f32_32x32x16_bf16 v[104:119],a[212:215],v[44:47],v[104:119]
v_fma_f32 v84,-v176,v148,v84
v_fma_f32 v85,-v176,v149,v85
v_fma_f32 v86,-v176,v150,v86
v_fma_f32 v87,-v176,v151,v87
v_mul_f32 v80,v80,v177
s_waitcnt lgkmcnt(3)
v_mfma_f32_32x32x16_bf16 v[88:103],a[56:59],v[48:51],v[88:103]
ds_read_b128 v[36:39],v19 offset:18432
buffer_load_dwordx4 v1,s[8:11],s63 offen offset:2048 sc1 lds
v_mul_f32 v81,v81,v177
v_mul_f32 v82,v82,v177
v_mfma_f32_32x32x16_bf16 v[104:119],a[216:219],v[48:51],v[104:119]
v_mul_f32 v83,v83,v177
v_mul_f32 v84,v84,v177
v_mul_f32 v85,v85,v177
v_mul_f32 v86,v86,v177
v_mul_f32 v87,v87,v177
v_mfma_f32_32x32x16_bf16 v[88:103],a[60:63],v[52:55],v[88:103]
ds_read_b128 v[40:43],v18 offset:20480
s_waitcnt vmcnt(12)
s_mov_b64 exec,1
buffer_store_dword v5,v1,s[8:11],s59 offen sc1
s_mov_b64 exec,-1
s_mov_b32 s59,2147483648
v_mfma_f32_32x32x16_bf16 v[104:119],a[220:223],v[52:55],v[104:119]
buffer_load_dwordx4 v1,s[8:11],s63 offen offset:3072 sc1 lds
s_add_u32 m0,s61,8192
s_add_u32 s63,s60,8192
v_cvt_pk_bf16_f32 v184,v80,v81
s_waitcnt lgkmcnt(3)
v_mfma_f32_32x32x16_bf16 v[88:103],a[64:67],v[24:27],v[88:103]
ds_read_b128 v[44:47],v19 offset:20480
v_cvt_pk_bf16_f32 v185,v82,v83
v_cvt_pk_bf16_f32 v186,v84,v85
v_cvt_pk_bf16_f32 v187,v86,v87
v_mfma_f32_32x32x16_bf16 v[104:119],a[224:227],v[24:27],v[104:119]
buffer_store_dwordx4 v[184:187],v21,s[8:11],s74 offen offset:2048 sc1
s_lshl_b32 s82,s72,6
s_add_u32 s82,s82,s73
s_lshl_b32 s82,s82,9
s_add_u32 s82,s82,s71
v_mfma_f32_32x32x16_bf16 v[88:103],a[68:71],v[28:31],v[88:103]
ds_read_b128 v[48:51],v18 offset:22528
buffer_load_dwordx4 v1,s[8:11],s63 offen sc1 lds
s_lshl_b32 s75,s69,2
s_add_u32 s82,s82,s75
v_mfma_f32_32x32x16_bf16 v[104:119],a[228:231],v[28:31],v[104:119]
s_add_u32 s82,s82,s39
v_add_f32 v156,v156,v166
v_add_f32 v157,v157,v167
v_add_f32 v158,v158,v168
s_waitcnt lgkmcnt(3)
v_mfma_f32_32x32x16_bf16 v[88:103],a[72:75],v[32:35],v[88:103]
ds_read_b128 v[52:55],v19 offset:22528
v_add_f32 v159,v159,v169
v_add_f32 v160,v160,v170
v_add_f32 v161,v161,v171
v_add_f32 v162,v162,v172
v_mfma_f32_32x32x16_bf16 v[104:119],a[232:235],v[32:35],v[104:119]
buffer_load_dwordx4 v1,s[8:11],s63 offen offset:1024 sc1 lds
s_mov_b32 s53,s33
s_mov_b32 s54,s34
s_add_u32 s79,s79,s33
s_or_b32 s60,s37,s33
v_mfma_f32_32x32x16_bf16 v[88:103],a[76:79],v[36:39],v[88:103]
ds_read_b128 v[24:27],v18 offset:24576
s_cmp_eq_u32 s60,0
s_addc_u32 s78,s78,0
s_lshl_b32 s41,s78,9
s_add_u32 s41,s41,s40
v_mfma_f32_32x32x16_bf16 v[104:119],a[236:239],v[36:39],v[104:119]
s_lshl_b32 s35,s79,9
s_add_u32 s35,s35,s40
s_add_u32 s35,s35,32768
v_add_f32 v163,v163,v173
v_add_f32 v164,v164,v174
s_waitcnt lgkmcnt(3)
v_mfma_f32_32x32x16_bf16 v[88:103],a[80:83],v[40:43],v[88:103]
ds_read_b128 v[28:31],v19 offset:24576
v_add_f32 v165,v165,v175
v_add_f32 v156,v156,v158
v_add_f32 v157,v157,v159
v_add_f32 v160,v160,v162
v_mfma_f32_32x32x16_bf16 v[104:119],a[240:243],v[40:43],v[104:119]
v_add_f32 v161,v161,v163
v_add_f32 v156,v156,v160
v_add_f32 v157,v157,v161
v_add_f32 v156,v156,v164
v_add_f32 v157,v157,v165
v_mfma_f32_32x32x16_bf16 v[88:103],a[84:87],v[44:47],v[88:103]
ds_read_b128 v[32:35],v18 offset:26624
v_mov_b32 v158,v156
v_mov_b32 v159,v157
s_nop 0
v_permlane32_swap_b32 v156,v158
v_permlane32_swap_b32 v157,v159
v_mfma_f32_32x32x16_bf16 v[104:119],a[244:247],v[44:47],v[104:119]
v_add_f32 v176,v156,v158
v_add_f32 v177,v157,v159
v_mul_f32 v176,0x3acccccd,v176
v_mul_f32 v177,0x3acccccd,v177
v_fma_f32 v177,-v176,v176,v177
s_waitcnt lgkmcnt(3)
v_mfma_f32_32x32x16_bf16 v[88:103],a[88:91],v[48:51],v[88:103]
ds_read_b128 v[36:39],v19 offset:26624
buffer_load_dword v3,v2,s[8:11],s35 offen sc1
buffer_load_dword v14,v4,s[8:11],s41 offen sc1
v_mfma_f32_32x32x16_bf16 v[104:119],a[248:251],v[48:51],v[104:119]
v_max_f32 v177,0,v177
v_cvt_pk_bf16_f32 v8,v176,v177
v_lshlrev_b32 v176,16,v8
v_and_b32 v177,0xffff0000,v8
v_add_f32 v177,0x3727c5ac,v177
v_mfma_f32_32x32x16_bf16 v[88:103],a[92:95],v[52:55],v[88:103]
ds_read_b128 v[40:43],v18 offset:28672
v_cvt_pk_bf16_f32 v8,v177,v177
v_lshlrev_b32 v177,16,v8
v_sqrt_f32 v177,v177
v_mfma_f32_32x32x16_bf16 v[104:119],a[252:255],v[52:55],v[104:119]
v_cvt_pk_bf16_f32 v8,v177,v177
v_lshlrev_b32 v177,16,v8
v_rcp_f32 v177,v177
s_waitcnt lgkmcnt(3)
v_mfma_f32_32x32x16_bf16 v[88:103],a[96:99],v[24:27],v[88:103]
ds_read_b128 v[44:47],v19 offset:28672
s_cmp_eq_u32 s51,0
s_cselect_b64 s[76:77],-1,0
v_cndmask_b32 v176,v176,0,s[76:77]
v_cndmask_b32 v177,v177,1.0,s[76:77]
v_mfma_f32_32x32x16_bf16 v[104:119],v[192:195],v[24:27],v[104:119]
s_mov_b32 s72,s51
s_mov_b32 s73,s52
v_mfma_f32_32x32x16_bf16 v[88:103],a[100:103],v[28:31],v[88:103]
ds_read_b128 v[48:51],v18 offset:30720
v_mfma_f32_32x32x16_bf16 v[104:119],v[196:199],v[28:31],v[104:119]
s_waitcnt lgkmcnt(3)
v_mfma_f32_32x32x16_bf16 v[88:103],a[104:107],v[32:35],v[88:103]
ds_read_b128 v[52:55],v19 offset:30720
v_mfma_f32_32x32x16_bf16 v[104:119],v[200:203],v[32:35],v[104:119]
v_mfma_f32_32x32x16_bf16 v[88:103],a[108:111],v[36:39],v[88:103]
ds_read_b128 v[24:27],v18 offset:32768
v_mfma_f32_32x32x16_bf16 v[104:119],v[204:207],v[36:39],v[104:119]
s_waitcnt lgkmcnt(3)
v_mfma_f32_32x32x16_bf16 v[88:103],a[112:115],v[40:43],v[88:103]
ds_read_b128 v[28:31],v19 offset:32768
v_mfma_f32_32x32x16_bf16 v[104:119],v[208:211],v[40:43],v[104:119]
v_mfma_f32_32x32x16_bf16 v[88:103],a[116:119],v[44:47],v[88:103]
ds_read_b128 v[32:35],v18 offset:34816
s_waitcnt vmcnt(4)
s_mov_b64 exec,1
buffer_store_dword v5,v1,s[8:11],s82 offen sc1
s_mov_b64 exec,-1
s_mov_b32 s82,2147483648
v_mfma_f32_32x32x16_bf16 v[104:119],v[212:215],v[44:47],v[104:119]
s_waitcnt lgkmcnt(3)
v_mfma_f32_32x32x16_bf16 v[88:103],a[120:123],v[48:51],v[88:103]
ds_read_b128 v[36:39],v19 offset:34816
v_mfma_f32_32x32x16_bf16 v[104:119],v[216:219],v[48:51],v[104:119]
v_mfma_f32_32x32x16_bf16 v[88:103],a[124:127],v[52:55],v[88:103]
ds_read_b128 v[40:43],v18 offset:36864
s_waitcnt vmcnt(1)
v_cmp_eq_u32 vcc,0,v14
s_cmp_eq_u64 vcc,0
s_cselect_b32 s36,0,2147483648
v_mfma_f32_32x32x16_bf16 v[104:119],v[220:223],v[52:55],v[104:119]
v_cmp_eq_u32 vcc,0,v3
s_cmp_lt_u32 s78,64
s_cselect_b32 s36,s36,2147483648
s_cmp_eq_u64 vcc,0
s_cselect_b32 s60,1,s36
s_waitcnt lgkmcnt(3)
v_mfma_f32_32x32x16_bf16 v[88:103],a[128:131],v[24:27],v[88:103]
ds_read_b128 v[44:47],v19 offset:36864
s_cmp_lt_u32 s79,64
s_cselect_b32 s60,s60,s36
s_sub_u32 s61,s78,s79
s_or_b32 s61,s61,s36
v_mfma_f32_32x32x16_bf16 v[104:119],v[224:227],v[24:27],v[104:119]
s_cmp_lt_u32 s61,16
s_cselect_b32 s36,0,s60
v_mov_b32 v23,s36
ds_write_b32 v13,v23
v_mfma_f32_32x32x16_bf16 v[88:103],a[132:135],v[28:31],v[88:103]
ds_read_b128 v[48:51],v18 offset:38912
v_mfma_f32_32x32x16_bf16 v[104:119],v[228:231],v[28:31],v[104:119]
s_waitcnt lgkmcnt(4)
v_mfma_f32_32x32x16_bf16 v[88:103],a[136:139],v[32:35],v[88:103]
ds_read_b128 v[52:55],v19 offset:38912
v_mfma_f32_32x32x16_bf16 v[104:119],v[232:235],v[32:35],v[104:119]
s_waitcnt lgkmcnt(2)
s_barrier
ds_read_b32 v23,v22
v_mfma_f32_32x32x16_bf16 v[88:103],a[140:143],v[36:39],v[88:103]
ds_read_b128 v[24:27],v16 offset:0
s_cmp_lt_u32 s50,2
s_cselect_b32 s42,1,0
s_or_b32 s42,s42,s37
s_mov_b32 s39,0
v_mfma_f32_32x32x16_bf16 v[104:119],v[236:239],v[36:39],v[104:119]
s_add_u32 s50,s50,1
s_sub_u32 s57,46080,s57
s_mov_b32 s51,s53
s_mov_b32 s52,s54
v_mfma_f32_32x32x16_bf16 v[88:103],a[144:147],v[40:43],v[88:103]
ds_read_b128 v[28:31],v17 offset:0
v_mfma_f32_32x32x16_bf16 v[104:119],v[240:243],v[40:43],v[104:119]
v_mfma_f32_32x32x16_bf16 v[88:103],a[148:151],v[44:47],v[88:103]
ds_read_b128 v[32:35],v16 offset:2048
s_waitcnt lgkmcnt(3)
v_readfirstlane_b32 s38,v23
s_and_b32 s37,s38,2147483648
v_mfma_f32_32x32x16_bf16 v[104:119],v[244:247],v[44:47],v[104:119]
s_and_b32 s33,s38,1
s_cselect_b32 s34,s79,s78
s_cmp_lg_u32 s42,0
v_mfma_f32_32x32x16_bf16 v[88:103],a[152:155],v[48:51],v[88:103]
ds_read_b128 v[36:39],v17 offset:2048
v_mfma_f32_32x32x16_bf16 v[104:119],v[248:251],v[48:51],v[104:119]
v_mfma_f32_32x32x16_bf16 v[88:103],a[156:159],v[52:55],v[88:103]
ds_read_b128 v[40:43],v16 offset:4096
v_mfma_f32_32x32x16_bf16 v[104:119],v[252:255],v[52:55],v[104:119]
s_cbranch_scc0 QKVQ_B0
s_branch QKVQ_S1
s_nop 9
QKVQ_S0:
s_mov_b32 s55,0
s_cmp_lt_u32 s42,2
s_cbranch_scc1 nt_219
s_mov_b32 s55,2
s_cmp_lg_u32 s37,0
s_cbranch_scc1 nt_219
s_mov_b32 s55,1
s_lshl_b32 s60,s33,6
s_add_u32 s60,s60,s34
s_mul_i32 s60,s60,46080
s_add_u32 s60,s60,206569472
s_lshl_b32 s62,s46,10
s_add_u32 s62,s62,40960
s_add_u32 m0,s57,s62
s_add_u32 s63,s60,s62
buffer_load_dwordx4 v1,s[8:11],s63 offen sc1 lds
s_add_u32 m0,s57,45056
s_add_u32 s63,s60,45056
buffer_load_dwordx4 v1,s[8:11],s63 offen sc1 lds
s_mul_i32 s61,s46,10240
s_add_u32 s60,s60,s61
s_add_u32 s61,s61,s57
s_add_u32 m0,s61,0
s_add_u32 s63,s60,0
buffer_load_dwordx4 v1,s[8:11],s63 offen sc1 lds
buffer_load_dwordx4 v1,s[8:11],s63 offen offset:1024 sc1 lds
buffer_load_dwordx4 v1,s[8:11],s63 offen offset:2048 sc1 lds
buffer_load_dwordx4 v1,s[8:11],s63 offen offset:3072 sc1 lds
s_add_u32 m0,s61,4096
s_add_u32 s63,s60,4096
buffer_load_dwordx4 v1,s[8:11],s63 offen sc1 lds
buffer_load_dwordx4 v1,s[8:11],s63 offen offset:1024 sc1 lds
buffer_load_dwordx4 v1,s[8:11],s63 offen offset:2048 sc1 lds
buffer_load_dwordx4 v1,s[8:11],s63 offen offset:3072 sc1 lds
s_add_u32 m0,s61,8192
s_add_u32 s63,s60,8192
buffer_load_dwordx4 v1,s[8:11],s63 offen sc1 lds
buffer_load_dwordx4 v1,s[8:11],s63 offen offset:1024 sc1 lds
nt_219:
s_nop 4
s_mul_i32 s74,s73,393216
s_add_u32 s74,s74,s39
s_add_u32 s74,s74,s70
v_fma_f32 v56,-v176,v120,v56
v_fma_f32 v57,-v176,v121,v57
v_fma_f32 v58,-v176,v122,v58
v_fma_f32 v59,-v176,v123,v59
v_fma_f32 v60,-v176,v124,v60
v_fma_f32 v61,-v176,v125,v61
v_fma_f32 v62,-v176,v126,v62
v_fma_f32 v63,-v176,v127,v63
v_mul_f32 v56,v56,v177
v_mul_f32 v57,v57,v177
v_mul_f32 v58,v58,v177
v_mul_f32 v59,v59,v177
v_mul_f32 v60,v60,v177
v_mul_f32 v61,v61,v177
v_mul_f32 v62,v62,v177
v_mul_f32 v63,v63,v177
v_cvt_pk_bf16_f32 v180,v56,v57
v_cvt_pk_bf16_f32 v181,v58,v59
v_cvt_pk_bf16_f32 v182,v60,v61
v_cvt_pk_bf16_f32 v183,v62,v63
buffer_store_dwordx4 v[180:183],v20,s[8:11],s74 offen sc1
v_fma_f32 v64,-v176,v128,v64
v_fma_f32 v65,-v176,v129,v65
v_fma_f32 v66,-v176,v130,v66
v_fma_f32 v67,-v176,v131,v67
v_fma_f32 v68,-v176,v132,v68
v_fma_f32 v69,-v176,v133,v69
v_fma_f32 v70,-v176,v134,v70
v_fma_f32 v71,-v176,v135,v71
v_mul_f32 v64,v64,v177
v_mul_f32 v65,v65,v177
v_mul_f32 v66,v66,v177
v_mul_f32 v67,v67,v177
v_mul_f32 v68,v68,v177
v_mul_f32 v69,v69,v177
v_mul_f32 v70,v70,v177
v_mul_f32 v71,v71,v177
v_cvt_pk_bf16_f32 v184,v64,v65
v_cvt_pk_bf16_f32 v185,v66,v67
v_cvt_pk_bf16_f32 v186,v68,v69
v_cvt_pk_bf16_f32 v187,v70,v71
buffer_store_dwordx4 v[184:187],v21,s[8:11],s74 offen sc1
v_fma_f32 v72,-v176,v136,v72
v_fma_f32 v73,-v176,v137,v73
v_fma_f32 v74,-v176,v138,v74
v_fma_f32 v75,-v176,v139,v75
v_fma_f32 v76,-v176,v140,v76
v_fma_f32 v77,-v176,v141,v77
v_fma_f32 v78,-v176,v142,v78
v_fma_f32 v79,-v176,v143,v79
v_mul_f32 v72,v72,v177
v_mul_f32 v73,v73,v177
v_mul_f32 v74,v74,v177
v_mul_f32 v75,v75,v177
v_mul_f32 v76,v76,v177
v_mul_f32 v77,v77,v177
v_mul_f32 v78,v78,v177
v_mul_f32 v79,v79,v177
v_cvt_pk_bf16_f32 v180,v72,v73
v_cvt_pk_bf16_f32 v181,v74,v75
v_cvt_pk_bf16_f32 v182,v76,v77
v_cvt_pk_bf16_f32 v183,v78,v79
buffer_store_dwordx4 v[180:183],v20,s[8:11],s74 offen offset:2048 sc1
v_fma_f32 v80,-v176,v144,v80
v_fma_f32 v81,-v176,v145,v81
v_fma_f32 v82,-v176,v146,v82
v_fma_f32 v83,-v176,v147,v83
v_fma_f32 v84,-v176,v148,v84
v_fma_f32 v85,-v176,v149,v85
v_fma_f32 v86,-v176,v150,v86
v_fma_f32 v87,-v176,v151,v87
v_mul_f32 v80,v80,v177
v_mul_f32 v81,v81,v177
v_mul_f32 v82,v82,v177
v_mul_f32 v83,v83,v177
v_mul_f32 v84,v84,v177
v_mul_f32 v85,v85,v177
v_mul_f32 v86,v86,v177
v_mul_f32 v87,v87,v177
v_cvt_pk_bf16_f32 v184,v80,v81
v_cvt_pk_bf16_f32 v185,v82,v83
v_cvt_pk_bf16_f32 v186,v84,v85
v_cvt_pk_bf16_f32 v187,v86,v87
buffer_store_dwordx4 v[184:187],v21,s[8:11],s74 offen offset:2048 sc1
s_lshl_b32 s82,s72,6
s_add_u32 s82,s82,s73
s_lshl_b32 s82,s82,9
s_add_u32 s82,s82,s71
s_lshl_b32 s75,s69,2
s_add_u32 s82,s82,s75
s_add_u32 s82,s82,s39
s_mov_b32 s59,s82
s_mov_b32 s82,2147483648
s_mov_b32 s39,2147483648
s_cmp_eq_u32 s55,0
s_cbranch_scc1 QKVQ_B1
s_cmp_eq_u32 s55,1
s_cbranch_scc1 QKVQ_CD1
s_waitcnt vmcnt(0)
s_mov_b64 exec,1
buffer_store_dword v5,v1,s[8:11],s59 offen sc1
s_mov_b64 exec,-1
s_mov_b32 s59,2147483648
s_cmp_eq_u32 s50,128
s_cbranch_scc1 QKVQ_END
s_branch QKVQ_COLD1
QKVQ_COLD0:
s_cmp_lg_u32 s46,0
s_cbranch_scc1 cp_220
ct_221:
buffer_load_dword v3,v2,s[8:11],s35 offen sc1
buffer_load_dword v14,v4,s[8:11],s41 offen sc1
s_waitcnt vmcnt(0)
v_cmp_eq_u32 vcc,0,v14
s_cmp_eq_u64 vcc,0
s_cselect_b32 s36,0,2147483648
v_cmp_eq_u32 vcc,0,v3
s_cmp_lt_u32 s78,64
s_cselect_b32 s36,s36,2147483648
s_cmp_eq_u64 vcc,0
s_cselect_b32 s60,1,s36
s_cmp_lt_u32 s79,64
s_cselect_b32 s60,s60,s36
s_sub_u32 s61,s78,s79
s_or_b32 s61,s61,s36
s_cmp_lt_u32 s61,16
s_cselect_b32 s36,0,s60
v_mov_b32 v23,s36
s_cmp_lt_u32 s36,2
s_cbranch_scc1 ct_221x
s_sleep 3
s_sub_u32 s47,s47,1
s_cbranch_scc1 ABORT
s_branch ct_221
ct_221x:
ds_write_b32 v22,v23 offset:4
s_waitcnt lgkmcnt(0)
cp_220:
s_barrier
ds_read_b32 v23,v22 offset:4
s_waitcnt lgkmcnt(0)
v_readfirstlane_b32 s38,v23
s_and_b32 s38,s38,1
s_and_b32 s37,s38,2147483648
s_and_b32 s33,s38,1
s_cselect_b32 s34,s79,s78
s_lshl_b32 s60,s33,6
s_add_u32 s60,s60,s34
s_mul_i32 s60,s60,46080
s_add_u32 s60,s60,206569472
s_lshl_b32 s62,s46,10
s_add_u32 s62,s62,40960
s_add_u32 m0,s57,s62
s_add_u32 s63,s60,s62
buffer_load_dwordx4 v1,s[8:11],s63 offen sc1 lds
s_add_u32 m0,s57,45056
s_add_u32 s63,s60,45056
buffer_load_dwordx4 v1,s[8:11],s63 offen sc1 lds
s_mul_i32 s61,s46,10240
s_add_u32 s60,s60,s61
s_add_u32 s61,s61,s57
s_add_u32 m0,s61,0
s_add_u32 s63,s60,0
buffer_load_dwordx4 v1,s[8:11],s63 offen sc1 lds
buffer_load_dwordx4 v1,s[8:11],s63 offen offset:1024 sc1 lds
buffer_load_dwordx4 v1,s[8:11],s63 offen offset:2048 sc1 lds
buffer_load_dwordx4 v1,s[8:11],s63 offen offset:3072 sc1 lds
s_add_u32 m0,s61,4096
s_add_u32 s63,s60,4096
buffer_load_dwordx4 v1,s[8:11],s63 offen sc1 lds
buffer_load_dwordx4 v1,s[8:11],s63 offen offset:1024 sc1 lds
buffer_load_dwordx4 v1,s[8:11],s63 offen offset:2048 sc1 lds
buffer_load_dwordx4 v1,s[8:11],s63 offen offset:3072 sc1 lds
s_add_u32 m0,s61,8192
s_add_u32 s63,s60,8192
buffer_load_dwordx4 v1,s[8:11],s63 offen sc1 lds
buffer_load_dwordx4 v1,s[8:11],s63 offen offset:1024 sc1 lds
QKVQ_CD0:
s_mov_b32 s51,s33
s_mov_b32 s52,s34
s_mov_b32 s53,s33
s_mov_b32 s54,s34
s_add_u32 s79,s79,s33
s_or_b32 s60,s37,s33
s_cmp_eq_u32 s60,0
s_addc_u32 s78,s78,0
s_lshl_b32 s41,s78,9
s_add_u32 s41,s41,s40
s_lshl_b32 s35,s79,9
s_add_u32 s35,s35,s40
s_add_u32 s35,s35,32768
buffer_load_dword v3,v2,s[8:11],s35 offen sc1
buffer_load_dword v14,v4,s[8:11],s41 offen sc1
s_waitcnt vmcnt(0)
s_mov_b64 exec,1
buffer_store_dword v5,v1,s[8:11],s59 offen sc1
s_mov_b64 exec,-1
s_mov_b32 s59,2147483648
v_cmp_eq_u32 vcc,0,v14
s_cmp_eq_u64 vcc,0
s_cselect_b32 s36,0,2147483648
v_cmp_eq_u32 vcc,0,v3
s_cmp_lt_u32 s78,64
s_cselect_b32 s36,s36,2147483648
s_cmp_eq_u64 vcc,0
s_cselect_b32 s60,1,s36
s_cmp_lt_u32 s79,64
s_cselect_b32 s60,s60,s36
s_sub_u32 s61,s78,s79
s_or_b32 s61,s61,s36
s_cmp_lt_u32 s61,16
s_cselect_b32 s36,0,s60
v_mov_b32 v23,s36
ds_write_b32 v13,v23
s_waitcnt lgkmcnt(0)
s_barrier
ds_read_b32 v23,v22
ds_read_b128 v[24:27],v16 offset:0
ds_read_b128 v[28:31],v17 offset:0
ds_read_b128 v[32:35],v16 offset:2048
ds_read_b128 v[36:39],v17 offset:2048
ds_read_b128 v[40:43],v16 offset:4096
s_waitcnt lgkmcnt(5)
v_readfirstlane_b32 s38,v23
s_and_b32 s37,s38,2147483648
s_and_b32 s33,s38,1
s_cselect_b32 s34,s79,s78
s_nop 0
s_branch QKVQ_B0
QKVQ_S1:
s_mov_b32 s55,0
s_cmp_lt_u32 s42,2
s_cbranch_scc1 nt_222
s_mov_b32 s55,2
s_cmp_lg_u32 s37,0
s_cbranch_scc1 nt_222
s_mov_b32 s55,1
s_lshl_b32 s60,s33,6
s_add_u32 s60,s60,s34
s_mul_i32 s60,s60,46080
s_add_u32 s60,s60,206569472
s_lshl_b32 s62,s46,10
s_add_u32 s62,s62,40960
s_add_u32 m0,s57,s62
s_add_u32 s63,s60,s62
buffer_load_dwordx4 v1,s[8:11],s63 offen sc1 lds
s_add_u32 m0,s57,45056
s_add_u32 s63,s60,45056
buffer_load_dwordx4 v1,s[8:11],s63 offen sc1 lds
s_mul_i32 s61,s46,10240
s_add_u32 s60,s60,s61
s_add_u32 s61,s61,s57
s_add_u32 m0,s61,0
s_add_u32 s63,s60,0
buffer_load_dwordx4 v1,s[8:11],s63 offen sc1 lds
buffer_load_dwordx4 v1,s[8:11],s63 offen offset:1024 sc1 lds
buffer_load_dwordx4 v1,s[8:11],s63 offen offset:2048 sc1 lds
buffer_load_dwordx4 v1,s[8:11],s63 offen offset:3072 sc1 lds
s_add_u32 m0,s61,4096
s_add_u32 s63,s60,4096
buffer_load_dwordx4 v1,s[8:11],s63 offen sc1 lds
buffer_load_dwordx4 v1,s[8:11],s63 offen offset:1024 sc1 lds
buffer_load_dwordx4 v1,s[8:11],s63 offen offset:2048 sc1 lds
buffer_load_dwordx4 v1,s[8:11],s63 offen offset:3072 sc1 lds
s_add_u32 m0,s61,8192
s_add_u32 s63,s60,8192
buffer_load_dwordx4 v1,s[8:11],s63 offen sc1 lds
buffer_load_dwordx4 v1,s[8:11],s63 offen offset:1024 sc1 lds
nt_222:
s_nop 4
s_mul_i32 s74,s73,393216
s_add_u32 s74,s74,s39
s_add_u32 s74,s74,s70
v_fma_f32 v88,-v176,v120,v88
v_fma_f32 v89,-v176,v121,v89
v_fma_f32 v90,-v176,v122,v90
v_fma_f32 v91,-v176,v123,v91
v_fma_f32 v92,-v176,v124,v92
v_fma_f32 v93,-v176,v125,v93
v_fma_f32 v94,-v176,v126,v94
v_fma_f32 v95,-v176,v127,v95
v_mul_f32 v88,v88,v177
v_mul_f32 v89,v89,v177
v_mul_f32 v90,v90,v177
v_mul_f32 v91,v91,v177
v_mul_f32 v92,v92,v177
v_mul_f32 v93,v93,v177
v_mul_f32 v94,v94,v177
v_mul_f32 v95,v95,v177
v_cvt_pk_bf16_f32 v180,v88,v89
v_cvt_pk_bf16_f32 v181,v90,v91
v_cvt_pk_bf16_f32 v182,v92,v93
v_cvt_pk_bf16_f32 v183,v94,v95
buffer_store_dwordx4 v[180:183],v20,s[8:11],s74 offen sc1
v_fma_f32 v96,-v176,v128,v96
v_fma_f32 v97,-v176,v129,v97
v_fma_f32 v98,-v176,v130,v98
v_fma_f32 v99,-v176,v131,v99
v_fma_f32 v100,-v176,v132,v100
v_fma_f32 v101,-v176,v133,v101
v_fma_f32 v102,-v176,v134,v102
v_fma_f32 v103,-v176,v135,v103
v_mul_f32 v96,v96,v177
v_mul_f32 v97,v97,v177
v_mul_f32 v98,v98,v177
v_mul_f32 v99,v99,v177
v_mul_f32 v100,v100,v177
v_mul_f32 v101,v101,v177
v_mul_f32 v102,v102,v177
v_mul_f32 v103,v103,v177
v_cvt_pk_bf16_f32 v184,v96,v97
v_cvt_pk_bf16_f32 v185,v98,v99
v_cvt_pk_bf16_f32 v186,v100,v101
v_cvt_pk_bf16_f32 v187,v102,v103
buffer_store_dwordx4 v[184:187],v21,s[8:11],s74 offen sc1
v_fma_f32 v104,-v176,v136,v104
v_fma_f32 v105,-v176,v137,v105
v_fma_f32 v106,-v176,v138,v106
v_fma_f32 v107,-v176,v139,v107
v_fma_f32 v108,-v176,v140,v108
v_fma_f32 v109,-v176,v141,v109
v_fma_f32 v110,-v176,v142,v110
v_fma_f32 v111,-v176,v143,v111
v_mul_f32 v104,v104,v177
v_mul_f32 v105,v105,v177
v_mul_f32 v106,v106,v177
v_mul_f32 v107,v107,v177
v_mul_f32 v108,v108,v177
v_mul_f32 v109,v109,v177
v_mul_f32 v110,v110,v177
v_mul_f32 v111,v111,v177
v_cvt_pk_bf16_f32 v180,v104,v105
v_cvt_pk_bf16_f32 v181,v106,v107
v_cvt_pk_bf16_f32 v182,v108,v109
v_cvt_pk_bf16_f32 v183,v110,v111
buffer_store_dwordx4 v[180:183],v20,s[8:11],s74 offen offset:2048 sc1
v_fma_f32 v112,-v176,v144,v112
v_fma_f32 v113,-v176,v145,v113
v_fma_f32 v114,-v176,v146,v114
v_fma_f32 v115,-v176,v147,v115
v_fma_f32 v116,-v176,v148,v116
v_fma_f32 v117,-v176,v149,v117
v_fma_f32 v118,-v176,v150,v118
v_fma_f32 v119,-v176,v151,v119
v_mul_f32 v112,v112,v177
v_mul_f32 v113,v113,v177
v_mul_f32 v114,v114,v177
v_mul_f32 v115,v115,v177
v_mul_f32 v116,v116,v177
v_mul_f32 v117,v117,v177
v_mul_f32 v118,v118,v177
v_mul_f32 v119,v119,v177
v_cvt_pk_bf16_f32 v184,v112,v113
v_cvt_pk_bf16_f32 v185,v114,v115
v_cvt_pk_bf16_f32 v186,v116,v117
v_cvt_pk_bf16_f32 v187,v118,v119
buffer_store_dwordx4 v[184:187],v21,s[8:11],s74 offen offset:2048 sc1
s_lshl_b32 s82,s72,6
s_add_u32 s82,s82,s73
s_lshl_b32 s82,s82,9
s_add_u32 s82,s82,s71
s_lshl_b32 s75,s69,2
s_add_u32 s82,s82,s75
s_add_u32 s82,s82,s39
s_mov_b32 s59,s82
s_mov_b32 s82,2147483648
s_mov_b32 s39,2147483648
s_cmp_eq_u32 s55,0
s_cbranch_scc1 QKVQ_B0
s_cmp_eq_u32 s55,1
s_cbranch_scc1 QKVQ_CD0
s_waitcnt vmcnt(0)
s_mov_b64 exec,1
buffer_store_dword v5,v1,s[8:11],s59 offen sc1
s_mov_b64 exec,-1
s_mov_b32 s59,2147483648
s_cmp_eq_u32 s50,128
s_cbranch_scc1 QKVQ_END
s_branch QKVQ_COLD0
QKVQ_COLD1:
s_cmp_lg_u32 s46,0
s_cbranch_scc1 cp_223
ct_224:
buffer_load_dword v3,v2,s[8:11],s35 offen sc1
buffer_load_dword v14,v4,s[8:11],s41 offen sc1
s_waitcnt vmcnt(0)
v_cmp_eq_u32 vcc,0,v14
s_cmp_eq_u64 vcc,0
s_cselect_b32 s36,0,2147483648
v_cmp_eq_u32 vcc,0,v3
s_cmp_lt_u32 s78,64
s_cselect_b32 s36,s36,2147483648
s_cmp_eq_u64 vcc,0
s_cselect_b32 s60,1,s36
s_cmp_lt_u32 s79,64
s_cselect_b32 s60,s60,s36
s_sub_u32 s61,s78,s79
s_or_b32 s61,s61,s36
s_cmp_lt_u32 s61,16
s_cselect_b32 s36,0,s60
v_mov_b32 v23,s36
s_cmp_lt_u32 s36,2
s_cbranch_scc1 ct_224x
s_sleep 3
s_sub_u32 s47,s47,1
s_cbranch_scc1 ABORT
s_branch ct_224
ct_224x:
ds_write_b32 v22,v23 offset:4
s_waitcnt lgkmcnt(0)
cp_223:
s_barrier
ds_read_b32 v23,v22 offset:4
s_waitcnt lgkmcnt(0)
v_readfirstlane_b32 s38,v23
s_and_b32 s38,s38,1
s_and_b32 s37,s38,2147483648
s_and_b32 s33,s38,1
s_cselect_b32 s34,s79,s78
s_lshl_b32 s60,s33,6
s_add_u32 s60,s60,s34
s_mul_i32 s60,s60,46080
s_add_u32 s60,s60,206569472
s_lshl_b32 s62,s46,10
s_add_u32 s62,s62,40960
s_add_u32 m0,s57,s62
s_add_u32 s63,s60,s62
buffer_load_dwordx4 v1,s[8:11],s63 offen sc1 lds
s_add_u32 m0,s57,45056
s_add_u32 s63,s60,45056
buffer_load_dwordx4 v1,s[8:11],s63 offen sc1 lds
s_mul_i32 s61,s46,10240
s_add_u32 s60,s60,s61
s_add_u32 s61,s61,s57
s_add_u32 m0,s61,0
s_add_u32 s63,s60,0
buffer_load_dwordx4 v1,s[8:11],s63 offen sc1 lds
buffer_load_dwordx4 v1,s[8:11],s63 offen offset:1024 sc1 lds
buffer_load_dwordx4 v1,s[8:11],s63 offen offset:2048 sc1 lds
buffer_load_dwordx4 v1,s[8:11],s63 offen offset:3072 sc1 lds
s_add_u32 m0,s61,4096
s_add_u32 s63,s60,4096
buffer_load_dwordx4 v1,s[8:11],s63 offen sc1 lds
buffer_load_dwordx4 v1,s[8:11],s63 offen offset:1024 sc1 lds
buffer_load_dwordx4 v1,s[8:11],s63 offen offset:2048 sc1 lds
buffer_load_dwordx4 v1,s[8:11],s63 offen offset:3072 sc1 lds
s_add_u32 m0,s61,8192
s_add_u32 s63,s60,8192
buffer_load_dwordx4 v1,s[8:11],s63 offen sc1 lds
buffer_load_dwordx4 v1,s[8:11],s63 offen offset:1024 sc1 lds
QKVQ_CD1:
s_mov_b32 s51,s33
s_mov_b32 s52,s34
s_mov_b32 s53,s33
s_mov_b32 s54,s34
s_add_u32 s79,s79,s33
s_or_b32 s60,s37,s33
s_cmp_eq_u32 s60,0
s_addc_u32 s78,s78,0
s_lshl_b32 s41,s78,9
s_add_u32 s41,s41,s40
s_lshl_b32 s35,s79,9
s_add_u32 s35,s35,s40
s_add_u32 s35,s35,32768
buffer_load_dword v3,v2,s[8:11],s35 offen sc1
buffer_load_dword v14,v4,s[8:11],s41 offen sc1
s_waitcnt vmcnt(0)
s_mov_b64 exec,1
buffer_store_dword v5,v1,s[8:11],s59 offen sc1
s_mov_b64 exec,-1
s_mov_b32 s59,2147483648
v_cmp_eq_u32 vcc,0,v14
s_cmp_eq_u64 vcc,0
s_cselect_b32 s36,0,2147483648
v_cmp_eq_u32 vcc,0,v3
s_cmp_lt_u32 s78,64
s_cselect_b32 s36,s36,2147483648
s_cmp_eq_u64 vcc,0
s_cselect_b32 s60,1,s36
s_cmp_lt_u32 s79,64
s_cselect_b32 s60,s60,s36
s_sub_u32 s61,s78,s79
s_or_b32 s61,s61,s36
s_cmp_lt_u32 s61,16
s_cselect_b32 s36,0,s60
v_mov_b32 v23,s36
ds_write_b32 v13,v23
s_waitcnt lgkmcnt(0)
s_barrier
ds_read_b32 v23,v22
ds_read_b128 v[24:27],v18 offset:0
ds_read_b128 v[28:31],v19 offset:0
ds_read_b128 v[32:35],v18 offset:2048
ds_read_b128 v[36:39],v19 offset:2048
ds_read_b128 v[40:43],v18 offset:4096
s_waitcnt lgkmcnt(5)
v_readfirstlane_b32 s38,v23
s_and_b32 s37,s38,2147483648
s_and_b32 s33,s38,1
s_cselect_b32 s34,s79,s78
s_nop 0
s_branch QKVQ_B1
QKVQ_END:
s_endpgm
ROLE_QKVV:
v_lshlrev_b32 v1,4,v0
v_mov_b32 v5,1
s_lshl_b32 s56,s48,2
s_add_u32 s56,s56,s46
v_bfe_u32 v6,v0,2,2
v_lshrrev_b32 v7,4,v0
v_add_u32 v7,v6,v7
v_and_b32 v7,3,v7
v_and_b32 v15,3,v0
v_lshlrev_b32 v15,4,v15
v_lshl_add_u32 v15,v7,6,v15
v_lshl_add_u32 v15,v6,8,v15
v_lshrrev_b32 v6,5,v0
v_bfe_u32 v7,v0,4,1
v_lshlrev_b32 v16,10,v7
v_bfe_u32 v7,v0,2,2
v_lshl_add_u32 v16,v7,8,v16
v_add_u32 v6,v6,v7
v_and_b32 v6,3,v6
v_lshl_add_u32 v16,v6,6,v16
v_and_b32 v6,3,v0
v_lshl_add_u32 v16,v6,4,v16
v_add_u32 v18,46080,v16
v_lshrrev_b32 v6,5,v0
v_bfe_u32 v7,v0,4,1
v_lshlrev_b32 v20,10,v7
v_lshl_add_u32 v20,v6,8,v20
v_and_b32 v6,15,v0
v_lshl_add_u32 v20,v6,4,v20
v_lshrrev_b32 v6,5,v0
v_add_u32 v6,2,v6
v_bfe_u32 v7,v0,4,1
v_lshlrev_b32 v17,10,v7
v_bfe_u32 v7,v0,2,2
v_lshl_add_u32 v17,v7,8,v17
v_add_u32 v6,v6,v7
v_and_b32 v6,3,v6
v_lshl_add_u32 v17,v6,6,v17
v_and_b32 v6,3,v0
v_lshl_add_u32 v17,v6,4,v17
v_add_u32 v19,46080,v17
v_lshrrev_b32 v6,5,v0
v_add_u32 v6,2,v6
v_bfe_u32 v7,v0,4,1
v_lshlrev_b32 v21,10,v7
v_lshl_add_u32 v21,v6,8,v21
v_and_b32 v6,15,v0
v_lshl_add_u32 v21,v6,4,v21
s_mov_b32 s69,s56
s_mov_b32 s70,99614720
s_mov_b32 s71,196608
s_lshl_b32 s60,s69,12
s_add_u32 s70,s70,s60
v_lshrrev_b32 v6,5,v0
v_mul_u32_u24 v188,2560,v6
v_and_b32 v6,31,v0
v_lshl_add_u32 v188,v6,3,v188
v_add_u32 v188,0xa000,v188
v_min_u32 v4,7,v0
v_lshlrev_b32 v4,2,v4
v_min_u32 v2,39,v0
v_lshlrev_b32 v2,2,v2
v_mov_b32 v12,93184
s_lshl_b32 s60,s46,8
s_add_u32 s60,s60,92160
v_and_b32 v6,31,v0
v_lshlrev_b32 v190,3,v6
v_add_u32 v190,s60,v190
v_lshrrev_b32 v6,5,v0
v_lshlrev_b32 v191,5,v6
v_add_u32 v191,s60,v191
s_waitcnt vmcnt(0)
s_barrier
s_cmp_lg_u32 s46,0
s_cbranch_scc1 arr_225
v_mov_b32 v6,1
s_lshl_b32 s3,s49,2
v_mov_b32 v7,s3
s_mov_b64 exec,1
buffer_atomic_add v6,v7,s[12:15],0 offen sc1
s_mov_b64 exec,-1
arr_225:
s_lshl_b32 s58,s69,7
s_mul_i32 s63,s46,40960
s_mov_b32 s4,s24
s_mov_b32 s5,s25
s_mov_b32 s6,7864320
s_mov_b32 s7,0x20000
v_lshrrev_b32 v9,3,v0
s_mov_b32 s64,12288
v_mul_lo_u32 v9,v9,s64
v_and_b32 v10,7,v0
v_lshl_add_u32 v6,v10,4,v9
s_add_u32 m0,s63,0
s_add_u32 s65,s58,0
buffer_load_dwordx4 v6,s[4:7],s65 offen lds
s_add_u32 m0,s63,1024
s_add_u32 s65,s58,98304
buffer_load_dwordx4 v6,s[4:7],s65 offen lds
s_add_u32 m0,s63,2048
s_add_u32 s65,s58,196608
buffer_load_dwordx4 v6,s[4:7],s65 offen lds
s_add_u32 m0,s63,3072
s_add_u32 s65,s58,294912
buffer_load_dwordx4 v6,s[4:7],s65 offen lds
s_add_u32 m0,s63,4096
s_add_u32 s65,s58,393216
buffer_load_dwordx4 v6,s[4:7],s65 offen lds
s_add_u32 m0,s63,5120
s_add_u32 s65,s58,491520
buffer_load_dwordx4 v6,s[4:7],s65 offen lds
s_add_u32 m0,s63,6144
s_add_u32 s65,s58,589824
buffer_load_dwordx4 v6,s[4:7],s65 offen lds
s_add_u32 m0,s63,7168
s_add_u32 s65,s58,688128
buffer_load_dwordx4 v6,s[4:7],s65 offen lds
s_add_u32 m0,s63,8192
s_add_u32 s65,s58,786432
buffer_load_dwordx4 v6,s[4:7],s65 offen lds
s_add_u32 m0,s63,9216
s_add_u32 s65,s58,884736
buffer_load_dwordx4 v6,s[4:7],s65 offen lds
s_add_u32 m0,s63,10240
s_add_u32 s65,s58,983040
buffer_load_dwordx4 v6,s[4:7],s65 offen lds
s_add_u32 m0,s63,11264
s_add_u32 s65,s58,1081344
buffer_load_dwordx4 v6,s[4:7],s65 offen lds
s_add_u32 m0,s63,12288
s_add_u32 s65,s58,1179648
buffer_load_dwordx4 v6,s[4:7],s65 offen lds
s_add_u32 m0,s63,13312
s_add_u32 s65,s58,1277952
buffer_load_dwordx4 v6,s[4:7],s65 offen lds
s_add_u32 m0,s63,14336
s_add_u32 s65,s58,1376256
buffer_load_dwordx4 v6,s[4:7],s65 offen lds
s_add_u32 m0,s63,15360
s_add_u32 s65,s58,1474560
buffer_load_dwordx4 v6,s[4:7],s65 offen lds
s_add_u32 m0,s63,16384
s_add_u32 s65,s58,1572864
buffer_load_dwordx4 v6,s[4:7],s65 offen lds
s_add_u32 m0,s63,17408
s_add_u32 s65,s58,1671168
buffer_load_dwordx4 v6,s[4:7],s65 offen lds
s_add_u32 m0,s63,18432
s_add_u32 s65,s58,1769472
buffer_load_dwordx4 v6,s[4:7],s65 offen lds
s_add_u32 m0,s63,19456
s_add_u32 s65,s58,1867776
buffer_load_dwordx4 v6,s[4:7],s65 offen lds
s_add_u32 m0,s63,20480
s_add_u32 s65,s58,1966080
buffer_load_dwordx4 v6,s[4:7],s65 offen lds
s_add_u32 m0,s63,21504
s_add_u32 s65,s58,2064384
buffer_load_dwordx4 v6,s[4:7],s65 offen lds
s_add_u32 m0,s63,22528
s_add_u32 s65,s58,2162688
buffer_load_dwordx4 v6,s[4:7],s65 offen lds
s_add_u32 m0,s63,23552
s_add_u32 s65,s58,2260992
buffer_load_dwordx4 v6,s[4:7],s65 offen lds
s_add_u32 m0,s63,24576
s_add_u32 s65,s58,2359296
buffer_load_dwordx4 v6,s[4:7],s65 offen lds
s_add_u32 m0,s63,25600
s_add_u32 s65,s58,2457600
buffer_load_dwordx4 v6,s[4:7],s65 offen lds
s_add_u32 m0,s63,26624
s_add_u32 s65,s58,2555904
buffer_load_dwordx4 v6,s[4:7],s65 offen lds
s_add_u32 m0,s63,27648
s_add_u32 s65,s58,2654208
buffer_load_dwordx4 v6,s[4:7],s65 offen lds
s_add_u32 m0,s63,28672
s_add_u32 s65,s58,2752512
buffer_load_dwordx4 v6,s[4:7],s65 offen lds
s_add_u32 m0,s63,29696
s_add_u32 s65,s58,2850816
buffer_load_dwordx4 v6,s[4:7],s65 offen lds
s_add_u32 m0,s63,30720
s_add_u32 s65,s58,2949120
buffer_load_dwordx4 v6,s[4:7],s65 offen lds
s_add_u32 m0,s63,31744
s_add_u32 s65,s58,3047424
buffer_load_dwordx4 v6,s[4:7],s65 offen lds
s_add_u32 m0,s63,32768
s_add_u32 s65,s58,3145728
buffer_load_dwordx4 v6,s[4:7],s65 offen lds
s_add_u32 m0,s63,33792
s_add_u32 s65,s58,3244032
buffer_load_dwordx4 v6,s[4:7],s65 offen lds
s_add_u32 m0,s63,34816
s_add_u32 s65,s58,3342336
buffer_load_dwordx4 v6,s[4:7],s65 offen lds
s_add_u32 m0,s63,35840
s_add_u32 s65,s58,3440640
buffer_load_dwordx4 v6,s[4:7],s65 offen lds
s_add_u32 m0,s63,36864
s_add_u32 s65,s58,3538944
buffer_load_dwordx4 v6,s[4:7],s65 offen lds
s_add_u32 m0,s63,37888
s_add_u32 s65,s58,3637248
buffer_load_dwordx4 v6,s[4:7],s65 offen lds
s_add_u32 m0,s63,38912
s_add_u32 s65,s58,3735552
buffer_load_dwordx4 v6,s[4:7],s65 offen lds
s_add_u32 m0,s63,39936
s_add_u32 s65,s58,3833856
buffer_load_dwordx4 v6,s[4:7],s65 offen lds
s_waitcnt vmcnt(20)
v_bfe_u32 v9,v0,2,2
v_lshrrev_b32 v10,5,v0
v_lshl_add_u32 v9,v10,2,v9
v_mul_u32_u24 v9,128,v9
v_and_b32 v10,1,v0
v_lshl_add_u32 v9,v10,3,v9
v_bfe_u32 v10,v0,1,1
v_lshl_add_u32 v9,v10,4,v9
v_bfe_u32 v10,v0,4,1
v_lshl_add_u32 v9,v10,5,v9
v_add_u32 v7,s63,v9
ds_read_b64_tr_b16 a[0:1],v7 offset:0
ds_read_b64_tr_b16 a[2:3],v7 offset:2048
ds_read_b64_tr_b16 a[4:5],v7 offset:1024
ds_read_b64_tr_b16 a[6:7],v7 offset:3072
ds_read_b64_tr_b16 a[160:161],v7 offset:64
ds_read_b64_tr_b16 a[162:163],v7 offset:2112
ds_read_b64_tr_b16 a[164:165],v7 offset:1088
ds_read_b64_tr_b16 a[166:167],v7 offset:3136
ds_read_b64_tr_b16 a[8:9],v7 offset:4096
ds_read_b64_tr_b16 a[10:11],v7 offset:6144
ds_read_b64_tr_b16 a[12:13],v7 offset:5120
ds_read_b64_tr_b16 a[14:15],v7 offset:7168
s_waitcnt lgkmcnt(4)
ds_read_b64_tr_b16 a[168:169],v7 offset:4160
ds_read_b64_tr_b16 a[170:171],v7 offset:6208
ds_read_b64_tr_b16 a[172:173],v7 offset:5184
ds_read_b64_tr_b16 a[174:175],v7 offset:7232
ds_read_b64_tr_b16 a[16:17],v7 offset:8192
ds_read_b64_tr_b16 a[18:19],v7 offset:10240
ds_read_b64_tr_b16 a[20:21],v7 offset:9216
ds_read_b64_tr_b16 a[22:23],v7 offset:11264
ds_read_b64_tr_b16 a[176:177],v7 offset:8256
ds_read_b64_tr_b16 a[178:179],v7 offset:10304
ds_read_b64_tr_b16 a[180:181],v7 offset:9280
ds_read_b64_tr_b16 a[182:183],v7 offset:11328
s_waitcnt lgkmcnt(4)
ds_read_b64_tr_b16 a[24:25],v7 offset:12288
ds_read_b64_tr_b16 a[26:27],v7 offset:14336
ds_read_b64_tr_b16 a[28:29],v7 offset:13312
ds_read_b64_tr_b16 a[30:31],v7 offset:15360
ds_read_b64_tr_b16 a[184:185],v7 offset:12352
ds_read_b64_tr_b16 a[186:187],v7 offset:14400
ds_read_b64_tr_b16 a[188:189],v7 offset:13376
ds_read_b64_tr_b16 a[190:191],v7 offset:15424
ds_read_b64_tr_b16 a[32:33],v7 offset:16384
ds_read_b64_tr_b16 a[34:35],v7 offset:18432
ds_read_b64_tr_b16 a[36:37],v7 offset:17408
ds_read_b64_tr_b16 a[38:39],v7 offset:19456
s_waitcnt lgkmcnt(4)
ds_read_b64_tr_b16 a[192:193],v7 offset:16448
ds_read_b64_tr_b16 a[194:195],v7 offset:18496
ds_read_b64_tr_b16 a[196:197],v7 offset:17472
ds_read_b64_tr_b16 a[198:199],v7 offset:19520
s_waitcnt lgkmcnt(0)
s_add_u32 m0,s63,0
s_add_u32 s65,s58,3932160
buffer_load_dwordx4 v6,s[4:7],s65 offen lds
s_add_u32 m0,s63,1024
s_add_u32 s65,s58,4030464
buffer_load_dwordx4 v6,s[4:7],s65 offen lds
s_add_u32 m0,s63,2048
s_add_u32 s65,s58,4128768
buffer_load_dwordx4 v6,s[4:7],s65 offen lds
s_add_u32 m0,s63,3072
s_add_u32 s65,s58,4227072
buffer_load_dwordx4 v6,s[4:7],s65 offen lds
s_add_u32 m0,s63,4096
s_add_u32 s65,s58,4325376
buffer_load_dwordx4 v6,s[4:7],s65 offen lds
s_add_u32 m0,s63,5120
s_add_u32 s65,s58,4423680
buffer_load_dwordx4 v6,s[4:7],s65 offen lds
s_add_u32 m0,s63,6144
s_add_u32 s65,s58,4521984
buffer_load_dwordx4 v6,s[4:7],s65 offen lds
s_add_u32 m0,s63,7168
s_add_u32 s65,s58,4620288
buffer_load_dwordx4 v6,s[4:7],s65 offen lds
s_add_u32 m0,s63,8192
s_add_u32 s65,s58,4718592
buffer_load_dwordx4 v6,s[4:7],s65 offen lds
s_add_u32 m0,s63,9216
s_add_u32 s65,s58,4816896
buffer_load_dwordx4 v6,s[4:7],s65 offen lds
s_add_u32 m0,s63,10240
s_add_u32 s65,s58,4915200
buffer_load_dwordx4 v6,s[4:7],s65 offen lds
s_add_u32 m0,s63,11264
s_add_u32 s65,s58,5013504
buffer_load_dwordx4 v6,s[4:7],s65 offen lds
s_add_u32 m0,s63,12288
s_add_u32 s65,s58,5111808
buffer_load_dwordx4 v6,s[4:7],s65 offen lds
s_add_u32 m0,s63,13312
s_add_u32 s65,s58,5210112
buffer_load_dwordx4 v6,s[4:7],s65 offen lds
s_add_u32 m0,s63,14336
s_add_u32 s65,s58,5308416
buffer_load_dwordx4 v6,s[4:7],s65 offen lds
s_add_u32 m0,s63,15360
s_add_u32 s65,s58,5406720
buffer_load_dwordx4 v6,s[4:7],s65 offen lds
s_add_u32 m0,s63,16384
s_add_u32 s65,s58,5505024
buffer_load_dwordx4 v6,s[4:7],s65 offen lds
s_add_u32 m0,s63,17408
s_add_u32 s65,s58,5603328
buffer_load_dwordx4 v6,s[4:7],s65 offen lds
s_add_u32 m0,s63,18432
s_add_u32 s65,s58,5701632
buffer_load_dwordx4 v6,s[4:7],s65 offen lds
s_add_u32 m0,s63,19456
s_add_u32 s65,s58,5799936
buffer_load_dwordx4 v6,s[4:7],s65 offen lds
s_waitcnt vmcnt(20)
v_bfe_u32 v9,v0,2,2
v_lshrrev_b32 v10,5,v0
v_lshl_add_u32 v9,v10,2,v9
v_mul_u32_u24 v9,128,v9
v_and_b32 v10,1,v0
v_lshl_add_u32 v9,v10,3,v9
v_bfe_u32 v10,v0,1,1
v_lshl_add_u32 v9,v10,4,v9
v_bfe_u32 v10,v0,4,1
v_lshl_add_u32 v9,v10,5,v9
v_add_u32 v7,s63,v9
ds_read_b64_tr_b16 a[40:41],v7 offset:20480
ds_read_b64_tr_b16 a[42:43],v7 offset:22528
ds_read_b64_tr_b16 a[44:45],v7 offset:21504
ds_read_b64_tr_b16 a[46:47],v7 offset:23552
ds_read_b64_tr_b16 a[200:201],v7 offset:20544
ds_read_b64_tr_b16 a[202:203],v7 offset:22592
ds_read_b64_tr_b16 a[204:205],v7 offset:21568
ds_read_b64_tr_b16 a[206:207],v7 offset:23616
ds_read_b64_tr_b16 a[48:49],v7 offset:24576
ds_read_b64_tr_b16 a[50:51],v7 offset:26624
ds_read_b64_tr_b16 a[52:53],v7 offset:25600
ds_read_b64_tr_b16 a[54:55],v7 offset:27648
s_waitcnt lgkmcnt(4)
ds_read_b64_tr_b16 a[208:209],v7 offset:24640
ds_read_b64_tr_b16 a[210:211],v7 offset:26688
ds_read_b64_tr_b16 a[212:213],v7 offset:25664
ds_read_b64_tr_b16 a[214:215],v7 offset:27712
ds_read_b64_tr_b16 a[56:57],v7 offset:28672
ds_read_b64_tr_b16 a[58:59],v7 offset:30720
ds_read_b64_tr_b16 a[60:61],v7 offset:29696
ds_read_b64_tr_b16 a[62:63],v7 offset:31744
ds_read_b64_tr_b16 a[216:217],v7 offset:28736
ds_read_b64_tr_b16 a[218:219],v7 offset:30784
ds_read_b64_tr_b16 a[220:221],v7 offset:29760
ds_read_b64_tr_b16 a[222:223],v7 offset:31808
s_waitcnt lgkmcnt(4)
ds_read_b64_tr_b16 a[64:65],v7 offset:32768
ds_read_b64_tr_b16 a[66:67],v7 offset:34816
ds_read_b64_tr_b16 a[68:69],v7 offset:33792
ds_read_b64_tr_b16 a[70:71],v7 offset:35840
ds_read_b64_tr_b16 a[224:225],v7 offset:32832
ds_read_b64_tr_b16 a[226:227],v7 offset:34880
ds_read_b64_tr_b16 a[228:229],v7 offset:33856
ds_read_b64_tr_b16 a[230:231],v7 offset:35904
ds_read_b64_tr_b16 a[72:73],v7 offset:36864
ds_read_b64_tr_b16 a[74:75],v7 offset:38912
ds_read_b64_tr_b16 a[76:77],v7 offset:37888
ds_read_b64_tr_b16 a[78:79],v7 offset:39936
s_waitcnt lgkmcnt(4)
ds_read_b64_tr_b16 a[232:233],v7 offset:36928
ds_read_b64_tr_b16 a[234:235],v7 offset:38976
ds_read_b64_tr_b16 a[236:237],v7 offset:37952
ds_read_b64_tr_b16 a[238:239],v7 offset:40000
s_waitcnt lgkmcnt(0)
s_add_u32 m0,s63,20480
s_add_u32 s65,s58,5898240
buffer_load_dwordx4 v6,s[4:7],s65 offen lds
s_add_u32 m0,s63,21504
s_add_u32 s65,s58,5996544
buffer_load_dwordx4 v6,s[4:7],s65 offen lds
s_add_u32 m0,s63,22528
s_add_u32 s65,s58,6094848
buffer_load_dwordx4 v6,s[4:7],s65 offen lds
s_add_u32 m0,s63,23552
s_add_u32 s65,s58,6193152
buffer_load_dwordx4 v6,s[4:7],s65 offen lds
s_add_u32 m0,s63,24576
s_add_u32 s65,s58,6291456
buffer_load_dwordx4 v6,s[4:7],s65 offen lds
s_add_u32 m0,s63,25600
s_add_u32 s65,s58,6389760
buffer_load_dwordx4 v6,s[4:7],s65 offen lds
s_add_u32 m0,s63,26624
s_add_u32 s65,s58,6488064
buffer_load_dwordx4 v6,s[4:7],s65 offen lds
s_add_u32 m0,s63,27648
s_add_u32 s65,s58,6586368
buffer_load_dwordx4 v6,s[4:7],s65 offen lds
s_add_u32 m0,s63,28672
s_add_u32 s65,s58,6684672
buffer_load_dwordx4 v6,s[4:7],s65 offen lds
s_add_u32 m0,s63,29696
s_add_u32 s65,s58,6782976
buffer_load_dwordx4 v6,s[4:7],s65 offen lds
s_add_u32 m0,s63,30720
s_add_u32 s65,s58,6881280
buffer_load_dwordx4 v6,s[4:7],s65 offen lds
s_add_u32 m0,s63,31744
s_add_u32 s65,s58,6979584
buffer_load_dwordx4 v6,s[4:7],s65 offen lds
s_add_u32 m0,s63,32768
s_add_u32 s65,s58,7077888
buffer_load_dwordx4 v6,s[4:7],s65 offen lds
s_add_u32 m0,s63,33792
s_add_u32 s65,s58,7176192
buffer_load_dwordx4 v6,s[4:7],s65 offen lds
s_add_u32 m0,s63,34816
s_add_u32 s65,s58,7274496
buffer_load_dwordx4 v6,s[4:7],s65 offen lds
s_add_u32 m0,s63,35840
s_add_u32 s65,s58,7372800
buffer_load_dwordx4 v6,s[4:7],s65 offen lds
s_add_u32 m0,s63,36864
s_add_u32 s65,s58,7471104
buffer_load_dwordx4 v6,s[4:7],s65 offen lds
s_add_u32 m0,s63,37888
s_add_u32 s65,s58,7569408
buffer_load_dwordx4 v6,s[4:7],s65 offen lds
s_add_u32 m0,s63,38912
s_add_u32 s65,s58,7667712
buffer_load_dwordx4 v6,s[4:7],s65 offen lds
s_add_u32 m0,s63,39936
s_add_u32 s65,s58,7766016
buffer_load_dwordx4 v6,s[4:7],s65 offen lds
s_waitcnt vmcnt(20)
v_bfe_u32 v9,v0,2,2
v_lshrrev_b32 v10,5,v0
v_lshl_add_u32 v9,v10,2,v9
v_mul_u32_u24 v9,128,v9
v_and_b32 v10,1,v0
v_lshl_add_u32 v9,v10,3,v9
v_bfe_u32 v10,v0,1,1
v_lshl_add_u32 v9,v10,4,v9
v_bfe_u32 v10,v0,4,1
v_lshl_add_u32 v9,v10,5,v9
v_add_u32 v7,s63,v9
ds_read_b64_tr_b16 a[80:81],v7 offset:0
ds_read_b64_tr_b16 a[82:83],v7 offset:2048
ds_read_b64_tr_b16 a[84:85],v7 offset:1024
ds_read_b64_tr_b16 a[86:87],v7 offset:3072
ds_read_b64_tr_b16 a[240:241],v7 offset:64
ds_read_b64_tr_b16 a[242:243],v7 offset:2112
ds_read_b64_tr_b16 a[244:245],v7 offset:1088
ds_read_b64_tr_b16 a[246:247],v7 offset:3136
ds_read_b64_tr_b16 a[88:89],v7 offset:4096
ds_read_b64_tr_b16 a[90:91],v7 offset:6144
ds_read_b64_tr_b16 a[92:93],v7 offset:5120
ds_read_b64_tr_b16 a[94:95],v7 offset:7168
s_waitcnt lgkmcnt(4)
ds_read_b64_tr_b16 a[248:249],v7 offset:4160
ds_read_b64_tr_b16 a[250:251],v7 offset:6208
ds_read_b64_tr_b16 a[252:253],v7 offset:5184
ds_read_b64_tr_b16 a[254:255],v7 offset:7232
ds_read_b64_tr_b16 a[96:97],v7 offset:8192
ds_read_b64_tr_b16 a[98:99],v7 offset:10240
ds_read_b64_tr_b16 a[100:101],v7 offset:9216
ds_read_b64_tr_b16 a[102:103],v7 offset:11264
ds_read_b64_tr_b16 v[192:193],v7 offset:8256
ds_read_b64_tr_b16 v[194:195],v7 offset:10304
ds_read_b64_tr_b16 v[196:197],v7 offset:9280
ds_read_b64_tr_b16 v[198:199],v7 offset:11328
s_waitcnt lgkmcnt(4)
ds_read_b64_tr_b16 a[104:105],v7 offset:12288
ds_read_b64_tr_b16 a[106:107],v7 offset:14336
ds_read_b64_tr_b16 a[108:109],v7 offset:13312
ds_read_b64_tr_b16 a[110:111],v7 offset:15360
ds_read_b64_tr_b16 v[200:201],v7 offset:12352
ds_read_b64_tr_b16 v[202:203],v7 offset:14400
ds_read_b64_tr_b16 v[204:205],v7 offset:13376
ds_read_b64_tr_b16 v[206:207],v7 offset:15424
ds_read_b64_tr_b16 a[112:113],v7 offset:16384
ds_read_b64_tr_b16 a[114:115],v7 offset:18432
ds_read_b64_tr_b16 a[116:117],v7 offset:17408
ds_read_b64_tr_b16 a[118:119],v7 offset:19456
s_waitcnt lgkmcnt(4)
ds_read_b64_tr_b16 v[208:209],v7 offset:16448
ds_read_b64_tr_b16 v[210:211],v7 offset:18496
ds_read_b64_tr_b16 v[212:213],v7 offset:17472
ds_read_b64_tr_b16 v[214:215],v7 offset:19520
s_waitcnt lgkmcnt(0)
s_waitcnt vmcnt(0)
v_bfe_u32 v9,v0,2,2
v_lshrrev_b32 v10,5,v0
v_lshl_add_u32 v9,v10,2,v9
v_mul_u32_u24 v9,128,v9
v_and_b32 v10,1,v0
v_lshl_add_u32 v9,v10,3,v9
v_bfe_u32 v10,v0,1,1
v_lshl_add_u32 v9,v10,4,v9
v_bfe_u32 v10,v0,4,1
v_lshl_add_u32 v9,v10,5,v9
v_add_u32 v7,s63,v9
ds_read_b64_tr_b16 a[120:121],v7 offset:20480
ds_read_b64_tr_b16 a[122:123],v7 offset:22528
ds_read_b64_tr_b16 a[124:125],v7 offset:21504
ds_read_b64_tr_b16 a[126:127],v7 offset:23552
ds_read_b64_tr_b16 v[216:217],v7 offset:20544
ds_read_b64_tr_b16 v[218:219],v7 offset:22592
ds_read_b64_tr_b16 v[220:221],v7 offset:21568
ds_read_b64_tr_b16 v[222:223],v7 offset:23616
ds_read_b64_tr_b16 a[128:129],v7 offset:24576
ds_read_b64_tr_b16 a[130:131],v7 offset:26624
ds_read_b64_tr_b16 a[132:133],v7 offset:25600
ds_read_b64_tr_b16 a[134:135],v7 offset:27648
s_waitcnt lgkmcnt(4)
ds_read_b64_tr_b16 v[224:225],v7 offset:24640
ds_read_b64_tr_b16 v[226:227],v7 offset:26688
ds_read_b64_tr_b16 v[228:229],v7 offset:25664
ds_read_b64_tr_b16 v[230:231],v7 offset:27712
ds_read_b64_tr_b16 a[136:137],v7 offset:28672
ds_read_b64_tr_b16 a[138:139],v7 offset:30720
ds_read_b64_tr_b16 a[140:141],v7 offset:29696
ds_read_b64_tr_b16 a[142:143],v7 offset:31744
ds_read_b64_tr_b16 v[232:233],v7 offset:28736
ds_read_b64_tr_b16 v[234:235],v7 offset:30784
ds_read_b64_tr_b16 v[236:237],v7 offset:29760
ds_read_b64_tr_b16 v[238:239],v7 offset:31808
s_waitcnt lgkmcnt(4)
ds_read_b64_tr_b16 a[144:145],v7 offset:32768
ds_read_b64_tr_b16 a[146:147],v7 offset:34816
ds_read_b64_tr_b16 a[148:149],v7 offset:33792
ds_read_b64_tr_b16 a[150:151],v7 offset:35840
ds_read_b64_tr_b16 v[240:241],v7 offset:32832
ds_read_b64_tr_b16 v[242:243],v7 offset:34880
ds_read_b64_tr_b16 v[244:245],v7 offset:33856
ds_read_b64_tr_b16 v[246:247],v7 offset:35904
ds_read_b64_tr_b16 a[152:153],v7 offset:36864
ds_read_b64_tr_b16 a[154:155],v7 offset:38912
ds_read_b64_tr_b16 a[156:157],v7 offset:37888
ds_read_b64_tr_b16 a[158:159],v7 offset:39936
s_waitcnt lgkmcnt(4)
ds_read_b64_tr_b16 v[248:249],v7 offset:36928
ds_read_b64_tr_b16 v[250:251],v7 offset:38976
ds_read_b64_tr_b16 v[252:253],v7 offset:37952
ds_read_b64_tr_b16 v[254:255],v7 offset:40000
s_waitcnt lgkmcnt(0)
v_mov_b32 v24,0x3f803f80
v_mov_b32 v25,0x3f803f80
v_mov_b32 v26,0x3f803f80
v_mov_b32 v27,0x3f803f80
s_nop 1
v_mfma_f32_32x32x16_bf16 v[56:71],v[24:27],a[0:3],0
v_mfma_f32_32x32x16_bf16 v[72:87],v[24:27],a[160:163],0
v_mfma_f32_32x32x16_bf16 v[56:71],v[24:27],a[4:7],v[56:71]
v_mfma_f32_32x32x16_bf16 v[72:87],v[24:27],a[164:167],v[72:87]
v_mfma_f32_32x32x16_bf16 v[56:71],v[24:27],a[8:11],v[56:71]
v_mfma_f32_32x32x16_bf16 v[72:87],v[24:27],a[168:171],v[72:87]
v_mfma_f32_32x32x16_bf16 v[56:71],v[24:27],a[12:15],v[56:71]
v_mfma_f32_32x32x16_bf16 v[72:87],v[24:27],a[172:175],v[72:87]
v_mfma_f32_32x32x16_bf16 v[56:71],v[24:27],a[16:19],v[56:71]
v_mfma_f32_32x32x16_bf16 v[72:87],v[24:27],a[176:179],v[72:87]
v_mfma_f32_32x32x16_bf16 v[56:71],v[24:27],a[20:23],v[56:71]
v_mfma_f32_32x32x16_bf16 v[72:87],v[24:27],a[180:183],v[72:87]
v_mfma_f32_32x32x16_bf16 v[56:71],v[24:27],a[24:27],v[56:71]
v_mfma_f32_32x32x16_bf16 v[72:87],v[24:27],a[184:187],v[72:87]
v_mfma_f32_32x32x16_bf16 v[56:71],v[24:27],a[28:31],v[56:71]
v_mfma_f32_32x32x16_bf16 v[72:87],v[24:27],a[188:191],v[72:87]
v_mfma_f32_32x32x16_bf16 v[56:71],v[24:27],a[32:35],v[56:71]
v_mfma_f32_32x32x16_bf16 v[72:87],v[24:27],a[192:195],v[72:87]
v_mfma_f32_32x32x16_bf16 v[56:71],v[24:27],a[36:39],v[56:71]
v_mfma_f32_32x32x16_bf16 v[72:87],v[24:27],a[196:199],v[72:87]
v_mfma_f32_32x32x16_bf16 v[56:71],v[24:27],a[40:43],v[56:71]
v_mfma_f32_32x32x16_bf16 v[72:87],v[24:27],a[200:203],v[72:87]
v_mfma_f32_32x32x16_bf16 v[56:71],v[24:27],a[44:47],v[56:71]
v_mfma_f32_32x32x16_bf16 v[72:87],v[24:27],a[204:207],v[72:87]
v_mfma_f32_32x32x16_bf16 v[56:71],v[24:27],a[48:51],v[56:71]
v_mfma_f32_32x32x16_bf16 v[72:87],v[24:27],a[208:211],v[72:87]
v_mfma_f32_32x32x16_bf16 v[56:71],v[24:27],a[52:55],v[56:71]
v_mfma_f32_32x32x16_bf16 v[72:87],v[24:27],a[212:215],v[72:87]
v_mfma_f32_32x32x16_bf16 v[56:71],v[24:27],a[56:59],v[56:71]
v_mfma_f32_32x32x16_bf16 v[72:87],v[24:27],a[216:219],v[72:87]
v_mfma_f32_32x32x16_bf16 v[56:71],v[24:27],a[60:63],v[56:71]
v_mfma_f32_32x32x16_bf16 v[72:87],v[24:27],a[220:223],v[72:87]
v_mfma_f32_32x32x16_bf16 v[56:71],v[24:27],a[64:67],v[56:71]
v_mfma_f32_32x32x16_bf16 v[72:87],v[24:27],a[224:227],v[72:87]
v_mfma_f32_32x32x16_bf16 v[56:71],v[24:27],a[68:71],v[56:71]
v_mfma_f32_32x32x16_bf16 v[72:87],v[24:27],a[228:231],v[72:87]
v_mfma_f32_32x32x16_bf16 v[56:71],v[24:27],a[72:75],v[56:71]
v_mfma_f32_32x32x16_bf16 v[72:87],v[24:27],a[232:235],v[72:87]
v_mfma_f32_32x32x16_bf16 v[56:71],v[24:27],a[76:79],v[56:71]
v_mfma_f32_32x32x16_bf16 v[72:87],v[24:27],a[236:239],v[72:87]
v_mfma_f32_32x32x16_bf16 v[56:71],v[24:27],a[80:83],v[56:71]
v_mfma_f32_32x32x16_bf16 v[72:87],v[24:27],a[240:243],v[72:87]
v_mfma_f32_32x32x16_bf16 v[56:71],v[24:27],a[84:87],v[56:71]
v_mfma_f32_32x32x16_bf16 v[72:87],v[24:27],a[244:247],v[72:87]
v_mfma_f32_32x32x16_bf16 v[56:71],v[24:27],a[88:91],v[56:71]
v_mfma_f32_32x32x16_bf16 v[72:87],v[24:27],a[248:251],v[72:87]
v_mfma_f32_32x32x16_bf16 v[56:71],v[24:27],a[92:95],v[56:71]
v_mfma_f32_32x32x16_bf16 v[72:87],v[24:27],a[252:255],v[72:87]
v_mfma_f32_32x32x16_bf16 v[56:71],v[24:27],a[96:99],v[56:71]
v_mfma_f32_32x32x16_bf16 v[72:87],v[24:27],v[192:195],v[72:87]
v_mfma_f32_32x32x16_bf16 v[56:71],v[24:27],a[100:103],v[56:71]
v_mfma_f32_32x32x16_bf16 v[72:87],v[24:27],v[196:199],v[72:87]
v_mfma_f32_32x32x16_bf16 v[56:71],v[24:27],a[104:107],v[56:71]
v_mfma_f32_32x32x16_bf16 v[72:87],v[24:27],v[200:203],v[72:87]
v_mfma_f32_32x32x16_bf16 v[56:71],v[24:27],a[108:111],v[56:71]
v_mfma_f32_32x32x16_bf16 v[72:87],v[24:27],v[204:207],v[72:87]
v_mfma_f32_32x32x16_bf16 v[56:71],v[24:27],a[112:115],v[56:71]
v_mfma_f32_32x32x16_bf16 v[72:87],v[24:27],v[208:211],v[72:87]
v_mfma_f32_32x32x16_bf16 v[56:71],v[24:27],a[116:119],v[56:71]
v_mfma_f32_32x32x16_bf16 v[72:87],v[24:27],v[212:215],v[72:87]
v_mfma_f32_32x32x16_bf16 v[56:71],v[24:27],a[120:123],v[56:71]
v_mfma_f32_32x32x16_bf16 v[72:87],v[24:27],v[216:219],v[72:87]
v_mfma_f32_32x32x16_bf16 v[56:71],v[24:27],a[124:127],v[56:71]
v_mfma_f32_32x32x16_bf16 v[72:87],v[24:27],v[220:223],v[72:87]
v_mfma_f32_32x32x16_bf16 v[56:71],v[24:27],a[128:131],v[56:71]
v_mfma_f32_32x32x16_bf16 v[72:87],v[24:27],v[224:227],v[72:87]
v_mfma_f32_32x32x16_bf16 v[56:71],v[24:27],a[132:135],v[56:71]
v_mfma_f32_32x32x16_bf16 v[72:87],v[24:27],v[228:231],v[72:87]
v_mfma_f32_32x32x16_bf16 v[56:71],v[24:27],a[136:139],v[56:71]
v_mfma_f32_32x32x16_bf16 v[72:87],v[24:27],v[232:235],v[72:87]
v_mfma_f32_32x32x16_bf16 v[56:71],v[24:27],a[140:143],v[56:71]
v_mfma_f32_32x32x16_bf16 v[72:87],v[24:27],v[236:239],v[72:87]
v_mfma_f32_32x32x16_bf16 v[56:71],v[24:27],a[144:147],v[56:71]
v_mfma_f32_32x32x16_bf16 v[72:87],v[24:27],v[240:243],v[72:87]
v_mfma_f32_32x32x16_bf16 v[56:71],v[24:27],a[148:151],v[56:71]
v_mfma_f32_32x32x16_bf16 v[72:87],v[24:27],v[244:247],v[72:87]
v_mfma_f32_32x32x16_bf16 v[56:71],v[24:27],a[152:155],v[56:71]
v_mfma_f32_32x32x16_bf16 v[72:87],v[24:27],v[248:251],v[72:87]
v_mfma_f32_32x32x16_bf16 v[56:71],v[24:27],a[156:159],v[56:71]
v_mfma_f32_32x32x16_bf16 v[72:87],v[24:27],v[252:255],v[72:87]
s_nop 4
v_mov_b32 v120,v56
s_nop 5
v_mov_b32 v121,v72
s_barrier
s_lshl_b32 s3,s49,2
v_mov_b32 v7,s3
s_nop 1
ibw_226:
buffer_load_dword v6,v7,s[12:15],0 offen sc1
s_waitcnt vmcnt(0)
v_cmp_ne_u32 vcc,256,v6
s_nop 0
s_cbranch_vccz ok_227
s_sleep 8
s_sub_u32 s47,s47,1
s_cbranch_scc1 ABORT
s_branch ibw_226
ok_227:
s_cmp_lg_u32 s49,0
s_cbranch_scc1 ibok_228
v_and_b32 v7,7,v0
v_lshlrev_b32 v7,2,v7
buffer_load_dword v6,v7,s[12:15],0 offen offset:32 sc1
s_waitcnt vmcnt(0)
v_cmp_ne_u32 vcc,32,v6
s_nop 0
s_cbranch_vccz ibok_228
s_barrier
s_mov_b32 s49,1
s_mov_b32 s3,s2
s_load_dwordx16 s[16:31],s[0:1],0
s_load_dwordx8 s[32:39],s[0:1],64
s_waitcnt lgkmcnt(0)
s_branch DISPATCH
ibok_228:
s_mov_b32 s50,0
s_mov_b32 s32,0
s_mov_b32 s57,0
s_mov_b32 s59,2147483648
s_mov_b32 s82,2147483648
s_mov_b32 s39,2147483648
v_mov_b32 v22,94208
s_mov_b32 s72,0
s_mov_b32 s73,0
s_mov_b32 s78,0
s_mov_b32 s79,0
s_cmp_eq_u32 s46,0
s_cselect_b32 s40,0,2147483648
s_lshl_b32 s60,s46,3
v_add_u32 v13,s60,v22
s_mov_b32 s83,s100
s_lshl_b32 s41,s78,9
s_add_u32 s41,s41,s40
s_lshl_b32 s35,s79,9
s_add_u32 s35,s35,s40
s_add_u32 s35,s35,32768
s_branch QKVV_COLD0
QKVV_B0:
s_waitcnt lgkmcnt(3)
v_mfma_f32_32x32x16_bf16 v[56:71],v[24:27],a[0:3],0
ds_read_b128 v[44:47],v17 offset:4096
v_add_u32 v189,s57,v188
v_mfma_f32_32x32x16_bf16 v[72:87],v[24:27],a[160:163],0
v_add_u32 v8,0x800,v189
s_sub_u32 s66,46080,s57
s_lshl_b32 s60,s33,6
s_add_u32 s60,s60,s34
s_mul_i32 s60,s60,46080
s_add_u32 s60,s60,s37
v_mfma_f32_32x32x16_bf16 v[56:71],v[28:31],a[4:7],v[56:71]
ds_read_b128 v[48:51],v16 offset:6144
ds_read2_b64 v[156:159],v189 offset0:0 offset1:32
s_add_u32 s60,s60,206569472
s_lshl_b32 s62,s46,10
v_mfma_f32_32x32x16_bf16 v[72:87],v[28:31],a[164:167],v[72:87]
ds_read2_b64 v[160:163],v189 offset0:64 offset1:96
s_add_u32 s62,s62,40960
s_add_u32 m0,s66,s62
s_add_u32 s63,s60,s62
s_waitcnt lgkmcnt(5)
v_mfma_f32_32x32x16_bf16 v[56:71],v[32:35],a[8:11],v[56:71]
ds_read_b128 v[52:55],v17 offset:6144
ds_read2_b64 v[164:167],v189 offset0:128 offset1:160
buffer_load_dwordx4 v1,s[8:11],s63 offen sc1 lds
v_mfma_f32_32x32x16_bf16 v[72:87],v[32:35],a[168:171],v[72:87]
ds_read2_b64 v[168:171],v189 offset0:192 offset1:224
s_add_u32 m0,s66,45056
s_add_u32 s63,s60,45056
s_mul_i32 s74,s73,393216
s_add_u32 s74,s74,s39
v_mfma_f32_32x32x16_bf16 v[56:71],v[36:39],a[12:15],v[56:71]
ds_read_b128 v[24:27],v16 offset:8192
ds_read2_b64 v[172:175],v8 offset0:0 offset1:32
s_add_u32 s74,s74,s70
v_fma_f32 v88,-v124,v120,v88
v_mfma_f32_32x32x16_bf16 v[72:87],v[36:39],a[172:175],v[72:87]
buffer_load_dwordx4 v1,s[8:11],s63 offen sc1 lds
s_mul_i32 s61,s46,10240
s_add_u32 s60,s60,s61
s_add_u32 s61,s61,s66
s_waitcnt lgkmcnt(8)
v_mfma_f32_32x32x16_bf16 v[56:71],v[40:43],a[16:19],v[56:71]
ds_read_b128 v[28:31],v17 offset:8192
s_add_u32 m0,s61,0
s_add_u32 s63,s60,0
v_fma_f32 v89,-v126,v120,v89
v_fma_f32 v90,-v128,v120,v90
v_mfma_f32_32x32x16_bf16 v[72:87],v[40:43],a[176:179],v[72:87]
v_fma_f32 v91,-v130,v120,v91
v_fma_f32 v96,-v140,v120,v96
v_fma_f32 v97,-v142,v120,v97
v_fma_f32 v98,-v144,v120,v98
v_fma_f32 v99,-v146,v120,v99
v_mfma_f32_32x32x16_bf16 v[56:71],v[44:47],a[20:23],v[56:71]
ds_read_b128 v[32:35],v16 offset:10240
buffer_load_dwordx4 v1,s[8:11],s63 offen sc1 lds
v_mul_f32 v88,v88,v125
v_mul_f32 v89,v89,v127
v_mfma_f32_32x32x16_bf16 v[72:87],v[44:47],a[180:183],v[72:87]
v_mul_f32 v90,v90,v129
v_mul_f32 v91,v91,v131
v_mul_f32 v96,v96,v141
v_mul_f32 v97,v97,v143
v_mul_f32 v98,v98,v145
s_waitcnt lgkmcnt(6)
v_mfma_f32_32x32x16_bf16 v[56:71],v[48:51],a[24:27],v[56:71]
ds_read_b128 v[36:39],v17 offset:10240
v_mul_f32 v99,v99,v147
v_cvt_pk_bf16_f32 v180,v88,v89
v_cvt_pk_bf16_f32 v181,v90,v91
v_cvt_pk_bf16_f32 v182,v96,v97
v_mfma_f32_32x32x16_bf16 v[72:87],v[48:51],a[184:187],v[72:87]
buffer_load_dwordx4 v1,s[8:11],s63 offen offset:1024 sc1 lds
v_cvt_pk_bf16_f32 v183,v98,v99
buffer_store_dwordx4 v[180:183],v20,s[8:11],s74 offen sc1
v_fma_f32 v92,-v132,v120,v92
v_mfma_f32_32x32x16_bf16 v[56:71],v[52:55],a[28:31],v[56:71]
ds_read_b128 v[40:43],v16 offset:12288
v_fma_f32 v93,-v134,v120,v93
v_fma_f32 v94,-v136,v120,v94
v_fma_f32 v95,-v138,v120,v95
v_fma_f32 v100,-v148,v120,v100
v_mfma_f32_32x32x16_bf16 v[72:87],v[52:55],a[188:191],v[72:87]
v_fma_f32 v101,-v150,v120,v101
v_fma_f32 v102,-v152,v120,v102
v_fma_f32 v103,-v154,v120,v103
v_mul_f32 v92,v92,v133
v_mul_f32 v93,v93,v135
s_waitcnt lgkmcnt(3)
v_mfma_f32_32x32x16_bf16 v[56:71],v[24:27],a[32:35],v[56:71]
ds_read_b128 v[44:47],v17 offset:12288
buffer_load_dwordx4 v1,s[8:11],s63 offen offset:2048 sc1 lds
v_mul_f32 v94,v94,v137
v_mul_f32 v95,v95,v139
v_mfma_f32_32x32x16_bf16 v[72:87],v[24:27],a[192:195],v[72:87]
v_mul_f32 v100,v100,v149
v_mul_f32 v101,v101,v151
v_mul_f32 v102,v102,v153
v_mul_f32 v103,v103,v155
v_cvt_pk_bf16_f32 v184,v92,v93
v_mfma_f32_32x32x16_bf16 v[56:71],v[28:31],a[36:39],v[56:71]
ds_read_b128 v[48:51],v16 offset:14336
v_cvt_pk_bf16_f32 v185,v94,v95
v_cvt_pk_bf16_f32 v186,v100,v101
v_cvt_pk_bf16_f32 v187,v102,v103
v_mfma_f32_32x32x16_bf16 v[72:87],v[28:31],a[196:199],v[72:87]
buffer_load_dwordx4 v1,s[8:11],s63 offen offset:3072 sc1 lds
s_add_u32 m0,s61,4096
s_add_u32 s63,s60,4096
s_waitcnt lgkmcnt(3)
v_mfma_f32_32x32x16_bf16 v[56:71],v[32:35],a[40:43],v[56:71]
ds_read_b128 v[52:55],v17 offset:14336
buffer_store_dwordx4 v[184:187],v21,s[8:11],s74 offen sc1
v_fma_f32 v104,-v124,v121,v104
v_fma_f32 v105,-v126,v121,v105
v_mfma_f32_32x32x16_bf16 v[72:87],v[32:35],a[200:203],v[72:87]
v_fma_f32 v106,-v128,v121,v106
v_fma_f32 v107,-v130,v121,v107
v_fma_f32 v112,-v140,v121,v112
v_fma_f32 v113,-v142,v121,v113
v_fma_f32 v114,-v144,v121,v114
v_mfma_f32_32x32x16_bf16 v[56:71],v[36:39],a[44:47],v[56:71]
ds_read_b128 v[24:27],v16 offset:16384
buffer_load_dwordx4 v1,s[8:11],s63 offen sc1 lds
v_fma_f32 v115,-v146,v121,v115
v_mul_f32 v104,v104,v125
v_mfma_f32_32x32x16_bf16 v[72:87],v[36:39],a[204:207],v[72:87]
v_mul_f32 v105,v105,v127
v_mul_f32 v106,v106,v129
v_mul_f32 v107,v107,v131
v_mul_f32 v112,v112,v141
v_mul_f32 v113,v113,v143
s_waitcnt lgkmcnt(3)
v_mfma_f32_32x32x16_bf16 v[56:71],v[40:43],a[48:51],v[56:71]
ds_read_b128 v[28:31],v17 offset:16384
v_mul_f32 v114,v114,v145
v_mul_f32 v115,v115,v147
v_cvt_pk_bf16_f32 v180,v104,v105
v_cvt_pk_bf16_f32 v181,v106,v107
v_mfma_f32_32x32x16_bf16 v[72:87],v[40:43],a[208:211],v[72:87]
buffer_load_dwordx4 v1,s[8:11],s63 offen offset:1024 sc1 lds
v_cvt_pk_bf16_f32 v182,v112,v113
v_cvt_pk_bf16_f32 v183,v114,v115
buffer_store_dwordx4 v[180:183],v20,s[8:11],s74 offen offset:2048 sc1
v_mfma_f32_32x32x16_bf16 v[56:71],v[44:47],a[52:55],v[56:71]
ds_read_b128 v[32:35],v16 offset:18432
v_fma_f32 v108,-v132,v121,v108
v_fma_f32 v109,-v134,v121,v109
v_fma_f32 v110,-v136,v121,v110
v_fma_f32 v111,-v138,v121,v111
v_mfma_f32_32x32x16_bf16 v[72:87],v[44:47],a[212:215],v[72:87]
v_fma_f32 v116,-v148,v121,v116
v_fma_f32 v117,-v150,v121,v117
v_fma_f32 v118,-v152,v121,v118
v_fma_f32 v119,-v154,v121,v119
v_mul_f32 v108,v108,v133
s_waitcnt lgkmcnt(3)
v_mfma_f32_32x32x16_bf16 v[56:71],v[48:51],a[56:59],v[56:71]
ds_read_b128 v[36:39],v17 offset:18432
buffer_load_dwordx4 v1,s[8:11],s63 offen offset:2048 sc1 lds
v_mul_f32 v109,v109,v135
v_mul_f32 v110,v110,v137
v_mfma_f32_32x32x16_bf16 v[72:87],v[48:51],a[216:219],v[72:87]
v_mul_f32 v111,v111,v139
v_mul_f32 v116,v116,v149
v_mul_f32 v117,v117,v151
v_mul_f32 v118,v118,v153
v_mul_f32 v119,v119,v155
v_mfma_f32_32x32x16_bf16 v[56:71],v[52:55],a[60:63],v[56:71]
ds_read_b128 v[40:43],v16 offset:20480
s_waitcnt vmcnt(12)
s_mov_b64 exec,1
buffer_store_dword v5,v1,s[8:11],s59 offen sc1
s_mov_b64 exec,-1
s_mov_b32 s59,2147483648
v_mfma_f32_32x32x16_bf16 v[72:87],v[52:55],a[220:223],v[72:87]
buffer_load_dwordx4 v1,s[8:11],s63 offen offset:3072 sc1 lds
s_add_u32 m0,s61,8192
s_add_u32 s63,s60,8192
v_cvt_pk_bf16_f32 v184,v108,v109
s_waitcnt lgkmcnt(3)
v_mfma_f32_32x32x16_bf16 v[56:71],v[24:27],a[64:67],v[56:71]
ds_read_b128 v[44:47],v17 offset:20480
v_cvt_pk_bf16_f32 v185,v110,v111
v_cvt_pk_bf16_f32 v186,v116,v117
v_cvt_pk_bf16_f32 v187,v118,v119
v_mfma_f32_32x32x16_bf16 v[72:87],v[24:27],a[224:227],v[72:87]
buffer_store_dwordx4 v[184:187],v21,s[8:11],s74 offen offset:2048 sc1
s_lshl_b32 s82,s72,6
s_add_u32 s82,s82,s73
s_lshl_b32 s82,s82,9
s_add_u32 s82,s82,s71
v_mfma_f32_32x32x16_bf16 v[56:71],v[28:31],a[68:71],v[56:71]
ds_read_b128 v[48:51],v16 offset:22528
buffer_load_dwordx4 v1,s[8:11],s63 offen sc1 lds
s_lshl_b32 s75,s69,2
s_add_u32 s82,s82,s75
v_mfma_f32_32x32x16_bf16 v[72:87],v[28:31],a[228:231],v[72:87]
s_add_u32 s82,s82,s39
v_add_f32 v156,v156,v166
v_add_f32 v157,v157,v167
v_add_f32 v158,v158,v168
s_waitcnt lgkmcnt(3)
v_mfma_f32_32x32x16_bf16 v[56:71],v[32:35],a[72:75],v[56:71]
ds_read_b128 v[52:55],v17 offset:22528
v_add_f32 v159,v159,v169
v_add_f32 v160,v160,v170
v_add_f32 v161,v161,v171
v_add_f32 v162,v162,v172
v_mfma_f32_32x32x16_bf16 v[72:87],v[32:35],a[232:235],v[72:87]
buffer_load_dwordx4 v1,s[8:11],s63 offen offset:1024 sc1 lds
s_mov_b32 s53,s33
s_mov_b32 s54,s34
s_add_u32 s79,s79,s33
s_or_b32 s60,s37,s33
v_mfma_f32_32x32x16_bf16 v[56:71],v[36:39],a[76:79],v[56:71]
ds_read_b128 v[24:27],v16 offset:24576
s_cmp_eq_u32 s60,0
s_addc_u32 s78,s78,0
s_lshl_b32 s41,s78,9
s_add_u32 s41,s41,s40
v_mfma_f32_32x32x16_bf16 v[72:87],v[36:39],a[236:239],v[72:87]
s_lshl_b32 s35,s79,9
s_add_u32 s35,s35,s40
s_add_u32 s35,s35,32768
v_add_f32 v163,v163,v173
v_add_f32 v164,v164,v174
s_waitcnt lgkmcnt(3)
v_mfma_f32_32x32x16_bf16 v[56:71],v[40:43],a[80:83],v[56:71]
ds_read_b128 v[28:31],v17 offset:24576
v_add_f32 v165,v165,v175
v_add_f32 v156,v156,v158
v_add_f32 v157,v157,v159
v_add_f32 v160,v160,v162
v_mfma_f32_32x32x16_bf16 v[72:87],v[40:43],a[240:243],v[72:87]
v_add_f32 v161,v161,v163
v_add_f32 v156,v156,v160
v_add_f32 v157,v157,v161
v_add_f32 v156,v156,v164
v_add_f32 v157,v157,v165
v_mfma_f32_32x32x16_bf16 v[56:71],v[44:47],a[84:87],v[56:71]
ds_read_b128 v[32:35],v16 offset:26624
v_mov_b32 v158,v156
v_mov_b32 v159,v157
s_nop 0
v_permlane32_swap_b32 v156,v158
v_permlane32_swap_b32 v157,v159
v_mfma_f32_32x32x16_bf16 v[72:87],v[44:47],a[244:247],v[72:87]
v_add_f32 v176,v156,v158
v_add_f32 v177,v157,v159
v_mul_f32 v176,0x3acccccd,v176
v_mul_f32 v177,0x3acccccd,v177
v_fma_f32 v177,-v176,v176,v177
s_waitcnt lgkmcnt(3)
v_mfma_f32_32x32x16_bf16 v[56:71],v[48:51],a[88:91],v[56:71]
ds_read_b128 v[36:39],v17 offset:26624
buffer_load_dword v3,v2,s[8:11],s35 offen sc1
buffer_load_dword v14,v4,s[8:11],s41 offen sc1
v_mfma_f32_32x32x16_bf16 v[72:87],v[48:51],a[248:251],v[72:87]
v_max_f32 v177,0,v177
v_cvt_pk_bf16_f32 v8,v176,v177
v_lshlrev_b32 v176,16,v8
v_and_b32 v177,0xffff0000,v8
v_add_f32 v177,0x3727c5ac,v177
v_mfma_f32_32x32x16_bf16 v[56:71],v[52:55],a[92:95],v[56:71]
ds_read_b128 v[40:43],v16 offset:28672
v_cvt_pk_bf16_f32 v8,v177,v177
v_lshlrev_b32 v177,16,v8
v_sqrt_f32 v177,v177
v_mfma_f32_32x32x16_bf16 v[72:87],v[52:55],a[252:255],v[72:87]
v_cvt_pk_bf16_f32 v8,v177,v177
v_lshlrev_b32 v177,16,v8
v_rcp_f32 v177,v177
s_waitcnt lgkmcnt(3)
v_mfma_f32_32x32x16_bf16 v[56:71],v[24:27],a[96:99],v[56:71]
ds_read_b128 v[44:47],v17 offset:28672
s_cmp_eq_u32 s51,0
s_cselect_b64 s[76:77],-1,0
v_cndmask_b32 v176,v176,0,s[76:77]
v_cndmask_b32 v177,v177,1.0,s[76:77]
v_mfma_f32_32x32x16_bf16 v[72:87],v[24:27],v[192:195],v[72:87]
s_mov_b32 s72,s51
s_mov_b32 s73,s52
ds_write_b64 v190,v[176:177]
ds_read_b128 v[124:127],v191 offset:0
v_mfma_f32_32x32x16_bf16 v[56:71],v[28:31],a[100:103],v[56:71]
ds_read_b128 v[48:51],v16 offset:30720
ds_read_b128 v[128:131],v191 offset:16
ds_read_b128 v[132:135],v191 offset:64
v_mfma_f32_32x32x16_bf16 v[72:87],v[28:31],v[196:199],v[72:87]
ds_read_b128 v[136:139],v191 offset:80
ds_read_b128 v[140:143],v191 offset:128
s_waitcnt lgkmcnt(9)
v_mfma_f32_32x32x16_bf16 v[56:71],v[32:35],a[104:107],v[56:71]
ds_read_b128 v[52:55],v17 offset:30720
ds_read_b128 v[144:147],v191 offset:144
ds_read_b128 v[148:151],v191 offset:192
v_mfma_f32_32x32x16_bf16 v[72:87],v[32:35],v[200:203],v[72:87]
ds_read_b128 v[152:155],v191 offset:208
v_mfma_f32_32x32x16_bf16 v[56:71],v[36:39],a[108:111],v[56:71]
ds_read_b128 v[24:27],v16 offset:32768
v_mfma_f32_32x32x16_bf16 v[72:87],v[36:39],v[204:207],v[72:87]
s_waitcnt lgkmcnt(12)
v_mfma_f32_32x32x16_bf16 v[56:71],v[40:43],a[112:115],v[56:71]
ds_read_b128 v[28:31],v17 offset:32768
v_mfma_f32_32x32x16_bf16 v[72:87],v[40:43],v[208:211],v[72:87]
v_mfma_f32_32x32x16_bf16 v[56:71],v[44:47],a[116:119],v[56:71]
ds_read_b128 v[32:35],v16 offset:34816
s_waitcnt vmcnt(4)
s_mov_b64 exec,1
buffer_store_dword v5,v1,s[8:11],s82 offen sc1
s_mov_b64 exec,-1
s_mov_b32 s82,2147483648
v_mfma_f32_32x32x16_bf16 v[72:87],v[44:47],v[212:215],v[72:87]
s_waitcnt lgkmcnt(6)
v_mfma_f32_32x32x16_bf16 v[56:71],v[48:51],a[120:123],v[56:71]
ds_read_b128 v[36:39],v17 offset:34816
v_mfma_f32_32x32x16_bf16 v[72:87],v[48:51],v[216:219],v[72:87]
v_mfma_f32_32x32x16_bf16 v[56:71],v[52:55],a[124:127],v[56:71]
ds_read_b128 v[40:43],v16 offset:36864
s_waitcnt vmcnt(1)
v_cmp_eq_u32 vcc,0,v14
s_cmp_eq_u64 vcc,0
s_cselect_b32 s36,0,2147483648
v_mfma_f32_32x32x16_bf16 v[72:87],v[52:55],v[220:223],v[72:87]
v_cmp_eq_u32 vcc,0,v3
s_cmp_lt_u32 s78,64
s_cselect_b32 s36,s36,2147483648
s_cmp_eq_u64 vcc,0
s_cselect_b32 s60,1,s36
s_waitcnt lgkmcnt(3)
v_mfma_f32_32x32x16_bf16 v[56:71],v[24:27],a[128:131],v[56:71]
ds_read_b128 v[44:47],v17 offset:36864
s_cmp_lt_u32 s79,64
s_cselect_b32 s60,s60,s36
s_sub_u32 s61,s78,s79
s_or_b32 s61,s61,s36
v_mfma_f32_32x32x16_bf16 v[72:87],v[24:27],v[224:227],v[72:87]
s_cmp_lt_u32 s61,16
s_cselect_b32 s36,0,s60
v_mov_b32 v23,s36
ds_write_b32 v13,v23
v_mfma_f32_32x32x16_bf16 v[56:71],v[28:31],a[132:135],v[56:71]
ds_read_b128 v[48:51],v16 offset:38912
v_mfma_f32_32x32x16_bf16 v[72:87],v[28:31],v[228:231],v[72:87]
s_waitcnt lgkmcnt(4)
v_mfma_f32_32x32x16_bf16 v[56:71],v[32:35],a[136:139],v[56:71]
ds_read_b128 v[52:55],v17 offset:38912
v_mfma_f32_32x32x16_bf16 v[72:87],v[32:35],v[232:235],v[72:87]
s_waitcnt lgkmcnt(2)
s_barrier
ds_read_b32 v23,v22
v_mfma_f32_32x32x16_bf16 v[56:71],v[36:39],a[140:143],v[56:71]
ds_read_b128 v[24:27],v18 offset:0
s_cmp_lt_u32 s50,2
s_cselect_b32 s42,1,0
s_or_b32 s42,s42,s37
s_mov_b32 s39,0
v_mfma_f32_32x32x16_bf16 v[72:87],v[36:39],v[236:239],v[72:87]
s_add_u32 s50,s50,1
s_sub_u32 s57,46080,s57
s_mov_b32 s51,s53
s_mov_b32 s52,s54
v_mfma_f32_32x32x16_bf16 v[56:71],v[40:43],a[144:147],v[56:71]
ds_read_b128 v[28:31],v19 offset:0
v_mfma_f32_32x32x16_bf16 v[72:87],v[40:43],v[240:243],v[72:87]
v_mfma_f32_32x32x16_bf16 v[56:71],v[44:47],a[148:151],v[56:71]
ds_read_b128 v[32:35],v18 offset:2048
s_waitcnt lgkmcnt(3)
v_readfirstlane_b32 s38,v23
s_and_b32 s37,s38,2147483648
v_mfma_f32_32x32x16_bf16 v[72:87],v[44:47],v[244:247],v[72:87]
s_and_b32 s33,s38,1
s_cselect_b32 s34,s79,s78
s_cmp_lg_u32 s42,0
v_mfma_f32_32x32x16_bf16 v[56:71],v[48:51],a[152:155],v[56:71]
ds_read_b128 v[36:39],v19 offset:2048
v_mfma_f32_32x32x16_bf16 v[72:87],v[48:51],v[248:251],v[72:87]
v_mfma_f32_32x32x16_bf16 v[56:71],v[52:55],a[156:159],v[56:71]
ds_read_b128 v[40:43],v18 offset:4096
v_mfma_f32_32x32x16_bf16 v[72:87],v[52:55],v[252:255],v[72:87]
s_cbranch_scc1 QKVV_S0
QKVV_B1:
s_waitcnt lgkmcnt(3)
v_mfma_f32_32x32x16_bf16 v[88:103],v[24:27],a[0:3],0
ds_read_b128 v[44:47],v19 offset:4096
v_add_u32 v189,s57,v188
v_mfma_f32_32x32x16_bf16 v[104:119],v[24:27],a[160:163],0
v_add_u32 v8,0x800,v189
s_sub_u32 s66,46080,s57
s_lshl_b32 s60,s33,6
s_add_u32 s60,s60,s34
s_mul_i32 s60,s60,46080
s_add_u32 s60,s60,s37
v_mfma_f32_32x32x16_bf16 v[88:103],v[28:31],a[4:7],v[88:103]
ds_read_b128 v[48:51],v18 offset:6144
ds_read2_b64 v[156:159],v189 offset0:0 offset1:32
s_add_u32 s60,s60,206569472
s_lshl_b32 s62,s46,10
v_mfma_f32_32x32x16_bf16 v[104:119],v[28:31],a[164:167],v[104:119]
ds_read2_b64 v[160:163],v189 offset0:64 offset1:96
s_add_u32 s62,s62,40960
s_add_u32 m0,s66,s62
s_add_u32 s63,s60,s62
s_waitcnt lgkmcnt(5)
v_mfma_f32_32x32x16_bf16 v[88:103],v[32:35],a[8:11],v[88:103]
ds_read_b128 v[52:55],v19 offset:6144
ds_read2_b64 v[164:167],v189 offset0:128 offset1:160
buffer_load_dwordx4 v1,s[8:11],s63 offen sc1 lds
v_mfma_f32_32x32x16_bf16 v[104:119],v[32:35],a[168:171],v[104:119]
ds_read2_b64 v[168:171],v189 offset0:192 offset1:224
s_add_u32 m0,s66,45056
s_add_u32 s63,s60,45056
s_mul_i32 s74,s73,393216
s_add_u32 s74,s74,s39
v_mfma_f32_32x32x16_bf16 v[88:103],v[36:39],a[12:15],v[88:103]
ds_read_b128 v[24:27],v18 offset:8192
ds_read2_b64 v[172:175],v8 offset0:0 offset1:32
s_add_u32 s74,s74,s70
v_fma_f32 v56,-v124,v120,v56
v_mfma_f32_32x32x16_bf16 v[104:119],v[36:39],a[172:175],v[104:119]
buffer_load_dwordx4 v1,s[8:11],s63 offen sc1 lds
s_mul_i32 s61,s46,10240
s_add_u32 s60,s60,s61
s_add_u32 s61,s61,s66
s_waitcnt lgkmcnt(8)
v_mfma_f32_32x32x16_bf16 v[88:103],v[40:43],a[16:19],v[88:103]
ds_read_b128 v[28:31],v19 offset:8192
s_add_u32 m0,s61,0
s_add_u32 s63,s60,0
v_fma_f32 v57,-v126,v120,v57
v_fma_f32 v58,-v128,v120,v58
v_mfma_f32_32x32x16_bf16 v[104:119],v[40:43],a[176:179],v[104:119]
v_fma_f32 v59,-v130,v120,v59
v_fma_f32 v64,-v140,v120,v64
v_fma_f32 v65,-v142,v120,v65
v_fma_f32 v66,-v144,v120,v66
v_fma_f32 v67,-v146,v120,v67
v_mfma_f32_32x32x16_bf16 v[88:103],v[44:47],a[20:23],v[88:103]
ds_read_b128 v[32:35],v18 offset:10240
buffer_load_dwordx4 v1,s[8:11],s63 offen sc1 lds
v_mul_f32 v56,v56,v125
v_mul_f32 v57,v57,v127
v_mfma_f32_32x32x16_bf16 v[104:119],v[44:47],a[180:183],v[104:119]
v_mul_f32 v58,v58,v129
v_mul_f32 v59,v59,v131
v_mul_f32 v64,v64,v141
v_mul_f32 v65,v65,v143
v_mul_f32 v66,v66,v145
s_waitcnt lgkmcnt(6)
v_mfma_f32_32x32x16_bf16 v[88:103],v[48:51],a[24:27],v[88:103]
ds_read_b128 v[36:39],v19 offset:10240
v_mul_f32 v67,v67,v147
v_cvt_pk_bf16_f32 v180,v56,v57
v_cvt_pk_bf16_f32 v181,v58,v59
v_cvt_pk_bf16_f32 v182,v64,v65
v_mfma_f32_32x32x16_bf16 v[104:119],v[48:51],a[184:187],v[104:119]
buffer_load_dwordx4 v1,s[8:11],s63 offen offset:1024 sc1 lds
v_cvt_pk_bf16_f32 v183,v66,v67
buffer_store_dwordx4 v[180:183],v20,s[8:11],s74 offen sc1
v_fma_f32 v60,-v132,v120,v60
v_mfma_f32_32x32x16_bf16 v[88:103],v[52:55],a[28:31],v[88:103]
ds_read_b128 v[40:43],v18 offset:12288
v_fma_f32 v61,-v134,v120,v61
v_fma_f32 v62,-v136,v120,v62
v_fma_f32 v63,-v138,v120,v63
v_fma_f32 v68,-v148,v120,v68
v_mfma_f32_32x32x16_bf16 v[104:119],v[52:55],a[188:191],v[104:119]
v_fma_f32 v69,-v150,v120,v69
v_fma_f32 v70,-v152,v120,v70
v_fma_f32 v71,-v154,v120,v71
v_mul_f32 v60,v60,v133
v_mul_f32 v61,v61,v135
s_waitcnt lgkmcnt(3)
v_mfma_f32_32x32x16_bf16 v[88:103],v[24:27],a[32:35],v[88:103]
ds_read_b128 v[44:47],v19 offset:12288
buffer_load_dwordx4 v1,s[8:11],s63 offen offset:2048 sc1 lds
v_mul_f32 v62,v62,v137
v_mul_f32 v63,v63,v139
v_mfma_f32_32x32x16_bf16 v[104:119],v[24:27],a[192:195],v[104:119]
v_mul_f32 v68,v68,v149
v_mul_f32 v69,v69,v151
v_mul_f32 v70,v70,v153
v_mul_f32 v71,v71,v155
v_cvt_pk_bf16_f32 v184,v60,v61
v_mfma_f32_32x32x16_bf16 v[88:103],v[28:31],a[36:39],v[88:103]
ds_read_b128 v[48:51],v18 offset:14336
v_cvt_pk_bf16_f32 v185,v62,v63
v_cvt_pk_bf16_f32 v186,v68,v69
v_cvt_pk_bf16_f32 v187,v70,v71
v_mfma_f32_32x32x16_bf16 v[104:119],v[28:31],a[196:199],v[104:119]
buffer_load_dwordx4 v1,s[8:11],s63 offen offset:3072 sc1 lds
s_add_u32 m0,s61,4096
s_add_u32 s63,s60,4096
s_waitcnt lgkmcnt(3)
v_mfma_f32_32x32x16_bf16 v[88:103],v[32:35],a[40:43],v[88:103]
ds_read_b128 v[52:55],v19 offset:14336
buffer_store_dwordx4 v[184:187],v21,s[8:11],s74 offen sc1
v_fma_f32 v72,-v124,v121,v72
v_fma_f32 v73,-v126,v121,v73
v_mfma_f32_32x32x16_bf16 v[104:119],v[32:35],a[200:203],v[104:119]
v_fma_f32 v74,-v128,v121,v74
v_fma_f32 v75,-v130,v121,v75
v_fma_f32 v80,-v140,v121,v80
v_fma_f32 v81,-v142,v121,v81
v_fma_f32 v82,-v144,v121,v82
v_mfma_f32_32x32x16_bf16 v[88:103],v[36:39],a[44:47],v[88:103]
ds_read_b128 v[24:27],v18 offset:16384
buffer_load_dwordx4 v1,s[8:11],s63 offen sc1 lds
v_fma_f32 v83,-v146,v121,v83
v_mul_f32 v72,v72,v125
v_mfma_f32_32x32x16_bf16 v[104:119],v[36:39],a[204:207],v[104:119]
v_mul_f32 v73,v73,v127
v_mul_f32 v74,v74,v129
v_mul_f32 v75,v75,v131
v_mul_f32 v80,v80,v141
v_mul_f32 v81,v81,v143
s_waitcnt lgkmcnt(3)
v_mfma_f32_32x32x16_bf16 v[88:103],v[40:43],a[48:51],v[88:103]
ds_read_b128 v[28:31],v19 offset:16384
v_mul_f32 v82,v82,v145
v_mul_f32 v83,v83,v147
v_cvt_pk_bf16_f32 v180,v72,v73
v_cvt_pk_bf16_f32 v181,v74,v75
v_mfma_f32_32x32x16_bf16 v[104:119],v[40:43],a[208:211],v[104:119]
buffer_load_dwordx4 v1,s[8:11],s63 offen offset:1024 sc1 lds
v_cvt_pk_bf16_f32 v182,v80,v81
v_cvt_pk_bf16_f32 v183,v82,v83
buffer_store_dwordx4 v[180:183],v20,s[8:11],s74 offen offset:2048 sc1
v_mfma_f32_32x32x16_bf16 v[88:103],v[44:47],a[52:55],v[88:103]
ds_read_b128 v[32:35],v18 offset:18432
v_fma_f32 v76,-v132,v121,v76
v_fma_f32 v77,-v134,v121,v77
v_fma_f32 v78,-v136,v121,v78
v_fma_f32 v79,-v138,v121,v79
v_mfma_f32_32x32x16_bf16 v[104:119],v[44:47],a[212:215],v[104:119]
v_fma_f32 v84,-v148,v121,v84
v_fma_f32 v85,-v150,v121,v85
v_fma_f32 v86,-v152,v121,v86
v_fma_f32 v87,-v154,v121,v87
v_mul_f32 v76,v76,v133
s_waitcnt lgkmcnt(3)
v_mfma_f32_32x32x16_bf16 v[88:103],v[48:51],a[56:59],v[88:103]
ds_read_b128 v[36:39],v19 offset:18432
buffer_load_dwordx4 v1,s[8:11],s63 offen offset:2048 sc1 lds
v_mul_f32 v77,v77,v135
v_mul_f32 v78,v78,v137
v_mfma_f32_32x32x16_bf16 v[104:119],v[48:51],a[216:219],v[104:119]
v_mul_f32 v79,v79,v139
v_mul_f32 v84,v84,v149
v_mul_f32 v85,v85,v151
v_mul_f32 v86,v86,v153
v_mul_f32 v87,v87,v155
v_mfma_f32_32x32x16_bf16 v[88:103],v[52:55],a[60:63],v[88:103]
ds_read_b128 v[40:43],v18 offset:20480
s_waitcnt vmcnt(12)
s_mov_b64 exec,1
buffer_store_dword v5,v1,s[8:11],s59 offen sc1
s_mov_b64 exec,-1
s_mov_b32 s59,2147483648
v_mfma_f32_32x32x16_bf16 v[104:119],v[52:55],a[220:223],v[104:119]
buffer_load_dwordx4 v1,s[8:11],s63 offen offset:3072 sc1 lds
s_add_u32 m0,s61,8192
s_add_u32 s63,s60,8192
v_cvt_pk_bf16_f32 v184,v76,v77
s_waitcnt lgkmcnt(3)
v_mfma_f32_32x32x16_bf16 v[88:103],v[24:27],a[64:67],v[88:103]
ds_read_b128 v[44:47],v19 offset:20480
v_cvt_pk_bf16_f32 v185,v78,v79
v_cvt_pk_bf16_f32 v186,v84,v85
v_cvt_pk_bf16_f32 v187,v86,v87
v_mfma_f32_32x32x16_bf16 v[104:119],v[24:27],a[224:227],v[104:119]
buffer_store_dwordx4 v[184:187],v21,s[8:11],s74 offen offset:2048 sc1
s_lshl_b32 s82,s72,6
s_add_u32 s82,s82,s73
s_lshl_b32 s82,s82,9
s_add_u32 s82,s82,s71
v_mfma_f32_32x32x16_bf16 v[88:103],v[28:31],a[68:71],v[88:103]
ds_read_b128 v[48:51],v18 offset:22528
buffer_load_dwordx4 v1,s[8:11],s63 offen sc1 lds
s_lshl_b32 s75,s69,2
s_add_u32 s82,s82,s75
v_mfma_f32_32x32x16_bf16 v[104:119],v[28:31],a[228:231],v[104:119]
s_add_u32 s82,s82,s39
v_add_f32 v156,v156,v166
v_add_f32 v157,v157,v167
v_add_f32 v158,v158,v168
s_waitcnt lgkmcnt(3)
v_mfma_f32_32x32x16_bf16 v[88:103],v[32:35],a[72:75],v[88:103]
ds_read_b128 v[52:55],v19 offset:22528
v_add_f32 v159,v159,v169
v_add_f32 v160,v160,v170
v_add_f32 v161,v161,v171
v_add_f32 v162,v162,v172
v_mfma_f32_32x32x16_bf16 v[104:119],v[32:35],a[232:235],v[104:119]
buffer_load_dwordx4 v1,s[8:11],s63 offen offset:1024 sc1 lds
s_mov_b32 s53,s33
s_mov_b32 s54,s34
s_add_u32 s79,s79,s33
s_or_b32 s60,s37,s33
v_mfma_f32_32x32x16_bf16 v[88:103],v[36:39],a[76:79],v[88:103]
ds_read_b128 v[24:27],v18 offset:24576
s_cmp_eq_u32 s60,0
s_addc_u32 s78,s78,0
s_lshl_b32 s41,s78,9
s_add_u32 s41,s41,s40
v_mfma_f32_32x32x16_bf16 v[104:119],v[36:39],a[236:239],v[104:119]
s_lshl_b32 s35,s79,9
s_add_u32 s35,s35,s40
s_add_u32 s35,s35,32768
v_add_f32 v163,v163,v173
v_add_f32 v164,v164,v174
s_waitcnt lgkmcnt(3)
v_mfma_f32_32x32x16_bf16 v[88:103],v[40:43],a[80:83],v[88:103]
ds_read_b128 v[28:31],v19 offset:24576
v_add_f32 v165,v165,v175
v_add_f32 v156,v156,v158
v_add_f32 v157,v157,v159
v_add_f32 v160,v160,v162
v_mfma_f32_32x32x16_bf16 v[104:119],v[40:43],a[240:243],v[104:119]
v_add_f32 v161,v161,v163
v_add_f32 v156,v156,v160
v_add_f32 v157,v157,v161
v_add_f32 v156,v156,v164
v_add_f32 v157,v157,v165
v_mfma_f32_32x32x16_bf16 v[88:103],v[44:47],a[84:87],v[88:103]
ds_read_b128 v[32:35],v18 offset:26624
v_mov_b32 v158,v156
v_mov_b32 v159,v157
s_nop 0
v_permlane32_swap_b32 v156,v158
v_permlane32_swap_b32 v157,v159
v_mfma_f32_32x32x16_bf16 v[104:119],v[44:47],a[244:247],v[104:119]
v_add_f32 v176,v156,v158
v_add_f32 v177,v157,v159
v_mul_f32 v176,0x3acccccd,v176
v_mul_f32 v177,0x3acccccd,v177
v_fma_f32 v177,-v176,v176,v177
s_waitcnt lgkmcnt(3)
v_mfma_f32_32x32x16_bf16 v[88:103],v[48:51],a[88:91],v[88:103]
ds_read_b128 v[36:39],v19 offset:26624
buffer_load_dword v3,v2,s[8:11],s35 offen sc1
buffer_load_dword v14,v4,s[8:11],s41 offen sc1
v_mfma_f32_32x32x16_bf16 v[104:119],v[48:51],a[248:251],v[104:119]
v_max_f32 v177,0,v177
v_cvt_pk_bf16_f32 v8,v176,v177
v_lshlrev_b32 v176,16,v8
v_and_b32 v177,0xffff0000,v8
v_add_f32 v177,0x3727c5ac,v177
v_mfma_f32_32x32x16_bf16 v[88:103],v[52:55],a[92:95],v[88:103]
ds_read_b128 v[40:43],v18 offset:28672
v_cvt_pk_bf16_f32 v8,v177,v177
v_lshlrev_b32 v177,16,v8
v_sqrt_f32 v177,v177
v_mfma_f32_32x32x16_bf16 v[104:119],v[52:55],a[252:255],v[104:119]
v_cvt_pk_bf16_f32 v8,v177,v177
v_lshlrev_b32 v177,16,v8
v_rcp_f32 v177,v177
s_waitcnt lgkmcnt(3)
v_mfma_f32_32x32x16_bf16 v[88:103],v[24:27],a[96:99],v[88:103]
ds_read_b128 v[44:47],v19 offset:28672
s_cmp_eq_u32 s51,0
s_cselect_b64 s[76:77],-1,0
v_cndmask_b32 v176,v176,0,s[76:77]
v_cndmask_b32 v177,v177,1.0,s[76:77]
v_mfma_f32_32x32x16_bf16 v[104:119],v[24:27],v[192:195],v[104:119]
s_mov_b32 s72,s51
s_mov_b32 s73,s52
ds_write_b64 v190,v[176:177]
ds_read_b128 v[124:127],v191 offset:0
v_mfma_f32_32x32x16_bf16 v[88:103],v[28:31],a[100:103],v[88:103]
ds_read_b128 v[48:51],v18 offset:30720
ds_read_b128 v[128:131],v191 offset:16
ds_read_b128 v[132:135],v191 offset:64
v_mfma_f32_32x32x16_bf16 v[104:119],v[28:31],v[196:199],v[104:119]
ds_read_b128 v[136:139],v191 offset:80
ds_read_b128 v[140:143],v191 offset:128
s_waitcnt lgkmcnt(9)
v_mfma_f32_32x32x16_bf16 v[88:103],v[32:35],a[104:107],v[88:103]
ds_read_b128 v[52:55],v19 offset:30720
ds_read_b128 v[144:147],v191 offset:144
ds_read_b128 v[148:151],v191 offset:192
v_mfma_f32_32x32x16_bf16 v[104:119],v[32:35],v[200:203],v[104:119]
ds_read_b128 v[152:155],v191 offset:208
v_mfma_f32_32x32x16_bf16 v[88:103],v[36:39],a[108:111],v[88:103]
ds_read_b128 v[24:27],v18 offset:32768
v_mfma_f32_32x32x16_bf16 v[104:119],v[36:39],v[204:207],v[104:119]
s_waitcnt lgkmcnt(12)
v_mfma_f32_32x32x16_bf16 v[88:103],v[40:43],a[112:115],v[88:103]
ds_read_b128 v[28:31],v19 offset:32768
v_mfma_f32_32x32x16_bf16 v[104:119],v[40:43],v[208:211],v[104:119]
v_mfma_f32_32x32x16_bf16 v[88:103],v[44:47],a[116:119],v[88:103]
ds_read_b128 v[32:35],v18 offset:34816
s_waitcnt vmcnt(4)
s_mov_b64 exec,1
buffer_store_dword v5,v1,s[8:11],s82 offen sc1
s_mov_b64 exec,-1
s_mov_b32 s82,2147483648
v_mfma_f32_32x32x16_bf16 v[104:119],v[44:47],v[212:215],v[104:119]
s_waitcnt lgkmcnt(6)
v_mfma_f32_32x32x16_bf16 v[88:103],v[48:51],a[120:123],v[88:103]
ds_read_b128 v[36:39],v19 offset:34816
v_mfma_f32_32x32x16_bf16 v[104:119],v[48:51],v[216:219],v[104:119]
v_mfma_f32_32x32x16_bf16 v[88:103],v[52:55],a[124:127],v[88:103]
ds_read_b128 v[40:43],v18 offset:36864
s_waitcnt vmcnt(1)
v_cmp_eq_u32 vcc,0,v14
s_cmp_eq_u64 vcc,0
s_cselect_b32 s36,0,2147483648
v_mfma_f32_32x32x16_bf16 v[104:119],v[52:55],v[220:223],v[104:119]
v_cmp_eq_u32 vcc,0,v3
s_cmp_lt_u32 s78,64
s_cselect_b32 s36,s36,2147483648
s_cmp_eq_u64 vcc,0
s_cselect_b32 s60,1,s36
s_waitcnt lgkmcnt(3)
v_mfma_f32_32x32x16_bf16 v[88:103],v[24:27],a[128:131],v[88:103]
ds_read_b128 v[44:47],v19 offset:36864
s_cmp_lt_u32 s79,64
s_cselect_b32 s60,s60,s36
s_sub_u32 s61,s78,s79
s_or_b32 s61,s61,s36
v_mfma_f32_32x32x16_bf16 v[104:119],v[24:27],v[224:227],v[104:119]
s_cmp_lt_u32 s61,16
s_cselect_b32 s36,0,s60
v_mov_b32 v23,s36
ds_write_b32 v13,v23
v_mfma_f32_32x32x16_bf16 v[88:103],v[28:31],a[132:135],v[88:103]
ds_read_b128 v[48:51],v18 offset:38912
v_mfma_f32_32x32x16_bf16 v[104:119],v[28:31],v[228:231],v[104:119]
s_waitcnt lgkmcnt(4)
v_mfma_f32_32x32x16_bf16 v[88:103],v[32:35],a[136:139],v[88:103]
ds_read_b128 v[52:55],v19 offset:38912
v_mfma_f32_32x32x16_bf16 v[104:119],v[32:35],v[232:235],v[104:119]
s_waitcnt lgkmcnt(2)
s_barrier
ds_read_b32 v23,v22
v_mfma_f32_32x32x16_bf16 v[88:103],v[36:39],a[140:143],v[88:103]
ds_read_b128 v[24:27],v16 offset:0
s_cmp_lt_u32 s50,2
s_cselect_b32 s42,1,0
s_or_b32 s42,s42,s37
s_mov_b32 s39,0
v_mfma_f32_32x32x16_bf16 v[104:119],v[36:39],v[236:239],v[104:119]
s_add_u32 s50,s50,1
s_sub_u32 s57,46080,s57
s_mov_b32 s51,s53
s_mov_b32 s52,s54
v_mfma_f32_32x32x16_bf16 v[88:103],v[40:43],a[144:147],v[88:103]
ds_read_b128 v[28:31],v17 offset:0
v_mfma_f32_32x32x16_bf16 v[104:119],v[40:43],v[240:243],v[104:119]
v_mfma_f32_32x32x16_bf16 v[88:103],v[44:47],a[148:151],v[88:103]
ds_read_b128 v[32:35],v16 offset:2048
s_waitcnt lgkmcnt(3)
v_readfirstlane_b32 s38,v23
s_and_b32 s37,s38,2147483648
v_mfma_f32_32x32x16_bf16 v[104:119],v[44:47],v[244:247],v[104:119]
s_and_b32 s33,s38,1
s_cselect_b32 s34,s79,s78
s_cmp_lg_u32 s42,0
v_mfma_f32_32x32x16_bf16 v[88:103],v[48:51],a[152:155],v[88:103]
ds_read_b128 v[36:39],v17 offset:2048
v_mfma_f32_32x32x16_bf16 v[104:119],v[48:51],v[248:251],v[104:119]
v_mfma_f32_32x32x16_bf16 v[88:103],v[52:55],a[156:159],v[88:103]
ds_read_b128 v[40:43],v16 offset:4096
v_mfma_f32_32x32x16_bf16 v[104:119],v[52:55],v[252:255],v[104:119]
s_cbranch_scc0 QKVV_B0
s_branch QKVV_S1
s_nop 9
QKVV_S0:
s_mov_b32 s55,0
s_cmp_lt_u32 s42,2
s_cbranch_scc1 nt_229
s_mov_b32 s55,2
s_cmp_lg_u32 s37,0
s_cbranch_scc1 nt_229
s_mov_b32 s55,1
s_lshl_b32 s60,s33,6
s_add_u32 s60,s60,s34
s_mul_i32 s60,s60,46080
s_add_u32 s60,s60,206569472
s_lshl_b32 s62,s46,10
s_add_u32 s62,s62,40960
s_add_u32 m0,s57,s62
s_add_u32 s63,s60,s62
buffer_load_dwordx4 v1,s[8:11],s63 offen sc1 lds
s_add_u32 m0,s57,45056
s_add_u32 s63,s60,45056
buffer_load_dwordx4 v1,s[8:11],s63 offen sc1 lds
s_mul_i32 s61,s46,10240
s_add_u32 s60,s60,s61
s_add_u32 s61,s61,s57
s_add_u32 m0,s61,0
s_add_u32 s63,s60,0
buffer_load_dwordx4 v1,s[8:11],s63 offen sc1 lds
buffer_load_dwordx4 v1,s[8:11],s63 offen offset:1024 sc1 lds
buffer_load_dwordx4 v1,s[8:11],s63 offen offset:2048 sc1 lds
buffer_load_dwordx4 v1,s[8:11],s63 offen offset:3072 sc1 lds
s_add_u32 m0,s61,4096
s_add_u32 s63,s60,4096
buffer_load_dwordx4 v1,s[8:11],s63 offen sc1 lds
buffer_load_dwordx4 v1,s[8:11],s63 offen offset:1024 sc1 lds
buffer_load_dwordx4 v1,s[8:11],s63 offen offset:2048 sc1 lds
buffer_load_dwordx4 v1,s[8:11],s63 offen offset:3072 sc1 lds
s_add_u32 m0,s61,8192
s_add_u32 s63,s60,8192
buffer_load_dwordx4 v1,s[8:11],s63 offen sc1 lds
buffer_load_dwordx4 v1,s[8:11],s63 offen offset:1024 sc1 lds
nt_229:
s_nop 4
s_mul_i32 s74,s73,393216
s_add_u32 s74,s74,s39
s_add_u32 s74,s74,s70
v_fma_f32 v56,-v124,v120,v56
v_fma_f32 v57,-v126,v120,v57
v_fma_f32 v58,-v128,v120,v58
v_fma_f32 v59,-v130,v120,v59
v_fma_f32 v64,-v140,v120,v64
v_fma_f32 v65,-v142,v120,v65
v_fma_f32 v66,-v144,v120,v66
v_fma_f32 v67,-v146,v120,v67
v_mul_f32 v56,v56,v125
v_mul_f32 v57,v57,v127
v_mul_f32 v58,v58,v129
v_mul_f32 v59,v59,v131
v_mul_f32 v64,v64,v141
v_mul_f32 v65,v65,v143
v_mul_f32 v66,v66,v145
v_mul_f32 v67,v67,v147
v_cvt_pk_bf16_f32 v180,v56,v57
v_cvt_pk_bf16_f32 v181,v58,v59
v_cvt_pk_bf16_f32 v182,v64,v65
v_cvt_pk_bf16_f32 v183,v66,v67
buffer_store_dwordx4 v[180:183],v20,s[8:11],s74 offen sc1
v_fma_f32 v60,-v132,v120,v60
v_fma_f32 v61,-v134,v120,v61
v_fma_f32 v62,-v136,v120,v62
v_fma_f32 v63,-v138,v120,v63
v_fma_f32 v68,-v148,v120,v68
v_fma_f32 v69,-v150,v120,v69
v_fma_f32 v70,-v152,v120,v70
v_fma_f32 v71,-v154,v120,v71
v_mul_f32 v60,v60,v133
v_mul_f32 v61,v61,v135
v_mul_f32 v62,v62,v137
v_mul_f32 v63,v63,v139
v_mul_f32 v68,v68,v149
v_mul_f32 v69,v69,v151
v_mul_f32 v70,v70,v153
v_mul_f32 v71,v71,v155
v_cvt_pk_bf16_f32 v184,v60,v61
v_cvt_pk_bf16_f32 v185,v62,v63
v_cvt_pk_bf16_f32 v186,v68,v69
v_cvt_pk_bf16_f32 v187,v70,v71
buffer_store_dwordx4 v[184:187],v21,s[8:11],s74 offen sc1
v_fma_f32 v72,-v124,v121,v72
v_fma_f32 v73,-v126,v121,v73
v_fma_f32 v74,-v128,v121,v74
v_fma_f32 v75,-v130,v121,v75
v_fma_f32 v80,-v140,v121,v80
v_fma_f32 v81,-v142,v121,v81
v_fma_f32 v82,-v144,v121,v82
v_fma_f32 v83,-v146,v121,v83
v_mul_f32 v72,v72,v125
v_mul_f32 v73,v73,v127
v_mul_f32 v74,v74,v129
v_mul_f32 v75,v75,v131
v_mul_f32 v80,v80,v141
v_mul_f32 v81,v81,v143
v_mul_f32 v82,v82,v145
v_mul_f32 v83,v83,v147
v_cvt_pk_bf16_f32 v180,v72,v73
v_cvt_pk_bf16_f32 v181,v74,v75
v_cvt_pk_bf16_f32 v182,v80,v81
v_cvt_pk_bf16_f32 v183,v82,v83
buffer_store_dwordx4 v[180:183],v20,s[8:11],s74 offen offset:2048 sc1
v_fma_f32 v76,-v132,v121,v76
v_fma_f32 v77,-v134,v121,v77
v_fma_f32 v78,-v136,v121,v78
v_fma_f32 v79,-v138,v121,v79
v_fma_f32 v84,-v148,v121,v84
v_fma_f32 v85,-v150,v121,v85
v_fma_f32 v86,-v152,v121,v86
v_fma_f32 v87,-v154,v121,v87
v_mul_f32 v76,v76,v133
v_mul_f32 v77,v77,v135
v_mul_f32 v78,v78,v137
v_mul_f32 v79,v79,v139
v_mul_f32 v84,v84,v149
v_mul_f32 v85,v85,v151
v_mul_f32 v86,v86,v153
v_mul_f32 v87,v87,v155
v_cvt_pk_bf16_f32 v184,v76,v77
v_cvt_pk_bf16_f32 v185,v78,v79
v_cvt_pk_bf16_f32 v186,v84,v85
v_cvt_pk_bf16_f32 v187,v86,v87
buffer_store_dwordx4 v[184:187],v21,s[8:11],s74 offen offset:2048 sc1
s_lshl_b32 s82,s72,6
s_add_u32 s82,s82,s73
s_lshl_b32 s82,s82,9
s_add_u32 s82,s82,s71
s_lshl_b32 s75,s69,2
s_add_u32 s82,s82,s75
s_add_u32 s82,s82,s39
s_mov_b32 s59,s82
s_mov_b32 s82,2147483648
s_mov_b32 s39,2147483648
s_cmp_eq_u32 s55,0
s_cbranch_scc1 QKVV_B1
s_cmp_eq_u32 s55,1
s_cbranch_scc1 QKVV_CD1
s_waitcnt vmcnt(0)
s_mov_b64 exec,1
buffer_store_dword v5,v1,s[8:11],s59 offen sc1
s_mov_b64 exec,-1
s_mov_b32 s59,2147483648
s_cmp_eq_u32 s50,128
s_cbranch_scc1 QKVV_END
s_branch QKVV_COLD1
QKVV_COLD0:
s_cmp_lg_u32 s46,0
s_cbranch_scc1 cp_230
ct_231:
buffer_load_dword v3,v2,s[8:11],s35 offen sc1
buffer_load_dword v14,v4,s[8:11],s41 offen sc1
s_waitcnt vmcnt(0)
v_cmp_eq_u32 vcc,0,v14
s_cmp_eq_u64 vcc,0
s_cselect_b32 s36,0,2147483648
v_cmp_eq_u32 vcc,0,v3
s_cmp_lt_u32 s78,64
s_cselect_b32 s36,s36,2147483648
s_cmp_eq_u64 vcc,0
s_cselect_b32 s60,1,s36
s_cmp_lt_u32 s79,64
s_cselect_b32 s60,s60,s36
s_sub_u32 s61,s78,s79
s_or_b32 s61,s61,s36
s_cmp_lt_u32 s61,16
s_cselect_b32 s36,0,s60
v_mov_b32 v23,s36
s_cmp_lt_u32 s36,2
s_cbranch_scc1 ct_231x
s_sleep 3
s_sub_u32 s47,s47,1
s_cbranch_scc1 ABORT
s_branch ct_231
ct_231x:
ds_write_b32 v22,v23 offset:4
s_waitcnt lgkmcnt(0)
cp_230:
s_barrier
ds_read_b32 v23,v22 offset:4
s_waitcnt lgkmcnt(0)
v_readfirstlane_b32 s38,v23
s_and_b32 s38,s38,1
s_and_b32 s37,s38,2147483648
s_and_b32 s33,s38,1
s_cselect_b32 s34,s79,s78
s_lshl_b32 s60,s33,6
s_add_u32 s60,s60,s34
s_mul_i32 s60,s60,46080
s_add_u32 s60,s60,206569472
s_lshl_b32 s62,s46,10
s_add_u32 s62,s62,40960
s_add_u32 m0,s57,s62
s_add_u32 s63,s60,s62
buffer_load_dwordx4 v1,s[8:11],s63 offen sc1 lds
s_add_u32 m0,s57,45056
s_add_u32 s63,s60,45056
buffer_load_dwordx4 v1,s[8:11],s63 offen sc1 lds
s_mul_i32 s61,s46,10240
s_add_u32 s60,s60,s61
s_add_u32 s61,s61,s57
s_add_u32 m0,s61,0
s_add_u32 s63,s60,0
buffer_load_dwordx4 v1,s[8:11],s63 offen sc1 lds
buffer_load_dwordx4 v1,s[8:11],s63 offen offset:1024 sc1 lds
buffer_load_dwordx4 v1,s[8:11],s63 offen offset:2048 sc1 lds
buffer_load_dwordx4 v1,s[8:11],s63 offen offset:3072 sc1 lds
s_add_u32 m0,s61,4096
s_add_u32 s63,s60,4096
buffer_load_dwordx4 v1,s[8:11],s63 offen sc1 lds
buffer_load_dwordx4 v1,s[8:11],s63 offen offset:1024 sc1 lds
buffer_load_dwordx4 v1,s[8:11],s63 offen offset:2048 sc1 lds
buffer_load_dwordx4 v1,s[8:11],s63 offen offset:3072 sc1 lds
s_add_u32 m0,s61,8192
s_add_u32 s63,s60,8192
buffer_load_dwordx4 v1,s[8:11],s63 offen sc1 lds
buffer_load_dwordx4 v1,s[8:11],s63 offen offset:1024 sc1 lds
QKVV_CD0:
s_mov_b32 s51,s33
s_mov_b32 s52,s34
s_mov_b32 s53,s33
s_mov_b32 s54,s34
s_add_u32 s79,s79,s33
s_or_b32 s60,s37,s33
s_cmp_eq_u32 s60,0
s_addc_u32 s78,s78,0
s_lshl_b32 s41,s78,9
s_add_u32 s41,s41,s40
s_lshl_b32 s35,s79,9
s_add_u32 s35,s35,s40
s_add_u32 s35,s35,32768
buffer_load_dword v3,v2,s[8:11],s35 offen sc1
buffer_load_dword v14,v4,s[8:11],s41 offen sc1
s_waitcnt vmcnt(0)
s_mov_b64 exec,1
buffer_store_dword v5,v1,s[8:11],s59 offen sc1
s_mov_b64 exec,-1
s_mov_b32 s59,2147483648
v_cmp_eq_u32 vcc,0,v14
s_cmp_eq_u64 vcc,0
s_cselect_b32 s36,0,2147483648
v_cmp_eq_u32 vcc,0,v3
s_cmp_lt_u32 s78,64
s_cselect_b32 s36,s36,2147483648
s_cmp_eq_u64 vcc,0
s_cselect_b32 s60,1,s36
s_cmp_lt_u32 s79,64
s_cselect_b32 s60,s60,s36
s_sub_u32 s61,s78,s79
s_or_b32 s61,s61,s36
s_cmp_lt_u32 s61,16
s_cselect_b32 s36,0,s60
v_mov_b32 v23,s36
ds_write_b32 v13,v23
s_waitcnt lgkmcnt(0)
s_barrier
ds_read_b32 v23,v22
ds_read_b128 v[24:27],v16 offset:0
ds_read_b128 v[28:31],v17 offset:0
ds_read_b128 v[32:35],v16 offset:2048
ds_read_b128 v[36:39],v17 offset:2048
ds_read_b128 v[40:43],v16 offset:4096
s_waitcnt lgkmcnt(5)
v_readfirstlane_b32 s38,v23
s_and_b32 s37,s38,2147483648
s_and_b32 s33,s38,1
s_cselect_b32 s34,s79,s78
s_nop 0
s_branch QKVV_B0
QKVV_S1:
s_mov_b32 s55,0
s_cmp_lt_u32 s42,2
s_cbranch_scc1 nt_232
s_mov_b32 s55,2
s_cmp_lg_u32 s37,0
s_cbranch_scc1 nt_232
s_mov_b32 s55,1
s_lshl_b32 s60,s33,6
s_add_u32 s60,s60,s34
s_mul_i32 s60,s60,46080
s_add_u32 s60,s60,206569472
s_lshl_b32 s62,s46,10
s_add_u32 s62,s62,40960
s_add_u32 m0,s57,s62
s_add_u32 s63,s60,s62
buffer_load_dwordx4 v1,s[8:11],s63 offen sc1 lds
s_add_u32 m0,s57,45056
s_add_u32 s63,s60,45056
buffer_load_dwordx4 v1,s[8:11],s63 offen sc1 lds
s_mul_i32 s61,s46,10240
s_add_u32 s60,s60,s61
s_add_u32 s61,s61,s57
s_add_u32 m0,s61,0
s_add_u32 s63,s60,0
buffer_load_dwordx4 v1,s[8:11],s63 offen sc1 lds
buffer_load_dwordx4 v1,s[8:11],s63 offen offset:1024 sc1 lds
buffer_load_dwordx4 v1,s[8:11],s63 offen offset:2048 sc1 lds
buffer_load_dwordx4 v1,s[8:11],s63 offen offset:3072 sc1 lds
s_add_u32 m0,s61,4096
s_add_u32 s63,s60,4096
buffer_load_dwordx4 v1,s[8:11],s63 offen sc1 lds
buffer_load_dwordx4 v1,s[8:11],s63 offen offset:1024 sc1 lds
buffer_load_dwordx4 v1,s[8:11],s63 offen offset:2048 sc1 lds
buffer_load_dwordx4 v1,s[8:11],s63 offen offset:3072 sc1 lds
s_add_u32 m0,s61,8192
s_add_u32 s63,s60,8192
buffer_load_dwordx4 v1,s[8:11],s63 offen sc1 lds
buffer_load_dwordx4 v1,s[8:11],s63 offen offset:1024 sc1 lds
nt_232:
s_nop 4
s_mul_i32 s74,s73,393216
s_add_u32 s74,s74,s39
s_add_u32 s74,s74,s70
v_fma_f32 v88,-v124,v120,v88
v_fma_f32 v89,-v126,v120,v89
v_fma_f32 v90,-v128,v120,v90
v_fma_f32 v91,-v130,v120,v91
v_fma_f32 v96,-v140,v120,v96
v_fma_f32 v97,-v142,v120,v97
v_fma_f32 v98,-v144,v120,v98
v_fma_f32 v99,-v146,v120,v99
v_mul_f32 v88,v88,v125
v_mul_f32 v89,v89,v127
v_mul_f32 v90,v90,v129
v_mul_f32 v91,v91,v131
v_mul_f32 v96,v96,v141
v_mul_f32 v97,v97,v143
v_mul_f32 v98,v98,v145
v_mul_f32 v99,v99,v147
v_cvt_pk_bf16_f32 v180,v88,v89
v_cvt_pk_bf16_f32 v181,v90,v91
v_cvt_pk_bf16_f32 v182,v96,v97
v_cvt_pk_bf16_f32 v183,v98,v99
buffer_store_dwordx4 v[180:183],v20,s[8:11],s74 offen sc1
v_fma_f32 v92,-v132,v120,v92
v_fma_f32 v93,-v134,v120,v93
v_fma_f32 v94,-v136,v120,v94
v_fma_f32 v95,-v138,v120,v95
v_fma_f32 v100,-v148,v120,v100
v_fma_f32 v101,-v150,v120,v101
v_fma_f32 v102,-v152,v120,v102
v_fma_f32 v103,-v154,v120,v103
v_mul_f32 v92,v92,v133
v_mul_f32 v93,v93,v135
v_mul_f32 v94,v94,v137
v_mul_f32 v95,v95,v139
v_mul_f32 v100,v100,v149
v_mul_f32 v101,v101,v151
v_mul_f32 v102,v102,v153
v_mul_f32 v103,v103,v155
v_cvt_pk_bf16_f32 v184,v92,v93
v_cvt_pk_bf16_f32 v185,v94,v95
v_cvt_pk_bf16_f32 v186,v100,v101
v_cvt_pk_bf16_f32 v187,v102,v103
buffer_store_dwordx4 v[184:187],v21,s[8:11],s74 offen sc1
v_fma_f32 v104,-v124,v121,v104
v_fma_f32 v105,-v126,v121,v105
v_fma_f32 v106,-v128,v121,v106
v_fma_f32 v107,-v130,v121,v107
v_fma_f32 v112,-v140,v121,v112
v_fma_f32 v113,-v142,v121,v113
v_fma_f32 v114,-v144,v121,v114
v_fma_f32 v115,-v146,v121,v115
v_mul_f32 v104,v104,v125
v_mul_f32 v105,v105,v127
v_mul_f32 v106,v106,v129
v_mul_f32 v107,v107,v131
v_mul_f32 v112,v112,v141
v_mul_f32 v113,v113,v143
v_mul_f32 v114,v114,v145
v_mul_f32 v115,v115,v147
v_cvt_pk_bf16_f32 v180,v104,v105
v_cvt_pk_bf16_f32 v181,v106,v107
v_cvt_pk_bf16_f32 v182,v112,v113
v_cvt_pk_bf16_f32 v183,v114,v115
buffer_store_dwordx4 v[180:183],v20,s[8:11],s74 offen offset:2048 sc1
v_fma_f32 v108,-v132,v121,v108
v_fma_f32 v109,-v134,v121,v109
v_fma_f32 v110,-v136,v121,v110
v_fma_f32 v111,-v138,v121,v111
v_fma_f32 v116,-v148,v121,v116
v_fma_f32 v117,-v150,v121,v117
v_fma_f32 v118,-v152,v121,v118
v_fma_f32 v119,-v154,v121,v119
v_mul_f32 v108,v108,v133
v_mul_f32 v109,v109,v135
v_mul_f32 v110,v110,v137
v_mul_f32 v111,v111,v139
v_mul_f32 v116,v116,v149
v_mul_f32 v117,v117,v151
v_mul_f32 v118,v118,v153
v_mul_f32 v119,v119,v155
v_cvt_pk_bf16_f32 v184,v108,v109
v_cvt_pk_bf16_f32 v185,v110,v111
v_cvt_pk_bf16_f32 v186,v116,v117
v_cvt_pk_bf16_f32 v187,v118,v119
buffer_store_dwordx4 v[184:187],v21,s[8:11],s74 offen offset:2048 sc1
s_lshl_b32 s82,s72,6
s_add_u32 s82,s82,s73
s_lshl_b32 s82,s82,9
s_add_u32 s82,s82,s71
s_lshl_b32 s75,s69,2
s_add_u32 s82,s82,s75
s_add_u32 s82,s82,s39
s_mov_b32 s59,s82
s_mov_b32 s82,2147483648
s_mov_b32 s39,2147483648
s_cmp_eq_u32 s55,0
s_cbranch_scc1 QKVV_B0
s_cmp_eq_u32 s55,1
s_cbranch_scc1 QKVV_CD0
s_waitcnt vmcnt(0)
s_mov_b64 exec,1
buffer_store_dword v5,v1,s[8:11],s59 offen sc1
s_mov_b64 exec,-1
s_mov_b32 s59,2147483648
s_cmp_eq_u32 s50,128
s_cbranch_scc1 QKVV_END
s_branch QKVV_COLD0
QKVV_COLD1:
s_cmp_lg_u32 s46,0
s_cbranch_scc1 cp_233
ct_234:
buffer_load_dword v3,v2,s[8:11],s35 offen sc1
buffer_load_dword v14,v4,s[8:11],s41 offen sc1
s_waitcnt vmcnt(0)
v_cmp_eq_u32 vcc,0,v14
s_cmp_eq_u64 vcc,0
s_cselect_b32 s36,0,2147483648
v_cmp_eq_u32 vcc,0,v3
s_cmp_lt_u32 s78,64
s_cselect_b32 s36,s36,2147483648
s_cmp_eq_u64 vcc,0
s_cselect_b32 s60,1,s36
s_cmp_lt_u32 s79,64
s_cselect_b32 s60,s60,s36
s_sub_u32 s61,s78,s79
s_or_b32 s61,s61,s36
s_cmp_lt_u32 s61,16
s_cselect_b32 s36,0,s60
v_mov_b32 v23,s36
s_cmp_lt_u32 s36,2
s_cbranch_scc1 ct_234x
s_sleep 3
s_sub_u32 s47,s47,1
s_cbranch_scc1 ABORT
s_branch ct_234
ct_234x:
ds_write_b32 v22,v23 offset:4
s_waitcnt lgkmcnt(0)
cp_233:
s_barrier
ds_read_b32 v23,v22 offset:4
s_waitcnt lgkmcnt(0)
v_readfirstlane_b32 s38,v23
s_and_b32 s38,s38,1
s_and_b32 s37,s38,2147483648
s_and_b32 s33,s38,1
s_cselect_b32 s34,s79,s78
s_lshl_b32 s60,s33,6
s_add_u32 s60,s60,s34
s_mul_i32 s60,s60,46080
s_add_u32 s60,s60,206569472
s_lshl_b32 s62,s46,10
s_add_u32 s62,s62,40960
s_add_u32 m0,s57,s62
s_add_u32 s63,s60,s62
buffer_load_dwordx4 v1,s[8:11],s63 offen sc1 lds
s_add_u32 m0,s57,45056
s_add_u32 s63,s60,45056
buffer_load_dwordx4 v1,s[8:11],s63 offen sc1 lds
s_mul_i32 s61,s46,10240
s_add_u32 s60,s60,s61
s_add_u32 s61,s61,s57
s_add_u32 m0,s61,0
s_add_u32 s63,s60,0
buffer_load_dwordx4 v1,s[8:11],s63 offen sc1 lds
buffer_load_dwordx4 v1,s[8:11],s63 offen offset:1024 sc1 lds
buffer_load_dwordx4 v1,s[8:11],s63 offen offset:2048 sc1 lds
buffer_load_dwordx4 v1,s[8:11],s63 offen offset:3072 sc1 lds
s_add_u32 m0,s61,4096
s_add_u32 s63,s60,4096
buffer_load_dwordx4 v1,s[8:11],s63 offen sc1 lds
buffer_load_dwordx4 v1,s[8:11],s63 offen offset:1024 sc1 lds
buffer_load_dwordx4 v1,s[8:11],s63 offen offset:2048 sc1 lds
buffer_load_dwordx4 v1,s[8:11],s63 offen offset:3072 sc1 lds
s_add_u32 m0,s61,8192
s_add_u32 s63,s60,8192
buffer_load_dwordx4 v1,s[8:11],s63 offen sc1 lds
buffer_load_dwordx4 v1,s[8:11],s63 offen offset:1024 sc1 lds
QKVV_CD1:
s_mov_b32 s51,s33
s_mov_b32 s52,s34
s_mov_b32 s53,s33
s_mov_b32 s54,s34
s_add_u32 s79,s79,s33
s_or_b32 s60,s37,s33
s_cmp_eq_u32 s60,0
s_addc_u32 s78,s78,0
s_lshl_b32 s41,s78,9
s_add_u32 s41,s41,s40
s_lshl_b32 s35,s79,9
s_add_u32 s35,s35,s40
s_add_u32 s35,s35,32768
buffer_load_dword v3,v2,s[8:11],s35 offen sc1
buffer_load_dword v14,v4,s[8:11],s41 offen sc1
s_waitcnt vmcnt(0)
s_mov_b64 exec,1
buffer_store_dword v5,v1,s[8:11],s59 offen sc1
s_mov_b64 exec,-1
s_mov_b32 s59,2147483648
v_cmp_eq_u32 vcc,0,v14
s_cmp_eq_u64 vcc,0
s_cselect_b32 s36,0,2147483648
v_cmp_eq_u32 vcc,0,v3
s_cmp_lt_u32 s78,64
s_cselect_b32 s36,s36,2147483648
s_cmp_eq_u64 vcc,0
s_cselect_b32 s60,1,s36
s_cmp_lt_u32 s79,64
s_cselect_b32 s60,s60,s36
s_sub_u32 s61,s78,s79
s_or_b32 s61,s61,s36
s_cmp_lt_u32 s61,16
s_cselect_b32 s36,0,s60
v_mov_b32 v23,s36
ds_write_b32 v13,v23
s_waitcnt lgkmcnt(0)
s_barrier
ds_read_b32 v23,v22
ds_read_b128 v[24:27],v18 offset:0
ds_read_b128 v[28:31],v19 offset:0
ds_read_b128 v[32:35],v18 offset:2048
ds_read_b128 v[36:39],v19 offset:2048
ds_read_b128 v[40:43],v18 offset:4096
s_waitcnt lgkmcnt(5)
v_readfirstlane_b32 s38,v23
s_and_b32 s37,s38,2147483648
s_and_b32 s33,s38,1
s_cselect_b32 s34,s79,s78
s_nop 0
s_branch QKVV_B1
QKVV_END:
s_endpgm
ROLE_ATT:
v_lshlrev_b32 v1,4,v0
v_mov_b32 v5,1
s_lshl_b32 s56,s48,2
s_add_u32 s56,s56,s46
v_bfe_u32 v6,v0,2,2
v_lshrrev_b32 v7,4,v0
v_add_u32 v7,v6,v7
v_and_b32 v7,3,v7
v_and_b32 v15,3,v0
v_lshlrev_b32 v15,4,v15
v_lshl_add_u32 v15,v7,6,v15
v_lshl_add_u32 v15,v6,8,v15
s_mov_b32 s68,s48
s_and_b32 s51,s46,1
s_lshr_b32 s86,s46,1
s_lshr_b32 s87,s68,3
s_lshl_b32 s87,s87,5
s_and_b32 s60,s68,7
s_add_u32 s87,s87,s60
v_lshlrev_b32 v229,3,v0
v_and_b32 v229,0x300,v1
v_add_u32 v229,v229,v1
v_mov_b32 v230,0xff800000
s_mov_b32 s80,-1
s_mov_b32 s81,0
s_mov_b32 s84,0x3d93cd3a
s_mov_b32 s85,0x3fb8aa3b
v_min_u32 v6,8,v0
v_mul_u32_u24 v7,86,v6
v_lshrrev_b32 v7,8,v7
v_mul_u32_u24 v8,3,v7
v_sub_u32 v6,v6,v8
s_mul_i32 s60,s68,3
v_add_u32 v6,s60,v6
v_lshlrev_b32 v2,2,v6
v_lshl_add_u32 v2,v7,16,v2
v_min_u32 v228,2,v0
v_lshlrev_b32 v228,2,v228
v_lshrrev_b32 v6,4,v0
v_lshlrev_b32 v6,2,v6
v_and_b32 v7,15,v0
v_add_u32 v8,0,v6
v_cmp_le_u32 s[72:73],v8,v7
v_add_u32 v8,1,v6
v_cmp_le_u32 s[74:75],v8,v7
v_add_u32 v8,2,v6
v_cmp_le_u32 s[76:77],v8,v7
v_add_u32 v8,3,v6
v_cmp_le_u32 s[78:79],v8,v7
s_mul_i32 s71,s68,12288
s_mul_i32 s60,s51,13
s_mul_i32 s69,s60,589824
s_mul_i32 s61,s68,18432
s_add_u32 s69,s69,s61
s_mul_i32 s61,s51,9216
s_add_u32 s69,s69,s61
s_add_u32 s69,s69,24120320
s_mul_i32 s70,s60,2048
s_lshl_b32 s61,s68,6
s_add_u32 s70,s70,s61
s_add_u32 s70,s70,688128
s_mul_i32 s69,s51,12582912
s_mul_i32 s61,s68,6144
s_add_u32 s69,s69,s61
s_add_u32 s69,s69,24117248
s_mul_i32 s70,s51,65536
s_lshl_b32 s61,s68,5
s_add_u32 s70,s70,s61
s_add_u32 s70,s70,688128
s_waitcnt vmcnt(0)
s_barrier
s_cmp_lg_u32 s46,0
s_cbranch_scc1 arr_235
v_mov_b32 v6,1
s_lshl_b32 s3,s49,2
v_mov_b32 v7,s3
s_mov_b64 exec,1
buffer_atomic_add v6,v7,s[12:15],0 offen sc1
s_mov_b64 exec,-1
arr_235:
s_mov_b32 s66,s56
s_and_b32 s53,s66,7
s_lshr_b32 s54,s66,3
v_lshrrev_b32 v6,4,v0
v_bfe_u32 v7,v0,2,2
v_and_b32 v8,3,v0
s_and_b32 s61,s53,3
s_lshl_b32 s60,s53,8
v_lshlrev_b32 v132,11,v6
v_lshrrev_b32 v9,1,v6
v_lshlrev_b32 v132,11,v9
v_and_b32 v9,1,v6
v_lshl_add_u32 v132,v9,12,v132
v_add_u32 v9,s61,v7
v_and_b32 v9,3,v9
v_lshl_add_u32 v132,v9,6,v132
v_lshl_add_u32 v132,v8,4,v132
v_add_u32 v132,s60,v132
s_lshl_b32 s60,s53,2
v_add_u32 v9,s60,v8
v_mul_u32_u24 v133,1280,v9
v_lshl_add_u32 v133,v6,5,v133
v_lshl_add_u32 v133,v7,3,v133
s_mov_b32 s4,s16
s_mov_b32 s5,s17
s_mov_b32 s6,2621440
s_mov_b32 s7,0x20000
s_mov_b32 s55,0
s_mul_i32 s62,s54,40960
buffer_load_dwordx2 v[32:33],v133,s[4:7],s62 offen offset:0
buffer_load_dwordx2 v[34:35],v133,s[4:7],s62 offen offset:128
buffer_load_dwordx2 v[36:37],v133,s[4:7],s62 offen offset:256
buffer_load_dwordx2 v[38:39],v133,s[4:7],s62 offen offset:384
buffer_load_dwordx2 v[40:41],v133,s[4:7],s62 offen offset:512
buffer_load_dwordx2 v[42:43],v133,s[4:7],s62 offen offset:640
buffer_load_dwordx2 v[44:45],v133,s[4:7],s62 offen offset:768
buffer_load_dwordx2 v[46:47],v133,s[4:7],s62 offen offset:896
buffer_load_dwordx2 v[48:49],v133,s[4:7],s62 offen offset:1024
buffer_load_dwordx2 v[50:51],v133,s[4:7],s62 offen offset:1152
s_add_u32 s66,s54,16
s_min_u32 s66,s66,63
s_mul_i32 s62,s66,40960
buffer_load_dwordx2 v[52:53],v133,s[4:7],s62 offen offset:0
buffer_load_dwordx2 v[54:55],v133,s[4:7],s62 offen offset:128
buffer_load_dwordx2 v[56:57],v133,s[4:7],s62 offen offset:256
buffer_load_dwordx2 v[58:59],v133,s[4:7],s62 offen offset:384
buffer_load_dwordx2 v[60:61],v133,s[4:7],s62 offen offset:512
buffer_load_dwordx2 v[62:63],v133,s[4:7],s62 offen offset:640
buffer_load_dwordx2 v[64:65],v133,s[4:7],s62 offen offset:768
buffer_load_dwordx2 v[66:67],v133,s[4:7],s62 offen offset:896
buffer_load_dwordx2 v[68:69],v133,s[4:7],s62 offen offset:1024
buffer_load_dwordx2 v[70:71],v133,s[4:7],s62 offen offset:1152
s_mul_i32 s64,s54,40960
s_add_u32 s64,s64,234749952
s_mul_i32 s65,s54,46080
s_add_u32 s65,s65,206569472
s_waitcnt vmcnt(10)
v_lshlrev_b32 v72,16,v32
v_and_b32 v73,0xffff0000,v32
v_lshlrev_b32 v74,16,v33
v_and_b32 v75,0xffff0000,v33
v_lshlrev_b32 v76,16,v34
v_and_b32 v77,0xffff0000,v34
v_lshlrev_b32 v78,16,v35
v_and_b32 v79,0xffff0000,v35
v_lshlrev_b32 v80,16,v36
v_and_b32 v81,0xffff0000,v36
v_lshlrev_b32 v82,16,v37
v_and_b32 v83,0xffff0000,v37
v_lshlrev_b32 v84,16,v38
v_and_b32 v85,0xffff0000,v38
v_lshlrev_b32 v86,16,v39
v_and_b32 v87,0xffff0000,v39
v_lshlrev_b32 v88,16,v40
v_and_b32 v89,0xffff0000,v40
v_lshlrev_b32 v90,16,v41
v_and_b32 v91,0xffff0000,v41
v_lshlrev_b32 v92,16,v42
v_and_b32 v93,0xffff0000,v42
v_lshlrev_b32 v94,16,v43
v_and_b32 v95,0xffff0000,v43
v_lshlrev_b32 v96,16,v44
v_and_b32 v97,0xffff0000,v44
v_lshlrev_b32 v98,16,v45
v_and_b32 v99,0xffff0000,v45
v_lshlrev_b32 v100,16,v46
v_and_b32 v101,0xffff0000,v46
v_lshlrev_b32 v102,16,v47
v_and_b32 v103,0xffff0000,v47
v_lshlrev_b32 v104,16,v48
v_and_b32 v105,0xffff0000,v48
v_lshlrev_b32 v106,16,v49
v_and_b32 v107,0xffff0000,v49
v_lshlrev_b32 v108,16,v50
v_and_b32 v109,0xffff0000,v50
v_lshlrev_b32 v110,16,v51
v_and_b32 v111,0xffff0000,v51
v_pk_add_f32 v[28:29],v[72:73],v[74:75]
v_pk_mul_f32 v[26:27],v[72:73],v[72:73]
v_pk_fma_f32 v[26:27],v[74:75],v[74:75],v[26:27]
v_pk_add_f32 v[28:29],v[28:29],v[76:77]
v_pk_fma_f32 v[26:27],v[76:77],v[76:77],v[26:27]
v_pk_add_f32 v[28:29],v[28:29],v[78:79]
v_pk_fma_f32 v[26:27],v[78:79],v[78:79],v[26:27]
v_pk_add_f32 v[28:29],v[28:29],v[80:81]
v_pk_fma_f32 v[26:27],v[80:81],v[80:81],v[26:27]
v_pk_add_f32 v[28:29],v[28:29],v[82:83]
v_pk_fma_f32 v[26:27],v[82:83],v[82:83],v[26:27]
v_pk_add_f32 v[28:29],v[28:29],v[84:85]
v_pk_fma_f32 v[26:27],v[84:85],v[84:85],v[26:27]
v_pk_add_f32 v[28:29],v[28:29],v[86:87]
v_pk_fma_f32 v[26:27],v[86:87],v[86:87],v[26:27]
v_pk_add_f32 v[28:29],v[28:29],v[88:89]
v_pk_fma_f32 v[26:27],v[88:89],v[88:89],v[26:27]
v_pk_add_f32 v[28:29],v[28:29],v[90:91]
v_pk_fma_f32 v[26:27],v[90:91],v[90:91],v[26:27]
v_pk_add_f32 v[28:29],v[28:29],v[92:93]
v_pk_fma_f32 v[26:27],v[92:93],v[92:93],v[26:27]
v_pk_add_f32 v[28:29],v[28:29],v[94:95]
v_pk_fma_f32 v[26:27],v[94:95],v[94:95],v[26:27]
v_pk_add_f32 v[28:29],v[28:29],v[96:97]
v_pk_fma_f32 v[26:27],v[96:97],v[96:97],v[26:27]
v_pk_add_f32 v[28:29],v[28:29],v[98:99]
v_pk_fma_f32 v[26:27],v[98:99],v[98:99],v[26:27]
v_pk_add_f32 v[28:29],v[28:29],v[100:101]
v_pk_fma_f32 v[26:27],v[100:101],v[100:101],v[26:27]
v_pk_add_f32 v[28:29],v[28:29],v[102:103]
v_pk_fma_f32 v[26:27],v[102:103],v[102:103],v[26:27]
v_pk_add_f32 v[28:29],v[28:29],v[104:105]
v_pk_fma_f32 v[26:27],v[104:105],v[104:105],v[26:27]
v_pk_add_f32 v[28:29],v[28:29],v[106:107]
v_pk_fma_f32 v[26:27],v[106:107],v[106:107],v[26:27]
v_pk_add_f32 v[28:29],v[28:29],v[108:109]
v_pk_fma_f32 v[26:27],v[108:109],v[108:109],v[26:27]
v_pk_add_f32 v[28:29],v[28:29],v[110:111]
v_pk_fma_f32 v[26:27],v[110:111],v[110:111],v[26:27]
v_add_f32 v24,v28,v29
v_add_f32 v25,v26,v27
s_nop 0
v_add_f32_dpp v24,v24,v24 row_ror:4 row_mask:0xf bank_mask:0xf
v_add_f32_dpp v25,v25,v25 row_ror:4 row_mask:0xf bank_mask:0xf
s_nop 0
v_add_f32_dpp v24,v24,v24 row_ror:8 row_mask:0xf bank_mask:0xf
v_add_f32_dpp v25,v25,v25 row_ror:8 row_mask:0xf bank_mask:0xf
v_mov_b32 v26,v24
v_mov_b32 v27,v25
s_nop 0
v_permlane32_swap_b32 v24,v26
v_permlane32_swap_b32 v25,v27
v_add_f32 v24,v24,v26
v_add_f32 v25,v25,v27
v_mov_b32 v26,v24
v_mov_b32 v27,v25
s_nop 0
v_permlane16_swap_b32 v24,v26
v_permlane16_swap_b32 v25,v27
v_add_f32 v24,v24,v26
v_add_f32 v25,v25,v27
v_mul_f32 v24,0x3acccccd,v24
v_mul_f32 v25,0x3acccccd,v25
v_fma_f32 v25,-v24,v24,v25
v_max_f32 v25,0,v25
v_cvt_pk_bf16_f32 v6,v24,v25
v_lshlrev_b32 v24,16,v6
v_and_b32 v25,0xffff0000,v6
v_add_f32 v25,0x3727c5ac,v25
v_cvt_pk_bf16_f32 v6,v25,v25
v_lshlrev_b32 v25,16,v6
v_sqrt_f32 v25,v25
s_nop 0
v_cvt_pk_bf16_f32 v6,v25,v25
v_lshlrev_b32 v25,16,v6
v_rcp_f32 v25,v25
s_nop 0
v_pk_add_f32 v[72:73],v[72:73],v[24:25] op_sel_hi:[1,0] neg_lo:[0,1] neg_hi:[0,1]
v_pk_add_f32 v[74:75],v[74:75],v[24:25] op_sel_hi:[1,0] neg_lo:[0,1] neg_hi:[0,1]
v_pk_add_f32 v[76:77],v[76:77],v[24:25] op_sel_hi:[1,0] neg_lo:[0,1] neg_hi:[0,1]
v_pk_add_f32 v[78:79],v[78:79],v[24:25] op_sel_hi:[1,0] neg_lo:[0,1] neg_hi:[0,1]
v_pk_add_f32 v[80:81],v[80:81],v[24:25] op_sel_hi:[1,0] neg_lo:[0,1] neg_hi:[0,1]
v_pk_add_f32 v[82:83],v[82:83],v[24:25] op_sel_hi:[1,0] neg_lo:[0,1] neg_hi:[0,1]
v_pk_add_f32 v[84:85],v[84:85],v[24:25] op_sel_hi:[1,0] neg_lo:[0,1] neg_hi:[0,1]
v_pk_add_f32 v[86:87],v[86:87],v[24:25] op_sel_hi:[1,0] neg_lo:[0,1] neg_hi:[0,1]
v_pk_add_f32 v[88:89],v[88:89],v[24:25] op_sel_hi:[1,0] neg_lo:[0,1] neg_hi:[0,1]
v_pk_add_f32 v[90:91],v[90:91],v[24:25] op_sel_hi:[1,0] neg_lo:[0,1] neg_hi:[0,1]
v_pk_add_f32 v[92:93],v[92:93],v[24:25] op_sel_hi:[1,0] neg_lo:[0,1] neg_hi:[0,1]
v_pk_add_f32 v[94:95],v[94:95],v[24:25] op_sel_hi:[1,0] neg_lo:[0,1] neg_hi:[0,1]
v_pk_add_f32 v[96:97],v[96:97],v[24:25] op_sel_hi:[1,0] neg_lo:[0,1] neg_hi:[0,1]
v_pk_add_f32 v[98:99],v[98:99],v[24:25] op_sel_hi:[1,0] neg_lo:[0,1] neg_hi:[0,1]
v_pk_add_f32 v[100:101],v[100:101],v[24:25] op_sel_hi:[1,0] neg_lo:[0,1] neg_hi:[0,1]
v_pk_add_f32 v[102:103],v[102:103],v[24:25] op_sel_hi:[1,0] neg_lo:[0,1] neg_hi:[0,1]
v_pk_add_f32 v[104:105],v[104:105],v[24:25] op_sel_hi:[1,0] neg_lo:[0,1] neg_hi:[0,1]
v_pk_add_f32 v[106:107],v[106:107],v[24:25] op_sel_hi:[1,0] neg_lo:[0,1] neg_hi:[0,1]
v_pk_add_f32 v[108:109],v[108:109],v[24:25] op_sel_hi:[1,0] neg_lo:[0,1] neg_hi:[0,1]
v_pk_add_f32 v[110:111],v[110:111],v[24:25] op_sel_hi:[1,0] neg_lo:[0,1] neg_hi:[0,1]
v_cvt_pk_bf16_f32 v6,v72,v73
v_lshlrev_b32 v72,16,v6
v_and_b32 v73,0xffff0000,v6
v_cvt_pk_bf16_f32 v8,v74,v75
v_lshlrev_b32 v74,16,v8
v_and_b32 v75,0xffff0000,v8
v_cvt_pk_bf16_f32 v6,v76,v77
v_lshlrev_b32 v76,16,v6
v_and_b32 v77,0xffff0000,v6
v_cvt_pk_bf16_f32 v8,v78,v79
v_lshlrev_b32 v78,16,v8
v_and_b32 v79,0xffff0000,v8
v_cvt_pk_bf16_f32 v6,v80,v81
v_lshlrev_b32 v80,16,v6
v_and_b32 v81,0xffff0000,v6
v_cvt_pk_bf16_f32 v8,v82,v83
v_lshlrev_b32 v82,16,v8
v_and_b32 v83,0xffff0000,v8
v_cvt_pk_bf16_f32 v6,v84,v85
v_lshlrev_b32 v84,16,v6
v_and_b32 v85,0xffff0000,v6
v_cvt_pk_bf16_f32 v8,v86,v87
v_lshlrev_b32 v86,16,v8
v_and_b32 v87,0xffff0000,v8
v_cvt_pk_bf16_f32 v6,v88,v89
v_lshlrev_b32 v88,16,v6
v_and_b32 v89,0xffff0000,v6
v_cvt_pk_bf16_f32 v8,v90,v91
v_lshlrev_b32 v90,16,v8
v_and_b32 v91,0xffff0000,v8
v_cvt_pk_bf16_f32 v6,v92,v93
v_lshlrev_b32 v92,16,v6
v_and_b32 v93,0xffff0000,v6
v_cvt_pk_bf16_f32 v8,v94,v95
v_lshlrev_b32 v94,16,v8
v_and_b32 v95,0xffff0000,v8
v_cvt_pk_bf16_f32 v6,v96,v97
v_lshlrev_b32 v96,16,v6
v_and_b32 v97,0xffff0000,v6
v_cvt_pk_bf16_f32 v8,v98,v99
v_lshlrev_b32 v98,16,v8
v_and_b32 v99,0xffff0000,v8
v_cvt_pk_bf16_f32 v6,v100,v101
v_lshlrev_b32 v100,16,v6
v_and_b32 v101,0xffff0000,v6
v_cvt_pk_bf16_f32 v8,v102,v103
v_lshlrev_b32 v102,16,v8
v_and_b32 v103,0xffff0000,v8
v_cvt_pk_bf16_f32 v6,v104,v105
v_lshlrev_b32 v104,16,v6
v_and_b32 v105,0xffff0000,v6
v_cvt_pk_bf16_f32 v8,v106,v107
v_lshlrev_b32 v106,16,v8
v_and_b32 v107,0xffff0000,v8
v_cvt_pk_bf16_f32 v6,v108,v109
v_lshlrev_b32 v108,16,v6
v_and_b32 v109,0xffff0000,v6
v_cvt_pk_bf16_f32 v8,v110,v111
v_lshlrev_b32 v110,16,v8
v_and_b32 v111,0xffff0000,v8
v_pk_mul_f32 v[72:73],v[72:73],v[24:25] op_sel:[0,1] op_sel_hi:[1,1]
v_pk_mul_f32 v[74:75],v[74:75],v[24:25] op_sel:[0,1] op_sel_hi:[1,1]
v_pk_mul_f32 v[76:77],v[76:77],v[24:25] op_sel:[0,1] op_sel_hi:[1,1]
v_pk_mul_f32 v[78:79],v[78:79],v[24:25] op_sel:[0,1] op_sel_hi:[1,1]
v_pk_mul_f32 v[80:81],v[80:81],v[24:25] op_sel:[0,1] op_sel_hi:[1,1]
v_pk_mul_f32 v[82:83],v[82:83],v[24:25] op_sel:[0,1] op_sel_hi:[1,1]
v_pk_mul_f32 v[84:85],v[84:85],v[24:25] op_sel:[0,1] op_sel_hi:[1,1]
v_pk_mul_f32 v[86:87],v[86:87],v[24:25] op_sel:[0,1] op_sel_hi:[1,1]
v_pk_mul_f32 v[88:89],v[88:89],v[24:25] op_sel:[0,1] op_sel_hi:[1,1]
v_pk_mul_f32 v[90:91],v[90:91],v[24:25] op_sel:[0,1] op_sel_hi:[1,1]
v_pk_mul_f32 v[92:93],v[92:93],v[24:25] op_sel:[0,1] op_sel_hi:[1,1]
v_pk_mul_f32 v[94:95],v[94:95],v[24:25] op_sel:[0,1] op_sel_hi:[1,1]
v_pk_mul_f32 v[96:97],v[96:97],v[24:25] op_sel:[0,1] op_sel_hi:[1,1]
v_pk_mul_f32 v[98:99],v[98:99],v[24:25] op_sel:[0,1] op_sel_hi:[1,1]
v_pk_mul_f32 v[100:101],v[100:101],v[24:25] op_sel:[0,1] op_sel_hi:[1,1]
v_pk_mul_f32 v[102:103],v[102:103],v[24:25] op_sel:[0,1] op_sel_hi:[1,1]
v_pk_mul_f32 v[104:105],v[104:105],v[24:25] op_sel:[0,1] op_sel_hi:[1,1]
v_pk_mul_f32 v[106:107],v[106:107],v[24:25] op_sel:[0,1] op_sel_hi:[1,1]
v_pk_mul_f32 v[108:109],v[108:109],v[24:25] op_sel:[0,1] op_sel_hi:[1,1]
v_pk_mul_f32 v[110:111],v[110:111],v[24:25] op_sel:[0,1] op_sel_hi:[1,1]
v_cvt_pk_bf16_f32 v112,v72,v73
v_lshlrev_b32 v72,16,v112
v_and_b32 v73,0xffff0000,v112
v_cvt_pk_bf16_f32 v113,v74,v75
v_lshlrev_b32 v74,16,v113
v_and_b32 v75,0xffff0000,v113
v_cvt_pk_bf16_f32 v114,v76,v77
v_lshlrev_b32 v76,16,v114
v_and_b32 v77,0xffff0000,v114
v_cvt_pk_bf16_f32 v115,v78,v79
v_lshlrev_b32 v78,16,v115
v_and_b32 v79,0xffff0000,v115
v_cvt_pk_bf16_f32 v116,v80,v81
v_lshlrev_b32 v80,16,v116
v_and_b32 v81,0xffff0000,v116
v_cvt_pk_bf16_f32 v117,v82,v83
v_lshlrev_b32 v82,16,v117
v_and_b32 v83,0xffff0000,v117
v_cvt_pk_bf16_f32 v118,v84,v85
v_lshlrev_b32 v84,16,v118
v_and_b32 v85,0xffff0000,v118
v_cvt_pk_bf16_f32 v119,v86,v87
v_lshlrev_b32 v86,16,v119
v_and_b32 v87,0xffff0000,v119
v_cvt_pk_bf16_f32 v120,v88,v89
v_lshlrev_b32 v88,16,v120
v_and_b32 v89,0xffff0000,v120
v_cvt_pk_bf16_f32 v121,v90,v91
v_lshlrev_b32 v90,16,v121
v_and_b32 v91,0xffff0000,v121
v_cvt_pk_bf16_f32 v122,v92,v93
v_lshlrev_b32 v92,16,v122
v_and_b32 v93,0xffff0000,v122
v_cvt_pk_bf16_f32 v123,v94,v95
v_lshlrev_b32 v94,16,v123
v_and_b32 v95,0xffff0000,v123
v_cvt_pk_bf16_f32 v124,v96,v97
v_lshlrev_b32 v96,16,v124
v_and_b32 v97,0xffff0000,v124
v_cvt_pk_bf16_f32 v125,v98,v99
v_lshlrev_b32 v98,16,v125
v_and_b32 v99,0xffff0000,v125
v_cvt_pk_bf16_f32 v126,v100,v101
v_lshlrev_b32 v100,16,v126
v_and_b32 v101,0xffff0000,v126
v_cvt_pk_bf16_f32 v127,v102,v103
v_lshlrev_b32 v102,16,v127
v_and_b32 v103,0xffff0000,v127
v_cvt_pk_bf16_f32 v128,v104,v105
v_lshlrev_b32 v104,16,v128
v_and_b32 v105,0xffff0000,v128
v_cvt_pk_bf16_f32 v129,v106,v107
v_lshlrev_b32 v106,16,v129
v_and_b32 v107,0xffff0000,v129
v_cvt_pk_bf16_f32 v130,v108,v109
v_lshlrev_b32 v108,16,v130
v_and_b32 v109,0xffff0000,v130
v_cvt_pk_bf16_f32 v131,v110,v111
v_lshlrev_b32 v110,16,v131
v_and_b32 v111,0xffff0000,v131
s_add_u32 s63,s65,0
v_permlane16_swap_b32 v112,v114
v_permlane16_swap_b32 v113,v115
buffer_store_dwordx4 v[112:115],v132,s[8:11],s63 offen sc1
s_add_u32 s63,s65,8192
v_permlane16_swap_b32 v116,v118
v_permlane16_swap_b32 v117,v119
buffer_store_dwordx4 v[116:119],v132,s[8:11],s63 offen sc1
s_add_u32 s63,s65,16384
v_permlane16_swap_b32 v120,v122
v_permlane16_swap_b32 v121,v123
buffer_store_dwordx4 v[120:123],v132,s[8:11],s63 offen sc1
s_add_u32 s63,s65,24576
v_permlane16_swap_b32 v124,v126
v_permlane16_swap_b32 v125,v127
buffer_store_dwordx4 v[124:127],v132,s[8:11],s63 offen sc1
s_add_u32 s63,s65,32768
v_permlane16_swap_b32 v128,v130
v_permlane16_swap_b32 v129,v131
buffer_store_dwordx4 v[128:131],v132,s[8:11],s63 offen sc1
s_add_u32 s63,s64,0
v_permlane16_swap_b32 v32,v34
v_permlane16_swap_b32 v33,v35
buffer_store_dwordx4 v[32:35],v132,s[8:11],s63 offen sc1
s_add_u32 s63,s64,8192
v_permlane16_swap_b32 v36,v38
v_permlane16_swap_b32 v37,v39
buffer_store_dwordx4 v[36:39],v132,s[8:11],s63 offen sc1
s_add_u32 s63,s64,16384
v_permlane16_swap_b32 v40,v42
v_permlane16_swap_b32 v41,v43
buffer_store_dwordx4 v[40:43],v132,s[8:11],s63 offen sc1
s_add_u32 s63,s64,24576
v_permlane16_swap_b32 v44,v46
v_permlane16_swap_b32 v45,v47
buffer_store_dwordx4 v[44:47],v132,s[8:11],s63 offen sc1
s_add_u32 s63,s64,32768
v_permlane16_swap_b32 v48,v50
v_permlane16_swap_b32 v49,v51
buffer_store_dwordx4 v[48:51],v132,s[8:11],s63 offen sc1
s_lshl_b32 s82,s55,6
s_add_u32 s82,s82,s54
s_lshl_b32 s82,s82,9
s_add_u32 s82,s82,0
s_lshl_b32 s61,s53,2
s_add_u32 s82,s82,s61
s_add_u32 s54,s54,16
s_lshl_b32 s3,s49,2
v_mov_b32 v7,s3
s_nop 1
ibw_236:
buffer_load_dword v6,v7,s[12:15],0 offen sc1
s_waitcnt vmcnt(0)
v_cmp_ne_u32 vcc,256,v6
s_nop 0
s_cbranch_vccz ok_237
s_sleep 8
s_sub_u32 s47,s47,1
s_cbranch_scc1 ABORT
s_branch ibw_236
ok_237:
s_cmp_lg_u32 s49,0
s_cbranch_scc1 ibok_238
v_and_b32 v7,7,v0
v_lshlrev_b32 v7,2,v7
buffer_load_dword v6,v7,s[12:15],0 offen offset:32 sc1
s_waitcnt vmcnt(0)
v_cmp_ne_u32 vcc,32,v6
s_nop 0
s_cbranch_vccz ibok_238
s_barrier
s_mov_b32 s49,1
s_mov_b32 s3,s2
s_load_dwordx16 s[16:31],s[0:1],0
s_load_dwordx8 s[32:39],s[0:1],64
s_waitcnt lgkmcnt(0)
s_branch DISPATCH
ibok_238:
s_mov_b64 exec,1
buffer_store_dword v5,v1,s[8:11],s82 offen sc1
s_mov_b64 exec,-1
s_add_u32 s66,s54,16
s_min_u32 s66,s66,63
s_mul_i32 s62,s66,40960
buffer_load_dwordx2 v[32:33],v133,s[4:7],s62 offen offset:0
buffer_load_dwordx2 v[34:35],v133,s[4:7],s62 offen offset:128
buffer_load_dwordx2 v[36:37],v133,s[4:7],s62 offen offset:256
buffer_load_dwordx2 v[38:39],v133,s[4:7],s62 offen offset:384
buffer_load_dwordx2 v[40:41],v133,s[4:7],s62 offen offset:512
buffer_load_dwordx2 v[42:43],v133,s[4:7],s62 offen offset:640
buffer_load_dwordx2 v[44:45],v133,s[4:7],s62 offen offset:768
buffer_load_dwordx2 v[46:47],v133,s[4:7],s62 offen offset:896
buffer_load_dwordx2 v[48:49],v133,s[4:7],s62 offen offset:1024
buffer_load_dwordx2 v[50:51],v133,s[4:7],s62 offen offset:1152
s_mul_i32 s64,s54,40960
s_add_u32 s64,s64,234749952
s_mul_i32 s65,s54,46080
s_add_u32 s65,s65,206569472
s_waitcnt vmcnt(10)
v_lshlrev_b32 v72,16,v52
v_and_b32 v73,0xffff0000,v52
v_lshlrev_b32 v74,16,v53
v_and_b32 v75,0xffff0000,v53
v_lshlrev_b32 v76,16,v54
v_and_b32 v77,0xffff0000,v54
v_lshlrev_b32 v78,16,v55
v_and_b32 v79,0xffff0000,v55
v_lshlrev_b32 v80,16,v56
v_and_b32 v81,0xffff0000,v56
v_lshlrev_b32 v82,16,v57
v_and_b32 v83,0xffff0000,v57
v_lshlrev_b32 v84,16,v58
v_and_b32 v85,0xffff0000,v58
v_lshlrev_b32 v86,16,v59
v_and_b32 v87,0xffff0000,v59
v_lshlrev_b32 v88,16,v60
v_and_b32 v89,0xffff0000,v60
v_lshlrev_b32 v90,16,v61
v_and_b32 v91,0xffff0000,v61
v_lshlrev_b32 v92,16,v62
v_and_b32 v93,0xffff0000,v62
v_lshlrev_b32 v94,16,v63
v_and_b32 v95,0xffff0000,v63
v_lshlrev_b32 v96,16,v64
v_and_b32 v97,0xffff0000,v64
v_lshlrev_b32 v98,16,v65
v_and_b32 v99,0xffff0000,v65
v_lshlrev_b32 v100,16,v66
v_and_b32 v101,0xffff0000,v66
v_lshlrev_b32 v102,16,v67
v_and_b32 v103,0xffff0000,v67
v_lshlrev_b32 v104,16,v68
v_and_b32 v105,0xffff0000,v68
v_lshlrev_b32 v106,16,v69
v_and_b32 v107,0xffff0000,v69
v_lshlrev_b32 v108,16,v70
v_and_b32 v109,0xffff0000,v70
v_lshlrev_b32 v110,16,v71
v_and_b32 v111,0xffff0000,v71
v_pk_add_f32 v[28:29],v[72:73],v[74:75]
v_pk_mul_f32 v[26:27],v[72:73],v[72:73]
v_pk_fma_f32 v[26:27],v[74:75],v[74:75],v[26:27]
v_pk_add_f32 v[28:29],v[28:29],v[76:77]
v_pk_fma_f32 v[26:27],v[76:77],v[76:77],v[26:27]
v_pk_add_f32 v[28:29],v[28:29],v[78:79]
v_pk_fma_f32 v[26:27],v[78:79],v[78:79],v[26:27]
v_pk_add_f32 v[28:29],v[28:29],v[80:81]
v_pk_fma_f32 v[26:27],v[80:81],v[80:81],v[26:27]
v_pk_add_f32 v[28:29],v[28:29],v[82:83]
v_pk_fma_f32 v[26:27],v[82:83],v[82:83],v[26:27]
v_pk_add_f32 v[28:29],v[28:29],v[84:85]
v_pk_fma_f32 v[26:27],v[84:85],v[84:85],v[26:27]
v_pk_add_f32 v[28:29],v[28:29],v[86:87]
v_pk_fma_f32 v[26:27],v[86:87],v[86:87],v[26:27]
v_pk_add_f32 v[28:29],v[28:29],v[88:89]
v_pk_fma_f32 v[26:27],v[88:89],v[88:89],v[26:27]
v_pk_add_f32 v[28:29],v[28:29],v[90:91]
v_pk_fma_f32 v[26:27],v[90:91],v[90:91],v[26:27]
v_pk_add_f32 v[28:29],v[28:29],v[92:93]
v_pk_fma_f32 v[26:27],v[92:93],v[92:93],v[26:27]
v_pk_add_f32 v[28:29],v[28:29],v[94:95]
v_pk_fma_f32 v[26:27],v[94:95],v[94:95],v[26:27]
v_pk_add_f32 v[28:29],v[28:29],v[96:97]
v_pk_fma_f32 v[26:27],v[96:97],v[96:97],v[26:27]
v_pk_add_f32 v[28:29],v[28:29],v[98:99]
v_pk_fma_f32 v[26:27],v[98:99],v[98:99],v[26:27]
v_pk_add_f32 v[28:29],v[28:29],v[100:101]
v_pk_fma_f32 v[26:27],v[100:101],v[100:101],v[26:27]
v_pk_add_f32 v[28:29],v[28:29],v[102:103]
v_pk_fma_f32 v[26:27],v[102:103],v[102:103],v[26:27]
v_pk_add_f32 v[28:29],v[28:29],v[104:105]
v_pk_fma_f32 v[26:27],v[104:105],v[104:105],v[26:27]
v_pk_add_f32 v[28:29],v[28:29],v[106:107]
v_pk_fma_f32 v[26:27],v[106:107],v[106:107],v[26:27]
v_pk_add_f32 v[28:29],v[28:29],v[108:109]
v_pk_fma_f32 v[26:27],v[108:109],v[108:109],v[26:27]
v_pk_add_f32 v[28:29],v[28:29],v[110:111]
v_pk_fma_f32 v[26:27],v[110:111],v[110:111],v[26:27]
v_add_f32 v24,v28,v29
v_add_f32 v25,v26,v27
s_nop 0
v_add_f32_dpp v24,v24,v24 row_ror:4 row_mask:0xf bank_mask:0xf
v_add_f32_dpp v25,v25,v25 row_ror:4 row_mask:0xf bank_mask:0xf
s_nop 0
v_add_f32_dpp v24,v24,v24 row_ror:8 row_mask:0xf bank_mask:0xf
v_add_f32_dpp v25,v25,v25 row_ror:8 row_mask:0xf bank_mask:0xf
v_mov_b32 v26,v24
v_mov_b32 v27,v25
s_nop 0
v_permlane32_swap_b32 v24,v26
v_permlane32_swap_b32 v25,v27
v_add_f32 v24,v24,v26
v_add_f32 v25,v25,v27
v_mov_b32 v26,v24
v_mov_b32 v27,v25
s_nop 0
v_permlane16_swap_b32 v24,v26
v_permlane16_swap_b32 v25,v27
v_add_f32 v24,v24,v26
v_add_f32 v25,v25,v27
v_mul_f32 v24,0x3acccccd,v24
v_mul_f32 v25,0x3acccccd,v25
v_fma_f32 v25,-v24,v24,v25
v_max_f32 v25,0,v25
v_cvt_pk_bf16_f32 v6,v24,v25
v_lshlrev_b32 v24,16,v6
v_and_b32 v25,0xffff0000,v6
v_add_f32 v25,0x3727c5ac,v25
v_cvt_pk_bf16_f32 v6,v25,v25
v_lshlrev_b32 v25,16,v6
v_sqrt_f32 v25,v25
s_nop 0
v_cvt_pk_bf16_f32 v6,v25,v25
v_lshlrev_b32 v25,16,v6
v_rcp_f32 v25,v25
s_nop 0
v_pk_add_f32 v[72:73],v[72:73],v[24:25] op_sel_hi:[1,0] neg_lo:[0,1] neg_hi:[0,1]
v_pk_add_f32 v[74:75],v[74:75],v[24:25] op_sel_hi:[1,0] neg_lo:[0,1] neg_hi:[0,1]
v_pk_add_f32 v[76:77],v[76:77],v[24:25] op_sel_hi:[1,0] neg_lo:[0,1] neg_hi:[0,1]
v_pk_add_f32 v[78:79],v[78:79],v[24:25] op_sel_hi:[1,0] neg_lo:[0,1] neg_hi:[0,1]
v_pk_add_f32 v[80:81],v[80:81],v[24:25] op_sel_hi:[1,0] neg_lo:[0,1] neg_hi:[0,1]
v_pk_add_f32 v[82:83],v[82:83],v[24:25] op_sel_hi:[1,0] neg_lo:[0,1] neg_hi:[0,1]
v_pk_add_f32 v[84:85],v[84:85],v[24:25] op_sel_hi:[1,0] neg_lo:[0,1] neg_hi:[0,1]
v_pk_add_f32 v[86:87],v[86:87],v[24:25] op_sel_hi:[1,0] neg_lo:[0,1] neg_hi:[0,1]
v_pk_add_f32 v[88:89],v[88:89],v[24:25] op_sel_hi:[1,0] neg_lo:[0,1] neg_hi:[0,1]
v_pk_add_f32 v[90:91],v[90:91],v[24:25] op_sel_hi:[1,0] neg_lo:[0,1] neg_hi:[0,1]
v_pk_add_f32 v[92:93],v[92:93],v[24:25] op_sel_hi:[1,0] neg_lo:[0,1] neg_hi:[0,1]
v_pk_add_f32 v[94:95],v[94:95],v[24:25] op_sel_hi:[1,0] neg_lo:[0,1] neg_hi:[0,1]
v_pk_add_f32 v[96:97],v[96:97],v[24:25] op_sel_hi:[1,0] neg_lo:[0,1] neg_hi:[0,1]
v_pk_add_f32 v[98:99],v[98:99],v[24:25] op_sel_hi:[1,0] neg_lo:[0,1] neg_hi:[0,1]
v_pk_add_f32 v[100:101],v[100:101],v[24:25] op_sel_hi:[1,0] neg_lo:[0,1] neg_hi:[0,1]
v_pk_add_f32 v[102:103],v[102:103],v[24:25] op_sel_hi:[1,0] neg_lo:[0,1] neg_hi:[0,1]
v_pk_add_f32 v[104:105],v[104:105],v[24:25] op_sel_hi:[1,0] neg_lo:[0,1] neg_hi:[0,1]
v_pk_add_f32 v[106:107],v[106:107],v[24:25] op_sel_hi:[1,0] neg_lo:[0,1] neg_hi:[0,1]
v_pk_add_f32 v[108:109],v[108:109],v[24:25] op_sel_hi:[1,0] neg_lo:[0,1] neg_hi:[0,1]
v_pk_add_f32 v[110:111],v[110:111],v[24:25] op_sel_hi:[1,0] neg_lo:[0,1] neg_hi:[0,1]
v_cvt_pk_bf16_f32 v6,v72,v73
v_lshlrev_b32 v72,16,v6
v_and_b32 v73,0xffff0000,v6
v_cvt_pk_bf16_f32 v8,v74,v75
v_lshlrev_b32 v74,16,v8
v_and_b32 v75,0xffff0000,v8
v_cvt_pk_bf16_f32 v6,v76,v77
v_lshlrev_b32 v76,16,v6
v_and_b32 v77,0xffff0000,v6
v_cvt_pk_bf16_f32 v8,v78,v79
v_lshlrev_b32 v78,16,v8
v_and_b32 v79,0xffff0000,v8
v_cvt_pk_bf16_f32 v6,v80,v81
v_lshlrev_b32 v80,16,v6
v_and_b32 v81,0xffff0000,v6
v_cvt_pk_bf16_f32 v8,v82,v83
v_lshlrev_b32 v82,16,v8
v_and_b32 v83,0xffff0000,v8
v_cvt_pk_bf16_f32 v6,v84,v85
v_lshlrev_b32 v84,16,v6
v_and_b32 v85,0xffff0000,v6
v_cvt_pk_bf16_f32 v8,v86,v87
v_lshlrev_b32 v86,16,v8
v_and_b32 v87,0xffff0000,v8
v_cvt_pk_bf16_f32 v6,v88,v89
v_lshlrev_b32 v88,16,v6
v_and_b32 v89,0xffff0000,v6
v_cvt_pk_bf16_f32 v8,v90,v91
v_lshlrev_b32 v90,16,v8
v_and_b32 v91,0xffff0000,v8
v_cvt_pk_bf16_f32 v6,v92,v93
v_lshlrev_b32 v92,16,v6
v_and_b32 v93,0xffff0000,v6
v_cvt_pk_bf16_f32 v8,v94,v95
v_lshlrev_b32 v94,16,v8
v_and_b32 v95,0xffff0000,v8
v_cvt_pk_bf16_f32 v6,v96,v97
v_lshlrev_b32 v96,16,v6
v_and_b32 v97,0xffff0000,v6
v_cvt_pk_bf16_f32 v8,v98,v99
v_lshlrev_b32 v98,16,v8
v_and_b32 v99,0xffff0000,v8
v_cvt_pk_bf16_f32 v6,v100,v101
v_lshlrev_b32 v100,16,v6
v_and_b32 v101,0xffff0000,v6
v_cvt_pk_bf16_f32 v8,v102,v103
v_lshlrev_b32 v102,16,v8
v_and_b32 v103,0xffff0000,v8
v_cvt_pk_bf16_f32 v6,v104,v105
v_lshlrev_b32 v104,16,v6
v_and_b32 v105,0xffff0000,v6
v_cvt_pk_bf16_f32 v8,v106,v107
v_lshlrev_b32 v106,16,v8
v_and_b32 v107,0xffff0000,v8
v_cvt_pk_bf16_f32 v6,v108,v109
v_lshlrev_b32 v108,16,v6
v_and_b32 v109,0xffff0000,v6
v_cvt_pk_bf16_f32 v8,v110,v111
v_lshlrev_b32 v110,16,v8
v_and_b32 v111,0xffff0000,v8
v_pk_mul_f32 v[72:73],v[72:73],v[24:25] op_sel:[0,1] op_sel_hi:[1,1]
v_pk_mul_f32 v[74:75],v[74:75],v[24:25] op_sel:[0,1] op_sel_hi:[1,1]
v_pk_mul_f32 v[76:77],v[76:77],v[24:25] op_sel:[0,1] op_sel_hi:[1,1]
v_pk_mul_f32 v[78:79],v[78:79],v[24:25] op_sel:[0,1] op_sel_hi:[1,1]
v_pk_mul_f32 v[80:81],v[80:81],v[24:25] op_sel:[0,1] op_sel_hi:[1,1]
v_pk_mul_f32 v[82:83],v[82:83],v[24:25] op_sel:[0,1] op_sel_hi:[1,1]
v_pk_mul_f32 v[84:85],v[84:85],v[24:25] op_sel:[0,1] op_sel_hi:[1,1]
v_pk_mul_f32 v[86:87],v[86:87],v[24:25] op_sel:[0,1] op_sel_hi:[1,1]
v_pk_mul_f32 v[88:89],v[88:89],v[24:25] op_sel:[0,1] op_sel_hi:[1,1]
v_pk_mul_f32 v[90:91],v[90:91],v[24:25] op_sel:[0,1] op_sel_hi:[1,1]
v_pk_mul_f32 v[92:93],v[92:93],v[24:25] op_sel:[0,1] op_sel_hi:[1,1]
v_pk_mul_f32 v[94:95],v[94:95],v[24:25] op_sel:[0,1] op_sel_hi:[1,1]
v_pk_mul_f32 v[96:97],v[96:97],v[24:25] op_sel:[0,1] op_sel_hi:[1,1]
v_pk_mul_f32 v[98:99],v[98:99],v[24:25] op_sel:[0,1] op_sel_hi:[1,1]
v_pk_mul_f32 v[100:101],v[100:101],v[24:25] op_sel:[0,1] op_sel_hi:[1,1]
v_pk_mul_f32 v[102:103],v[102:103],v[24:25] op_sel:[0,1] op_sel_hi:[1,1]
v_pk_mul_f32 v[104:105],v[104:105],v[24:25] op_sel:[0,1] op_sel_hi:[1,1]
v_pk_mul_f32 v[106:107],v[106:107],v[24:25] op_sel:[0,1] op_sel_hi:[1,1]
v_pk_mul_f32 v[108:109],v[108:109],v[24:25] op_sel:[0,1] op_sel_hi:[1,1]
v_pk_mul_f32 v[110:111],v[110:111],v[24:25] op_sel:[0,1] op_sel_hi:[1,1]
v_cvt_pk_bf16_f32 v112,v72,v73
v_lshlrev_b32 v72,16,v112
v_and_b32 v73,0xffff0000,v112
v_cvt_pk_bf16_f32 v113,v74,v75
v_lshlrev_b32 v74,16,v113
v_and_b32 v75,0xffff0000,v113
v_cvt_pk_bf16_f32 v114,v76,v77
v_lshlrev_b32 v76,16,v114
v_and_b32 v77,0xffff0000,v114
v_cvt_pk_bf16_f32 v115,v78,v79
v_lshlrev_b32 v78,16,v115
v_and_b32 v79,0xffff0000,v115
v_cvt_pk_bf16_f32 v116,v80,v81
v_lshlrev_b32 v80,16,v116
v_and_b32 v81,0xffff0000,v116
v_cvt_pk_bf16_f32 v117,v82,v83
v_lshlrev_b32 v82,16,v117
v_and_b32 v83,0xffff0000,v117
v_cvt_pk_bf16_f32 v118,v84,v85
v_lshlrev_b32 v84,16,v118
v_and_b32 v85,0xffff0000,v118
v_cvt_pk_bf16_f32 v119,v86,v87
v_lshlrev_b32 v86,16,v119
v_and_b32 v87,0xffff0000,v119
v_cvt_pk_bf16_f32 v120,v88,v89
v_lshlrev_b32 v88,16,v120
v_and_b32 v89,0xffff0000,v120
v_cvt_pk_bf16_f32 v121,v90,v91
v_lshlrev_b32 v90,16,v121
v_and_b32 v91,0xffff0000,v121
v_cvt_pk_bf16_f32 v122,v92,v93
v_lshlrev_b32 v92,16,v122
v_and_b32 v93,0xffff0000,v122
v_cvt_pk_bf16_f32 v123,v94,v95
v_lshlrev_b32 v94,16,v123
v_and_b32 v95,0xffff0000,v123
v_cvt_pk_bf16_f32 v124,v96,v97
v_lshlrev_b32 v96,16,v124
v_and_b32 v97,0xffff0000,v124
v_cvt_pk_bf16_f32 v125,v98,v99
v_lshlrev_b32 v98,16,v125
v_and_b32 v99,0xffff0000,v125
v_cvt_pk_bf16_f32 v126,v100,v101
v_lshlrev_b32 v100,16,v126
v_and_b32 v101,0xffff0000,v126
v_cvt_pk_bf16_f32 v127,v102,v103
v_lshlrev_b32 v102,16,v127
v_and_b32 v103,0xffff0000,v127
v_cvt_pk_bf16_f32 v128,v104,v105
v_lshlrev_b32 v104,16,v128
v_and_b32 v105,0xffff0000,v128
v_cvt_pk_bf16_f32 v129,v106,v107
v_lshlrev_b32 v106,16,v129
v_and_b32 v107,0xffff0000,v129
v_cvt_pk_bf16_f32 v130,v108,v109
v_lshlrev_b32 v108,16,v130
v_and_b32 v109,0xffff0000,v130
v_cvt_pk_bf16_f32 v131,v110,v111
v_lshlrev_b32 v110,16,v131
v_and_b32 v111,0xffff0000,v131
s_add_u32 s63,s65,0
v_permlane16_swap_b32 v112,v114
v_permlane16_swap_b32 v113,v115
buffer_store_dwordx4 v[112:115],v132,s[8:11],s63 offen sc1
s_add_u32 s63,s65,8192
v_permlane16_swap_b32 v116,v118
v_permlane16_swap_b32 v117,v119
buffer_store_dwordx4 v[116:119],v132,s[8:11],s63 offen sc1
s_add_u32 s63,s65,16384
v_permlane16_swap_b32 v120,v122
v_permlane16_swap_b32 v121,v123
buffer_store_dwordx4 v[120:123],v132,s[8:11],s63 offen sc1
s_add_u32 s63,s65,24576
v_permlane16_swap_b32 v124,v126
v_permlane16_swap_b32 v125,v127
buffer_store_dwordx4 v[124:127],v132,s[8:11],s63 offen sc1
s_add_u32 s63,s65,32768
v_permlane16_swap_b32 v128,v130
v_permlane16_swap_b32 v129,v131
buffer_store_dwordx4 v[128:131],v132,s[8:11],s63 offen sc1
s_add_u32 s63,s64,0
v_permlane16_swap_b32 v52,v54
v_permlane16_swap_b32 v53,v55
buffer_store_dwordx4 v[52:55],v132,s[8:11],s63 offen sc1
s_add_u32 s63,s64,8192
v_permlane16_swap_b32 v56,v58
v_permlane16_swap_b32 v57,v59
buffer_store_dwordx4 v[56:59],v132,s[8:11],s63 offen sc1
s_add_u32 s63,s64,16384
v_permlane16_swap_b32 v60,v62
v_permlane16_swap_b32 v61,v63
buffer_store_dwordx4 v[60:63],v132,s[8:11],s63 offen sc1
s_add_u32 s63,s64,24576
v_permlane16_swap_b32 v64,v66
v_permlane16_swap_b32 v65,v67
buffer_store_dwordx4 v[64:67],v132,s[8:11],s63 offen sc1
s_add_u32 s63,s64,32768
v_permlane16_swap_b32 v68,v70
v_permlane16_swap_b32 v69,v71
buffer_store_dwordx4 v[68:71],v132,s[8:11],s63 offen sc1
s_lshl_b32 s82,s55,6
s_add_u32 s82,s82,s54
s_lshl_b32 s82,s82,9
s_add_u32 s82,s82,0
s_lshl_b32 s61,s53,2
s_add_u32 s82,s82,s61
s_add_u32 s54,s54,16
R0_LOOPA:
s_add_u32 s66,s54,16
s_min_u32 s66,s66,63
s_mul_i32 s62,s66,40960
buffer_load_dwordx2 v[52:53],v133,s[4:7],s62 offen offset:0
buffer_load_dwordx2 v[54:55],v133,s[4:7],s62 offen offset:128
buffer_load_dwordx2 v[56:57],v133,s[4:7],s62 offen offset:256
buffer_load_dwordx2 v[58:59],v133,s[4:7],s62 offen offset:384
buffer_load_dwordx2 v[60:61],v133,s[4:7],s62 offen offset:512
buffer_load_dwordx2 v[62:63],v133,s[4:7],s62 offen offset:640
buffer_load_dwordx2 v[64:65],v133,s[4:7],s62 offen offset:768
buffer_load_dwordx2 v[66:67],v133,s[4:7],s62 offen offset:896
buffer_load_dwordx2 v[68:69],v133,s[4:7],s62 offen offset:1024
buffer_load_dwordx2 v[70:71],v133,s[4:7],s62 offen offset:1152
s_mul_i32 s64,s54,40960
s_add_u32 s64,s64,234749952
s_mul_i32 s65,s54,46080
s_add_u32 s65,s65,206569472
s_waitcnt vmcnt(10)
s_mov_b64 exec,1
buffer_store_dword v5,v1,s[8:11],s82 offen sc1
s_mov_b64 exec,-1
v_lshlrev_b32 v72,16,v32
v_and_b32 v73,0xffff0000,v32
v_lshlrev_b32 v74,16,v33
v_and_b32 v75,0xffff0000,v33
v_lshlrev_b32 v76,16,v34
v_and_b32 v77,0xffff0000,v34
v_lshlrev_b32 v78,16,v35
v_and_b32 v79,0xffff0000,v35
v_lshlrev_b32 v80,16,v36
v_and_b32 v81,0xffff0000,v36
v_lshlrev_b32 v82,16,v37
v_and_b32 v83,0xffff0000,v37
v_lshlrev_b32 v84,16,v38
v_and_b32 v85,0xffff0000,v38
v_lshlrev_b32 v86,16,v39
v_and_b32 v87,0xffff0000,v39
v_lshlrev_b32 v88,16,v40
v_and_b32 v89,0xffff0000,v40
v_lshlrev_b32 v90,16,v41
v_and_b32 v91,0xffff0000,v41
v_lshlrev_b32 v92,16,v42
v_and_b32 v93,0xffff0000,v42
v_lshlrev_b32 v94,16,v43
v_and_b32 v95,0xffff0000,v43
v_lshlrev_b32 v96,16,v44
v_and_b32 v97,0xffff0000,v44
v_lshlrev_b32 v98,16,v45
v_and_b32 v99,0xffff0000,v45
v_lshlrev_b32 v100,16,v46
v_and_b32 v101,0xffff0000,v46
v_lshlrev_b32 v102,16,v47
v_and_b32 v103,0xffff0000,v47
v_lshlrev_b32 v104,16,v48
v_and_b32 v105,0xffff0000,v48
v_lshlrev_b32 v106,16,v49
v_and_b32 v107,0xffff0000,v49
v_lshlrev_b32 v108,16,v50
v_and_b32 v109,0xffff0000,v50
v_lshlrev_b32 v110,16,v51
v_and_b32 v111,0xffff0000,v51
v_pk_add_f32 v[28:29],v[72:73],v[74:75]
v_pk_mul_f32 v[26:27],v[72:73],v[72:73]
v_pk_fma_f32 v[26:27],v[74:75],v[74:75],v[26:27]
v_pk_add_f32 v[28:29],v[28:29],v[76:77]
v_pk_fma_f32 v[26:27],v[76:77],v[76:77],v[26:27]
v_pk_add_f32 v[28:29],v[28:29],v[78:79]
v_pk_fma_f32 v[26:27],v[78:79],v[78:79],v[26:27]
v_pk_add_f32 v[28:29],v[28:29],v[80:81]
v_pk_fma_f32 v[26:27],v[80:81],v[80:81],v[26:27]
v_pk_add_f32 v[28:29],v[28:29],v[82:83]
v_pk_fma_f32 v[26:27],v[82:83],v[82:83],v[26:27]
v_pk_add_f32 v[28:29],v[28:29],v[84:85]
v_pk_fma_f32 v[26:27],v[84:85],v[84:85],v[26:27]
v_pk_add_f32 v[28:29],v[28:29],v[86:87]
v_pk_fma_f32 v[26:27],v[86:87],v[86:87],v[26:27]
v_pk_add_f32 v[28:29],v[28:29],v[88:89]
v_pk_fma_f32 v[26:27],v[88:89],v[88:89],v[26:27]
v_pk_add_f32 v[28:29],v[28:29],v[90:91]
v_pk_fma_f32 v[26:27],v[90:91],v[90:91],v[26:27]
v_pk_add_f32 v[28:29],v[28:29],v[92:93]
v_pk_fma_f32 v[26:27],v[92:93],v[92:93],v[26:27]
v_pk_add_f32 v[28:29],v[28:29],v[94:95]
v_pk_fma_f32 v[26:27],v[94:95],v[94:95],v[26:27]
v_pk_add_f32 v[28:29],v[28:29],v[96:97]
v_pk_fma_f32 v[26:27],v[96:97],v[96:97],v[26:27]
v_pk_add_f32 v[28:29],v[28:29],v[98:99]
v_pk_fma_f32 v[26:27],v[98:99],v[98:99],v[26:27]
v_pk_add_f32 v[28:29],v[28:29],v[100:101]
v_pk_fma_f32 v[26:27],v[100:101],v[100:101],v[26:27]
v_pk_add_f32 v[28:29],v[28:29],v[102:103]
v_pk_fma_f32 v[26:27],v[102:103],v[102:103],v[26:27]
v_pk_add_f32 v[28:29],v[28:29],v[104:105]
v_pk_fma_f32 v[26:27],v[104:105],v[104:105],v[26:27]
v_pk_add_f32 v[28:29],v[28:29],v[106:107]
v_pk_fma_f32 v[26:27],v[106:107],v[106:107],v[26:27]
v_pk_add_f32 v[28:29],v[28:29],v[108:109]
v_pk_fma_f32 v[26:27],v[108:109],v[108:109],v[26:27]
v_pk_add_f32 v[28:29],v[28:29],v[110:111]
v_pk_fma_f32 v[26:27],v[110:111],v[110:111],v[26:27]
v_add_f32 v24,v28,v29
v_add_f32 v25,v26,v27
s_nop 0
v_add_f32_dpp v24,v24,v24 row_ror:4 row_mask:0xf bank_mask:0xf
v_add_f32_dpp v25,v25,v25 row_ror:4 row_mask:0xf bank_mask:0xf
s_nop 0
v_add_f32_dpp v24,v24,v24 row_ror:8 row_mask:0xf bank_mask:0xf
v_add_f32_dpp v25,v25,v25 row_ror:8 row_mask:0xf bank_mask:0xf
v_mov_b32 v26,v24
v_mov_b32 v27,v25
s_nop 0
v_permlane32_swap_b32 v24,v26
v_permlane32_swap_b32 v25,v27
v_add_f32 v24,v24,v26
v_add_f32 v25,v25,v27
v_mov_b32 v26,v24
v_mov_b32 v27,v25
s_nop 0
v_permlane16_swap_b32 v24,v26
v_permlane16_swap_b32 v25,v27
v_add_f32 v24,v24,v26
v_add_f32 v25,v25,v27
v_mul_f32 v24,0x3acccccd,v24
v_mul_f32 v25,0x3acccccd,v25
v_fma_f32 v25,-v24,v24,v25
v_max_f32 v25,0,v25
v_cvt_pk_bf16_f32 v6,v24,v25
v_lshlrev_b32 v24,16,v6
v_and_b32 v25,0xffff0000,v6
v_add_f32 v25,0x3727c5ac,v25
v_cvt_pk_bf16_f32 v6,v25,v25
v_lshlrev_b32 v25,16,v6
v_sqrt_f32 v25,v25
s_nop 0
v_cvt_pk_bf16_f32 v6,v25,v25
v_lshlrev_b32 v25,16,v6
v_rcp_f32 v25,v25
s_nop 0
v_pk_add_f32 v[72:73],v[72:73],v[24:25] op_sel_hi:[1,0] neg_lo:[0,1] neg_hi:[0,1]
v_pk_add_f32 v[74:75],v[74:75],v[24:25] op_sel_hi:[1,0] neg_lo:[0,1] neg_hi:[0,1]
v_pk_add_f32 v[76:77],v[76:77],v[24:25] op_sel_hi:[1,0] neg_lo:[0,1] neg_hi:[0,1]
v_pk_add_f32 v[78:79],v[78:79],v[24:25] op_sel_hi:[1,0] neg_lo:[0,1] neg_hi:[0,1]
v_pk_add_f32 v[80:81],v[80:81],v[24:25] op_sel_hi:[1,0] neg_lo:[0,1] neg_hi:[0,1]
v_pk_add_f32 v[82:83],v[82:83],v[24:25] op_sel_hi:[1,0] neg_lo:[0,1] neg_hi:[0,1]
v_pk_add_f32 v[84:85],v[84:85],v[24:25] op_sel_hi:[1,0] neg_lo:[0,1] neg_hi:[0,1]
v_pk_add_f32 v[86:87],v[86:87],v[24:25] op_sel_hi:[1,0] neg_lo:[0,1] neg_hi:[0,1]
v_pk_add_f32 v[88:89],v[88:89],v[24:25] op_sel_hi:[1,0] neg_lo:[0,1] neg_hi:[0,1]
v_pk_add_f32 v[90:91],v[90:91],v[24:25] op_sel_hi:[1,0] neg_lo:[0,1] neg_hi:[0,1]
v_pk_add_f32 v[92:93],v[92:93],v[24:25] op_sel_hi:[1,0] neg_lo:[0,1] neg_hi:[0,1]
v_pk_add_f32 v[94:95],v[94:95],v[24:25] op_sel_hi:[1,0] neg_lo:[0,1] neg_hi:[0,1]
v_pk_add_f32 v[96:97],v[96:97],v[24:25] op_sel_hi:[1,0] neg_lo:[0,1] neg_hi:[0,1]
v_pk_add_f32 v[98:99],v[98:99],v[24:25] op_sel_hi:[1,0] neg_lo:[0,1] neg_hi:[0,1]
v_pk_add_f32 v[100:101],v[100:101],v[24:25] op_sel_hi:[1,0] neg_lo:[0,1] neg_hi:[0,1]
v_pk_add_f32 v[102:103],v[102:103],v[24:25] op_sel_hi:[1,0] neg_lo:[0,1] neg_hi:[0,1]
v_pk_add_f32 v[104:105],v[104:105],v[24:25] op_sel_hi:[1,0] neg_lo:[0,1] neg_hi:[0,1]
v_pk_add_f32 v[106:107],v[106:107],v[24:25] op_sel_hi:[1,0] neg_lo:[0,1] neg_hi:[0,1]
v_pk_add_f32 v[108:109],v[108:109],v[24:25] op_sel_hi:[1,0] neg_lo:[0,1] neg_hi:[0,1]
v_pk_add_f32 v[110:111],v[110:111],v[24:25] op_sel_hi:[1,0] neg_lo:[0,1] neg_hi:[0,1]
v_cvt_pk_bf16_f32 v6,v72,v73
v_lshlrev_b32 v72,16,v6
v_and_b32 v73,0xffff0000,v6
v_cvt_pk_bf16_f32 v8,v74,v75
v_lshlrev_b32 v74,16,v8
v_and_b32 v75,0xffff0000,v8
v_cvt_pk_bf16_f32 v6,v76,v77
v_lshlrev_b32 v76,16,v6
v_and_b32 v77,0xffff0000,v6
v_cvt_pk_bf16_f32 v8,v78,v79
v_lshlrev_b32 v78,16,v8
v_and_b32 v79,0xffff0000,v8
v_cvt_pk_bf16_f32 v6,v80,v81
v_lshlrev_b32 v80,16,v6
v_and_b32 v81,0xffff0000,v6
v_cvt_pk_bf16_f32 v8,v82,v83
v_lshlrev_b32 v82,16,v8
v_and_b32 v83,0xffff0000,v8
v_cvt_pk_bf16_f32 v6,v84,v85
v_lshlrev_b32 v84,16,v6
v_and_b32 v85,0xffff0000,v6
v_cvt_pk_bf16_f32 v8,v86,v87
v_lshlrev_b32 v86,16,v8
v_and_b32 v87,0xffff0000,v8
v_cvt_pk_bf16_f32 v6,v88,v89
v_lshlrev_b32 v88,16,v6
v_and_b32 v89,0xffff0000,v6
v_cvt_pk_bf16_f32 v8,v90,v91
v_lshlrev_b32 v90,16,v8
v_and_b32 v91,0xffff0000,v8
v_cvt_pk_bf16_f32 v6,v92,v93
v_lshlrev_b32 v92,16,v6
v_and_b32 v93,0xffff0000,v6
v_cvt_pk_bf16_f32 v8,v94,v95
v_lshlrev_b32 v94,16,v8
v_and_b32 v95,0xffff0000,v8
v_cvt_pk_bf16_f32 v6,v96,v97
v_lshlrev_b32 v96,16,v6
v_and_b32 v97,0xffff0000,v6
v_cvt_pk_bf16_f32 v8,v98,v99
v_lshlrev_b32 v98,16,v8
v_and_b32 v99,0xffff0000,v8
v_cvt_pk_bf16_f32 v6,v100,v101
v_lshlrev_b32 v100,16,v6
v_and_b32 v101,0xffff0000,v6
v_cvt_pk_bf16_f32 v8,v102,v103
v_lshlrev_b32 v102,16,v8
v_and_b32 v103,0xffff0000,v8
v_cvt_pk_bf16_f32 v6,v104,v105
v_lshlrev_b32 v104,16,v6
v_and_b32 v105,0xffff0000,v6
v_cvt_pk_bf16_f32 v8,v106,v107
v_lshlrev_b32 v106,16,v8
v_and_b32 v107,0xffff0000,v8
v_cvt_pk_bf16_f32 v6,v108,v109
v_lshlrev_b32 v108,16,v6
v_and_b32 v109,0xffff0000,v6
v_cvt_pk_bf16_f32 v8,v110,v111
v_lshlrev_b32 v110,16,v8
v_and_b32 v111,0xffff0000,v8
v_pk_mul_f32 v[72:73],v[72:73],v[24:25] op_sel:[0,1] op_sel_hi:[1,1]
v_pk_mul_f32 v[74:75],v[74:75],v[24:25] op_sel:[0,1] op_sel_hi:[1,1]
v_pk_mul_f32 v[76:77],v[76:77],v[24:25] op_sel:[0,1] op_sel_hi:[1,1]
v_pk_mul_f32 v[78:79],v[78:79],v[24:25] op_sel:[0,1] op_sel_hi:[1,1]
v_pk_mul_f32 v[80:81],v[80:81],v[24:25] op_sel:[0,1] op_sel_hi:[1,1]
v_pk_mul_f32 v[82:83],v[82:83],v[24:25] op_sel:[0,1] op_sel_hi:[1,1]
v_pk_mul_f32 v[84:85],v[84:85],v[24:25] op_sel:[0,1] op_sel_hi:[1,1]
v_pk_mul_f32 v[86:87],v[86:87],v[24:25] op_sel:[0,1] op_sel_hi:[1,1]
v_pk_mul_f32 v[88:89],v[88:89],v[24:25] op_sel:[0,1] op_sel_hi:[1,1]
v_pk_mul_f32 v[90:91],v[90:91],v[24:25] op_sel:[0,1] op_sel_hi:[1,1]
v_pk_mul_f32 v[92:93],v[92:93],v[24:25] op_sel:[0,1] op_sel_hi:[1,1]
v_pk_mul_f32 v[94:95],v[94:95],v[24:25] op_sel:[0,1] op_sel_hi:[1,1]
v_pk_mul_f32 v[96:97],v[96:97],v[24:25] op_sel:[0,1] op_sel_hi:[1,1]
v_pk_mul_f32 v[98:99],v[98:99],v[24:25] op_sel:[0,1] op_sel_hi:[1,1]
v_pk_mul_f32 v[100:101],v[100:101],v[24:25] op_sel:[0,1] op_sel_hi:[1,1]
v_pk_mul_f32 v[102:103],v[102:103],v[24:25] op_sel:[0,1] op_sel_hi:[1,1]
v_pk_mul_f32 v[104:105],v[104:105],v[24:25] op_sel:[0,1] op_sel_hi:[1,1]
v_pk_mul_f32 v[106:107],v[106:107],v[24:25] op_sel:[0,1] op_sel_hi:[1,1]
v_pk_mul_f32 v[108:109],v[108:109],v[24:25] op_sel:[0,1] op_sel_hi:[1,1]
v_pk_mul_f32 v[110:111],v[110:111],v[24:25] op_sel:[0,1] op_sel_hi:[1,1]
v_cvt_pk_bf16_f32 v112,v72,v73
v_lshlrev_b32 v72,16,v112
v_and_b32 v73,0xffff0000,v112
v_cvt_pk_bf16_f32 v113,v74,v75
v_lshlrev_b32 v74,16,v113
v_and_b32 v75,0xffff0000,v113
v_cvt_pk_bf16_f32 v114,v76,v77
v_lshlrev_b32 v76,16,v114
v_and_b32 v77,0xffff0000,v114
v_cvt_pk_bf16_f32 v115,v78,v79
v_lshlrev_b32 v78,16,v115
v_and_b32 v79,0xffff0000,v115
v_cvt_pk_bf16_f32 v116,v80,v81
v_lshlrev_b32 v80,16,v116
v_and_b32 v81,0xffff0000,v116
v_cvt_pk_bf16_f32 v117,v82,v83
v_lshlrev_b32 v82,16,v117
v_and_b32 v83,0xffff0000,v117
v_cvt_pk_bf16_f32 v118,v84,v85
v_lshlrev_b32 v84,16,v118
v_and_b32 v85,0xffff0000,v118
v_cvt_pk_bf16_f32 v119,v86,v87
v_lshlrev_b32 v86,16,v119
v_and_b32 v87,0xffff0000,v119
v_cvt_pk_bf16_f32 v120,v88,v89
v_lshlrev_b32 v88,16,v120
v_and_b32 v89,0xffff0000,v120
v_cvt_pk_bf16_f32 v121,v90,v91
v_lshlrev_b32 v90,16,v121
v_and_b32 v91,0xffff0000,v121
v_cvt_pk_bf16_f32 v122,v92,v93
v_lshlrev_b32 v92,16,v122
v_and_b32 v93,0xffff0000,v122
v_cvt_pk_bf16_f32 v123,v94,v95
v_lshlrev_b32 v94,16,v123
v_and_b32 v95,0xffff0000,v123
v_cvt_pk_bf16_f32 v124,v96,v97
v_lshlrev_b32 v96,16,v124
v_and_b32 v97,0xffff0000,v124
v_cvt_pk_bf16_f32 v125,v98,v99
v_lshlrev_b32 v98,16,v125
v_and_b32 v99,0xffff0000,v125
v_cvt_pk_bf16_f32 v126,v100,v101
v_lshlrev_b32 v100,16,v126
v_and_b32 v101,0xffff0000,v126
v_cvt_pk_bf16_f32 v127,v102,v103
v_lshlrev_b32 v102,16,v127
v_and_b32 v103,0xffff0000,v127
v_cvt_pk_bf16_f32 v128,v104,v105
v_lshlrev_b32 v104,16,v128
v_and_b32 v105,0xffff0000,v128
v_cvt_pk_bf16_f32 v129,v106,v107
v_lshlrev_b32 v106,16,v129
v_and_b32 v107,0xffff0000,v129
v_cvt_pk_bf16_f32 v130,v108,v109
v_lshlrev_b32 v108,16,v130
v_and_b32 v109,0xffff0000,v130
v_cvt_pk_bf16_f32 v131,v110,v111
v_lshlrev_b32 v110,16,v131
v_and_b32 v111,0xffff0000,v131
s_add_u32 s63,s65,0
v_permlane16_swap_b32 v112,v114
v_permlane16_swap_b32 v113,v115
buffer_store_dwordx4 v[112:115],v132,s[8:11],s63 offen sc1
s_add_u32 s63,s65,8192
v_permlane16_swap_b32 v116,v118
v_permlane16_swap_b32 v117,v119
buffer_store_dwordx4 v[116:119],v132,s[8:11],s63 offen sc1
s_add_u32 s63,s65,16384
v_permlane16_swap_b32 v120,v122
v_permlane16_swap_b32 v121,v123
buffer_store_dwordx4 v[120:123],v132,s[8:11],s63 offen sc1
s_add_u32 s63,s65,24576
v_permlane16_swap_b32 v124,v126
v_permlane16_swap_b32 v125,v127
buffer_store_dwordx4 v[124:127],v132,s[8:11],s63 offen sc1
s_add_u32 s63,s65,32768
v_permlane16_swap_b32 v128,v130
v_permlane16_swap_b32 v129,v131
buffer_store_dwordx4 v[128:131],v132,s[8:11],s63 offen sc1
s_add_u32 s63,s64,0
v_permlane16_swap_b32 v32,v34
v_permlane16_swap_b32 v33,v35
buffer_store_dwordx4 v[32:35],v132,s[8:11],s63 offen sc1
s_add_u32 s63,s64,8192
v_permlane16_swap_b32 v36,v38
v_permlane16_swap_b32 v37,v39
buffer_store_dwordx4 v[36:39],v132,s[8:11],s63 offen sc1
s_add_u32 s63,s64,16384
v_permlane16_swap_b32 v40,v42
v_permlane16_swap_b32 v41,v43
buffer_store_dwordx4 v[40:43],v132,s[8:11],s63 offen sc1
s_add_u32 s63,s64,24576
v_permlane16_swap_b32 v44,v46
v_permlane16_swap_b32 v45,v47
buffer_store_dwordx4 v[44:47],v132,s[8:11],s63 offen sc1
s_add_u32 s63,s64,32768
v_permlane16_swap_b32 v48,v50
v_permlane16_swap_b32 v49,v51
buffer_store_dwordx4 v[48:51],v132,s[8:11],s63 offen sc1
s_lshl_b32 s82,s55,6
s_add_u32 s82,s82,s54
s_lshl_b32 s82,s82,9
s_add_u32 s82,s82,0
s_lshl_b32 s61,s53,2
s_add_u32 s82,s82,s61
s_add_u32 s54,s54,16
s_cmp_ge_u32 s54,64
s_cbranch_scc1 R0_ENDA
s_add_u32 s66,s54,16
s_min_u32 s66,s66,63
s_mul_i32 s62,s66,40960
buffer_load_dwordx2 v[32:33],v133,s[4:7],s62 offen offset:0
buffer_load_dwordx2 v[34:35],v133,s[4:7],s62 offen offset:128
buffer_load_dwordx2 v[36:37],v133,s[4:7],s62 offen offset:256
buffer_load_dwordx2 v[38:39],v133,s[4:7],s62 offen offset:384
buffer_load_dwordx2 v[40:41],v133,s[4:7],s62 offen offset:512
buffer_load_dwordx2 v[42:43],v133,s[4:7],s62 offen offset:640
buffer_load_dwordx2 v[44:45],v133,s[4:7],s62 offen offset:768
buffer_load_dwordx2 v[46:47],v133,s[4:7],s62 offen offset:896
buffer_load_dwordx2 v[48:49],v133,s[4:7],s62 offen offset:1024
buffer_load_dwordx2 v[50:51],v133,s[4:7],s62 offen offset:1152
s_mul_i32 s64,s54,40960
s_add_u32 s64,s64,234749952
s_mul_i32 s65,s54,46080
s_add_u32 s65,s65,206569472
s_waitcnt vmcnt(10)
s_mov_b64 exec,1
buffer_store_dword v5,v1,s[8:11],s82 offen sc1
s_mov_b64 exec,-1
v_lshlrev_b32 v72,16,v52
v_and_b32 v73,0xffff0000,v52
v_lshlrev_b32 v74,16,v53
v_and_b32 v75,0xffff0000,v53
v_lshlrev_b32 v76,16,v54
v_and_b32 v77,0xffff0000,v54
v_lshlrev_b32 v78,16,v55
v_and_b32 v79,0xffff0000,v55
v_lshlrev_b32 v80,16,v56
v_and_b32 v81,0xffff0000,v56
v_lshlrev_b32 v82,16,v57
v_and_b32 v83,0xffff0000,v57
v_lshlrev_b32 v84,16,v58
v_and_b32 v85,0xffff0000,v58
v_lshlrev_b32 v86,16,v59
v_and_b32 v87,0xffff0000,v59
v_lshlrev_b32 v88,16,v60
v_and_b32 v89,0xffff0000,v60
v_lshlrev_b32 v90,16,v61
v_and_b32 v91,0xffff0000,v61
v_lshlrev_b32 v92,16,v62
v_and_b32 v93,0xffff0000,v62
v_lshlrev_b32 v94,16,v63
v_and_b32 v95,0xffff0000,v63
v_lshlrev_b32 v96,16,v64
v_and_b32 v97,0xffff0000,v64
v_lshlrev_b32 v98,16,v65
v_and_b32 v99,0xffff0000,v65
v_lshlrev_b32 v100,16,v66
v_and_b32 v101,0xffff0000,v66
v_lshlrev_b32 v102,16,v67
v_and_b32 v103,0xffff0000,v67
v_lshlrev_b32 v104,16,v68
v_and_b32 v105,0xffff0000,v68
v_lshlrev_b32 v106,16,v69
v_and_b32 v107,0xffff0000,v69
v_lshlrev_b32 v108,16,v70
v_and_b32 v109,0xffff0000,v70
v_lshlrev_b32 v110,16,v71
v_and_b32 v111,0xffff0000,v71
v_pk_add_f32 v[28:29],v[72:73],v[74:75]
v_pk_mul_f32 v[26:27],v[72:73],v[72:73]
v_pk_fma_f32 v[26:27],v[74:75],v[74:75],v[26:27]
v_pk_add_f32 v[28:29],v[28:29],v[76:77]
v_pk_fma_f32 v[26:27],v[76:77],v[76:77],v[26:27]
v_pk_add_f32 v[28:29],v[28:29],v[78:79]
v_pk_fma_f32 v[26:27],v[78:79],v[78:79],v[26:27]
v_pk_add_f32 v[28:29],v[28:29],v[80:81]
v_pk_fma_f32 v[26:27],v[80:81],v[80:81],v[26:27]
v_pk_add_f32 v[28:29],v[28:29],v[82:83]
v_pk_fma_f32 v[26:27],v[82:83],v[82:83],v[26:27]
v_pk_add_f32 v[28:29],v[28:29],v[84:85]
v_pk_fma_f32 v[26:27],v[84:85],v[84:85],v[26:27]
v_pk_add_f32 v[28:29],v[28:29],v[86:87]
v_pk_fma_f32 v[26:27],v[86:87],v[86:87],v[26:27]
v_pk_add_f32 v[28:29],v[28:29],v[88:89]
v_pk_fma_f32 v[26:27],v[88:89],v[88:89],v[26:27]
v_pk_add_f32 v[28:29],v[28:29],v[90:91]
v_pk_fma_f32 v[26:27],v[90:91],v[90:91],v[26:27]
v_pk_add_f32 v[28:29],v[28:29],v[92:93]
v_pk_fma_f32 v[26:27],v[92:93],v[92:93],v[26:27]
v_pk_add_f32 v[28:29],v[28:29],v[94:95]
v_pk_fma_f32 v[26:27],v[94:95],v[94:95],v[26:27]
v_pk_add_f32 v[28:29],v[28:29],v[96:97]
v_pk_fma_f32 v[26:27],v[96:97],v[96:97],v[26:27]
v_pk_add_f32 v[28:29],v[28:29],v[98:99]
v_pk_fma_f32 v[26:27],v[98:99],v[98:99],v[26:27]
v_pk_add_f32 v[28:29],v[28:29],v[100:101]
v_pk_fma_f32 v[26:27],v[100:101],v[100:101],v[26:27]
v_pk_add_f32 v[28:29],v[28:29],v[102:103]
v_pk_fma_f32 v[26:27],v[102:103],v[102:103],v[26:27]
v_pk_add_f32 v[28:29],v[28:29],v[104:105]
v_pk_fma_f32 v[26:27],v[104:105],v[104:105],v[26:27]
v_pk_add_f32 v[28:29],v[28:29],v[106:107]
v_pk_fma_f32 v[26:27],v[106:107],v[106:107],v[26:27]
v_pk_add_f32 v[28:29],v[28:29],v[108:109]
v_pk_fma_f32 v[26:27],v[108:109],v[108:109],v[26:27]
v_pk_add_f32 v[28:29],v[28:29],v[110:111]
v_pk_fma_f32 v[26:27],v[110:111],v[110:111],v[26:27]
v_add_f32 v24,v28,v29
v_add_f32 v25,v26,v27
s_nop 0
v_add_f32_dpp v24,v24,v24 row_ror:4 row_mask:0xf bank_mask:0xf
v_add_f32_dpp v25,v25,v25 row_ror:4 row_mask:0xf bank_mask:0xf
s_nop 0
v_add_f32_dpp v24,v24,v24 row_ror:8 row_mask:0xf bank_mask:0xf
v_add_f32_dpp v25,v25,v25 row_ror:8 row_mask:0xf bank_mask:0xf
v_mov_b32 v26,v24
v_mov_b32 v27,v25
s_nop 0
v_permlane32_swap_b32 v24,v26
v_permlane32_swap_b32 v25,v27
v_add_f32 v24,v24,v26
v_add_f32 v25,v25,v27
v_mov_b32 v26,v24
v_mov_b32 v27,v25
s_nop 0
v_permlane16_swap_b32 v24,v26
v_permlane16_swap_b32 v25,v27
v_add_f32 v24,v24,v26
v_add_f32 v25,v25,v27
v_mul_f32 v24,0x3acccccd,v24
v_mul_f32 v25,0x3acccccd,v25
v_fma_f32 v25,-v24,v24,v25
v_max_f32 v25,0,v25
v_cvt_pk_bf16_f32 v6,v24,v25
v_lshlrev_b32 v24,16,v6
v_and_b32 v25,0xffff0000,v6
v_add_f32 v25,0x3727c5ac,v25
v_cvt_pk_bf16_f32 v6,v25,v25
v_lshlrev_b32 v25,16,v6
v_sqrt_f32 v25,v25
s_nop 0
v_cvt_pk_bf16_f32 v6,v25,v25
v_lshlrev_b32 v25,16,v6
v_rcp_f32 v25,v25
s_nop 0
v_pk_add_f32 v[72:73],v[72:73],v[24:25] op_sel_hi:[1,0] neg_lo:[0,1] neg_hi:[0,1]
v_pk_add_f32 v[74:75],v[74:75],v[24:25] op_sel_hi:[1,0] neg_lo:[0,1] neg_hi:[0,1]
v_pk_add_f32 v[76:77],v[76:77],v[24:25] op_sel_hi:[1,0] neg_lo:[0,1] neg_hi:[0,1]
v_pk_add_f32 v[78:79],v[78:79],v[24:25] op_sel_hi:[1,0] neg_lo:[0,1] neg_hi:[0,1]
v_pk_add_f32 v[80:81],v[80:81],v[24:25] op_sel_hi:[1,0] neg_lo:[0,1] neg_hi:[0,1]
v_pk_add_f32 v[82:83],v[82:83],v[24:25] op_sel_hi:[1,0] neg_lo:[0,1] neg_hi:[0,1]
v_pk_add_f32 v[84:85],v[84:85],v[24:25] op_sel_hi:[1,0] neg_lo:[0,1] neg_hi:[0,1]
v_pk_add_f32 v[86:87],v[86:87],v[24:25] op_sel_hi:[1,0] neg_lo:[0,1] neg_hi:[0,1]
v_pk_add_f32 v[88:89],v[88:89],v[24:25] op_sel_hi:[1,0] neg_lo:[0,1] neg_hi:[0,1]
v_pk_add_f32 v[90:91],v[90:91],v[24:25] op_sel_hi:[1,0] neg_lo:[0,1] neg_hi:[0,1]
v_pk_add_f32 v[92:93],v[92:93],v[24:25] op_sel_hi:[1,0] neg_lo:[0,1] neg_hi:[0,1]
v_pk_add_f32 v[94:95],v[94:95],v[24:25] op_sel_hi:[1,0] neg_lo:[0,1] neg_hi:[0,1]
v_pk_add_f32 v[96:97],v[96:97],v[24:25] op_sel_hi:[1,0] neg_lo:[0,1] neg_hi:[0,1]
v_pk_add_f32 v[98:99],v[98:99],v[24:25] op_sel_hi:[1,0] neg_lo:[0,1] neg_hi:[0,1]
v_pk_add_f32 v[100:101],v[100:101],v[24:25] op_sel_hi:[1,0] neg_lo:[0,1] neg_hi:[0,1]
v_pk_add_f32 v[102:103],v[102:103],v[24:25] op_sel_hi:[1,0] neg_lo:[0,1] neg_hi:[0,1]
v_pk_add_f32 v[104:105],v[104:105],v[24:25] op_sel_hi:[1,0] neg_lo:[0,1] neg_hi:[0,1]
v_pk_add_f32 v[106:107],v[106:107],v[24:25] op_sel_hi:[1,0] neg_lo:[0,1] neg_hi:[0,1]
v_pk_add_f32 v[108:109],v[108:109],v[24:25] op_sel_hi:[1,0] neg_lo:[0,1] neg_hi:[0,1]
v_pk_add_f32 v[110:111],v[110:111],v[24:25] op_sel_hi:[1,0] neg_lo:[0,1] neg_hi:[0,1]
v_cvt_pk_bf16_f32 v6,v72,v73
v_lshlrev_b32 v72,16,v6
v_and_b32 v73,0xffff0000,v6
v_cvt_pk_bf16_f32 v8,v74,v75
v_lshlrev_b32 v74,16,v8
v_and_b32 v75,0xffff0000,v8
v_cvt_pk_bf16_f32 v6,v76,v77
v_lshlrev_b32 v76,16,v6
v_and_b32 v77,0xffff0000,v6
v_cvt_pk_bf16_f32 v8,v78,v79
v_lshlrev_b32 v78,16,v8
v_and_b32 v79,0xffff0000,v8
v_cvt_pk_bf16_f32 v6,v80,v81
v_lshlrev_b32 v80,16,v6
v_and_b32 v81,0xffff0000,v6
v_cvt_pk_bf16_f32 v8,v82,v83
v_lshlrev_b32 v82,16,v8
v_and_b32 v83,0xffff0000,v8
v_cvt_pk_bf16_f32 v6,v84,v85
v_lshlrev_b32 v84,16,v6
v_and_b32 v85,0xffff0000,v6
v_cvt_pk_bf16_f32 v8,v86,v87
v_lshlrev_b32 v86,16,v8
v_and_b32 v87,0xffff0000,v8
v_cvt_pk_bf16_f32 v6,v88,v89
v_lshlrev_b32 v88,16,v6
v_and_b32 v89,0xffff0000,v6
v_cvt_pk_bf16_f32 v8,v90,v91
v_lshlrev_b32 v90,16,v8
v_and_b32 v91,0xffff0000,v8
v_cvt_pk_bf16_f32 v6,v92,v93
v_lshlrev_b32 v92,16,v6
v_and_b32 v93,0xffff0000,v6
v_cvt_pk_bf16_f32 v8,v94,v95
v_lshlrev_b32 v94,16,v8
v_and_b32 v95,0xffff0000,v8
v_cvt_pk_bf16_f32 v6,v96,v97
v_lshlrev_b32 v96,16,v6
v_and_b32 v97,0xffff0000,v6
v_cvt_pk_bf16_f32 v8,v98,v99
v_lshlrev_b32 v98,16,v8
v_and_b32 v99,0xffff0000,v8
v_cvt_pk_bf16_f32 v6,v100,v101
v_lshlrev_b32 v100,16,v6
v_and_b32 v101,0xffff0000,v6
v_cvt_pk_bf16_f32 v8,v102,v103
v_lshlrev_b32 v102,16,v8
v_and_b32 v103,0xffff0000,v8
v_cvt_pk_bf16_f32 v6,v104,v105
v_lshlrev_b32 v104,16,v6
v_and_b32 v105,0xffff0000,v6
v_cvt_pk_bf16_f32 v8,v106,v107
v_lshlrev_b32 v106,16,v8
v_and_b32 v107,0xffff0000,v8
v_cvt_pk_bf16_f32 v6,v108,v109
v_lshlrev_b32 v108,16,v6
v_and_b32 v109,0xffff0000,v6
v_cvt_pk_bf16_f32 v8,v110,v111
v_lshlrev_b32 v110,16,v8
v_and_b32 v111,0xffff0000,v8
v_pk_mul_f32 v[72:73],v[72:73],v[24:25] op_sel:[0,1] op_sel_hi:[1,1]
v_pk_mul_f32 v[74:75],v[74:75],v[24:25] op_sel:[0,1] op_sel_hi:[1,1]
v_pk_mul_f32 v[76:77],v[76:77],v[24:25] op_sel:[0,1] op_sel_hi:[1,1]
v_pk_mul_f32 v[78:79],v[78:79],v[24:25] op_sel:[0,1] op_sel_hi:[1,1]
v_pk_mul_f32 v[80:81],v[80:81],v[24:25] op_sel:[0,1] op_sel_hi:[1,1]
v_pk_mul_f32 v[82:83],v[82:83],v[24:25] op_sel:[0,1] op_sel_hi:[1,1]
v_pk_mul_f32 v[84:85],v[84:85],v[24:25] op_sel:[0,1] op_sel_hi:[1,1]
v_pk_mul_f32 v[86:87],v[86:87],v[24:25] op_sel:[0,1] op_sel_hi:[1,1]
v_pk_mul_f32 v[88:89],v[88:89],v[24:25] op_sel:[0,1] op_sel_hi:[1,1]
v_pk_mul_f32 v[90:91],v[90:91],v[24:25] op_sel:[0,1] op_sel_hi:[1,1]
v_pk_mul_f32 v[92:93],v[92:93],v[24:25] op_sel:[0,1] op_sel_hi:[1,1]
v_pk_mul_f32 v[94:95],v[94:95],v[24:25] op_sel:[0,1] op_sel_hi:[1,1]
v_pk_mul_f32 v[96:97],v[96:97],v[24:25] op_sel:[0,1] op_sel_hi:[1,1]
v_pk_mul_f32 v[98:99],v[98:99],v[24:25] op_sel:[0,1] op_sel_hi:[1,1]
v_pk_mul_f32 v[100:101],v[100:101],v[24:25] op_sel:[0,1] op_sel_hi:[1,1]
v_pk_mul_f32 v[102:103],v[102:103],v[24:25] op_sel:[0,1] op_sel_hi:[1,1]
v_pk_mul_f32 v[104:105],v[104:105],v[24:25] op_sel:[0,1] op_sel_hi:[1,1]
v_pk_mul_f32 v[106:107],v[106:107],v[24:25] op_sel:[0,1] op_sel_hi:[1,1]
v_pk_mul_f32 v[108:109],v[108:109],v[24:25] op_sel:[0,1] op_sel_hi:[1,1]
v_pk_mul_f32 v[110:111],v[110:111],v[24:25] op_sel:[0,1] op_sel_hi:[1,1]
v_cvt_pk_bf16_f32 v112,v72,v73
v_lshlrev_b32 v72,16,v112
v_and_b32 v73,0xffff0000,v112
v_cvt_pk_bf16_f32 v113,v74,v75
v_lshlrev_b32 v74,16,v113
v_and_b32 v75,0xffff0000,v113
v_cvt_pk_bf16_f32 v114,v76,v77
v_lshlrev_b32 v76,16,v114
v_and_b32 v77,0xffff0000,v114
v_cvt_pk_bf16_f32 v115,v78,v79
v_lshlrev_b32 v78,16,v115
v_and_b32 v79,0xffff0000,v115
v_cvt_pk_bf16_f32 v116,v80,v81
v_lshlrev_b32 v80,16,v116
v_and_b32 v81,0xffff0000,v116
v_cvt_pk_bf16_f32 v117,v82,v83
v_lshlrev_b32 v82,16,v117
v_and_b32 v83,0xffff0000,v117
v_cvt_pk_bf16_f32 v118,v84,v85
v_lshlrev_b32 v84,16,v118
v_and_b32 v85,0xffff0000,v118
v_cvt_pk_bf16_f32 v119,v86,v87
v_lshlrev_b32 v86,16,v119
v_and_b32 v87,0xffff0000,v119
v_cvt_pk_bf16_f32 v120,v88,v89
v_lshlrev_b32 v88,16,v120
v_and_b32 v89,0xffff0000,v120
v_cvt_pk_bf16_f32 v121,v90,v91
v_lshlrev_b32 v90,16,v121
v_and_b32 v91,0xffff0000,v121
v_cvt_pk_bf16_f32 v122,v92,v93
v_lshlrev_b32 v92,16,v122
v_and_b32 v93,0xffff0000,v122
v_cvt_pk_bf16_f32 v123,v94,v95
v_lshlrev_b32 v94,16,v123
v_and_b32 v95,0xffff0000,v123
v_cvt_pk_bf16_f32 v124,v96,v97
v_lshlrev_b32 v96,16,v124
v_and_b32 v97,0xffff0000,v124
v_cvt_pk_bf16_f32 v125,v98,v99
v_lshlrev_b32 v98,16,v125
v_and_b32 v99,0xffff0000,v125
v_cvt_pk_bf16_f32 v126,v100,v101
v_lshlrev_b32 v100,16,v126
v_and_b32 v101,0xffff0000,v126
v_cvt_pk_bf16_f32 v127,v102,v103
v_lshlrev_b32 v102,16,v127
v_and_b32 v103,0xffff0000,v127
v_cvt_pk_bf16_f32 v128,v104,v105
v_lshlrev_b32 v104,16,v128
v_and_b32 v105,0xffff0000,v128
v_cvt_pk_bf16_f32 v129,v106,v107
v_lshlrev_b32 v106,16,v129
v_and_b32 v107,0xffff0000,v129
v_cvt_pk_bf16_f32 v130,v108,v109
v_lshlrev_b32 v108,16,v130
v_and_b32 v109,0xffff0000,v130
v_cvt_pk_bf16_f32 v131,v110,v111
v_lshlrev_b32 v110,16,v131
v_and_b32 v111,0xffff0000,v131
s_add_u32 s63,s65,0
v_permlane16_swap_b32 v112,v114
v_permlane16_swap_b32 v113,v115
buffer_store_dwordx4 v[112:115],v132,s[8:11],s63 offen sc1
s_add_u32 s63,s65,8192
v_permlane16_swap_b32 v116,v118
v_permlane16_swap_b32 v117,v119
buffer_store_dwordx4 v[116:119],v132,s[8:11],s63 offen sc1
s_add_u32 s63,s65,16384
v_permlane16_swap_b32 v120,v122
v_permlane16_swap_b32 v121,v123
buffer_store_dwordx4 v[120:123],v132,s[8:11],s63 offen sc1
s_add_u32 s63,s65,24576
v_permlane16_swap_b32 v124,v126
v_permlane16_swap_b32 v125,v127
buffer_store_dwordx4 v[124:127],v132,s[8:11],s63 offen sc1
s_add_u32 s63,s65,32768
v_permlane16_swap_b32 v128,v130
v_permlane16_swap_b32 v129,v131
buffer_store_dwordx4 v[128:131],v132,s[8:11],s63 offen sc1
s_add_u32 s63,s64,0
v_permlane16_swap_b32 v52,v54
v_permlane16_swap_b32 v53,v55
buffer_store_dwordx4 v[52:55],v132,s[8:11],s63 offen sc1
s_add_u32 s63,s64,8192
v_permlane16_swap_b32 v56,v58
v_permlane16_swap_b32 v57,v59
buffer_store_dwordx4 v[56:59],v132,s[8:11],s63 offen sc1
s_add_u32 s63,s64,16384
v_permlane16_swap_b32 v60,v62
v_permlane16_swap_b32 v61,v63
buffer_store_dwordx4 v[60:63],v132,s[8:11],s63 offen sc1
s_add_u32 s63,s64,24576
v_permlane16_swap_b32 v64,v66
v_permlane16_swap_b32 v65,v67
buffer_store_dwordx4 v[64:67],v132,s[8:11],s63 offen sc1
s_add_u32 s63,s64,32768
v_permlane16_swap_b32 v68,v70
v_permlane16_swap_b32 v69,v71
buffer_store_dwordx4 v[68:71],v132,s[8:11],s63 offen sc1
s_lshl_b32 s82,s55,6
s_add_u32 s82,s82,s54
s_lshl_b32 s82,s82,9
s_add_u32 s82,s82,0
s_lshl_b32 s61,s53,2
s_add_u32 s82,s82,s61
s_add_u32 s54,s54,16
s_cmp_lt_u32 s54,64
s_cbranch_scc1 R0_LOOPA
R0_ENDA:
s_waitcnt vmcnt(0)
s_mov_b64 exec,1
buffer_store_dword v5,v1,s[8:11],s82 offen sc1
s_mov_b64 exec,-1
s_mov_b32 s52,s86
s_mul_i32 s60,s86,196608
s_add_u32 s69,s69,s60
s_mul_i32 s60,s86,1024
s_add_u32 s70,s70,s60
v_mov_b32 v231,0
s_mov_b32 s83,s100
s_nop 0
ATT_LOOP:
s_lshl_b32 s67,s51,6
s_add_u32 s67,s67,s52
s_lshl_b32 s67,s67,9
s_add_u32 s67,s67,65536
s_mul_i32 s66,s52,393216
s_add_u32 s66,s66,s71
v_cmp_eq_u32 vcc,0,v231
s_nop 0
s_cbranch_vccz ATT_RDY
fb_239:
buffer_load_dword v3,v2,s[8:11],s67 offen sc1
s_waitcnt vmcnt(0)
v_cmp_eq_u32 vcc,0,v3
s_nop 0
s_cbranch_vccz ok_240
s_sleep 20
s_sub_u32 s47,s47,1
s_cbranch_scc1 ABORT
s_branch fb_239
ok_240:
ATT_RDY:
s_add_u32 s63,s66,124780544
buffer_load_dwordx4 v[16:19],v1,s[8:11],s63 offen sc1
buffer_load_dwordx4 v[20:23],v1,s[8:11],s63 offen offset:1024 sc1
buffer_load_dwordx4 v[24:27],v1,s[8:11],s63 offen offset:2048 sc1
buffer_load_dwordx4 v[28:31],v1,s[8:11],s63 offen offset:3072 sc1
s_add_u32 s63,s66,124784640
buffer_load_dwordx4 v[32:35],v1,s[8:11],s63 offen sc1
buffer_load_dwordx4 v[36:39],v1,s[8:11],s63 offen offset:1024 sc1
buffer_load_dwordx4 v[40:43],v1,s[8:11],s63 offen offset:2048 sc1
buffer_load_dwordx4 v[44:47],v1,s[8:11],s63 offen offset:3072 sc1
s_add_u32 s63,s66,124788736
buffer_load_dwordx4 v[48:51],v1,s[8:11],s63 offen sc1
buffer_load_dwordx4 v[52:55],v1,s[8:11],s63 offen offset:1024 sc1
buffer_load_dwordx4 v[56:59],v1,s[8:11],s63 offen offset:2048 sc1
buffer_load_dwordx4 v[60:63],v1,s[8:11],s63 offen offset:3072 sc1
s_add_u32 s63,s66,74448896
buffer_load_dwordx4 v[64:67],v1,s[8:11],s63 offen sc1
buffer_load_dwordx4 v[68:71],v1,s[8:11],s63 offen offset:1024 sc1
buffer_load_dwordx4 v[72:75],v1,s[8:11],s63 offen offset:2048 sc1
buffer_load_dwordx4 v[76:79],v1,s[8:11],s63 offen offset:3072 sc1
s_add_u32 s63,s66,74452992
buffer_load_dwordx4 v[80:83],v1,s[8:11],s63 offen sc1
buffer_load_dwordx4 v[84:87],v1,s[8:11],s63 offen offset:1024 sc1
buffer_load_dwordx4 v[88:91],v1,s[8:11],s63 offen offset:2048 sc1
buffer_load_dwordx4 v[92:95],v1,s[8:11],s63 offen offset:3072 sc1
s_add_u32 s63,s66,74457088
buffer_load_dwordx4 v[96:99],v1,s[8:11],s63 offen sc1
buffer_load_dwordx4 v[100:103],v1,s[8:11],s63 offen offset:1024 sc1
buffer_load_dwordx4 v[104:107],v1,s[8:11],s63 offen offset:2048 sc1
buffer_load_dwordx4 v[108:111],v1,s[8:11],s63 offen offset:3072 sc1
s_add_u32 s63,s66,99614720
buffer_load_dwordx4 v[112:115],v1,s[8:11],s63 offen sc1
buffer_load_dwordx4 v[116:119],v1,s[8:11],s63 offen offset:1024 sc1
buffer_load_dwordx4 v[120:123],v1,s[8:11],s63 offen offset:2048 sc1
buffer_load_dwordx4 v[124:127],v1,s[8:11],s63 offen offset:3072 sc1
s_add_u32 s63,s66,99618816
buffer_load_dwordx4 v[128:131],v1,s[8:11],s63 offen sc1
buffer_load_dwordx4 v[132:135],v1,s[8:11],s63 offen offset:1024 sc1
buffer_load_dwordx4 v[136:139],v1,s[8:11],s63 offen offset:2048 sc1
buffer_load_dwordx4 v[140:143],v1,s[8:11],s63 offen offset:3072 sc1
s_add_u32 s63,s66,99622912
buffer_load_dwordx4 v[144:147],v1,s[8:11],s63 offen sc1
buffer_load_dwordx4 v[148:151],v1,s[8:11],s63 offen offset:1024 sc1
buffer_load_dwordx4 v[152:155],v1,s[8:11],s63 offen offset:2048 sc1
buffer_load_dwordx4 v[156:159],v1,s[8:11],s63 offen offset:3072 sc1
v_lshlrev_b32 v232,7,v0
s_add_u32 s63,s66,149946368
buffer_load_dword v233,v232,s[8:11],s63 offen sc1
s_add_u32 s63,s66,149950464
buffer_load_dword v233,v232,s[8:11],s63 offen sc1
s_waitcnt vmcnt(14)
v_mfma_f32_16x16x32_bf16 v[184:187],v[64:67],v[16:19],0
v_mfma_f32_16x16x32_bf16 v[188:191],v[64:67],v[20:23],0
v_mfma_f32_16x16x32_bf16 v[192:195],v[68:71],v[20:23],0
v_mfma_f32_16x16x32_bf16 v[184:187],v[72:75],v[24:27],v[184:187]
v_mfma_f32_16x16x32_bf16 v[188:191],v[72:75],v[28:31],v[188:191]
v_mfma_f32_16x16x32_bf16 v[192:195],v[76:79],v[28:31],v[192:195]
v_mfma_f32_16x16x32_bf16 v[184:187],v[80:83],v[32:35],v[184:187]
v_mfma_f32_16x16x32_bf16 v[188:191],v[80:83],v[36:39],v[188:191]
v_mfma_f32_16x16x32_bf16 v[192:195],v[84:87],v[36:39],v[192:195]
v_mfma_f32_16x16x32_bf16 v[184:187],v[88:91],v[40:43],v[184:187]
v_mfma_f32_16x16x32_bf16 v[188:191],v[88:91],v[44:47],v[188:191]
v_mfma_f32_16x16x32_bf16 v[192:195],v[92:95],v[44:47],v[192:195]
v_mfma_f32_16x16x32_bf16 v[184:187],v[96:99],v[48:51],v[184:187]
v_mfma_f32_16x16x32_bf16 v[188:191],v[96:99],v[52:55],v[188:191]
v_mfma_f32_16x16x32_bf16 v[192:195],v[100:103],v[52:55],v[192:195]
v_mfma_f32_16x16x32_bf16 v[184:187],v[104:107],v[56:59],v[184:187]
v_mfma_f32_16x16x32_bf16 v[188:191],v[104:107],v[60:63],v[188:191]
v_mfma_f32_16x16x32_bf16 v[192:195],v[108:111],v[60:63],v[192:195]
s_nop 1
v_cvt_pk_bf16_f32 v6,v184,v185
v_lshlrev_b32 v184,16,v6
v_and_b32 v185,0xffff0000,v6
v_cvt_pk_bf16_f32 v6,v186,v187
v_lshlrev_b32 v186,16,v6
v_and_b32 v187,0xffff0000,v6
v_cvt_pk_bf16_f32 v6,v188,v189
v_lshlrev_b32 v188,16,v6
v_and_b32 v189,0xffff0000,v6
v_cvt_pk_bf16_f32 v6,v190,v191
v_lshlrev_b32 v190,16,v6
v_and_b32 v191,0xffff0000,v6
v_cvt_pk_bf16_f32 v6,v192,v193
v_lshlrev_b32 v192,16,v6
v_and_b32 v193,0xffff0000,v6
v_cvt_pk_bf16_f32 v6,v194,v195
v_lshlrev_b32 v194,16,v6
v_and_b32 v195,0xffff0000,v6
v_mul_f32 v184,s84,v184
v_mul_f32 v185,s84,v185
v_mul_f32 v186,s84,v186
v_mul_f32 v187,s84,v187
v_mul_f32 v188,s84,v188
v_mul_f32 v189,s84,v189
v_mul_f32 v190,s84,v190
v_mul_f32 v191,s84,v191
v_mul_f32 v192,s84,v192
v_mul_f32 v193,s84,v193
v_mul_f32 v194,s84,v194
v_mul_f32 v195,s84,v195
v_cvt_pk_bf16_f32 v6,v184,v185
v_lshlrev_b32 v184,16,v6
v_and_b32 v185,0xffff0000,v6
v_cvt_pk_bf16_f32 v6,v186,v187
v_lshlrev_b32 v186,16,v6
v_and_b32 v187,0xffff0000,v6
v_cvt_pk_bf16_f32 v6,v188,v189
v_lshlrev_b32 v188,16,v6
v_and_b32 v189,0xffff0000,v6
v_cvt_pk_bf16_f32 v6,v190,v191
v_lshlrev_b32 v190,16,v6
v_and_b32 v191,0xffff0000,v6
v_cvt_pk_bf16_f32 v6,v192,v193
v_lshlrev_b32 v192,16,v6
v_and_b32 v193,0xffff0000,v6
v_cvt_pk_bf16_f32 v6,v194,v195
v_lshlrev_b32 v194,16,v6
v_and_b32 v195,0xffff0000,v6
v_cndmask_b32 v184,v230,v184,s[72:73]
v_cndmask_b32 v185,v230,v185,s[74:75]
v_cndmask_b32 v186,v230,v186,s[76:77]
v_cndmask_b32 v187,v230,v187,s[78:79]
v_cndmask_b32 v192,v230,v192,s[72:73]
v_cndmask_b32 v193,v230,v193,s[74:75]
v_cndmask_b32 v194,v230,v194,s[76:77]
v_cndmask_b32 v195,v230,v195,s[78:79]
s_nop 1
fb_241:
buffer_load_dword v3,v228,s[8:11],s70 offen sc1
s_waitcnt vmcnt(0)
v_cmp_eq_u32 vcc,0,v3
s_nop 0
s_cbranch_vccz ok_242
s_sleep 4
s_sub_u32 s47,s47,1
s_cbranch_scc1 ABORT
s_branch fb_241
ok_242:
buffer_load_dwordx4 v[160:163],v1,s[8:11],s69 offen sc1
buffer_load_dwordx4 v[164:167],v1,s[8:11],s69 offen offset:1024 sc1
buffer_load_dwordx4 v[168:171],v1,s[8:11],s69 offen offset:2048 sc1
s_add_u32 s63,s69,3072
buffer_load_dwordx4 v[172:175],v1,s[8:11],s63 offen sc1
buffer_load_dwordx4 v[176:179],v1,s[8:11],s63 offen offset:1024 sc1
buffer_load_dwordx4 v[180:183],v1,s[8:11],s63 offen offset:2048 sc1
buffer_load_dword v231,v2,s[8:11],s67 offen offset:1024 sc1
s_waitcnt vmcnt(4)
v_mfma_f32_16x16x32_bf16 v[196:199],v[160:163],v[16:19],0
v_mfma_f32_16x16x32_bf16 v[200:203],v[160:163],v[24:27],0
v_mfma_f32_16x16x32_bf16 v[204:207],v[160:163],v[20:23],0
v_mfma_f32_16x16x32_bf16 v[208:211],v[160:163],v[28:31],0
v_mfma_f32_16x16x32_bf16 v[196:199],v[164:167],v[32:35],v[196:199]
v_mfma_f32_16x16x32_bf16 v[200:203],v[164:167],v[40:43],v[200:203]
v_mfma_f32_16x16x32_bf16 v[204:207],v[164:167],v[36:39],v[204:207]
v_mfma_f32_16x16x32_bf16 v[208:211],v[164:167],v[44:47],v[208:211]
v_mfma_f32_16x16x32_bf16 v[196:199],v[168:171],v[48:51],v[196:199]
v_mfma_f32_16x16x32_bf16 v[200:203],v[168:171],v[56:59],v[200:203]
v_mfma_f32_16x16x32_bf16 v[204:207],v[168:171],v[52:55],v[204:207]
v_mfma_f32_16x16x32_bf16 v[208:211],v[168:171],v[60:63],v[208:211]
v_permlane32_swap_b32 v196,v197
s_nop 0
v_permlane32_swap_b32 v200,v201
v_permlane32_swap_b32 v198,v199
v_permlane32_swap_b32 v202,v203
v_add_f32 v196,v196,v201
v_add_f32 v197,v198,v203
v_permlane32_swap_b32 v204,v205
v_permlane32_swap_b32 v208,v209
v_permlane32_swap_b32 v206,v207
v_permlane32_swap_b32 v210,v211
v_add_f32 v204,v204,v209
v_add_f32 v205,v206,v211
v_cvt_pk_bf16_f32 v6,v196,v197
v_lshlrev_b32 v196,16,v6
v_and_b32 v197,0xffff0000,v6
v_cvt_pk_bf16_f32 v6,v204,v205
v_lshlrev_b32 v204,16,v6
v_and_b32 v205,0xffff0000,v6
v_mul_f32 v196,s84,v196
v_mul_f32 v197,s84,v197
v_mul_f32 v204,s84,v204
v_mul_f32 v205,s84,v205
v_cvt_pk_bf16_f32 v6,v196,v197
v_lshlrev_b32 v196,16,v6
v_and_b32 v197,0xffff0000,v6
v_cvt_pk_bf16_f32 v6,v204,v205
v_lshlrev_b32 v204,16,v6
v_and_b32 v205,0xffff0000,v6
v_max3_f32 v6,v184,v185,v186
v_max3_f32 v6,v6,v187,v196
v_max_f32 v6,v6,v197
v_mov_b32 v7,v6
s_nop 1
v_permlane32_swap_b32 v6,v7
v_max_f32 v6,v6,v7
v_mov_b32 v7,v6
s_nop 1
v_permlane16_swap_b32 v6,v7
v_max_f32 v6,v6,v7
v_mul_f32 v6,s85,v6
v_fma_f32 v184,v184,s85,-v6
v_fma_f32 v185,v185,s85,-v6
v_fma_f32 v186,v186,s85,-v6
v_fma_f32 v187,v187,s85,-v6
v_fma_f32 v196,v196,s85,-v6
v_fma_f32 v197,v197,s85,-v6
v_exp_f32 v184,v184
v_exp_f32 v185,v185
v_exp_f32 v186,v186
v_exp_f32 v187,v187
v_exp_f32 v196,v196
v_exp_f32 v197,v197
v_add_f32 v6,v184,v185
v_add_f32 v6,v6,v186
v_add_f32 v6,v6,v187
v_add_f32 v6,v6,v196
v_add_f32 v6,v6,v197
v_mov_b32 v7,v6
s_nop 1
v_permlane32_swap_b32 v6,v7
v_add_f32 v6,v6,v7
v_mov_b32 v7,v6
s_nop 1
v_permlane16_swap_b32 v6,v7
v_add_f32 v6,v6,v7
v_rcp_f32 v6,v6
s_nop 0
v_mul_f32 v184,v184,v6
v_mul_f32 v185,v185,v6
v_mul_f32 v186,v186,v6
v_mul_f32 v187,v187,v6
v_mul_f32 v196,v196,v6
v_mul_f32 v197,v197,v6
v_cvt_pk_bf16_f32 v212,v184,v185
v_cvt_pk_bf16_f32 v213,v186,v187
v_mov_b32 v214,0
v_mov_b32 v215,0
v_cvt_pk_bf16_f32 v216,v196,v197
v_mov_b32 v217,0
v_mov_b32 v218,0
v_cvt_pk_bf16_f32 v219,v196,v197
v_max3_f32 v8,v188,v189,v190
v_max3_f32 v8,v8,v191,v192
v_max3_f32 v8,v8,v193,v194
v_max3_f32 v8,v8,v195,v204
v_max_f32 v8,v8,v205
v_mov_b32 v9,v8
s_nop 1
v_permlane32_swap_b32 v8,v9
v_max_f32 v8,v8,v9
v_mov_b32 v9,v8
s_nop 1
v_permlane16_swap_b32 v8,v9
v_max_f32 v8,v8,v9
v_mul_f32 v8,s85,v8
v_fma_f32 v188,v188,s85,-v8
v_fma_f32 v189,v189,s85,-v8
v_fma_f32 v190,v190,s85,-v8
v_fma_f32 v191,v191,s85,-v8
v_fma_f32 v192,v192,s85,-v8
v_fma_f32 v193,v193,s85,-v8
v_fma_f32 v194,v194,s85,-v8
v_fma_f32 v195,v195,s85,-v8
v_fma_f32 v204,v204,s85,-v8
v_fma_f32 v205,v205,s85,-v8
v_exp_f32 v188,v188
v_exp_f32 v189,v189
v_exp_f32 v190,v190
v_exp_f32 v191,v191
v_exp_f32 v192,v192
v_exp_f32 v193,v193
v_exp_f32 v194,v194
v_exp_f32 v195,v195
v_exp_f32 v204,v204
v_exp_f32 v205,v205
v_add_f32 v8,v188,v189
v_add_f32 v8,v8,v190
v_add_f32 v8,v8,v191
v_add_f32 v8,v8,v192
v_add_f32 v8,v8,v193
v_add_f32 v8,v8,v194
v_add_f32 v8,v8,v195
v_add_f32 v8,v8,v204
v_add_f32 v8,v8,v205
v_mov_b32 v9,v8
s_nop 1
v_permlane32_swap_b32 v8,v9
v_add_f32 v8,v8,v9
v_mov_b32 v9,v8
s_nop 1
v_permlane16_swap_b32 v8,v9
v_add_f32 v8,v8,v9
v_rcp_f32 v8,v8
s_nop 0
v_mul_f32 v188,v188,v8
v_mul_f32 v189,v189,v8
v_mul_f32 v190,v190,v8
v_mul_f32 v191,v191,v8
v_mul_f32 v192,v192,v8
v_mul_f32 v193,v193,v8
v_mul_f32 v194,v194,v8
v_mul_f32 v195,v195,v8
v_mul_f32 v204,v204,v8
v_mul_f32 v205,v205,v8
v_cvt_pk_bf16_f32 v220,v188,v189
v_cvt_pk_bf16_f32 v221,v190,v191
v_cvt_pk_bf16_f32 v222,v192,v193
v_cvt_pk_bf16_f32 v223,v194,v195
v_cvt_pk_bf16_f32 v224,v204,v205
v_mov_b32 v225,0
v_mov_b32 v226,0
v_cvt_pk_bf16_f32 v227,v204,v205
s_waitcnt vmcnt(1)
s_add_u32 s66,s66,149946368
v_mfma_f32_16x16x32_bf16 v[16:19],v[112:115],v[212:215],0
v_mfma_f32_16x16x32_bf16 v[20:23],v[116:119],v[212:215],0
v_mfma_f32_16x16x32_bf16 v[24:27],v[120:123],v[212:215],0
v_mfma_f32_16x16x32_bf16 v[28:31],v[124:127],v[212:215],0
v_mfma_f32_16x16x32_bf16 v[32:35],v[128:131],v[212:215],0
v_mfma_f32_16x16x32_bf16 v[36:39],v[132:135],v[212:215],0
v_mfma_f32_16x16x32_bf16 v[40:43],v[136:139],v[212:215],0
v_mfma_f32_16x16x32_bf16 v[44:47],v[140:143],v[212:215],0
v_mfma_f32_16x16x32_bf16 v[48:51],v[144:147],v[212:215],0
v_mfma_f32_16x16x32_bf16 v[52:55],v[148:151],v[212:215],0
v_mfma_f32_16x16x32_bf16 v[56:59],v[152:155],v[212:215],0
v_mfma_f32_16x16x32_bf16 v[60:63],v[156:159],v[212:215],0
v_mfma_f32_16x16x16_bf16 v[16:19],v[172:173],v[216:217],v[16:19]
v_mfma_f32_16x16x16_bf16 v[20:23],v[172:173],v[218:219],v[20:23]
v_mfma_f32_16x16x16_bf16 v[24:27],v[174:175],v[216:217],v[24:27]
v_mfma_f32_16x16x16_bf16 v[28:31],v[174:175],v[218:219],v[28:31]
v_mfma_f32_16x16x16_bf16 v[32:35],v[176:177],v[216:217],v[32:35]
v_mfma_f32_16x16x16_bf16 v[36:39],v[176:177],v[218:219],v[36:39]
v_mfma_f32_16x16x16_bf16 v[40:43],v[178:179],v[216:217],v[40:43]
v_mfma_f32_16x16x16_bf16 v[44:47],v[178:179],v[218:219],v[44:47]
v_mfma_f32_16x16x16_bf16 v[48:51],v[180:181],v[216:217],v[48:51]
v_mfma_f32_16x16x16_bf16 v[52:55],v[180:181],v[218:219],v[52:55]
v_mfma_f32_16x16x16_bf16 v[56:59],v[182:183],v[216:217],v[56:59]
v_mfma_f32_16x16x16_bf16 v[60:63],v[182:183],v[218:219],v[60:63]
v_mfma_f32_16x16x32_bf16 v[64:67],v[112:115],v[220:223],0
v_mfma_f32_16x16x32_bf16 v[68:71],v[116:119],v[220:223],0
v_mfma_f32_16x16x32_bf16 v[72:75],v[120:123],v[220:223],0
v_mfma_f32_16x16x32_bf16 v[76:79],v[124:127],v[220:223],0
v_mfma_f32_16x16x32_bf16 v[80:83],v[128:131],v[220:223],0
v_mfma_f32_16x16x32_bf16 v[84:87],v[132:135],v[220:223],0
v_mfma_f32_16x16x32_bf16 v[88:91],v[136:139],v[220:223],0
v_mfma_f32_16x16x32_bf16 v[92:95],v[140:143],v[220:223],0
v_mfma_f32_16x16x32_bf16 v[96:99],v[144:147],v[220:223],0
v_mfma_f32_16x16x32_bf16 v[100:103],v[148:151],v[220:223],0
v_mfma_f32_16x16x32_bf16 v[104:107],v[152:155],v[220:223],0
v_mfma_f32_16x16x32_bf16 v[108:111],v[156:159],v[220:223],0
v_mfma_f32_16x16x16_bf16 v[64:67],v[172:173],v[224:225],v[64:67]
v_mfma_f32_16x16x16_bf16 v[68:71],v[172:173],v[226:227],v[68:71]
v_mfma_f32_16x16x16_bf16 v[72:75],v[174:175],v[224:225],v[72:75]
v_mfma_f32_16x16x16_bf16 v[76:79],v[174:175],v[226:227],v[76:79]
v_mfma_f32_16x16x16_bf16 v[80:83],v[176:177],v[224:225],v[80:83]
v_mfma_f32_16x16x16_bf16 v[84:87],v[176:177],v[226:227],v[84:87]
v_mfma_f32_16x16x16_bf16 v[88:91],v[178:179],v[224:225],v[88:91]
v_mfma_f32_16x16x16_bf16 v[92:95],v[178:179],v[226:227],v[92:95]
v_mfma_f32_16x16x16_bf16 v[96:99],v[180:181],v[224:225],v[96:99]
v_mfma_f32_16x16x16_bf16 v[100:103],v[180:181],v[226:227],v[100:103]
v_mfma_f32_16x16x16_bf16 v[104:107],v[182:183],v[224:225],v[104:107]
v_mfma_f32_16x16x16_bf16 v[108:111],v[182:183],v[226:227],v[108:111]
s_cmp_lg_u32 s49,0
s_nop 5
s_cbranch_scc1 ATT_OS
v_cvt_pk_bf16_f32 v232,v16,v17
v_cvt_pk_bf16_f32 v233,v18,v19
v_cvt_pk_bf16_f32 v234,v20,v21
v_cvt_pk_bf16_f32 v235,v22,v23
s_add_u32 s63,s66,0
buffer_store_dwordx4 v[232:235],v229,s[8:11],s63 offen offset:0
v_cvt_pk_bf16_f32 v236,v24,v25
v_cvt_pk_bf16_f32 v237,v26,v27
v_cvt_pk_bf16_f32 v238,v28,v29
v_cvt_pk_bf16_f32 v239,v30,v31
buffer_store_dwordx4 v[236:239],v229,s[8:11],s63 offen offset:2048
v_cvt_pk_bf16_f32 v232,v32,v33
v_cvt_pk_bf16_f32 v233,v34,v35
v_cvt_pk_bf16_f32 v234,v36,v37
v_cvt_pk_bf16_f32 v235,v38,v39
s_add_u32 s63,s66,4096
buffer_store_dwordx4 v[232:235],v229,s[8:11],s63 offen offset:0
v_cvt_pk_bf16_f32 v236,v40,v41
v_cvt_pk_bf16_f32 v237,v42,v43
v_cvt_pk_bf16_f32 v238,v44,v45
v_cvt_pk_bf16_f32 v239,v46,v47
buffer_store_dwordx4 v[236:239],v229,s[8:11],s63 offen offset:2048
v_cvt_pk_bf16_f32 v232,v48,v49
v_cvt_pk_bf16_f32 v233,v50,v51
v_cvt_pk_bf16_f32 v234,v52,v53
v_cvt_pk_bf16_f32 v235,v54,v55
s_add_u32 s63,s66,8192
buffer_store_dwordx4 v[232:235],v229,s[8:11],s63 offen offset:0
v_cvt_pk_bf16_f32 v236,v56,v57
v_cvt_pk_bf16_f32 v237,v58,v59
v_cvt_pk_bf16_f32 v238,v60,v61
v_cvt_pk_bf16_f32 v239,v62,v63
buffer_store_dwordx4 v[236:239],v229,s[8:11],s63 offen offset:2048
v_cvt_pk_bf16_f32 v232,v64,v65
v_cvt_pk_bf16_f32 v233,v66,v67
v_cvt_pk_bf16_f32 v234,v68,v69
v_cvt_pk_bf16_f32 v235,v70,v71
s_add_u32 s63,s66,256
buffer_store_dwordx4 v[232:235],v229,s[8:11],s63 offen offset:0
v_cvt_pk_bf16_f32 v236,v72,v73
v_cvt_pk_bf16_f32 v237,v74,v75
v_cvt_pk_bf16_f32 v238,v76,v77
v_cvt_pk_bf16_f32 v239,v78,v79
buffer_store_dwordx4 v[236:239],v229,s[8:11],s63 offen offset:2048
v_cvt_pk_bf16_f32 v232,v80,v81
v_cvt_pk_bf16_f32 v233,v82,v83
v_cvt_pk_bf16_f32 v234,v84,v85
v_cvt_pk_bf16_f32 v235,v86,v87
s_add_u32 s63,s66,4352
buffer_store_dwordx4 v[232:235],v229,s[8:11],s63 offen offset:0
v_cvt_pk_bf16_f32 v236,v88,v89
v_cvt_pk_bf16_f32 v237,v90,v91
v_cvt_pk_bf16_f32 v238,v92,v93
v_cvt_pk_bf16_f32 v239,v94,v95
buffer_store_dwordx4 v[236:239],v229,s[8:11],s63 offen offset:2048
v_cvt_pk_bf16_f32 v232,v96,v97
v_cvt_pk_bf16_f32 v233,v98,v99
v_cvt_pk_bf16_f32 v234,v100,v101
v_cvt_pk_bf16_f32 v235,v102,v103
s_add_u32 s63,s66,8448
buffer_store_dwordx4 v[232:235],v229,s[8:11],s63 offen offset:0
v_cvt_pk_bf16_f32 v236,v104,v105
v_cvt_pk_bf16_f32 v237,v106,v107
v_cvt_pk_bf16_f32 v238,v108,v109
v_cvt_pk_bf16_f32 v239,v110,v111
buffer_store_dwordx4 v[236:239],v229,s[8:11],s63 offen offset:2048
s_lshl_b32 s60,s51,6
s_add_u32 s60,s60,s52
s_lshl_b32 s60,s60,9
s_add_u32 s60,s60,262144
s_lshl_b32 s61,s87,2
s_add_u32 s60,s60,s61
s_waitcnt vmcnt(0)
s_mov_b64 exec,1
buffer_store_dword v5,v1,s[8:11],s60 offen
s_mov_b64 exec,-1
s_branch ATT_OJ
ATT_OS:
v_cvt_pk_bf16_f32 v232,v16,v17
v_cvt_pk_bf16_f32 v233,v18,v19
v_cvt_pk_bf16_f32 v234,v20,v21
v_cvt_pk_bf16_f32 v235,v22,v23
s_add_u32 s63,s66,0
buffer_store_dwordx4 v[232:235],v229,s[8:11],s63 offen sc1
v_cvt_pk_bf16_f32 v236,v24,v25
v_cvt_pk_bf16_f32 v237,v26,v27
v_cvt_pk_bf16_f32 v238,v28,v29
v_cvt_pk_bf16_f32 v239,v30,v31
buffer_store_dwordx4 v[236:239],v229,s[8:11],s63 offen offset:2048 sc1
v_cvt_pk_bf16_f32 v232,v32,v33
v_cvt_pk_bf16_f32 v233,v34,v35
v_cvt_pk_bf16_f32 v234,v36,v37
v_cvt_pk_bf16_f32 v235,v38,v39
s_add_u32 s63,s66,4096
buffer_store_dwordx4 v[232:235],v229,s[8:11],s63 offen sc1
v_cvt_pk_bf16_f32 v236,v40,v41
v_cvt_pk_bf16_f32 v237,v42,v43
v_cvt_pk_bf16_f32 v238,v44,v45
v_cvt_pk_bf16_f32 v239,v46,v47
buffer_store_dwordx4 v[236:239],v229,s[8:11],s63 offen offset:2048 sc1
v_cvt_pk_bf16_f32 v232,v48,v49
v_cvt_pk_bf16_f32 v233,v50,v51
v_cvt_pk_bf16_f32 v234,v52,v53
v_cvt_pk_bf16_f32 v235,v54,v55
s_add_u32 s63,s66,8192
buffer_store_dwordx4 v[232:235],v229,s[8:11],s63 offen sc1
v_cvt_pk_bf16_f32 v236,v56,v57
v_cvt_pk_bf16_f32 v237,v58,v59
v_cvt_pk_bf16_f32 v238,v60,v61
v_cvt_pk_bf16_f32 v239,v62,v63
buffer_store_dwordx4 v[236:239],v229,s[8:11],s63 offen offset:2048 sc1
v_cvt_pk_bf16_f32 v232,v64,v65
v_cvt_pk_bf16_f32 v233,v66,v67
v_cvt_pk_bf16_f32 v234,v68,v69
v_cvt_pk_bf16_f32 v235,v70,v71
s_add_u32 s63,s66,256
buffer_store_dwordx4 v[232:235],v229,s[8:11],s63 offen sc1
v_cvt_pk_bf16_f32 v236,v72,v73
v_cvt_pk_bf16_f32 v237,v74,v75
v_cvt_pk_bf16_f32 v238,v76,v77
v_cvt_pk_bf16_f32 v239,v78,v79
buffer_store_dwordx4 v[236:239],v229,s[8:11],s63 offen offset:2048 sc1
v_cvt_pk_bf16_f32 v232,v80,v81
v_cvt_pk_bf16_f32 v233,v82,v83
v_cvt_pk_bf16_f32 v234,v84,v85
v_cvt_pk_bf16_f32 v235,v86,v87
s_add_u32 s63,s66,4352
buffer_store_dwordx4 v[232:235],v229,s[8:11],s63 offen sc1
v_cvt_pk_bf16_f32 v236,v88,v89
v_cvt_pk_bf16_f32 v237,v90,v91
v_cvt_pk_bf16_f32 v238,v92,v93
v_cvt_pk_bf16_f32 v239,v94,v95
buffer_store_dwordx4 v[236:239],v229,s[8:11],s63 offen offset:2048 sc1
v_cvt_pk_bf16_f32 v232,v96,v97
v_cvt_pk_bf16_f32 v233,v98,v99
v_cvt_pk_bf16_f32 v234,v100,v101
v_cvt_pk_bf16_f32 v235,v102,v103
s_add_u32 s63,s66,8448
buffer_store_dwordx4 v[232:235],v229,s[8:11],s63 offen sc1
v_cvt_pk_bf16_f32 v236,v104,v105
v_cvt_pk_bf16_f32 v237,v106,v107
v_cvt_pk_bf16_f32 v238,v108,v109
v_cvt_pk_bf16_f32 v239,v110,v111
buffer_store_dwordx4 v[236:239],v229,s[8:11],s63 offen offset:2048 sc1
s_lshl_b32 s60,s51,6
s_add_u32 s60,s60,s52
s_lshl_b32 s60,s60,9
s_add_u32 s60,s60,262144
s_lshl_b32 s61,s87,2
s_add_u32 s60,s60,s61
s_waitcnt vmcnt(0)
s_mov_b64 exec,1
buffer_store_dword v5,v1,s[8:11],s60 offen sc1
s_mov_b64 exec,-1
ATT_OJ:
s_add_u32 s69,s69,393216
s_add_u32 s70,s70,2048
s_add_u32 s52,s52,2
s_cmp_lt_u32 s52,64
s_cbranch_scc1 ATT_LOOP
s_endpgm
ROLE_WO:
v_lshlrev_b32 v1,4,v0
v_mov_b32 v5,1
s_lshl_b32 s56,s48,2
s_add_u32 s56,s56,s46
v_bfe_u32 v6,v0,2,2
v_lshrrev_b32 v7,4,v0
v_add_u32 v7,v6,v7
v_and_b32 v7,3,v7
v_and_b32 v15,3,v0
v_lshlrev_b32 v15,4,v15
v_lshl_add_u32 v15,v7,6,v15
v_lshl_add_u32 v15,v6,8,v15
v_lshrrev_b32 v6,5,v0
v_bfe_u32 v7,v0,4,1
v_lshlrev_b32 v16,10,v7
v_lshl_add_u32 v16,v6,8,v16
v_and_b32 v6,15,v0
v_lshl_add_u32 v16,v6,4,v16
v_add_u32 v18,49152,v16
v_lshrrev_b32 v6,5,v0
v_bfe_u32 v7,v0,4,1
v_lshlrev_b32 v20,10,v7
v_lshl_add_u32 v20,v6,8,v20
v_and_b32 v6,15,v0
v_lshl_add_u32 v20,v6,4,v20
v_lshrrev_b32 v6,5,v0
v_add_u32 v6,2,v6
v_bfe_u32 v7,v0,4,1
v_lshlrev_b32 v17,10,v7
v_lshl_add_u32 v17,v6,8,v17
v_and_b32 v6,15,v0
v_lshl_add_u32 v17,v6,4,v17
v_add_u32 v19,49152,v17
v_lshrrev_b32 v6,5,v0
v_add_u32 v6,2,v6
v_bfe_u32 v7,v0,4,1
v_lshlrev_b32 v21,10,v7
v_lshl_add_u32 v21,v6,8,v21
v_and_b32 v6,15,v0
v_lshl_add_u32 v21,v6,4,v21
v_add_u32 v16,0,v1
v_add_u32 v17,1024,v1
v_add_u32 v18,49152,v1
v_add_u32 v19,50176,v1
s_mul_i32 s68,s48,52429
s_lshr_b32 s68,s68,18
s_mul_i32 s60,s68,20
s_sub_u32 s60,s56,s60
s_lshl2_add_u32 s61,s68,s46
s_lshr_b32 s62,s61,3
s_mul_i32 s62,s62,24
s_add_u32 s61,s61,s62
s_lshl_b32 s61,s61,2
v_mov_b32 v2,s61
v_bfe_u32 v6,v0,2,3
v_mul_u32_u24 v20,5120,v6
v_and_b32 v6,3,v0
v_lshl_add_u32 v20,v6,4,v20
v_lshrrev_b32 v6,5,v0
v_lshl_add_u32 v20,v6,6,v20
s_mul_i32 s58,s68,983040
s_lshl_b32 s61,s60,6
s_add_u32 s58,s58,s61
s_mul_i32 s69,s68,40960
s_lshl_b32 s60,s60,8
s_add_u32 s69,s69,s60
s_add_u32 s69,s69,175112192
s_lshl_b32 s75,s56,2
s_add_u32 s75,s75,819200
s_waitcnt vmcnt(0)
s_barrier
s_cmp_lg_u32 s46,0
s_cbranch_scc1 arr_243
v_mov_b32 v6,1
s_lshl_b32 s3,s49,2
v_mov_b32 v7,s3
s_mov_b64 exec,1
buffer_atomic_add v6,v7,s[12:15],0 offen sc1
s_mov_b64 exec,-1
arr_243:
s_mul_i32 s63,s46,40960
s_mov_b32 s4,s26
s_mov_b32 s5,s27
s_mov_b32 s6,7864320
s_mov_b32 s7,0x20000
v_lshrrev_b32 v9,2,v0
s_mov_b32 s64,1280
v_mul_lo_u32 v9,v9,s64
v_and_b32 v10,3,v0
v_lshl_add_u32 v6,v10,4,v9
s_add_u32 m0,s63,0
s_add_u32 s65,s58,0
buffer_load_dwordx4 v6,s[4:7],s65 offen lds
s_add_u32 m0,s63,1024
s_add_u32 s65,s58,20480
buffer_load_dwordx4 v6,s[4:7],s65 offen lds
s_add_u32 m0,s63,2048
s_add_u32 s65,s58,40960
buffer_load_dwordx4 v6,s[4:7],s65 offen lds
s_add_u32 m0,s63,3072
s_add_u32 s65,s58,61440
buffer_load_dwordx4 v6,s[4:7],s65 offen lds
s_add_u32 m0,s63,4096
s_add_u32 s65,s58,81920
buffer_load_dwordx4 v6,s[4:7],s65 offen lds
s_add_u32 m0,s63,5120
s_add_u32 s65,s58,102400
buffer_load_dwordx4 v6,s[4:7],s65 offen lds
s_add_u32 m0,s63,6144
s_add_u32 s65,s58,122880
buffer_load_dwordx4 v6,s[4:7],s65 offen lds
s_add_u32 m0,s63,7168
s_add_u32 s65,s58,143360
buffer_load_dwordx4 v6,s[4:7],s65 offen lds
s_add_u32 m0,s63,8192
s_add_u32 s65,s58,163840
buffer_load_dwordx4 v6,s[4:7],s65 offen lds
s_add_u32 m0,s63,9216
s_add_u32 s65,s58,184320
buffer_load_dwordx4 v6,s[4:7],s65 offen lds
s_add_u32 m0,s63,10240
s_add_u32 s65,s58,204800
buffer_load_dwordx4 v6,s[4:7],s65 offen lds
s_add_u32 m0,s63,11264
s_add_u32 s65,s58,225280
buffer_load_dwordx4 v6,s[4:7],s65 offen lds
s_add_u32 m0,s63,12288
s_add_u32 s65,s58,245760
buffer_load_dwordx4 v6,s[4:7],s65 offen lds
s_add_u32 m0,s63,13312
s_add_u32 s65,s58,266240
buffer_load_dwordx4 v6,s[4:7],s65 offen lds
s_add_u32 m0,s63,14336
s_add_u32 s65,s58,286720
buffer_load_dwordx4 v6,s[4:7],s65 offen lds
s_add_u32 m0,s63,15360
s_add_u32 s65,s58,307200
buffer_load_dwordx4 v6,s[4:7],s65 offen lds
s_add_u32 m0,s63,16384
s_add_u32 s65,s58,327680
buffer_load_dwordx4 v6,s[4:7],s65 offen lds
s_add_u32 m0,s63,17408
s_add_u32 s65,s58,348160
buffer_load_dwordx4 v6,s[4:7],s65 offen lds
s_add_u32 m0,s63,18432
s_add_u32 s65,s58,368640
buffer_load_dwordx4 v6,s[4:7],s65 offen lds
s_add_u32 m0,s63,19456
s_add_u32 s65,s58,389120
buffer_load_dwordx4 v6,s[4:7],s65 offen lds
s_add_u32 m0,s63,20480
s_add_u32 s65,s58,409600
buffer_load_dwordx4 v6,s[4:7],s65 offen lds
s_add_u32 m0,s63,21504
s_add_u32 s65,s58,430080
buffer_load_dwordx4 v6,s[4:7],s65 offen lds
s_add_u32 m0,s63,22528
s_add_u32 s65,s58,450560
buffer_load_dwordx4 v6,s[4:7],s65 offen lds
s_add_u32 m0,s63,23552
s_add_u32 s65,s58,471040
buffer_load_dwordx4 v6,s[4:7],s65 offen lds
s_add_u32 m0,s63,24576
s_add_u32 s65,s58,491520
buffer_load_dwordx4 v6,s[4:7],s65 offen lds
s_add_u32 m0,s63,25600
s_add_u32 s65,s58,512000
buffer_load_dwordx4 v6,s[4:7],s65 offen lds
s_add_u32 m0,s63,26624
s_add_u32 s65,s58,532480
buffer_load_dwordx4 v6,s[4:7],s65 offen lds
s_add_u32 m0,s63,27648
s_add_u32 s65,s58,552960
buffer_load_dwordx4 v6,s[4:7],s65 offen lds
s_add_u32 m0,s63,28672
s_add_u32 s65,s58,573440
buffer_load_dwordx4 v6,s[4:7],s65 offen lds
s_add_u32 m0,s63,29696
s_add_u32 s65,s58,593920
buffer_load_dwordx4 v6,s[4:7],s65 offen lds
s_add_u32 m0,s63,30720
s_add_u32 s65,s58,614400
buffer_load_dwordx4 v6,s[4:7],s65 offen lds
s_add_u32 m0,s63,31744
s_add_u32 s65,s58,634880
buffer_load_dwordx4 v6,s[4:7],s65 offen lds
s_add_u32 m0,s63,32768
s_add_u32 s65,s58,655360
buffer_load_dwordx4 v6,s[4:7],s65 offen lds
s_add_u32 m0,s63,33792
s_add_u32 s65,s58,675840
buffer_load_dwordx4 v6,s[4:7],s65 offen lds
s_add_u32 m0,s63,34816
s_add_u32 s65,s58,696320
buffer_load_dwordx4 v6,s[4:7],s65 offen lds
s_add_u32 m0,s63,35840
s_add_u32 s65,s58,716800
buffer_load_dwordx4 v6,s[4:7],s65 offen lds
s_add_u32 m0,s63,36864
s_add_u32 s65,s58,737280
buffer_load_dwordx4 v6,s[4:7],s65 offen lds
s_add_u32 m0,s63,37888
s_add_u32 s65,s58,757760
buffer_load_dwordx4 v6,s[4:7],s65 offen lds
s_add_u32 m0,s63,38912
s_add_u32 s65,s58,778240
buffer_load_dwordx4 v6,s[4:7],s65 offen lds
s_add_u32 m0,s63,39936
s_add_u32 s65,s58,798720
buffer_load_dwordx4 v6,s[4:7],s65 offen lds
s_waitcnt vmcnt(20)
v_bfe_u32 v9,v0,2,2
v_lshrrev_b32 v10,5,v0
v_lshl_add_u32 v9,v10,2,v9
v_mul_u32_u24 v9,64,v9
v_and_b32 v10,1,v0
v_lshl_add_u32 v9,v10,3,v9
v_bfe_u32 v10,v0,1,1
v_lshl_add_u32 v9,v10,5,v9
v_bfe_u32 v10,v0,4,1
v_lshl_add_u32 v9,v10,4,v9
v_add_u32 v7,s63,v9
ds_read_b64_tr_b16 a[0:1],v7 offset:0
ds_read_b64_tr_b16 a[2:3],v7 offset:1024
ds_read_b64_tr_b16 a[4:5],v7 offset:512
ds_read_b64_tr_b16 a[6:7],v7 offset:1536
ds_read_b64_tr_b16 a[8:9],v7 offset:2048
ds_read_b64_tr_b16 a[10:11],v7 offset:3072
ds_read_b64_tr_b16 a[12:13],v7 offset:2560
ds_read_b64_tr_b16 a[14:15],v7 offset:3584
ds_read_b64_tr_b16 a[16:17],v7 offset:4096
ds_read_b64_tr_b16 a[18:19],v7 offset:5120
ds_read_b64_tr_b16 a[20:21],v7 offset:4608
ds_read_b64_tr_b16 a[22:23],v7 offset:5632
s_waitcnt lgkmcnt(4)
ds_read_b64_tr_b16 a[24:25],v7 offset:6144
ds_read_b64_tr_b16 a[26:27],v7 offset:7168
ds_read_b64_tr_b16 a[28:29],v7 offset:6656
ds_read_b64_tr_b16 a[30:31],v7 offset:7680
ds_read_b64_tr_b16 a[32:33],v7 offset:8192
ds_read_b64_tr_b16 a[34:35],v7 offset:9216
ds_read_b64_tr_b16 a[36:37],v7 offset:8704
ds_read_b64_tr_b16 a[38:39],v7 offset:9728
ds_read_b64_tr_b16 a[40:41],v7 offset:10240
ds_read_b64_tr_b16 a[42:43],v7 offset:11264
ds_read_b64_tr_b16 a[44:45],v7 offset:10752
ds_read_b64_tr_b16 a[46:47],v7 offset:11776
s_waitcnt lgkmcnt(4)
ds_read_b64_tr_b16 a[48:49],v7 offset:12288
ds_read_b64_tr_b16 a[50:51],v7 offset:13312
ds_read_b64_tr_b16 a[52:53],v7 offset:12800
ds_read_b64_tr_b16 a[54:55],v7 offset:13824
ds_read_b64_tr_b16 a[56:57],v7 offset:14336
ds_read_b64_tr_b16 a[58:59],v7 offset:15360
ds_read_b64_tr_b16 a[60:61],v7 offset:14848
ds_read_b64_tr_b16 a[62:63],v7 offset:15872
ds_read_b64_tr_b16 a[64:65],v7 offset:16384
ds_read_b64_tr_b16 a[66:67],v7 offset:17408
ds_read_b64_tr_b16 a[68:69],v7 offset:16896
ds_read_b64_tr_b16 a[70:71],v7 offset:17920
s_waitcnt lgkmcnt(4)
ds_read_b64_tr_b16 a[72:73],v7 offset:18432
ds_read_b64_tr_b16 a[74:75],v7 offset:19456
ds_read_b64_tr_b16 a[76:77],v7 offset:18944
ds_read_b64_tr_b16 a[78:79],v7 offset:19968
s_waitcnt lgkmcnt(0)
s_add_u32 m0,s63,0
s_add_u32 s65,s58,819200
buffer_load_dwordx4 v6,s[4:7],s65 offen lds
s_add_u32 m0,s63,1024
s_add_u32 s65,s58,839680
buffer_load_dwordx4 v6,s[4:7],s65 offen lds
s_add_u32 m0,s63,2048
s_add_u32 s65,s58,860160
buffer_load_dwordx4 v6,s[4:7],s65 offen lds
s_add_u32 m0,s63,3072
s_add_u32 s65,s58,880640
buffer_load_dwordx4 v6,s[4:7],s65 offen lds
s_add_u32 m0,s63,4096
s_add_u32 s65,s58,901120
buffer_load_dwordx4 v6,s[4:7],s65 offen lds
s_add_u32 m0,s63,5120
s_add_u32 s65,s58,921600
buffer_load_dwordx4 v6,s[4:7],s65 offen lds
s_add_u32 m0,s63,6144
s_add_u32 s65,s58,942080
buffer_load_dwordx4 v6,s[4:7],s65 offen lds
s_add_u32 m0,s63,7168
s_add_u32 s65,s58,962560
buffer_load_dwordx4 v6,s[4:7],s65 offen lds
s_waitcnt vmcnt(8)
v_bfe_u32 v9,v0,2,2
v_lshrrev_b32 v10,5,v0
v_lshl_add_u32 v9,v10,2,v9
v_mul_u32_u24 v9,64,v9
v_and_b32 v10,1,v0
v_lshl_add_u32 v9,v10,3,v9
v_bfe_u32 v10,v0,1,1
v_lshl_add_u32 v9,v10,5,v9
v_bfe_u32 v10,v0,4,1
v_lshl_add_u32 v9,v10,4,v9
v_add_u32 v7,s63,v9
ds_read_b64_tr_b16 a[80:81],v7 offset:20480
ds_read_b64_tr_b16 a[82:83],v7 offset:21504
ds_read_b64_tr_b16 a[84:85],v7 offset:20992
ds_read_b64_tr_b16 a[86:87],v7 offset:22016
ds_read_b64_tr_b16 a[88:89],v7 offset:22528
ds_read_b64_tr_b16 a[90:91],v7 offset:23552
ds_read_b64_tr_b16 a[92:93],v7 offset:23040
ds_read_b64_tr_b16 a[94:95],v7 offset:24064
ds_read_b64_tr_b16 a[96:97],v7 offset:24576
ds_read_b64_tr_b16 a[98:99],v7 offset:25600
ds_read_b64_tr_b16 a[100:101],v7 offset:25088
ds_read_b64_tr_b16 a[102:103],v7 offset:26112
s_waitcnt lgkmcnt(4)
ds_read_b64_tr_b16 a[104:105],v7 offset:26624
ds_read_b64_tr_b16 a[106:107],v7 offset:27648
ds_read_b64_tr_b16 a[108:109],v7 offset:27136
ds_read_b64_tr_b16 a[110:111],v7 offset:28160
ds_read_b64_tr_b16 a[112:113],v7 offset:28672
ds_read_b64_tr_b16 a[114:115],v7 offset:29696
ds_read_b64_tr_b16 a[116:117],v7 offset:29184
ds_read_b64_tr_b16 a[118:119],v7 offset:30208
ds_read_b64_tr_b16 a[120:121],v7 offset:30720
ds_read_b64_tr_b16 a[122:123],v7 offset:31744
ds_read_b64_tr_b16 a[124:125],v7 offset:31232
ds_read_b64_tr_b16 a[126:127],v7 offset:32256
s_waitcnt lgkmcnt(4)
ds_read_b64_tr_b16 a[128:129],v7 offset:32768
ds_read_b64_tr_b16 a[130:131],v7 offset:33792
ds_read_b64_tr_b16 a[132:133],v7 offset:33280
ds_read_b64_tr_b16 a[134:135],v7 offset:34304
ds_read_b64_tr_b16 a[136:137],v7 offset:34816
ds_read_b64_tr_b16 a[138:139],v7 offset:35840
ds_read_b64_tr_b16 a[140:141],v7 offset:35328
ds_read_b64_tr_b16 a[142:143],v7 offset:36352
ds_read_b64_tr_b16 a[144:145],v7 offset:36864
ds_read_b64_tr_b16 a[146:147],v7 offset:37888
ds_read_b64_tr_b16 a[148:149],v7 offset:37376
ds_read_b64_tr_b16 a[150:151],v7 offset:38400
s_waitcnt lgkmcnt(4)
ds_read_b64_tr_b16 a[152:153],v7 offset:38912
ds_read_b64_tr_b16 a[154:155],v7 offset:39936
ds_read_b64_tr_b16 a[156:157],v7 offset:39424
ds_read_b64_tr_b16 a[158:159],v7 offset:40448
s_waitcnt lgkmcnt(0)
s_waitcnt vmcnt(0)
v_bfe_u32 v9,v0,2,2
v_lshrrev_b32 v10,5,v0
v_lshl_add_u32 v9,v10,2,v9
v_mul_u32_u24 v9,64,v9
v_and_b32 v10,1,v0
v_lshl_add_u32 v9,v10,3,v9
v_bfe_u32 v10,v0,1,1
v_lshl_add_u32 v9,v10,5,v9
v_bfe_u32 v10,v0,4,1
v_lshl_add_u32 v9,v10,4,v9
v_add_u32 v7,s63,v9
ds_read_b64_tr_b16 a[160:161],v7 offset:0
ds_read_b64_tr_b16 a[162:163],v7 offset:1024
ds_read_b64_tr_b16 a[164:165],v7 offset:512
ds_read_b64_tr_b16 a[166:167],v7 offset:1536
ds_read_b64_tr_b16 a[168:169],v7 offset:2048
ds_read_b64_tr_b16 a[170:171],v7 offset:3072
ds_read_b64_tr_b16 a[172:173],v7 offset:2560
ds_read_b64_tr_b16 a[174:175],v7 offset:3584
ds_read_b64_tr_b16 a[176:177],v7 offset:4096
ds_read_b64_tr_b16 a[178:179],v7 offset:5120
ds_read_b64_tr_b16 a[180:181],v7 offset:4608
ds_read_b64_tr_b16 a[182:183],v7 offset:5632
s_waitcnt lgkmcnt(4)
ds_read_b64_tr_b16 a[184:185],v7 offset:6144
ds_read_b64_tr_b16 a[186:187],v7 offset:7168
ds_read_b64_tr_b16 a[188:189],v7 offset:6656
ds_read_b64_tr_b16 a[190:191],v7 offset:7680
s_waitcnt lgkmcnt(0)
s_barrier
s_lshl_b32 s3,s49,2
v_mov_b32 v7,s3
s_nop 1
ibw_244:
buffer_load_dword v6,v7,s[12:15],0 offen sc1
s_waitcnt vmcnt(0)
v_cmp_ne_u32 vcc,256,v6
s_nop 0
s_cbranch_vccz ok_245
s_sleep 8
s_sub_u32 s47,s47,1
s_cbranch_scc1 ABORT
s_branch ibw_244
ok_245:
s_cmp_lg_u32 s49,0
s_cbranch_scc1 ibok_246
v_and_b32 v7,7,v0
v_lshlrev_b32 v7,2,v7
buffer_load_dword v6,v7,s[12:15],0 offen offset:32 sc1
s_waitcnt vmcnt(0)
v_cmp_ne_u32 vcc,32,v6
s_nop 0
s_cbranch_vccz ibok_246
s_barrier
s_mov_b32 s49,1
s_mov_b32 s3,s2
s_load_dwordx16 s[16:31],s[0:1],0
s_load_dwordx8 s[32:39],s[0:1],64
s_waitcnt lgkmcnt(0)
s_branch DISPATCH
ibok_246:
s_mov_b32 s50,0
s_mov_b32 s32,0
s_mov_b32 s57,0
s_mov_b32 s59,2147483648
s_mov_b32 s82,2147483648
s_mov_b32 s39,2147483648
v_mov_b32 v22,100352
v_lshl_add_u32 v22,v0,2,v22
v_mov_b32 v23,0
ds_write_b32 v22,v23
s_mov_b32 s39,1600000
v_and_b32 v72,15,v0
v_lshlrev_b32 v72,7,v72
s_mov_b64 s[76:77],-1
s_mov_b64 s[80:81],-1
s_waitcnt lgkmcnt(0)
s_barrier
s_mov_b32 s83,s100
s_min_u32 s62,s32,127
s_sub_u32 s60,s62,14
s_lshr_b32 s34,s60,1
s_and_b32 s33,s60,1
s_cmp_eq_u32 s33,0
s_cselect_b32 s61,14,0
s_add_u32 s34,s34,s61
s_sub_u32 s61,s60,50
s_cmp_ge_u32 s60,100
s_cselect_b32 s34,s61,s34
s_cselect_b32 s33,1,s33
s_cmp_lt_u32 s62,14
s_cselect_b32 s34,s62,s34
s_cselect_b32 s33,0,s33
s_lshl_b32 s35,s33,6
s_add_u32 s35,s35,s34
s_lshl_b32 s35,s35,9
s_add_u32 s35,s35,262144
s_sub_u32 s57,49152,s57
v_swap_b32 v16,v18
v_swap_b32 v17,v19
s_add_u32 s62,s32,1
s_min_u32 s62,s62,127
s_sub_u32 s60,s62,14
s_lshr_b32 s41,s60,1
s_and_b32 s40,s60,1
s_cmp_eq_u32 s40,0
s_cselect_b32 s61,14,0
s_add_u32 s41,s41,s61
s_sub_u32 s61,s60,50
s_cmp_ge_u32 s60,100
s_cselect_b32 s41,s61,s41
s_cselect_b32 s40,1,s40
s_cmp_lt_u32 s62,14
s_cselect_b32 s41,s62,s41
s_cselect_b32 s40,0,s40
s_lshl_b32 s42,s40,6
s_add_u32 s42,s42,s41
s_lshl_b32 s42,s42,9
s_add_u32 s42,s42,262144
WO_COLD:
s_mov_b32 s37,0
fb_247:
buffer_load_dword v3,v2,s[8:11],s35 offen sc1
s_waitcnt vmcnt(0)
v_cmp_eq_u32 vcc,0,v3
s_and_b64 vcc,vcc,s[76:77]
s_cbranch_scc0 ok_248
s_sleep 1
s_sub_u32 s47,s47,1
s_cbranch_scc1 ABORT
s_branch fb_247
ok_248:
WO_COLD2:
s_sub_u32 s66,49152,s57
s_mul_i32 s60,s34,393216
s_add_u32 s60,s60,s37
s_mul_i32 s61,s68,49152
s_add_u32 s60,s60,s61
s_mul_i32 s61,s46,12288
s_add_u32 s60,s60,s61
s_add_u32 s60,s60,149946368
s_add_u32 s61,s61,s66
s_add_u32 m0,s61,0
s_add_u32 s63,s60,0
buffer_load_dwordx4 v1,s[8:11],s63 offen sc1 lds
buffer_load_dwordx4 v1,s[8:11],s63 offen offset:1024 sc1 lds
buffer_load_dwordx4 v1,s[8:11],s63 offen offset:2048 sc1 lds
buffer_load_dwordx4 v1,s[8:11],s63 offen offset:3072 sc1 lds
s_add_u32 m0,s61,4096
s_add_u32 s63,s60,4096
buffer_load_dwordx4 v1,s[8:11],s63 offen sc1 lds
buffer_load_dwordx4 v1,s[8:11],s63 offen offset:1024 sc1 lds
buffer_load_dwordx4 v1,s[8:11],s63 offen offset:2048 sc1 lds
buffer_load_dwordx4 v1,s[8:11],s63 offen offset:3072 sc1 lds
s_waitcnt vmcnt(7)
s_mov_b64 exec,1
buffer_store_dword v5,v1,s[8:11],s59 offen sc1
s_mov_b64 exec,-1
s_mov_b32 s59,2147483648
s_add_u32 m0,s61,8192
s_add_u32 s63,s60,8192
buffer_load_dwordx4 v1,s[8:11],s63 offen sc1 lds
buffer_load_dwordx4 v1,s[8:11],s63 offen offset:1024 sc1 lds
buffer_load_dwordx4 v1,s[8:11],s63 offen offset:2048 sc1 lds
buffer_load_dwordx4 v1,s[8:11],s63 offen offset:3072 sc1 lds
s_mov_b32 s35,s42
buffer_load_dword v3,v2,s[8:11],s35 offen sc1
s_mov_b32 s53,s33
s_mov_b32 s54,s34
s_add_u32 s32,s32,1
s_mov_b32 s33,s40
s_mov_b32 s34,s41
s_mov_b64 s[76:77],s[80:81]
s_sub_u32 s57,49152,s57
v_swap_b32 v16,v18
v_swap_b32 v17,v19
s_mov_b32 s51,s53
s_mov_b32 s52,s54
s_mov_b32 s37,2147483648
s_waitcnt vmcnt(6)
s_branch WO_GO
WO_NEXT:
s_sub_u32 s57,49152,s57
v_swap_b32 v16,v18
v_swap_b32 v17,v19
s_mov_b32 s51,s53
s_mov_b32 s52,s54
s_waitcnt vmcnt(2)
v_cmp_eq_u32 vcc,0,v3
s_and_b64 vcc,vcc,s[76:77]
s_cselect_b32 s37,2147483648,0
s_cmp_lt_u32 s32,128
s_cselect_b32 s37,s37,2147483648
WO_GO:
s_barrier
ds_read_b128 v[24:27],v16 offset:0
ds_read_b128 v[28:31],v17 offset:0
ds_read_b128 v[32:35],v16 offset:12288
ds_read_b128 v[36:39],v17 offset:12288
ds_read_b128 v[40:43],v16 offset:24576
ds_read_b128 v[44:47],v17 offset:24576
ds_read_b128 v[48:51],v16 offset:36864
s_waitcnt lgkmcnt(6)
v_mfma_f32_32x32x16_bf16 v[56:71],a[0:3],v[24:27],0
ds_read_b128 v[52:55],v17 offset:36864
s_sub_u32 s66,49152,s57
s_mul_i32 s60,s34,393216
s_add_u32 s60,s60,s37
s_waitcnt lgkmcnt(6)
v_mfma_f32_32x32x16_bf16 v[56:71],a[4:7],v[28:31],v[56:71]
ds_read_b128 v[24:27],v16 offset:2048
s_mul_i32 s61,s68,49152
s_add_u32 s60,s60,s61
s_mul_i32 s61,s46,12288
s_waitcnt lgkmcnt(5)
v_mfma_f32_32x32x16_bf16 v[56:71],a[48:51],v[32:35],v[56:71]
ds_read_b128 v[28:31],v17 offset:2048
s_add_u32 s60,s60,s61
s_add_u32 s60,s60,149946368
s_add_u32 s61,s61,s66
s_add_u32 m0,s61,0
v_mfma_f32_32x32x16_bf16 v[56:71],a[52:55],v[36:39],v[56:71]
ds_read_b128 v[32:35],v16 offset:14336
s_add_u32 s63,s60,0
buffer_load_dwordx4 v1,s[8:11],s63 offen sc1 lds
s_waitcnt lgkmcnt(5)
v_mfma_f32_32x32x16_bf16 v[56:71],a[96:99],v[40:43],v[56:71]
ds_read_b128 v[36:39],v17 offset:14336
s_mul_i32 s71,s52,491520
s_add_u32 s71,s71,s69
s_lshl_b32 s70,s51,6
s_add_u32 s70,s70,s52
v_mfma_f32_32x32x16_bf16 v[56:71],a[100:103],v[44:47],v[56:71]
ds_read_b128 v[40:43],v16 offset:26624
buffer_load_dwordx4 v1,s[8:11],s63 offen offset:1024 sc1 lds
s_mul_i32 s70,s70,640
s_waitcnt lgkmcnt(5)
v_mfma_f32_32x32x16_bf16 v[56:71],a[144:147],v[48:51],v[56:71]
ds_read_b128 v[44:47],v17 offset:26624
s_add_u32 s82,s70,s75
v_mfma_f32_32x32x16_bf16 v[56:71],a[148:151],v[52:55],v[56:71]
ds_read_b128 v[48:51],v16 offset:38912
buffer_load_dwordx4 v1,s[8:11],s63 offen offset:2048 sc1 lds
s_waitcnt lgkmcnt(5)
v_mfma_f32_32x32x16_bf16 v[56:71],a[8:11],v[24:27],v[56:71]
ds_read_b128 v[52:55],v17 offset:38912
v_mfma_f32_32x32x16_bf16 v[56:71],a[12:15],v[28:31],v[56:71]
ds_read_b128 v[24:27],v16 offset:4096
buffer_load_dwordx4 v1,s[8:11],s63 offen offset:3072 sc1 lds
s_add_u32 m0,s61,4096
s_waitcnt lgkmcnt(5)
v_mfma_f32_32x32x16_bf16 v[56:71],a[56:59],v[32:35],v[56:71]
ds_read_b128 v[28:31],v17 offset:4096
s_add_u32 s63,s60,4096
v_mfma_f32_32x32x16_bf16 v[56:71],a[60:63],v[36:39],v[56:71]
ds_read_b128 v[32:35],v16 offset:16384
buffer_load_dwordx4 v1,s[8:11],s63 offen sc1 lds
s_waitcnt lgkmcnt(5)
v_mfma_f32_32x32x16_bf16 v[56:71],a[104:107],v[40:43],v[56:71]
ds_read_b128 v[36:39],v17 offset:16384
v_mfma_f32_32x32x16_bf16 v[56:71],a[108:111],v[44:47],v[56:71]
ds_read_b128 v[40:43],v16 offset:28672
buffer_load_dwordx4 v1,s[8:11],s63 offen offset:1024 sc1 lds
s_waitcnt lgkmcnt(5)
v_mfma_f32_32x32x16_bf16 v[56:71],a[152:155],v[48:51],v[56:71]
ds_read_b128 v[44:47],v17 offset:28672
v_mfma_f32_32x32x16_bf16 v[56:71],a[156:159],v[52:55],v[56:71]
ds_read_b128 v[48:51],v16 offset:40960
buffer_load_dwordx4 v1,s[8:11],s63 offen offset:2048 sc1 lds
s_waitcnt lgkmcnt(5)
v_mfma_f32_32x32x16_bf16 v[56:71],a[16:19],v[24:27],v[56:71]
ds_read_b128 v[52:55],v17 offset:40960
v_mfma_f32_32x32x16_bf16 v[56:71],a[20:23],v[28:31],v[56:71]
ds_read_b128 v[24:27],v16 offset:6144
buffer_load_dwordx4 v1,s[8:11],s63 offen offset:3072 sc1 lds
s_add_u32 m0,s61,8192
s_waitcnt lgkmcnt(5)
v_mfma_f32_32x32x16_bf16 v[56:71],a[64:67],v[32:35],v[56:71]
ds_read_b128 v[28:31],v17 offset:6144
s_add_u32 s63,s60,8192
v_mfma_f32_32x32x16_bf16 v[56:71],a[68:71],v[36:39],v[56:71]
ds_read_b128 v[32:35],v16 offset:18432
buffer_load_dwordx4 v1,s[8:11],s63 offen sc1 lds
s_waitcnt lgkmcnt(5)
v_mfma_f32_32x32x16_bf16 v[56:71],a[112:115],v[40:43],v[56:71]
ds_read_b128 v[36:39],v17 offset:18432
v_mfma_f32_32x32x16_bf16 v[56:71],a[116:119],v[44:47],v[56:71]
ds_read_b128 v[40:43],v16 offset:30720
buffer_load_dwordx4 v1,s[8:11],s63 offen offset:1024 sc1 lds
s_waitcnt lgkmcnt(5)
v_mfma_f32_32x32x16_bf16 v[56:71],a[160:163],v[48:51],v[56:71]
ds_read_b128 v[44:47],v17 offset:30720
v_mfma_f32_32x32x16_bf16 v[56:71],a[164:167],v[52:55],v[56:71]
ds_read_b128 v[48:51],v16 offset:43008
buffer_load_dwordx4 v1,s[8:11],s63 offen offset:2048 sc1 lds
s_waitcnt lgkmcnt(5)
v_mfma_f32_32x32x16_bf16 v[56:71],a[24:27],v[24:27],v[56:71]
ds_read_b128 v[52:55],v17 offset:43008
s_waitcnt vmcnt(11)
s_mov_b64 exec,1
buffer_store_dword v5,v1,s[8:11],s59 offen sc1
s_mov_b64 exec,-1
s_mov_b32 s59,2147483648
s_barrier
v_mfma_f32_32x32x16_bf16 v[56:71],a[28:31],v[28:31],v[56:71]
ds_read_b128 v[24:27],v16 offset:8192
buffer_load_dwordx4 v1,s[8:11],s63 offen offset:3072 sc1 lds
s_add_u32 s62,s32,1
s_waitcnt lgkmcnt(5)
v_mfma_f32_32x32x16_bf16 v[56:71],a[72:75],v[32:35],v[56:71]
ds_read_b128 v[28:31],v17 offset:8192
s_min_u32 s62,s62,127
s_sub_u32 s60,s62,14
s_lshr_b32 s41,s60,1
s_and_b32 s40,s60,1
v_mfma_f32_32x32x16_bf16 v[56:71],a[76:79],v[36:39],v[56:71]
ds_read_b128 v[32:35],v16 offset:20480
s_cmp_eq_u32 s40,0
s_cselect_b32 s61,14,0
s_add_u32 s41,s41,s61
s_waitcnt lgkmcnt(5)
v_mfma_f32_32x32x16_bf16 v[56:71],a[120:123],v[40:43],v[56:71]
ds_read_b128 v[36:39],v17 offset:20480
s_sub_u32 s61,s60,50
s_cmp_ge_u32 s60,100
s_cselect_b32 s41,s61,s41
s_cselect_b32 s40,1,s40
v_mfma_f32_32x32x16_bf16 v[56:71],a[124:127],v[44:47],v[56:71]
ds_read_b128 v[40:43],v16 offset:32768
s_cmp_lt_u32 s62,14
s_cselect_b32 s41,s62,s41
s_cselect_b32 s40,0,s40
s_waitcnt lgkmcnt(5)
v_mfma_f32_32x32x16_bf16 v[56:71],a[168:171],v[48:51],v[56:71]
ds_read_b128 v[44:47],v17 offset:32768
s_lshl_b32 s42,s40,6
s_add_u32 s42,s42,s41
s_lshl_b32 s42,s42,9
s_add_u32 s42,s42,262144
v_mfma_f32_32x32x16_bf16 v[56:71],a[172:175],v[52:55],v[56:71]
ds_read_b128 v[48:51],v16 offset:45056
s_waitcnt lgkmcnt(5)
v_mfma_f32_32x32x16_bf16 v[56:71],a[32:35],v[24:27],v[56:71]
ds_read_b128 v[52:55],v17 offset:45056
v_mfma_f32_32x32x16_bf16 v[56:71],a[36:39],v[28:31],v[56:71]
ds_read_b128 v[24:27],v16 offset:10240
s_waitcnt lgkmcnt(5)
v_mfma_f32_32x32x16_bf16 v[56:71],a[80:83],v[32:35],v[56:71]
ds_read_b128 v[28:31],v17 offset:10240
v_mfma_f32_32x32x16_bf16 v[56:71],a[84:87],v[36:39],v[56:71]
ds_read_b128 v[32:35],v16 offset:22528
s_waitcnt lgkmcnt(5)
v_mfma_f32_32x32x16_bf16 v[56:71],a[128:131],v[40:43],v[56:71]
ds_read_b128 v[36:39],v17 offset:22528
buffer_load_dword v3,v2,s[8:11],s35 offen sc1
v_mfma_f32_32x32x16_bf16 v[56:71],a[132:135],v[44:47],v[56:71]
ds_read_b128 v[40:43],v16 offset:34816
s_waitcnt lgkmcnt(5)
v_mfma_f32_32x32x16_bf16 v[56:71],a[176:179],v[48:51],v[56:71]
ds_read_b128 v[44:47],v17 offset:34816
v_mfma_f32_32x32x16_bf16 v[56:71],a[180:183],v[52:55],v[56:71]
ds_read_b128 v[48:51],v16 offset:47104
s_waitcnt lgkmcnt(5)
v_mfma_f32_32x32x16_bf16 v[56:71],a[40:43],v[24:27],v[56:71]
ds_read_b128 v[52:55],v17 offset:47104
v_mfma_f32_32x32x16_bf16 v[56:71],a[44:47],v[28:31],v[56:71]
s_waitcnt lgkmcnt(4)
v_mfma_f32_32x32x16_bf16 v[56:71],a[88:91],v[32:35],v[56:71]
v_mfma_f32_32x32x16_bf16 v[56:71],a[92:95],v[36:39],v[56:71]
s_waitcnt lgkmcnt(2)
v_mfma_f32_32x32x16_bf16 v[56:71],a[136:139],v[40:43],v[56:71]
v_mfma_f32_32x32x16_bf16 v[56:71],a[140:143],v[44:47],v[56:71]
s_waitcnt lgkmcnt(0)
v_mfma_f32_32x32x16_bf16 v[56:71],a[184:187],v[48:51],v[56:71]
v_mfma_f32_32x32x16_bf16 v[56:71],a[188:191],v[52:55],v[56:71]
s_cmp_eq_u32 s37,0
s_cbranch_scc0 sec_251
s_mov_b32 s35,s42
buffer_load_dword v3,v2,s[8:11],s35 offen sc1
s_mov_b32 s53,s33
s_mov_b32 s54,s34
s_add_u32 s32,s32,1
s_mov_b32 s33,s40
s_mov_b32 s34,s41
s_mov_b64 s[76:77],s[80:81]
s_nop 2
ep_249:
v_cvt_pk_bf16_f32 v112,v56,v57
v_cvt_pk_bf16_f32 v113,v58,v59
v_cvt_pk_bf16_f32 v114,v60,v61
v_cvt_pk_bf16_f32 v115,v62,v63
v_cvt_pk_bf16_f32 v116,v64,v65
v_cvt_pk_bf16_f32 v117,v66,v67
v_cvt_pk_bf16_f32 v118,v68,v69
v_cvt_pk_bf16_f32 v119,v70,v71
buffer_store_dwordx4 v[112:115],v20,s[8:11],s71 offen sc1
buffer_store_dwordx4 v[116:119],v20,s[8:11],s71 offen offset:128 sc1
s_mov_b32 s59,s82
s_cmp_eq_u32 s37,0
s_cbranch_scc1 WO_NEXT
s_waitcnt vmcnt(2)
v_cmp_eq_u32 vcc,0,v3
s_and_b64 vcc,vcc,s[76:77]
s_cselect_b32 s37,2147483648,0
s_cmp_lt_u32 s32,128
s_cselect_b32 s37,s37,2147483648
s_cmp_eq_u32 s37,0
s_cbranch_scc1 WO_COLD2
s_waitcnt vmcnt(0)
s_mov_b64 exec,1
buffer_store_dword v5,v1,s[8:11],s59 offen sc1
s_mov_b64 exec,-1
s_mov_b32 s59,2147483648
s_cmp_lt_u32 s32,128
s_cbranch_scc1 WO_COLD
s_branch WO_END
sec_251:
s_waitcnt vmcnt(0)
v_cmp_eq_u32 vcc,0,v3
s_and_b64 vcc,vcc,s[76:77]
s_cselect_b32 s37,2147483648,0
s_cmp_lt_u32 s32,128
s_cselect_b32 s37,s37,2147483648
s_cmp_lg_u32 s37,0
s_cbranch_scc1 nr_250
s_sub_u32 s66,49152,s57
s_mul_i32 s60,s34,393216
s_add_u32 s60,s60,s37
s_mul_i32 s61,s68,49152
s_add_u32 s60,s60,s61
s_mul_i32 s61,s46,12288
s_add_u32 s60,s60,s61
s_add_u32 s60,s60,149946368
s_add_u32 s61,s61,s66
s_add_u32 m0,s61,0
s_add_u32 s63,s60,0
buffer_load_dwordx4 v1,s[8:11],s63 offen sc1 lds
v_cvt_pk_bf16_f32 v112,v56,v57
buffer_load_dwordx4 v1,s[8:11],s63 offen offset:1024 sc1 lds
v_cvt_pk_bf16_f32 v113,v58,v59
buffer_load_dwordx4 v1,s[8:11],s63 offen offset:2048 sc1 lds
v_cvt_pk_bf16_f32 v114,v60,v61
buffer_load_dwordx4 v1,s[8:11],s63 offen offset:3072 sc1 lds
v_cvt_pk_bf16_f32 v115,v62,v63
s_add_u32 m0,s61,4096
s_add_u32 s63,s60,4096
buffer_load_dwordx4 v1,s[8:11],s63 offen sc1 lds
v_cvt_pk_bf16_f32 v116,v64,v65
buffer_load_dwordx4 v1,s[8:11],s63 offen offset:1024 sc1 lds
v_cvt_pk_bf16_f32 v117,v66,v67
buffer_load_dwordx4 v1,s[8:11],s63 offen offset:2048 sc1 lds
v_cvt_pk_bf16_f32 v118,v68,v69
buffer_load_dwordx4 v1,s[8:11],s63 offen offset:3072 sc1 lds
v_cvt_pk_bf16_f32 v119,v70,v71
s_add_u32 m0,s61,8192
s_add_u32 s63,s60,8192
buffer_load_dwordx4 v1,s[8:11],s63 offen sc1 lds
buffer_load_dwordx4 v1,s[8:11],s63 offen offset:1024 sc1 lds
buffer_load_dwordx4 v1,s[8:11],s63 offen offset:2048 sc1 lds
buffer_load_dwordx4 v1,s[8:11],s63 offen offset:3072 sc1 lds
s_mov_b32 s35,s42
buffer_load_dword v3,v2,s[8:11],s35 offen sc1
s_mov_b32 s53,s33
s_mov_b32 s54,s34
s_add_u32 s32,s32,1
s_mov_b32 s33,s40
s_mov_b32 s34,s41
s_mov_b64 s[76:77],s[80:81]
buffer_store_dwordx4 v[112:115],v20,s[8:11],s71 offen sc1
buffer_store_dwordx4 v[116:119],v20,s[8:11],s71 offen offset:128 sc1
s_mov_b32 s59,s82
s_branch WO_NEXT
nr_250:
buffer_load_dword v3,v2,s[8:11],s35 offen sc1
s_branch ep_249
WO_END:
s_endpgm
ROLE_R1:
s_lshr_b32 s68,s48,3
s_and_b32 s48,s48,7
v_lshlrev_b32 v1,4,v0
v_mov_b32 v5,1
s_lshl_b32 s56,s48,2
s_add_u32 s56,s56,s46
v_bfe_u32 v6,v0,2,2
v_lshrrev_b32 v7,4,v0
v_add_u32 v7,v6,v7
v_and_b32 v7,3,v7
v_and_b32 v15,3,v0
v_lshlrev_b32 v15,4,v15
v_lshl_add_u32 v15,v7,6,v15
v_lshl_add_u32 v15,v6,8,v15
v_lshrrev_b32 v6,4,v0
v_bfe_u32 v7,v0,2,2
v_and_b32 v8,3,v0
v_add_u32 v9,s48,v7
v_and_b32 v9,3,v9
v_lshlrev_b32 v17,6,v9
v_lshl_add_u32 v17,v8,4,v17
s_lshl_b32 s60,s48,8
s_lshl_b32 s61,s46,13
s_add_u32 s61,s61,s60
v_lshl_add_u32 v16,v6,11,v17
v_add_u32 v16,s61,v16
s_lshl_b32 s61,s46,11
s_add_u32 s61,s61,s60
s_add_u32 s61,s61,32768
v_add_u32 v17,s61,v17
v_lshl_add_u32 v18,v6,2,v17
v_mul_u32_u24 v19,40960,v6
v_and_b32 v9,0xff,v1
v_add_u32 v19,v19,v9
s_mul_i32 s60,s46,768
s_sub_u32 s60,4096,s60
v_add_u32 v19,s60,v19
s_mul_i32 s69,s48,5120
s_lshl_b32 s60,s46,10
s_add_u32 s69,s69,s60
s_add_u32 s69,s69,175112192
s_cmp_eq_u32 s68,0
s_mov_b32 s70,209518592
s_cselect_b32 s70,234749952,s70
s_mov_b32 s71,46080
s_cselect_b32 s71,40960,s71
s_mov_b32 s72,0x3f80
s_mov_b32 s73,0x3f800000
v_lshlrev_b32 v21,5,v8
s_lshl_b32 s60,s46,3
v_add_u32 v20,s60,v21
v_min_u32 v2,39,v0
v_lshlrev_b32 v2,4,v2
s_waitcnt vmcnt(0)
s_barrier
s_cmp_lg_u32 s46,0
s_cbranch_scc1 arr_252
v_mov_b32 v6,1
s_lshl_b32 s3,s49,2
v_mov_b32 v7,s3
s_mov_b64 exec,1
buffer_atomic_add v6,v7,s[12:15],0 offen sc1
s_mov_b64 exec,-1
arr_252:
s_cmp_lg_u32 s49,0
s_cbranch_scc1 vr_253
s_mov_b64 exec,1
s_lshl_b32 s60,s68,5
s_add_u32 s60,s60,s56
s_and_b32 s61,s60,7
s_lshl_b32 s61,s61,14
s_lshl_b32 s60,s60,7
s_add_u32 s60,s60,s61
s_add_u32 s60,s60,11796480
s_add_u32 s61,s60,0x2000
s_mov_b32 s62,-1
s_mov_b32 s63,-1
s_mov_b32 s50,6
vr_253l:
buffer_store_dword v5,v1,s[8:11],s60 offen sc1
buffer_store_dword v5,v1,s[8:11],s61 offen sc1
s_waitcnt vmcnt(0)
s_memtime s[64:65]
s_waitcnt lgkmcnt(0)
buffer_load_dword v3,v1,s[8:11],s60 offen sc1
s_waitcnt vmcnt(0)
s_memtime s[66:67]
s_waitcnt lgkmcnt(0)
s_sub_u32 s66,s66,s64
s_min_u32 s62,s62,s66
s_memtime s[64:65]
s_waitcnt lgkmcnt(0)
buffer_load_dword v3,v1,s[8:11],s61 offen sc1
s_waitcnt vmcnt(0)
s_memtime s[66:67]
s_waitcnt lgkmcnt(0)
s_sub_u32 s66,s66,s64
s_min_u32 s63,s63,s66
s_sub_u32 s50,s50,1
s_cmp_lg_u32 s50,0
s_cbranch_scc1 vr_253l
s_cmp_lt_u32 s63,s62
s_cselect_b32 s60,0x10001,1
v_mov_b32 v3,s60
v_mov_b32 v6,192
buffer_atomic_add v3,v6,s[12:15],0 offen sc1
s_mov_b64 exec,-1
vr_253:
s_lshl_b32 s3,s49,2
v_mov_b32 v7,s3
s_nop 1
ibw_254:
buffer_load_dword v6,v7,s[12:15],0 offen sc1
s_waitcnt vmcnt(0)
v_cmp_ne_u32 vcc,256,v6
s_nop 0
s_cbranch_vccz ok_255
s_sleep 8
s_sub_u32 s47,s47,1
s_cbranch_scc1 ABORT
s_branch ibw_254
ok_255:
s_cmp_lg_u32 s49,0
s_cbranch_scc1 ibok_256
v_and_b32 v7,7,v0
v_lshlrev_b32 v7,2,v7
buffer_load_dword v6,v7,s[12:15],0 offen offset:32 sc1
s_waitcnt vmcnt(0)
v_cmp_ne_u32 vcc,32,v6
s_nop 0
s_cbranch_vccz ibok_256
s_barrier
s_mov_b32 s49,1
s_mov_b32 s3,s2
s_load_dwordx16 s[16:31],s[0:1],0
s_load_dwordx8 s[32:39],s[0:1],64
s_waitcnt lgkmcnt(0)
s_branch DISPATCH
ibok_256:
s_mov_b32 s83,s100
s_mov_b32 s51,s68
s_mov_b32 s52,0
s_mul_i32 s35,s68,40960
s_add_u32 s35,s35,819200
R1_LOOP:
s_mul_i32 s66,s52,491520
s_add_u32 s66,s66,s69
s_mul_i32 s65,s52,s71
s_add_u32 s65,s65,s70
s_lshl_b32 s60,s51,6
s_add_u32 s60,s60,s52
s_mul_i32 s74,s60,40960
s_add_u32 s74,s74,218365952
s_mul_i32 s75,s60,46080
s_add_u32 s75,s75,223608832
s_lshl_b32 s82,s51,6
s_add_u32 s82,s82,s52
s_lshl_b32 s82,s82,9
s_add_u32 s82,s82,393216
s_lshl_b32 s61,s56,2
s_add_u32 s82,s82,s61
s_cmp_lg_u32 s46,0
s_cbranch_scc1 rp_257
rt_258:
buffer_load_dwordx4 v[24:27],v2,s[8:11],s35 offen sc1
s_waitcnt vmcnt(0)
v_min3_u32 v24,v24,v25,v26
v_min_u32 v24,v24,v27
v_cmp_eq_u32 vcc,0,v24
s_nop 0
s_cbranch_vccz ok_259
s_sleep 3
s_sub_u32 s47,s47,1
s_cbranch_scc1 ABORT
s_branch rt_258
ok_259:
rp_257:
s_barrier
s_add_u32 s63,s66,0
buffer_load_dwordx4 v[68:71],v19,s[8:11],s63 offen sc1
s_add_u32 s63,s66,163840
buffer_load_dwordx4 v[72:75],v19,s[8:11],s63 offen sc1
buffer_load_dwordx4 v[76:79],v16,s[8:11],s65 offen sc1
buffer_load_dword v80,v18,s[8:11],s65 offen sc1
s_add_u32 s63,s66,0
buffer_load_dwordx4 v[36:39],v1,s[8:11],s63 offen sc1
s_add_u32 s63,s66,40960
buffer_load_dwordx4 v[40:43],v1,s[8:11],s63 offen sc1
s_add_u32 s63,s66,81920
buffer_load_dwordx4 v[44:47],v1,s[8:11],s63 offen sc1
s_add_u32 s63,s66,122880
buffer_load_dwordx4 v[48:51],v1,s[8:11],s63 offen sc1
s_add_u32 s63,s66,163840
buffer_load_dwordx4 v[52:55],v1,s[8:11],s63 offen sc1
s_add_u32 s63,s66,204800
buffer_load_dwordx4 v[56:59],v1,s[8:11],s63 offen sc1
s_add_u32 s63,s66,245760
buffer_load_dwordx4 v[60:63],v1,s[8:11],s63 offen sc1
s_add_u32 s63,s66,286720
buffer_load_dwordx4 v[64:67],v1,s[8:11],s63 offen sc1
s_waitcnt vmcnt(11)
v_lshlrev_b32 v92,16,v68
v_and_b32 v93,0xffff0000,v68
v_lshlrev_b32 v94,16,v69
v_and_b32 v95,0xffff0000,v69
v_lshlrev_b32 v96,16,v70
v_and_b32 v97,0xffff0000,v70
v_lshlrev_b32 v98,16,v71
v_and_b32 v99,0xffff0000,v71
s_waitcnt vmcnt(10)
v_dot2c_f32_bf16 v92,s72,v72
v_dot2c_f32_bf16 v93,s73,v72
v_dot2c_f32_bf16 v94,s72,v73
v_dot2c_f32_bf16 v95,s73,v73
v_dot2c_f32_bf16 v96,s72,v74
v_dot2c_f32_bf16 v97,s73,v74
v_dot2c_f32_bf16 v98,s72,v75
v_dot2c_f32_bf16 v99,s73,v75
v_permlane32_swap_b32 v92,v96
v_permlane32_swap_b32 v93,v97
v_permlane32_swap_b32 v94,v98
v_permlane32_swap_b32 v95,v99
v_add_f32 v92,v92,v96
v_add_f32 v93,v93,v97
v_add_f32 v94,v94,v98
v_add_f32 v95,v95,v99
s_nop 0
v_permlane16_swap_b32 v92,v94
v_permlane16_swap_b32 v93,v95
v_add_f32 v90,v92,v94
v_add_f32 v91,v93,v95
s_waitcnt vmcnt(8)
v_lshlrev_b32 v100,16,v76
v_and_b32 v101,0xffff0000,v76
v_lshlrev_b32 v102,16,v77
v_and_b32 v103,0xffff0000,v77
v_lshlrev_b32 v104,16,v78
v_and_b32 v105,0xffff0000,v78
v_lshlrev_b32 v106,16,v79
v_and_b32 v107,0xffff0000,v79
v_lshlrev_b32 v108,16,v80
v_and_b32 v109,0xffff0000,v80
s_waitcnt vmcnt(7)
v_lshlrev_b32 v82,16,v36
v_and_b32 v83,0xffff0000,v36
v_lshlrev_b32 v84,16,v37
v_and_b32 v85,0xffff0000,v37
v_lshlrev_b32 v86,16,v38
v_and_b32 v87,0xffff0000,v38
v_lshlrev_b32 v88,16,v39
v_and_b32 v89,0xffff0000,v39
s_waitcnt vmcnt(6)
v_dot2c_f32_bf16 v82,s72,v40
v_dot2c_f32_bf16 v83,s73,v40
v_dot2c_f32_bf16 v84,s72,v41
v_dot2c_f32_bf16 v85,s73,v41
v_dot2c_f32_bf16 v86,s72,v42
v_dot2c_f32_bf16 v87,s73,v42
v_dot2c_f32_bf16 v88,s72,v43
v_dot2c_f32_bf16 v89,s73,v43
s_waitcnt vmcnt(5)
v_dot2c_f32_bf16 v82,s72,v44
v_dot2c_f32_bf16 v83,s73,v44
v_dot2c_f32_bf16 v84,s72,v45
v_dot2c_f32_bf16 v85,s73,v45
v_dot2c_f32_bf16 v86,s72,v46
v_dot2c_f32_bf16 v87,s73,v46
v_dot2c_f32_bf16 v88,s72,v47
v_dot2c_f32_bf16 v89,s73,v47
s_waitcnt vmcnt(4)
v_dot2c_f32_bf16 v82,s72,v48
v_dot2c_f32_bf16 v83,s73,v48
v_dot2c_f32_bf16 v84,s72,v49
v_dot2c_f32_bf16 v85,s73,v49
v_dot2c_f32_bf16 v86,s72,v50
v_dot2c_f32_bf16 v87,s73,v50
v_dot2c_f32_bf16 v88,s72,v51
v_dot2c_f32_bf16 v89,s73,v51
s_waitcnt vmcnt(3)
v_dot2c_f32_bf16 v82,s72,v52
v_dot2c_f32_bf16 v83,s73,v52
v_dot2c_f32_bf16 v84,s72,v53
v_dot2c_f32_bf16 v85,s73,v53
v_dot2c_f32_bf16 v86,s72,v54
v_dot2c_f32_bf16 v87,s73,v54
v_dot2c_f32_bf16 v88,s72,v55
v_dot2c_f32_bf16 v89,s73,v55
s_waitcnt vmcnt(2)
v_dot2c_f32_bf16 v82,s72,v56
v_dot2c_f32_bf16 v83,s73,v56
v_dot2c_f32_bf16 v84,s72,v57
v_dot2c_f32_bf16 v85,s73,v57
v_dot2c_f32_bf16 v86,s72,v58
v_dot2c_f32_bf16 v87,s73,v58
v_dot2c_f32_bf16 v88,s72,v59
v_dot2c_f32_bf16 v89,s73,v59
s_waitcnt vmcnt(1)
v_dot2c_f32_bf16 v82,s72,v60
v_dot2c_f32_bf16 v83,s73,v60
v_dot2c_f32_bf16 v84,s72,v61
v_dot2c_f32_bf16 v85,s73,v61
v_dot2c_f32_bf16 v86,s72,v62
v_dot2c_f32_bf16 v87,s73,v62
v_dot2c_f32_bf16 v88,s72,v63
v_dot2c_f32_bf16 v89,s73,v63
s_waitcnt vmcnt(0)
v_dot2c_f32_bf16 v82,s72,v64
v_dot2c_f32_bf16 v83,s73,v64
v_dot2c_f32_bf16 v84,s72,v65
v_dot2c_f32_bf16 v85,s73,v65
v_dot2c_f32_bf16 v86,s72,v66
v_dot2c_f32_bf16 v87,s73,v66
v_dot2c_f32_bf16 v88,s72,v67
v_dot2c_f32_bf16 v89,s73,v67
v_pk_add_f32 v[82:83],v[82:83],v[100:101]
v_pk_add_f32 v[84:85],v[84:85],v[102:103]
v_pk_add_f32 v[86:87],v[86:87],v[104:105]
v_pk_add_f32 v[88:89],v[88:89],v[106:107]
v_pk_add_f32 v[90:91],v[90:91],v[108:109]
v_cvt_pk_bf16_f32 v112,v82,v83
v_lshlrev_b32 v82,16,v112
v_and_b32 v83,0xffff0000,v112
v_cvt_pk_bf16_f32 v113,v84,v85
v_lshlrev_b32 v84,16,v113
v_and_b32 v85,0xffff0000,v113
v_cvt_pk_bf16_f32 v114,v86,v87
v_lshlrev_b32 v86,16,v114
v_and_b32 v87,0xffff0000,v114
v_cvt_pk_bf16_f32 v115,v88,v89
v_lshlrev_b32 v88,16,v115
v_and_b32 v89,0xffff0000,v115
v_cvt_pk_bf16_f32 v116,v90,v91
v_lshlrev_b32 v90,16,v116
v_and_b32 v91,0xffff0000,v116
v_pk_add_f32 v[32:33],v[82:83],v[84:85]
v_pk_mul_f32 v[30:31],v[82:83],v[82:83]
v_pk_fma_f32 v[30:31],v[84:85],v[84:85],v[30:31]
v_pk_add_f32 v[32:33],v[32:33],v[86:87]
v_pk_fma_f32 v[30:31],v[86:87],v[86:87],v[30:31]
v_pk_add_f32 v[32:33],v[32:33],v[88:89]
v_pk_fma_f32 v[30:31],v[88:89],v[88:89],v[30:31]
v_pk_add_f32 v[32:33],v[32:33],v[90:91]
v_pk_fma_f32 v[30:31],v[90:91],v[90:91],v[30:31]
v_add_f32 v28,v32,v33
v_add_f32 v29,v30,v31
s_nop 0
v_add_f32_dpp v28,v28,v28 row_ror:4 row_mask:0xf bank_mask:0xf
v_add_f32_dpp v29,v29,v29 row_ror:4 row_mask:0xf bank_mask:0xf
s_nop 0
v_add_f32_dpp v28,v28,v28 row_ror:8 row_mask:0xf bank_mask:0xf
v_add_f32_dpp v29,v29,v29 row_ror:8 row_mask:0xf bank_mask:0xf
v_mov_b32 v30,v28
v_mov_b32 v31,v29
s_nop 0
v_permlane32_swap_b32 v28,v30
v_permlane32_swap_b32 v29,v31
v_add_f32 v28,v28,v30
v_add_f32 v29,v29,v31
v_mov_b32 v30,v28
v_mov_b32 v31,v29
s_nop 0
v_permlane16_swap_b32 v28,v30
v_permlane16_swap_b32 v29,v31
v_add_f32 v28,v28,v30
v_add_f32 v29,v29,v31
ds_write_b64 v20,v[28:29]
s_waitcnt lgkmcnt(0)
s_barrier
ds_read_b128 v[136:139],v21
ds_read_b128 v[140:143],v21 offset:16
buffer_store_dwordx4 v[112:115],v16,s[8:11],s74 offen sc1
v_mov_b32 v117,v116
s_nop 1
v_permlane16_swap_b32 v116,v117
s_nop 1
v_permlane32_swap_b32 v116,v118
v_permlane32_swap_b32 v117,v119
s_mov_b64 exec,0xffff
buffer_store_dwordx4 v[116:119],v17,s[8:11],s74 offen sc1
s_mov_b64 exec,-1
s_waitcnt lgkmcnt(0)
v_pk_add_f32 v[136:137],v[136:137],v[138:139]
v_pk_add_f32 v[140:141],v[140:141],v[142:143]
v_pk_add_f32 v[28:29],v[136:137],v[140:141]
v_mul_f32 v28,0x3acccccd,v28
v_mul_f32 v29,0x3acccccd,v29
v_fma_f32 v29,-v28,v28,v29
v_max_f32 v29,0,v29
v_mov_b32 v32,v28
v_mov_b32 v33,v29
v_cvt_pk_bf16_f32 v6,v28,v29
v_lshlrev_b32 v28,16,v6
v_and_b32 v29,0xffff0000,v6
v_add_f32 v29,0x3727c5ac,v29
v_cvt_pk_bf16_f32 v6,v29,v29
v_lshlrev_b32 v29,16,v6
v_sqrt_f32 v29,v29
s_nop 0
v_cvt_pk_bf16_f32 v6,v29,v29
v_lshlrev_b32 v29,16,v6
v_rcp_f32 v29,v29
s_nop 0
v_pk_add_f32 v[82:83],v[82:83],v[28:29] op_sel_hi:[1,0] neg_lo:[0,1] neg_hi:[0,1]
v_pk_add_f32 v[84:85],v[84:85],v[28:29] op_sel_hi:[1,0] neg_lo:[0,1] neg_hi:[0,1]
v_pk_add_f32 v[86:87],v[86:87],v[28:29] op_sel_hi:[1,0] neg_lo:[0,1] neg_hi:[0,1]
v_pk_add_f32 v[88:89],v[88:89],v[28:29] op_sel_hi:[1,0] neg_lo:[0,1] neg_hi:[0,1]
v_pk_add_f32 v[90:91],v[90:91],v[28:29] op_sel_hi:[1,0] neg_lo:[0,1] neg_hi:[0,1]
v_cvt_pk_bf16_f32 v6,v82,v83
v_lshlrev_b32 v82,16,v6
v_and_b32 v83,0xffff0000,v6
v_cvt_pk_bf16_f32 v8,v84,v85
v_lshlrev_b32 v84,16,v8
v_and_b32 v85,0xffff0000,v8
v_cvt_pk_bf16_f32 v6,v86,v87
v_lshlrev_b32 v86,16,v6
v_and_b32 v87,0xffff0000,v6
v_cvt_pk_bf16_f32 v8,v88,v89
v_lshlrev_b32 v88,16,v8
v_and_b32 v89,0xffff0000,v8
v_cvt_pk_bf16_f32 v6,v90,v91
v_lshlrev_b32 v90,16,v6
v_and_b32 v91,0xffff0000,v6
v_pk_mul_f32 v[82:83],v[82:83],v[28:29] op_sel:[0,1] op_sel_hi:[1,1]
v_pk_mul_f32 v[84:85],v[84:85],v[28:29] op_sel:[0,1] op_sel_hi:[1,1]
v_pk_mul_f32 v[86:87],v[86:87],v[28:29] op_sel:[0,1] op_sel_hi:[1,1]
v_pk_mul_f32 v[88:89],v[88:89],v[28:29] op_sel:[0,1] op_sel_hi:[1,1]
v_pk_mul_f32 v[90:91],v[90:91],v[28:29] op_sel:[0,1] op_sel_hi:[1,1]
v_cvt_pk_bf16_f32 v124,v82,v83
v_cvt_pk_bf16_f32 v125,v84,v85
v_cvt_pk_bf16_f32 v126,v86,v87
v_cvt_pk_bf16_f32 v127,v88,v89
v_cvt_pk_bf16_f32 v128,v90,v91
buffer_store_dwordx4 v[124:127],v16,s[8:11],s75 offen sc1
v_mov_b32 v129,v128
s_nop 1
v_permlane16_swap_b32 v128,v129
s_nop 1
v_permlane32_swap_b32 v128,v130
v_permlane32_swap_b32 v129,v131
s_mov_b64 exec,0xffff
buffer_store_dwordx4 v[128:131],v17,s[8:11],s75 offen sc1
s_mov_b64 exec,-1
s_cmp_lg_u32 s46,3
s_cbranch_scc1 zs_260
v_sub_f32 v32,v32,v28
v_mul_f32 v33,v33,v29
v_mul_f32 v32,v32,v29
v_mul_f32 v33,v33,v29
v_cvt_pk_bf16_f32 v6,v32,v33
v_lshlrev_b32 v32,16,v6
v_and_b32 v33,0xffff0000,v6
v_add_f32 v33,0x3727c5ac,v33
v_cvt_pk_bf16_f32 v6,v33,v33
v_lshlrev_b32 v33,16,v6
v_sqrt_f32 v33,v33
s_nop 0
v_cvt_pk_bf16_f32 v6,v33,v33
v_lshlrev_b32 v33,16,v6
v_rcp_f32 v33,v33
s_lshl_b32 s60,s48,5
s_add_u32 s63,s75,s60
s_add_u32 s63,s63,40960
v_lshlrev_b32 v6,3,v0
s_mov_b64 exec,15
buffer_store_dwordx2 v[32:33],v6,s[8:11],s63 offen sc1
s_mov_b64 exec,-1
zs_260:
s_add_u32 s52,s52,1
s_add_u32 s35,s35,640
s_waitcnt vmcnt(0)
s_mov_b64 exec,1
buffer_store_dword v5,v1,s[8:11],s82 offen sc1
s_mov_b64 exec,-1
s_cmp_lt_u32 s52,64
s_cbranch_scc1 R1_LOOP
s_endpgm
ROLE_W1:
v_lshlrev_b32 v1,4,v0
v_mov_b32 v5,1
s_lshl_b32 s56,s48,2
s_add_u32 s56,s56,s46
v_bfe_u32 v6,v0,2,2
v_lshrrev_b32 v7,4,v0
v_add_u32 v7,v6,v7
v_and_b32 v7,3,v7
v_and_b32 v15,3,v0
v_lshlrev_b32 v15,4,v15
v_lshl_add_u32 v15,v7,6,v15
v_lshl_add_u32 v15,v6,8,v15
v_lshrrev_b32 v6,5,v0
v_bfe_u32 v7,v0,4,1
v_lshlrev_b32 v16,10,v7
v_bfe_u32 v7,v0,2,2
v_lshl_add_u32 v16,v7,8,v16
v_add_u32 v6,v6,v7
v_and_b32 v6,3,v6
v_lshl_add_u32 v16,v6,6,v16
v_and_b32 v6,3,v0
v_lshl_add_u32 v16,v6,4,v16
v_add_u32 v18,46080,v16
v_lshrrev_b32 v6,5,v0
v_bfe_u32 v7,v0,4,1
v_lshlrev_b32 v20,10,v7
v_lshl_add_u32 v20,v6,8,v20
v_and_b32 v6,15,v0
v_lshl_add_u32 v20,v6,4,v20
v_lshrrev_b32 v6,5,v0
v_add_u32 v6,2,v6
v_bfe_u32 v7,v0,4,1
v_lshlrev_b32 v17,10,v7
v_bfe_u32 v7,v0,2,2
v_lshl_add_u32 v17,v7,8,v17
v_add_u32 v6,v6,v7
v_and_b32 v6,3,v6
v_lshl_add_u32 v17,v6,6,v17
v_and_b32 v6,3,v0
v_lshl_add_u32 v17,v6,4,v17
v_add_u32 v19,46080,v17
v_lshrrev_b32 v6,5,v0
v_add_u32 v6,2,v6
v_bfe_u32 v7,v0,4,1
v_lshlrev_b32 v21,10,v7
v_lshl_add_u32 v21,v6,8,v21
v_and_b32 v6,15,v0
v_lshl_add_u32 v21,v6,4,v21
v_min_u32 v2,31,v0
v_lshlrev_b32 v2,2,v2
v_mov_b32 v112,0xc0135761
v_mov_b32 v113,0xbdd2d3e8
s_mov_b32 s68,0xbdd2d3e8
v_mov_b32 v116,0
v_mov_b32 v117,0
v_mov_b32 v118,0
v_mov_b32 v119,0
s_lshl_b32 s60,s56,11
s_add_u32 s61,s60,237699072
buffer_store_dwordx4 v[116:119],v1,s[8:11],s61 offen sc1
buffer_store_dwordx4 v[116:119],v1,s[8:11],s61 offen offset:1024 sc1
s_add_u32 s61,s60,238067712
buffer_store_dwordx4 v[116:119],v1,s[8:11],s61 offen sc1
buffer_store_dwordx4 v[116:119],v1,s[8:11],s61 offen offset:1024 sc1
s_waitcnt vmcnt(0)
s_barrier
s_cmp_lg_u32 s46,0
s_cbranch_scc1 arr_261
v_mov_b32 v6,1
s_lshl_b32 s3,s49,2
v_mov_b32 v7,s3
s_mov_b64 exec,1
buffer_atomic_add v6,v7,s[12:15],0 offen sc1
s_mov_b64 exec,-1
arr_261:
s_lshl_b32 s58,s56,6
s_mul_i32 s63,s46,40960
s_mov_b32 s4,s32
s_mov_b32 s5,s33
s_mov_b32 s6,819200
s_mov_b32 s7,0x20000
v_lshrrev_b32 v9,2,v0
s_mov_b32 s64,1280
v_mul_lo_u32 v9,v9,s64
v_and_b32 v10,3,v0
v_lshl_add_u32 v6,v10,4,v9
s_add_u32 m0,s63,0
s_add_u32 s65,s58,0
buffer_load_dwordx4 v6,s[4:7],s65 offen lds
s_add_u32 m0,s63,1024
s_add_u32 s65,s58,20480
buffer_load_dwordx4 v6,s[4:7],s65 offen lds
s_add_u32 m0,s63,2048
s_add_u32 s65,s58,40960
buffer_load_dwordx4 v6,s[4:7],s65 offen lds
s_add_u32 m0,s63,3072
s_add_u32 s65,s58,61440
buffer_load_dwordx4 v6,s[4:7],s65 offen lds
s_add_u32 m0,s63,4096
s_add_u32 s65,s58,81920
buffer_load_dwordx4 v6,s[4:7],s65 offen lds
s_add_u32 m0,s63,5120
s_add_u32 s65,s58,102400
buffer_load_dwordx4 v6,s[4:7],s65 offen lds
s_add_u32 m0,s63,6144
s_add_u32 s65,s58,122880
buffer_load_dwordx4 v6,s[4:7],s65 offen lds
s_add_u32 m0,s63,7168
s_add_u32 s65,s58,143360
buffer_load_dwordx4 v6,s[4:7],s65 offen lds
s_add_u32 m0,s63,8192
s_add_u32 s65,s58,163840
buffer_load_dwordx4 v6,s[4:7],s65 offen lds
s_add_u32 m0,s63,9216
s_add_u32 s65,s58,184320
buffer_load_dwordx4 v6,s[4:7],s65 offen lds
s_add_u32 m0,s63,10240
s_add_u32 s65,s58,204800
buffer_load_dwordx4 v6,s[4:7],s65 offen lds
s_add_u32 m0,s63,11264
s_add_u32 s65,s58,225280
buffer_load_dwordx4 v6,s[4:7],s65 offen lds
s_add_u32 m0,s63,12288
s_add_u32 s65,s58,245760
buffer_load_dwordx4 v6,s[4:7],s65 offen lds
s_add_u32 m0,s63,13312
s_add_u32 s65,s58,266240
buffer_load_dwordx4 v6,s[4:7],s65 offen lds
s_add_u32 m0,s63,14336
s_add_u32 s65,s58,286720
buffer_load_dwordx4 v6,s[4:7],s65 offen lds
s_add_u32 m0,s63,15360
s_add_u32 s65,s58,307200
buffer_load_dwordx4 v6,s[4:7],s65 offen lds
s_add_u32 m0,s63,16384
s_add_u32 s65,s58,327680
buffer_load_dwordx4 v6,s[4:7],s65 offen lds
s_add_u32 m0,s63,17408
s_add_u32 s65,s58,348160
buffer_load_dwordx4 v6,s[4:7],s65 offen lds
s_add_u32 m0,s63,18432
s_add_u32 s65,s58,368640
buffer_load_dwordx4 v6,s[4:7],s65 offen lds
s_add_u32 m0,s63,19456
s_add_u32 s65,s58,389120
buffer_load_dwordx4 v6,s[4:7],s65 offen lds
s_add_u32 m0,s63,20480
s_add_u32 s65,s58,409600
buffer_load_dwordx4 v6,s[4:7],s65 offen lds
s_add_u32 m0,s63,21504
s_add_u32 s65,s58,430080
buffer_load_dwordx4 v6,s[4:7],s65 offen lds
s_add_u32 m0,s63,22528
s_add_u32 s65,s58,450560
buffer_load_dwordx4 v6,s[4:7],s65 offen lds
s_add_u32 m0,s63,23552
s_add_u32 s65,s58,471040
buffer_load_dwordx4 v6,s[4:7],s65 offen lds
s_add_u32 m0,s63,24576
s_add_u32 s65,s58,491520
buffer_load_dwordx4 v6,s[4:7],s65 offen lds
s_add_u32 m0,s63,25600
s_add_u32 s65,s58,512000
buffer_load_dwordx4 v6,s[4:7],s65 offen lds
s_add_u32 m0,s63,26624
s_add_u32 s65,s58,532480
buffer_load_dwordx4 v6,s[4:7],s65 offen lds
s_add_u32 m0,s63,27648
s_add_u32 s65,s58,552960
buffer_load_dwordx4 v6,s[4:7],s65 offen lds
s_add_u32 m0,s63,28672
s_add_u32 s65,s58,573440
buffer_load_dwordx4 v6,s[4:7],s65 offen lds
s_add_u32 m0,s63,29696
s_add_u32 s65,s58,593920
buffer_load_dwordx4 v6,s[4:7],s65 offen lds
s_add_u32 m0,s63,30720
s_add_u32 s65,s58,614400
buffer_load_dwordx4 v6,s[4:7],s65 offen lds
s_add_u32 m0,s63,31744
s_add_u32 s65,s58,634880
buffer_load_dwordx4 v6,s[4:7],s65 offen lds
s_add_u32 m0,s63,32768
s_add_u32 s65,s58,655360
buffer_load_dwordx4 v6,s[4:7],s65 offen lds
s_add_u32 m0,s63,33792
s_add_u32 s65,s58,675840
buffer_load_dwordx4 v6,s[4:7],s65 offen lds
s_add_u32 m0,s63,34816
s_add_u32 s65,s58,696320
buffer_load_dwordx4 v6,s[4:7],s65 offen lds
s_add_u32 m0,s63,35840
s_add_u32 s65,s58,716800
buffer_load_dwordx4 v6,s[4:7],s65 offen lds
s_add_u32 m0,s63,36864
s_add_u32 s65,s58,737280
buffer_load_dwordx4 v6,s[4:7],s65 offen lds
s_add_u32 m0,s63,37888
s_add_u32 s65,s58,757760
buffer_load_dwordx4 v6,s[4:7],s65 offen lds
s_add_u32 m0,s63,38912
s_add_u32 s65,s58,778240
buffer_load_dwordx4 v6,s[4:7],s65 offen lds
s_add_u32 m0,s63,39936
s_add_u32 s65,s58,798720
buffer_load_dwordx4 v6,s[4:7],s65 offen lds
s_waitcnt vmcnt(20)
v_bfe_u32 v9,v0,2,2
v_lshrrev_b32 v10,5,v0
v_lshl_add_u32 v9,v10,2,v9
v_mul_u32_u24 v9,64,v9
v_and_b32 v10,1,v0
v_lshl_add_u32 v9,v10,3,v9
v_bfe_u32 v10,v0,1,1
v_lshl_add_u32 v9,v10,5,v9
v_bfe_u32 v10,v0,4,1
v_lshl_add_u32 v9,v10,4,v9
v_add_u32 v7,s63,v9
ds_read_b64_tr_b16 a[0:1],v7 offset:0
ds_read_b64_tr_b16 a[2:3],v7 offset:1024
ds_read_b64_tr_b16 a[4:5],v7 offset:512
ds_read_b64_tr_b16 a[6:7],v7 offset:1536
ds_read_b64_tr_b16 a[8:9],v7 offset:2048
ds_read_b64_tr_b16 a[10:11],v7 offset:3072
ds_read_b64_tr_b16 a[12:13],v7 offset:2560
ds_read_b64_tr_b16 a[14:15],v7 offset:3584
ds_read_b64_tr_b16 a[16:17],v7 offset:4096
ds_read_b64_tr_b16 a[18:19],v7 offset:5120
ds_read_b64_tr_b16 a[20:21],v7 offset:4608
ds_read_b64_tr_b16 a[22:23],v7 offset:5632
s_waitcnt lgkmcnt(4)
ds_read_b64_tr_b16 a[24:25],v7 offset:6144
ds_read_b64_tr_b16 a[26:27],v7 offset:7168
ds_read_b64_tr_b16 a[28:29],v7 offset:6656
ds_read_b64_tr_b16 a[30:31],v7 offset:7680
ds_read_b64_tr_b16 a[32:33],v7 offset:8192
ds_read_b64_tr_b16 a[34:35],v7 offset:9216
ds_read_b64_tr_b16 a[36:37],v7 offset:8704
ds_read_b64_tr_b16 a[38:39],v7 offset:9728
ds_read_b64_tr_b16 a[40:41],v7 offset:10240
ds_read_b64_tr_b16 a[42:43],v7 offset:11264
ds_read_b64_tr_b16 a[44:45],v7 offset:10752
ds_read_b64_tr_b16 a[46:47],v7 offset:11776
s_waitcnt lgkmcnt(4)
ds_read_b64_tr_b16 a[48:49],v7 offset:12288
ds_read_b64_tr_b16 a[50:51],v7 offset:13312
ds_read_b64_tr_b16 a[52:53],v7 offset:12800
ds_read_b64_tr_b16 a[54:55],v7 offset:13824
ds_read_b64_tr_b16 a[56:57],v7 offset:14336
ds_read_b64_tr_b16 a[58:59],v7 offset:15360
ds_read_b64_tr_b16 a[60:61],v7 offset:14848
ds_read_b64_tr_b16 a[62:63],v7 offset:15872
ds_read_b64_tr_b16 a[64:65],v7 offset:16384
ds_read_b64_tr_b16 a[66:67],v7 offset:17408
ds_read_b64_tr_b16 a[68:69],v7 offset:16896
ds_read_b64_tr_b16 a[70:71],v7 offset:17920
s_waitcnt lgkmcnt(4)
ds_read_b64_tr_b16 a[72:73],v7 offset:18432
ds_read_b64_tr_b16 a[74:75],v7 offset:19456
ds_read_b64_tr_b16 a[76:77],v7 offset:18944
ds_read_b64_tr_b16 a[78:79],v7 offset:19968
s_waitcnt lgkmcnt(0)
s_waitcnt vmcnt(0)
v_bfe_u32 v9,v0,2,2
v_lshrrev_b32 v10,5,v0
v_lshl_add_u32 v9,v10,2,v9
v_mul_u32_u24 v9,64,v9
v_and_b32 v10,1,v0
v_lshl_add_u32 v9,v10,3,v9
v_bfe_u32 v10,v0,1,1
v_lshl_add_u32 v9,v10,5,v9
v_bfe_u32 v10,v0,4,1
v_lshl_add_u32 v9,v10,4,v9
v_add_u32 v7,s63,v9
ds_read_b64_tr_b16 a[80:81],v7 offset:20480
ds_read_b64_tr_b16 a[82:83],v7 offset:21504
ds_read_b64_tr_b16 a[84:85],v7 offset:20992
ds_read_b64_tr_b16 a[86:87],v7 offset:22016
ds_read_b64_tr_b16 a[88:89],v7 offset:22528
ds_read_b64_tr_b16 a[90:91],v7 offset:23552
ds_read_b64_tr_b16 a[92:93],v7 offset:23040
ds_read_b64_tr_b16 a[94:95],v7 offset:24064
ds_read_b64_tr_b16 a[96:97],v7 offset:24576
ds_read_b64_tr_b16 a[98:99],v7 offset:25600
ds_read_b64_tr_b16 a[100:101],v7 offset:25088
ds_read_b64_tr_b16 a[102:103],v7 offset:26112
s_waitcnt lgkmcnt(4)
ds_read_b64_tr_b16 a[104:105],v7 offset:26624
ds_read_b64_tr_b16 a[106:107],v7 offset:27648
ds_read_b64_tr_b16 a[108:109],v7 offset:27136
ds_read_b64_tr_b16 a[110:111],v7 offset:28160
ds_read_b64_tr_b16 a[112:113],v7 offset:28672
ds_read_b64_tr_b16 a[114:115],v7 offset:29696
ds_read_b64_tr_b16 a[116:117],v7 offset:29184
ds_read_b64_tr_b16 a[118:119],v7 offset:30208
ds_read_b64_tr_b16 a[120:121],v7 offset:30720
ds_read_b64_tr_b16 a[122:123],v7 offset:31744
ds_read_b64_tr_b16 a[124:125],v7 offset:31232
ds_read_b64_tr_b16 a[126:127],v7 offset:32256
s_waitcnt lgkmcnt(4)
ds_read_b64_tr_b16 a[128:129],v7 offset:32768
ds_read_b64_tr_b16 a[130:131],v7 offset:33792
ds_read_b64_tr_b16 a[132:133],v7 offset:33280
ds_read_b64_tr_b16 a[134:135],v7 offset:34304
ds_read_b64_tr_b16 a[136:137],v7 offset:34816
ds_read_b64_tr_b16 a[138:139],v7 offset:35840
ds_read_b64_tr_b16 a[140:141],v7 offset:35328
ds_read_b64_tr_b16 a[142:143],v7 offset:36352
ds_read_b64_tr_b16 a[144:145],v7 offset:36864
ds_read_b64_tr_b16 a[146:147],v7 offset:37888
ds_read_b64_tr_b16 a[148:149],v7 offset:37376
ds_read_b64_tr_b16 a[150:151],v7 offset:38400
s_waitcnt lgkmcnt(4)
ds_read_b64_tr_b16 a[152:153],v7 offset:38912
ds_read_b64_tr_b16 a[154:155],v7 offset:39936
ds_read_b64_tr_b16 a[156:157],v7 offset:39424
ds_read_b64_tr_b16 a[158:159],v7 offset:40448
s_waitcnt lgkmcnt(0)
v_mov_b32 v24,0x3f803f80
v_mov_b32 v25,0x3f803f80
v_mov_b32 v26,0x3f803f80
v_mov_b32 v27,0x3f803f80
s_nop 1
v_mfma_f32_32x32x16_bf16 v[144:159],a[0:3],v[24:27],0
v_mfma_f32_32x32x16_bf16 v[144:159],a[4:7],v[24:27],v[144:159]
v_mfma_f32_32x32x16_bf16 v[144:159],a[8:11],v[24:27],v[144:159]
v_mfma_f32_32x32x16_bf16 v[144:159],a[12:15],v[24:27],v[144:159]
v_mfma_f32_32x32x16_bf16 v[144:159],a[16:19],v[24:27],v[144:159]
v_mfma_f32_32x32x16_bf16 v[144:159],a[20:23],v[24:27],v[144:159]
v_mfma_f32_32x32x16_bf16 v[144:159],a[24:27],v[24:27],v[144:159]
v_mfma_f32_32x32x16_bf16 v[144:159],a[28:31],v[24:27],v[144:159]
v_mfma_f32_32x32x16_bf16 v[144:159],a[32:35],v[24:27],v[144:159]
v_mfma_f32_32x32x16_bf16 v[144:159],a[36:39],v[24:27],v[144:159]
v_mfma_f32_32x32x16_bf16 v[144:159],a[40:43],v[24:27],v[144:159]
v_mfma_f32_32x32x16_bf16 v[144:159],a[44:47],v[24:27],v[144:159]
v_mfma_f32_32x32x16_bf16 v[144:159],a[48:51],v[24:27],v[144:159]
v_mfma_f32_32x32x16_bf16 v[144:159],a[52:55],v[24:27],v[144:159]
v_mfma_f32_32x32x16_bf16 v[144:159],a[56:59],v[24:27],v[144:159]
v_mfma_f32_32x32x16_bf16 v[144:159],a[60:63],v[24:27],v[144:159]
v_mfma_f32_32x32x16_bf16 v[144:159],a[64:67],v[24:27],v[144:159]
v_mfma_f32_32x32x16_bf16 v[144:159],a[68:71],v[24:27],v[144:159]
v_mfma_f32_32x32x16_bf16 v[144:159],a[72:75],v[24:27],v[144:159]
v_mfma_f32_32x32x16_bf16 v[144:159],a[76:79],v[24:27],v[144:159]
v_mfma_f32_32x32x16_bf16 v[144:159],a[80:83],v[24:27],v[144:159]
v_mfma_f32_32x32x16_bf16 v[144:159],a[84:87],v[24:27],v[144:159]
v_mfma_f32_32x32x16_bf16 v[144:159],a[88:91],v[24:27],v[144:159]
v_mfma_f32_32x32x16_bf16 v[144:159],a[92:95],v[24:27],v[144:159]
v_mfma_f32_32x32x16_bf16 v[144:159],a[96:99],v[24:27],v[144:159]
v_mfma_f32_32x32x16_bf16 v[144:159],a[100:103],v[24:27],v[144:159]
v_mfma_f32_32x32x16_bf16 v[144:159],a[104:107],v[24:27],v[144:159]
v_mfma_f32_32x32x16_bf16 v[144:159],a[108:111],v[24:27],v[144:159]
v_mfma_f32_32x32x16_bf16 v[144:159],a[112:115],v[24:27],v[144:159]
v_mfma_f32_32x32x16_bf16 v[144:159],a[116:119],v[24:27],v[144:159]
v_mfma_f32_32x32x16_bf16 v[144:159],a[120:123],v[24:27],v[144:159]
v_mfma_f32_32x32x16_bf16 v[144:159],a[124:127],v[24:27],v[144:159]
v_mfma_f32_32x32x16_bf16 v[144:159],a[128:131],v[24:27],v[144:159]
v_mfma_f32_32x32x16_bf16 v[144:159],a[132:135],v[24:27],v[144:159]
v_mfma_f32_32x32x16_bf16 v[144:159],a[136:139],v[24:27],v[144:159]
v_mfma_f32_32x32x16_bf16 v[144:159],a[140:143],v[24:27],v[144:159]
v_mfma_f32_32x32x16_bf16 v[144:159],a[144:147],v[24:27],v[144:159]
v_mfma_f32_32x32x16_bf16 v[144:159],a[148:151],v[24:27],v[144:159]
v_mfma_f32_32x32x16_bf16 v[144:159],a[152:155],v[24:27],v[144:159]
v_mfma_f32_32x32x16_bf16 v[144:159],a[156:159],v[24:27],v[144:159]
v_and_b32 v182,31,v0
v_lshlrev_b32 v182,3,v182
v_add_u32 v182,0xa000,v182
s_barrier
s_lshl_b32 s3,s49,2
v_mov_b32 v7,s3
s_nop 5
ibw_262:
buffer_load_dword v6,v7,s[12:15],0 offen sc1
s_waitcnt vmcnt(0)
v_cmp_ne_u32 vcc,256,v6
s_nop 0
s_cbranch_vccz ok_263
s_sleep 8
s_sub_u32 s47,s47,1
s_cbranch_scc1 ABORT
s_branch ibw_262
ok_263:
s_cmp_lg_u32 s49,0
s_cbranch_scc1 ibok_264
v_and_b32 v7,7,v0
v_lshlrev_b32 v7,2,v7
buffer_load_dword v6,v7,s[12:15],0 offen offset:32 sc1
s_waitcnt vmcnt(0)
v_cmp_ne_u32 vcc,32,v6
s_nop 0
s_cbranch_vccz ibok_264
s_barrier
s_mov_b32 s49,1
s_mov_b32 s3,s2
s_load_dwordx16 s[16:31],s[0:1],0
s_load_dwordx8 s[32:39],s[0:1],64
s_waitcnt lgkmcnt(0)
s_branch DISPATCH
ibok_264:
s_mov_b32 s50,0
s_mov_b32 s32,0
s_mov_b32 s57,0
s_mov_b32 s59,2147483648
s_mov_b32 s82,2147483648
s_mov_b32 s39,2147483648
v_mov_b32 v22,94208
v_lshl_add_u32 v22,v0,2,v22
v_mov_b32 v23,0
ds_write_b32 v22,v23
s_mov_b32 s39,1600000
v_and_b32 v72,15,v0
v_lshlrev_b32 v72,7,v72
v_min_u32 v6,51,v0
v_lshlrev_b32 v6,2,v6
v_add_u32 v2,0,v6
v_add_u32 v7,127360,v6
v_cmp_gt_u32 s[78:79],32,v0
s_nop 1
v_cndmask_b32 v2,v7,v2,s[78:79]
s_mov_b32 s51,0
s_mov_b32 s52,0
s_mul_i32 s62,s51,9
s_and_b32 s63,s52,7
s_add_u32 s62,s62,s63
s_mul_i32 s62,s62,40960
s_add_u32 s62,s62,237371392
s_lshl_b32 s63,s56,11
s_add_u32 s62,s62,s63
buffer_load_dword v73,v72,s[8:11],s62 offen sc1
s_mov_b32 s51,0
s_mov_b32 s52,1
s_mul_i32 s62,s51,9
s_and_b32 s63,s52,7
s_add_u32 s62,s62,s63
s_mul_i32 s62,s62,40960
s_add_u32 s62,s62,237371392
s_lshl_b32 s63,s56,11
s_add_u32 s62,s62,s63
buffer_load_dword v73,v72,s[8:11],s62 offen sc1
s_mov_b32 s51,0
s_mov_b32 s52,2
s_mul_i32 s62,s51,9
s_and_b32 s63,s52,7
s_add_u32 s62,s62,s63
s_mul_i32 s62,s62,40960
s_add_u32 s62,s62,237371392
s_lshl_b32 s63,s56,11
s_add_u32 s62,s62,s63
buffer_load_dword v73,v72,s[8:11],s62 offen sc1
s_mov_b32 s51,0
s_mov_b32 s52,3
s_mul_i32 s62,s51,9
s_and_b32 s63,s52,7
s_add_u32 s62,s62,s63
s_mul_i32 s62,s62,40960
s_add_u32 s62,s62,237371392
s_lshl_b32 s63,s56,11
s_add_u32 s62,s62,s63
buffer_load_dword v73,v72,s[8:11],s62 offen sc1
s_mov_b32 s51,0
s_mov_b32 s52,4
s_mul_i32 s62,s51,9
s_and_b32 s63,s52,7
s_add_u32 s62,s62,s63
s_mul_i32 s62,s62,40960
s_add_u32 s62,s62,237371392
s_lshl_b32 s63,s56,11
s_add_u32 s62,s62,s63
buffer_load_dword v73,v72,s[8:11],s62 offen sc1
s_mov_b32 s51,0
s_mov_b32 s52,5
s_mul_i32 s62,s51,9
s_and_b32 s63,s52,7
s_add_u32 s62,s62,s63
s_mul_i32 s62,s62,40960
s_add_u32 s62,s62,237371392
s_lshl_b32 s63,s56,11
s_add_u32 s62,s62,s63
buffer_load_dword v73,v72,s[8:11],s62 offen sc1
s_mov_b32 s51,0
s_mov_b32 s52,6
s_mul_i32 s62,s51,9
s_and_b32 s63,s52,7
s_add_u32 s62,s62,s63
s_mul_i32 s62,s62,40960
s_add_u32 s62,s62,237371392
s_lshl_b32 s63,s56,11
s_add_u32 s62,s62,s63
buffer_load_dword v73,v72,s[8:11],s62 offen sc1
s_mov_b32 s51,0
s_mov_b32 s52,7
s_mul_i32 s62,s51,9
s_and_b32 s63,s52,7
s_add_u32 s62,s62,s63
s_mul_i32 s62,s62,40960
s_add_u32 s62,s62,237371392
s_lshl_b32 s63,s56,11
s_add_u32 s62,s62,s63
buffer_load_dword v73,v72,s[8:11],s62 offen sc1
s_mov_b32 s51,1
s_mov_b32 s52,0
s_mul_i32 s62,s51,9
s_and_b32 s63,s52,7
s_add_u32 s62,s62,s63
s_mul_i32 s62,s62,40960
s_add_u32 s62,s62,237371392
s_lshl_b32 s63,s56,11
s_add_u32 s62,s62,s63
buffer_load_dword v73,v72,s[8:11],s62 offen sc1
s_mov_b32 s51,1
s_mov_b32 s52,1
s_mul_i32 s62,s51,9
s_and_b32 s63,s52,7
s_add_u32 s62,s62,s63
s_mul_i32 s62,s62,40960
s_add_u32 s62,s62,237371392
s_lshl_b32 s63,s56,11
s_add_u32 s62,s62,s63
buffer_load_dword v73,v72,s[8:11],s62 offen sc1
s_mov_b32 s51,1
s_mov_b32 s52,2
s_mul_i32 s62,s51,9
s_and_b32 s63,s52,7
s_add_u32 s62,s62,s63
s_mul_i32 s62,s62,40960
s_add_u32 s62,s62,237371392
s_lshl_b32 s63,s56,11
s_add_u32 s62,s62,s63
buffer_load_dword v73,v72,s[8:11],s62 offen sc1
s_mov_b32 s51,1
s_mov_b32 s52,3
s_mul_i32 s62,s51,9
s_and_b32 s63,s52,7
s_add_u32 s62,s62,s63
s_mul_i32 s62,s62,40960
s_add_u32 s62,s62,237371392
s_lshl_b32 s63,s56,11
s_add_u32 s62,s62,s63
buffer_load_dword v73,v72,s[8:11],s62 offen sc1
s_mov_b32 s51,1
s_mov_b32 s52,4
s_mul_i32 s62,s51,9
s_and_b32 s63,s52,7
s_add_u32 s62,s62,s63
s_mul_i32 s62,s62,40960
s_add_u32 s62,s62,237371392
s_lshl_b32 s63,s56,11
s_add_u32 s62,s62,s63
buffer_load_dword v73,v72,s[8:11],s62 offen sc1
s_mov_b32 s51,1
s_mov_b32 s52,5
s_mul_i32 s62,s51,9
s_and_b32 s63,s52,7
s_add_u32 s62,s62,s63
s_mul_i32 s62,s62,40960
s_add_u32 s62,s62,237371392
s_lshl_b32 s63,s56,11
s_add_u32 s62,s62,s63
buffer_load_dword v73,v72,s[8:11],s62 offen sc1
s_mov_b32 s51,1
s_mov_b32 s52,6
s_mul_i32 s62,s51,9
s_and_b32 s63,s52,7
s_add_u32 s62,s62,s63
s_mul_i32 s62,s62,40960
s_add_u32 s62,s62,237371392
s_lshl_b32 s63,s56,11
s_add_u32 s62,s62,s63
buffer_load_dword v73,v72,s[8:11],s62 offen sc1
s_mov_b32 s51,1
s_mov_b32 s52,7
s_mul_i32 s62,s51,9
s_and_b32 s63,s52,7
s_add_u32 s62,s62,s63
s_mul_i32 s62,s62,40960
s_add_u32 s62,s62,237371392
s_lshl_b32 s63,s56,11
s_add_u32 s62,s62,s63
buffer_load_dword v73,v72,s[8:11],s62 offen sc1
s_waitcnt vmcnt(0)
s_waitcnt lgkmcnt(0)
s_barrier
s_mov_b32 s83,s100
s_min_u32 s62,s32,127
s_sub_u32 s60,s62,15
s_lshr_b32 s34,s60,1
s_and_b32 s33,s60,1
s_cmp_eq_u32 s33,0
s_cselect_b32 s61,15,0
s_add_u32 s34,s34,s61
s_sub_u32 s61,s60,49
s_cmp_ge_u32 s60,98
s_cselect_b32 s34,s61,s34
s_cselect_b32 s33,1,s33
s_cmp_lt_u32 s62,15
s_cselect_b32 s34,s62,s34
s_cselect_b32 s33,0,s33
s_lshl_b32 s35,s33,6
s_add_u32 s35,s35,s34
s_lshl_b32 s35,s35,9
s_add_u32 s35,s35,393216
s_cmp_lt_u32 s34,7
s_cselect_b64 s[76:77],s[78:79],-1
s_sub_u32 s57,46080,s57
v_swap_b32 v16,v18
v_swap_b32 v17,v19
s_add_u32 s62,s32,1
s_min_u32 s62,s62,127
s_sub_u32 s60,s62,15
s_lshr_b32 s41,s60,1
s_and_b32 s40,s60,1
s_cmp_eq_u32 s40,0
s_cselect_b32 s61,15,0
s_add_u32 s41,s41,s61
s_sub_u32 s61,s60,49
s_cmp_ge_u32 s60,98
s_cselect_b32 s41,s61,s41
s_cselect_b32 s40,1,s40
s_cmp_lt_u32 s62,15
s_cselect_b32 s41,s62,s41
s_cselect_b32 s40,0,s40
s_lshl_b32 s42,s40,6
s_add_u32 s42,s42,s41
s_lshl_b32 s42,s42,9
s_add_u32 s42,s42,393216
s_cmp_lt_u32 s41,7
s_cselect_b64 s[80:81],s[78:79],-1
W1_COLD:
s_mov_b32 s37,0
s_cmp_lg_u32 s46,0
s_cbranch_scc1 wo_265
fb_267:
buffer_load_dword v3,v2,s[8:11],s35 offen sc1
s_waitcnt vmcnt(0)
v_cmp_eq_u32 vcc,0,v3
s_and_b64 vcc,vcc,s[76:77]
s_cbranch_scc0 ok_268
s_sleep 3
s_sub_u32 s47,s47,1
s_cbranch_scc1 ABORT
s_branch fb_267
ok_268:
W1_COLD2:
s_add_u32 s65,s32,1
s_or_b32 s65,s65,s37
v_mov_b32 v23,s65
ds_max_i32 v22,v23
s_branch wd_266
wo_265:
ds_read_b32 v23,v22
s_waitcnt lgkmcnt(0)
v_cmp_ge_u32 vcc,s32,v23
s_nop 0
s_cbranch_vccz wd_266
s_sleep 1
s_sub_u32 s39,s39,1
s_cbranch_scc1 ABORT
s_branch wo_265
wd_266:
s_sub_u32 s66,46080,s57
s_lshl_b32 s60,s33,6
s_add_u32 s60,s60,s34
s_mul_i32 s60,s60,46080
s_add_u32 s60,s60,s37
s_add_u32 s60,s60,223608832
s_mov_b32 s67,s60
s_mul_i32 s61,s46,10240
s_add_u32 s60,s60,s61
s_add_u32 s61,s61,s66
s_add_u32 m0,s61,0
s_add_u32 s63,s60,0
buffer_load_dwordx4 v1,s[8:11],s63 offen sc1 lds
buffer_load_dwordx4 v1,s[8:11],s63 offen offset:1024 sc1 lds
buffer_load_dwordx4 v1,s[8:11],s63 offen offset:2048 sc1 lds
buffer_load_dwordx4 v1,s[8:11],s63 offen offset:3072 sc1 lds
s_add_u32 m0,s61,4096
s_add_u32 s63,s60,4096
buffer_load_dwordx4 v1,s[8:11],s63 offen sc1 lds
buffer_load_dwordx4 v1,s[8:11],s63 offen offset:1024 sc1 lds
s_waitcnt vmcnt(6)
s_mov_b64 exec,1
s_cmp_lg_u32 s49,0
s_cbranch_scc0 ls_269
buffer_store_dword v5,v1,s[8:11],s59 offen sc1
s_branch ls_270
ls_269:
buffer_store_dword v5,v1,s[8:11],s59 offen
ls_270:
s_mov_b64 exec,-1
s_mov_b32 s59,2147483648
buffer_load_dwordx4 v1,s[8:11],s63 offen offset:2048 sc1 lds
buffer_load_dwordx4 v1,s[8:11],s63 offen offset:3072 sc1 lds
s_add_u32 m0,s61,8192
s_add_u32 s63,s60,8192
buffer_load_dwordx4 v1,s[8:11],s63 offen sc1 lds
buffer_load_dwordx4 v1,s[8:11],s63 offen offset:1024 sc1 lds
s_add_u32 m0,s66,40960
s_add_u32 s63,s67,40960
buffer_load_dwordx4 v1,s[8:11],s63 offen sc1 lds
s_mov_b32 s35,s42
buffer_load_dword v3,v2,s[8:11],s35 offen sc1
s_mov_b32 s53,s33
s_mov_b32 s54,s34
s_add_u32 s32,s32,1
s_mov_b32 s33,s40
s_mov_b32 s34,s41
s_mov_b64 s[76:77],s[80:81]
s_sub_u32 s57,46080,s57
v_swap_b32 v16,v18
v_swap_b32 v17,v19
s_mov_b32 s51,s53
s_mov_b32 s52,s54
s_mov_b32 s37,2147483648
s_waitcnt vmcnt(7)
s_branch W1_GO
W1_NEXT:
s_sub_u32 s57,46080,s57
v_swap_b32 v16,v18
v_swap_b32 v17,v19
s_mov_b32 s51,s53
s_mov_b32 s52,s54
s_waitcnt vmcnt(2)
v_cmp_eq_u32 vcc,0,v3
s_and_b64 vcc,vcc,s[76:77]
s_cselect_b32 s37,2147483648,0
s_cmp_lt_u32 s32,128
s_cselect_b32 s37,s37,2147483648
W1_GO:
s_barrier
ds_read_b128 v[24:27],v16 offset:0
ds_read_b128 v[28:31],v17 offset:0
ds_read_b128 v[32:35],v16 offset:10240
ds_read_b128 v[36:39],v17 offset:10240
ds_read_b128 v[40:43],v16 offset:20480
ds_read_b128 v[44:47],v17 offset:20480
ds_read_b128 v[48:51],v16 offset:30720
s_waitcnt lgkmcnt(6)
v_mfma_f32_32x32x16_bf16 v[56:71],a[0:3],v[24:27],0
ds_read_b128 v[52:55],v17 offset:30720
s_lshl_b32 s60,s51,6
s_add_u32 s60,s60,s52
s_mul_i32 s60,s60,40960
s_waitcnt lgkmcnt(6)
v_mfma_f32_32x32x16_bf16 v[56:71],a[4:7],v[28:31],v[56:71]
ds_read_b128 v[24:27],v16 offset:2048
s_lshl_b32 s61,s56,11
s_add_u32 s60,s60,s61
s_add_u32 s60,s60,218365952
s_waitcnt lgkmcnt(5)
v_mfma_f32_32x32x16_bf16 v[56:71],a[40:43],v[32:35],v[56:71]
ds_read_b128 v[28:31],v17 offset:2048
buffer_load_dword v73,v72,s[8:11],s60 offen sc1
s_add_u32 s65,s32,1
s_or_b32 s65,s65,s37
v_mfma_f32_32x32x16_bf16 v[56:71],a[44:47],v[36:39],v[56:71]
ds_read_b128 v[32:35],v16 offset:12288
v_mov_b32 v23,s65
ds_max_i32 v22,v23
s_waitcnt lgkmcnt(6)
v_mfma_f32_32x32x16_bf16 v[56:71],a[80:83],v[40:43],v[56:71]
ds_read_b128 v[36:39],v17 offset:12288
s_sub_u32 s66,46080,s57
s_lshl_b32 s60,s33,6
s_add_u32 s60,s60,s34
s_mul_i32 s60,s60,46080
v_mfma_f32_32x32x16_bf16 v[56:71],a[84:87],v[44:47],v[56:71]
ds_read_b128 v[40:43],v16 offset:22528
s_add_u32 s60,s60,s37
s_add_u32 s60,s60,223608832
s_mov_b32 s67,s60
s_waitcnt lgkmcnt(6)
v_mfma_f32_32x32x16_bf16 v[56:71],a[120:123],v[48:51],v[56:71]
ds_read_b128 v[44:47],v17 offset:22528
s_mul_i32 s61,s46,10240
s_add_u32 s60,s60,s61
s_add_u32 s61,s61,s66
s_add_u32 m0,s61,0
v_mfma_f32_32x32x16_bf16 v[56:71],a[124:127],v[52:55],v[56:71]
ds_read_b128 v[48:51],v16 offset:32768
s_add_u32 s63,s60,0
buffer_load_dwordx4 v1,s[8:11],s63 offen sc1 lds
s_waitcnt lgkmcnt(6)
v_mfma_f32_32x32x16_bf16 v[56:71],a[8:11],v[24:27],v[56:71]
ds_read_b128 v[52:55],v17 offset:32768
s_mul_i32 s71,s51,9
s_and_b32 s72,s52,7
s_add_u32 s71,s71,s72
s_mul_i32 s71,s71,40960
v_mfma_f32_32x32x16_bf16 v[56:71],a[12:15],v[28:31],v[56:71]
ds_read_b128 v[24:27],v16 offset:4096
s_add_u32 s71,s71,237371392
s_lshl_b32 s72,s56,11
s_add_u32 s71,s71,s72
s_waitcnt lgkmcnt(5)
v_mfma_f32_32x32x16_bf16 v[56:71],a[48:51],v[32:35],v[56:71]
ds_read_b128 v[28:31],v17 offset:4096
buffer_load_dword v3,v2,s[8:11],s35 offen sc1
s_lshl_b32 s82,s51,6
v_mfma_f32_32x32x16_bf16 v[56:71],a[52:55],v[36:39],v[56:71]
ds_read_b128 v[32:35],v16 offset:14336
buffer_load_dwordx4 v1,s[8:11],s63 offen offset:1024 sc1 lds
s_add_u32 s82,s82,s52
s_waitcnt lgkmcnt(5)
v_mfma_f32_32x32x16_bf16 v[56:71],a[88:91],v[40:43],v[56:71]
ds_read_b128 v[36:39],v17 offset:14336
s_waitcnt vmcnt(4)
s_mov_b64 exec,1
s_cmp_lg_u32 s49,0
s_cbranch_scc0 ls_271
buffer_store_dword v5,v1,s[8:11],s59 offen sc1
s_branch ls_272
ls_271:
buffer_store_dword v5,v1,s[8:11],s59 offen
ls_272:
s_mov_b64 exec,-1
s_mov_b32 s59,2147483648
v_mfma_f32_32x32x16_bf16 v[56:71],a[92:95],v[44:47],v[56:71]
ds_read_b128 v[40:43],v16 offset:24576
s_lshl_b32 s82,s82,9
s_add_u32 s82,s82,458752
s_lshl_b32 s70,s56,2
s_waitcnt lgkmcnt(5)
v_mfma_f32_32x32x16_bf16 v[56:71],a[128:131],v[48:51],v[56:71]
ds_read_b128 v[44:47],v17 offset:24576
buffer_load_dwordx4 v1,s[8:11],s63 offen offset:2048 sc1 lds
s_add_u32 s82,s82,s70
v_mfma_f32_32x32x16_bf16 v[56:71],a[132:135],v[52:55],v[56:71]
ds_read_b128 v[48:51],v16 offset:34816
s_waitcnt lgkmcnt(5)
v_mfma_f32_32x32x16_bf16 v[56:71],a[16:19],v[24:27],v[56:71]
ds_read_b128 v[52:55],v17 offset:34816
s_barrier
v_mfma_f32_32x32x16_bf16 v[56:71],a[20:23],v[28:31],v[56:71]
ds_read_b128 v[24:27],v16 offset:6144
v_add_u32 v183,s57,v182
buffer_load_dwordx4 v1,s[8:11],s63 offen offset:3072 sc1 lds
s_waitcnt lgkmcnt(5)
v_mfma_f32_32x32x16_bf16 v[56:71],a[56:59],v[32:35],v[56:71]
ds_read_b128 v[28:31],v17 offset:6144
ds_read_b64 v[180:181],v183
s_add_u32 m0,s61,4096
s_add_u32 s63,s60,4096
v_mfma_f32_32x32x16_bf16 v[56:71],a[60:63],v[36:39],v[56:71]
ds_read_b128 v[32:35],v16 offset:16384
s_waitcnt lgkmcnt(6)
v_mfma_f32_32x32x16_bf16 v[56:71],a[96:99],v[40:43],v[56:71]
ds_read_b128 v[36:39],v17 offset:16384
buffer_load_dwordx4 v1,s[8:11],s63 offen sc1 lds
v_mfma_f32_32x32x16_bf16 v[56:71],a[100:103],v[44:47],v[56:71]
ds_read_b128 v[40:43],v16 offset:26624
s_waitcnt lgkmcnt(6)
v_mfma_f32_32x32x16_bf16 v[56:71],a[136:139],v[48:51],v[56:71]
ds_read_b128 v[44:47],v17 offset:26624
v_mfma_f32_32x32x16_bf16 v[56:71],a[140:143],v[52:55],v[56:71]
ds_read_b128 v[48:51],v16 offset:36864
buffer_load_dwordx4 v1,s[8:11],s63 offen offset:1024 sc1 lds
s_waitcnt lgkmcnt(6)
v_mfma_f32_32x32x16_bf16 v[56:71],a[24:27],v[24:27],v[56:71]
ds_read_b128 v[52:55],v17 offset:36864
v_mfma_f32_32x32x16_bf16 v[56:71],a[28:31],v[28:31],v[56:71]
ds_read_b128 v[24:27],v16 offset:8192
s_waitcnt lgkmcnt(5)
v_mfma_f32_32x32x16_bf16 v[56:71],a[64:67],v[32:35],v[56:71]
ds_read_b128 v[28:31],v17 offset:8192
buffer_load_dwordx4 v1,s[8:11],s63 offen offset:2048 sc1 lds
v_mfma_f32_32x32x16_bf16 v[56:71],a[68:71],v[36:39],v[56:71]
ds_read_b128 v[32:35],v16 offset:18432
s_waitcnt lgkmcnt(5)
v_mfma_f32_32x32x16_bf16 v[56:71],a[104:107],v[40:43],v[56:71]
ds_read_b128 v[36:39],v17 offset:18432
v_mfma_f32_32x32x16_bf16 v[56:71],a[108:111],v[44:47],v[56:71]
ds_read_b128 v[40:43],v16 offset:28672
buffer_load_dwordx4 v1,s[8:11],s63 offen offset:3072 sc1 lds
s_add_u32 m0,s61,8192
s_waitcnt lgkmcnt(5)
v_mfma_f32_32x32x16_bf16 v[56:71],a[144:147],v[48:51],v[56:71]
ds_read_b128 v[44:47],v17 offset:28672
s_add_u32 s63,s60,8192
v_mfma_f32_32x32x16_bf16 v[56:71],a[148:151],v[52:55],v[56:71]
ds_read_b128 v[48:51],v16 offset:38912
s_waitcnt lgkmcnt(5)
v_mfma_f32_32x32x16_bf16 v[56:71],a[32:35],v[24:27],v[56:71]
ds_read_b128 v[52:55],v17 offset:38912
buffer_load_dwordx4 v1,s[8:11],s63 offen sc1 lds
v_mfma_f32_32x32x16_bf16 v[56:71],a[36:39],v[28:31],v[56:71]
s_waitcnt lgkmcnt(4)
v_mfma_f32_32x32x16_bf16 v[56:71],a[72:75],v[32:35],v[56:71]
v_mfma_f32_32x32x16_bf16 v[56:71],a[76:79],v[36:39],v[56:71]
buffer_load_dwordx4 v1,s[8:11],s63 offen offset:1024 sc1 lds
s_add_u32 m0,s66,40960
s_add_u32 s63,s67,40960
s_waitcnt lgkmcnt(2)
v_mfma_f32_32x32x16_bf16 v[56:71],a[112:115],v[40:43],v[56:71]
v_mfma_f32_32x32x16_bf16 v[56:71],a[116:119],v[44:47],v[56:71]
s_waitcnt lgkmcnt(0)
v_mfma_f32_32x32x16_bf16 v[56:71],a[152:155],v[48:51],v[56:71]
buffer_load_dwordx4 v1,s[8:11],s63 offen sc1 lds
s_add_u32 s62,s32,1
s_min_u32 s62,s62,127
s_sub_u32 s60,s62,15
s_lshr_b32 s41,s60,1
v_mfma_f32_32x32x16_bf16 v[56:71],a[156:159],v[52:55],v[56:71]
s_and_b32 s40,s60,1
s_cmp_eq_u32 s40,0
s_cselect_b32 s61,15,0
s_add_u32 s41,s41,s61
s_sub_u32 s61,s60,49
s_cmp_ge_u32 s60,98
s_cselect_b32 s41,s61,s41
s_cselect_b32 s40,1,s40
s_cmp_lt_u32 s62,15
s_cselect_b32 s41,s62,s41
s_cselect_b32 s40,0,s40
s_lshl_b32 s42,s40,6
s_add_u32 s42,s42,s41
s_lshl_b32 s42,s42,9
s_add_u32 s42,s42,393216
s_cmp_lt_u32 s41,7
s_cselect_b64 s[80:81],s[78:79],-1
s_cmp_eq_u32 s37,0
s_cbranch_scc0 sec_275
s_mov_b32 s35,s42
buffer_load_dword v3,v2,s[8:11],s35 offen sc1
s_mov_b32 s53,s33
s_mov_b32 s54,s34
s_add_u32 s32,s32,1
s_mov_b32 s33,s40
s_mov_b32 s34,s41
s_mov_b64 s[76:77],s[80:81]
s_nop 2
ep_273:
v_pk_fma_f32 v[56:57],v[144:145],v[180:181],v[56:57] op_sel_hi:[1,0,1] neg_lo:[0,1,0] neg_hi:[0,1,0]
v_pk_fma_f32 v[58:59],v[146:147],v[180:181],v[58:59] op_sel_hi:[1,0,1] neg_lo:[0,1,0] neg_hi:[0,1,0]
v_pk_fma_f32 v[60:61],v[148:149],v[180:181],v[60:61] op_sel_hi:[1,0,1] neg_lo:[0,1,0] neg_hi:[0,1,0]
v_pk_fma_f32 v[62:63],v[150:151],v[180:181],v[62:63] op_sel_hi:[1,0,1] neg_lo:[0,1,0] neg_hi:[0,1,0]
v_pk_fma_f32 v[64:65],v[152:153],v[180:181],v[64:65] op_sel_hi:[1,0,1] neg_lo:[0,1,0] neg_hi:[0,1,0]
v_pk_fma_f32 v[66:67],v[154:155],v[180:181],v[66:67] op_sel_hi:[1,0,1] neg_lo:[0,1,0] neg_hi:[0,1,0]
v_pk_fma_f32 v[68:69],v[156:157],v[180:181],v[68:69] op_sel_hi:[1,0,1] neg_lo:[0,1,0] neg_hi:[0,1,0]
v_pk_fma_f32 v[70:71],v[158:159],v[180:181],v[70:71] op_sel_hi:[1,0,1] neg_lo:[0,1,0] neg_hi:[0,1,0]
v_pk_mul_f32 v[56:57],v[56:57],v[180:181] op_sel:[0,1] op_sel_hi:[1,1]
v_pk_mul_f32 v[58:59],v[58:59],v[180:181] op_sel:[0,1] op_sel_hi:[1,1]
v_pk_mul_f32 v[60:61],v[60:61],v[180:181] op_sel:[0,1] op_sel_hi:[1,1]
v_pk_mul_f32 v[62:63],v[62:63],v[180:181] op_sel:[0,1] op_sel_hi:[1,1]
v_pk_mul_f32 v[64:65],v[64:65],v[180:181] op_sel:[0,1] op_sel_hi:[1,1]
v_pk_mul_f32 v[66:67],v[66:67],v[180:181] op_sel:[0,1] op_sel_hi:[1,1]
v_pk_mul_f32 v[68:69],v[68:69],v[180:181] op_sel:[0,1] op_sel_hi:[1,1]
v_pk_mul_f32 v[70:71],v[70:71],v[180:181] op_sel:[0,1] op_sel_hi:[1,1]
v_cvt_pk_bf16_f32 v140,v56,v57
v_lshlrev_b32 v56,16,v140
v_and_b32 v57,0xffff0000,v140
v_cvt_pk_bf16_f32 v140,v58,v59
v_lshlrev_b32 v58,16,v140
v_and_b32 v59,0xffff0000,v140
v_cvt_pk_bf16_f32 v140,v60,v61
v_lshlrev_b32 v60,16,v140
v_and_b32 v61,0xffff0000,v140
v_cvt_pk_bf16_f32 v140,v62,v63
v_lshlrev_b32 v62,16,v140
v_and_b32 v63,0xffff0000,v140
v_cvt_pk_bf16_f32 v140,v64,v65
v_lshlrev_b32 v64,16,v140
v_and_b32 v65,0xffff0000,v140
v_cvt_pk_bf16_f32 v140,v66,v67
v_lshlrev_b32 v66,16,v140
v_and_b32 v67,0xffff0000,v140
v_cvt_pk_bf16_f32 v140,v68,v69
v_lshlrev_b32 v68,16,v140
v_and_b32 v69,0xffff0000,v140
v_cvt_pk_bf16_f32 v140,v70,v71
v_lshlrev_b32 v70,16,v140
v_and_b32 v71,0xffff0000,v140
v_pk_mul_f32 v[124:125],v[56:57],v[56:57]
v_pk_mul_f32 v[126:127],v[58:59],v[58:59]
v_pk_mul_f32 v[128:129],v[60:61],v[60:61]
v_pk_mul_f32 v[130:131],v[62:63],v[62:63]
v_pk_mul_f32 v[132:133],v[64:65],v[64:65]
v_pk_mul_f32 v[134:135],v[66:67],v[66:67]
v_pk_mul_f32 v[136:137],v[68:69],v[68:69]
v_pk_mul_f32 v[138:139],v[70:71],v[70:71]
v_pk_fma_f32 v[124:125],v[124:125],v[112:113],v[112:113] op_sel:[0,1,0] op_sel_hi:[1,1,0]
v_pk_fma_f32 v[126:127],v[126:127],v[112:113],v[112:113] op_sel:[0,1,0] op_sel_hi:[1,1,0]
v_pk_fma_f32 v[128:129],v[128:129],v[112:113],v[112:113] op_sel:[0,1,0] op_sel_hi:[1,1,0]
v_pk_fma_f32 v[130:131],v[130:131],v[112:113],v[112:113] op_sel:[0,1,0] op_sel_hi:[1,1,0]
v_pk_fma_f32 v[132:133],v[132:133],v[112:113],v[112:113] op_sel:[0,1,0] op_sel_hi:[1,1,0]
v_pk_fma_f32 v[134:135],v[134:135],v[112:113],v[112:113] op_sel:[0,1,0] op_sel_hi:[1,1,0]
v_pk_fma_f32 v[136:137],v[136:137],v[112:113],v[112:113] op_sel:[0,1,0] op_sel_hi:[1,1,0]
v_pk_fma_f32 v[138:139],v[138:139],v[112:113],v[112:113] op_sel:[0,1,0] op_sel_hi:[1,1,0]
v_pk_mul_f32 v[124:125],v[124:125],v[56:57]
v_pk_mul_f32 v[126:127],v[126:127],v[58:59]
v_pk_mul_f32 v[128:129],v[128:129],v[60:61]
v_pk_mul_f32 v[130:131],v[130:131],v[62:63]
v_pk_mul_f32 v[132:133],v[132:133],v[64:65]
v_pk_mul_f32 v[134:135],v[134:135],v[66:67]
v_pk_mul_f32 v[136:137],v[136:137],v[68:69]
v_pk_mul_f32 v[138:139],v[138:139],v[70:71]
v_exp_f32 v124,v124
v_exp_f32 v125,v125
v_exp_f32 v126,v126
v_exp_f32 v127,v127
v_exp_f32 v128,v128
v_exp_f32 v129,v129
v_exp_f32 v130,v130
v_exp_f32 v131,v131
v_exp_f32 v132,v132
v_exp_f32 v133,v133
v_exp_f32 v134,v134
v_exp_f32 v135,v135
v_exp_f32 v136,v136
v_exp_f32 v137,v137
v_exp_f32 v138,v138
v_exp_f32 v139,v139
v_pk_add_f32 v[124:125],v[124:125],1.0 op_sel_hi:[1,0]
v_pk_add_f32 v[126:127],v[126:127],1.0 op_sel_hi:[1,0]
v_pk_add_f32 v[128:129],v[128:129],1.0 op_sel_hi:[1,0]
v_pk_add_f32 v[130:131],v[130:131],1.0 op_sel_hi:[1,0]
v_pk_add_f32 v[132:133],v[132:133],1.0 op_sel_hi:[1,0]
v_pk_add_f32 v[134:135],v[134:135],1.0 op_sel_hi:[1,0]
v_pk_add_f32 v[136:137],v[136:137],1.0 op_sel_hi:[1,0]
v_pk_add_f32 v[138:139],v[138:139],1.0 op_sel_hi:[1,0]
v_rcp_f32 v124,v124
v_rcp_f32 v125,v125
v_rcp_f32 v126,v126
v_rcp_f32 v127,v127
v_rcp_f32 v128,v128
v_rcp_f32 v129,v129
v_rcp_f32 v130,v130
v_rcp_f32 v131,v131
v_rcp_f32 v132,v132
v_rcp_f32 v133,v133
v_rcp_f32 v134,v134
v_rcp_f32 v135,v135
v_rcp_f32 v136,v136
v_rcp_f32 v137,v137
v_rcp_f32 v138,v138
v_rcp_f32 v139,v139
v_pk_mul_f32 v[56:57],v[56:57],v[124:125]
v_pk_mul_f32 v[58:59],v[58:59],v[126:127]
v_pk_mul_f32 v[60:61],v[60:61],v[128:129]
v_pk_mul_f32 v[62:63],v[62:63],v[130:131]
v_pk_mul_f32 v[64:65],v[64:65],v[132:133]
v_pk_mul_f32 v[66:67],v[66:67],v[134:135]
v_pk_mul_f32 v[68:69],v[68:69],v[136:137]
v_pk_mul_f32 v[70:71],v[70:71],v[138:139]
v_cvt_pk_bf16_f32 v116,v56,v57
v_cvt_pk_bf16_f32 v117,v58,v59
v_cvt_pk_bf16_f32 v118,v60,v61
v_cvt_pk_bf16_f32 v119,v62,v63
v_cvt_pk_bf16_f32 v120,v64,v65
v_cvt_pk_bf16_f32 v121,v66,v67
v_cvt_pk_bf16_f32 v122,v68,v69
v_cvt_pk_bf16_f32 v123,v70,v71
s_cmp_lg_u32 s49,0
s_cbranch_scc0 ls_276
buffer_store_dwordx4 v[116:119],v20,s[8:11],s71 offen sc1
buffer_store_dwordx4 v[120:123],v21,s[8:11],s71 offen sc1
s_branch ls_277
ls_276:
buffer_store_dwordx4 v[116:119],v20,s[8:11],s71 offen
buffer_store_dwordx4 v[120:123],v21,s[8:11],s71 offen
ls_277:
s_mov_b32 s59,s82
s_cmp_eq_u32 s37,0
s_cbranch_scc1 W1_NEXT
s_waitcnt vmcnt(2)
v_cmp_eq_u32 vcc,0,v3
s_and_b64 vcc,vcc,s[76:77]
s_cselect_b32 s37,2147483648,0
s_cmp_lt_u32 s32,128
s_cselect_b32 s37,s37,2147483648
s_cmp_eq_u32 s37,0
s_cbranch_scc1 W1_COLD2
s_waitcnt vmcnt(0)
s_mov_b64 exec,1
s_cmp_lg_u32 s49,0
s_cbranch_scc0 ls_278
buffer_store_dword v5,v1,s[8:11],s59 offen sc1
s_branch ls_279
ls_278:
buffer_store_dword v5,v1,s[8:11],s59 offen
ls_279:
s_mov_b64 exec,-1
s_mov_b32 s59,2147483648
s_cmp_lt_u32 s32,128
s_cbranch_scc1 W1_COLD
s_branch W1_END
sec_275:
s_waitcnt vmcnt(11)
v_cmp_eq_u32 vcc,0,v3
s_and_b64 vcc,vcc,s[76:77]
s_cselect_b32 s37,2147483648,0
s_cmp_lt_u32 s32,128
s_cselect_b32 s37,s37,2147483648
s_cmp_lg_u32 s37,0
s_cbranch_scc1 nr_274
s_add_u32 s65,s32,1
s_or_b32 s65,s65,s37
v_mov_b32 v23,s65
ds_max_i32 v22,v23
s_sub_u32 s66,46080,s57
s_lshl_b32 s60,s33,6
s_add_u32 s60,s60,s34
s_mul_i32 s60,s60,46080
s_add_u32 s60,s60,s37
s_add_u32 s60,s60,223608832
s_mov_b32 s67,s60
s_mul_i32 s61,s46,10240
s_add_u32 s60,s60,s61
s_add_u32 s61,s61,s66
s_add_u32 m0,s61,0
s_add_u32 s63,s60,0
buffer_load_dwordx4 v1,s[8:11],s63 offen sc1 lds
v_pk_fma_f32 v[56:57],v[144:145],v[180:181],v[56:57] op_sel_hi:[1,0,1] neg_lo:[0,1,0] neg_hi:[0,1,0]
v_pk_fma_f32 v[58:59],v[146:147],v[180:181],v[58:59] op_sel_hi:[1,0,1] neg_lo:[0,1,0] neg_hi:[0,1,0]
v_pk_fma_f32 v[60:61],v[148:149],v[180:181],v[60:61] op_sel_hi:[1,0,1] neg_lo:[0,1,0] neg_hi:[0,1,0]
v_pk_fma_f32 v[62:63],v[150:151],v[180:181],v[62:63] op_sel_hi:[1,0,1] neg_lo:[0,1,0] neg_hi:[0,1,0]
v_pk_fma_f32 v[64:65],v[152:153],v[180:181],v[64:65] op_sel_hi:[1,0,1] neg_lo:[0,1,0] neg_hi:[0,1,0]
v_pk_fma_f32 v[66:67],v[154:155],v[180:181],v[66:67] op_sel_hi:[1,0,1] neg_lo:[0,1,0] neg_hi:[0,1,0]
v_pk_fma_f32 v[68:69],v[156:157],v[180:181],v[68:69] op_sel_hi:[1,0,1] neg_lo:[0,1,0] neg_hi:[0,1,0]
v_pk_fma_f32 v[70:71],v[158:159],v[180:181],v[70:71] op_sel_hi:[1,0,1] neg_lo:[0,1,0] neg_hi:[0,1,0]
v_pk_mul_f32 v[56:57],v[56:57],v[180:181] op_sel:[0,1] op_sel_hi:[1,1]
buffer_load_dwordx4 v1,s[8:11],s63 offen offset:1024 sc1 lds
v_pk_mul_f32 v[58:59],v[58:59],v[180:181] op_sel:[0,1] op_sel_hi:[1,1]
v_pk_mul_f32 v[60:61],v[60:61],v[180:181] op_sel:[0,1] op_sel_hi:[1,1]
v_pk_mul_f32 v[62:63],v[62:63],v[180:181] op_sel:[0,1] op_sel_hi:[1,1]
v_pk_mul_f32 v[64:65],v[64:65],v[180:181] op_sel:[0,1] op_sel_hi:[1,1]
v_pk_mul_f32 v[66:67],v[66:67],v[180:181] op_sel:[0,1] op_sel_hi:[1,1]
v_pk_mul_f32 v[68:69],v[68:69],v[180:181] op_sel:[0,1] op_sel_hi:[1,1]
v_pk_mul_f32 v[70:71],v[70:71],v[180:181] op_sel:[0,1] op_sel_hi:[1,1]
v_cvt_pk_bf16_f32 v140,v56,v57
v_lshlrev_b32 v56,16,v140
buffer_load_dwordx4 v1,s[8:11],s63 offen offset:2048 sc1 lds
v_and_b32 v57,0xffff0000,v140
v_cvt_pk_bf16_f32 v140,v58,v59
v_lshlrev_b32 v58,16,v140
v_and_b32 v59,0xffff0000,v140
v_cvt_pk_bf16_f32 v140,v60,v61
v_lshlrev_b32 v60,16,v140
v_and_b32 v61,0xffff0000,v140
v_cvt_pk_bf16_f32 v140,v62,v63
v_lshlrev_b32 v62,16,v140
buffer_load_dwordx4 v1,s[8:11],s63 offen offset:3072 sc1 lds
v_and_b32 v63,0xffff0000,v140
v_cvt_pk_bf16_f32 v140,v64,v65
v_lshlrev_b32 v64,16,v140
v_and_b32 v65,0xffff0000,v140
v_cvt_pk_bf16_f32 v140,v66,v67
v_lshlrev_b32 v66,16,v140
v_and_b32 v67,0xffff0000,v140
v_cvt_pk_bf16_f32 v140,v68,v69
v_lshlrev_b32 v68,16,v140
s_add_u32 m0,s61,4096
s_add_u32 s63,s60,4096
buffer_load_dwordx4 v1,s[8:11],s63 offen sc1 lds
v_and_b32 v69,0xffff0000,v140
v_cvt_pk_bf16_f32 v140,v70,v71
v_lshlrev_b32 v70,16,v140
v_and_b32 v71,0xffff0000,v140
v_pk_mul_f32 v[124:125],v[56:57],v[56:57]
v_pk_mul_f32 v[126:127],v[58:59],v[58:59]
v_pk_mul_f32 v[128:129],v[60:61],v[60:61]
v_pk_mul_f32 v[130:131],v[62:63],v[62:63]
v_pk_mul_f32 v[132:133],v[64:65],v[64:65]
buffer_load_dwordx4 v1,s[8:11],s63 offen offset:1024 sc1 lds
v_pk_mul_f32 v[134:135],v[66:67],v[66:67]
v_pk_mul_f32 v[136:137],v[68:69],v[68:69]
v_pk_mul_f32 v[138:139],v[70:71],v[70:71]
v_pk_fma_f32 v[124:125],v[124:125],v[112:113],v[112:113] op_sel:[0,1,0] op_sel_hi:[1,1,0]
v_pk_fma_f32 v[126:127],v[126:127],v[112:113],v[112:113] op_sel:[0,1,0] op_sel_hi:[1,1,0]
v_pk_fma_f32 v[128:129],v[128:129],v[112:113],v[112:113] op_sel:[0,1,0] op_sel_hi:[1,1,0]
v_pk_fma_f32 v[130:131],v[130:131],v[112:113],v[112:113] op_sel:[0,1,0] op_sel_hi:[1,1,0]
v_pk_fma_f32 v[132:133],v[132:133],v[112:113],v[112:113] op_sel:[0,1,0] op_sel_hi:[1,1,0]
v_pk_fma_f32 v[134:135],v[134:135],v[112:113],v[112:113] op_sel:[0,1,0] op_sel_hi:[1,1,0]
buffer_load_dwordx4 v1,s[8:11],s63 offen offset:2048 sc1 lds
v_pk_fma_f32 v[136:137],v[136:137],v[112:113],v[112:113] op_sel:[0,1,0] op_sel_hi:[1,1,0]
v_pk_fma_f32 v[138:139],v[138:139],v[112:113],v[112:113] op_sel:[0,1,0] op_sel_hi:[1,1,0]
v_pk_mul_f32 v[124:125],v[124:125],v[56:57]
v_pk_mul_f32 v[126:127],v[126:127],v[58:59]
v_pk_mul_f32 v[128:129],v[128:129],v[60:61]
v_pk_mul_f32 v[130:131],v[130:131],v[62:63]
v_pk_mul_f32 v[132:133],v[132:133],v[64:65]
v_pk_mul_f32 v[134:135],v[134:135],v[66:67]
v_pk_mul_f32 v[136:137],v[136:137],v[68:69]
buffer_load_dwordx4 v1,s[8:11],s63 offen offset:3072 sc1 lds
v_pk_mul_f32 v[138:139],v[138:139],v[70:71]
v_exp_f32 v124,v124
v_exp_f32 v125,v125
v_exp_f32 v126,v126
v_exp_f32 v127,v127
v_exp_f32 v128,v128
v_exp_f32 v129,v129
v_exp_f32 v130,v130
v_exp_f32 v131,v131
s_add_u32 m0,s61,8192
s_add_u32 s63,s60,8192
buffer_load_dwordx4 v1,s[8:11],s63 offen sc1 lds
v_exp_f32 v132,v132
v_exp_f32 v133,v133
v_exp_f32 v134,v134
v_exp_f32 v135,v135
v_exp_f32 v136,v136
v_exp_f32 v137,v137
v_exp_f32 v138,v138
v_exp_f32 v139,v139
v_pk_add_f32 v[124:125],v[124:125],1.0 op_sel_hi:[1,0]
buffer_load_dwordx4 v1,s[8:11],s63 offen offset:1024 sc1 lds
v_pk_add_f32 v[126:127],v[126:127],1.0 op_sel_hi:[1,0]
v_pk_add_f32 v[128:129],v[128:129],1.0 op_sel_hi:[1,0]
v_pk_add_f32 v[130:131],v[130:131],1.0 op_sel_hi:[1,0]
v_pk_add_f32 v[132:133],v[132:133],1.0 op_sel_hi:[1,0]
v_pk_add_f32 v[134:135],v[134:135],1.0 op_sel_hi:[1,0]
v_pk_add_f32 v[136:137],v[136:137],1.0 op_sel_hi:[1,0]
v_pk_add_f32 v[138:139],v[138:139],1.0 op_sel_hi:[1,0]
v_rcp_f32 v124,v124
v_rcp_f32 v125,v125
s_add_u32 m0,s66,40960
s_add_u32 s63,s67,40960
buffer_load_dwordx4 v1,s[8:11],s63 offen sc1 lds
v_rcp_f32 v126,v126
v_rcp_f32 v127,v127
v_rcp_f32 v128,v128
v_rcp_f32 v129,v129
v_rcp_f32 v130,v130
v_rcp_f32 v131,v131
v_rcp_f32 v132,v132
v_rcp_f32 v133,v133
v_rcp_f32 v134,v134
s_mov_b32 s35,s42
buffer_load_dword v3,v2,s[8:11],s35 offen sc1
s_mov_b32 s53,s33
s_mov_b32 s54,s34
s_add_u32 s32,s32,1
s_mov_b32 s33,s40
s_mov_b32 s34,s41
s_mov_b64 s[76:77],s[80:81]
v_rcp_f32 v135,v135
v_rcp_f32 v136,v136
v_rcp_f32 v137,v137
v_rcp_f32 v138,v138
v_rcp_f32 v139,v139
v_pk_mul_f32 v[56:57],v[56:57],v[124:125]
v_pk_mul_f32 v[58:59],v[58:59],v[126:127]
v_pk_mul_f32 v[60:61],v[60:61],v[128:129]
v_pk_mul_f32 v[62:63],v[62:63],v[130:131]
v_pk_mul_f32 v[64:65],v[64:65],v[132:133]
v_pk_mul_f32 v[66:67],v[66:67],v[134:135]
v_pk_mul_f32 v[68:69],v[68:69],v[136:137]
v_pk_mul_f32 v[70:71],v[70:71],v[138:139]
v_cvt_pk_bf16_f32 v116,v56,v57
v_cvt_pk_bf16_f32 v117,v58,v59
v_cvt_pk_bf16_f32 v118,v60,v61
v_cvt_pk_bf16_f32 v119,v62,v63
v_cvt_pk_bf16_f32 v120,v64,v65
v_cvt_pk_bf16_f32 v121,v66,v67
v_cvt_pk_bf16_f32 v122,v68,v69
v_cvt_pk_bf16_f32 v123,v70,v71
s_cmp_lg_u32 s49,0
s_cbranch_scc0 ls_280
buffer_store_dwordx4 v[116:119],v20,s[8:11],s71 offen sc1
buffer_store_dwordx4 v[120:123],v21,s[8:11],s71 offen sc1
s_branch ls_281
ls_280:
buffer_store_dwordx4 v[116:119],v20,s[8:11],s71 offen
buffer_store_dwordx4 v[120:123],v21,s[8:11],s71 offen
ls_281:
s_mov_b32 s59,s82
s_branch W1_NEXT
nr_274:
buffer_load_dword v3,v2,s[8:11],s35 offen sc1
s_branch ep_273
W1_END:
s_endpgm
ROLE_W2:
v_lshlrev_b32 v1,4,v0
v_mov_b32 v5,1
s_lshl_b32 s56,s48,2
s_add_u32 s56,s56,s46
v_bfe_u32 v6,v0,2,2
v_lshrrev_b32 v7,4,v0
v_add_u32 v7,v6,v7
v_and_b32 v7,3,v7
v_and_b32 v15,3,v0
v_lshlrev_b32 v15,4,v15
v_lshl_add_u32 v15,v7,6,v15
v_lshl_add_u32 v15,v6,8,v15
v_lshrrev_b32 v6,5,v0
v_bfe_u32 v7,v0,4,1
v_lshlrev_b32 v16,10,v7
v_lshl_add_u32 v16,v6,8,v16
v_and_b32 v6,15,v0
v_lshl_add_u32 v16,v6,4,v16
v_add_u32 v18,40960,v16
v_lshrrev_b32 v6,5,v0
v_bfe_u32 v7,v0,4,1
v_lshlrev_b32 v20,10,v7
v_lshl_add_u32 v20,v6,8,v20
v_and_b32 v6,15,v0
v_lshl_add_u32 v20,v6,4,v20
v_lshrrev_b32 v6,5,v0
v_add_u32 v6,2,v6
v_bfe_u32 v7,v0,4,1
v_lshlrev_b32 v17,10,v7
v_lshl_add_u32 v17,v6,8,v17
v_and_b32 v6,15,v0
v_lshl_add_u32 v17,v6,4,v17
v_add_u32 v19,40960,v17
v_lshrrev_b32 v6,5,v0
v_add_u32 v6,2,v6
v_bfe_u32 v7,v0,4,1
v_lshlrev_b32 v21,10,v7
v_lshl_add_u32 v21,v6,8,v21
v_and_b32 v6,15,v0
v_lshl_add_u32 v21,v6,4,v21
v_min_u32 v2,19,v0
v_lshlrev_b32 v2,2,v2
s_lshr_b32 s60,s46,1
s_add_u32 s60,s60,1
s_sub_u32 s61,32,s60
s_add_u32 s60,s60,32
s_bitcmp1_b32 s46,0
s_cselect_b32 s60,s60,s61
v_and_b32 v6,15,v0
v_add_u32 v6,s60,v6
v_lshrrev_b32 v7,5,v6
v_mul_u32_u24 v112,40960,v7
v_bfe_u32 v7,v6,4,1
v_lshl_add_u32 v112,v7,10,v112
v_and_b32 v7,15,v6
v_lshl_add_u32 v112,v7,4,v112
v_lshrrev_b32 v7,4,v0
v_lshl_add_u32 v112,v7,8,v112
v_and_b32 v6,15,v0
v_add_u32 v6,s60,v6
v_add_u32 v6,16,v6
v_lshrrev_b32 v7,5,v6
v_mul_u32_u24 v113,40960,v7
v_bfe_u32 v7,v6,4,1
v_lshl_add_u32 v113,v7,10,v113
v_and_b32 v7,15,v6
v_lshl_add_u32 v113,v7,4,v113
v_lshrrev_b32 v7,4,v0
v_lshl_add_u32 v113,v7,8,v113
v_lshrrev_b32 v6,5,v0
v_and_b32 v7,15,v0
v_lshlrev_b32 v114,3,v7
v_lshl_add_u32 v114,v6,7,v114
v_and_b32 v114,31,v0
v_lshlrev_b32 v114,3,v114
v_lshrrev_b32 v6,5,v0
v_bfe_u32 v7,v0,4,1
v_lshlrev_b32 v116,10,v7
v_bfe_u32 v7,v0,2,2
v_lshl_add_u32 v116,v7,8,v116
v_add_u32 v6,v6,v7
v_and_b32 v6,3,v6
v_lshl_add_u32 v116,v6,6,v116
v_and_b32 v6,3,v0
v_lshl_add_u32 v116,v6,4,v116
v_lshrrev_b32 v6,5,v0
v_add_u32 v6,2,v6
v_bfe_u32 v7,v0,4,1
v_lshlrev_b32 v117,10,v7
v_bfe_u32 v7,v0,2,2
v_lshl_add_u32 v117,v7,8,v117
v_add_u32 v6,v6,v7
v_and_b32 v6,3,v6
v_lshl_add_u32 v117,v6,6,v117
v_and_b32 v6,3,v0
v_lshl_add_u32 v117,v6,4,v117
v_subrev_u32 v6,40960,v112
v_cmp_gt_u32 vcc,40960,v6
s_nop 1
v_cndmask_b32 v78,0,1,vcc
v_xor_b32 v76,1,v78
v_and_b32 v74,2047,v112
v_subrev_u32 v6,40960,v113
v_cmp_gt_u32 vcc,40960,v6
s_nop 1
v_cndmask_b32 v79,0,1,vcc
v_xor_b32 v77,1,v79
v_and_b32 v75,2047,v113
s_and_b32 s68,s46,1
s_lshl_b32 s68,s68,1
s_sub_u32 s68,s68,1
s_waitcnt vmcnt(0)
s_barrier
s_cmp_lg_u32 s46,0
s_cbranch_scc1 arr_282
v_mov_b32 v6,1
s_lshl_b32 s3,s49,2
v_mov_b32 v7,s3
s_mov_b64 exec,1
buffer_atomic_add v6,v7,s[12:15],0 offen sc1
s_mov_b64 exec,-1
arr_282:
s_lshl_b32 s58,s56,6
s_mul_i32 s63,s46,40960
s_mov_b32 s4,s34
s_mov_b32 s5,s35
s_mov_b32 s6,819200
s_mov_b32 s7,0x20000
v_lshrrev_b32 v9,2,v0
s_mov_b32 s64,1280
v_mul_lo_u32 v9,v9,s64
v_and_b32 v10,3,v0
v_lshl_add_u32 v6,v10,4,v9
s_add_u32 m0,s63,0
s_add_u32 s65,s58,0
buffer_load_dwordx4 v6,s[4:7],s65 offen lds
s_add_u32 m0,s63,1024
s_add_u32 s65,s58,20480
buffer_load_dwordx4 v6,s[4:7],s65 offen lds
s_add_u32 m0,s63,2048
s_add_u32 s65,s58,40960
buffer_load_dwordx4 v6,s[4:7],s65 offen lds
s_add_u32 m0,s63,3072
s_add_u32 s65,s58,61440
buffer_load_dwordx4 v6,s[4:7],s65 offen lds
s_add_u32 m0,s63,4096
s_add_u32 s65,s58,81920
buffer_load_dwordx4 v6,s[4:7],s65 offen lds
s_add_u32 m0,s63,5120
s_add_u32 s65,s58,102400
buffer_load_dwordx4 v6,s[4:7],s65 offen lds
s_add_u32 m0,s63,6144
s_add_u32 s65,s58,122880
buffer_load_dwordx4 v6,s[4:7],s65 offen lds
s_add_u32 m0,s63,7168
s_add_u32 s65,s58,143360
buffer_load_dwordx4 v6,s[4:7],s65 offen lds
s_add_u32 m0,s63,8192
s_add_u32 s65,s58,163840
buffer_load_dwordx4 v6,s[4:7],s65 offen lds
s_add_u32 m0,s63,9216
s_add_u32 s65,s58,184320
buffer_load_dwordx4 v6,s[4:7],s65 offen lds
s_add_u32 m0,s63,10240
s_add_u32 s65,s58,204800
buffer_load_dwordx4 v6,s[4:7],s65 offen lds
s_add_u32 m0,s63,11264
s_add_u32 s65,s58,225280
buffer_load_dwordx4 v6,s[4:7],s65 offen lds
s_add_u32 m0,s63,12288
s_add_u32 s65,s58,245760
buffer_load_dwordx4 v6,s[4:7],s65 offen lds
s_add_u32 m0,s63,13312
s_add_u32 s65,s58,266240
buffer_load_dwordx4 v6,s[4:7],s65 offen lds
s_add_u32 m0,s63,14336
s_add_u32 s65,s58,286720
buffer_load_dwordx4 v6,s[4:7],s65 offen lds
s_add_u32 m0,s63,15360
s_add_u32 s65,s58,307200
buffer_load_dwordx4 v6,s[4:7],s65 offen lds
s_add_u32 m0,s63,16384
s_add_u32 s65,s58,327680
buffer_load_dwordx4 v6,s[4:7],s65 offen lds
s_add_u32 m0,s63,17408
s_add_u32 s65,s58,348160
buffer_load_dwordx4 v6,s[4:7],s65 offen lds
s_add_u32 m0,s63,18432
s_add_u32 s65,s58,368640
buffer_load_dwordx4 v6,s[4:7],s65 offen lds
s_add_u32 m0,s63,19456
s_add_u32 s65,s58,389120
buffer_load_dwordx4 v6,s[4:7],s65 offen lds
s_add_u32 m0,s63,20480
s_add_u32 s65,s58,409600
buffer_load_dwordx4 v6,s[4:7],s65 offen lds
s_add_u32 m0,s63,21504
s_add_u32 s65,s58,430080
buffer_load_dwordx4 v6,s[4:7],s65 offen lds
s_add_u32 m0,s63,22528
s_add_u32 s65,s58,450560
buffer_load_dwordx4 v6,s[4:7],s65 offen lds
s_add_u32 m0,s63,23552
s_add_u32 s65,s58,471040
buffer_load_dwordx4 v6,s[4:7],s65 offen lds
s_add_u32 m0,s63,24576
s_add_u32 s65,s58,491520
buffer_load_dwordx4 v6,s[4:7],s65 offen lds
s_add_u32 m0,s63,25600
s_add_u32 s65,s58,512000
buffer_load_dwordx4 v6,s[4:7],s65 offen lds
s_add_u32 m0,s63,26624
s_add_u32 s65,s58,532480
buffer_load_dwordx4 v6,s[4:7],s65 offen lds
s_add_u32 m0,s63,27648
s_add_u32 s65,s58,552960
buffer_load_dwordx4 v6,s[4:7],s65 offen lds
s_add_u32 m0,s63,28672
s_add_u32 s65,s58,573440
buffer_load_dwordx4 v6,s[4:7],s65 offen lds
s_add_u32 m0,s63,29696
s_add_u32 s65,s58,593920
buffer_load_dwordx4 v6,s[4:7],s65 offen lds
s_add_u32 m0,s63,30720
s_add_u32 s65,s58,614400
buffer_load_dwordx4 v6,s[4:7],s65 offen lds
s_add_u32 m0,s63,31744
s_add_u32 s65,s58,634880
buffer_load_dwordx4 v6,s[4:7],s65 offen lds
s_add_u32 m0,s63,32768
s_add_u32 s65,s58,655360
buffer_load_dwordx4 v6,s[4:7],s65 offen lds
s_add_u32 m0,s63,33792
s_add_u32 s65,s58,675840
buffer_load_dwordx4 v6,s[4:7],s65 offen lds
s_add_u32 m0,s63,34816
s_add_u32 s65,s58,696320
buffer_load_dwordx4 v6,s[4:7],s65 offen lds
s_add_u32 m0,s63,35840
s_add_u32 s65,s58,716800
buffer_load_dwordx4 v6,s[4:7],s65 offen lds
s_add_u32 m0,s63,36864
s_add_u32 s65,s58,737280
buffer_load_dwordx4 v6,s[4:7],s65 offen lds
s_add_u32 m0,s63,37888
s_add_u32 s65,s58,757760
buffer_load_dwordx4 v6,s[4:7],s65 offen lds
s_add_u32 m0,s63,38912
s_add_u32 s65,s58,778240
buffer_load_dwordx4 v6,s[4:7],s65 offen lds
s_add_u32 m0,s63,39936
s_add_u32 s65,s58,798720
buffer_load_dwordx4 v6,s[4:7],s65 offen lds
s_waitcnt vmcnt(20)
v_bfe_u32 v9,v0,2,2
v_lshrrev_b32 v10,5,v0
v_lshl_add_u32 v9,v10,2,v9
v_mul_u32_u24 v9,64,v9
v_and_b32 v10,1,v0
v_lshl_add_u32 v9,v10,3,v9
v_bfe_u32 v10,v0,1,1
v_lshl_add_u32 v9,v10,5,v9
v_bfe_u32 v10,v0,4,1
v_lshl_add_u32 v9,v10,4,v9
v_add_u32 v7,s63,v9
ds_read_b64_tr_b16 a[0:1],v7 offset:0
ds_read_b64_tr_b16 a[2:3],v7 offset:1024
ds_read_b64_tr_b16 a[4:5],v7 offset:512
ds_read_b64_tr_b16 a[6:7],v7 offset:1536
ds_read_b64_tr_b16 a[8:9],v7 offset:2048
ds_read_b64_tr_b16 a[10:11],v7 offset:3072
ds_read_b64_tr_b16 a[12:13],v7 offset:2560
ds_read_b64_tr_b16 a[14:15],v7 offset:3584
ds_read_b64_tr_b16 a[16:17],v7 offset:4096
ds_read_b64_tr_b16 a[18:19],v7 offset:5120
ds_read_b64_tr_b16 a[20:21],v7 offset:4608
ds_read_b64_tr_b16 a[22:23],v7 offset:5632
s_waitcnt lgkmcnt(4)
ds_read_b64_tr_b16 a[24:25],v7 offset:6144
ds_read_b64_tr_b16 a[26:27],v7 offset:7168
ds_read_b64_tr_b16 a[28:29],v7 offset:6656
ds_read_b64_tr_b16 a[30:31],v7 offset:7680
ds_read_b64_tr_b16 a[32:33],v7 offset:8192
ds_read_b64_tr_b16 a[34:35],v7 offset:9216
ds_read_b64_tr_b16 a[36:37],v7 offset:8704
ds_read_b64_tr_b16 a[38:39],v7 offset:9728
ds_read_b64_tr_b16 a[40:41],v7 offset:10240
ds_read_b64_tr_b16 a[42:43],v7 offset:11264
ds_read_b64_tr_b16 a[44:45],v7 offset:10752
ds_read_b64_tr_b16 a[46:47],v7 offset:11776
s_waitcnt lgkmcnt(4)
ds_read_b64_tr_b16 a[48:49],v7 offset:12288
ds_read_b64_tr_b16 a[50:51],v7 offset:13312
ds_read_b64_tr_b16 a[52:53],v7 offset:12800
ds_read_b64_tr_b16 a[54:55],v7 offset:13824
ds_read_b64_tr_b16 a[56:57],v7 offset:14336
ds_read_b64_tr_b16 a[58:59],v7 offset:15360
ds_read_b64_tr_b16 a[60:61],v7 offset:14848
ds_read_b64_tr_b16 a[62:63],v7 offset:15872
ds_read_b64_tr_b16 a[64:65],v7 offset:16384
ds_read_b64_tr_b16 a[66:67],v7 offset:17408
ds_read_b64_tr_b16 a[68:69],v7 offset:16896
ds_read_b64_tr_b16 a[70:71],v7 offset:17920
s_waitcnt lgkmcnt(4)
ds_read_b64_tr_b16 a[72:73],v7 offset:18432
ds_read_b64_tr_b16 a[74:75],v7 offset:19456
ds_read_b64_tr_b16 a[76:77],v7 offset:18944
ds_read_b64_tr_b16 a[78:79],v7 offset:19968
s_waitcnt lgkmcnt(0)
s_waitcnt vmcnt(0)
v_bfe_u32 v9,v0,2,2
v_lshrrev_b32 v10,5,v0
v_lshl_add_u32 v9,v10,2,v9
v_mul_u32_u24 v9,64,v9
v_and_b32 v10,1,v0
v_lshl_add_u32 v9,v10,3,v9
v_bfe_u32 v10,v0,1,1
v_lshl_add_u32 v9,v10,5,v9
v_bfe_u32 v10,v0,4,1
v_lshl_add_u32 v9,v10,4,v9
v_add_u32 v7,s63,v9
ds_read_b64_tr_b16 a[80:81],v7 offset:20480
ds_read_b64_tr_b16 a[82:83],v7 offset:21504
ds_read_b64_tr_b16 a[84:85],v7 offset:20992
ds_read_b64_tr_b16 a[86:87],v7 offset:22016
ds_read_b64_tr_b16 a[88:89],v7 offset:22528
ds_read_b64_tr_b16 a[90:91],v7 offset:23552
ds_read_b64_tr_b16 a[92:93],v7 offset:23040
ds_read_b64_tr_b16 a[94:95],v7 offset:24064
ds_read_b64_tr_b16 a[96:97],v7 offset:24576
ds_read_b64_tr_b16 a[98:99],v7 offset:25600
ds_read_b64_tr_b16 a[100:101],v7 offset:25088
ds_read_b64_tr_b16 a[102:103],v7 offset:26112
s_waitcnt lgkmcnt(4)
ds_read_b64_tr_b16 a[104:105],v7 offset:26624
ds_read_b64_tr_b16 a[106:107],v7 offset:27648
ds_read_b64_tr_b16 a[108:109],v7 offset:27136
ds_read_b64_tr_b16 a[110:111],v7 offset:28160
ds_read_b64_tr_b16 a[112:113],v7 offset:28672
ds_read_b64_tr_b16 a[114:115],v7 offset:29696
ds_read_b64_tr_b16 a[116:117],v7 offset:29184
ds_read_b64_tr_b16 a[118:119],v7 offset:30208
ds_read_b64_tr_b16 a[120:121],v7 offset:30720
ds_read_b64_tr_b16 a[122:123],v7 offset:31744
ds_read_b64_tr_b16 a[124:125],v7 offset:31232
ds_read_b64_tr_b16 a[126:127],v7 offset:32256
s_waitcnt lgkmcnt(4)
ds_read_b64_tr_b16 a[128:129],v7 offset:32768
ds_read_b64_tr_b16 a[130:131],v7 offset:33792
ds_read_b64_tr_b16 a[132:133],v7 offset:33280
ds_read_b64_tr_b16 a[134:135],v7 offset:34304
ds_read_b64_tr_b16 a[136:137],v7 offset:34816
ds_read_b64_tr_b16 a[138:139],v7 offset:35840
ds_read_b64_tr_b16 a[140:141],v7 offset:35328
ds_read_b64_tr_b16 a[142:143],v7 offset:36352
ds_read_b64_tr_b16 a[144:145],v7 offset:36864
ds_read_b64_tr_b16 a[146:147],v7 offset:37888
ds_read_b64_tr_b16 a[148:149],v7 offset:37376
ds_read_b64_tr_b16 a[150:151],v7 offset:38400
s_waitcnt lgkmcnt(4)
ds_read_b64_tr_b16 a[152:153],v7 offset:38912
ds_read_b64_tr_b16 a[154:155],v7 offset:39936
ds_read_b64_tr_b16 a[156:157],v7 offset:39424
ds_read_b64_tr_b16 a[158:159],v7 offset:40448
s_waitcnt lgkmcnt(0)
s_barrier
s_lshl_b32 s3,s49,2
v_mov_b32 v7,s3
s_nop 1
ibw_283:
buffer_load_dword v6,v7,s[12:15],0 offen sc1
s_waitcnt vmcnt(0)
v_cmp_ne_u32 vcc,256,v6
s_nop 0
s_cbranch_vccz ok_284
s_sleep 8
s_sub_u32 s47,s47,1
s_cbranch_scc1 ABORT
s_branch ibw_283
ok_284:
s_cmp_lg_u32 s49,0
s_cbranch_scc1 ibok_285
v_and_b32 v7,7,v0
v_lshlrev_b32 v7,2,v7
buffer_load_dword v6,v7,s[12:15],0 offen offset:32 sc1
s_waitcnt vmcnt(0)
v_cmp_ne_u32 vcc,32,v6
s_nop 0
s_cbranch_vccz ibok_285
s_barrier
s_mov_b32 s49,1
s_mov_b32 s3,s2
s_load_dwordx16 s[16:31],s[0:1],0
s_load_dwordx8 s[32:39],s[0:1],64
s_waitcnt lgkmcnt(0)
s_branch DISPATCH
ibok_285:
s_mov_b32 s50,0
s_mov_b32 s32,0
s_mov_b32 s57,0
s_mov_b32 s59,2147483648
s_mov_b32 s82,2147483648
s_mov_b32 s39,2147483648
v_mov_b32 v22,83968
v_lshl_add_u32 v22,v0,2,v22
v_mov_b32 v23,0
ds_write_b32 v22,v23
s_mov_b32 s39,1600000
v_and_b32 v72,15,v0
v_lshlrev_b32 v72,7,v72
s_mul_i32 s60,s56,-1792
s_add_u32 s60,s60,40960
v_and_b32 v6,128,v72
v_add_u32 v6,s60,v6
v_cmp_lt_u32 vcc,15,v0
s_nop 1
v_cndmask_b32 v72,v72,v6,vcc
v_min_u32 v6,59,v0
v_lshlrev_b32 v6,2,v6
v_add_u32 v2,135168,v6
v_add_u32 v7,-80,v6
v_cmp_gt_u32 s[78:79],20,v0
s_nop 1
v_cndmask_b32 v2,v7,v2,s[78:79]
s_mov_b32 s51,0
s_mov_b32 s52,0
s_mul_i32 s62,s51,8
s_and_b32 s63,s52,7
s_add_u32 s62,s62,s63
s_mul_i32 s62,s62,46080
s_add_u32 s62,s62,212467712
s_lshl_b32 s63,s56,11
s_add_u32 s62,s62,s63
buffer_load_dword v73,v72,s[8:11],s62 offen sc1
s_mov_b32 s51,0
s_mov_b32 s52,1
s_mul_i32 s62,s51,8
s_and_b32 s63,s52,7
s_add_u32 s62,s62,s63
s_mul_i32 s62,s62,46080
s_add_u32 s62,s62,212467712
s_lshl_b32 s63,s56,11
s_add_u32 s62,s62,s63
buffer_load_dword v73,v72,s[8:11],s62 offen sc1
s_mov_b32 s51,0
s_mov_b32 s52,2
s_mul_i32 s62,s51,8
s_and_b32 s63,s52,7
s_add_u32 s62,s62,s63
s_mul_i32 s62,s62,46080
s_add_u32 s62,s62,212467712
s_lshl_b32 s63,s56,11
s_add_u32 s62,s62,s63
buffer_load_dword v73,v72,s[8:11],s62 offen sc1
s_mov_b32 s51,0
s_mov_b32 s52,3
s_mul_i32 s62,s51,8
s_and_b32 s63,s52,7
s_add_u32 s62,s62,s63
s_mul_i32 s62,s62,46080
s_add_u32 s62,s62,212467712
s_lshl_b32 s63,s56,11
s_add_u32 s62,s62,s63
buffer_load_dword v73,v72,s[8:11],s62 offen sc1
s_mov_b32 s51,0
s_mov_b32 s52,4
s_mul_i32 s62,s51,8
s_and_b32 s63,s52,7
s_add_u32 s62,s62,s63
s_mul_i32 s62,s62,46080
s_add_u32 s62,s62,212467712
s_lshl_b32 s63,s56,11
s_add_u32 s62,s62,s63
buffer_load_dword v73,v72,s[8:11],s62 offen sc1
s_mov_b32 s51,0
s_mov_b32 s52,5
s_mul_i32 s62,s51,8
s_and_b32 s63,s52,7
s_add_u32 s62,s62,s63
s_mul_i32 s62,s62,46080
s_add_u32 s62,s62,212467712
s_lshl_b32 s63,s56,11
s_add_u32 s62,s62,s63
buffer_load_dword v73,v72,s[8:11],s62 offen sc1
s_mov_b32 s51,0
s_mov_b32 s52,6
s_mul_i32 s62,s51,8
s_and_b32 s63,s52,7
s_add_u32 s62,s62,s63
s_mul_i32 s62,s62,46080
s_add_u32 s62,s62,212467712
s_lshl_b32 s63,s56,11
s_add_u32 s62,s62,s63
buffer_load_dword v73,v72,s[8:11],s62 offen sc1
s_mov_b32 s51,0
s_mov_b32 s52,7
s_mul_i32 s62,s51,8
s_and_b32 s63,s52,7
s_add_u32 s62,s62,s63
s_mul_i32 s62,s62,46080
s_add_u32 s62,s62,212467712
s_lshl_b32 s63,s56,11
s_add_u32 s62,s62,s63
buffer_load_dword v73,v72,s[8:11],s62 offen sc1
s_mov_b32 s51,1
s_mov_b32 s52,0
s_mul_i32 s62,s51,8
s_and_b32 s63,s52,7
s_add_u32 s62,s62,s63
s_mul_i32 s62,s62,46080
s_add_u32 s62,s62,212467712
s_lshl_b32 s63,s56,11
s_add_u32 s62,s62,s63
buffer_load_dword v73,v72,s[8:11],s62 offen sc1
s_mov_b32 s51,1
s_mov_b32 s52,1
s_mul_i32 s62,s51,8
s_and_b32 s63,s52,7
s_add_u32 s62,s62,s63
s_mul_i32 s62,s62,46080
s_add_u32 s62,s62,212467712
s_lshl_b32 s63,s56,11
s_add_u32 s62,s62,s63
buffer_load_dword v73,v72,s[8:11],s62 offen sc1
s_mov_b32 s51,1
s_mov_b32 s52,2
s_mul_i32 s62,s51,8
s_and_b32 s63,s52,7
s_add_u32 s62,s62,s63
s_mul_i32 s62,s62,46080
s_add_u32 s62,s62,212467712
s_lshl_b32 s63,s56,11
s_add_u32 s62,s62,s63
buffer_load_dword v73,v72,s[8:11],s62 offen sc1
s_mov_b32 s51,1
s_mov_b32 s52,3
s_mul_i32 s62,s51,8
s_and_b32 s63,s52,7
s_add_u32 s62,s62,s63
s_mul_i32 s62,s62,46080
s_add_u32 s62,s62,212467712
s_lshl_b32 s63,s56,11
s_add_u32 s62,s62,s63
buffer_load_dword v73,v72,s[8:11],s62 offen sc1
s_mov_b32 s51,1
s_mov_b32 s52,4
s_mul_i32 s62,s51,8
s_and_b32 s63,s52,7
s_add_u32 s62,s62,s63
s_mul_i32 s62,s62,46080
s_add_u32 s62,s62,212467712
s_lshl_b32 s63,s56,11
s_add_u32 s62,s62,s63
buffer_load_dword v73,v72,s[8:11],s62 offen sc1
s_mov_b32 s51,1
s_mov_b32 s52,5
s_mul_i32 s62,s51,8
s_and_b32 s63,s52,7
s_add_u32 s62,s62,s63
s_mul_i32 s62,s62,46080
s_add_u32 s62,s62,212467712
s_lshl_b32 s63,s56,11
s_add_u32 s62,s62,s63
buffer_load_dword v73,v72,s[8:11],s62 offen sc1
s_mov_b32 s51,1
s_mov_b32 s52,6
s_mul_i32 s62,s51,8
s_and_b32 s63,s52,7
s_add_u32 s62,s62,s63
s_mul_i32 s62,s62,46080
s_add_u32 s62,s62,212467712
s_lshl_b32 s63,s56,11
s_add_u32 s62,s62,s63
buffer_load_dword v73,v72,s[8:11],s62 offen sc1
s_mov_b32 s51,1
s_mov_b32 s52,7
s_mul_i32 s62,s51,8
s_and_b32 s63,s52,7
s_add_u32 s62,s62,s63
s_mul_i32 s62,s62,46080
s_add_u32 s62,s62,212467712
s_lshl_b32 s63,s56,11
s_add_u32 s62,s62,s63
buffer_load_dword v73,v72,s[8:11],s62 offen sc1
s_waitcnt vmcnt(0)
s_waitcnt lgkmcnt(0)
s_barrier
s_mov_b32 s83,s100
s_min_u32 s62,s32,127
s_sub_u32 s60,s62,15
s_lshr_b32 s34,s60,1
s_and_b32 s33,s60,1
s_cmp_eq_u32 s33,0
s_cselect_b32 s61,15,0
s_add_u32 s34,s34,s61
s_sub_u32 s61,s60,49
s_cmp_ge_u32 s60,98
s_cselect_b32 s34,s61,s34
s_cselect_b32 s33,1,s33
s_cmp_lt_u32 s62,15
s_cselect_b32 s34,s62,s34
s_cselect_b32 s33,0,s33
s_add_u32 s60,s34,1
s_min_u32 s60,s60,63
s_lshl_b32 s35,s33,6
s_add_u32 s35,s35,s60
s_lshl_b32 s35,s35,9
s_add_u32 s35,s35,323584
s_cmp_lt_u32 s60,8
s_cselect_b64 s[76:77],s[78:79],-1
s_sub_u32 s57,40960,s57
v_swap_b32 v16,v18
v_swap_b32 v17,v19
s_add_u32 s62,s32,1
s_min_u32 s62,s62,127
s_sub_u32 s60,s62,15
s_lshr_b32 s41,s60,1
s_and_b32 s40,s60,1
s_cmp_eq_u32 s40,0
s_cselect_b32 s61,15,0
s_add_u32 s41,s41,s61
s_sub_u32 s61,s60,49
s_cmp_ge_u32 s60,98
s_cselect_b32 s41,s61,s41
s_cselect_b32 s40,1,s40
s_cmp_lt_u32 s62,15
s_cselect_b32 s41,s62,s41
s_cselect_b32 s40,0,s40
s_add_u32 s60,s41,1
s_min_u32 s60,s60,63
s_lshl_b32 s42,s40,6
s_add_u32 s42,s42,s60
s_lshl_b32 s42,s42,9
s_add_u32 s42,s42,323584
s_cmp_lt_u32 s60,8
s_cselect_b64 s[80:81],s[78:79],-1
W2_COLD:
s_mov_b32 s37,0
fb_286:
buffer_load_dword v3,v2,s[8:11],s35 offen sc1
s_waitcnt vmcnt(0)
v_cmp_eq_u32 vcc,0,v3
s_and_b64 vcc,vcc,s[76:77]
s_cbranch_scc0 ok_287
s_sleep 1
s_sub_u32 s47,s47,1
s_cbranch_scc1 ABORT
s_branch fb_286
ok_287:
W2_COLD2:
s_sub_u32 s66,40960,s57
s_add_u32 s61,s34,s68
s_and_b32 s62,s61,7
s_cmp_lt_u32 s61,64
s_cselect_b32 s62,s62,8
s_mul_i32 s62,s62,40960
s_and_b32 s61,s34,7
s_mul_i32 s61,s61,40960
v_mad_u32_u24 v112,v76,s62,v74
v_mad_u32_u24 v112,v78,s61,v112
v_mad_u32_u24 v113,v77,s62,v75
v_mad_u32_u24 v113,v79,s61,v113
s_mov_b32 s60,s33
s_mul_i32 s60,s60,368640
s_add_u32 s60,s60,s37
s_mul_i32 s61,s46,10240
s_add_u32 s60,s60,s61
s_add_u32 s60,s60,237371392
s_add_u32 s61,s61,s66
s_add_u32 m0,s61,0
s_add_u32 s63,s60,0
buffer_load_dwordx4 v112,s[8:11],s63 offen sc1 lds
s_add_u32 m0,s61,1024
s_nop 0
buffer_load_dwordx4 v113,s[8:11],s63 offen sc1 lds
s_add_u32 m0,s61,2048
s_add_u32 s63,s60,2048
buffer_load_dwordx4 v112,s[8:11],s63 offen sc1 lds
s_add_u32 m0,s61,3072
s_nop 0
buffer_load_dwordx4 v113,s[8:11],s63 offen sc1 lds
s_add_u32 m0,s61,4096
s_add_u32 s63,s60,4096
buffer_load_dwordx4 v112,s[8:11],s63 offen sc1 lds
s_add_u32 m0,s61,5120
s_nop 0
buffer_load_dwordx4 v113,s[8:11],s63 offen sc1 lds
s_waitcnt vmcnt(5)
s_mov_b64 exec,1
s_cmp_lg_u32 s49,0
s_cbranch_scc0 ls_288
buffer_store_dword v5,v1,s[8:11],s59 offen sc1
s_branch ls_289
ls_288:
buffer_store_dword v5,v1,s[8:11],s59 offen
ls_289:
s_mov_b64 exec,-1
s_mov_b32 s59,2147483648
s_add_u32 m0,s61,6144
s_add_u32 s63,s60,6144
buffer_load_dwordx4 v112,s[8:11],s63 offen sc1 lds
s_add_u32 m0,s61,7168
s_nop 0
buffer_load_dwordx4 v113,s[8:11],s63 offen sc1 lds
s_add_u32 m0,s61,8192
s_add_u32 s63,s60,8192
buffer_load_dwordx4 v112,s[8:11],s63 offen sc1 lds
s_add_u32 m0,s61,9216
s_nop 0
buffer_load_dwordx4 v113,s[8:11],s63 offen sc1 lds
s_mov_b32 s35,s42
s_mov_b32 s53,s33
s_mov_b32 s54,s34
s_add_u32 s32,s32,1
s_mov_b32 s33,s40
s_mov_b32 s34,s41
s_mov_b64 s[76:77],s[80:81]
s_sub_u32 s57,40960,s57
v_swap_b32 v16,v18
v_swap_b32 v17,v19
s_mov_b32 s51,s53
s_mov_b32 s52,s54
s_waitcnt vmcnt(5)
s_branch W2_GO
W2_NEXT:
s_sub_u32 s57,40960,s57
v_swap_b32 v16,v18
v_swap_b32 v17,v19
s_mov_b32 s51,s53
s_mov_b32 s52,s54
s_waitcnt vmcnt(3)
W2_GO:
s_barrier
ds_read_b128 v[24:27],v16 offset:0
ds_read_b128 v[28:31],v17 offset:0
ds_read_b128 v[32:35],v16 offset:10240
ds_read_b128 v[36:39],v17 offset:10240
ds_read_b128 v[40:43],v16 offset:20480
ds_read_b128 v[44:47],v17 offset:20480
ds_read_b128 v[48:51],v16 offset:30720
buffer_load_dword v3,v2,s[8:11],s35 offen sc1
s_waitcnt lgkmcnt(6)
v_mfma_f32_32x32x16_bf16 v[56:71],a[0:3],v[24:27],0
ds_read_b128 v[52:55],v17 offset:30720
s_lshl_b32 s60,s51,6
s_add_u32 s60,s60,s52
s_mul_i32 s60,s60,46080
s_waitcnt lgkmcnt(6)
v_mfma_f32_32x32x16_bf16 v[56:71],a[4:7],v[28:31],v[56:71]
ds_read_b128 v[24:27],v16 offset:2048
s_lshl_b32 s61,s56,11
s_add_u32 s60,s60,s61
s_add_u32 s60,s60,223608832
s_waitcnt lgkmcnt(5)
v_mfma_f32_32x32x16_bf16 v[56:71],a[40:43],v[32:35],v[56:71]
ds_read_b128 v[28:31],v17 offset:2048
buffer_load_dwordx4 v[120:123],v116,s[8:11],s60 offen sc1
buffer_load_dwordx4 v[124:127],v117,s[8:11],s60 offen sc1
v_mfma_f32_32x32x16_bf16 v[56:71],a[44:47],v[36:39],v[56:71]
ds_read_b128 v[32:35],v16 offset:12288
s_add_u32 s62,s32,1
s_min_u32 s62,s62,127
s_sub_u32 s60,s62,15
s_waitcnt lgkmcnt(5)
v_mfma_f32_32x32x16_bf16 v[56:71],a[80:83],v[40:43],v[56:71]
ds_read_b128 v[36:39],v17 offset:12288
s_lshr_b32 s41,s60,1
s_and_b32 s40,s60,1
s_cmp_eq_u32 s40,0
s_cselect_b32 s61,15,0
v_mfma_f32_32x32x16_bf16 v[56:71],a[84:87],v[44:47],v[56:71]
ds_read_b128 v[40:43],v16 offset:22528
s_add_u32 s41,s41,s61
s_sub_u32 s61,s60,49
s_mul_i32 s71,s51,8
s_waitcnt lgkmcnt(5)
v_mfma_f32_32x32x16_bf16 v[56:71],a[120:123],v[48:51],v[56:71]
ds_read_b128 v[44:47],v17 offset:22528
s_cmp_ge_u32 s60,98
s_cselect_b32 s41,s61,s41
s_cselect_b32 s40,1,s40
s_and_b32 s72,s52,7
v_mfma_f32_32x32x16_bf16 v[56:71],a[124:127],v[52:55],v[56:71]
ds_read_b128 v[48:51],v16 offset:32768
s_cmp_lt_u32 s62,15
s_cselect_b32 s41,s62,s41
s_cselect_b32 s40,0,s40
s_waitcnt lgkmcnt(5)
v_mfma_f32_32x32x16_bf16 v[56:71],a[8:11],v[24:27],v[56:71]
ds_read_b128 v[52:55],v17 offset:32768
s_add_u32 s60,s41,1
s_min_u32 s60,s60,63
s_lshl_b32 s42,s40,6
s_add_u32 s42,s42,s60
v_mfma_f32_32x32x16_bf16 v[56:71],a[12:15],v[28:31],v[56:71]
ds_read_b128 v[24:27],v16 offset:4096
s_lshl_b32 s42,s42,9
s_add_u32 s42,s42,323584
s_add_u32 s71,s71,s72
s_waitcnt lgkmcnt(5)
v_mfma_f32_32x32x16_bf16 v[56:71],a[48:51],v[32:35],v[56:71]
ds_read_b128 v[28:31],v17 offset:4096
s_cmp_lt_u32 s60,8
s_cselect_b64 s[80:81],s[78:79],-1
s_mul_i32 s71,s71,46080
s_add_u32 s71,s71,212467712
v_mfma_f32_32x32x16_bf16 v[56:71],a[52:55],v[36:39],v[56:71]
ds_read_b128 v[32:35],v16 offset:14336
s_lshl_b32 s72,s56,8
s_add_u32 s72,s72,s71
s_add_u32 s72,s72,40960
s_waitcnt lgkmcnt(5)
v_mfma_f32_32x32x16_bf16 v[56:71],a[88:91],v[40:43],v[56:71]
ds_read_b128 v[36:39],v17 offset:14336
s_waitcnt vmcnt(2)
s_mov_b64 exec,1
s_cmp_lg_u32 s49,0
s_cbranch_scc0 ls_290
buffer_store_dword v5,v1,s[8:11],s59 offen sc1
s_branch ls_291
ls_290:
buffer_store_dword v5,v1,s[8:11],s59 offen
ls_291:
s_mov_b64 exec,-1
s_mov_b32 s59,2147483648
v_mfma_f32_32x32x16_bf16 v[56:71],a[92:95],v[44:47],v[56:71]
ds_read_b128 v[40:43],v16 offset:24576
v_cmp_eq_u32 vcc,0,v3
s_and_b64 vcc,vcc,s[76:77]
s_cselect_b32 s37,2147483648,0
s_waitcnt lgkmcnt(5)
v_mfma_f32_32x32x16_bf16 v[56:71],a[128:131],v[48:51],v[56:71]
ds_read_b128 v[44:47],v17 offset:24576
s_cmp_lt_u32 s32,128
s_cselect_b32 s37,s37,2147483648
s_sub_u32 s66,40960,s57
s_add_u32 s61,s34,s68
v_mfma_f32_32x32x16_bf16 v[56:71],a[132:135],v[52:55],v[56:71]
ds_read_b128 v[48:51],v16 offset:34816
s_and_b32 s62,s61,7
s_cmp_lt_u32 s61,64
s_cselect_b32 s62,s62,8
s_waitcnt lgkmcnt(5)
v_mfma_f32_32x32x16_bf16 v[56:71],a[16:19],v[24:27],v[56:71]
ds_read_b128 v[52:55],v17 offset:34816
s_mul_i32 s62,s62,40960
s_and_b32 s61,s34,7
s_mul_i32 s61,s61,40960
v_mad_u32_u24 v112,v76,s62,v74
s_barrier
v_mfma_f32_32x32x16_bf16 v[56:71],a[20:23],v[28:31],v[56:71]
ds_read_b128 v[24:27],v16 offset:6144
v_mad_u32_u24 v112,v78,s61,v112
v_mad_u32_u24 v113,v77,s62,v75
v_mad_u32_u24 v113,v79,s61,v113
s_waitcnt lgkmcnt(5)
v_mfma_f32_32x32x16_bf16 v[56:71],a[56:59],v[32:35],v[56:71]
ds_read_b128 v[28:31],v17 offset:6144
s_mov_b32 s60,s33
s_mul_i32 s60,s60,368640
s_add_u32 s60,s60,s37
s_mul_i32 s61,s46,10240
v_mfma_f32_32x32x16_bf16 v[56:71],a[60:63],v[36:39],v[56:71]
ds_read_b128 v[32:35],v16 offset:16384
s_add_u32 s60,s60,s61
s_add_u32 s60,s60,237371392
s_add_u32 s61,s61,s66
s_waitcnt lgkmcnt(5)
v_mfma_f32_32x32x16_bf16 v[56:71],a[96:99],v[40:43],v[56:71]
ds_read_b128 v[36:39],v17 offset:16384
s_add_u32 m0,s61,0
s_add_u32 s63,s60,0
buffer_load_dwordx4 v112,s[8:11],s63 offen sc1 lds
v_mfma_f32_32x32x16_bf16 v[56:71],a[100:103],v[44:47],v[56:71]
ds_read_b128 v[40:43],v16 offset:26624
s_add_u32 m0,s61,1024
s_lshl_b32 s73,s56,11
s_add_u32 s71,s71,s73
s_waitcnt lgkmcnt(5)
v_mfma_f32_32x32x16_bf16 v[56:71],a[136:139],v[48:51],v[56:71]
ds_read_b128 v[44:47],v17 offset:26624
buffer_load_dwordx4 v113,s[8:11],s63 offen sc1 lds
s_add_u32 m0,s61,2048
s_add_u32 s63,s60,2048
v_mfma_f32_32x32x16_bf16 v[56:71],a[140:143],v[52:55],v[56:71]
ds_read_b128 v[48:51],v16 offset:36864
s_lshl_b32 s82,s51,6
s_add_u32 s82,s82,s52
s_lshl_b32 s82,s82,9
s_waitcnt lgkmcnt(5)
v_mfma_f32_32x32x16_bf16 v[56:71],a[24:27],v[24:27],v[56:71]
ds_read_b128 v[52:55],v17 offset:36864
buffer_load_dwordx4 v112,s[8:11],s63 offen sc1 lds
s_add_u32 m0,s61,3072
s_add_u32 s82,s82,524288
v_mfma_f32_32x32x16_bf16 v[56:71],a[28:31],v[28:31],v[56:71]
ds_read_b128 v[24:27],v16 offset:8192
s_lshl_b32 s70,s56,2
s_add_u32 s82,s82,s70
s_waitcnt lgkmcnt(5)
v_mfma_f32_32x32x16_bf16 v[56:71],a[64:67],v[32:35],v[56:71]
ds_read_b128 v[28:31],v17 offset:8192
buffer_load_dwordx4 v113,s[8:11],s63 offen sc1 lds
s_add_u32 m0,s61,4096
s_add_u32 s63,s60,4096
v_mfma_f32_32x32x16_bf16 v[56:71],a[68:71],v[36:39],v[56:71]
ds_read_b128 v[32:35],v16 offset:18432
s_waitcnt lgkmcnt(5)
v_mfma_f32_32x32x16_bf16 v[56:71],a[104:107],v[40:43],v[56:71]
ds_read_b128 v[36:39],v17 offset:18432
buffer_load_dwordx4 v112,s[8:11],s63 offen sc1 lds
s_add_u32 m0,s61,5120
v_mfma_f32_32x32x16_bf16 v[56:71],a[108:111],v[44:47],v[56:71]
ds_read_b128 v[40:43],v16 offset:28672
s_waitcnt lgkmcnt(5)
v_mfma_f32_32x32x16_bf16 v[56:71],a[144:147],v[48:51],v[56:71]
ds_read_b128 v[44:47],v17 offset:28672
buffer_load_dword v3,v2,s[8:11],s35 offen sc1
v_mfma_f32_32x32x16_bf16 v[56:71],a[148:151],v[52:55],v[56:71]
ds_read_b128 v[48:51],v16 offset:38912
buffer_load_dwordx4 v113,s[8:11],s63 offen sc1 lds
s_add_u32 m0,s61,6144
s_waitcnt lgkmcnt(5)
v_mfma_f32_32x32x16_bf16 v[56:71],a[32:35],v[24:27],v[56:71]
ds_read_b128 v[52:55],v17 offset:38912
s_add_u32 s63,s60,6144
v_mfma_f32_32x32x16_bf16 v[56:71],a[36:39],v[28:31],v[56:71]
buffer_load_dwordx4 v112,s[8:11],s63 offen sc1 lds
s_add_u32 m0,s61,7168
s_waitcnt lgkmcnt(4)
v_mfma_f32_32x32x16_bf16 v[56:71],a[72:75],v[32:35],v[56:71]
v_mfma_f32_32x32x16_bf16 v[56:71],a[76:79],v[36:39],v[56:71]
buffer_load_dwordx4 v113,s[8:11],s63 offen sc1 lds
s_add_u32 m0,s61,8192
s_add_u32 s63,s60,8192
s_waitcnt lgkmcnt(2)
v_mfma_f32_32x32x16_bf16 v[56:71],a[112:115],v[40:43],v[56:71]
v_mfma_f32_32x32x16_bf16 v[56:71],a[116:119],v[44:47],v[56:71]
buffer_load_dwordx4 v112,s[8:11],s63 offen sc1 lds
s_add_u32 m0,s61,9216
s_waitcnt lgkmcnt(0)
v_mfma_f32_32x32x16_bf16 v[56:71],a[152:155],v[48:51],v[56:71]
v_mfma_f32_32x32x16_bf16 v[56:71],a[156:159],v[52:55],v[56:71]
buffer_load_dwordx4 v113,s[8:11],s63 offen sc1 lds
s_waitcnt vmcnt(12)
v_lshlrev_b32 v128,16,v120
v_and_b32 v129,0xffff0000,v120
v_lshlrev_b32 v130,16,v121
v_and_b32 v131,0xffff0000,v121
v_lshlrev_b32 v132,16,v122
v_and_b32 v133,0xffff0000,v122
v_lshlrev_b32 v134,16,v123
v_and_b32 v135,0xffff0000,v123
v_lshlrev_b32 v136,16,v124
v_and_b32 v137,0xffff0000,v124
v_lshlrev_b32 v138,16,v125
v_and_b32 v139,0xffff0000,v125
v_lshlrev_b32 v140,16,v126
v_and_b32 v141,0xffff0000,v126
v_lshlrev_b32 v142,16,v127
v_and_b32 v143,0xffff0000,v127
s_cmp_eq_u32 s37,0
s_cbranch_scc0 sec_294
s_mov_b32 s35,s42
s_mov_b32 s53,s33
s_mov_b32 s54,s34
s_add_u32 s32,s32,1
s_mov_b32 s33,s40
s_mov_b32 s34,s41
s_mov_b64 s[76:77],s[80:81]
s_nop 2
ep_292:
v_cvt_pk_bf16_f32 v6,v56,v57
v_lshlrev_b32 v56,16,v6
v_and_b32 v57,0xffff0000,v6
v_cvt_pk_bf16_f32 v6,v58,v59
v_lshlrev_b32 v58,16,v6
v_and_b32 v59,0xffff0000,v6
v_cvt_pk_bf16_f32 v6,v60,v61
v_lshlrev_b32 v60,16,v6
v_and_b32 v61,0xffff0000,v6
v_cvt_pk_bf16_f32 v6,v62,v63
v_lshlrev_b32 v62,16,v6
v_and_b32 v63,0xffff0000,v6
v_cvt_pk_bf16_f32 v6,v64,v65
v_lshlrev_b32 v64,16,v6
v_and_b32 v65,0xffff0000,v6
v_cvt_pk_bf16_f32 v6,v66,v67
v_lshlrev_b32 v66,16,v6
v_and_b32 v67,0xffff0000,v6
v_cvt_pk_bf16_f32 v6,v68,v69
v_lshlrev_b32 v68,16,v6
v_and_b32 v69,0xffff0000,v6
v_cvt_pk_bf16_f32 v6,v70,v71
v_lshlrev_b32 v70,16,v6
v_and_b32 v71,0xffff0000,v6
v_pk_add_f32 v[56:57],v[56:57],v[128:129]
v_pk_add_f32 v[58:59],v[58:59],v[130:131]
v_pk_add_f32 v[60:61],v[60:61],v[132:133]
v_pk_add_f32 v[62:63],v[62:63],v[134:135]
v_pk_add_f32 v[64:65],v[64:65],v[136:137]
v_pk_add_f32 v[66:67],v[66:67],v[138:139]
v_pk_add_f32 v[68:69],v[68:69],v[140:141]
v_pk_add_f32 v[70:71],v[70:71],v[142:143]
v_cvt_pk_bf16_f32 v144,v56,v57
v_lshlrev_b32 v56,16,v144
v_and_b32 v57,0xffff0000,v144
v_cvt_pk_bf16_f32 v145,v58,v59
v_lshlrev_b32 v58,16,v145
v_and_b32 v59,0xffff0000,v145
v_cvt_pk_bf16_f32 v146,v60,v61
v_lshlrev_b32 v60,16,v146
v_and_b32 v61,0xffff0000,v146
v_cvt_pk_bf16_f32 v147,v62,v63
v_lshlrev_b32 v62,16,v147
v_and_b32 v63,0xffff0000,v147
v_cvt_pk_bf16_f32 v148,v64,v65
v_lshlrev_b32 v64,16,v148
v_and_b32 v65,0xffff0000,v148
v_cvt_pk_bf16_f32 v149,v66,v67
v_lshlrev_b32 v66,16,v149
v_and_b32 v67,0xffff0000,v149
v_cvt_pk_bf16_f32 v150,v68,v69
v_lshlrev_b32 v68,16,v150
v_and_b32 v69,0xffff0000,v150
v_cvt_pk_bf16_f32 v151,v70,v71
v_lshlrev_b32 v70,16,v151
v_and_b32 v71,0xffff0000,v151
s_cmp_lg_u32 s49,0
s_cbranch_scc0 ls_295
buffer_store_dwordx4 v[144:147],v20,s[8:11],s71 offen sc1
buffer_store_dwordx4 v[148:151],v21,s[8:11],s71 offen sc1
s_branch ls_296
ls_295:
buffer_store_dwordx4 v[144:147],v20,s[8:11],s71 offen
buffer_store_dwordx4 v[148:151],v21,s[8:11],s71 offen
ls_296:
v_pk_add_f32 v[6:7],v[56:57],v[58:59]
v_pk_mul_f32 v[8:9],v[56:57],v[56:57]
v_pk_fma_f32 v[8:9],v[58:59],v[58:59],v[8:9]
v_pk_add_f32 v[6:7],v[6:7],v[60:61]
v_pk_fma_f32 v[8:9],v[60:61],v[60:61],v[8:9]
v_pk_add_f32 v[6:7],v[6:7],v[62:63]
v_pk_fma_f32 v[8:9],v[62:63],v[62:63],v[8:9]
v_pk_add_f32 v[6:7],v[6:7],v[64:65]
v_pk_fma_f32 v[8:9],v[64:65],v[64:65],v[8:9]
v_pk_add_f32 v[6:7],v[6:7],v[66:67]
v_pk_fma_f32 v[8:9],v[66:67],v[66:67],v[8:9]
v_pk_add_f32 v[6:7],v[6:7],v[68:69]
v_pk_fma_f32 v[8:9],v[68:69],v[68:69],v[8:9]
v_pk_add_f32 v[6:7],v[6:7],v[70:71]
v_pk_fma_f32 v[8:9],v[70:71],v[70:71],v[8:9]
v_add_f32 v6,v6,v7
v_add_f32 v7,v8,v9
v_mov_b32 v8,v6
v_mov_b32 v9,v7
s_nop 0
v_permlane32_swap_b32 v6,v8
v_permlane32_swap_b32 v7,v9
v_pk_add_f32 v[6:7],v[6:7],v[8:9]
s_mov_b32 exec_hi,0
s_cmp_lg_u32 s49,0
s_cbranch_scc0 ls_297
buffer_store_dwordx2 v[6:7],v114,s[8:11],s72 offen sc1
s_branch ls_298
ls_297:
buffer_store_dwordx2 v[6:7],v114,s[8:11],s72 offen
ls_298:
s_mov_b32 exec_hi,-1
s_mov_b32 s59,s82
s_cmp_eq_u32 s37,0
s_cbranch_scc1 W2_NEXT
s_waitcnt vmcnt(3)
v_cmp_eq_u32 vcc,0,v3
s_and_b64 vcc,vcc,s[76:77]
s_cselect_b32 s37,2147483648,0
s_cmp_lt_u32 s32,128
s_cselect_b32 s37,s37,2147483648
s_cmp_eq_u32 s37,0
s_cbranch_scc1 W2_COLD2
s_waitcnt vmcnt(0)
s_mov_b64 exec,1
s_cmp_lg_u32 s49,0
s_cbranch_scc0 ls_299
buffer_store_dword v5,v1,s[8:11],s59 offen sc1
s_branch ls_300
ls_299:
buffer_store_dword v5,v1,s[8:11],s59 offen
ls_300:
s_mov_b64 exec,-1
s_mov_b32 s59,2147483648
s_cmp_lt_u32 s32,128
s_cbranch_scc1 W2_COLD
s_branch W2_END
sec_294:
s_waitcnt vmcnt(5)
v_cmp_eq_u32 vcc,0,v3
s_and_b64 vcc,vcc,s[76:77]
s_cselect_b32 s37,2147483648,0
s_cmp_lt_u32 s32,128
s_cselect_b32 s37,s37,2147483648
s_cmp_lg_u32 s37,0
s_cbranch_scc1 nr_293
s_sub_u32 s66,40960,s57
s_add_u32 s61,s34,s68
s_and_b32 s62,s61,7
s_cmp_lt_u32 s61,64
s_cselect_b32 s62,s62,8
s_mul_i32 s62,s62,40960
s_and_b32 s61,s34,7
s_mul_i32 s61,s61,40960
v_mad_u32_u24 v112,v76,s62,v74
v_mad_u32_u24 v112,v78,s61,v112
v_mad_u32_u24 v113,v77,s62,v75
v_mad_u32_u24 v113,v79,s61,v113
s_mov_b32 s60,s33
s_mul_i32 s60,s60,368640
s_add_u32 s60,s60,s37
s_mul_i32 s61,s46,10240
s_add_u32 s60,s60,s61
s_add_u32 s60,s60,237371392
s_add_u32 s61,s61,s66
s_add_u32 m0,s61,0
s_add_u32 s63,s60,0
buffer_load_dwordx4 v112,s[8:11],s63 offen sc1 lds
v_cvt_pk_bf16_f32 v6,v56,v57
v_lshlrev_b32 v56,16,v6
v_and_b32 v57,0xffff0000,v6
v_cvt_pk_bf16_f32 v6,v58,v59
s_add_u32 m0,s61,1024
s_nop 0
buffer_load_dwordx4 v113,s[8:11],s63 offen sc1 lds
v_lshlrev_b32 v58,16,v6
v_and_b32 v59,0xffff0000,v6
v_cvt_pk_bf16_f32 v6,v60,v61
v_lshlrev_b32 v60,16,v6
s_add_u32 m0,s61,2048
s_add_u32 s63,s60,2048
buffer_load_dwordx4 v112,s[8:11],s63 offen sc1 lds
v_and_b32 v61,0xffff0000,v6
v_cvt_pk_bf16_f32 v6,v62,v63
v_lshlrev_b32 v62,16,v6
v_and_b32 v63,0xffff0000,v6
s_add_u32 m0,s61,3072
s_nop 0
buffer_load_dwordx4 v113,s[8:11],s63 offen sc1 lds
v_cvt_pk_bf16_f32 v6,v64,v65
v_lshlrev_b32 v64,16,v6
v_and_b32 v65,0xffff0000,v6
v_cvt_pk_bf16_f32 v6,v66,v67
s_add_u32 m0,s61,4096
s_add_u32 s63,s60,4096
buffer_load_dwordx4 v112,s[8:11],s63 offen sc1 lds
v_lshlrev_b32 v66,16,v6
v_and_b32 v67,0xffff0000,v6
v_cvt_pk_bf16_f32 v6,v68,v69
v_lshlrev_b32 v68,16,v6
s_add_u32 m0,s61,5120
s_nop 0
buffer_load_dwordx4 v113,s[8:11],s63 offen sc1 lds
v_and_b32 v69,0xffff0000,v6
v_cvt_pk_bf16_f32 v6,v70,v71
v_lshlrev_b32 v70,16,v6
v_and_b32 v71,0xffff0000,v6
s_add_u32 m0,s61,6144
s_add_u32 s63,s60,6144
buffer_load_dwordx4 v112,s[8:11],s63 offen sc1 lds
v_pk_add_f32 v[56:57],v[56:57],v[128:129]
v_pk_add_f32 v[58:59],v[58:59],v[130:131]
v_pk_add_f32 v[60:61],v[60:61],v[132:133]
v_pk_add_f32 v[62:63],v[62:63],v[134:135]
s_add_u32 m0,s61,7168
s_nop 0
buffer_load_dwordx4 v113,s[8:11],s63 offen sc1 lds
v_pk_add_f32 v[64:65],v[64:65],v[136:137]
v_pk_add_f32 v[66:67],v[66:67],v[138:139]
v_pk_add_f32 v[68:69],v[68:69],v[140:141]
v_pk_add_f32 v[70:71],v[70:71],v[142:143]
s_add_u32 m0,s61,8192
s_add_u32 s63,s60,8192
buffer_load_dwordx4 v112,s[8:11],s63 offen sc1 lds
v_cvt_pk_bf16_f32 v144,v56,v57
v_lshlrev_b32 v56,16,v144
v_and_b32 v57,0xffff0000,v144
v_cvt_pk_bf16_f32 v145,v58,v59
s_add_u32 m0,s61,9216
s_nop 0
buffer_load_dwordx4 v113,s[8:11],s63 offen sc1 lds
v_lshlrev_b32 v58,16,v145
v_and_b32 v59,0xffff0000,v145
v_cvt_pk_bf16_f32 v146,v60,v61
v_lshlrev_b32 v60,16,v146
s_mov_b32 s35,s42
s_mov_b32 s53,s33
s_mov_b32 s54,s34
s_add_u32 s32,s32,1
s_mov_b32 s33,s40
s_mov_b32 s34,s41
s_mov_b64 s[76:77],s[80:81]
v_and_b32 v61,0xffff0000,v146
v_cvt_pk_bf16_f32 v147,v62,v63
v_lshlrev_b32 v62,16,v147
v_and_b32 v63,0xffff0000,v147
v_cvt_pk_bf16_f32 v148,v64,v65
v_lshlrev_b32 v64,16,v148
v_and_b32 v65,0xffff0000,v148
v_cvt_pk_bf16_f32 v149,v66,v67
v_lshlrev_b32 v66,16,v149
v_and_b32 v67,0xffff0000,v149
v_cvt_pk_bf16_f32 v150,v68,v69
v_lshlrev_b32 v68,16,v150
v_and_b32 v69,0xffff0000,v150
v_cvt_pk_bf16_f32 v151,v70,v71
v_lshlrev_b32 v70,16,v151
v_and_b32 v71,0xffff0000,v151
s_cmp_lg_u32 s49,0
s_cbranch_scc0 ls_301
buffer_store_dwordx4 v[144:147],v20,s[8:11],s71 offen sc1
buffer_store_dwordx4 v[148:151],v21,s[8:11],s71 offen sc1
s_branch ls_302
ls_301:
buffer_store_dwordx4 v[144:147],v20,s[8:11],s71 offen
buffer_store_dwordx4 v[148:151],v21,s[8:11],s71 offen
ls_302:
v_pk_add_f32 v[6:7],v[56:57],v[58:59]
v_pk_mul_f32 v[8:9],v[56:57],v[56:57]
v_pk_fma_f32 v[8:9],v[58:59],v[58:59],v[8:9]
v_pk_add_f32 v[6:7],v[6:7],v[60:61]
v_pk_fma_f32 v[8:9],v[60:61],v[60:61],v[8:9]
v_pk_add_f32 v[6:7],v[6:7],v[62:63]
v_pk_fma_f32 v[8:9],v[62:63],v[62:63],v[8:9]
v_pk_add_f32 v[6:7],v[6:7],v[64:65]
v_pk_fma_f32 v[8:9],v[64:65],v[64:65],v[8:9]
v_pk_add_f32 v[6:7],v[6:7],v[66:67]
v_pk_fma_f32 v[8:9],v[66:67],v[66:67],v[8:9]
v_pk_add_f32 v[6:7],v[6:7],v[68:69]
v_pk_fma_f32 v[8:9],v[68:69],v[68:69],v[8:9]
v_pk_add_f32 v[6:7],v[6:7],v[70:71]
v_pk_fma_f32 v[8:9],v[70:71],v[70:71],v[8:9]
v_add_f32 v6,v6,v7
v_add_f32 v7,v8,v9
v_mov_b32 v8,v6
v_mov_b32 v9,v7
s_nop 0
v_permlane32_swap_b32 v6,v8
v_permlane32_swap_b32 v7,v9
v_pk_add_f32 v[6:7],v[6:7],v[8:9]
s_mov_b32 exec_hi,0
s_cmp_lg_u32 s49,0
s_cbranch_scc0 ls_303
buffer_store_dwordx2 v[6:7],v114,s[8:11],s72 offen sc1
s_branch ls_304
ls_303:
buffer_store_dwordx2 v[6:7],v114,s[8:11],s72 offen
ls_304:
s_mov_b32 exec_hi,-1
s_mov_b32 s59,s82
s_branch W2_NEXT
nr_293:
buffer_load_dword v3,v2,s[8:11],s35 offen sc1
s_branch ep_292
W2_END:
s_endpgm
ROLE_W3:
v_lshlrev_b32 v1,4,v0
v_mov_b32 v5,1
s_lshl_b32 s56,s48,2
s_add_u32 s56,s56,s46
v_bfe_u32 v6,v0,2,2
v_lshrrev_b32 v7,4,v0
v_add_u32 v7,v6,v7
v_and_b32 v7,3,v7
v_and_b32 v15,3,v0
v_lshlrev_b32 v15,4,v15
v_lshl_add_u32 v15,v7,6,v15
v_lshl_add_u32 v15,v6,8,v15
v_lshrrev_b32 v6,5,v0
v_bfe_u32 v7,v0,4,1
v_lshlrev_b32 v16,10,v7
v_lshl_add_u32 v16,v6,8,v16
v_and_b32 v6,15,v0
v_lshl_add_u32 v16,v6,4,v16
v_add_u32 v18,46080,v16
v_lshrrev_b32 v6,5,v0
v_bfe_u32 v7,v0,4,1
v_lshlrev_b32 v20,10,v7
v_lshl_add_u32 v20,v6,8,v20
v_and_b32 v6,15,v0
v_lshl_add_u32 v20,v6,4,v20
v_lshrrev_b32 v6,5,v0
v_add_u32 v6,2,v6
v_bfe_u32 v7,v0,4,1
v_lshlrev_b32 v17,10,v7
v_lshl_add_u32 v17,v6,8,v17
v_and_b32 v6,15,v0
v_lshl_add_u32 v17,v6,4,v17
v_add_u32 v19,46080,v17
v_lshrrev_b32 v6,5,v0
v_add_u32 v6,2,v6
v_bfe_u32 v7,v0,4,1
v_lshlrev_b32 v21,10,v7
v_lshl_add_u32 v21,v6,8,v21
v_and_b32 v6,15,v0
v_lshl_add_u32 v21,v6,4,v21
v_min_u32 v2,19,v0
v_lshlrev_b32 v2,2,v2
v_mov_b32 v112,0xc0135761
v_mov_b32 v113,0xbdd2d3e8
s_mov_b32 s68,0xbdd2d3e8
v_lshrrev_b32 v6,5,v0
v_mul_u32_u24 v182,2560,v6
v_and_b32 v6,31,v0
v_lshl_add_u32 v182,v6,3,v182
v_add_u32 v182,0xa000,v182
v_mov_b32 v20,v1
v_add_u32 v21,1024,v1
s_waitcnt vmcnt(0)
s_barrier
s_cmp_lg_u32 s46,0
s_cbranch_scc1 arr_305
v_mov_b32 v6,1
s_lshl_b32 s3,s49,2
v_mov_b32 v7,s3
s_mov_b64 exec,1
buffer_atomic_add v6,v7,s[12:15],0 offen sc1
s_mov_b64 exec,-1
arr_305:
s_lshl_b32 s58,s56,6
s_mul_i32 s63,s46,40960
s_mov_b32 s4,s36
s_mov_b32 s5,s37
s_mov_b32 s6,1966080
s_mov_b32 s7,0x20000
v_lshrrev_b32 v9,2,v0
s_mov_b32 s64,3072
v_mul_lo_u32 v9,v9,s64
v_and_b32 v10,3,v0
v_lshl_add_u32 v6,v10,4,v9
s_add_u32 m0,s63,0
s_add_u32 s65,s58,0
buffer_load_dwordx4 v6,s[4:7],s65 offen lds
s_add_u32 m0,s63,1024
s_add_u32 s65,s58,49152
buffer_load_dwordx4 v6,s[4:7],s65 offen lds
s_add_u32 m0,s63,2048
s_add_u32 s65,s58,98304
buffer_load_dwordx4 v6,s[4:7],s65 offen lds
s_add_u32 m0,s63,3072
s_add_u32 s65,s58,147456
buffer_load_dwordx4 v6,s[4:7],s65 offen lds
s_add_u32 m0,s63,4096
s_add_u32 s65,s58,196608
buffer_load_dwordx4 v6,s[4:7],s65 offen lds
s_add_u32 m0,s63,5120
s_add_u32 s65,s58,245760
buffer_load_dwordx4 v6,s[4:7],s65 offen lds
s_add_u32 m0,s63,6144
s_add_u32 s65,s58,294912
buffer_load_dwordx4 v6,s[4:7],s65 offen lds
s_add_u32 m0,s63,7168
s_add_u32 s65,s58,344064
buffer_load_dwordx4 v6,s[4:7],s65 offen lds
s_add_u32 m0,s63,8192
s_add_u32 s65,s58,393216
buffer_load_dwordx4 v6,s[4:7],s65 offen lds
s_add_u32 m0,s63,9216
s_add_u32 s65,s58,442368
buffer_load_dwordx4 v6,s[4:7],s65 offen lds
s_add_u32 m0,s63,10240
s_add_u32 s65,s58,491520
buffer_load_dwordx4 v6,s[4:7],s65 offen lds
s_add_u32 m0,s63,11264
s_add_u32 s65,s58,540672
buffer_load_dwordx4 v6,s[4:7],s65 offen lds
s_add_u32 m0,s63,12288
s_add_u32 s65,s58,589824
buffer_load_dwordx4 v6,s[4:7],s65 offen lds
s_add_u32 m0,s63,13312
s_add_u32 s65,s58,638976
buffer_load_dwordx4 v6,s[4:7],s65 offen lds
s_add_u32 m0,s63,14336
s_add_u32 s65,s58,688128
buffer_load_dwordx4 v6,s[4:7],s65 offen lds
s_add_u32 m0,s63,15360
s_add_u32 s65,s58,737280
buffer_load_dwordx4 v6,s[4:7],s65 offen lds
s_add_u32 m0,s63,16384
s_add_u32 s65,s58,786432
buffer_load_dwordx4 v6,s[4:7],s65 offen lds
s_add_u32 m0,s63,17408
s_add_u32 s65,s58,835584
buffer_load_dwordx4 v6,s[4:7],s65 offen lds
s_add_u32 m0,s63,18432
s_add_u32 s65,s58,884736
buffer_load_dwordx4 v6,s[4:7],s65 offen lds
s_add_u32 m0,s63,19456
s_add_u32 s65,s58,933888
buffer_load_dwordx4 v6,s[4:7],s65 offen lds
s_add_u32 m0,s63,20480
s_add_u32 s65,s58,983040
buffer_load_dwordx4 v6,s[4:7],s65 offen lds
s_add_u32 m0,s63,21504
s_add_u32 s65,s58,1032192
buffer_load_dwordx4 v6,s[4:7],s65 offen lds
s_add_u32 m0,s63,22528
s_add_u32 s65,s58,1081344
buffer_load_dwordx4 v6,s[4:7],s65 offen lds
s_add_u32 m0,s63,23552
s_add_u32 s65,s58,1130496
buffer_load_dwordx4 v6,s[4:7],s65 offen lds
s_add_u32 m0,s63,24576
s_add_u32 s65,s58,1179648
buffer_load_dwordx4 v6,s[4:7],s65 offen lds
s_add_u32 m0,s63,25600
s_add_u32 s65,s58,1228800
buffer_load_dwordx4 v6,s[4:7],s65 offen lds
s_add_u32 m0,s63,26624
s_add_u32 s65,s58,1277952
buffer_load_dwordx4 v6,s[4:7],s65 offen lds
s_add_u32 m0,s63,27648
s_add_u32 s65,s58,1327104
buffer_load_dwordx4 v6,s[4:7],s65 offen lds
s_add_u32 m0,s63,28672
s_add_u32 s65,s58,1376256
buffer_load_dwordx4 v6,s[4:7],s65 offen lds
s_add_u32 m0,s63,29696
s_add_u32 s65,s58,1425408
buffer_load_dwordx4 v6,s[4:7],s65 offen lds
s_add_u32 m0,s63,30720
s_add_u32 s65,s58,1474560
buffer_load_dwordx4 v6,s[4:7],s65 offen lds
s_add_u32 m0,s63,31744
s_add_u32 s65,s58,1523712
buffer_load_dwordx4 v6,s[4:7],s65 offen lds
s_add_u32 m0,s63,32768
s_add_u32 s65,s58,1572864
buffer_load_dwordx4 v6,s[4:7],s65 offen lds
s_add_u32 m0,s63,33792
s_add_u32 s65,s58,1622016
buffer_load_dwordx4 v6,s[4:7],s65 offen lds
s_add_u32 m0,s63,34816
s_add_u32 s65,s58,1671168
buffer_load_dwordx4 v6,s[4:7],s65 offen lds
s_add_u32 m0,s63,35840
s_add_u32 s65,s58,1720320
buffer_load_dwordx4 v6,s[4:7],s65 offen lds
s_add_u32 m0,s63,36864
s_add_u32 s65,s58,1769472
buffer_load_dwordx4 v6,s[4:7],s65 offen lds
s_add_u32 m0,s63,37888
s_add_u32 s65,s58,1818624
buffer_load_dwordx4 v6,s[4:7],s65 offen lds
s_add_u32 m0,s63,38912
s_add_u32 s65,s58,1867776
buffer_load_dwordx4 v6,s[4:7],s65 offen lds
s_add_u32 m0,s63,39936
s_add_u32 s65,s58,1916928
buffer_load_dwordx4 v6,s[4:7],s65 offen lds
s_waitcnt vmcnt(20)
v_bfe_u32 v9,v0,2,2
v_lshrrev_b32 v10,5,v0
v_lshl_add_u32 v9,v10,2,v9
v_mul_u32_u24 v9,64,v9
v_and_b32 v10,1,v0
v_lshl_add_u32 v9,v10,3,v9
v_bfe_u32 v10,v0,1,1
v_lshl_add_u32 v9,v10,5,v9
v_bfe_u32 v10,v0,4,1
v_lshl_add_u32 v9,v10,4,v9
v_add_u32 v7,s63,v9
ds_read_b64_tr_b16 a[0:1],v7 offset:0
ds_read_b64_tr_b16 a[2:3],v7 offset:1024
ds_read_b64_tr_b16 a[4:5],v7 offset:512
ds_read_b64_tr_b16 a[6:7],v7 offset:1536
ds_read_b64_tr_b16 a[8:9],v7 offset:2048
ds_read_b64_tr_b16 a[10:11],v7 offset:3072
ds_read_b64_tr_b16 a[12:13],v7 offset:2560
ds_read_b64_tr_b16 a[14:15],v7 offset:3584
ds_read_b64_tr_b16 a[16:17],v7 offset:4096
ds_read_b64_tr_b16 a[18:19],v7 offset:5120
ds_read_b64_tr_b16 a[20:21],v7 offset:4608
ds_read_b64_tr_b16 a[22:23],v7 offset:5632
s_waitcnt lgkmcnt(4)
ds_read_b64_tr_b16 a[24:25],v7 offset:6144
ds_read_b64_tr_b16 a[26:27],v7 offset:7168
ds_read_b64_tr_b16 a[28:29],v7 offset:6656
ds_read_b64_tr_b16 a[30:31],v7 offset:7680
ds_read_b64_tr_b16 a[32:33],v7 offset:8192
ds_read_b64_tr_b16 a[34:35],v7 offset:9216
ds_read_b64_tr_b16 a[36:37],v7 offset:8704
ds_read_b64_tr_b16 a[38:39],v7 offset:9728
ds_read_b64_tr_b16 a[40:41],v7 offset:10240
ds_read_b64_tr_b16 a[42:43],v7 offset:11264
ds_read_b64_tr_b16 a[44:45],v7 offset:10752
ds_read_b64_tr_b16 a[46:47],v7 offset:11776
s_waitcnt lgkmcnt(4)
ds_read_b64_tr_b16 a[48:49],v7 offset:12288
ds_read_b64_tr_b16 a[50:51],v7 offset:13312
ds_read_b64_tr_b16 a[52:53],v7 offset:12800
ds_read_b64_tr_b16 a[54:55],v7 offset:13824
ds_read_b64_tr_b16 a[56:57],v7 offset:14336
ds_read_b64_tr_b16 a[58:59],v7 offset:15360
ds_read_b64_tr_b16 a[60:61],v7 offset:14848
ds_read_b64_tr_b16 a[62:63],v7 offset:15872
ds_read_b64_tr_b16 a[64:65],v7 offset:16384
ds_read_b64_tr_b16 a[66:67],v7 offset:17408
ds_read_b64_tr_b16 a[68:69],v7 offset:16896
ds_read_b64_tr_b16 a[70:71],v7 offset:17920
s_waitcnt lgkmcnt(4)
ds_read_b64_tr_b16 a[72:73],v7 offset:18432
ds_read_b64_tr_b16 a[74:75],v7 offset:19456
ds_read_b64_tr_b16 a[76:77],v7 offset:18944
ds_read_b64_tr_b16 a[78:79],v7 offset:19968
s_waitcnt lgkmcnt(0)
s_waitcnt vmcnt(0)
v_bfe_u32 v9,v0,2,2
v_lshrrev_b32 v10,5,v0
v_lshl_add_u32 v9,v10,2,v9
v_mul_u32_u24 v9,64,v9
v_and_b32 v10,1,v0
v_lshl_add_u32 v9,v10,3,v9
v_bfe_u32 v10,v0,1,1
v_lshl_add_u32 v9,v10,5,v9
v_bfe_u32 v10,v0,4,1
v_lshl_add_u32 v9,v10,4,v9
v_add_u32 v7,s63,v9
ds_read_b64_tr_b16 a[80:81],v7 offset:20480
ds_read_b64_tr_b16 a[82:83],v7 offset:21504
ds_read_b64_tr_b16 a[84:85],v7 offset:20992
ds_read_b64_tr_b16 a[86:87],v7 offset:22016
ds_read_b64_tr_b16 a[88:89],v7 offset:22528
ds_read_b64_tr_b16 a[90:91],v7 offset:23552
ds_read_b64_tr_b16 a[92:93],v7 offset:23040
ds_read_b64_tr_b16 a[94:95],v7 offset:24064
ds_read_b64_tr_b16 a[96:97],v7 offset:24576
ds_read_b64_tr_b16 a[98:99],v7 offset:25600
ds_read_b64_tr_b16 a[100:101],v7 offset:25088
ds_read_b64_tr_b16 a[102:103],v7 offset:26112
s_waitcnt lgkmcnt(4)
ds_read_b64_tr_b16 a[104:105],v7 offset:26624
ds_read_b64_tr_b16 a[106:107],v7 offset:27648
ds_read_b64_tr_b16 a[108:109],v7 offset:27136
ds_read_b64_tr_b16 a[110:111],v7 offset:28160
ds_read_b64_tr_b16 a[112:113],v7 offset:28672
ds_read_b64_tr_b16 a[114:115],v7 offset:29696
ds_read_b64_tr_b16 a[116:117],v7 offset:29184
ds_read_b64_tr_b16 a[118:119],v7 offset:30208
ds_read_b64_tr_b16 a[120:121],v7 offset:30720
ds_read_b64_tr_b16 a[122:123],v7 offset:31744
ds_read_b64_tr_b16 a[124:125],v7 offset:31232
ds_read_b64_tr_b16 a[126:127],v7 offset:32256
s_waitcnt lgkmcnt(4)
ds_read_b64_tr_b16 a[128:129],v7 offset:32768
ds_read_b64_tr_b16 a[130:131],v7 offset:33792
ds_read_b64_tr_b16 a[132:133],v7 offset:33280
ds_read_b64_tr_b16 a[134:135],v7 offset:34304
ds_read_b64_tr_b16 a[136:137],v7 offset:34816
ds_read_b64_tr_b16 a[138:139],v7 offset:35840
ds_read_b64_tr_b16 a[140:141],v7 offset:35328
ds_read_b64_tr_b16 a[142:143],v7 offset:36352
ds_read_b64_tr_b16 a[144:145],v7 offset:36864
ds_read_b64_tr_b16 a[146:147],v7 offset:37888
ds_read_b64_tr_b16 a[148:149],v7 offset:37376
ds_read_b64_tr_b16 a[150:151],v7 offset:38400
s_waitcnt lgkmcnt(4)
ds_read_b64_tr_b16 a[152:153],v7 offset:38912
ds_read_b64_tr_b16 a[154:155],v7 offset:39936
ds_read_b64_tr_b16 a[156:157],v7 offset:39424
ds_read_b64_tr_b16 a[158:159],v7 offset:40448
s_waitcnt lgkmcnt(0)
v_mov_b32 v24,0x3f803f80
v_mov_b32 v25,0x3f803f80
v_mov_b32 v26,0x3f803f80
v_mov_b32 v27,0x3f803f80
s_nop 1
v_mfma_f32_32x32x16_bf16 v[144:159],a[0:3],v[24:27],0
v_mfma_f32_32x32x16_bf16 v[144:159],a[4:7],v[24:27],v[144:159]
v_mfma_f32_32x32x16_bf16 v[144:159],a[8:11],v[24:27],v[144:159]
v_mfma_f32_32x32x16_bf16 v[144:159],a[12:15],v[24:27],v[144:159]
v_mfma_f32_32x32x16_bf16 v[144:159],a[16:19],v[24:27],v[144:159]
v_mfma_f32_32x32x16_bf16 v[144:159],a[20:23],v[24:27],v[144:159]
v_mfma_f32_32x32x16_bf16 v[144:159],a[24:27],v[24:27],v[144:159]
v_mfma_f32_32x32x16_bf16 v[144:159],a[28:31],v[24:27],v[144:159]
v_mfma_f32_32x32x16_bf16 v[144:159],a[32:35],v[24:27],v[144:159]
v_mfma_f32_32x32x16_bf16 v[144:159],a[36:39],v[24:27],v[144:159]
v_mfma_f32_32x32x16_bf16 v[144:159],a[40:43],v[24:27],v[144:159]
v_mfma_f32_32x32x16_bf16 v[144:159],a[44:47],v[24:27],v[144:159]
v_mfma_f32_32x32x16_bf16 v[144:159],a[48:51],v[24:27],v[144:159]
v_mfma_f32_32x32x16_bf16 v[144:159],a[52:55],v[24:27],v[144:159]
v_mfma_f32_32x32x16_bf16 v[144:159],a[56:59],v[24:27],v[144:159]
v_mfma_f32_32x32x16_bf16 v[144:159],a[60:63],v[24:27],v[144:159]
v_mfma_f32_32x32x16_bf16 v[144:159],a[64:67],v[24:27],v[144:159]
v_mfma_f32_32x32x16_bf16 v[144:159],a[68:71],v[24:27],v[144:159]
v_mfma_f32_32x32x16_bf16 v[144:159],a[72:75],v[24:27],v[144:159]
v_mfma_f32_32x32x16_bf16 v[144:159],a[76:79],v[24:27],v[144:159]
v_mfma_f32_32x32x16_bf16 v[144:159],a[80:83],v[24:27],v[144:159]
v_mfma_f32_32x32x16_bf16 v[144:159],a[84:87],v[24:27],v[144:159]
v_mfma_f32_32x32x16_bf16 v[144:159],a[88:91],v[24:27],v[144:159]
v_mfma_f32_32x32x16_bf16 v[144:159],a[92:95],v[24:27],v[144:159]
v_mfma_f32_32x32x16_bf16 v[144:159],a[96:99],v[24:27],v[144:159]
v_mfma_f32_32x32x16_bf16 v[144:159],a[100:103],v[24:27],v[144:159]
v_mfma_f32_32x32x16_bf16 v[144:159],a[104:107],v[24:27],v[144:159]
v_mfma_f32_32x32x16_bf16 v[144:159],a[108:111],v[24:27],v[144:159]
v_mfma_f32_32x32x16_bf16 v[144:159],a[112:115],v[24:27],v[144:159]
v_mfma_f32_32x32x16_bf16 v[144:159],a[116:119],v[24:27],v[144:159]
v_mfma_f32_32x32x16_bf16 v[144:159],a[120:123],v[24:27],v[144:159]
v_mfma_f32_32x32x16_bf16 v[144:159],a[124:127],v[24:27],v[144:159]
v_mfma_f32_32x32x16_bf16 v[144:159],a[128:131],v[24:27],v[144:159]
v_mfma_f32_32x32x16_bf16 v[144:159],a[132:135],v[24:27],v[144:159]
v_mfma_f32_32x32x16_bf16 v[144:159],a[136:139],v[24:27],v[144:159]
v_mfma_f32_32x32x16_bf16 v[144:159],a[140:143],v[24:27],v[144:159]
v_mfma_f32_32x32x16_bf16 v[144:159],a[144:147],v[24:27],v[144:159]
v_mfma_f32_32x32x16_bf16 v[144:159],a[148:151],v[24:27],v[144:159]
v_mfma_f32_32x32x16_bf16 v[144:159],a[152:155],v[24:27],v[144:159]
v_mfma_f32_32x32x16_bf16 v[144:159],a[156:159],v[24:27],v[144:159]
s_barrier
s_lshl_b32 s3,s49,2
v_mov_b32 v7,s3
s_nop 8
ibw_306:
buffer_load_dword v6,v7,s[12:15],0 offen sc1
s_waitcnt vmcnt(0)
v_cmp_ne_u32 vcc,256,v6
s_nop 0
s_cbranch_vccz ok_307
s_sleep 8
s_sub_u32 s47,s47,1
s_cbranch_scc1 ABORT
s_branch ibw_306
ok_307:
s_cmp_lg_u32 s49,0
s_cbranch_scc1 ibok_308
v_and_b32 v7,7,v0
v_lshlrev_b32 v7,2,v7
buffer_load_dword v6,v7,s[12:15],0 offen offset:32 sc1
s_waitcnt vmcnt(0)
v_cmp_ne_u32 vcc,32,v6
s_nop 0
s_cbranch_vccz ibok_308
s_barrier
s_mov_b32 s49,1
s_mov_b32 s3,s2
s_load_dwordx16 s[16:31],s[0:1],0
s_load_dwordx8 s[32:39],s[0:1],64
s_waitcnt lgkmcnt(0)
s_branch DISPATCH
ibok_308:
s_mov_b32 s50,0
s_mov_b32 s32,0
s_mov_b32 s57,0
s_mov_b32 s59,2147483648
s_mov_b32 s82,2147483648
s_mov_b32 s39,2147483648
v_mov_b32 v22,94208
v_lshl_add_u32 v22,v0,2,v22
v_mov_b32 v23,0
ds_write_b32 v22,v23
s_mov_b32 s39,1600000
v_and_b32 v72,15,v0
v_lshlrev_b32 v72,7,v72
v_min_u32 v6,59,v0
v_lshlrev_b32 v6,2,v6
v_add_u32 v2,198656,v6
v_add_u32 v7,-80,v6
v_cmp_gt_u32 s[78:79],20,v0
s_nop 1
v_cndmask_b32 v2,v7,v2,s[78:79]
s_mov_b32 s51,0
s_mov_b32 s52,0
s_mul_i32 s62,s51,4
s_and_b32 s63,s52,3
s_add_u32 s62,s62,s63
s_mul_i32 s62,s62,98304
s_add_u32 s62,s62,242778112
s_lshl_b32 s63,s56,11
s_add_u32 s62,s62,s63
buffer_load_dword v73,v72,s[8:11],s62 offen sc1
s_mov_b32 s51,0
s_mov_b32 s52,1
s_mul_i32 s62,s51,4
s_and_b32 s63,s52,3
s_add_u32 s62,s62,s63
s_mul_i32 s62,s62,98304
s_add_u32 s62,s62,242778112
s_lshl_b32 s63,s56,11
s_add_u32 s62,s62,s63
buffer_load_dword v73,v72,s[8:11],s62 offen sc1
s_mov_b32 s51,0
s_mov_b32 s52,2
s_mul_i32 s62,s51,4
s_and_b32 s63,s52,3
s_add_u32 s62,s62,s63
s_mul_i32 s62,s62,98304
s_add_u32 s62,s62,242778112
s_lshl_b32 s63,s56,11
s_add_u32 s62,s62,s63
buffer_load_dword v73,v72,s[8:11],s62 offen sc1
s_mov_b32 s51,0
s_mov_b32 s52,3
s_mul_i32 s62,s51,4
s_and_b32 s63,s52,3
s_add_u32 s62,s62,s63
s_mul_i32 s62,s62,98304
s_add_u32 s62,s62,242778112
s_lshl_b32 s63,s56,11
s_add_u32 s62,s62,s63
buffer_load_dword v73,v72,s[8:11],s62 offen sc1
s_mov_b32 s51,1
s_mov_b32 s52,0
s_mul_i32 s62,s51,4
s_and_b32 s63,s52,3
s_add_u32 s62,s62,s63
s_mul_i32 s62,s62,98304
s_add_u32 s62,s62,242778112
s_lshl_b32 s63,s56,11
s_add_u32 s62,s62,s63
buffer_load_dword v73,v72,s[8:11],s62 offen sc1
s_mov_b32 s51,1
s_mov_b32 s52,1
s_mul_i32 s62,s51,4
s_and_b32 s63,s52,3
s_add_u32 s62,s62,s63
s_mul_i32 s62,s62,98304
s_add_u32 s62,s62,242778112
s_lshl_b32 s63,s56,11
s_add_u32 s62,s62,s63
buffer_load_dword v73,v72,s[8:11],s62 offen sc1
s_mov_b32 s51,1
s_mov_b32 s52,2
s_mul_i32 s62,s51,4
s_and_b32 s63,s52,3
s_add_u32 s62,s62,s63
s_mul_i32 s62,s62,98304
s_add_u32 s62,s62,242778112
s_lshl_b32 s63,s56,11
s_add_u32 s62,s62,s63
buffer_load_dword v73,v72,s[8:11],s62 offen sc1
s_mov_b32 s51,1
s_mov_b32 s52,3
s_mul_i32 s62,s51,4
s_and_b32 s63,s52,3
s_add_u32 s62,s62,s63
s_mul_i32 s62,s62,98304
s_add_u32 s62,s62,242778112
s_lshl_b32 s63,s56,11
s_add_u32 s62,s62,s63
buffer_load_dword v73,v72,s[8:11],s62 offen sc1
s_waitcnt vmcnt(0)
s_waitcnt lgkmcnt(0)
s_barrier
s_mov_b32 s83,s100
s_min_u32 s62,s32,127
s_sub_u32 s60,s62,15
s_lshr_b32 s34,s60,1
s_and_b32 s33,s60,1
s_cmp_eq_u32 s33,0
s_cselect_b32 s61,15,0
s_add_u32 s34,s34,s61
s_sub_u32 s61,s60,49
s_cmp_ge_u32 s60,98
s_cselect_b32 s34,s61,s34
s_cselect_b32 s33,1,s33
s_cmp_lt_u32 s62,15
s_cselect_b32 s34,s62,s34
s_cselect_b32 s33,0,s33
s_lshl_b32 s35,s33,6
s_add_u32 s35,s35,s34
s_lshl_b32 s35,s35,9
s_add_u32 s35,s35,325632
s_cmp_lt_u32 s34,4
s_cselect_b64 s[76:77],s[78:79],-1
s_sub_u32 s57,46080,s57
v_swap_b32 v16,v18
v_swap_b32 v17,v19
s_add_u32 s62,s32,1
s_min_u32 s62,s62,127
s_sub_u32 s60,s62,15
s_lshr_b32 s41,s60,1
s_and_b32 s40,s60,1
s_cmp_eq_u32 s40,0
s_cselect_b32 s61,15,0
s_add_u32 s41,s41,s61
s_sub_u32 s61,s60,49
s_cmp_ge_u32 s60,98
s_cselect_b32 s41,s61,s41
s_cselect_b32 s40,1,s40
s_cmp_lt_u32 s62,15
s_cselect_b32 s41,s62,s41
s_cselect_b32 s40,0,s40
s_lshl_b32 s42,s40,6
s_add_u32 s42,s42,s41
s_lshl_b32 s42,s42,9
s_add_u32 s42,s42,325632
s_cmp_lt_u32 s41,4
s_cselect_b64 s[80:81],s[78:79],-1
W3_COLD:
s_mov_b32 s37,0
fb_309:
buffer_load_dword v3,v2,s[8:11],s35 offen sc1
s_waitcnt vmcnt(0)
v_cmp_eq_u32 vcc,0,v3
s_and_b64 vcc,vcc,s[76:77]
s_cbranch_scc0 ok_310
s_sleep 1
s_sub_u32 s47,s47,1
s_cbranch_scc1 ABORT
s_branch fb_309
ok_310:
W3_COLD2:
s_sub_u32 s66,46080,s57
s_mul_i32 s60,s33,8
s_and_b32 s61,s34,7
s_add_u32 s60,s60,s61
s_mul_i32 s60,s60,46080
s_add_u32 s60,s60,s37
s_add_u32 s60,s60,212467712
s_mov_b32 s67,s60
s_mul_i32 s61,s46,10240
s_add_u32 s60,s60,s61
s_add_u32 s61,s61,s66
s_add_u32 m0,s61,0
s_add_u32 s63,s60,0
buffer_load_dwordx4 v1,s[8:11],s63 offen sc1 lds
buffer_load_dwordx4 v1,s[8:11],s63 offen offset:1024 sc1 lds
buffer_load_dwordx4 v1,s[8:11],s63 offen offset:2048 sc1 lds
buffer_load_dwordx4 v1,s[8:11],s63 offen offset:3072 sc1 lds
s_add_u32 m0,s61,4096
s_add_u32 s63,s60,4096
buffer_load_dwordx4 v1,s[8:11],s63 offen sc1 lds
buffer_load_dwordx4 v1,s[8:11],s63 offen offset:1024 sc1 lds
s_waitcnt vmcnt(5)
s_mov_b64 exec,1
s_cmp_lg_u32 s49,0
s_cbranch_scc0 ls_311
buffer_store_dword v5,v1,s[8:11],s59 offen sc1
s_branch ls_312
ls_311:
buffer_store_dword v5,v1,s[8:11],s59 offen
ls_312:
s_mov_b64 exec,-1
s_mov_b32 s59,2147483648
buffer_load_dwordx4 v1,s[8:11],s63 offen offset:2048 sc1 lds
buffer_load_dwordx4 v1,s[8:11],s63 offen offset:3072 sc1 lds
s_add_u32 m0,s61,8192
s_add_u32 s63,s60,8192
buffer_load_dwordx4 v1,s[8:11],s63 offen sc1 lds
buffer_load_dwordx4 v1,s[8:11],s63 offen offset:1024 sc1 lds
s_lshl_b32 s62,s46,10
s_add_u32 s62,s62,40960
s_add_u32 m0,s66,s62
s_add_u32 s63,s67,s62
buffer_load_dwordx4 v1,s[8:11],s63 offen sc1 lds
s_add_u32 m0,s66,45056
s_add_u32 s63,s67,45056
buffer_load_dwordx4 v1,s[8:11],s63 offen sc1 lds
s_mov_b32 s35,s42
s_mov_b32 s53,s33
s_mov_b32 s54,s34
s_add_u32 s32,s32,1
s_mov_b32 s33,s40
s_mov_b32 s34,s41
s_mov_b64 s[76:77],s[80:81]
s_sub_u32 s57,46080,s57
v_swap_b32 v16,v18
v_swap_b32 v17,v19
s_mov_b32 s51,s53
s_mov_b32 s52,s54
s_waitcnt vmcnt(7)
s_branch W3_GO
W3_NEXT:
s_sub_u32 s57,46080,s57
v_swap_b32 v16,v18
v_swap_b32 v17,v19
s_mov_b32 s51,s53
s_mov_b32 s52,s54
s_waitcnt vmcnt(2)
W3_GO:
s_barrier
ds_read_b128 v[24:27],v16 offset:0
ds_read_b128 v[28:31],v17 offset:0
ds_read_b128 v[32:35],v16 offset:10240
ds_read_b128 v[36:39],v17 offset:10240
ds_read_b128 v[40:43],v16 offset:20480
ds_read_b128 v[44:47],v17 offset:20480
ds_read_b128 v[48:51],v16 offset:30720
buffer_load_dword v3,v2,s[8:11],s35 offen sc1
s_waitcnt lgkmcnt(6)
v_mfma_f32_32x32x16_bf16 v[56:71],a[0:3],v[24:27],0
ds_read_b128 v[52:55],v17 offset:30720
s_add_u32 s62,s32,1
s_min_u32 s62,s62,127
s_sub_u32 s60,s62,15
s_waitcnt lgkmcnt(6)
v_mfma_f32_32x32x16_bf16 v[56:71],a[4:7],v[28:31],v[56:71]
ds_read_b128 v[24:27],v16 offset:2048
s_lshr_b32 s41,s60,1
s_and_b32 s40,s60,1
s_mul_i32 s71,s51,4
s_waitcnt lgkmcnt(5)
v_mfma_f32_32x32x16_bf16 v[56:71],a[40:43],v[32:35],v[56:71]
ds_read_b128 v[28:31],v17 offset:2048
s_cmp_eq_u32 s40,0
s_cselect_b32 s61,15,0
s_add_u32 s41,s41,s61
s_sub_u32 s61,s60,49
v_mfma_f32_32x32x16_bf16 v[56:71],a[44:47],v[36:39],v[56:71]
ds_read_b128 v[32:35],v16 offset:12288
s_cmp_ge_u32 s60,98
s_cselect_b32 s41,s61,s41
s_cselect_b32 s40,1,s40
s_waitcnt lgkmcnt(5)
v_mfma_f32_32x32x16_bf16 v[56:71],a[80:83],v[40:43],v[56:71]
ds_read_b128 v[36:39],v17 offset:12288
s_cmp_lt_u32 s62,15
s_cselect_b32 s41,s62,s41
s_cselect_b32 s40,0,s40
s_lshl_b32 s42,s40,6
v_mfma_f32_32x32x16_bf16 v[56:71],a[84:87],v[44:47],v[56:71]
ds_read_b128 v[40:43],v16 offset:22528
s_add_u32 s42,s42,s41
s_lshl_b32 s42,s42,9
s_add_u32 s42,s42,325632
s_waitcnt lgkmcnt(5)
v_mfma_f32_32x32x16_bf16 v[56:71],a[120:123],v[48:51],v[56:71]
ds_read_b128 v[44:47],v17 offset:22528
s_cmp_lt_u32 s41,4
s_cselect_b64 s[80:81],s[78:79],-1
s_and_b32 s72,s52,3
s_add_u32 s71,s71,s72
v_mfma_f32_32x32x16_bf16 v[56:71],a[124:127],v[52:55],v[56:71]
ds_read_b128 v[48:51],v16 offset:32768
s_mul_i32 s71,s71,98304
s_add_u32 s71,s71,242778112
s_lshl_b32 s72,s56,11
s_waitcnt lgkmcnt(5)
v_mfma_f32_32x32x16_bf16 v[56:71],a[8:11],v[24:27],v[56:71]
ds_read_b128 v[52:55],v17 offset:32768
s_add_u32 s71,s71,s72
s_lshl_b32 s82,s51,6
s_add_u32 s82,s82,s52
s_lshl_b32 s82,s82,9
v_mfma_f32_32x32x16_bf16 v[56:71],a[12:15],v[28:31],v[56:71]
ds_read_b128 v[24:27],v16 offset:4096
s_add_u32 s82,s82,589824
s_lshl_b32 s70,s56,2
s_add_u32 s82,s82,s70
s_waitcnt lgkmcnt(5)
v_mfma_f32_32x32x16_bf16 v[56:71],a[48:51],v[32:35],v[56:71]
ds_read_b128 v[28:31],v17 offset:4096
v_mfma_f32_32x32x16_bf16 v[56:71],a[52:55],v[36:39],v[56:71]
ds_read_b128 v[32:35],v16 offset:14336
s_waitcnt lgkmcnt(5)
v_mfma_f32_32x32x16_bf16 v[56:71],a[88:91],v[40:43],v[56:71]
ds_read_b128 v[36:39],v17 offset:14336
s_waitcnt vmcnt(0)
s_mov_b64 exec,1
s_cmp_lg_u32 s49,0
s_cbranch_scc0 ls_313
buffer_store_dword v5,v1,s[8:11],s59 offen sc1
s_branch ls_314
ls_313:
buffer_store_dword v5,v1,s[8:11],s59 offen
ls_314:
s_mov_b64 exec,-1
s_mov_b32 s59,2147483648
v_mfma_f32_32x32x16_bf16 v[56:71],a[92:95],v[44:47],v[56:71]
ds_read_b128 v[40:43],v16 offset:24576
v_cmp_eq_u32 vcc,0,v3
s_and_b64 vcc,vcc,s[76:77]
s_cselect_b32 s37,2147483648,0
s_waitcnt lgkmcnt(5)
v_mfma_f32_32x32x16_bf16 v[56:71],a[128:131],v[48:51],v[56:71]
ds_read_b128 v[44:47],v17 offset:24576
s_cmp_lt_u32 s32,128
s_cselect_b32 s37,s37,2147483648
s_sub_u32 s66,46080,s57
s_mul_i32 s60,s33,8
v_mfma_f32_32x32x16_bf16 v[56:71],a[132:135],v[52:55],v[56:71]
ds_read_b128 v[48:51],v16 offset:34816
s_and_b32 s61,s34,7
s_add_u32 s60,s60,s61
s_mul_i32 s60,s60,46080
s_waitcnt lgkmcnt(5)
v_mfma_f32_32x32x16_bf16 v[56:71],a[16:19],v[24:27],v[56:71]
ds_read_b128 v[52:55],v17 offset:34816
s_add_u32 s60,s60,s37
s_add_u32 s60,s60,212467712
s_mov_b32 s67,s60
s_mul_i32 s61,s46,10240
s_barrier
v_mfma_f32_32x32x16_bf16 v[56:71],a[20:23],v[28:31],v[56:71]
ds_read_b128 v[24:27],v16 offset:6144
v_add_u32 v183,s57,v182
s_add_u32 s60,s60,s61
s_add_u32 s61,s61,s66
s_waitcnt lgkmcnt(5)
v_mfma_f32_32x32x16_bf16 v[56:71],a[56:59],v[32:35],v[56:71]
ds_read_b128 v[28:31],v17 offset:6144
v_add_u32 v8,0x800,v183
s_add_u32 m0,s61,0
s_add_u32 s63,s60,0
v_mfma_f32_32x32x16_bf16 v[56:71],a[60:63],v[36:39],v[56:71]
ds_read_b128 v[32:35],v16 offset:16384
ds_read2_b64 v[160:163],v183 offset0:0 offset1:32
s_waitcnt lgkmcnt(6)
v_mfma_f32_32x32x16_bf16 v[56:71],a[96:99],v[40:43],v[56:71]
ds_read_b128 v[36:39],v17 offset:16384
ds_read2_b64 v[164:167],v183 offset0:64 offset1:96
buffer_load_dwordx4 v1,s[8:11],s63 offen sc1 lds
v_mfma_f32_32x32x16_bf16 v[56:71],a[100:103],v[44:47],v[56:71]
ds_read_b128 v[40:43],v16 offset:26624
ds_read2_b64 v[168:171],v183 offset0:128 offset1:160
s_waitcnt lgkmcnt(8)
v_mfma_f32_32x32x16_bf16 v[56:71],a[136:139],v[48:51],v[56:71]
ds_read_b128 v[44:47],v17 offset:26624
ds_read2_b64 v[172:175],v183 offset0:192 offset1:224
buffer_load_dwordx4 v1,s[8:11],s63 offen offset:1024 sc1 lds
v_mfma_f32_32x32x16_bf16 v[56:71],a[140:143],v[52:55],v[56:71]
ds_read_b128 v[48:51],v16 offset:36864
ds_read2_b64 v[176:179],v8 offset0:0 offset1:32
s_waitcnt lgkmcnt(10)
v_mfma_f32_32x32x16_bf16 v[56:71],a[24:27],v[24:27],v[56:71]
ds_read_b128 v[52:55],v17 offset:36864
buffer_load_dwordx4 v1,s[8:11],s63 offen offset:2048 sc1 lds
v_mfma_f32_32x32x16_bf16 v[56:71],a[28:31],v[28:31],v[56:71]
ds_read_b128 v[24:27],v16 offset:8192
s_waitcnt lgkmcnt(9)
v_mfma_f32_32x32x16_bf16 v[56:71],a[64:67],v[32:35],v[56:71]
ds_read_b128 v[28:31],v17 offset:8192
buffer_load_dwordx4 v1,s[8:11],s63 offen offset:3072 sc1 lds
s_add_u32 m0,s61,4096
s_add_u32 s63,s60,4096
v_mfma_f32_32x32x16_bf16 v[56:71],a[68:71],v[36:39],v[56:71]
ds_read_b128 v[32:35],v16 offset:18432
s_waitcnt lgkmcnt(4)
v_add_f32 v160,v160,v170
v_add_f32 v161,v161,v171
v_mfma_f32_32x32x16_bf16 v[56:71],a[104:107],v[40:43],v[56:71]
ds_read_b128 v[36:39],v17 offset:18432
buffer_load_dwordx4 v1,s[8:11],s63 offen sc1 lds
v_add_f32 v162,v162,v172
v_add_f32 v163,v163,v173
v_mfma_f32_32x32x16_bf16 v[56:71],a[108:111],v[44:47],v[56:71]
ds_read_b128 v[40:43],v16 offset:28672
v_add_f32 v164,v164,v174
v_add_f32 v165,v165,v175
v_add_f32 v166,v166,v176
s_waitcnt lgkmcnt(5)
v_mfma_f32_32x32x16_bf16 v[56:71],a[144:147],v[48:51],v[56:71]
ds_read_b128 v[44:47],v17 offset:28672
buffer_load_dword v3,v2,s[8:11],s35 offen sc1
v_add_f32 v167,v167,v177
v_mfma_f32_32x32x16_bf16 v[56:71],a[148:151],v[52:55],v[56:71]
ds_read_b128 v[48:51],v16 offset:38912
buffer_load_dwordx4 v1,s[8:11],s63 offen offset:1024 sc1 lds
v_add_f32 v168,v168,v178
s_waitcnt lgkmcnt(5)
v_mfma_f32_32x32x16_bf16 v[56:71],a[32:35],v[24:27],v[56:71]
ds_read_b128 v[52:55],v17 offset:38912
v_add_f32 v169,v169,v179
v_add_f32 v160,v160,v162
v_add_f32 v161,v161,v163
v_add_f32 v164,v164,v166
v_mfma_f32_32x32x16_bf16 v[56:71],a[36:39],v[28:31],v[56:71]
buffer_load_dwordx4 v1,s[8:11],s63 offen offset:2048 sc1 lds
v_add_f32 v165,v165,v167
v_add_f32 v160,v160,v164
v_add_f32 v161,v161,v165
s_waitcnt lgkmcnt(4)
v_mfma_f32_32x32x16_bf16 v[56:71],a[72:75],v[32:35],v[56:71]
v_add_f32 v160,v160,v168
v_add_f32 v161,v161,v169
v_mov_b32 v162,v160
v_mov_b32 v163,v161
s_nop 0
v_permlane32_swap_b32 v160,v162
v_mfma_f32_32x32x16_bf16 v[56:71],a[76:79],v[36:39],v[56:71]
buffer_load_dwordx4 v1,s[8:11],s63 offen offset:3072 sc1 lds
s_add_u32 m0,s61,8192
s_add_u32 s63,s60,8192
v_permlane32_swap_b32 v161,v163
s_waitcnt lgkmcnt(2)
v_mfma_f32_32x32x16_bf16 v[56:71],a[112:115],v[40:43],v[56:71]
v_add_f32 v180,v160,v162
v_add_f32 v181,v161,v163
v_mul_f32 v180,0x3acccccd,v180
v_mul_f32 v181,0x3acccccd,v181
v_fma_f32 v181,-v180,v180,v181
v_mfma_f32_32x32x16_bf16 v[56:71],a[116:119],v[44:47],v[56:71]
buffer_load_dwordx4 v1,s[8:11],s63 offen sc1 lds
v_max_f32 v181,0,v181
v_cvt_pk_bf16_f32 v8,v180,v181
v_lshlrev_b32 v180,16,v8
s_waitcnt lgkmcnt(0)
v_mfma_f32_32x32x16_bf16 v[56:71],a[152:155],v[48:51],v[56:71]
v_and_b32 v181,0xffff0000,v8
v_add_f32 v181,0x3727c5ac,v181
v_cvt_pk_bf16_f32 v8,v181,v181
v_lshlrev_b32 v181,16,v8
v_sqrt_f32 v181,v181
v_mfma_f32_32x32x16_bf16 v[56:71],a[156:159],v[52:55],v[56:71]
buffer_load_dwordx4 v1,s[8:11],s63 offen offset:1024 sc1 lds
s_lshl_b32 s62,s46,10
s_add_u32 s62,s62,40960
s_add_u32 m0,s66,s62
s_add_u32 s63,s67,s62
buffer_load_dwordx4 v1,s[8:11],s63 offen sc1 lds
s_add_u32 m0,s66,45056
s_add_u32 s63,s67,45056
buffer_load_dwordx4 v1,s[8:11],s63 offen sc1 lds
v_cvt_pk_bf16_f32 v8,v181,v181
v_lshlrev_b32 v181,16,v8
v_rcp_f32 v181,v181
s_cmp_eq_u32 s37,0
s_cbranch_scc0 sec_317
s_mov_b32 s35,s42
s_mov_b32 s53,s33
s_mov_b32 s54,s34
s_add_u32 s32,s32,1
s_mov_b32 s33,s40
s_mov_b32 s34,s41
s_mov_b64 s[76:77],s[80:81]
s_nop 2
ep_315:
v_pk_fma_f32 v[56:57],v[144:145],v[180:181],v[56:57] op_sel_hi:[1,0,1] neg_lo:[0,1,0] neg_hi:[0,1,0]
v_pk_fma_f32 v[58:59],v[146:147],v[180:181],v[58:59] op_sel_hi:[1,0,1] neg_lo:[0,1,0] neg_hi:[0,1,0]
v_pk_fma_f32 v[60:61],v[148:149],v[180:181],v[60:61] op_sel_hi:[1,0,1] neg_lo:[0,1,0] neg_hi:[0,1,0]
v_pk_fma_f32 v[62:63],v[150:151],v[180:181],v[62:63] op_sel_hi:[1,0,1] neg_lo:[0,1,0] neg_hi:[0,1,0]
v_pk_fma_f32 v[64:65],v[152:153],v[180:181],v[64:65] op_sel_hi:[1,0,1] neg_lo:[0,1,0] neg_hi:[0,1,0]
v_pk_fma_f32 v[66:67],v[154:155],v[180:181],v[66:67] op_sel_hi:[1,0,1] neg_lo:[0,1,0] neg_hi:[0,1,0]
v_pk_fma_f32 v[68:69],v[156:157],v[180:181],v[68:69] op_sel_hi:[1,0,1] neg_lo:[0,1,0] neg_hi:[0,1,0]
v_pk_fma_f32 v[70:71],v[158:159],v[180:181],v[70:71] op_sel_hi:[1,0,1] neg_lo:[0,1,0] neg_hi:[0,1,0]
v_pk_mul_f32 v[56:57],v[56:57],v[180:181] op_sel:[0,1] op_sel_hi:[1,1]
v_pk_mul_f32 v[58:59],v[58:59],v[180:181] op_sel:[0,1] op_sel_hi:[1,1]
v_pk_mul_f32 v[60:61],v[60:61],v[180:181] op_sel:[0,1] op_sel_hi:[1,1]
v_pk_mul_f32 v[62:63],v[62:63],v[180:181] op_sel:[0,1] op_sel_hi:[1,1]
v_pk_mul_f32 v[64:65],v[64:65],v[180:181] op_sel:[0,1] op_sel_hi:[1,1]
v_pk_mul_f32 v[66:67],v[66:67],v[180:181] op_sel:[0,1] op_sel_hi:[1,1]
v_pk_mul_f32 v[68:69],v[68:69],v[180:181] op_sel:[0,1] op_sel_hi:[1,1]
v_pk_mul_f32 v[70:71],v[70:71],v[180:181] op_sel:[0,1] op_sel_hi:[1,1]
v_cvt_pk_bf16_f32 v140,v56,v57
v_lshlrev_b32 v56,16,v140
v_and_b32 v57,0xffff0000,v140
v_cvt_pk_bf16_f32 v140,v58,v59
v_lshlrev_b32 v58,16,v140
v_and_b32 v59,0xffff0000,v140
v_cvt_pk_bf16_f32 v140,v60,v61
v_lshlrev_b32 v60,16,v140
v_and_b32 v61,0xffff0000,v140
v_cvt_pk_bf16_f32 v140,v62,v63
v_lshlrev_b32 v62,16,v140
v_and_b32 v63,0xffff0000,v140
v_cvt_pk_bf16_f32 v140,v64,v65
v_lshlrev_b32 v64,16,v140
v_and_b32 v65,0xffff0000,v140
v_cvt_pk_bf16_f32 v140,v66,v67
v_lshlrev_b32 v66,16,v140
v_and_b32 v67,0xffff0000,v140
v_cvt_pk_bf16_f32 v140,v68,v69
v_lshlrev_b32 v68,16,v140
v_and_b32 v69,0xffff0000,v140
v_cvt_pk_bf16_f32 v140,v70,v71
v_lshlrev_b32 v70,16,v140
v_and_b32 v71,0xffff0000,v140
v_pk_mul_f32 v[124:125],v[56:57],v[56:57]
v_pk_mul_f32 v[126:127],v[58:59],v[58:59]
v_pk_mul_f32 v[128:129],v[60:61],v[60:61]
v_pk_mul_f32 v[130:131],v[62:63],v[62:63]
v_pk_mul_f32 v[132:133],v[64:65],v[64:65]
v_pk_mul_f32 v[134:135],v[66:67],v[66:67]
v_pk_mul_f32 v[136:137],v[68:69],v[68:69]
v_pk_mul_f32 v[138:139],v[70:71],v[70:71]
v_pk_fma_f32 v[124:125],v[124:125],v[112:113],v[112:113] op_sel:[0,1,0] op_sel_hi:[1,1,0]
v_pk_fma_f32 v[126:127],v[126:127],v[112:113],v[112:113] op_sel:[0,1,0] op_sel_hi:[1,1,0]
v_pk_fma_f32 v[128:129],v[128:129],v[112:113],v[112:113] op_sel:[0,1,0] op_sel_hi:[1,1,0]
v_pk_fma_f32 v[130:131],v[130:131],v[112:113],v[112:113] op_sel:[0,1,0] op_sel_hi:[1,1,0]
v_pk_fma_f32 v[132:133],v[132:133],v[112:113],v[112:113] op_sel:[0,1,0] op_sel_hi:[1,1,0]
v_pk_fma_f32 v[134:135],v[134:135],v[112:113],v[112:113] op_sel:[0,1,0] op_sel_hi:[1,1,0]
v_pk_fma_f32 v[136:137],v[136:137],v[112:113],v[112:113] op_sel:[0,1,0] op_sel_hi:[1,1,0]
v_pk_fma_f32 v[138:139],v[138:139],v[112:113],v[112:113] op_sel:[0,1,0] op_sel_hi:[1,1,0]
v_pk_mul_f32 v[124:125],v[124:125],v[56:57]
v_pk_mul_f32 v[126:127],v[126:127],v[58:59]
v_pk_mul_f32 v[128:129],v[128:129],v[60:61]
v_pk_mul_f32 v[130:131],v[130:131],v[62:63]
v_pk_mul_f32 v[132:133],v[132:133],v[64:65]
v_pk_mul_f32 v[134:135],v[134:135],v[66:67]
v_pk_mul_f32 v[136:137],v[136:137],v[68:69]
v_pk_mul_f32 v[138:139],v[138:139],v[70:71]
v_exp_f32 v124,v124
v_exp_f32 v125,v125
v_exp_f32 v126,v126
v_exp_f32 v127,v127
v_exp_f32 v128,v128
v_exp_f32 v129,v129
v_exp_f32 v130,v130
v_exp_f32 v131,v131
v_exp_f32 v132,v132
v_exp_f32 v133,v133
v_exp_f32 v134,v134
v_exp_f32 v135,v135
v_exp_f32 v136,v136
v_exp_f32 v137,v137
v_exp_f32 v138,v138
v_exp_f32 v139,v139
v_pk_add_f32 v[124:125],v[124:125],1.0 op_sel_hi:[1,0]
v_pk_add_f32 v[126:127],v[126:127],1.0 op_sel_hi:[1,0]
v_pk_add_f32 v[128:129],v[128:129],1.0 op_sel_hi:[1,0]
v_pk_add_f32 v[130:131],v[130:131],1.0 op_sel_hi:[1,0]
v_pk_add_f32 v[132:133],v[132:133],1.0 op_sel_hi:[1,0]
v_pk_add_f32 v[134:135],v[134:135],1.0 op_sel_hi:[1,0]
v_pk_add_f32 v[136:137],v[136:137],1.0 op_sel_hi:[1,0]
v_pk_add_f32 v[138:139],v[138:139],1.0 op_sel_hi:[1,0]
v_rcp_f32 v124,v124
v_rcp_f32 v125,v125
v_rcp_f32 v126,v126
v_rcp_f32 v127,v127
v_rcp_f32 v128,v128
v_rcp_f32 v129,v129
v_rcp_f32 v130,v130
v_rcp_f32 v131,v131
v_rcp_f32 v132,v132
v_rcp_f32 v133,v133
v_rcp_f32 v134,v134
v_rcp_f32 v135,v135
v_rcp_f32 v136,v136
v_rcp_f32 v137,v137
v_rcp_f32 v138,v138
v_rcp_f32 v139,v139
v_pk_mul_f32 v[56:57],v[56:57],v[124:125]
v_pk_mul_f32 v[58:59],v[58:59],v[126:127]
v_pk_mul_f32 v[60:61],v[60:61],v[128:129]
v_pk_mul_f32 v[62:63],v[62:63],v[130:131]
v_pk_mul_f32 v[64:65],v[64:65],v[132:133]
v_pk_mul_f32 v[66:67],v[66:67],v[134:135]
v_pk_mul_f32 v[68:69],v[68:69],v[136:137]
v_pk_mul_f32 v[70:71],v[70:71],v[138:139]
v_cvt_pk_bf16_f32 v116,v56,v57
v_cvt_pk_bf16_f32 v117,v58,v59
v_cvt_pk_bf16_f32 v118,v60,v61
v_cvt_pk_bf16_f32 v119,v62,v63
v_cvt_pk_bf16_f32 v120,v64,v65
v_cvt_pk_bf16_f32 v121,v66,v67
v_cvt_pk_bf16_f32 v122,v68,v69
v_cvt_pk_bf16_f32 v123,v70,v71
s_cmp_lg_u32 s49,0
s_cbranch_scc0 ls_318
buffer_store_dwordx4 v[116:119],v20,s[8:11],s71 offen sc1
buffer_store_dwordx4 v[120:123],v21,s[8:11],s71 offen sc1
s_branch ls_319
ls_318:
buffer_store_dwordx4 v[116:119],v20,s[8:11],s71 offen
buffer_store_dwordx4 v[120:123],v21,s[8:11],s71 offen
ls_319:
s_mov_b32 s59,s82
s_cmp_eq_u32 s37,0
s_cbranch_scc1 W3_NEXT
s_waitcnt vmcnt(2)
v_cmp_eq_u32 vcc,0,v3
s_and_b64 vcc,vcc,s[76:77]
s_cselect_b32 s37,2147483648,0
s_cmp_lt_u32 s32,128
s_cselect_b32 s37,s37,2147483648
s_cmp_eq_u32 s37,0
s_cbranch_scc1 W3_COLD2
s_waitcnt vmcnt(0)
s_mov_b64 exec,1
s_cmp_lg_u32 s49,0
s_cbranch_scc0 ls_320
buffer_store_dword v5,v1,s[8:11],s59 offen sc1
s_branch ls_321
ls_320:
buffer_store_dword v5,v1,s[8:11],s59 offen
ls_321:
s_mov_b64 exec,-1
s_mov_b32 s59,2147483648
s_cmp_lt_u32 s32,128
s_cbranch_scc1 W3_COLD
s_branch W3_END
sec_317:
s_waitcnt vmcnt(7)
v_cmp_eq_u32 vcc,0,v3
s_and_b64 vcc,vcc,s[76:77]
s_cselect_b32 s37,2147483648,0
s_cmp_lt_u32 s32,128
s_cselect_b32 s37,s37,2147483648
s_cmp_lg_u32 s37,0
s_cbranch_scc1 nr_316
s_sub_u32 s66,46080,s57
s_mul_i32 s60,s33,8
s_and_b32 s61,s34,7
s_add_u32 s60,s60,s61
s_mul_i32 s60,s60,46080
s_add_u32 s60,s60,s37
s_add_u32 s60,s60,212467712
s_mov_b32 s67,s60
s_mul_i32 s61,s46,10240
s_add_u32 s60,s60,s61
s_add_u32 s61,s61,s66
s_add_u32 m0,s61,0
s_add_u32 s63,s60,0
buffer_load_dwordx4 v1,s[8:11],s63 offen sc1 lds
v_pk_fma_f32 v[56:57],v[144:145],v[180:181],v[56:57] op_sel_hi:[1,0,1] neg_lo:[0,1,0] neg_hi:[0,1,0]
v_pk_fma_f32 v[58:59],v[146:147],v[180:181],v[58:59] op_sel_hi:[1,0,1] neg_lo:[0,1,0] neg_hi:[0,1,0]
v_pk_fma_f32 v[60:61],v[148:149],v[180:181],v[60:61] op_sel_hi:[1,0,1] neg_lo:[0,1,0] neg_hi:[0,1,0]
v_pk_fma_f32 v[62:63],v[150:151],v[180:181],v[62:63] op_sel_hi:[1,0,1] neg_lo:[0,1,0] neg_hi:[0,1,0]
v_pk_fma_f32 v[64:65],v[152:153],v[180:181],v[64:65] op_sel_hi:[1,0,1] neg_lo:[0,1,0] neg_hi:[0,1,0]
v_pk_fma_f32 v[66:67],v[154:155],v[180:181],v[66:67] op_sel_hi:[1,0,1] neg_lo:[0,1,0] neg_hi:[0,1,0]
v_pk_fma_f32 v[68:69],v[156:157],v[180:181],v[68:69] op_sel_hi:[1,0,1] neg_lo:[0,1,0] neg_hi:[0,1,0]
v_pk_fma_f32 v[70:71],v[158:159],v[180:181],v[70:71] op_sel_hi:[1,0,1] neg_lo:[0,1,0] neg_hi:[0,1,0]
buffer_load_dwordx4 v1,s[8:11],s63 offen offset:1024 sc1 lds
v_pk_mul_f32 v[56:57],v[56:57],v[180:181] op_sel:[0,1] op_sel_hi:[1,1]
v_pk_mul_f32 v[58:59],v[58:59],v[180:181] op_sel:[0,1] op_sel_hi:[1,1]
v_pk_mul_f32 v[60:61],v[60:61],v[180:181] op_sel:[0,1] op_sel_hi:[1,1]
v_pk_mul_f32 v[62:63],v[62:63],v[180:181] op_sel:[0,1] op_sel_hi:[1,1]
v_pk_mul_f32 v[64:65],v[64:65],v[180:181] op_sel:[0,1] op_sel_hi:[1,1]
v_pk_mul_f32 v[66:67],v[66:67],v[180:181] op_sel:[0,1] op_sel_hi:[1,1]
v_pk_mul_f32 v[68:69],v[68:69],v[180:181] op_sel:[0,1] op_sel_hi:[1,1]
v_pk_mul_f32 v[70:71],v[70:71],v[180:181] op_sel:[0,1] op_sel_hi:[1,1]
buffer_load_dwordx4 v1,s[8:11],s63 offen offset:2048 sc1 lds
v_cvt_pk_bf16_f32 v140,v56,v57
v_lshlrev_b32 v56,16,v140
v_and_b32 v57,0xffff0000,v140
v_cvt_pk_bf16_f32 v140,v58,v59
v_lshlrev_b32 v58,16,v140
v_and_b32 v59,0xffff0000,v140
v_cvt_pk_bf16_f32 v140,v60,v61
v_lshlrev_b32 v60,16,v140
buffer_load_dwordx4 v1,s[8:11],s63 offen offset:3072 sc1 lds
v_and_b32 v61,0xffff0000,v140
v_cvt_pk_bf16_f32 v140,v62,v63
v_lshlrev_b32 v62,16,v140
v_and_b32 v63,0xffff0000,v140
v_cvt_pk_bf16_f32 v140,v64,v65
v_lshlrev_b32 v64,16,v140
v_and_b32 v65,0xffff0000,v140
v_cvt_pk_bf16_f32 v140,v66,v67
s_add_u32 m0,s61,4096
s_add_u32 s63,s60,4096
buffer_load_dwordx4 v1,s[8:11],s63 offen sc1 lds
v_lshlrev_b32 v66,16,v140
v_and_b32 v67,0xffff0000,v140
v_cvt_pk_bf16_f32 v140,v68,v69
v_lshlrev_b32 v68,16,v140
v_and_b32 v69,0xffff0000,v140
v_cvt_pk_bf16_f32 v140,v70,v71
v_lshlrev_b32 v70,16,v140
v_and_b32 v71,0xffff0000,v140
buffer_load_dwordx4 v1,s[8:11],s63 offen offset:1024 sc1 lds
v_pk_mul_f32 v[124:125],v[56:57],v[56:57]
v_pk_mul_f32 v[126:127],v[58:59],v[58:59]
v_pk_mul_f32 v[128:129],v[60:61],v[60:61]
v_pk_mul_f32 v[130:131],v[62:63],v[62:63]
v_pk_mul_f32 v[132:133],v[64:65],v[64:65]
v_pk_mul_f32 v[134:135],v[66:67],v[66:67]
v_pk_mul_f32 v[136:137],v[68:69],v[68:69]
v_pk_mul_f32 v[138:139],v[70:71],v[70:71]
buffer_load_dwordx4 v1,s[8:11],s63 offen offset:2048 sc1 lds
v_pk_fma_f32 v[124:125],v[124:125],v[112:113],v[112:113] op_sel:[0,1,0] op_sel_hi:[1,1,0]
v_pk_fma_f32 v[126:127],v[126:127],v[112:113],v[112:113] op_sel:[0,1,0] op_sel_hi:[1,1,0]
v_pk_fma_f32 v[128:129],v[128:129],v[112:113],v[112:113] op_sel:[0,1,0] op_sel_hi:[1,1,0]
v_pk_fma_f32 v[130:131],v[130:131],v[112:113],v[112:113] op_sel:[0,1,0] op_sel_hi:[1,1,0]
v_pk_fma_f32 v[132:133],v[132:133],v[112:113],v[112:113] op_sel:[0,1,0] op_sel_hi:[1,1,0]
v_pk_fma_f32 v[134:135],v[134:135],v[112:113],v[112:113] op_sel:[0,1,0] op_sel_hi:[1,1,0]
v_pk_fma_f32 v[136:137],v[136:137],v[112:113],v[112:113] op_sel:[0,1,0] op_sel_hi:[1,1,0]
v_pk_fma_f32 v[138:139],v[138:139],v[112:113],v[112:113] op_sel:[0,1,0] op_sel_hi:[1,1,0]
buffer_load_dwordx4 v1,s[8:11],s63 offen offset:3072 sc1 lds
v_pk_mul_f32 v[124:125],v[124:125],v[56:57]
v_pk_mul_f32 v[126:127],v[126:127],v[58:59]
v_pk_mul_f32 v[128:129],v[128:129],v[60:61]
v_pk_mul_f32 v[130:131],v[130:131],v[62:63]
v_pk_mul_f32 v[132:133],v[132:133],v[64:65]
v_pk_mul_f32 v[134:135],v[134:135],v[66:67]
v_pk_mul_f32 v[136:137],v[136:137],v[68:69]
v_pk_mul_f32 v[138:139],v[138:139],v[70:71]
s_add_u32 m0,s61,8192
s_add_u32 s63,s60,8192
buffer_load_dwordx4 v1,s[8:11],s63 offen sc1 lds
v_exp_f32 v124,v124
v_exp_f32 v125,v125
v_exp_f32 v126,v126
v_exp_f32 v127,v127
v_exp_f32 v128,v128
v_exp_f32 v129,v129
v_exp_f32 v130,v130
v_exp_f32 v131,v131
buffer_load_dwordx4 v1,s[8:11],s63 offen offset:1024 sc1 lds
v_exp_f32 v132,v132
v_exp_f32 v133,v133
v_exp_f32 v134,v134
v_exp_f32 v135,v135
v_exp_f32 v136,v136
v_exp_f32 v137,v137
v_exp_f32 v138,v138
v_exp_f32 v139,v139
s_lshl_b32 s62,s46,10
s_add_u32 s62,s62,40960
s_add_u32 m0,s66,s62
s_add_u32 s63,s67,s62
buffer_load_dwordx4 v1,s[8:11],s63 offen sc1 lds
v_pk_add_f32 v[124:125],v[124:125],1.0 op_sel_hi:[1,0]
v_pk_add_f32 v[126:127],v[126:127],1.0 op_sel_hi:[1,0]
v_pk_add_f32 v[128:129],v[128:129],1.0 op_sel_hi:[1,0]
v_pk_add_f32 v[130:131],v[130:131],1.0 op_sel_hi:[1,0]
v_pk_add_f32 v[132:133],v[132:133],1.0 op_sel_hi:[1,0]
v_pk_add_f32 v[134:135],v[134:135],1.0 op_sel_hi:[1,0]
v_pk_add_f32 v[136:137],v[136:137],1.0 op_sel_hi:[1,0]
v_pk_add_f32 v[138:139],v[138:139],1.0 op_sel_hi:[1,0]
s_add_u32 m0,s66,45056
s_add_u32 s63,s67,45056
buffer_load_dwordx4 v1,s[8:11],s63 offen sc1 lds
v_rcp_f32 v124,v124
v_rcp_f32 v125,v125
v_rcp_f32 v126,v126
v_rcp_f32 v127,v127
v_rcp_f32 v128,v128
v_rcp_f32 v129,v129
v_rcp_f32 v130,v130
v_rcp_f32 v131,v131
s_mov_b32 s35,s42
s_mov_b32 s53,s33
s_mov_b32 s54,s34
s_add_u32 s32,s32,1
s_mov_b32 s33,s40
s_mov_b32 s34,s41
s_mov_b64 s[76:77],s[80:81]
v_rcp_f32 v132,v132
v_rcp_f32 v133,v133
v_rcp_f32 v134,v134
v_rcp_f32 v135,v135
v_rcp_f32 v136,v136
v_rcp_f32 v137,v137
v_rcp_f32 v138,v138
v_rcp_f32 v139,v139
v_pk_mul_f32 v[56:57],v[56:57],v[124:125]
v_pk_mul_f32 v[58:59],v[58:59],v[126:127]
v_pk_mul_f32 v[60:61],v[60:61],v[128:129]
v_pk_mul_f32 v[62:63],v[62:63],v[130:131]
v_pk_mul_f32 v[64:65],v[64:65],v[132:133]
v_pk_mul_f32 v[66:67],v[66:67],v[134:135]
v_pk_mul_f32 v[68:69],v[68:69],v[136:137]
v_pk_mul_f32 v[70:71],v[70:71],v[138:139]
v_cvt_pk_bf16_f32 v116,v56,v57
v_cvt_pk_bf16_f32 v117,v58,v59
v_cvt_pk_bf16_f32 v118,v60,v61
v_cvt_pk_bf16_f32 v119,v62,v63
v_cvt_pk_bf16_f32 v120,v64,v65
v_cvt_pk_bf16_f32 v121,v66,v67
v_cvt_pk_bf16_f32 v122,v68,v69
v_cvt_pk_bf16_f32 v123,v70,v71
s_cmp_lg_u32 s49,0
s_cbranch_scc0 ls_322
buffer_store_dwordx4 v[116:119],v20,s[8:11],s71 offen sc1
buffer_store_dwordx4 v[120:123],v21,s[8:11],s71 offen sc1
s_branch ls_323
ls_322:
buffer_store_dwordx4 v[116:119],v20,s[8:11],s71 offen
buffer_store_dwordx4 v[120:123],v21,s[8:11],s71 offen
ls_323:
s_mov_b32 s59,s82
s_branch W3_NEXT
nr_316:
buffer_load_dword v3,v2,s[8:11],s35 offen sc1
s_branch ep_315
W3_END:
s_endpgm
ROLE_W4:
v_lshlrev_b32 v1,4,v0
v_mov_b32 v5,1
s_lshl_b32 s56,s48,2
s_add_u32 s56,s56,s46
v_bfe_u32 v6,v0,2,2
v_lshrrev_b32 v7,4,v0
v_add_u32 v7,v6,v7
v_and_b32 v7,3,v7
v_and_b32 v15,3,v0
v_lshlrev_b32 v15,4,v15
v_lshl_add_u32 v15,v7,6,v15
v_lshl_add_u32 v15,v6,8,v15
v_lshrrev_b32 v6,5,v0
v_bfe_u32 v7,v0,4,1
v_lshlrev_b32 v208,10,v7
v_lshl_add_u32 v208,v6,8,v208
v_and_b32 v6,15,v0
v_lshl_add_u32 v208,v6,4,v208
v_lshrrev_b32 v6,5,v0
v_add_u32 v6,2,v6
v_bfe_u32 v7,v0,4,1
v_lshlrev_b32 v209,10,v7
v_lshl_add_u32 v209,v6,8,v209
v_and_b32 v6,15,v0
v_lshl_add_u32 v209,v6,4,v209
v_min_u32 v2,11,v0
s_mul_i32 s60,s46,12
v_add_u32 v2,s60,v2
v_lshlrev_b32 v2,2,v2
s_and_b32 s60,s46,1
s_lshl_b32 s68,s48,1
s_add_u32 s68,s68,s60
s_lshr_b32 s69,s46,1
s_mul_i32 s71,s46,24576
s_mul_i32 s58,s46,491520
s_lshl_b32 s61,s48,7
s_add_u32 s58,s58,s61
s_add_u32 s71,s71,242778112
v_and_b32 v6,15,v0
v_lshlrev_b32 v204,3,v6
s_lshl_b32 s60,s69,4
v_add_u32 v6,s60,v6
v_mul_u32_u24 v205,1280,v6
v_lshrrev_b32 v6,4,v0
v_lshl_add_u32 v205,v6,3,v205
s_lshl_b32 s60,s68,6
v_add_u32 v205,s60,v205
s_mov_b32 s76,s40
s_mov_b32 s77,s41
s_mov_b32 s78,2621440
s_mov_b32 s79,0x20000
s_lshl_b32 s70,s68,1
s_add_u32 s70,s70,s69
s_lshl_b32 s70,s70,10
v_bfe_u32 v6,v0,4,1
v_lshlrev_b32 v206,14,v6
v_lshrrev_b32 v6,5,v0
v_lshl_add_u32 v206,v6,8,v206
v_and_b32 v6,15,v0
v_lshl_add_u32 v206,v6,4,v206
s_lshl_b32 s60,s46,11
v_add_u32 v206,s60,v206
s_lshl_b32 s60,s46,13
v_add_u32 v207,s60,v1
s_waitcnt vmcnt(0)
s_barrier
s_cmp_lg_u32 s46,0
s_cbranch_scc1 arr_324
v_mov_b32 v6,1
s_lshl_b32 s3,s49,2
v_mov_b32 v7,s3
s_mov_b64 exec,1
buffer_atomic_add v6,v7,s[12:15],0 offen sc1
s_mov_b64 exec,-1
arr_324:
s_mul_i32 s63,s46,40960
s_mov_b32 s4,s38
s_mov_b32 s5,s39
s_mov_b32 s6,1966080
s_mov_b32 s7,0x20000
v_lshrrev_b32 v9,3,v0
s_mov_b32 s64,1280
v_mul_lo_u32 v9,v9,s64
v_and_b32 v10,7,v0
v_lshl_add_u32 v6,v10,4,v9
s_add_u32 m0,s63,0
s_add_u32 s65,s58,0
buffer_load_dwordx4 v6,s[4:7],s65 offen lds
s_add_u32 m0,s63,1024
s_add_u32 s65,s58,10240
buffer_load_dwordx4 v6,s[4:7],s65 offen lds
s_add_u32 m0,s63,2048
s_add_u32 s65,s58,20480
buffer_load_dwordx4 v6,s[4:7],s65 offen lds
s_add_u32 m0,s63,3072
s_add_u32 s65,s58,30720
buffer_load_dwordx4 v6,s[4:7],s65 offen lds
s_add_u32 m0,s63,4096
s_add_u32 s65,s58,40960
buffer_load_dwordx4 v6,s[4:7],s65 offen lds
s_add_u32 m0,s63,5120
s_add_u32 s65,s58,51200
buffer_load_dwordx4 v6,s[4:7],s65 offen lds
s_add_u32 m0,s63,6144
s_add_u32 s65,s58,61440
buffer_load_dwordx4 v6,s[4:7],s65 offen lds
s_add_u32 m0,s63,7168
s_add_u32 s65,s58,71680
buffer_load_dwordx4 v6,s[4:7],s65 offen lds
s_add_u32 m0,s63,8192
s_add_u32 s65,s58,81920
buffer_load_dwordx4 v6,s[4:7],s65 offen lds
s_add_u32 m0,s63,9216
s_add_u32 s65,s58,92160
buffer_load_dwordx4 v6,s[4:7],s65 offen lds
s_add_u32 m0,s63,10240
s_add_u32 s65,s58,102400
buffer_load_dwordx4 v6,s[4:7],s65 offen lds
s_add_u32 m0,s63,11264
s_add_u32 s65,s58,112640
buffer_load_dwordx4 v6,s[4:7],s65 offen lds
s_add_u32 m0,s63,12288
s_add_u32 s65,s58,122880
buffer_load_dwordx4 v6,s[4:7],s65 offen lds
s_add_u32 m0,s63,13312
s_add_u32 s65,s58,133120
buffer_load_dwordx4 v6,s[4:7],s65 offen lds
s_add_u32 m0,s63,14336
s_add_u32 s65,s58,143360
buffer_load_dwordx4 v6,s[4:7],s65 offen lds
s_add_u32 m0,s63,15360
s_add_u32 s65,s58,153600
buffer_load_dwordx4 v6,s[4:7],s65 offen lds
s_add_u32 m0,s63,16384
s_add_u32 s65,s58,163840
buffer_load_dwordx4 v6,s[4:7],s65 offen lds
s_add_u32 m0,s63,17408
s_add_u32 s65,s58,174080
buffer_load_dwordx4 v6,s[4:7],s65 offen lds
s_add_u32 m0,s63,18432
s_add_u32 s65,s58,184320
buffer_load_dwordx4 v6,s[4:7],s65 offen lds
s_add_u32 m0,s63,19456
s_add_u32 s65,s58,194560
buffer_load_dwordx4 v6,s[4:7],s65 offen lds
s_add_u32 m0,s63,20480
s_add_u32 s65,s58,204800
buffer_load_dwordx4 v6,s[4:7],s65 offen lds
s_add_u32 m0,s63,21504
s_add_u32 s65,s58,215040
buffer_load_dwordx4 v6,s[4:7],s65 offen lds
s_add_u32 m0,s63,22528
s_add_u32 s65,s58,225280
buffer_load_dwordx4 v6,s[4:7],s65 offen lds
s_add_u32 m0,s63,23552
s_add_u32 s65,s58,235520
buffer_load_dwordx4 v6,s[4:7],s65 offen lds
s_add_u32 m0,s63,24576
s_add_u32 s65,s58,245760
buffer_load_dwordx4 v6,s[4:7],s65 offen lds
s_add_u32 m0,s63,25600
s_add_u32 s65,s58,256000
buffer_load_dwordx4 v6,s[4:7],s65 offen lds
s_add_u32 m0,s63,26624
s_add_u32 s65,s58,266240
buffer_load_dwordx4 v6,s[4:7],s65 offen lds
s_add_u32 m0,s63,27648
s_add_u32 s65,s58,276480
buffer_load_dwordx4 v6,s[4:7],s65 offen lds
s_add_u32 m0,s63,28672
s_add_u32 s65,s58,286720
buffer_load_dwordx4 v6,s[4:7],s65 offen lds
s_add_u32 m0,s63,29696
s_add_u32 s65,s58,296960
buffer_load_dwordx4 v6,s[4:7],s65 offen lds
s_add_u32 m0,s63,30720
s_add_u32 s65,s58,307200
buffer_load_dwordx4 v6,s[4:7],s65 offen lds
s_add_u32 m0,s63,31744
s_add_u32 s65,s58,317440
buffer_load_dwordx4 v6,s[4:7],s65 offen lds
s_add_u32 m0,s63,32768
s_add_u32 s65,s58,327680
buffer_load_dwordx4 v6,s[4:7],s65 offen lds
s_add_u32 m0,s63,33792
s_add_u32 s65,s58,337920
buffer_load_dwordx4 v6,s[4:7],s65 offen lds
s_add_u32 m0,s63,34816
s_add_u32 s65,s58,348160
buffer_load_dwordx4 v6,s[4:7],s65 offen lds
s_add_u32 m0,s63,35840
s_add_u32 s65,s58,358400
buffer_load_dwordx4 v6,s[4:7],s65 offen lds
s_add_u32 m0,s63,36864
s_add_u32 s65,s58,368640
buffer_load_dwordx4 v6,s[4:7],s65 offen lds
s_add_u32 m0,s63,37888
s_add_u32 s65,s58,378880
buffer_load_dwordx4 v6,s[4:7],s65 offen lds
s_add_u32 m0,s63,38912
s_add_u32 s65,s58,389120
buffer_load_dwordx4 v6,s[4:7],s65 offen lds
s_add_u32 m0,s63,39936
s_add_u32 s65,s58,399360
buffer_load_dwordx4 v6,s[4:7],s65 offen lds
s_waitcnt vmcnt(20)
v_bfe_u32 v9,v0,2,2
v_lshrrev_b32 v10,5,v0
v_lshl_add_u32 v9,v10,2,v9
v_mul_u32_u24 v9,128,v9
v_and_b32 v10,1,v0
v_lshl_add_u32 v9,v10,3,v9
v_bfe_u32 v10,v0,1,1
v_lshl_add_u32 v9,v10,5,v9
v_bfe_u32 v10,v0,4,1
v_lshl_add_u32 v9,v10,4,v9
v_add_u32 v7,s63,v9
ds_read_b64_tr_b16 a[0:1],v7 offset:0
ds_read_b64_tr_b16 a[2:3],v7 offset:2048
ds_read_b64_tr_b16 a[4:5],v7 offset:1024
ds_read_b64_tr_b16 a[6:7],v7 offset:3072
ds_read_b64_tr_b16 a[96:97],v7 offset:64
ds_read_b64_tr_b16 a[98:99],v7 offset:2112
ds_read_b64_tr_b16 a[100:101],v7 offset:1088
ds_read_b64_tr_b16 a[102:103],v7 offset:3136
ds_read_b64_tr_b16 a[8:9],v7 offset:4096
ds_read_b64_tr_b16 a[10:11],v7 offset:6144
ds_read_b64_tr_b16 a[12:13],v7 offset:5120
ds_read_b64_tr_b16 a[14:15],v7 offset:7168
s_waitcnt lgkmcnt(4)
ds_read_b64_tr_b16 a[104:105],v7 offset:4160
ds_read_b64_tr_b16 a[106:107],v7 offset:6208
ds_read_b64_tr_b16 a[108:109],v7 offset:5184
ds_read_b64_tr_b16 a[110:111],v7 offset:7232
ds_read_b64_tr_b16 a[16:17],v7 offset:8192
ds_read_b64_tr_b16 a[18:19],v7 offset:10240
ds_read_b64_tr_b16 a[20:21],v7 offset:9216
ds_read_b64_tr_b16 a[22:23],v7 offset:11264
ds_read_b64_tr_b16 a[112:113],v7 offset:8256
ds_read_b64_tr_b16 a[114:115],v7 offset:10304
ds_read_b64_tr_b16 a[116:117],v7 offset:9280
ds_read_b64_tr_b16 a[118:119],v7 offset:11328
s_waitcnt lgkmcnt(4)
ds_read_b64_tr_b16 a[24:25],v7 offset:12288
ds_read_b64_tr_b16 a[26:27],v7 offset:14336
ds_read_b64_tr_b16 a[28:29],v7 offset:13312
ds_read_b64_tr_b16 a[30:31],v7 offset:15360
ds_read_b64_tr_b16 a[120:121],v7 offset:12352
ds_read_b64_tr_b16 a[122:123],v7 offset:14400
ds_read_b64_tr_b16 a[124:125],v7 offset:13376
ds_read_b64_tr_b16 a[126:127],v7 offset:15424
ds_read_b64_tr_b16 a[32:33],v7 offset:16384
ds_read_b64_tr_b16 a[34:35],v7 offset:18432
ds_read_b64_tr_b16 a[36:37],v7 offset:17408
ds_read_b64_tr_b16 a[38:39],v7 offset:19456
s_waitcnt lgkmcnt(4)
ds_read_b64_tr_b16 a[128:129],v7 offset:16448
ds_read_b64_tr_b16 a[130:131],v7 offset:18496
ds_read_b64_tr_b16 a[132:133],v7 offset:17472
ds_read_b64_tr_b16 a[134:135],v7 offset:19520
s_waitcnt lgkmcnt(0)
s_add_u32 m0,s63,0
s_add_u32 s65,s58,409600
buffer_load_dwordx4 v6,s[4:7],s65 offen lds
s_add_u32 m0,s63,1024
s_add_u32 s65,s58,419840
buffer_load_dwordx4 v6,s[4:7],s65 offen lds
s_add_u32 m0,s63,2048
s_add_u32 s65,s58,430080
buffer_load_dwordx4 v6,s[4:7],s65 offen lds
s_add_u32 m0,s63,3072
s_add_u32 s65,s58,440320
buffer_load_dwordx4 v6,s[4:7],s65 offen lds
s_add_u32 m0,s63,4096
s_add_u32 s65,s58,450560
buffer_load_dwordx4 v6,s[4:7],s65 offen lds
s_add_u32 m0,s63,5120
s_add_u32 s65,s58,460800
buffer_load_dwordx4 v6,s[4:7],s65 offen lds
s_add_u32 m0,s63,6144
s_add_u32 s65,s58,471040
buffer_load_dwordx4 v6,s[4:7],s65 offen lds
s_add_u32 m0,s63,7168
s_add_u32 s65,s58,481280
buffer_load_dwordx4 v6,s[4:7],s65 offen lds
s_waitcnt vmcnt(8)
v_bfe_u32 v9,v0,2,2
v_lshrrev_b32 v10,5,v0
v_lshl_add_u32 v9,v10,2,v9
v_mul_u32_u24 v9,128,v9
v_and_b32 v10,1,v0
v_lshl_add_u32 v9,v10,3,v9
v_bfe_u32 v10,v0,1,1
v_lshl_add_u32 v9,v10,5,v9
v_bfe_u32 v10,v0,4,1
v_lshl_add_u32 v9,v10,4,v9
v_add_u32 v7,s63,v9
ds_read_b64_tr_b16 a[40:41],v7 offset:20480
ds_read_b64_tr_b16 a[42:43],v7 offset:22528
ds_read_b64_tr_b16 a[44:45],v7 offset:21504
ds_read_b64_tr_b16 a[46:47],v7 offset:23552
ds_read_b64_tr_b16 a[136:137],v7 offset:20544
ds_read_b64_tr_b16 a[138:139],v7 offset:22592
ds_read_b64_tr_b16 a[140:141],v7 offset:21568
ds_read_b64_tr_b16 a[142:143],v7 offset:23616
ds_read_b64_tr_b16 a[48:49],v7 offset:24576
ds_read_b64_tr_b16 a[50:51],v7 offset:26624
ds_read_b64_tr_b16 a[52:53],v7 offset:25600
ds_read_b64_tr_b16 a[54:55],v7 offset:27648
s_waitcnt lgkmcnt(4)
ds_read_b64_tr_b16 a[144:145],v7 offset:24640
ds_read_b64_tr_b16 a[146:147],v7 offset:26688
ds_read_b64_tr_b16 a[148:149],v7 offset:25664
ds_read_b64_tr_b16 a[150:151],v7 offset:27712
ds_read_b64_tr_b16 a[56:57],v7 offset:28672
ds_read_b64_tr_b16 a[58:59],v7 offset:30720
ds_read_b64_tr_b16 a[60:61],v7 offset:29696
ds_read_b64_tr_b16 a[62:63],v7 offset:31744
ds_read_b64_tr_b16 a[152:153],v7 offset:28736
ds_read_b64_tr_b16 a[154:155],v7 offset:30784
ds_read_b64_tr_b16 a[156:157],v7 offset:29760
ds_read_b64_tr_b16 a[158:159],v7 offset:31808
s_waitcnt lgkmcnt(4)
ds_read_b64_tr_b16 a[64:65],v7 offset:32768
ds_read_b64_tr_b16 a[66:67],v7 offset:34816
ds_read_b64_tr_b16 a[68:69],v7 offset:33792
ds_read_b64_tr_b16 a[70:71],v7 offset:35840
ds_read_b64_tr_b16 a[160:161],v7 offset:32832
ds_read_b64_tr_b16 a[162:163],v7 offset:34880
ds_read_b64_tr_b16 a[164:165],v7 offset:33856
ds_read_b64_tr_b16 a[166:167],v7 offset:35904
ds_read_b64_tr_b16 a[72:73],v7 offset:36864
ds_read_b64_tr_b16 a[74:75],v7 offset:38912
ds_read_b64_tr_b16 a[76:77],v7 offset:37888
ds_read_b64_tr_b16 a[78:79],v7 offset:39936
s_waitcnt lgkmcnt(4)
ds_read_b64_tr_b16 a[168:169],v7 offset:36928
ds_read_b64_tr_b16 a[170:171],v7 offset:38976
ds_read_b64_tr_b16 a[172:173],v7 offset:37952
ds_read_b64_tr_b16 a[174:175],v7 offset:40000
s_waitcnt lgkmcnt(0)
s_waitcnt vmcnt(0)
v_bfe_u32 v9,v0,2,2
v_lshrrev_b32 v10,5,v0
v_lshl_add_u32 v9,v10,2,v9
v_mul_u32_u24 v9,128,v9
v_and_b32 v10,1,v0
v_lshl_add_u32 v9,v10,3,v9
v_bfe_u32 v10,v0,1,1
v_lshl_add_u32 v9,v10,5,v9
v_bfe_u32 v10,v0,4,1
v_lshl_add_u32 v9,v10,4,v9
v_add_u32 v7,s63,v9
ds_read_b64_tr_b16 a[80:81],v7 offset:0
ds_read_b64_tr_b16 a[82:83],v7 offset:2048
ds_read_b64_tr_b16 a[84:85],v7 offset:1024
ds_read_b64_tr_b16 a[86:87],v7 offset:3072
ds_read_b64_tr_b16 a[176:177],v7 offset:64
ds_read_b64_tr_b16 a[178:179],v7 offset:2112
ds_read_b64_tr_b16 a[180:181],v7 offset:1088
ds_read_b64_tr_b16 a[182:183],v7 offset:3136
ds_read_b64_tr_b16 a[88:89],v7 offset:4096
ds_read_b64_tr_b16 a[90:91],v7 offset:6144
ds_read_b64_tr_b16 a[92:93],v7 offset:5120
ds_read_b64_tr_b16 a[94:95],v7 offset:7168
s_waitcnt lgkmcnt(4)
ds_read_b64_tr_b16 a[184:185],v7 offset:4160
ds_read_b64_tr_b16 a[186:187],v7 offset:6208
ds_read_b64_tr_b16 a[188:189],v7 offset:5184
ds_read_b64_tr_b16 a[190:191],v7 offset:7232
s_waitcnt lgkmcnt(0)
s_barrier
s_lshl_b32 s3,s49,2
v_mov_b32 v7,s3
s_nop 1
ibw_325:
buffer_load_dword v6,v7,s[12:15],0 offen sc1
s_waitcnt vmcnt(0)
v_cmp_ne_u32 vcc,256,v6
s_nop 0
s_cbranch_vccz ok_326
s_sleep 8
s_sub_u32 s47,s47,1
s_cbranch_scc1 ABORT
s_branch ibw_325
ok_326:
s_cmp_lg_u32 s49,0
s_cbranch_scc1 ibok_327
v_and_b32 v7,7,v0
v_lshlrev_b32 v7,2,v7
buffer_load_dword v6,v7,s[12:15],0 offen offset:32 sc1
s_waitcnt vmcnt(0)
v_cmp_ne_u32 vcc,32,v6
s_nop 0
s_cbranch_vccz ibok_327
s_barrier
s_mov_b32 s49,1
s_mov_b32 s3,s2
s_load_dwordx16 s[16:31],s[0:1],0
s_load_dwordx8 s[32:39],s[0:1],64
s_waitcnt lgkmcnt(0)
s_branch DISPATCH
ibok_327:
s_mov_b32 s83,s100
s_mov_b32 s32,0
s_mov_b32 s59,2147483648
s_min_u32 s62,s32,127
s_sub_u32 s60,s62,16
s_lshr_b32 s34,s60,1
s_and_b32 s33,s60,1
s_cmp_eq_u32 s33,0
s_cselect_b32 s61,16,0
s_add_u32 s34,s34,s61
s_sub_u32 s61,s60,48
s_cmp_ge_u32 s60,96
s_cselect_b32 s34,s61,s34
s_cselect_b32 s33,1,s33
s_cmp_lt_u32 s62,16
s_cselect_b32 s34,s62,s34
s_cselect_b32 s33,0,s33
s_lshl_b32 s35,s33,6
s_add_u32 s35,s35,s34
s_lshl_b32 s35,s35,9
s_add_u32 s35,s35,589824
s_and_b32 s60,s34,3
s_lshl2_add_u32 s60,s33,s60
s_mul_i32 s73,s60,98304
s_add_u32 s73,s73,s71
s_add_u32 s62,s32,1
s_min_u32 s62,s62,127
s_sub_u32 s60,s62,16
s_lshr_b32 s29,s60,1
s_and_b32 s28,s60,1
s_cmp_eq_u32 s28,0
s_cselect_b32 s61,16,0
s_add_u32 s29,s29,s61
s_sub_u32 s61,s60,48
s_cmp_ge_u32 s60,96
s_cselect_b32 s29,s61,s29
s_cselect_b32 s28,1,s28
s_cmp_lt_u32 s62,16
s_cselect_b32 s29,s62,s29
s_cselect_b32 s28,0,s28
s_lshl_b32 s30,s28,6
s_add_u32 s30,s30,s29
s_lshl_b32 s30,s30,9
s_add_u32 s30,s30,589824
s_and_b32 s60,s29,3
s_lshl2_add_u32 s60,s28,s60
s_mul_i32 s31,s60,98304
s_add_u32 s31,s31,s71
W4_COLD:
buffer_load_dword v3,v2,s[8:11],s35 offen sc1
s_waitcnt vmcnt(1)
s_mov_b64 exec,1
buffer_store_dword v5,v1,s[8:11],s59 offen sc1
s_mov_b64 exec,-1
s_mov_b32 s59,2147483648
s_cmp_ge_u32 s32,128
s_cbranch_scc1 W4_END
s_waitcnt vmcnt(1)
v_cmp_eq_u32 vcc,0,v3
s_nop 0
s_cbranch_vccz W4_RDY
fb_328:
buffer_load_dword v3,v2,s[8:11],s35 offen sc1
s_waitcnt vmcnt(0)
v_cmp_eq_u32 vcc,0,v3
s_nop 0
s_cbranch_vccz ok_329
s_sleep 1
s_sub_u32 s47,s47,1
s_cbranch_scc1 ABORT
s_branch fb_328
ok_329:
W4_RDY:
s_add_u32 s63,s73,0
buffer_load_dwordx4 v[16:19],v1,s[8:11],s63 offen sc1
s_nop 7
buffer_load_dwordx4 v[20:23],v1,s[8:11],s63 offen offset:1024 sc1
s_nop 7
buffer_load_dwordx4 v[24:27],v1,s[8:11],s63 offen offset:2048 sc1
s_nop 7
buffer_load_dwordx4 v[28:31],v1,s[8:11],s63 offen offset:3072 sc1
s_nop 7
s_add_u32 s63,s73,4096
buffer_load_dwordx4 v[32:35],v1,s[8:11],s63 offen sc1
s_nop 7
buffer_load_dwordx4 v[36:39],v1,s[8:11],s63 offen offset:1024 sc1
s_nop 7
buffer_load_dwordx4 v[40:43],v1,s[8:11],s63 offen offset:2048 sc1
s_nop 7
buffer_load_dwordx4 v[44:47],v1,s[8:11],s63 offen offset:3072 sc1
W4_C:
s_mov_b32 s51,s33
s_mov_b32 s52,s34
s_mov_b32 s72,s73
s_add_u32 s32,s32,1
s_mov_b32 s33,s28
s_mov_b32 s34,s29
s_mov_b32 s35,s30
s_mov_b32 s73,s31
s_waitcnt vmcnt(7)
v_mfma_f32_32x32x16_bf16 v[112:127],a[0:3],v[16:19],0
s_add_u32 s63,s72,8192
buffer_load_dwordx4 v[48:51],v1,s[8:11],s63 offen sc1
v_xor_b32 v206,0x8000,v206
v_xor_b32 v207,0x8000,v207
s_lshl_b32 s64,s51,6
v_mfma_f32_32x32x16_bf16 v[128:143],a[96:99],v[16:19],0
s_add_u32 s64,s64,s52
s_and_b32 s65,s52,7
s_lshl3_add_u32 s65,s51,s65
s_mul_i32 s65,s65,46080
s_add_u32 s65,s65,s70
s_add_u32 s65,s65,212467712
s_waitcnt vmcnt(7)
v_mfma_f32_32x32x16_bf16 v[112:127],a[4:7],v[20:23],v[112:127]
buffer_load_dwordx4 v[52:55],v1,s[8:11],s63 offen offset:1024 sc1
buffer_load_dwordx4 v[176:179],v1,s[8:11],s65 offen sc1
s_mul_i32 s65,s64,40960
s_add_u32 s65,s65,s70
v_mfma_f32_32x32x16_bf16 v[128:143],a[100:103],v[20:23],v[128:143]
s_add_u32 s65,s65,218365952
buffer_load_dwordx4 v[180:183],v15,s[8:11],s65 offen sc1
s_lshl_b32 s82,s64,9
s_lshl2_add_u32 s82,s56,s82
s_add_u32 s42,s82,32768
s_waitcnt vmcnt(9)
v_mfma_f32_32x32x16_bf16 v[112:127],a[8:11],v[24:27],v[112:127]
buffer_load_dwordx4 v[56:59],v1,s[8:11],s63 offen offset:2048 sc1
s_add_u32 s82,s82,327680
s_mul_i32 s41,s52,46080
s_add_u32 s41,s41,209518592
s_add_u32 s40,s41,s70
v_mfma_f32_32x32x16_bf16 v[128:143],a[104:107],v[24:27],v[128:143]
s_lshr_b32 s64,s70,3
s_add_u32 s41,s41,s64
s_add_u32 s41,s41,40960
s_mul_i32 s64,s52,40960
s_add_u32 s62,s32,1
s_min_u32 s62,s62,127
s_waitcnt vmcnt(9)
v_mfma_f32_32x32x16_bf16 v[112:127],a[12:15],v[28:31],v[112:127]
buffer_load_dwordx4 v[60:63],v1,s[8:11],s63 offen offset:3072 sc1
s_add_u32 s63,s72,12288
s_cmp_lg_u32 s51,0
s_cselect_b32 s40,s64,s40
s_cselect_b32 s42,2147483648,s42
v_mfma_f32_32x32x16_bf16 v[128:143],a[108:111],v[28:31],v[128:143]
s_sub_u32 s60,s62,16
s_lshr_b32 s29,s60,1
s_and_b32 s28,s60,1
s_cmp_eq_u32 s28,0
s_cselect_b32 s61,16,0
s_add_u32 s29,s29,s61
s_waitcnt vmcnt(9)
v_mfma_f32_32x32x16_bf16 v[112:127],a[16:19],v[32:35],v[112:127]
buffer_load_dwordx4 v[64:67],v1,s[8:11],s63 offen sc1
s_sub_u32 s61,s60,48
s_cmp_ge_u32 s60,96
s_cselect_b32 s29,s61,s29
s_cselect_b32 s28,1,s28
v_mfma_f32_32x32x16_bf16 v[128:143],a[112:115],v[32:35],v[128:143]
s_cmp_lt_u32 s62,16
s_cselect_b32 s29,s62,s29
s_cselect_b32 s28,0,s28
s_lshl_b32 s30,s28,6
s_add_u32 s30,s30,s29
s_lshl_b32 s30,s30,9
s_waitcnt vmcnt(9)
v_mfma_f32_32x32x16_bf16 v[112:127],a[20:23],v[36:39],v[112:127]
buffer_load_dwordx4 v[68:71],v1,s[8:11],s63 offen offset:1024 sc1
s_add_u32 s30,s30,589824
s_and_b32 s60,s29,3
s_lshl2_add_u32 s60,s28,s60
s_mul_i32 s31,s60,98304
v_mfma_f32_32x32x16_bf16 v[128:143],a[116:119],v[36:39],v[128:143]
s_add_u32 s31,s31,s71
s_waitcnt vmcnt(9)
v_mfma_f32_32x32x16_bf16 v[112:127],a[24:27],v[40:43],v[112:127]
buffer_load_dwordx4 v[72:75],v1,s[8:11],s63 offen offset:2048 sc1
v_mfma_f32_32x32x16_bf16 v[128:143],a[120:123],v[40:43],v[128:143]
s_waitcnt vmcnt(9)
v_mfma_f32_32x32x16_bf16 v[112:127],a[28:31],v[44:47],v[112:127]
buffer_load_dwordx4 v[76:79],v1,s[8:11],s63 offen offset:3072 sc1
s_add_u32 s63,s72,16384
v_mfma_f32_32x32x16_bf16 v[128:143],a[124:127],v[44:47],v[128:143]
s_waitcnt vmcnt(9)
v_mfma_f32_32x32x16_bf16 v[112:127],a[32:35],v[48:51],v[112:127]
buffer_load_dwordx4 v[80:83],v1,s[8:11],s63 offen sc1
s_mov_b64 exec,1
buffer_store_dword v5,v1,s[8:11],s59 offen sc1
s_mov_b64 exec,-1
s_mov_b32 s59,2147483648
v_mfma_f32_32x32x16_bf16 v[128:143],a[128:131],v[48:51],v[128:143]
buffer_load_dword v3,v2,s[8:11],s35 offen sc1
s_waitcnt vmcnt(11)
v_mfma_f32_32x32x16_bf16 v[112:127],a[36:39],v[52:55],v[112:127]
buffer_load_dwordx4 v[84:87],v1,s[8:11],s63 offen offset:1024 sc1
v_mfma_f32_32x32x16_bf16 v[128:143],a[132:135],v[52:55],v[128:143]
s_waitcnt vmcnt(9)
v_mfma_f32_32x32x16_bf16 v[112:127],a[40:43],v[56:59],v[112:127]
buffer_load_dwordx4 v[88:91],v1,s[8:11],s63 offen offset:2048 sc1
v_mfma_f32_32x32x16_bf16 v[128:143],a[136:139],v[56:59],v[128:143]
s_waitcnt vmcnt(9)
v_mfma_f32_32x32x16_bf16 v[112:127],a[44:47],v[60:63],v[112:127]
buffer_load_dwordx4 v[92:95],v1,s[8:11],s63 offen offset:3072 sc1
s_add_u32 s63,s72,20480
v_mfma_f32_32x32x16_bf16 v[128:143],a[140:143],v[60:63],v[128:143]
s_waitcnt vmcnt(9)
v_mfma_f32_32x32x16_bf16 v[112:127],a[48:51],v[64:67],v[112:127]
buffer_load_dwordx4 v[96:99],v1,s[8:11],s63 offen sc1
v_mfma_f32_32x32x16_bf16 v[128:143],a[144:147],v[64:67],v[128:143]
s_waitcnt vmcnt(9)
v_mfma_f32_32x32x16_bf16 v[112:127],a[52:55],v[68:71],v[112:127]
buffer_load_dwordx4 v[100:103],v1,s[8:11],s63 offen offset:1024 sc1
v_mfma_f32_32x32x16_bf16 v[128:143],a[148:151],v[68:71],v[128:143]
s_waitcnt vmcnt(9)
v_mfma_f32_32x32x16_bf16 v[112:127],a[56:59],v[72:75],v[112:127]
buffer_load_dwordx4 v[104:107],v1,s[8:11],s63 offen offset:2048 sc1
v_mfma_f32_32x32x16_bf16 v[128:143],a[152:155],v[72:75],v[128:143]
s_waitcnt vmcnt(6)
v_cmp_eq_u32 vcc,0,v3
s_cmp_eq_u64 vcc,0
s_cselect_b32 s37,0,2147483648
s_cmp_lt_u32 s32,128
s_cselect_b32 s37,s37,2147483648
v_mfma_f32_32x32x16_bf16 v[112:127],a[60:63],v[76:79],v[112:127]
buffer_load_dwordx4 v[108:111],v1,s[8:11],s63 offen offset:3072 sc1
s_cmp_eq_u32 s37,0
v_mfma_f32_32x32x16_bf16 v[128:143],a[156:159],v[76:79],v[128:143]
s_cbranch_scc0 no_330
v_mfma_f32_32x32x16_bf16 v[112:127],a[64:67],v[80:83],v[112:127]
s_add_u32 s63,s73,0
buffer_load_dwordx4 v[16:19],v1,s[8:11],s63 offen sc1
v_mfma_f32_32x32x16_bf16 v[128:143],a[160:163],v[80:83],v[128:143]
s_waitcnt vmcnt(7)
v_mfma_f32_32x32x16_bf16 v[112:127],a[68:71],v[84:87],v[112:127]
buffer_load_dwordx4 v[20:23],v1,s[8:11],s63 offen offset:1024 sc1
v_mfma_f32_32x32x16_bf16 v[128:143],a[164:167],v[84:87],v[128:143]
s_waitcnt vmcnt(7)
v_mfma_f32_32x32x16_bf16 v[112:127],a[72:75],v[88:91],v[112:127]
buffer_load_dwordx4 v[24:27],v1,s[8:11],s63 offen offset:2048 sc1
v_mfma_f32_32x32x16_bf16 v[128:143],a[168:171],v[88:91],v[128:143]
v_lshlrev_b32 v184,16,v176
v_and_b32 v185,0xffff0000,v176
v_lshlrev_b32 v186,16,v177
v_and_b32 v187,0xffff0000,v177
v_lshlrev_b32 v188,16,v178
s_waitcnt vmcnt(7)
v_mfma_f32_32x32x16_bf16 v[112:127],a[76:79],v[92:95],v[112:127]
buffer_load_dwordx4 v[28:31],v1,s[8:11],s63 offen offset:3072 sc1
s_add_u32 s63,s73,4096
v_and_b32 v189,0xffff0000,v178
v_lshlrev_b32 v190,16,v179
v_and_b32 v191,0xffff0000,v179
v_mfma_f32_32x32x16_bf16 v[128:143],a[172:175],v[92:95],v[128:143]
v_lshlrev_b32 v192,16,v180
v_and_b32 v193,0xffff0000,v180
v_lshlrev_b32 v194,16,v181
v_and_b32 v195,0xffff0000,v181
v_lshlrev_b32 v196,16,v182
s_waitcnt vmcnt(7)
v_mfma_f32_32x32x16_bf16 v[112:127],a[80:83],v[96:99],v[112:127]
buffer_load_dwordx4 v[32:35],v1,s[8:11],s63 offen sc1
v_and_b32 v197,0xffff0000,v182
v_lshlrev_b32 v198,16,v183
v_and_b32 v199,0xffff0000,v183
s_waitcnt vmcnt(7)
v_mfma_f32_32x32x16_bf16 v[112:127],a[84:87],v[100:103],v[112:127]
s_waitcnt vmcnt(6)
v_mfma_f32_32x32x16_bf16 v[112:127],a[88:91],v[104:107],v[112:127]
buffer_load_dwordx4 v[36:39],v1,s[8:11],s63 offen offset:1024 sc1
s_waitcnt vmcnt(6)
v_mfma_f32_32x32x16_bf16 v[112:127],a[92:95],v[108:111],v[112:127]
v_mfma_f32_32x32x16_bf16 v[128:143],a[176:179],v[96:99],v[128:143]
buffer_load_dwordx4 v[40:43],v1,s[8:11],s63 offen offset:2048 sc1
s_mov_b64 exec,1
s_cmp_lg_u32 s49,0
s_cbranch_scc0 ls_331
buffer_store_dword v5,v1,s[8:11],s82 offen sc1
s_branch ls_332
ls_331:
buffer_store_dword v5,v1,s[8:11],s82 offen
ls_332:
s_mov_b64 exec,-1
v_mfma_f32_32x32x16_bf16 v[128:143],a[180:183],v[100:103],v[128:143]
ds_write_b128 v206,v[112:115] offset:0
ds_write_b128 v206,v[116:119] offset:1024
ds_write_b128 v206,v[120:123] offset:512
v_mfma_f32_32x32x16_bf16 v[128:143],a[184:187],v[104:107],v[128:143]
buffer_load_dwordx4 v[44:47],v1,s[8:11],s63 offen offset:3072 sc1
ds_write_b128 v206,v[124:127] offset:1536
v_mfma_f32_32x32x16_bf16 v[128:143],a[188:191],v[108:111],v[128:143]
buffer_load_dword v3,v2,s[8:11],s30 offen sc1
s_nop 5
s_branch W4_E1
no_330:
v_mfma_f32_32x32x16_bf16 v[112:127],a[64:67],v[80:83],v[112:127]
v_mfma_f32_32x32x16_bf16 v[128:143],a[160:163],v[80:83],v[128:143]
s_waitcnt vmcnt(6)
v_mfma_f32_32x32x16_bf16 v[112:127],a[68:71],v[84:87],v[112:127]
v_mfma_f32_32x32x16_bf16 v[128:143],a[164:167],v[84:87],v[128:143]
s_waitcnt vmcnt(5)
v_mfma_f32_32x32x16_bf16 v[112:127],a[72:75],v[88:91],v[112:127]
v_mfma_f32_32x32x16_bf16 v[128:143],a[168:171],v[88:91],v[128:143]
v_lshlrev_b32 v184,16,v176
v_and_b32 v185,0xffff0000,v176
v_lshlrev_b32 v186,16,v177
v_and_b32 v187,0xffff0000,v177
v_lshlrev_b32 v188,16,v178
s_waitcnt vmcnt(4)
v_mfma_f32_32x32x16_bf16 v[112:127],a[76:79],v[92:95],v[112:127]
buffer_load_dword v3,v2,s[8:11],s35 offen sc1
v_and_b32 v189,0xffff0000,v178
v_lshlrev_b32 v190,16,v179
v_and_b32 v191,0xffff0000,v179
v_lshlrev_b32 v192,16,v180
v_mfma_f32_32x32x16_bf16 v[128:143],a[172:175],v[92:95],v[128:143]
v_and_b32 v193,0xffff0000,v180
v_lshlrev_b32 v194,16,v181
v_and_b32 v195,0xffff0000,v181
v_lshlrev_b32 v196,16,v182
v_and_b32 v197,0xffff0000,v182
s_waitcnt vmcnt(4)
v_mfma_f32_32x32x16_bf16 v[112:127],a[80:83],v[96:99],v[112:127]
v_lshlrev_b32 v198,16,v183
v_and_b32 v199,0xffff0000,v183
s_waitcnt vmcnt(3)
v_mfma_f32_32x32x16_bf16 v[112:127],a[84:87],v[100:103],v[112:127]
s_waitcnt vmcnt(2)
v_mfma_f32_32x32x16_bf16 v[112:127],a[88:91],v[104:107],v[112:127]
s_waitcnt vmcnt(1)
v_mfma_f32_32x32x16_bf16 v[112:127],a[92:95],v[108:111],v[112:127]
v_mfma_f32_32x32x16_bf16 v[128:143],a[176:179],v[96:99],v[128:143]
s_mov_b64 exec,1
s_cmp_lg_u32 s49,0
s_cbranch_scc0 ls_333
buffer_store_dword v5,v1,s[8:11],s82 offen sc1
s_branch ls_334
ls_333:
buffer_store_dword v5,v1,s[8:11],s82 offen
ls_334:
s_mov_b64 exec,-1
v_mfma_f32_32x32x16_bf16 v[128:143],a[180:183],v[100:103],v[128:143]
ds_write_b128 v206,v[112:115] offset:0
ds_write_b128 v206,v[116:119] offset:1024
ds_write_b128 v206,v[120:123] offset:512
v_mfma_f32_32x32x16_bf16 v[128:143],a[184:187],v[104:107],v[128:143]
ds_write_b128 v206,v[124:127] offset:1536
v_mfma_f32_32x32x16_bf16 v[128:143],a[188:191],v[108:111],v[128:143]
s_waitcnt vmcnt(1)
v_cmp_eq_u32 vcc,0,v3
s_cmp_eq_u64 vcc,0
s_cselect_b32 s37,0,2147483648
s_cmp_lt_u32 s32,128
s_cselect_b32 s37,s37,2147483648
s_cmp_eq_u32 s37,0
s_cbranch_scc1 W4_E2
s_branch W4_E0
W4_E2:
s_add_u32 s63,s73,0
buffer_load_dwordx4 v[16:19],v1,s[8:11],s63 offen sc1
s_nop 2
ds_write_b128 v206,v[128:131] offset:8192
ds_write_b128 v206,v[132:135] offset:9216
buffer_load_dwordx4 v[20:23],v1,s[8:11],s63 offen offset:1024 sc1
ds_write_b128 v206,v[136:139] offset:8704
ds_write_b128 v206,v[140:143] offset:9728
buffer_load_dwordx4 v[24:27],v1,s[8:11],s63 offen offset:2048 sc1
s_waitcnt lgkmcnt(0)
s_barrier
ds_read_b128 v[144:147],v207 offset:0
ds_read_b128 v[148:151],v207 offset:1024
ds_read_b128 v[152:155],v207 offset:2048
ds_read_b128 v[156:159],v207 offset:3072
ds_read_b128 v[160:163],v207 offset:4096
ds_read_b128 v[164:167],v207 offset:5120
ds_read_b128 v[168:171],v207 offset:6144
ds_read_b128 v[172:175],v207 offset:7168
buffer_load_dwordx4 v[28:31],v1,s[8:11],s63 offen offset:3072 sc1
s_add_u32 s63,s73,4096
buffer_load_dwordx4 v[32:35],v1,s[8:11],s63 offen sc1
buffer_load_dwordx4 v[36:39],v1,s[8:11],s63 offen offset:1024 sc1
s_waitcnt lgkmcnt(4)
v_pk_add_f32 v[144:145],v[144:145],v[152:153]
v_pk_add_f32 v[146:147],v[146:147],v[154:155]
v_pk_add_f32 v[148:149],v[148:149],v[156:157]
v_pk_add_f32 v[150:151],v[150:151],v[158:159]
s_waitcnt lgkmcnt(0)
v_pk_add_f32 v[160:161],v[160:161],v[168:169]
v_pk_add_f32 v[162:163],v[162:163],v[170:171]
v_pk_add_f32 v[164:165],v[164:165],v[172:173]
v_pk_add_f32 v[166:167],v[166:167],v[174:175]
buffer_load_dwordx4 v[40:43],v1,s[8:11],s63 offen offset:2048 sc1
v_pk_add_f32 v[144:145],v[144:145],v[160:161]
v_pk_add_f32 v[146:147],v[146:147],v[162:163]
v_pk_add_f32 v[148:149],v[148:149],v[164:165]
v_pk_add_f32 v[150:151],v[150:151],v[166:167]
v_cvt_pk_bf16_f32 v6,v144,v145
v_lshlrev_b32 v144,16,v6
v_and_b32 v145,0xffff0000,v6
v_cvt_pk_bf16_f32 v6,v146,v147
v_lshlrev_b32 v146,16,v6
v_and_b32 v147,0xffff0000,v6
v_cvt_pk_bf16_f32 v6,v148,v149
v_lshlrev_b32 v148,16,v6
v_and_b32 v149,0xffff0000,v6
v_cvt_pk_bf16_f32 v6,v150,v151
v_lshlrev_b32 v150,16,v6
v_and_b32 v151,0xffff0000,v6
buffer_load_dwordx4 v[44:47],v1,s[8:11],s63 offen offset:3072 sc1
v_pk_add_f32 v[144:145],v[144:145],v[184:185]
v_pk_add_f32 v[146:147],v[146:147],v[186:187]
v_pk_add_f32 v[148:149],v[148:149],v[188:189]
v_pk_add_f32 v[150:151],v[150:151],v[190:191]
v_cvt_pk_bf16_f32 v6,v144,v145
v_lshlrev_b32 v144,16,v6
v_and_b32 v145,0xffff0000,v6
v_cvt_pk_bf16_f32 v6,v146,v147
v_lshlrev_b32 v146,16,v6
v_and_b32 v147,0xffff0000,v6
v_cvt_pk_bf16_f32 v6,v148,v149
v_lshlrev_b32 v148,16,v6
v_and_b32 v149,0xffff0000,v6
v_cvt_pk_bf16_f32 v6,v150,v151
v_lshlrev_b32 v150,16,v6
v_and_b32 v151,0xffff0000,v6
v_pk_add_f32 v[144:145],v[144:145],v[192:193]
v_pk_add_f32 v[146:147],v[146:147],v[194:195]
v_pk_add_f32 v[148:149],v[148:149],v[196:197]
v_pk_add_f32 v[150:151],v[150:151],v[198:199]
v_cvt_pk_bf16_f32 v200,v144,v145
v_cvt_pk_bf16_f32 v201,v146,v147
v_cvt_pk_bf16_f32 v202,v148,v149
v_cvt_pk_bf16_f32 v203,v150,v151
s_cmp_lg_u32 s51,0
s_cbranch_scc1 w4o_335
buffer_store_dwordx4 v[200:203],v15,s[8:11],s40 offen sc1
v_lshlrev_b32 v144,16,v200
v_and_b32 v145,0xffff0000,v200
v_lshlrev_b32 v146,16,v201
v_and_b32 v147,0xffff0000,v201
v_lshlrev_b32 v148,16,v202
v_and_b32 v149,0xffff0000,v202
v_lshlrev_b32 v150,16,v203
v_and_b32 v151,0xffff0000,v203
v_pk_add_f32 v[6:7],v[144:145],v[146:147]
v_pk_mul_f32 v[8:9],v[144:145],v[144:145]
v_pk_fma_f32 v[8:9],v[146:147],v[146:147],v[8:9]
v_pk_add_f32 v[6:7],v[6:7],v[148:149]
v_pk_fma_f32 v[8:9],v[148:149],v[148:149],v[8:9]
v_pk_add_f32 v[6:7],v[6:7],v[150:151]
v_pk_fma_f32 v[8:9],v[150:151],v[150:151],v[8:9]
v_add_f32 v6,v6,v7
v_add_f32 v7,v8,v9
s_nop 1
v_permlane32_swap_b32 v6,v7
v_add_f32 v6,v6,v7
v_mov_b32 v7,v6
s_nop 1
v_permlane16_swap_b32 v6,v7
v_add_f32 v6,v6,v7
v_mov_b32 v7,v6
s_nop 1
v_permlane32_swap_b32 v6,v7
s_mov_b64 exec,0xffff
buffer_store_dwordx2 v[6:7],v204,s[8:11],s41 offen sc1
s_mov_b64 exec,-1
s_branch w4n_336
w4o_335:
buffer_store_dwordx2 v[200:201],v205,s[76:79],s40 offen
buffer_store_dwordx2 v[202:203],v205,s[76:79],s40 offen offset:32
w4n_336:
s_mov_b32 s59,s42
s_branch W4_C
W4_E1:
s_add_u32 s63,s73,8192
buffer_load_dwordx4 v[48:51],v1,s[8:11],s63 offen sc1
s_nop 2
ds_write_b128 v206,v[128:131] offset:8192
ds_write_b128 v206,v[132:135] offset:9216
buffer_load_dwordx4 v[52:55],v1,s[8:11],s63 offen offset:1024 sc1
ds_write_b128 v206,v[136:139] offset:8704
ds_write_b128 v206,v[140:143] offset:9728
buffer_load_dwordx4 v[56:59],v1,s[8:11],s63 offen offset:2048 sc1
s_waitcnt lgkmcnt(0)
s_barrier
ds_read_b128 v[144:147],v207 offset:0
ds_read_b128 v[148:151],v207 offset:1024
ds_read_b128 v[152:155],v207 offset:2048
ds_read_b128 v[156:159],v207 offset:3072
ds_read_b128 v[160:163],v207 offset:4096
ds_read_b128 v[164:167],v207 offset:5120
ds_read_b128 v[168:171],v207 offset:6144
ds_read_b128 v[172:175],v207 offset:7168
buffer_load_dwordx4 v[60:63],v1,s[8:11],s63 offen offset:3072 sc1
s_add_u32 s63,s73,12288
buffer_load_dwordx4 v[64:67],v1,s[8:11],s63 offen sc1
buffer_load_dwordx4 v[68:71],v1,s[8:11],s63 offen offset:1024 sc1
s_waitcnt lgkmcnt(4)
v_pk_add_f32 v[144:145],v[144:145],v[152:153]
v_pk_add_f32 v[146:147],v[146:147],v[154:155]
v_pk_add_f32 v[148:149],v[148:149],v[156:157]
v_pk_add_f32 v[150:151],v[150:151],v[158:159]
s_waitcnt lgkmcnt(0)
v_pk_add_f32 v[160:161],v[160:161],v[168:169]
v_pk_add_f32 v[162:163],v[162:163],v[170:171]
v_pk_add_f32 v[164:165],v[164:165],v[172:173]
v_pk_add_f32 v[166:167],v[166:167],v[174:175]
v_pk_add_f32 v[144:145],v[144:145],v[160:161]
v_pk_add_f32 v[146:147],v[146:147],v[162:163]
v_pk_add_f32 v[148:149],v[148:149],v[164:165]
v_pk_add_f32 v[150:151],v[150:151],v[166:167]
v_cvt_pk_bf16_f32 v6,v144,v145
v_lshlrev_b32 v144,16,v6
v_and_b32 v145,0xffff0000,v6
v_cvt_pk_bf16_f32 v6,v146,v147
v_lshlrev_b32 v146,16,v6
v_and_b32 v147,0xffff0000,v6
v_cvt_pk_bf16_f32 v6,v148,v149
v_lshlrev_b32 v148,16,v6
v_and_b32 v149,0xffff0000,v6
v_cvt_pk_bf16_f32 v6,v150,v151
v_lshlrev_b32 v150,16,v6
v_and_b32 v151,0xffff0000,v6
v_pk_add_f32 v[144:145],v[144:145],v[184:185]
v_pk_add_f32 v[146:147],v[146:147],v[186:187]
v_pk_add_f32 v[148:149],v[148:149],v[188:189]
v_pk_add_f32 v[150:151],v[150:151],v[190:191]
v_cvt_pk_bf16_f32 v6,v144,v145
v_lshlrev_b32 v144,16,v6
v_and_b32 v145,0xffff0000,v6
v_cvt_pk_bf16_f32 v6,v146,v147
v_lshlrev_b32 v146,16,v6
v_and_b32 v147,0xffff0000,v6
v_cvt_pk_bf16_f32 v6,v148,v149
v_lshlrev_b32 v148,16,v6
v_and_b32 v149,0xffff0000,v6
v_cvt_pk_bf16_f32 v6,v150,v151
v_lshlrev_b32 v150,16,v6
v_and_b32 v151,0xffff0000,v6
v_pk_add_f32 v[144:145],v[144:145],v[192:193]
v_pk_add_f32 v[146:147],v[146:147],v[194:195]
v_pk_add_f32 v[148:149],v[148:149],v[196:197]
v_pk_add_f32 v[150:151],v[150:151],v[198:199]
v_cvt_pk_bf16_f32 v200,v144,v145
v_cvt_pk_bf16_f32 v201,v146,v147
v_cvt_pk_bf16_f32 v202,v148,v149
v_cvt_pk_bf16_f32 v203,v150,v151
s_cmp_lg_u32 s51,0
s_cbranch_scc1 w4o_337
buffer_store_dwordx4 v[200:203],v15,s[8:11],s40 offen sc1
v_lshlrev_b32 v144,16,v200
v_and_b32 v145,0xffff0000,v200
v_lshlrev_b32 v146,16,v201
v_and_b32 v147,0xffff0000,v201
v_lshlrev_b32 v148,16,v202
v_and_b32 v149,0xffff0000,v202
v_lshlrev_b32 v150,16,v203
v_and_b32 v151,0xffff0000,v203
v_pk_add_f32 v[6:7],v[144:145],v[146:147]
v_pk_mul_f32 v[8:9],v[144:145],v[144:145]
v_pk_fma_f32 v[8:9],v[146:147],v[146:147],v[8:9]
v_pk_add_f32 v[6:7],v[6:7],v[148:149]
v_pk_fma_f32 v[8:9],v[148:149],v[148:149],v[8:9]
v_pk_add_f32 v[6:7],v[6:7],v[150:151]
v_pk_fma_f32 v[8:9],v[150:151],v[150:151],v[8:9]
v_add_f32 v6,v6,v7
v_add_f32 v7,v8,v9
s_nop 1
v_permlane32_swap_b32 v6,v7
v_add_f32 v6,v6,v7
v_mov_b32 v7,v6
s_nop 1
v_permlane16_swap_b32 v6,v7
v_add_f32 v6,v6,v7
v_mov_b32 v7,v6
s_nop 1
v_permlane32_swap_b32 v6,v7
s_mov_b64 exec,0xffff
buffer_store_dwordx2 v[6:7],v204,s[8:11],s41 offen sc1
s_mov_b64 exec,-1
s_branch w4n_338
w4o_337:
buffer_store_dwordx2 v[200:201],v205,s[76:79],s40 offen
buffer_store_dwordx2 v[202:203],v205,s[76:79],s40 offen offset:32
w4n_338:
s_mov_b32 s59,s42
s_waitcnt vmcnt(8)
s_branch W4_W
W4_E0:
s_nop 4
ds_write_b128 v206,v[128:131] offset:8192
ds_write_b128 v206,v[132:135] offset:9216
ds_write_b128 v206,v[136:139] offset:8704
ds_write_b128 v206,v[140:143] offset:9728
s_waitcnt lgkmcnt(0)
s_barrier
ds_read_b128 v[144:147],v207 offset:0
ds_read_b128 v[148:151],v207 offset:1024
ds_read_b128 v[152:155],v207 offset:2048
ds_read_b128 v[156:159],v207 offset:3072
ds_read_b128 v[160:163],v207 offset:4096
ds_read_b128 v[164:167],v207 offset:5120
ds_read_b128 v[168:171],v207 offset:6144
ds_read_b128 v[172:175],v207 offset:7168
s_waitcnt lgkmcnt(4)
v_pk_add_f32 v[144:145],v[144:145],v[152:153]
v_pk_add_f32 v[146:147],v[146:147],v[154:155]
v_pk_add_f32 v[148:149],v[148:149],v[156:157]
v_pk_add_f32 v[150:151],v[150:151],v[158:159]
s_waitcnt lgkmcnt(0)
v_pk_add_f32 v[160:161],v[160:161],v[168:169]
v_pk_add_f32 v[162:163],v[162:163],v[170:171]
v_pk_add_f32 v[164:165],v[164:165],v[172:173]
v_pk_add_f32 v[166:167],v[166:167],v[174:175]
v_pk_add_f32 v[144:145],v[144:145],v[160:161]
v_pk_add_f32 v[146:147],v[146:147],v[162:163]
v_pk_add_f32 v[148:149],v[148:149],v[164:165]
v_pk_add_f32 v[150:151],v[150:151],v[166:167]
v_cvt_pk_bf16_f32 v6,v144,v145
v_lshlrev_b32 v144,16,v6
v_and_b32 v145,0xffff0000,v6
v_cvt_pk_bf16_f32 v6,v146,v147
v_lshlrev_b32 v146,16,v6
v_and_b32 v147,0xffff0000,v6
v_cvt_pk_bf16_f32 v6,v148,v149
v_lshlrev_b32 v148,16,v6
v_and_b32 v149,0xffff0000,v6
v_cvt_pk_bf16_f32 v6,v150,v151
v_lshlrev_b32 v150,16,v6
v_and_b32 v151,0xffff0000,v6
v_pk_add_f32 v[144:145],v[144:145],v[184:185]
v_pk_add_f32 v[146:147],v[146:147],v[186:187]
v_pk_add_f32 v[148:149],v[148:149],v[188:189]
v_pk_add_f32 v[150:151],v[150:151],v[190:191]
v_cvt_pk_bf16_f32 v6,v144,v145
v_lshlrev_b32 v144,16,v6
v_and_b32 v145,0xffff0000,v6
v_cvt_pk_bf16_f32 v6,v146,v147
v_lshlrev_b32 v146,16,v6
v_and_b32 v147,0xffff0000,v6
v_cvt_pk_bf16_f32 v6,v148,v149
v_lshlrev_b32 v148,16,v6
v_and_b32 v149,0xffff0000,v6
v_cvt_pk_bf16_f32 v6,v150,v151
v_lshlrev_b32 v150,16,v6
v_and_b32 v151,0xffff0000,v6
v_pk_add_f32 v[144:145],v[144:145],v[192:193]
v_pk_add_f32 v[146:147],v[146:147],v[194:195]
v_pk_add_f32 v[148:149],v[148:149],v[196:197]
v_pk_add_f32 v[150:151],v[150:151],v[198:199]
v_cvt_pk_bf16_f32 v200,v144,v145
v_cvt_pk_bf16_f32 v201,v146,v147
v_cvt_pk_bf16_f32 v202,v148,v149
v_cvt_pk_bf16_f32 v203,v150,v151
s_cmp_lg_u32 s51,0
s_cbranch_scc1 w4o_339
buffer_store_dwordx4 v[200:203],v15,s[8:11],s40 offen sc1
v_lshlrev_b32 v144,16,v200
v_and_b32 v145,0xffff0000,v200
v_lshlrev_b32 v146,16,v201
v_and_b32 v147,0xffff0000,v201
v_lshlrev_b32 v148,16,v202
v_and_b32 v149,0xffff0000,v202
v_lshlrev_b32 v150,16,v203
v_and_b32 v151,0xffff0000,v203
v_pk_add_f32 v[6:7],v[144:145],v[146:147]
v_pk_mul_f32 v[8:9],v[144:145],v[144:145]
v_pk_fma_f32 v[8:9],v[146:147],v[146:147],v[8:9]
v_pk_add_f32 v[6:7],v[6:7],v[148:149]
v_pk_fma_f32 v[8:9],v[148:149],v[148:149],v[8:9]
v_pk_add_f32 v[6:7],v[6:7],v[150:151]
v_pk_fma_f32 v[8:9],v[150:151],v[150:151],v[8:9]
v_add_f32 v6,v6,v7
v_add_f32 v7,v8,v9
s_nop 1
v_permlane32_swap_b32 v6,v7
v_add_f32 v6,v6,v7
v_mov_b32 v7,v6
s_nop 1
v_permlane16_swap_b32 v6,v7
v_add_f32 v6,v6,v7
v_mov_b32 v7,v6
s_nop 1
v_permlane32_swap_b32 v6,v7
s_mov_b64 exec,0xffff
buffer_store_dwordx2 v[6:7],v204,s[8:11],s41 offen sc1
s_mov_b64 exec,-1
s_branch w4n_340
w4o_339:
buffer_store_dwordx2 v[200:201],v205,s[76:79],s40 offen
buffer_store_dwordx2 v[202:203],v205,s[76:79],s40 offen offset:32
w4n_340:
s_mov_b32 s59,s42
s_cmp_lg_u32 s37,0
s_cbranch_scc1 W4_COLD
s_waitcnt vmcnt(2)
W4_W:
s_mov_b32 s51,s33
s_mov_b32 s52,s34
s_mov_b32 s72,s73
s_add_u32 s32,s32,1
s_mov_b32 s33,s28
s_mov_b32 s34,s29
s_mov_b32 s35,s30
s_mov_b32 s73,s31
v_cmp_eq_u32 vcc,0,v3
s_cmp_eq_u64 vcc,0
s_cselect_b32 s37,0,2147483648
s_cmp_lt_u32 s32,128
s_cselect_b32 s37,s37,2147483648
s_cmp_lg_u32 s37,0
s_cbranch_scc1 W4_W0
s_waitcnt vmcnt(15)
v_mfma_f32_32x32x16_bf16 v[112:127],a[0:3],v[16:19],0
s_add_u32 s63,s72,12288
buffer_load_dwordx4 v[72:75],v1,s[8:11],s63 offen offset:2048 sc1
v_xor_b32 v206,0x8000,v206
v_xor_b32 v207,0x8000,v207
s_lshl_b32 s64,s51,6
v_mfma_f32_32x32x16_bf16 v[128:143],a[96:99],v[16:19],0
s_add_u32 s64,s64,s52
s_and_b32 s65,s52,7
s_lshl3_add_u32 s65,s51,s65
s_mul_i32 s65,s65,46080
s_add_u32 s65,s65,s70
s_add_u32 s65,s65,212467712
s_waitcnt vmcnt(15)
v_mfma_f32_32x32x16_bf16 v[112:127],a[4:7],v[20:23],v[112:127]
buffer_load_dwordx4 v[76:79],v1,s[8:11],s63 offen offset:3072 sc1
s_add_u32 s63,s72,16384
buffer_load_dwordx4 v[176:179],v1,s[8:11],s65 offen sc1
s_mul_i32 s65,s64,40960
v_mfma_f32_32x32x16_bf16 v[128:143],a[100:103],v[20:23],v[128:143]
s_add_u32 s65,s65,s70
s_add_u32 s65,s65,218365952
buffer_load_dwordx4 v[180:183],v15,s[8:11],s65 offen sc1
s_lshl_b32 s82,s64,9
s_lshl2_add_u32 s82,s56,s82
s_waitcnt vmcnt(17)
v_mfma_f32_32x32x16_bf16 v[112:127],a[8:11],v[24:27],v[112:127]
buffer_load_dwordx4 v[80:83],v1,s[8:11],s63 offen sc1
s_add_u32 s42,s82,32768
s_add_u32 s82,s82,327680
s_mul_i32 s41,s52,46080
s_add_u32 s41,s41,209518592
v_mfma_f32_32x32x16_bf16 v[128:143],a[104:107],v[24:27],v[128:143]
s_add_u32 s40,s41,s70
s_lshr_b32 s64,s70,3
s_add_u32 s41,s41,s64
s_add_u32 s41,s41,40960
s_mul_i32 s64,s52,40960
s_add_u32 s62,s32,1
s_waitcnt vmcnt(17)
v_mfma_f32_32x32x16_bf16 v[112:127],a[12:15],v[28:31],v[112:127]
buffer_load_dwordx4 v[84:87],v1,s[8:11],s63 offen offset:1024 sc1
s_cmp_lg_u32 s51,0
s_cselect_b32 s40,s64,s40
s_cselect_b32 s42,2147483648,s42
s_min_u32 s62,s62,127
v_mfma_f32_32x32x16_bf16 v[128:143],a[108:111],v[28:31],v[128:143]
s_sub_u32 s60,s62,16
s_lshr_b32 s29,s60,1
s_and_b32 s28,s60,1
s_cmp_eq_u32 s28,0
s_cselect_b32 s61,16,0
s_add_u32 s29,s29,s61
s_waitcnt vmcnt(17)
v_mfma_f32_32x32x16_bf16 v[112:127],a[16:19],v[32:35],v[112:127]
buffer_load_dwordx4 v[88:91],v1,s[8:11],s63 offen offset:2048 sc1
s_sub_u32 s61,s60,48
s_cmp_ge_u32 s60,96
s_cselect_b32 s29,s61,s29
s_cselect_b32 s28,1,s28
v_mfma_f32_32x32x16_bf16 v[128:143],a[112:115],v[32:35],v[128:143]
s_cmp_lt_u32 s62,16
s_cselect_b32 s29,s62,s29
s_cselect_b32 s28,0,s28
s_lshl_b32 s30,s28,6
s_add_u32 s30,s30,s29
s_lshl_b32 s30,s30,9
s_waitcnt vmcnt(17)
v_mfma_f32_32x32x16_bf16 v[112:127],a[20:23],v[36:39],v[112:127]
buffer_load_dwordx4 v[92:95],v1,s[8:11],s63 offen offset:3072 sc1
s_add_u32 s63,s72,20480
s_add_u32 s30,s30,589824
s_and_b32 s60,s29,3
s_lshl2_add_u32 s60,s28,s60
v_mfma_f32_32x32x16_bf16 v[128:143],a[116:119],v[36:39],v[128:143]
s_mul_i32 s31,s60,98304
s_add_u32 s31,s31,s71
s_waitcnt vmcnt(17)
v_mfma_f32_32x32x16_bf16 v[112:127],a[24:27],v[40:43],v[112:127]
buffer_load_dwordx4 v[96:99],v1,s[8:11],s63 offen sc1
v_mfma_f32_32x32x16_bf16 v[128:143],a[120:123],v[40:43],v[128:143]
s_waitcnt vmcnt(17)
v_mfma_f32_32x32x16_bf16 v[112:127],a[28:31],v[44:47],v[112:127]
buffer_load_dwordx4 v[100:103],v1,s[8:11],s63 offen offset:1024 sc1
v_mfma_f32_32x32x16_bf16 v[128:143],a[124:127],v[44:47],v[128:143]
s_waitcnt vmcnt(17)
v_mfma_f32_32x32x16_bf16 v[112:127],a[32:35],v[48:51],v[112:127]
buffer_load_dwordx4 v[104:107],v1,s[8:11],s63 offen offset:2048 sc1
v_mfma_f32_32x32x16_bf16 v[128:143],a[128:131],v[48:51],v[128:143]
s_waitcnt vmcnt(17)
v_mfma_f32_32x32x16_bf16 v[112:127],a[36:39],v[52:55],v[112:127]
buffer_load_dwordx4 v[108:111],v1,s[8:11],s63 offen offset:3072 sc1
s_add_u32 s63,s73,0
buffer_load_dwordx4 v[16:19],v1,s[8:11],s63 offen sc1
v_mfma_f32_32x32x16_bf16 v[128:143],a[132:135],v[52:55],v[128:143]
s_waitcnt vmcnt(18)
v_mfma_f32_32x32x16_bf16 v[112:127],a[40:43],v[56:59],v[112:127]
buffer_load_dwordx4 v[20:23],v1,s[8:11],s63 offen offset:1024 sc1
v_mfma_f32_32x32x16_bf16 v[128:143],a[136:139],v[56:59],v[128:143]
s_waitcnt vmcnt(18)
v_mfma_f32_32x32x16_bf16 v[112:127],a[44:47],v[60:63],v[112:127]
buffer_load_dwordx4 v[24:27],v1,s[8:11],s63 offen offset:2048 sc1
v_mfma_f32_32x32x16_bf16 v[128:143],a[140:143],v[60:63],v[128:143]
s_waitcnt vmcnt(18)
v_mfma_f32_32x32x16_bf16 v[112:127],a[48:51],v[64:67],v[112:127]
buffer_load_dwordx4 v[28:31],v1,s[8:11],s63 offen offset:3072 sc1
s_add_u32 s63,s73,4096
v_mfma_f32_32x32x16_bf16 v[128:143],a[144:147],v[64:67],v[128:143]
s_waitcnt vmcnt(18)
v_mfma_f32_32x32x16_bf16 v[112:127],a[52:55],v[68:71],v[112:127]
s_waitcnt vmcnt(16)
s_mov_b64 exec,1
buffer_store_dword v5,v1,s[8:11],s59 offen sc1
s_mov_b64 exec,-1
s_mov_b32 s59,2147483648
v_mfma_f32_32x32x16_bf16 v[128:143],a[148:151],v[68:71],v[128:143]
buffer_load_dwordx4 v[32:35],v1,s[8:11],s63 offen sc1
s_waitcnt vmcnt(17)
v_mfma_f32_32x32x16_bf16 v[112:127],a[56:59],v[72:75],v[112:127]
v_mfma_f32_32x32x16_bf16 v[128:143],a[152:155],v[72:75],v[128:143]
buffer_load_dwordx4 v[36:39],v1,s[8:11],s63 offen offset:1024 sc1
s_waitcnt vmcnt(17)
v_mfma_f32_32x32x16_bf16 v[112:127],a[60:63],v[76:79],v[112:127]
v_mfma_f32_32x32x16_bf16 v[128:143],a[156:159],v[76:79],v[128:143]
buffer_load_dwordx4 v[40:43],v1,s[8:11],s63 offen offset:2048 sc1
s_waitcnt vmcnt(15)
v_mfma_f32_32x32x16_bf16 v[112:127],a[64:67],v[80:83],v[112:127]
v_mfma_f32_32x32x16_bf16 v[128:143],a[160:163],v[80:83],v[128:143]
buffer_load_dwordx4 v[44:47],v1,s[8:11],s63 offen offset:3072 sc1
s_add_u32 s63,s73,8192
s_waitcnt vmcnt(15)
v_mfma_f32_32x32x16_bf16 v[112:127],a[68:71],v[84:87],v[112:127]
v_mfma_f32_32x32x16_bf16 v[128:143],a[164:167],v[84:87],v[128:143]
buffer_load_dwordx4 v[48:51],v1,s[8:11],s63 offen sc1
s_waitcnt vmcnt(15)
v_mfma_f32_32x32x16_bf16 v[112:127],a[72:75],v[88:91],v[112:127]
v_mfma_f32_32x32x16_bf16 v[128:143],a[168:171],v[88:91],v[128:143]
buffer_load_dwordx4 v[52:55],v1,s[8:11],s63 offen offset:1024 sc1
v_lshlrev_b32 v184,16,v176
v_and_b32 v185,0xffff0000,v176
v_lshlrev_b32 v186,16,v177
s_waitcnt vmcnt(15)
v_mfma_f32_32x32x16_bf16 v[112:127],a[76:79],v[92:95],v[112:127]
v_and_b32 v187,0xffff0000,v177
v_lshlrev_b32 v188,16,v178
v_and_b32 v189,0xffff0000,v178
v_lshlrev_b32 v190,16,v179
v_and_b32 v191,0xffff0000,v179
v_mfma_f32_32x32x16_bf16 v[128:143],a[172:175],v[92:95],v[128:143]
buffer_load_dwordx4 v[56:59],v1,s[8:11],s63 offen offset:2048 sc1
v_lshlrev_b32 v192,16,v180
v_and_b32 v193,0xffff0000,v180
v_lshlrev_b32 v194,16,v181
v_and_b32 v195,0xffff0000,v181
s_waitcnt vmcnt(15)
v_mfma_f32_32x32x16_bf16 v[112:127],a[80:83],v[96:99],v[112:127]
v_lshlrev_b32 v196,16,v182
v_and_b32 v197,0xffff0000,v182
v_lshlrev_b32 v198,16,v183
v_and_b32 v199,0xffff0000,v183
s_waitcnt vmcnt(14)
v_mfma_f32_32x32x16_bf16 v[112:127],a[84:87],v[100:103],v[112:127]
buffer_load_dwordx4 v[60:63],v1,s[8:11],s63 offen offset:3072 sc1
s_add_u32 s63,s73,12288
s_waitcnt vmcnt(14)
v_mfma_f32_32x32x16_bf16 v[112:127],a[88:91],v[104:107],v[112:127]
s_waitcnt vmcnt(13)
v_mfma_f32_32x32x16_bf16 v[112:127],a[92:95],v[108:111],v[112:127]
buffer_load_dwordx4 v[64:67],v1,s[8:11],s63 offen sc1
v_mfma_f32_32x32x16_bf16 v[128:143],a[176:179],v[96:99],v[128:143]
s_mov_b64 exec,1
s_cmp_lg_u32 s49,0
s_cbranch_scc0 ls_341
buffer_store_dword v5,v1,s[8:11],s82 offen sc1
s_branch ls_342
ls_341:
buffer_store_dword v5,v1,s[8:11],s82 offen
ls_342:
s_mov_b64 exec,-1
v_mfma_f32_32x32x16_bf16 v[128:143],a[180:183],v[100:103],v[128:143]
buffer_load_dwordx4 v[68:71],v1,s[8:11],s63 offen offset:1024 sc1
ds_write_b128 v206,v[112:115] offset:0
ds_write_b128 v206,v[116:119] offset:1024
v_mfma_f32_32x32x16_bf16 v[128:143],a[184:187],v[104:107],v[128:143]
ds_write_b128 v206,v[120:123] offset:512
ds_write_b128 v206,v[124:127] offset:1536
v_mfma_f32_32x32x16_bf16 v[128:143],a[188:191],v[108:111],v[128:143]
buffer_load_dword v3,v2,s[8:11],s30 offen sc1
s_nop 5
s_branch W4_E0
s_nop 3
W4_W0:
s_waitcnt vmcnt(15)
v_mfma_f32_32x32x16_bf16 v[112:127],a[0:3],v[16:19],0
s_add_u32 s63,s72,12288
buffer_load_dwordx4 v[72:75],v1,s[8:11],s63 offen offset:2048 sc1
v_xor_b32 v206,0x8000,v206
v_xor_b32 v207,0x8000,v207
s_lshl_b32 s64,s51,6
v_mfma_f32_32x32x16_bf16 v[128:143],a[96:99],v[16:19],0
s_add_u32 s64,s64,s52
s_and_b32 s65,s52,7
s_lshl3_add_u32 s65,s51,s65
s_mul_i32 s65,s65,46080
s_add_u32 s65,s65,s70
s_add_u32 s65,s65,212467712
s_waitcnt vmcnt(15)
v_mfma_f32_32x32x16_bf16 v[112:127],a[4:7],v[20:23],v[112:127]
buffer_load_dwordx4 v[76:79],v1,s[8:11],s63 offen offset:3072 sc1
s_add_u32 s63,s72,16384
buffer_load_dwordx4 v[176:179],v1,s[8:11],s65 offen sc1
s_mul_i32 s65,s64,40960
v_mfma_f32_32x32x16_bf16 v[128:143],a[100:103],v[20:23],v[128:143]
s_add_u32 s65,s65,s70
s_add_u32 s65,s65,218365952
buffer_load_dwordx4 v[180:183],v15,s[8:11],s65 offen sc1
s_lshl_b32 s82,s64,9
s_lshl2_add_u32 s82,s56,s82
s_waitcnt vmcnt(17)
v_mfma_f32_32x32x16_bf16 v[112:127],a[8:11],v[24:27],v[112:127]
buffer_load_dwordx4 v[80:83],v1,s[8:11],s63 offen sc1
s_add_u32 s42,s82,32768
s_add_u32 s82,s82,327680
s_mul_i32 s41,s52,46080
s_add_u32 s41,s41,209518592
v_mfma_f32_32x32x16_bf16 v[128:143],a[104:107],v[24:27],v[128:143]
s_add_u32 s40,s41,s70
s_lshr_b32 s64,s70,3
s_add_u32 s41,s41,s64
s_add_u32 s41,s41,40960
s_mul_i32 s64,s52,40960
s_add_u32 s62,s32,1
s_waitcnt vmcnt(17)
v_mfma_f32_32x32x16_bf16 v[112:127],a[12:15],v[28:31],v[112:127]
buffer_load_dwordx4 v[84:87],v1,s[8:11],s63 offen offset:1024 sc1
s_cmp_lg_u32 s51,0
s_cselect_b32 s40,s64,s40
s_cselect_b32 s42,2147483648,s42
s_min_u32 s62,s62,127
v_mfma_f32_32x32x16_bf16 v[128:143],a[108:111],v[28:31],v[128:143]
s_sub_u32 s60,s62,16
s_lshr_b32 s29,s60,1
s_and_b32 s28,s60,1
s_cmp_eq_u32 s28,0
s_cselect_b32 s61,16,0
s_add_u32 s29,s29,s61
s_waitcnt vmcnt(17)
v_mfma_f32_32x32x16_bf16 v[112:127],a[16:19],v[32:35],v[112:127]
buffer_load_dwordx4 v[88:91],v1,s[8:11],s63 offen offset:2048 sc1
s_sub_u32 s61,s60,48
s_cmp_ge_u32 s60,96
s_cselect_b32 s29,s61,s29
s_cselect_b32 s28,1,s28
v_mfma_f32_32x32x16_bf16 v[128:143],a[112:115],v[32:35],v[128:143]
s_cmp_lt_u32 s62,16
s_cselect_b32 s29,s62,s29
s_cselect_b32 s28,0,s28
s_lshl_b32 s30,s28,6
s_add_u32 s30,s30,s29
s_lshl_b32 s30,s30,9
s_waitcnt vmcnt(17)
v_mfma_f32_32x32x16_bf16 v[112:127],a[20:23],v[36:39],v[112:127]
buffer_load_dwordx4 v[92:95],v1,s[8:11],s63 offen offset:3072 sc1
s_add_u32 s63,s72,20480
s_add_u32 s30,s30,589824
s_and_b32 s60,s29,3
s_lshl2_add_u32 s60,s28,s60
v_mfma_f32_32x32x16_bf16 v[128:143],a[116:119],v[36:39],v[128:143]
s_mul_i32 s31,s60,98304
s_add_u32 s31,s31,s71
s_waitcnt vmcnt(17)
v_mfma_f32_32x32x16_bf16 v[112:127],a[24:27],v[40:43],v[112:127]
buffer_load_dwordx4 v[96:99],v1,s[8:11],s63 offen sc1
v_mfma_f32_32x32x16_bf16 v[128:143],a[120:123],v[40:43],v[128:143]
s_waitcnt vmcnt(17)
v_mfma_f32_32x32x16_bf16 v[112:127],a[28:31],v[44:47],v[112:127]
buffer_load_dwordx4 v[100:103],v1,s[8:11],s63 offen offset:1024 sc1
v_mfma_f32_32x32x16_bf16 v[128:143],a[124:127],v[44:47],v[128:143]
s_waitcnt vmcnt(17)
v_mfma_f32_32x32x16_bf16 v[112:127],a[32:35],v[48:51],v[112:127]
buffer_load_dwordx4 v[104:107],v1,s[8:11],s63 offen offset:2048 sc1
v_mfma_f32_32x32x16_bf16 v[128:143],a[128:131],v[48:51],v[128:143]
s_waitcnt vmcnt(17)
v_mfma_f32_32x32x16_bf16 v[112:127],a[36:39],v[52:55],v[112:127]
buffer_load_dwordx4 v[108:111],v1,s[8:11],s63 offen offset:3072 sc1
v_mfma_f32_32x32x16_bf16 v[128:143],a[132:135],v[52:55],v[128:143]
s_waitcnt vmcnt(17)
v_mfma_f32_32x32x16_bf16 v[112:127],a[40:43],v[56:59],v[112:127]
v_mfma_f32_32x32x16_bf16 v[128:143],a[136:139],v[56:59],v[128:143]
s_waitcnt vmcnt(16)
v_mfma_f32_32x32x16_bf16 v[112:127],a[44:47],v[60:63],v[112:127]
v_mfma_f32_32x32x16_bf16 v[128:143],a[140:143],v[60:63],v[128:143]
s_waitcnt vmcnt(15)
v_mfma_f32_32x32x16_bf16 v[112:127],a[48:51],v[64:67],v[112:127]
v_mfma_f32_32x32x16_bf16 v[128:143],a[144:147],v[64:67],v[128:143]
s_waitcnt vmcnt(14)
v_mfma_f32_32x32x16_bf16 v[112:127],a[52:55],v[68:71],v[112:127]
s_waitcnt vmcnt(12)
s_mov_b64 exec,1
buffer_store_dword v5,v1,s[8:11],s59 offen sc1
s_mov_b64 exec,-1
s_mov_b32 s59,2147483648
v_mfma_f32_32x32x16_bf16 v[128:143],a[148:151],v[68:71],v[128:143]
s_waitcnt vmcnt(12)
v_mfma_f32_32x32x16_bf16 v[112:127],a[56:59],v[72:75],v[112:127]
v_mfma_f32_32x32x16_bf16 v[128:143],a[152:155],v[72:75],v[128:143]
s_waitcnt vmcnt(11)
v_mfma_f32_32x32x16_bf16 v[112:127],a[60:63],v[76:79],v[112:127]
v_mfma_f32_32x32x16_bf16 v[128:143],a[156:159],v[76:79],v[128:143]
s_waitcnt vmcnt(8)
v_mfma_f32_32x32x16_bf16 v[112:127],a[64:67],v[80:83],v[112:127]
v_mfma_f32_32x32x16_bf16 v[128:143],a[160:163],v[80:83],v[128:143]
s_waitcnt vmcnt(7)
v_mfma_f32_32x32x16_bf16 v[112:127],a[68:71],v[84:87],v[112:127]
v_mfma_f32_32x32x16_bf16 v[128:143],a[164:167],v[84:87],v[128:143]
s_waitcnt vmcnt(6)
v_mfma_f32_32x32x16_bf16 v[112:127],a[72:75],v[88:91],v[112:127]
v_mfma_f32_32x32x16_bf16 v[128:143],a[168:171],v[88:91],v[128:143]
v_lshlrev_b32 v184,16,v176
v_and_b32 v185,0xffff0000,v176
v_lshlrev_b32 v186,16,v177
v_and_b32 v187,0xffff0000,v177
v_lshlrev_b32 v188,16,v178
s_waitcnt vmcnt(5)
v_mfma_f32_32x32x16_bf16 v[112:127],a[76:79],v[92:95],v[112:127]
buffer_load_dword v3,v2,s[8:11],s35 offen sc1
v_and_b32 v189,0xffff0000,v178
v_lshlrev_b32 v190,16,v179
v_and_b32 v191,0xffff0000,v179
v_lshlrev_b32 v192,16,v180
v_mfma_f32_32x32x16_bf16 v[128:143],a[172:175],v[92:95],v[128:143]
v_and_b32 v193,0xffff0000,v180
v_lshlrev_b32 v194,16,v181
v_and_b32 v195,0xffff0000,v181
v_lshlrev_b32 v196,16,v182
v_and_b32 v197,0xffff0000,v182
s_waitcnt vmcnt(5)
v_mfma_f32_32x32x16_bf16 v[112:127],a[80:83],v[96:99],v[112:127]
v_lshlrev_b32 v198,16,v183
v_and_b32 v199,0xffff0000,v183
s_waitcnt vmcnt(4)
v_mfma_f32_32x32x16_bf16 v[112:127],a[84:87],v[100:103],v[112:127]
s_waitcnt vmcnt(3)
v_mfma_f32_32x32x16_bf16 v[112:127],a[88:91],v[104:107],v[112:127]
s_waitcnt vmcnt(2)
v_mfma_f32_32x32x16_bf16 v[112:127],a[92:95],v[108:111],v[112:127]
v_mfma_f32_32x32x16_bf16 v[128:143],a[176:179],v[96:99],v[128:143]
s_mov_b64 exec,1
s_cmp_lg_u32 s49,0
s_cbranch_scc0 ls_343
buffer_store_dword v5,v1,s[8:11],s82 offen sc1
s_branch ls_344
ls_343:
buffer_store_dword v5,v1,s[8:11],s82 offen
ls_344:
s_mov_b64 exec,-1
v_mfma_f32_32x32x16_bf16 v[128:143],a[180:183],v[100:103],v[128:143]
ds_write_b128 v206,v[112:115] offset:0
ds_write_b128 v206,v[116:119] offset:1024
ds_write_b128 v206,v[120:123] offset:512
v_mfma_f32_32x32x16_bf16 v[128:143],a[184:187],v[104:107],v[128:143]
ds_write_b128 v206,v[124:127] offset:1536
v_mfma_f32_32x32x16_bf16 v[128:143],a[188:191],v[108:111],v[128:143]
s_waitcnt vmcnt(1)
v_cmp_eq_u32 vcc,0,v3
s_cmp_eq_u64 vcc,0
s_cselect_b32 s37,0,2147483648
s_cmp_lt_u32 s32,128
s_cselect_b32 s37,s37,2147483648
s_cmp_eq_u32 s37,0
s_cbranch_scc1 W4_E2
s_branch W4_E0
s_nop 2
W4_END:
s_endpgm
.section .rodata,"a"
.p2align 6
.amdhsa_kernel interleave_layers__memory_aug_recurrent_mem_tr__mixer_s_mlp__prompt_kernel
  .amdhsa_next_free_vgpr 512
  .amdhsa_next_free_sgpr 102
  .amdhsa_accum_offset 256
  .amdhsa_group_segment_fixed_size 0
  .amdhsa_kernarg_size 120
  .amdhsa_user_sgpr_count 2
  .amdhsa_user_sgpr_kernarg_segment_ptr 1
  .amdhsa_system_sgpr_workgroup_id_x 1
.end_amdhsa_kernel
```

```asm
; @launch grid=(256,1,1) block=(256,1,1) lds=163840
.amdgcn_target "amdgcn-amd-amdhsa--gfx950"
.text
.globl interleave_layers__memory_aug_recurrent_mem_tr__mixer_s_mlp__prompt_kernel
.p2align 8
.type interleave_layers__memory_aug_recurrent_mem_tr__mixer_s_mlp__prompt_kernel,@function
interleave_layers__memory_aug_recurrent_mem_tr__mixer_s_mlp__prompt_kernel:
s_cmp_ge_u32 s2,256
s_cbranch_scc1 EXIT
s_load_dwordx16 s[16:31],s[0:1],0
s_load_dwordx8 s[32:39],s[0:1],64
s_load_dwordx4 s[40:43],s[0:1],96
s_load_dwordx2 s[44:45],s[0:1],112
v_lshrrev_b32 v1,6,v0
v_and_b32 v0,63,v0
v_readfirstlane_b32 s46,v1
s_mov_b32 s47,200000
s_mov_b32 s49,0
s_getreg_b32 s4,hwreg(HW_REG_XCC_ID)
s_and_b32 s4,s4,7
s_waitcnt lgkmcnt(0)
s_mov_b32 s8,s44
s_mov_b32 s9,s45
s_mov_b32 s10,268435456
s_mov_b32 s11,0x20000
s_mov_b32 s12,s42
s_mov_b32 s13,s43
s_mov_b32 s14,256
s_mov_b32 s15,0x20000
v_lshlrev_b32 v1,4,v0
v_mov_b32 v4,0
v_mov_b32 v5,0
v_mov_b32 v6,0
v_mov_b32 v7,0
s_lshl_b32 s5,s2,2
s_add_u32 s5,s5,s46
s_lshl_b32 s5,s5,10
buffer_store_dwordx4 v[4:7],v1,s[8:11],s5 offen sc1
v_mov_b32 v2,0
s_cmp_lg_u32 s46,0
s_cbranch_scc1 TK_DONE
s_mov_b64 exec,1
v_mov_b32 v1,1
s_lshl_b32 s5,s4,2
v_mov_b32 v3,s5
buffer_atomic_add v1,v3,s[12:15],0 offen offset:32 sc0 sc1
s_waitcnt vmcnt(0)
v_readfirstlane_b32 s5,v1
s_lshl_b32 s6,s4,5
s_add_u32 s6,s6,s5
s_cmp_lt_u32 s5,32
s_cselect_b32 s6,s6,999
v_mov_b32 v1,s6
ds_write_b32 v2,v1
s_mov_b64 exec,-1
s_waitcnt lgkmcnt(0)
TK_DONE:
s_barrier
ds_read_b32 v1,v2
s_waitcnt lgkmcnt(0)
v_readfirstlane_b32 s3,v1
s_barrier
s_nop 2
s_branch DISPATCH
ROLE_CS:
s_lshr_b32 s28,s48,4
s_and_b32 s29,s48,15
s_mul_i32 s82,s28,2097152
s_add_u32 s82,s82,2097152
v_lshlrev_b32 v1,4,v0
v_and_b32 v12,1,v0
v_mul_u32_u24 v2,0xaaaa,v12
v_or_b32 v2,0x4444,v2
s_add_u32 s60,s46,1
s_and_b32 s60,s60,3
s_lshl_b32 s60,s60,11
s_add_u32 s60,s60,131072
v_add_u32 v3,s60,v1
s_add_u32 s60,s46,2
s_and_b32 s60,s60,3
s_lshl_b32 s60,s60,11
s_add_u32 s60,s60,131072
v_add_u32 v4,s60,v1
s_add_u32 s60,s46,3
s_and_b32 s60,s60,3
s_lshl_b32 s60,s60,11
s_add_u32 s60,s60,131072
v_add_u32 v5,s60,v1
v_add_u32 v59,139264,v1
s_lshl_b32 s60,s46,11
s_add_u32 s60,s60,131072
v_add_u32 v22,s60,v1
s_lshr_b32 s60,s46,1
s_lshl_b32 s60,s60,10
s_and_b32 s61,s46,1
s_lshl_b32 s61,s61,3
s_add_u32 s60,s60,s61
v_add_u32 v23,s60,v59
s_mul_i32 s60,s46,20480
v_add_u32 v21,s60,v1
v_and_b32 v11,7,v0
v_lshlrev_b32 v11,2,v11
v_bfe_u32 v12,v0,3,2
v_lshl_add_u32 v11,v12,7,v11
s_xor_b32 s60,s28,1
s_lshl_b32 s60,s60,19
s_lshl_b32 s61,s46,11
s_add_u32 s83,s60,s61
s_add_u32 s83,s83,10485760
s_mov_b32 s36,0
s_mov_b32 s88,0xcccccccc
s_mov_b32 s89,0xcccccccc
s_mov_b32 s90,0x33333333
s_mov_b32 s91,0x33333333
s_mov_b32 s87,0x3dd53b95
v_lshrrev_b32 v14,4,v0
v_and_b32 v15,15,v0
v_lshrrev_b32 v12,2,v15
v_add_u32 v12,v12,v14
v_and_b32 v12,3,v12
v_lshlrev_b32 v6,3,v12
v_lshl_add_u32 v6,v15,5,v6
s_mul_i32 s60,s46,1536
s_add_u32 s60,s60,141312
v_add_u32 v6,s60,v6
v_add_u32 v12,v0,v14
v_and_b32 v12,3,v12
v_lshlrev_b32 v7,3,v12
v_lshrrev_b32 v12,2,v0
v_lshl_add_u32 v7,v12,5,v7
v_add_u32 v7,141312,v7
s_min_u32 s62,s46,2
v_lshrrev_b32 v12,2,v15
v_and_b32 v13,1,v15
v_lshl_add_u32 v12,v12,1,v13
v_bfe_u32 v13,v15,1,1
v_lshlrev_b32 v8,8,v14
v_lshl_add_u32 v8,v12,5,v8
v_xor_b32 v16,1,v13
v_lshl_add_u32 v8,v16,4,v8
v_lshlrev_b32 v20,8,v14
v_lshl_add_u32 v20,v13,7,v20
v_and_b32 v16,3,v12
v_lshl_add_u32 v20,v16,5,v20
v_lshrrev_b32 v16,2,v12
v_lshl_add_u32 v20,v16,4,v20
v_min_u32 v12,5,v0
s_mul_i32 s60,s48,3
v_add_u32 v9,s60,v12
v_lshlrev_b32 v9,2,v9
v_add_u32 v13,65524,v9
v_cmp_lt_u32 vcc,2,v12
s_nop 1
v_cndmask_b32 v9,v9,v13,vcc
s_mul_i32 s84,s48,12288
s_add_u32 s84,s84,74448896
s_mul_i32 s60,s29,3072
s_lshl_b32 s61,s62,10
s_add_u32 s60,s60,s61
s_add_u32 s60,s60,s82
s_add_u32 s33,s60,163840
s_add_u32 s34,s60,557056
s_mul_i32 s85,s48,6144
s_add_u32 s85,s85,24117248
s_lshl_b32 s86,s48,5
s_lshl_b32 s61,s62,2
s_add_u32 s86,s86,688128
s_lshr_b32 s60,s29,2
s_lshl_b32 s60,s60,7
s_and_b32 s63,s29,3
s_mul_i32 s63,s63,12
s_add_u32 s60,s60,s63
s_add_u32 s60,s60,s61
s_add_u32 s60,s60,s82
s_add_u32 s35,s60,951296
s_cmp_eq_u32 s46,3
s_cbranch_scc1 si_1
v_mov_b32 v12,-1
v_mov_b32 v13,0
s_cmp_lg_u32 s49,0
s_cbranch_scc1 ls_2
s_add_u32 s60,s33,0
buffer_store_dword v12,v1,s[8:11],s60 offen
s_add_u32 s60,s33,49152
buffer_store_dword v12,v1,s[8:11],s60 offen
s_add_u32 s60,s33,98304
buffer_store_dword v12,v1,s[8:11],s60 offen
s_add_u32 s60,s33,147456
buffer_store_dword v12,v1,s[8:11],s60 offen
s_add_u32 s60,s33,196608
buffer_store_dword v12,v1,s[8:11],s60 offen
s_add_u32 s60,s33,245760
buffer_store_dword v12,v1,s[8:11],s60 offen
s_add_u32 s60,s33,294912
buffer_store_dword v12,v1,s[8:11],s60 offen
s_add_u32 s60,s33,344064
buffer_store_dword v12,v1,s[8:11],s60 offen
s_mov_b64 exec,1
buffer_store_dword v13,v1,s[8:11],s35 offen
buffer_store_dword v13,v1,s[8:11],s35 offen offset:512
s_mov_b64 exec,-1
s_branch ls_3
ls_2:
s_add_u32 s60,s33,0
buffer_store_dword v12,v1,s[8:11],s60 offen sc1
s_add_u32 s60,s33,49152
buffer_store_dword v12,v1,s[8:11],s60 offen sc1
s_add_u32 s60,s33,98304
buffer_store_dword v12,v1,s[8:11],s60 offen sc1
s_add_u32 s60,s33,147456
buffer_store_dword v12,v1,s[8:11],s60 offen sc1
s_add_u32 s60,s33,196608
buffer_store_dword v12,v1,s[8:11],s60 offen sc1
s_add_u32 s60,s33,245760
buffer_store_dword v12,v1,s[8:11],s60 offen sc1
s_add_u32 s60,s33,294912
buffer_store_dword v12,v1,s[8:11],s60 offen sc1
s_add_u32 s60,s33,344064
buffer_store_dword v12,v1,s[8:11],s60 offen sc1
s_mov_b64 exec,1
buffer_store_dword v13,v1,s[8:11],s35 offen sc1
buffer_store_dword v13,v1,s[8:11],s35 offen offset:512 sc1
s_mov_b64 exec,-1
ls_3:
si_1:
s_mul_i32 s73,s48,384
s_mov_b32 s74,s73
v_add_u32 v12,0,v0
v_mul_u32_u24 v13,2731,v12
v_lshrrev_b32 v13,16,v13
v_mul_u32_u24 v16,24,v13
v_sub_u32 v12,v12,v16
v_mul_u32_u24 v104,12288,v13
v_lshl_add_u32 v104,v12,4,v104
v_add_u32 v12,64,v0
v_mul_u32_u24 v13,2731,v12
v_lshrrev_b32 v13,16,v13
v_mul_u32_u24 v16,24,v13
v_sub_u32 v12,v12,v16
v_mul_u32_u24 v105,12288,v13
v_lshl_add_u32 v105,v12,4,v105
v_add_u32 v12,128,v0
v_mul_u32_u24 v13,2731,v12
v_lshrrev_b32 v13,16,v13
v_mul_u32_u24 v16,24,v13
v_sub_u32 v12,v12,v16
v_mul_u32_u24 v106,12288,v13
v_lshl_add_u32 v106,v12,4,v106
s_mov_b32 s4,s20
s_mov_b32 s5,s21
s_mov_b32 s6,7864320
s_mov_b32 s7,0x20000
s_mov_b32 s52,s22
s_mov_b32 s53,s23
s_mov_b32 s54,7864320
s_mov_b32 s55,0x20000
s_branch SV_LOAD
ROLE_CV:
s_lshr_b32 s28,s48,3
s_and_b32 s29,s48,7
s_mul_i32 s82,s28,2097152
s_add_u32 s82,s82,2097152
v_lshlrev_b32 v1,4,v0
v_and_b32 v12,1,v0
v_mul_u32_u24 v2,0xaaaa,v12
v_or_b32 v2,0x4444,v2
s_add_u32 s60,s46,1
s_and_b32 s60,s60,3
s_lshl_b32 s60,s60,11
s_add_u32 s60,s60,131072
v_add_u32 v3,s60,v1
s_add_u32 s60,s46,2
s_and_b32 s60,s60,3
s_lshl_b32 s60,s60,11
s_add_u32 s60,s60,131072
v_add_u32 v4,s60,v1
s_add_u32 s60,s46,3
s_and_b32 s60,s60,3
s_lshl_b32 s60,s60,11
s_add_u32 s60,s60,131072
v_add_u32 v5,s60,v1
v_add_u32 v59,139264,v1
s_lshl_b32 s60,s46,11
s_add_u32 s60,s60,131072
v_add_u32 v22,s60,v1
s_lshr_b32 s60,s46,1
s_lshl_b32 s60,s60,10
s_and_b32 s61,s46,1
s_lshl_b32 s61,s61,3
s_add_u32 s60,s60,s61
v_add_u32 v23,s60,v59
s_mul_i32 s60,s46,20480
v_add_u32 v21,s60,v1
v_and_b32 v11,7,v0
v_lshlrev_b32 v11,2,v11
v_bfe_u32 v12,v0,3,2
v_lshl_add_u32 v11,v12,7,v11
s_xor_b32 s60,s28,1
s_lshl_b32 s60,s60,19
s_lshl_b32 s61,s46,11
s_add_u32 s83,s60,s61
s_add_u32 s83,s83,10485760
s_mov_b32 s36,1
v_mov_b32 v8,0
v_mov_b32 v9,0
v_mov_b32 v20,0
s_and_b32 s62,s46,1
s_lshl_b32 s60,s62,11
v_add_u32 v6,s60,v1
s_lshl_b32 s60,s62,3
s_add_u32 s60,s60,1024
v_add_u32 v7,s60,v1
s_lshr_b32 s61,s46,1
s_lshl_b32 s60,s29,1
s_add_u32 s60,s60,s61
s_mul_i32 s60,s60,3072
s_add_u32 s60,s60,s82
s_add_u32 s34,s60,557056
s_lshl_b32 s60,s48,1
s_add_u32 s60,s60,s61
s_mul_i32 s85,s60,6144
s_add_u32 s85,s85,24120320
s_lshl_b32 s86,s60,5
s_lshl_b32 s61,s62,2
s_add_u32 s86,s86,s61
s_add_u32 s86,s86,688132
v_mov_b32 v12,-1
v_mov_b32 v13,-1
v_mov_b32 v14,-1
v_mov_b32 v15,-1
s_cmp_lg_u32 s49,0
s_cbranch_scc1 ls_4
s_add_u32 s60,s34,0
buffer_store_dwordx4 v[12:15],v6,s[8:11],s60 offen
buffer_store_dwordx2 v[12:13],v7,s[8:11],s60 offen
s_add_u32 s60,s34,49152
buffer_store_dwordx4 v[12:15],v6,s[8:11],s60 offen
buffer_store_dwordx2 v[12:13],v7,s[8:11],s60 offen
s_add_u32 s60,s34,98304
buffer_store_dwordx4 v[12:15],v6,s[8:11],s60 offen
buffer_store_dwordx2 v[12:13],v7,s[8:11],s60 offen
s_add_u32 s60,s34,147456
buffer_store_dwordx4 v[12:15],v6,s[8:11],s60 offen
buffer_store_dwordx2 v[12:13],v7,s[8:11],s60 offen
s_add_u32 s60,s34,196608
buffer_store_dwordx4 v[12:15],v6,s[8:11],s60 offen
buffer_store_dwordx2 v[12:13],v7,s[8:11],s60 offen
s_add_u32 s60,s34,245760
buffer_store_dwordx4 v[12:15],v6,s[8:11],s60 offen
buffer_store_dwordx2 v[12:13],v7,s[8:11],s60 offen
s_add_u32 s60,s34,294912
buffer_store_dwordx4 v[12:15],v6,s[8:11],s60 offen
buffer_store_dwordx2 v[12:13],v7,s[8:11],s60 offen
s_add_u32 s60,s34,344064
buffer_store_dwordx4 v[12:15],v6,s[8:11],s60 offen
buffer_store_dwordx2 v[12:13],v7,s[8:11],s60 offen
s_branch ls_5
ls_4:
s_add_u32 s60,s34,0
buffer_store_dwordx4 v[12:15],v6,s[8:11],s60 offen sc1
buffer_store_dwordx2 v[12:13],v7,s[8:11],s60 offen sc1
s_add_u32 s60,s34,49152
buffer_store_dwordx4 v[12:15],v6,s[8:11],s60 offen sc1
buffer_store_dwordx2 v[12:13],v7,s[8:11],s60 offen sc1
s_add_u32 s60,s34,98304
buffer_store_dwordx4 v[12:15],v6,s[8:11],s60 offen sc1
buffer_store_dwordx2 v[12:13],v7,s[8:11],s60 offen sc1
s_add_u32 s60,s34,147456
buffer_store_dwordx4 v[12:15],v6,s[8:11],s60 offen sc1
buffer_store_dwordx2 v[12:13],v7,s[8:11],s60 offen sc1
s_add_u32 s60,s34,196608
buffer_store_dwordx4 v[12:15],v6,s[8:11],s60 offen sc1
buffer_store_dwordx2 v[12:13],v7,s[8:11],s60 offen sc1
s_add_u32 s60,s34,245760
buffer_store_dwordx4 v[12:15],v6,s[8:11],s60 offen sc1
buffer_store_dwordx2 v[12:13],v7,s[8:11],s60 offen sc1
s_add_u32 s60,s34,294912
buffer_store_dwordx4 v[12:15],v6,s[8:11],s60 offen sc1
buffer_store_dwordx2 v[12:13],v7,s[8:11],s60 offen sc1
s_add_u32 s60,s34,344064
buffer_store_dwordx4 v[12:15],v6,s[8:11],s60 offen sc1
buffer_store_dwordx2 v[12:13],v7,s[8:11],s60 offen sc1
s_nop 0
ls_5:
s_mul_i32 s73,s48,768
s_add_u32 s74,s73,96
v_add_u32 v12,0,v0
v_mul_u32_u24 v13,2731,v12
v_lshrrev_b32 v13,16,v13
v_mul_u32_u24 v16,24,v13
v_sub_u32 v12,v12,v16
v_mul_u32_u24 v104,12288,v13
v_lshl_add_u32 v104,v12,4,v104
v_mul_u32_u24 v13,43,v12
v_lshrrev_b32 v13,8,v13
v_mul_u32_u24 v13,96,v13
v_add_u32 v104,v104,v13
v_add_u32 v12,64,v0
v_mul_u32_u24 v13,2731,v12
v_lshrrev_b32 v13,16,v13
v_mul_u32_u24 v16,24,v13
v_sub_u32 v12,v12,v16
v_mul_u32_u24 v105,12288,v13
v_lshl_add_u32 v105,v12,4,v105
v_mul_u32_u24 v13,43,v12
v_lshrrev_b32 v13,8,v13
v_mul_u32_u24 v13,96,v13
v_add_u32 v105,v105,v13
v_add_u32 v12,128,v0
v_mul_u32_u24 v13,2731,v12
v_lshrrev_b32 v13,16,v13
v_mul_u32_u24 v16,24,v13
v_sub_u32 v12,v12,v16
v_mul_u32_u24 v106,12288,v13
v_lshl_add_u32 v106,v12,4,v106
v_mul_u32_u24 v13,43,v12
v_lshrrev_b32 v13,8,v13
v_mul_u32_u24 v13,96,v13
v_add_u32 v106,v106,v13
s_mov_b32 s4,s24
s_mov_b32 s5,s25
s_mov_b32 s6,7864320
s_mov_b32 s7,0x20000
s_mov_b32 s52,s24
s_mov_b32 s53,s25
s_mov_b32 s54,7864320
s_mov_b32 s55,0x20000
SV_LOAD:
s_waitcnt vmcnt(0)
s_barrier
s_cmp_lg_u32 s46,0
s_cbranch_scc1 arr_6
v_mov_b32 v12,1
s_lshl_b32 s3,s49,2
v_mov_b32 v13,s3
s_mov_b64 exec,1
buffer_atomic_add v12,v13,s[12:15],0 offen sc1
s_mov_b64 exec,-1
arr_6:
s_and_b32 s60,s46,1
s_mul_i32 s60,s60,196608
s_lshr_b32 s61,s46,1
s_mul_i32 s75,s61,393216
s_add_u32 s75,s75,s60
s_mul_i32 s76,s61,393216
s_add_u32 s76,s76,s60
s_mul_i32 s77,s46,6144
v_lshrrev_b32 v14,4,v0
v_and_b32 v15,15,v0
v_and_b32 v12,1,v14
v_lshlrev_b32 v12,2,v12
v_lshrrev_b32 v13,1,v14
v_lshl_add_u32 v12,v13,4,v12
v_bfe_u32 v13,v0,2,1
v_add_u32 v12,v12,v13
v_bfe_u32 v13,v0,3,1
v_lshl_add_u32 v12,v13,3,v12
v_mul_u32_u24 v107,384,v12
v_and_b32 v13,3,v0
v_lshl_add_u32 v107,v13,3,v107
s_mul_i32 s60,s46,96
v_add_u32 v107,s60,v107
s_add_u32 s60,s75,s73
s_add_u32 m0,s77,0
s_add_u32 s61,s60,0
buffer_load_dwordx4 v104,s[4:7],s61 offen lds
s_add_u32 m0,s77,1024
s_add_u32 s61,s60,0
buffer_load_dwordx4 v105,s[4:7],s61 offen lds
s_add_u32 m0,s77,2048
s_add_u32 s61,s60,0
buffer_load_dwordx4 v106,s[4:7],s61 offen lds
s_add_u32 m0,s77,3072
s_add_u32 s61,s60,98304
buffer_load_dwordx4 v104,s[4:7],s61 offen lds
s_add_u32 m0,s77,4096
s_add_u32 s61,s60,98304
buffer_load_dwordx4 v105,s[4:7],s61 offen lds
s_add_u32 m0,s77,5120
s_add_u32 s61,s60,98304
buffer_load_dwordx4 v106,s[4:7],s61 offen lds
s_add_u32 s60,s75,s74
s_add_u32 m0,s77,24576
s_add_u32 s61,s60,0
buffer_load_dwordx4 v104,s[52:55],s61 offen lds
s_add_u32 m0,s77,25600
s_add_u32 s61,s60,0
buffer_load_dwordx4 v105,s[52:55],s61 offen lds
s_add_u32 m0,s77,26624
s_add_u32 s61,s60,0
buffer_load_dwordx4 v106,s[52:55],s61 offen lds
s_add_u32 m0,s77,27648
s_add_u32 s61,s60,98304
buffer_load_dwordx4 v104,s[52:55],s61 offen lds
s_add_u32 m0,s77,28672
s_add_u32 s61,s60,98304
buffer_load_dwordx4 v105,s[52:55],s61 offen lds
s_add_u32 m0,s77,29696
s_add_u32 s61,s60,98304
buffer_load_dwordx4 v106,s[52:55],s61 offen lds
s_add_u32 s60,s75,s73
s_add_u32 m0,s77,49152
s_add_u32 s61,s60,786432
buffer_load_dwordx4 v104,s[4:7],s61 offen lds
s_add_u32 m0,s77,50176
s_add_u32 s61,s60,786432
buffer_load_dwordx4 v105,s[4:7],s61 offen lds
s_add_u32 m0,s77,51200
s_add_u32 s61,s60,786432
buffer_load_dwordx4 v106,s[4:7],s61 offen lds
s_add_u32 m0,s77,52224
s_add_u32 s61,s60,884736
buffer_load_dwordx4 v104,s[4:7],s61 offen lds
s_add_u32 m0,s77,53248
s_add_u32 s61,s60,884736
buffer_load_dwordx4 v105,s[4:7],s61 offen lds
s_add_u32 m0,s77,54272
s_add_u32 s61,s60,884736
buffer_load_dwordx4 v106,s[4:7],s61 offen lds
s_add_u32 s60,s75,s74
s_add_u32 m0,s77,73728
s_add_u32 s61,s60,786432
buffer_load_dwordx4 v104,s[52:55],s61 offen lds
s_add_u32 m0,s77,74752
s_add_u32 s61,s60,786432
buffer_load_dwordx4 v105,s[52:55],s61 offen lds
s_add_u32 m0,s77,75776
s_add_u32 s61,s60,786432
buffer_load_dwordx4 v106,s[52:55],s61 offen lds
s_add_u32 m0,s77,76800
s_add_u32 s61,s60,884736
buffer_load_dwordx4 v104,s[52:55],s61 offen lds
s_add_u32 m0,s77,77824
s_add_u32 s61,s60,884736
buffer_load_dwordx4 v105,s[52:55],s61 offen lds
s_add_u32 m0,s77,78848
s_add_u32 s61,s60,884736
buffer_load_dwordx4 v106,s[52:55],s61 offen lds
s_add_u32 s60,s75,s73
s_add_u32 m0,s77,98304
s_add_u32 s61,s60,1572864
buffer_load_dwordx4 v104,s[4:7],s61 offen lds
s_add_u32 m0,s77,99328
s_add_u32 s61,s60,1572864
buffer_load_dwordx4 v105,s[4:7],s61 offen lds
s_add_u32 m0,s77,100352
s_add_u32 s61,s60,1572864
buffer_load_dwordx4 v106,s[4:7],s61 offen lds
s_add_u32 m0,s77,101376
s_add_u32 s61,s60,1671168
buffer_load_dwordx4 v104,s[4:7],s61 offen lds
s_add_u32 m0,s77,102400
s_add_u32 s61,s60,1671168
buffer_load_dwordx4 v105,s[4:7],s61 offen lds
s_add_u32 m0,s77,103424
s_add_u32 s61,s60,1671168
buffer_load_dwordx4 v106,s[4:7],s61 offen lds
s_waitcnt vmcnt(24)
s_barrier
s_add_u32 s60,s75,s74
s_add_u32 m0,s77,122880
s_add_u32 s61,s60,1572864
buffer_load_dwordx4 v104,s[52:55],s61 offen lds
s_add_u32 m0,s77,123904
s_add_u32 s61,s60,1572864
buffer_load_dwordx4 v105,s[52:55],s61 offen lds
s_add_u32 m0,s77,124928
s_add_u32 s61,s60,1572864
buffer_load_dwordx4 v106,s[52:55],s61 offen lds
s_add_u32 m0,s77,125952
s_add_u32 s61,s60,1671168
buffer_load_dwordx4 v104,s[52:55],s61 offen lds
s_add_u32 m0,s77,126976
s_add_u32 s61,s60,1671168
buffer_load_dwordx4 v105,s[52:55],s61 offen lds
s_add_u32 m0,s77,128000
s_add_u32 s61,s60,1671168
buffer_load_dwordx4 v106,s[52:55],s61 offen lds
v_add_u32 v12,0,v107
s_cmp_eq_u32 s46,1
s_cbranch_scc1 lw_9
s_cmp_eq_u32 s46,2
s_cbranch_scc1 lw_10
s_cmp_eq_u32 s46,3
s_cbranch_scc1 lw_11
lw_8:
ds_read_b64_tr_b16 a[0:1],v12 offset:0
ds_read_b64_tr_b16 a[2:3],v12 offset:768
ds_read_b64_tr_b16 a[4:5],v12 offset:12288
ds_read_b64_tr_b16 a[6:7],v12 offset:13056
ds_read_b64_tr_b16 a[8:9],v12 offset:32
ds_read_b64_tr_b16 a[10:11],v12 offset:800
ds_read_b64_tr_b16 a[12:13],v12 offset:12320
ds_read_b64_tr_b16 a[14:15],v12 offset:13088
ds_read_b64_tr_b16 a[16:17],v12 offset:64
ds_read_b64_tr_b16 a[18:19],v12 offset:832
ds_read_b64_tr_b16 a[20:21],v12 offset:12352
ds_read_b64_tr_b16 a[22:23],v12 offset:13120
s_branch ld_7
lw_9:
ds_read_b64_tr_b16 a[240:241],v12 offset:0
ds_read_b64_tr_b16 a[242:243],v12 offset:768
ds_read_b64_tr_b16 a[244:245],v12 offset:12288
ds_read_b64_tr_b16 a[246:247],v12 offset:13056
ds_read_b64_tr_b16 a[248:249],v12 offset:32
ds_read_b64_tr_b16 a[250:251],v12 offset:800
ds_read_b64_tr_b16 a[252:253],v12 offset:12320
ds_read_b64_tr_b16 a[254:255],v12 offset:13088
ds_read_b64_tr_b16 v[112:113],v12 offset:64
ds_read_b64_tr_b16 v[114:115],v12 offset:832
ds_read_b64_tr_b16 v[116:117],v12 offset:12352
ds_read_b64_tr_b16 v[118:119],v12 offset:13120
s_branch ld_7
lw_10:
ds_read_b64_tr_b16 a[160:161],v12 offset:0
ds_read_b64_tr_b16 a[162:163],v12 offset:768
ds_read_b64_tr_b16 a[164:165],v12 offset:12288
ds_read_b64_tr_b16 a[166:167],v12 offset:13056
ds_read_b64_tr_b16 a[168:169],v12 offset:32
ds_read_b64_tr_b16 a[170:171],v12 offset:800
ds_read_b64_tr_b16 a[172:173],v12 offset:12320
ds_read_b64_tr_b16 a[174:175],v12 offset:13088
ds_read_b64_tr_b16 a[176:177],v12 offset:64
ds_read_b64_tr_b16 a[178:179],v12 offset:832
ds_read_b64_tr_b16 a[180:181],v12 offset:12352
ds_read_b64_tr_b16 a[182:183],v12 offset:13120
s_branch ld_7
lw_11:
ds_read_b64_tr_b16 a[80:81],v12 offset:0
ds_read_b64_tr_b16 a[82:83],v12 offset:768
ds_read_b64_tr_b16 a[84:85],v12 offset:12288
ds_read_b64_tr_b16 a[86:87],v12 offset:13056
ds_read_b64_tr_b16 a[88:89],v12 offset:32
ds_read_b64_tr_b16 a[90:91],v12 offset:800
ds_read_b64_tr_b16 a[92:93],v12 offset:12320
ds_read_b64_tr_b16 a[94:95],v12 offset:13088
ds_read_b64_tr_b16 a[96:97],v12 offset:64
ds_read_b64_tr_b16 a[98:99],v12 offset:832
ds_read_b64_tr_b16 a[100:101],v12 offset:12352
ds_read_b64_tr_b16 a[102:103],v12 offset:13120
ld_7:
s_waitcnt lgkmcnt(0)
s_waitcnt vmcnt(24)
s_barrier
s_add_u32 s60,s75,s73
s_add_u32 m0,s77,0
s_add_u32 s61,s60,2359296
buffer_load_dwordx4 v104,s[4:7],s61 offen lds
s_add_u32 m0,s77,1024
s_add_u32 s61,s60,2359296
buffer_load_dwordx4 v105,s[4:7],s61 offen lds
s_add_u32 m0,s77,2048
s_add_u32 s61,s60,2359296
buffer_load_dwordx4 v106,s[4:7],s61 offen lds
s_add_u32 m0,s77,3072
s_add_u32 s61,s60,2457600
buffer_load_dwordx4 v104,s[4:7],s61 offen lds
s_add_u32 m0,s77,4096
s_add_u32 s61,s60,2457600
buffer_load_dwordx4 v105,s[4:7],s61 offen lds
s_add_u32 m0,s77,5120
s_add_u32 s61,s60,2457600
buffer_load_dwordx4 v106,s[4:7],s61 offen lds
v_add_u32 v12,24576,v107
s_cmp_eq_u32 s46,1
s_cbranch_scc1 lw_14
s_cmp_eq_u32 s46,2
s_cbranch_scc1 lw_15
s_cmp_eq_u32 s46,3
s_cbranch_scc1 lw_16
lw_13:
ds_read_b64_tr_b16 a[24:25],v12 offset:0
ds_read_b64_tr_b16 a[26:27],v12 offset:768
ds_read_b64_tr_b16 a[28:29],v12 offset:12288
ds_read_b64_tr_b16 a[30:31],v12 offset:13056
ds_read_b64_tr_b16 a[32:33],v12 offset:32
ds_read_b64_tr_b16 a[34:35],v12 offset:800
ds_read_b64_tr_b16 a[36:37],v12 offset:12320
ds_read_b64_tr_b16 a[38:39],v12 offset:13088
ds_read_b64_tr_b16 v[24:25],v12 offset:64
ds_read_b64_tr_b16 v[26:27],v12 offset:832
ds_read_b64_tr_b16 v[28:29],v12 offset:12352
ds_read_b64_tr_b16 v[30:31],v12 offset:13120
s_branch ld_12
lw_14:
ds_read_b64_tr_b16 v[120:121],v12 offset:0
ds_read_b64_tr_b16 v[122:123],v12 offset:768
ds_read_b64_tr_b16 v[124:125],v12 offset:12288
ds_read_b64_tr_b16 v[126:127],v12 offset:13056
ds_read_b64_tr_b16 v[128:129],v12 offset:32
ds_read_b64_tr_b16 v[130:131],v12 offset:800
ds_read_b64_tr_b16 v[132:133],v12 offset:12320
ds_read_b64_tr_b16 v[134:135],v12 offset:13088
ds_read_b64_tr_b16 v[72:73],v12 offset:64
ds_read_b64_tr_b16 v[74:75],v12 offset:832
ds_read_b64_tr_b16 v[76:77],v12 offset:12352
ds_read_b64_tr_b16 v[78:79],v12 offset:13120
s_branch ld_12
lw_15:
ds_read_b64_tr_b16 a[184:185],v12 offset:0
ds_read_b64_tr_b16 a[186:187],v12 offset:768
ds_read_b64_tr_b16 a[188:189],v12 offset:12288
ds_read_b64_tr_b16 a[190:191],v12 offset:13056
ds_read_b64_tr_b16 a[192:193],v12 offset:32
ds_read_b64_tr_b16 a[194:195],v12 offset:800
ds_read_b64_tr_b16 a[196:197],v12 offset:12320
ds_read_b64_tr_b16 a[198:199],v12 offset:13088
ds_read_b64_tr_b16 v[56:57],v12 offset:64
ds_read_b64_tr_b16 v[58:59],v12 offset:832
ds_read_b64_tr_b16 v[60:61],v12 offset:12352
ds_read_b64_tr_b16 v[62:63],v12 offset:13120
s_branch ld_12
lw_16:
ds_read_b64_tr_b16 a[104:105],v12 offset:0
ds_read_b64_tr_b16 a[106:107],v12 offset:768
ds_read_b64_tr_b16 a[108:109],v12 offset:12288
ds_read_b64_tr_b16 a[110:111],v12 offset:13056
ds_read_b64_tr_b16 a[112:113],v12 offset:32
ds_read_b64_tr_b16 a[114:115],v12 offset:800
ds_read_b64_tr_b16 a[116:117],v12 offset:12320
ds_read_b64_tr_b16 a[118:119],v12 offset:13088
ds_read_b64_tr_b16 v[40:41],v12 offset:64
ds_read_b64_tr_b16 v[42:43],v12 offset:832
ds_read_b64_tr_b16 v[44:45],v12 offset:12352
ds_read_b64_tr_b16 v[46:47],v12 offset:13120
ld_12:
s_waitcnt lgkmcnt(0)
s_waitcnt vmcnt(24)
s_barrier
s_add_u32 s60,s75,s74
s_add_u32 m0,s77,24576
s_add_u32 s61,s60,2359296
buffer_load_dwordx4 v104,s[52:55],s61 offen lds
s_add_u32 m0,s77,25600
s_add_u32 s61,s60,2359296
buffer_load_dwordx4 v105,s[52:55],s61 offen lds
s_add_u32 m0,s77,26624
s_add_u32 s61,s60,2359296
buffer_load_dwordx4 v106,s[52:55],s61 offen lds
s_add_u32 m0,s77,27648
s_add_u32 s61,s60,2457600
buffer_load_dwordx4 v104,s[52:55],s61 offen lds
s_add_u32 m0,s77,28672
s_add_u32 s61,s60,2457600
buffer_load_dwordx4 v105,s[52:55],s61 offen lds
s_add_u32 m0,s77,29696
s_add_u32 s61,s60,2457600
buffer_load_dwordx4 v106,s[52:55],s61 offen lds
v_add_u32 v12,49152,v107
s_cmp_eq_u32 s46,1
s_cbranch_scc1 lw_19
s_cmp_eq_u32 s46,2
s_cbranch_scc1 lw_20
s_cmp_eq_u32 s46,3
s_cbranch_scc1 lw_21
lw_18:
ds_read_b64_tr_b16 a[40:41],v12 offset:0
ds_read_b64_tr_b16 a[42:43],v12 offset:768
ds_read_b64_tr_b16 a[44:45],v12 offset:12288
ds_read_b64_tr_b16 a[46:47],v12 offset:13056
ds_read_b64_tr_b16 a[48:49],v12 offset:32
ds_read_b64_tr_b16 a[50:51],v12 offset:800
ds_read_b64_tr_b16 a[52:53],v12 offset:12320
ds_read_b64_tr_b16 a[54:55],v12 offset:13088
ds_read_b64_tr_b16 a[56:57],v12 offset:64
ds_read_b64_tr_b16 a[58:59],v12 offset:832
ds_read_b64_tr_b16 a[60:61],v12 offset:12352
ds_read_b64_tr_b16 a[62:63],v12 offset:13120
s_branch ld_17
lw_19:
ds_read_b64_tr_b16 v[136:137],v12 offset:0
ds_read_b64_tr_b16 v[138:139],v12 offset:768
ds_read_b64_tr_b16 v[140:141],v12 offset:12288
ds_read_b64_tr_b16 v[142:143],v12 offset:13056
ds_read_b64_tr_b16 v[144:145],v12 offset:32
ds_read_b64_tr_b16 v[146:147],v12 offset:800
ds_read_b64_tr_b16 v[148:149],v12 offset:12320
ds_read_b64_tr_b16 v[150:151],v12 offset:13088
ds_read_b64_tr_b16 v[152:153],v12 offset:64
ds_read_b64_tr_b16 v[154:155],v12 offset:832
ds_read_b64_tr_b16 v[156:157],v12 offset:12352
ds_read_b64_tr_b16 v[158:159],v12 offset:13120
s_branch ld_17
lw_20:
ds_read_b64_tr_b16 a[200:201],v12 offset:0
ds_read_b64_tr_b16 a[202:203],v12 offset:768
ds_read_b64_tr_b16 a[204:205],v12 offset:12288
ds_read_b64_tr_b16 a[206:207],v12 offset:13056
ds_read_b64_tr_b16 a[208:209],v12 offset:32
ds_read_b64_tr_b16 a[210:211],v12 offset:800
ds_read_b64_tr_b16 a[212:213],v12 offset:12320
ds_read_b64_tr_b16 a[214:215],v12 offset:13088
ds_read_b64_tr_b16 a[216:217],v12 offset:64
ds_read_b64_tr_b16 a[218:219],v12 offset:832
ds_read_b64_tr_b16 a[220:221],v12 offset:12352
ds_read_b64_tr_b16 a[222:223],v12 offset:13120
s_branch ld_17
lw_21:
ds_read_b64_tr_b16 a[120:121],v12 offset:0
ds_read_b64_tr_b16 a[122:123],v12 offset:768
ds_read_b64_tr_b16 a[124:125],v12 offset:12288
ds_read_b64_tr_b16 a[126:127],v12 offset:13056
ds_read_b64_tr_b16 a[128:129],v12 offset:32
ds_read_b64_tr_b16 a[130:131],v12 offset:800
ds_read_b64_tr_b16 a[132:133],v12 offset:12320
ds_read_b64_tr_b16 a[134:135],v12 offset:13088
ds_read_b64_tr_b16 a[136:137],v12 offset:64
ds_read_b64_tr_b16 a[138:139],v12 offset:832
ds_read_b64_tr_b16 a[140:141],v12 offset:12352
ds_read_b64_tr_b16 a[142:143],v12 offset:13120
ld_17:
s_waitcnt lgkmcnt(0)
s_waitcnt vmcnt(24)
s_barrier
s_add_u32 s60,s75,s73
s_add_u32 m0,s77,49152
s_add_u32 s61,s60,3145728
buffer_load_dwordx4 v104,s[4:7],s61 offen lds
s_add_u32 m0,s77,50176
s_add_u32 s61,s60,3145728
buffer_load_dwordx4 v105,s[4:7],s61 offen lds
s_add_u32 m0,s77,51200
s_add_u32 s61,s60,3145728
buffer_load_dwordx4 v106,s[4:7],s61 offen lds
s_add_u32 m0,s77,52224
s_add_u32 s61,s60,3244032
buffer_load_dwordx4 v104,s[4:7],s61 offen lds
s_add_u32 m0,s77,53248
s_add_u32 s61,s60,3244032
buffer_load_dwordx4 v105,s[4:7],s61 offen lds
s_add_u32 m0,s77,54272
s_add_u32 s61,s60,3244032
buffer_load_dwordx4 v106,s[4:7],s61 offen lds
v_add_u32 v12,73728,v107
s_cmp_eq_u32 s46,1
s_cbranch_scc1 lw_24
s_cmp_eq_u32 s46,2
s_cbranch_scc1 lw_25
s_cmp_eq_u32 s46,3
s_cbranch_scc1 lw_26
lw_23:
ds_read_b64_tr_b16 a[64:65],v12 offset:0
ds_read_b64_tr_b16 a[66:67],v12 offset:768
ds_read_b64_tr_b16 a[68:69],v12 offset:12288
ds_read_b64_tr_b16 a[70:71],v12 offset:13056
ds_read_b64_tr_b16 a[72:73],v12 offset:32
ds_read_b64_tr_b16 a[74:75],v12 offset:800
ds_read_b64_tr_b16 a[76:77],v12 offset:12320
ds_read_b64_tr_b16 a[78:79],v12 offset:13088
ds_read_b64_tr_b16 v[32:33],v12 offset:64
ds_read_b64_tr_b16 v[34:35],v12 offset:832
ds_read_b64_tr_b16 v[36:37],v12 offset:12352
ds_read_b64_tr_b16 v[38:39],v12 offset:13120
s_branch ld_22
lw_24:
ds_read_b64_tr_b16 v[160:161],v12 offset:0
ds_read_b64_tr_b16 v[162:163],v12 offset:768
ds_read_b64_tr_b16 v[164:165],v12 offset:12288
ds_read_b64_tr_b16 v[166:167],v12 offset:13056
ds_read_b64_tr_b16 v[168:169],v12 offset:32
ds_read_b64_tr_b16 v[170:171],v12 offset:800
ds_read_b64_tr_b16 v[172:173],v12 offset:12320
ds_read_b64_tr_b16 v[174:175],v12 offset:13088
ds_read_b64_tr_b16 v[80:81],v12 offset:64
ds_read_b64_tr_b16 v[82:83],v12 offset:832
ds_read_b64_tr_b16 v[84:85],v12 offset:12352
ds_read_b64_tr_b16 v[86:87],v12 offset:13120
s_branch ld_22
lw_25:
ds_read_b64_tr_b16 a[224:225],v12 offset:0
ds_read_b64_tr_b16 a[226:227],v12 offset:768
ds_read_b64_tr_b16 a[228:229],v12 offset:12288
ds_read_b64_tr_b16 a[230:231],v12 offset:13056
ds_read_b64_tr_b16 a[232:233],v12 offset:32
ds_read_b64_tr_b16 a[234:235],v12 offset:800
ds_read_b64_tr_b16 a[236:237],v12 offset:12320
ds_read_b64_tr_b16 a[238:239],v12 offset:13088
ds_read_b64_tr_b16 v[64:65],v12 offset:64
ds_read_b64_tr_b16 v[66:67],v12 offset:832
ds_read_b64_tr_b16 v[68:69],v12 offset:12352
ds_read_b64_tr_b16 v[70:71],v12 offset:13120
s_branch ld_22
lw_26:
ds_read_b64_tr_b16 a[144:145],v12 offset:0
ds_read_b64_tr_b16 a[146:147],v12 offset:768
ds_read_b64_tr_b16 a[148:149],v12 offset:12288
ds_read_b64_tr_b16 a[150:151],v12 offset:13056
ds_read_b64_tr_b16 a[152:153],v12 offset:32
ds_read_b64_tr_b16 a[154:155],v12 offset:800
ds_read_b64_tr_b16 a[156:157],v12 offset:12320
ds_read_b64_tr_b16 a[158:159],v12 offset:13088
ds_read_b64_tr_b16 v[48:49],v12 offset:64
ds_read_b64_tr_b16 v[50:51],v12 offset:832
ds_read_b64_tr_b16 v[52:53],v12 offset:12352
ds_read_b64_tr_b16 v[54:55],v12 offset:13120
ld_22:
s_waitcnt lgkmcnt(0)
s_waitcnt vmcnt(24)
s_barrier
s_add_u32 s60,s75,s74
s_add_u32 m0,s77,73728
s_add_u32 s61,s60,3145728
buffer_load_dwordx4 v104,s[52:55],s61 offen lds
s_add_u32 m0,s77,74752
s_add_u32 s61,s60,3145728
buffer_load_dwordx4 v105,s[52:55],s61 offen lds
s_add_u32 m0,s77,75776
s_add_u32 s61,s60,3145728
buffer_load_dwordx4 v106,s[52:55],s61 offen lds
s_add_u32 m0,s77,76800
s_add_u32 s61,s60,3244032
buffer_load_dwordx4 v104,s[52:55],s61 offen lds
s_add_u32 m0,s77,77824
s_add_u32 s61,s60,3244032
buffer_load_dwordx4 v105,s[52:55],s61 offen lds
s_add_u32 m0,s77,78848
s_add_u32 s61,s60,3244032
buffer_load_dwordx4 v106,s[52:55],s61 offen lds
v_add_u32 v12,98304,v107
s_cmp_eq_u32 s46,1
s_cbranch_scc1 lw_29
s_cmp_eq_u32 s46,2
s_cbranch_scc1 lw_30
s_cmp_eq_u32 s46,3
s_cbranch_scc1 lw_31
lw_28:
ds_read_b64_tr_b16 a[80:81],v12 offset:0
ds_read_b64_tr_b16 a[82:83],v12 offset:768
ds_read_b64_tr_b16 a[84:85],v12 offset:12288
ds_read_b64_tr_b16 a[86:87],v12 offset:13056
ds_read_b64_tr_b16 a[88:89],v12 offset:32
ds_read_b64_tr_b16 a[90:91],v12 offset:800
ds_read_b64_tr_b16 a[92:93],v12 offset:12320
ds_read_b64_tr_b16 a[94:95],v12 offset:13088
ds_read_b64_tr_b16 a[96:97],v12 offset:64
ds_read_b64_tr_b16 a[98:99],v12 offset:832
ds_read_b64_tr_b16 a[100:101],v12 offset:12352
ds_read_b64_tr_b16 a[102:103],v12 offset:13120
s_branch ld_27
lw_29:
ds_read_b64_tr_b16 a[0:1],v12 offset:0
ds_read_b64_tr_b16 a[2:3],v12 offset:768
ds_read_b64_tr_b16 a[4:5],v12 offset:12288
ds_read_b64_tr_b16 a[6:7],v12 offset:13056
ds_read_b64_tr_b16 a[8:9],v12 offset:32
ds_read_b64_tr_b16 a[10:11],v12 offset:800
ds_read_b64_tr_b16 a[12:13],v12 offset:12320
ds_read_b64_tr_b16 a[14:15],v12 offset:13088
ds_read_b64_tr_b16 a[16:17],v12 offset:64
ds_read_b64_tr_b16 a[18:19],v12 offset:832
ds_read_b64_tr_b16 a[20:21],v12 offset:12352
ds_read_b64_tr_b16 a[22:23],v12 offset:13120
s_branch ld_27
lw_30:
ds_read_b64_tr_b16 a[240:241],v12 offset:0
ds_read_b64_tr_b16 a[242:243],v12 offset:768
ds_read_b64_tr_b16 a[244:245],v12 offset:12288
ds_read_b64_tr_b16 a[246:247],v12 offset:13056
ds_read_b64_tr_b16 a[248:249],v12 offset:32
ds_read_b64_tr_b16 a[250:251],v12 offset:800
ds_read_b64_tr_b16 a[252:253],v12 offset:12320
ds_read_b64_tr_b16 a[254:255],v12 offset:13088
ds_read_b64_tr_b16 v[112:113],v12 offset:64
ds_read_b64_tr_b16 v[114:115],v12 offset:832
ds_read_b64_tr_b16 v[116:117],v12 offset:12352
ds_read_b64_tr_b16 v[118:119],v12 offset:13120
s_branch ld_27
lw_31:
ds_read_b64_tr_b16 a[160:161],v12 offset:0
ds_read_b64_tr_b16 a[162:163],v12 offset:768
ds_read_b64_tr_b16 a[164:165],v12 offset:12288
ds_read_b64_tr_b16 a[166:167],v12 offset:13056
ds_read_b64_tr_b16 a[168:169],v12 offset:32
ds_read_b64_tr_b16 a[170:171],v12 offset:800
ds_read_b64_tr_b16 a[172:173],v12 offset:12320
ds_read_b64_tr_b16 a[174:175],v12 offset:13088
ds_read_b64_tr_b16 a[176:177],v12 offset:64
ds_read_b64_tr_b16 a[178:179],v12 offset:832
ds_read_b64_tr_b16 a[180:181],v12 offset:12352
ds_read_b64_tr_b16 a[182:183],v12 offset:13120
ld_27:
s_waitcnt lgkmcnt(0)
s_waitcnt vmcnt(24)
s_barrier
s_add_u32 s60,s75,s73
s_add_u32 m0,s77,98304
s_add_u32 s61,s60,3932160
buffer_load_dwordx4 v104,s[4:7],s61 offen lds
s_add_u32 m0,s77,99328
s_add_u32 s61,s60,3932160
buffer_load_dwordx4 v105,s[4:7],s61 offen lds
s_add_u32 m0,s77,100352
s_add_u32 s61,s60,3932160
buffer_load_dwordx4 v106,s[4:7],s61 offen lds
s_add_u32 m0,s77,101376
s_add_u32 s61,s60,4030464
buffer_load_dwordx4 v104,s[4:7],s61 offen lds
s_add_u32 m0,s77,102400
s_add_u32 s61,s60,4030464
buffer_load_dwordx4 v105,s[4:7],s61 offen lds
s_add_u32 m0,s77,103424
s_add_u32 s61,s60,4030464
buffer_load_dwordx4 v106,s[4:7],s61 offen lds
v_add_u32 v12,122880,v107
s_cmp_eq_u32 s46,1
s_cbranch_scc1 lw_34
s_cmp_eq_u32 s46,2
s_cbranch_scc1 lw_35
s_cmp_eq_u32 s46,3
s_cbranch_scc1 lw_36
lw_33:
ds_read_b64_tr_b16 a[104:105],v12 offset:0
ds_read_b64_tr_b16 a[106:107],v12 offset:768
ds_read_b64_tr_b16 a[108:109],v12 offset:12288
ds_read_b64_tr_b16 a[110:111],v12 offset:13056
ds_read_b64_tr_b16 a[112:113],v12 offset:32
ds_read_b64_tr_b16 a[114:115],v12 offset:800
ds_read_b64_tr_b16 a[116:117],v12 offset:12320
ds_read_b64_tr_b16 a[118:119],v12 offset:13088
ds_read_b64_tr_b16 v[40:41],v12 offset:64
ds_read_b64_tr_b16 v[42:43],v12 offset:832
ds_read_b64_tr_b16 v[44:45],v12 offset:12352
ds_read_b64_tr_b16 v[46:47],v12 offset:13120
s_branch ld_32
lw_34:
ds_read_b64_tr_b16 a[24:25],v12 offset:0
ds_read_b64_tr_b16 a[26:27],v12 offset:768
ds_read_b64_tr_b16 a[28:29],v12 offset:12288
ds_read_b64_tr_b16 a[30:31],v12 offset:13056
ds_read_b64_tr_b16 a[32:33],v12 offset:32
ds_read_b64_tr_b16 a[34:35],v12 offset:800
ds_read_b64_tr_b16 a[36:37],v12 offset:12320
ds_read_b64_tr_b16 a[38:39],v12 offset:13088
ds_read_b64_tr_b16 v[24:25],v12 offset:64
ds_read_b64_tr_b16 v[26:27],v12 offset:832
ds_read_b64_tr_b16 v[28:29],v12 offset:12352
ds_read_b64_tr_b16 v[30:31],v12 offset:13120
s_branch ld_32
lw_35:
ds_read_b64_tr_b16 v[120:121],v12 offset:0
ds_read_b64_tr_b16 v[122:123],v12 offset:768
ds_read_b64_tr_b16 v[124:125],v12 offset:12288
ds_read_b64_tr_b16 v[126:127],v12 offset:13056
ds_read_b64_tr_b16 v[128:129],v12 offset:32
ds_read_b64_tr_b16 v[130:131],v12 offset:800
ds_read_b64_tr_b16 v[132:133],v12 offset:12320
ds_read_b64_tr_b16 v[134:135],v12 offset:13088
ds_read_b64_tr_b16 v[72:73],v12 offset:64
ds_read_b64_tr_b16 v[74:75],v12 offset:832
ds_read_b64_tr_b16 v[76:77],v12 offset:12352
ds_read_b64_tr_b16 v[78:79],v12 offset:13120
s_branch ld_32
lw_36:
ds_read_b64_tr_b16 a[184:185],v12 offset:0
ds_read_b64_tr_b16 a[186:187],v12 offset:768
ds_read_b64_tr_b16 a[188:189],v12 offset:12288
ds_read_b64_tr_b16 a[190:191],v12 offset:13056
ds_read_b64_tr_b16 a[192:193],v12 offset:32
ds_read_b64_tr_b16 a[194:195],v12 offset:800
ds_read_b64_tr_b16 a[196:197],v12 offset:12320
ds_read_b64_tr_b16 a[198:199],v12 offset:13088
ds_read_b64_tr_b16 v[56:57],v12 offset:64
ds_read_b64_tr_b16 v[58:59],v12 offset:832
ds_read_b64_tr_b16 v[60:61],v12 offset:12352
ds_read_b64_tr_b16 v[62:63],v12 offset:13120
ld_32:
s_waitcnt lgkmcnt(0)
s_waitcnt vmcnt(24)
s_barrier
s_add_u32 s60,s75,s74
s_add_u32 m0,s77,122880
s_add_u32 s61,s60,3932160
buffer_load_dwordx4 v104,s[52:55],s61 offen lds
s_add_u32 m0,s77,123904
s_add_u32 s61,s60,3932160
buffer_load_dwordx4 v105,s[52:55],s61 offen lds
s_add_u32 m0,s77,124928
s_add_u32 s61,s60,3932160
buffer_load_dwordx4 v106,s[52:55],s61 offen lds
s_add_u32 m0,s77,125952
s_add_u32 s61,s60,4030464
buffer_load_dwordx4 v104,s[52:55],s61 offen lds
s_add_u32 m0,s77,126976
s_add_u32 s61,s60,4030464
buffer_load_dwordx4 v105,s[52:55],s61 offen lds
s_add_u32 m0,s77,128000
s_add_u32 s61,s60,4030464
buffer_load_dwordx4 v106,s[52:55],s61 offen lds
v_add_u32 v12,0,v107
s_cmp_eq_u32 s46,1
s_cbranch_scc1 lw_39
s_cmp_eq_u32 s46,2
s_cbranch_scc1 lw_40
s_cmp_eq_u32 s46,3
s_cbranch_scc1 lw_41
lw_38:
ds_read_b64_tr_b16 a[120:121],v12 offset:0
ds_read_b64_tr_b16 a[122:123],v12 offset:768
ds_read_b64_tr_b16 a[124:125],v12 offset:12288
ds_read_b64_tr_b16 a[126:127],v12 offset:13056
ds_read_b64_tr_b16 a[128:129],v12 offset:32
ds_read_b64_tr_b16 a[130:131],v12 offset:800
ds_read_b64_tr_b16 a[132:133],v12 offset:12320
ds_read_b64_tr_b16 a[134:135],v12 offset:13088
ds_read_b64_tr_b16 a[136:137],v12 offset:64
ds_read_b64_tr_b16 a[138:139],v12 offset:832
ds_read_b64_tr_b16 a[140:141],v12 offset:12352
ds_read_b64_tr_b16 a[142:143],v12 offset:13120
s_branch ld_37
lw_39:
ds_read_b64_tr_b16 a[40:41],v12 offset:0
ds_read_b64_tr_b16 a[42:43],v12 offset:768
ds_read_b64_tr_b16 a[44:45],v12 offset:12288
ds_read_b64_tr_b16 a[46:47],v12 offset:13056
ds_read_b64_tr_b16 a[48:49],v12 offset:32
ds_read_b64_tr_b16 a[50:51],v12 offset:800
ds_read_b64_tr_b16 a[52:53],v12 offset:12320
ds_read_b64_tr_b16 a[54:55],v12 offset:13088
ds_read_b64_tr_b16 a[56:57],v12 offset:64
ds_read_b64_tr_b16 a[58:59],v12 offset:832
ds_read_b64_tr_b16 a[60:61],v12 offset:12352
ds_read_b64_tr_b16 a[62:63],v12 offset:13120
s_branch ld_37
lw_40:
ds_read_b64_tr_b16 v[136:137],v12 offset:0
ds_read_b64_tr_b16 v[138:139],v12 offset:768
ds_read_b64_tr_b16 v[140:141],v12 offset:12288
ds_read_b64_tr_b16 v[142:143],v12 offset:13056
ds_read_b64_tr_b16 v[144:145],v12 offset:32
ds_read_b64_tr_b16 v[146:147],v12 offset:800
ds_read_b64_tr_b16 v[148:149],v12 offset:12320
ds_read_b64_tr_b16 v[150:151],v12 offset:13088
ds_read_b64_tr_b16 v[152:153],v12 offset:64
ds_read_b64_tr_b16 v[154:155],v12 offset:832
ds_read_b64_tr_b16 v[156:157],v12 offset:12352
ds_read_b64_tr_b16 v[158:159],v12 offset:13120
s_branch ld_37
lw_41:
ds_read_b64_tr_b16 a[200:201],v12 offset:0
ds_read_b64_tr_b16 a[202:203],v12 offset:768
ds_read_b64_tr_b16 a[204:205],v12 offset:12288
ds_read_b64_tr_b16 a[206:207],v12 offset:13056
ds_read_b64_tr_b16 a[208:209],v12 offset:32
ds_read_b64_tr_b16 a[210:211],v12 offset:800
ds_read_b64_tr_b16 a[212:213],v12 offset:12320
ds_read_b64_tr_b16 a[214:215],v12 offset:13088
ds_read_b64_tr_b16 a[216:217],v12 offset:64
ds_read_b64_tr_b16 a[218:219],v12 offset:832
ds_read_b64_tr_b16 a[220:221],v12 offset:12352
ds_read_b64_tr_b16 a[222:223],v12 offset:13120
ld_37:
s_waitcnt lgkmcnt(0)
s_waitcnt vmcnt(24)
s_barrier
s_add_u32 s60,s75,s73
s_add_u32 m0,s77,0
s_add_u32 s61,s60,4718592
buffer_load_dwordx4 v104,s[4:7],s61 offen lds
s_add_u32 m0,s77,1024
s_add_u32 s61,s60,4718592
buffer_load_dwordx4 v105,s[4:7],s61 offen lds
s_add_u32 m0,s77,2048
s_add_u32 s61,s60,4718592
buffer_load_dwordx4 v106,s[4:7],s61 offen lds
s_add_u32 m0,s77,3072
s_add_u32 s61,s60,4816896
buffer_load_dwordx4 v104,s[4:7],s61 offen lds
s_add_u32 m0,s77,4096
s_add_u32 s61,s60,4816896
buffer_load_dwordx4 v105,s[4:7],s61 offen lds
s_add_u32 m0,s77,5120
s_add_u32 s61,s60,4816896
buffer_load_dwordx4 v106,s[4:7],s61 offen lds
v_add_u32 v12,24576,v107
s_cmp_eq_u32 s46,1
s_cbranch_scc1 lw_44
s_cmp_eq_u32 s46,2
s_cbranch_scc1 lw_45
s_cmp_eq_u32 s46,3
s_cbranch_scc1 lw_46
lw_43:
ds_read_b64_tr_b16 a[144:145],v12 offset:0
ds_read_b64_tr_b16 a[146:147],v12 offset:768
ds_read_b64_tr_b16 a[148:149],v12 offset:12288
ds_read_b64_tr_b16 a[150:151],v12 offset:13056
ds_read_b64_tr_b16 a[152:153],v12 offset:32
ds_read_b64_tr_b16 a[154:155],v12 offset:800
ds_read_b64_tr_b16 a[156:157],v12 offset:12320
ds_read_b64_tr_b16 a[158:159],v12 offset:13088
ds_read_b64_tr_b16 v[48:49],v12 offset:64
ds_read_b64_tr_b16 v[50:51],v12 offset:832
ds_read_b64_tr_b16 v[52:53],v12 offset:12352
ds_read_b64_tr_b16 v[54:55],v12 offset:13120
s_branch ld_42
lw_44:
ds_read_b64_tr_b16 a[64:65],v12 offset:0
ds_read_b64_tr_b16 a[66:67],v12 offset:768
ds_read_b64_tr_b16 a[68:69],v12 offset:12288
ds_read_b64_tr_b16 a[70:71],v12 offset:13056
ds_read_b64_tr_b16 a[72:73],v12 offset:32
ds_read_b64_tr_b16 a[74:75],v12 offset:800
ds_read_b64_tr_b16 a[76:77],v12 offset:12320
ds_read_b64_tr_b16 a[78:79],v12 offset:13088
ds_read_b64_tr_b16 v[32:33],v12 offset:64
ds_read_b64_tr_b16 v[34:35],v12 offset:832
ds_read_b64_tr_b16 v[36:37],v12 offset:12352
ds_read_b64_tr_b16 v[38:39],v12 offset:13120
s_branch ld_42
lw_45:
ds_read_b64_tr_b16 v[160:161],v12 offset:0
ds_read_b64_tr_b16 v[162:163],v12 offset:768
ds_read_b64_tr_b16 v[164:165],v12 offset:12288
ds_read_b64_tr_b16 v[166:167],v12 offset:13056
ds_read_b64_tr_b16 v[168:169],v12 offset:32
ds_read_b64_tr_b16 v[170:171],v12 offset:800
ds_read_b64_tr_b16 v[172:173],v12 offset:12320
ds_read_b64_tr_b16 v[174:175],v12 offset:13088
ds_read_b64_tr_b16 v[80:81],v12 offset:64
ds_read_b64_tr_b16 v[82:83],v12 offset:832
ds_read_b64_tr_b16 v[84:85],v12 offset:12352
ds_read_b64_tr_b16 v[86:87],v12 offset:13120
s_branch ld_42
lw_46:
ds_read_b64_tr_b16 a[224:225],v12 offset:0
ds_read_b64_tr_b16 a[226:227],v12 offset:768
ds_read_b64_tr_b16 a[228:229],v12 offset:12288
ds_read_b64_tr_b16 a[230:231],v12 offset:13056
ds_read_b64_tr_b16 a[232:233],v12 offset:32
ds_read_b64_tr_b16 a[234:235],v12 offset:800
ds_read_b64_tr_b16 a[236:237],v12 offset:12320
ds_read_b64_tr_b16 a[238:239],v12 offset:13088
ds_read_b64_tr_b16 v[64:65],v12 offset:64
ds_read_b64_tr_b16 v[66:67],v12 offset:832
ds_read_b64_tr_b16 v[68:69],v12 offset:12352
ds_read_b64_tr_b16 v[70:71],v12 offset:13120
ld_42:
s_waitcnt lgkmcnt(0)
s_waitcnt vmcnt(24)
s_barrier
s_add_u32 s60,s75,s74
s_add_u32 m0,s77,24576
s_add_u32 s61,s60,4718592
buffer_load_dwordx4 v104,s[52:55],s61 offen lds
s_add_u32 m0,s77,25600
s_add_u32 s61,s60,4718592
buffer_load_dwordx4 v105,s[52:55],s61 offen lds
s_add_u32 m0,s77,26624
s_add_u32 s61,s60,4718592
buffer_load_dwordx4 v106,s[52:55],s61 offen lds
s_add_u32 m0,s77,27648
s_add_u32 s61,s60,4816896
buffer_load_dwordx4 v104,s[52:55],s61 offen lds
s_add_u32 m0,s77,28672
s_add_u32 s61,s60,4816896
buffer_load_dwordx4 v105,s[52:55],s61 offen lds
s_add_u32 m0,s77,29696
s_add_u32 s61,s60,4816896
buffer_load_dwordx4 v106,s[52:55],s61 offen lds
v_add_u32 v12,49152,v107
s_cmp_eq_u32 s46,1
s_cbranch_scc1 lw_49
s_cmp_eq_u32 s46,2
s_cbranch_scc1 lw_50
s_cmp_eq_u32 s46,3
s_cbranch_scc1 lw_51
lw_48:
ds_read_b64_tr_b16 a[160:161],v12 offset:0
ds_read_b64_tr_b16 a[162:163],v12 offset:768
ds_read_b64_tr_b16 a[164:165],v12 offset:12288
ds_read_b64_tr_b16 a[166:167],v12 offset:13056
ds_read_b64_tr_b16 a[168:169],v12 offset:32
ds_read_b64_tr_b16 a[170:171],v12 offset:800
ds_read_b64_tr_b16 a[172:173],v12 offset:12320
ds_read_b64_tr_b16 a[174:175],v12 offset:13088
ds_read_b64_tr_b16 a[176:177],v12 offset:64
ds_read_b64_tr_b16 a[178:179],v12 offset:832
ds_read_b64_tr_b16 a[180:181],v12 offset:12352
ds_read_b64_tr_b16 a[182:183],v12 offset:13120
s_branch ld_47
lw_49:
ds_read_b64_tr_b16 a[80:81],v12 offset:0
ds_read_b64_tr_b16 a[82:83],v12 offset:768
ds_read_b64_tr_b16 a[84:85],v12 offset:12288
ds_read_b64_tr_b16 a[86:87],v12 offset:13056
ds_read_b64_tr_b16 a[88:89],v12 offset:32
ds_read_b64_tr_b16 a[90:91],v12 offset:800
ds_read_b64_tr_b16 a[92:93],v12 offset:12320
ds_read_b64_tr_b16 a[94:95],v12 offset:13088
ds_read_b64_tr_b16 a[96:97],v12 offset:64
ds_read_b64_tr_b16 a[98:99],v12 offset:832
ds_read_b64_tr_b16 a[100:101],v12 offset:12352
ds_read_b64_tr_b16 a[102:103],v12 offset:13120
s_branch ld_47
lw_50:
ds_read_b64_tr_b16 a[0:1],v12 offset:0
ds_read_b64_tr_b16 a[2:3],v12 offset:768
ds_read_b64_tr_b16 a[4:5],v12 offset:12288
ds_read_b64_tr_b16 a[6:7],v12 offset:13056
ds_read_b64_tr_b16 a[8:9],v12 offset:32
ds_read_b64_tr_b16 a[10:11],v12 offset:800
ds_read_b64_tr_b16 a[12:13],v12 offset:12320
ds_read_b64_tr_b16 a[14:15],v12 offset:13088
ds_read_b64_tr_b16 a[16:17],v12 offset:64
ds_read_b64_tr_b16 a[18:19],v12 offset:832
ds_read_b64_tr_b16 a[20:21],v12 offset:12352
ds_read_b64_tr_b16 a[22:23],v12 offset:13120
s_branch ld_47
lw_51:
ds_read_b64_tr_b16 a[240:241],v12 offset:0
ds_read_b64_tr_b16 a[242:243],v12 offset:768
ds_read_b64_tr_b16 a[244:245],v12 offset:12288
ds_read_b64_tr_b16 a[246:247],v12 offset:13056
ds_read_b64_tr_b16 a[248:249],v12 offset:32
ds_read_b64_tr_b16 a[250:251],v12 offset:800
ds_read_b64_tr_b16 a[252:253],v12 offset:12320
ds_read_b64_tr_b16 a[254:255],v12 offset:13088
ds_read_b64_tr_b16 v[112:113],v12 offset:64
ds_read_b64_tr_b16 v[114:115],v12 offset:832
ds_read_b64_tr_b16 v[116:117],v12 offset:12352
ds_read_b64_tr_b16 v[118:119],v12 offset:13120
ld_47:
s_waitcnt lgkmcnt(0)
s_waitcnt vmcnt(24)
s_barrier
s_add_u32 s60,s75,s73
s_add_u32 m0,s77,49152
s_add_u32 s61,s60,5505024
buffer_load_dwordx4 v104,s[4:7],s61 offen lds
s_add_u32 m0,s77,50176
s_add_u32 s61,s60,5505024
buffer_load_dwordx4 v105,s[4:7],s61 offen lds
s_add_u32 m0,s77,51200
s_add_u32 s61,s60,5505024
buffer_load_dwordx4 v106,s[4:7],s61 offen lds
s_add_u32 m0,s77,52224
s_add_u32 s61,s60,5603328
buffer_load_dwordx4 v104,s[4:7],s61 offen lds
s_add_u32 m0,s77,53248
s_add_u32 s61,s60,5603328
buffer_load_dwordx4 v105,s[4:7],s61 offen lds
s_add_u32 m0,s77,54272
s_add_u32 s61,s60,5603328
buffer_load_dwordx4 v106,s[4:7],s61 offen lds
v_add_u32 v12,73728,v107
s_cmp_eq_u32 s46,1
s_cbranch_scc1 lw_54
s_cmp_eq_u32 s46,2
s_cbranch_scc1 lw_55
s_cmp_eq_u32 s46,3
s_cbranch_scc1 lw_56
lw_53:
ds_read_b64_tr_b16 a[184:185],v12 offset:0
ds_read_b64_tr_b16 a[186:187],v12 offset:768
ds_read_b64_tr_b16 a[188:189],v12 offset:12288
ds_read_b64_tr_b16 a[190:191],v12 offset:13056
ds_read_b64_tr_b16 a[192:193],v12 offset:32
ds_read_b64_tr_b16 a[194:195],v12 offset:800
ds_read_b64_tr_b16 a[196:197],v12 offset:12320
ds_read_b64_tr_b16 a[198:199],v12 offset:13088
ds_read_b64_tr_b16 v[56:57],v12 offset:64
ds_read_b64_tr_b16 v[58:59],v12 offset:832
ds_read_b64_tr_b16 v[60:61],v12 offset:12352
ds_read_b64_tr_b16 v[62:63],v12 offset:13120
s_branch ld_52
lw_54:
ds_read_b64_tr_b16 a[104:105],v12 offset:0
ds_read_b64_tr_b16 a[106:107],v12 offset:768
ds_read_b64_tr_b16 a[108:109],v12 offset:12288
ds_read_b64_tr_b16 a[110:111],v12 offset:13056
ds_read_b64_tr_b16 a[112:113],v12 offset:32
ds_read_b64_tr_b16 a[114:115],v12 offset:800
ds_read_b64_tr_b16 a[116:117],v12 offset:12320
ds_read_b64_tr_b16 a[118:119],v12 offset:13088
ds_read_b64_tr_b16 v[40:41],v12 offset:64
ds_read_b64_tr_b16 v[42:43],v12 offset:832
ds_read_b64_tr_b16 v[44:45],v12 offset:12352
ds_read_b64_tr_b16 v[46:47],v12 offset:13120
s_branch ld_52
lw_55:
ds_read_b64_tr_b16 a[24:25],v12 offset:0
ds_read_b64_tr_b16 a[26:27],v12 offset:768
ds_read_b64_tr_b16 a[28:29],v12 offset:12288
ds_read_b64_tr_b16 a[30:31],v12 offset:13056
ds_read_b64_tr_b16 a[32:33],v12 offset:32
ds_read_b64_tr_b16 a[34:35],v12 offset:800
ds_read_b64_tr_b16 a[36:37],v12 offset:12320
ds_read_b64_tr_b16 a[38:39],v12 offset:13088
ds_read_b64_tr_b16 v[24:25],v12 offset:64
ds_read_b64_tr_b16 v[26:27],v12 offset:832
ds_read_b64_tr_b16 v[28:29],v12 offset:12352
ds_read_b64_tr_b16 v[30:31],v12 offset:13120
s_branch ld_52
lw_56:
ds_read_b64_tr_b16 v[120:121],v12 offset:0
ds_read_b64_tr_b16 v[122:123],v12 offset:768
ds_read_b64_tr_b16 v[124:125],v12 offset:12288
ds_read_b64_tr_b16 v[126:127],v12 offset:13056
ds_read_b64_tr_b16 v[128:129],v12 offset:32
ds_read_b64_tr_b16 v[130:131],v12 offset:800
ds_read_b64_tr_b16 v[132:133],v12 offset:12320
ds_read_b64_tr_b16 v[134:135],v12 offset:13088
ds_read_b64_tr_b16 v[72:73],v12 offset:64
ds_read_b64_tr_b16 v[74:75],v12 offset:832
ds_read_b64_tr_b16 v[76:77],v12 offset:12352
ds_read_b64_tr_b16 v[78:79],v12 offset:13120
ld_52:
s_waitcnt lgkmcnt(0)
s_waitcnt vmcnt(24)
s_barrier
s_add_u32 s60,s75,s74
s_add_u32 m0,s77,73728
s_add_u32 s61,s60,5505024
buffer_load_dwordx4 v104,s[52:55],s61 offen lds
s_add_u32 m0,s77,74752
s_add_u32 s61,s60,5505024
buffer_load_dwordx4 v105,s[52:55],s61 offen lds
s_add_u32 m0,s77,75776
s_add_u32 s61,s60,5505024
buffer_load_dwordx4 v106,s[52:55],s61 offen lds
s_add_u32 m0,s77,76800
s_add_u32 s61,s60,5603328
buffer_load_dwordx4 v104,s[52:55],s61 offen lds
s_add_u32 m0,s77,77824
s_add_u32 s61,s60,5603328
buffer_load_dwordx4 v105,s[52:55],s61 offen lds
s_add_u32 m0,s77,78848
s_add_u32 s61,s60,5603328
buffer_load_dwordx4 v106,s[52:55],s61 offen lds
v_add_u32 v12,98304,v107
s_cmp_eq_u32 s46,1
s_cbranch_scc1 lw_59
s_cmp_eq_u32 s46,2
s_cbranch_scc1 lw_60
s_cmp_eq_u32 s46,3
s_cbranch_scc1 lw_61
lw_58:
ds_read_b64_tr_b16 a[200:201],v12 offset:0
ds_read_b64_tr_b16 a[202:203],v12 offset:768
ds_read_b64_tr_b16 a[204:205],v12 offset:12288
ds_read_b64_tr_b16 a[206:207],v12 offset:13056
ds_read_b64_tr_b16 a[208:209],v12 offset:32
ds_read_b64_tr_b16 a[210:211],v12 offset:800
ds_read_b64_tr_b16 a[212:213],v12 offset:12320
ds_read_b64_tr_b16 a[214:215],v12 offset:13088
ds_read_b64_tr_b16 a[216:217],v12 offset:64
ds_read_b64_tr_b16 a[218:219],v12 offset:832
ds_read_b64_tr_b16 a[220:221],v12 offset:12352
ds_read_b64_tr_b16 a[222:223],v12 offset:13120
s_branch ld_57
lw_59:
ds_read_b64_tr_b16 a[120:121],v12 offset:0
ds_read_b64_tr_b16 a[122:123],v12 offset:768
ds_read_b64_tr_b16 a[124:125],v12 offset:12288
ds_read_b64_tr_b16 a[126:127],v12 offset:13056
ds_read_b64_tr_b16 a[128:129],v12 offset:32
ds_read_b64_tr_b16 a[130:131],v12 offset:800
ds_read_b64_tr_b16 a[132:133],v12 offset:12320
ds_read_b64_tr_b16 a[134:135],v12 offset:13088
ds_read_b64_tr_b16 a[136:137],v12 offset:64
ds_read_b64_tr_b16 a[138:139],v12 offset:832
ds_read_b64_tr_b16 a[140:141],v12 offset:12352
ds_read_b64_tr_b16 a[142:143],v12 offset:13120
s_branch ld_57
lw_60:
ds_read_b64_tr_b16 a[40:41],v12 offset:0
ds_read_b64_tr_b16 a[42:43],v12 offset:768
ds_read_b64_tr_b16 a[44:45],v12 offset:12288
ds_read_b64_tr_b16 a[46:47],v12 offset:13056
ds_read_b64_tr_b16 a[48:49],v12 offset:32
ds_read_b64_tr_b16 a[50:51],v12 offset:800
ds_read_b64_tr_b16 a[52:53],v12 offset:12320
ds_read_b64_tr_b16 a[54:55],v12 offset:13088
ds_read_b64_tr_b16 a[56:57],v12 offset:64
ds_read_b64_tr_b16 a[58:59],v12 offset:832
ds_read_b64_tr_b16 a[60:61],v12 offset:12352
ds_read_b64_tr_b16 a[62:63],v12 offset:13120
s_branch ld_57
lw_61:
ds_read_b64_tr_b16 v[136:137],v12 offset:0
ds_read_b64_tr_b16 v[138:139],v12 offset:768
ds_read_b64_tr_b16 v[140:141],v12 offset:12288
ds_read_b64_tr_b16 v[142:143],v12 offset:13056
ds_read_b64_tr_b16 v[144:145],v12 offset:32
ds_read_b64_tr_b16 v[146:147],v12 offset:800
ds_read_b64_tr_b16 v[148:149],v12 offset:12320
ds_read_b64_tr_b16 v[150:151],v12 offset:13088
ds_read_b64_tr_b16 v[152:153],v12 offset:64
ds_read_b64_tr_b16 v[154:155],v12 offset:832
ds_read_b64_tr_b16 v[156:157],v12 offset:12352
ds_read_b64_tr_b16 v[158:159],v12 offset:13120
ld_57:
s_waitcnt lgkmcnt(0)
s_waitcnt vmcnt(24)
s_barrier
s_add_u32 s60,s76,s73
s_add_u32 m0,s77,98304
s_add_u32 s61,s60,6291456
buffer_load_dwordx4 v104,s[4:7],s61 offen lds
s_add_u32 m0,s77,99328
s_add_u32 s61,s60,6291456
buffer_load_dwordx4 v105,s[4:7],s61 offen lds
s_add_u32 m0,s77,100352
s_add_u32 s61,s60,6291456
buffer_load_dwordx4 v106,s[4:7],s61 offen lds
s_add_u32 m0,s77,101376
s_add_u32 s61,s60,6389760
buffer_load_dwordx4 v104,s[4:7],s61 offen lds
s_add_u32 m0,s77,102400
s_add_u32 s61,s60,6389760
buffer_load_dwordx4 v105,s[4:7],s61 offen lds
s_add_u32 m0,s77,103424
s_add_u32 s61,s60,6389760
buffer_load_dwordx4 v106,s[4:7],s61 offen lds
v_add_u32 v12,122880,v107
s_cmp_eq_u32 s46,1
s_cbranch_scc1 lw_64
s_cmp_eq_u32 s46,2
s_cbranch_scc1 lw_65
s_cmp_eq_u32 s46,3
s_cbranch_scc1 lw_66
lw_63:
ds_read_b64_tr_b16 a[224:225],v12 offset:0
ds_read_b64_tr_b16 a[226:227],v12 offset:768
ds_read_b64_tr_b16 a[228:229],v12 offset:12288
ds_read_b64_tr_b16 a[230:231],v12 offset:13056
ds_read_b64_tr_b16 a[232:233],v12 offset:32
ds_read_b64_tr_b16 a[234:235],v12 offset:800
ds_read_b64_tr_b16 a[236:237],v12 offset:12320
ds_read_b64_tr_b16 a[238:239],v12 offset:13088
ds_read_b64_tr_b16 v[64:65],v12 offset:64
ds_read_b64_tr_b16 v[66:67],v12 offset:832
ds_read_b64_tr_b16 v[68:69],v12 offset:12352
ds_read_b64_tr_b16 v[70:71],v12 offset:13120
s_branch ld_62
lw_64:
ds_read_b64_tr_b16 a[144:145],v12 offset:0
ds_read_b64_tr_b16 a[146:147],v12 offset:768
ds_read_b64_tr_b16 a[148:149],v12 offset:12288
ds_read_b64_tr_b16 a[150:151],v12 offset:13056
ds_read_b64_tr_b16 a[152:153],v12 offset:32
ds_read_b64_tr_b16 a[154:155],v12 offset:800
ds_read_b64_tr_b16 a[156:157],v12 offset:12320
ds_read_b64_tr_b16 a[158:159],v12 offset:13088
ds_read_b64_tr_b16 v[48:49],v12 offset:64
ds_read_b64_tr_b16 v[50:51],v12 offset:832
ds_read_b64_tr_b16 v[52:53],v12 offset:12352
ds_read_b64_tr_b16 v[54:55],v12 offset:13120
s_branch ld_62
lw_65:
ds_read_b64_tr_b16 a[64:65],v12 offset:0
ds_read_b64_tr_b16 a[66:67],v12 offset:768
ds_read_b64_tr_b16 a[68:69],v12 offset:12288
ds_read_b64_tr_b16 a[70:71],v12 offset:13056
ds_read_b64_tr_b16 a[72:73],v12 offset:32
ds_read_b64_tr_b16 a[74:75],v12 offset:800
ds_read_b64_tr_b16 a[76:77],v12 offset:12320
ds_read_b64_tr_b16 a[78:79],v12 offset:13088
ds_read_b64_tr_b16 v[32:33],v12 offset:64
ds_read_b64_tr_b16 v[34:35],v12 offset:832
ds_read_b64_tr_b16 v[36:37],v12 offset:12352
ds_read_b64_tr_b16 v[38:39],v12 offset:13120
s_branch ld_62
lw_66:
ds_read_b64_tr_b16 v[160:161],v12 offset:0
ds_read_b64_tr_b16 v[162:163],v12 offset:768
ds_read_b64_tr_b16 v[164:165],v12 offset:12288
ds_read_b64_tr_b16 v[166:167],v12 offset:13056
ds_read_b64_tr_b16 v[168:169],v12 offset:32
ds_read_b64_tr_b16 v[170:171],v12 offset:800
ds_read_b64_tr_b16 v[172:173],v12 offset:12320
ds_read_b64_tr_b16 v[174:175],v12 offset:13088
ds_read_b64_tr_b16 v[80:81],v12 offset:64
ds_read_b64_tr_b16 v[82:83],v12 offset:832
ds_read_b64_tr_b16 v[84:85],v12 offset:12352
ds_read_b64_tr_b16 v[86:87],v12 offset:13120
ld_62:
s_waitcnt lgkmcnt(0)
s_waitcnt vmcnt(24)
s_barrier
s_add_u32 s60,s76,s74
s_add_u32 m0,s77,122880
s_add_u32 s61,s60,6291456
buffer_load_dwordx4 v104,s[52:55],s61 offen lds
s_add_u32 m0,s77,123904
s_add_u32 s61,s60,6291456
buffer_load_dwordx4 v105,s[52:55],s61 offen lds
s_add_u32 m0,s77,124928
s_add_u32 s61,s60,6291456
buffer_load_dwordx4 v106,s[52:55],s61 offen lds
s_add_u32 m0,s77,125952
s_add_u32 s61,s60,6389760
buffer_load_dwordx4 v104,s[52:55],s61 offen lds
s_add_u32 m0,s77,126976
s_add_u32 s61,s60,6389760
buffer_load_dwordx4 v105,s[52:55],s61 offen lds
s_add_u32 m0,s77,128000
s_add_u32 s61,s60,6389760
buffer_load_dwordx4 v106,s[52:55],s61 offen lds
v_add_u32 v12,0,v107
s_cmp_eq_u32 s46,1
s_cbranch_scc1 lw_69
s_cmp_eq_u32 s46,2
s_cbranch_scc1 lw_70
s_cmp_eq_u32 s46,3
s_cbranch_scc1 lw_71
lw_68:
ds_read_b64_tr_b16 a[240:241],v12 offset:0
ds_read_b64_tr_b16 a[242:243],v12 offset:768
ds_read_b64_tr_b16 a[244:245],v12 offset:12288
ds_read_b64_tr_b16 a[246:247],v12 offset:13056
ds_read_b64_tr_b16 a[248:249],v12 offset:32
ds_read_b64_tr_b16 a[250:251],v12 offset:800
ds_read_b64_tr_b16 a[252:253],v12 offset:12320
ds_read_b64_tr_b16 a[254:255],v12 offset:13088
ds_read_b64_tr_b16 v[112:113],v12 offset:64
ds_read_b64_tr_b16 v[114:115],v12 offset:832
ds_read_b64_tr_b16 v[116:117],v12 offset:12352
ds_read_b64_tr_b16 v[118:119],v12 offset:13120
s_branch ld_67
lw_69:
ds_read_b64_tr_b16 a[160:161],v12 offset:0
ds_read_b64_tr_b16 a[162:163],v12 offset:768
ds_read_b64_tr_b16 a[164:165],v12 offset:12288
ds_read_b64_tr_b16 a[166:167],v12 offset:13056
ds_read_b64_tr_b16 a[168:169],v12 offset:32
ds_read_b64_tr_b16 a[170:171],v12 offset:800
ds_read_b64_tr_b16 a[172:173],v12 offset:12320
ds_read_b64_tr_b16 a[174:175],v12 offset:13088
ds_read_b64_tr_b16 a[176:177],v12 offset:64
ds_read_b64_tr_b16 a[178:179],v12 offset:832
ds_read_b64_tr_b16 a[180:181],v12 offset:12352
ds_read_b64_tr_b16 a[182:183],v12 offset:13120
s_branch ld_67
lw_70:
ds_read_b64_tr_b16 a[80:81],v12 offset:0
ds_read_b64_tr_b16 a[82:83],v12 offset:768
ds_read_b64_tr_b16 a[84:85],v12 offset:12288
ds_read_b64_tr_b16 a[86:87],v12 offset:13056
ds_read_b64_tr_b16 a[88:89],v12 offset:32
ds_read_b64_tr_b16 a[90:91],v12 offset:800
ds_read_b64_tr_b16 a[92:93],v12 offset:12320
ds_read_b64_tr_b16 a[94:95],v12 offset:13088
ds_read_b64_tr_b16 a[96:97],v12 offset:64
ds_read_b64_tr_b16 a[98:99],v12 offset:832
ds_read_b64_tr_b16 a[100:101],v12 offset:12352
ds_read_b64_tr_b16 a[102:103],v12 offset:13120
s_branch ld_67
lw_71:
ds_read_b64_tr_b16 a[0:1],v12 offset:0
ds_read_b64_tr_b16 a[2:3],v12 offset:768
ds_read_b64_tr_b16 a[4:5],v12 offset:12288
ds_read_b64_tr_b16 a[6:7],v12 offset:13056
ds_read_b64_tr_b16 a[8:9],v12 offset:32
ds_read_b64_tr_b16 a[10:11],v12 offset:800
ds_read_b64_tr_b16 a[12:13],v12 offset:12320
ds_read_b64_tr_b16 a[14:15],v12 offset:13088
ds_read_b64_tr_b16 a[16:17],v12 offset:64
ds_read_b64_tr_b16 a[18:19],v12 offset:832
ds_read_b64_tr_b16 a[20:21],v12 offset:12352
ds_read_b64_tr_b16 a[22:23],v12 offset:13120
ld_67:
s_waitcnt lgkmcnt(0)
s_waitcnt vmcnt(24)
s_barrier
s_add_u32 s60,s76,s73
s_add_u32 m0,s77,0
s_add_u32 s61,s60,7077888
buffer_load_dwordx4 v104,s[4:7],s61 offen lds
s_add_u32 m0,s77,1024
s_add_u32 s61,s60,7077888
buffer_load_dwordx4 v105,s[4:7],s61 offen lds
s_add_u32 m0,s77,2048
s_add_u32 s61,s60,7077888
buffer_load_dwordx4 v106,s[4:7],s61 offen lds
s_add_u32 m0,s77,3072
s_add_u32 s61,s60,7176192
buffer_load_dwordx4 v104,s[4:7],s61 offen lds
s_add_u32 m0,s77,4096
s_add_u32 s61,s60,7176192
buffer_load_dwordx4 v105,s[4:7],s61 offen lds
s_add_u32 m0,s77,5120
s_add_u32 s61,s60,7176192
buffer_load_dwordx4 v106,s[4:7],s61 offen lds
v_add_u32 v12,24576,v107
s_cmp_eq_u32 s46,1
s_cbranch_scc1 lw_74
s_cmp_eq_u32 s46,2
s_cbranch_scc1 lw_75
s_cmp_eq_u32 s46,3
s_cbranch_scc1 lw_76
lw_73:
ds_read_b64_tr_b16 v[120:121],v12 offset:0
ds_read_b64_tr_b16 v[122:123],v12 offset:768
ds_read_b64_tr_b16 v[124:125],v12 offset:12288
ds_read_b64_tr_b16 v[126:127],v12 offset:13056
ds_read_b64_tr_b16 v[128:129],v12 offset:32
ds_read_b64_tr_b16 v[130:131],v12 offset:800
ds_read_b64_tr_b16 v[132:133],v12 offset:12320
ds_read_b64_tr_b16 v[134:135],v12 offset:13088
ds_read_b64_tr_b16 v[72:73],v12 offset:64
ds_read_b64_tr_b16 v[74:75],v12 offset:832
ds_read_b64_tr_b16 v[76:77],v12 offset:12352
ds_read_b64_tr_b16 v[78:79],v12 offset:13120
s_branch ld_72
lw_74:
ds_read_b64_tr_b16 a[184:185],v12 offset:0
ds_read_b64_tr_b16 a[186:187],v12 offset:768
ds_read_b64_tr_b16 a[188:189],v12 offset:12288
ds_read_b64_tr_b16 a[190:191],v12 offset:13056
ds_read_b64_tr_b16 a[192:193],v12 offset:32
ds_read_b64_tr_b16 a[194:195],v12 offset:800
ds_read_b64_tr_b16 a[196:197],v12 offset:12320
ds_read_b64_tr_b16 a[198:199],v12 offset:13088
ds_read_b64_tr_b16 v[56:57],v12 offset:64
ds_read_b64_tr_b16 v[58:59],v12 offset:832
ds_read_b64_tr_b16 v[60:61],v12 offset:12352
ds_read_b64_tr_b16 v[62:63],v12 offset:13120
s_branch ld_72
lw_75:
ds_read_b64_tr_b16 a[104:105],v12 offset:0
ds_read_b64_tr_b16 a[106:107],v12 offset:768
ds_read_b64_tr_b16 a[108:109],v12 offset:12288
ds_read_b64_tr_b16 a[110:111],v12 offset:13056
ds_read_b64_tr_b16 a[112:113],v12 offset:32
ds_read_b64_tr_b16 a[114:115],v12 offset:800
ds_read_b64_tr_b16 a[116:117],v12 offset:12320
ds_read_b64_tr_b16 a[118:119],v12 offset:13088
ds_read_b64_tr_b16 v[40:41],v12 offset:64
ds_read_b64_tr_b16 v[42:43],v12 offset:832
ds_read_b64_tr_b16 v[44:45],v12 offset:12352
ds_read_b64_tr_b16 v[46:47],v12 offset:13120
s_branch ld_72
lw_76:
ds_read_b64_tr_b16 a[24:25],v12 offset:0
ds_read_b64_tr_b16 a[26:27],v12 offset:768
ds_read_b64_tr_b16 a[28:29],v12 offset:12288
ds_read_b64_tr_b16 a[30:31],v12 offset:13056
ds_read_b64_tr_b16 a[32:33],v12 offset:32
ds_read_b64_tr_b16 a[34:35],v12 offset:800
ds_read_b64_tr_b16 a[36:37],v12 offset:12320
ds_read_b64_tr_b16 a[38:39],v12 offset:13088
ds_read_b64_tr_b16 v[24:25],v12 offset:64
ds_read_b64_tr_b16 v[26:27],v12 offset:832
ds_read_b64_tr_b16 v[28:29],v12 offset:12352
ds_read_b64_tr_b16 v[30:31],v12 offset:13120
ld_72:
s_waitcnt lgkmcnt(0)
s_waitcnt vmcnt(24)
s_barrier
s_add_u32 s60,s76,s74
s_add_u32 m0,s77,24576
s_add_u32 s61,s60,7077888
buffer_load_dwordx4 v104,s[52:55],s61 offen lds
s_add_u32 m0,s77,25600
s_add_u32 s61,s60,7077888
buffer_load_dwordx4 v105,s[52:55],s61 offen lds
s_add_u32 m0,s77,26624
s_add_u32 s61,s60,7077888
buffer_load_dwordx4 v106,s[52:55],s61 offen lds
s_add_u32 m0,s77,27648
s_add_u32 s61,s60,7176192
buffer_load_dwordx4 v104,s[52:55],s61 offen lds
s_add_u32 m0,s77,28672
s_add_u32 s61,s60,7176192
buffer_load_dwordx4 v105,s[52:55],s61 offen lds
s_add_u32 m0,s77,29696
s_add_u32 s61,s60,7176192
buffer_load_dwordx4 v106,s[52:55],s61 offen lds
v_add_u32 v12,49152,v107
s_cmp_eq_u32 s46,1
s_cbranch_scc1 lw_79
s_cmp_eq_u32 s46,2
s_cbranch_scc1 lw_80
s_cmp_eq_u32 s46,3
s_cbranch_scc1 lw_81
lw_78:
ds_read_b64_tr_b16 v[136:137],v12 offset:0
ds_read_b64_tr_b16 v[138:139],v12 offset:768
ds_read_b64_tr_b16 v[140:141],v12 offset:12288
ds_read_b64_tr_b16 v[142:143],v12 offset:13056
ds_read_b64_tr_b16 v[144:145],v12 offset:32
ds_read_b64_tr_b16 v[146:147],v12 offset:800
ds_read_b64_tr_b16 v[148:149],v12 offset:12320
ds_read_b64_tr_b16 v[150:151],v12 offset:13088
ds_read_b64_tr_b16 v[152:153],v12 offset:64
ds_read_b64_tr_b16 v[154:155],v12 offset:832
ds_read_b64_tr_b16 v[156:157],v12 offset:12352
ds_read_b64_tr_b16 v[158:159],v12 offset:13120
s_branch ld_77
lw_79:
ds_read_b64_tr_b16 a[200:201],v12 offset:0
ds_read_b64_tr_b16 a[202:203],v12 offset:768
ds_read_b64_tr_b16 a[204:205],v12 offset:12288
ds_read_b64_tr_b16 a[206:207],v12 offset:13056
ds_read_b64_tr_b16 a[208:209],v12 offset:32
ds_read_b64_tr_b16 a[210:211],v12 offset:800
ds_read_b64_tr_b16 a[212:213],v12 offset:12320
ds_read_b64_tr_b16 a[214:215],v12 offset:13088
ds_read_b64_tr_b16 a[216:217],v12 offset:64
ds_read_b64_tr_b16 a[218:219],v12 offset:832
ds_read_b64_tr_b16 a[220:221],v12 offset:12352
ds_read_b64_tr_b16 a[222:223],v12 offset:13120
s_branch ld_77
lw_80:
ds_read_b64_tr_b16 a[120:121],v12 offset:0
ds_read_b64_tr_b16 a[122:123],v12 offset:768
ds_read_b64_tr_b16 a[124:125],v12 offset:12288
ds_read_b64_tr_b16 a[126:127],v12 offset:13056
ds_read_b64_tr_b16 a[128:129],v12 offset:32
ds_read_b64_tr_b16 a[130:131],v12 offset:800
ds_read_b64_tr_b16 a[132:133],v12 offset:12320
ds_read_b64_tr_b16 a[134:135],v12 offset:13088
ds_read_b64_tr_b16 a[136:137],v12 offset:64
ds_read_b64_tr_b16 a[138:139],v12 offset:832
ds_read_b64_tr_b16 a[140:141],v12 offset:12352
ds_read_b64_tr_b16 a[142:143],v12 offset:13120
s_branch ld_77
lw_81:
ds_read_b64_tr_b16 a[40:41],v12 offset:0
ds_read_b64_tr_b16 a[42:43],v12 offset:768
ds_read_b64_tr_b16 a[44:45],v12 offset:12288
ds_read_b64_tr_b16 a[46:47],v12 offset:13056
ds_read_b64_tr_b16 a[48:49],v12 offset:32
ds_read_b64_tr_b16 a[50:51],v12 offset:800
ds_read_b64_tr_b16 a[52:53],v12 offset:12320
ds_read_b64_tr_b16 a[54:55],v12 offset:13088
ds_read_b64_tr_b16 a[56:57],v12 offset:64
ds_read_b64_tr_b16 a[58:59],v12 offset:832
ds_read_b64_tr_b16 a[60:61],v12 offset:12352
ds_read_b64_tr_b16 a[62:63],v12 offset:13120
ld_77:
s_waitcnt lgkmcnt(0)
s_waitcnt vmcnt(24)
s_barrier
v_add_u32 v12,73728,v107
s_cmp_eq_u32 s46,1
s_cbranch_scc1 lw_84
s_cmp_eq_u32 s46,2
s_cbranch_scc1 lw_85
s_cmp_eq_u32 s46,3
s_cbranch_scc1 lw_86
lw_83:
ds_read_b64_tr_b16 v[160:161],v12 offset:0
ds_read_b64_tr_b16 v[162:163],v12 offset:768
ds_read_b64_tr_b16 v[164:165],v12 offset:12288
ds_read_b64_tr_b16 v[166:167],v12 offset:13056
ds_read_b64_tr_b16 v[168:169],v12 offset:32
ds_read_b64_tr_b16 v[170:171],v12 offset:800
ds_read_b64_tr_b16 v[172:173],v12 offset:12320
ds_read_b64_tr_b16 v[174:175],v12 offset:13088
ds_read_b64_tr_b16 v[80:81],v12 offset:64
ds_read_b64_tr_b16 v[82:83],v12 offset:832
ds_read_b64_tr_b16 v[84:85],v12 offset:12352
ds_read_b64_tr_b16 v[86:87],v12 offset:13120
s_branch ld_82
lw_84:
ds_read_b64_tr_b16 a[224:225],v12 offset:0
ds_read_b64_tr_b16 a[226:227],v12 offset:768
ds_read_b64_tr_b16 a[228:229],v12 offset:12288
ds_read_b64_tr_b16 a[230:231],v12 offset:13056
ds_read_b64_tr_b16 a[232:233],v12 offset:32
ds_read_b64_tr_b16 a[234:235],v12 offset:800
ds_read_b64_tr_b16 a[236:237],v12 offset:12320
ds_read_b64_tr_b16 a[238:239],v12 offset:13088
ds_read_b64_tr_b16 v[64:65],v12 offset:64
ds_read_b64_tr_b16 v[66:67],v12 offset:832
ds_read_b64_tr_b16 v[68:69],v12 offset:12352
ds_read_b64_tr_b16 v[70:71],v12 offset:13120
s_branch ld_82
lw_85:
ds_read_b64_tr_b16 a[144:145],v12 offset:0
ds_read_b64_tr_b16 a[146:147],v12 offset:768
ds_read_b64_tr_b16 a[148:149],v12 offset:12288
ds_read_b64_tr_b16 a[150:151],v12 offset:13056
ds_read_b64_tr_b16 a[152:153],v12 offset:32
ds_read_b64_tr_b16 a[154:155],v12 offset:800
ds_read_b64_tr_b16 a[156:157],v12 offset:12320
ds_read_b64_tr_b16 a[158:159],v12 offset:13088
ds_read_b64_tr_b16 v[48:49],v12 offset:64
ds_read_b64_tr_b16 v[50:51],v12 offset:832
ds_read_b64_tr_b16 v[52:53],v12 offset:12352
ds_read_b64_tr_b16 v[54:55],v12 offset:13120
s_branch ld_82
lw_86:
ds_read_b64_tr_b16 a[64:65],v12 offset:0
ds_read_b64_tr_b16 a[66:67],v12 offset:768
ds_read_b64_tr_b16 a[68:69],v12 offset:12288
ds_read_b64_tr_b16 a[70:71],v12 offset:13056
ds_read_b64_tr_b16 a[72:73],v12 offset:32
ds_read_b64_tr_b16 a[74:75],v12 offset:800
ds_read_b64_tr_b16 a[76:77],v12 offset:12320
ds_read_b64_tr_b16 a[78:79],v12 offset:13088
ds_read_b64_tr_b16 v[32:33],v12 offset:64
ds_read_b64_tr_b16 v[34:35],v12 offset:832
ds_read_b64_tr_b16 v[36:37],v12 offset:12352
ds_read_b64_tr_b16 v[38:39],v12 offset:13120
ld_82:
s_waitcnt lgkmcnt(0)
s_waitcnt vmcnt(18)
s_barrier
v_add_u32 v12,98304,v107
ds_read_b64_tr_b16 v[176:177],v12 offset:0
ds_read_b64_tr_b16 v[178:179],v12 offset:768
ds_read_b64_tr_b16 v[180:181],v12 offset:12288
ds_read_b64_tr_b16 v[182:183],v12 offset:13056
ds_read_b64_tr_b16 v[184:185],v12 offset:32
ds_read_b64_tr_b16 v[186:187],v12 offset:800
ds_read_b64_tr_b16 v[188:189],v12 offset:12320
ds_read_b64_tr_b16 v[190:191],v12 offset:13088
ds_read_b64_tr_b16 v[192:193],v12 offset:64
ds_read_b64_tr_b16 v[194:195],v12 offset:832
ds_read_b64_tr_b16 v[196:197],v12 offset:12352
ds_read_b64_tr_b16 v[198:199],v12 offset:13120
s_waitcnt lgkmcnt(0)
s_waitcnt vmcnt(12)
s_barrier
v_add_u32 v12,122880,v107
ds_read_b64_tr_b16 v[200:201],v12 offset:0
ds_read_b64_tr_b16 v[202:203],v12 offset:768
ds_read_b64_tr_b16 v[204:205],v12 offset:12288
ds_read_b64_tr_b16 v[206:207],v12 offset:13056
ds_read_b64_tr_b16 v[208:209],v12 offset:32
ds_read_b64_tr_b16 v[210:211],v12 offset:800
ds_read_b64_tr_b16 v[212:213],v12 offset:12320
ds_read_b64_tr_b16 v[214:215],v12 offset:13088
ds_read_b64_tr_b16 v[88:89],v12 offset:64
ds_read_b64_tr_b16 v[90:91],v12 offset:832
ds_read_b64_tr_b16 v[92:93],v12 offset:12352
ds_read_b64_tr_b16 v[94:95],v12 offset:13120
s_waitcnt lgkmcnt(0)
s_waitcnt vmcnt(6)
s_barrier
v_add_u32 v12,0,v107
ds_read_b64_tr_b16 v[216:217],v12 offset:0
ds_read_b64_tr_b16 v[218:219],v12 offset:768
ds_read_b64_tr_b16 v[220:221],v12 offset:12288
ds_read_b64_tr_b16 v[222:223],v12 offset:13056
ds_read_b64_tr_b16 v[224:225],v12 offset:32
ds_read_b64_tr_b16 v[226:227],v12 offset:800
ds_read_b64_tr_b16 v[228:229],v12 offset:12320
ds_read_b64_tr_b16 v[230:231],v12 offset:13088
ds_read_b64_tr_b16 v[232:233],v12 offset:64
ds_read_b64_tr_b16 v[234:235],v12 offset:832
ds_read_b64_tr_b16 v[236:237],v12 offset:12352
ds_read_b64_tr_b16 v[238:239],v12 offset:13120
s_waitcnt lgkmcnt(0)
s_waitcnt vmcnt(0)
s_barrier
v_add_u32 v12,24576,v107
ds_read_b64_tr_b16 v[240:241],v12 offset:0
ds_read_b64_tr_b16 v[242:243],v12 offset:768
ds_read_b64_tr_b16 v[244:245],v12 offset:12288
ds_read_b64_tr_b16 v[246:247],v12 offset:13056
ds_read_b64_tr_b16 v[248:249],v12 offset:32
ds_read_b64_tr_b16 v[250:251],v12 offset:800
ds_read_b64_tr_b16 v[252:253],v12 offset:12320
ds_read_b64_tr_b16 v[254:255],v12 offset:13088
ds_read_b64_tr_b16 v[96:97],v12 offset:64
ds_read_b64_tr_b16 v[98:99],v12 offset:832
ds_read_b64_tr_b16 v[100:101],v12 offset:12352
ds_read_b64_tr_b16 v[102:103],v12 offset:13120
s_waitcnt lgkmcnt(0)
s_barrier
ds_write_b128 v21,v[24:27] offset:0
ds_write_b128 v21,v[28:31] offset:1024
ds_write_b128 v21,v[32:35] offset:2048
ds_write_b128 v21,v[36:39] offset:3072
ds_write_b128 v21,v[40:43] offset:4096
ds_write_b128 v21,v[44:47] offset:5120
ds_write_b128 v21,v[48:51] offset:6144
ds_write_b128 v21,v[52:55] offset:7168
ds_write_b128 v21,v[56:59] offset:8192
ds_write_b128 v21,v[60:63] offset:9216
ds_write_b128 v21,v[64:67] offset:10240
ds_write_b128 v21,v[68:71] offset:11264
ds_write_b128 v21,v[72:75] offset:12288
ds_write_b128 v21,v[76:79] offset:13312
ds_write_b128 v21,v[80:83] offset:14336
ds_write_b128 v21,v[84:87] offset:15360
ds_write_b128 v21,v[88:91] offset:16384
ds_write_b128 v21,v[92:95] offset:17408
ds_write_b128 v21,v[96:99] offset:18432
ds_write_b128 v21,v[100:103] offset:19456
s_waitcnt lgkmcnt(0)
v_add_u32 v59,139264,v1
s_barrier
s_lshl_b32 s3,s49,2
v_mov_b32 v13,s3
s_nop 1
ibw_87:
buffer_load_dword v12,v13,s[12:15],0 offen sc1
s_waitcnt vmcnt(0)
v_cmp_ne_u32 vcc,256,v12
s_nop 0
s_cbranch_vccz ok_88
s_sleep 8
s_sub_u32 s47,s47,1
s_cbranch_scc1 ABORT
s_branch ibw_87
ok_88:
s_cmp_lg_u32 s49,0
s_cbranch_scc1 ibok_89
v_and_b32 v13,7,v0
v_lshlrev_b32 v13,2,v13
buffer_load_dword v12,v13,s[12:15],0 offen offset:32 sc1
s_waitcnt vmcnt(0)
v_cmp_ne_u32 vcc,32,v12
s_nop 0
s_cbranch_vccz ibok_89
s_barrier
s_mov_b32 s49,1
s_mov_b32 s3,s2
s_load_dwordx16 s[16:31],s[0:1],0
s_load_dwordx8 s[32:39],s[0:1],64
s_waitcnt lgkmcnt(0)
s_branch DISPATCH
ibok_89:
v_mov_b32 v13,192
s_cmp_lg_u32 s49,0
s_cbranch_scc1 vx_91
vw_90:
buffer_load_dword v12,v13,s[12:15],0 offen sc1
s_waitcnt vmcnt(0)
v_and_b32 v14,0xffff,v12
v_cmp_ne_u32 vcc,64,v14
s_nop 0
s_cbranch_vccz ok_92
s_sleep 4
s_sub_u32 s47,s47,1
s_cbranch_scc1 ABORT
s_branch vw_90
ok_92:
v_readfirstlane_b32 s60,v12
s_cmp_gt_u32 s60,2162688
s_cselect_b32 s60,0x2000,0
s_add_u32 s83,s83,s60
s_nop 1
vx_91:
s_mul_i32 s6,s46,2048
v_sub_u32 v18,v23,v22
v_add_u32 v18,v18,v1
v_add_u32 v18,8192,v18
s_mov_b32 s37,0x3f80
s_mov_b32 s81,0x3f800000
s_add_u32 s6,s6,s82
s_mov_b32 s7,0
s_add_u32 s7,s7,s82
s_add_u32 s7,s7,950272
s_mov_b32 s50,0
s_mov_b32 s4,0
s_mov_b32 s5,0
s_mov_b32 s78,2147483648
s_mov_b32 s79,2147483648
s_mov_b32 s30,2147483648
s_sub_u32 s60,s4,s5
s_cmp_gt_i32 s60,13
s_cselect_b32 s51,1,0
s_cmp_eq_u32 s4,64
s_cselect_b32 s51,1,s51
s_cmp_eq_u32 s51,0
s_cselect_b32 s52,s4,s5
s_addc_u32 s4,s4,0
s_add_u32 s5,s5,s51
s_and_b32 s60,s52,1
s_lshl2_add_u32 s60,s51,s60
s_lshl_b32 s68,s60,16
s_add_u32 s68,s68,s83
s_mul_i32 s59,s60,20480
s_add_u32 s59,s59,s6
s_lshl_b32 s69,s51,9
s_add_u32 s69,s69,s7
s_bfe_u32 s57,s52,65537
s_add_u32 s58,s52,1
s_cmp_lg_u32 s36,0
s_cbranch_scc1 CV_START
s_cmp_eq_u32 s46,3
s_cbranch_scc1 CH_START
s_lshl_b32 s60,s46,2
s_add_u32 s60,s60,147456
v_mov_b32 v20,s60
v_mov_b32 v12,0
ds_write_b32 v20,v12
v_add_u32 v58,106496,v1
v_mov_b32 v9,147468
s_lshl_b32 s85,s46,12
s_add_u32 s84,s84,s85
s_add_u32 s74,s85,81920
s_add_u32 s75,s74,s74
s_add_u32 s75,s75,24576
s_mul_i32 s60,s29,3
s_add_u32 s60,s60,s46
v_lshlrev_b32 v13,7,v0
s_add_u32 s61,s60,0
s_min_u32 s61,s61,115
s_lshl_b32 s61,s61,13
s_add_u32 s61,s61,s82
buffer_load_dword v14,v13,s[8:11],s61 offen sc1
s_add_u32 s61,s60,48
s_min_u32 s61,s61,115
s_lshl_b32 s61,s61,13
s_add_u32 s61,s61,s82
buffer_load_dword v14,v13,s[8:11],s61 offen sc1
s_add_u32 s61,s60,96
s_min_u32 s61,s61,115
s_lshl_b32 s61,s61,13
s_add_u32 s61,s61,s82
buffer_load_dword v14,v13,s[8:11],s61 offen sc1
s_waitcnt vmcnt(0)
s_mov_b64 vcc,-1
s_waitcnt lgkmcnt(0)
v_mov_b32 v10,0
v_mov_b32 v11,0
v_mov_b32 v24,0
v_mov_b32 v25,0
v_mov_b32 v26,0
v_mov_b32 v27,0
v_mov_b32 v28,0
v_mov_b32 v29,0
v_mov_b32 v30,0
v_mov_b32 v31,0
v_mov_b32 v32,0
v_mov_b32 v33,0
v_mov_b32 v34,0
v_mov_b32 v35,0
v_mov_b32 v36,0
v_mov_b32 v37,0
v_mov_b32 v38,0
v_mov_b32 v39,0
v_mov_b32 v40,0
v_mov_b32 v41,0
v_mov_b32 v42,0
v_mov_b32 v43,0
v_mov_b32 v44,0
v_mov_b32 v45,0
v_mov_b32 v46,0
v_mov_b32 v47,0
s_cmp_lg_u32 s49,0
s_cbranch_scc1 CS_LOOP_S
CS_LOOP_F:
s_barrier
buffer_load_dwordx2 v[80:81],v18,s[8:11],s59 offen sc1
buffer_load_dwordx4 v[72:75],v1,s[8:11],s59 offen sc1
buffer_load_dwordx4 v[76:79],v1,s[8:11],s59 offen offset:1024 sc1
s_cbranch_vccz fj_95f
s_waitcnt vmcnt(2)
s_sleep 3
fj_95f:
buffer_load_dwordx2 v[90:91],v18,s[8:11],s68 offen sc1
buffer_load_dwordx4 v[82:85],v1,s[8:11],s68 offen sc1
buffer_load_dwordx4 v[86:89],v1,s[8:11],s68 offen offset:1024 sc1
v_mfma_f32_32x32x8_bf16 v[24:39],v[10:11],v[10:11],0
v_mfma_f32_16x16x16_bf16 v[40:43],v[10:11],v[10:11],0
v_mfma_f32_16x16x16_bf16 v[44:47],v[10:11],v[10:11],0
fj_95:
fa_93:
s_waitcnt vmcnt(5)
v_lshlrev_b32 v108,16,v80
v_and_b32 v109,0xffff0000,v80
v_lshlrev_b32 v110,16,v81
v_and_b32 v111,0xffff0000,v81
s_waitcnt vmcnt(4)
v_lshlrev_b32 v92,16,v72
v_and_b32 v93,0xffff0000,v72
v_lshlrev_b32 v94,16,v73
v_and_b32 v95,0xffff0000,v73
v_lshlrev_b32 v96,16,v74
v_and_b32 v97,0xffff0000,v74
v_lshlrev_b32 v98,16,v75
v_and_b32 v99,0xffff0000,v75
s_waitcnt vmcnt(3)
v_lshlrev_b32 v100,16,v76
v_and_b32 v101,0xffff0000,v76
v_lshlrev_b32 v102,16,v77
v_and_b32 v103,0xffff0000,v77
v_lshlrev_b32 v104,16,v78
v_and_b32 v105,0xffff0000,v78
v_lshlrev_b32 v106,16,v79
v_and_b32 v107,0xffff0000,v79
s_waitcnt vmcnt(2)
v_dot2c_f32_bf16 v108,s37,v90
v_dot2c_f32_bf16 v109,s81,v90
v_dot2c_f32_bf16 v110,s37,v91
v_dot2c_f32_bf16 v111,s81,v91
v_bitop3_b32 v16,v80,v90,s57 bitop3:0x7e
v_cvt_pk_bf16_f32 v56,v108,v109
s_nop 0
v_cvt_pk_bf16_f32 v57,v110,v111
ds_write_b64 v23,v[56:57]
s_waitcnt vmcnt(1)
v_dot2c_f32_bf16 v92,s37,v82
v_dot2c_f32_bf16 v93,s81,v82
v_dot2c_f32_bf16 v94,s37,v83
v_dot2c_f32_bf16 v95,s81,v83
v_dot2c_f32_bf16 v96,s37,v84
v_dot2c_f32_bf16 v97,s81,v84
v_dot2c_f32_bf16 v98,s37,v85
v_dot2c_f32_bf16 v99,s81,v85
v_bitop3_b32 v17,v72,v82,s57 bitop3:0x7e
v_or_b32 v16,v16,v17
v_cvt_pk_bf16_f32 v48,v92,v93
v_cvt_pk_bf16_f32 v49,v94,v95
v_cvt_pk_bf16_f32 v50,v96,v97
v_cvt_pk_bf16_f32 v51,v98,v99
ds_write_b128 v22,v[48:51] offset:0
s_waitcnt vmcnt(0)
v_dot2c_f32_bf16 v100,s37,v86
v_dot2c_f32_bf16 v101,s81,v86
v_dot2c_f32_bf16 v102,s37,v87
v_dot2c_f32_bf16 v103,s81,v87
v_dot2c_f32_bf16 v104,s37,v88
v_dot2c_f32_bf16 v105,s81,v88
v_dot2c_f32_bf16 v106,s37,v89
v_dot2c_f32_bf16 v107,s81,v89
v_bitop3_b32 v17,v76,v86,s57 bitop3:0x7e
v_bitop3_b32 v16,v16,v17,1 bitop3:0xa8
v_cmp_ne_u32 vcc,0,v16
v_cvt_pk_bf16_f32 v52,v100,v101
v_cvt_pk_bf16_f32 v53,v102,v103
v_cvt_pk_bf16_f32 v54,v104,v105
v_cvt_pk_bf16_f32 v55,v106,v107
ds_write_b128 v22,v[52:55] offset:1024
s_cbranch_vccnz fr_94
fj_95g:
v_smfmac_f32_16x16x64_bf16 v[24:27],v[48:51],a[0:7],v2
ds_read_b128 v[72:75],v21 offset:0
v_xor_b32 v58,57344,v58
v_smfmac_f32_16x16x64_bf16 v[28:31],v[48:51],a[8:15],v2
ds_read_b128 v[76:79],v21 offset:1024
s_sub_u32 s60,s4,s5
v_smfmac_f32_16x16x64_bf16 v[32:35],v[48:51],a[16:23],v2
ds_read_b128 v[80:83],v21 offset:2048
s_cmp_gt_i32 s60,13
v_smfmac_f32_16x16x64_bf16 v[36:39],v[48:51],a[24:31],v2
ds_read_b128 v[84:87],v21 offset:3072
s_cselect_b32 s53,1,0
s_waitcnt lgkmcnt(4)
s_barrier
v_smfmac_f32_16x16x64_bf16 v[40:43],v[48:51],a[32:39],v2
ds_read_b128 v[60:63],v3 offset:0
s_cmp_eq_u32 s4,64
v_smfmac_f32_16x16x64_bf16 v[24:27],v[52:55],a[40:47],v2
ds_read_b128 v[64:67],v3 offset:1024
s_cselect_b32 s53,1,s53
v_smfmac_f32_16x16x64_bf16 v[28:31],v[52:55],a[48:55],v2
ds_read_b128 v[68:71],v4 offset:0
s_cmp_eq_u32 s53,0
v_smfmac_f32_16x16x64_bf16 v[32:35],v[52:55],a[56:63],v2
s_cselect_b32 s54,s4,s5
s_addc_u32 s4,s4,0
s_add_u32 s5,s5,s53
v_smfmac_f32_16x16x64_bf16 v[36:39],v[52:55],a[64:71],v2
s_mul_i32 s73,s54,393216
s_add_u32 s73,s73,s84
s_sub_u32 s74,s75,s74
v_smfmac_f32_16x16x64_bf16 v[40:43],v[52:55],a[72:79],v2
s_mov_b32 m0,s74
s_and_b32 s60,s52,1
s_waitcnt lgkmcnt(5)
v_smfmac_f32_16x16x64_bf16 v[44:47],v[48:51],v[72:79],v2
ds_read_b128 v[72:75],v21 offset:4096
s_waitcnt lgkmcnt(4)
v_smfmac_f32_16x16x64_bf16 v[44:47],v[52:55],v[80:87],v2
ds_read_b128 v[76:79],v21 offset:5120
s_waitcnt lgkmcnt(4)
v_smfmac_f32_16x16x64_bf16 v[24:27],v[60:63],a[80:87],v2
ds_read_b128 v[80:83],v21 offset:6144
s_lshl2_add_u32 s60,s51,s60
v_smfmac_f32_16x16x64_bf16 v[28:31],v[60:63],a[88:95],v2
ds_read_b128 v[84:87],v21 offset:7168
s_mul_i32 s60,s60,49152
v_smfmac_f32_16x16x64_bf16 v[32:35],v[60:63],a[96:103],v2
s_add_u32 s71,s60,s34
s_add_u32 s70,s60,s33
s_lshl_b32 s60,s51,9
v_smfmac_f32_16x16x64_bf16 v[36:39],v[60:63],a[104:111],v2
s_add_u32 s72,s60,s35
buffer_load_dwordx4 v1,s[8:11],s73 offen sc1 lds
v_smfmac_f32_16x16x64_bf16 v[40:43],v[60:63],a[112:119],v2
buffer_load_dwordx4 v1,s[8:11],s73 offen offset:1024 sc1 lds
s_waitcnt lgkmcnt(2)
v_smfmac_f32_16x16x64_bf16 v[44:47],v[60:63],v[72:79],v2
ds_read_b128 v[60:63],v4 offset:1024
v_smfmac_f32_16x16x64_bf16 v[24:27],v[64:67],a[120:127],v2
ds_read_b128 v[72:75],v21 offset:8192
v_smfmac_f32_16x16x64_bf16 v[28:31],v[64:67],a[128:135],v2
ds_read_b128 v[76:79],v21 offset:9216
v_smfmac_f32_16x16x64_bf16 v[32:35],v[64:67],a[136:143],v2
buffer_load_dwordx4 v1,s[8:11],s73 offen offset:2048 sc1 lds
v_smfmac_f32_16x16x64_bf16 v[36:39],v[64:67],a[144:151],v2
buffer_load_dwordx4 v1,s[8:11],s73 offen offset:3072 sc1 lds
v_add_u32 v17,s85,v58
v_smfmac_f32_16x16x64_bf16 v[40:43],v[64:67],a[152:159],v2
v_mov_b32 v16,s58
s_and_b32 s60,s54,1
s_waitcnt lgkmcnt(3)
v_smfmac_f32_16x16x64_bf16 v[44:47],v[64:67],v[80:87],v2
ds_read_b128 v[64:67],v5 offset:0
s_lshl2_add_u32 s60,s53,s60
v_smfmac_f32_16x16x64_bf16 v[24:27],v[68:71],a[160:167],v2
ds_read_b128 v[80:83],v21 offset:10240
s_lshl_b32 s68,s60,16
v_smfmac_f32_16x16x64_bf16 v[28:31],v[68:71],a[168:175],v2
ds_read_b128 v[84:87],v21 offset:11264
s_add_u32 s68,s68,s83
v_smfmac_f32_16x16x64_bf16 v[32:35],v[68:71],a[176:183],v2
s_mul_i32 s59,s60,20480
s_add_u32 s59,s59,s6
s_lshl_b32 s69,s53,9
v_smfmac_f32_16x16x64_bf16 v[36:39],v[68:71],a[184:191],v2
s_add_u32 s69,s69,s7
s_bfe_u32 s31,s54,65537
s_add_u32 s32,s54,1
v_smfmac_f32_16x16x64_bf16 v[40:43],v[68:71],a[192:199],v2
s_add_u32 s50,s50,1
s_mov_b32 s51,s53
s_waitcnt lgkmcnt(3)
v_smfmac_f32_16x16x64_bf16 v[44:47],v[68:71],v[72:79],v2
ds_read_b128 v[68:71],v5 offset:1024
s_mov_b32 s52,s54
v_smfmac_f32_16x16x64_bf16 v[24:27],v[60:63],a[200:207],v2
ds_read_b128 v[72:75],v21 offset:12288
s_mov_b32 s58,s32
v_smfmac_f32_16x16x64_bf16 v[28:31],v[60:63],a[208:215],v2
ds_read_b128 v[76:79],v21 offset:13312
s_mov_b64 vcc,s[88:89]
v_smfmac_f32_16x16x64_bf16 v[32:35],v[60:63],a[216:223],v2
ds_read_b128 v[48:51],v58 offset:0
v_smfmac_f32_16x16x64_bf16 v[36:39],v[60:63],a[224:231],v2
v_smfmac_f32_16x16x64_bf16 v[40:43],v[60:63],a[232:239],v2
ds_read_b128 v[52:55],v58 offset:1024
s_waitcnt lgkmcnt(5)
v_smfmac_f32_16x16x64_bf16 v[44:47],v[60:63],v[80:87],v2
ds_read_b128 v[60:63],v59 offset:0
v_smfmac_f32_16x16x64_bf16 v[24:27],v[64:67],a[240:247],v2
ds_read_b128 v[80:83],v21 offset:14336
v_smfmac_f32_16x16x64_bf16 v[28:31],v[64:67],a[248:255],v2
ds_read_b128 v[84:87],v21 offset:15360
v_smfmac_f32_16x16x64_bf16 v[32:35],v[64:67],v[112:119],v2
ds_read_b128 v[88:91],v58 offset:2048
v_smfmac_f32_16x16x64_bf16 v[36:39],v[64:67],v[120:127],v2
v_smfmac_f32_16x16x64_bf16 v[40:43],v[64:67],v[128:135],v2
ds_read_b128 v[92:95],v58 offset:3072
s_waitcnt lgkmcnt(7)
v_smfmac_f32_16x16x64_bf16 v[44:47],v[64:67],v[72:79],v2
ds_read_b128 v[64:67],v59 offset:1024
v_smfmac_f32_16x16x64_bf16 v[24:27],v[68:71],v[136:143],v2
ds_read_b128 v[72:75],v21 offset:16384
v_smfmac_f32_16x16x64_bf16 v[28:31],v[68:71],v[144:151],v2
ds_read_b128 v[76:79],v21 offset:17408
v_smfmac_f32_16x16x64_bf16 v[32:35],v[68:71],v[152:159],v2
ds_read_b128 v[96:99],v58 offset:4096
v_smfmac_f32_16x16x64_bf16 v[36:39],v[68:71],v[160:167],v2
v_smfmac_f32_16x16x64_bf16 v[40:43],v[68:71],v[168:175],v2
ds_read_b128 v[100:103],v58 offset:5120
s_waitcnt lgkmcnt(7)
v_smfmac_f32_16x16x64_bf16 v[44:47],v[68:71],v[80:87],v2
ds_read_b128 v[80:83],v21 offset:18432
v_smfmac_f32_16x16x64_bf16 v[24:27],v[60:63],v[176:183],v2
ds_read_b128 v[84:87],v21 offset:19456
v_smfmac_f32_16x16x64_bf16 v[36:39],v[60:63],v[200:207],v2
ds_read_b128 v[104:107],v58 offset:6144
s_waitcnt lgkmcnt(7)
v_smfmac_f32_16x16x64_bf16 v[24:27],v[64:67],v[216:223],v2
v_smfmac_f32_16x16x64_bf16 v[36:39],v[64:67],v[240:247],v2
ds_read_b128 v[108:111],v58 offset:7168
v_smfmac_f32_16x16x64_bf16 v[28:31],v[60:63],v[184:191],v2
v_smfmac_f32_16x16x64_bf16 v[40:43],v[60:63],v[208:215],v2
v_add_f32 v24,v24,v25
v_smfmac_f32_16x16x64_bf16 v[28:31],v[64:67],v[224:231],v2
v_add_f32 v26,v26,v27
v_smfmac_f32_16x16x64_bf16 v[40:43],v[64:67],v[248:255],v2
v_add_f32 v36,v36,v37
v_smfmac_f32_16x16x64_bf16 v[32:35],v[60:63],v[192:199],v2
v_add_f32 v38,v38,v39
s_waitcnt lgkmcnt(6)
v_smfmac_f32_16x16x64_bf16 v[44:47],v[60:63],v[72:79],v2
v_cvt_pk_bf16_f32 v37,v24,v26
v_smfmac_f32_16x16x64_bf16 v[32:35],v[64:67],v[232:239],v2
v_cvt_pk_bf16_f32 v36,v36,v38
s_waitcnt lgkmcnt(2)
v_smfmac_f32_16x16x64_bf16 v[44:47],v[64:67],v[80:87],v2
ds_write_b64 v6,v[36:37] offset:0
v_add_f32 v28,v28,v29
v_add_f32 v30,v30,v31
v_add_f32 v40,v40,v41
v_add_f32 v42,v42,v43
v_cvt_pk_bf16_f32 v41,v28,v30
v_cvt_pk_bf16_f32 v40,v40,v42
ds_write_b64 v6,v[40:41] offset:512
v_add_f32 v32,v32,v33
v_add_f32 v34,v34,v35
v_add_f32 v44,v44,v45
v_add_f32 v46,v46,v47
v_cvt_pk_bf16_f32 v45,v32,v34
v_cvt_pk_bf16_f32 v44,v44,v46
ds_write_b64 v6,v[44:45] offset:1024
ds_read_b128 v[72:75],v58 offset:8192
ds_read_b128 v[76:79],v58 offset:9216
s_waitcnt lgkmcnt(2)
s_barrier
ds_read_b64_tr_b16 v[24:25],v7 offset:0
ds_read_b64_tr_b16 v[26:27],v7 offset:512
ds_read_b64_tr_b16 v[28:29],v7 offset:1024
ds_read_b64_tr_b16 v[30:31],v7 offset:1536
ds_read_b64_tr_b16 v[32:33],v7 offset:2048
ds_read_b64_tr_b16 v[34:35],v7 offset:2560
ds_read_b64_tr_b16 v[36:37],v7 offset:3072
ds_read_b64_tr_b16 v[38:39],v7 offset:3584
s_waitcnt lgkmcnt(6)
v_mfma_f32_16x16x32_bf16 v[60:63],v[48:51],v[24:27],0
ds_read_b64_tr_b16 v[40:41],v7 offset:4096
v_mfma_f32_16x16x32_bf16 v[64:67],v[52:55],v[24:27],0
ds_read_b64_tr_b16 v[42:43],v7 offset:4608
v_mfma_f32_16x16x32_bf16 v[68:71],v[24:27],v[24:27],0
ds_read_b128 v[80:83],v58 offset:10240
s_waitcnt lgkmcnt(7)
v_mfma_f32_16x16x32_bf16 v[60:63],v[88:91],v[28:31],v[60:63]
ds_read_b128 v[84:87],v58 offset:11264
v_mfma_f32_16x16x32_bf16 v[64:67],v[92:95],v[28:31],v[64:67]
ds_read_b64_tr_b16 v[44:45],v7 offset:5120
v_mfma_f32_16x16x32_bf16 v[68:71],v[28:31],v[28:31],v[68:71]
ds_read_b64_tr_b16 v[46:47],v7 offset:5632
s_waitcnt lgkmcnt(8)
v_mfma_f32_16x16x32_bf16 v[60:63],v[96:99],v[32:35],v[60:63]
ds_read_b128 v[24:27],v17 offset:12288
v_mfma_f32_16x16x32_bf16 v[64:67],v[100:103],v[32:35],v[64:67]
ds_read_b128 v[28:31],v17 offset:13312
v_mfma_f32_16x16x32_bf16 v[68:71],v[32:35],v[32:35],v[68:71]
s_waitcnt lgkmcnt(8)
v_mfma_f32_16x16x32_bf16 v[60:63],v[104:107],v[36:39],v[60:63]
ds_read_b128 v[32:35],v17 offset:14336
v_mfma_f32_16x16x32_bf16 v[64:67],v[108:111],v[36:39],v[64:67]
v_mfma_f32_16x16x32_bf16 v[68:71],v[36:39],v[36:39],v[68:71]
s_waitcnt lgkmcnt(7)
v_mfma_f32_16x16x32_bf16 v[60:63],v[72:75],v[40:43],v[60:63]
ds_read_b128 v[36:39],v17 offset:15360
v_mfma_f32_16x16x32_bf16 v[64:67],v[76:79],v[40:43],v[64:67]
v_mfma_f32_16x16x32_bf16 v[68:71],v[40:43],v[40:43],v[68:71]
s_waitcnt lgkmcnt(4)
v_mfma_f32_16x16x32_bf16 v[60:63],v[80:83],v[44:47],v[60:63]
v_mfma_f32_16x16x32_bf16 v[64:67],v[84:87],v[44:47],v[64:67]
buffer_load_dwordx4 v[48:51],v1,s[8:11],s71 offen sc1
v_mfma_f32_16x16x32_bf16 v[68:71],v[44:47],v[44:47],v[68:71]
s_nop 4
v_cndmask_b32_dpp v60,v64,v60,vcc quad_perm:[2,3,2,3] row_mask:0xf bank_mask:0xf
v_cndmask_b32_dpp v61,v65,v61,vcc quad_perm:[2,3,2,3] row_mask:0xf bank_mask:0xf
v_cndmask_b32_dpp v62,v66,v62,vcc quad_perm:[2,3,2,3] row_mask:0xf bank_mask:0xf
v_cndmask_b32_dpp v63,v67,v63,vcc quad_perm:[2,3,2,3] row_mask:0xf bank_mask:0xf
v_max3_f32 v12,v60,v61,v62
v_cndmask_b32_dpp v68,v69,v68,vcc quad_perm:[2,3,2,3] row_mask:0xf bank_mask:0xf
v_max3_f32 v12,v12,v63,v68
s_nop 1
v_max_f32_dpp v13,v12,v12 quad_perm:[2,3,0,1] row_mask:0xf bank_mask:0xf
v_max_f32_dpp v12,v12,v12 quad_perm:[2,3,0,1] row_mask:0xf bank_mask:0xf
s_nop 1
v_permlane32_swap_b32 v12,v13
v_max_f32 v15,v12,v13
v_max_f32 v12,v12,v13
s_mov_b64 exec,1
buffer_store_dword v16,v1,s[8:11],s72 offen
s_mov_b64 exec,-1
v_permlane16_swap_b32 v12,v15
v_max_f32 v12,v12,v15
v_mul_f32 v12,s87,v12
v_fma_f32 v60,v60,s87,-v12
v_fma_f32 v61,v61,s87,-v12
v_fma_f32 v62,v62,s87,-v12
v_fma_f32 v63,v63,s87,-v12
v_fma_f32 v68,v68,s87,-v12
v_exp_f32 v60,v60
v_exp_f32 v61,v61
v_exp_f32 v62,v62
v_exp_f32 v63,v63
v_exp_f32 v68,v68
v_cvt_pk_bf16_f32 v70,v60,v61
v_cvt_pk_bf16_f32 v71,v62,v63
v_cndmask_b32 v46,v70,v10,vcc
v_cndmask_b32 v47,v71,v10,vcc
v_cndmask_b32_dpp v44,v70,v10,vcc quad_perm:[2,3,0,1] row_mask:0xf bank_mask:0xf
v_cndmask_b32_dpp v45,v71,v10,vcc quad_perm:[2,3,0,1] row_mask:0xf bank_mask:0xf
s_mov_b64 vcc,s[90:91]
s_waitcnt lgkmcnt(0)
v_cndmask_b32 v40,v70,v10,vcc
v_mfma_f32_16x16x32_bf16 v[64:67],v[28:31],v[44:47],0
v_cndmask_b32 v41,v71,v10,vcc
v_cndmask_b32_dpp v42,v70,v10,vcc quad_perm:[2,3,0,1] row_mask:0xf bank_mask:0xf
v_mfma_f32_16x16x32_bf16 v[52:55],v[36:39],v[44:47],0
v_cndmask_b32_dpp v43,v71,v10,vcc quad_perm:[2,3,0,1] row_mask:0xf bank_mask:0xf
v_mov_b32_dpp v14,v68 quad_perm:[2,3,0,1] row_mask:0xf bank_mask:0xf
v_add_f32 v12,v60,v61
v_mfma_f32_16x16x32_bf16 v[64:67],v[24:27],v[40:43],v[64:67]
v_cvt_pk_bf16_f32 v56,v68,v14
v_cvt_pk_bf16_f32 v57,v14,v68
v_mfma_f32_16x16x32_bf16 v[52:55],v[32:35],v[40:43],v[52:55]
v_cndmask_b32 v56,v56,v10,vcc
v_cndmask_b32 v57,v10,v57,vcc
ds_read_b32 v0,v9
v_add_f32 v13,v62,v63
v_add_f32 v12,v12,v68
v_add_f32 v12,v12,v13
s_waitcnt vmcnt(1)
v_bitop3_b32 v17,v48,v50,s57 bitop3:0x7e
v_add_f32_dpp v13,v12,v12 quad_perm:[2,3,0,1] row_mask:0xf bank_mask:0xf
v_and_b32 v17,1,v17
v_add_f32_dpp v12,v12,v12 quad_perm:[2,3,0,1] row_mask:0xf bank_mask:0xf
v_cmp_ne_u32 vcc,0,v17
s_cbranch_vccnz vb_96
vo_97:
v_mfma_f32_16x16x16_bf16 v[64:67],v[48:49],v[56:57],v[64:67]
v_permlane32_swap_b32 v12,v13
v_add_f32 v15,v12,v13
v_mfma_f32_16x16x16_bf16 v[52:55],v[50:51],v[56:57],v[52:55]
v_add_f32 v12,v12,v13
s_nop 1
v_permlane16_swap_b32 v12,v15
v_add_f32 v12,v12,v15
v_rcp_f32 v12,v12
s_nop 0
v_mul_f32 v64,v64,v12
v_mul_f32 v65,v65,v12
v_mul_f32 v66,v66,v12
v_mul_f32 v67,v67,v12
v_mul_f32 v52,v52,v12
v_mul_f32 v53,v53,v12
v_mul_f32 v54,v54,v12
v_mul_f32 v55,v55,v12
v_cvt_pk_bf16_f32 v48,v64,v65
v_cvt_pk_bf16_f32 v49,v66,v67
v_cvt_pk_bf16_f32 v50,v52,v53
v_cvt_pk_bf16_f32 v51,v54,v55
v_and_or_b32 v48,v48,-2,s57
buffer_store_dwordx4 v[48:51],v8,s[8:11],s70 offen
s_mov_b32 s57,s31
v_mov_b32 v12,s50
s_waitcnt lgkmcnt(0)
v_cmp_ne_u32 vcc,s50,v0
ds_write_b32 v20,v12
s_cmp_lt_u32 s50,128
s_cbranch_scc1 CS_LOOP_F
s_branch CS_DONE
fr_94:
v_bitop3_b32 v12,v72,v76,s57 bitop3:0x7e
v_bitop3_b32 v13,v80,v80,s57 bitop3:0x7e
v_xor_b32 v14,s57,v80
v_or3_b32 v12,v12,v13,v14
v_and_b32 v12,1,v12
v_cmp_ne_u32 vcc,0,v12
s_cbranch_vccz sk_98
buffer_load_dwordx2 v[80:81],v18,s[8:11],s59 offen sc1
buffer_load_dwordx4 v[72:75],v1,s[8:11],s59 offen sc1
buffer_load_dwordx4 v[76:79],v1,s[8:11],s59 offen offset:1024 sc1
sk_98:
buffer_load_dwordx2 v[90:91],v18,s[8:11],s68 offen sc1
buffer_load_dwordx4 v[82:85],v1,s[8:11],s68 offen sc1
buffer_load_dwordx4 v[86:89],v1,s[8:11],s68 offen offset:1024 sc1
s_sub_u32 s47,s47,1
s_cbranch_scc1 ABORT
s_waitcnt lgkmcnt(0)
s_branch fa_93
vb_96:
s_sub_u32 s47,s47,1
s_cbranch_scc1 ABORT
buffer_load_dwordx4 v[48:51],v1,s[8:11],s71 offen sc1
s_waitcnt vmcnt(0)
v_bitop3_b32 v17,v48,v50,s57 bitop3:0x7e
v_and_b32 v17,1,v17
v_cmp_ne_u32 vcc,0,v17
s_nop 0
s_cbranch_vccnz vb_96
s_branch vo_97
CS_LOOP_S:
s_barrier
buffer_load_dwordx2 v[80:81],v18,s[8:11],s59 offen sc1
buffer_load_dwordx4 v[72:75],v1,s[8:11],s59 offen sc1
buffer_load_dwordx4 v[76:79],v1,s[8:11],s59 offen offset:1024 sc1
s_cbranch_vccz fj_101f
s_waitcnt vmcnt(2)
s_sleep 3
fj_101f:
buffer_load_dwordx2 v[90:91],v18,s[8:11],s68 offen sc1
buffer_load_dwordx4 v[82:85],v1,s[8:11],s68 offen sc1
buffer_load_dwordx4 v[86:89],v1,s[8:11],s68 offen offset:1024 sc1
v_mfma_f32_32x32x8_bf16 v[24:39],v[10:11],v[10:11],0
v_mfma_f32_16x16x16_bf16 v[40:43],v[10:11],v[10:11],0
v_mfma_f32_16x16x16_bf16 v[44:47],v[10:11],v[10:11],0
fj_101:
fa_99:
s_waitcnt vmcnt(5)
v_lshlrev_b32 v108,16,v80
v_and_b32 v109,0xffff0000,v80
v_lshlrev_b32 v110,16,v81
v_and_b32 v111,0xffff0000,v81
s_waitcnt vmcnt(4)
v_lshlrev_b32 v92,16,v72
v_and_b32 v93,0xffff0000,v72
v_lshlrev_b32 v94,16,v73
v_and_b32 v95,0xffff0000,v73
v_lshlrev_b32 v96,16,v74
v_and_b32 v97,0xffff0000,v74
v_lshlrev_b32 v98,16,v75
v_and_b32 v99,0xffff0000,v75
s_waitcnt vmcnt(3)
v_lshlrev_b32 v100,16,v76
v_and_b32 v101,0xffff0000,v76
v_lshlrev_b32 v102,16,v77
v_and_b32 v103,0xffff0000,v77
v_lshlrev_b32 v104,16,v78
v_and_b32 v105,0xffff0000,v78
v_lshlrev_b32 v106,16,v79
v_and_b32 v107,0xffff0000,v79
s_waitcnt vmcnt(2)
v_dot2c_f32_bf16 v108,s37,v90
v_dot2c_f32_bf16 v109,s81,v90
v_dot2c_f32_bf16 v110,s37,v91
v_dot2c_f32_bf16 v111,s81,v91
v_bitop3_b32 v16,v80,v90,s57 bitop3:0x7e
v_cvt_pk_bf16_f32 v56,v108,v109
s_nop 0
v_cvt_pk_bf16_f32 v57,v110,v111
ds_write_b64 v23,v[56:57]
s_waitcnt vmcnt(1)
v_dot2c_f32_bf16 v92,s37,v82
v_dot2c_f32_bf16 v93,s81,v82
v_dot2c_f32_bf16 v94,s37,v83
v_dot2c_f32_bf16 v95,s81,v83
v_dot2c_f32_bf16 v96,s37,v84
v_dot2c_f32_bf16 v97,s81,v84
v_dot2c_f32_bf16 v98,s37,v85
v_dot2c_f32_bf16 v99,s81,v85
v_bitop3_b32 v17,v72,v82,s57 bitop3:0x7e
v_or_b32 v16,v16,v17
v_cvt_pk_bf16_f32 v48,v92,v93
v_cvt_pk_bf16_f32 v49,v94,v95
v_cvt_pk_bf16_f32 v50,v96,v97
v_cvt_pk_bf16_f32 v51,v98,v99
ds_write_b128 v22,v[48:51] offset:0
s_waitcnt vmcnt(0)
v_dot2c_f32_bf16 v100,s37,v86
v_dot2c_f32_bf16 v101,s81,v86
v_dot2c_f32_bf16 v102,s37,v87
v_dot2c_f32_bf16 v103,s81,v87
v_dot2c_f32_bf16 v104,s37,v88
v_dot2c_f32_bf16 v105,s81,v88
v_dot2c_f32_bf16 v106,s37,v89
v_dot2c_f32_bf16 v107,s81,v89
v_bitop3_b32 v17,v76,v86,s57 bitop3:0x7e
v_bitop3_b32 v16,v16,v17,1 bitop3:0xa8
v_cmp_ne_u32 vcc,0,v16
v_cvt_pk_bf16_f32 v52,v100,v101
v_cvt_pk_bf16_f32 v53,v102,v103
v_cvt_pk_bf16_f32 v54,v104,v105
v_cvt_pk_bf16_f32 v55,v106,v107
ds_write_b128 v22,v[52:55] offset:1024
s_cbranch_vccnz fr_100
fj_101g:
v_smfmac_f32_16x16x64_bf16 v[24:27],v[48:51],a[0:7],v2
ds_read_b128 v[72:75],v21 offset:0
v_xor_b32 v58,57344,v58
v_smfmac_f32_16x16x64_bf16 v[28:31],v[48:51],a[8:15],v2
ds_read_b128 v[76:79],v21 offset:1024
s_sub_u32 s60,s4,s5
v_smfmac_f32_16x16x64_bf16 v[32:35],v[48:51],a[16:23],v2
ds_read_b128 v[80:83],v21 offset:2048
s_cmp_gt_i32 s60,13
v_smfmac_f32_16x16x64_bf16 v[36:39],v[48:51],a[24:31],v2
ds_read_b128 v[84:87],v21 offset:3072
s_cselect_b32 s53,1,0
s_waitcnt lgkmcnt(4)
s_barrier
v_smfmac_f32_16x16x64_bf16 v[40:43],v[48:51],a[32:39],v2
ds_read_b128 v[60:63],v3 offset:0
s_cmp_eq_u32 s4,64
v_smfmac_f32_16x16x64_bf16 v[24:27],v[52:55],a[40:47],v2
ds_read_b128 v[64:67],v3 offset:1024
s_cselect_b32 s53,1,s53
v_smfmac_f32_16x16x64_bf16 v[28:31],v[52:55],a[48:55],v2
ds_read_b128 v[68:71],v4 offset:0
s_cmp_eq_u32 s53,0
v_smfmac_f32_16x16x64_bf16 v[32:35],v[52:55],a[56:63],v2
s_cselect_b32 s54,s4,s5
s_addc_u32 s4,s4,0
s_add_u32 s5,s5,s53
v_smfmac_f32_16x16x64_bf16 v[36:39],v[52:55],a[64:71],v2
s_mul_i32 s73,s54,393216
s_add_u32 s73,s73,s84
s_sub_u32 s74,s75,s74
v_smfmac_f32_16x16x64_bf16 v[40:43],v[52:55],a[72:79],v2
s_mov_b32 m0,s74
s_and_b32 s60,s52,1
s_waitcnt lgkmcnt(5)
v_smfmac_f32_16x16x64_bf16 v[44:47],v[48:51],v[72:79],v2
ds_read_b128 v[72:75],v21 offset:4096
s_waitcnt lgkmcnt(4)
v_smfmac_f32_16x16x64_bf16 v[44:47],v[52:55],v[80:87],v2
ds_read_b128 v[76:79],v21 offset:5120
s_waitcnt lgkmcnt(4)
v_smfmac_f32_16x16x64_bf16 v[24:27],v[60:63],a[80:87],v2
ds_read_b128 v[80:83],v21 offset:6144
s_lshl2_add_u32 s60,s51,s60
v_smfmac_f32_16x16x64_bf16 v[28:31],v[60:63],a[88:95],v2
ds_read_b128 v[84:87],v21 offset:7168
s_mul_i32 s60,s60,49152
v_smfmac_f32_16x16x64_bf16 v[32:35],v[60:63],a[96:103],v2
s_add_u32 s71,s60,s34
s_add_u32 s70,s60,s33
s_lshl_b32 s60,s51,9
v_smfmac_f32_16x16x64_bf16 v[36:39],v[60:63],a[104:111],v2
s_add_u32 s72,s60,s35
buffer_load_dwordx4 v1,s[8:11],s73 offen sc1 lds
v_smfmac_f32_16x16x64_bf16 v[40:43],v[60:63],a[112:119],v2
buffer_load_dwordx4 v1,s[8:11],s73 offen offset:1024 sc1 lds
s_waitcnt lgkmcnt(2)
v_smfmac_f32_16x16x64_bf16 v[44:47],v[60:63],v[72:79],v2
ds_read_b128 v[60:63],v4 offset:1024
v_smfmac_f32_16x16x64_bf16 v[24:27],v[64:67],a[120:127],v2
ds_read_b128 v[72:75],v21 offset:8192
v_smfmac_f32_16x16x64_bf16 v[28:31],v[64:67],a[128:135],v2
ds_read_b128 v[76:79],v21 offset:9216
v_smfmac_f32_16x16x64_bf16 v[32:35],v[64:67],a[136:143],v2
buffer_load_dwordx4 v1,s[8:11],s73 offen offset:2048 sc1 lds
v_smfmac_f32_16x16x64_bf16 v[36:39],v[64:67],a[144:151],v2
buffer_load_dwordx4 v1,s[8:11],s73 offen offset:3072 sc1 lds
v_add_u32 v17,s85,v58
v_smfmac_f32_16x16x64_bf16 v[40:43],v[64:67],a[152:159],v2
v_mov_b32 v16,s58
s_and_b32 s60,s54,1
s_waitcnt lgkmcnt(3)
v_smfmac_f32_16x16x64_bf16 v[44:47],v[64:67],v[80:87],v2
ds_read_b128 v[64:67],v5 offset:0
s_lshl2_add_u32 s60,s53,s60
v_smfmac_f32_16x16x64_bf16 v[24:27],v[68:71],a[160:167],v2
ds_read_b128 v[80:83],v21 offset:10240
s_lshl_b32 s68,s60,16
v_smfmac_f32_16x16x64_bf16 v[28:31],v[68:71],a[168:175],v2
ds_read_b128 v[84:87],v21 offset:11264
s_add_u32 s68,s68,s83
v_smfmac_f32_16x16x64_bf16 v[32:35],v[68:71],a[176:183],v2
s_mul_i32 s59,s60,20480
s_add_u32 s59,s59,s6
s_lshl_b32 s69,s53,9
v_smfmac_f32_16x16x64_bf16 v[36:39],v[68:71],a[184:191],v2
s_add_u32 s69,s69,s7
s_bfe_u32 s31,s54,65537
s_add_u32 s32,s54,1
v_smfmac_f32_16x16x64_bf16 v[40:43],v[68:71],a[192:199],v2
s_add_u32 s50,s50,1
s_mov_b32 s51,s53
s_waitcnt lgkmcnt(3)
v_smfmac_f32_16x16x64_bf16 v[44:47],v[68:71],v[72:79],v2
ds_read_b128 v[68:71],v5 offset:1024
s_mov_b32 s52,s54
v_smfmac_f32_16x16x64_bf16 v[24:27],v[60:63],a[200:207],v2
ds_read_b128 v[72:75],v21 offset:12288
s_mov_b32 s58,s32
v_smfmac_f32_16x16x64_bf16 v[28:31],v[60:63],a[208:215],v2
ds_read_b128 v[76:79],v21 offset:13312
s_mov_b64 vcc,s[88:89]
v_smfmac_f32_16x16x64_bf16 v[32:35],v[60:63],a[216:223],v2
ds_read_b128 v[48:51],v58 offset:0
v_smfmac_f32_16x16x64_bf16 v[36:39],v[60:63],a[224:231],v2
v_smfmac_f32_16x16x64_bf16 v[40:43],v[60:63],a[232:239],v2
ds_read_b128 v[52:55],v58 offset:1024
s_waitcnt lgkmcnt(5)
v_smfmac_f32_16x16x64_bf16 v[44:47],v[60:63],v[80:87],v2
ds_read_b128 v[60:63],v59 offset:0
v_smfmac_f32_16x16x64_bf16 v[24:27],v[64:67],a[240:247],v2
ds_read_b128 v[80:83],v21 offset:14336
v_smfmac_f32_16x16x64_bf16 v[28:31],v[64:67],a[248:255],v2
ds_read_b128 v[84:87],v21 offset:15360
v_smfmac_f32_16x16x64_bf16 v[32:35],v[64:67],v[112:119],v2
ds_read_b128 v[88:91],v58 offset:2048
v_smfmac_f32_16x16x64_bf16 v[36:39],v[64:67],v[120:127],v2
v_smfmac_f32_16x16x64_bf16 v[40:43],v[64:67],v[128:135],v2
ds_read_b128 v[92:95],v58 offset:3072
s_waitcnt lgkmcnt(7)
v_smfmac_f32_16x16x64_bf16 v[44:47],v[64:67],v[72:79],v2
ds_read_b128 v[64:67],v59 offset:1024
v_smfmac_f32_16x16x64_bf16 v[24:27],v[68:71],v[136:143],v2
ds_read_b128 v[72:75],v21 offset:16384
v_smfmac_f32_16x16x64_bf16 v[28:31],v[68:71],v[144:151],v2
ds_read_b128 v[76:79],v21 offset:17408
v_smfmac_f32_16x16x64_bf16 v[32:35],v[68:71],v[152:159],v2
ds_read_b128 v[96:99],v58 offset:4096
v_smfmac_f32_16x16x64_bf16 v[36:39],v[68:71],v[160:167],v2
v_smfmac_f32_16x16x64_bf16 v[40:43],v[68:71],v[168:175],v2
ds_read_b128 v[100:103],v58 offset:5120
s_waitcnt lgkmcnt(7)
v_smfmac_f32_16x16x64_bf16 v[44:47],v[68:71],v[80:87],v2
ds_read_b128 v[80:83],v21 offset:18432
v_smfmac_f32_16x16x64_bf16 v[24:27],v[60:63],v[176:183],v2
ds_read_b128 v[84:87],v21 offset:19456
v_smfmac_f32_16x16x64_bf16 v[36:39],v[60:63],v[200:207],v2
ds_read_b128 v[104:107],v58 offset:6144
s_waitcnt lgkmcnt(7)
v_smfmac_f32_16x16x64_bf16 v[24:27],v[64:67],v[216:223],v2
v_smfmac_f32_16x16x64_bf16 v[36:39],v[64:67],v[240:247],v2
ds_read_b128 v[108:111],v58 offset:7168
v_smfmac_f32_16x16x64_bf16 v[28:31],v[60:63],v[184:191],v2
v_smfmac_f32_16x16x64_bf16 v[40:43],v[60:63],v[208:215],v2
v_add_f32 v24,v24,v25
v_smfmac_f32_16x16x64_bf16 v[28:31],v[64:67],v[224:231],v2
v_add_f32 v26,v26,v27
v_smfmac_f32_16x16x64_bf16 v[40:43],v[64:67],v[248:255],v2
v_add_f32 v36,v36,v37
v_smfmac_f32_16x16x64_bf16 v[32:35],v[60:63],v[192:199],v2
v_add_f32 v38,v38,v39
s_waitcnt lgkmcnt(6)
v_smfmac_f32_16x16x64_bf16 v[44:47],v[60:63],v[72:79],v2
v_cvt_pk_bf16_f32 v37,v24,v26
v_smfmac_f32_16x16x64_bf16 v[32:35],v[64:67],v[232:239],v2
v_cvt_pk_bf16_f32 v36,v36,v38
s_waitcnt lgkmcnt(2)
v_smfmac_f32_16x16x64_bf16 v[44:47],v[64:67],v[80:87],v2
ds_write_b64 v6,v[36:37] offset:0
v_add_f32 v28,v28,v29
v_add_f32 v30,v30,v31
v_add_f32 v40,v40,v41
v_add_f32 v42,v42,v43
v_cvt_pk_bf16_f32 v41,v28,v30
v_cvt_pk_bf16_f32 v40,v40,v42
ds_write_b64 v6,v[40:41] offset:512
v_add_f32 v32,v32,v33
v_add_f32 v34,v34,v35
v_add_f32 v44,v44,v45
v_add_f32 v46,v46,v47
v_cvt_pk_bf16_f32 v45,v32,v34
v_cvt_pk_bf16_f32 v44,v44,v46
ds_write_b64 v6,v[44:45] offset:1024
ds_read_b128 v[72:75],v58 offset:8192
ds_read_b128 v[76:79],v58 offset:9216
s_waitcnt lgkmcnt(2)
s_barrier
ds_read_b64_tr_b16 v[24:25],v7 offset:0
ds_read_b64_tr_b16 v[26:27],v7 offset:512
ds_read_b64_tr_b16 v[28:29],v7 offset:1024
ds_read_b64_tr_b16 v[30:31],v7 offset:1536
ds_read_b64_tr_b16 v[32:33],v7 offset:2048
ds_read_b64_tr_b16 v[34:35],v7 offset:2560
ds_read_b64_tr_b16 v[36:37],v7 offset:3072
ds_read_b64_tr_b16 v[38:39],v7 offset:3584
s_waitcnt lgkmcnt(6)
v_mfma_f32_16x16x32_bf16 v[60:63],v[48:51],v[24:27],0
ds_read_b64_tr_b16 v[40:41],v7 offset:4096
v_mfma_f32_16x16x32_bf16 v[64:67],v[52:55],v[24:27],0
ds_read_b64_tr_b16 v[42:43],v7 offset:4608
v_mfma_f32_16x16x32_bf16 v[68:71],v[24:27],v[24:27],0
ds_read_b128 v[80:83],v58 offset:10240
s_waitcnt lgkmcnt(7)
v_mfma_f32_16x16x32_bf16 v[60:63],v[88:91],v[28:31],v[60:63]
ds_read_b128 v[84:87],v58 offset:11264
v_mfma_f32_16x16x32_bf16 v[64:67],v[92:95],v[28:31],v[64:67]
ds_read_b64_tr_b16 v[44:45],v7 offset:5120
v_mfma_f32_16x16x32_bf16 v[68:71],v[28:31],v[28:31],v[68:71]
ds_read_b64_tr_b16 v[46:47],v7 offset:5632
s_waitcnt lgkmcnt(8)
v_mfma_f32_16x16x32_bf16 v[60:63],v[96:99],v[32:35],v[60:63]
ds_read_b128 v[24:27],v17 offset:12288
v_mfma_f32_16x16x32_bf16 v[64:67],v[100:103],v[32:35],v[64:67]
ds_read_b128 v[28:31],v17 offset:13312
v_mfma_f32_16x16x32_bf16 v[68:71],v[32:35],v[32:35],v[68:71]
s_waitcnt lgkmcnt(8)
v_mfma_f32_16x16x32_bf16 v[60:63],v[104:107],v[36:39],v[60:63]
ds_read_b128 v[32:35],v17 offset:14336
v_mfma_f32_16x16x32_bf16 v[64:67],v[108:111],v[36:39],v[64:67]
v_mfma_f32_16x16x32_bf16 v[68:71],v[36:39],v[36:39],v[68:71]
s_waitcnt lgkmcnt(7)
v_mfma_f32_16x16x32_bf16 v[60:63],v[72:75],v[40:43],v[60:63]
ds_read_b128 v[36:39],v17 offset:15360
v_mfma_f32_16x16x32_bf16 v[64:67],v[76:79],v[40:43],v[64:67]
v_mfma_f32_16x16x32_bf16 v[68:71],v[40:43],v[40:43],v[68:71]
s_waitcnt lgkmcnt(4)
v_mfma_f32_16x16x32_bf16 v[60:63],v[80:83],v[44:47],v[60:63]
v_mfma_f32_16x16x32_bf16 v[64:67],v[84:87],v[44:47],v[64:67]
buffer_load_dwordx4 v[48:51],v1,s[8:11],s71 offen sc1
v_mfma_f32_16x16x32_bf16 v[68:71],v[44:47],v[44:47],v[68:71]
s_nop 4
v_cndmask_b32_dpp v60,v64,v60,vcc quad_perm:[2,3,2,3] row_mask:0xf bank_mask:0xf
v_cndmask_b32_dpp v61,v65,v61,vcc quad_perm:[2,3,2,3] row_mask:0xf bank_mask:0xf
v_cndmask_b32_dpp v62,v66,v62,vcc quad_perm:[2,3,2,3] row_mask:0xf bank_mask:0xf
v_cndmask_b32_dpp v63,v67,v63,vcc quad_perm:[2,3,2,3] row_mask:0xf bank_mask:0xf
v_max3_f32 v12,v60,v61,v62
v_cndmask_b32_dpp v68,v69,v68,vcc quad_perm:[2,3,2,3] row_mask:0xf bank_mask:0xf
v_max3_f32 v12,v12,v63,v68
s_nop 1
v_max_f32_dpp v13,v12,v12 quad_perm:[2,3,0,1] row_mask:0xf bank_mask:0xf
v_max_f32_dpp v12,v12,v12 quad_perm:[2,3,0,1] row_mask:0xf bank_mask:0xf
s_nop 1
v_permlane32_swap_b32 v12,v13
v_max_f32 v15,v12,v13
v_max_f32 v12,v12,v13
s_mov_b64 exec,1
buffer_store_dword v16,v1,s[8:11],s72 offen sc1
s_mov_b64 exec,-1
v_permlane16_swap_b32 v12,v15
v_max_f32 v12,v12,v15
v_mul_f32 v12,s87,v12
v_fma_f32 v60,v60,s87,-v12
v_fma_f32 v61,v61,s87,-v12
v_fma_f32 v62,v62,s87,-v12
v_fma_f32 v63,v63,s87,-v12
v_fma_f32 v68,v68,s87,-v12
v_exp_f32 v60,v60
v_exp_f32 v61,v61
v_exp_f32 v62,v62
v_exp_f32 v63,v63
v_exp_f32 v68,v68
v_cvt_pk_bf16_f32 v70,v60,v61
v_cvt_pk_bf16_f32 v71,v62,v63
v_cndmask_b32 v46,v70,v10,vcc
v_cndmask_b32 v47,v71,v10,vcc
v_cndmask_b32_dpp v44,v70,v10,vcc quad_perm:[2,3,0,1] row_mask:0xf bank_mask:0xf
v_cndmask_b32_dpp v45,v71,v10,vcc quad_perm:[2,3,0,1] row_mask:0xf bank_mask:0xf
s_mov_b64 vcc,s[90:91]
s_waitcnt lgkmcnt(0)
v_cndmask_b32 v40,v70,v10,vcc
v_mfma_f32_16x16x32_bf16 v[64:67],v[28:31],v[44:47],0
v_cndmask_b32 v41,v71,v10,vcc
v_cndmask_b32_dpp v42,v70,v10,vcc quad_perm:[2,3,0,1] row_mask:0xf bank_mask:0xf
v_mfma_f32_16x16x32_bf16 v[52:55],v[36:39],v[44:47],0
v_cndmask_b32_dpp v43,v71,v10,vcc quad_perm:[2,3,0,1] row_mask:0xf bank_mask:0xf
v_mov_b32_dpp v14,v68 quad_perm:[2,3,0,1] row_mask:0xf bank_mask:0xf
v_add_f32 v12,v60,v61
v_mfma_f32_16x16x32_bf16 v[64:67],v[24:27],v[40:43],v[64:67]
v_cvt_pk_bf16_f32 v56,v68,v14
v_cvt_pk_bf16_f32 v57,v14,v68
v_mfma_f32_16x16x32_bf16 v[52:55],v[32:35],v[40:43],v[52:55]
v_cndmask_b32 v56,v56,v10,vcc
v_cndmask_b32 v57,v10,v57,vcc
ds_read_b32 v0,v9
v_add_f32 v13,v62,v63
v_add_f32 v12,v12,v68
v_add_f32 v12,v12,v13
s_waitcnt vmcnt(1)
v_bitop3_b32 v17,v48,v50,s57 bitop3:0x7e
v_add_f32_dpp v13,v12,v12 quad_perm:[2,3,0,1] row_mask:0xf bank_mask:0xf
v_and_b32 v17,1,v17
v_add_f32_dpp v12,v12,v12 quad_perm:[2,3,0,1] row_mask:0xf bank_mask:0xf
v_cmp_ne_u32 vcc,0,v17
s_cbranch_vccnz vb_102
vo_103:
v_mfma_f32_16x16x16_bf16 v[64:67],v[48:49],v[56:57],v[64:67]
v_permlane32_swap_b32 v12,v13
v_add_f32 v15,v12,v13
v_mfma_f32_16x16x16_bf16 v[52:55],v[50:51],v[56:57],v[52:55]
v_add_f32 v12,v12,v13
s_nop 1
v_permlane16_swap_b32 v12,v15
v_add_f32 v12,v12,v15
v_rcp_f32 v12,v12
s_nop 0
v_mul_f32 v64,v64,v12
v_mul_f32 v65,v65,v12
v_mul_f32 v66,v66,v12
v_mul_f32 v67,v67,v12
v_mul_f32 v52,v52,v12
v_mul_f32 v53,v53,v12
v_mul_f32 v54,v54,v12
v_mul_f32 v55,v55,v12
v_cvt_pk_bf16_f32 v48,v64,v65
v_cvt_pk_bf16_f32 v49,v66,v67
v_cvt_pk_bf16_f32 v50,v52,v53
v_cvt_pk_bf16_f32 v51,v54,v55
v_and_or_b32 v48,v48,-2,s57
buffer_store_dwordx4 v[48:51],v8,s[8:11],s70 offen sc1
s_mov_b32 s57,s31
v_mov_b32 v12,s50
s_waitcnt lgkmcnt(0)
v_cmp_ne_u32 vcc,s50,v0
ds_write_b32 v20,v12
s_cmp_lt_u32 s50,128
s_cbranch_scc1 CS_LOOP_S
s_branch CS_DONE
fr_100:
v_bitop3_b32 v12,v72,v76,s57 bitop3:0x7e
v_bitop3_b32 v13,v80,v80,s57 bitop3:0x7e
v_xor_b32 v14,s57,v80
v_or3_b32 v12,v12,v13,v14
v_and_b32 v12,1,v12
v_cmp_ne_u32 vcc,0,v12
s_cbranch_vccz sk_104
buffer_load_dwordx2 v[80:81],v18,s[8:11],s59 offen sc1
buffer_load_dwordx4 v[72:75],v1,s[8:11],s59 offen sc1
buffer_load_dwordx4 v[76:79],v1,s[8:11],s59 offen offset:1024 sc1
sk_104:
buffer_load_dwordx2 v[90:91],v18,s[8:11],s68 offen sc1
buffer_load_dwordx4 v[82:85],v1,s[8:11],s68 offen sc1
buffer_load_dwordx4 v[86:89],v1,s[8:11],s68 offen offset:1024 sc1
s_sub_u32 s47,s47,1
s_cbranch_scc1 ABORT
s_waitcnt lgkmcnt(0)
s_branch fa_99
vb_102:
s_sub_u32 s47,s47,1
s_cbranch_scc1 ABORT
buffer_load_dwordx4 v[48:51],v1,s[8:11],s71 offen sc1
s_waitcnt vmcnt(0)
v_bitop3_b32 v17,v48,v50,s57 bitop3:0x7e
v_and_b32 v17,1,v17
v_cmp_ne_u32 vcc,0,v17
s_nop 0
s_cbranch_vccnz vb_102
s_branch vo_103
CH_START:
s_sub_u32 s60,s4,s5
s_cmp_gt_i32 s60,13
s_cselect_b32 s53,1,0
s_cmp_eq_u32 s4,64
s_cselect_b32 s53,1,s53
s_cmp_eq_u32 s53,0
s_cselect_b32 s54,s4,s5
s_addc_u32 s4,s4,0
s_add_u32 s5,s5,s53
s_sub_u32 s60,s4,s5
s_cmp_gt_i32 s60,13
s_cselect_b32 s55,1,0
s_cmp_eq_u32 s4,64
s_cselect_b32 s55,1,s55
s_cmp_eq_u32 s55,0
s_cselect_b32 s56,s4,s5
s_addc_u32 s4,s4,0
s_add_u32 s5,s5,s55
s_mov_b32 s74,81920
s_mul_i32 s73,s52,393216
s_add_u32 s73,s73,s84
s_lshl_b32 s75,s51,6
s_add_u32 s75,s75,s52
s_lshl_b32 s75,s75,9
s_add_u32 s75,s75,131072
fl_105:
buffer_load_dword v12,v9,s[8:11],s75 offen sc1
s_waitcnt vmcnt(0)
v_cmp_eq_u32 vcc,0,v12
s_nop 0
s_cbranch_vccz ok_106
s_sleep 1
s_sub_u32 s47,s47,1
s_cbranch_scc1 ABORT
s_branch fl_105
ok_106:
s_add_u32 m0,s74,0
s_add_u32 s67,s73,0
buffer_load_dwordx4 v1,s[8:11],s67 offen sc1 lds
buffer_load_dwordx4 v1,s[8:11],s67 offen offset:1024 sc1 lds
buffer_load_dwordx4 v1,s[8:11],s67 offen offset:2048 sc1 lds
buffer_load_dwordx4 v1,s[8:11],s67 offen offset:3072 sc1 lds
s_add_u32 m0,s74,4096
s_add_u32 s67,s73,4096
buffer_load_dwordx4 v1,s[8:11],s67 offen sc1 lds
buffer_load_dwordx4 v1,s[8:11],s67 offen offset:1024 sc1 lds
buffer_load_dwordx4 v1,s[8:11],s67 offen offset:2048 sc1 lds
buffer_load_dwordx4 v1,s[8:11],s67 offen offset:3072 sc1 lds
s_add_u32 m0,s74,8192
s_add_u32 s67,s73,8192
buffer_load_dwordx4 v1,s[8:11],s67 offen sc1 lds
buffer_load_dwordx4 v1,s[8:11],s67 offen offset:1024 sc1 lds
buffer_load_dwordx4 v1,s[8:11],s67 offen offset:2048 sc1 lds
buffer_load_dwordx4 v1,s[8:11],s67 offen offset:3072 sc1 lds
s_add_u32 m0,s74,12288
s_add_u32 s67,s73,25165824
buffer_load_dwordx4 v1,s[8:11],s67 offen sc1 lds
buffer_load_dwordx4 v1,s[8:11],s67 offen offset:1024 sc1 lds
buffer_load_dwordx4 v1,s[8:11],s67 offen offset:2048 sc1 lds
buffer_load_dwordx4 v1,s[8:11],s67 offen offset:3072 sc1 lds
s_add_u32 m0,s74,16384
s_add_u32 s67,s73,25169920
buffer_load_dwordx4 v1,s[8:11],s67 offen sc1 lds
buffer_load_dwordx4 v1,s[8:11],s67 offen offset:1024 sc1 lds
buffer_load_dwordx4 v1,s[8:11],s67 offen offset:2048 sc1 lds
buffer_load_dwordx4 v1,s[8:11],s67 offen offset:3072 sc1 lds
s_add_u32 m0,s74,20480
s_add_u32 s67,s73,25174016
buffer_load_dwordx4 v1,s[8:11],s67 offen sc1 lds
buffer_load_dwordx4 v1,s[8:11],s67 offen offset:1024 sc1 lds
buffer_load_dwordx4 v1,s[8:11],s67 offen offset:2048 sc1 lds
buffer_load_dwordx4 v1,s[8:11],s67 offen offset:3072 sc1 lds
s_mov_b32 s74,106496
s_mul_i32 s73,s54,393216
s_add_u32 s73,s73,s84
s_lshl_b32 s75,s53,6
s_add_u32 s75,s75,s54
s_lshl_b32 s75,s75,9
s_add_u32 s75,s75,131072
s_lshl_b32 s76,s55,6
s_add_u32 s76,s76,s56
s_lshl_b32 s76,s76,9
s_add_u32 s76,s76,131072
s_mov_b32 s77,1
v_min_u32 v8,2,v0
v_lshlrev_b32 v8,2,v8
v_add_u32 v8,147456,v8
v_mov_b32 v58,147468
s_mov_b32 s80,0
v_mov_b32 v24,0
v_mov_b32 v25,0
v_mov_b32 v26,0
v_mov_b32 v27,0
v_mov_b32 v28,0
v_mov_b32 v29,0
v_mov_b32 v30,0
v_mov_b32 v31,0
v_mov_b32 v32,0
v_mov_b32 v33,0
v_mov_b32 v34,0
v_mov_b32 v35,0
v_mov_b32 v36,0
v_mov_b32 v37,0
v_mov_b32 v38,0
v_mov_b32 v39,0
v_mov_b32 v40,0
v_mov_b32 v41,0
v_mov_b32 v42,0
v_mov_b32 v43,0
v_mov_b32 v44,0
v_mov_b32 v45,0
v_mov_b32 v46,0
v_mov_b32 v47,0
s_nop 1
CH_LOOP:
v_mov_b32 v14,s50
s_nop 1
db_110:
buffer_load_dword v12,v11,s[8:11],s69 offen sc1
s_waitcnt vmcnt(0)
v_cmp_gt_u32 vcc,s58,v12
s_cbranch_vccz dbok_111
s_sub_u32 s47,s47,1
s_cbranch_scc1 ABORT
s_branch db_110
dbok_111:
ds_write_b32 v58,v14
buffer_load_dwordx2 v[68:69],v18,s[8:11],s59 offen sc1
buffer_load_dwordx4 v[60:63],v1,s[8:11],s59 offen sc1
buffer_load_dwordx4 v[64:67],v1,s[8:11],s59 offen offset:1024 sc1
s_barrier
s_waitcnt vmcnt(2)
s_sleep 3
fj_109f:
buffer_load_dwordx2 v[78:79],v18,s[8:11],s68 offen sc1
buffer_load_dwordx4 v[70:73],v1,s[8:11],s68 offen sc1
buffer_load_dwordx4 v[74:77],v1,s[8:11],s68 offen offset:1024 sc1
s_mov_b64 vcc,s[90:91]
ds_read_b64_tr_b16 v[100:101],v7 offset:0
ds_read_b64_tr_b16 v[102:103],v7 offset:512
ds_read_b64_tr_b16 v[48:49],v7 offset:1024
ds_read_b64_tr_b16 v[50:51],v7 offset:1536
ds_read_b64_tr_b16 v[104:105],v7 offset:2048
ds_read_b64_tr_b16 v[106:107],v7 offset:2560
ds_read_b64_tr_b16 v[52:53],v7 offset:3072
ds_read_b64_tr_b16 v[54:55],v7 offset:3584
ds_read_b64_tr_b16 v[108:109],v7 offset:4096
ds_read_b64_tr_b16 v[110:111],v7 offset:4608
ds_read_b64_tr_b16 v[12:13],v7 offset:5120
ds_read_b64_tr_b16 v[14:15],v7 offset:5632
s_waitcnt lgkmcnt(8)
v_cndmask_b32_dpp v100,v48,v100,vcc quad_perm:[0,1,0,1] row_mask:0xf bank_mask:0xf
v_cndmask_b32_dpp v101,v49,v101,vcc quad_perm:[0,1,0,1] row_mask:0xf bank_mask:0xf
v_cndmask_b32_dpp v102,v50,v102,vcc quad_perm:[0,1,0,1] row_mask:0xf bank_mask:0xf
v_cndmask_b32_dpp v103,v51,v103,vcc quad_perm:[0,1,0,1] row_mask:0xf bank_mask:0xf
s_waitcnt lgkmcnt(4)
v_cndmask_b32_dpp v104,v52,v104,vcc quad_perm:[0,1,0,1] row_mask:0xf bank_mask:0xf
v_cndmask_b32_dpp v105,v53,v105,vcc quad_perm:[0,1,0,1] row_mask:0xf bank_mask:0xf
v_cndmask_b32_dpp v106,v54,v106,vcc quad_perm:[0,1,0,1] row_mask:0xf bank_mask:0xf
v_cndmask_b32_dpp v107,v55,v107,vcc quad_perm:[0,1,0,1] row_mask:0xf bank_mask:0xf
s_waitcnt lgkmcnt(0)
v_cndmask_b32_dpp v108,v12,v108,vcc quad_perm:[0,1,0,1] row_mask:0xf bank_mask:0xf
v_cndmask_b32_dpp v109,v13,v109,vcc quad_perm:[0,1,0,1] row_mask:0xf bank_mask:0xf
v_cndmask_b32_dpp v110,v14,v110,vcc quad_perm:[0,1,0,1] row_mask:0xf bank_mask:0xf
v_cndmask_b32_dpp v111,v15,v111,vcc quad_perm:[0,1,0,1] row_mask:0xf bank_mask:0xf
fj_109:
fa_107:
s_waitcnt vmcnt(5)
v_lshlrev_b32 v96,16,v68
v_and_b32 v97,0xffff0000,v68
v_lshlrev_b32 v98,16,v69
v_and_b32 v99,0xffff0000,v69
s_waitcnt vmcnt(4)
v_lshlrev_b32 v80,16,v60
v_and_b32 v81,0xffff0000,v60
v_lshlrev_b32 v82,16,v61
v_and_b32 v83,0xffff0000,v61
v_lshlrev_b32 v84,16,v62
v_and_b32 v85,0xffff0000,v62
v_lshlrev_b32 v86,16,v63
v_and_b32 v87,0xffff0000,v63
s_waitcnt vmcnt(3)
v_lshlrev_b32 v88,16,v64
v_and_b32 v89,0xffff0000,v64
v_lshlrev_b32 v90,16,v65
v_and_b32 v91,0xffff0000,v65
v_lshlrev_b32 v92,16,v66
v_and_b32 v93,0xffff0000,v66
v_lshlrev_b32 v94,16,v67
v_and_b32 v95,0xffff0000,v67
s_waitcnt vmcnt(2)
v_dot2c_f32_bf16 v96,s37,v78
v_dot2c_f32_bf16 v97,s81,v78
v_dot2c_f32_bf16 v98,s37,v79
v_dot2c_f32_bf16 v99,s81,v79
v_bitop3_b32 v16,v68,v78,s57 bitop3:0x7e
v_cvt_pk_bf16_f32 v56,v96,v97
s_nop 0
v_cvt_pk_bf16_f32 v57,v98,v99
ds_write_b64 v23,v[56:57]
s_waitcnt vmcnt(1)
v_dot2c_f32_bf16 v80,s37,v70
v_dot2c_f32_bf16 v81,s81,v70
v_dot2c_f32_bf16 v82,s37,v71
v_dot2c_f32_bf16 v83,s81,v71
v_dot2c_f32_bf16 v84,s37,v72
v_dot2c_f32_bf16 v85,s81,v72
v_dot2c_f32_bf16 v86,s37,v73
v_dot2c_f32_bf16 v87,s81,v73
v_bitop3_b32 v17,v60,v70,s57 bitop3:0x7e
v_or_b32 v16,v16,v17
v_cvt_pk_bf16_f32 v48,v80,v81
v_cvt_pk_bf16_f32 v49,v82,v83
v_cvt_pk_bf16_f32 v50,v84,v85
v_cvt_pk_bf16_f32 v51,v86,v87
ds_write_b128 v22,v[48:51] offset:0
s_waitcnt vmcnt(0)
v_dot2c_f32_bf16 v88,s37,v74
v_dot2c_f32_bf16 v89,s81,v74
v_dot2c_f32_bf16 v90,s37,v75
v_dot2c_f32_bf16 v91,s81,v75
v_dot2c_f32_bf16 v92,s37,v76
v_dot2c_f32_bf16 v93,s81,v76
v_dot2c_f32_bf16 v94,s37,v77
v_dot2c_f32_bf16 v95,s81,v77
v_bitop3_b32 v17,v64,v74,s57 bitop3:0x7e
v_bitop3_b32 v16,v16,v17,1 bitop3:0xa8
v_cmp_ne_u32 vcc,0,v16
v_cvt_pk_bf16_f32 v52,v88,v89
v_cvt_pk_bf16_f32 v53,v90,v91
v_cvt_pk_bf16_f32 v54,v92,v93
v_cvt_pk_bf16_f32 v55,v94,v95
ds_write_b128 v22,v[52:55] offset:1024
s_cbranch_vccnz fr_108
fj_109g:
v_smfmac_f32_16x16x64_bf16 v[24:27],v[48:51],a[0:7],v2
ds_read_b128 v[72:75],v21 offset:0
s_and_b32 s60,s54,1
v_smfmac_f32_16x16x64_bf16 v[28:31],v[48:51],a[8:15],v2
ds_read_b128 v[76:79],v21 offset:1024
s_lshl2_add_u32 s60,s53,s60
v_smfmac_f32_16x16x64_bf16 v[32:35],v[48:51],a[16:23],v2
ds_read_b128 v[80:83],v21 offset:2048
s_lshl_b32 s68,s60,16
v_smfmac_f32_16x16x64_bf16 v[36:39],v[48:51],a[24:31],v2
ds_read_b128 v[84:87],v21 offset:3072
s_add_u32 s68,s68,s83
s_waitcnt lgkmcnt(4)
s_barrier
v_smfmac_f32_16x16x64_bf16 v[40:43],v[48:51],a[32:39],v2
ds_read_b128 v[60:63],v3 offset:0
s_mul_i32 s59,s60,20480
v_smfmac_f32_16x16x64_bf16 v[24:27],v[52:55],a[40:47],v2
ds_read_b128 v[64:67],v3 offset:1024
s_add_u32 s59,s59,s6
v_smfmac_f32_16x16x64_bf16 v[28:31],v[52:55],a[48:55],v2
ds_read_b128 v[68:71],v4 offset:0
s_lshl_b32 s69,s53,9
v_smfmac_f32_16x16x64_bf16 v[32:35],v[52:55],a[56:63],v2
s_add_u32 m0,s74,12288
s_add_u32 s67,s73,25165824
s_add_u32 s69,s69,s7
v_smfmac_f32_16x16x64_bf16 v[36:39],v[52:55],a[64:71],v2
buffer_load_dwordx4 v1,s[8:11],s67 offen sc1 lds
s_bfe_u32 s31,s54,65537
v_smfmac_f32_16x16x64_bf16 v[40:43],v[52:55],a[72:79],v2
buffer_load_dwordx4 v1,s[8:11],s67 offen offset:1024 sc1 lds
s_waitcnt lgkmcnt(5)
v_smfmac_f32_16x16x64_bf16 v[44:47],v[48:51],v[72:79],v2
ds_read_b128 v[72:75],v21 offset:4096
s_waitcnt lgkmcnt(4)
v_smfmac_f32_16x16x64_bf16 v[44:47],v[52:55],v[80:87],v2
ds_read_b128 v[76:79],v21 offset:5120
s_waitcnt lgkmcnt(4)
v_smfmac_f32_16x16x64_bf16 v[24:27],v[60:63],a[80:87],v2
ds_read_b128 v[80:83],v21 offset:6144
s_add_u32 s32,s54,1
v_smfmac_f32_16x16x64_bf16 v[28:31],v[60:63],a[88:95],v2
ds_read_b128 v[84:87],v21 offset:7168
v_smfmac_f32_16x16x64_bf16 v[32:35],v[60:63],a[96:103],v2
buffer_load_dwordx4 v1,s[8:11],s67 offen offset:2048 sc1 lds
v_smfmac_f32_16x16x64_bf16 v[36:39],v[60:63],a[104:111],v2
buffer_load_dwordx4 v1,s[8:11],s67 offen offset:3072 sc1 lds
v_smfmac_f32_16x16x64_bf16 v[40:43],v[60:63],a[112:119],v2
s_add_u32 m0,s74,16384
s_add_u32 s67,s73,25169920
s_waitcnt lgkmcnt(2)
v_smfmac_f32_16x16x64_bf16 v[44:47],v[60:63],v[72:79],v2
ds_read_b128 v[60:63],v4 offset:1024
v_smfmac_f32_16x16x64_bf16 v[24:27],v[64:67],a[120:127],v2
ds_read_b128 v[72:75],v21 offset:8192
v_smfmac_f32_16x16x64_bf16 v[28:31],v[64:67],a[128:135],v2
ds_read_b128 v[76:79],v21 offset:9216
v_smfmac_f32_16x16x64_bf16 v[32:35],v[64:67],a[136:143],v2
v_mov_b32 v17,1
buffer_load_dwordx4 v1,s[8:11],s67 offen sc1 lds
v_smfmac_f32_16x16x64_bf16 v[36:39],v[64:67],a[144:151],v2
s_mov_b64 exec,1
buffer_store_dword v17,v1,s[8:11],s79 offen sc1
s_mov_b64 exec,-1
v_smfmac_f32_16x16x64_bf16 v[40:43],v[64:67],a[152:159],v2
buffer_store_dwordx4 v[100:103],v20,s[8:11],s78 offen sc1
s_waitcnt lgkmcnt(3)
v_smfmac_f32_16x16x64_bf16 v[44:47],v[64:67],v[80:87],v2
ds_read_b128 v[64:67],v5 offset:0
v_smfmac_f32_16x16x64_bf16 v[24:27],v[68:71],a[160:167],v2
ds_read_b128 v[80:83],v21 offset:10240
v_smfmac_f32_16x16x64_bf16 v[28:31],v[68:71],a[168:175],v2
ds_read_b128 v[84:87],v21 offset:11264
v_smfmac_f32_16x16x64_bf16 v[32:35],v[68:71],a[176:183],v2
buffer_store_dwordx4 v[104:107],v20,s[8:11],s78 offen offset:1024 sc1
v_smfmac_f32_16x16x64_bf16 v[36:39],v[68:71],a[184:191],v2
buffer_store_dwordx4 v[108:111],v20,s[8:11],s78 offen offset:2048 sc1
s_and_b32 s79,s78,2147483648
v_smfmac_f32_16x16x64_bf16 v[40:43],v[68:71],a[192:199],v2
s_or_b32 s79,s79,s30
s_mov_b32 s78,2147483648
s_waitcnt lgkmcnt(3)
v_smfmac_f32_16x16x64_bf16 v[44:47],v[68:71],v[72:79],v2
ds_read_b128 v[68:71],v5 offset:1024
v_smfmac_f32_16x16x64_bf16 v[24:27],v[60:63],a[200:207],v2
ds_read_b128 v[72:75],v21 offset:12288
v_smfmac_f32_16x16x64_bf16 v[28:31],v[60:63],a[208:215],v2
ds_read_b128 v[76:79],v21 offset:13312
v_smfmac_f32_16x16x64_bf16 v[32:35],v[60:63],a[216:223],v2
buffer_load_dword v10,v9,s[8:11],s76 offen sc1
v_smfmac_f32_16x16x64_bf16 v[36:39],v[60:63],a[224:231],v2
buffer_load_dwordx4 v1,s[8:11],s67 offen offset:1024 sc1 lds
v_smfmac_f32_16x16x64_bf16 v[40:43],v[60:63],a[232:239],v2
buffer_load_dwordx4 v1,s[8:11],s67 offen offset:2048 sc1 lds
s_waitcnt lgkmcnt(3)
v_smfmac_f32_16x16x64_bf16 v[44:47],v[60:63],v[80:87],v2
ds_read_b128 v[60:63],v59 offset:0
v_smfmac_f32_16x16x64_bf16 v[24:27],v[64:67],a[240:247],v2
ds_read_b128 v[80:83],v21 offset:14336
v_smfmac_f32_16x16x64_bf16 v[28:31],v[64:67],a[248:255],v2
ds_read_b128 v[84:87],v21 offset:15360
v_smfmac_f32_16x16x64_bf16 v[32:35],v[64:67],v[112:119],v2
buffer_load_dwordx4 v1,s[8:11],s67 offen offset:3072 sc1 lds
v_smfmac_f32_16x16x64_bf16 v[36:39],v[64:67],v[120:127],v2
s_add_u32 m0,s74,20480
s_add_u32 s67,s73,25174016
v_smfmac_f32_16x16x64_bf16 v[40:43],v[64:67],v[128:135],v2
buffer_load_dwordx4 v1,s[8:11],s67 offen sc1 lds
s_waitcnt lgkmcnt(3)
v_smfmac_f32_16x16x64_bf16 v[44:47],v[64:67],v[72:79],v2
ds_read_b128 v[64:67],v59 offset:1024
v_smfmac_f32_16x16x64_bf16 v[24:27],v[68:71],v[136:143],v2
ds_read_b128 v[72:75],v21 offset:16384
v_smfmac_f32_16x16x64_bf16 v[28:31],v[68:71],v[144:151],v2
ds_read_b128 v[76:79],v21 offset:17408
v_smfmac_f32_16x16x64_bf16 v[32:35],v[68:71],v[152:159],v2
buffer_load_dwordx4 v1,s[8:11],s67 offen offset:1024 sc1 lds
v_smfmac_f32_16x16x64_bf16 v[36:39],v[68:71],v[160:167],v2
buffer_load_dwordx4 v1,s[8:11],s67 offen offset:2048 sc1 lds
v_smfmac_f32_16x16x64_bf16 v[40:43],v[68:71],v[168:175],v2
buffer_load_dwordx4 v1,s[8:11],s67 offen offset:3072 sc1 lds
s_waitcnt lgkmcnt(3)
v_smfmac_f32_16x16x64_bf16 v[44:47],v[68:71],v[80:87],v2
ds_read_b128 v[80:83],v21 offset:18432
v_smfmac_f32_16x16x64_bf16 v[24:27],v[60:63],v[176:183],v2
ds_read_b128 v[84:87],v21 offset:19456
v_smfmac_f32_16x16x64_bf16 v[36:39],v[60:63],v[200:207],v2
s_waitcnt lgkmcnt(4)
v_smfmac_f32_16x16x64_bf16 v[24:27],v[64:67],v[216:223],v2
v_smfmac_f32_16x16x64_bf16 v[36:39],v[64:67],v[240:247],v2
v_smfmac_f32_16x16x64_bf16 v[28:31],v[60:63],v[184:191],v2
v_smfmac_f32_16x16x64_bf16 v[40:43],v[60:63],v[208:215],v2
v_add_f32 v24,v24,v25
v_smfmac_f32_16x16x64_bf16 v[28:31],v[64:67],v[224:231],v2
v_add_f32 v26,v26,v27
v_smfmac_f32_16x16x64_bf16 v[40:43],v[64:67],v[248:255],v2
v_add_f32 v36,v36,v37
v_smfmac_f32_16x16x64_bf16 v[32:35],v[60:63],v[192:199],v2
v_add_f32 v38,v38,v39
s_waitcnt lgkmcnt(2)
v_smfmac_f32_16x16x64_bf16 v[44:47],v[60:63],v[72:79],v2
v_cvt_pk_bf16_f32 v37,v24,v26
v_smfmac_f32_16x16x64_bf16 v[32:35],v[64:67],v[232:239],v2
v_cvt_pk_bf16_f32 v36,v36,v38
s_waitcnt lgkmcnt(0)
v_smfmac_f32_16x16x64_bf16 v[44:47],v[64:67],v[80:87],v2
ds_write_b64 v6,v[36:37] offset:0
v_add_f32 v28,v28,v29
v_add_f32 v30,v30,v31
v_add_f32 v40,v40,v41
v_add_f32 v42,v42,v43
v_cvt_pk_bf16_f32 v41,v28,v30
v_cvt_pk_bf16_f32 v40,v40,v42
ds_write_b64 v6,v[40:41] offset:512
v_add_f32 v32,v32,v33
v_add_f32 v34,v34,v35
v_add_f32 v44,v44,v45
v_add_f32 v46,v46,v47
v_cvt_pk_bf16_f32 v45,v32,v34
v_cvt_pk_bf16_f32 v44,v44,v46
ds_write_b64 v6,v[44:45] offset:1024
s_waitcnt lgkmcnt(0)
s_barrier
buffer_load_dword v16,v11,s[8:11],s69 offen sc1
s_lshl_b32 s60,s51,6
s_add_u32 s60,s60,s52
s_mul_i32 s78,s60,196608
s_add_u32 s78,s78,s85
s_lshl_b32 s60,s60,10
s_add_u32 s30,s60,s86
s_cmp_ge_u32 s54,63
s_cselect_b32 s77,0,s77
s_cmp_eq_u32 s53,s51
s_cselect_b32 s60,1,s77
s_cmp_eq_u32 s60,0
s_cbranch_scc0 h1_112
h2_113:
s_add_u32 s50,s50,1
s_mov_b32 s51,s53
s_mov_b32 s52,s54
s_mov_b32 s57,s31
s_mov_b32 s58,s32
s_mov_b32 s53,s55
s_mov_b32 s54,s56
s_mov_b32 s75,s76
s_sub_u32 s60,s4,s5
s_cmp_gt_i32 s60,13
s_cselect_b32 s55,1,0
s_cmp_eq_u32 s4,64
s_cselect_b32 s55,1,s55
s_cmp_eq_u32 s55,0
s_cselect_b32 s56,s4,s5
s_addc_u32 s4,s4,0
s_add_u32 s5,s5,s55
s_lshl_b32 s76,s55,6
s_add_u32 s76,s76,s56
s_lshl_b32 s76,s76,9
s_add_u32 s76,s76,131072
s_mul_i32 s73,s54,393216
s_add_u32 s73,s73,s84
s_xor_b32 s74,s74,57344
v_mov_b32 v24,0
v_mov_b32 v25,0
v_mov_b32 v26,0
v_mov_b32 v27,0
v_mov_b32 v28,0
v_mov_b32 v29,0
v_mov_b32 v30,0
v_mov_b32 v31,0
v_mov_b32 v32,0
v_mov_b32 v33,0
v_mov_b32 v34,0
v_mov_b32 v35,0
v_mov_b32 v36,0
v_mov_b32 v37,0
v_mov_b32 v38,0
v_mov_b32 v39,0
v_mov_b32 v40,0
v_mov_b32 v41,0
v_mov_b32 v42,0
v_mov_b32 v43,0
v_mov_b32 v44,0
v_mov_b32 v45,0
v_mov_b32 v46,0
v_mov_b32 v47,0
s_waitcnt vmcnt(0)
v_cmp_eq_u32 vcc,0,v10
s_cmp_lg_u64 vcc,0
s_cselect_b32 s77,1,0
v_cmp_gt_u32 vcc,s58,v16
s_nop 0
s_cbranch_vccz CH_RUNG
s_cmp_lt_u32 s50,128
s_cbranch_scc1 CH_LOOP
s_branch CS_DONE
h1_112:
s_mov_b64 vcc,s[90:91]
ds_read_b64_tr_b16 v[100:101],v7 offset:0
ds_read_b64_tr_b16 v[102:103],v7 offset:512
ds_read_b64_tr_b16 v[48:49],v7 offset:1024
ds_read_b64_tr_b16 v[50:51],v7 offset:1536
ds_read_b64_tr_b16 v[104:105],v7 offset:2048
ds_read_b64_tr_b16 v[106:107],v7 offset:2560
ds_read_b64_tr_b16 v[52:53],v7 offset:3072
ds_read_b64_tr_b16 v[54:55],v7 offset:3584
ds_read_b64_tr_b16 v[108:109],v7 offset:4096
ds_read_b64_tr_b16 v[110:111],v7 offset:4608
ds_read_b64_tr_b16 v[12:13],v7 offset:5120
ds_read_b64_tr_b16 v[14:15],v7 offset:5632
s_waitcnt lgkmcnt(8)
v_cndmask_b32_dpp v100,v48,v100,vcc quad_perm:[0,1,0,1] row_mask:0xf bank_mask:0xf
v_cndmask_b32_dpp v101,v49,v101,vcc quad_perm:[0,1,0,1] row_mask:0xf bank_mask:0xf
v_cndmask_b32_dpp v102,v50,v102,vcc quad_perm:[0,1,0,1] row_mask:0xf bank_mask:0xf
v_cndmask_b32_dpp v103,v51,v103,vcc quad_perm:[0,1,0,1] row_mask:0xf bank_mask:0xf
s_waitcnt lgkmcnt(4)
v_cndmask_b32_dpp v104,v52,v104,vcc quad_perm:[0,1,0,1] row_mask:0xf bank_mask:0xf
v_cndmask_b32_dpp v105,v53,v105,vcc quad_perm:[0,1,0,1] row_mask:0xf bank_mask:0xf
v_cndmask_b32_dpp v106,v54,v106,vcc quad_perm:[0,1,0,1] row_mask:0xf bank_mask:0xf
v_cndmask_b32_dpp v107,v55,v107,vcc quad_perm:[0,1,0,1] row_mask:0xf bank_mask:0xf
s_waitcnt lgkmcnt(0)
v_cndmask_b32_dpp v108,v12,v108,vcc quad_perm:[0,1,0,1] row_mask:0xf bank_mask:0xf
v_cndmask_b32_dpp v109,v13,v109,vcc quad_perm:[0,1,0,1] row_mask:0xf bank_mask:0xf
v_cndmask_b32_dpp v110,v14,v110,vcc quad_perm:[0,1,0,1] row_mask:0xf bank_mask:0xf
v_cndmask_b32_dpp v111,v15,v111,vcc quad_perm:[0,1,0,1] row_mask:0xf bank_mask:0xf
s_cmp_eq_u32 s50,127
s_cbranch_scc1 sp_114x
sp_114:
ds_read_b32 v12,v8
s_waitcnt lgkmcnt(0)
v_cmp_ge_u32 vcc,s50,v12
s_nop 0
s_cbranch_vccz ok_115
s_sleep 1
s_sub_u32 s47,s47,1
s_cbranch_scc1 ABORT
s_branch sp_114
ok_115:
sp_114x:
s_waitcnt vmcnt(0)
s_cmp_ge_u32 s79,2147483648
s_cbranch_scc1 pf_116
v_mov_b32 v17,1
s_mov_b64 exec,1
buffer_store_dword v17,v1,s[8:11],s79 offen sc1
s_mov_b64 exec,-1
s_mov_b32 s79,2147483648
pf_116:
s_cmp_eq_u32 s78,2147483648
s_cbranch_scc1 pk_117
buffer_store_dwordx4 v[100:103],v20,s[8:11],s78 offen sc1
buffer_store_dwordx4 v[104:107],v20,s[8:11],s78 offen offset:1024 sc1
buffer_store_dwordx4 v[108:111],v20,s[8:11],s78 offen offset:2048 sc1
s_mov_b32 s79,s30
s_mov_b32 s78,2147483648
pk_117:
s_waitcnt vmcnt(0)
s_cmp_ge_u32 s79,2147483648
s_cbranch_scc1 pf_118
v_mov_b32 v17,1
s_mov_b64 exec,1
buffer_store_dword v17,v1,s[8:11],s79 offen sc1
s_mov_b64 exec,-1
s_mov_b32 s79,2147483648
pf_118:
s_cmp_eq_u32 s77,0
s_cbranch_scc1 h2_113
fl_119:
buffer_load_dword v12,v9,s[8:11],s75 offen sc1
s_waitcnt vmcnt(0)
v_cmp_eq_u32 vcc,0,v12
s_nop 0
s_cbranch_vccz ok_120
s_sleep 1
s_sub_u32 s47,s47,1
s_cbranch_scc1 ABORT
s_branch fl_119
ok_120:
s_add_u32 m0,s74,0
s_add_u32 s67,s73,0
buffer_load_dwordx4 v1,s[8:11],s67 offen sc1 lds
buffer_load_dwordx4 v1,s[8:11],s67 offen offset:1024 sc1 lds
buffer_load_dwordx4 v1,s[8:11],s67 offen offset:2048 sc1 lds
buffer_load_dwordx4 v1,s[8:11],s67 offen offset:3072 sc1 lds
s_add_u32 m0,s74,4096
s_add_u32 s67,s73,4096
buffer_load_dwordx4 v1,s[8:11],s67 offen sc1 lds
buffer_load_dwordx4 v1,s[8:11],s67 offen offset:1024 sc1 lds
buffer_load_dwordx4 v1,s[8:11],s67 offen offset:2048 sc1 lds
buffer_load_dwordx4 v1,s[8:11],s67 offen offset:3072 sc1 lds
s_add_u32 m0,s74,8192
s_add_u32 s67,s73,8192
buffer_load_dwordx4 v1,s[8:11],s67 offen sc1 lds
buffer_load_dwordx4 v1,s[8:11],s67 offen offset:1024 sc1 lds
buffer_load_dwordx4 v1,s[8:11],s67 offen offset:2048 sc1 lds
buffer_load_dwordx4 v1,s[8:11],s67 offen offset:3072 sc1 lds
s_add_u32 m0,s74,12288
s_add_u32 s67,s73,25165824
buffer_load_dwordx4 v1,s[8:11],s67 offen sc1 lds
buffer_load_dwordx4 v1,s[8:11],s67 offen offset:1024 sc1 lds
buffer_load_dwordx4 v1,s[8:11],s67 offen offset:2048 sc1 lds
buffer_load_dwordx4 v1,s[8:11],s67 offen offset:3072 sc1 lds
s_add_u32 m0,s74,16384
s_add_u32 s67,s73,25169920
buffer_load_dwordx4 v1,s[8:11],s67 offen sc1 lds
buffer_load_dwordx4 v1,s[8:11],s67 offen offset:1024 sc1 lds
buffer_load_dwordx4 v1,s[8:11],s67 offen offset:2048 sc1 lds
buffer_load_dwordx4 v1,s[8:11],s67 offen offset:3072 sc1 lds
s_add_u32 m0,s74,20480
s_add_u32 s67,s73,25174016
buffer_load_dwordx4 v1,s[8:11],s67 offen sc1 lds
buffer_load_dwordx4 v1,s[8:11],s67 offen offset:1024 sc1 lds
buffer_load_dwordx4 v1,s[8:11],s67 offen offset:2048 sc1 lds
buffer_load_dwordx4 v1,s[8:11],s67 offen offset:3072 sc1 lds
s_branch h2_113
fr_108:
v_bitop3_b32 v12,v60,v64,s57 bitop3:0x7e
v_bitop3_b32 v13,v68,v68,s57 bitop3:0x7e
v_xor_b32 v14,s57,v68
v_or3_b32 v12,v12,v13,v14
v_and_b32 v12,1,v12
v_cmp_ne_u32 vcc,0,v12
s_cbranch_vccz sk_121
buffer_load_dwordx2 v[68:69],v18,s[8:11],s59 offen sc1
buffer_load_dwordx4 v[60:63],v1,s[8:11],s59 offen sc1
buffer_load_dwordx4 v[64:67],v1,s[8:11],s59 offen offset:1024 sc1
sk_121:
buffer_load_dwordx2 v[78:79],v18,s[8:11],s68 offen sc1
buffer_load_dwordx4 v[70:73],v1,s[8:11],s68 offen sc1
buffer_load_dwordx4 v[74:77],v1,s[8:11],s68 offen offset:1024 sc1
s_sub_u32 s47,s47,1
s_cbranch_scc1 ABORT
s_waitcnt lgkmcnt(0)
s_branch fa_107
CH_RUNG:
v_mov_b32 v14,s50
ds_write_b32 v58,v14
buffer_load_dwordx2 v[68:69],v18,s[8:11],s59 offen sc1
buffer_load_dwordx4 v[60:63],v1,s[8:11],s59 offen sc1
buffer_load_dwordx4 v[64:67],v1,s[8:11],s59 offen offset:1024 sc1
fj_109e:
buffer_load_dwordx2 v[78:79],v18,s[8:11],s68 offen sc1
buffer_load_dwordx4 v[70:73],v1,s[8:11],s68 offen sc1
buffer_load_dwordx4 v[74:77],v1,s[8:11],s68 offen offset:1024 sc1
s_mov_b64 vcc,s[90:91]
ds_read_b64_tr_b16 v[100:101],v7 offset:0
ds_read_b64_tr_b16 v[102:103],v7 offset:512
ds_read_b64_tr_b16 v[48:49],v7 offset:1024
ds_read_b64_tr_b16 v[50:51],v7 offset:1536
ds_read_b64_tr_b16 v[104:105],v7 offset:2048
ds_read_b64_tr_b16 v[106:107],v7 offset:2560
ds_read_b64_tr_b16 v[52:53],v7 offset:3072
ds_read_b64_tr_b16 v[54:55],v7 offset:3584
ds_read_b64_tr_b16 v[108:109],v7 offset:4096
ds_read_b64_tr_b16 v[110:111],v7 offset:4608
ds_read_b64_tr_b16 v[12:13],v7 offset:5120
ds_read_b64_tr_b16 v[14:15],v7 offset:5632
s_waitcnt lgkmcnt(8)
v_cndmask_b32_dpp v100,v48,v100,vcc quad_perm:[0,1,0,1] row_mask:0xf bank_mask:0xf
v_cndmask_b32_dpp v101,v49,v101,vcc quad_perm:[0,1,0,1] row_mask:0xf bank_mask:0xf
v_cndmask_b32_dpp v102,v50,v102,vcc quad_perm:[0,1,0,1] row_mask:0xf bank_mask:0xf
v_cndmask_b32_dpp v103,v51,v103,vcc quad_perm:[0,1,0,1] row_mask:0xf bank_mask:0xf
s_waitcnt lgkmcnt(4)
v_cndmask_b32_dpp v104,v52,v104,vcc quad_perm:[0,1,0,1] row_mask:0xf bank_mask:0xf
v_cndmask_b32_dpp v105,v53,v105,vcc quad_perm:[0,1,0,1] row_mask:0xf bank_mask:0xf
v_cndmask_b32_dpp v106,v54,v106,vcc quad_perm:[0,1,0,1] row_mask:0xf bank_mask:0xf
v_cndmask_b32_dpp v107,v55,v107,vcc quad_perm:[0,1,0,1] row_mask:0xf bank_mask:0xf
s_waitcnt lgkmcnt(0)
v_cndmask_b32_dpp v108,v12,v108,vcc quad_perm:[0,1,0,1] row_mask:0xf bank_mask:0xf
v_cndmask_b32_dpp v109,v13,v109,vcc quad_perm:[0,1,0,1] row_mask:0xf bank_mask:0xf
v_cndmask_b32_dpp v110,v14,v110,vcc quad_perm:[0,1,0,1] row_mask:0xf bank_mask:0xf
v_cndmask_b32_dpp v111,v15,v111,vcc quad_perm:[0,1,0,1] row_mask:0xf bank_mask:0xf
s_barrier
s_branch fj_109
CS_DONE:
v_lshrrev_b32 v0,4,v1
s_add_u32 s61,s48,0
s_endpgm
CV_START:
s_and_b32 s60,s46,1
s_lshl1_add_u32 s60,s49,s60
s_cmp_eq_u32 s60,1
s_cbranch_scc1 CV_LOOP_F1
s_cmp_eq_u32 s60,2
s_cbranch_scc1 CV_LOOP_S0
s_cmp_eq_u32 s60,3
s_cbranch_scc1 CV_LOOP_S1
CV_LOOP_F0:
v_mov_b32 v24,0
v_mov_b32 v25,0
v_mov_b32 v26,0
v_mov_b32 v27,0
v_mov_b32 v28,0
v_mov_b32 v29,0
v_mov_b32 v30,0
v_mov_b32 v31,0
v_mov_b32 v32,0
v_mov_b32 v33,0
v_mov_b32 v34,0
v_mov_b32 v35,0
v_mov_b32 v36,0
v_mov_b32 v37,0
v_mov_b32 v38,0
v_mov_b32 v39,0
v_mov_b32 v40,0
v_mov_b32 v41,0
v_mov_b32 v42,0
v_mov_b32 v43,0
v_mov_b32 v44,0
v_mov_b32 v45,0
v_mov_b32 v46,0
v_mov_b32 v47,0
s_cmp_lg_u32 s46,0
s_cbranch_scc1 np_125
db_126:
buffer_load_dword v12,v11,s[8:11],s69 offen sc1
s_waitcnt vmcnt(0)
v_cmp_gt_u32 vcc,s58,v12
s_cbranch_vccz dbok_127
s_sub_u32 s47,s47,1
s_cbranch_scc1 ABORT
s_branch db_126
dbok_127:
np_125:
s_barrier
buffer_load_dwordx2 v[68:69],v18,s[8:11],s59 offen sc1
buffer_load_dwordx4 v[60:63],v1,s[8:11],s59 offen sc1
buffer_load_dwordx4 v[64:67],v1,s[8:11],s59 offen offset:1024 sc1
s_waitcnt vmcnt(2)
s_sleep 3
fj_124f:
buffer_load_dwordx2 v[78:79],v18,s[8:11],s68 offen sc1
buffer_load_dwordx4 v[70:73],v1,s[8:11],s68 offen sc1
buffer_load_dwordx4 v[74:77],v1,s[8:11],s68 offen offset:1024 sc1
fj_124:
fa_122:
s_waitcnt vmcnt(5)
v_lshlrev_b32 v96,16,v68
v_and_b32 v97,0xffff0000,v68
v_lshlrev_b32 v98,16,v69
v_and_b32 v99,0xffff0000,v69
s_waitcnt vmcnt(4)
v_lshlrev_b32 v80,16,v60
v_and_b32 v81,0xffff0000,v60
v_lshlrev_b32 v82,16,v61
v_and_b32 v83,0xffff0000,v61
v_lshlrev_b32 v84,16,v62
v_and_b32 v85,0xffff0000,v62
v_lshlrev_b32 v86,16,v63
v_and_b32 v87,0xffff0000,v63
s_waitcnt vmcnt(3)
v_lshlrev_b32 v88,16,v64
v_and_b32 v89,0xffff0000,v64
v_lshlrev_b32 v90,16,v65
v_and_b32 v91,0xffff0000,v65
v_lshlrev_b32 v92,16,v66
v_and_b32 v93,0xffff0000,v66
v_lshlrev_b32 v94,16,v67
v_and_b32 v95,0xffff0000,v67
s_waitcnt vmcnt(2)
v_dot2c_f32_bf16 v96,s37,v78
v_dot2c_f32_bf16 v97,s81,v78
v_dot2c_f32_bf16 v98,s37,v79
v_dot2c_f32_bf16 v99,s81,v79
v_bitop3_b32 v16,v68,v78,s57 bitop3:0x7e
v_cvt_pk_bf16_f32 v56,v96,v97
s_nop 0
v_cvt_pk_bf16_f32 v57,v98,v99
ds_write_b64 v23,v[56:57]
s_waitcnt vmcnt(1)
v_dot2c_f32_bf16 v80,s37,v70
v_dot2c_f32_bf16 v81,s81,v70
v_dot2c_f32_bf16 v82,s37,v71
v_dot2c_f32_bf16 v83,s81,v71
v_dot2c_f32_bf16 v84,s37,v72
v_dot2c_f32_bf16 v85,s81,v72
v_dot2c_f32_bf16 v86,s37,v73
v_dot2c_f32_bf16 v87,s81,v73
v_bitop3_b32 v17,v60,v70,s57 bitop3:0x7e
v_or_b32 v16,v16,v17
v_cvt_pk_bf16_f32 v48,v80,v81
v_cvt_pk_bf16_f32 v49,v82,v83
v_cvt_pk_bf16_f32 v50,v84,v85
v_cvt_pk_bf16_f32 v51,v86,v87
ds_write_b128 v22,v[48:51] offset:0
s_waitcnt vmcnt(0)
v_dot2c_f32_bf16 v88,s37,v74
v_dot2c_f32_bf16 v89,s81,v74
v_dot2c_f32_bf16 v90,s37,v75
v_dot2c_f32_bf16 v91,s81,v75
v_dot2c_f32_bf16 v92,s37,v76
v_dot2c_f32_bf16 v93,s81,v76
v_dot2c_f32_bf16 v94,s37,v77
v_dot2c_f32_bf16 v95,s81,v77
v_bitop3_b32 v17,v64,v74,s57 bitop3:0x7e
v_bitop3_b32 v16,v16,v17,1 bitop3:0xa8
v_cmp_ne_u32 vcc,0,v16
v_cvt_pk_bf16_f32 v52,v88,v89
v_cvt_pk_bf16_f32 v53,v90,v91
v_cvt_pk_bf16_f32 v54,v92,v93
v_cvt_pk_bf16_f32 v55,v94,v95
ds_write_b128 v22,v[52:55] offset:1024
s_cbranch_vccnz fr_123
fj_124g:
v_smfmac_f32_16x16x64_bf16 v[24:27],v[48:51],a[0:7],v2
ds_read_b128 v[72:75],v21 offset:0
s_and_b32 s60,s52,1
v_smfmac_f32_16x16x64_bf16 v[28:31],v[48:51],a[8:15],v2
ds_read_b128 v[76:79],v21 offset:1024
s_lshl2_add_u32 s60,s51,s60
v_smfmac_f32_16x16x64_bf16 v[32:35],v[48:51],a[16:23],v2
ds_read_b128 v[80:83],v21 offset:2048
s_mul_i32 s60,s60,49152
v_smfmac_f32_16x16x64_bf16 v[36:39],v[48:51],a[24:31],v2
ds_read_b128 v[84:87],v21 offset:3072
s_add_u32 s71,s60,s34
s_waitcnt lgkmcnt(4)
s_barrier
v_smfmac_f32_16x16x64_bf16 v[40:43],v[48:51],a[32:39],v2
ds_read_b128 v[60:63],v3 offset:0
v_smfmac_f32_16x16x64_bf16 v[24:27],v[52:55],a[40:47],v2
ds_read_b128 v[64:67],v3 offset:1024
v_mov_b32 v17,1
v_smfmac_f32_16x16x64_bf16 v[28:31],v[52:55],a[48:55],v2
ds_read_b128 v[68:71],v4 offset:0
v_smfmac_f32_16x16x64_bf16 v[32:35],v[52:55],a[56:63],v2
s_mov_b64 exec,1
buffer_store_dword v17,v1,s[8:11],s79 offen sc1
s_mov_b64 exec,-1
v_smfmac_f32_16x16x64_bf16 v[36:39],v[52:55],a[64:71],v2
buffer_store_dwordx4 v[100:103],v6,s[8:11],s78 offen sc1
v_smfmac_f32_16x16x64_bf16 v[40:43],v[52:55],a[72:79],v2
buffer_store_dwordx2 v[104:105],v7,s[8:11],s78 offen sc1
s_waitcnt lgkmcnt(5)
v_smfmac_f32_16x16x64_bf16 v[44:47],v[48:51],v[72:79],v2
ds_read_b128 v[72:75],v21 offset:4096
s_waitcnt lgkmcnt(4)
v_smfmac_f32_16x16x64_bf16 v[44:47],v[52:55],v[80:87],v2
ds_read_b128 v[76:79],v21 offset:5120
s_waitcnt lgkmcnt(4)
v_smfmac_f32_16x16x64_bf16 v[24:27],v[60:63],a[80:87],v2
ds_read_b128 v[80:83],v21 offset:6144
s_and_b32 s79,s78,2147483648
v_smfmac_f32_16x16x64_bf16 v[28:31],v[60:63],a[88:95],v2
ds_read_b128 v[84:87],v21 offset:7168
s_or_b32 s79,s79,s30
v_smfmac_f32_16x16x64_bf16 v[32:35],v[60:63],a[96:103],v2
s_mov_b32 s78,2147483648
v_smfmac_f32_16x16x64_bf16 v[36:39],v[60:63],a[104:111],v2
v_smfmac_f32_16x16x64_bf16 v[40:43],v[60:63],a[112:119],v2
s_waitcnt lgkmcnt(2)
v_smfmac_f32_16x16x64_bf16 v[44:47],v[60:63],v[72:79],v2
ds_read_b128 v[60:63],v4 offset:1024
v_smfmac_f32_16x16x64_bf16 v[24:27],v[64:67],a[120:127],v2
ds_read_b128 v[72:75],v21 offset:8192
v_smfmac_f32_16x16x64_bf16 v[28:31],v[64:67],a[128:135],v2
ds_read_b128 v[76:79],v21 offset:9216
v_smfmac_f32_16x16x64_bf16 v[32:35],v[64:67],a[136:143],v2
v_smfmac_f32_16x16x64_bf16 v[36:39],v[64:67],a[144:151],v2
v_smfmac_f32_16x16x64_bf16 v[40:43],v[64:67],a[152:159],v2
s_waitcnt lgkmcnt(3)
v_smfmac_f32_16x16x64_bf16 v[44:47],v[64:67],v[80:87],v2
ds_read_b128 v[64:67],v5 offset:0
v_smfmac_f32_16x16x64_bf16 v[24:27],v[68:71],a[160:167],v2
ds_read_b128 v[80:83],v21 offset:10240
v_smfmac_f32_16x16x64_bf16 v[28:31],v[68:71],a[168:175],v2
ds_read_b128 v[84:87],v21 offset:11264
v_smfmac_f32_16x16x64_bf16 v[32:35],v[68:71],a[176:183],v2
v_smfmac_f32_16x16x64_bf16 v[36:39],v[68:71],a[184:191],v2
v_smfmac_f32_16x16x64_bf16 v[40:43],v[68:71],a[192:199],v2
s_waitcnt lgkmcnt(3)
v_smfmac_f32_16x16x64_bf16 v[44:47],v[68:71],v[72:79],v2
ds_read_b128 v[68:71],v5 offset:1024
v_smfmac_f32_16x16x64_bf16 v[24:27],v[60:63],a[200:207],v2
ds_read_b128 v[72:75],v21 offset:12288
v_smfmac_f32_16x16x64_bf16 v[28:31],v[60:63],a[208:215],v2
ds_read_b128 v[76:79],v21 offset:13312
v_smfmac_f32_16x16x64_bf16 v[32:35],v[60:63],a[216:223],v2
v_smfmac_f32_16x16x64_bf16 v[36:39],v[60:63],a[224:231],v2
v_smfmac_f32_16x16x64_bf16 v[40:43],v[60:63],a[232:239],v2
s_waitcnt lgkmcnt(3)
v_smfmac_f32_16x16x64_bf16 v[44:47],v[60:63],v[80:87],v2
ds_read_b128 v[60:63],v59 offset:0
v_smfmac_f32_16x16x64_bf16 v[24:27],v[64:67],a[240:247],v2
ds_read_b128 v[80:83],v21 offset:14336
v_smfmac_f32_16x16x64_bf16 v[28:31],v[64:67],a[248:255],v2
ds_read_b128 v[84:87],v21 offset:15360
v_smfmac_f32_16x16x64_bf16 v[32:35],v[64:67],v[112:119],v2
v_smfmac_f32_16x16x64_bf16 v[36:39],v[64:67],v[120:127],v2
v_smfmac_f32_16x16x64_bf16 v[40:43],v[64:67],v[128:135],v2
s_waitcnt lgkmcnt(3)
v_smfmac_f32_16x16x64_bf16 v[44:47],v[64:67],v[72:79],v2
ds_read_b128 v[64:67],v59 offset:1024
v_smfmac_f32_16x16x64_bf16 v[24:27],v[68:71],v[136:143],v2
ds_read_b128 v[72:75],v21 offset:16384
v_smfmac_f32_16x16x64_bf16 v[28:31],v[68:71],v[144:151],v2
ds_read_b128 v[76:79],v21 offset:17408
v_smfmac_f32_16x16x64_bf16 v[32:35],v[68:71],v[152:159],v2
v_smfmac_f32_16x16x64_bf16 v[36:39],v[68:71],v[160:167],v2
v_smfmac_f32_16x16x64_bf16 v[40:43],v[68:71],v[168:175],v2
s_waitcnt lgkmcnt(3)
v_smfmac_f32_16x16x64_bf16 v[44:47],v[68:71],v[80:87],v2
ds_read_b128 v[80:83],v21 offset:18432
v_smfmac_f32_16x16x64_bf16 v[24:27],v[60:63],v[176:183],v2
ds_read_b128 v[84:87],v21 offset:19456
v_smfmac_f32_16x16x64_bf16 v[28:31],v[60:63],v[184:191],v2
s_waitcnt lgkmcnt(4)
v_smfmac_f32_16x16x64_bf16 v[24:27],v[64:67],v[216:223],v2
v_smfmac_f32_16x16x64_bf16 v[28:31],v[64:67],v[224:231],v2
v_smfmac_f32_16x16x64_bf16 v[32:35],v[60:63],v[192:199],v2
v_smfmac_f32_16x16x64_bf16 v[36:39],v[60:63],v[200:207],v2
v_add_f32 v24,v24,v25
v_smfmac_f32_16x16x64_bf16 v[32:35],v[64:67],v[232:239],v2
v_add_f32 v26,v26,v27
v_smfmac_f32_16x16x64_bf16 v[36:39],v[64:67],v[240:247],v2
v_add_f32 v28,v28,v29
v_smfmac_f32_16x16x64_bf16 v[40:43],v[60:63],v[208:215],v2
v_add_f32 v30,v30,v31
s_waitcnt lgkmcnt(2)
v_smfmac_f32_16x16x64_bf16 v[44:47],v[60:63],v[72:79],v2
v_cvt_pk_bf16_f32 v100,v24,v26
v_smfmac_f32_16x16x64_bf16 v[40:43],v[64:67],v[248:255],v2
v_cvt_pk_bf16_f32 v101,v28,v30
s_waitcnt lgkmcnt(0)
v_smfmac_f32_16x16x64_bf16 v[44:47],v[64:67],v[80:87],v2
v_and_or_b32 v100,v100,-2,s57
v_add_f32 v32,v32,v33
v_add_f32 v34,v34,v35
v_add_f32 v36,v36,v37
v_add_f32 v38,v38,v39
v_cvt_pk_bf16_f32 v102,v32,v34
v_cvt_pk_bf16_f32 v103,v36,v38
v_and_or_b32 v102,v102,-2,s57
buffer_store_dwordx4 v[100:103],v6,s[8:11],s71 offen
v_add_f32 v40,v40,v41
v_add_f32 v42,v42,v43
v_add_f32 v44,v44,v45
v_add_f32 v46,v46,v47
v_cvt_pk_bf16_f32 v104,v40,v42
v_cvt_pk_bf16_f32 v105,v44,v46
v_and_or_b32 v104,v104,-2,s57
buffer_store_dwordx2 v[104:105],v7,s[8:11],s71 offen
s_lshl_b32 s60,s51,6
s_add_u32 s60,s60,s52
s_mul_i32 s78,s60,196608
s_add_u32 s78,s78,s85
s_lshl_b32 s60,s60,10
s_add_u32 s30,s60,s86
s_sub_u32 s60,s4,s5
s_cmp_gt_i32 s60,13
s_cselect_b32 s53,1,0
s_cmp_eq_u32 s4,64
s_cselect_b32 s53,1,s53
s_cmp_eq_u32 s53,0
s_cselect_b32 s54,s4,s5
s_addc_u32 s4,s4,0
s_add_u32 s5,s5,s53
s_and_b32 s60,s54,1
s_lshl2_add_u32 s60,s53,s60
s_lshl_b32 s68,s60,16
s_add_u32 s68,s68,s83
s_mul_i32 s59,s60,20480
s_add_u32 s59,s59,s6
s_lshl_b32 s69,s53,9
s_add_u32 s69,s69,s7
s_bfe_u32 s31,s54,65537
s_add_u32 s32,s54,1
s_cmp_lg_u32 s53,s51
s_cbranch_scc1 nx_128
s_waitcnt vmcnt(0)
s_cmp_ge_u32 s79,2147483648
s_cbranch_scc1 pf_129
v_mov_b32 v17,1
s_mov_b64 exec,1
buffer_store_dword v17,v1,s[8:11],s79 offen sc1
s_mov_b64 exec,-1
s_mov_b32 s79,2147483648
pf_129:
s_cmp_eq_u32 s78,2147483648
s_cbranch_scc1 pk_130
buffer_store_dwordx4 v[100:103],v6,s[8:11],s78 offen sc1
buffer_store_dwordx2 v[104:105],v7,s[8:11],s78 offen sc1
s_mov_b32 s79,s30
s_mov_b32 s78,2147483648
pk_130:
s_waitcnt vmcnt(0)
s_cmp_ge_u32 s79,2147483648
s_cbranch_scc1 pf_131
v_mov_b32 v17,1
s_mov_b64 exec,1
buffer_store_dword v17,v1,s[8:11],s79 offen sc1
s_mov_b64 exec,-1
s_mov_b32 s79,2147483648
pf_131:
nx_128:
s_add_u32 s50,s50,1
s_mov_b32 s51,s53
s_mov_b32 s52,s54
s_mov_b32 s57,s31
s_mov_b32 s58,s32
s_cmp_lt_u32 s50,128
s_cbranch_scc1 CV_LOOP_F0
s_branch CV_DONE
fr_123:
v_bitop3_b32 v12,v60,v64,s57 bitop3:0x7e
v_bitop3_b32 v13,v68,v68,s57 bitop3:0x7e
v_xor_b32 v14,s57,v68
v_or3_b32 v12,v12,v13,v14
v_and_b32 v12,1,v12
v_cmp_ne_u32 vcc,0,v12
s_cbranch_vccz sk_132
buffer_load_dwordx2 v[68:69],v18,s[8:11],s59 offen sc1
buffer_load_dwordx4 v[60:63],v1,s[8:11],s59 offen sc1
buffer_load_dwordx4 v[64:67],v1,s[8:11],s59 offen offset:1024 sc1
sk_132:
buffer_load_dwordx2 v[78:79],v18,s[8:11],s68 offen sc1
buffer_load_dwordx4 v[70:73],v1,s[8:11],s68 offen sc1
buffer_load_dwordx4 v[74:77],v1,s[8:11],s68 offen offset:1024 sc1
s_sub_u32 s47,s47,1
s_cbranch_scc1 ABORT
s_waitcnt lgkmcnt(0)
s_branch fa_122
CV_LOOP_F1:
v_mov_b32 v24,0
v_mov_b32 v25,0
v_mov_b32 v26,0
v_mov_b32 v27,0
v_mov_b32 v28,0
v_mov_b32 v29,0
v_mov_b32 v30,0
v_mov_b32 v31,0
v_mov_b32 v32,0
v_mov_b32 v33,0
v_mov_b32 v34,0
v_mov_b32 v35,0
v_mov_b32 v36,0
v_mov_b32 v37,0
v_mov_b32 v38,0
v_mov_b32 v39,0
v_mov_b32 v40,0
v_mov_b32 v41,0
v_mov_b32 v42,0
v_mov_b32 v43,0
v_mov_b32 v44,0
v_mov_b32 v45,0
v_mov_b32 v46,0
v_mov_b32 v47,0
s_barrier
buffer_load_dwordx2 v[68:69],v18,s[8:11],s59 offen sc1
buffer_load_dwordx4 v[60:63],v1,s[8:11],s59 offen sc1
buffer_load_dwordx4 v[64:67],v1,s[8:11],s59 offen offset:1024 sc1
s_waitcnt vmcnt(2)
s_sleep 3
fj_135f:
buffer_load_dwordx2 v[78:79],v18,s[8:11],s68 offen sc1
buffer_load_dwordx4 v[70:73],v1,s[8:11],s68 offen sc1
buffer_load_dwordx4 v[74:77],v1,s[8:11],s68 offen offset:1024 sc1
fj_135:
fa_133:
s_waitcnt vmcnt(5)
v_lshlrev_b32 v96,16,v68
v_and_b32 v97,0xffff0000,v68
v_lshlrev_b32 v98,16,v69
v_and_b32 v99,0xffff0000,v69
s_waitcnt vmcnt(4)
v_lshlrev_b32 v80,16,v60
v_and_b32 v81,0xffff0000,v60
v_lshlrev_b32 v82,16,v61
v_and_b32 v83,0xffff0000,v61
v_lshlrev_b32 v84,16,v62
v_and_b32 v85,0xffff0000,v62
v_lshlrev_b32 v86,16,v63
v_and_b32 v87,0xffff0000,v63
s_waitcnt vmcnt(3)
v_lshlrev_b32 v88,16,v64
v_and_b32 v89,0xffff0000,v64
v_lshlrev_b32 v90,16,v65
v_and_b32 v91,0xffff0000,v65
v_lshlrev_b32 v92,16,v66
v_and_b32 v93,0xffff0000,v66
v_lshlrev_b32 v94,16,v67
v_and_b32 v95,0xffff0000,v67
s_waitcnt vmcnt(2)
v_dot2c_f32_bf16 v96,s37,v78
v_dot2c_f32_bf16 v97,s81,v78
v_dot2c_f32_bf16 v98,s37,v79
v_dot2c_f32_bf16 v99,s81,v79
v_bitop3_b32 v16,v68,v78,s57 bitop3:0x7e
v_cvt_pk_bf16_f32 v56,v96,v97
s_nop 0
v_cvt_pk_bf16_f32 v57,v98,v99
ds_write_b64 v23,v[56:57]
s_waitcnt vmcnt(1)
v_dot2c_f32_bf16 v80,s37,v70
v_dot2c_f32_bf16 v81,s81,v70
v_dot2c_f32_bf16 v82,s37,v71
v_dot2c_f32_bf16 v83,s81,v71
v_dot2c_f32_bf16 v84,s37,v72
v_dot2c_f32_bf16 v85,s81,v72
v_dot2c_f32_bf16 v86,s37,v73
v_dot2c_f32_bf16 v87,s81,v73
v_bitop3_b32 v17,v60,v70,s57 bitop3:0x7e
v_or_b32 v16,v16,v17
v_cvt_pk_bf16_f32 v48,v80,v81
v_cvt_pk_bf16_f32 v49,v82,v83
v_cvt_pk_bf16_f32 v50,v84,v85
v_cvt_pk_bf16_f32 v51,v86,v87
ds_write_b128 v22,v[48:51] offset:0
s_waitcnt vmcnt(0)
v_dot2c_f32_bf16 v88,s37,v74
v_dot2c_f32_bf16 v89,s81,v74
v_dot2c_f32_bf16 v90,s37,v75
v_dot2c_f32_bf16 v91,s81,v75
v_dot2c_f32_bf16 v92,s37,v76
v_dot2c_f32_bf16 v93,s81,v76
v_dot2c_f32_bf16 v94,s37,v77
v_dot2c_f32_bf16 v95,s81,v77
v_bitop3_b32 v17,v64,v74,s57 bitop3:0x7e
v_bitop3_b32 v16,v16,v17,1 bitop3:0xa8
v_cmp_ne_u32 vcc,0,v16
v_cvt_pk_bf16_f32 v52,v88,v89
v_cvt_pk_bf16_f32 v53,v90,v91
v_cvt_pk_bf16_f32 v54,v92,v93
v_cvt_pk_bf16_f32 v55,v94,v95
ds_write_b128 v22,v[52:55] offset:1024
s_cbranch_vccnz fr_134
fj_135g:
v_smfmac_f32_16x16x64_bf16 v[24:27],v[48:51],a[0:7],v2
ds_read_b128 v[72:75],v21 offset:0
s_and_b32 s60,s52,1
v_smfmac_f32_16x16x64_bf16 v[28:31],v[48:51],a[8:15],v2
ds_read_b128 v[76:79],v21 offset:1024
s_lshl2_add_u32 s60,s51,s60
v_smfmac_f32_16x16x64_bf16 v[32:35],v[48:51],a[16:23],v2
ds_read_b128 v[80:83],v21 offset:2048
s_mul_i32 s60,s60,49152
v_smfmac_f32_16x16x64_bf16 v[36:39],v[48:51],a[24:31],v2
ds_read_b128 v[84:87],v21 offset:3072
s_add_u32 s71,s60,s34
s_waitcnt lgkmcnt(4)
s_barrier
v_smfmac_f32_16x16x64_bf16 v[40:43],v[48:51],a[32:39],v2
ds_read_b128 v[60:63],v3 offset:0
v_smfmac_f32_16x16x64_bf16 v[24:27],v[52:55],a[40:47],v2
ds_read_b128 v[64:67],v3 offset:1024
v_mov_b32 v17,1
v_smfmac_f32_16x16x64_bf16 v[28:31],v[52:55],a[48:55],v2
ds_read_b128 v[68:71],v4 offset:0
v_smfmac_f32_16x16x64_bf16 v[32:35],v[52:55],a[56:63],v2
s_mov_b64 exec,1
buffer_store_dword v17,v1,s[8:11],s79 offen sc1
s_mov_b64 exec,-1
v_smfmac_f32_16x16x64_bf16 v[36:39],v[52:55],a[64:71],v2
buffer_store_dwordx4 v[102:105],v6,s[8:11],s78 offen sc1
v_smfmac_f32_16x16x64_bf16 v[40:43],v[52:55],a[72:79],v2
buffer_store_dwordx2 v[100:101],v7,s[8:11],s78 offen sc1
s_waitcnt lgkmcnt(5)
v_smfmac_f32_16x16x64_bf16 v[44:47],v[48:51],v[72:79],v2
ds_read_b128 v[72:75],v21 offset:4096
s_waitcnt lgkmcnt(4)
v_smfmac_f32_16x16x64_bf16 v[44:47],v[52:55],v[80:87],v2
ds_read_b128 v[76:79],v21 offset:5120
s_waitcnt lgkmcnt(4)
v_smfmac_f32_16x16x64_bf16 v[24:27],v[60:63],a[80:87],v2
ds_read_b128 v[80:83],v21 offset:6144
s_and_b32 s79,s78,2147483648
v_smfmac_f32_16x16x64_bf16 v[28:31],v[60:63],a[88:95],v2
ds_read_b128 v[84:87],v21 offset:7168
s_or_b32 s79,s79,s30
v_smfmac_f32_16x16x64_bf16 v[32:35],v[60:63],a[96:103],v2
s_mov_b32 s78,2147483648
v_smfmac_f32_16x16x64_bf16 v[36:39],v[60:63],a[104:111],v2
v_smfmac_f32_16x16x64_bf16 v[40:43],v[60:63],a[112:119],v2
s_waitcnt lgkmcnt(2)
v_smfmac_f32_16x16x64_bf16 v[44:47],v[60:63],v[72:79],v2
ds_read_b128 v[60:63],v4 offset:1024
v_smfmac_f32_16x16x64_bf16 v[24:27],v[64:67],a[120:127],v2
ds_read_b128 v[72:75],v21 offset:8192
v_smfmac_f32_16x16x64_bf16 v[28:31],v[64:67],a[128:135],v2
ds_read_b128 v[76:79],v21 offset:9216
v_smfmac_f32_16x16x64_bf16 v[32:35],v[64:67],a[136:143],v2
v_smfmac_f32_16x16x64_bf16 v[36:39],v[64:67],a[144:151],v2
v_smfmac_f32_16x16x64_bf16 v[40:43],v[64:67],a[152:159],v2
s_waitcnt lgkmcnt(3)
v_smfmac_f32_16x16x64_bf16 v[44:47],v[64:67],v[80:87],v2
ds_read_b128 v[64:67],v5 offset:0
v_smfmac_f32_16x16x64_bf16 v[24:27],v[68:71],a[160:167],v2
ds_read_b128 v[80:83],v21 offset:10240
v_smfmac_f32_16x16x64_bf16 v[28:31],v[68:71],a[168:175],v2
ds_read_b128 v[84:87],v21 offset:11264
v_smfmac_f32_16x16x64_bf16 v[32:35],v[68:71],a[176:183],v2
v_smfmac_f32_16x16x64_bf16 v[36:39],v[68:71],a[184:191],v2
v_smfmac_f32_16x16x64_bf16 v[40:43],v[68:71],a[192:199],v2
s_waitcnt lgkmcnt(3)
v_smfmac_f32_16x16x64_bf16 v[44:47],v[68:71],v[72:79],v2
ds_read_b128 v[68:71],v5 offset:1024
v_smfmac_f32_16x16x64_bf16 v[24:27],v[60:63],a[200:207],v2
ds_read_b128 v[72:75],v21 offset:12288
v_smfmac_f32_16x16x64_bf16 v[28:31],v[60:63],a[208:215],v2
ds_read_b128 v[76:79],v21 offset:13312
v_smfmac_f32_16x16x64_bf16 v[32:35],v[60:63],a[216:223],v2
v_smfmac_f32_16x16x64_bf16 v[36:39],v[60:63],a[224:231],v2
v_smfmac_f32_16x16x64_bf16 v[40:43],v[60:63],a[232:239],v2
s_waitcnt lgkmcnt(3)
v_smfmac_f32_16x16x64_bf16 v[44:47],v[60:63],v[80:87],v2
ds_read_b128 v[60:63],v59 offset:0
v_smfmac_f32_16x16x64_bf16 v[24:27],v[64:67],a[240:247],v2
ds_read_b128 v[80:83],v21 offset:14336
v_smfmac_f32_16x16x64_bf16 v[28:31],v[64:67],a[248:255],v2
ds_read_b128 v[84:87],v21 offset:15360
v_smfmac_f32_16x16x64_bf16 v[32:35],v[64:67],v[112:119],v2
v_smfmac_f32_16x16x64_bf16 v[36:39],v[64:67],v[120:127],v2
v_smfmac_f32_16x16x64_bf16 v[40:43],v[64:67],v[128:135],v2
s_waitcnt lgkmcnt(3)
v_smfmac_f32_16x16x64_bf16 v[44:47],v[64:67],v[72:79],v2
ds_read_b128 v[64:67],v59 offset:1024
v_smfmac_f32_16x16x64_bf16 v[24:27],v[68:71],v[136:143],v2
ds_read_b128 v[72:75],v21 offset:16384
v_smfmac_f32_16x16x64_bf16 v[28:31],v[68:71],v[144:151],v2
ds_read_b128 v[76:79],v21 offset:17408
v_smfmac_f32_16x16x64_bf16 v[32:35],v[68:71],v[152:159],v2
v_smfmac_f32_16x16x64_bf16 v[36:39],v[68:71],v[160:167],v2
v_smfmac_f32_16x16x64_bf16 v[40:43],v[68:71],v[168:175],v2
s_waitcnt lgkmcnt(3)
v_smfmac_f32_16x16x64_bf16 v[44:47],v[68:71],v[80:87],v2
ds_read_b128 v[80:83],v21 offset:18432
v_smfmac_f32_16x16x64_bf16 v[24:27],v[60:63],v[176:183],v2
ds_read_b128 v[84:87],v21 offset:19456
v_smfmac_f32_16x16x64_bf16 v[28:31],v[60:63],v[184:191],v2
s_waitcnt lgkmcnt(4)
v_smfmac_f32_16x16x64_bf16 v[24:27],v[64:67],v[216:223],v2
v_smfmac_f32_16x16x64_bf16 v[28:31],v[64:67],v[224:231],v2
v_smfmac_f32_16x16x64_bf16 v[32:35],v[60:63],v[192:199],v2
v_smfmac_f32_16x16x64_bf16 v[36:39],v[60:63],v[200:207],v2
v_add_f32 v24,v24,v25
v_smfmac_f32_16x16x64_bf16 v[32:35],v[64:67],v[232:239],v2
v_add_f32 v26,v26,v27
v_smfmac_f32_16x16x64_bf16 v[36:39],v[64:67],v[240:247],v2
v_add_f32 v28,v28,v29
v_smfmac_f32_16x16x64_bf16 v[40:43],v[60:63],v[208:215],v2
v_add_f32 v30,v30,v31
s_waitcnt lgkmcnt(2)
v_smfmac_f32_16x16x64_bf16 v[44:47],v[60:63],v[72:79],v2
v_cvt_pk_bf16_f32 v100,v24,v26
v_smfmac_f32_16x16x64_bf16 v[40:43],v[64:67],v[248:255],v2
v_cvt_pk_bf16_f32 v101,v28,v30
s_waitcnt lgkmcnt(0)
v_smfmac_f32_16x16x64_bf16 v[44:47],v[64:67],v[80:87],v2
v_and_or_b32 v100,v100,-2,s57
buffer_store_dwordx2 v[100:101],v7,s[8:11],s71 offen
v_add_f32 v32,v32,v33
v_add_f32 v34,v34,v35
v_add_f32 v36,v36,v37
v_add_f32 v38,v38,v39
v_cvt_pk_bf16_f32 v102,v32,v34
v_cvt_pk_bf16_f32 v103,v36,v38
v_and_or_b32 v102,v102,-2,s57
v_add_f32 v40,v40,v41
v_add_f32 v42,v42,v43
v_add_f32 v44,v44,v45
v_add_f32 v46,v46,v47
v_cvt_pk_bf16_f32 v104,v40,v42
v_cvt_pk_bf16_f32 v105,v44,v46
v_and_or_b32 v104,v104,-2,s57
buffer_store_dwordx4 v[102:105],v6,s[8:11],s71 offen
s_lshl_b32 s60,s51,6
s_add_u32 s60,s60,s52
s_mul_i32 s78,s60,196608
s_add_u32 s78,s78,s85
s_lshl_b32 s60,s60,10
s_add_u32 s30,s60,s86
s_sub_u32 s60,s4,s5
s_cmp_gt_i32 s60,13
s_cselect_b32 s53,1,0
s_cmp_eq_u32 s4,64
s_cselect_b32 s53,1,s53
s_cmp_eq_u32 s53,0
s_cselect_b32 s54,s4,s5
s_addc_u32 s4,s4,0
s_add_u32 s5,s5,s53
s_and_b32 s60,s54,1
s_lshl2_add_u32 s60,s53,s60
s_lshl_b32 s68,s60,16
s_add_u32 s68,s68,s83
s_mul_i32 s59,s60,20480
s_add_u32 s59,s59,s6
s_lshl_b32 s69,s53,9
s_add_u32 s69,s69,s7
s_bfe_u32 s31,s54,65537
s_add_u32 s32,s54,1
s_cmp_lg_u32 s53,s51
s_cbranch_scc1 nx_136
s_waitcnt vmcnt(0)
s_cmp_ge_u32 s79,2147483648
s_cbranch_scc1 pf_137
v_mov_b32 v17,1
s_mov_b64 exec,1
buffer_store_dword v17,v1,s[8:11],s79 offen sc1
s_mov_b64 exec,-1
s_mov_b32 s79,2147483648
pf_137:
s_cmp_eq_u32 s78,2147483648
s_cbranch_scc1 pk_138
buffer_store_dwordx4 v[102:105],v6,s[8:11],s78 offen sc1
buffer_store_dwordx2 v[100:101],v7,s[8:11],s78 offen sc1
s_mov_b32 s79,s30
s_mov_b32 s78,2147483648
pk_138:
s_waitcnt vmcnt(0)
s_cmp_ge_u32 s79,2147483648
s_cbranch_scc1 pf_139
v_mov_b32 v17,1
s_mov_b64 exec,1
buffer_store_dword v17,v1,s[8:11],s79 offen sc1
s_mov_b64 exec,-1
s_mov_b32 s79,2147483648
pf_139:
nx_136:
s_add_u32 s50,s50,1
s_mov_b32 s51,s53
s_mov_b32 s52,s54
s_mov_b32 s57,s31
s_mov_b32 s58,s32
s_cmp_lt_u32 s50,128
s_cbranch_scc1 CV_LOOP_F1
s_branch CV_DONE
fr_134:
v_bitop3_b32 v12,v60,v64,s57 bitop3:0x7e
v_bitop3_b32 v13,v68,v68,s57 bitop3:0x7e
v_xor_b32 v14,s57,v68
v_or3_b32 v12,v12,v13,v14
v_and_b32 v12,1,v12
v_cmp_ne_u32 vcc,0,v12
s_cbranch_vccz sk_140
buffer_load_dwordx2 v[68:69],v18,s[8:11],s59 offen sc1
buffer_load_dwordx4 v[60:63],v1,s[8:11],s59 offen sc1
buffer_load_dwordx4 v[64:67],v1,s[8:11],s59 offen offset:1024 sc1
sk_140:
buffer_load_dwordx2 v[78:79],v18,s[8:11],s68 offen sc1
buffer_load_dwordx4 v[70:73],v1,s[8:11],s68 offen sc1
buffer_load_dwordx4 v[74:77],v1,s[8:11],s68 offen offset:1024 sc1
s_sub_u32 s47,s47,1
s_cbranch_scc1 ABORT
s_waitcnt lgkmcnt(0)
s_branch fa_133
CV_LOOP_S0:
v_mov_b32 v24,0
v_mov_b32 v25,0
v_mov_b32 v26,0
v_mov_b32 v27,0
v_mov_b32 v28,0
v_mov_b32 v29,0
v_mov_b32 v30,0
v_mov_b32 v31,0
v_mov_b32 v32,0
v_mov_b32 v33,0
v_mov_b32 v34,0
v_mov_b32 v35,0
v_mov_b32 v36,0
v_mov_b32 v37,0
v_mov_b32 v38,0
v_mov_b32 v39,0
v_mov_b32 v40,0
v_mov_b32 v41,0
v_mov_b32 v42,0
v_mov_b32 v43,0
v_mov_b32 v44,0
v_mov_b32 v45,0
v_mov_b32 v46,0
v_mov_b32 v47,0
s_cmp_lg_u32 s46,0
s_cbranch_scc1 np_144
db_145:
buffer_load_dword v12,v11,s[8:11],s69 offen sc1
s_waitcnt vmcnt(0)
v_cmp_gt_u32 vcc,s58,v12
s_cbranch_vccz dbok_146
s_sub_u32 s47,s47,1
s_cbranch_scc1 ABORT
s_branch db_145
dbok_146:
np_144:
s_barrier
buffer_load_dwordx2 v[68:69],v18,s[8:11],s59 offen sc1
buffer_load_dwordx4 v[60:63],v1,s[8:11],s59 offen sc1
buffer_load_dwordx4 v[64:67],v1,s[8:11],s59 offen offset:1024 sc1
s_waitcnt vmcnt(2)
s_sleep 3
fj_143f:
buffer_load_dwordx2 v[78:79],v18,s[8:11],s68 offen sc1
buffer_load_dwordx4 v[70:73],v1,s[8:11],s68 offen sc1
buffer_load_dwordx4 v[74:77],v1,s[8:11],s68 offen offset:1024 sc1
fj_143:
fa_141:
s_waitcnt vmcnt(5)
v_lshlrev_b32 v96,16,v68
v_and_b32 v97,0xffff0000,v68
v_lshlrev_b32 v98,16,v69
v_and_b32 v99,0xffff0000,v69
s_waitcnt vmcnt(4)
v_lshlrev_b32 v80,16,v60
v_and_b32 v81,0xffff0000,v60
v_lshlrev_b32 v82,16,v61
v_and_b32 v83,0xffff0000,v61
v_lshlrev_b32 v84,16,v62
v_and_b32 v85,0xffff0000,v62
v_lshlrev_b32 v86,16,v63
v_and_b32 v87,0xffff0000,v63
s_waitcnt vmcnt(3)
v_lshlrev_b32 v88,16,v64
v_and_b32 v89,0xffff0000,v64
v_lshlrev_b32 v90,16,v65
v_and_b32 v91,0xffff0000,v65
v_lshlrev_b32 v92,16,v66
v_and_b32 v93,0xffff0000,v66
v_lshlrev_b32 v94,16,v67
v_and_b32 v95,0xffff0000,v67
s_waitcnt vmcnt(2)
v_dot2c_f32_bf16 v96,s37,v78
v_dot2c_f32_bf16 v97,s81,v78
v_dot2c_f32_bf16 v98,s37,v79
v_dot2c_f32_bf16 v99,s81,v79
v_bitop3_b32 v16,v68,v78,s57 bitop3:0x7e
v_cvt_pk_bf16_f32 v56,v96,v97
s_nop 0
v_cvt_pk_bf16_f32 v57,v98,v99
ds_write_b64 v23,v[56:57]
s_waitcnt vmcnt(1)
v_dot2c_f32_bf16 v80,s37,v70
v_dot2c_f32_bf16 v81,s81,v70
v_dot2c_f32_bf16 v82,s37,v71
v_dot2c_f32_bf16 v83,s81,v71
v_dot2c_f32_bf16 v84,s37,v72
v_dot2c_f32_bf16 v85,s81,v72
v_dot2c_f32_bf16 v86,s37,v73
v_dot2c_f32_bf16 v87,s81,v73
v_bitop3_b32 v17,v60,v70,s57 bitop3:0x7e
v_or_b32 v16,v16,v17
v_cvt_pk_bf16_f32 v48,v80,v81
v_cvt_pk_bf16_f32 v49,v82,v83
v_cvt_pk_bf16_f32 v50,v84,v85
v_cvt_pk_bf16_f32 v51,v86,v87
ds_write_b128 v22,v[48:51] offset:0
s_waitcnt vmcnt(0)
v_dot2c_f32_bf16 v88,s37,v74
v_dot2c_f32_bf16 v89,s81,v74
v_dot2c_f32_bf16 v90,s37,v75
v_dot2c_f32_bf16 v91,s81,v75
v_dot2c_f32_bf16 v92,s37,v76
v_dot2c_f32_bf16 v93,s81,v76
v_dot2c_f32_bf16 v94,s37,v77
v_dot2c_f32_bf16 v95,s81,v77
v_bitop3_b32 v17,v64,v74,s57 bitop3:0x7e
v_bitop3_b32 v16,v16,v17,1 bitop3:0xa8
v_cmp_ne_u32 vcc,0,v16
v_cvt_pk_bf16_f32 v52,v88,v89
v_cvt_pk_bf16_f32 v53,v90,v91
v_cvt_pk_bf16_f32 v54,v92,v93
v_cvt_pk_bf16_f32 v55,v94,v95
ds_write_b128 v22,v[52:55] offset:1024
s_cbranch_vccnz fr_142
fj_143g:
v_smfmac_f32_16x16x64_bf16 v[24:27],v[48:51],a[0:7],v2
ds_read_b128 v[72:75],v21 offset:0
s_and_b32 s60,s52,1
v_smfmac_f32_16x16x64_bf16 v[28:31],v[48:51],a[8:15],v2
ds_read_b128 v[76:79],v21 offset:1024
s_lshl2_add_u32 s60,s51,s60
v_smfmac_f32_16x16x64_bf16 v[32:35],v[48:51],a[16:23],v2
ds_read_b128 v[80:83],v21 offset:2048
s_mul_i32 s60,s60,49152
v_smfmac_f32_16x16x64_bf16 v[36:39],v[48:51],a[24:31],v2
ds_read_b128 v[84:87],v21 offset:3072
s_add_u32 s71,s60,s34
s_waitcnt lgkmcnt(4)
s_barrier
v_smfmac_f32_16x16x64_bf16 v[40:43],v[48:51],a[32:39],v2
ds_read_b128 v[60:63],v3 offset:0
v_smfmac_f32_16x16x64_bf16 v[24:27],v[52:55],a[40:47],v2
ds_read_b128 v[64:67],v3 offset:1024
v_mov_b32 v17,1
v_smfmac_f32_16x16x64_bf16 v[28:31],v[52:55],a[48:55],v2
ds_read_b128 v[68:71],v4 offset:0
v_smfmac_f32_16x16x64_bf16 v[32:35],v[52:55],a[56:63],v2
s_mov_b64 exec,1
buffer_store_dword v17,v1,s[8:11],s79 offen sc1
s_mov_b64 exec,-1
v_smfmac_f32_16x16x64_bf16 v[36:39],v[52:55],a[64:71],v2
buffer_store_dwordx4 v[100:103],v6,s[8:11],s78 offen sc1
v_smfmac_f32_16x16x64_bf16 v[40:43],v[52:55],a[72:79],v2
buffer_store_dwordx2 v[104:105],v7,s[8:11],s78 offen sc1
s_waitcnt lgkmcnt(5)
v_smfmac_f32_16x16x64_bf16 v[44:47],v[48:51],v[72:79],v2
ds_read_b128 v[72:75],v21 offset:4096
s_waitcnt lgkmcnt(4)
v_smfmac_f32_16x16x64_bf16 v[44:47],v[52:55],v[80:87],v2
ds_read_b128 v[76:79],v21 offset:5120
s_waitcnt lgkmcnt(4)
v_smfmac_f32_16x16x64_bf16 v[24:27],v[60:63],a[80:87],v2
ds_read_b128 v[80:83],v21 offset:6144
s_and_b32 s79,s78,2147483648
v_smfmac_f32_16x16x64_bf16 v[28:31],v[60:63],a[88:95],v2
ds_read_b128 v[84:87],v21 offset:7168
s_or_b32 s79,s79,s30
v_smfmac_f32_16x16x64_bf16 v[32:35],v[60:63],a[96:103],v2
s_mov_b32 s78,2147483648
v_smfmac_f32_16x16x64_bf16 v[36:39],v[60:63],a[104:111],v2
v_smfmac_f32_16x16x64_bf16 v[40:43],v[60:63],a[112:119],v2
s_waitcnt lgkmcnt(2)
v_smfmac_f32_16x16x64_bf16 v[44:47],v[60:63],v[72:79],v2
ds_read_b128 v[60:63],v4 offset:1024
v_smfmac_f32_16x16x64_bf16 v[24:27],v[64:67],a[120:127],v2
ds_read_b128 v[72:75],v21 offset:8192
v_smfmac_f32_16x16x64_bf16 v[28:31],v[64:67],a[128:135],v2
ds_read_b128 v[76:79],v21 offset:9216
v_smfmac_f32_16x16x64_bf16 v[32:35],v[64:67],a[136:143],v2
v_smfmac_f32_16x16x64_bf16 v[36:39],v[64:67],a[144:151],v2
v_smfmac_f32_16x16x64_bf16 v[40:43],v[64:67],a[152:159],v2
s_waitcnt lgkmcnt(3)
v_smfmac_f32_16x16x64_bf16 v[44:47],v[64:67],v[80:87],v2
ds_read_b128 v[64:67],v5 offset:0
v_smfmac_f32_16x16x64_bf16 v[24:27],v[68:71],a[160:167],v2
ds_read_b128 v[80:83],v21 offset:10240
v_smfmac_f32_16x16x64_bf16 v[28:31],v[68:71],a[168:175],v2
ds_read_b128 v[84:87],v21 offset:11264
v_smfmac_f32_16x16x64_bf16 v[32:35],v[68:71],a[176:183],v2
v_smfmac_f32_16x16x64_bf16 v[36:39],v[68:71],a[184:191],v2
v_smfmac_f32_16x16x64_bf16 v[40:43],v[68:71],a[192:199],v2
s_waitcnt lgkmcnt(3)
v_smfmac_f32_16x16x64_bf16 v[44:47],v[68:71],v[72:79],v2
ds_read_b128 v[68:71],v5 offset:1024
v_smfmac_f32_16x16x64_bf16 v[24:27],v[60:63],a[200:207],v2
ds_read_b128 v[72:75],v21 offset:12288
v_smfmac_f32_16x16x64_bf16 v[28:31],v[60:63],a[208:215],v2
ds_read_b128 v[76:79],v21 offset:13312
v_smfmac_f32_16x16x64_bf16 v[32:35],v[60:63],a[216:223],v2
v_smfmac_f32_16x16x64_bf16 v[36:39],v[60:63],a[224:231],v2
v_smfmac_f32_16x16x64_bf16 v[40:43],v[60:63],a[232:239],v2
s_waitcnt lgkmcnt(3)
v_smfmac_f32_16x16x64_bf16 v[44:47],v[60:63],v[80:87],v2
ds_read_b128 v[60:63],v59 offset:0
v_smfmac_f32_16x16x64_bf16 v[24:27],v[64:67],a[240:247],v2
ds_read_b128 v[80:83],v21 offset:14336
v_smfmac_f32_16x16x64_bf16 v[28:31],v[64:67],a[248:255],v2
ds_read_b128 v[84:87],v21 offset:15360
v_smfmac_f32_16x16x64_bf16 v[32:35],v[64:67],v[112:119],v2
v_smfmac_f32_16x16x64_bf16 v[36:39],v[64:67],v[120:127],v2
v_smfmac_f32_16x16x64_bf16 v[40:43],v[64:67],v[128:135],v2
s_waitcnt lgkmcnt(3)
v_smfmac_f32_16x16x64_bf16 v[44:47],v[64:67],v[72:79],v2
ds_read_b128 v[64:67],v59 offset:1024
v_smfmac_f32_16x16x64_bf16 v[24:27],v[68:71],v[136:143],v2
ds_read_b128 v[72:75],v21 offset:16384
v_smfmac_f32_16x16x64_bf16 v[28:31],v[68:71],v[144:151],v2
ds_read_b128 v[76:79],v21 offset:17408
v_smfmac_f32_16x16x64_bf16 v[32:35],v[68:71],v[152:159],v2
v_smfmac_f32_16x16x64_bf16 v[36:39],v[68:71],v[160:167],v2
v_smfmac_f32_16x16x64_bf16 v[40:43],v[68:71],v[168:175],v2
s_waitcnt lgkmcnt(3)
v_smfmac_f32_16x16x64_bf16 v[44:47],v[68:71],v[80:87],v2
ds_read_b128 v[80:83],v21 offset:18432
v_smfmac_f32_16x16x64_bf16 v[24:27],v[60:63],v[176:183],v2
ds_read_b128 v[84:87],v21 offset:19456
v_smfmac_f32_16x16x64_bf16 v[28:31],v[60:63],v[184:191],v2
s_waitcnt lgkmcnt(4)
v_smfmac_f32_16x16x64_bf16 v[24:27],v[64:67],v[216:223],v2
v_smfmac_f32_16x16x64_bf16 v[28:31],v[64:67],v[224:231],v2
v_smfmac_f32_16x16x64_bf16 v[32:35],v[60:63],v[192:199],v2
v_smfmac_f32_16x16x64_bf16 v[36:39],v[60:63],v[200:207],v2
v_add_f32 v24,v24,v25
v_smfmac_f32_16x16x64_bf16 v[32:35],v[64:67],v[232:239],v2
v_add_f32 v26,v26,v27
v_smfmac_f32_16x16x64_bf16 v[36:39],v[64:67],v[240:247],v2
v_add_f32 v28,v28,v29
v_smfmac_f32_16x16x64_bf16 v[40:43],v[60:63],v[208:215],v2
v_add_f32 v30,v30,v31
s_waitcnt lgkmcnt(2)
v_smfmac_f32_16x16x64_bf16 v[44:47],v[60:63],v[72:79],v2
v_cvt_pk_bf16_f32 v100,v24,v26
v_smfmac_f32_16x16x64_bf16 v[40:43],v[64:67],v[248:255],v2
v_cvt_pk_bf16_f32 v101,v28,v30
s_waitcnt lgkmcnt(0)
v_smfmac_f32_16x16x64_bf16 v[44:47],v[64:67],v[80:87],v2
v_and_or_b32 v100,v100,-2,s57
v_add_f32 v32,v32,v33
v_add_f32 v34,v34,v35
v_add_f32 v36,v36,v37
v_add_f32 v38,v38,v39
v_cvt_pk_bf16_f32 v102,v32,v34
v_cvt_pk_bf16_f32 v103,v36,v38
v_and_or_b32 v102,v102,-2,s57
buffer_store_dwordx4 v[100:103],v6,s[8:11],s71 offen sc1
v_add_f32 v40,v40,v41
v_add_f32 v42,v42,v43
v_add_f32 v44,v44,v45
v_add_f32 v46,v46,v47
v_cvt_pk_bf16_f32 v104,v40,v42
v_cvt_pk_bf16_f32 v105,v44,v46
v_and_or_b32 v104,v104,-2,s57
buffer_store_dwordx2 v[104:105],v7,s[8:11],s71 offen sc1
s_lshl_b32 s60,s51,6
s_add_u32 s60,s60,s52
s_mul_i32 s78,s60,196608
s_add_u32 s78,s78,s85
s_lshl_b32 s60,s60,10
s_add_u32 s30,s60,s86
s_sub_u32 s60,s4,s5
s_cmp_gt_i32 s60,13
s_cselect_b32 s53,1,0
s_cmp_eq_u32 s4,64
s_cselect_b32 s53,1,s53
s_cmp_eq_u32 s53,0
s_cselect_b32 s54,s4,s5
s_addc_u32 s4,s4,0
s_add_u32 s5,s5,s53
s_and_b32 s60,s54,1
s_lshl2_add_u32 s60,s53,s60
s_lshl_b32 s68,s60,16
s_add_u32 s68,s68,s83
s_mul_i32 s59,s60,20480
s_add_u32 s59,s59,s6
s_lshl_b32 s69,s53,9
s_add_u32 s69,s69,s7
s_bfe_u32 s31,s54,65537
s_add_u32 s32,s54,1
s_cmp_lg_u32 s53,s51
s_cbranch_scc1 nx_147
s_waitcnt vmcnt(0)
s_cmp_ge_u32 s79,2147483648
s_cbranch_scc1 pf_148
v_mov_b32 v17,1
s_mov_b64 exec,1
buffer_store_dword v17,v1,s[8:11],s79 offen sc1
s_mov_b64 exec,-1
s_mov_b32 s79,2147483648
pf_148:
s_cmp_eq_u32 s78,2147483648
s_cbranch_scc1 pk_149
buffer_store_dwordx4 v[100:103],v6,s[8:11],s78 offen sc1
buffer_store_dwordx2 v[104:105],v7,s[8:11],s78 offen sc1
s_mov_b32 s79,s30
s_mov_b32 s78,2147483648
pk_149:
s_waitcnt vmcnt(0)
s_cmp_ge_u32 s79,2147483648
s_cbranch_scc1 pf_150
v_mov_b32 v17,1
s_mov_b64 exec,1
buffer_store_dword v17,v1,s[8:11],s79 offen sc1
s_mov_b64 exec,-1
s_mov_b32 s79,2147483648
pf_150:
nx_147:
s_add_u32 s50,s50,1
s_mov_b32 s51,s53
s_mov_b32 s52,s54
s_mov_b32 s57,s31
s_mov_b32 s58,s32
s_cmp_lt_u32 s50,128
s_cbranch_scc1 CV_LOOP_S0
s_branch CV_DONE
fr_142:
v_bitop3_b32 v12,v60,v64,s57 bitop3:0x7e
v_bitop3_b32 v13,v68,v68,s57 bitop3:0x7e
v_xor_b32 v14,s57,v68
v_or3_b32 v12,v12,v13,v14
v_and_b32 v12,1,v12
v_cmp_ne_u32 vcc,0,v12
s_cbranch_vccz sk_151
buffer_load_dwordx2 v[68:69],v18,s[8:11],s59 offen sc1
buffer_load_dwordx4 v[60:63],v1,s[8:11],s59 offen sc1
buffer_load_dwordx4 v[64:67],v1,s[8:11],s59 offen offset:1024 sc1
sk_151:
buffer_load_dwordx2 v[78:79],v18,s[8:11],s68 offen sc1
buffer_load_dwordx4 v[70:73],v1,s[8:11],s68 offen sc1
buffer_load_dwordx4 v[74:77],v1,s[8:11],s68 offen offset:1024 sc1
s_sub_u32 s47,s47,1
s_cbranch_scc1 ABORT
s_waitcnt lgkmcnt(0)
s_branch fa_141
CV_LOOP_S1:
v_mov_b32 v24,0
v_mov_b32 v25,0
v_mov_b32 v26,0
v_mov_b32 v27,0
v_mov_b32 v28,0
v_mov_b32 v29,0
v_mov_b32 v30,0
v_mov_b32 v31,0
v_mov_b32 v32,0
v_mov_b32 v33,0
v_mov_b32 v34,0
v_mov_b32 v35,0
v_mov_b32 v36,0
v_mov_b32 v37,0
v_mov_b32 v38,0
v_mov_b32 v39,0
v_mov_b32 v40,0
v_mov_b32 v41,0
v_mov_b32 v42,0
v_mov_b32 v43,0
v_mov_b32 v44,0
v_mov_b32 v45,0
v_mov_b32 v46,0
v_mov_b32 v47,0
s_barrier
buffer_load_dwordx2 v[68:69],v18,s[8:11],s59 offen sc1
buffer_load_dwordx4 v[60:63],v1,s[8:11],s59 offen sc1
buffer_load_dwordx4 v[64:67],v1,s[8:11],s59 offen offset:1024 sc1
s_waitcnt vmcnt(2)
s_sleep 3
fj_154f:
buffer_load_dwordx2 v[78:79],v18,s[8:11],s68 offen sc1
buffer_load_dwordx4 v[70:73],v1,s[8:11],s68 offen sc1
buffer_load_dwordx4 v[74:77],v1,s[8:11],s68 offen offset:1024 sc1
fj_154:
fa_152:
s_waitcnt vmcnt(5)
v_lshlrev_b32 v96,16,v68
v_and_b32 v97,0xffff0000,v68
v_lshlrev_b32 v98,16,v69
v_and_b32 v99,0xffff0000,v69
s_waitcnt vmcnt(4)
v_lshlrev_b32 v80,16,v60
v_and_b32 v81,0xffff0000,v60
v_lshlrev_b32 v82,16,v61
v_and_b32 v83,0xffff0000,v61
v_lshlrev_b32 v84,16,v62
v_and_b32 v85,0xffff0000,v62
v_lshlrev_b32 v86,16,v63
v_and_b32 v87,0xffff0000,v63
s_waitcnt vmcnt(3)
v_lshlrev_b32 v88,16,v64
v_and_b32 v89,0xffff0000,v64
v_lshlrev_b32 v90,16,v65
v_and_b32 v91,0xffff0000,v65
v_lshlrev_b32 v92,16,v66
v_and_b32 v93,0xffff0000,v66
v_lshlrev_b32 v94,16,v67
v_and_b32 v95,0xffff0000,v67
s_waitcnt vmcnt(2)
v_dot2c_f32_bf16 v96,s37,v78
v_dot2c_f32_bf16 v97,s81,v78
v_dot2c_f32_bf16 v98,s37,v79
v_dot2c_f32_bf16 v99,s81,v79
v_bitop3_b32 v16,v68,v78,s57 bitop3:0x7e
v_cvt_pk_bf16_f32 v56,v96,v97
s_nop 0
v_cvt_pk_bf16_f32 v57,v98,v99
ds_write_b64 v23,v[56:57]
s_waitcnt vmcnt(1)
v_dot2c_f32_bf16 v80,s37,v70
v_dot2c_f32_bf16 v81,s81,v70
v_dot2c_f32_bf16 v82,s37,v71
v_dot2c_f32_bf16 v83,s81,v71
v_dot2c_f32_bf16 v84,s37,v72
v_dot2c_f32_bf16 v85,s81,v72
v_dot2c_f32_bf16 v86,s37,v73
v_dot2c_f32_bf16 v87,s81,v73
v_bitop3_b32 v17,v60,v70,s57 bitop3:0x7e
v_or_b32 v16,v16,v17
v_cvt_pk_bf16_f32 v48,v80,v81
v_cvt_pk_bf16_f32 v49,v82,v83
v_cvt_pk_bf16_f32 v50,v84,v85
v_cvt_pk_bf16_f32 v51,v86,v87
ds_write_b128 v22,v[48:51] offset:0
s_waitcnt vmcnt(0)
v_dot2c_f32_bf16 v88,s37,v74
v_dot2c_f32_bf16 v89,s81,v74
v_dot2c_f32_bf16 v90,s37,v75
v_dot2c_f32_bf16 v91,s81,v75
v_dot2c_f32_bf16 v92,s37,v76
v_dot2c_f32_bf16 v93,s81,v76
v_dot2c_f32_bf16 v94,s37,v77
v_dot2c_f32_bf16 v95,s81,v77
v_bitop3_b32 v17,v64,v74,s57 bitop3:0x7e
v_bitop3_b32 v16,v16,v17,1 bitop3:0xa8
v_cmp_ne_u32 vcc,0,v16
v_cvt_pk_bf16_f32 v52,v88,v89
v_cvt_pk_bf16_f32 v53,v90,v91
v_cvt_pk_bf16_f32 v54,v92,v93
v_cvt_pk_bf16_f32 v55,v94,v95
ds_write_b128 v22,v[52:55] offset:1024
s_cbranch_vccnz fr_153
fj_154g:
v_smfmac_f32_16x16x64_bf16 v[24:27],v[48:51],a[0:7],v2
ds_read_b128 v[72:75],v21 offset:0
s_and_b32 s60,s52,1
v_smfmac_f32_16x16x64_bf16 v[28:31],v[48:51],a[8:15],v2
ds_read_b128 v[76:79],v21 offset:1024
s_lshl2_add_u32 s60,s51,s60
v_smfmac_f32_16x16x64_bf16 v[32:35],v[48:51],a[16:23],v2
ds_read_b128 v[80:83],v21 offset:2048
s_mul_i32 s60,s60,49152
v_smfmac_f32_16x16x64_bf16 v[36:39],v[48:51],a[24:31],v2
ds_read_b128 v[84:87],v21 offset:3072
s_add_u32 s71,s60,s34
s_waitcnt lgkmcnt(4)
s_barrier
v_smfmac_f32_16x16x64_bf16 v[40:43],v[48:51],a[32:39],v2
ds_read_b128 v[60:63],v3 offset:0
v_smfmac_f32_16x16x64_bf16 v[24:27],v[52:55],a[40:47],v2
ds_read_b128 v[64:67],v3 offset:1024
v_mov_b32 v17,1
v_smfmac_f32_16x16x64_bf16 v[28:31],v[52:55],a[48:55],v2
ds_read_b128 v[68:71],v4 offset:0
v_smfmac_f32_16x16x64_bf16 v[32:35],v[52:55],a[56:63],v2
s_mov_b64 exec,1
buffer_store_dword v17,v1,s[8:11],s79 offen sc1
s_mov_b64 exec,-1
v_smfmac_f32_16x16x64_bf16 v[36:39],v[52:55],a[64:71],v2
buffer_store_dwordx4 v[102:105],v6,s[8:11],s78 offen sc1
v_smfmac_f32_16x16x64_bf16 v[40:43],v[52:55],a[72:79],v2
buffer_store_dwordx2 v[100:101],v7,s[8:11],s78 offen sc1
s_waitcnt lgkmcnt(5)
v_smfmac_f32_16x16x64_bf16 v[44:47],v[48:51],v[72:79],v2
ds_read_b128 v[72:75],v21 offset:4096
s_waitcnt lgkmcnt(4)
v_smfmac_f32_16x16x64_bf16 v[44:47],v[52:55],v[80:87],v2
ds_read_b128 v[76:79],v21 offset:5120
s_waitcnt lgkmcnt(4)
v_smfmac_f32_16x16x64_bf16 v[24:27],v[60:63],a[80:87],v2
ds_read_b128 v[80:83],v21 offset:6144
s_and_b32 s79,s78,2147483648
v_smfmac_f32_16x16x64_bf16 v[28:31],v[60:63],a[88:95],v2
ds_read_b128 v[84:87],v21 offset:7168
s_or_b32 s79,s79,s30
v_smfmac_f32_16x16x64_bf16 v[32:35],v[60:63],a[96:103],v2
s_mov_b32 s78,2147483648
v_smfmac_f32_16x16x64_bf16 v[36:39],v[60:63],a[104:111],v2
v_smfmac_f32_16x16x64_bf16 v[40:43],v[60:63],a[112:119],v2
s_waitcnt lgkmcnt(2)
v_smfmac_f32_16x16x64_bf16 v[44:47],v[60:63],v[72:79],v2
ds_read_b128 v[60:63],v4 offset:1024
v_smfmac_f32_16x16x64_bf16 v[24:27],v[64:67],a[120:127],v2
ds_read_b128 v[72:75],v21 offset:8192
v_smfmac_f32_16x16x64_bf16 v[28:31],v[64:67],a[128:135],v2
ds_read_b128 v[76:79],v21 offset:9216
v_smfmac_f32_16x16x64_bf16 v[32:35],v[64:67],a[136:143],v2
v_smfmac_f32_16x16x64_bf16 v[36:39],v[64:67],a[144:151],v2
v_smfmac_f32_16x16x64_bf16 v[40:43],v[64:67],a[152:159],v2
s_waitcnt lgkmcnt(3)
v_smfmac_f32_16x16x64_bf16 v[44:47],v[64:67],v[80:87],v2
ds_read_b128 v[64:67],v5 offset:0
v_smfmac_f32_16x16x64_bf16 v[24:27],v[68:71],a[160:167],v2
ds_read_b128 v[80:83],v21 offset:10240
v_smfmac_f32_16x16x64_bf16 v[28:31],v[68:71],a[168:175],v2
ds_read_b128 v[84:87],v21 offset:11264
v_smfmac_f32_16x16x64_bf16 v[32:35],v[68:71],a[176:183],v2
v_smfmac_f32_16x16x64_bf16 v[36:39],v[68:71],a[184:191],v2
v_smfmac_f32_16x16x64_bf16 v[40:43],v[68:71],a[192:199],v2
s_waitcnt lgkmcnt(3)
v_smfmac_f32_16x16x64_bf16 v[44:47],v[68:71],v[72:79],v2
ds_read_b128 v[68:71],v5 offset:1024
v_smfmac_f32_16x16x64_bf16 v[24:27],v[60:63],a[200:207],v2
ds_read_b128 v[72:75],v21 offset:12288
v_smfmac_f32_16x16x64_bf16 v[28:31],v[60:63],a[208:215],v2
ds_read_b128 v[76:79],v21 offset:13312
v_smfmac_f32_16x16x64_bf16 v[32:35],v[60:63],a[216:223],v2
v_smfmac_f32_16x16x64_bf16 v[36:39],v[60:63],a[224:231],v2
v_smfmac_f32_16x16x64_bf16 v[40:43],v[60:63],a[232:239],v2
s_waitcnt lgkmcnt(3)
v_smfmac_f32_16x16x64_bf16 v[44:47],v[60:63],v[80:87],v2
ds_read_b128 v[60:63],v59 offset:0
v_smfmac_f32_16x16x64_bf16 v[24:27],v[64:67],a[240:247],v2
ds_read_b128 v[80:83],v21 offset:14336
v_smfmac_f32_16x16x64_bf16 v[28:31],v[64:67],a[248:255],v2
ds_read_b128 v[84:87],v21 offset:15360
v_smfmac_f32_16x16x64_bf16 v[32:35],v[64:67],v[112:119],v2
v_smfmac_f32_16x16x64_bf16 v[36:39],v[64:67],v[120:127],v2
v_smfmac_f32_16x16x64_bf16 v[40:43],v[64:67],v[128:135],v2
s_waitcnt lgkmcnt(3)
v_smfmac_f32_16x16x64_bf16 v[44:47],v[64:67],v[72:79],v2
ds_read_b128 v[64:67],v59 offset:1024
v_smfmac_f32_16x16x64_bf16 v[24:27],v[68:71],v[136:143],v2
ds_read_b128 v[72:75],v21 offset:16384
v_smfmac_f32_16x16x64_bf16 v[28:31],v[68:71],v[144:151],v2
ds_read_b128 v[76:79],v21 offset:17408
v_smfmac_f32_16x16x64_bf16 v[32:35],v[68:71],v[152:159],v2
v_smfmac_f32_16x16x64_bf16 v[36:39],v[68:71],v[160:167],v2
v_smfmac_f32_16x16x64_bf16 v[40:43],v[68:71],v[168:175],v2
s_waitcnt lgkmcnt(3)
v_smfmac_f32_16x16x64_bf16 v[44:47],v[68:71],v[80:87],v2
ds_read_b128 v[80:83],v21 offset:18432
v_smfmac_f32_16x16x64_bf16 v[24:27],v[60:63],v[176:183],v2
ds_read_b128 v[84:87],v21 offset:19456
v_smfmac_f32_16x16x64_bf16 v[28:31],v[60:63],v[184:191],v2
s_waitcnt lgkmcnt(4)
v_smfmac_f32_16x16x64_bf16 v[24:27],v[64:67],v[216:223],v2
v_smfmac_f32_16x16x64_bf16 v[28:31],v[64:67],v[224:231],v2
v_smfmac_f32_16x16x64_bf16 v[32:35],v[60:63],v[192:199],v2
v_smfmac_f32_16x16x64_bf16 v[36:39],v[60:63],v[200:207],v2
v_add_f32 v24,v24,v25
v_smfmac_f32_16x16x64_bf16 v[32:35],v[64:67],v[232:239],v2
v_add_f32 v26,v26,v27
v_smfmac_f32_16x16x64_bf16 v[36:39],v[64:67],v[240:247],v2
v_add_f32 v28,v28,v29
v_smfmac_f32_16x16x64_bf16 v[40:43],v[60:63],v[208:215],v2
v_add_f32 v30,v30,v31
s_waitcnt lgkmcnt(2)
v_smfmac_f32_16x16x64_bf16 v[44:47],v[60:63],v[72:79],v2
v_cvt_pk_bf16_f32 v100,v24,v26
v_smfmac_f32_16x16x64_bf16 v[40:43],v[64:67],v[248:255],v2
v_cvt_pk_bf16_f32 v101,v28,v30
s_waitcnt lgkmcnt(0)
v_smfmac_f32_16x16x64_bf16 v[44:47],v[64:67],v[80:87],v2
v_and_or_b32 v100,v100,-2,s57
buffer_store_dwordx2 v[100:101],v7,s[8:11],s71 offen sc1
v_add_f32 v32,v32,v33
v_add_f32 v34,v34,v35
v_add_f32 v36,v36,v37
v_add_f32 v38,v38,v39
v_cvt_pk_bf16_f32 v102,v32,v34
v_cvt_pk_bf16_f32 v103,v36,v38
v_and_or_b32 v102,v102,-2,s57
v_add_f32 v40,v40,v41
v_add_f32 v42,v42,v43
v_add_f32 v44,v44,v45
v_add_f32 v46,v46,v47
v_cvt_pk_bf16_f32 v104,v40,v42
v_cvt_pk_bf16_f32 v105,v44,v46
v_and_or_b32 v104,v104,-2,s57
buffer_store_dwordx4 v[102:105],v6,s[8:11],s71 offen sc1
s_lshl_b32 s60,s51,6
s_add_u32 s60,s60,s52
s_mul_i32 s78,s60,196608
s_add_u32 s78,s78,s85
s_lshl_b32 s60,s60,10
s_add_u32 s30,s60,s86
s_sub_u32 s60,s4,s5
s_cmp_gt_i32 s60,13
s_cselect_b32 s53,1,0
s_cmp_eq_u32 s4,64
s_cselect_b32 s53,1,s53
s_cmp_eq_u32 s53,0
s_cselect_b32 s54,s4,s5
s_addc_u32 s4,s4,0
s_add_u32 s5,s5,s53
s_and_b32 s60,s54,1
s_lshl2_add_u32 s60,s53,s60
s_lshl_b32 s68,s60,16
s_add_u32 s68,s68,s83
s_mul_i32 s59,s60,20480
s_add_u32 s59,s59,s6
s_lshl_b32 s69,s53,9
s_add_u32 s69,s69,s7
s_bfe_u32 s31,s54,65537
s_add_u32 s32,s54,1
s_cmp_lg_u32 s53,s51
s_cbranch_scc1 nx_155
s_waitcnt vmcnt(0)
s_cmp_ge_u32 s79,2147483648
s_cbranch_scc1 pf_156
v_mov_b32 v17,1
s_mov_b64 exec,1
buffer_store_dword v17,v1,s[8:11],s79 offen sc1
s_mov_b64 exec,-1
s_mov_b32 s79,2147483648
pf_156:
s_cmp_eq_u32 s78,2147483648
s_cbranch_scc1 pk_157
buffer_store_dwordx4 v[102:105],v6,s[8:11],s78 offen sc1
buffer_store_dwordx2 v[100:101],v7,s[8:11],s78 offen sc1
s_mov_b32 s79,s30
s_mov_b32 s78,2147483648
pk_157:
s_waitcnt vmcnt(0)
s_cmp_ge_u32 s79,2147483648
s_cbranch_scc1 pf_158
v_mov_b32 v17,1
s_mov_b64 exec,1
buffer_store_dword v17,v1,s[8:11],s79 offen sc1
s_mov_b64 exec,-1
s_mov_b32 s79,2147483648
pf_158:
nx_155:
s_add_u32 s50,s50,1
s_mov_b32 s51,s53
s_mov_b32 s52,s54
s_mov_b32 s57,s31
s_mov_b32 s58,s32
s_cmp_lt_u32 s50,128
s_cbranch_scc1 CV_LOOP_S1
s_branch CV_DONE
fr_153:
v_bitop3_b32 v12,v60,v64,s57 bitop3:0x7e
v_bitop3_b32 v13,v68,v68,s57 bitop3:0x7e
v_xor_b32 v14,s57,v68
v_or3_b32 v12,v12,v13,v14
v_and_b32 v12,1,v12
v_cmp_ne_u32 vcc,0,v12
s_cbranch_vccz sk_159
buffer_load_dwordx2 v[68:69],v18,s[8:11],s59 offen sc1
buffer_load_dwordx4 v[60:63],v1,s[8:11],s59 offen sc1
buffer_load_dwordx4 v[64:67],v1,s[8:11],s59 offen offset:1024 sc1
sk_159:
buffer_load_dwordx2 v[78:79],v18,s[8:11],s68 offen sc1
buffer_load_dwordx4 v[70:73],v1,s[8:11],s68 offen sc1
buffer_load_dwordx4 v[74:77],v1,s[8:11],s68 offen offset:1024 sc1
s_sub_u32 s47,s47,1
s_cbranch_scc1 ABORT
s_waitcnt lgkmcnt(0)
s_branch fa_152
CV_DONE:
s_add_u32 s61,s48,32
s_endpgm
ROLE_CW:
s_lshr_b32 s28,s48,3
s_and_b32 s29,s48,7
s_mul_i32 s82,s28,2097152
s_add_u32 s82,s82,2097152
v_lshlrev_b32 v1,4,v0
v_and_b32 v12,1,v0
v_mul_u32_u24 v2,0xaaaa,v12
v_or_b32 v2,0x4444,v2
v_lshrrev_b32 v14,4,v0
v_and_b32 v15,15,v0
v_min_u32 v3,11,v15
v_lshlrev_b32 v3,2,v3
v_lshl_add_u32 v3,v14,7,v3
s_mul_i32 s60,s46,24576
v_add_u32 v4,s60,v1
v_mul_u32_u24 v5,704,v14
v_and_b32 v12,3,v15
v_lshl_add_u32 v5,v12,2,v5
v_bfe_u32 v12,v15,2,1
v_lshl_add_u32 v5,v12,5,v5
v_bfe_u32 v12,v15,3,1
v_lshl_add_u32 v5,v12,4,v5
s_mul_i32 s60,s46,2816
s_add_u32 s60,s60,98304
v_add_u32 v5,s60,v5
s_mul_i32 s60,s46,24
s_min_u32 s60,s60,64
s_cmp_lt_u32 s46,2
s_cselect_b32 s61,23,15
s_mov_b32 s88,0xffff
s_cselect_b32 s88,0xffffff,s88
s_mov_b32 s89,0
v_and_b32 v12,31,v0
v_min_u32 v12,s61,v12
v_add_u32 v12,s60,v12
v_lshrrev_b32 v13,5,v0
v_lshl_add_u32 v12,v12,1,v13
v_bfe_u32 v13,v12,2,3
v_mul_u32_u24 v6,352,v13
v_mul_u32_u24 v17,1280,v13
v_lshrrev_b32 v13,5,v12
v_lshl_add_u32 v6,v13,6,v6
v_lshl_add_u32 v17,v13,5,v17
v_and_b32 v13,3,v12
v_lshl_add_u32 v17,v13,3,v17
v_and_b32 v13,1,v12
v_lshl_add_u32 v6,v13,5,v6
v_bfe_u32 v13,v12,1,1
v_lshl_add_u32 v6,v13,4,v6
v_add_u32 v6,98304,v6
s_mul_i32 s60,s29,1280
v_lshlrev_b32 v9,3,v12
v_add_u32 v9,s60,v9
v_lshrrev_b32 v13,13,v9
v_lshl_add_u32 v9,v13,13,v9
v_xor_b32 v10,1,v12
v_or_b32 v10,v10,v13
v_and_b32 v10,1,v10
s_mov_b32 s4,s18
s_mov_b32 s5,s19
s_mov_b32 s6,10240
s_mov_b32 s7,0x20000
s_mul_i32 s60,s29,160
buffer_load_dwordx2 v[32:33],v17,s[4:7],s60 offen
s_mul_i32 s84,s29,0
s_add_u32 s84,s84,s82
s_lshl_b32 s83,s28,19
s_lshr_b32 s60,s29,1
s_and_b32 s61,s29,1
s_mul_i32 s62,s61,0
s_add_u32 s83,s83,s62
s_add_u32 s83,s83,10485760
s_lshl_b32 s85,s60,7
s_lshl_b32 s61,s61,2
s_add_u32 s61,s61,s46
s_lshl_b32 s61,s61,2
s_add_u32 s85,s85,s61
s_add_u32 s85,s85,s82
s_add_u32 s85,s85,950272
s_mul_i32 s33,s46,12288
s_add_u32 s33,s33,s82
s_add_u32 s33,s33,163840
s_mov_b32 s35,0
s_add_u32 s35,s35,s82
s_add_u32 s35,s35,951296
s_cmp_eq_u32 s28,0
s_cselect_b32 s63,0xffff0000,0
s_waitcnt vmcnt(0)
s_cselect_b64 vcc,-1,0
v_bfi_b32 v36,v10,0,v32
v_lshlrev_b32 v34,16,v32
v_lshlrev_b32 v35,16,v36
v_sub_f32 v34,v34,v35
v_lshrrev_b32 v34,16,v34
v_and_b32 v34,-2,v34
v_cndmask_b32 v36,v34,v36,vcc
v_cndmask_b32 v37,0,v33,vcc
s_nop 0
v_permlane32_swap_b32 v36,v38
v_permlane32_swap_b32 v37,v39
v_mov_b32 v40,-1
v_mov_b32 v41,-1
v_mov_b32 v42,-1
v_mov_b32 v43,-1
v_mov_b32 v44,1
s_mov_b64 exec,s[88:89]
s_add_u32 s60,s83,0
buffer_store_dwordx4 v[36:39],v9,s[8:11],s60 offen sc1
s_add_u32 s60,s83,8192
buffer_store_dwordx4 v[36:39],v9,s[8:11],s60 offen sc1
s_add_u32 s60,s83,65536
buffer_store_dwordx4 v[40:43],v9,s[8:11],s60 offen sc1
s_add_u32 s60,s83,73728
buffer_store_dwordx4 v[40:43],v9,s[8:11],s60 offen sc1
s_add_u32 s60,s83,131072
buffer_store_dwordx4 v[40:43],v9,s[8:11],s60 offen sc1
s_add_u32 s60,s83,139264
buffer_store_dwordx4 v[40:43],v9,s[8:11],s60 offen sc1
s_add_u32 s60,s83,196608
buffer_store_dwordx4 v[40:43],v9,s[8:11],s60 offen sc1
s_add_u32 s60,s83,204800
buffer_store_dwordx4 v[40:43],v9,s[8:11],s60 offen sc1
s_add_u32 s60,s83,262144
buffer_store_dwordx4 v[36:39],v9,s[8:11],s60 offen sc1
s_add_u32 s60,s83,270336
buffer_store_dwordx4 v[36:39],v9,s[8:11],s60 offen sc1
s_add_u32 s60,s83,327680
buffer_store_dwordx4 v[40:43],v9,s[8:11],s60 offen sc1
s_add_u32 s60,s83,335872
buffer_store_dwordx4 v[40:43],v9,s[8:11],s60 offen sc1
s_add_u32 s60,s83,393216
buffer_store_dwordx4 v[40:43],v9,s[8:11],s60 offen sc1
s_add_u32 s60,s83,401408
buffer_store_dwordx4 v[40:43],v9,s[8:11],s60 offen sc1
s_add_u32 s60,s83,458752
buffer_store_dwordx4 v[40:43],v9,s[8:11],s60 offen sc1
s_add_u32 s60,s83,466944
buffer_store_dwordx4 v[40:43],v9,s[8:11],s60 offen sc1
s_cmp_lg_u32 s49,0
s_cbranch_scc1 ls_160
s_add_u32 s60,s84,0
buffer_store_dwordx4 v[36:39],v9,s[8:11],s60 offen
s_add_u32 s60,s84,20480
buffer_store_dwordx4 v[40:43],v9,s[8:11],s60 offen
s_add_u32 s60,s84,40960
buffer_store_dwordx4 v[40:43],v9,s[8:11],s60 offen
s_add_u32 s60,s84,61440
buffer_store_dwordx4 v[40:43],v9,s[8:11],s60 offen
s_add_u32 s60,s84,81920
buffer_store_dwordx4 v[36:39],v9,s[8:11],s60 offen
s_add_u32 s60,s84,102400
buffer_store_dwordx4 v[40:43],v9,s[8:11],s60 offen
s_add_u32 s60,s84,122880
buffer_store_dwordx4 v[40:43],v9,s[8:11],s60 offen
s_add_u32 s60,s84,143360
buffer_store_dwordx4 v[40:43],v9,s[8:11],s60 offen
s_mov_b64 exec,1
buffer_store_dword v44,v1,s[8:11],s85 offen
buffer_store_dword v44,v1,s[8:11],s85 offen offset:512
s_branch ls_161
ls_160:
s_add_u32 s60,s84,0
buffer_store_dwordx4 v[36:39],v9,s[8:11],s60 offen sc1
s_add_u32 s60,s84,20480
buffer_store_dwordx4 v[40:43],v9,s[8:11],s60 offen sc1
s_add_u32 s60,s84,40960
buffer_store_dwordx4 v[40:43],v9,s[8:11],s60 offen sc1
s_add_u32 s60,s84,61440
buffer_store_dwordx4 v[40:43],v9,s[8:11],s60 offen sc1
s_add_u32 s60,s84,81920
buffer_store_dwordx4 v[36:39],v9,s[8:11],s60 offen sc1
s_add_u32 s60,s84,102400
buffer_store_dwordx4 v[40:43],v9,s[8:11],s60 offen sc1
s_add_u32 s60,s84,122880
buffer_store_dwordx4 v[40:43],v9,s[8:11],s60 offen sc1
s_add_u32 s60,s84,143360
buffer_store_dwordx4 v[40:43],v9,s[8:11],s60 offen sc1
s_mov_b64 exec,1
buffer_store_dword v44,v1,s[8:11],s85 offen sc1
buffer_store_dword v44,v1,s[8:11],s85 offen offset:512 sc1
ls_161:
s_mov_b64 exec,-1
s_waitcnt vmcnt(0)
s_barrier
s_cmp_lg_u32 s46,0
s_cbranch_scc1 arr_162
v_mov_b32 v12,1
s_lshl_b32 s3,s49,2
v_mov_b32 v13,s3
s_mov_b64 exec,1
buffer_atomic_add v12,v13,s[12:15],0 offen sc1
s_mov_b64 exec,-1
arr_162:
s_mov_b32 s4,s26
s_mov_b32 s5,s27
s_mov_b32 s6,7864320
s_mov_b32 s7,0x20000
s_lshl_b32 s60,s28,2
s_add_u32 s60,s60,s46
s_mul_i32 s73,s60,983040
s_mul_i32 s60,s29,160
s_add_u32 s73,s73,s60
s_mul_i32 s74,s46,40960
v_add_u32 v12,0,v0
v_mul_u32_u24 v13,6554,v12
v_lshrrev_b32 v13,16,v13
v_mul_u32_u24 v16,10,v13
v_sub_u32 v12,v12,v16
v_mul_u32_u24 v20,1280,v13
v_lshl_add_u32 v20,v12,4,v20
v_add_u32 v12,64,v0
v_mul_u32_u24 v13,6554,v12
v_lshrrev_b32 v13,16,v13
v_mul_u32_u24 v16,10,v13
v_sub_u32 v12,v12,v16
v_mul_u32_u24 v21,1280,v13
v_lshl_add_u32 v21,v12,4,v21
v_add_u32 v12,128,v0
v_mul_u32_u24 v13,6554,v12
v_lshrrev_b32 v13,16,v13
v_mul_u32_u24 v16,10,v13
v_sub_u32 v12,v12,v16
v_mul_u32_u24 v22,1280,v13
v_lshl_add_u32 v22,v12,4,v22
v_add_u32 v12,192,v0
v_mul_u32_u24 v13,6554,v12
v_lshrrev_b32 v13,16,v13
v_mul_u32_u24 v16,10,v13
v_sub_u32 v12,v12,v16
v_mul_u32_u24 v23,1280,v13
v_lshl_add_u32 v23,v12,4,v23
v_add_u32 v12,256,v0
v_mul_u32_u24 v13,6554,v12
v_lshrrev_b32 v13,16,v13
v_mul_u32_u24 v16,10,v13
v_sub_u32 v12,v12,v16
v_mul_u32_u24 v24,1280,v13
v_lshl_add_u32 v24,v12,4,v24
v_add_u32 v12,320,v0
v_mul_u32_u24 v13,6554,v12
v_lshrrev_b32 v13,16,v13
v_mul_u32_u24 v16,10,v13
v_sub_u32 v12,v12,v16
v_mul_u32_u24 v25,1280,v13
v_lshl_add_u32 v25,v12,4,v25
v_add_u32 v12,384,v0
v_mul_u32_u24 v13,6554,v12
v_lshrrev_b32 v13,16,v13
v_mul_u32_u24 v16,10,v13
v_sub_u32 v12,v12,v16
v_mul_u32_u24 v26,1280,v13
v_lshl_add_u32 v26,v12,4,v26
v_add_u32 v12,448,v0
v_mul_u32_u24 v13,6554,v12
v_lshrrev_b32 v13,16,v13
v_mul_u32_u24 v16,10,v13
v_sub_u32 v12,v12,v16
v_mul_u32_u24 v27,1280,v13
v_lshl_add_u32 v27,v12,4,v27
v_add_u32 v12,512,v0
v_mul_u32_u24 v13,6554,v12
v_lshrrev_b32 v13,16,v13
v_mul_u32_u24 v16,10,v13
v_sub_u32 v12,v12,v16
v_mul_u32_u24 v28,1280,v13
v_lshl_add_u32 v28,v12,4,v28
v_add_u32 v12,576,v0
v_mul_u32_u24 v13,6554,v12
v_lshrrev_b32 v13,16,v13
v_mul_u32_u24 v16,10,v13
v_sub_u32 v12,v12,v16
v_mul_u32_u24 v29,1280,v13
v_lshl_add_u32 v29,v12,4,v29
v_lshrrev_b32 v14,4,v0
v_and_b32 v12,1,v14
v_lshlrev_b32 v12,5,v12
v_lshrrev_b32 v13,1,v14
v_lshl_add_u32 v12,v13,2,v12
v_bfe_u32 v13,v0,2,1
v_add_u32 v12,v12,v13
v_bfe_u32 v13,v0,3,1
v_lshl_add_u32 v12,v13,4,v12
v_mul_u32_u24 v30,160,v12
v_and_b32 v13,3,v0
v_lshl_add_u32 v30,v13,3,v30
v_add_u32 v30,s74,v30
s_add_u32 s61,s73,0
s_add_u32 m0,s74,0
s_nop 0
buffer_load_dwordx4 v20,s[4:7],s61 offen lds
s_add_u32 m0,s74,1024
s_nop 0
buffer_load_dwordx4 v21,s[4:7],s61 offen lds
s_add_u32 m0,s74,2048
s_nop 0
buffer_load_dwordx4 v22,s[4:7],s61 offen lds
s_add_u32 m0,s74,3072
s_nop 0
buffer_load_dwordx4 v23,s[4:7],s61 offen lds
s_add_u32 m0,s74,4096
s_nop 0
buffer_load_dwordx4 v24,s[4:7],s61 offen lds
s_add_u32 m0,s74,5120
s_nop 0
buffer_load_dwordx4 v25,s[4:7],s61 offen lds
s_add_u32 m0,s74,6144
s_nop 0
buffer_load_dwordx4 v26,s[4:7],s61 offen lds
s_add_u32 m0,s74,7168
s_nop 0
buffer_load_dwordx4 v27,s[4:7],s61 offen lds
s_add_u32 m0,s74,8192
s_nop 0
buffer_load_dwordx4 v28,s[4:7],s61 offen lds
s_add_u32 m0,s74,9216
s_nop 0
buffer_load_dwordx4 v29,s[4:7],s61 offen lds
s_add_u32 s61,s73,81920
s_add_u32 m0,s74,10240
s_nop 0
buffer_load_dwordx4 v20,s[4:7],s61 offen lds
s_add_u32 m0,s74,11264
s_nop 0
buffer_load_dwordx4 v21,s[4:7],s61 offen lds
s_add_u32 m0,s74,12288
s_nop 0
buffer_load_dwordx4 v22,s[4:7],s61 offen lds
s_add_u32 m0,s74,13312
s_nop 0
buffer_load_dwordx4 v23,s[4:7],s61 offen lds
s_add_u32 m0,s74,14336
s_nop 0
buffer_load_dwordx4 v24,s[4:7],s61 offen lds
s_add_u32 m0,s74,15360
s_nop 0
buffer_load_dwordx4 v25,s[4:7],s61 offen lds
s_add_u32 m0,s74,16384
s_nop 0
buffer_load_dwordx4 v26,s[4:7],s61 offen lds
s_add_u32 m0,s74,17408
s_nop 0
buffer_load_dwordx4 v27,s[4:7],s61 offen lds
s_add_u32 m0,s74,18432
s_nop 0
buffer_load_dwordx4 v28,s[4:7],s61 offen lds
s_add_u32 m0,s74,19456
s_nop 0
buffer_load_dwordx4 v29,s[4:7],s61 offen lds
s_add_u32 s61,s73,163840
s_add_u32 m0,s74,20480
s_nop 0
buffer_load_dwordx4 v20,s[4:7],s61 offen lds
s_add_u32 m0,s74,21504
s_nop 0
buffer_load_dwordx4 v21,s[4:7],s61 offen lds
s_add_u32 m0,s74,22528
s_nop 0
buffer_load_dwordx4 v22,s[4:7],s61 offen lds
s_add_u32 m0,s74,23552
s_nop 0
buffer_load_dwordx4 v23,s[4:7],s61 offen lds
s_add_u32 m0,s74,24576
s_nop 0
buffer_load_dwordx4 v24,s[4:7],s61 offen lds
s_add_u32 m0,s74,25600
s_nop 0
buffer_load_dwordx4 v25,s[4:7],s61 offen lds
s_add_u32 m0,s74,26624
s_nop 0
buffer_load_dwordx4 v26,s[4:7],s61 offen lds
s_add_u32 m0,s74,27648
s_nop 0
buffer_load_dwordx4 v27,s[4:7],s61 offen lds
s_add_u32 m0,s74,28672
s_nop 0
buffer_load_dwordx4 v28,s[4:7],s61 offen lds
s_add_u32 m0,s74,29696
s_nop 0
buffer_load_dwordx4 v29,s[4:7],s61 offen lds
s_add_u32 s61,s73,245760
s_add_u32 m0,s74,30720
s_nop 0
buffer_load_dwordx4 v20,s[4:7],s61 offen lds
s_add_u32 m0,s74,31744
s_nop 0
buffer_load_dwordx4 v21,s[4:7],s61 offen lds
s_add_u32 m0,s74,32768
s_nop 0
buffer_load_dwordx4 v22,s[4:7],s61 offen lds
s_add_u32 m0,s74,33792
s_nop 0
buffer_load_dwordx4 v23,s[4:7],s61 offen lds
s_add_u32 m0,s74,34816
s_nop 0
buffer_load_dwordx4 v24,s[4:7],s61 offen lds
s_add_u32 m0,s74,35840
s_nop 0
buffer_load_dwordx4 v25,s[4:7],s61 offen lds
s_add_u32 m0,s74,36864
s_nop 0
buffer_load_dwordx4 v26,s[4:7],s61 offen lds
s_add_u32 m0,s74,37888
s_nop 0
buffer_load_dwordx4 v27,s[4:7],s61 offen lds
s_add_u32 m0,s74,38912
s_nop 0
buffer_load_dwordx4 v28,s[4:7],s61 offen lds
s_add_u32 m0,s74,39936
s_nop 0
buffer_load_dwordx4 v29,s[4:7],s61 offen lds
s_waitcnt vmcnt(30)
ds_read_b64_tr_b16 a[0:1],v30 offset:0
ds_read_b64_tr_b16 a[2:3],v30 offset:320
ds_read_b64_tr_b16 a[4:5],v30 offset:1280
ds_read_b64_tr_b16 a[6:7],v30 offset:1600
ds_read_b64_tr_b16 a[8:9],v30 offset:32
ds_read_b64_tr_b16 a[10:11],v30 offset:352
ds_read_b64_tr_b16 a[12:13],v30 offset:1312
ds_read_b64_tr_b16 a[14:15],v30 offset:1632
ds_read_b64_tr_b16 a[16:17],v30 offset:64
ds_read_b64_tr_b16 a[18:19],v30 offset:384
ds_read_b64_tr_b16 a[20:21],v30 offset:1344
ds_read_b64_tr_b16 a[22:23],v30 offset:1664
s_waitcnt lgkmcnt(4)
ds_read_b64_tr_b16 a[24:25],v30 offset:96
ds_read_b64_tr_b16 a[26:27],v30 offset:416
ds_read_b64_tr_b16 a[28:29],v30 offset:1376
ds_read_b64_tr_b16 a[30:31],v30 offset:1696
ds_read_b64_tr_b16 v[32:33],v30 offset:128
ds_read_b64_tr_b16 v[34:35],v30 offset:448
ds_read_b64_tr_b16 v[36:37],v30 offset:1408
ds_read_b64_tr_b16 v[38:39],v30 offset:1728
s_waitcnt lgkmcnt(0)
s_add_u32 s61,s73,327680
s_add_u32 m0,s74,0
s_nop 0
buffer_load_dwordx4 v20,s[4:7],s61 offen lds
s_add_u32 m0,s74,1024
s_nop 0
buffer_load_dwordx4 v21,s[4:7],s61 offen lds
s_add_u32 m0,s74,2048
s_nop 0
buffer_load_dwordx4 v22,s[4:7],s61 offen lds
s_add_u32 m0,s74,3072
s_nop 0
buffer_load_dwordx4 v23,s[4:7],s61 offen lds
s_add_u32 m0,s74,4096
s_nop 0
buffer_load_dwordx4 v24,s[4:7],s61 offen lds
s_add_u32 m0,s74,5120
s_nop 0
buffer_load_dwordx4 v25,s[4:7],s61 offen lds
s_add_u32 m0,s74,6144
s_nop 0
buffer_load_dwordx4 v26,s[4:7],s61 offen lds
s_add_u32 m0,s74,7168
s_nop 0
buffer_load_dwordx4 v27,s[4:7],s61 offen lds
s_add_u32 m0,s74,8192
s_nop 0
buffer_load_dwordx4 v28,s[4:7],s61 offen lds
s_add_u32 m0,s74,9216
s_nop 0
buffer_load_dwordx4 v29,s[4:7],s61 offen lds
s_waitcnt vmcnt(30)
ds_read_b64_tr_b16 a[32:33],v30 offset:10240
ds_read_b64_tr_b16 a[34:35],v30 offset:10560
ds_read_b64_tr_b16 a[36:37],v30 offset:11520
ds_read_b64_tr_b16 a[38:39],v30 offset:11840
ds_read_b64_tr_b16 a[40:41],v30 offset:10272
ds_read_b64_tr_b16 a[42:43],v30 offset:10592
ds_read_b64_tr_b16 a[44:45],v30 offset:11552
ds_read_b64_tr_b16 a[46:47],v30 offset:11872
ds_read_b64_tr_b16 a[48:49],v30 offset:10304
ds_read_b64_tr_b16 a[50:51],v30 offset:10624
ds_read_b64_tr_b16 a[52:53],v30 offset:11584
ds_read_b64_tr_b16 a[54:55],v30 offset:11904
s_waitcnt lgkmcnt(4)
ds_read_b64_tr_b16 a[56:57],v30 offset:10336
ds_read_b64_tr_b16 a[58:59],v30 offset:10656
ds_read_b64_tr_b16 a[60:61],v30 offset:11616
ds_read_b64_tr_b16 a[62:63],v30 offset:11936
ds_read_b64_tr_b16 v[40:41],v30 offset:10368
ds_read_b64_tr_b16 v[42:43],v30 offset:10688
ds_read_b64_tr_b16 v[44:45],v30 offset:11648
ds_read_b64_tr_b16 v[46:47],v30 offset:11968
s_waitcnt lgkmcnt(0)
s_add_u32 s61,s73,409600
s_add_u32 m0,s74,10240
s_nop 0
buffer_load_dwordx4 v20,s[4:7],s61 offen lds
s_add_u32 m0,s74,11264
s_nop 0
buffer_load_dwordx4 v21,s[4:7],s61 offen lds
s_add_u32 m0,s74,12288
s_nop 0
buffer_load_dwordx4 v22,s[4:7],s61 offen lds
s_add_u32 m0,s74,13312
s_nop 0
buffer_load_dwordx4 v23,s[4:7],s61 offen lds
s_add_u32 m0,s74,14336
s_nop 0
buffer_load_dwordx4 v24,s[4:7],s61 offen lds
s_add_u32 m0,s74,15360
s_nop 0
buffer_load_dwordx4 v25,s[4:7],s61 offen lds
s_add_u32 m0,s74,16384
s_nop 0
buffer_load_dwordx4 v26,s[4:7],s61 offen lds
s_add_u32 m0,s74,17408
s_nop 0
buffer_load_dwordx4 v27,s[4:7],s61 offen lds
s_add_u32 m0,s74,18432
s_nop 0
buffer_load_dwordx4 v28,s[4:7],s61 offen lds
s_add_u32 m0,s74,19456
s_nop 0
buffer_load_dwordx4 v29,s[4:7],s61 offen lds
s_waitcnt vmcnt(30)
ds_read_b64_tr_b16 a[64:65],v30 offset:20480
ds_read_b64_tr_b16 a[66:67],v30 offset:20800
ds_read_b64_tr_b16 a[68:69],v30 offset:21760
ds_read_b64_tr_b16 a[70:71],v30 offset:22080
ds_read_b64_tr_b16 a[72:73],v30 offset:20512
ds_read_b64_tr_b16 a[74:75],v30 offset:20832
ds_read_b64_tr_b16 a[76:77],v30 offset:21792
ds_read_b64_tr_b16 a[78:79],v30 offset:22112
ds_read_b64_tr_b16 a[80:81],v30 offset:20544
ds_read_b64_tr_b16 a[82:83],v30 offset:20864
ds_read_b64_tr_b16 a[84:85],v30 offset:21824
ds_read_b64_tr_b16 a[86:87],v30 offset:22144
s_waitcnt lgkmcnt(4)
ds_read_b64_tr_b16 a[88:89],v30 offset:20576
ds_read_b64_tr_b16 a[90:91],v30 offset:20896
ds_read_b64_tr_b16 a[92:93],v30 offset:21856
ds_read_b64_tr_b16 a[94:95],v30 offset:22176
ds_read_b64_tr_b16 v[48:49],v30 offset:20608
ds_read_b64_tr_b16 v[50:51],v30 offset:20928
ds_read_b64_tr_b16 v[52:53],v30 offset:21888
ds_read_b64_tr_b16 v[54:55],v30 offset:22208
s_waitcnt lgkmcnt(0)
s_add_u32 s61,s73,491520
s_add_u32 m0,s74,20480
s_nop 0
buffer_load_dwordx4 v20,s[4:7],s61 offen lds
s_add_u32 m0,s74,21504
s_nop 0
buffer_load_dwordx4 v21,s[4:7],s61 offen lds
s_add_u32 m0,s74,22528
s_nop 0
buffer_load_dwordx4 v22,s[4:7],s61 offen lds
s_add_u32 m0,s74,23552
s_nop 0
buffer_load_dwordx4 v23,s[4:7],s61 offen lds
s_add_u32 m0,s74,24576
s_nop 0
buffer_load_dwordx4 v24,s[4:7],s61 offen lds
s_add_u32 m0,s74,25600
s_nop 0
buffer_load_dwordx4 v25,s[4:7],s61 offen lds
s_add_u32 m0,s74,26624
s_nop 0
buffer_load_dwordx4 v26,s[4:7],s61 offen lds
s_add_u32 m0,s74,27648
s_nop 0
buffer_load_dwordx4 v27,s[4:7],s61 offen lds
s_add_u32 m0,s74,28672
s_nop 0
buffer_load_dwordx4 v28,s[4:7],s61 offen lds
s_add_u32 m0,s74,29696
s_nop 0
buffer_load_dwordx4 v29,s[4:7],s61 offen lds
s_waitcnt vmcnt(30)
ds_read_b64_tr_b16 a[96:97],v30 offset:30720
ds_read_b64_tr_b16 a[98:99],v30 offset:31040
ds_read_b64_tr_b16 a[100:101],v30 offset:32000
ds_read_b64_tr_b16 a[102:103],v30 offset:32320
ds_read_b64_tr_b16 a[104:105],v30 offset:30752
ds_read_b64_tr_b16 a[106:107],v30 offset:31072
ds_read_b64_tr_b16 a[108:109],v30 offset:32032
ds_read_b64_tr_b16 a[110:111],v30 offset:32352
ds_read_b64_tr_b16 a[112:113],v30 offset:30784
ds_read_b64_tr_b16 a[114:115],v30 offset:31104
ds_read_b64_tr_b16 a[116:117],v30 offset:32064
ds_read_b64_tr_b16 a[118:119],v30 offset:32384
s_waitcnt lgkmcnt(4)
ds_read_b64_tr_b16 a[120:121],v30 offset:30816
ds_read_b64_tr_b16 a[122:123],v30 offset:31136
ds_read_b64_tr_b16 a[124:125],v30 offset:32096
ds_read_b64_tr_b16 a[126:127],v30 offset:32416
ds_read_b64_tr_b16 v[56:57],v30 offset:30848
ds_read_b64_tr_b16 v[58:59],v30 offset:31168
ds_read_b64_tr_b16 v[60:61],v30 offset:32128
ds_read_b64_tr_b16 v[62:63],v30 offset:32448
s_waitcnt lgkmcnt(0)
s_add_u32 s61,s73,573440
s_add_u32 m0,s74,30720
s_nop 0
buffer_load_dwordx4 v20,s[4:7],s61 offen lds
s_add_u32 m0,s74,31744
s_nop 0
buffer_load_dwordx4 v21,s[4:7],s61 offen lds
s_add_u32 m0,s74,32768
s_nop 0
buffer_load_dwordx4 v22,s[4:7],s61 offen lds
s_add_u32 m0,s74,33792
s_nop 0
buffer_load_dwordx4 v23,s[4:7],s61 offen lds
s_add_u32 m0,s74,34816
s_nop 0
buffer_load_dwordx4 v24,s[4:7],s61 offen lds
s_add_u32 m0,s74,35840
s_nop 0
buffer_load_dwordx4 v25,s[4:7],s61 offen lds
s_add_u32 m0,s74,36864
s_nop 0
buffer_load_dwordx4 v26,s[4:7],s61 offen lds
s_add_u32 m0,s74,37888
s_nop 0
buffer_load_dwordx4 v27,s[4:7],s61 offen lds
s_add_u32 m0,s74,38912
s_nop 0
buffer_load_dwordx4 v28,s[4:7],s61 offen lds
s_add_u32 m0,s74,39936
s_nop 0
buffer_load_dwordx4 v29,s[4:7],s61 offen lds
s_waitcnt vmcnt(30)
ds_read_b64_tr_b16 a[128:129],v30 offset:0
ds_read_b64_tr_b16 a[130:131],v30 offset:320
ds_read_b64_tr_b16 a[132:133],v30 offset:1280
ds_read_b64_tr_b16 a[134:135],v30 offset:1600
ds_read_b64_tr_b16 a[136:137],v30 offset:32
ds_read_b64_tr_b16 a[138:139],v30 offset:352
ds_read_b64_tr_b16 a[140:141],v30 offset:1312
ds_read_b64_tr_b16 a[142:143],v30 offset:1632
ds_read_b64_tr_b16 a[144:145],v30 offset:64
ds_read_b64_tr_b16 a[146:147],v30 offset:384
ds_read_b64_tr_b16 a[148:149],v30 offset:1344
ds_read_b64_tr_b16 a[150:151],v30 offset:1664
s_waitcnt lgkmcnt(4)
ds_read_b64_tr_b16 a[152:153],v30 offset:96
ds_read_b64_tr_b16 a[154:155],v30 offset:416
ds_read_b64_tr_b16 a[156:157],v30 offset:1376
ds_read_b64_tr_b16 a[158:159],v30 offset:1696
ds_read_b64_tr_b16 v[64:65],v30 offset:128
ds_read_b64_tr_b16 v[66:67],v30 offset:448
ds_read_b64_tr_b16 v[68:69],v30 offset:1408
ds_read_b64_tr_b16 v[70:71],v30 offset:1728
s_waitcnt lgkmcnt(0)
s_add_u32 s61,s73,655360
s_add_u32 m0,s74,0
s_nop 0
buffer_load_dwordx4 v20,s[4:7],s61 offen lds
s_add_u32 m0,s74,1024
s_nop 0
buffer_load_dwordx4 v21,s[4:7],s61 offen lds
s_add_u32 m0,s74,2048
s_nop 0
buffer_load_dwordx4 v22,s[4:7],s61 offen lds
s_add_u32 m0,s74,3072
s_nop 0
buffer_load_dwordx4 v23,s[4:7],s61 offen lds
s_add_u32 m0,s74,4096
s_nop 0
buffer_load_dwordx4 v24,s[4:7],s61 offen lds
s_add_u32 m0,s74,5120
s_nop 0
buffer_load_dwordx4 v25,s[4:7],s61 offen lds
s_add_u32 m0,s74,6144
s_nop 0
buffer_load_dwordx4 v26,s[4:7],s61 offen lds
s_add_u32 m0,s74,7168
s_nop 0
buffer_load_dwordx4 v27,s[4:7],s61 offen lds
s_add_u32 m0,s74,8192
s_nop 0
buffer_load_dwordx4 v28,s[4:7],s61 offen lds
s_add_u32 m0,s74,9216
s_nop 0
buffer_load_dwordx4 v29,s[4:7],s61 offen lds
s_waitcnt vmcnt(30)
ds_read_b64_tr_b16 a[160:161],v30 offset:10240
ds_read_b64_tr_b16 a[162:163],v30 offset:10560
ds_read_b64_tr_b16 a[164:165],v30 offset:11520
ds_read_b64_tr_b16 a[166:167],v30 offset:11840
ds_read_b64_tr_b16 a[168:169],v30 offset:10272
ds_read_b64_tr_b16 a[170:171],v30 offset:10592
ds_read_b64_tr_b16 a[172:173],v30 offset:11552
ds_read_b64_tr_b16 a[174:175],v30 offset:11872
ds_read_b64_tr_b16 a[176:177],v30 offset:10304
ds_read_b64_tr_b16 a[178:179],v30 offset:10624
ds_read_b64_tr_b16 a[180:181],v30 offset:11584
ds_read_b64_tr_b16 a[182:183],v30 offset:11904
s_waitcnt lgkmcnt(4)
ds_read_b64_tr_b16 a[184:185],v30 offset:10336
ds_read_b64_tr_b16 a[186:187],v30 offset:10656
ds_read_b64_tr_b16 a[188:189],v30 offset:11616
ds_read_b64_tr_b16 a[190:191],v30 offset:11936
ds_read_b64_tr_b16 v[72:73],v30 offset:10368
ds_read_b64_tr_b16 v[74:75],v30 offset:10688
ds_read_b64_tr_b16 v[76:77],v30 offset:11648
ds_read_b64_tr_b16 v[78:79],v30 offset:11968
s_waitcnt lgkmcnt(0)
s_add_u32 s61,s73,737280
s_add_u32 m0,s74,10240
s_nop 0
buffer_load_dwordx4 v20,s[4:7],s61 offen lds
s_add_u32 m0,s74,11264
s_nop 0
buffer_load_dwordx4 v21,s[4:7],s61 offen lds
s_add_u32 m0,s74,12288
s_nop 0
buffer_load_dwordx4 v22,s[4:7],s61 offen lds
s_add_u32 m0,s74,13312
s_nop 0
buffer_load_dwordx4 v23,s[4:7],s61 offen lds
s_add_u32 m0,s74,14336
s_nop 0
buffer_load_dwordx4 v24,s[4:7],s61 offen lds
s_add_u32 m0,s74,15360
s_nop 0
buffer_load_dwordx4 v25,s[4:7],s61 offen lds
s_add_u32 m0,s74,16384
s_nop 0
buffer_load_dwordx4 v26,s[4:7],s61 offen lds
s_add_u32 m0,s74,17408
s_nop 0
buffer_load_dwordx4 v27,s[4:7],s61 offen lds
s_add_u32 m0,s74,18432
s_nop 0
buffer_load_dwordx4 v28,s[4:7],s61 offen lds
s_add_u32 m0,s74,19456
s_nop 0
buffer_load_dwordx4 v29,s[4:7],s61 offen lds
s_waitcnt vmcnt(30)
ds_read_b64_tr_b16 a[192:193],v30 offset:20480
ds_read_b64_tr_b16 a[194:195],v30 offset:20800
ds_read_b64_tr_b16 a[196:197],v30 offset:21760
ds_read_b64_tr_b16 a[198:199],v30 offset:22080
ds_read_b64_tr_b16 a[200:201],v30 offset:20512
ds_read_b64_tr_b16 a[202:203],v30 offset:20832
ds_read_b64_tr_b16 a[204:205],v30 offset:21792
ds_read_b64_tr_b16 a[206:207],v30 offset:22112
ds_read_b64_tr_b16 a[208:209],v30 offset:20544
ds_read_b64_tr_b16 a[210:211],v30 offset:20864
ds_read_b64_tr_b16 a[212:213],v30 offset:21824
ds_read_b64_tr_b16 a[214:215],v30 offset:22144
s_waitcnt lgkmcnt(4)
ds_read_b64_tr_b16 a[216:217],v30 offset:20576
ds_read_b64_tr_b16 a[218:219],v30 offset:20896
ds_read_b64_tr_b16 a[220:221],v30 offset:21856
ds_read_b64_tr_b16 a[222:223],v30 offset:22176
ds_read_b64_tr_b16 v[80:81],v30 offset:20608
ds_read_b64_tr_b16 v[82:83],v30 offset:20928
ds_read_b64_tr_b16 v[84:85],v30 offset:21888
ds_read_b64_tr_b16 v[86:87],v30 offset:22208
s_waitcnt lgkmcnt(0)
s_add_u32 s61,s73,819200
s_add_u32 m0,s74,20480
s_nop 0
buffer_load_dwordx4 v20,s[4:7],s61 offen lds
s_add_u32 m0,s74,21504
s_nop 0
buffer_load_dwordx4 v21,s[4:7],s61 offen lds
s_add_u32 m0,s74,22528
s_nop 0
buffer_load_dwordx4 v22,s[4:7],s61 offen lds
s_add_u32 m0,s74,23552
s_nop 0
buffer_load_dwordx4 v23,s[4:7],s61 offen lds
s_add_u32 m0,s74,24576
s_nop 0
buffer_load_dwordx4 v24,s[4:7],s61 offen lds
s_add_u32 m0,s74,25600
s_nop 0
buffer_load_dwordx4 v25,s[4:7],s61 offen lds
s_add_u32 m0,s74,26624
s_nop 0
buffer_load_dwordx4 v26,s[4:7],s61 offen lds
s_add_u32 m0,s74,27648
s_nop 0
buffer_load_dwordx4 v27,s[4:7],s61 offen lds
s_add_u32 m0,s74,28672
s_nop 0
buffer_load_dwordx4 v28,s[4:7],s61 offen lds
s_add_u32 m0,s74,29696
s_nop 0
buffer_load_dwordx4 v29,s[4:7],s61 offen lds
s_waitcnt vmcnt(30)
ds_read_b64_tr_b16 a[224:225],v30 offset:30720
ds_read_b64_tr_b16 a[226:227],v30 offset:31040
ds_read_b64_tr_b16 a[228:229],v30 offset:32000
ds_read_b64_tr_b16 a[230:231],v30 offset:32320
ds_read_b64_tr_b16 a[232:233],v30 offset:30752
ds_read_b64_tr_b16 a[234:235],v30 offset:31072
ds_read_b64_tr_b16 a[236:237],v30 offset:32032
ds_read_b64_tr_b16 a[238:239],v30 offset:32352
ds_read_b64_tr_b16 a[240:241],v30 offset:30784
ds_read_b64_tr_b16 a[242:243],v30 offset:31104
ds_read_b64_tr_b16 a[244:245],v30 offset:32064
ds_read_b64_tr_b16 a[246:247],v30 offset:32384
s_waitcnt lgkmcnt(4)
ds_read_b64_tr_b16 a[248:249],v30 offset:30816
ds_read_b64_tr_b16 a[250:251],v30 offset:31136
ds_read_b64_tr_b16 a[252:253],v30 offset:32096
ds_read_b64_tr_b16 a[254:255],v30 offset:32416
ds_read_b64_tr_b16 v[88:89],v30 offset:30848
ds_read_b64_tr_b16 v[90:91],v30 offset:31168
ds_read_b64_tr_b16 v[92:93],v30 offset:32128
ds_read_b64_tr_b16 v[94:95],v30 offset:32448
s_waitcnt lgkmcnt(0)
s_add_u32 s61,s73,901120
s_add_u32 m0,s74,30720
s_nop 0
buffer_load_dwordx4 v20,s[4:7],s61 offen lds
s_add_u32 m0,s74,31744
s_nop 0
buffer_load_dwordx4 v21,s[4:7],s61 offen lds
s_add_u32 m0,s74,32768
s_nop 0
buffer_load_dwordx4 v22,s[4:7],s61 offen lds
s_add_u32 m0,s74,33792
s_nop 0
buffer_load_dwordx4 v23,s[4:7],s61 offen lds
s_add_u32 m0,s74,34816
s_nop 0
buffer_load_dwordx4 v24,s[4:7],s61 offen lds
s_add_u32 m0,s74,35840
s_nop 0
buffer_load_dwordx4 v25,s[4:7],s61 offen lds
s_add_u32 m0,s74,36864
s_nop 0
buffer_load_dwordx4 v26,s[4:7],s61 offen lds
s_add_u32 m0,s74,37888
s_nop 0
buffer_load_dwordx4 v27,s[4:7],s61 offen lds
s_add_u32 m0,s74,38912
s_nop 0
buffer_load_dwordx4 v28,s[4:7],s61 offen lds
s_add_u32 m0,s74,39936
s_nop 0
buffer_load_dwordx4 v29,s[4:7],s61 offen lds
s_waitcnt vmcnt(30)
ds_read_b64_tr_b16 v[128:129],v30 offset:0
ds_read_b64_tr_b16 v[130:131],v30 offset:320
ds_read_b64_tr_b16 v[132:133],v30 offset:1280
ds_read_b64_tr_b16 v[134:135],v30 offset:1600
ds_read_b64_tr_b16 v[136:137],v30 offset:32
ds_read_b64_tr_b16 v[138:139],v30 offset:352
ds_read_b64_tr_b16 v[140:141],v30 offset:1312
ds_read_b64_tr_b16 v[142:143],v30 offset:1632
ds_read_b64_tr_b16 v[144:145],v30 offset:64
ds_read_b64_tr_b16 v[146:147],v30 offset:384
ds_read_b64_tr_b16 v[148:149],v30 offset:1344
ds_read_b64_tr_b16 v[150:151],v30 offset:1664
s_waitcnt lgkmcnt(4)
ds_read_b64_tr_b16 v[152:153],v30 offset:96
ds_read_b64_tr_b16 v[154:155],v30 offset:416
ds_read_b64_tr_b16 v[156:157],v30 offset:1376
ds_read_b64_tr_b16 v[158:159],v30 offset:1696
ds_read_b64_tr_b16 v[96:97],v30 offset:128
ds_read_b64_tr_b16 v[98:99],v30 offset:448
ds_read_b64_tr_b16 v[100:101],v30 offset:1408
ds_read_b64_tr_b16 v[102:103],v30 offset:1728
s_waitcnt lgkmcnt(0)
s_waitcnt vmcnt(20)
ds_read_b64_tr_b16 v[160:161],v30 offset:10240
ds_read_b64_tr_b16 v[162:163],v30 offset:10560
ds_read_b64_tr_b16 v[164:165],v30 offset:11520
ds_read_b64_tr_b16 v[166:167],v30 offset:11840
ds_read_b64_tr_b16 v[168:169],v30 offset:10272
ds_read_b64_tr_b16 v[170:171],v30 offset:10592
ds_read_b64_tr_b16 v[172:173],v30 offset:11552
ds_read_b64_tr_b16 v[174:175],v30 offset:11872
ds_read_b64_tr_b16 v[176:177],v30 offset:10304
ds_read_b64_tr_b16 v[178:179],v30 offset:10624
ds_read_b64_tr_b16 v[180:181],v30 offset:11584
ds_read_b64_tr_b16 v[182:183],v30 offset:11904
s_waitcnt lgkmcnt(4)
ds_read_b64_tr_b16 v[184:185],v30 offset:10336
ds_read_b64_tr_b16 v[186:187],v30 offset:10656
ds_read_b64_tr_b16 v[188:189],v30 offset:11616
ds_read_b64_tr_b16 v[190:191],v30 offset:11936
ds_read_b64_tr_b16 v[104:105],v30 offset:10368
ds_read_b64_tr_b16 v[106:107],v30 offset:10688
ds_read_b64_tr_b16 v[108:109],v30 offset:11648
ds_read_b64_tr_b16 v[110:111],v30 offset:11968
s_waitcnt lgkmcnt(0)
s_waitcnt vmcnt(10)
ds_read_b64_tr_b16 v[192:193],v30 offset:20480
ds_read_b64_tr_b16 v[194:195],v30 offset:20800
ds_read_b64_tr_b16 v[196:197],v30 offset:21760
ds_read_b64_tr_b16 v[198:199],v30 offset:22080
ds_read_b64_tr_b16 v[200:201],v30 offset:20512
ds_read_b64_tr_b16 v[202:203],v30 offset:20832
ds_read_b64_tr_b16 v[204:205],v30 offset:21792
ds_read_b64_tr_b16 v[206:207],v30 offset:22112
ds_read_b64_tr_b16 v[208:209],v30 offset:20544
ds_read_b64_tr_b16 v[210:211],v30 offset:20864
ds_read_b64_tr_b16 v[212:213],v30 offset:21824
ds_read_b64_tr_b16 v[214:215],v30 offset:22144
s_waitcnt lgkmcnt(4)
ds_read_b64_tr_b16 v[216:217],v30 offset:20576
ds_read_b64_tr_b16 v[218:219],v30 offset:20896
ds_read_b64_tr_b16 v[220:221],v30 offset:21856
ds_read_b64_tr_b16 v[222:223],v30 offset:22176
ds_read_b64_tr_b16 v[112:113],v30 offset:20608
ds_read_b64_tr_b16 v[114:115],v30 offset:20928
ds_read_b64_tr_b16 v[116:117],v30 offset:21888
ds_read_b64_tr_b16 v[118:119],v30 offset:22208
s_waitcnt lgkmcnt(0)
s_waitcnt vmcnt(0)
ds_read_b64_tr_b16 v[224:225],v30 offset:30720
ds_read_b64_tr_b16 v[226:227],v30 offset:31040
ds_read_b64_tr_b16 v[228:229],v30 offset:32000
ds_read_b64_tr_b16 v[230:231],v30 offset:32320
ds_read_b64_tr_b16 v[232:233],v30 offset:30752
ds_read_b64_tr_b16 v[234:235],v30 offset:31072
ds_read_b64_tr_b16 v[236:237],v30 offset:32032
ds_read_b64_tr_b16 v[238:239],v30 offset:32352
ds_read_b64_tr_b16 v[240:241],v30 offset:30784
ds_read_b64_tr_b16 v[242:243],v30 offset:31104
ds_read_b64_tr_b16 v[244:245],v30 offset:32064
ds_read_b64_tr_b16 v[246:247],v30 offset:32384
s_waitcnt lgkmcnt(4)
ds_read_b64_tr_b16 v[248:249],v30 offset:30816
ds_read_b64_tr_b16 v[250:251],v30 offset:31136
ds_read_b64_tr_b16 v[252:253],v30 offset:32096
ds_read_b64_tr_b16 v[254:255],v30 offset:32416
ds_read_b64_tr_b16 v[120:121],v30 offset:30848
ds_read_b64_tr_b16 v[122:123],v30 offset:31168
ds_read_b64_tr_b16 v[124:125],v30 offset:32128
ds_read_b64_tr_b16 v[126:127],v30 offset:32448
s_waitcnt lgkmcnt(0)
s_barrier
ds_write_b128 v4,v[32:35] offset:0
ds_write_b128 v4,v[36:39] offset:1024
ds_write_b128 v4,v[40:43] offset:2048
ds_write_b128 v4,v[44:47] offset:3072
ds_write_b128 v4,v[48:51] offset:4096
ds_write_b128 v4,v[52:55] offset:5120
ds_write_b128 v4,v[56:59] offset:6144
ds_write_b128 v4,v[60:63] offset:7168
s_waitcnt lgkmcnt(0)
ds_write_b128 v4,v[64:67] offset:8192
ds_write_b128 v4,v[68:71] offset:9216
ds_write_b128 v4,v[72:75] offset:10240
ds_write_b128 v4,v[76:79] offset:11264
ds_write_b128 v4,v[80:83] offset:12288
ds_write_b128 v4,v[84:87] offset:13312
ds_write_b128 v4,v[88:91] offset:14336
ds_write_b128 v4,v[92:95] offset:15360
s_waitcnt lgkmcnt(0)
ds_write_b128 v4,v[96:99] offset:16384
ds_write_b128 v4,v[100:103] offset:17408
ds_write_b128 v4,v[104:107] offset:18432
ds_write_b128 v4,v[108:111] offset:19456
ds_write_b128 v4,v[112:115] offset:20480
ds_write_b128 v4,v[116:119] offset:21504
ds_write_b128 v4,v[120:123] offset:22528
ds_write_b128 v4,v[124:127] offset:23552
s_waitcnt lgkmcnt(0)
s_barrier
s_lshl_b32 s3,s49,2
v_mov_b32 v13,s3
s_nop 1
ibw_163:
buffer_load_dword v12,v13,s[12:15],0 offen sc1
s_waitcnt vmcnt(0)
v_cmp_ne_u32 vcc,256,v12
s_nop 0
s_cbranch_vccz ok_164
s_sleep 8
s_sub_u32 s47,s47,1
s_cbranch_scc1 ABORT
s_branch ibw_163
ok_164:
s_cmp_lg_u32 s49,0
s_cbranch_scc1 ibok_165
v_and_b32 v13,7,v0
v_lshlrev_b32 v13,2,v13
buffer_load_dword v12,v13,s[12:15],0 offen offset:32 sc1
s_waitcnt vmcnt(0)
v_cmp_ne_u32 vcc,32,v12
s_nop 0
s_cbranch_vccz ibok_165
s_barrier
s_mov_b32 s49,1
s_mov_b32 s3,s2
s_load_dwordx16 s[16:31],s[0:1],0
s_load_dwordx8 s[32:39],s[0:1],64
s_waitcnt lgkmcnt(0)
s_branch DISPATCH
ibok_165:
v_mov_b32 v13,192
s_cmp_lg_u32 s49,0
s_cbranch_scc1 vx_167
vw_166:
buffer_load_dword v12,v13,s[12:15],0 offen sc1
s_waitcnt vmcnt(0)
v_and_b32 v14,0xffff,v12
v_cmp_ne_u32 vcc,64,v14
s_nop 0
s_cbranch_vccz ok_168
s_sleep 4
s_sub_u32 s47,s47,1
s_cbranch_scc1 ABORT
s_branch vw_166
ok_168:
v_readfirstlane_b32 s60,v12
s_cmp_gt_u32 s60,2162688
s_cselect_b32 s60,0x2000,0
s_add_u32 s83,s83,s60
s_nop 1
vx_167:
s_mov_b32 s50,0
s_mov_b32 s77,0
ds_read_b128 v[20:23],v4 offset:12288
ds_read_b128 v[24:27],v4 offset:13312
ds_read_b128 v[116:119],v4 offset:22528
ds_read_b128 v[120:123],v4 offset:23552
s_waitcnt lgkmcnt(0)
s_cmp_lg_u32 s49,0
s_cbranch_scc1 CW_LOOP_S
CW_LOOP_F:
s_sub_u32 s60,s50,13
s_lshr_b32 s52,s60,1
s_and_b32 s51,s60,1
s_cmp_eq_u32 s51,0
s_cselect_b32 s61,13,0
s_add_u32 s52,s52,s61
s_sub_u32 s61,s60,51
s_cmp_ge_u32 s60,102
s_cselect_b32 s52,s61,s52
s_cselect_b32 s51,1,s51
s_cmp_lt_u32 s50,13
s_cselect_b32 s52,s50,s52
s_cselect_b32 s51,0,s51
s_cmp_eq_u32 s52,63
s_cbranch_scc1 CW_NEXT_F
s_add_u32 s58,s52,1
s_lshl_b32 s61,s51,9
s_add_u32 s72,s61,s35
s_add_u32 s69,s61,s85
s_lshl_b32 s61,s51,2
s_and_b32 s60,s52,1
s_add_u32 s60,s60,s61
s_mul_i32 s70,s60,49152
s_add_u32 s70,s70,s33
s_add_u32 s71,s70,4096
s_add_u32 s80,s70,8192
s_bfe_u32 s57,s52,65537
s_bfe_u32 s31,s58,65537
s_and_b32 s60,s58,1
s_add_u32 s60,s60,s61
s_mul_i32 s59,s60,20480
s_add_u32 s59,s59,s84
s_lshl_b32 s68,s60,16
s_add_u32 s68,s68,s83
s_xor_b32 s77,s77,11264
v_add_u32 v7,s77,v5
v_add_u32 v8,s77,v6
s_add_u32 s60,s52,2
v_mov_b32 v16,s60
ds_read_b128 v[100:103],v4 offset:0
ds_read_b128 v[104:107],v4 offset:1024
ds_read_b128 v[108:111],v4 offset:6144
ds_read_b128 v[112:115],v4 offset:7168
s_cmp_lg_u32 s46,0
s_cbranch_scc1 np_169
db_171:
buffer_load_dword v12,v3,s[8:11],s72 offen sc1
s_waitcnt vmcnt(0)
v_cmp_gt_u32 vcc,s58,v12
s_cbranch_vccz dbok_172
s_sub_u32 s47,s47,1
s_cbranch_scc1 ABORT
s_branch db_171
dbok_172:
np_169:
s_barrier
rd_170:
buffer_load_dwordx4 v[32:35],v1,s[8:11],s70 offen sc1
v_mov_b32 v80,0
v_mov_b32 v81,0
v_mov_b32 v82,0
v_mov_b32 v83,0
v_mov_b32 v84,0
buffer_load_dwordx4 v[36:39],v1,s[8:11],s70 offen offset:3072 sc1
v_mov_b32 v85,0
v_mov_b32 v86,0
v_mov_b32 v87,0
v_mov_b32 v88,0
v_mov_b32 v89,0
buffer_load_dwordx4 v[40:43],v1,s[8:11],s71 offen offset:2048 sc1
v_mov_b32 v90,0
v_mov_b32 v91,0
v_mov_b32 v92,0
v_mov_b32 v93,0
v_mov_b32 v94,0
buffer_load_dwordx4 v[44:47],v1,s[8:11],s80 offen offset:1024 sc1
v_mov_b32 v95,0
v_mov_b32 v96,0
v_mov_b32 v97,0
v_mov_b32 v98,0
v_mov_b32 v99,0
buffer_load_dwordx4 v[48:51],v1,s[8:11],s70 offen offset:1024 sc1
s_waitcnt vmcnt(4)
v_and_b32 v12,1,v32
v_cmp_ne_u32 vcc,s57,v12
s_cbranch_vccnz ws_173
wg_177:
v_smfmac_f32_16x16x64_bf16 v[80:83],v[32:35],a[0:7],v2
buffer_load_dwordx4 v[52:55],v1,s[8:11],s71 offen sc1
v_smfmac_f32_16x16x64_bf16 v[84:87],v[32:35],a[8:15],v2
s_waitcnt vmcnt(4)
v_and_b32 v12,1,v36
v_smfmac_f32_16x16x64_bf16 v[88:91],v[32:35],a[16:23],v2
v_cmp_ne_u32 vcc,s57,v12
v_smfmac_f32_16x16x64_bf16 v[92:95],v[32:35],a[24:31],v2
s_waitcnt lgkmcnt(2)
v_smfmac_f32_16x16x64_bf16 v[96:99],v[32:35],v[100:107],v2
s_cbranch_vccnz ws_174
wg_178:
v_smfmac_f32_16x16x64_bf16 v[80:83],v[36:39],a[96:103],v2
buffer_load_dwordx4 v[56:59],v1,s[8:11],s71 offen offset:3072 sc1
v_smfmac_f32_16x16x64_bf16 v[84:87],v[36:39],a[104:111],v2
s_waitcnt vmcnt(4)
v_and_b32 v12,1,v40
v_smfmac_f32_16x16x64_bf16 v[88:91],v[36:39],a[112:119],v2
v_cmp_ne_u32 vcc,s57,v12
v_smfmac_f32_16x16x64_bf16 v[92:95],v[36:39],a[120:127],v2
s_waitcnt lgkmcnt(0)
v_smfmac_f32_16x16x64_bf16 v[96:99],v[36:39],v[108:115],v2
s_cbranch_vccnz ws_175
wg_179:
v_smfmac_f32_16x16x64_bf16 v[80:83],v[40:43],a[192:199],v2
buffer_load_dwordx4 v[60:63],v1,s[8:11],s80 offen offset:2048 sc1
v_smfmac_f32_16x16x64_bf16 v[84:87],v[40:43],a[200:207],v2
s_waitcnt vmcnt(4)
v_and_b32 v12,1,v44
v_smfmac_f32_16x16x64_bf16 v[88:91],v[40:43],a[208:215],v2
v_cmp_ne_u32 vcc,s57,v12
ds_read_b128 v[100:103],v4 offset:18432
v_smfmac_f32_16x16x64_bf16 v[92:95],v[40:43],a[216:223],v2
ds_read_b128 v[104:107],v4 offset:19456
v_smfmac_f32_16x16x64_bf16 v[96:99],v[40:43],v[20:27],v2
s_cbranch_vccnz ws_176
wg_180:
v_smfmac_f32_16x16x64_bf16 v[80:83],v[44:47],v[160:167],v2
buffer_load_dwordx4 v[64:67],v1,s[8:11],s70 offen offset:2048 sc1
v_smfmac_f32_16x16x64_bf16 v[84:87],v[44:47],v[168:175],v2
ds_read_b128 v[108:111],v4 offset:2048
v_smfmac_f32_16x16x64_bf16 v[88:91],v[44:47],v[176:183],v2
ds_read_b128 v[112:115],v4 offset:3072
v_smfmac_f32_16x16x64_bf16 v[92:95],v[44:47],v[184:191],v2
s_waitcnt lgkmcnt(2)
v_smfmac_f32_16x16x64_bf16 v[96:99],v[44:47],v[100:107],v2
buffer_load_dwordx4 v[68:71],v1,s[8:11],s71 offen offset:1024 sc1
s_waitcnt vmcnt(5)
v_smfmac_f32_16x16x64_bf16 v[80:83],v[48:51],a[32:39],v2
ds_read_b128 v[100:103],v4 offset:8192
v_smfmac_f32_16x16x64_bf16 v[84:87],v[48:51],a[40:47],v2
ds_read_b128 v[104:107],v4 offset:9216
v_smfmac_f32_16x16x64_bf16 v[88:91],v[48:51],a[48:55],v2
v_smfmac_f32_16x16x64_bf16 v[92:95],v[48:51],a[56:63],v2
buffer_load_dwordx4 v[72:75],v1,s[8:11],s80 offen sc1
s_waitcnt lgkmcnt(2)
v_smfmac_f32_16x16x64_bf16 v[96:99],v[48:51],v[108:115],v2
s_waitcnt vmcnt(5)
v_smfmac_f32_16x16x64_bf16 v[80:83],v[52:55],a[128:135],v2
ds_read_b128 v[108:111],v4 offset:14336
v_bitop3_b32 v13,v48,v52,s57 bitop3:0x7e
v_smfmac_f32_16x16x64_bf16 v[84:87],v[52:55],a[136:143],v2
ds_read_b128 v[112:115],v4 offset:15360
v_smfmac_f32_16x16x64_bf16 v[88:91],v[52:55],a[144:151],v2
buffer_load_dwordx4 v[76:79],v1,s[8:11],s80 offen offset:3072 sc1
v_smfmac_f32_16x16x64_bf16 v[92:95],v[52:55],a[152:159],v2
s_waitcnt lgkmcnt(2)
v_smfmac_f32_16x16x64_bf16 v[96:99],v[52:55],v[100:107],v2
s_waitcnt vmcnt(5)
v_smfmac_f32_16x16x64_bf16 v[80:83],v[56:59],a[224:231],v2
ds_read_b128 v[100:103],v4 offset:20480
v_smfmac_f32_16x16x64_bf16 v[84:87],v[56:59],a[232:239],v2
ds_read_b128 v[104:107],v4 offset:21504
v_smfmac_f32_16x16x64_bf16 v[88:91],v[56:59],a[240:247],v2
v_smfmac_f32_16x16x64_bf16 v[92:95],v[56:59],a[248:255],v2
s_waitcnt lgkmcnt(2)
v_smfmac_f32_16x16x64_bf16 v[96:99],v[56:59],v[108:115],v2
s_waitcnt vmcnt(4)
v_smfmac_f32_16x16x64_bf16 v[80:83],v[60:63],v[192:199],v2
ds_read_b128 v[108:111],v4 offset:4096
v_bitop3_b32 v14,v56,v60,s57 bitop3:0x7e
v_smfmac_f32_16x16x64_bf16 v[84:87],v[60:63],v[200:207],v2
ds_read_b128 v[112:115],v4 offset:5120
v_or_b32 v13,v13,v14
v_smfmac_f32_16x16x64_bf16 v[88:91],v[60:63],v[208:215],v2
v_smfmac_f32_16x16x64_bf16 v[92:95],v[60:63],v[216:223],v2
s_waitcnt lgkmcnt(2)
v_smfmac_f32_16x16x64_bf16 v[96:99],v[60:63],v[100:107],v2
s_waitcnt vmcnt(3)
v_smfmac_f32_16x16x64_bf16 v[80:83],v[64:67],a[64:71],v2
ds_read_b128 v[100:103],v4 offset:10240
v_smfmac_f32_16x16x64_bf16 v[84:87],v[64:67],a[72:79],v2
ds_read_b128 v[104:107],v4 offset:11264
v_smfmac_f32_16x16x64_bf16 v[88:91],v[64:67],a[80:87],v2
v_smfmac_f32_16x16x64_bf16 v[92:95],v[64:67],a[88:95],v2
s_waitcnt lgkmcnt(2)
v_smfmac_f32_16x16x64_bf16 v[96:99],v[64:67],v[108:115],v2
s_waitcnt vmcnt(0)
v_smfmac_f32_16x16x64_bf16 v[80:83],v[68:71],a[160:167],v2
ds_read_b128 v[108:111],v4 offset:16384
v_bitop3_b32 v14,v64,v68,s57 bitop3:0x7e
v_smfmac_f32_16x16x64_bf16 v[80:83],v[72:75],v[128:135],v2
ds_read_b128 v[112:115],v4 offset:17408
v_or_b32 v13,v13,v14
v_smfmac_f32_16x16x64_bf16 v[80:83],v[76:79],v[224:231],v2
v_bitop3_b32 v14,v72,v76,s57 bitop3:0x7e
v_smfmac_f32_16x16x64_bf16 v[84:87],v[68:71],a[168:175],v2
v_or_b32 v13,v13,v14
v_smfmac_f32_16x16x64_bf16 v[84:87],v[72:75],v[136:143],v2
v_and_b32 v13,1,v13
v_smfmac_f32_16x16x64_bf16 v[84:87],v[76:79],v[232:239],v2
v_cmp_ne_u32 vcc,0,v13
v_smfmac_f32_16x16x64_bf16 v[88:91],v[68:71],a[176:183],v2
s_cbranch_vccnz rd_170x
v_smfmac_f32_16x16x64_bf16 v[88:91],v[72:75],v[144:151],v2
v_add_f32 v80,v80,v81
v_smfmac_f32_16x16x64_bf16 v[88:91],v[76:79],v[240:247],v2
v_add_f32 v82,v82,v83
ds_write2_b32 v7,v80,v82 offset0:0 offset1:88
v_smfmac_f32_16x16x64_bf16 v[92:95],v[68:71],a[184:191],v2
v_add_f32 v84,v84,v85
v_smfmac_f32_16x16x64_bf16 v[92:95],v[72:75],v[152:159],v2
v_add_f32 v86,v86,v87
ds_write2_b32 v7,v84,v86 offset0:16 offset1:104
v_smfmac_f32_16x16x64_bf16 v[92:95],v[76:79],v[248:255],v2
v_add_f32 v88,v88,v89
s_waitcnt lgkmcnt(4)
v_smfmac_f32_16x16x64_bf16 v[96:99],v[68:71],v[100:107],v2
v_add_f32 v90,v90,v91
s_waitcnt lgkmcnt(2)
v_smfmac_f32_16x16x64_bf16 v[96:99],v[72:75],v[108:115],v2
ds_write2_b32 v7,v88,v90 offset0:32 offset1:120
v_smfmac_f32_16x16x64_bf16 v[96:99],v[76:79],v[116:123],v2
v_add_f32 v92,v92,v93
v_add_f32 v94,v94,v95
ds_write2_b32 v7,v92,v94 offset0:48 offset1:136
s_nop 4
v_add_f32 v96,v96,v97
v_add_f32 v98,v98,v99
ds_write2_b32 v7,v96,v98 offset0:64 offset1:152
s_waitcnt lgkmcnt(0)
s_barrier
ds_read_b128 v[32:35],v8 offset:0
ds_read_b128 v[36:39],v8 offset:2816
ds_read_b128 v[40:43],v8 offset:5632
ds_read_b128 v[44:47],v8 offset:8448
s_mov_b64 exec,1
buffer_store_dword v16,v1,s[8:11],s69 offen
s_mov_b64 exec,-1
s_waitcnt lgkmcnt(2)
v_pk_add_f32 v[32:33],v[32:33],v[36:37]
v_pk_add_f32 v[34:35],v[34:35],v[38:39]
s_waitcnt lgkmcnt(0)
v_pk_add_f32 v[40:41],v[40:41],v[44:45]
v_pk_add_f32 v[42:43],v[42:43],v[46:47]
v_pk_add_f32 v[32:33],v[32:33],v[40:41]
v_pk_add_f32 v[34:35],v[34:35],v[42:43]
v_cvt_pk_bf16_f32 v32,v32,v33
v_cvt_pk_bf16_f32 v33,v34,v35
v_bfi_b32 v32,v10,s31,v32
s_nop 0
v_permlane32_swap_b32 v33,v35
v_permlane32_swap_b32 v32,v34
s_mov_b64 exec,s[88:89]
buffer_store_dwordx4 v[32:35],v9,s[8:11],s59 offen
s_barrier
buffer_store_dwordx4 v[32:35],v9,s[8:11],s68 offen sc1
s_mov_b64 exec,-1
s_nop 0
CW_NEXT_F:
s_add_u32 s50,s50,1
s_cmp_lt_u32 s50,128
s_cbranch_scc1 CW_LOOP_F
s_branch CW_DONE
ws_173:
buffer_load_dwordx4 v[32:35],v1,s[8:11],s70 offen sc1
buffer_load_dwordx4 v[36:39],v1,s[8:11],s70 offen offset:3072 sc1
buffer_load_dwordx4 v[40:43],v1,s[8:11],s71 offen offset:2048 sc1
buffer_load_dwordx4 v[44:47],v1,s[8:11],s80 offen offset:1024 sc1
buffer_load_dwordx4 v[48:51],v1,s[8:11],s70 offen offset:1024 sc1
s_sub_u32 s47,s47,1
s_cbranch_scc1 ABORT
s_waitcnt vmcnt(4)
v_and_b32 v12,1,v32
v_cmp_ne_u32 vcc,s57,v12
s_nop 0
s_cbranch_vccnz ws_173
s_branch wg_177
ws_174:
buffer_load_dwordx4 v[36:39],v1,s[8:11],s70 offen offset:3072 sc1
buffer_load_dwordx4 v[40:43],v1,s[8:11],s71 offen offset:2048 sc1
buffer_load_dwordx4 v[44:47],v1,s[8:11],s80 offen offset:1024 sc1
buffer_load_dwordx4 v[48:51],v1,s[8:11],s70 offen offset:1024 sc1
buffer_load_dwordx4 v[52:55],v1,s[8:11],s71 offen sc1
s_sub_u32 s47,s47,1
s_cbranch_scc1 ABORT
s_waitcnt vmcnt(4)
v_and_b32 v12,1,v36
v_cmp_ne_u32 vcc,s57,v12
s_nop 0
s_cbranch_vccnz ws_174
s_branch wg_178
ws_175:
buffer_load_dwordx4 v[40:43],v1,s[8:11],s71 offen offset:2048 sc1
buffer_load_dwordx4 v[44:47],v1,s[8:11],s80 offen offset:1024 sc1
buffer_load_dwordx4 v[48:51],v1,s[8:11],s70 offen offset:1024 sc1
buffer_load_dwordx4 v[52:55],v1,s[8:11],s71 offen sc1
buffer_load_dwordx4 v[56:59],v1,s[8:11],s71 offen offset:3072 sc1
s_sub_u32 s47,s47,1
s_cbranch_scc1 ABORT
s_waitcnt vmcnt(4)
v_and_b32 v12,1,v40
v_cmp_ne_u32 vcc,s57,v12
s_nop 0
s_cbranch_vccnz ws_175
s_branch wg_179
ws_176:
buffer_load_dwordx4 v[44:47],v1,s[8:11],s80 offen offset:1024 sc1
buffer_load_dwordx4 v[48:51],v1,s[8:11],s70 offen offset:1024 sc1
buffer_load_dwordx4 v[52:55],v1,s[8:11],s71 offen sc1
buffer_load_dwordx4 v[56:59],v1,s[8:11],s71 offen offset:3072 sc1
buffer_load_dwordx4 v[60:63],v1,s[8:11],s80 offen offset:2048 sc1
s_sub_u32 s47,s47,1
s_cbranch_scc1 ABORT
s_waitcnt vmcnt(4)
v_and_b32 v12,1,v44
v_cmp_ne_u32 vcc,s57,v12
s_nop 0
s_cbranch_vccnz ws_176
s_branch wg_180
rd_170x:
s_sub_u32 s47,s47,1
s_cbranch_scc1 ABORT
s_waitcnt lgkmcnt(0)
s_nop 7
ds_read_b128 v[100:103],v4 offset:0
ds_read_b128 v[104:107],v4 offset:1024
ds_read_b128 v[108:111],v4 offset:6144
ds_read_b128 v[112:115],v4 offset:7168
s_branch rd_170
CW_LOOP_S:
s_sub_u32 s60,s50,13
s_lshr_b32 s52,s60,1
s_and_b32 s51,s60,1
s_cmp_eq_u32 s51,0
s_cselect_b32 s61,13,0
s_add_u32 s52,s52,s61
s_sub_u32 s61,s60,51
s_cmp_ge_u32 s60,102
s_cselect_b32 s52,s61,s52
s_cselect_b32 s51,1,s51
s_cmp_lt_u32 s50,13
s_cselect_b32 s52,s50,s52
s_cselect_b32 s51,0,s51
s_cmp_eq_u32 s52,63
s_cbranch_scc1 CW_NEXT_S
s_add_u32 s58,s52,1
s_lshl_b32 s61,s51,9
s_add_u32 s72,s61,s35
s_add_u32 s69,s61,s85
s_lshl_b32 s61,s51,2
s_and_b32 s60,s52,1
s_add_u32 s60,s60,s61
s_mul_i32 s70,s60,49152
s_add_u32 s70,s70,s33
s_add_u32 s71,s70,4096
s_add_u32 s80,s70,8192
s_bfe_u32 s57,s52,65537
s_bfe_u32 s31,s58,65537
s_and_b32 s60,s58,1
s_add_u32 s60,s60,s61
s_mul_i32 s59,s60,20480
s_add_u32 s59,s59,s84
s_lshl_b32 s68,s60,16
s_add_u32 s68,s68,s83
s_xor_b32 s77,s77,11264
v_add_u32 v7,s77,v5
v_add_u32 v8,s77,v6
s_add_u32 s60,s52,2
v_mov_b32 v16,s60
ds_read_b128 v[100:103],v4 offset:0
ds_read_b128 v[104:107],v4 offset:1024
ds_read_b128 v[108:111],v4 offset:6144
ds_read_b128 v[112:115],v4 offset:7168
s_cmp_lg_u32 s46,0
s_cbranch_scc1 np_181
db_183:
buffer_load_dword v12,v3,s[8:11],s72 offen sc1
s_waitcnt vmcnt(0)
v_cmp_gt_u32 vcc,s58,v12
s_cbranch_vccz dbok_184
s_sub_u32 s47,s47,1
s_cbranch_scc1 ABORT
s_branch db_183
dbok_184:
np_181:
s_barrier
rd_182:
buffer_load_dwordx4 v[32:35],v1,s[8:11],s70 offen sc1
v_mov_b32 v80,0
v_mov_b32 v81,0
v_mov_b32 v82,0
v_mov_b32 v83,0
v_mov_b32 v84,0
buffer_load_dwordx4 v[36:39],v1,s[8:11],s70 offen offset:3072 sc1
v_mov_b32 v85,0
v_mov_b32 v86,0
v_mov_b32 v87,0
v_mov_b32 v88,0
v_mov_b32 v89,0
buffer_load_dwordx4 v[40:43],v1,s[8:11],s71 offen offset:2048 sc1
v_mov_b32 v90,0
v_mov_b32 v91,0
v_mov_b32 v92,0
v_mov_b32 v93,0
v_mov_b32 v94,0
buffer_load_dwordx4 v[44:47],v1,s[8:11],s80 offen offset:1024 sc1
v_mov_b32 v95,0
v_mov_b32 v96,0
v_mov_b32 v97,0
v_mov_b32 v98,0
v_mov_b32 v99,0
buffer_load_dwordx4 v[48:51],v1,s[8:11],s70 offen offset:1024 sc1
s_waitcnt vmcnt(4)
v_and_b32 v12,1,v32
v_cmp_ne_u32 vcc,s57,v12
s_cbranch_vccnz ws_185
wg_189:
v_smfmac_f32_16x16x64_bf16 v[80:83],v[32:35],a[0:7],v2
buffer_load_dwordx4 v[52:55],v1,s[8:11],s71 offen sc1
v_smfmac_f32_16x16x64_bf16 v[84:87],v[32:35],a[8:15],v2
s_waitcnt vmcnt(4)
v_and_b32 v12,1,v36
v_smfmac_f32_16x16x64_bf16 v[88:91],v[32:35],a[16:23],v2
v_cmp_ne_u32 vcc,s57,v12
v_smfmac_f32_16x16x64_bf16 v[92:95],v[32:35],a[24:31],v2
s_waitcnt lgkmcnt(2)
v_smfmac_f32_16x16x64_bf16 v[96:99],v[32:35],v[100:107],v2
s_cbranch_vccnz ws_186
wg_190:
v_smfmac_f32_16x16x64_bf16 v[80:83],v[36:39],a[96:103],v2
buffer_load_dwordx4 v[56:59],v1,s[8:11],s71 offen offset:3072 sc1
v_smfmac_f32_16x16x64_bf16 v[84:87],v[36:39],a[104:111],v2
s_waitcnt vmcnt(4)
v_and_b32 v12,1,v40
v_smfmac_f32_16x16x64_bf16 v[88:91],v[36:39],a[112:119],v2
v_cmp_ne_u32 vcc,s57,v12
v_smfmac_f32_16x16x64_bf16 v[92:95],v[36:39],a[120:127],v2
s_waitcnt lgkmcnt(0)
v_smfmac_f32_16x16x64_bf16 v[96:99],v[36:39],v[108:115],v2
s_cbranch_vccnz ws_187
wg_191:
v_smfmac_f32_16x16x64_bf16 v[80:83],v[40:43],a[192:199],v2
buffer_load_dwordx4 v[60:63],v1,s[8:11],s80 offen offset:2048 sc1
v_smfmac_f32_16x16x64_bf16 v[84:87],v[40:43],a[200:207],v2
s_waitcnt vmcnt(4)
v_and_b32 v12,1,v44
v_smfmac_f32_16x16x64_bf16 v[88:91],v[40:43],a[208:215],v2
v_cmp_ne_u32 vcc,s57,v12
ds_read_b128 v[100:103],v4 offset:18432
v_smfmac_f32_16x16x64_bf16 v[92:95],v[40:43],a[216:223],v2
ds_read_b128 v[104:107],v4 offset:19456
v_smfmac_f32_16x16x64_bf16 v[96:99],v[40:43],v[20:27],v2
s_cbranch_vccnz ws_188
wg_192:
v_smfmac_f32_16x16x64_bf16 v[80:83],v[44:47],v[160:167],v2
buffer_load_dwordx4 v[64:67],v1,s[8:11],s70 offen offset:2048 sc1
v_smfmac_f32_16x16x64_bf16 v[84:87],v[44:47],v[168:175],v2
ds_read_b128 v[108:111],v4 offset:2048
v_smfmac_f32_16x16x64_bf16 v[88:91],v[44:47],v[176:183],v2
ds_read_b128 v[112:115],v4 offset:3072
v_smfmac_f32_16x16x64_bf16 v[92:95],v[44:47],v[184:191],v2
s_waitcnt lgkmcnt(2)
v_smfmac_f32_16x16x64_bf16 v[96:99],v[44:47],v[100:107],v2
buffer_load_dwordx4 v[68:71],v1,s[8:11],s71 offen offset:1024 sc1
s_waitcnt vmcnt(5)
v_smfmac_f32_16x16x64_bf16 v[80:83],v[48:51],a[32:39],v2
ds_read_b128 v[100:103],v4 offset:8192
v_smfmac_f32_16x16x64_bf16 v[84:87],v[48:51],a[40:47],v2
ds_read_b128 v[104:107],v4 offset:9216
v_smfmac_f32_16x16x64_bf16 v[88:91],v[48:51],a[48:55],v2
v_smfmac_f32_16x16x64_bf16 v[92:95],v[48:51],a[56:63],v2
buffer_load_dwordx4 v[72:75],v1,s[8:11],s80 offen sc1
s_waitcnt lgkmcnt(2)
v_smfmac_f32_16x16x64_bf16 v[96:99],v[48:51],v[108:115],v2
s_waitcnt vmcnt(5)
v_smfmac_f32_16x16x64_bf16 v[80:83],v[52:55],a[128:135],v2
ds_read_b128 v[108:111],v4 offset:14336
v_bitop3_b32 v13,v48,v52,s57 bitop3:0x7e
v_smfmac_f32_16x16x64_bf16 v[84:87],v[52:55],a[136:143],v2
ds_read_b128 v[112:115],v4 offset:15360
v_smfmac_f32_16x16x64_bf16 v[88:91],v[52:55],a[144:151],v2
buffer_load_dwordx4 v[76:79],v1,s[8:11],s80 offen offset:3072 sc1
v_smfmac_f32_16x16x64_bf16 v[92:95],v[52:55],a[152:159],v2
s_waitcnt lgkmcnt(2)
v_smfmac_f32_16x16x64_bf16 v[96:99],v[52:55],v[100:107],v2
s_waitcnt vmcnt(5)
v_smfmac_f32_16x16x64_bf16 v[80:83],v[56:59],a[224:231],v2
ds_read_b128 v[100:103],v4 offset:20480
v_smfmac_f32_16x16x64_bf16 v[84:87],v[56:59],a[232:239],v2
ds_read_b128 v[104:107],v4 offset:21504
v_smfmac_f32_16x16x64_bf16 v[88:91],v[56:59],a[240:247],v2
v_smfmac_f32_16x16x64_bf16 v[92:95],v[56:59],a[248:255],v2
s_waitcnt lgkmcnt(2)
v_smfmac_f32_16x16x64_bf16 v[96:99],v[56:59],v[108:115],v2
s_waitcnt vmcnt(4)
v_smfmac_f32_16x16x64_bf16 v[80:83],v[60:63],v[192:199],v2
ds_read_b128 v[108:111],v4 offset:4096
v_bitop3_b32 v14,v56,v60,s57 bitop3:0x7e
v_smfmac_f32_16x16x64_bf16 v[84:87],v[60:63],v[200:207],v2
ds_read_b128 v[112:115],v4 offset:5120
v_or_b32 v13,v13,v14
v_smfmac_f32_16x16x64_bf16 v[88:91],v[60:63],v[208:215],v2
v_smfmac_f32_16x16x64_bf16 v[92:95],v[60:63],v[216:223],v2
s_waitcnt lgkmcnt(2)
v_smfmac_f32_16x16x64_bf16 v[96:99],v[60:63],v[100:107],v2
s_waitcnt vmcnt(3)
v_smfmac_f32_16x16x64_bf16 v[80:83],v[64:67],a[64:71],v2
ds_read_b128 v[100:103],v4 offset:10240
v_smfmac_f32_16x16x64_bf16 v[84:87],v[64:67],a[72:79],v2
ds_read_b128 v[104:107],v4 offset:11264
v_smfmac_f32_16x16x64_bf16 v[88:91],v[64:67],a[80:87],v2
v_smfmac_f32_16x16x64_bf16 v[92:95],v[64:67],a[88:95],v2
s_waitcnt lgkmcnt(2)
v_smfmac_f32_16x16x64_bf16 v[96:99],v[64:67],v[108:115],v2
s_waitcnt vmcnt(0)
v_smfmac_f32_16x16x64_bf16 v[80:83],v[68:71],a[160:167],v2
ds_read_b128 v[108:111],v4 offset:16384
v_bitop3_b32 v14,v64,v68,s57 bitop3:0x7e
v_smfmac_f32_16x16x64_bf16 v[80:83],v[72:75],v[128:135],v2
ds_read_b128 v[112:115],v4 offset:17408
v_or_b32 v13,v13,v14
v_smfmac_f32_16x16x64_bf16 v[80:83],v[76:79],v[224:231],v2
v_bitop3_b32 v14,v72,v76,s57 bitop3:0x7e
v_smfmac_f32_16x16x64_bf16 v[84:87],v[68:71],a[168:175],v2
v_or_b32 v13,v13,v14
v_smfmac_f32_16x16x64_bf16 v[84:87],v[72:75],v[136:143],v2
v_and_b32 v13,1,v13
v_smfmac_f32_16x16x64_bf16 v[84:87],v[76:79],v[232:239],v2
v_cmp_ne_u32 vcc,0,v13
v_smfmac_f32_16x16x64_bf16 v[88:91],v[68:71],a[176:183],v2
s_cbranch_vccnz rd_182x
v_smfmac_f32_16x16x64_bf16 v[88:91],v[72:75],v[144:151],v2
v_add_f32 v80,v80,v81
v_smfmac_f32_16x16x64_bf16 v[88:91],v[76:79],v[240:247],v2
v_add_f32 v82,v82,v83
ds_write2_b32 v7,v80,v82 offset0:0 offset1:88
v_smfmac_f32_16x16x64_bf16 v[92:95],v[68:71],a[184:191],v2
v_add_f32 v84,v84,v85
v_smfmac_f32_16x16x64_bf16 v[92:95],v[72:75],v[152:159],v2
v_add_f32 v86,v86,v87
ds_write2_b32 v7,v84,v86 offset0:16 offset1:104
v_smfmac_f32_16x16x64_bf16 v[92:95],v[76:79],v[248:255],v2
v_add_f32 v88,v88,v89
s_waitcnt lgkmcnt(4)
v_smfmac_f32_16x16x64_bf16 v[96:99],v[68:71],v[100:107],v2
v_add_f32 v90,v90,v91
s_waitcnt lgkmcnt(2)
v_smfmac_f32_16x16x64_bf16 v[96:99],v[72:75],v[108:115],v2
ds_write2_b32 v7,v88,v90 offset0:32 offset1:120
v_smfmac_f32_16x16x64_bf16 v[96:99],v[76:79],v[116:123],v2
v_add_f32 v92,v92,v93
v_add_f32 v94,v94,v95
ds_write2_b32 v7,v92,v94 offset0:48 offset1:136
s_nop 4
v_add_f32 v96,v96,v97
v_add_f32 v98,v98,v99
ds_write2_b32 v7,v96,v98 offset0:64 offset1:152
s_waitcnt lgkmcnt(0)
s_barrier
ds_read_b128 v[32:35],v8 offset:0
ds_read_b128 v[36:39],v8 offset:2816
ds_read_b128 v[40:43],v8 offset:5632
ds_read_b128 v[44:47],v8 offset:8448
s_mov_b64 exec,1
buffer_store_dword v16,v1,s[8:11],s69 offen sc1
s_mov_b64 exec,-1
s_waitcnt lgkmcnt(2)
v_pk_add_f32 v[32:33],v[32:33],v[36:37]
v_pk_add_f32 v[34:35],v[34:35],v[38:39]
s_waitcnt lgkmcnt(0)
v_pk_add_f32 v[40:41],v[40:41],v[44:45]
v_pk_add_f32 v[42:43],v[42:43],v[46:47]
v_pk_add_f32 v[32:33],v[32:33],v[40:41]
v_pk_add_f32 v[34:35],v[34:35],v[42:43]
v_cvt_pk_bf16_f32 v32,v32,v33
v_cvt_pk_bf16_f32 v33,v34,v35
v_bfi_b32 v32,v10,s31,v32
s_nop 0
v_permlane32_swap_b32 v33,v35
v_permlane32_swap_b32 v32,v34
s_mov_b64 exec,s[88:89]
buffer_store_dwordx4 v[32:35],v9,s[8:11],s59 offen sc1
s_barrier
buffer_store_dwordx4 v[32:35],v9,s[8:11],s68 offen sc1
s_mov_b64 exec,-1
s_nop 0
CW_NEXT_S:
s_add_u32 s50,s50,1
s_cmp_lt_u32 s50,128
s_cbranch_scc1 CW_LOOP_S
s_branch CW_DONE
ws_185:
buffer_load_dwordx4 v[32:35],v1,s[8:11],s70 offen sc1
buffer_load_dwordx4 v[36:39],v1,s[8:11],s70 offen offset:3072 sc1
buffer_load_dwordx4 v[40:43],v1,s[8:11],s71 offen offset:2048 sc1
buffer_load_dwordx4 v[44:47],v1,s[8:11],s80 offen offset:1024 sc1
buffer_load_dwordx4 v[48:51],v1,s[8:11],s70 offen offset:1024 sc1
s_sub_u32 s47,s47,1
s_cbranch_scc1 ABORT
s_waitcnt vmcnt(4)
v_and_b32 v12,1,v32
v_cmp_ne_u32 vcc,s57,v12
s_nop 0
s_cbranch_vccnz ws_185
s_branch wg_189
ws_186:
buffer_load_dwordx4 v[36:39],v1,s[8:11],s70 offen offset:3072 sc1
buffer_load_dwordx4 v[40:43],v1,s[8:11],s71 offen offset:2048 sc1
buffer_load_dwordx4 v[44:47],v1,s[8:11],s80 offen offset:1024 sc1
buffer_load_dwordx4 v[48:51],v1,s[8:11],s70 offen offset:1024 sc1
buffer_load_dwordx4 v[52:55],v1,s[8:11],s71 offen sc1
s_sub_u32 s47,s47,1
s_cbranch_scc1 ABORT
s_waitcnt vmcnt(4)
v_and_b32 v12,1,v36
v_cmp_ne_u32 vcc,s57,v12
s_nop 0
s_cbranch_vccnz ws_186
s_branch wg_190
ws_187:
buffer_load_dwordx4 v[40:43],v1,s[8:11],s71 offen offset:2048 sc1
buffer_load_dwordx4 v[44:47],v1,s[8:11],s80 offen offset:1024 sc1
buffer_load_dwordx4 v[48:51],v1,s[8:11],s70 offen offset:1024 sc1
buffer_load_dwordx4 v[52:55],v1,s[8:11],s71 offen sc1
buffer_load_dwordx4 v[56:59],v1,s[8:11],s71 offen offset:3072 sc1
s_sub_u32 s47,s47,1
s_cbranch_scc1 ABORT
s_waitcnt vmcnt(4)
v_and_b32 v12,1,v40
v_cmp_ne_u32 vcc,s57,v12
s_nop 0
s_cbranch_vccnz ws_187
s_branch wg_191
ws_188:
buffer_load_dwordx4 v[44:47],v1,s[8:11],s80 offen offset:1024 sc1
buffer_load_dwordx4 v[48:51],v1,s[8:11],s70 offen offset:1024 sc1
buffer_load_dwordx4 v[52:55],v1,s[8:11],s71 offen sc1
buffer_load_dwordx4 v[56:59],v1,s[8:11],s71 offen offset:3072 sc1
buffer_load_dwordx4 v[60:63],v1,s[8:11],s80 offen offset:2048 sc1
s_sub_u32 s47,s47,1
s_cbranch_scc1 ABORT
s_waitcnt vmcnt(4)
v_and_b32 v12,1,v44
v_cmp_ne_u32 vcc,s57,v12
s_nop 0
s_cbranch_vccnz ws_188
s_branch wg_192
rd_182x:
s_sub_u32 s47,s47,1
s_cbranch_scc1 ABORT
s_waitcnt lgkmcnt(0)
s_nop 7
ds_read_b128 v[100:103],v4 offset:0
ds_read_b128 v[104:107],v4 offset:1024
ds_read_b128 v[108:111],v4 offset:6144
ds_read_b128 v[112:115],v4 offset:7168
s_branch rd_182
CW_DONE:
s_add_u32 s61,s48,48
s_endpgm
DISPATCH:
s_sub_u32 s48,s3,0
s_cmp_lt_u32 s3,8
s_cbranch_scc1 ROLE_CW
s_sub_u32 s48,s3,8
s_cmp_lt_u32 s3,16
s_cbranch_scc1 ROLE_CV
s_sub_u32 s48,s3,16
s_cmp_lt_u32 s3,32
s_cbranch_scc1 ROLE_CS
s_sub_u32 s48,s3,24
s_cmp_lt_u32 s3,40
s_cbranch_scc1 ROLE_CW
s_sub_u32 s48,s3,32
s_cmp_lt_u32 s3,48
s_cbranch_scc1 ROLE_CV
s_sub_u32 s48,s3,32
s_cmp_lt_u32 s3,64
s_cbranch_scc1 ROLE_CS
s_sub_u32 s48,s3,64
s_cmp_lt_u32 s3,69
s_cbranch_scc1 ROLE_W1
s_sub_u32 s48,s3,69
s_cmp_lt_u32 s3,74
s_cbranch_scc1 ROLE_W2
s_sub_u32 s48,s3,74
s_cmp_lt_u32 s3,86
s_cbranch_scc1 ROLE_W3
s_sub_u32 s48,s3,86
s_cmp_lt_u32 s3,96
s_cbranch_scc1 ROLE_W4
s_sub_u32 s48,s3,96
s_cmp_lt_u32 s3,104
s_cbranch_scc1 ROLE_QKVQ
s_sub_u32 s48,s3,104
s_cmp_lt_u32 s3,112
s_cbranch_scc1 ROLE_QKVV
s_sub_u32 s48,s3,112
s_cmp_lt_u32 s3,128
s_cbranch_scc1 ROLE_R1
s_sub_u32 s48,s3,120
s_cmp_lt_u32 s3,132
s_cbranch_scc1 ROLE_QKVV
s_sub_u32 s48,s3,124
s_cmp_lt_u32 s3,142
s_cbranch_scc1 ROLE_QKVQ
s_sub_u32 s48,s3,142
s_cmp_lt_u32 s3,150
s_cbranch_scc1 ROLE_ATT
s_sub_u32 s48,s3,150
s_cmp_lt_u32 s3,160
s_cbranch_scc1 ROLE_WO
s_sub_u32 s48,s3,148
s_cmp_lt_u32 s3,164
s_cbranch_scc1 ROLE_QKVV
s_sub_u32 s48,s3,146
s_cmp_lt_u32 s3,174
s_cbranch_scc1 ROLE_QKVQ
s_sub_u32 s48,s3,166
s_cmp_lt_u32 s3,182
s_cbranch_scc1 ROLE_ATT
s_sub_u32 s48,s3,172
s_cmp_lt_u32 s3,192
s_cbranch_scc1 ROLE_WO
s_sub_u32 s48,s3,176
s_cmp_lt_u32 s3,196
s_cbranch_scc1 ROLE_QKVV
s_sub_u32 s48,s3,168
s_cmp_lt_u32 s3,206
s_cbranch_scc1 ROLE_QKVQ
s_sub_u32 s48,s3,190
s_cmp_lt_u32 s3,214
s_cbranch_scc1 ROLE_ATT
s_sub_u32 s48,s3,194
s_cmp_lt_u32 s3,224
s_cbranch_scc1 ROLE_WO
s_sub_u32 s48,s3,204
s_cmp_lt_u32 s3,228
s_cbranch_scc1 ROLE_QKVV
s_sub_u32 s48,s3,190
s_cmp_lt_u32 s3,238
s_cbranch_scc1 ROLE_QKVQ
s_sub_u32 s48,s3,214
s_cmp_lt_u32 s3,246
s_cbranch_scc1 ROLE_ATT
s_sub_u32 s48,s3,216
s_cmp_lt_u32 s3,256
s_cbranch_scc1 ROLE_WO
s_branch ROLE_SPARE
EXIT:
s_endpgm
ABORT:
s_mov_b64 exec,1
v_mov_b32 v1,s2
v_add_u32 v1,0x10000,v1
v_mov_b32 v2,8
buffer_store_dword v1,v2,s[12:15],0 offen
s_endpgm
ROLE_SPARE:
s_waitcnt vmcnt(0)
s_barrier
s_cmp_lg_u32 s46,0
s_cbranch_scc1 arr_193
v_mov_b32 v12,1
s_lshl_b32 s3,s49,2
v_mov_b32 v13,s3
s_mov_b64 exec,1
buffer_atomic_add v12,v13,s[12:15],0 offen sc1
s_mov_b64 exec,-1
arr_193:
s_lshl_b32 s3,s49,2
v_mov_b32 v13,s3
s_nop 1
ibw_194:
buffer_load_dword v12,v13,s[12:15],0 offen sc1
s_waitcnt vmcnt(0)
v_cmp_ne_u32 vcc,256,v12
s_nop 0
s_cbranch_vccz ok_195
s_sleep 8
s_sub_u32 s47,s47,1
s_cbranch_scc1 ABORT
s_branch ibw_194
ok_195:
s_cmp_lg_u32 s49,0
s_cbranch_scc1 ibok_196
v_and_b32 v13,7,v0
v_lshlrev_b32 v13,2,v13
buffer_load_dword v12,v13,s[12:15],0 offen offset:32 sc1
s_waitcnt vmcnt(0)
v_cmp_ne_u32 vcc,32,v12
s_nop 0
s_cbranch_vccz ibok_196
s_barrier
s_mov_b32 s49,1
s_mov_b32 s3,s2
s_load_dwordx16 s[16:31],s[0:1],0
s_load_dwordx8 s[32:39],s[0:1],64
s_waitcnt lgkmcnt(0)
s_branch DISPATCH
ibok_196:
s_endpgm
ROLE_QKVQ:
v_lshlrev_b32 v1,4,v0
v_mov_b32 v5,1
s_lshl_b32 s56,s48,2
s_add_u32 s56,s56,s46
v_bfe_u32 v6,v0,2,2
v_lshrrev_b32 v7,4,v0
v_add_u32 v7,v6,v7
v_and_b32 v7,3,v7
v_and_b32 v15,3,v0
v_lshlrev_b32 v15,4,v15
v_lshl_add_u32 v15,v7,6,v15
v_lshl_add_u32 v15,v6,8,v15
v_lshrrev_b32 v6,5,v0
v_bfe_u32 v7,v0,4,1
v_lshlrev_b32 v16,10,v7
v_bfe_u32 v7,v0,2,2
v_lshl_add_u32 v16,v7,8,v16
v_add_u32 v6,v6,v7
v_and_b32 v6,3,v6
v_lshl_add_u32 v16,v6,6,v16
v_and_b32 v6,3,v0
v_lshl_add_u32 v16,v6,4,v16
v_add_u32 v18,46080,v16
v_lshrrev_b32 v6,5,v0
v_bfe_u32 v7,v0,4,1
v_lshlrev_b32 v20,10,v7
v_lshl_add_u32 v20,v6,8,v20
v_and_b32 v6,15,v0
v_lshl_add_u32 v20,v6,4,v20
v_lshrrev_b32 v6,5,v0
v_add_u32 v6,2,v6
v_bfe_u32 v7,v0,4,1
v_lshlrev_b32 v17,10,v7
v_bfe_u32 v7,v0,2,2
v_lshl_add_u32 v17,v7,8,v17
v_add_u32 v6,v6,v7
v_and_b32 v6,3,v6
v_lshl_add_u32 v17,v6,6,v17
v_and_b32 v6,3,v0
v_lshl_add_u32 v17,v6,4,v17
v_add_u32 v19,46080,v17
v_lshrrev_b32 v6,5,v0
v_add_u32 v6,2,v6
v_bfe_u32 v7,v0,4,1
v_lshlrev_b32 v21,10,v7
v_lshl_add_u32 v21,v6,8,v21
v_and_b32 v6,15,v0
v_lshl_add_u32 v21,v6,4,v21
s_cmp_ge_u32 s48,24
s_cselect_b32 s68,1,0
s_mul_i32 s60,s68,96
s_sub_u32 s69,s56,s60
s_mul_i32 s70,s68,50331648
s_add_u32 s70,s70,74448896
s_mul_i32 s60,s68,65536
s_sub_u32 s71,131072,s60
s_lshl_b32 s60,s69,12
s_add_u32 s70,s70,s60
v_lshrrev_b32 v6,5,v0
v_mul_u32_u24 v188,2560,v6
v_and_b32 v6,31,v0
v_lshl_add_u32 v188,v6,3,v188
v_add_u32 v188,0xa000,v188
v_min_u32 v4,7,v0
v_lshlrev_b32 v4,2,v4
v_min_u32 v2,39,v0
v_lshlrev_b32 v2,2,v2
v_mov_b32 v12,93184
s_waitcnt vmcnt(0)
s_barrier
s_cmp_lg_u32 s46,0
s_cbranch_scc1 arr_197
v_mov_b32 v6,1
s_lshl_b32 s3,s49,2
v_mov_b32 v7,s3
s_mov_b64 exec,1
buffer_atomic_add v6,v7,s[12:15],0 offen sc1
s_mov_b64 exec,-1
arr_197:
s_lshl_b32 s58,s69,7
s_mul_i32 s63,s46,40960
s_cmp_eq_u32 s68,0
s_cselect_b32 s4,s22,s20
s_cselect_b32 s5,s23,s21
s_mov_b32 s6,7864320
s_mov_b32 s7,0x20000
v_lshrrev_b32 v9,3,v0
s_mov_b32 s64,12288
v_mul_lo_u32 v9,v9,s64
v_and_b32 v10,7,v0
v_lshl_add_u32 v6,v10,4,v9
s_add_u32 m0,s63,0
s_add_u32 s65,s58,0
buffer_load_dwordx4 v6,s[4:7],s65 offen lds
s_add_u32 m0,s63,1024
s_add_u32 s65,s58,98304
buffer_load_dwordx4 v6,s[4:7],s65 offen lds
s_add_u32 m0,s63,2048
s_add_u32 s65,s58,196608
buffer_load_dwordx4 v6,s[4:7],s65 offen lds
s_add_u32 m0,s63,3072
s_add_u32 s65,s58,294912
buffer_load_dwordx4 v6,s[4:7],s65 offen lds
s_add_u32 m0,s63,4096
s_add_u32 s65,s58,393216
buffer_load_dwordx4 v6,s[4:7],s65 offen lds
s_add_u32 m0,s63,5120
s_add_u32 s65,s58,491520
buffer_load_dwordx4 v6,s[4:7],s65 offen lds
s_add_u32 m0,s63,6144
s_add_u32 s65,s58,589824
buffer_load_dwordx4 v6,s[4:7],s65 offen lds
s_add_u32 m0,s63,7168
s_add_u32 s65,s58,688128
buffer_load_dwordx4 v6,s[4:7],s65 offen lds
s_add_u32 m0,s63,8192
s_add_u32 s65,s58,786432
buffer_load_dwordx4 v6,s[4:7],s65 offen lds
s_add_u32 m0,s63,9216
s_add_u32 s65,s58,884736
buffer_load_dwordx4 v6,s[4:7],s65 offen lds
s_add_u32 m0,s63,10240
s_add_u32 s65,s58,983040
buffer_load_dwordx4 v6,s[4:7],s65 offen lds
s_add_u32 m0,s63,11264
s_add_u32 s65,s58,1081344
buffer_load_dwordx4 v6,s[4:7],s65 offen lds
s_add_u32 m0,s63,12288
s_add_u32 s65,s58,1179648
buffer_load_dwordx4 v6,s[4:7],s65 offen lds
s_add_u32 m0,s63,13312
s_add_u32 s65,s58,1277952
buffer_load_dwordx4 v6,s[4:7],s65 offen lds
s_add_u32 m0,s63,14336
s_add_u32 s65,s58,1376256
buffer_load_dwordx4 v6,s[4:7],s65 offen lds
s_add_u32 m0,s63,15360
s_add_u32 s65,s58,1474560
buffer_load_dwordx4 v6,s[4:7],s65 offen lds
s_add_u32 m0,s63,16384
s_add_u32 s65,s58,1572864
buffer_load_dwordx4 v6,s[4:7],s65 offen lds
s_add_u32 m0,s63,17408
s_add_u32 s65,s58,1671168
buffer_load_dwordx4 v6,s[4:7],s65 offen lds
s_add_u32 m0,s63,18432
s_add_u32 s65,s58,1769472
buffer_load_dwordx4 v6,s[4:7],s65 offen lds
s_add_u32 m0,s63,19456
s_add_u32 s65,s58,1867776
buffer_load_dwordx4 v6,s[4:7],s65 offen lds
s_add_u32 m0,s63,20480
s_add_u32 s65,s58,1966080
buffer_load_dwordx4 v6,s[4:7],s65 offen lds
s_add_u32 m0,s63,21504
s_add_u32 s65,s58,2064384
buffer_load_dwordx4 v6,s[4:7],s65 offen lds
s_add_u32 m0,s63,22528
s_add_u32 s65,s58,2162688
buffer_load_dwordx4 v6,s[4:7],s65 offen lds
s_add_u32 m0,s63,23552
s_add_u32 s65,s58,2260992
buffer_load_dwordx4 v6,s[4:7],s65 offen lds
s_add_u32 m0,s63,24576
s_add_u32 s65,s58,2359296
buffer_load_dwordx4 v6,s[4:7],s65 offen lds
s_add_u32 m0,s63,25600
s_add_u32 s65,s58,2457600
buffer_load_dwordx4 v6,s[4:7],s65 offen lds
s_add_u32 m0,s63,26624
s_add_u32 s65,s58,2555904
buffer_load_dwordx4 v6,s[4:7],s65 offen lds
s_add_u32 m0,s63,27648
s_add_u32 s65,s58,2654208
buffer_load_dwordx4 v6,s[4:7],s65 offen lds
s_add_u32 m0,s63,28672
s_add_u32 s65,s58,2752512
buffer_load_dwordx4 v6,s[4:7],s65 offen lds
s_add_u32 m0,s63,29696
s_add_u32 s65,s58,2850816
buffer_load_dwordx4 v6,s[4:7],s65 offen lds
s_add_u32 m0,s63,30720
s_add_u32 s65,s58,2949120
buffer_load_dwordx4 v6,s[4:7],s65 offen lds
s_add_u32 m0,s63,31744
s_add_u32 s65,s58,3047424
buffer_load_dwordx4 v6,s[4:7],s65 offen lds
s_add_u32 m0,s63,32768
s_add_u32 s65,s58,3145728
buffer_load_dwordx4 v6,s[4:7],s65 offen lds
s_add_u32 m0,s63,33792
s_add_u32 s65,s58,3244032
buffer_load_dwordx4 v6,s[4:7],s65 offen lds
s_add_u32 m0,s63,34816
s_add_u32 s65,s58,3342336
buffer_load_dwordx4 v6,s[4:7],s65 offen lds
s_add_u32 m0,s63,35840
s_add_u32 s65,s58,3440640
buffer_load_dwordx4 v6,s[4:7],s65 offen lds
s_add_u32 m0,s63,36864
s_add_u32 s65,s58,3538944
buffer_load_dwordx4 v6,s[4:7],s65 offen lds
s_add_u32 m0,s63,37888
s_add_u32 s65,s58,3637248
buffer_load_dwordx4 v6,s[4:7],s65 offen lds
s_add_u32 m0,s63,38912
s_add_u32 s65,s58,3735552
buffer_load_dwordx4 v6,s[4:7],s65 offen lds
s_add_u32 m0,s63,39936
s_add_u32 s65,s58,3833856
buffer_load_dwordx4 v6,s[4:7],s65 offen lds
s_waitcnt vmcnt(20)
v_bfe_u32 v9,v0,2,2
v_lshrrev_b32 v10,5,v0
v_lshl_add_u32 v9,v10,2,v9
v_mul_u32_u24 v9,128,v9
v_and_b32 v10,1,v0
v_lshl_add_u32 v9,v10,3,v9
v_bfe_u32 v10,v0,1,1
v_lshl_add_u32 v9,v10,5,v9
v_bfe_u32 v10,v0,4,1
v_lshl_add_u32 v9,v10,4,v9
v_add_u32 v7,s63,v9
ds_read_b64_tr_b16 a[0:1],v7 offset:0
ds_read_b64_tr_b16 a[2:3],v7 offset:2048
ds_read_b64_tr_b16 a[4:5],v7 offset:1024
ds_read_b64_tr_b16 a[6:7],v7 offset:3072
ds_read_b64_tr_b16 a[160:161],v7 offset:64
ds_read_b64_tr_b16 a[162:163],v7 offset:2112
ds_read_b64_tr_b16 a[164:165],v7 offset:1088
ds_read_b64_tr_b16 a[166:167],v7 offset:3136
ds_read_b64_tr_b16 a[8:9],v7 offset:4096
ds_read_b64_tr_b16 a[10:11],v7 offset:6144
ds_read_b64_tr_b16 a[12:13],v7 offset:5120
ds_read_b64_tr_b16 a[14:15],v7 offset:7168
s_waitcnt lgkmcnt(4)
ds_read_b64_tr_b16 a[168:169],v7 offset:4160
ds_read_b64_tr_b16 a[170:171],v7 offset:6208
ds_read_b64_tr_b16 a[172:173],v7 offset:5184
ds_read_b64_tr_b16 a[174:175],v7 offset:7232
ds_read_b64_tr_b16 a[16:17],v7 offset:8192
ds_read_b64_tr_b16 a[18:19],v7 offset:10240
ds_read_b64_tr_b16 a[20:21],v7 offset:9216
ds_read_b64_tr_b16 a[22:23],v7 offset:11264
ds_read_b64_tr_b16 a[176:177],v7 offset:8256
ds_read_b64_tr_b16 a[178:179],v7 offset:10304
ds_read_b64_tr_b16 a[180:181],v7 offset:9280
ds_read_b64_tr_b16 a[182:183],v7 offset:11328
s_waitcnt lgkmcnt(4)
ds_read_b64_tr_b16 a[24:25],v7 offset:12288
ds_read_b64_tr_b16 a[26:27],v7 offset:14336
ds_read_b64_tr_b16 a[28:29],v7 offset:13312
ds_read_b64_tr_b16 a[30:31],v7 offset:15360
ds_read_b64_tr_b16 a[184:185],v7 offset:12352
ds_read_b64_tr_b16 a[186:187],v7 offset:14400
ds_read_b64_tr_b16 a[188:189],v7 offset:13376
ds_read_b64_tr_b16 a[190:191],v7 offset:15424
ds_read_b64_tr_b16 a[32:33],v7 offset:16384
ds_read_b64_tr_b16 a[34:35],v7 offset:18432
ds_read_b64_tr_b16 a[36:37],v7 offset:17408
ds_read_b64_tr_b16 a[38:39],v7 offset:19456
s_waitcnt lgkmcnt(4)
ds_read_b64_tr_b16 a[192:193],v7 offset:16448
ds_read_b64_tr_b16 a[194:195],v7 offset:18496
ds_read_b64_tr_b16 a[196:197],v7 offset:17472
ds_read_b64_tr_b16 a[198:199],v7 offset:19520
s_waitcnt lgkmcnt(0)
s_add_u32 m0,s63,0
s_add_u32 s65,s58,3932160
buffer_load_dwordx4 v6,s[4:7],s65 offen lds
s_add_u32 m0,s63,1024
s_add_u32 s65,s58,4030464
buffer_load_dwordx4 v6,s[4:7],s65 offen lds
s_add_u32 m0,s63,2048
s_add_u32 s65,s58,4128768
buffer_load_dwordx4 v6,s[4:7],s65 offen lds
s_add_u32 m0,s63,3072
s_add_u32 s65,s58,4227072
buffer_load_dwordx4 v6,s[4:7],s65 offen lds
s_add_u32 m0,s63,4096
s_add_u32 s65,s58,4325376
buffer_load_dwordx4 v6,s[4:7],s65 offen lds
s_add_u32 m0,s63,5120
s_add_u32 s65,s58,4423680
buffer_load_dwordx4 v6,s[4:7],s65 offen lds
s_add_u32 m0,s63,6144
s_add_u32 s65,s58,4521984
buffer_load_dwordx4 v6,s[4:7],s65 offen lds
s_add_u32 m0,s63,7168
s_add_u32 s65,s58,4620288
buffer_load_dwordx4 v6,s[4:7],s65 offen lds
s_add_u32 m0,s63,8192
s_add_u32 s65,s58,4718592
buffer_load_dwordx4 v6,s[4:7],s65 offen lds
s_add_u32 m0,s63,9216
s_add_u32 s65,s58,4816896
buffer_load_dwordx4 v6,s[4:7],s65 offen lds
s_add_u32 m0,s63,10240
s_add_u32 s65,s58,4915200
buffer_load_dwordx4 v6,s[4:7],s65 offen lds
s_add_u32 m0,s63,11264
s_add_u32 s65,s58,5013504
buffer_load_dwordx4 v6,s[4:7],s65 offen lds
s_add_u32 m0,s63,12288
s_add_u32 s65,s58,5111808
buffer_load_dwordx4 v6,s[4:7],s65 offen lds
s_add_u32 m0,s63,13312
s_add_u32 s65,s58,5210112
buffer_load_dwordx4 v6,s[4:7],s65 offen lds
s_add_u32 m0,s63,14336
s_add_u32 s65,s58,5308416
buffer_load_dwordx4 v6,s[4:7],s65 offen lds
s_add_u32 m0,s63,15360
s_add_u32 s65,s58,5406720
buffer_load_dwordx4 v6,s[4:7],s65 offen lds
s_add_u32 m0,s63,16384
s_add_u32 s65,s58,5505024
buffer_load_dwordx4 v6,s[4:7],s65 offen lds
s_add_u32 m0,s63,17408
s_add_u32 s65,s58,5603328
buffer_load_dwordx4 v6,s[4:7],s65 offen lds
s_add_u32 m0,s63,18432
s_add_u32 s65,s58,5701632
buffer_load_dwordx4 v6,s[4:7],s65 offen lds
s_add_u32 m0,s63,19456
s_add_u32 s65,s58,5799936
buffer_load_dwordx4 v6,s[4:7],s65 offen lds
s_waitcnt vmcnt(20)
v_bfe_u32 v9,v0,2,2
v_lshrrev_b32 v10,5,v0
v_lshl_add_u32 v9,v10,2,v9
v_mul_u32_u24 v9,128,v9
v_and_b32 v10,1,v0
v_lshl_add_u32 v9,v10,3,v9
v_bfe_u32 v10,v0,1,1
v_lshl_add_u32 v9,v10,5,v9
v_bfe_u32 v10,v0,4,1
v_lshl_add_u32 v9,v10,4,v9
v_add_u32 v7,s63,v9
ds_read_b64_tr_b16 a[40:41],v7 offset:20480
ds_read_b64_tr_b16 a[42:43],v7 offset:22528
ds_read_b64_tr_b16 a[44:45],v7 offset:21504
ds_read_b64_tr_b16 a[46:47],v7 offset:23552
ds_read_b64_tr_b16 a[200:201],v7 offset:20544
ds_read_b64_tr_b16 a[202:203],v7 offset:22592
ds_read_b64_tr_b16 a[204:205],v7 offset:21568
ds_read_b64_tr_b16 a[206:207],v7 offset:23616
ds_read_b64_tr_b16 a[48:49],v7 offset:24576
ds_read_b64_tr_b16 a[50:51],v7 offset:26624
ds_read_b64_tr_b16 a[52:53],v7 offset:25600
ds_read_b64_tr_b16 a[54:55],v7 offset:27648
s_waitcnt lgkmcnt(4)
ds_read_b64_tr_b16 a[208:209],v7 offset:24640
ds_read_b64_tr_b16 a[210:211],v7 offset:26688
ds_read_b64_tr_b16 a[212:213],v7 offset:25664
ds_read_b64_tr_b16 a[214:215],v7 offset:27712
ds_read_b64_tr_b16 a[56:57],v7 offset:28672
ds_read_b64_tr_b16 a[58:59],v7 offset:30720
ds_read_b64_tr_b16 a[60:61],v7 offset:29696
ds_read_b64_tr_b16 a[62:63],v7 offset:31744
ds_read_b64_tr_b16 a[216:217],v7 offset:28736
ds_read_b64_tr_b16 a[218:219],v7 offset:30784
ds_read_b64_tr_b16 a[220:221],v7 offset:29760
ds_read_b64_tr_b16 a[222:223],v7 offset:31808
s_waitcnt lgkmcnt(4)
ds_read_b64_tr_b16 a[64:65],v7 offset:32768
ds_read_b64_tr_b16 a[66:67],v7 offset:34816
ds_read_b64_tr_b16 a[68:69],v7 offset:33792
ds_read_b64_tr_b16 a[70:71],v7 offset:35840
ds_read_b64_tr_b16 a[224:225],v7 offset:32832
ds_read_b64_tr_b16 a[226:227],v7 offset:34880
ds_read_b64_tr_b16 a[228:229],v7 offset:33856
ds_read_b64_tr_b16 a[230:231],v7 offset:35904
ds_read_b64_tr_b16 a[72:73],v7 offset:36864
ds_read_b64_tr_b16 a[74:75],v7 offset:38912
ds_read_b64_tr_b16 a[76:77],v7 offset:37888
ds_read_b64_tr_b16 a[78:79],v7 offset:39936
s_waitcnt lgkmcnt(4)
ds_read_b64_tr_b16 a[232:233],v7 offset:36928
ds_read_b64_tr_b16 a[234:235],v7 offset:38976
ds_read_b64_tr_b16 a[236:237],v7 offset:37952
ds_read_b64_tr_b16 a[238:239],v7 offset:40000
s_waitcnt lgkmcnt(0)
s_add_u32 m0,s63,20480
s_add_u32 s65,s58,5898240
buffer_load_dwordx4 v6,s[4:7],s65 offen lds
s_add_u32 m0,s63,21504
s_add_u32 s65,s58,5996544
buffer_load_dwordx4 v6,s[4:7],s65 offen lds
s_add_u32 m0,s63,22528
s_add_u32 s65,s58,6094848
buffer_load_dwordx4 v6,s[4:7],s65 offen lds
s_add_u32 m0,s63,23552
s_add_u32 s65,s58,6193152
buffer_load_dwordx4 v6,s[4:7],s65 offen lds
s_add_u32 m0,s63,24576
s_add_u32 s65,s58,6291456
buffer_load_dwordx4 v6,s[4:7],s65 offen lds
s_add_u32 m0,s63,25600
s_add_u32 s65,s58,6389760
buffer_load_dwordx4 v6,s[4:7],s65 offen lds
s_add_u32 m0,s63,26624
s_add_u32 s65,s58,6488064
buffer_load_dwordx4 v6,s[4:7],s65 offen lds
s_add_u32 m0,s63,27648
s_add_u32 s65,s58,6586368
buffer_load_dwordx4 v6,s[4:7],s65 offen lds
s_add_u32 m0,s63,28672
s_add_u32 s65,s58,6684672
buffer_load_dwordx4 v6,s[4:7],s65 offen lds
s_add_u32 m0,s63,29696
s_add_u32 s65,s58,6782976
buffer_load_dwordx4 v6,s[4:7],s65 offen lds
s_add_u32 m0,s63,30720
s_add_u32 s65,s58,6881280
buffer_load_dwordx4 v6,s[4:7],s65 offen lds
s_add_u32 m0,s63,31744
s_add_u32 s65,s58,6979584
buffer_load_dwordx4 v6,s[4:7],s65 offen lds
s_add_u32 m0,s63,32768
s_add_u32 s65,s58,7077888
buffer_load_dwordx4 v6,s[4:7],s65 offen lds
s_add_u32 m0,s63,33792
s_add_u32 s65,s58,7176192
buffer_load_dwordx4 v6,s[4:7],s65 offen lds
s_add_u32 m0,s63,34816
s_add_u32 s65,s58,7274496
buffer_load_dwordx4 v6,s[4:7],s65 offen lds
s_add_u32 m0,s63,35840
s_add_u32 s65,s58,7372800
buffer_load_dwordx4 v6,s[4:7],s65 offen lds
s_add_u32 m0,s63,36864
s_add_u32 s65,s58,7471104
buffer_load_dwordx4 v6,s[4:7],s65 offen lds
s_add_u32 m0,s63,37888
s_add_u32 s65,s58,7569408
buffer_load_dwordx4 v6,s[4:7],s65 offen lds
s_add_u32 m0,s63,38912
s_add_u32 s65,s58,7667712
buffer_load_dwordx4 v6,s[4:7],s65 offen lds
s_add_u32 m0,s63,39936
s_add_u32 s65,s58,7766016
buffer_load_dwordx4 v6,s[4:7],s65 offen lds
s_waitcnt vmcnt(20)
v_bfe_u32 v9,v0,2,2
v_lshrrev_b32 v10,5,v0
v_lshl_add_u32 v9,v10,2,v9
v_mul_u32_u24 v9,128,v9
v_and_b32 v10,1,v0
v_lshl_add_u32 v9,v10,3,v9
v_bfe_u32 v10,v0,1,1
v_lshl_add_u32 v9,v10,5,v9
v_bfe_u32 v10,v0,4,1
v_lshl_add_u32 v9,v10,4,v9
v_add_u32 v7,s63,v9
ds_read_b64_tr_b16 a[80:81],v7 offset:0
ds_read_b64_tr_b16 a[82:83],v7 offset:2048
ds_read_b64_tr_b16 a[84:85],v7 offset:1024
ds_read_b64_tr_b16 a[86:87],v7 offset:3072
ds_read_b64_tr_b16 a[240:241],v7 offset:64
ds_read_b64_tr_b16 a[242:243],v7 offset:2112
ds_read_b64_tr_b16 a[244:245],v7 offset:1088
ds_read_b64_tr_b16 a[246:247],v7 offset:3136
ds_read_b64_tr_b16 a[88:89],v7 offset:4096
ds_read_b64_tr_b16 a[90:91],v7 offset:6144
ds_read_b64_tr_b16 a[92:93],v7 offset:5120
ds_read_b64_tr_b16 a[94:95],v7 offset:7168
s_waitcnt lgkmcnt(4)
ds_read_b64_tr_b16 a[248:249],v7 offset:4160
ds_read_b64_tr_b16 a[250:251],v7 offset:6208
ds_read_b64_tr_b16 a[252:253],v7 offset:5184
ds_read_b64_tr_b16 a[254:255],v7 offset:7232
ds_read_b64_tr_b16 a[96:97],v7 offset:8192
ds_read_b64_tr_b16 a[98:99],v7 offset:10240
ds_read_b64_tr_b16 a[100:101],v7 offset:9216
ds_read_b64_tr_b16 a[102:103],v7 offset:11264
ds_read_b64_tr_b16 v[192:193],v7 offset:8256
ds_read_b64_tr_b16 v[194:195],v7 offset:10304
ds_read_b64_tr_b16 v[196:197],v7 offset:9280
ds_read_b64_tr_b16 v[198:199],v7 offset:11328
s_waitcnt lgkmcnt(4)
ds_read_b64_tr_b16 a[104:105],v7 offset:12288
ds_read_b64_tr_b16 a[106:107],v7 offset:14336
ds_read_b64_tr_b16 a[108:109],v7 offset:13312
ds_read_b64_tr_b16 a[110:111],v7 offset:15360
ds_read_b64_tr_b16 v[200:201],v7 offset:12352
ds_read_b64_tr_b16 v[202:203],v7 offset:14400
ds_read_b64_tr_b16 v[204:205],v7 offset:13376
ds_read_b64_tr_b16 v[206:207],v7 offset:15424
ds_read_b64_tr_b16 a[112:113],v7 offset:16384
ds_read_b64_tr_b16 a[114:115],v7 offset:18432
ds_read_b64_tr_b16 a[116:117],v7 offset:17408
ds_read_b64_tr_b16 a[118:119],v7 offset:19456
s_waitcnt lgkmcnt(4)
ds_read_b64_tr_b16 v[208:209],v7 offset:16448
ds_read_b64_tr_b16 v[210:211],v7 offset:18496
ds_read_b64_tr_b16 v[212:213],v7 offset:17472
ds_read_b64_tr_b16 v[214:215],v7 offset:19520
s_waitcnt lgkmcnt(0)
s_waitcnt vmcnt(0)
v_bfe_u32 v9,v0,2,2
v_lshrrev_b32 v10,5,v0
v_lshl_add_u32 v9,v10,2,v9
v_mul_u32_u24 v9,128,v9
v_and_b32 v10,1,v0
v_lshl_add_u32 v9,v10,3,v9
v_bfe_u32 v10,v0,1,1
v_lshl_add_u32 v9,v10,5,v9
v_bfe_u32 v10,v0,4,1
v_lshl_add_u32 v9,v10,4,v9
v_add_u32 v7,s63,v9
ds_read_b64_tr_b16 a[120:121],v7 offset:20480
ds_read_b64_tr_b16 a[122:123],v7 offset:22528
ds_read_b64_tr_b16 a[124:125],v7 offset:21504
ds_read_b64_tr_b16 a[126:127],v7 offset:23552
ds_read_b64_tr_b16 v[216:217],v7 offset:20544
ds_read_b64_tr_b16 v[218:219],v7 offset:22592
ds_read_b64_tr_b16 v[220:221],v7 offset:21568
ds_read_b64_tr_b16 v[222:223],v7 offset:23616
ds_read_b64_tr_b16 a[128:129],v7 offset:24576
ds_read_b64_tr_b16 a[130:131],v7 offset:26624
ds_read_b64_tr_b16 a[132:133],v7 offset:25600
ds_read_b64_tr_b16 a[134:135],v7 offset:27648
s_waitcnt lgkmcnt(4)
ds_read_b64_tr_b16 v[224:225],v7 offset:24640
ds_read_b64_tr_b16 v[226:227],v7 offset:26688
ds_read_b64_tr_b16 v[228:229],v7 offset:25664
ds_read_b64_tr_b16 v[230:231],v7 offset:27712
ds_read_b64_tr_b16 a[136:137],v7 offset:28672
ds_read_b64_tr_b16 a[138:139],v7 offset:30720
ds_read_b64_tr_b16 a[140:141],v7 offset:29696
ds_read_b64_tr_b16 a[142:143],v7 offset:31744
ds_read_b64_tr_b16 v[232:233],v7 offset:28736
ds_read_b64_tr_b16 v[234:235],v7 offset:30784
ds_read_b64_tr_b16 v[236:237],v7 offset:29760
ds_read_b64_tr_b16 v[238:239],v7 offset:31808
s_waitcnt lgkmcnt(4)
ds_read_b64_tr_b16 a[144:145],v7 offset:32768
ds_read_b64_tr_b16 a[146:147],v7 offset:34816
ds_read_b64_tr_b16 a[148:149],v7 offset:33792
ds_read_b64_tr_b16 a[150:151],v7 offset:35840
ds_read_b64_tr_b16 v[240:241],v7 offset:32832
ds_read_b64_tr_b16 v[242:243],v7 offset:34880
ds_read_b64_tr_b16 v[244:245],v7 offset:33856
ds_read_b64_tr_b16 v[246:247],v7 offset:35904
ds_read_b64_tr_b16 a[152:153],v7 offset:36864
ds_read_b64_tr_b16 a[154:155],v7 offset:38912
ds_read_b64_tr_b16 a[156:157],v7 offset:37888
ds_read_b64_tr_b16 a[158:159],v7 offset:39936
s_waitcnt lgkmcnt(4)
ds_read_b64_tr_b16 v[248:249],v7 offset:36928
ds_read_b64_tr_b16 v[250:251],v7 offset:38976
ds_read_b64_tr_b16 v[252:253],v7 offset:37952
ds_read_b64_tr_b16 v[254:255],v7 offset:40000
s_waitcnt lgkmcnt(0)
v_mov_b32 v24,0x3f803f80
v_mov_b32 v25,0x3f803f80
v_mov_b32 v26,0x3f803f80
v_mov_b32 v27,0x3f803f80
s_nop 1
v_mfma_f32_32x32x16_bf16 v[120:135],a[0:3],v[24:27],0
v_mfma_f32_32x32x16_bf16 v[136:151],a[160:163],v[24:27],0
v_mfma_f32_32x32x16_bf16 v[120:135],a[4:7],v[24:27],v[120:135]
v_mfma_f32_32x32x16_bf16 v[136:151],a[164:167],v[24:27],v[136:151]
v_mfma_f32_32x32x16_bf16 v[120:135],a[8:11],v[24:27],v[120:135]
v_mfma_f32_32x32x16_bf16 v[136:151],a[168:171],v[24:27],v[136:151]
v_mfma_f32_32x32x16_bf16 v[120:135],a[12:15],v[24:27],v[120:135]
v_mfma_f32_32x32x16_bf16 v[136:151],a[172:175],v[24:27],v[136:151]
v_mfma_f32_32x32x16_bf16 v[120:135],a[16:19],v[24:27],v[120:135]
v_mfma_f32_32x32x16_bf16 v[136:151],a[176:179],v[24:27],v[136:151]
v_mfma_f32_32x32x16_bf16 v[120:135],a[20:23],v[24:27],v[120:135]
v_mfma_f32_32x32x16_bf16 v[136:151],a[180:183],v[24:27],v[136:151]
v_mfma_f32_32x32x16_bf16 v[120:135],a[24:27],v[24:27],v[120:135]
v_mfma_f32_32x32x16_bf16 v[136:151],a[184:187],v[24:27],v[136:151]
v_mfma_f32_32x32x16_bf16 v[120:135],a[28:31],v[24:27],v[120:135]
v_mfma_f32_32x32x16_bf16 v[136:151],a[188:191],v[24:27],v[136:151]
v_mfma_f32_32x32x16_bf16 v[120:135],a[32:35],v[24:27],v[120:135]
v_mfma_f32_32x32x16_bf16 v[136:151],a[192:195],v[24:27],v[136:151]
v_mfma_f32_32x32x16_bf16 v[120:135],a[36:39],v[24:27],v[120:135]
v_mfma_f32_32x32x16_bf16 v[136:151],a[196:199],v[24:27],v[136:151]
v_mfma_f32_32x32x16_bf16 v[120:135],a[40:43],v[24:27],v[120:135]
v_mfma_f32_32x32x16_bf16 v[136:151],a[200:203],v[24:27],v[136:151]
v_mfma_f32_32x32x16_bf16 v[120:135],a[44:47],v[24:27],v[120:135]
v_mfma_f32_32x32x16_bf16 v[136:151],a[204:207],v[24:27],v[136:151]
v_mfma_f32_32x32x16_bf16 v[120:135],a[48:51],v[24:27],v[120:135]
v_mfma_f32_32x32x16_bf16 v[136:151],a[208:211],v[24:27],v[136:151]
v_mfma_f32_32x32x16_bf16 v[120:135],a[52:55],v[24:27],v[120:135]
v_mfma_f32_32x32x16_bf16 v[136:151],a[212:215],v[24:27],v[136:151]
v_mfma_f32_32x32x16_bf16 v[120:135],a[56:59],v[24:27],v[120:135]
v_mfma_f32_32x32x16_bf16 v[136:151],a[216:219],v[24:27],v[136:151]
v_mfma_f32_32x32x16_bf16 v[120:135],a[60:63],v[24:27],v[120:135]
v_mfma_f32_32x32x16_bf16 v[136:151],a[220:223],v[24:27],v[136:151]
v_mfma_f32_32x32x16_bf16 v[120:135],a[64:67],v[24:27],v[120:135]
v_mfma_f32_32x32x16_bf16 v[136:151],a[224:227],v[24:27],v[136:151]
v_mfma_f32_32x32x16_bf16 v[120:135],a[68:71],v[24:27],v[120:135]
v_mfma_f32_32x32x16_bf16 v[136:151],a[228:231],v[24:27],v[136:151]
v_mfma_f32_32x32x16_bf16 v[120:135],a[72:75],v[24:27],v[120:135]
v_mfma_f32_32x32x16_bf16 v[136:151],a[232:235],v[24:27],v[136:151]
v_mfma_f32_32x32x16_bf16 v[120:135],a[76:79],v[24:27],v[120:135]
v_mfma_f32_32x32x16_bf16 v[136:151],a[236:239],v[24:27],v[136:151]
v_mfma_f32_32x32x16_bf16 v[120:135],a[80:83],v[24:27],v[120:135]
v_mfma_f32_32x32x16_bf16 v[136:151],a[240:243],v[24:27],v[136:151]
v_mfma_f32_32x32x16_bf16 v[120:135],a[84:87],v[24:27],v[120:135]
v_mfma_f32_32x32x16_bf16 v[136:151],a[244:247],v[24:27],v[136:151]
v_mfma_f32_32x32x16_bf16 v[120:135],a[88:91],v[24:27],v[120:135]
v_mfma_f32_32x32x16_bf16 v[136:151],a[248:251],v[24:27],v[136:151]
v_mfma_f32_32x32x16_bf16 v[120:135],a[92:95],v[24:27],v[120:135]
v_mfma_f32_32x32x16_bf16 v[136:151],a[252:255],v[24:27],v[136:151]
v_mfma_f32_32x32x16_bf16 v[120:135],a[96:99],v[24:27],v[120:135]
v_mfma_f32_32x32x16_bf16 v[136:151],v[192:195],v[24:27],v[136:151]
v_mfma_f32_32x32x16_bf16 v[120:135],a[100:103],v[24:27],v[120:135]
v_mfma_f32_32x32x16_bf16 v[136:151],v[196:199],v[24:27],v[136:151]
v_mfma_f32_32x32x16_bf16 v[120:135],a[104:107],v[24:27],v[120:135]
v_mfma_f32_32x32x16_bf16 v[136:151],v[200:203],v[24:27],v[136:151]
v_mfma_f32_32x32x16_bf16 v[120:135],a[108:111],v[24:27],v[120:135]
v_mfma_f32_32x32x16_bf16 v[136:151],v[204:207],v[24:27],v[136:151]
v_mfma_f32_32x32x16_bf16 v[120:135],a[112:115],v[24:27],v[120:135]
v_mfma_f32_32x32x16_bf16 v[136:151],v[208:211],v[24:27],v[136:151]
v_mfma_f32_32x32x16_bf16 v[120:135],a[116:119],v[24:27],v[120:135]
v_mfma_f32_32x32x16_bf16 v[136:151],v[212:215],v[24:27],v[136:151]
v_mfma_f32_32x32x16_bf16 v[120:135],a[120:123],v[24:27],v[120:135]
v_mfma_f32_32x32x16_bf16 v[136:151],v[216:219],v[24:27],v[136:151]
v_mfma_f32_32x32x16_bf16 v[120:135],a[124:127],v[24:27],v[120:135]
v_mfma_f32_32x32x16_bf16 v[136:151],v[220:223],v[24:27],v[136:151]
v_mfma_f32_32x32x16_bf16 v[120:135],a[128:131],v[24:27],v[120:135]
v_mfma_f32_32x32x16_bf16 v[136:151],v[224:227],v[24:27],v[136:151]
v_mfma_f32_32x32x16_bf16 v[120:135],a[132:135],v[24:27],v[120:135]
v_mfma_f32_32x32x16_bf16 v[136:151],v[228:231],v[24:27],v[136:151]
v_mfma_f32_32x32x16_bf16 v[120:135],a[136:139],v[24:27],v[120:135]
v_mfma_f32_32x32x16_bf16 v[136:151],v[232:235],v[24:27],v[136:151]
v_mfma_f32_32x32x16_bf16 v[120:135],a[140:143],v[24:27],v[120:135]
v_mfma_f32_32x32x16_bf16 v[136:151],v[236:239],v[24:27],v[136:151]
v_mfma_f32_32x32x16_bf16 v[120:135],a[144:147],v[24:27],v[120:135]
v_mfma_f32_32x32x16_bf16 v[136:151],v[240:243],v[24:27],v[136:151]
v_mfma_f32_32x32x16_bf16 v[120:135],a[148:151],v[24:27],v[120:135]
v_mfma_f32_32x32x16_bf16 v[136:151],v[244:247],v[24:27],v[136:151]
v_mfma_f32_32x32x16_bf16 v[120:135],a[152:155],v[24:27],v[120:135]
v_mfma_f32_32x32x16_bf16 v[136:151],v[248:251],v[24:27],v[136:151]
v_mfma_f32_32x32x16_bf16 v[120:135],a[156:159],v[24:27],v[120:135]
v_mfma_f32_32x32x16_bf16 v[136:151],v[252:255],v[24:27],v[136:151]
s_barrier
s_lshl_b32 s3,s49,2
v_mov_b32 v7,s3
s_nop 8
ibw_198:
buffer_load_dword v6,v7,s[12:15],0 offen sc1
s_waitcnt vmcnt(0)
v_cmp_ne_u32 vcc,256,v6
s_nop 0
s_cbranch_vccz ok_199
s_sleep 8
s_sub_u32 s47,s47,1
s_cbranch_scc1 ABORT
s_branch ibw_198
ok_199:
s_cmp_lg_u32 s49,0
s_cbranch_scc1 ibok_200
v_and_b32 v7,7,v0
v_lshlrev_b32 v7,2,v7
buffer_load_dword v6,v7,s[12:15],0 offen offset:32 sc1
s_waitcnt vmcnt(0)
v_cmp_ne_u32 vcc,32,v6
s_nop 0
s_cbranch_vccz ibok_200
s_barrier
s_mov_b32 s49,1
s_mov_b32 s3,s2
s_load_dwordx16 s[16:31],s[0:1],0
s_load_dwordx8 s[32:39],s[0:1],64
s_waitcnt lgkmcnt(0)
s_branch DISPATCH
ibok_200:
s_mov_b32 s50,0
s_mov_b32 s32,0
s_mov_b32 s57,0
s_mov_b32 s59,2147483648
s_mov_b32 s82,2147483648
s_mov_b32 s39,2147483648
v_mov_b32 v22,94208
s_mov_b32 s72,0
s_mov_b32 s73,0
s_mov_b32 s78,0
s_mov_b32 s79,0
s_cmp_eq_u32 s46,0
s_cselect_b32 s40,0,2147483648
s_lshl_b32 s60,s46,3
v_add_u32 v13,s60,v22
s_mov_b32 s83,s100
s_lshl_b32 s41,s78,9
s_add_u32 s41,s41,s40
s_lshl_b32 s35,s79,9
s_add_u32 s35,s35,s40
s_add_u32 s35,s35,32768
s_branch QKVQ_COLD0
QKVQ_B0:
s_waitcnt lgkmcnt(3)
v_mfma_f32_32x32x16_bf16 v[56:71],a[0:3],v[24:27],0
ds_read_b128 v[44:47],v17 offset:4096
v_add_u32 v189,s57,v188
v_mfma_f32_32x32x16_bf16 v[72:87],a[160:163],v[24:27],0
v_add_u32 v8,0x800,v189
s_sub_u32 s66,46080,s57
s_lshl_b32 s60,s33,6
s_add_u32 s60,s60,s34
s_mul_i32 s60,s60,46080
s_add_u32 s60,s60,s37
v_mfma_f32_32x32x16_bf16 v[56:71],a[4:7],v[28:31],v[56:71]
ds_read_b128 v[48:51],v16 offset:6144
ds_read2_b64 v[156:159],v189 offset0:0 offset1:32
s_add_u32 s60,s60,206569472
s_lshl_b32 s62,s46,10
v_mfma_f32_32x32x16_bf16 v[72:87],a[164:167],v[28:31],v[72:87]
ds_read2_b64 v[160:163],v189 offset0:64 offset1:96
s_add_u32 s62,s62,40960
s_add_u32 m0,s66,s62
s_add_u32 s63,s60,s62
s_waitcnt lgkmcnt(5)
v_mfma_f32_32x32x16_bf16 v[56:71],a[8:11],v[32:35],v[56:71]
ds_read_b128 v[52:55],v17 offset:6144
ds_read2_b64 v[164:167],v189 offset0:128 offset1:160
buffer_load_dwordx4 v1,s[8:11],s63 offen sc1 lds
v_mfma_f32_32x32x16_bf16 v[72:87],a[168:171],v[32:35],v[72:87]
ds_read2_b64 v[168:171],v189 offset0:192 offset1:224
s_add_u32 m0,s66,45056
s_add_u32 s63,s60,45056
s_mul_i32 s74,s73,393216
s_add_u32 s74,s74,s39
v_mfma_f32_32x32x16_bf16 v[56:71],a[12:15],v[36:39],v[56:71]
ds_read_b128 v[24:27],v16 offset:8192
ds_read2_b64 v[172:175],v8 offset0:0 offset1:32
s_add_u32 s74,s74,s70
v_fma_f32 v88,-v176,v120,v88
v_mfma_f32_32x32x16_bf16 v[72:87],a[172:175],v[36:39],v[72:87]
buffer_load_dwordx4 v1,s[8:11],s63 offen sc1 lds
s_mul_i32 s61,s46,10240
s_add_u32 s60,s60,s61
s_add_u32 s61,s61,s66
s_waitcnt lgkmcnt(8)
v_mfma_f32_32x32x16_bf16 v[56:71],a[16:19],v[40:43],v[56:71]
ds_read_b128 v[28:31],v17 offset:8192
s_add_u32 m0,s61,0
s_add_u32 s63,s60,0
v_fma_f32 v89,-v176,v121,v89
v_fma_f32 v90,-v176,v122,v90
v_mfma_f32_32x32x16_bf16 v[72:87],a[176:179],v[40:43],v[72:87]
v_fma_f32 v91,-v176,v123,v91
v_fma_f32 v92,-v176,v124,v92
v_fma_f32 v93,-v176,v125,v93
v_fma_f32 v94,-v176,v126,v94
v_fma_f32 v95,-v176,v127,v95
v_mfma_f32_32x32x16_bf16 v[56:71],a[20:23],v[44:47],v[56:71]
ds_read_b128 v[32:35],v16 offset:10240
buffer_load_dwordx4 v1,s[8:11],s63 offen sc1 lds
s_mov_b32 s53,s33
s_mov_b32 s54,s34
v_mfma_f32_32x32x16_bf16 v[72:87],a[180:183],v[44:47],v[72:87]
s_add_u32 s79,s79,s33
s_or_b32 s65,s37,s33
s_cmp_eq_u32 s65,0
s_addc_u32 s78,s78,0
s_lshl_b32 s41,s78,9
s_waitcnt lgkmcnt(6)
v_mfma_f32_32x32x16_bf16 v[56:71],a[24:27],v[48:51],v[56:71]
ds_read_b128 v[36:39],v17 offset:10240
s_add_u32 s41,s41,s40
s_lshl_b32 s35,s79,9
s_add_u32 s35,s35,s40
s_add_u32 s35,s35,32768
v_mfma_f32_32x32x16_bf16 v[72:87],a[184:187],v[48:51],v[72:87]
buffer_load_dwordx4 v1,s[8:11],s63 offen offset:1024 sc1 lds
v_mul_f32 v88,v88,v177
v_mul_f32 v89,v89,v177
v_mul_f32 v90,v90,v177
v_mul_f32 v91,v91,v177
v_mfma_f32_32x32x16_bf16 v[56:71],a[28:31],v[52:55],v[56:71]
ds_read_b128 v[40:43],v16 offset:12288
v_mul_f32 v92,v92,v177
v_mul_f32 v93,v93,v177
v_mul_f32 v94,v94,v177
v_mul_f32 v95,v95,v177
v_mfma_f32_32x32x16_bf16 v[72:87],a[188:191],v[52:55],v[72:87]
v_cvt_pk_bf16_f32 v88,v88,v89
v_cvt_pk_bf16_f32 v89,v90,v91
v_cvt_pk_bf16_f32 v90,v92,v93
v_cvt_pk_bf16_f32 v91,v94,v95
v_fma_f32 v96,-v176,v128,v96
s_waitcnt lgkmcnt(3)
v_mfma_f32_32x32x16_bf16 v[56:71],a[32:35],v[24:27],v[56:71]
ds_read_b128 v[44:47],v17 offset:12288
buffer_load_dwordx4 v1,s[8:11],s63 offen offset:2048 sc1 lds
v_fma_f32 v97,-v176,v129,v97
v_fma_f32 v98,-v176,v130,v98
v_mfma_f32_32x32x16_bf16 v[72:87],a[192:195],v[24:27],v[72:87]
v_fma_f32 v99,-v176,v131,v99
v_fma_f32 v100,-v176,v132,v100
v_fma_f32 v101,-v176,v133,v101
v_fma_f32 v102,-v176,v134,v102
v_fma_f32 v103,-v176,v135,v103
v_mfma_f32_32x32x16_bf16 v[56:71],a[36:39],v[28:31],v[56:71]
ds_read_b128 v[48:51],v16 offset:14336
v_mul_f32 v96,v96,v177
v_mul_f32 v97,v97,v177
v_mul_f32 v98,v98,v177
v_mul_f32 v99,v99,v177
v_mfma_f32_32x32x16_bf16 v[72:87],a[196:199],v[28:31],v[72:87]
buffer_load_dwordx4 v1,s[8:11],s63 offen offset:3072 sc1 lds
s_add_u32 m0,s61,4096
s_add_u32 s63,s60,4096
v_mul_f32 v100,v100,v177
s_waitcnt lgkmcnt(3)
v_mfma_f32_32x32x16_bf16 v[56:71],a[40:43],v[32:35],v[56:71]
ds_read_b128 v[52:55],v17 offset:14336
v_mul_f32 v101,v101,v177
v_mul_f32 v102,v102,v177
v_mul_f32 v103,v103,v177
v_cvt_pk_bf16_f32 v96,v96,v97
v_mfma_f32_32x32x16_bf16 v[72:87],a[200:203],v[32:35],v[72:87]
v_cvt_pk_bf16_f32 v97,v98,v99
v_cvt_pk_bf16_f32 v98,v100,v101
v_cvt_pk_bf16_f32 v99,v102,v103
v_fma_f32 v104,-v176,v136,v104
v_fma_f32 v105,-v176,v137,v105
v_mfma_f32_32x32x16_bf16 v[56:71],a[44:47],v[36:39],v[56:71]
ds_read_b128 v[24:27],v16 offset:16384
buffer_load_dwordx4 v1,s[8:11],s63 offen sc1 lds
v_fma_f32 v106,-v176,v138,v106
v_fma_f32 v107,-v176,v139,v107
v_mfma_f32_32x32x16_bf16 v[72:87],a[204:207],v[36:39],v[72:87]
v_fma_f32 v108,-v176,v140,v108
v_fma_f32 v109,-v176,v141,v109
v_fma_f32 v110,-v176,v142,v110
v_fma_f32 v111,-v176,v143,v111
v_mul_f32 v104,v104,v177
s_waitcnt lgkmcnt(3)
v_mfma_f32_32x32x16_bf16 v[56:71],a[48:51],v[40:43],v[56:71]
ds_read_b128 v[28:31],v17 offset:16384
v_mul_f32 v105,v105,v177
v_mul_f32 v106,v106,v177
v_mul_f32 v107,v107,v177
v_mul_f32 v108,v108,v177
v_mfma_f32_32x32x16_bf16 v[72:87],a[208:211],v[40:43],v[72:87]
buffer_load_dwordx4 v1,s[8:11],s63 offen offset:1024 sc1 lds
v_mul_f32 v109,v109,v177
v_mul_f32 v110,v110,v177
v_mul_f32 v111,v111,v177
v_cvt_pk_bf16_f32 v104,v104,v105
v_mfma_f32_32x32x16_bf16 v[56:71],a[52:55],v[44:47],v[56:71]
ds_read_b128 v[32:35],v16 offset:18432
v_cvt_pk_bf16_f32 v105,v106,v107
v_cvt_pk_bf16_f32 v106,v108,v109
v_cvt_pk_bf16_f32 v107,v110,v111
v_fma_f32 v112,-v176,v144,v112
v_mfma_f32_32x32x16_bf16 v[72:87],a[212:215],v[44:47],v[72:87]
v_fma_f32 v113,-v176,v145,v113
v_fma_f32 v114,-v176,v146,v114
v_fma_f32 v115,-v176,v147,v115
v_fma_f32 v116,-v176,v148,v116
v_fma_f32 v117,-v176,v149,v117
s_waitcnt lgkmcnt(3)
v_mfma_f32_32x32x16_bf16 v[56:71],a[56:59],v[48:51],v[56:71]
ds_read_b128 v[36:39],v17 offset:18432
buffer_load_dwordx4 v1,s[8:11],s63 offen offset:2048 sc1 lds
v_fma_f32 v118,-v176,v150,v118
v_fma_f32 v119,-v176,v151,v119
v_mfma_f32_32x32x16_bf16 v[72:87],a[216:219],v[48:51],v[72:87]
v_mul_f32 v112,v112,v177
v_mul_f32 v113,v113,v177
v_mul_f32 v114,v114,v177
v_mul_f32 v115,v115,v177
v_mul_f32 v116,v116,v177
v_mfma_f32_32x32x16_bf16 v[56:71],a[60:63],v[52:55],v[56:71]
ds_read_b128 v[40:43],v16 offset:20480
s_waitcnt vmcnt(9)
s_mov_b64 exec,1
buffer_store_dword v5,v1,s[8:11],s59 offen sc1
s_mov_b64 exec,-1
s_mov_b32 s59,2147483648
v_mfma_f32_32x32x16_bf16 v[72:87],a[220:223],v[52:55],v[72:87]
buffer_load_dwordx4 v1,s[8:11],s63 offen offset:3072 sc1 lds
s_add_u32 m0,s61,8192
s_add_u32 s63,s60,8192
v_mul_f32 v117,v117,v177
s_waitcnt lgkmcnt(3)
v_mfma_f32_32x32x16_bf16 v[56:71],a[64:67],v[24:27],v[56:71]
ds_read_b128 v[44:47],v17 offset:20480
v_mul_f32 v118,v118,v177
v_mul_f32 v119,v119,v177
v_cvt_pk_bf16_f32 v112,v112,v113
v_cvt_pk_bf16_f32 v113,v114,v115
v_mfma_f32_32x32x16_bf16 v[72:87],a[224:227],v[24:27],v[72:87]
v_cvt_pk_bf16_f32 v114,v116,v117
v_cvt_pk_bf16_f32 v115,v118,v119
s_lshl_b32 s82,s72,6
s_add_u32 s82,s82,s73
s_lshl_b32 s82,s82,9
s_add_u32 s82,s82,s71
v_mfma_f32_32x32x16_bf16 v[56:71],a[68:71],v[28:31],v[56:71]
ds_read_b128 v[48:51],v16 offset:22528
buffer_load_dwordx4 v1,s[8:11],s63 offen sc1 lds
s_lshl_b32 s75,s69,2
s_add_u32 s82,s82,s75
v_mfma_f32_32x32x16_bf16 v[72:87],a[228:231],v[28:31],v[72:87]
buffer_load_dword v3,v2,s[8:11],s35 offen sc1
buffer_load_dword v14,v4,s[8:11],s41 offen sc1
s_add_u32 s82,s82,s39
s_waitcnt lgkmcnt(3)
v_mfma_f32_32x32x16_bf16 v[56:71],a[72:75],v[32:35],v[56:71]
ds_read_b128 v[52:55],v17 offset:22528
v_add_f32 v156,v156,v166
v_add_f32 v157,v157,v167
v_add_f32 v158,v158,v168
v_mfma_f32_32x32x16_bf16 v[72:87],a[232:235],v[32:35],v[72:87]
buffer_load_dwordx4 v1,s[8:11],s63 offen offset:1024 sc1 lds
v_add_f32 v159,v159,v169
v_add_f32 v160,v160,v170
v_add_f32 v161,v161,v171
v_add_f32 v162,v162,v172
v_mfma_f32_32x32x16_bf16 v[56:71],a[76:79],v[36:39],v[56:71]
ds_read_b128 v[24:27],v16 offset:24576
v_add_f32 v163,v163,v173
v_add_f32 v164,v164,v174
v_add_f32 v165,v165,v175
v_add_f32 v156,v156,v158
v_mfma_f32_32x32x16_bf16 v[72:87],a[236:239],v[36:39],v[72:87]
v_add_f32 v157,v157,v159
v_add_f32 v160,v160,v162
v_add_f32 v161,v161,v163
v_add_f32 v156,v156,v160
v_add_f32 v157,v157,v161
s_waitcnt lgkmcnt(3)
v_mfma_f32_32x32x16_bf16 v[56:71],a[80:83],v[40:43],v[56:71]
ds_read_b128 v[28:31],v17 offset:24576
buffer_store_dwordx4 v[88:91],v20,s[8:11],s74 offen sc1
v_add_f32 v156,v156,v164
v_add_f32 v157,v157,v165
v_mfma_f32_32x32x16_bf16 v[72:87],a[240:243],v[40:43],v[72:87]
v_mov_b32 v158,v156
v_mov_b32 v159,v157
s_nop 0
v_permlane32_swap_b32 v156,v158
v_permlane32_swap_b32 v157,v159
v_add_f32 v176,v156,v158
v_mfma_f32_32x32x16_bf16 v[56:71],a[84:87],v[44:47],v[56:71]
ds_read_b128 v[32:35],v16 offset:26624
buffer_store_dwordx4 v[96:99],v21,s[8:11],s74 offen sc1
v_add_f32 v177,v157,v159
v_mul_f32 v176,0x3acccccd,v176
v_mfma_f32_32x32x16_bf16 v[72:87],a[244:247],v[44:47],v[72:87]
v_mul_f32 v177,0x3acccccd,v177
v_fma_f32 v177,-v176,v176,v177
v_max_f32 v177,0,v177
v_cvt_pk_bf16_f32 v8,v176,v177
v_lshlrev_b32 v176,16,v8
s_waitcnt lgkmcnt(3)
v_mfma_f32_32x32x16_bf16 v[56:71],a[88:91],v[48:51],v[56:71]
ds_read_b128 v[36:39],v17 offset:26624
buffer_store_dwordx4 v[104:107],v20,s[8:11],s74 offen offset:2048 sc1
v_and_b32 v177,0xffff0000,v8
v_add_f32 v177,0x3727c5ac,v177
v_mfma_f32_32x32x16_bf16 v[72:87],a[248:251],v[48:51],v[72:87]
v_cvt_pk_bf16_f32 v8,v177,v177
v_lshlrev_b32 v177,16,v8
v_sqrt_f32 v177,v177
s_nop 0
v_cvt_pk_bf16_f32 v8,v177,v177
v_lshlrev_b32 v177,16,v8
v_mfma_f32_32x32x16_bf16 v[56:71],a[92:95],v[52:55],v[56:71]
ds_read_b128 v[40:43],v16 offset:28672
buffer_store_dwordx4 v[112:115],v21,s[8:11],s74 offen offset:2048 sc1
v_rcp_f32 v177,v177
v_mfma_f32_32x32x16_bf16 v[72:87],a[252:255],v[52:55],v[72:87]
s_cmp_eq_u32 s51,0
s_cselect_b64 s[76:77],-1,0
v_cndmask_b32 v176,v176,0,s[76:77]
v_cndmask_b32 v177,v177,1.0,s[76:77]
s_mov_b32 s72,s51
s_waitcnt lgkmcnt(3)
v_mfma_f32_32x32x16_bf16 v[56:71],a[96:99],v[24:27],v[56:71]
ds_read_b128 v[44:47],v17 offset:28672
s_mov_b32 s73,s52
v_mfma_f32_32x32x16_bf16 v[72:87],v[192:195],v[24:27],v[72:87]
v_mfma_f32_32x32x16_bf16 v[56:71],a[100:103],v[28:31],v[56:71]
ds_read_b128 v[48:51],v16 offset:30720
v_mfma_f32_32x32x16_bf16 v[72:87],v[196:199],v[28:31],v[72:87]
s_waitcnt lgkmcnt(3)
v_mfma_f32_32x32x16_bf16 v[56:71],a[104:107],v[32:35],v[56:71]
ds_read_b128 v[52:55],v17 offset:30720
v_mfma_f32_32x32x16_bf16 v[72:87],v[200:203],v[32:35],v[72:87]
v_mfma_f32_32x32x16_bf16 v[56:71],a[108:111],v[36:39],v[56:71]
ds_read_b128 v[24:27],v16 offset:32768
v_mfma_f32_32x32x16_bf16 v[72:87],v[204:207],v[36:39],v[72:87]
s_waitcnt lgkmcnt(3)
v_mfma_f32_32x32x16_bf16 v[56:71],a[112:115],v[40:43],v[56:71]
ds_read_b128 v[28:31],v17 offset:32768
v_mfma_f32_32x32x16_bf16 v[72:87],v[208:211],v[40:43],v[72:87]
v_mfma_f32_32x32x16_bf16 v[56:71],a[116:119],v[44:47],v[56:71]
ds_read_b128 v[32:35],v16 offset:34816
v_mfma_f32_32x32x16_bf16 v[72:87],v[212:215],v[44:47],v[72:87]
s_waitcnt lgkmcnt(3)
v_mfma_f32_32x32x16_bf16 v[56:71],a[120:123],v[48:51],v[56:71]
ds_read_b128 v[36:39],v17 offset:34816
v_mfma_f32_32x32x16_bf16 v[72:87],v[216:219],v[48:51],v[72:87]
v_mfma_f32_32x32x16_bf16 v[56:71],a[124:127],v[52:55],v[56:71]
ds_read_b128 v[40:43],v16 offset:36864
v_mfma_f32_32x32x16_bf16 v[72:87],v[220:223],v[52:55],v[72:87]
s_waitcnt lgkmcnt(3)
v_mfma_f32_32x32x16_bf16 v[56:71],a[128:131],v[24:27],v[56:71]
ds_read_b128 v[44:47],v17 offset:36864
s_waitcnt vmcnt(4)
v_cmp_eq_u32 vcc,0,v14
s_cmp_eq_u64 vcc,0
s_cselect_b32 s36,0,2147483648
v_mfma_f32_32x32x16_bf16 v[72:87],v[224:227],v[24:27],v[72:87]
v_cmp_eq_u32 vcc,0,v3
s_cmp_lt_u32 s78,64
s_cselect_b32 s36,s36,2147483648
s_cmp_eq_u64 vcc,0
s_cselect_b32 s60,1,s36
v_mfma_f32_32x32x16_bf16 v[56:71],a[132:135],v[28:31],v[56:71]
ds_read_b128 v[48:51],v16 offset:38912
s_cmp_lt_u32 s79,64
s_cselect_b32 s60,s60,s36
s_sub_u32 s61,s78,s79
s_or_b32 s61,s61,s36
v_mfma_f32_32x32x16_bf16 v[72:87],v[228:231],v[28:31],v[72:87]
s_cmp_lt_u32 s61,16
s_cselect_b32 s36,0,s60
v_mov_b32 v23,s36
s_waitcnt lgkmcnt(3)
v_mfma_f32_32x32x16_bf16 v[56:71],a[136:139],v[32:35],v[56:71]
ds_read_b128 v[52:55],v17 offset:38912
ds_write_b32 v13,v23
v_mfma_f32_32x32x16_bf16 v[72:87],v[232:235],v[32:35],v[72:87]
s_waitcnt lgkmcnt(0)
s_barrier
ds_read_b32 v23,v22
v_mfma_f32_32x32x16_bf16 v[56:71],a[140:143],v[36:39],v[56:71]
ds_read_b128 v[24:27],v18 offset:0
s_cmp_lt_u32 s50,2
s_cselect_b32 s42,1,0
s_cmp_ge_u32 s78,64
s_cselect_b32 s42,1,s42
v_mfma_f32_32x32x16_bf16 v[72:87],v[236:239],v[36:39],v[72:87]
s_or_b32 s42,s42,s37
s_mov_b32 s39,0
s_add_u32 s50,s50,1
s_sub_u32 s57,46080,s57
s_mov_b32 s51,s53
s_mov_b32 s52,s54
v_mfma_f32_32x32x16_bf16 v[56:71],a[144:147],v[40:43],v[56:71]
ds_read_b128 v[28:31],v19 offset:0
v_mfma_f32_32x32x16_bf16 v[72:87],v[240:243],v[40:43],v[72:87]
v_mfma_f32_32x32x16_bf16 v[56:71],a[148:151],v[44:47],v[56:71]
ds_read_b128 v[32:35],v18 offset:2048
s_waitcnt vmcnt(0)
s_mov_b64 exec,1
buffer_store_dword v5,v1,s[8:11],s82 offen sc1
s_mov_b64 exec,-1
s_mov_b32 s82,2147483648
v_mfma_f32_32x32x16_bf16 v[72:87],v[244:247],v[44:47],v[72:87]
s_waitcnt lgkmcnt(3)
v_readfirstlane_b32 s38,v23
s_and_b32 s37,s38,2147483648
s_and_b32 s33,s38,1
s_cselect_b32 s34,s79,s78
s_cmp_lg_u32 s42,0
v_mfma_f32_32x32x16_bf16 v[56:71],a[152:155],v[48:51],v[56:71]
ds_read_b128 v[36:39],v19 offset:2048
v_mfma_f32_32x32x16_bf16 v[72:87],v[248:251],v[48:51],v[72:87]
v_mfma_f32_32x32x16_bf16 v[56:71],a[156:159],v[52:55],v[56:71]
ds_read_b128 v[40:43],v18 offset:4096
v_mfma_f32_32x32x16_bf16 v[72:87],v[252:255],v[52:55],v[72:87]
s_cbranch_scc1 QKVQ_S0
QKVQ_B1:
s_waitcnt lgkmcnt(3)
v_mfma_f32_32x32x16_bf16 v[88:103],a[0:3],v[24:27],0
ds_read_b128 v[44:47],v19 offset:4096
v_add_u32 v189,s57,v188
v_mfma_f32_32x32x16_bf16 v[104:119],a[160:163],v[24:27],0
v_add_u32 v8,0x800,v189
s_sub_u32 s66,46080,s57
s_lshl_b32 s60,s33,6
s_add_u32 s60,s60,s34
s_mul_i32 s60,s60,46080
s_add_u32 s60,s60,s37
v_mfma_f32_32x32x16_bf16 v[88:103],a[4:7],v[28:31],v[88:103]
ds_read_b128 v[48:51],v18 offset:6144
ds_read2_b64 v[156:159],v189 offset0:0 offset1:32
s_add_u32 s60,s60,206569472
s_lshl_b32 s62,s46,10
v_mfma_f32_32x32x16_bf16 v[104:119],a[164:167],v[28:31],v[104:119]
ds_read2_b64 v[160:163],v189 offset0:64 offset1:96
s_add_u32 s62,s62,40960
s_add_u32 m0,s66,s62
s_add_u32 s63,s60,s62
s_waitcnt lgkmcnt(5)
v_mfma_f32_32x32x16_bf16 v[88:103],a[8:11],v[32:35],v[88:103]
ds_read_b128 v[52:55],v19 offset:6144
ds_read2_b64 v[164:167],v189 offset0:128 offset1:160
buffer_load_dwordx4 v1,s[8:11],s63 offen sc1 lds
v_mfma_f32_32x32x16_bf16 v[104:119],a[168:171],v[32:35],v[104:119]
ds_read2_b64 v[168:171],v189 offset0:192 offset1:224
s_add_u32 m0,s66,45056
s_add_u32 s63,s60,45056
s_mul_i32 s74,s73,393216
s_add_u32 s74,s74,s39
v_mfma_f32_32x32x16_bf16 v[88:103],a[12:15],v[36:39],v[88:103]
ds_read_b128 v[24:27],v18 offset:8192
ds_read2_b64 v[172:175],v8 offset0:0 offset1:32
s_add_u32 s74,s74,s70
v_fma_f32 v56,-v176,v120,v56
v_mfma_f32_32x32x16_bf16 v[104:119],a[172:175],v[36:39],v[104:119]
buffer_load_dwordx4 v1,s[8:11],s63 offen sc1 lds
s_mul_i32 s61,s46,10240
s_add_u32 s60,s60,s61
s_add_u32 s61,s61,s66
s_waitcnt lgkmcnt(8)
v_mfma_f32_32x32x16_bf16 v[88:103],a[16:19],v[40:43],v[88:103]
ds_read_b128 v[28:31],v19 offset:8192
s_add_u32 m0,s61,0
s_add_u32 s63,s60,0
v_fma_f32 v57,-v176,v121,v57
v_fma_f32 v58,-v176,v122,v58
v_mfma_f32_32x32x16_bf16 v[104:119],a[176:179],v[40:43],v[104:119]
v_fma_f32 v59,-v176,v123,v59
v_fma_f32 v60,-v176,v124,v60
v_fma_f32 v61,-v176,v125,v61
v_fma_f32 v62,-v176,v126,v62
v_fma_f32 v63,-v176,v127,v63
v_mfma_f32_32x32x16_bf16 v[88:103],a[20:23],v[44:47],v[88:103]
ds_read_b128 v[32:35],v18 offset:10240
buffer_load_dwordx4 v1,s[8:11],s63 offen sc1 lds
s_mov_b32 s53,s33
s_mov_b32 s54,s34
v_mfma_f32_32x32x16_bf16 v[104:119],a[180:183],v[44:47],v[104:119]
s_add_u32 s79,s79,s33
s_or_b32 s65,s37,s33
s_cmp_eq_u32 s65,0
s_addc_u32 s78,s78,0
s_lshl_b32 s41,s78,9
s_waitcnt lgkmcnt(6)
v_mfma_f32_32x32x16_bf16 v[88:103],a[24:27],v[48:51],v[88:103]
ds_read_b128 v[36:39],v19 offset:10240
s_add_u32 s41,s41,s40
s_lshl_b32 s35,s79,9
s_add_u32 s35,s35,s40
s_add_u32 s35,s35,32768
v_mfma_f32_32x32x16_bf16 v[104:119],a[184:187],v[48:51],v[104:119]
buffer_load_dwordx4 v1,s[8:11],s63 offen offset:1024 sc1 lds
v_mul_f32 v56,v56,v177
v_mul_f32 v57,v57,v177
v_mul_f32 v58,v58,v177
v_mul_f32 v59,v59,v177
v_mfma_f32_32x32x16_bf16 v[88:103],a[28:31],v[52:55],v[88:103]
ds_read_b128 v[40:43],v18 offset:12288
v_mul_f32 v60,v60,v177
v_mul_f32 v61,v61,v177
v_mul_f32 v62,v62,v177
v_mul_f32 v63,v63,v177
v_mfma_f32_32x32x16_bf16 v[104:119],a[188:191],v[52:55],v[104:119]
v_cvt_pk_bf16_f32 v56,v56,v57
v_cvt_pk_bf16_f32 v57,v58,v59
v_cvt_pk_bf16_f32 v58,v60,v61
v_cvt_pk_bf16_f32 v59,v62,v63
v_fma_f32 v64,-v176,v128,v64
s_waitcnt lgkmcnt(3)
v_mfma_f32_32x32x16_bf16 v[88:103],a[32:35],v[24:27],v[88:103]
ds_read_b128 v[44:47],v19 offset:12288
buffer_load_dwordx4 v1,s[8:11],s63 offen offset:2048 sc1 lds
v_fma_f32 v65,-v176,v129,v65
v_fma_f32 v66,-v176,v130,v66
v_mfma_f32_32x32x16_bf16 v[104:119],a[192:195],v[24:27],v[104:119]
v_fma_f32 v67,-v176,v131,v67
v_fma_f32 v68,-v176,v132,v68
v_fma_f32 v69,-v176,v133,v69
v_fma_f32 v70,-v176,v134,v70
v_fma_f32 v71,-v176,v135,v71
v_mfma_f32_32x32x16_bf16 v[88:103],a[36:39],v[28:31],v[88:103]
ds_read_b128 v[48:51],v18 offset:14336
v_mul_f32 v64,v64,v177
v_mul_f32 v65,v65,v177
v_mul_f32 v66,v66,v177
v_mul_f32 v67,v67,v177
v_mfma_f32_32x32x16_bf16 v[104:119],a[196:199],v[28:31],v[104:119]
buffer_load_dwordx4 v1,s[8:11],s63 offen offset:3072 sc1 lds
s_add_u32 m0,s61,4096
s_add_u32 s63,s60,4096
v_mul_f32 v68,v68,v177
s_waitcnt lgkmcnt(3)
v_mfma_f32_32x32x16_bf16 v[88:103],a[40:43],v[32:35],v[88:103]
ds_read_b128 v[52:55],v19 offset:14336
v_mul_f32 v69,v69,v177
v_mul_f32 v70,v70,v177
v_mul_f32 v71,v71,v177
v_cvt_pk_bf16_f32 v64,v64,v65
v_mfma_f32_32x32x16_bf16 v[104:119],a[200:203],v[32:35],v[104:119]
v_cvt_pk_bf16_f32 v65,v66,v67
v_cvt_pk_bf16_f32 v66,v68,v69
v_cvt_pk_bf16_f32 v67,v70,v71
v_fma_f32 v72,-v176,v136,v72
v_fma_f32 v73,-v176,v137,v73
v_mfma_f32_32x32x16_bf16 v[88:103],a[44:47],v[36:39],v[88:103]
ds_read_b128 v[24:27],v18 offset:16384
buffer_load_dwordx4 v1,s[8:11],s63 offen sc1 lds
v_fma_f32 v74,-v176,v138,v74
v_fma_f32 v75,-v176,v139,v75
v_mfma_f32_32x32x16_bf16 v[104:119],a[204:207],v[36:39],v[104:119]
v_fma_f32 v76,-v176,v140,v76
v_fma_f32 v77,-v176,v141,v77
v_fma_f32 v78,-v176,v142,v78
v_fma_f32 v79,-v176,v143,v79
v_mul_f32 v72,v72,v177
s_waitcnt lgkmcnt(3)
v_mfma_f32_32x32x16_bf16 v[88:103],a[48:51],v[40:43],v[88:103]
ds_read_b128 v[28:31],v19 offset:16384
v_mul_f32 v73,v73,v177
v_mul_f32 v74,v74,v177
v_mul_f32 v75,v75,v177
v_mul_f32 v76,v76,v177
v_mfma_f32_32x32x16_bf16 v[104:119],a[208:211],v[40:43],v[104:119]
buffer_load_dwordx4 v1,s[8:11],s63 offen offset:1024 sc1 lds
v_mul_f32 v77,v77,v177
v_mul_f32 v78,v78,v177
v_mul_f32 v79,v79,v177
v_cvt_pk_bf16_f32 v72,v72,v73
v_mfma_f32_32x32x16_bf16 v[88:103],a[52:55],v[44:47],v[88:103]
ds_read_b128 v[32:35],v18 offset:18432
v_cvt_pk_bf16_f32 v73,v74,v75
v_cvt_pk_bf16_f32 v74,v76,v77
v_cvt_pk_bf16_f32 v75,v78,v79
v_fma_f32 v80,-v176,v144,v80
v_mfma_f32_32x32x16_bf16 v[104:119],a[212:215],v[44:47],v[104:119]
v_fma_f32 v81,-v176,v145,v81
v_fma_f32 v82,-v176,v146,v82
v_fma_f32 v83,-v176,v147,v83
v_fma_f32 v84,-v176,v148,v84
v_fma_f32 v85,-v176,v149,v85
s_waitcnt lgkmcnt(3)
v_mfma_f32_32x32x16_bf16 v[88:103],a[56:59],v[48:51],v[88:103]
ds_read_b128 v[36:39],v19 offset:18432
buffer_load_dwordx4 v1,s[8:11],s63 offen offset:2048 sc1 lds
v_fma_f32 v86,-v176,v150,v86
v_fma_f32 v87,-v176,v151,v87
v_mfma_f32_32x32x16_bf16 v[104:119],a[216:219],v[48:51],v[104:119]
v_mul_f32 v80,v80,v177
v_mul_f32 v81,v81,v177
v_mul_f32 v82,v82,v177
v_mul_f32 v83,v83,v177
v_mul_f32 v84,v84,v177
v_mfma_f32_32x32x16_bf16 v[88:103],a[60:63],v[52:55],v[88:103]
ds_read_b128 v[40:43],v18 offset:20480
s_waitcnt vmcnt(9)
s_mov_b64 exec,1
buffer_store_dword v5,v1,s[8:11],s59 offen sc1
s_mov_b64 exec,-1
s_mov_b32 s59,2147483648
v_mfma_f32_32x32x16_bf16 v[104:119],a[220:223],v[52:55],v[104:119]
buffer_load_dwordx4 v1,s[8:11],s63 offen offset:3072 sc1 lds
s_add_u32 m0,s61,8192
s_add_u32 s63,s60,8192
v_mul_f32 v85,v85,v177
s_waitcnt lgkmcnt(3)
v_mfma_f32_32x32x16_bf16 v[88:103],a[64:67],v[24:27],v[88:103]
ds_read_b128 v[44:47],v19 offset:20480
v_mul_f32 v86,v86,v177
v_mul_f32 v87,v87,v177
v_cvt_pk_bf16_f32 v80,v80,v81
v_cvt_pk_bf16_f32 v81,v82,v83
v_mfma_f32_32x32x16_bf16 v[104:119],a[224:227],v[24:27],v[104:119]
v_cvt_pk_bf16_f32 v82,v84,v85
v_cvt_pk_bf16_f32 v83,v86,v87
s_lshl_b32 s82,s72,6
s_add_u32 s82,s82,s73
s_lshl_b32 s82,s82,9
s_add_u32 s82,s82,s71
v_mfma_f32_32x32x16_bf16 v[88:103],a[68:71],v[28:31],v[88:103]
ds_read_b128 v[48:51],v18 offset:22528
buffer_load_dwordx4 v1,s[8:11],s63 offen sc1 lds
s_lshl_b32 s75,s69,2
s_add_u32 s82,s82,s75
v_mfma_f32_32x32x16_bf16 v[104:119],a[228:231],v[28:31],v[104:119]
buffer_load_dword v3,v2,s[8:11],s35 offen sc1
buffer_load_dword v14,v4,s[8:11],s41 offen sc1
s_add_u32 s82,s82,s39
s_waitcnt lgkmcnt(3)
v_mfma_f32_32x32x16_bf16 v[88:103],a[72:75],v[32:35],v[88:103]
ds_read_b128 v[52:55],v19 offset:22528
v_add_f32 v156,v156,v166
v_add_f32 v157,v157,v167
v_add_f32 v158,v158,v168
v_mfma_f32_32x32x16_bf16 v[104:119],a[232:235],v[32:35],v[104:119]
buffer_load_dwordx4 v1,s[8:11],s63 offen offset:1024 sc1 lds
v_add_f32 v159,v159,v169
v_add_f32 v160,v160,v170
v_add_f32 v161,v161,v171
v_add_f32 v162,v162,v172
v_mfma_f32_32x32x16_bf16 v[88:103],a[76:79],v[36:39],v[88:103]
ds_read_b128 v[24:27],v18 offset:24576
v_add_f32 v163,v163,v173
v_add_f32 v164,v164,v174
v_add_f32 v165,v165,v175
v_add_f32 v156,v156,v158
v_mfma_f32_32x32x16_bf16 v[104:119],a[236:239],v[36:39],v[104:119]
v_add_f32 v157,v157,v159
v_add_f32 v160,v160,v162
v_add_f32 v161,v161,v163
v_add_f32 v156,v156,v160
v_add_f32 v157,v157,v161
s_waitcnt lgkmcnt(3)
v_mfma_f32_32x32x16_bf16 v[88:103],a[80:83],v[40:43],v[88:103]
ds_read_b128 v[28:31],v19 offset:24576
buffer_store_dwordx4 v[56:59],v20,s[8:11],s74 offen sc1
v_add_f32 v156,v156,v164
v_add_f32 v157,v157,v165
v_mfma_f32_32x32x16_bf16 v[104:119],a[240:243],v[40:43],v[104:119]
v_mov_b32 v158,v156
v_mov_b32 v159,v157
s_nop 0
v_permlane32_swap_b32 v156,v158
v_permlane32_swap_b32 v157,v159
v_add_f32 v176,v156,v158
v_mfma_f32_32x32x16_bf16 v[88:103],a[84:87],v[44:47],v[88:103]
ds_read_b128 v[32:35],v18 offset:26624
buffer_store_dwordx4 v[64:67],v21,s[8:11],s74 offen sc1
v_add_f32 v177,v157,v159
v_mul_f32 v176,0x3acccccd,v176
v_mfma_f32_32x32x16_bf16 v[104:119],a[244:247],v[44:47],v[104:119]
v_mul_f32 v177,0x3acccccd,v177
v_fma_f32 v177,-v176,v176,v177
v_max_f32 v177,0,v177
v_cvt_pk_bf16_f32 v8,v176,v177
v_lshlrev_b32 v176,16,v8
s_waitcnt lgkmcnt(3)
v_mfma_f32_32x32x16_bf16 v[88:103],a[88:91],v[48:51],v[88:103]
ds_read_b128 v[36:39],v19 offset:26624
buffer_store_dwordx4 v[72:75],v20,s[8:11],s74 offen offset:2048 sc1
v_and_b32 v177,0xffff0000,v8
v_add_f32 v177,0x3727c5ac,v177
v_mfma_f32_32x32x16_bf16 v[104:119],a[248:251],v[48:51],v[104:119]
v_cvt_pk_bf16_f32 v8,v177,v177
v_lshlrev_b32 v177,16,v8
v_sqrt_f32 v177,v177
s_nop 0
v_cvt_pk_bf16_f32 v8,v177,v177
v_lshlrev_b32 v177,16,v8
v_mfma_f32_32x32x16_bf16 v[88:103],a[92:95],v[52:55],v[88:103]
ds_read_b128 v[40:43],v18 offset:28672
buffer_store_dwordx4 v[80:83],v21,s[8:11],s74 offen offset:2048 sc1
v_rcp_f32 v177,v177
v_mfma_f32_32x32x16_bf16 v[104:119],a[252:255],v[52:55],v[104:119]
s_cmp_eq_u32 s51,0
s_cselect_b64 s[76:77],-1,0
v_cndmask_b32 v176,v176,0,s[76:77]
v_cndmask_b32 v177,v177,1.0,s[76:77]
s_mov_b32 s72,s51
s_waitcnt lgkmcnt(3)
v_mfma_f32_32x32x16_bf16 v[88:103],a[96:99],v[24:27],v[88:103]
ds_read_b128 v[44:47],v19 offset:28672
s_mov_b32 s73,s52
v_mfma_f32_32x32x16_bf16 v[104:119],v[192:195],v[24:27],v[104:119]
v_mfma_f32_32x32x16_bf16 v[88:103],a[100:103],v[28:31],v[88:103]
ds_read_b128 v[48:51],v18 offset:30720
v_mfma_f32_32x32x16_bf16 v[104:119],v[196:199],v[28:31],v[104:119]
s_waitcnt lgkmcnt(3)
v_mfma_f32_32x32x16_bf16 v[88:103],a[104:107],v[32:35],v[88:103]
ds_read_b128 v[52:55],v19 offset:30720
v_mfma_f32_32x32x16_bf16 v[104:119],v[200:203],v[32:35],v[104:119]
v_mfma_f32_32x32x16_bf16 v[88:103],a[108:111],v[36:39],v[88:103]
ds_read_b128 v[24:27],v18 offset:32768
v_mfma_f32_32x32x16_bf16 v[104:119],v[204:207],v[36:39],v[104:119]
s_waitcnt lgkmcnt(3)
v_mfma_f32_32x32x16_bf16 v[88:103],a[112:115],v[40:43],v[88:103]
ds_read_b128 v[28:31],v19 offset:32768
v_mfma_f32_32x32x16_bf16 v[104:119],v[208:211],v[40:43],v[104:119]
v_mfma_f32_32x32x16_bf16 v[88:103],a[116:119],v[44:47],v[88:103]
ds_read_b128 v[32:35],v18 offset:34816
v_mfma_f32_32x32x16_bf16 v[104:119],v[212:215],v[44:47],v[104:119]
s_waitcnt lgkmcnt(3)
v_mfma_f32_32x32x16_bf16 v[88:103],a[120:123],v[48:51],v[88:103]
ds_read_b128 v[36:39],v19 offset:34816
v_mfma_f32_32x32x16_bf16 v[104:119],v[216:219],v[48:51],v[104:119]
v_mfma_f32_32x32x16_bf16 v[88:103],a[124:127],v[52:55],v[88:103]
ds_read_b128 v[40:43],v18 offset:36864
v_mfma_f32_32x32x16_bf16 v[104:119],v[220:223],v[52:55],v[104:119]
s_waitcnt lgkmcnt(3)
v_mfma_f32_32x32x16_bf16 v[88:103],a[128:131],v[24:27],v[88:103]
ds_read_b128 v[44:47],v19 offset:36864
s_waitcnt vmcnt(4)
v_cmp_eq_u32 vcc,0,v14
s_cmp_eq_u64 vcc,0
s_cselect_b32 s36,0,2147483648
v_mfma_f32_32x32x16_bf16 v[104:119],v[224:227],v[24:27],v[104:119]
v_cmp_eq_u32 vcc,0,v3
s_cmp_lt_u32 s78,64
s_cselect_b32 s36,s36,2147483648
s_cmp_eq_u64 vcc,0
s_cselect_b32 s60,1,s36
v_mfma_f32_32x32x16_bf16 v[88:103],a[132:135],v[28:31],v[88:103]
ds_read_b128 v[48:51],v18 offset:38912
s_cmp_lt_u32 s79,64
s_cselect_b32 s60,s60,s36
s_sub_u32 s61,s78,s79
s_or_b32 s61,s61,s36
v_mfma_f32_32x32x16_bf16 v[104:119],v[228:231],v[28:31],v[104:119]
s_cmp_lt_u32 s61,16
s_cselect_b32 s36,0,s60
v_mov_b32 v23,s36
s_waitcnt lgkmcnt(3)
v_mfma_f32_32x32x16_bf16 v[88:103],a[136:139],v[32:35],v[88:103]
ds_read_b128 v[52:55],v19 offset:38912
ds_write_b32 v13,v23
v_mfma_f32_32x32x16_bf16 v[104:119],v[232:235],v[32:35],v[104:119]
s_waitcnt lgkmcnt(0)
s_barrier
ds_read_b32 v23,v22
v_mfma_f32_32x32x16_bf16 v[88:103],a[140:143],v[36:39],v[88:103]
ds_read_b128 v[24:27],v16 offset:0
s_cmp_lt_u32 s50,2
s_cselect_b32 s42,1,0
s_cmp_ge_u32 s78,64
s_cselect_b32 s42,1,s42
v_mfma_f32_32x32x16_bf16 v[104:119],v[236:239],v[36:39],v[104:119]
s_or_b32 s42,s42,s37
s_mov_b32 s39,0
s_add_u32 s50,s50,1
s_sub_u32 s57,46080,s57
s_mov_b32 s51,s53
s_mov_b32 s52,s54
v_mfma_f32_32x32x16_bf16 v[88:103],a[144:147],v[40:43],v[88:103]
ds_read_b128 v[28:31],v17 offset:0
v_mfma_f32_32x32x16_bf16 v[104:119],v[240:243],v[40:43],v[104:119]
v_mfma_f32_32x32x16_bf16 v[88:103],a[148:151],v[44:47],v[88:103]
ds_read_b128 v[32:35],v16 offset:2048
s_waitcnt vmcnt(0)
s_mov_b64 exec,1
buffer_store_dword v5,v1,s[8:11],s82 offen sc1
s_mov_b64 exec,-1
s_mov_b32 s82,2147483648
v_mfma_f32_32x32x16_bf16 v[104:119],v[244:247],v[44:47],v[104:119]
s_waitcnt lgkmcnt(3)
v_readfirstlane_b32 s38,v23
s_and_b32 s37,s38,2147483648
s_and_b32 s33,s38,1
s_cselect_b32 s34,s79,s78
s_cmp_lg_u32 s42,0
v_mfma_f32_32x32x16_bf16 v[88:103],a[152:155],v[48:51],v[88:103]
ds_read_b128 v[36:39],v17 offset:2048
v_mfma_f32_32x32x16_bf16 v[104:119],v[248:251],v[48:51],v[104:119]
v_mfma_f32_32x32x16_bf16 v[88:103],a[156:159],v[52:55],v[88:103]
ds_read_b128 v[40:43],v16 offset:4096
v_mfma_f32_32x32x16_bf16 v[104:119],v[252:255],v[52:55],v[104:119]
s_cbranch_scc0 QKVQ_B0
s_branch QKVQ_S1
s_nop 9
QKVQ_S0:
s_mov_b32 s55,0
s_cmp_lt_u32 s42,2
s_cbranch_scc1 nt_201
s_mov_b32 s55,2
s_cmp_lg_u32 s37,0
s_cbranch_scc1 nt_201
s_mov_b32 s55,1
s_lshl_b32 s60,s33,6
s_add_u32 s60,s60,s34
s_mul_i32 s60,s60,46080
s_add_u32 s60,s60,206569472
s_lshl_b32 s62,s46,10
s_add_u32 s62,s62,40960
s_add_u32 m0,s57,s62
s_add_u32 s63,s60,s62
buffer_load_dwordx4 v1,s[8:11],s63 offen sc1 lds
s_add_u32 m0,s57,45056
s_add_u32 s63,s60,45056
buffer_load_dwordx4 v1,s[8:11],s63 offen sc1 lds
s_mul_i32 s61,s46,10240
s_add_u32 s60,s60,s61
s_add_u32 s61,s61,s57
s_add_u32 m0,s61,0
s_add_u32 s63,s60,0
buffer_load_dwordx4 v1,s[8:11],s63 offen sc1 lds
buffer_load_dwordx4 v1,s[8:11],s63 offen offset:1024 sc1 lds
buffer_load_dwordx4 v1,s[8:11],s63 offen offset:2048 sc1 lds
buffer_load_dwordx4 v1,s[8:11],s63 offen offset:3072 sc1 lds
s_add_u32 m0,s61,4096
s_add_u32 s63,s60,4096
buffer_load_dwordx4 v1,s[8:11],s63 offen sc1 lds
buffer_load_dwordx4 v1,s[8:11],s63 offen offset:1024 sc1 lds
buffer_load_dwordx4 v1,s[8:11],s63 offen offset:2048 sc1 lds
buffer_load_dwordx4 v1,s[8:11],s63 offen offset:3072 sc1 lds
s_add_u32 m0,s61,8192
s_add_u32 s63,s60,8192
buffer_load_dwordx4 v1,s[8:11],s63 offen sc1 lds
buffer_load_dwordx4 v1,s[8:11],s63 offen offset:1024 sc1 lds
nt_201:
s_nop 4
s_mul_i32 s74,s73,393216
s_add_u32 s74,s74,s39
s_add_u32 s74,s74,s70
v_fma_f32 v56,-v176,v120,v56
v_fma_f32 v57,-v176,v121,v57
v_fma_f32 v58,-v176,v122,v58
v_fma_f32 v59,-v176,v123,v59
v_fma_f32 v60,-v176,v124,v60
v_fma_f32 v61,-v176,v125,v61
v_fma_f32 v62,-v176,v126,v62
v_fma_f32 v63,-v176,v127,v63
v_mul_f32 v56,v56,v177
v_mul_f32 v57,v57,v177
v_mul_f32 v58,v58,v177
v_mul_f32 v59,v59,v177
v_mul_f32 v60,v60,v177
v_mul_f32 v61,v61,v177
v_mul_f32 v62,v62,v177
v_mul_f32 v63,v63,v177
v_cvt_pk_bf16_f32 v56,v56,v57
v_cvt_pk_bf16_f32 v57,v58,v59
v_cvt_pk_bf16_f32 v58,v60,v61
v_cvt_pk_bf16_f32 v59,v62,v63
buffer_store_dwordx4 v[56:59],v20,s[8:11],s74 offen sc1
v_fma_f32 v64,-v176,v128,v64
v_fma_f32 v65,-v176,v129,v65
v_fma_f32 v66,-v176,v130,v66
v_fma_f32 v67,-v176,v131,v67
v_fma_f32 v68,-v176,v132,v68
v_fma_f32 v69,-v176,v133,v69
v_fma_f32 v70,-v176,v134,v70
v_fma_f32 v71,-v176,v135,v71
v_mul_f32 v64,v64,v177
v_mul_f32 v65,v65,v177
v_mul_f32 v66,v66,v177
v_mul_f32 v67,v67,v177
v_mul_f32 v68,v68,v177
v_mul_f32 v69,v69,v177
v_mul_f32 v70,v70,v177
v_mul_f32 v71,v71,v177
v_cvt_pk_bf16_f32 v64,v64,v65
v_cvt_pk_bf16_f32 v65,v66,v67
v_cvt_pk_bf16_f32 v66,v68,v69
v_cvt_pk_bf16_f32 v67,v70,v71
buffer_store_dwordx4 v[64:67],v21,s[8:11],s74 offen sc1
v_fma_f32 v72,-v176,v136,v72
v_fma_f32 v73,-v176,v137,v73
v_fma_f32 v74,-v176,v138,v74
v_fma_f32 v75,-v176,v139,v75
v_fma_f32 v76,-v176,v140,v76
v_fma_f32 v77,-v176,v141,v77
v_fma_f32 v78,-v176,v142,v78
v_fma_f32 v79,-v176,v143,v79
v_mul_f32 v72,v72,v177
v_mul_f32 v73,v73,v177
v_mul_f32 v74,v74,v177
v_mul_f32 v75,v75,v177
v_mul_f32 v76,v76,v177
v_mul_f32 v77,v77,v177
v_mul_f32 v78,v78,v177
v_mul_f32 v79,v79,v177
v_cvt_pk_bf16_f32 v72,v72,v73
v_cvt_pk_bf16_f32 v73,v74,v75
v_cvt_pk_bf16_f32 v74,v76,v77
v_cvt_pk_bf16_f32 v75,v78,v79
buffer_store_dwordx4 v[72:75],v20,s[8:11],s74 offen offset:2048 sc1
v_fma_f32 v80,-v176,v144,v80
v_fma_f32 v81,-v176,v145,v81
v_fma_f32 v82,-v176,v146,v82
v_fma_f32 v83,-v176,v147,v83
v_fma_f32 v84,-v176,v148,v84
v_fma_f32 v85,-v176,v149,v85
v_fma_f32 v86,-v176,v150,v86
v_fma_f32 v87,-v176,v151,v87
v_mul_f32 v80,v80,v177
v_mul_f32 v81,v81,v177
v_mul_f32 v82,v82,v177
v_mul_f32 v83,v83,v177
v_mul_f32 v84,v84,v177
v_mul_f32 v85,v85,v177
v_mul_f32 v86,v86,v177
v_mul_f32 v87,v87,v177
v_cvt_pk_bf16_f32 v80,v80,v81
v_cvt_pk_bf16_f32 v81,v82,v83
v_cvt_pk_bf16_f32 v82,v84,v85
v_cvt_pk_bf16_f32 v83,v86,v87
buffer_store_dwordx4 v[80:83],v21,s[8:11],s74 offen offset:2048 sc1
s_lshl_b32 s82,s72,6
s_add_u32 s82,s82,s73
s_lshl_b32 s82,s82,9
s_add_u32 s82,s82,s71
s_lshl_b32 s75,s69,2
s_add_u32 s82,s82,s75
s_add_u32 s82,s82,s39
s_mov_b32 s59,s82
s_mov_b32 s82,2147483648
s_mov_b32 s39,2147483648
s_cmp_eq_u32 s55,0
s_cbranch_scc1 QKVQ_B1
s_cmp_eq_u32 s55,1
s_cbranch_scc1 QKVQ_CD1
s_waitcnt vmcnt(0)
s_mov_b64 exec,1
buffer_store_dword v5,v1,s[8:11],s59 offen sc1
s_mov_b64 exec,-1
s_mov_b32 s59,2147483648
s_cmp_eq_u32 s50,128
s_cbranch_scc1 QKVQ_END
s_branch QKVQ_COLD1
QKVQ_COLD0:
s_cmp_lg_u32 s46,0
s_cbranch_scc1 cp_202
ct_203:
buffer_load_dword v3,v2,s[8:11],s35 offen sc1
buffer_load_dword v14,v4,s[8:11],s41 offen sc1
s_waitcnt vmcnt(0)
v_cmp_eq_u32 vcc,0,v14
s_cmp_eq_u64 vcc,0
s_cselect_b32 s36,0,2147483648
v_cmp_eq_u32 vcc,0,v3
s_cmp_lt_u32 s78,64
s_cselect_b32 s36,s36,2147483648
s_cmp_eq_u64 vcc,0
s_cselect_b32 s60,1,s36
s_cmp_lt_u32 s79,64
s_cselect_b32 s60,s60,s36
s_sub_u32 s61,s78,s79
s_or_b32 s61,s61,s36
s_cmp_lt_u32 s61,16
s_cselect_b32 s36,0,s60
v_mov_b32 v23,s36
s_cmp_lt_u32 s36,2
s_cbranch_scc1 ct_203x
s_sleep 3
s_sub_u32 s47,s47,1
s_cbranch_scc1 ABORT
s_branch ct_203
ct_203x:
ds_write_b32 v22,v23 offset:4
s_waitcnt lgkmcnt(0)
cp_202:
s_barrier
ds_read_b32 v23,v22 offset:4
s_waitcnt lgkmcnt(0)
v_readfirstlane_b32 s38,v23
s_and_b32 s38,s38,1
s_and_b32 s37,s38,2147483648
s_and_b32 s33,s38,1
s_cselect_b32 s34,s79,s78
s_lshl_b32 s60,s33,6
s_add_u32 s60,s60,s34
s_mul_i32 s60,s60,46080
s_add_u32 s60,s60,206569472
s_lshl_b32 s62,s46,10
s_add_u32 s62,s62,40960
s_add_u32 m0,s57,s62
s_add_u32 s63,s60,s62
buffer_load_dwordx4 v1,s[8:11],s63 offen sc1 lds
s_add_u32 m0,s57,45056
s_add_u32 s63,s60,45056
buffer_load_dwordx4 v1,s[8:11],s63 offen sc1 lds
s_mul_i32 s61,s46,10240
s_add_u32 s60,s60,s61
s_add_u32 s61,s61,s57
s_add_u32 m0,s61,0
s_add_u32 s63,s60,0
buffer_load_dwordx4 v1,s[8:11],s63 offen sc1 lds
buffer_load_dwordx4 v1,s[8:11],s63 offen offset:1024 sc1 lds
buffer_load_dwordx4 v1,s[8:11],s63 offen offset:2048 sc1 lds
buffer_load_dwordx4 v1,s[8:11],s63 offen offset:3072 sc1 lds
s_add_u32 m0,s61,4096
s_add_u32 s63,s60,4096
buffer_load_dwordx4 v1,s[8:11],s63 offen sc1 lds
buffer_load_dwordx4 v1,s[8:11],s63 offen offset:1024 sc1 lds
buffer_load_dwordx4 v1,s[8:11],s63 offen offset:2048 sc1 lds
buffer_load_dwordx4 v1,s[8:11],s63 offen offset:3072 sc1 lds
s_add_u32 m0,s61,8192
s_add_u32 s63,s60,8192
buffer_load_dwordx4 v1,s[8:11],s63 offen sc1 lds
buffer_load_dwordx4 v1,s[8:11],s63 offen offset:1024 sc1 lds
QKVQ_CD0:
s_mov_b32 s51,s33
s_mov_b32 s52,s34
s_mov_b32 s53,s33
s_mov_b32 s54,s34
s_add_u32 s79,s79,s33
s_or_b32 s60,s37,s33
s_cmp_eq_u32 s60,0
s_addc_u32 s78,s78,0
s_lshl_b32 s41,s78,9
s_add_u32 s41,s41,s40
s_lshl_b32 s35,s79,9
s_add_u32 s35,s35,s40
s_add_u32 s35,s35,32768
buffer_load_dword v3,v2,s[8:11],s35 offen sc1
buffer_load_dword v14,v4,s[8:11],s41 offen sc1
s_waitcnt vmcnt(0)
s_mov_b64 exec,1
buffer_store_dword v5,v1,s[8:11],s59 offen sc1
s_mov_b64 exec,-1
s_mov_b32 s59,2147483648
v_cmp_eq_u32 vcc,0,v14
s_cmp_eq_u64 vcc,0
s_cselect_b32 s36,0,2147483648
v_cmp_eq_u32 vcc,0,v3
s_cmp_lt_u32 s78,64
s_cselect_b32 s36,s36,2147483648
s_cmp_eq_u64 vcc,0
s_cselect_b32 s60,1,s36
s_cmp_lt_u32 s79,64
s_cselect_b32 s60,s60,s36
s_sub_u32 s61,s78,s79
s_or_b32 s61,s61,s36
s_cmp_lt_u32 s61,16
s_cselect_b32 s36,0,s60
v_mov_b32 v23,s36
ds_write_b32 v13,v23
s_waitcnt lgkmcnt(0)
s_barrier
ds_read_b32 v23,v22
ds_read_b128 v[24:27],v16 offset:0
ds_read_b128 v[28:31],v17 offset:0
ds_read_b128 v[32:35],v16 offset:2048
ds_read_b128 v[36:39],v17 offset:2048
ds_read_b128 v[40:43],v16 offset:4096
s_waitcnt lgkmcnt(5)
v_readfirstlane_b32 s38,v23
s_and_b32 s37,s38,2147483648
s_and_b32 s33,s38,1
s_cselect_b32 s34,s79,s78
s_nop 0
s_branch QKVQ_B0
QKVQ_S1:
s_mov_b32 s55,0
s_cmp_lt_u32 s42,2
s_cbranch_scc1 nt_204
s_mov_b32 s55,2
s_cmp_lg_u32 s37,0
s_cbranch_scc1 nt_204
s_mov_b32 s55,1
s_lshl_b32 s60,s33,6
s_add_u32 s60,s60,s34
s_mul_i32 s60,s60,46080
s_add_u32 s60,s60,206569472
s_lshl_b32 s62,s46,10
s_add_u32 s62,s62,40960
s_add_u32 m0,s57,s62
s_add_u32 s63,s60,s62
buffer_load_dwordx4 v1,s[8:11],s63 offen sc1 lds
s_add_u32 m0,s57,45056
s_add_u32 s63,s60,45056
buffer_load_dwordx4 v1,s[8:11],s63 offen sc1 lds
s_mul_i32 s61,s46,10240
s_add_u32 s60,s60,s61
s_add_u32 s61,s61,s57
s_add_u32 m0,s61,0
s_add_u32 s63,s60,0
buffer_load_dwordx4 v1,s[8:11],s63 offen sc1 lds
buffer_load_dwordx4 v1,s[8:11],s63 offen offset:1024 sc1 lds
buffer_load_dwordx4 v1,s[8:11],s63 offen offset:2048 sc1 lds
buffer_load_dwordx4 v1,s[8:11],s63 offen offset:3072 sc1 lds
s_add_u32 m0,s61,4096
s_add_u32 s63,s60,4096
buffer_load_dwordx4 v1,s[8:11],s63 offen sc1 lds
buffer_load_dwordx4 v1,s[8:11],s63 offen offset:1024 sc1 lds
buffer_load_dwordx4 v1,s[8:11],s63 offen offset:2048 sc1 lds
buffer_load_dwordx4 v1,s[8:11],s63 offen offset:3072 sc1 lds
s_add_u32 m0,s61,8192
s_add_u32 s63,s60,8192
buffer_load_dwordx4 v1,s[8:11],s63 offen sc1 lds
buffer_load_dwordx4 v1,s[8:11],s63 offen offset:1024 sc1 lds
nt_204:
s_nop 4
s_mul_i32 s74,s73,393216
s_add_u32 s74,s74,s39
s_add_u32 s74,s74,s70
v_fma_f32 v88,-v176,v120,v88
v_fma_f32 v89,-v176,v121,v89
v_fma_f32 v90,-v176,v122,v90
v_fma_f32 v91,-v176,v123,v91
v_fma_f32 v92,-v176,v124,v92
v_fma_f32 v93,-v176,v125,v93
v_fma_f32 v94,-v176,v126,v94
v_fma_f32 v95,-v176,v127,v95
v_mul_f32 v88,v88,v177
v_mul_f32 v89,v89,v177
v_mul_f32 v90,v90,v177
v_mul_f32 v91,v91,v177
v_mul_f32 v92,v92,v177
v_mul_f32 v93,v93,v177
v_mul_f32 v94,v94,v177
v_mul_f32 v95,v95,v177
v_cvt_pk_bf16_f32 v88,v88,v89
v_cvt_pk_bf16_f32 v89,v90,v91
v_cvt_pk_bf16_f32 v90,v92,v93
v_cvt_pk_bf16_f32 v91,v94,v95
buffer_store_dwordx4 v[88:91],v20,s[8:11],s74 offen sc1
v_fma_f32 v96,-v176,v128,v96
v_fma_f32 v97,-v176,v129,v97
v_fma_f32 v98,-v176,v130,v98
v_fma_f32 v99,-v176,v131,v99
v_fma_f32 v100,-v176,v132,v100
v_fma_f32 v101,-v176,v133,v101
v_fma_f32 v102,-v176,v134,v102
v_fma_f32 v103,-v176,v135,v103
v_mul_f32 v96,v96,v177
v_mul_f32 v97,v97,v177
v_mul_f32 v98,v98,v177
v_mul_f32 v99,v99,v177
v_mul_f32 v100,v100,v177
v_mul_f32 v101,v101,v177
v_mul_f32 v102,v102,v177
v_mul_f32 v103,v103,v177
v_cvt_pk_bf16_f32 v96,v96,v97
v_cvt_pk_bf16_f32 v97,v98,v99
v_cvt_pk_bf16_f32 v98,v100,v101
v_cvt_pk_bf16_f32 v99,v102,v103
buffer_store_dwordx4 v[96:99],v21,s[8:11],s74 offen sc1
v_fma_f32 v104,-v176,v136,v104
v_fma_f32 v105,-v176,v137,v105
v_fma_f32 v106,-v176,v138,v106
v_fma_f32 v107,-v176,v139,v107
v_fma_f32 v108,-v176,v140,v108
v_fma_f32 v109,-v176,v141,v109
v_fma_f32 v110,-v176,v142,v110
v_fma_f32 v111,-v176,v143,v111
v_mul_f32 v104,v104,v177
v_mul_f32 v105,v105,v177
v_mul_f32 v106,v106,v177
v_mul_f32 v107,v107,v177
v_mul_f32 v108,v108,v177
v_mul_f32 v109,v109,v177
v_mul_f32 v110,v110,v177
v_mul_f32 v111,v111,v177
v_cvt_pk_bf16_f32 v104,v104,v105
v_cvt_pk_bf16_f32 v105,v106,v107
v_cvt_pk_bf16_f32 v106,v108,v109
v_cvt_pk_bf16_f32 v107,v110,v111
buffer_store_dwordx4 v[104:107],v20,s[8:11],s74 offen offset:2048 sc1
v_fma_f32 v112,-v176,v144,v112
v_fma_f32 v113,-v176,v145,v113
v_fma_f32 v114,-v176,v146,v114
v_fma_f32 v115,-v176,v147,v115
v_fma_f32 v116,-v176,v148,v116
v_fma_f32 v117,-v176,v149,v117
v_fma_f32 v118,-v176,v150,v118
v_fma_f32 v119,-v176,v151,v119
v_mul_f32 v112,v112,v177
v_mul_f32 v113,v113,v177
v_mul_f32 v114,v114,v177
v_mul_f32 v115,v115,v177
v_mul_f32 v116,v116,v177
v_mul_f32 v117,v117,v177
v_mul_f32 v118,v118,v177
v_mul_f32 v119,v119,v177
v_cvt_pk_bf16_f32 v112,v112,v113
v_cvt_pk_bf16_f32 v113,v114,v115
v_cvt_pk_bf16_f32 v114,v116,v117
v_cvt_pk_bf16_f32 v115,v118,v119
buffer_store_dwordx4 v[112:115],v21,s[8:11],s74 offen offset:2048 sc1
s_lshl_b32 s82,s72,6
s_add_u32 s82,s82,s73
s_lshl_b32 s82,s82,9
s_add_u32 s82,s82,s71
s_lshl_b32 s75,s69,2
s_add_u32 s82,s82,s75
s_add_u32 s82,s82,s39
s_mov_b32 s59,s82
s_mov_b32 s82,2147483648
s_mov_b32 s39,2147483648
s_cmp_eq_u32 s55,0
s_cbranch_scc1 QKVQ_B0
s_cmp_eq_u32 s55,1
s_cbranch_scc1 QKVQ_CD0
s_waitcnt vmcnt(0)
s_mov_b64 exec,1
buffer_store_dword v5,v1,s[8:11],s59 offen sc1
s_mov_b64 exec,-1
s_mov_b32 s59,2147483648
s_cmp_eq_u32 s50,128
s_cbranch_scc1 QKVQ_END
s_branch QKVQ_COLD0
QKVQ_COLD1:
s_cmp_lg_u32 s46,0
s_cbranch_scc1 cp_205
ct_206:
buffer_load_dword v3,v2,s[8:11],s35 offen sc1
buffer_load_dword v14,v4,s[8:11],s41 offen sc1
s_waitcnt vmcnt(0)
v_cmp_eq_u32 vcc,0,v14
s_cmp_eq_u64 vcc,0
s_cselect_b32 s36,0,2147483648
v_cmp_eq_u32 vcc,0,v3
s_cmp_lt_u32 s78,64
s_cselect_b32 s36,s36,2147483648
s_cmp_eq_u64 vcc,0
s_cselect_b32 s60,1,s36
s_cmp_lt_u32 s79,64
s_cselect_b32 s60,s60,s36
s_sub_u32 s61,s78,s79
s_or_b32 s61,s61,s36
s_cmp_lt_u32 s61,16
s_cselect_b32 s36,0,s60
v_mov_b32 v23,s36
s_cmp_lt_u32 s36,2
s_cbranch_scc1 ct_206x
s_sleep 3
s_sub_u32 s47,s47,1
s_cbranch_scc1 ABORT
s_branch ct_206
ct_206x:
ds_write_b32 v22,v23 offset:4
s_waitcnt lgkmcnt(0)
cp_205:
s_barrier
ds_read_b32 v23,v22 offset:4
s_waitcnt lgkmcnt(0)
v_readfirstlane_b32 s38,v23
s_and_b32 s38,s38,1
s_and_b32 s37,s38,2147483648
s_and_b32 s33,s38,1
s_cselect_b32 s34,s79,s78
s_lshl_b32 s60,s33,6
s_add_u32 s60,s60,s34
s_mul_i32 s60,s60,46080
s_add_u32 s60,s60,206569472
s_lshl_b32 s62,s46,10
s_add_u32 s62,s62,40960
s_add_u32 m0,s57,s62
s_add_u32 s63,s60,s62
buffer_load_dwordx4 v1,s[8:11],s63 offen sc1 lds
s_add_u32 m0,s57,45056
s_add_u32 s63,s60,45056
buffer_load_dwordx4 v1,s[8:11],s63 offen sc1 lds
s_mul_i32 s61,s46,10240
s_add_u32 s60,s60,s61
s_add_u32 s61,s61,s57
s_add_u32 m0,s61,0
s_add_u32 s63,s60,0
buffer_load_dwordx4 v1,s[8:11],s63 offen sc1 lds
buffer_load_dwordx4 v1,s[8:11],s63 offen offset:1024 sc1 lds
buffer_load_dwordx4 v1,s[8:11],s63 offen offset:2048 sc1 lds
buffer_load_dwordx4 v1,s[8:11],s63 offen offset:3072 sc1 lds
s_add_u32 m0,s61,4096
s_add_u32 s63,s60,4096
buffer_load_dwordx4 v1,s[8:11],s63 offen sc1 lds
buffer_load_dwordx4 v1,s[8:11],s63 offen offset:1024 sc1 lds
buffer_load_dwordx4 v1,s[8:11],s63 offen offset:2048 sc1 lds
buffer_load_dwordx4 v1,s[8:11],s63 offen offset:3072 sc1 lds
s_add_u32 m0,s61,8192
s_add_u32 s63,s60,8192
buffer_load_dwordx4 v1,s[8:11],s63 offen sc1 lds
buffer_load_dwordx4 v1,s[8:11],s63 offen offset:1024 sc1 lds
QKVQ_CD1:
s_mov_b32 s51,s33
s_mov_b32 s52,s34
s_mov_b32 s53,s33
s_mov_b32 s54,s34
s_add_u32 s79,s79,s33
s_or_b32 s60,s37,s33
s_cmp_eq_u32 s60,0
s_addc_u32 s78,s78,0
s_lshl_b32 s41,s78,9
s_add_u32 s41,s41,s40
s_lshl_b32 s35,s79,9
s_add_u32 s35,s35,s40
s_add_u32 s35,s35,32768
buffer_load_dword v3,v2,s[8:11],s35 offen sc1
buffer_load_dword v14,v4,s[8:11],s41 offen sc1
s_waitcnt vmcnt(0)
s_mov_b64 exec,1
buffer_store_dword v5,v1,s[8:11],s59 offen sc1
s_mov_b64 exec,-1
s_mov_b32 s59,2147483648
v_cmp_eq_u32 vcc,0,v14
s_cmp_eq_u64 vcc,0
s_cselect_b32 s36,0,2147483648
v_cmp_eq_u32 vcc,0,v3
s_cmp_lt_u32 s78,64
s_cselect_b32 s36,s36,2147483648
s_cmp_eq_u64 vcc,0
s_cselect_b32 s60,1,s36
s_cmp_lt_u32 s79,64
s_cselect_b32 s60,s60,s36
s_sub_u32 s61,s78,s79
s_or_b32 s61,s61,s36
s_cmp_lt_u32 s61,16
s_cselect_b32 s36,0,s60
v_mov_b32 v23,s36
ds_write_b32 v13,v23
s_waitcnt lgkmcnt(0)
s_barrier
ds_read_b32 v23,v22
ds_read_b128 v[24:27],v18 offset:0
ds_read_b128 v[28:31],v19 offset:0
ds_read_b128 v[32:35],v18 offset:2048
ds_read_b128 v[36:39],v19 offset:2048
ds_read_b128 v[40:43],v18 offset:4096
s_waitcnt lgkmcnt(5)
v_readfirstlane_b32 s38,v23
s_and_b32 s37,s38,2147483648
s_and_b32 s33,s38,1
s_cselect_b32 s34,s79,s78
s_nop 0
s_branch QKVQ_B1
QKVQ_END:
s_endpgm
ROLE_QKVV:
v_lshlrev_b32 v1,4,v0
v_mov_b32 v5,1
s_lshl_b32 s56,s48,2
s_add_u32 s56,s56,s46
v_bfe_u32 v6,v0,2,2
v_lshrrev_b32 v7,4,v0
v_add_u32 v7,v6,v7
v_and_b32 v7,3,v7
v_and_b32 v15,3,v0
v_lshlrev_b32 v15,4,v15
v_lshl_add_u32 v15,v7,6,v15
v_lshl_add_u32 v15,v6,8,v15
v_lshrrev_b32 v6,5,v0
v_bfe_u32 v7,v0,4,1
v_lshlrev_b32 v16,10,v7
v_bfe_u32 v7,v0,2,2
v_lshl_add_u32 v16,v7,8,v16
v_add_u32 v6,v6,v7
v_and_b32 v6,3,v6
v_lshl_add_u32 v16,v6,6,v16
v_and_b32 v6,3,v0
v_lshl_add_u32 v16,v6,4,v16
v_add_u32 v18,46080,v16
v_lshrrev_b32 v6,5,v0
v_bfe_u32 v7,v0,4,1
v_lshlrev_b32 v20,10,v7
v_lshl_add_u32 v20,v6,8,v20
v_and_b32 v6,15,v0
v_lshl_add_u32 v20,v6,4,v20
v_lshrrev_b32 v6,5,v0
v_add_u32 v6,2,v6
v_bfe_u32 v7,v0,4,1
v_lshlrev_b32 v17,10,v7
v_bfe_u32 v7,v0,2,2
v_lshl_add_u32 v17,v7,8,v17
v_add_u32 v6,v6,v7
v_and_b32 v6,3,v6
v_lshl_add_u32 v17,v6,6,v17
v_and_b32 v6,3,v0
v_lshl_add_u32 v17,v6,4,v17
v_add_u32 v19,46080,v17
v_lshrrev_b32 v6,5,v0
v_add_u32 v6,2,v6
v_bfe_u32 v7,v0,4,1
v_lshlrev_b32 v21,10,v7
v_lshl_add_u32 v21,v6,8,v21
v_and_b32 v6,15,v0
v_lshl_add_u32 v21,v6,4,v21
s_mov_b32 s69,s56
s_mov_b32 s70,99614720
s_mov_b32 s71,196608
s_lshl_b32 s60,s69,12
s_add_u32 s70,s70,s60
v_lshrrev_b32 v6,5,v0
v_mul_u32_u24 v188,2560,v6
v_and_b32 v6,31,v0
v_lshl_add_u32 v188,v6,3,v188
v_add_u32 v188,0xa000,v188
v_min_u32 v4,7,v0
v_lshlrev_b32 v4,2,v4
v_min_u32 v2,39,v0
v_lshlrev_b32 v2,2,v2
v_mov_b32 v12,93184
s_lshl_b32 s60,s46,8
s_add_u32 s60,s60,92160
v_and_b32 v6,31,v0
v_lshlrev_b32 v190,3,v6
v_add_u32 v190,s60,v190
v_lshrrev_b32 v6,5,v0
v_lshlrev_b32 v191,5,v6
v_add_u32 v191,s60,v191
s_waitcnt vmcnt(0)
s_barrier
s_cmp_lg_u32 s46,0
s_cbranch_scc1 arr_207
v_mov_b32 v6,1
s_lshl_b32 s3,s49,2
v_mov_b32 v7,s3
s_mov_b64 exec,1
buffer_atomic_add v6,v7,s[12:15],0 offen sc1
s_mov_b64 exec,-1
arr_207:
s_lshl_b32 s58,s69,7
s_mul_i32 s63,s46,40960
s_mov_b32 s4,s24
s_mov_b32 s5,s25
s_mov_b32 s6,7864320
s_mov_b32 s7,0x20000
v_lshrrev_b32 v9,3,v0
s_mov_b32 s64,12288
v_mul_lo_u32 v9,v9,s64
v_and_b32 v10,7,v0
v_lshl_add_u32 v6,v10,4,v9
s_add_u32 m0,s63,0
s_add_u32 s65,s58,0
buffer_load_dwordx4 v6,s[4:7],s65 offen lds
s_add_u32 m0,s63,1024
s_add_u32 s65,s58,98304
buffer_load_dwordx4 v6,s[4:7],s65 offen lds
s_add_u32 m0,s63,2048
s_add_u32 s65,s58,196608
buffer_load_dwordx4 v6,s[4:7],s65 offen lds
s_add_u32 m0,s63,3072
s_add_u32 s65,s58,294912
buffer_load_dwordx4 v6,s[4:7],s65 offen lds
s_add_u32 m0,s63,4096
s_add_u32 s65,s58,393216
buffer_load_dwordx4 v6,s[4:7],s65 offen lds
s_add_u32 m0,s63,5120
s_add_u32 s65,s58,491520
buffer_load_dwordx4 v6,s[4:7],s65 offen lds
s_add_u32 m0,s63,6144
s_add_u32 s65,s58,589824
buffer_load_dwordx4 v6,s[4:7],s65 offen lds
s_add_u32 m0,s63,7168
s_add_u32 s65,s58,688128
buffer_load_dwordx4 v6,s[4:7],s65 offen lds
s_add_u32 m0,s63,8192
s_add_u32 s65,s58,786432
buffer_load_dwordx4 v6,s[4:7],s65 offen lds
s_add_u32 m0,s63,9216
s_add_u32 s65,s58,884736
buffer_load_dwordx4 v6,s[4:7],s65 offen lds
s_add_u32 m0,s63,10240
s_add_u32 s65,s58,983040
buffer_load_dwordx4 v6,s[4:7],s65 offen lds
s_add_u32 m0,s63,11264
s_add_u32 s65,s58,1081344
buffer_load_dwordx4 v6,s[4:7],s65 offen lds
s_add_u32 m0,s63,12288
s_add_u32 s65,s58,1179648
buffer_load_dwordx4 v6,s[4:7],s65 offen lds
s_add_u32 m0,s63,13312
s_add_u32 s65,s58,1277952
buffer_load_dwordx4 v6,s[4:7],s65 offen lds
s_add_u32 m0,s63,14336
s_add_u32 s65,s58,1376256
buffer_load_dwordx4 v6,s[4:7],s65 offen lds
s_add_u32 m0,s63,15360
s_add_u32 s65,s58,1474560
buffer_load_dwordx4 v6,s[4:7],s65 offen lds
s_add_u32 m0,s63,16384
s_add_u32 s65,s58,1572864
buffer_load_dwordx4 v6,s[4:7],s65 offen lds
s_add_u32 m0,s63,17408
s_add_u32 s65,s58,1671168
buffer_load_dwordx4 v6,s[4:7],s65 offen lds
s_add_u32 m0,s63,18432
s_add_u32 s65,s58,1769472
buffer_load_dwordx4 v6,s[4:7],s65 offen lds
s_add_u32 m0,s63,19456
s_add_u32 s65,s58,1867776
buffer_load_dwordx4 v6,s[4:7],s65 offen lds
s_add_u32 m0,s63,20480
s_add_u32 s65,s58,1966080
buffer_load_dwordx4 v6,s[4:7],s65 offen lds
s_add_u32 m0,s63,21504
s_add_u32 s65,s58,2064384
buffer_load_dwordx4 v6,s[4:7],s65 offen lds
s_add_u32 m0,s63,22528
s_add_u32 s65,s58,2162688
buffer_load_dwordx4 v6,s[4:7],s65 offen lds
s_add_u32 m0,s63,23552
s_add_u32 s65,s58,2260992
buffer_load_dwordx4 v6,s[4:7],s65 offen lds
s_add_u32 m0,s63,24576
s_add_u32 s65,s58,2359296
buffer_load_dwordx4 v6,s[4:7],s65 offen lds
s_add_u32 m0,s63,25600
s_add_u32 s65,s58,2457600
buffer_load_dwordx4 v6,s[4:7],s65 offen lds
s_add_u32 m0,s63,26624
s_add_u32 s65,s58,2555904
buffer_load_dwordx4 v6,s[4:7],s65 offen lds
s_add_u32 m0,s63,27648
s_add_u32 s65,s58,2654208
buffer_load_dwordx4 v6,s[4:7],s65 offen lds
s_add_u32 m0,s63,28672
s_add_u32 s65,s58,2752512
buffer_load_dwordx4 v6,s[4:7],s65 offen lds
s_add_u32 m0,s63,29696
s_add_u32 s65,s58,2850816
buffer_load_dwordx4 v6,s[4:7],s65 offen lds
s_add_u32 m0,s63,30720
s_add_u32 s65,s58,2949120
buffer_load_dwordx4 v6,s[4:7],s65 offen lds
s_add_u32 m0,s63,31744
s_add_u32 s65,s58,3047424
buffer_load_dwordx4 v6,s[4:7],s65 offen lds
s_add_u32 m0,s63,32768
s_add_u32 s65,s58,3145728
buffer_load_dwordx4 v6,s[4:7],s65 offen lds
s_add_u32 m0,s63,33792
s_add_u32 s65,s58,3244032
buffer_load_dwordx4 v6,s[4:7],s65 offen lds
s_add_u32 m0,s63,34816
s_add_u32 s65,s58,3342336
buffer_load_dwordx4 v6,s[4:7],s65 offen lds
s_add_u32 m0,s63,35840
s_add_u32 s65,s58,3440640
buffer_load_dwordx4 v6,s[4:7],s65 offen lds
s_add_u32 m0,s63,36864
s_add_u32 s65,s58,3538944
buffer_load_dwordx4 v6,s[4:7],s65 offen lds
s_add_u32 m0,s63,37888
s_add_u32 s65,s58,3637248
buffer_load_dwordx4 v6,s[4:7],s65 offen lds
s_add_u32 m0,s63,38912
s_add_u32 s65,s58,3735552
buffer_load_dwordx4 v6,s[4:7],s65 offen lds
s_add_u32 m0,s63,39936
s_add_u32 s65,s58,3833856
buffer_load_dwordx4 v6,s[4:7],s65 offen lds
s_waitcnt vmcnt(20)
v_bfe_u32 v9,v0,2,2
v_lshrrev_b32 v10,5,v0
v_lshl_add_u32 v9,v10,2,v9
v_mul_u32_u24 v9,128,v9
v_and_b32 v10,1,v0
v_lshl_add_u32 v9,v10,3,v9
v_bfe_u32 v10,v0,1,1
v_lshl_add_u32 v9,v10,4,v9
v_bfe_u32 v10,v0,4,1
v_lshl_add_u32 v9,v10,5,v9
v_add_u32 v7,s63,v9
ds_read_b64_tr_b16 a[0:1],v7 offset:0
ds_read_b64_tr_b16 a[2:3],v7 offset:2048
ds_read_b64_tr_b16 a[4:5],v7 offset:1024
ds_read_b64_tr_b16 a[6:7],v7 offset:3072
ds_read_b64_tr_b16 a[160:161],v7 offset:64
ds_read_b64_tr_b16 a[162:163],v7 offset:2112
ds_read_b64_tr_b16 a[164:165],v7 offset:1088
ds_read_b64_tr_b16 a[166:167],v7 offset:3136
ds_read_b64_tr_b16 a[8:9],v7 offset:4096
ds_read_b64_tr_b16 a[10:11],v7 offset:6144
ds_read_b64_tr_b16 a[12:13],v7 offset:5120
ds_read_b64_tr_b16 a[14:15],v7 offset:7168
s_waitcnt lgkmcnt(4)
ds_read_b64_tr_b16 a[168:169],v7 offset:4160
ds_read_b64_tr_b16 a[170:171],v7 offset:6208
ds_read_b64_tr_b16 a[172:173],v7 offset:5184
ds_read_b64_tr_b16 a[174:175],v7 offset:7232
ds_read_b64_tr_b16 a[16:17],v7 offset:8192
ds_read_b64_tr_b16 a[18:19],v7 offset:10240
ds_read_b64_tr_b16 a[20:21],v7 offset:9216
ds_read_b64_tr_b16 a[22:23],v7 offset:11264
ds_read_b64_tr_b16 a[176:177],v7 offset:8256
ds_read_b64_tr_b16 a[178:179],v7 offset:10304
ds_read_b64_tr_b16 a[180:181],v7 offset:9280
ds_read_b64_tr_b16 a[182:183],v7 offset:11328
s_waitcnt lgkmcnt(4)
ds_read_b64_tr_b16 a[24:25],v7 offset:12288
ds_read_b64_tr_b16 a[26:27],v7 offset:14336
ds_read_b64_tr_b16 a[28:29],v7 offset:13312
ds_read_b64_tr_b16 a[30:31],v7 offset:15360
ds_read_b64_tr_b16 a[184:185],v7 offset:12352
ds_read_b64_tr_b16 a[186:187],v7 offset:14400
ds_read_b64_tr_b16 a[188:189],v7 offset:13376
ds_read_b64_tr_b16 a[190:191],v7 offset:15424
ds_read_b64_tr_b16 a[32:33],v7 offset:16384
ds_read_b64_tr_b16 a[34:35],v7 offset:18432
ds_read_b64_tr_b16 a[36:37],v7 offset:17408
ds_read_b64_tr_b16 a[38:39],v7 offset:19456
s_waitcnt lgkmcnt(4)
ds_read_b64_tr_b16 a[192:193],v7 offset:16448
ds_read_b64_tr_b16 a[194:195],v7 offset:18496
ds_read_b64_tr_b16 a[196:197],v7 offset:17472
ds_read_b64_tr_b16 a[198:199],v7 offset:19520
s_waitcnt lgkmcnt(0)
s_add_u32 m0,s63,0
s_add_u32 s65,s58,3932160
buffer_load_dwordx4 v6,s[4:7],s65 offen lds
s_add_u32 m0,s63,1024
s_add_u32 s65,s58,4030464
buffer_load_dwordx4 v6,s[4:7],s65 offen lds
s_add_u32 m0,s63,2048
s_add_u32 s65,s58,4128768
buffer_load_dwordx4 v6,s[4:7],s65 offen lds
s_add_u32 m0,s63,3072
s_add_u32 s65,s58,4227072
buffer_load_dwordx4 v6,s[4:7],s65 offen lds
s_add_u32 m0,s63,4096
s_add_u32 s65,s58,4325376
buffer_load_dwordx4 v6,s[4:7],s65 offen lds
s_add_u32 m0,s63,5120
s_add_u32 s65,s58,4423680
buffer_load_dwordx4 v6,s[4:7],s65 offen lds
s_add_u32 m0,s63,6144
s_add_u32 s65,s58,4521984
buffer_load_dwordx4 v6,s[4:7],s65 offen lds
s_add_u32 m0,s63,7168
s_add_u32 s65,s58,4620288
buffer_load_dwordx4 v6,s[4:7],s65 offen lds
s_add_u32 m0,s63,8192
s_add_u32 s65,s58,4718592
buffer_load_dwordx4 v6,s[4:7],s65 offen lds
s_add_u32 m0,s63,9216
s_add_u32 s65,s58,4816896
buffer_load_dwordx4 v6,s[4:7],s65 offen lds
s_add_u32 m0,s63,10240
s_add_u32 s65,s58,4915200
buffer_load_dwordx4 v6,s[4:7],s65 offen lds
s_add_u32 m0,s63,11264
s_add_u32 s65,s58,5013504
buffer_load_dwordx4 v6,s[4:7],s65 offen lds
s_add_u32 m0,s63,12288
s_add_u32 s65,s58,5111808
buffer_load_dwordx4 v6,s[4:7],s65 offen lds
s_add_u32 m0,s63,13312
s_add_u32 s65,s58,5210112
buffer_load_dwordx4 v6,s[4:7],s65 offen lds
s_add_u32 m0,s63,14336
s_add_u32 s65,s58,5308416
buffer_load_dwordx4 v6,s[4:7],s65 offen lds
s_add_u32 m0,s63,15360
s_add_u32 s65,s58,5406720
buffer_load_dwordx4 v6,s[4:7],s65 offen lds
s_add_u32 m0,s63,16384
s_add_u32 s65,s58,5505024
buffer_load_dwordx4 v6,s[4:7],s65 offen lds
s_add_u32 m0,s63,17408
s_add_u32 s65,s58,5603328
buffer_load_dwordx4 v6,s[4:7],s65 offen lds
s_add_u32 m0,s63,18432
s_add_u32 s65,s58,5701632
buffer_load_dwordx4 v6,s[4:7],s65 offen lds
s_add_u32 m0,s63,19456
s_add_u32 s65,s58,5799936
buffer_load_dwordx4 v6,s[4:7],s65 offen lds
s_waitcnt vmcnt(20)
v_bfe_u32 v9,v0,2,2
v_lshrrev_b32 v10,5,v0
v_lshl_add_u32 v9,v10,2,v9
v_mul_u32_u24 v9,128,v9
v_and_b32 v10,1,v0
v_lshl_add_u32 v9,v10,3,v9
v_bfe_u32 v10,v0,1,1
v_lshl_add_u32 v9,v10,4,v9
v_bfe_u32 v10,v0,4,1
v_lshl_add_u32 v9,v10,5,v9
v_add_u32 v7,s63,v9
ds_read_b64_tr_b16 a[40:41],v7 offset:20480
ds_read_b64_tr_b16 a[42:43],v7 offset:22528
ds_read_b64_tr_b16 a[44:45],v7 offset:21504
ds_read_b64_tr_b16 a[46:47],v7 offset:23552
ds_read_b64_tr_b16 a[200:201],v7 offset:20544
ds_read_b64_tr_b16 a[202:203],v7 offset:22592
ds_read_b64_tr_b16 a[204:205],v7 offset:21568
ds_read_b64_tr_b16 a[206:207],v7 offset:23616
ds_read_b64_tr_b16 a[48:49],v7 offset:24576
ds_read_b64_tr_b16 a[50:51],v7 offset:26624
ds_read_b64_tr_b16 a[52:53],v7 offset:25600
ds_read_b64_tr_b16 a[54:55],v7 offset:27648
s_waitcnt lgkmcnt(4)
ds_read_b64_tr_b16 a[208:209],v7 offset:24640
ds_read_b64_tr_b16 a[210:211],v7 offset:26688
ds_read_b64_tr_b16 a[212:213],v7 offset:25664
ds_read_b64_tr_b16 a[214:215],v7 offset:27712
ds_read_b64_tr_b16 a[56:57],v7 offset:28672
ds_read_b64_tr_b16 a[58:59],v7 offset:30720
ds_read_b64_tr_b16 a[60:61],v7 offset:29696
ds_read_b64_tr_b16 a[62:63],v7 offset:31744
ds_read_b64_tr_b16 a[216:217],v7 offset:28736
ds_read_b64_tr_b16 a[218:219],v7 offset:30784
ds_read_b64_tr_b16 a[220:221],v7 offset:29760
ds_read_b64_tr_b16 a[222:223],v7 offset:31808
s_waitcnt lgkmcnt(4)
ds_read_b64_tr_b16 a[64:65],v7 offset:32768
ds_read_b64_tr_b16 a[66:67],v7 offset:34816
ds_read_b64_tr_b16 a[68:69],v7 offset:33792
ds_read_b64_tr_b16 a[70:71],v7 offset:35840
ds_read_b64_tr_b16 a[224:225],v7 offset:32832
ds_read_b64_tr_b16 a[226:227],v7 offset:34880
ds_read_b64_tr_b16 a[228:229],v7 offset:33856
ds_read_b64_tr_b16 a[230:231],v7 offset:35904
ds_read_b64_tr_b16 a[72:73],v7 offset:36864
ds_read_b64_tr_b16 a[74:75],v7 offset:38912
ds_read_b64_tr_b16 a[76:77],v7 offset:37888
ds_read_b64_tr_b16 a[78:79],v7 offset:39936
s_waitcnt lgkmcnt(4)
ds_read_b64_tr_b16 a[232:233],v7 offset:36928
ds_read_b64_tr_b16 a[234:235],v7 offset:38976
ds_read_b64_tr_b16 a[236:237],v7 offset:37952
ds_read_b64_tr_b16 a[238:239],v7 offset:40000
s_waitcnt lgkmcnt(0)
s_add_u32 m0,s63,20480
s_add_u32 s65,s58,5898240
buffer_load_dwordx4 v6,s[4:7],s65 offen lds
s_add_u32 m0,s63,21504
s_add_u32 s65,s58,5996544
buffer_load_dwordx4 v6,s[4:7],s65 offen lds
s_add_u32 m0,s63,22528
s_add_u32 s65,s58,6094848
buffer_load_dwordx4 v6,s[4:7],s65 offen lds
s_add_u32 m0,s63,23552
s_add_u32 s65,s58,6193152
buffer_load_dwordx4 v6,s[4:7],s65 offen lds
s_add_u32 m0,s63,24576
s_add_u32 s65,s58,6291456
buffer_load_dwordx4 v6,s[4:7],s65 offen lds
s_add_u32 m0,s63,25600
s_add_u32 s65,s58,6389760
buffer_load_dwordx4 v6,s[4:7],s65 offen lds
s_add_u32 m0,s63,26624
s_add_u32 s65,s58,6488064
buffer_load_dwordx4 v6,s[4:7],s65 offen lds
s_add_u32 m0,s63,27648
s_add_u32 s65,s58,6586368
buffer_load_dwordx4 v6,s[4:7],s65 offen lds
s_add_u32 m0,s63,28672
s_add_u32 s65,s58,6684672
buffer_load_dwordx4 v6,s[4:7],s65 offen lds
s_add_u32 m0,s63,29696
s_add_u32 s65,s58,6782976
buffer_load_dwordx4 v6,s[4:7],s65 offen lds
s_add_u32 m0,s63,30720
s_add_u32 s65,s58,6881280
buffer_load_dwordx4 v6,s[4:7],s65 offen lds
s_add_u32 m0,s63,31744
s_add_u32 s65,s58,6979584
buffer_load_dwordx4 v6,s[4:7],s65 offen lds
s_add_u32 m0,s63,32768
s_add_u32 s65,s58,7077888
buffer_load_dwordx4 v6,s[4:7],s65 offen lds
s_add_u32 m0,s63,33792
s_add_u32 s65,s58,7176192
buffer_load_dwordx4 v6,s[4:7],s65 offen lds
s_add_u32 m0,s63,34816
s_add_u32 s65,s58,7274496
buffer_load_dwordx4 v6,s[4:7],s65 offen lds
s_add_u32 m0,s63,35840
s_add_u32 s65,s58,7372800
buffer_load_dwordx4 v6,s[4:7],s65 offen lds
s_add_u32 m0,s63,36864
s_add_u32 s65,s58,7471104
buffer_load_dwordx4 v6,s[4:7],s65 offen lds
s_add_u32 m0,s63,37888
s_add_u32 s65,s58,7569408
buffer_load_dwordx4 v6,s[4:7],s65 offen lds
s_add_u32 m0,s63,38912
s_add_u32 s65,s58,7667712
buffer_load_dwordx4 v6,s[4:7],s65 offen lds
s_add_u32 m0,s63,39936
s_add_u32 s65,s58,7766016
buffer_load_dwordx4 v6,s[4:7],s65 offen lds
s_waitcnt vmcnt(20)
v_bfe_u32 v9,v0,2,2
v_lshrrev_b32 v10,5,v0
v_lshl_add_u32 v9,v10,2,v9
v_mul_u32_u24 v9,128,v9
v_and_b32 v10,1,v0
v_lshl_add_u32 v9,v10,3,v9
v_bfe_u32 v10,v0,1,1
v_lshl_add_u32 v9,v10,4,v9
v_bfe_u32 v10,v0,4,1
v_lshl_add_u32 v9,v10,5,v9
v_add_u32 v7,s63,v9
ds_read_b64_tr_b16 a[80:81],v7 offset:0
ds_read_b64_tr_b16 a[82:83],v7 offset:2048
ds_read_b64_tr_b16 a[84:85],v7 offset:1024
ds_read_b64_tr_b16 a[86:87],v7 offset:3072
ds_read_b64_tr_b16 a[240:241],v7 offset:64
ds_read_b64_tr_b16 a[242:243],v7 offset:2112
ds_read_b64_tr_b16 a[244:245],v7 offset:1088
ds_read_b64_tr_b16 a[246:247],v7 offset:3136
ds_read_b64_tr_b16 a[88:89],v7 offset:4096
ds_read_b64_tr_b16 a[90:91],v7 offset:6144
ds_read_b64_tr_b16 a[92:93],v7 offset:5120
ds_read_b64_tr_b16 a[94:95],v7 offset:7168
s_waitcnt lgkmcnt(4)
ds_read_b64_tr_b16 a[248:249],v7 offset:4160
ds_read_b64_tr_b16 a[250:251],v7 offset:6208
ds_read_b64_tr_b16 a[252:253],v7 offset:5184
ds_read_b64_tr_b16 a[254:255],v7 offset:7232
ds_read_b64_tr_b16 a[96:97],v7 offset:8192
ds_read_b64_tr_b16 a[98:99],v7 offset:10240
ds_read_b64_tr_b16 a[100:101],v7 offset:9216
ds_read_b64_tr_b16 a[102:103],v7 offset:11264
ds_read_b64_tr_b16 v[192:193],v7 offset:8256
ds_read_b64_tr_b16 v[194:195],v7 offset:10304
ds_read_b64_tr_b16 v[196:197],v7 offset:9280
ds_read_b64_tr_b16 v[198:199],v7 offset:11328
s_waitcnt lgkmcnt(4)
ds_read_b64_tr_b16 a[104:105],v7 offset:12288
ds_read_b64_tr_b16 a[106:107],v7 offset:14336
ds_read_b64_tr_b16 a[108:109],v7 offset:13312
ds_read_b64_tr_b16 a[110:111],v7 offset:15360
ds_read_b64_tr_b16 v[200:201],v7 offset:12352
ds_read_b64_tr_b16 v[202:203],v7 offset:14400
ds_read_b64_tr_b16 v[204:205],v7 offset:13376
ds_read_b64_tr_b16 v[206:207],v7 offset:15424
ds_read_b64_tr_b16 a[112:113],v7 offset:16384
ds_read_b64_tr_b16 a[114:115],v7 offset:18432
ds_read_b64_tr_b16 a[116:117],v7 offset:17408
ds_read_b64_tr_b16 a[118:119],v7 offset:19456
s_waitcnt lgkmcnt(4)
ds_read_b64_tr_b16 v[208:209],v7 offset:16448
ds_read_b64_tr_b16 v[210:211],v7 offset:18496
ds_read_b64_tr_b16 v[212:213],v7 offset:17472
ds_read_b64_tr_b16 v[214:215],v7 offset:19520
s_waitcnt lgkmcnt(0)
s_waitcnt vmcnt(0)
v_bfe_u32 v9,v0,2,2
v_lshrrev_b32 v10,5,v0
v_lshl_add_u32 v9,v10,2,v9
v_mul_u32_u24 v9,128,v9
v_and_b32 v10,1,v0
v_lshl_add_u32 v9,v10,3,v9
v_bfe_u32 v10,v0,1,1
v_lshl_add_u32 v9,v10,4,v9
v_bfe_u32 v10,v0,4,1
v_lshl_add_u32 v9,v10,5,v9
v_add_u32 v7,s63,v9
ds_read_b64_tr_b16 a[120:121],v7 offset:20480
ds_read_b64_tr_b16 a[122:123],v7 offset:22528
ds_read_b64_tr_b16 a[124:125],v7 offset:21504
ds_read_b64_tr_b16 a[126:127],v7 offset:23552
ds_read_b64_tr_b16 v[216:217],v7 offset:20544
ds_read_b64_tr_b16 v[218:219],v7 offset:22592
ds_read_b64_tr_b16 v[220:221],v7 offset:21568
ds_read_b64_tr_b16 v[222:223],v7 offset:23616
ds_read_b64_tr_b16 a[128:129],v7 offset:24576
ds_read_b64_tr_b16 a[130:131],v7 offset:26624
ds_read_b64_tr_b16 a[132:133],v7 offset:25600
ds_read_b64_tr_b16 a[134:135],v7 offset:27648
s_waitcnt lgkmcnt(4)
ds_read_b64_tr_b16 v[224:225],v7 offset:24640
ds_read_b64_tr_b16 v[226:227],v7 offset:26688
ds_read_b64_tr_b16 v[228:229],v7 offset:25664
ds_read_b64_tr_b16 v[230:231],v7 offset:27712
ds_read_b64_tr_b16 a[136:137],v7 offset:28672
ds_read_b64_tr_b16 a[138:139],v7 offset:30720
ds_read_b64_tr_b16 a[140:141],v7 offset:29696
ds_read_b64_tr_b16 a[142:143],v7 offset:31744
ds_read_b64_tr_b16 v[232:233],v7 offset:28736
ds_read_b64_tr_b16 v[234:235],v7 offset:30784
ds_read_b64_tr_b16 v[236:237],v7 offset:29760
ds_read_b64_tr_b16 v[238:239],v7 offset:31808
s_waitcnt lgkmcnt(4)
ds_read_b64_tr_b16 a[144:145],v7 offset:32768
ds_read_b64_tr_b16 a[146:147],v7 offset:34816
ds_read_b64_tr_b16 a[148:149],v7 offset:33792
ds_read_b64_tr_b16 a[150:151],v7 offset:35840
ds_read_b64_tr_b16 v[240:241],v7 offset:32832
ds_read_b64_tr_b16 v[242:243],v7 offset:34880
ds_read_b64_tr_b16 v[244:245],v7 offset:33856
ds_read_b64_tr_b16 v[246:247],v7 offset:35904
ds_read_b64_tr_b16 a[152:153],v7 offset:36864
ds_read_b64_tr_b16 a[154:155],v7 offset:38912
ds_read_b64_tr_b16 a[156:157],v7 offset:37888
ds_read_b64_tr_b16 a[158:159],v7 offset:39936
s_waitcnt lgkmcnt(4)
ds_read_b64_tr_b16 v[248:249],v7 offset:36928
ds_read_b64_tr_b16 v[250:251],v7 offset:38976
ds_read_b64_tr_b16 v[252:253],v7 offset:37952
ds_read_b64_tr_b16 v[254:255],v7 offset:40000
s_waitcnt lgkmcnt(0)
v_mov_b32 v24,0x3f803f80
v_mov_b32 v25,0x3f803f80
v_mov_b32 v26,0x3f803f80
v_mov_b32 v27,0x3f803f80
s_nop 1
v_mfma_f32_32x32x16_bf16 v[56:71],v[24:27],a[0:3],0
v_mfma_f32_32x32x16_bf16 v[72:87],v[24:27],a[160:163],0
v_mfma_f32_32x32x16_bf16 v[56:71],v[24:27],a[4:7],v[56:71]
v_mfma_f32_32x32x16_bf16 v[72:87],v[24:27],a[164:167],v[72:87]
v_mfma_f32_32x32x16_bf16 v[56:71],v[24:27],a[8:11],v[56:71]
v_mfma_f32_32x32x16_bf16 v[72:87],v[24:27],a[168:171],v[72:87]
v_mfma_f32_32x32x16_bf16 v[56:71],v[24:27],a[12:15],v[56:71]
v_mfma_f32_32x32x16_bf16 v[72:87],v[24:27],a[172:175],v[72:87]
v_mfma_f32_32x32x16_bf16 v[56:71],v[24:27],a[16:19],v[56:71]
v_mfma_f32_32x32x16_bf16 v[72:87],v[24:27],a[176:179],v[72:87]
v_mfma_f32_32x32x16_bf16 v[56:71],v[24:27],a[20:23],v[56:71]
v_mfma_f32_32x32x16_bf16 v[72:87],v[24:27],a[180:183],v[72:87]
v_mfma_f32_32x32x16_bf16 v[56:71],v[24:27],a[24:27],v[56:71]
v_mfma_f32_32x32x16_bf16 v[72:87],v[24:27],a[184:187],v[72:87]
v_mfma_f32_32x32x16_bf16 v[56:71],v[24:27],a[28:31],v[56:71]
v_mfma_f32_32x32x16_bf16 v[72:87],v[24:27],a[188:191],v[72:87]
v_mfma_f32_32x32x16_bf16 v[56:71],v[24:27],a[32:35],v[56:71]
v_mfma_f32_32x32x16_bf16 v[72:87],v[24:27],a[192:195],v[72:87]
v_mfma_f32_32x32x16_bf16 v[56:71],v[24:27],a[36:39],v[56:71]
v_mfma_f32_32x32x16_bf16 v[72:87],v[24:27],a[196:199],v[72:87]
v_mfma_f32_32x32x16_bf16 v[56:71],v[24:27],a[40:43],v[56:71]
v_mfma_f32_32x32x16_bf16 v[72:87],v[24:27],a[200:203],v[72:87]
v_mfma_f32_32x32x16_bf16 v[56:71],v[24:27],a[44:47],v[56:71]
v_mfma_f32_32x32x16_bf16 v[72:87],v[24:27],a[204:207],v[72:87]
v_mfma_f32_32x32x16_bf16 v[56:71],v[24:27],a[48:51],v[56:71]
v_mfma_f32_32x32x16_bf16 v[72:87],v[24:27],a[208:211],v[72:87]
v_mfma_f32_32x32x16_bf16 v[56:71],v[24:27],a[52:55],v[56:71]
v_mfma_f32_32x32x16_bf16 v[72:87],v[24:27],a[212:215],v[72:87]
v_mfma_f32_32x32x16_bf16 v[56:71],v[24:27],a[56:59],v[56:71]
v_mfma_f32_32x32x16_bf16 v[72:87],v[24:27],a[216:219],v[72:87]
v_mfma_f32_32x32x16_bf16 v[56:71],v[24:27],a[60:63],v[56:71]
v_mfma_f32_32x32x16_bf16 v[72:87],v[24:27],a[220:223],v[72:87]
v_mfma_f32_32x32x16_bf16 v[56:71],v[24:27],a[64:67],v[56:71]
v_mfma_f32_32x32x16_bf16 v[72:87],v[24:27],a[224:227],v[72:87]
v_mfma_f32_32x32x16_bf16 v[56:71],v[24:27],a[68:71],v[56:71]
v_mfma_f32_32x32x16_bf16 v[72:87],v[24:27],a[228:231],v[72:87]
v_mfma_f32_32x32x16_bf16 v[56:71],v[24:27],a[72:75],v[56:71]
v_mfma_f32_32x32x16_bf16 v[72:87],v[24:27],a[232:235],v[72:87]
v_mfma_f32_32x32x16_bf16 v[56:71],v[24:27],a[76:79],v[56:71]
v_mfma_f32_32x32x16_bf16 v[72:87],v[24:27],a[236:239],v[72:87]
v_mfma_f32_32x32x16_bf16 v[56:71],v[24:27],a[80:83],v[56:71]
v_mfma_f32_32x32x16_bf16 v[72:87],v[24:27],a[240:243],v[72:87]
v_mfma_f32_32x32x16_bf16 v[56:71],v[24:27],a[84:87],v[56:71]
v_mfma_f32_32x32x16_bf16 v[72:87],v[24:27],a[244:247],v[72:87]
v_mfma_f32_32x32x16_bf16 v[56:71],v[24:27],a[88:91],v[56:71]
v_mfma_f32_32x32x16_bf16 v[72:87],v[24:27],a[248:251],v[72:87]
v_mfma_f32_32x32x16_bf16 v[56:71],v[24:27],a[92:95],v[56:71]
v_mfma_f32_32x32x16_bf16 v[72:87],v[24:27],a[252:255],v[72:87]
v_mfma_f32_32x32x16_bf16 v[56:71],v[24:27],a[96:99],v[56:71]
v_mfma_f32_32x32x16_bf16 v[72:87],v[24:27],v[192:195],v[72:87]
v_mfma_f32_32x32x16_bf16 v[56:71],v[24:27],a[100:103],v[56:71]
v_mfma_f32_32x32x16_bf16 v[72:87],v[24:27],v[196:199],v[72:87]
v_mfma_f32_32x32x16_bf16 v[56:71],v[24:27],a[104:107],v[56:71]
v_mfma_f32_32x32x16_bf16 v[72:87],v[24:27],v[200:203],v[72:87]
v_mfma_f32_32x32x16_bf16 v[56:71],v[24:27],a[108:111],v[56:71]
v_mfma_f32_32x32x16_bf16 v[72:87],v[24:27],v[204:207],v[72:87]
v_mfma_f32_32x32x16_bf16 v[56:71],v[24:27],a[112:115],v[56:71]
v_mfma_f32_32x32x16_bf16 v[72:87],v[24:27],v[208:211],v[72:87]
v_mfma_f32_32x32x16_bf16 v[56:71],v[24:27],a[116:119],v[56:71]
v_mfma_f32_32x32x16_bf16 v[72:87],v[24:27],v[212:215],v[72:87]
v_mfma_f32_32x32x16_bf16 v[56:71],v[24:27],a[120:123],v[56:71]
v_mfma_f32_32x32x16_bf16 v[72:87],v[24:27],v[216:219],v[72:87]
v_mfma_f32_32x32x16_bf16 v[56:71],v[24:27],a[124:127],v[56:71]
v_mfma_f32_32x32x16_bf16 v[72:87],v[24:27],v[220:223],v[72:87]
v_mfma_f32_32x32x16_bf16 v[56:71],v[24:27],a[128:131],v[56:71]
v_mfma_f32_32x32x16_bf16 v[72:87],v[24:27],v[224:227],v[72:87]
v_mfma_f32_32x32x16_bf16 v[56:71],v[24:27],a[132:135],v[56:71]
v_mfma_f32_32x32x16_bf16 v[72:87],v[24:27],v[228:231],v[72:87]
v_mfma_f32_32x32x16_bf16 v[56:71],v[24:27],a[136:139],v[56:71]
v_mfma_f32_32x32x16_bf16 v[72:87],v[24:27],v[232:235],v[72:87]
v_mfma_f32_32x32x16_bf16 v[56:71],v[24:27],a[140:143],v[56:71]
v_mfma_f32_32x32x16_bf16 v[72:87],v[24:27],v[236:239],v[72:87]
v_mfma_f32_32x32x16_bf16 v[56:71],v[24:27],a[144:147],v[56:71]
v_mfma_f32_32x32x16_bf16 v[72:87],v[24:27],v[240:243],v[72:87]
v_mfma_f32_32x32x16_bf16 v[56:71],v[24:27],a[148:151],v[56:71]
v_mfma_f32_32x32x16_bf16 v[72:87],v[24:27],v[244:247],v[72:87]
v_mfma_f32_32x32x16_bf16 v[56:71],v[24:27],a[152:155],v[56:71]
v_mfma_f32_32x32x16_bf16 v[72:87],v[24:27],v[248:251],v[72:87]
v_mfma_f32_32x32x16_bf16 v[56:71],v[24:27],a[156:159],v[56:71]
v_mfma_f32_32x32x16_bf16 v[72:87],v[24:27],v[252:255],v[72:87]
s_nop 4
v_mov_b32 v120,v56
s_nop 5
v_mov_b32 v121,v72
s_barrier
s_lshl_b32 s3,s49,2
v_mov_b32 v7,s3
s_nop 1
ibw_208:
buffer_load_dword v6,v7,s[12:15],0 offen sc1
s_waitcnt vmcnt(0)
v_cmp_ne_u32 vcc,256,v6
s_nop 0
s_cbranch_vccz ok_209
s_sleep 8
s_sub_u32 s47,s47,1
s_cbranch_scc1 ABORT
s_branch ibw_208
ok_209:
s_cmp_lg_u32 s49,0
s_cbranch_scc1 ibok_210
v_and_b32 v7,7,v0
v_lshlrev_b32 v7,2,v7
buffer_load_dword v6,v7,s[12:15],0 offen offset:32 sc1
s_waitcnt vmcnt(0)
v_cmp_ne_u32 vcc,32,v6
s_nop 0
s_cbranch_vccz ibok_210
s_barrier
s_mov_b32 s49,1
s_mov_b32 s3,s2
s_load_dwordx16 s[16:31],s[0:1],0
s_load_dwordx8 s[32:39],s[0:1],64
s_waitcnt lgkmcnt(0)
s_branch DISPATCH
ibok_210:
s_mov_b32 s50,0
s_mov_b32 s32,0
s_mov_b32 s57,0
s_mov_b32 s59,2147483648
s_mov_b32 s82,2147483648
s_mov_b32 s39,2147483648
v_mov_b32 v22,94208
s_mov_b32 s72,0
s_mov_b32 s73,0
s_mov_b32 s78,0
s_mov_b32 s79,0
s_cmp_eq_u32 s46,0
s_cselect_b32 s40,0,2147483648
s_lshl_b32 s60,s46,3
v_add_u32 v13,s60,v22
s_mov_b32 s83,s100
s_lshl_b32 s41,s78,9
s_add_u32 s41,s41,s40
s_lshl_b32 s35,s79,9
s_add_u32 s35,s35,s40
s_add_u32 s35,s35,32768
s_branch QKVV_COLD0
QKVV_B0:
s_waitcnt lgkmcnt(3)
v_mfma_f32_32x32x16_bf16 v[56:71],v[24:27],a[0:3],0
ds_read_b128 v[44:47],v17 offset:4096
v_add_u32 v189,s57,v188
v_mfma_f32_32x32x16_bf16 v[72:87],v[24:27],a[160:163],0
v_add_u32 v8,0x800,v189
s_sub_u32 s66,46080,s57
s_lshl_b32 s60,s33,6
s_add_u32 s60,s60,s34
s_mul_i32 s60,s60,46080
s_add_u32 s60,s60,s37
v_mfma_f32_32x32x16_bf16 v[56:71],v[28:31],a[4:7],v[56:71]
ds_read_b128 v[48:51],v16 offset:6144
ds_read2_b64 v[156:159],v189 offset0:0 offset1:32
s_add_u32 s60,s60,206569472
s_lshl_b32 s62,s46,10
v_mfma_f32_32x32x16_bf16 v[72:87],v[28:31],a[164:167],v[72:87]
ds_read2_b64 v[160:163],v189 offset0:64 offset1:96
s_add_u32 s62,s62,40960
s_add_u32 m0,s66,s62
s_add_u32 s63,s60,s62
s_waitcnt lgkmcnt(5)
v_mfma_f32_32x32x16_bf16 v[56:71],v[32:35],a[8:11],v[56:71]
ds_read_b128 v[52:55],v17 offset:6144
ds_read2_b64 v[164:167],v189 offset0:128 offset1:160
buffer_load_dwordx4 v1,s[8:11],s63 offen sc1 lds
v_mfma_f32_32x32x16_bf16 v[72:87],v[32:35],a[168:171],v[72:87]
ds_read2_b64 v[168:171],v189 offset0:192 offset1:224
s_add_u32 m0,s66,45056
s_add_u32 s63,s60,45056
s_mul_i32 s74,s73,393216
s_add_u32 s74,s74,s39
v_mfma_f32_32x32x16_bf16 v[56:71],v[36:39],a[12:15],v[56:71]
ds_read_b128 v[24:27],v16 offset:8192
ds_read2_b64 v[172:175],v8 offset0:0 offset1:32
s_add_u32 s74,s74,s70
v_fma_f32 v88,-v124,v120,v88
v_mfma_f32_32x32x16_bf16 v[72:87],v[36:39],a[172:175],v[72:87]
buffer_load_dwordx4 v1,s[8:11],s63 offen sc1 lds
s_mul_i32 s61,s46,10240
s_add_u32 s60,s60,s61
s_add_u32 s61,s61,s66
s_waitcnt lgkmcnt(8)
v_mfma_f32_32x32x16_bf16 v[56:71],v[40:43],a[16:19],v[56:71]
ds_read_b128 v[28:31],v17 offset:8192
s_add_u32 m0,s61,0
s_add_u32 s63,s60,0
v_fma_f32 v89,-v126,v120,v89
v_fma_f32 v90,-v128,v120,v90
v_mfma_f32_32x32x16_bf16 v[72:87],v[40:43],a[176:179],v[72:87]
v_fma_f32 v91,-v130,v120,v91
v_fma_f32 v96,-v140,v120,v96
v_fma_f32 v97,-v142,v120,v97
v_fma_f32 v98,-v144,v120,v98
v_fma_f32 v99,-v146,v120,v99
v_mfma_f32_32x32x16_bf16 v[56:71],v[44:47],a[20:23],v[56:71]
ds_read_b128 v[32:35],v16 offset:10240
buffer_load_dwordx4 v1,s[8:11],s63 offen sc1 lds
s_mov_b32 s53,s33
s_mov_b32 s54,s34
v_mfma_f32_32x32x16_bf16 v[72:87],v[44:47],a[180:183],v[72:87]
s_add_u32 s79,s79,s33
s_or_b32 s65,s37,s33
s_cmp_eq_u32 s65,0
s_addc_u32 s78,s78,0
s_lshl_b32 s41,s78,9
s_waitcnt lgkmcnt(6)
v_mfma_f32_32x32x16_bf16 v[56:71],v[48:51],a[24:27],v[56:71]
ds_read_b128 v[36:39],v17 offset:10240
s_add_u32 s41,s41,s40
s_lshl_b32 s35,s79,9
s_add_u32 s35,s35,s40
s_add_u32 s35,s35,32768
v_mfma_f32_32x32x16_bf16 v[72:87],v[48:51],a[184:187],v[72:87]
buffer_load_dwordx4 v1,s[8:11],s63 offen offset:1024 sc1 lds
v_mul_f32 v88,v88,v125
v_mul_f32 v89,v89,v127
v_mul_f32 v90,v90,v129
v_mul_f32 v91,v91,v131
v_mfma_f32_32x32x16_bf16 v[56:71],v[52:55],a[28:31],v[56:71]
ds_read_b128 v[40:43],v16 offset:12288
v_mul_f32 v96,v96,v141
v_mul_f32 v97,v97,v143
v_mul_f32 v98,v98,v145
v_mul_f32 v99,v99,v147
v_mfma_f32_32x32x16_bf16 v[72:87],v[52:55],a[188:191],v[72:87]
v_cvt_pk_bf16_f32 v88,v88,v89
v_cvt_pk_bf16_f32 v89,v90,v91
v_cvt_pk_bf16_f32 v90,v96,v97
v_cvt_pk_bf16_f32 v91,v98,v99
v_fma_f32 v92,-v132,v120,v92
s_waitcnt lgkmcnt(3)
v_mfma_f32_32x32x16_bf16 v[56:71],v[24:27],a[32:35],v[56:71]
ds_read_b128 v[44:47],v17 offset:12288
buffer_load_dwordx4 v1,s[8:11],s63 offen offset:2048 sc1 lds
v_fma_f32 v93,-v134,v120,v93
v_fma_f32 v94,-v136,v120,v94
v_mfma_f32_32x32x16_bf16 v[72:87],v[24:27],a[192:195],v[72:87]
v_fma_f32 v95,-v138,v120,v95
v_fma_f32 v100,-v148,v120,v100
v_fma_f32 v101,-v150,v120,v101
v_fma_f32 v102,-v152,v120,v102
v_fma_f32 v103,-v154,v120,v103
v_mfma_f32_32x32x16_bf16 v[56:71],v[28:31],a[36:39],v[56:71]
ds_read_b128 v[48:51],v16 offset:14336
v_mul_f32 v92,v92,v133
v_mul_f32 v93,v93,v135
v_mul_f32 v94,v94,v137
v_mul_f32 v95,v95,v139
v_mfma_f32_32x32x16_bf16 v[72:87],v[28:31],a[196:199],v[72:87]
buffer_load_dwordx4 v1,s[8:11],s63 offen offset:3072 sc1 lds
s_add_u32 m0,s61,4096
s_add_u32 s63,s60,4096
v_mul_f32 v100,v100,v149
s_waitcnt lgkmcnt(3)
v_mfma_f32_32x32x16_bf16 v[56:71],v[32:35],a[40:43],v[56:71]
ds_read_b128 v[52:55],v17 offset:14336
v_mul_f32 v101,v101,v151
v_mul_f32 v102,v102,v153
v_mul_f32 v103,v103,v155
v_cvt_pk_bf16_f32 v92,v92,v93
v_mfma_f32_32x32x16_bf16 v[72:87],v[32:35],a[200:203],v[72:87]
v_cvt_pk_bf16_f32 v93,v94,v95
v_cvt_pk_bf16_f32 v94,v100,v101
v_cvt_pk_bf16_f32 v95,v102,v103
v_fma_f32 v104,-v124,v121,v104
v_fma_f32 v105,-v126,v121,v105
v_mfma_f32_32x32x16_bf16 v[56:71],v[36:39],a[44:47],v[56:71]
ds_read_b128 v[24:27],v16 offset:16384
buffer_load_dwordx4 v1,s[8:11],s63 offen sc1 lds
v_fma_f32 v106,-v128,v121,v106
v_fma_f32 v107,-v130,v121,v107
v_mfma_f32_32x32x16_bf16 v[72:87],v[36:39],a[204:207],v[72:87]
v_fma_f32 v112,-v140,v121,v112
v_fma_f32 v113,-v142,v121,v113
v_fma_f32 v114,-v144,v121,v114
v_fma_f32 v115,-v146,v121,v115
v_mul_f32 v104,v104,v125
s_waitcnt lgkmcnt(3)
v_mfma_f32_32x32x16_bf16 v[56:71],v[40:43],a[48:51],v[56:71]
ds_read_b128 v[28:31],v17 offset:16384
v_mul_f32 v105,v105,v127
v_mul_f32 v106,v106,v129
v_mul_f32 v107,v107,v131
v_mul_f32 v112,v112,v141
v_mfma_f32_32x32x16_bf16 v[72:87],v[40:43],a[208:211],v[72:87]
buffer_load_dwordx4 v1,s[8:11],s63 offen offset:1024 sc1 lds
v_mul_f32 v113,v113,v143
v_mul_f32 v114,v114,v145
v_mul_f32 v115,v115,v147
v_cvt_pk_bf16_f32 v104,v104,v105
v_mfma_f32_32x32x16_bf16 v[56:71],v[44:47],a[52:55],v[56:71]
ds_read_b128 v[32:35],v16 offset:18432
v_cvt_pk_bf16_f32 v105,v106,v107
v_cvt_pk_bf16_f32 v106,v112,v113
v_cvt_pk_bf16_f32 v107,v114,v115
v_fma_f32 v108,-v132,v121,v108
v_mfma_f32_32x32x16_bf16 v[72:87],v[44:47],a[212:215],v[72:87]
v_fma_f32 v109,-v134,v121,v109
v_fma_f32 v110,-v136,v121,v110
v_fma_f32 v111,-v138,v121,v111
v_fma_f32 v116,-v148,v121,v116
v_fma_f32 v117,-v150,v121,v117
s_waitcnt lgkmcnt(3)
v_mfma_f32_32x32x16_bf16 v[56:71],v[48:51],a[56:59],v[56:71]
ds_read_b128 v[36:39],v17 offset:18432
buffer_load_dwordx4 v1,s[8:11],s63 offen offset:2048 sc1 lds
v_fma_f32 v118,-v152,v121,v118
v_fma_f32 v119,-v154,v121,v119
v_mfma_f32_32x32x16_bf16 v[72:87],v[48:51],a[216:219],v[72:87]
v_mul_f32 v108,v108,v133
v_mul_f32 v109,v109,v135
v_mul_f32 v110,v110,v137
v_mul_f32 v111,v111,v139
v_mul_f32 v116,v116,v149
v_mfma_f32_32x32x16_bf16 v[56:71],v[52:55],a[60:63],v[56:71]
ds_read_b128 v[40:43],v16 offset:20480
s_waitcnt vmcnt(9)
s_mov_b64 exec,1
buffer_store_dword v5,v1,s[8:11],s59 offen sc1
s_mov_b64 exec,-1
s_mov_b32 s59,2147483648
v_mfma_f32_32x32x16_bf16 v[72:87],v[52:55],a[220:223],v[72:87]
buffer_load_dwordx4 v1,s[8:11],s63 offen offset:3072 sc1 lds
s_add_u32 m0,s61,8192
s_add_u32 s63,s60,8192
v_mul_f32 v117,v117,v151
s_waitcnt lgkmcnt(3)
v_mfma_f32_32x32x16_bf16 v[56:71],v[24:27],a[64:67],v[56:71]
ds_read_b128 v[44:47],v17 offset:20480
v_mul_f32 v118,v118,v153
v_mul_f32 v119,v119,v155
v_cvt_pk_bf16_f32 v108,v108,v109
v_cvt_pk_bf16_f32 v109,v110,v111
v_mfma_f32_32x32x16_bf16 v[72:87],v[24:27],a[224:227],v[72:87]
v_cvt_pk_bf16_f32 v110,v116,v117
v_cvt_pk_bf16_f32 v111,v118,v119
s_lshl_b32 s82,s72,6
s_add_u32 s82,s82,s73
s_lshl_b32 s82,s82,9
s_add_u32 s82,s82,s71
v_mfma_f32_32x32x16_bf16 v[56:71],v[28:31],a[68:71],v[56:71]
ds_read_b128 v[48:51],v16 offset:22528
buffer_load_dwordx4 v1,s[8:11],s63 offen sc1 lds
s_lshl_b32 s75,s69,2
s_add_u32 s82,s82,s75
v_mfma_f32_32x32x16_bf16 v[72:87],v[28:31],a[228:231],v[72:87]
buffer_load_dword v3,v2,s[8:11],s35 offen sc1
buffer_load_dword v14,v4,s[8:11],s41 offen sc1
s_add_u32 s82,s82,s39
s_waitcnt lgkmcnt(3)
v_mfma_f32_32x32x16_bf16 v[56:71],v[32:35],a[72:75],v[56:71]
ds_read_b128 v[52:55],v17 offset:22528
v_add_f32 v156,v156,v166
v_add_f32 v157,v157,v167
v_add_f32 v158,v158,v168
v_mfma_f32_32x32x16_bf16 v[72:87],v[32:35],a[232:235],v[72:87]
buffer_load_dwordx4 v1,s[8:11],s63 offen offset:1024 sc1 lds
v_add_f32 v159,v159,v169
v_add_f32 v160,v160,v170
v_add_f32 v161,v161,v171
v_add_f32 v162,v162,v172
v_mfma_f32_32x32x16_bf16 v[56:71],v[36:39],a[76:79],v[56:71]
ds_read_b128 v[24:27],v16 offset:24576
v_add_f32 v163,v163,v173
v_add_f32 v164,v164,v174
v_add_f32 v165,v165,v175
v_add_f32 v156,v156,v158
v_mfma_f32_32x32x16_bf16 v[72:87],v[36:39],a[236:239],v[72:87]
v_add_f32 v157,v157,v159
v_add_f32 v160,v160,v162
v_add_f32 v161,v161,v163
v_add_f32 v156,v156,v160
v_add_f32 v157,v157,v161
s_waitcnt lgkmcnt(3)
v_mfma_f32_32x32x16_bf16 v[56:71],v[40:43],a[80:83],v[56:71]
ds_read_b128 v[28:31],v17 offset:24576
buffer_store_dwordx4 v[88:91],v20,s[8:11],s74 offen sc1
v_add_f32 v156,v156,v164
v_add_f32 v157,v157,v165
v_mfma_f32_32x32x16_bf16 v[72:87],v[40:43],a[240:243],v[72:87]
v_mov_b32 v158,v156
v_mov_b32 v159,v157
s_nop 0
v_permlane32_swap_b32 v156,v158
v_permlane32_swap_b32 v157,v159
v_add_f32 v176,v156,v158
v_mfma_f32_32x32x16_bf16 v[56:71],v[44:47],a[84:87],v[56:71]
ds_read_b128 v[32:35],v16 offset:26624
buffer_store_dwordx4 v[92:95],v21,s[8:11],s74 offen sc1
v_add_f32 v177,v157,v159
v_mul_f32 v176,0x3acccccd,v176
v_mfma_f32_32x32x16_bf16 v[72:87],v[44:47],a[244:247],v[72:87]
v_mul_f32 v177,0x3acccccd,v177
v_fma_f32 v177,-v176,v176,v177
v_max_f32 v177,0,v177
v_cvt_pk_bf16_f32 v8,v176,v177
v_lshlrev_b32 v176,16,v8
s_waitcnt lgkmcnt(3)
v_mfma_f32_32x32x16_bf16 v[56:71],v[48:51],a[88:91],v[56:71]
ds_read_b128 v[36:39],v17 offset:26624
buffer_store_dwordx4 v[104:107],v20,s[8:11],s74 offen offset:2048 sc1
v_and_b32 v177,0xffff0000,v8
v_add_f32 v177,0x3727c5ac,v177
v_mfma_f32_32x32x16_bf16 v[72:87],v[48:51],a[248:251],v[72:87]
v_cvt_pk_bf16_f32 v8,v177,v177
v_lshlrev_b32 v177,16,v8
v_sqrt_f32 v177,v177
s_nop 0
v_cvt_pk_bf16_f32 v8,v177,v177
v_lshlrev_b32 v177,16,v8
v_mfma_f32_32x32x16_bf16 v[56:71],v[52:55],a[92:95],v[56:71]
ds_read_b128 v[40:43],v16 offset:28672
buffer_store_dwordx4 v[108:111],v21,s[8:11],s74 offen offset:2048 sc1
v_rcp_f32 v177,v177
v_mfma_f32_32x32x16_bf16 v[72:87],v[52:55],a[252:255],v[72:87]
s_cmp_eq_u32 s51,0
s_cselect_b64 s[76:77],-1,0
v_cndmask_b32 v176,v176,0,s[76:77]
v_cndmask_b32 v177,v177,1.0,s[76:77]
s_mov_b32 s72,s51
s_waitcnt lgkmcnt(3)
v_mfma_f32_32x32x16_bf16 v[56:71],v[24:27],a[96:99],v[56:71]
ds_read_b128 v[44:47],v17 offset:28672
s_mov_b32 s73,s52
ds_write_b64 v190,v[176:177]
v_mfma_f32_32x32x16_bf16 v[72:87],v[24:27],v[192:195],v[72:87]
ds_read_b128 v[124:127],v191 offset:0
ds_read_b128 v[128:131],v191 offset:16
ds_read_b128 v[132:135],v191 offset:64
v_mfma_f32_32x32x16_bf16 v[56:71],v[28:31],a[100:103],v[56:71]
ds_read_b128 v[48:51],v16 offset:30720
ds_read_b128 v[136:139],v191 offset:80
ds_read_b128 v[140:143],v191 offset:128
v_mfma_f32_32x32x16_bf16 v[72:87],v[28:31],v[196:199],v[72:87]
ds_read_b128 v[144:147],v191 offset:144
ds_read_b128 v[148:151],v191 offset:192
s_waitcnt lgkmcnt(11)
v_mfma_f32_32x32x16_bf16 v[56:71],v[32:35],a[104:107],v[56:71]
ds_read_b128 v[52:55],v17 offset:30720
ds_read_b128 v[152:155],v191 offset:208
v_mfma_f32_32x32x16_bf16 v[72:87],v[32:35],v[200:203],v[72:87]
v_mfma_f32_32x32x16_bf16 v[56:71],v[36:39],a[108:111],v[56:71]
ds_read_b128 v[24:27],v16 offset:32768
v_mfma_f32_32x32x16_bf16 v[72:87],v[36:39],v[204:207],v[72:87]
s_waitcnt lgkmcnt(12)
v_mfma_f32_32x32x16_bf16 v[56:71],v[40:43],a[112:115],v[56:71]
ds_read_b128 v[28:31],v17 offset:32768
v_mfma_f32_32x32x16_bf16 v[72:87],v[40:43],v[208:211],v[72:87]
v_mfma_f32_32x32x16_bf16 v[56:71],v[44:47],a[116:119],v[56:71]
ds_read_b128 v[32:35],v16 offset:34816
v_mfma_f32_32x32x16_bf16 v[72:87],v[44:47],v[212:215],v[72:87]
s_waitcnt lgkmcnt(4)
v_mfma_f32_32x32x16_bf16 v[56:71],v[48:51],a[120:123],v[56:71]
ds_read_b128 v[36:39],v17 offset:34816
v_mfma_f32_32x32x16_bf16 v[72:87],v[48:51],v[216:219],v[72:87]
v_mfma_f32_32x32x16_bf16 v[56:71],v[52:55],a[124:127],v[56:71]
ds_read_b128 v[40:43],v16 offset:36864
v_mfma_f32_32x32x16_bf16 v[72:87],v[52:55],v[220:223],v[72:87]
s_waitcnt lgkmcnt(3)
v_mfma_f32_32x32x16_bf16 v[56:71],v[24:27],a[128:131],v[56:71]
ds_read_b128 v[44:47],v17 offset:36864
s_waitcnt vmcnt(4)
v_cmp_eq_u32 vcc,0,v14
s_cmp_eq_u64 vcc,0
s_cselect_b32 s36,0,2147483648
v_mfma_f32_32x32x16_bf16 v[72:87],v[24:27],v[224:227],v[72:87]
v_cmp_eq_u32 vcc,0,v3
s_cmp_lt_u32 s78,64
s_cselect_b32 s36,s36,2147483648
s_cmp_eq_u64 vcc,0
s_cselect_b32 s60,1,s36
v_mfma_f32_32x32x16_bf16 v[56:71],v[28:31],a[132:135],v[56:71]
ds_read_b128 v[48:51],v16 offset:38912
s_cmp_lt_u32 s79,64
s_cselect_b32 s60,s60,s36
s_sub_u32 s61,s78,s79
s_or_b32 s61,s61,s36
v_mfma_f32_32x32x16_bf16 v[72:87],v[28:31],v[228:231],v[72:87]
s_cmp_lt_u32 s61,16
s_cselect_b32 s36,0,s60
v_mov_b32 v23,s36
s_waitcnt lgkmcnt(3)
v_mfma_f32_32x32x16_bf16 v[56:71],v[32:35],a[136:139],v[56:71]
ds_read_b128 v[52:55],v17 offset:38912
ds_write_b32 v13,v23
v_mfma_f32_32x32x16_bf16 v[72:87],v[32:35],v[232:235],v[72:87]
s_waitcnt lgkmcnt(0)
s_barrier
ds_read_b32 v23,v22
v_mfma_f32_32x32x16_bf16 v[56:71],v[36:39],a[140:143],v[56:71]
ds_read_b128 v[24:27],v18 offset:0
s_cmp_lt_u32 s50,2
s_cselect_b32 s42,1,0
s_cmp_ge_u32 s78,64
s_cselect_b32 s42,1,s42
v_mfma_f32_32x32x16_bf16 v[72:87],v[36:39],v[236:239],v[72:87]
s_or_b32 s42,s42,s37
s_mov_b32 s39,0
s_add_u32 s50,s50,1
s_sub_u32 s57,46080,s57
s_mov_b32 s51,s53
s_mov_b32 s52,s54
v_mfma_f32_32x32x16_bf16 v[56:71],v[40:43],a[144:147],v[56:71]
ds_read_b128 v[28:31],v19 offset:0
v_mfma_f32_32x32x16_bf16 v[72:87],v[40:43],v[240:243],v[72:87]
v_mfma_f32_32x32x16_bf16 v[56:71],v[44:47],a[148:151],v[56:71]
ds_read_b128 v[32:35],v18 offset:2048
s_waitcnt vmcnt(0)
s_mov_b64 exec,1
buffer_store_dword v5,v1,s[8:11],s82 offen sc1
s_mov_b64 exec,-1
s_mov_b32 s82,2147483648
v_mfma_f32_32x32x16_bf16 v[72:87],v[44:47],v[244:247],v[72:87]
s_waitcnt lgkmcnt(3)
v_readfirstlane_b32 s38,v23
s_and_b32 s37,s38,2147483648
s_and_b32 s33,s38,1
s_cselect_b32 s34,s79,s78
s_cmp_lg_u32 s42,0
v_mfma_f32_32x32x16_bf16 v[56:71],v[48:51],a[152:155],v[56:71]
ds_read_b128 v[36:39],v19 offset:2048
v_mfma_f32_32x32x16_bf16 v[72:87],v[48:51],v[248:251],v[72:87]
v_mfma_f32_32x32x16_bf16 v[56:71],v[52:55],a[156:159],v[56:71]
ds_read_b128 v[40:43],v18 offset:4096
v_mfma_f32_32x32x16_bf16 v[72:87],v[52:55],v[252:255],v[72:87]
s_cbranch_scc1 QKVV_S0
QKVV_B1:
s_waitcnt lgkmcnt(3)
v_mfma_f32_32x32x16_bf16 v[88:103],v[24:27],a[0:3],0
ds_read_b128 v[44:47],v19 offset:4096
v_add_u32 v189,s57,v188
v_mfma_f32_32x32x16_bf16 v[104:119],v[24:27],a[160:163],0
v_add_u32 v8,0x800,v189
s_sub_u32 s66,46080,s57
s_lshl_b32 s60,s33,6
s_add_u32 s60,s60,s34
s_mul_i32 s60,s60,46080
s_add_u32 s60,s60,s37
v_mfma_f32_32x32x16_bf16 v[88:103],v[28:31],a[4:7],v[88:103]
ds_read_b128 v[48:51],v18 offset:6144
ds_read2_b64 v[156:159],v189 offset0:0 offset1:32
s_add_u32 s60,s60,206569472
s_lshl_b32 s62,s46,10
v_mfma_f32_32x32x16_bf16 v[104:119],v[28:31],a[164:167],v[104:119]
ds_read2_b64 v[160:163],v189 offset0:64 offset1:96
s_add_u32 s62,s62,40960
s_add_u32 m0,s66,s62
s_add_u32 s63,s60,s62
s_waitcnt lgkmcnt(5)
v_mfma_f32_32x32x16_bf16 v[88:103],v[32:35],a[8:11],v[88:103]
ds_read_b128 v[52:55],v19 offset:6144
ds_read2_b64 v[164:167],v189 offset0:128 offset1:160
buffer_load_dwordx4 v1,s[8:11],s63 offen sc1 lds
v_mfma_f32_32x32x16_bf16 v[104:119],v[32:35],a[168:171],v[104:119]
ds_read2_b64 v[168:171],v189 offset0:192 offset1:224
s_add_u32 m0,s66,45056
s_add_u32 s63,s60,45056
s_mul_i32 s74,s73,393216
s_add_u32 s74,s74,s39
v_mfma_f32_32x32x16_bf16 v[88:103],v[36:39],a[12:15],v[88:103]
ds_read_b128 v[24:27],v18 offset:8192
ds_read2_b64 v[172:175],v8 offset0:0 offset1:32
s_add_u32 s74,s74,s70
v_fma_f32 v56,-v124,v120,v56
v_mfma_f32_32x32x16_bf16 v[104:119],v[36:39],a[172:175],v[104:119]
buffer_load_dwordx4 v1,s[8:11],s63 offen sc1 lds
s_mul_i32 s61,s46,10240
s_add_u32 s60,s60,s61
s_add_u32 s61,s61,s66
s_waitcnt lgkmcnt(8)
v_mfma_f32_32x32x16_bf16 v[88:103],v[40:43],a[16:19],v[88:103]
ds_read_b128 v[28:31],v19 offset:8192
s_add_u32 m0,s61,0
s_add_u32 s63,s60,0
v_fma_f32 v57,-v126,v120,v57
v_fma_f32 v58,-v128,v120,v58
v_mfma_f32_32x32x16_bf16 v[104:119],v[40:43],a[176:179],v[104:119]
v_fma_f32 v59,-v130,v120,v59
v_fma_f32 v64,-v140,v120,v64
v_fma_f32 v65,-v142,v120,v65
v_fma_f32 v66,-v144,v120,v66
v_fma_f32 v67,-v146,v120,v67
v_mfma_f32_32x32x16_bf16 v[88:103],v[44:47],a[20:23],v[88:103]
ds_read_b128 v[32:35],v18 offset:10240
buffer_load_dwordx4 v1,s[8:11],s63 offen sc1 lds
s_mov_b32 s53,s33
s_mov_b32 s54,s34
v_mfma_f32_32x32x16_bf16 v[104:119],v[44:47],a[180:183],v[104:119]
s_add_u32 s79,s79,s33
s_or_b32 s65,s37,s33
s_cmp_eq_u32 s65,0
s_addc_u32 s78,s78,0
s_lshl_b32 s41,s78,9
s_waitcnt lgkmcnt(6)
v_mfma_f32_32x32x16_bf16 v[88:103],v[48:51],a[24:27],v[88:103]
ds_read_b128 v[36:39],v19 offset:10240
s_add_u32 s41,s41,s40
s_lshl_b32 s35,s79,9
s_add_u32 s35,s35,s40
s_add_u32 s35,s35,32768
v_mfma_f32_32x32x16_bf16 v[104:119],v[48:51],a[184:187],v[104:119]
buffer_load_dwordx4 v1,s[8:11],s63 offen offset:1024 sc1 lds
v_mul_f32 v56,v56,v125
v_mul_f32 v57,v57,v127
v_mul_f32 v58,v58,v129
v_mul_f32 v59,v59,v131
v_mfma_f32_32x32x16_bf16 v[88:103],v[52:55],a[28:31],v[88:103]
ds_read_b128 v[40:43],v18 offset:12288
v_mul_f32 v64,v64,v141
v_mul_f32 v65,v65,v143
v_mul_f32 v66,v66,v145
v_mul_f32 v67,v67,v147
v_mfma_f32_32x32x16_bf16 v[104:119],v[52:55],a[188:191],v[104:119]
v_cvt_pk_bf16_f32 v56,v56,v57
v_cvt_pk_bf16_f32 v57,v58,v59
v_cvt_pk_bf16_f32 v58,v64,v65
v_cvt_pk_bf16_f32 v59,v66,v67
v_fma_f32 v60,-v132,v120,v60
s_waitcnt lgkmcnt(3)
v_mfma_f32_32x32x16_bf16 v[88:103],v[24:27],a[32:35],v[88:103]
ds_read_b128 v[44:47],v19 offset:12288
buffer_load_dwordx4 v1,s[8:11],s63 offen offset:2048 sc1 lds
v_fma_f32 v61,-v134,v120,v61
v_fma_f32 v62,-v136,v120,v62
v_mfma_f32_32x32x16_bf16 v[104:119],v[24:27],a[192:195],v[104:119]
v_fma_f32 v63,-v138,v120,v63
v_fma_f32 v68,-v148,v120,v68
v_fma_f32 v69,-v150,v120,v69
v_fma_f32 v70,-v152,v120,v70
v_fma_f32 v71,-v154,v120,v71
v_mfma_f32_32x32x16_bf16 v[88:103],v[28:31],a[36:39],v[88:103]
ds_read_b128 v[48:51],v18 offset:14336
v_mul_f32 v60,v60,v133
v_mul_f32 v61,v61,v135
v_mul_f32 v62,v62,v137
v_mul_f32 v63,v63,v139
v_mfma_f32_32x32x16_bf16 v[104:119],v[28:31],a[196:199],v[104:119]
buffer_load_dwordx4 v1,s[8:11],s63 offen offset:3072 sc1 lds
s_add_u32 m0,s61,4096
s_add_u32 s63,s60,4096
v_mul_f32 v68,v68,v149
s_waitcnt lgkmcnt(3)
v_mfma_f32_32x32x16_bf16 v[88:103],v[32:35],a[40:43],v[88:103]
ds_read_b128 v[52:55],v19 offset:14336
v_mul_f32 v69,v69,v151
v_mul_f32 v70,v70,v153
v_mul_f32 v71,v71,v155
v_cvt_pk_bf16_f32 v60,v60,v61
v_mfma_f32_32x32x16_bf16 v[104:119],v[32:35],a[200:203],v[104:119]
v_cvt_pk_bf16_f32 v61,v62,v63
v_cvt_pk_bf16_f32 v62,v68,v69
v_cvt_pk_bf16_f32 v63,v70,v71
v_fma_f32 v72,-v124,v121,v72
v_fma_f32 v73,-v126,v121,v73
v_mfma_f32_32x32x16_bf16 v[88:103],v[36:39],a[44:47],v[88:103]
ds_read_b128 v[24:27],v18 offset:16384
buffer_load_dwordx4 v1,s[8:11],s63 offen sc1 lds
v_fma_f32 v74,-v128,v121,v74
v_fma_f32 v75,-v130,v121,v75
v_mfma_f32_32x32x16_bf16 v[104:119],v[36:39],a[204:207],v[104:119]
v_fma_f32 v80,-v140,v121,v80
v_fma_f32 v81,-v142,v121,v81
v_fma_f32 v82,-v144,v121,v82
v_fma_f32 v83,-v146,v121,v83
v_mul_f32 v72,v72,v125
s_waitcnt lgkmcnt(3)
v_mfma_f32_32x32x16_bf16 v[88:103],v[40:43],a[48:51],v[88:103]
ds_read_b128 v[28:31],v19 offset:16384
v_mul_f32 v73,v73,v127
v_mul_f32 v74,v74,v129
v_mul_f32 v75,v75,v131
v_mul_f32 v80,v80,v141
v_mfma_f32_32x32x16_bf16 v[104:119],v[40:43],a[208:211],v[104:119]
buffer_load_dwordx4 v1,s[8:11],s63 offen offset:1024 sc1 lds
v_mul_f32 v81,v81,v143
v_mul_f32 v82,v82,v145
v_mul_f32 v83,v83,v147
v_cvt_pk_bf16_f32 v72,v72,v73
v_mfma_f32_32x32x16_bf16 v[88:103],v[44:47],a[52:55],v[88:103]
ds_read_b128 v[32:35],v18 offset:18432
v_cvt_pk_bf16_f32 v73,v74,v75
v_cvt_pk_bf16_f32 v74,v80,v81
v_cvt_pk_bf16_f32 v75,v82,v83
v_fma_f32 v76,-v132,v121,v76
v_mfma_f32_32x32x16_bf16 v[104:119],v[44:47],a[212:215],v[104:119]
v_fma_f32 v77,-v134,v121,v77
v_fma_f32 v78,-v136,v121,v78
v_fma_f32 v79,-v138,v121,v79
v_fma_f32 v84,-v148,v121,v84
v_fma_f32 v85,-v150,v121,v85
s_waitcnt lgkmcnt(3)
v_mfma_f32_32x32x16_bf16 v[88:103],v[48:51],a[56:59],v[88:103]
ds_read_b128 v[36:39],v19 offset:18432
buffer_load_dwordx4 v1,s[8:11],s63 offen offset:2048 sc1 lds
v_fma_f32 v86,-v152,v121,v86
v_fma_f32 v87,-v154,v121,v87
v_mfma_f32_32x32x16_bf16 v[104:119],v[48:51],a[216:219],v[104:119]
v_mul_f32 v76,v76,v133
v_mul_f32 v77,v77,v135
v_mul_f32 v78,v78,v137
v_mul_f32 v79,v79,v139
v_mul_f32 v84,v84,v149
v_mfma_f32_32x32x16_bf16 v[88:103],v[52:55],a[60:63],v[88:103]
ds_read_b128 v[40:43],v18 offset:20480
s_waitcnt vmcnt(9)
s_mov_b64 exec,1
buffer_store_dword v5,v1,s[8:11],s59 offen sc1
s_mov_b64 exec,-1
s_mov_b32 s59,2147483648
v_mfma_f32_32x32x16_bf16 v[104:119],v[52:55],a[220:223],v[104:119]
buffer_load_dwordx4 v1,s[8:11],s63 offen offset:3072 sc1 lds
s_add_u32 m0,s61,8192
s_add_u32 s63,s60,8192
v_mul_f32 v85,v85,v151
s_waitcnt lgkmcnt(3)
v_mfma_f32_32x32x16_bf16 v[88:103],v[24:27],a[64:67],v[88:103]
ds_read_b128 v[44:47],v19 offset:20480
v_mul_f32 v86,v86,v153
v_mul_f32 v87,v87,v155
v_cvt_pk_bf16_f32 v76,v76,v77
v_cvt_pk_bf16_f32 v77,v78,v79
v_mfma_f32_32x32x16_bf16 v[104:119],v[24:27],a[224:227],v[104:119]
v_cvt_pk_bf16_f32 v78,v84,v85
v_cvt_pk_bf16_f32 v79,v86,v87
s_lshl_b32 s82,s72,6
s_add_u32 s82,s82,s73
s_lshl_b32 s82,s82,9
s_add_u32 s82,s82,s71
v_mfma_f32_32x32x16_bf16 v[88:103],v[28:31],a[68:71],v[88:103]
ds_read_b128 v[48:51],v18 offset:22528
buffer_load_dwordx4 v1,s[8:11],s63 offen sc1 lds
s_lshl_b32 s75,s69,2
s_add_u32 s82,s82,s75
v_mfma_f32_32x32x16_bf16 v[104:119],v[28:31],a[228:231],v[104:119]
buffer_load_dword v3,v2,s[8:11],s35 offen sc1
buffer_load_dword v14,v4,s[8:11],s41 offen sc1
s_add_u32 s82,s82,s39
s_waitcnt lgkmcnt(3)
v_mfma_f32_32x32x16_bf16 v[88:103],v[32:35],a[72:75],v[88:103]
ds_read_b128 v[52:55],v19 offset:22528
v_add_f32 v156,v156,v166
v_add_f32 v157,v157,v167
v_add_f32 v158,v158,v168
v_mfma_f32_32x32x16_bf16 v[104:119],v[32:35],a[232:235],v[104:119]
buffer_load_dwordx4 v1,s[8:11],s63 offen offset:1024 sc1 lds
v_add_f32 v159,v159,v169
v_add_f32 v160,v160,v170
v_add_f32 v161,v161,v171
v_add_f32 v162,v162,v172
v_mfma_f32_32x32x16_bf16 v[88:103],v[36:39],a[76:79],v[88:103]
ds_read_b128 v[24:27],v18 offset:24576
v_add_f32 v163,v163,v173
v_add_f32 v164,v164,v174
v_add_f32 v165,v165,v175
v_add_f32 v156,v156,v158
v_mfma_f32_32x32x16_bf16 v[104:119],v[36:39],a[236:239],v[104:119]
v_add_f32 v157,v157,v159
v_add_f32 v160,v160,v162
v_add_f32 v161,v161,v163
v_add_f32 v156,v156,v160
v_add_f32 v157,v157,v161
s_waitcnt lgkmcnt(3)
v_mfma_f32_32x32x16_bf16 v[88:103],v[40:43],a[80:83],v[88:103]
ds_read_b128 v[28:31],v19 offset:24576
buffer_store_dwordx4 v[56:59],v20,s[8:11],s74 offen sc1
v_add_f32 v156,v156,v164
v_add_f32 v157,v157,v165
v_mfma_f32_32x32x16_bf16 v[104:119],v[40:43],a[240:243],v[104:119]
v_mov_b32 v158,v156
v_mov_b32 v159,v157
s_nop 0
v_permlane32_swap_b32 v156,v158
v_permlane32_swap_b32 v157,v159
v_add_f32 v176,v156,v158
v_mfma_f32_32x32x16_bf16 v[88:103],v[44:47],a[84:87],v[88:103]
ds_read_b128 v[32:35],v18 offset:26624
buffer_store_dwordx4 v[60:63],v21,s[8:11],s74 offen sc1
v_add_f32 v177,v157,v159
v_mul_f32 v176,0x3acccccd,v176
v_mfma_f32_32x32x16_bf16 v[104:119],v[44:47],a[244:247],v[104:119]
v_mul_f32 v177,0x3acccccd,v177
v_fma_f32 v177,-v176,v176,v177
v_max_f32 v177,0,v177
v_cvt_pk_bf16_f32 v8,v176,v177
v_lshlrev_b32 v176,16,v8
s_waitcnt lgkmcnt(3)
v_mfma_f32_32x32x16_bf16 v[88:103],v[48:51],a[88:91],v[88:103]
ds_read_b128 v[36:39],v19 offset:26624
buffer_store_dwordx4 v[72:75],v20,s[8:11],s74 offen offset:2048 sc1
v_and_b32 v177,0xffff0000,v8
v_add_f32 v177,0x3727c5ac,v177
v_mfma_f32_32x32x16_bf16 v[104:119],v[48:51],a[248:251],v[104:119]
v_cvt_pk_bf16_f32 v8,v177,v177
v_lshlrev_b32 v177,16,v8
v_sqrt_f32 v177,v177
s_nop 0
v_cvt_pk_bf16_f32 v8,v177,v177
v_lshlrev_b32 v177,16,v8
v_mfma_f32_32x32x16_bf16 v[88:103],v[52:55],a[92:95],v[88:103]
ds_read_b128 v[40:43],v18 offset:28672
buffer_store_dwordx4 v[76:79],v21,s[8:11],s74 offen offset:2048 sc1
v_rcp_f32 v177,v177
v_mfma_f32_32x32x16_bf16 v[104:119],v[52:55],a[252:255],v[104:119]
s_cmp_eq_u32 s51,0
s_cselect_b64 s[76:77],-1,0
v_cndmask_b32 v176,v176,0,s[76:77]
v_cndmask_b32 v177,v177,1.0,s[76:77]
s_mov_b32 s72,s51
s_waitcnt lgkmcnt(3)
v_mfma_f32_32x32x16_bf16 v[88:103],v[24:27],a[96:99],v[88:103]
ds_read_b128 v[44:47],v19 offset:28672
s_mov_b32 s73,s52
ds_write_b64 v190,v[176:177]
v_mfma_f32_32x32x16_bf16 v[104:119],v[24:27],v[192:195],v[104:119]
ds_read_b128 v[124:127],v191 offset:0
ds_read_b128 v[128:131],v191 offset:16
ds_read_b128 v[132:135],v191 offset:64
v_mfma_f32_32x32x16_bf16 v[88:103],v[28:31],a[100:103],v[88:103]
ds_read_b128 v[48:51],v18 offset:30720
ds_read_b128 v[136:139],v191 offset:80
ds_read_b128 v[140:143],v191 offset:128
v_mfma_f32_32x32x16_bf16 v[104:119],v[28:31],v[196:199],v[104:119]
ds_read_b128 v[144:147],v191 offset:144
ds_read_b128 v[148:151],v191 offset:192
s_waitcnt lgkmcnt(11)
v_mfma_f32_32x32x16_bf16 v[88:103],v[32:35],a[104:107],v[88:103]
ds_read_b128 v[52:55],v19 offset:30720
ds_read_b128 v[152:155],v191 offset:208
v_mfma_f32_32x32x16_bf16 v[104:119],v[32:35],v[200:203],v[104:119]
v_mfma_f32_32x32x16_bf16 v[88:103],v[36:39],a[108:111],v[88:103]
ds_read_b128 v[24:27],v18 offset:32768
v_mfma_f32_32x32x16_bf16 v[104:119],v[36:39],v[204:207],v[104:119]
s_waitcnt lgkmcnt(12)
v_mfma_f32_32x32x16_bf16 v[88:103],v[40:43],a[112:115],v[88:103]
ds_read_b128 v[28:31],v19 offset:32768
v_mfma_f32_32x32x16_bf16 v[104:119],v[40:43],v[208:211],v[104:119]
v_mfma_f32_32x32x16_bf16 v[88:103],v[44:47],a[116:119],v[88:103]
ds_read_b128 v[32:35],v18 offset:34816
v_mfma_f32_32x32x16_bf16 v[104:119],v[44:47],v[212:215],v[104:119]
s_waitcnt lgkmcnt(4)
v_mfma_f32_32x32x16_bf16 v[88:103],v[48:51],a[120:123],v[88:103]
ds_read_b128 v[36:39],v19 offset:34816
v_mfma_f32_32x32x16_bf16 v[104:119],v[48:51],v[216:219],v[104:119]
v_mfma_f32_32x32x16_bf16 v[88:103],v[52:55],a[124:127],v[88:103]
ds_read_b128 v[40:43],v18 offset:36864
v_mfma_f32_32x32x16_bf16 v[104:119],v[52:55],v[220:223],v[104:119]
s_waitcnt lgkmcnt(3)
v_mfma_f32_32x32x16_bf16 v[88:103],v[24:27],a[128:131],v[88:103]
ds_read_b128 v[44:47],v19 offset:36864
s_waitcnt vmcnt(4)
v_cmp_eq_u32 vcc,0,v14
s_cmp_eq_u64 vcc,0
s_cselect_b32 s36,0,2147483648
v_mfma_f32_32x32x16_bf16 v[104:119],v[24:27],v[224:227],v[104:119]
v_cmp_eq_u32 vcc,0,v3
s_cmp_lt_u32 s78,64
s_cselect_b32 s36,s36,2147483648
s_cmp_eq_u64 vcc,0
s_cselect_b32 s60,1,s36
v_mfma_f32_32x32x16_bf16 v[88:103],v[28:31],a[132:135],v[88:103]
ds_read_b128 v[48:51],v18 offset:38912
s_cmp_lt_u32 s79,64
s_cselect_b32 s60,s60,s36
s_sub_u32 s61,s78,s79
s_or_b32 s61,s61,s36
v_mfma_f32_32x32x16_bf16 v[104:119],v[28:31],v[228:231],v[104:119]
s_cmp_lt_u32 s61,16
s_cselect_b32 s36,0,s60
v_mov_b32 v23,s36
s_waitcnt lgkmcnt(3)
v_mfma_f32_32x32x16_bf16 v[88:103],v[32:35],a[136:139],v[88:103]
ds_read_b128 v[52:55],v19 offset:38912
ds_write_b32 v13,v23
v_mfma_f32_32x32x16_bf16 v[104:119],v[32:35],v[232:235],v[104:119]
s_waitcnt lgkmcnt(0)
s_barrier
ds_read_b32 v23,v22
v_mfma_f32_32x32x16_bf16 v[88:103],v[36:39],a[140:143],v[88:103]
ds_read_b128 v[24:27],v16 offset:0
s_cmp_lt_u32 s50,2
s_cselect_b32 s42,1,0
s_cmp_ge_u32 s78,64
s_cselect_b32 s42,1,s42
v_mfma_f32_32x32x16_bf16 v[104:119],v[36:39],v[236:239],v[104:119]
s_or_b32 s42,s42,s37
s_mov_b32 s39,0
s_add_u32 s50,s50,1
s_sub_u32 s57,46080,s57
s_mov_b32 s51,s53
s_mov_b32 s52,s54
v_mfma_f32_32x32x16_bf16 v[88:103],v[40:43],a[144:147],v[88:103]
ds_read_b128 v[28:31],v17 offset:0
v_mfma_f32_32x32x16_bf16 v[104:119],v[40:43],v[240:243],v[104:119]
v_mfma_f32_32x32x16_bf16 v[88:103],v[44:47],a[148:151],v[88:103]
ds_read_b128 v[32:35],v16 offset:2048
s_waitcnt vmcnt(0)
s_mov_b64 exec,1
buffer_store_dword v5,v1,s[8:11],s82 offen sc1
s_mov_b64 exec,-1
s_mov_b32 s82,2147483648
v_mfma_f32_32x32x16_bf16 v[104:119],v[44:47],v[244:247],v[104:119]
s_waitcnt lgkmcnt(3)
v_readfirstlane_b32 s38,v23
s_and_b32 s37,s38,2147483648
s_and_b32 s33,s38,1
s_cselect_b32 s34,s79,s78
s_cmp_lg_u32 s42,0
v_mfma_f32_32x32x16_bf16 v[88:103],v[48:51],a[152:155],v[88:103]
ds_read_b128 v[36:39],v17 offset:2048
v_mfma_f32_32x32x16_bf16 v[104:119],v[48:51],v[248:251],v[104:119]
v_mfma_f32_32x32x16_bf16 v[88:103],v[52:55],a[156:159],v[88:103]
ds_read_b128 v[40:43],v16 offset:4096
v_mfma_f32_32x32x16_bf16 v[104:119],v[52:55],v[252:255],v[104:119]
s_cbranch_scc0 QKVV_B0
s_branch QKVV_S1
s_nop 9
QKVV_S0:
s_mov_b32 s55,0
s_cmp_lt_u32 s42,2
s_cbranch_scc1 nt_211
s_mov_b32 s55,2
s_cmp_lg_u32 s37,0
s_cbranch_scc1 nt_211
s_mov_b32 s55,1
s_lshl_b32 s60,s33,6
s_add_u32 s60,s60,s34
s_mul_i32 s60,s60,46080
s_add_u32 s60,s60,206569472
s_lshl_b32 s62,s46,10
s_add_u32 s62,s62,40960
s_add_u32 m0,s57,s62
s_add_u32 s63,s60,s62
buffer_load_dwordx4 v1,s[8:11],s63 offen sc1 lds
s_add_u32 m0,s57,45056
s_add_u32 s63,s60,45056
buffer_load_dwordx4 v1,s[8:11],s63 offen sc1 lds
s_mul_i32 s61,s46,10240
s_add_u32 s60,s60,s61
s_add_u32 s61,s61,s57
s_add_u32 m0,s61,0
s_add_u32 s63,s60,0
buffer_load_dwordx4 v1,s[8:11],s63 offen sc1 lds
buffer_load_dwordx4 v1,s[8:11],s63 offen offset:1024 sc1 lds
buffer_load_dwordx4 v1,s[8:11],s63 offen offset:2048 sc1 lds
buffer_load_dwordx4 v1,s[8:11],s63 offen offset:3072 sc1 lds
s_add_u32 m0,s61,4096
s_add_u32 s63,s60,4096
buffer_load_dwordx4 v1,s[8:11],s63 offen sc1 lds
buffer_load_dwordx4 v1,s[8:11],s63 offen offset:1024 sc1 lds
buffer_load_dwordx4 v1,s[8:11],s63 offen offset:2048 sc1 lds
buffer_load_dwordx4 v1,s[8:11],s63 offen offset:3072 sc1 lds
s_add_u32 m0,s61,8192
s_add_u32 s63,s60,8192
buffer_load_dwordx4 v1,s[8:11],s63 offen sc1 lds
buffer_load_dwordx4 v1,s[8:11],s63 offen offset:1024 sc1 lds
nt_211:
s_nop 4
s_mul_i32 s74,s73,393216
s_add_u32 s74,s74,s39
s_add_u32 s74,s74,s70
v_fma_f32 v56,-v124,v120,v56
v_fma_f32 v57,-v126,v120,v57
v_fma_f32 v58,-v128,v120,v58
v_fma_f32 v59,-v130,v120,v59
v_fma_f32 v64,-v140,v120,v64
v_fma_f32 v65,-v142,v120,v65
v_fma_f32 v66,-v144,v120,v66
v_fma_f32 v67,-v146,v120,v67
v_mul_f32 v56,v56,v125
v_mul_f32 v57,v57,v127
v_mul_f32 v58,v58,v129
v_mul_f32 v59,v59,v131
v_mul_f32 v64,v64,v141
v_mul_f32 v65,v65,v143
v_mul_f32 v66,v66,v145
v_mul_f32 v67,v67,v147
v_cvt_pk_bf16_f32 v56,v56,v57
v_cvt_pk_bf16_f32 v57,v58,v59
v_cvt_pk_bf16_f32 v58,v64,v65
v_cvt_pk_bf16_f32 v59,v66,v67
buffer_store_dwordx4 v[56:59],v20,s[8:11],s74 offen sc1
v_fma_f32 v60,-v132,v120,v60
v_fma_f32 v61,-v134,v120,v61
v_fma_f32 v62,-v136,v120,v62
v_fma_f32 v63,-v138,v120,v63
v_fma_f32 v68,-v148,v120,v68
v_fma_f32 v69,-v150,v120,v69
v_fma_f32 v70,-v152,v120,v70
v_fma_f32 v71,-v154,v120,v71
v_mul_f32 v60,v60,v133
v_mul_f32 v61,v61,v135
v_mul_f32 v62,v62,v137
v_mul_f32 v63,v63,v139
v_mul_f32 v68,v68,v149
v_mul_f32 v69,v69,v151
v_mul_f32 v70,v70,v153
v_mul_f32 v71,v71,v155
v_cvt_pk_bf16_f32 v60,v60,v61
v_cvt_pk_bf16_f32 v61,v62,v63
v_cvt_pk_bf16_f32 v62,v68,v69
v_cvt_pk_bf16_f32 v63,v70,v71
buffer_store_dwordx4 v[60:63],v21,s[8:11],s74 offen sc1
v_fma_f32 v72,-v124,v121,v72
v_fma_f32 v73,-v126,v121,v73
v_fma_f32 v74,-v128,v121,v74
v_fma_f32 v75,-v130,v121,v75
v_fma_f32 v80,-v140,v121,v80
v_fma_f32 v81,-v142,v121,v81
v_fma_f32 v82,-v144,v121,v82
v_fma_f32 v83,-v146,v121,v83
v_mul_f32 v72,v72,v125
v_mul_f32 v73,v73,v127
v_mul_f32 v74,v74,v129
v_mul_f32 v75,v75,v131
v_mul_f32 v80,v80,v141
v_mul_f32 v81,v81,v143
v_mul_f32 v82,v82,v145
v_mul_f32 v83,v83,v147
v_cvt_pk_bf16_f32 v72,v72,v73
v_cvt_pk_bf16_f32 v73,v74,v75
v_cvt_pk_bf16_f32 v74,v80,v81
v_cvt_pk_bf16_f32 v75,v82,v83
buffer_store_dwordx4 v[72:75],v20,s[8:11],s74 offen offset:2048 sc1
v_fma_f32 v76,-v132,v121,v76
v_fma_f32 v77,-v134,v121,v77
v_fma_f32 v78,-v136,v121,v78
v_fma_f32 v79,-v138,v121,v79
v_fma_f32 v84,-v148,v121,v84
v_fma_f32 v85,-v150,v121,v85
v_fma_f32 v86,-v152,v121,v86
v_fma_f32 v87,-v154,v121,v87
v_mul_f32 v76,v76,v133
v_mul_f32 v77,v77,v135
v_mul_f32 v78,v78,v137
v_mul_f32 v79,v79,v139
v_mul_f32 v84,v84,v149
v_mul_f32 v85,v85,v151
v_mul_f32 v86,v86,v153
v_mul_f32 v87,v87,v155
v_cvt_pk_bf16_f32 v76,v76,v77
v_cvt_pk_bf16_f32 v77,v78,v79
v_cvt_pk_bf16_f32 v78,v84,v85
v_cvt_pk_bf16_f32 v79,v86,v87
buffer_store_dwordx4 v[76:79],v21,s[8:11],s74 offen offset:2048 sc1
s_lshl_b32 s82,s72,6
s_add_u32 s82,s82,s73
s_lshl_b32 s82,s82,9
s_add_u32 s82,s82,s71
s_lshl_b32 s75,s69,2
s_add_u32 s82,s82,s75
s_add_u32 s82,s82,s39
s_mov_b32 s59,s82
s_mov_b32 s82,2147483648
s_mov_b32 s39,2147483648
s_cmp_eq_u32 s55,0
s_cbranch_scc1 QKVV_B1
s_cmp_eq_u32 s55,1
s_cbranch_scc1 QKVV_CD1
s_waitcnt vmcnt(0)
s_mov_b64 exec,1
buffer_store_dword v5,v1,s[8:11],s59 offen sc1
s_mov_b64 exec,-1
s_mov_b32 s59,2147483648
s_cmp_eq_u32 s50,128
s_cbranch_scc1 QKVV_END
s_branch QKVV_COLD1
QKVV_COLD0:
s_cmp_lg_u32 s46,0
s_cbranch_scc1 cp_212
ct_213:
buffer_load_dword v3,v2,s[8:11],s35 offen sc1
buffer_load_dword v14,v4,s[8:11],s41 offen sc1
s_waitcnt vmcnt(0)
v_cmp_eq_u32 vcc,0,v14
s_cmp_eq_u64 vcc,0
s_cselect_b32 s36,0,2147483648
v_cmp_eq_u32 vcc,0,v3
s_cmp_lt_u32 s78,64
s_cselect_b32 s36,s36,2147483648
s_cmp_eq_u64 vcc,0
s_cselect_b32 s60,1,s36
s_cmp_lt_u32 s79,64
s_cselect_b32 s60,s60,s36
s_sub_u32 s61,s78,s79
s_or_b32 s61,s61,s36
s_cmp_lt_u32 s61,16
s_cselect_b32 s36,0,s60
v_mov_b32 v23,s36
s_cmp_lt_u32 s36,2
s_cbranch_scc1 ct_213x
s_sleep 3
s_sub_u32 s47,s47,1
s_cbranch_scc1 ABORT
s_branch ct_213
ct_213x:
ds_write_b32 v22,v23 offset:4
s_waitcnt lgkmcnt(0)
cp_212:
s_barrier
ds_read_b32 v23,v22 offset:4
s_waitcnt lgkmcnt(0)
v_readfirstlane_b32 s38,v23
s_and_b32 s38,s38,1
s_and_b32 s37,s38,2147483648
s_and_b32 s33,s38,1
s_cselect_b32 s34,s79,s78
s_lshl_b32 s60,s33,6
s_add_u32 s60,s60,s34
s_mul_i32 s60,s60,46080
s_add_u32 s60,s60,206569472
s_lshl_b32 s62,s46,10
s_add_u32 s62,s62,40960
s_add_u32 m0,s57,s62
s_add_u32 s63,s60,s62
buffer_load_dwordx4 v1,s[8:11],s63 offen sc1 lds
s_add_u32 m0,s57,45056
s_add_u32 s63,s60,45056
buffer_load_dwordx4 v1,s[8:11],s63 offen sc1 lds
s_mul_i32 s61,s46,10240
s_add_u32 s60,s60,s61
s_add_u32 s61,s61,s57
s_add_u32 m0,s61,0
s_add_u32 s63,s60,0
buffer_load_dwordx4 v1,s[8:11],s63 offen sc1 lds
buffer_load_dwordx4 v1,s[8:11],s63 offen offset:1024 sc1 lds
buffer_load_dwordx4 v1,s[8:11],s63 offen offset:2048 sc1 lds
buffer_load_dwordx4 v1,s[8:11],s63 offen offset:3072 sc1 lds
s_add_u32 m0,s61,4096
s_add_u32 s63,s60,4096
buffer_load_dwordx4 v1,s[8:11],s63 offen sc1 lds
buffer_load_dwordx4 v1,s[8:11],s63 offen offset:1024 sc1 lds
buffer_load_dwordx4 v1,s[8:11],s63 offen offset:2048 sc1 lds
buffer_load_dwordx4 v1,s[8:11],s63 offen offset:3072 sc1 lds
s_add_u32 m0,s61,8192
s_add_u32 s63,s60,8192
buffer_load_dwordx4 v1,s[8:11],s63 offen sc1 lds
buffer_load_dwordx4 v1,s[8:11],s63 offen offset:1024 sc1 lds
QKVV_CD0:
s_mov_b32 s51,s33
s_mov_b32 s52,s34
s_mov_b32 s53,s33
s_mov_b32 s54,s34
s_add_u32 s79,s79,s33
s_or_b32 s60,s37,s33
s_cmp_eq_u32 s60,0
s_addc_u32 s78,s78,0
s_lshl_b32 s41,s78,9
s_add_u32 s41,s41,s40
s_lshl_b32 s35,s79,9
s_add_u32 s35,s35,s40
s_add_u32 s35,s35,32768
buffer_load_dword v3,v2,s[8:11],s35 offen sc1
buffer_load_dword v14,v4,s[8:11],s41 offen sc1
s_waitcnt vmcnt(0)
s_mov_b64 exec,1
buffer_store_dword v5,v1,s[8:11],s59 offen sc1
s_mov_b64 exec,-1
s_mov_b32 s59,2147483648
v_cmp_eq_u32 vcc,0,v14
s_cmp_eq_u64 vcc,0
s_cselect_b32 s36,0,2147483648
v_cmp_eq_u32 vcc,0,v3
s_cmp_lt_u32 s78,64
s_cselect_b32 s36,s36,2147483648
s_cmp_eq_u64 vcc,0
s_cselect_b32 s60,1,s36
s_cmp_lt_u32 s79,64
s_cselect_b32 s60,s60,s36
s_sub_u32 s61,s78,s79
s_or_b32 s61,s61,s36
s_cmp_lt_u32 s61,16
s_cselect_b32 s36,0,s60
v_mov_b32 v23,s36
ds_write_b32 v13,v23
s_waitcnt lgkmcnt(0)
s_barrier
ds_read_b32 v23,v22
ds_read_b128 v[24:27],v16 offset:0
ds_read_b128 v[28:31],v17 offset:0
ds_read_b128 v[32:35],v16 offset:2048
ds_read_b128 v[36:39],v17 offset:2048
ds_read_b128 v[40:43],v16 offset:4096
s_waitcnt lgkmcnt(5)
v_readfirstlane_b32 s38,v23
s_and_b32 s37,s38,2147483648
s_and_b32 s33,s38,1
s_cselect_b32 s34,s79,s78
s_nop 0
s_branch QKVV_B0
QKVV_S1:
s_mov_b32 s55,0
s_cmp_lt_u32 s42,2
s_cbranch_scc1 nt_214
s_mov_b32 s55,2
s_cmp_lg_u32 s37,0
s_cbranch_scc1 nt_214
s_mov_b32 s55,1
s_lshl_b32 s60,s33,6
s_add_u32 s60,s60,s34
s_mul_i32 s60,s60,46080
s_add_u32 s60,s60,206569472
s_lshl_b32 s62,s46,10
s_add_u32 s62,s62,40960
s_add_u32 m0,s57,s62
s_add_u32 s63,s60,s62
buffer_load_dwordx4 v1,s[8:11],s63 offen sc1 lds
s_add_u32 m0,s57,45056
s_add_u32 s63,s60,45056
buffer_load_dwordx4 v1,s[8:11],s63 offen sc1 lds
s_mul_i32 s61,s46,10240
s_add_u32 s60,s60,s61
s_add_u32 s61,s61,s57
s_add_u32 m0,s61,0
s_add_u32 s63,s60,0
buffer_load_dwordx4 v1,s[8:11],s63 offen sc1 lds
buffer_load_dwordx4 v1,s[8:11],s63 offen offset:1024 sc1 lds
buffer_load_dwordx4 v1,s[8:11],s63 offen offset:2048 sc1 lds
buffer_load_dwordx4 v1,s[8:11],s63 offen offset:3072 sc1 lds
s_add_u32 m0,s61,4096
s_add_u32 s63,s60,4096
buffer_load_dwordx4 v1,s[8:11],s63 offen sc1 lds
buffer_load_dwordx4 v1,s[8:11],s63 offen offset:1024 sc1 lds
buffer_load_dwordx4 v1,s[8:11],s63 offen offset:2048 sc1 lds
buffer_load_dwordx4 v1,s[8:11],s63 offen offset:3072 sc1 lds
s_add_u32 m0,s61,8192
s_add_u32 s63,s60,8192
buffer_load_dwordx4 v1,s[8:11],s63 offen sc1 lds
buffer_load_dwordx4 v1,s[8:11],s63 offen offset:1024 sc1 lds
nt_214:
s_nop 4
s_mul_i32 s74,s73,393216
s_add_u32 s74,s74,s39
s_add_u32 s74,s74,s70
v_fma_f32 v88,-v124,v120,v88
v_fma_f32 v89,-v126,v120,v89
v_fma_f32 v90,-v128,v120,v90
v_fma_f32 v91,-v130,v120,v91
v_fma_f32 v96,-v140,v120,v96
v_fma_f32 v97,-v142,v120,v97
v_fma_f32 v98,-v144,v120,v98
v_fma_f32 v99,-v146,v120,v99
v_mul_f32 v88,v88,v125
v_mul_f32 v89,v89,v127
v_mul_f32 v90,v90,v129
v_mul_f32 v91,v91,v131
v_mul_f32 v96,v96,v141
v_mul_f32 v97,v97,v143
v_mul_f32 v98,v98,v145
v_mul_f32 v99,v99,v147
v_cvt_pk_bf16_f32 v88,v88,v89
v_cvt_pk_bf16_f32 v89,v90,v91
v_cvt_pk_bf16_f32 v90,v96,v97
v_cvt_pk_bf16_f32 v91,v98,v99
buffer_store_dwordx4 v[88:91],v20,s[8:11],s74 offen sc1
v_fma_f32 v92,-v132,v120,v92
v_fma_f32 v93,-v134,v120,v93
v_fma_f32 v94,-v136,v120,v94
v_fma_f32 v95,-v138,v120,v95
v_fma_f32 v100,-v148,v120,v100
v_fma_f32 v101,-v150,v120,v101
v_fma_f32 v102,-v152,v120,v102
v_fma_f32 v103,-v154,v120,v103
v_mul_f32 v92,v92,v133
v_mul_f32 v93,v93,v135
v_mul_f32 v94,v94,v137
v_mul_f32 v95,v95,v139
v_mul_f32 v100,v100,v149
v_mul_f32 v101,v101,v151
v_mul_f32 v102,v102,v153
v_mul_f32 v103,v103,v155
v_cvt_pk_bf16_f32 v92,v92,v93
v_cvt_pk_bf16_f32 v93,v94,v95
v_cvt_pk_bf16_f32 v94,v100,v101
v_cvt_pk_bf16_f32 v95,v102,v103
buffer_store_dwordx4 v[92:95],v21,s[8:11],s74 offen sc1
v_fma_f32 v104,-v124,v121,v104
v_fma_f32 v105,-v126,v121,v105
v_fma_f32 v106,-v128,v121,v106
v_fma_f32 v107,-v130,v121,v107
v_fma_f32 v112,-v140,v121,v112
v_fma_f32 v113,-v142,v121,v113
v_fma_f32 v114,-v144,v121,v114
v_fma_f32 v115,-v146,v121,v115
v_mul_f32 v104,v104,v125
v_mul_f32 v105,v105,v127
v_mul_f32 v106,v106,v129
v_mul_f32 v107,v107,v131
v_mul_f32 v112,v112,v141
v_mul_f32 v113,v113,v143
v_mul_f32 v114,v114,v145
v_mul_f32 v115,v115,v147
v_cvt_pk_bf16_f32 v104,v104,v105
v_cvt_pk_bf16_f32 v105,v106,v107
v_cvt_pk_bf16_f32 v106,v112,v113
v_cvt_pk_bf16_f32 v107,v114,v115
buffer_store_dwordx4 v[104:107],v20,s[8:11],s74 offen offset:2048 sc1
v_fma_f32 v108,-v132,v121,v108
v_fma_f32 v109,-v134,v121,v109
v_fma_f32 v110,-v136,v121,v110
v_fma_f32 v111,-v138,v121,v111
v_fma_f32 v116,-v148,v121,v116
v_fma_f32 v117,-v150,v121,v117
v_fma_f32 v118,-v152,v121,v118
v_fma_f32 v119,-v154,v121,v119
v_mul_f32 v108,v108,v133
v_mul_f32 v109,v109,v135
v_mul_f32 v110,v110,v137
v_mul_f32 v111,v111,v139
v_mul_f32 v116,v116,v149
v_mul_f32 v117,v117,v151
v_mul_f32 v118,v118,v153
v_mul_f32 v119,v119,v155
v_cvt_pk_bf16_f32 v108,v108,v109
v_cvt_pk_bf16_f32 v109,v110,v111
v_cvt_pk_bf16_f32 v110,v116,v117
v_cvt_pk_bf16_f32 v111,v118,v119
buffer_store_dwordx4 v[108:111],v21,s[8:11],s74 offen offset:2048 sc1
s_lshl_b32 s82,s72,6
s_add_u32 s82,s82,s73
s_lshl_b32 s82,s82,9
s_add_u32 s82,s82,s71
s_lshl_b32 s75,s69,2
s_add_u32 s82,s82,s75
s_add_u32 s82,s82,s39
s_mov_b32 s59,s82
s_mov_b32 s82,2147483648
s_mov_b32 s39,2147483648
s_cmp_eq_u32 s55,0
s_cbranch_scc1 QKVV_B0
s_cmp_eq_u32 s55,1
s_cbranch_scc1 QKVV_CD0
s_waitcnt vmcnt(0)
s_mov_b64 exec,1
buffer_store_dword v5,v1,s[8:11],s59 offen sc1
s_mov_b64 exec,-1
s_mov_b32 s59,2147483648
s_cmp_eq_u32 s50,128
s_cbranch_scc1 QKVV_END
s_branch QKVV_COLD0
QKVV_COLD1:
s_cmp_lg_u32 s46,0
s_cbranch_scc1 cp_215
ct_216:
buffer_load_dword v3,v2,s[8:11],s35 offen sc1
buffer_load_dword v14,v4,s[8:11],s41 offen sc1
s_waitcnt vmcnt(0)
v_cmp_eq_u32 vcc,0,v14
s_cmp_eq_u64 vcc,0
s_cselect_b32 s36,0,2147483648
v_cmp_eq_u32 vcc,0,v3
s_cmp_lt_u32 s78,64
s_cselect_b32 s36,s36,2147483648
s_cmp_eq_u64 vcc,0
s_cselect_b32 s60,1,s36
s_cmp_lt_u32 s79,64
s_cselect_b32 s60,s60,s36
s_sub_u32 s61,s78,s79
s_or_b32 s61,s61,s36
s_cmp_lt_u32 s61,16
s_cselect_b32 s36,0,s60
v_mov_b32 v23,s36
s_cmp_lt_u32 s36,2
s_cbranch_scc1 ct_216x
s_sleep 3
s_sub_u32 s47,s47,1
s_cbranch_scc1 ABORT
s_branch ct_216
ct_216x:
ds_write_b32 v22,v23 offset:4
s_waitcnt lgkmcnt(0)
cp_215:
s_barrier
ds_read_b32 v23,v22 offset:4
s_waitcnt lgkmcnt(0)
v_readfirstlane_b32 s38,v23
s_and_b32 s38,s38,1
s_and_b32 s37,s38,2147483648
s_and_b32 s33,s38,1
s_cselect_b32 s34,s79,s78
s_lshl_b32 s60,s33,6
s_add_u32 s60,s60,s34
s_mul_i32 s60,s60,46080
s_add_u32 s60,s60,206569472
s_lshl_b32 s62,s46,10
s_add_u32 s62,s62,40960
s_add_u32 m0,s57,s62
s_add_u32 s63,s60,s62
buffer_load_dwordx4 v1,s[8:11],s63 offen sc1 lds
s_add_u32 m0,s57,45056
s_add_u32 s63,s60,45056
buffer_load_dwordx4 v1,s[8:11],s63 offen sc1 lds
s_mul_i32 s61,s46,10240
s_add_u32 s60,s60,s61
s_add_u32 s61,s61,s57
s_add_u32 m0,s61,0
s_add_u32 s63,s60,0
buffer_load_dwordx4 v1,s[8:11],s63 offen sc1 lds
buffer_load_dwordx4 v1,s[8:11],s63 offen offset:1024 sc1 lds
buffer_load_dwordx4 v1,s[8:11],s63 offen offset:2048 sc1 lds
buffer_load_dwordx4 v1,s[8:11],s63 offen offset:3072 sc1 lds
s_add_u32 m0,s61,4096
s_add_u32 s63,s60,4096
buffer_load_dwordx4 v1,s[8:11],s63 offen sc1 lds
buffer_load_dwordx4 v1,s[8:11],s63 offen offset:1024 sc1 lds
buffer_load_dwordx4 v1,s[8:11],s63 offen offset:2048 sc1 lds
buffer_load_dwordx4 v1,s[8:11],s63 offen offset:3072 sc1 lds
s_add_u32 m0,s61,8192
s_add_u32 s63,s60,8192
buffer_load_dwordx4 v1,s[8:11],s63 offen sc1 lds
buffer_load_dwordx4 v1,s[8:11],s63 offen offset:1024 sc1 lds
QKVV_CD1:
s_mov_b32 s51,s33
s_mov_b32 s52,s34
s_mov_b32 s53,s33
s_mov_b32 s54,s34
s_add_u32 s79,s79,s33
s_or_b32 s60,s37,s33
s_cmp_eq_u32 s60,0
s_addc_u32 s78,s78,0
s_lshl_b32 s41,s78,9
s_add_u32 s41,s41,s40
s_lshl_b32 s35,s79,9
s_add_u32 s35,s35,s40
s_add_u32 s35,s35,32768
buffer_load_dword v3,v2,s[8:11],s35 offen sc1
buffer_load_dword v14,v4,s[8:11],s41 offen sc1
s_waitcnt vmcnt(0)
s_mov_b64 exec,1
buffer_store_dword v5,v1,s[8:11],s59 offen sc1
s_mov_b64 exec,-1
s_mov_b32 s59,2147483648
v_cmp_eq_u32 vcc,0,v14
s_cmp_eq_u64 vcc,0
s_cselect_b32 s36,0,2147483648
v_cmp_eq_u32 vcc,0,v3
s_cmp_lt_u32 s78,64
s_cselect_b32 s36,s36,2147483648
s_cmp_eq_u64 vcc,0
s_cselect_b32 s60,1,s36
s_cmp_lt_u32 s79,64
s_cselect_b32 s60,s60,s36
s_sub_u32 s61,s78,s79
s_or_b32 s61,s61,s36
s_cmp_lt_u32 s61,16
s_cselect_b32 s36,0,s60
v_mov_b32 v23,s36
ds_write_b32 v13,v23
s_waitcnt lgkmcnt(0)
s_barrier
ds_read_b32 v23,v22
ds_read_b128 v[24:27],v18 offset:0
ds_read_b128 v[28:31],v19 offset:0
ds_read_b128 v[32:35],v18 offset:2048
ds_read_b128 v[36:39],v19 offset:2048
ds_read_b128 v[40:43],v18 offset:4096
s_waitcnt lgkmcnt(5)
v_readfirstlane_b32 s38,v23
s_and_b32 s37,s38,2147483648
s_and_b32 s33,s38,1
s_cselect_b32 s34,s79,s78
s_nop 0
s_branch QKVV_B1
QKVV_END:
s_endpgm
ROLE_ATT:
v_lshlrev_b32 v1,4,v0
v_mov_b32 v5,1
s_lshl_b32 s56,s48,2
s_add_u32 s56,s56,s46
v_bfe_u32 v6,v0,2,2
v_lshrrev_b32 v7,4,v0
v_add_u32 v7,v6,v7
v_and_b32 v7,3,v7
v_and_b32 v15,3,v0
v_lshlrev_b32 v15,4,v15
v_lshl_add_u32 v15,v7,6,v15
v_lshl_add_u32 v15,v6,8,v15
s_mov_b32 s68,s48
s_and_b32 s51,s46,1
s_lshr_b32 s86,s46,1
s_lshr_b32 s87,s68,3
s_lshl_b32 s87,s87,5
s_and_b32 s60,s68,7
s_add_u32 s87,s87,s60
v_lshlrev_b32 v229,3,v0
v_and_b32 v229,0x300,v1
v_add_u32 v229,v229,v1
v_mov_b32 v230,0xff800000
s_mov_b32 s80,-1
s_mov_b32 s81,0
s_mov_b32 s84,0x3d93cd3a
s_mov_b32 s85,0x3fb8aa3b
v_min_u32 v6,8,v0
v_mul_u32_u24 v7,86,v6
v_lshrrev_b32 v7,8,v7
v_mul_u32_u24 v8,3,v7
v_sub_u32 v6,v6,v8
s_mul_i32 s60,s68,3
v_add_u32 v6,s60,v6
v_lshlrev_b32 v2,2,v6
v_lshl_add_u32 v2,v7,16,v2
v_min_u32 v228,2,v0
v_lshlrev_b32 v228,2,v228
v_lshrrev_b32 v6,4,v0
v_lshlrev_b32 v6,2,v6
v_and_b32 v7,15,v0
v_add_u32 v8,0,v6
v_cmp_le_u32 s[72:73],v8,v7
v_add_u32 v8,1,v6
v_cmp_le_u32 s[74:75],v8,v7
v_add_u32 v8,2,v6
v_cmp_le_u32 s[76:77],v8,v7
v_add_u32 v8,3,v6
v_cmp_le_u32 s[78:79],v8,v7
s_mul_i32 s71,s68,12288
s_mul_i32 s60,s51,13
s_mul_i32 s69,s60,589824
s_mul_i32 s61,s68,18432
s_add_u32 s69,s69,s61
s_mul_i32 s61,s51,9216
s_add_u32 s69,s69,s61
s_add_u32 s69,s69,24120320
s_mul_i32 s70,s60,2048
s_lshl_b32 s61,s68,6
s_add_u32 s70,s70,s61
s_add_u32 s70,s70,688128
s_mul_i32 s69,s51,12582912
s_mul_i32 s61,s68,6144
s_add_u32 s69,s69,s61
s_add_u32 s69,s69,24117248
s_mul_i32 s70,s51,65536
s_lshl_b32 s61,s68,5
s_add_u32 s70,s70,s61
s_add_u32 s70,s70,688128
s_waitcnt vmcnt(0)
s_barrier
s_cmp_lg_u32 s46,0
s_cbranch_scc1 arr_217
v_mov_b32 v6,1
s_lshl_b32 s3,s49,2
v_mov_b32 v7,s3
s_mov_b64 exec,1
buffer_atomic_add v6,v7,s[12:15],0 offen sc1
s_mov_b64 exec,-1
arr_217:
s_mov_b32 s66,s56
s_and_b32 s53,s66,7
s_lshr_b32 s54,s66,3
v_lshrrev_b32 v6,4,v0
v_bfe_u32 v7,v0,2,2
v_and_b32 v8,3,v0
s_and_b32 s61,s53,3
s_lshl_b32 s60,s53,8
v_lshlrev_b32 v132,11,v6
v_lshrrev_b32 v9,1,v6
v_lshlrev_b32 v132,11,v9
v_and_b32 v9,1,v6
v_lshl_add_u32 v132,v9,12,v132
v_add_u32 v9,s61,v7
v_and_b32 v9,3,v9
v_lshl_add_u32 v132,v9,6,v132
v_lshl_add_u32 v132,v8,4,v132
v_add_u32 v132,s60,v132
s_lshl_b32 s60,s53,2
v_add_u32 v9,s60,v8
v_mul_u32_u24 v133,1280,v9
v_lshl_add_u32 v133,v6,5,v133
v_lshl_add_u32 v133,v7,3,v133
s_mov_b32 s4,s16
s_mov_b32 s5,s17
s_mov_b32 s6,2621440
s_mov_b32 s7,0x20000
s_mov_b32 s55,0
s_mul_i32 s62,s54,40960
buffer_load_dwordx2 v[32:33],v133,s[4:7],s62 offen offset:0
buffer_load_dwordx2 v[34:35],v133,s[4:7],s62 offen offset:128
buffer_load_dwordx2 v[36:37],v133,s[4:7],s62 offen offset:256
buffer_load_dwordx2 v[38:39],v133,s[4:7],s62 offen offset:384
buffer_load_dwordx2 v[40:41],v133,s[4:7],s62 offen offset:512
buffer_load_dwordx2 v[42:43],v133,s[4:7],s62 offen offset:640
buffer_load_dwordx2 v[44:45],v133,s[4:7],s62 offen offset:768
buffer_load_dwordx2 v[46:47],v133,s[4:7],s62 offen offset:896
buffer_load_dwordx2 v[48:49],v133,s[4:7],s62 offen offset:1024
buffer_load_dwordx2 v[50:51],v133,s[4:7],s62 offen offset:1152
s_add_u32 s66,s54,16
s_min_u32 s66,s66,63
s_mul_i32 s62,s66,40960
buffer_load_dwordx2 v[52:53],v133,s[4:7],s62 offen offset:0
buffer_load_dwordx2 v[54:55],v133,s[4:7],s62 offen offset:128
buffer_load_dwordx2 v[56:57],v133,s[4:7],s62 offen offset:256
buffer_load_dwordx2 v[58:59],v133,s[4:7],s62 offen offset:384
buffer_load_dwordx2 v[60:61],v133,s[4:7],s62 offen offset:512
buffer_load_dwordx2 v[62:63],v133,s[4:7],s62 offen offset:640
buffer_load_dwordx2 v[64:65],v133,s[4:7],s62 offen offset:768
buffer_load_dwordx2 v[66:67],v133,s[4:7],s62 offen offset:896
buffer_load_dwordx2 v[68:69],v133,s[4:7],s62 offen offset:1024
buffer_load_dwordx2 v[70:71],v133,s[4:7],s62 offen offset:1152
s_mul_i32 s64,s54,40960
s_add_u32 s64,s64,234749952
s_mul_i32 s65,s54,46080
s_add_u32 s65,s65,206569472
s_waitcnt vmcnt(10)
v_lshlrev_b32 v72,16,v32
v_and_b32 v73,0xffff0000,v32
v_lshlrev_b32 v74,16,v33
v_and_b32 v75,0xffff0000,v33
v_lshlrev_b32 v76,16,v34
v_and_b32 v77,0xffff0000,v34
v_lshlrev_b32 v78,16,v35
v_and_b32 v79,0xffff0000,v35
v_lshlrev_b32 v80,16,v36
v_and_b32 v81,0xffff0000,v36
v_lshlrev_b32 v82,16,v37
v_and_b32 v83,0xffff0000,v37
v_lshlrev_b32 v84,16,v38
v_and_b32 v85,0xffff0000,v38
v_lshlrev_b32 v86,16,v39
v_and_b32 v87,0xffff0000,v39
v_lshlrev_b32 v88,16,v40
v_and_b32 v89,0xffff0000,v40
v_lshlrev_b32 v90,16,v41
v_and_b32 v91,0xffff0000,v41
v_lshlrev_b32 v92,16,v42
v_and_b32 v93,0xffff0000,v42
v_lshlrev_b32 v94,16,v43
v_and_b32 v95,0xffff0000,v43
v_lshlrev_b32 v96,16,v44
v_and_b32 v97,0xffff0000,v44
v_lshlrev_b32 v98,16,v45
v_and_b32 v99,0xffff0000,v45
v_lshlrev_b32 v100,16,v46
v_and_b32 v101,0xffff0000,v46
v_lshlrev_b32 v102,16,v47
v_and_b32 v103,0xffff0000,v47
v_lshlrev_b32 v104,16,v48
v_and_b32 v105,0xffff0000,v48
v_lshlrev_b32 v106,16,v49
v_and_b32 v107,0xffff0000,v49
v_lshlrev_b32 v108,16,v50
v_and_b32 v109,0xffff0000,v50
v_lshlrev_b32 v110,16,v51
v_and_b32 v111,0xffff0000,v51
v_pk_add_f32 v[28:29],v[72:73],v[74:75]
v_pk_mul_f32 v[26:27],v[72:73],v[72:73]
v_pk_fma_f32 v[26:27],v[74:75],v[74:75],v[26:27]
v_pk_add_f32 v[28:29],v[28:29],v[76:77]
v_pk_fma_f32 v[26:27],v[76:77],v[76:77],v[26:27]
v_pk_add_f32 v[28:29],v[28:29],v[78:79]
v_pk_fma_f32 v[26:27],v[78:79],v[78:79],v[26:27]
v_pk_add_f32 v[28:29],v[28:29],v[80:81]
v_pk_fma_f32 v[26:27],v[80:81],v[80:81],v[26:27]
v_pk_add_f32 v[28:29],v[28:29],v[82:83]
v_pk_fma_f32 v[26:27],v[82:83],v[82:83],v[26:27]
v_pk_add_f32 v[28:29],v[28:29],v[84:85]
v_pk_fma_f32 v[26:27],v[84:85],v[84:85],v[26:27]
v_pk_add_f32 v[28:29],v[28:29],v[86:87]
v_pk_fma_f32 v[26:27],v[86:87],v[86:87],v[26:27]
v_pk_add_f32 v[28:29],v[28:29],v[88:89]
v_pk_fma_f32 v[26:27],v[88:89],v[88:89],v[26:27]
v_pk_add_f32 v[28:29],v[28:29],v[90:91]
v_pk_fma_f32 v[26:27],v[90:91],v[90:91],v[26:27]
v_pk_add_f32 v[28:29],v[28:29],v[92:93]
v_pk_fma_f32 v[26:27],v[92:93],v[92:93],v[26:27]
v_pk_add_f32 v[28:29],v[28:29],v[94:95]
v_pk_fma_f32 v[26:27],v[94:95],v[94:95],v[26:27]
v_pk_add_f32 v[28:29],v[28:29],v[96:97]
v_pk_fma_f32 v[26:27],v[96:97],v[96:97],v[26:27]
v_pk_add_f32 v[28:29],v[28:29],v[98:99]
v_pk_fma_f32 v[26:27],v[98:99],v[98:99],v[26:27]
v_pk_add_f32 v[28:29],v[28:29],v[100:101]
v_pk_fma_f32 v[26:27],v[100:101],v[100:101],v[26:27]
v_pk_add_f32 v[28:29],v[28:29],v[102:103]
v_pk_fma_f32 v[26:27],v[102:103],v[102:103],v[26:27]
v_pk_add_f32 v[28:29],v[28:29],v[104:105]
v_pk_fma_f32 v[26:27],v[104:105],v[104:105],v[26:27]
v_pk_add_f32 v[28:29],v[28:29],v[106:107]
v_pk_fma_f32 v[26:27],v[106:107],v[106:107],v[26:27]
v_pk_add_f32 v[28:29],v[28:29],v[108:109]
v_pk_fma_f32 v[26:27],v[108:109],v[108:109],v[26:27]
v_pk_add_f32 v[28:29],v[28:29],v[110:111]
v_pk_fma_f32 v[26:27],v[110:111],v[110:111],v[26:27]
v_add_f32 v24,v28,v29
v_add_f32 v25,v26,v27
s_nop 0
v_add_f32_dpp v24,v24,v24 row_ror:4 row_mask:0xf bank_mask:0xf
v_add_f32_dpp v25,v25,v25 row_ror:4 row_mask:0xf bank_mask:0xf
s_nop 0
v_add_f32_dpp v24,v24,v24 row_ror:8 row_mask:0xf bank_mask:0xf
v_add_f32_dpp v25,v25,v25 row_ror:8 row_mask:0xf bank_mask:0xf
v_mov_b32 v26,v24
v_mov_b32 v27,v25
s_nop 0
v_permlane32_swap_b32 v24,v26
v_permlane32_swap_b32 v25,v27
v_add_f32 v24,v24,v26
v_add_f32 v25,v25,v27
v_mov_b32 v26,v24
v_mov_b32 v27,v25
s_nop 0
v_permlane16_swap_b32 v24,v26
v_permlane16_swap_b32 v25,v27
v_add_f32 v24,v24,v26
v_add_f32 v25,v25,v27
v_mul_f32 v24,0x3acccccd,v24
v_mul_f32 v25,0x3acccccd,v25
v_fma_f32 v25,-v24,v24,v25
v_max_f32 v25,0,v25
v_cvt_pk_bf16_f32 v6,v24,v25
v_lshlrev_b32 v24,16,v6
v_and_b32 v25,0xffff0000,v6
v_add_f32 v25,0x3727c5ac,v25
v_cvt_pk_bf16_f32 v6,v25,v25
v_lshlrev_b32 v25,16,v6
v_sqrt_f32 v25,v25
s_nop 0
v_cvt_pk_bf16_f32 v6,v25,v25
v_lshlrev_b32 v25,16,v6
v_rcp_f32 v25,v25
s_nop 0
v_pk_add_f32 v[72:73],v[72:73],v[24:25] op_sel_hi:[1,0] neg_lo:[0,1] neg_hi:[0,1]
v_pk_add_f32 v[74:75],v[74:75],v[24:25] op_sel_hi:[1,0] neg_lo:[0,1] neg_hi:[0,1]
v_pk_add_f32 v[76:77],v[76:77],v[24:25] op_sel_hi:[1,0] neg_lo:[0,1] neg_hi:[0,1]
v_pk_add_f32 v[78:79],v[78:79],v[24:25] op_sel_hi:[1,0] neg_lo:[0,1] neg_hi:[0,1]
v_pk_add_f32 v[80:81],v[80:81],v[24:25] op_sel_hi:[1,0] neg_lo:[0,1] neg_hi:[0,1]
v_pk_add_f32 v[82:83],v[82:83],v[24:25] op_sel_hi:[1,0] neg_lo:[0,1] neg_hi:[0,1]
v_pk_add_f32 v[84:85],v[84:85],v[24:25] op_sel_hi:[1,0] neg_lo:[0,1] neg_hi:[0,1]
v_pk_add_f32 v[86:87],v[86:87],v[24:25] op_sel_hi:[1,0] neg_lo:[0,1] neg_hi:[0,1]
v_pk_add_f32 v[88:89],v[88:89],v[24:25] op_sel_hi:[1,0] neg_lo:[0,1] neg_hi:[0,1]
v_pk_add_f32 v[90:91],v[90:91],v[24:25] op_sel_hi:[1,0] neg_lo:[0,1] neg_hi:[0,1]
v_pk_add_f32 v[92:93],v[92:93],v[24:25] op_sel_hi:[1,0] neg_lo:[0,1] neg_hi:[0,1]
v_pk_add_f32 v[94:95],v[94:95],v[24:25] op_sel_hi:[1,0] neg_lo:[0,1] neg_hi:[0,1]
v_pk_add_f32 v[96:97],v[96:97],v[24:25] op_sel_hi:[1,0] neg_lo:[0,1] neg_hi:[0,1]
v_pk_add_f32 v[98:99],v[98:99],v[24:25] op_sel_hi:[1,0] neg_lo:[0,1] neg_hi:[0,1]
v_pk_add_f32 v[100:101],v[100:101],v[24:25] op_sel_hi:[1,0] neg_lo:[0,1] neg_hi:[0,1]
v_pk_add_f32 v[102:103],v[102:103],v[24:25] op_sel_hi:[1,0] neg_lo:[0,1] neg_hi:[0,1]
v_pk_add_f32 v[104:105],v[104:105],v[24:25] op_sel_hi:[1,0] neg_lo:[0,1] neg_hi:[0,1]
v_pk_add_f32 v[106:107],v[106:107],v[24:25] op_sel_hi:[1,0] neg_lo:[0,1] neg_hi:[0,1]
v_pk_add_f32 v[108:109],v[108:109],v[24:25] op_sel_hi:[1,0] neg_lo:[0,1] neg_hi:[0,1]
v_pk_add_f32 v[110:111],v[110:111],v[24:25] op_sel_hi:[1,0] neg_lo:[0,1] neg_hi:[0,1]
v_cvt_pk_bf16_f32 v6,v72,v73
v_lshlrev_b32 v72,16,v6
v_and_b32 v73,0xffff0000,v6
v_cvt_pk_bf16_f32 v8,v74,v75
v_lshlrev_b32 v74,16,v8
v_and_b32 v75,0xffff0000,v8
v_cvt_pk_bf16_f32 v6,v76,v77
v_lshlrev_b32 v76,16,v6
v_and_b32 v77,0xffff0000,v6
v_cvt_pk_bf16_f32 v8,v78,v79
v_lshlrev_b32 v78,16,v8
v_and_b32 v79,0xffff0000,v8
v_cvt_pk_bf16_f32 v6,v80,v81
v_lshlrev_b32 v80,16,v6
v_and_b32 v81,0xffff0000,v6
v_cvt_pk_bf16_f32 v8,v82,v83
v_lshlrev_b32 v82,16,v8
v_and_b32 v83,0xffff0000,v8
v_cvt_pk_bf16_f32 v6,v84,v85
v_lshlrev_b32 v84,16,v6
v_and_b32 v85,0xffff0000,v6
v_cvt_pk_bf16_f32 v8,v86,v87
v_lshlrev_b32 v86,16,v8
v_and_b32 v87,0xffff0000,v8
v_cvt_pk_bf16_f32 v6,v88,v89
v_lshlrev_b32 v88,16,v6
v_and_b32 v89,0xffff0000,v6
v_cvt_pk_bf16_f32 v8,v90,v91
v_lshlrev_b32 v90,16,v8
v_and_b32 v91,0xffff0000,v8
v_cvt_pk_bf16_f32 v6,v92,v93
v_lshlrev_b32 v92,16,v6
v_and_b32 v93,0xffff0000,v6
v_cvt_pk_bf16_f32 v8,v94,v95
v_lshlrev_b32 v94,16,v8
v_and_b32 v95,0xffff0000,v8
v_cvt_pk_bf16_f32 v6,v96,v97
v_lshlrev_b32 v96,16,v6
v_and_b32 v97,0xffff0000,v6
v_cvt_pk_bf16_f32 v8,v98,v99
v_lshlrev_b32 v98,16,v8
v_and_b32 v99,0xffff0000,v8
v_cvt_pk_bf16_f32 v6,v100,v101
v_lshlrev_b32 v100,16,v6
v_and_b32 v101,0xffff0000,v6
v_cvt_pk_bf16_f32 v8,v102,v103
v_lshlrev_b32 v102,16,v8
v_and_b32 v103,0xffff0000,v8
v_cvt_pk_bf16_f32 v6,v104,v105
v_lshlrev_b32 v104,16,v6
v_and_b32 v105,0xffff0000,v6
v_cvt_pk_bf16_f32 v8,v106,v107
v_lshlrev_b32 v106,16,v8
v_and_b32 v107,0xffff0000,v8
v_cvt_pk_bf16_f32 v6,v108,v109
v_lshlrev_b32 v108,16,v6
v_and_b32 v109,0xffff0000,v6
v_cvt_pk_bf16_f32 v8,v110,v111
v_lshlrev_b32 v110,16,v8
v_and_b32 v111,0xffff0000,v8
v_pk_mul_f32 v[72:73],v[72:73],v[24:25] op_sel:[0,1] op_sel_hi:[1,1]
v_pk_mul_f32 v[74:75],v[74:75],v[24:25] op_sel:[0,1] op_sel_hi:[1,1]
v_pk_mul_f32 v[76:77],v[76:77],v[24:25] op_sel:[0,1] op_sel_hi:[1,1]
v_pk_mul_f32 v[78:79],v[78:79],v[24:25] op_sel:[0,1] op_sel_hi:[1,1]
v_pk_mul_f32 v[80:81],v[80:81],v[24:25] op_sel:[0,1] op_sel_hi:[1,1]
v_pk_mul_f32 v[82:83],v[82:83],v[24:25] op_sel:[0,1] op_sel_hi:[1,1]
v_pk_mul_f32 v[84:85],v[84:85],v[24:25] op_sel:[0,1] op_sel_hi:[1,1]
v_pk_mul_f32 v[86:87],v[86:87],v[24:25] op_sel:[0,1] op_sel_hi:[1,1]
v_pk_mul_f32 v[88:89],v[88:89],v[24:25] op_sel:[0,1] op_sel_hi:[1,1]
v_pk_mul_f32 v[90:91],v[90:91],v[24:25] op_sel:[0,1] op_sel_hi:[1,1]
v_pk_mul_f32 v[92:93],v[92:93],v[24:25] op_sel:[0,1] op_sel_hi:[1,1]
v_pk_mul_f32 v[94:95],v[94:95],v[24:25] op_sel:[0,1] op_sel_hi:[1,1]
v_pk_mul_f32 v[96:97],v[96:97],v[24:25] op_sel:[0,1] op_sel_hi:[1,1]
v_pk_mul_f32 v[98:99],v[98:99],v[24:25] op_sel:[0,1] op_sel_hi:[1,1]
v_pk_mul_f32 v[100:101],v[100:101],v[24:25] op_sel:[0,1] op_sel_hi:[1,1]
v_pk_mul_f32 v[102:103],v[102:103],v[24:25] op_sel:[0,1] op_sel_hi:[1,1]
v_pk_mul_f32 v[104:105],v[104:105],v[24:25] op_sel:[0,1] op_sel_hi:[1,1]
v_pk_mul_f32 v[106:107],v[106:107],v[24:25] op_sel:[0,1] op_sel_hi:[1,1]
v_pk_mul_f32 v[108:109],v[108:109],v[24:25] op_sel:[0,1] op_sel_hi:[1,1]
v_pk_mul_f32 v[110:111],v[110:111],v[24:25] op_sel:[0,1] op_sel_hi:[1,1]
v_cvt_pk_bf16_f32 v112,v72,v73
v_lshlrev_b32 v72,16,v112
v_and_b32 v73,0xffff0000,v112
v_cvt_pk_bf16_f32 v113,v74,v75
v_lshlrev_b32 v74,16,v113
v_and_b32 v75,0xffff0000,v113
v_cvt_pk_bf16_f32 v114,v76,v77
v_lshlrev_b32 v76,16,v114
v_and_b32 v77,0xffff0000,v114
v_cvt_pk_bf16_f32 v115,v78,v79
v_lshlrev_b32 v78,16,v115
v_and_b32 v79,0xffff0000,v115
v_cvt_pk_bf16_f32 v116,v80,v81
v_lshlrev_b32 v80,16,v116
v_and_b32 v81,0xffff0000,v116
v_cvt_pk_bf16_f32 v117,v82,v83
v_lshlrev_b32 v82,16,v117
v_and_b32 v83,0xffff0000,v117
v_cvt_pk_bf16_f32 v118,v84,v85
v_lshlrev_b32 v84,16,v118
v_and_b32 v85,0xffff0000,v118
v_cvt_pk_bf16_f32 v119,v86,v87
v_lshlrev_b32 v86,16,v119
v_and_b32 v87,0xffff0000,v119
v_cvt_pk_bf16_f32 v120,v88,v89
v_lshlrev_b32 v88,16,v120
v_and_b32 v89,0xffff0000,v120
v_cvt_pk_bf16_f32 v121,v90,v91
v_lshlrev_b32 v90,16,v121
v_and_b32 v91,0xffff0000,v121
v_cvt_pk_bf16_f32 v122,v92,v93
v_lshlrev_b32 v92,16,v122
v_and_b32 v93,0xffff0000,v122
v_cvt_pk_bf16_f32 v123,v94,v95
v_lshlrev_b32 v94,16,v123
v_and_b32 v95,0xffff0000,v123
v_cvt_pk_bf16_f32 v124,v96,v97
v_lshlrev_b32 v96,16,v124
v_and_b32 v97,0xffff0000,v124
v_cvt_pk_bf16_f32 v125,v98,v99
v_lshlrev_b32 v98,16,v125
v_and_b32 v99,0xffff0000,v125
v_cvt_pk_bf16_f32 v126,v100,v101
v_lshlrev_b32 v100,16,v126
v_and_b32 v101,0xffff0000,v126
v_cvt_pk_bf16_f32 v127,v102,v103
v_lshlrev_b32 v102,16,v127
v_and_b32 v103,0xffff0000,v127
v_cvt_pk_bf16_f32 v128,v104,v105
v_lshlrev_b32 v104,16,v128
v_and_b32 v105,0xffff0000,v128
v_cvt_pk_bf16_f32 v129,v106,v107
v_lshlrev_b32 v106,16,v129
v_and_b32 v107,0xffff0000,v129
v_cvt_pk_bf16_f32 v130,v108,v109
v_lshlrev_b32 v108,16,v130
v_and_b32 v109,0xffff0000,v130
v_cvt_pk_bf16_f32 v131,v110,v111
v_lshlrev_b32 v110,16,v131
v_and_b32 v111,0xffff0000,v131
s_add_u32 s63,s65,0
v_permlane16_swap_b32 v112,v114
v_permlane16_swap_b32 v113,v115
buffer_store_dwordx4 v[112:115],v132,s[8:11],s63 offen sc1
s_add_u32 s63,s65,8192
v_permlane16_swap_b32 v116,v118
v_permlane16_swap_b32 v117,v119
buffer_store_dwordx4 v[116:119],v132,s[8:11],s63 offen sc1
s_add_u32 s63,s65,16384
v_permlane16_swap_b32 v120,v122
v_permlane16_swap_b32 v121,v123
buffer_store_dwordx4 v[120:123],v132,s[8:11],s63 offen sc1
s_add_u32 s63,s65,24576
v_permlane16_swap_b32 v124,v126
v_permlane16_swap_b32 v125,v127
buffer_store_dwordx4 v[124:127],v132,s[8:11],s63 offen sc1
s_add_u32 s63,s65,32768
v_permlane16_swap_b32 v128,v130
v_permlane16_swap_b32 v129,v131
buffer_store_dwordx4 v[128:131],v132,s[8:11],s63 offen sc1
s_add_u32 s63,s64,0
v_permlane16_swap_b32 v32,v34
v_permlane16_swap_b32 v33,v35
buffer_store_dwordx4 v[32:35],v132,s[8:11],s63 offen sc1
s_add_u32 s63,s64,8192
v_permlane16_swap_b32 v36,v38
v_permlane16_swap_b32 v37,v39
buffer_store_dwordx4 v[36:39],v132,s[8:11],s63 offen sc1
s_add_u32 s63,s64,16384
v_permlane16_swap_b32 v40,v42
v_permlane16_swap_b32 v41,v43
buffer_store_dwordx4 v[40:43],v132,s[8:11],s63 offen sc1
s_add_u32 s63,s64,24576
v_permlane16_swap_b32 v44,v46
v_permlane16_swap_b32 v45,v47
buffer_store_dwordx4 v[44:47],v132,s[8:11],s63 offen sc1
s_add_u32 s63,s64,32768
v_permlane16_swap_b32 v48,v50
v_permlane16_swap_b32 v49,v51
buffer_store_dwordx4 v[48:51],v132,s[8:11],s63 offen sc1
s_lshl_b32 s82,s55,6
s_add_u32 s82,s82,s54
s_lshl_b32 s82,s82,9
s_add_u32 s82,s82,0
s_lshl_b32 s61,s53,2
s_add_u32 s82,s82,s61
s_add_u32 s54,s54,16
s_lshl_b32 s3,s49,2
v_mov_b32 v7,s3
s_nop 1
ibw_218:
buffer_load_dword v6,v7,s[12:15],0 offen sc1
s_waitcnt vmcnt(0)
v_cmp_ne_u32 vcc,256,v6
s_nop 0
s_cbranch_vccz ok_219
s_sleep 8
s_sub_u32 s47,s47,1
s_cbranch_scc1 ABORT
s_branch ibw_218
ok_219:
s_cmp_lg_u32 s49,0
s_cbranch_scc1 ibok_220
v_and_b32 v7,7,v0
v_lshlrev_b32 v7,2,v7
buffer_load_dword v6,v7,s[12:15],0 offen offset:32 sc1
s_waitcnt vmcnt(0)
v_cmp_ne_u32 vcc,32,v6
s_nop 0
s_cbranch_vccz ibok_220
s_barrier
s_mov_b32 s49,1
s_mov_b32 s3,s2
s_load_dwordx16 s[16:31],s[0:1],0
s_load_dwordx8 s[32:39],s[0:1],64
s_waitcnt lgkmcnt(0)
s_branch DISPATCH
ibok_220:
s_mov_b64 exec,1
buffer_store_dword v5,v1,s[8:11],s82 offen sc1
s_mov_b64 exec,-1
s_add_u32 s66,s54,16
s_min_u32 s66,s66,63
s_mul_i32 s62,s66,40960
buffer_load_dwordx2 v[32:33],v133,s[4:7],s62 offen offset:0
buffer_load_dwordx2 v[34:35],v133,s[4:7],s62 offen offset:128
buffer_load_dwordx2 v[36:37],v133,s[4:7],s62 offen offset:256
buffer_load_dwordx2 v[38:39],v133,s[4:7],s62 offen offset:384
buffer_load_dwordx2 v[40:41],v133,s[4:7],s62 offen offset:512
buffer_load_dwordx2 v[42:43],v133,s[4:7],s62 offen offset:640
buffer_load_dwordx2 v[44:45],v133,s[4:7],s62 offen offset:768
buffer_load_dwordx2 v[46:47],v133,s[4:7],s62 offen offset:896
buffer_load_dwordx2 v[48:49],v133,s[4:7],s62 offen offset:1024
buffer_load_dwordx2 v[50:51],v133,s[4:7],s62 offen offset:1152
s_mul_i32 s64,s54,40960
s_add_u32 s64,s64,234749952
s_mul_i32 s65,s54,46080
s_add_u32 s65,s65,206569472
s_waitcnt vmcnt(10)
v_lshlrev_b32 v72,16,v52
v_and_b32 v73,0xffff0000,v52
v_lshlrev_b32 v74,16,v53
v_and_b32 v75,0xffff0000,v53
v_lshlrev_b32 v76,16,v54
v_and_b32 v77,0xffff0000,v54
v_lshlrev_b32 v78,16,v55
v_and_b32 v79,0xffff0000,v55
v_lshlrev_b32 v80,16,v56
v_and_b32 v81,0xffff0000,v56
v_lshlrev_b32 v82,16,v57
v_and_b32 v83,0xffff0000,v57
v_lshlrev_b32 v84,16,v58
v_and_b32 v85,0xffff0000,v58
v_lshlrev_b32 v86,16,v59
v_and_b32 v87,0xffff0000,v59
v_lshlrev_b32 v88,16,v60
v_and_b32 v89,0xffff0000,v60
v_lshlrev_b32 v90,16,v61
v_and_b32 v91,0xffff0000,v61
v_lshlrev_b32 v92,16,v62
v_and_b32 v93,0xffff0000,v62
v_lshlrev_b32 v94,16,v63
v_and_b32 v95,0xffff0000,v63
v_lshlrev_b32 v96,16,v64
v_and_b32 v97,0xffff0000,v64
v_lshlrev_b32 v98,16,v65
v_and_b32 v99,0xffff0000,v65
v_lshlrev_b32 v100,16,v66
v_and_b32 v101,0xffff0000,v66
v_lshlrev_b32 v102,16,v67
v_and_b32 v103,0xffff0000,v67
v_lshlrev_b32 v104,16,v68
v_and_b32 v105,0xffff0000,v68
v_lshlrev_b32 v106,16,v69
v_and_b32 v107,0xffff0000,v69
v_lshlrev_b32 v108,16,v70
v_and_b32 v109,0xffff0000,v70
v_lshlrev_b32 v110,16,v71
v_and_b32 v111,0xffff0000,v71
v_pk_add_f32 v[28:29],v[72:73],v[74:75]
v_pk_mul_f32 v[26:27],v[72:73],v[72:73]
v_pk_fma_f32 v[26:27],v[74:75],v[74:75],v[26:27]
v_pk_add_f32 v[28:29],v[28:29],v[76:77]
v_pk_fma_f32 v[26:27],v[76:77],v[76:77],v[26:27]
v_pk_add_f32 v[28:29],v[28:29],v[78:79]
v_pk_fma_f32 v[26:27],v[78:79],v[78:79],v[26:27]
v_pk_add_f32 v[28:29],v[28:29],v[80:81]
v_pk_fma_f32 v[26:27],v[80:81],v[80:81],v[26:27]
v_pk_add_f32 v[28:29],v[28:29],v[82:83]
v_pk_fma_f32 v[26:27],v[82:83],v[82:83],v[26:27]
v_pk_add_f32 v[28:29],v[28:29],v[84:85]
v_pk_fma_f32 v[26:27],v[84:85],v[84:85],v[26:27]
v_pk_add_f32 v[28:29],v[28:29],v[86:87]
v_pk_fma_f32 v[26:27],v[86:87],v[86:87],v[26:27]
v_pk_add_f32 v[28:29],v[28:29],v[88:89]
v_pk_fma_f32 v[26:27],v[88:89],v[88:89],v[26:27]
v_pk_add_f32 v[28:29],v[28:29],v[90:91]
v_pk_fma_f32 v[26:27],v[90:91],v[90:91],v[26:27]
v_pk_add_f32 v[28:29],v[28:29],v[92:93]
v_pk_fma_f32 v[26:27],v[92:93],v[92:93],v[26:27]
v_pk_add_f32 v[28:29],v[28:29],v[94:95]
v_pk_fma_f32 v[26:27],v[94:95],v[94:95],v[26:27]
v_pk_add_f32 v[28:29],v[28:29],v[96:97]
v_pk_fma_f32 v[26:27],v[96:97],v[96:97],v[26:27]
v_pk_add_f32 v[28:29],v[28:29],v[98:99]
v_pk_fma_f32 v[26:27],v[98:99],v[98:99],v[26:27]
v_pk_add_f32 v[28:29],v[28:29],v[100:101]
v_pk_fma_f32 v[26:27],v[100:101],v[100:101],v[26:27]
v_pk_add_f32 v[28:29],v[28:29],v[102:103]
v_pk_fma_f32 v[26:27],v[102:103],v[102:103],v[26:27]
v_pk_add_f32 v[28:29],v[28:29],v[104:105]
v_pk_fma_f32 v[26:27],v[104:105],v[104:105],v[26:27]
v_pk_add_f32 v[28:29],v[28:29],v[106:107]
v_pk_fma_f32 v[26:27],v[106:107],v[106:107],v[26:27]
v_pk_add_f32 v[28:29],v[28:29],v[108:109]
v_pk_fma_f32 v[26:27],v[108:109],v[108:109],v[26:27]
v_pk_add_f32 v[28:29],v[28:29],v[110:111]
v_pk_fma_f32 v[26:27],v[110:111],v[110:111],v[26:27]
v_add_f32 v24,v28,v29
v_add_f32 v25,v26,v27
s_nop 0
v_add_f32_dpp v24,v24,v24 row_ror:4 row_mask:0xf bank_mask:0xf
v_add_f32_dpp v25,v25,v25 row_ror:4 row_mask:0xf bank_mask:0xf
s_nop 0
v_add_f32_dpp v24,v24,v24 row_ror:8 row_mask:0xf bank_mask:0xf
v_add_f32_dpp v25,v25,v25 row_ror:8 row_mask:0xf bank_mask:0xf
v_mov_b32 v26,v24
v_mov_b32 v27,v25
s_nop 0
v_permlane32_swap_b32 v24,v26
v_permlane32_swap_b32 v25,v27
v_add_f32 v24,v24,v26
v_add_f32 v25,v25,v27
v_mov_b32 v26,v24
v_mov_b32 v27,v25
s_nop 0
v_permlane16_swap_b32 v24,v26
v_permlane16_swap_b32 v25,v27
v_add_f32 v24,v24,v26
v_add_f32 v25,v25,v27
v_mul_f32 v24,0x3acccccd,v24
v_mul_f32 v25,0x3acccccd,v25
v_fma_f32 v25,-v24,v24,v25
v_max_f32 v25,0,v25
v_cvt_pk_bf16_f32 v6,v24,v25
v_lshlrev_b32 v24,16,v6
v_and_b32 v25,0xffff0000,v6
v_add_f32 v25,0x3727c5ac,v25
v_cvt_pk_bf16_f32 v6,v25,v25
v_lshlrev_b32 v25,16,v6
v_sqrt_f32 v25,v25
s_nop 0
v_cvt_pk_bf16_f32 v6,v25,v25
v_lshlrev_b32 v25,16,v6
v_rcp_f32 v25,v25
s_nop 0
v_pk_add_f32 v[72:73],v[72:73],v[24:25] op_sel_hi:[1,0] neg_lo:[0,1] neg_hi:[0,1]
v_pk_add_f32 v[74:75],v[74:75],v[24:25] op_sel_hi:[1,0] neg_lo:[0,1] neg_hi:[0,1]
v_pk_add_f32 v[76:77],v[76:77],v[24:25] op_sel_hi:[1,0] neg_lo:[0,1] neg_hi:[0,1]
v_pk_add_f32 v[78:79],v[78:79],v[24:25] op_sel_hi:[1,0] neg_lo:[0,1] neg_hi:[0,1]
v_pk_add_f32 v[80:81],v[80:81],v[24:25] op_sel_hi:[1,0] neg_lo:[0,1] neg_hi:[0,1]
v_pk_add_f32 v[82:83],v[82:83],v[24:25] op_sel_hi:[1,0] neg_lo:[0,1] neg_hi:[0,1]
v_pk_add_f32 v[84:85],v[84:85],v[24:25] op_sel_hi:[1,0] neg_lo:[0,1] neg_hi:[0,1]
v_pk_add_f32 v[86:87],v[86:87],v[24:25] op_sel_hi:[1,0] neg_lo:[0,1] neg_hi:[0,1]
v_pk_add_f32 v[88:89],v[88:89],v[24:25] op_sel_hi:[1,0] neg_lo:[0,1] neg_hi:[0,1]
v_pk_add_f32 v[90:91],v[90:91],v[24:25] op_sel_hi:[1,0] neg_lo:[0,1] neg_hi:[0,1]
v_pk_add_f32 v[92:93],v[92:93],v[24:25] op_sel_hi:[1,0] neg_lo:[0,1] neg_hi:[0,1]
v_pk_add_f32 v[94:95],v[94:95],v[24:25] op_sel_hi:[1,0] neg_lo:[0,1] neg_hi:[0,1]
v_pk_add_f32 v[96:97],v[96:97],v[24:25] op_sel_hi:[1,0] neg_lo:[0,1] neg_hi:[0,1]
v_pk_add_f32 v[98:99],v[98:99],v[24:25] op_sel_hi:[1,0] neg_lo:[0,1] neg_hi:[0,1]
v_pk_add_f32 v[100:101],v[100:101],v[24:25] op_sel_hi:[1,0] neg_lo:[0,1] neg_hi:[0,1]
v_pk_add_f32 v[102:103],v[102:103],v[24:25] op_sel_hi:[1,0] neg_lo:[0,1] neg_hi:[0,1]
v_pk_add_f32 v[104:105],v[104:105],v[24:25] op_sel_hi:[1,0] neg_lo:[0,1] neg_hi:[0,1]
v_pk_add_f32 v[106:107],v[106:107],v[24:25] op_sel_hi:[1,0] neg_lo:[0,1] neg_hi:[0,1]
v_pk_add_f32 v[108:109],v[108:109],v[24:25] op_sel_hi:[1,0] neg_lo:[0,1] neg_hi:[0,1]
v_pk_add_f32 v[110:111],v[110:111],v[24:25] op_sel_hi:[1,0] neg_lo:[0,1] neg_hi:[0,1]
v_cvt_pk_bf16_f32 v6,v72,v73
v_lshlrev_b32 v72,16,v6
v_and_b32 v73,0xffff0000,v6
v_cvt_pk_bf16_f32 v8,v74,v75
v_lshlrev_b32 v74,16,v8
v_and_b32 v75,0xffff0000,v8
v_cvt_pk_bf16_f32 v6,v76,v77
v_lshlrev_b32 v76,16,v6
v_and_b32 v77,0xffff0000,v6
v_cvt_pk_bf16_f32 v8,v78,v79
v_lshlrev_b32 v78,16,v8
v_and_b32 v79,0xffff0000,v8
v_cvt_pk_bf16_f32 v6,v80,v81
v_lshlrev_b32 v80,16,v6
v_and_b32 v81,0xffff0000,v6
v_cvt_pk_bf16_f32 v8,v82,v83
v_lshlrev_b32 v82,16,v8
v_and_b32 v83,0xffff0000,v8
v_cvt_pk_bf16_f32 v6,v84,v85
v_lshlrev_b32 v84,16,v6
v_and_b32 v85,0xffff0000,v6
v_cvt_pk_bf16_f32 v8,v86,v87
v_lshlrev_b32 v86,16,v8
v_and_b32 v87,0xffff0000,v8
v_cvt_pk_bf16_f32 v6,v88,v89
v_lshlrev_b32 v88,16,v6
v_and_b32 v89,0xffff0000,v6
v_cvt_pk_bf16_f32 v8,v90,v91
v_lshlrev_b32 v90,16,v8
v_and_b32 v91,0xffff0000,v8
v_cvt_pk_bf16_f32 v6,v92,v93
v_lshlrev_b32 v92,16,v6
v_and_b32 v93,0xffff0000,v6
v_cvt_pk_bf16_f32 v8,v94,v95
v_lshlrev_b32 v94,16,v8
v_and_b32 v95,0xffff0000,v8
v_cvt_pk_bf16_f32 v6,v96,v97
v_lshlrev_b32 v96,16,v6
v_and_b32 v97,0xffff0000,v6
v_cvt_pk_bf16_f32 v8,v98,v99
v_lshlrev_b32 v98,16,v8
v_and_b32 v99,0xffff0000,v8
v_cvt_pk_bf16_f32 v6,v100,v101
v_lshlrev_b32 v100,16,v6
v_and_b32 v101,0xffff0000,v6
v_cvt_pk_bf16_f32 v8,v102,v103
v_lshlrev_b32 v102,16,v8
v_and_b32 v103,0xffff0000,v8
v_cvt_pk_bf16_f32 v6,v104,v105
v_lshlrev_b32 v104,16,v6
v_and_b32 v105,0xffff0000,v6
v_cvt_pk_bf16_f32 v8,v106,v107
v_lshlrev_b32 v106,16,v8
v_and_b32 v107,0xffff0000,v8
v_cvt_pk_bf16_f32 v6,v108,v109
v_lshlrev_b32 v108,16,v6
v_and_b32 v109,0xffff0000,v6
v_cvt_pk_bf16_f32 v8,v110,v111
v_lshlrev_b32 v110,16,v8
v_and_b32 v111,0xffff0000,v8
v_pk_mul_f32 v[72:73],v[72:73],v[24:25] op_sel:[0,1] op_sel_hi:[1,1]
v_pk_mul_f32 v[74:75],v[74:75],v[24:25] op_sel:[0,1] op_sel_hi:[1,1]
v_pk_mul_f32 v[76:77],v[76:77],v[24:25] op_sel:[0,1] op_sel_hi:[1,1]
v_pk_mul_f32 v[78:79],v[78:79],v[24:25] op_sel:[0,1] op_sel_hi:[1,1]
v_pk_mul_f32 v[80:81],v[80:81],v[24:25] op_sel:[0,1] op_sel_hi:[1,1]
v_pk_mul_f32 v[82:83],v[82:83],v[24:25] op_sel:[0,1] op_sel_hi:[1,1]
v_pk_mul_f32 v[84:85],v[84:85],v[24:25] op_sel:[0,1] op_sel_hi:[1,1]
v_pk_mul_f32 v[86:87],v[86:87],v[24:25] op_sel:[0,1] op_sel_hi:[1,1]
v_pk_mul_f32 v[88:89],v[88:89],v[24:25] op_sel:[0,1] op_sel_hi:[1,1]
v_pk_mul_f32 v[90:91],v[90:91],v[24:25] op_sel:[0,1] op_sel_hi:[1,1]
v_pk_mul_f32 v[92:93],v[92:93],v[24:25] op_sel:[0,1] op_sel_hi:[1,1]
v_pk_mul_f32 v[94:95],v[94:95],v[24:25] op_sel:[0,1] op_sel_hi:[1,1]
v_pk_mul_f32 v[96:97],v[96:97],v[24:25] op_sel:[0,1] op_sel_hi:[1,1]
v_pk_mul_f32 v[98:99],v[98:99],v[24:25] op_sel:[0,1] op_sel_hi:[1,1]
v_pk_mul_f32 v[100:101],v[100:101],v[24:25] op_sel:[0,1] op_sel_hi:[1,1]
v_pk_mul_f32 v[102:103],v[102:103],v[24:25] op_sel:[0,1] op_sel_hi:[1,1]
v_pk_mul_f32 v[104:105],v[104:105],v[24:25] op_sel:[0,1] op_sel_hi:[1,1]
v_pk_mul_f32 v[106:107],v[106:107],v[24:25] op_sel:[0,1] op_sel_hi:[1,1]
v_pk_mul_f32 v[108:109],v[108:109],v[24:25] op_sel:[0,1] op_sel_hi:[1,1]
v_pk_mul_f32 v[110:111],v[110:111],v[24:25] op_sel:[0,1] op_sel_hi:[1,1]
v_cvt_pk_bf16_f32 v112,v72,v73
v_lshlrev_b32 v72,16,v112
v_and_b32 v73,0xffff0000,v112
v_cvt_pk_bf16_f32 v113,v74,v75
v_lshlrev_b32 v74,16,v113
v_and_b32 v75,0xffff0000,v113
v_cvt_pk_bf16_f32 v114,v76,v77
v_lshlrev_b32 v76,16,v114
v_and_b32 v77,0xffff0000,v114
v_cvt_pk_bf16_f32 v115,v78,v79
v_lshlrev_b32 v78,16,v115
v_and_b32 v79,0xffff0000,v115
v_cvt_pk_bf16_f32 v116,v80,v81
v_lshlrev_b32 v80,16,v116
v_and_b32 v81,0xffff0000,v116
v_cvt_pk_bf16_f32 v117,v82,v83
v_lshlrev_b32 v82,16,v117
v_and_b32 v83,0xffff0000,v117
v_cvt_pk_bf16_f32 v118,v84,v85
v_lshlrev_b32 v84,16,v118
v_and_b32 v85,0xffff0000,v118
v_cvt_pk_bf16_f32 v119,v86,v87
v_lshlrev_b32 v86,16,v119
v_and_b32 v87,0xffff0000,v119
v_cvt_pk_bf16_f32 v120,v88,v89
v_lshlrev_b32 v88,16,v120
v_and_b32 v89,0xffff0000,v120
v_cvt_pk_bf16_f32 v121,v90,v91
v_lshlrev_b32 v90,16,v121
v_and_b32 v91,0xffff0000,v121
v_cvt_pk_bf16_f32 v122,v92,v93
v_lshlrev_b32 v92,16,v122
v_and_b32 v93,0xffff0000,v122
v_cvt_pk_bf16_f32 v123,v94,v95
v_lshlrev_b32 v94,16,v123
v_and_b32 v95,0xffff0000,v123
v_cvt_pk_bf16_f32 v124,v96,v97
v_lshlrev_b32 v96,16,v124
v_and_b32 v97,0xffff0000,v124
v_cvt_pk_bf16_f32 v125,v98,v99
v_lshlrev_b32 v98,16,v125
v_and_b32 v99,0xffff0000,v125
v_cvt_pk_bf16_f32 v126,v100,v101
v_lshlrev_b32 v100,16,v126
v_and_b32 v101,0xffff0000,v126
v_cvt_pk_bf16_f32 v127,v102,v103
v_lshlrev_b32 v102,16,v127
v_and_b32 v103,0xffff0000,v127
v_cvt_pk_bf16_f32 v128,v104,v105
v_lshlrev_b32 v104,16,v128
v_and_b32 v105,0xffff0000,v128
v_cvt_pk_bf16_f32 v129,v106,v107
v_lshlrev_b32 v106,16,v129
v_and_b32 v107,0xffff0000,v129
v_cvt_pk_bf16_f32 v130,v108,v109
v_lshlrev_b32 v108,16,v130
v_and_b32 v109,0xffff0000,v130
v_cvt_pk_bf16_f32 v131,v110,v111
v_lshlrev_b32 v110,16,v131
v_and_b32 v111,0xffff0000,v131
s_add_u32 s63,s65,0
v_permlane16_swap_b32 v112,v114
v_permlane16_swap_b32 v113,v115
buffer_store_dwordx4 v[112:115],v132,s[8:11],s63 offen sc1
s_add_u32 s63,s65,8192
v_permlane16_swap_b32 v116,v118
v_permlane16_swap_b32 v117,v119
buffer_store_dwordx4 v[116:119],v132,s[8:11],s63 offen sc1
s_add_u32 s63,s65,16384
v_permlane16_swap_b32 v120,v122
v_permlane16_swap_b32 v121,v123
buffer_store_dwordx4 v[120:123],v132,s[8:11],s63 offen sc1
s_add_u32 s63,s65,24576
v_permlane16_swap_b32 v124,v126
v_permlane16_swap_b32 v125,v127
buffer_store_dwordx4 v[124:127],v132,s[8:11],s63 offen sc1
s_add_u32 s63,s65,32768
v_permlane16_swap_b32 v128,v130
v_permlane16_swap_b32 v129,v131
buffer_store_dwordx4 v[128:131],v132,s[8:11],s63 offen sc1
s_add_u32 s63,s64,0
v_permlane16_swap_b32 v52,v54
v_permlane16_swap_b32 v53,v55
buffer_store_dwordx4 v[52:55],v132,s[8:11],s63 offen sc1
s_add_u32 s63,s64,8192
v_permlane16_swap_b32 v56,v58
v_permlane16_swap_b32 v57,v59
buffer_store_dwordx4 v[56:59],v132,s[8:11],s63 offen sc1
s_add_u32 s63,s64,16384
v_permlane16_swap_b32 v60,v62
v_permlane16_swap_b32 v61,v63
buffer_store_dwordx4 v[60:63],v132,s[8:11],s63 offen sc1
s_add_u32 s63,s64,24576
v_permlane16_swap_b32 v64,v66
v_permlane16_swap_b32 v65,v67
buffer_store_dwordx4 v[64:67],v132,s[8:11],s63 offen sc1
s_add_u32 s63,s64,32768
v_permlane16_swap_b32 v68,v70
v_permlane16_swap_b32 v69,v71
buffer_store_dwordx4 v[68:71],v132,s[8:11],s63 offen sc1
s_lshl_b32 s82,s55,6
s_add_u32 s82,s82,s54
s_lshl_b32 s82,s82,9
s_add_u32 s82,s82,0
s_lshl_b32 s61,s53,2
s_add_u32 s82,s82,s61
s_add_u32 s54,s54,16
R0_LOOPA:
s_add_u32 s66,s54,16
s_min_u32 s66,s66,63
s_mul_i32 s62,s66,40960
buffer_load_dwordx2 v[52:53],v133,s[4:7],s62 offen offset:0
buffer_load_dwordx2 v[54:55],v133,s[4:7],s62 offen offset:128
buffer_load_dwordx2 v[56:57],v133,s[4:7],s62 offen offset:256
buffer_load_dwordx2 v[58:59],v133,s[4:7],s62 offen offset:384
buffer_load_dwordx2 v[60:61],v133,s[4:7],s62 offen offset:512
buffer_load_dwordx2 v[62:63],v133,s[4:7],s62 offen offset:640
buffer_load_dwordx2 v[64:65],v133,s[4:7],s62 offen offset:768
buffer_load_dwordx2 v[66:67],v133,s[4:7],s62 offen offset:896
buffer_load_dwordx2 v[68:69],v133,s[4:7],s62 offen offset:1024
buffer_load_dwordx2 v[70:71],v133,s[4:7],s62 offen offset:1152
s_mul_i32 s64,s54,40960
s_add_u32 s64,s64,234749952
s_mul_i32 s65,s54,46080
s_add_u32 s65,s65,206569472
s_waitcnt vmcnt(10)
s_mov_b64 exec,1
buffer_store_dword v5,v1,s[8:11],s82 offen sc1
s_mov_b64 exec,-1
v_lshlrev_b32 v72,16,v32
v_and_b32 v73,0xffff0000,v32
v_lshlrev_b32 v74,16,v33
v_and_b32 v75,0xffff0000,v33
v_lshlrev_b32 v76,16,v34
v_and_b32 v77,0xffff0000,v34
v_lshlrev_b32 v78,16,v35
v_and_b32 v79,0xffff0000,v35
v_lshlrev_b32 v80,16,v36
v_and_b32 v81,0xffff0000,v36
v_lshlrev_b32 v82,16,v37
v_and_b32 v83,0xffff0000,v37
v_lshlrev_b32 v84,16,v38
v_and_b32 v85,0xffff0000,v38
v_lshlrev_b32 v86,16,v39
v_and_b32 v87,0xffff0000,v39
v_lshlrev_b32 v88,16,v40
v_and_b32 v89,0xffff0000,v40
v_lshlrev_b32 v90,16,v41
v_and_b32 v91,0xffff0000,v41
v_lshlrev_b32 v92,16,v42
v_and_b32 v93,0xffff0000,v42
v_lshlrev_b32 v94,16,v43
v_and_b32 v95,0xffff0000,v43
v_lshlrev_b32 v96,16,v44
v_and_b32 v97,0xffff0000,v44
v_lshlrev_b32 v98,16,v45
v_and_b32 v99,0xffff0000,v45
v_lshlrev_b32 v100,16,v46
v_and_b32 v101,0xffff0000,v46
v_lshlrev_b32 v102,16,v47
v_and_b32 v103,0xffff0000,v47
v_lshlrev_b32 v104,16,v48
v_and_b32 v105,0xffff0000,v48
v_lshlrev_b32 v106,16,v49
v_and_b32 v107,0xffff0000,v49
v_lshlrev_b32 v108,16,v50
v_and_b32 v109,0xffff0000,v50
v_lshlrev_b32 v110,16,v51
v_and_b32 v111,0xffff0000,v51
v_pk_add_f32 v[28:29],v[72:73],v[74:75]
v_pk_mul_f32 v[26:27],v[72:73],v[72:73]
v_pk_fma_f32 v[26:27],v[74:75],v[74:75],v[26:27]
v_pk_add_f32 v[28:29],v[28:29],v[76:77]
v_pk_fma_f32 v[26:27],v[76:77],v[76:77],v[26:27]
v_pk_add_f32 v[28:29],v[28:29],v[78:79]
v_pk_fma_f32 v[26:27],v[78:79],v[78:79],v[26:27]
v_pk_add_f32 v[28:29],v[28:29],v[80:81]
v_pk_fma_f32 v[26:27],v[80:81],v[80:81],v[26:27]
v_pk_add_f32 v[28:29],v[28:29],v[82:83]
v_pk_fma_f32 v[26:27],v[82:83],v[82:83],v[26:27]
v_pk_add_f32 v[28:29],v[28:29],v[84:85]
v_pk_fma_f32 v[26:27],v[84:85],v[84:85],v[26:27]
v_pk_add_f32 v[28:29],v[28:29],v[86:87]
v_pk_fma_f32 v[26:27],v[86:87],v[86:87],v[26:27]
v_pk_add_f32 v[28:29],v[28:29],v[88:89]
v_pk_fma_f32 v[26:27],v[88:89],v[88:89],v[26:27]
v_pk_add_f32 v[28:29],v[28:29],v[90:91]
v_pk_fma_f32 v[26:27],v[90:91],v[90:91],v[26:27]
v_pk_add_f32 v[28:29],v[28:29],v[92:93]
v_pk_fma_f32 v[26:27],v[92:93],v[92:93],v[26:27]
v_pk_add_f32 v[28:29],v[28:29],v[94:95]
v_pk_fma_f32 v[26:27],v[94:95],v[94:95],v[26:27]
v_pk_add_f32 v[28:29],v[28:29],v[96:97]
v_pk_fma_f32 v[26:27],v[96:97],v[96:97],v[26:27]
v_pk_add_f32 v[28:29],v[28:29],v[98:99]
v_pk_fma_f32 v[26:27],v[98:99],v[98:99],v[26:27]
v_pk_add_f32 v[28:29],v[28:29],v[100:101]
v_pk_fma_f32 v[26:27],v[100:101],v[100:101],v[26:27]
v_pk_add_f32 v[28:29],v[28:29],v[102:103]
v_pk_fma_f32 v[26:27],v[102:103],v[102:103],v[26:27]
v_pk_add_f32 v[28:29],v[28:29],v[104:105]
v_pk_fma_f32 v[26:27],v[104:105],v[104:105],v[26:27]
v_pk_add_f32 v[28:29],v[28:29],v[106:107]
v_pk_fma_f32 v[26:27],v[106:107],v[106:107],v[26:27]
v_pk_add_f32 v[28:29],v[28:29],v[108:109]
v_pk_fma_f32 v[26:27],v[108:109],v[108:109],v[26:27]
v_pk_add_f32 v[28:29],v[28:29],v[110:111]
v_pk_fma_f32 v[26:27],v[110:111],v[110:111],v[26:27]
v_add_f32 v24,v28,v29
v_add_f32 v25,v26,v27
s_nop 0
v_add_f32_dpp v24,v24,v24 row_ror:4 row_mask:0xf bank_mask:0xf
v_add_f32_dpp v25,v25,v25 row_ror:4 row_mask:0xf bank_mask:0xf
s_nop 0
v_add_f32_dpp v24,v24,v24 row_ror:8 row_mask:0xf bank_mask:0xf
v_add_f32_dpp v25,v25,v25 row_ror:8 row_mask:0xf bank_mask:0xf
v_mov_b32 v26,v24
v_mov_b32 v27,v25
s_nop 0
v_permlane32_swap_b32 v24,v26
v_permlane32_swap_b32 v25,v27
v_add_f32 v24,v24,v26
v_add_f32 v25,v25,v27
v_mov_b32 v26,v24
v_mov_b32 v27,v25
s_nop 0
v_permlane16_swap_b32 v24,v26
v_permlane16_swap_b32 v25,v27
v_add_f32 v24,v24,v26
v_add_f32 v25,v25,v27
v_mul_f32 v24,0x3acccccd,v24
v_mul_f32 v25,0x3acccccd,v25
v_fma_f32 v25,-v24,v24,v25
v_max_f32 v25,0,v25
v_cvt_pk_bf16_f32 v6,v24,v25
v_lshlrev_b32 v24,16,v6
v_and_b32 v25,0xffff0000,v6
v_add_f32 v25,0x3727c5ac,v25
v_cvt_pk_bf16_f32 v6,v25,v25
v_lshlrev_b32 v25,16,v6
v_sqrt_f32 v25,v25
s_nop 0
v_cvt_pk_bf16_f32 v6,v25,v25
v_lshlrev_b32 v25,16,v6
v_rcp_f32 v25,v25
s_nop 0
v_pk_add_f32 v[72:73],v[72:73],v[24:25] op_sel_hi:[1,0] neg_lo:[0,1] neg_hi:[0,1]
v_pk_add_f32 v[74:75],v[74:75],v[24:25] op_sel_hi:[1,0] neg_lo:[0,1] neg_hi:[0,1]
v_pk_add_f32 v[76:77],v[76:77],v[24:25] op_sel_hi:[1,0] neg_lo:[0,1] neg_hi:[0,1]
v_pk_add_f32 v[78:79],v[78:79],v[24:25] op_sel_hi:[1,0] neg_lo:[0,1] neg_hi:[0,1]
v_pk_add_f32 v[80:81],v[80:81],v[24:25] op_sel_hi:[1,0] neg_lo:[0,1] neg_hi:[0,1]
v_pk_add_f32 v[82:83],v[82:83],v[24:25] op_sel_hi:[1,0] neg_lo:[0,1] neg_hi:[0,1]
v_pk_add_f32 v[84:85],v[84:85],v[24:25] op_sel_hi:[1,0] neg_lo:[0,1] neg_hi:[0,1]
v_pk_add_f32 v[86:87],v[86:87],v[24:25] op_sel_hi:[1,0] neg_lo:[0,1] neg_hi:[0,1]
v_pk_add_f32 v[88:89],v[88:89],v[24:25] op_sel_hi:[1,0] neg_lo:[0,1] neg_hi:[0,1]
v_pk_add_f32 v[90:91],v[90:91],v[24:25] op_sel_hi:[1,0] neg_lo:[0,1] neg_hi:[0,1]
v_pk_add_f32 v[92:93],v[92:93],v[24:25] op_sel_hi:[1,0] neg_lo:[0,1] neg_hi:[0,1]
v_pk_add_f32 v[94:95],v[94:95],v[24:25] op_sel_hi:[1,0] neg_lo:[0,1] neg_hi:[0,1]
v_pk_add_f32 v[96:97],v[96:97],v[24:25] op_sel_hi:[1,0] neg_lo:[0,1] neg_hi:[0,1]
v_pk_add_f32 v[98:99],v[98:99],v[24:25] op_sel_hi:[1,0] neg_lo:[0,1] neg_hi:[0,1]
v_pk_add_f32 v[100:101],v[100:101],v[24:25] op_sel_hi:[1,0] neg_lo:[0,1] neg_hi:[0,1]
v_pk_add_f32 v[102:103],v[102:103],v[24:25] op_sel_hi:[1,0] neg_lo:[0,1] neg_hi:[0,1]
v_pk_add_f32 v[104:105],v[104:105],v[24:25] op_sel_hi:[1,0] neg_lo:[0,1] neg_hi:[0,1]
v_pk_add_f32 v[106:107],v[106:107],v[24:25] op_sel_hi:[1,0] neg_lo:[0,1] neg_hi:[0,1]
v_pk_add_f32 v[108:109],v[108:109],v[24:25] op_sel_hi:[1,0] neg_lo:[0,1] neg_hi:[0,1]
v_pk_add_f32 v[110:111],v[110:111],v[24:25] op_sel_hi:[1,0] neg_lo:[0,1] neg_hi:[0,1]
v_cvt_pk_bf16_f32 v6,v72,v73
v_lshlrev_b32 v72,16,v6
v_and_b32 v73,0xffff0000,v6
v_cvt_pk_bf16_f32 v8,v74,v75
v_lshlrev_b32 v74,16,v8
v_and_b32 v75,0xffff0000,v8
v_cvt_pk_bf16_f32 v6,v76,v77
v_lshlrev_b32 v76,16,v6
v_and_b32 v77,0xffff0000,v6
v_cvt_pk_bf16_f32 v8,v78,v79
v_lshlrev_b32 v78,16,v8
v_and_b32 v79,0xffff0000,v8
v_cvt_pk_bf16_f32 v6,v80,v81
v_lshlrev_b32 v80,16,v6
v_and_b32 v81,0xffff0000,v6
v_cvt_pk_bf16_f32 v8,v82,v83
v_lshlrev_b32 v82,16,v8
v_and_b32 v83,0xffff0000,v8
v_cvt_pk_bf16_f32 v6,v84,v85
v_lshlrev_b32 v84,16,v6
v_and_b32 v85,0xffff0000,v6
v_cvt_pk_bf16_f32 v8,v86,v87
v_lshlrev_b32 v86,16,v8
v_and_b32 v87,0xffff0000,v8
v_cvt_pk_bf16_f32 v6,v88,v89
v_lshlrev_b32 v88,16,v6
v_and_b32 v89,0xffff0000,v6
v_cvt_pk_bf16_f32 v8,v90,v91
v_lshlrev_b32 v90,16,v8
v_and_b32 v91,0xffff0000,v8
v_cvt_pk_bf16_f32 v6,v92,v93
v_lshlrev_b32 v92,16,v6
v_and_b32 v93,0xffff0000,v6
v_cvt_pk_bf16_f32 v8,v94,v95
v_lshlrev_b32 v94,16,v8
v_and_b32 v95,0xffff0000,v8
v_cvt_pk_bf16_f32 v6,v96,v97
v_lshlrev_b32 v96,16,v6
v_and_b32 v97,0xffff0000,v6
v_cvt_pk_bf16_f32 v8,v98,v99
v_lshlrev_b32 v98,16,v8
v_and_b32 v99,0xffff0000,v8
v_cvt_pk_bf16_f32 v6,v100,v101
v_lshlrev_b32 v100,16,v6
v_and_b32 v101,0xffff0000,v6
v_cvt_pk_bf16_f32 v8,v102,v103
v_lshlrev_b32 v102,16,v8
v_and_b32 v103,0xffff0000,v8
v_cvt_pk_bf16_f32 v6,v104,v105
v_lshlrev_b32 v104,16,v6
v_and_b32 v105,0xffff0000,v6
v_cvt_pk_bf16_f32 v8,v106,v107
v_lshlrev_b32 v106,16,v8
v_and_b32 v107,0xffff0000,v8
v_cvt_pk_bf16_f32 v6,v108,v109
v_lshlrev_b32 v108,16,v6
v_and_b32 v109,0xffff0000,v6
v_cvt_pk_bf16_f32 v8,v110,v111
v_lshlrev_b32 v110,16,v8
v_and_b32 v111,0xffff0000,v8
v_pk_mul_f32 v[72:73],v[72:73],v[24:25] op_sel:[0,1] op_sel_hi:[1,1]
v_pk_mul_f32 v[74:75],v[74:75],v[24:25] op_sel:[0,1] op_sel_hi:[1,1]
v_pk_mul_f32 v[76:77],v[76:77],v[24:25] op_sel:[0,1] op_sel_hi:[1,1]
v_pk_mul_f32 v[78:79],v[78:79],v[24:25] op_sel:[0,1] op_sel_hi:[1,1]
v_pk_mul_f32 v[80:81],v[80:81],v[24:25] op_sel:[0,1] op_sel_hi:[1,1]
v_pk_mul_f32 v[82:83],v[82:83],v[24:25] op_sel:[0,1] op_sel_hi:[1,1]
v_pk_mul_f32 v[84:85],v[84:85],v[24:25] op_sel:[0,1] op_sel_hi:[1,1]
v_pk_mul_f32 v[86:87],v[86:87],v[24:25] op_sel:[0,1] op_sel_hi:[1,1]
v_pk_mul_f32 v[88:89],v[88:89],v[24:25] op_sel:[0,1] op_sel_hi:[1,1]
v_pk_mul_f32 v[90:91],v[90:91],v[24:25] op_sel:[0,1] op_sel_hi:[1,1]
v_pk_mul_f32 v[92:93],v[92:93],v[24:25] op_sel:[0,1] op_sel_hi:[1,1]
v_pk_mul_f32 v[94:95],v[94:95],v[24:25] op_sel:[0,1] op_sel_hi:[1,1]
v_pk_mul_f32 v[96:97],v[96:97],v[24:25] op_sel:[0,1] op_sel_hi:[1,1]
v_pk_mul_f32 v[98:99],v[98:99],v[24:25] op_sel:[0,1] op_sel_hi:[1,1]
v_pk_mul_f32 v[100:101],v[100:101],v[24:25] op_sel:[0,1] op_sel_hi:[1,1]
v_pk_mul_f32 v[102:103],v[102:103],v[24:25] op_sel:[0,1] op_sel_hi:[1,1]
v_pk_mul_f32 v[104:105],v[104:105],v[24:25] op_sel:[0,1] op_sel_hi:[1,1]
v_pk_mul_f32 v[106:107],v[106:107],v[24:25] op_sel:[0,1] op_sel_hi:[1,1]
v_pk_mul_f32 v[108:109],v[108:109],v[24:25] op_sel:[0,1] op_sel_hi:[1,1]
v_pk_mul_f32 v[110:111],v[110:111],v[24:25] op_sel:[0,1] op_sel_hi:[1,1]
v_cvt_pk_bf16_f32 v112,v72,v73
v_lshlrev_b32 v72,16,v112
v_and_b32 v73,0xffff0000,v112
v_cvt_pk_bf16_f32 v113,v74,v75
v_lshlrev_b32 v74,16,v113
v_and_b32 v75,0xffff0000,v113
v_cvt_pk_bf16_f32 v114,v76,v77
v_lshlrev_b32 v76,16,v114
v_and_b32 v77,0xffff0000,v114
v_cvt_pk_bf16_f32 v115,v78,v79
v_lshlrev_b32 v78,16,v115
v_and_b32 v79,0xffff0000,v115
v_cvt_pk_bf16_f32 v116,v80,v81
v_lshlrev_b32 v80,16,v116
v_and_b32 v81,0xffff0000,v116
v_cvt_pk_bf16_f32 v117,v82,v83
v_lshlrev_b32 v82,16,v117
v_and_b32 v83,0xffff0000,v117
v_cvt_pk_bf16_f32 v118,v84,v85
v_lshlrev_b32 v84,16,v118
v_and_b32 v85,0xffff0000,v118
v_cvt_pk_bf16_f32 v119,v86,v87
v_lshlrev_b32 v86,16,v119
v_and_b32 v87,0xffff0000,v119
v_cvt_pk_bf16_f32 v120,v88,v89
v_lshlrev_b32 v88,16,v120
v_and_b32 v89,0xffff0000,v120
v_cvt_pk_bf16_f32 v121,v90,v91
v_lshlrev_b32 v90,16,v121
v_and_b32 v91,0xffff0000,v121
v_cvt_pk_bf16_f32 v122,v92,v93
v_lshlrev_b32 v92,16,v122
v_and_b32 v93,0xffff0000,v122
v_cvt_pk_bf16_f32 v123,v94,v95
v_lshlrev_b32 v94,16,v123
v_and_b32 v95,0xffff0000,v123
v_cvt_pk_bf16_f32 v124,v96,v97
v_lshlrev_b32 v96,16,v124
v_and_b32 v97,0xffff0000,v124
v_cvt_pk_bf16_f32 v125,v98,v99
v_lshlrev_b32 v98,16,v125
v_and_b32 v99,0xffff0000,v125
v_cvt_pk_bf16_f32 v126,v100,v101
v_lshlrev_b32 v100,16,v126
v_and_b32 v101,0xffff0000,v126
v_cvt_pk_bf16_f32 v127,v102,v103
v_lshlrev_b32 v102,16,v127
v_and_b32 v103,0xffff0000,v127
v_cvt_pk_bf16_f32 v128,v104,v105
v_lshlrev_b32 v104,16,v128
v_and_b32 v105,0xffff0000,v128
v_cvt_pk_bf16_f32 v129,v106,v107
v_lshlrev_b32 v106,16,v129
v_and_b32 v107,0xffff0000,v129
v_cvt_pk_bf16_f32 v130,v108,v109
v_lshlrev_b32 v108,16,v130
v_and_b32 v109,0xffff0000,v130
v_cvt_pk_bf16_f32 v131,v110,v111
v_lshlrev_b32 v110,16,v131
v_and_b32 v111,0xffff0000,v131
s_add_u32 s63,s65,0
v_permlane16_swap_b32 v112,v114
v_permlane16_swap_b32 v113,v115
buffer_store_dwordx4 v[112:115],v132,s[8:11],s63 offen sc1
s_add_u32 s63,s65,8192
v_permlane16_swap_b32 v116,v118
v_permlane16_swap_b32 v117,v119
buffer_store_dwordx4 v[116:119],v132,s[8:11],s63 offen sc1
s_add_u32 s63,s65,16384
v_permlane16_swap_b32 v120,v122
v_permlane16_swap_b32 v121,v123
buffer_store_dwordx4 v[120:123],v132,s[8:11],s63 offen sc1
s_add_u32 s63,s65,24576
v_permlane16_swap_b32 v124,v126
v_permlane16_swap_b32 v125,v127
buffer_store_dwordx4 v[124:127],v132,s[8:11],s63 offen sc1
s_add_u32 s63,s65,32768
v_permlane16_swap_b32 v128,v130
v_permlane16_swap_b32 v129,v131
buffer_store_dwordx4 v[128:131],v132,s[8:11],s63 offen sc1
s_add_u32 s63,s64,0
v_permlane16_swap_b32 v32,v34
v_permlane16_swap_b32 v33,v35
buffer_store_dwordx4 v[32:35],v132,s[8:11],s63 offen sc1
s_add_u32 s63,s64,8192
v_permlane16_swap_b32 v36,v38
v_permlane16_swap_b32 v37,v39
buffer_store_dwordx4 v[36:39],v132,s[8:11],s63 offen sc1
s_add_u32 s63,s64,16384
v_permlane16_swap_b32 v40,v42
v_permlane16_swap_b32 v41,v43
buffer_store_dwordx4 v[40:43],v132,s[8:11],s63 offen sc1
s_add_u32 s63,s64,24576
v_permlane16_swap_b32 v44,v46
v_permlane16_swap_b32 v45,v47
buffer_store_dwordx4 v[44:47],v132,s[8:11],s63 offen sc1
s_add_u32 s63,s64,32768
v_permlane16_swap_b32 v48,v50
v_permlane16_swap_b32 v49,v51
buffer_store_dwordx4 v[48:51],v132,s[8:11],s63 offen sc1
s_lshl_b32 s82,s55,6
s_add_u32 s82,s82,s54
s_lshl_b32 s82,s82,9
s_add_u32 s82,s82,0
s_lshl_b32 s61,s53,2
s_add_u32 s82,s82,s61
s_add_u32 s54,s54,16
s_cmp_ge_u32 s54,64
s_cbranch_scc1 R0_ENDA
s_add_u32 s66,s54,16
s_min_u32 s66,s66,63
s_mul_i32 s62,s66,40960
buffer_load_dwordx2 v[32:33],v133,s[4:7],s62 offen offset:0
buffer_load_dwordx2 v[34:35],v133,s[4:7],s62 offen offset:128
buffer_load_dwordx2 v[36:37],v133,s[4:7],s62 offen offset:256
buffer_load_dwordx2 v[38:39],v133,s[4:7],s62 offen offset:384
buffer_load_dwordx2 v[40:41],v133,s[4:7],s62 offen offset:512
buffer_load_dwordx2 v[42:43],v133,s[4:7],s62 offen offset:640
buffer_load_dwordx2 v[44:45],v133,s[4:7],s62 offen offset:768
buffer_load_dwordx2 v[46:47],v133,s[4:7],s62 offen offset:896
buffer_load_dwordx2 v[48:49],v133,s[4:7],s62 offen offset:1024
buffer_load_dwordx2 v[50:51],v133,s[4:7],s62 offen offset:1152
s_mul_i32 s64,s54,40960
s_add_u32 s64,s64,234749952
s_mul_i32 s65,s54,46080
s_add_u32 s65,s65,206569472
s_waitcnt vmcnt(10)
s_mov_b64 exec,1
buffer_store_dword v5,v1,s[8:11],s82 offen sc1
s_mov_b64 exec,-1
v_lshlrev_b32 v72,16,v52
v_and_b32 v73,0xffff0000,v52
v_lshlrev_b32 v74,16,v53
v_and_b32 v75,0xffff0000,v53
v_lshlrev_b32 v76,16,v54
v_and_b32 v77,0xffff0000,v54
v_lshlrev_b32 v78,16,v55
v_and_b32 v79,0xffff0000,v55
v_lshlrev_b32 v80,16,v56
v_and_b32 v81,0xffff0000,v56
v_lshlrev_b32 v82,16,v57
v_and_b32 v83,0xffff0000,v57
v_lshlrev_b32 v84,16,v58
v_and_b32 v85,0xffff0000,v58
v_lshlrev_b32 v86,16,v59
v_and_b32 v87,0xffff0000,v59
v_lshlrev_b32 v88,16,v60
v_and_b32 v89,0xffff0000,v60
v_lshlrev_b32 v90,16,v61
v_and_b32 v91,0xffff0000,v61
v_lshlrev_b32 v92,16,v62
v_and_b32 v93,0xffff0000,v62
v_lshlrev_b32 v94,16,v63
v_and_b32 v95,0xffff0000,v63
v_lshlrev_b32 v96,16,v64
v_and_b32 v97,0xffff0000,v64
v_lshlrev_b32 v98,16,v65
v_and_b32 v99,0xffff0000,v65
v_lshlrev_b32 v100,16,v66
v_and_b32 v101,0xffff0000,v66
v_lshlrev_b32 v102,16,v67
v_and_b32 v103,0xffff0000,v67
v_lshlrev_b32 v104,16,v68
v_and_b32 v105,0xffff0000,v68
v_lshlrev_b32 v106,16,v69
v_and_b32 v107,0xffff0000,v69
v_lshlrev_b32 v108,16,v70
v_and_b32 v109,0xffff0000,v70
v_lshlrev_b32 v110,16,v71
v_and_b32 v111,0xffff0000,v71
v_pk_add_f32 v[28:29],v[72:73],v[74:75]
v_pk_mul_f32 v[26:27],v[72:73],v[72:73]
v_pk_fma_f32 v[26:27],v[74:75],v[74:75],v[26:27]
v_pk_add_f32 v[28:29],v[28:29],v[76:77]
v_pk_fma_f32 v[26:27],v[76:77],v[76:77],v[26:27]
v_pk_add_f32 v[28:29],v[28:29],v[78:79]
v_pk_fma_f32 v[26:27],v[78:79],v[78:79],v[26:27]
v_pk_add_f32 v[28:29],v[28:29],v[80:81]
v_pk_fma_f32 v[26:27],v[80:81],v[80:81],v[26:27]
v_pk_add_f32 v[28:29],v[28:29],v[82:83]
v_pk_fma_f32 v[26:27],v[82:83],v[82:83],v[26:27]
v_pk_add_f32 v[28:29],v[28:29],v[84:85]
v_pk_fma_f32 v[26:27],v[84:85],v[84:85],v[26:27]
v_pk_add_f32 v[28:29],v[28:29],v[86:87]
v_pk_fma_f32 v[26:27],v[86:87],v[86:87],v[26:27]
v_pk_add_f32 v[28:29],v[28:29],v[88:89]
v_pk_fma_f32 v[26:27],v[88:89],v[88:89],v[26:27]
v_pk_add_f32 v[28:29],v[28:29],v[90:91]
v_pk_fma_f32 v[26:27],v[90:91],v[90:91],v[26:27]
v_pk_add_f32 v[28:29],v[28:29],v[92:93]
v_pk_fma_f32 v[26:27],v[92:93],v[92:93],v[26:27]
v_pk_add_f32 v[28:29],v[28:29],v[94:95]
v_pk_fma_f32 v[26:27],v[94:95],v[94:95],v[26:27]
v_pk_add_f32 v[28:29],v[28:29],v[96:97]
v_pk_fma_f32 v[26:27],v[96:97],v[96:97],v[26:27]
v_pk_add_f32 v[28:29],v[28:29],v[98:99]
v_pk_fma_f32 v[26:27],v[98:99],v[98:99],v[26:27]
v_pk_add_f32 v[28:29],v[28:29],v[100:101]
v_pk_fma_f32 v[26:27],v[100:101],v[100:101],v[26:27]
v_pk_add_f32 v[28:29],v[28:29],v[102:103]
v_pk_fma_f32 v[26:27],v[102:103],v[102:103],v[26:27]
v_pk_add_f32 v[28:29],v[28:29],v[104:105]
v_pk_fma_f32 v[26:27],v[104:105],v[104:105],v[26:27]
v_pk_add_f32 v[28:29],v[28:29],v[106:107]
v_pk_fma_f32 v[26:27],v[106:107],v[106:107],v[26:27]
v_pk_add_f32 v[28:29],v[28:29],v[108:109]
v_pk_fma_f32 v[26:27],v[108:109],v[108:109],v[26:27]
v_pk_add_f32 v[28:29],v[28:29],v[110:111]
v_pk_fma_f32 v[26:27],v[110:111],v[110:111],v[26:27]
v_add_f32 v24,v28,v29
v_add_f32 v25,v26,v27
s_nop 0
v_add_f32_dpp v24,v24,v24 row_ror:4 row_mask:0xf bank_mask:0xf
v_add_f32_dpp v25,v25,v25 row_ror:4 row_mask:0xf bank_mask:0xf
s_nop 0
v_add_f32_dpp v24,v24,v24 row_ror:8 row_mask:0xf bank_mask:0xf
v_add_f32_dpp v25,v25,v25 row_ror:8 row_mask:0xf bank_mask:0xf
v_mov_b32 v26,v24
v_mov_b32 v27,v25
s_nop 0
v_permlane32_swap_b32 v24,v26
v_permlane32_swap_b32 v25,v27
v_add_f32 v24,v24,v26
v_add_f32 v25,v25,v27
v_mov_b32 v26,v24
v_mov_b32 v27,v25
s_nop 0
v_permlane16_swap_b32 v24,v26
v_permlane16_swap_b32 v25,v27
v_add_f32 v24,v24,v26
v_add_f32 v25,v25,v27
v_mul_f32 v24,0x3acccccd,v24
v_mul_f32 v25,0x3acccccd,v25
v_fma_f32 v25,-v24,v24,v25
v_max_f32 v25,0,v25
v_cvt_pk_bf16_f32 v6,v24,v25
v_lshlrev_b32 v24,16,v6
v_and_b32 v25,0xffff0000,v6
v_add_f32 v25,0x3727c5ac,v25
v_cvt_pk_bf16_f32 v6,v25,v25
v_lshlrev_b32 v25,16,v6
v_sqrt_f32 v25,v25
s_nop 0
v_cvt_pk_bf16_f32 v6,v25,v25
v_lshlrev_b32 v25,16,v6
v_rcp_f32 v25,v25
s_nop 0
v_pk_add_f32 v[72:73],v[72:73],v[24:25] op_sel_hi:[1,0] neg_lo:[0,1] neg_hi:[0,1]
v_pk_add_f32 v[74:75],v[74:75],v[24:25] op_sel_hi:[1,0] neg_lo:[0,1] neg_hi:[0,1]
v_pk_add_f32 v[76:77],v[76:77],v[24:25] op_sel_hi:[1,0] neg_lo:[0,1] neg_hi:[0,1]
v_pk_add_f32 v[78:79],v[78:79],v[24:25] op_sel_hi:[1,0] neg_lo:[0,1] neg_hi:[0,1]
v_pk_add_f32 v[80:81],v[80:81],v[24:25] op_sel_hi:[1,0] neg_lo:[0,1] neg_hi:[0,1]
v_pk_add_f32 v[82:83],v[82:83],v[24:25] op_sel_hi:[1,0] neg_lo:[0,1] neg_hi:[0,1]
v_pk_add_f32 v[84:85],v[84:85],v[24:25] op_sel_hi:[1,0] neg_lo:[0,1] neg_hi:[0,1]
v_pk_add_f32 v[86:87],v[86:87],v[24:25] op_sel_hi:[1,0] neg_lo:[0,1] neg_hi:[0,1]
v_pk_add_f32 v[88:89],v[88:89],v[24:25] op_sel_hi:[1,0] neg_lo:[0,1] neg_hi:[0,1]
v_pk_add_f32 v[90:91],v[90:91],v[24:25] op_sel_hi:[1,0] neg_lo:[0,1] neg_hi:[0,1]
v_pk_add_f32 v[92:93],v[92:93],v[24:25] op_sel_hi:[1,0] neg_lo:[0,1] neg_hi:[0,1]
v_pk_add_f32 v[94:95],v[94:95],v[24:25] op_sel_hi:[1,0] neg_lo:[0,1] neg_hi:[0,1]
v_pk_add_f32 v[96:97],v[96:97],v[24:25] op_sel_hi:[1,0] neg_lo:[0,1] neg_hi:[0,1]
v_pk_add_f32 v[98:99],v[98:99],v[24:25] op_sel_hi:[1,0] neg_lo:[0,1] neg_hi:[0,1]
v_pk_add_f32 v[100:101],v[100:101],v[24:25] op_sel_hi:[1,0] neg_lo:[0,1] neg_hi:[0,1]
v_pk_add_f32 v[102:103],v[102:103],v[24:25] op_sel_hi:[1,0] neg_lo:[0,1] neg_hi:[0,1]
v_pk_add_f32 v[104:105],v[104:105],v[24:25] op_sel_hi:[1,0] neg_lo:[0,1] neg_hi:[0,1]
v_pk_add_f32 v[106:107],v[106:107],v[24:25] op_sel_hi:[1,0] neg_lo:[0,1] neg_hi:[0,1]
v_pk_add_f32 v[108:109],v[108:109],v[24:25] op_sel_hi:[1,0] neg_lo:[0,1] neg_hi:[0,1]
v_pk_add_f32 v[110:111],v[110:111],v[24:25] op_sel_hi:[1,0] neg_lo:[0,1] neg_hi:[0,1]
v_cvt_pk_bf16_f32 v6,v72,v73
v_lshlrev_b32 v72,16,v6
v_and_b32 v73,0xffff0000,v6
v_cvt_pk_bf16_f32 v8,v74,v75
v_lshlrev_b32 v74,16,v8
v_and_b32 v75,0xffff0000,v8
v_cvt_pk_bf16_f32 v6,v76,v77
v_lshlrev_b32 v76,16,v6
v_and_b32 v77,0xffff0000,v6
v_cvt_pk_bf16_f32 v8,v78,v79
v_lshlrev_b32 v78,16,v8
v_and_b32 v79,0xffff0000,v8
v_cvt_pk_bf16_f32 v6,v80,v81
v_lshlrev_b32 v80,16,v6
v_and_b32 v81,0xffff0000,v6
v_cvt_pk_bf16_f32 v8,v82,v83
v_lshlrev_b32 v82,16,v8
v_and_b32 v83,0xffff0000,v8
v_cvt_pk_bf16_f32 v6,v84,v85
v_lshlrev_b32 v84,16,v6
v_and_b32 v85,0xffff0000,v6
v_cvt_pk_bf16_f32 v8,v86,v87
v_lshlrev_b32 v86,16,v8
v_and_b32 v87,0xffff0000,v8
v_cvt_pk_bf16_f32 v6,v88,v89
v_lshlrev_b32 v88,16,v6
v_and_b32 v89,0xffff0000,v6
v_cvt_pk_bf16_f32 v8,v90,v91
v_lshlrev_b32 v90,16,v8
v_and_b32 v91,0xffff0000,v8
v_cvt_pk_bf16_f32 v6,v92,v93
v_lshlrev_b32 v92,16,v6
v_and_b32 v93,0xffff0000,v6
v_cvt_pk_bf16_f32 v8,v94,v95
v_lshlrev_b32 v94,16,v8
v_and_b32 v95,0xffff0000,v8
v_cvt_pk_bf16_f32 v6,v96,v97
v_lshlrev_b32 v96,16,v6
v_and_b32 v97,0xffff0000,v6
v_cvt_pk_bf16_f32 v8,v98,v99
v_lshlrev_b32 v98,16,v8
v_and_b32 v99,0xffff0000,v8
v_cvt_pk_bf16_f32 v6,v100,v101
v_lshlrev_b32 v100,16,v6
v_and_b32 v101,0xffff0000,v6
v_cvt_pk_bf16_f32 v8,v102,v103
v_lshlrev_b32 v102,16,v8
v_and_b32 v103,0xffff0000,v8
v_cvt_pk_bf16_f32 v6,v104,v105
v_lshlrev_b32 v104,16,v6
v_and_b32 v105,0xffff0000,v6
v_cvt_pk_bf16_f32 v8,v106,v107
v_lshlrev_b32 v106,16,v8
v_and_b32 v107,0xffff0000,v8
v_cvt_pk_bf16_f32 v6,v108,v109
v_lshlrev_b32 v108,16,v6
v_and_b32 v109,0xffff0000,v6
v_cvt_pk_bf16_f32 v8,v110,v111
v_lshlrev_b32 v110,16,v8
v_and_b32 v111,0xffff0000,v8
v_pk_mul_f32 v[72:73],v[72:73],v[24:25] op_sel:[0,1] op_sel_hi:[1,1]
v_pk_mul_f32 v[74:75],v[74:75],v[24:25] op_sel:[0,1] op_sel_hi:[1,1]
v_pk_mul_f32 v[76:77],v[76:77],v[24:25] op_sel:[0,1] op_sel_hi:[1,1]
v_pk_mul_f32 v[78:79],v[78:79],v[24:25] op_sel:[0,1] op_sel_hi:[1,1]
v_pk_mul_f32 v[80:81],v[80:81],v[24:25] op_sel:[0,1] op_sel_hi:[1,1]
v_pk_mul_f32 v[82:83],v[82:83],v[24:25] op_sel:[0,1] op_sel_hi:[1,1]
v_pk_mul_f32 v[84:85],v[84:85],v[24:25] op_sel:[0,1] op_sel_hi:[1,1]
v_pk_mul_f32 v[86:87],v[86:87],v[24:25] op_sel:[0,1] op_sel_hi:[1,1]
v_pk_mul_f32 v[88:89],v[88:89],v[24:25] op_sel:[0,1] op_sel_hi:[1,1]
v_pk_mul_f32 v[90:91],v[90:91],v[24:25] op_sel:[0,1] op_sel_hi:[1,1]
v_pk_mul_f32 v[92:93],v[92:93],v[24:25] op_sel:[0,1] op_sel_hi:[1,1]
v_pk_mul_f32 v[94:95],v[94:95],v[24:25] op_sel:[0,1] op_sel_hi:[1,1]
v_pk_mul_f32 v[96:97],v[96:97],v[24:25] op_sel:[0,1] op_sel_hi:[1,1]
v_pk_mul_f32 v[98:99],v[98:99],v[24:25] op_sel:[0,1] op_sel_hi:[1,1]
v_pk_mul_f32 v[100:101],v[100:101],v[24:25] op_sel:[0,1] op_sel_hi:[1,1]
v_pk_mul_f32 v[102:103],v[102:103],v[24:25] op_sel:[0,1] op_sel_hi:[1,1]
v_pk_mul_f32 v[104:105],v[104:105],v[24:25] op_sel:[0,1] op_sel_hi:[1,1]
v_pk_mul_f32 v[106:107],v[106:107],v[24:25] op_sel:[0,1] op_sel_hi:[1,1]
v_pk_mul_f32 v[108:109],v[108:109],v[24:25] op_sel:[0,1] op_sel_hi:[1,1]
v_pk_mul_f32 v[110:111],v[110:111],v[24:25] op_sel:[0,1] op_sel_hi:[1,1]
v_cvt_pk_bf16_f32 v112,v72,v73
v_lshlrev_b32 v72,16,v112
v_and_b32 v73,0xffff0000,v112
v_cvt_pk_bf16_f32 v113,v74,v75
v_lshlrev_b32 v74,16,v113
v_and_b32 v75,0xffff0000,v113
v_cvt_pk_bf16_f32 v114,v76,v77
v_lshlrev_b32 v76,16,v114
v_and_b32 v77,0xffff0000,v114
v_cvt_pk_bf16_f32 v115,v78,v79
v_lshlrev_b32 v78,16,v115
v_and_b32 v79,0xffff0000,v115
v_cvt_pk_bf16_f32 v116,v80,v81
v_lshlrev_b32 v80,16,v116
v_and_b32 v81,0xffff0000,v116
v_cvt_pk_bf16_f32 v117,v82,v83
v_lshlrev_b32 v82,16,v117
v_and_b32 v83,0xffff0000,v117
v_cvt_pk_bf16_f32 v118,v84,v85
v_lshlrev_b32 v84,16,v118
v_and_b32 v85,0xffff0000,v118
v_cvt_pk_bf16_f32 v119,v86,v87
v_lshlrev_b32 v86,16,v119
v_and_b32 v87,0xffff0000,v119
v_cvt_pk_bf16_f32 v120,v88,v89
v_lshlrev_b32 v88,16,v120
v_and_b32 v89,0xffff0000,v120
v_cvt_pk_bf16_f32 v121,v90,v91
v_lshlrev_b32 v90,16,v121
v_and_b32 v91,0xffff0000,v121
v_cvt_pk_bf16_f32 v122,v92,v93
v_lshlrev_b32 v92,16,v122
v_and_b32 v93,0xffff0000,v122
v_cvt_pk_bf16_f32 v123,v94,v95
v_lshlrev_b32 v94,16,v123
v_and_b32 v95,0xffff0000,v123
v_cvt_pk_bf16_f32 v124,v96,v97
v_lshlrev_b32 v96,16,v124
v_and_b32 v97,0xffff0000,v124
v_cvt_pk_bf16_f32 v125,v98,v99
v_lshlrev_b32 v98,16,v125
v_and_b32 v99,0xffff0000,v125
v_cvt_pk_bf16_f32 v126,v100,v101
v_lshlrev_b32 v100,16,v126
v_and_b32 v101,0xffff0000,v126
v_cvt_pk_bf16_f32 v127,v102,v103
v_lshlrev_b32 v102,16,v127
v_and_b32 v103,0xffff0000,v127
v_cvt_pk_bf16_f32 v128,v104,v105
v_lshlrev_b32 v104,16,v128
v_and_b32 v105,0xffff0000,v128
v_cvt_pk_bf16_f32 v129,v106,v107
v_lshlrev_b32 v106,16,v129
v_and_b32 v107,0xffff0000,v129
v_cvt_pk_bf16_f32 v130,v108,v109
v_lshlrev_b32 v108,16,v130
v_and_b32 v109,0xffff0000,v130
v_cvt_pk_bf16_f32 v131,v110,v111
v_lshlrev_b32 v110,16,v131
v_and_b32 v111,0xffff0000,v131
s_add_u32 s63,s65,0
v_permlane16_swap_b32 v112,v114
v_permlane16_swap_b32 v113,v115
buffer_store_dwordx4 v[112:115],v132,s[8:11],s63 offen sc1
s_add_u32 s63,s65,8192
v_permlane16_swap_b32 v116,v118
v_permlane16_swap_b32 v117,v119
buffer_store_dwordx4 v[116:119],v132,s[8:11],s63 offen sc1
s_add_u32 s63,s65,16384
v_permlane16_swap_b32 v120,v122
v_permlane16_swap_b32 v121,v123
buffer_store_dwordx4 v[120:123],v132,s[8:11],s63 offen sc1
s_add_u32 s63,s65,24576
v_permlane16_swap_b32 v124,v126
v_permlane16_swap_b32 v125,v127
buffer_store_dwordx4 v[124:127],v132,s[8:11],s63 offen sc1
s_add_u32 s63,s65,32768
v_permlane16_swap_b32 v128,v130
v_permlane16_swap_b32 v129,v131
buffer_store_dwordx4 v[128:131],v132,s[8:11],s63 offen sc1
s_add_u32 s63,s64,0
v_permlane16_swap_b32 v52,v54
v_permlane16_swap_b32 v53,v55
buffer_store_dwordx4 v[52:55],v132,s[8:11],s63 offen sc1
s_add_u32 s63,s64,8192
v_permlane16_swap_b32 v56,v58
v_permlane16_swap_b32 v57,v59
buffer_store_dwordx4 v[56:59],v132,s[8:11],s63 offen sc1
s_add_u32 s63,s64,16384
v_permlane16_swap_b32 v60,v62
v_permlane16_swap_b32 v61,v63
buffer_store_dwordx4 v[60:63],v132,s[8:11],s63 offen sc1
s_add_u32 s63,s64,24576
v_permlane16_swap_b32 v64,v66
v_permlane16_swap_b32 v65,v67
buffer_store_dwordx4 v[64:67],v132,s[8:11],s63 offen sc1
s_add_u32 s63,s64,32768
v_permlane16_swap_b32 v68,v70
v_permlane16_swap_b32 v69,v71
buffer_store_dwordx4 v[68:71],v132,s[8:11],s63 offen sc1
s_lshl_b32 s82,s55,6
s_add_u32 s82,s82,s54
s_lshl_b32 s82,s82,9
s_add_u32 s82,s82,0
s_lshl_b32 s61,s53,2
s_add_u32 s82,s82,s61
s_add_u32 s54,s54,16
s_cmp_lt_u32 s54,64
s_cbranch_scc1 R0_LOOPA
R0_ENDA:
s_waitcnt vmcnt(0)
s_mov_b64 exec,1
buffer_store_dword v5,v1,s[8:11],s82 offen sc1
s_mov_b64 exec,-1
s_mov_b32 s52,s86
s_mul_i32 s60,s86,196608
s_add_u32 s69,s69,s60
s_mul_i32 s60,s86,1024
s_add_u32 s70,s70,s60
v_mov_b32 v231,0
s_mov_b32 s83,s100
s_nop 0
ATT_LOOP:
s_lshl_b32 s67,s51,6
s_add_u32 s67,s67,s52
s_lshl_b32 s67,s67,9
s_add_u32 s67,s67,65536
s_mul_i32 s66,s52,393216
s_add_u32 s66,s66,s71
v_cmp_eq_u32 vcc,0,v231
s_nop 0
s_cbranch_vccz ATT_RDY
fb_221:
buffer_load_dword v3,v2,s[8:11],s67 offen sc1
s_waitcnt vmcnt(0)
v_cmp_eq_u32 vcc,0,v3
s_nop 0
s_cbranch_vccz ok_222
s_sleep 20
s_sub_u32 s47,s47,1
s_cbranch_scc1 ABORT
s_branch fb_221
ok_222:
ATT_RDY:
s_add_u32 s63,s66,124780544
buffer_load_dwordx4 v[16:19],v1,s[8:11],s63 offen sc1
buffer_load_dwordx4 v[20:23],v1,s[8:11],s63 offen offset:1024 sc1
buffer_load_dwordx4 v[24:27],v1,s[8:11],s63 offen offset:2048 sc1
buffer_load_dwordx4 v[28:31],v1,s[8:11],s63 offen offset:3072 sc1
s_add_u32 s63,s66,124784640
buffer_load_dwordx4 v[32:35],v1,s[8:11],s63 offen sc1
buffer_load_dwordx4 v[36:39],v1,s[8:11],s63 offen offset:1024 sc1
buffer_load_dwordx4 v[40:43],v1,s[8:11],s63 offen offset:2048 sc1
buffer_load_dwordx4 v[44:47],v1,s[8:11],s63 offen offset:3072 sc1
s_add_u32 s63,s66,124788736
buffer_load_dwordx4 v[48:51],v1,s[8:11],s63 offen sc1
buffer_load_dwordx4 v[52:55],v1,s[8:11],s63 offen offset:1024 sc1
buffer_load_dwordx4 v[56:59],v1,s[8:11],s63 offen offset:2048 sc1
buffer_load_dwordx4 v[60:63],v1,s[8:11],s63 offen offset:3072 sc1
s_add_u32 s63,s66,74448896
buffer_load_dwordx4 v[64:67],v1,s[8:11],s63 offen sc1
buffer_load_dwordx4 v[68:71],v1,s[8:11],s63 offen offset:1024 sc1
buffer_load_dwordx4 v[72:75],v1,s[8:11],s63 offen offset:2048 sc1
buffer_load_dwordx4 v[76:79],v1,s[8:11],s63 offen offset:3072 sc1
s_add_u32 s63,s66,74452992
buffer_load_dwordx4 v[80:83],v1,s[8:11],s63 offen sc1
buffer_load_dwordx4 v[84:87],v1,s[8:11],s63 offen offset:1024 sc1
buffer_load_dwordx4 v[88:91],v1,s[8:11],s63 offen offset:2048 sc1
buffer_load_dwordx4 v[92:95],v1,s[8:11],s63 offen offset:3072 sc1
s_add_u32 s63,s66,74457088
buffer_load_dwordx4 v[96:99],v1,s[8:11],s63 offen sc1
buffer_load_dwordx4 v[100:103],v1,s[8:11],s63 offen offset:1024 sc1
buffer_load_dwordx4 v[104:107],v1,s[8:11],s63 offen offset:2048 sc1
buffer_load_dwordx4 v[108:111],v1,s[8:11],s63 offen offset:3072 sc1
s_add_u32 s63,s66,99614720
buffer_load_dwordx4 v[112:115],v1,s[8:11],s63 offen sc1
buffer_load_dwordx4 v[116:119],v1,s[8:11],s63 offen offset:1024 sc1
buffer_load_dwordx4 v[120:123],v1,s[8:11],s63 offen offset:2048 sc1
buffer_load_dwordx4 v[124:127],v1,s[8:11],s63 offen offset:3072 sc1
s_add_u32 s63,s66,99618816
buffer_load_dwordx4 v[128:131],v1,s[8:11],s63 offen sc1
buffer_load_dwordx4 v[132:135],v1,s[8:11],s63 offen offset:1024 sc1
buffer_load_dwordx4 v[136:139],v1,s[8:11],s63 offen offset:2048 sc1
buffer_load_dwordx4 v[140:143],v1,s[8:11],s63 offen offset:3072 sc1
s_add_u32 s63,s66,99622912
buffer_load_dwordx4 v[144:147],v1,s[8:11],s63 offen sc1
buffer_load_dwordx4 v[148:151],v1,s[8:11],s63 offen offset:1024 sc1
buffer_load_dwordx4 v[152:155],v1,s[8:11],s63 offen offset:2048 sc1
buffer_load_dwordx4 v[156:159],v1,s[8:11],s63 offen offset:3072 sc1
v_lshlrev_b32 v232,7,v0
s_add_u32 s63,s66,149946368
buffer_load_dword v233,v232,s[8:11],s63 offen sc1
s_add_u32 s63,s66,149950464
buffer_load_dword v233,v232,s[8:11],s63 offen sc1
s_waitcnt vmcnt(14)
v_mfma_f32_16x16x32_bf16 v[184:187],v[64:67],v[16:19],0
v_mfma_f32_16x16x32_bf16 v[188:191],v[64:67],v[20:23],0
v_mfma_f32_16x16x32_bf16 v[192:195],v[68:71],v[20:23],0
v_mfma_f32_16x16x32_bf16 v[184:187],v[72:75],v[24:27],v[184:187]
v_mfma_f32_16x16x32_bf16 v[188:191],v[72:75],v[28:31],v[188:191]
v_mfma_f32_16x16x32_bf16 v[192:195],v[76:79],v[28:31],v[192:195]
v_mfma_f32_16x16x32_bf16 v[184:187],v[80:83],v[32:35],v[184:187]
v_mfma_f32_16x16x32_bf16 v[188:191],v[80:83],v[36:39],v[188:191]
v_mfma_f32_16x16x32_bf16 v[192:195],v[84:87],v[36:39],v[192:195]
v_mfma_f32_16x16x32_bf16 v[184:187],v[88:91],v[40:43],v[184:187]
v_mfma_f32_16x16x32_bf16 v[188:191],v[88:91],v[44:47],v[188:191]
v_mfma_f32_16x16x32_bf16 v[192:195],v[92:95],v[44:47],v[192:195]
v_mfma_f32_16x16x32_bf16 v[184:187],v[96:99],v[48:51],v[184:187]
v_mfma_f32_16x16x32_bf16 v[188:191],v[96:99],v[52:55],v[188:191]
v_mfma_f32_16x16x32_bf16 v[192:195],v[100:103],v[52:55],v[192:195]
v_mfma_f32_16x16x32_bf16 v[184:187],v[104:107],v[56:59],v[184:187]
v_mfma_f32_16x16x32_bf16 v[188:191],v[104:107],v[60:63],v[188:191]
v_mfma_f32_16x16x32_bf16 v[192:195],v[108:111],v[60:63],v[192:195]
s_nop 1
v_cvt_pk_bf16_f32 v6,v184,v185
v_lshlrev_b32 v184,16,v6
v_and_b32 v185,0xffff0000,v6
v_cvt_pk_bf16_f32 v6,v186,v187
v_lshlrev_b32 v186,16,v6
v_and_b32 v187,0xffff0000,v6
v_cvt_pk_bf16_f32 v6,v188,v189
v_lshlrev_b32 v188,16,v6
v_and_b32 v189,0xffff0000,v6
v_cvt_pk_bf16_f32 v6,v190,v191
v_lshlrev_b32 v190,16,v6
v_and_b32 v191,0xffff0000,v6
v_cvt_pk_bf16_f32 v6,v192,v193
v_lshlrev_b32 v192,16,v6
v_and_b32 v193,0xffff0000,v6
v_cvt_pk_bf16_f32 v6,v194,v195
v_lshlrev_b32 v194,16,v6
v_and_b32 v195,0xffff0000,v6
v_mul_f32 v184,s84,v184
v_mul_f32 v185,s84,v185
v_mul_f32 v186,s84,v186
v_mul_f32 v187,s84,v187
v_mul_f32 v188,s84,v188
v_mul_f32 v189,s84,v189
v_mul_f32 v190,s84,v190
v_mul_f32 v191,s84,v191
v_mul_f32 v192,s84,v192
v_mul_f32 v193,s84,v193
v_mul_f32 v194,s84,v194
v_mul_f32 v195,s84,v195
v_cvt_pk_bf16_f32 v6,v184,v185
v_lshlrev_b32 v184,16,v6
v_and_b32 v185,0xffff0000,v6
v_cvt_pk_bf16_f32 v6,v186,v187
v_lshlrev_b32 v186,16,v6
v_and_b32 v187,0xffff0000,v6
v_cvt_pk_bf16_f32 v6,v188,v189
v_lshlrev_b32 v188,16,v6
v_and_b32 v189,0xffff0000,v6
v_cvt_pk_bf16_f32 v6,v190,v191
v_lshlrev_b32 v190,16,v6
v_and_b32 v191,0xffff0000,v6
v_cvt_pk_bf16_f32 v6,v192,v193
v_lshlrev_b32 v192,16,v6
v_and_b32 v193,0xffff0000,v6
v_cvt_pk_bf16_f32 v6,v194,v195
v_lshlrev_b32 v194,16,v6
v_and_b32 v195,0xffff0000,v6
v_cndmask_b32 v184,v230,v184,s[72:73]
v_cndmask_b32 v185,v230,v185,s[74:75]
v_cndmask_b32 v186,v230,v186,s[76:77]
v_cndmask_b32 v187,v230,v187,s[78:79]
v_cndmask_b32 v192,v230,v192,s[72:73]
v_cndmask_b32 v193,v230,v193,s[74:75]
v_cndmask_b32 v194,v230,v194,s[76:77]
v_cndmask_b32 v195,v230,v195,s[78:79]
v_max3_f32 v241,v188,v189,v190
v_max3_f32 v240,v184,v185,v186
v_max3_f32 v241,v241,v191,v192
v_max_f32 v240,v240,v187
v_max3_f32 v241,v241,v193,v194
v_mov_b32 v244,v240
v_max_f32 v241,v241,v195
s_nop 0
v_permlane32_swap_b32 v240,v244
v_mov_b32 v248,v241
v_max_f32 v240,v240,v244
s_nop 0
v_permlane32_swap_b32 v241,v248
v_mov_b32 v244,v240
v_max_f32 v241,v241,v248
s_nop 0
v_permlane16_swap_b32 v240,v244
v_mov_b32 v248,v241
v_max_f32 v240,v240,v244
s_nop 0
v_permlane16_swap_b32 v241,v248
v_mul_f32 v244,s85,v240
v_max_f32 v241,v241,v248
v_fma_f32 v184,v184,s85,-v244
v_mul_f32 v248,s85,v241
v_fma_f32 v185,v185,s85,-v244
v_fma_f32 v188,v188,s85,-v248
v_fma_f32 v186,v186,s85,-v244
v_fma_f32 v189,v189,s85,-v248
v_fma_f32 v187,v187,s85,-v244
v_fma_f32 v190,v190,s85,-v248
v_exp_f32 v184,v184
v_fma_f32 v191,v191,s85,-v248
v_exp_f32 v185,v185
v_fma_f32 v192,v192,s85,-v248
v_exp_f32 v186,v186
v_fma_f32 v193,v193,s85,-v248
v_exp_f32 v187,v187
v_fma_f32 v194,v194,s85,-v248
v_add_f32 v242,v184,v185
v_fma_f32 v195,v195,s85,-v248
v_add_f32 v242,v242,v186
v_exp_f32 v188,v188
v_add_f32 v242,v242,v187
v_exp_f32 v189,v189
v_exp_f32 v190,v190
v_exp_f32 v191,v191
v_exp_f32 v192,v192
v_exp_f32 v193,v193
v_exp_f32 v194,v194
v_exp_f32 v195,v195
v_add_f32 v243,v188,v189
v_add_f32 v243,v243,v190
v_add_f32 v243,v243,v191
v_add_f32 v243,v243,v192
v_add_f32 v243,v243,v193
v_add_f32 v243,v243,v194
v_add_f32 v243,v243,v195
v_mov_b32 v215,0
v_mov_b32 v225,0
v_mov_b32 v226,0
s_add_u32 s66,s66,149946368
s_lshl_b32 s82,s51,6
s_add_u32 s82,s82,s52
s_lshl_b32 s82,s82,9
s_add_u32 s82,s82,262144
s_lshl_b32 s61,s87,2
s_add_u32 s82,s82,s61
fb_223:
buffer_load_dword v3,v228,s[8:11],s70 offen sc1
s_waitcnt vmcnt(0)
v_cmp_eq_u32 vcc,0,v3
s_nop 0
s_cbranch_vccz ok_224
s_sleep 4
s_sub_u32 s47,s47,1
s_cbranch_scc1 ABORT
s_branch fb_223
ok_224:
buffer_load_dwordx4 v[160:163],v1,s[8:11],s69 offen sc1
buffer_load_dwordx4 v[164:167],v1,s[8:11],s69 offen offset:1024 sc1
buffer_load_dwordx4 v[168:171],v1,s[8:11],s69 offen offset:2048 sc1
s_add_u32 s63,s69,3072
buffer_load_dwordx4 v[172:175],v1,s[8:11],s63 offen sc1
buffer_load_dwordx4 v[176:179],v1,s[8:11],s63 offen offset:1024 sc1
buffer_load_dwordx4 v[180:183],v1,s[8:11],s63 offen offset:2048 sc1
buffer_load_dword v231,v2,s[8:11],s67 offen offset:1024 sc1
s_waitcnt vmcnt(4)
v_mfma_f32_16x16x32_bf16 v[196:199],v[160:163],v[16:19],0
v_mfma_f32_16x16x32_bf16 v[200:203],v[160:163],v[24:27],0
v_mfma_f32_16x16x32_bf16 v[204:207],v[160:163],v[20:23],0
v_mfma_f32_16x16x32_bf16 v[208:211],v[160:163],v[28:31],0
v_mfma_f32_16x16x32_bf16 v[196:199],v[164:167],v[32:35],v[196:199]
v_mfma_f32_16x16x32_bf16 v[200:203],v[164:167],v[40:43],v[200:203]
v_mfma_f32_16x16x32_bf16 v[204:207],v[164:167],v[36:39],v[204:207]
v_mfma_f32_16x16x32_bf16 v[208:211],v[164:167],v[44:47],v[208:211]
v_mfma_f32_16x16x32_bf16 v[196:199],v[168:171],v[48:51],v[196:199]
v_mfma_f32_16x16x32_bf16 v[200:203],v[168:171],v[56:59],v[200:203]
v_mfma_f32_16x16x32_bf16 v[204:207],v[168:171],v[52:55],v[204:207]
v_mfma_f32_16x16x32_bf16 v[208:211],v[168:171],v[60:63],v[208:211]
s_nop 4
v_permlane32_swap_b32 v204,v205
v_permlane32_swap_b32 v196,v197
s_nop 0
v_permlane32_swap_b32 v208,v209
v_permlane32_swap_b32 v200,v201
v_permlane32_swap_b32 v206,v207
v_permlane32_swap_b32 v198,v199
v_permlane32_swap_b32 v210,v211
v_permlane32_swap_b32 v202,v203
v_add_f32 v204,v204,v209
v_add_f32 v196,v196,v201
v_add_f32 v205,v206,v211
v_add_f32 v197,v198,v203
v_cvt_pk_bf16_f32 v248,v204,v205
v_cvt_pk_bf16_f32 v244,v196,v197
v_lshlrev_b32 v204,16,v248
v_lshlrev_b32 v196,16,v244
v_and_b32 v205,0xffff0000,v248
v_and_b32 v197,0xffff0000,v244
v_mul_f32 v204,s84,v204
v_mul_f32 v196,s84,v196
v_mul_f32 v205,s84,v205
v_mul_f32 v197,s84,v197
v_cvt_pk_bf16_f32 v248,v204,v205
v_cvt_pk_bf16_f32 v244,v196,v197
v_lshlrev_b32 v204,16,v248
v_lshlrev_b32 v196,16,v244
v_and_b32 v205,0xffff0000,v248
v_and_b32 v197,0xffff0000,v244
v_max3_f32 v248,v204,v205,v241
v_max3_f32 v244,v196,v197,v240
v_mov_b32 v249,v248
v_mov_b32 v245,v244
s_nop 0
v_permlane32_swap_b32 v248,v249
v_permlane32_swap_b32 v244,v245
v_max_f32 v248,v248,v249
v_max_f32 v244,v244,v245
v_mov_b32 v249,v248
v_mov_b32 v245,v244
s_nop 0
v_permlane16_swap_b32 v248,v249
v_permlane16_swap_b32 v244,v245
v_max_f32 v248,v248,v249
v_max_f32 v244,v244,v245
v_mul_f32 v248,s85,v248
v_mul_f32 v244,s85,v244
v_fma_f32 v250,v241,s85,-v248
v_fma_f32 v246,v240,s85,-v244
v_fma_f32 v204,v204,s85,-v248
v_fma_f32 v196,v196,s85,-v244
v_fma_f32 v205,v205,s85,-v248
v_fma_f32 v197,v197,s85,-v244
v_exp_f32 v250,v250
v_exp_f32 v246,v246
v_exp_f32 v204,v204
v_exp_f32 v196,v196
v_exp_f32 v205,v205
v_exp_f32 v197,v197
v_fma_f32 v248,v250,v243,v204
v_fma_f32 v244,v246,v242,v196
v_add_f32 v248,v248,v205
v_add_f32 v244,v244,v197
v_mov_b32 v249,v248
v_mov_b32 v245,v244
s_nop 0
v_permlane32_swap_b32 v248,v249
v_permlane32_swap_b32 v244,v245
v_add_f32 v248,v248,v249
v_add_f32 v244,v244,v245
v_mov_b32 v249,v248
v_mov_b32 v245,v244
s_nop 0
v_permlane16_swap_b32 v248,v249
v_permlane16_swap_b32 v244,v245
v_add_f32 v248,v248,v249
v_add_f32 v244,v244,v245
v_rcp_f32 v248,v248
v_rcp_f32 v244,v244
v_mul_f32 v250,v250,v248
v_mul_f32 v246,v246,v244
v_mul_f32 v188,v188,v250
v_mul_f32 v184,v184,v246
v_mul_f32 v189,v189,v250
v_mul_f32 v185,v185,v246
v_mul_f32 v190,v190,v250
v_mul_f32 v186,v186,v246
v_mul_f32 v191,v191,v250
v_mul_f32 v187,v187,v246
v_mul_f32 v192,v192,v250
v_cvt_pk_bf16_f32 v212,v184,v185
v_mul_f32 v193,v193,v250
v_cvt_pk_bf16_f32 v213,v186,v187
v_mul_f32 v194,v194,v250
v_mul_f32 v196,v196,v244
v_mul_f32 v195,v195,v250
v_mul_f32 v197,v197,v244
v_cvt_pk_bf16_f32 v220,v188,v189
v_cvt_pk_bf16_f32 v214,v196,v197
v_cvt_pk_bf16_f32 v221,v190,v191
v_cvt_pk_bf16_f32 v222,v192,v193
v_cvt_pk_bf16_f32 v223,v194,v195
v_mul_f32 v204,v204,v248
v_mul_f32 v205,v205,v248
v_cvt_pk_bf16_f32 v224,v204,v205
v_cvt_pk_bf16_f32 v227,v204,v205
s_waitcnt vmcnt(1)
s_cmp_lg_u32 s49,0
s_cbranch_scc1 ATT_OS
v_mfma_f32_16x16x32_bf16 v[64:67],v[112:115],v[220:223],0
v_mfma_f32_16x16x32_bf16 v[68:71],v[116:119],v[220:223],0
v_mfma_f32_16x16x16_bf16 v[64:67],v[172:173],v[224:225],v[64:67]
v_mov_b32 v114,v172
v_mov_b32 v118,v173
v_mfma_f32_16x16x16_bf16 v[68:71],v[172:173],v[226:227],v[68:71]
v_mfma_f32_16x16x32_bf16 v[72:75],v[120:123],v[220:223],0
v_mfma_f32_16x16x32_bf16 v[76:79],v[124:127],v[220:223],0
v_cvt_pk_bf16_f32 v232,v64,v65
v_cvt_pk_bf16_f32 v233,v66,v67
v_mfma_f32_16x16x16_bf16 v[72:75],v[174:175],v[224:225],v[72:75]
v_mov_b32 v122,v174
v_mov_b32 v126,v175
v_mfma_f32_16x16x16_bf16 v[76:79],v[174:175],v[226:227],v[76:79]
v_cvt_pk_bf16_f32 v234,v68,v69
v_cvt_pk_bf16_f32 v235,v70,v71
s_add_u32 s63,s66,256
v_mfma_f32_16x16x32_bf16 v[80:83],v[128:131],v[220:223],0
buffer_store_dwordx4 v[232:235],v229,s[8:11],s63 offen offset:0
v_mfma_f32_16x16x32_bf16 v[84:87],v[132:135],v[220:223],0
v_cvt_pk_bf16_f32 v236,v72,v73
v_cvt_pk_bf16_f32 v237,v74,v75
v_mfma_f32_16x16x16_bf16 v[80:83],v[176:177],v[224:225],v[80:83]
v_mov_b32 v130,v176
v_mov_b32 v134,v177
v_mfma_f32_16x16x16_bf16 v[84:87],v[176:177],v[226:227],v[84:87]
v_cvt_pk_bf16_f32 v238,v76,v77
v_cvt_pk_bf16_f32 v239,v78,v79
v_mfma_f32_16x16x32_bf16 v[88:91],v[136:139],v[220:223],0
buffer_store_dwordx4 v[236:239],v229,s[8:11],s63 offen offset:2048
v_mfma_f32_16x16x32_bf16 v[92:95],v[140:143],v[220:223],0
v_cvt_pk_bf16_f32 v232,v80,v81
v_cvt_pk_bf16_f32 v233,v82,v83
v_mfma_f32_16x16x16_bf16 v[88:91],v[178:179],v[224:225],v[88:91]
v_mov_b32 v138,v178
v_mov_b32 v142,v179
v_mfma_f32_16x16x16_bf16 v[92:95],v[178:179],v[226:227],v[92:95]
v_cvt_pk_bf16_f32 v234,v84,v85
v_cvt_pk_bf16_f32 v235,v86,v87
s_add_u32 s63,s66,4352
v_mfma_f32_16x16x32_bf16 v[96:99],v[144:147],v[220:223],0
buffer_store_dwordx4 v[232:235],v229,s[8:11],s63 offen offset:0
v_mfma_f32_16x16x32_bf16 v[100:103],v[148:151],v[220:223],0
v_cvt_pk_bf16_f32 v236,v88,v89
v_cvt_pk_bf16_f32 v237,v90,v91
v_mfma_f32_16x16x16_bf16 v[96:99],v[180:181],v[224:225],v[96:99]
v_mov_b32 v146,v180
v_mov_b32 v150,v181
v_mfma_f32_16x16x16_bf16 v[100:103],v[180:181],v[226:227],v[100:103]
v_cvt_pk_bf16_f32 v238,v92,v93
v_cvt_pk_bf16_f32 v239,v94,v95
v_mfma_f32_16x16x32_bf16 v[104:107],v[152:155],v[220:223],0
buffer_store_dwordx4 v[236:239],v229,s[8:11],s63 offen offset:2048
v_mfma_f32_16x16x32_bf16 v[108:111],v[156:159],v[220:223],0
v_cvt_pk_bf16_f32 v232,v96,v97
v_cvt_pk_bf16_f32 v233,v98,v99
v_mfma_f32_16x16x16_bf16 v[104:107],v[182:183],v[224:225],v[104:107]
v_mov_b32 v154,v182
v_mov_b32 v158,v183
v_mfma_f32_16x16x16_bf16 v[108:111],v[182:183],v[226:227],v[108:111]
v_cvt_pk_bf16_f32 v234,v100,v101
v_cvt_pk_bf16_f32 v235,v102,v103
s_add_u32 s63,s66,8448
v_mfma_f32_16x16x32_bf16 v[16:19],v[112:115],v[212:215],0
buffer_store_dwordx4 v[232:235],v229,s[8:11],s63 offen offset:0
v_mfma_f32_16x16x32_bf16 v[20:23],v[116:119],v[212:215],0
v_cvt_pk_bf16_f32 v236,v104,v105
v_cvt_pk_bf16_f32 v237,v106,v107
v_mfma_f32_16x16x32_bf16 v[24:27],v[120:123],v[212:215],0
v_cvt_pk_bf16_f32 v238,v108,v109
v_cvt_pk_bf16_f32 v239,v110,v111
v_mfma_f32_16x16x32_bf16 v[28:31],v[124:127],v[212:215],0
buffer_store_dwordx4 v[236:239],v229,s[8:11],s63 offen offset:2048
v_cvt_pk_bf16_f32 v232,v16,v17
v_mfma_f32_16x16x32_bf16 v[32:35],v[128:131],v[212:215],0
v_cvt_pk_bf16_f32 v233,v18,v19
v_cvt_pk_bf16_f32 v234,v20,v21
v_mfma_f32_16x16x32_bf16 v[36:39],v[132:135],v[212:215],0
v_cvt_pk_bf16_f32 v235,v22,v23
s_add_u32 s63,s66,0
v_mfma_f32_16x16x32_bf16 v[40:43],v[136:139],v[212:215],0
buffer_store_dwordx4 v[232:235],v229,s[8:11],s63 offen offset:0
v_cvt_pk_bf16_f32 v236,v24,v25
v_mfma_f32_16x16x32_bf16 v[44:47],v[140:143],v[212:215],0
v_cvt_pk_bf16_f32 v237,v26,v27
v_cvt_pk_bf16_f32 v238,v28,v29
v_mfma_f32_16x16x32_bf16 v[48:51],v[144:147],v[212:215],0
v_cvt_pk_bf16_f32 v239,v30,v31
buffer_store_dwordx4 v[236:239],v229,s[8:11],s63 offen offset:2048
v_mfma_f32_16x16x32_bf16 v[52:55],v[148:151],v[212:215],0
v_cvt_pk_bf16_f32 v232,v32,v33
v_cvt_pk_bf16_f32 v233,v34,v35
v_mfma_f32_16x16x32_bf16 v[56:59],v[152:155],v[212:215],0
v_cvt_pk_bf16_f32 v234,v36,v37
v_cvt_pk_bf16_f32 v235,v38,v39
s_add_u32 s63,s66,4096
v_mfma_f32_16x16x32_bf16 v[60:63],v[156:159],v[212:215],0
buffer_store_dwordx4 v[232:235],v229,s[8:11],s63 offen offset:0
v_cvt_pk_bf16_f32 v236,v40,v41
v_cvt_pk_bf16_f32 v237,v42,v43
v_cvt_pk_bf16_f32 v238,v44,v45
v_cvt_pk_bf16_f32 v239,v46,v47
buffer_store_dwordx4 v[236:239],v229,s[8:11],s63 offen offset:2048
v_cvt_pk_bf16_f32 v232,v48,v49
v_cvt_pk_bf16_f32 v233,v50,v51
v_cvt_pk_bf16_f32 v234,v52,v53
v_cvt_pk_bf16_f32 v235,v54,v55
s_add_u32 s63,s66,8192
buffer_store_dwordx4 v[232:235],v229,s[8:11],s63 offen offset:0
v_cvt_pk_bf16_f32 v236,v56,v57
v_cvt_pk_bf16_f32 v237,v58,v59
v_cvt_pk_bf16_f32 v238,v60,v61
v_cvt_pk_bf16_f32 v239,v62,v63
buffer_store_dwordx4 v[236:239],v229,s[8:11],s63 offen offset:2048
s_waitcnt vmcnt(0)
s_mov_b64 exec,1
buffer_store_dword v5,v1,s[8:11],s82 offen
s_mov_b64 exec,-1
s_branch ATT_OJ
ATT_OS:
v_mfma_f32_16x16x32_bf16 v[64:67],v[112:115],v[220:223],0
v_mfma_f32_16x16x32_bf16 v[68:71],v[116:119],v[220:223],0
v_mfma_f32_16x16x16_bf16 v[64:67],v[172:173],v[224:225],v[64:67]
v_mov_b32 v114,v172
v_mov_b32 v118,v173
v_mfma_f32_16x16x16_bf16 v[68:71],v[172:173],v[226:227],v[68:71]
v_mfma_f32_16x16x32_bf16 v[72:75],v[120:123],v[220:223],0
v_mfma_f32_16x16x32_bf16 v[76:79],v[124:127],v[220:223],0
v_cvt_pk_bf16_f32 v232,v64,v65
v_cvt_pk_bf16_f32 v233,v66,v67
v_mfma_f32_16x16x16_bf16 v[72:75],v[174:175],v[224:225],v[72:75]
v_mov_b32 v122,v174
v_mov_b32 v126,v175
v_mfma_f32_16x16x16_bf16 v[76:79],v[174:175],v[226:227],v[76:79]
v_cvt_pk_bf16_f32 v234,v68,v69
v_cvt_pk_bf16_f32 v235,v70,v71
s_add_u32 s63,s66,256
v_mfma_f32_16x16x32_bf16 v[80:83],v[128:131],v[220:223],0
buffer_store_dwordx4 v[232:235],v229,s[8:11],s63 offen sc1
v_mfma_f32_16x16x32_bf16 v[84:87],v[132:135],v[220:223],0
v_cvt_pk_bf16_f32 v236,v72,v73
v_cvt_pk_bf16_f32 v237,v74,v75
v_mfma_f32_16x16x16_bf16 v[80:83],v[176:177],v[224:225],v[80:83]
v_mov_b32 v130,v176
v_mov_b32 v134,v177
v_mfma_f32_16x16x16_bf16 v[84:87],v[176:177],v[226:227],v[84:87]
v_cvt_pk_bf16_f32 v238,v76,v77
v_cvt_pk_bf16_f32 v239,v78,v79
v_mfma_f32_16x16x32_bf16 v[88:91],v[136:139],v[220:223],0
buffer_store_dwordx4 v[236:239],v229,s[8:11],s63 offen offset:2048 sc1
v_mfma_f32_16x16x32_bf16 v[92:95],v[140:143],v[220:223],0
v_cvt_pk_bf16_f32 v232,v80,v81
v_cvt_pk_bf16_f32 v233,v82,v83
v_mfma_f32_16x16x16_bf16 v[88:91],v[178:179],v[224:225],v[88:91]
v_mov_b32 v138,v178
v_mov_b32 v142,v179
v_mfma_f32_16x16x16_bf16 v[92:95],v[178:179],v[226:227],v[92:95]
v_cvt_pk_bf16_f32 v234,v84,v85
v_cvt_pk_bf16_f32 v235,v86,v87
s_add_u32 s63,s66,4352
v_mfma_f32_16x16x32_bf16 v[96:99],v[144:147],v[220:223],0
buffer_store_dwordx4 v[232:235],v229,s[8:11],s63 offen sc1
v_mfma_f32_16x16x32_bf16 v[100:103],v[148:151],v[220:223],0
v_cvt_pk_bf16_f32 v236,v88,v89
v_cvt_pk_bf16_f32 v237,v90,v91
v_mfma_f32_16x16x16_bf16 v[96:99],v[180:181],v[224:225],v[96:99]
v_mov_b32 v146,v180
v_mov_b32 v150,v181
v_mfma_f32_16x16x16_bf16 v[100:103],v[180:181],v[226:227],v[100:103]
v_cvt_pk_bf16_f32 v238,v92,v93
v_cvt_pk_bf16_f32 v239,v94,v95
v_mfma_f32_16x16x32_bf16 v[104:107],v[152:155],v[220:223],0
buffer_store_dwordx4 v[236:239],v229,s[8:11],s63 offen offset:2048 sc1
v_mfma_f32_16x16x32_bf16 v[108:111],v[156:159],v[220:223],0
v_cvt_pk_bf16_f32 v232,v96,v97
v_cvt_pk_bf16_f32 v233,v98,v99
v_mfma_f32_16x16x16_bf16 v[104:107],v[182:183],v[224:225],v[104:107]
v_mov_b32 v154,v182
v_mov_b32 v158,v183
v_mfma_f32_16x16x16_bf16 v[108:111],v[182:183],v[226:227],v[108:111]
v_cvt_pk_bf16_f32 v234,v100,v101
v_cvt_pk_bf16_f32 v235,v102,v103
s_add_u32 s63,s66,8448
v_mfma_f32_16x16x32_bf16 v[16:19],v[112:115],v[212:215],0
buffer_store_dwordx4 v[232:235],v229,s[8:11],s63 offen sc1
v_mfma_f32_16x16x32_bf16 v[20:23],v[116:119],v[212:215],0
v_cvt_pk_bf16_f32 v236,v104,v105
v_cvt_pk_bf16_f32 v237,v106,v107
v_mfma_f32_16x16x32_bf16 v[24:27],v[120:123],v[212:215],0
v_cvt_pk_bf16_f32 v238,v108,v109
v_cvt_pk_bf16_f32 v239,v110,v111
v_mfma_f32_16x16x32_bf16 v[28:31],v[124:127],v[212:215],0
buffer_store_dwordx4 v[236:239],v229,s[8:11],s63 offen offset:2048 sc1
v_cvt_pk_bf16_f32 v232,v16,v17
v_mfma_f32_16x16x32_bf16 v[32:35],v[128:131],v[212:215],0
v_cvt_pk_bf16_f32 v233,v18,v19
v_cvt_pk_bf16_f32 v234,v20,v21
v_mfma_f32_16x16x32_bf16 v[36:39],v[132:135],v[212:215],0
v_cvt_pk_bf16_f32 v235,v22,v23
s_add_u32 s63,s66,0
v_mfma_f32_16x16x32_bf16 v[40:43],v[136:139],v[212:215],0
buffer_store_dwordx4 v[232:235],v229,s[8:11],s63 offen sc1
v_cvt_pk_bf16_f32 v236,v24,v25
v_mfma_f32_16x16x32_bf16 v[44:47],v[140:143],v[212:215],0
v_cvt_pk_bf16_f32 v237,v26,v27
v_cvt_pk_bf16_f32 v238,v28,v29
v_mfma_f32_16x16x32_bf16 v[48:51],v[144:147],v[212:215],0
v_cvt_pk_bf16_f32 v239,v30,v31
buffer_store_dwordx4 v[236:239],v229,s[8:11],s63 offen offset:2048 sc1
v_mfma_f32_16x16x32_bf16 v[52:55],v[148:151],v[212:215],0
v_cvt_pk_bf16_f32 v232,v32,v33
v_cvt_pk_bf16_f32 v233,v34,v35
v_mfma_f32_16x16x32_bf16 v[56:59],v[152:155],v[212:215],0
v_cvt_pk_bf16_f32 v234,v36,v37
v_cvt_pk_bf16_f32 v235,v38,v39
s_add_u32 s63,s66,4096
v_mfma_f32_16x16x32_bf16 v[60:63],v[156:159],v[212:215],0
buffer_store_dwordx4 v[232:235],v229,s[8:11],s63 offen sc1
v_cvt_pk_bf16_f32 v236,v40,v41
v_cvt_pk_bf16_f32 v237,v42,v43
v_cvt_pk_bf16_f32 v238,v44,v45
v_cvt_pk_bf16_f32 v239,v46,v47
buffer_store_dwordx4 v[236:239],v229,s[8:11],s63 offen offset:2048 sc1
v_cvt_pk_bf16_f32 v232,v48,v49
v_cvt_pk_bf16_f32 v233,v50,v51
v_cvt_pk_bf16_f32 v234,v52,v53
v_cvt_pk_bf16_f32 v235,v54,v55
s_add_u32 s63,s66,8192
buffer_store_dwordx4 v[232:235],v229,s[8:11],s63 offen sc1
v_cvt_pk_bf16_f32 v236,v56,v57
v_cvt_pk_bf16_f32 v237,v58,v59
v_cvt_pk_bf16_f32 v238,v60,v61
v_cvt_pk_bf16_f32 v239,v62,v63
buffer_store_dwordx4 v[236:239],v229,s[8:11],s63 offen offset:2048 sc1
s_waitcnt vmcnt(0)
s_mov_b64 exec,1
buffer_store_dword v5,v1,s[8:11],s82 offen sc1
s_mov_b64 exec,-1
ATT_OJ:
s_add_u32 s69,s69,393216
s_add_u32 s70,s70,2048
s_add_u32 s52,s52,2
s_cmp_lt_u32 s52,64
s_cbranch_scc1 ATT_LOOP
s_endpgm
ROLE_WO:
v_lshlrev_b32 v1,4,v0
v_mov_b32 v5,1
s_lshl_b32 s56,s48,2
s_add_u32 s56,s56,s46
v_bfe_u32 v6,v0,2,2
v_lshrrev_b32 v7,4,v0
v_add_u32 v7,v6,v7
v_and_b32 v7,3,v7
v_and_b32 v15,3,v0
v_lshlrev_b32 v15,4,v15
v_lshl_add_u32 v15,v7,6,v15
v_lshl_add_u32 v15,v6,8,v15
v_lshrrev_b32 v6,5,v0
v_bfe_u32 v7,v0,4,1
v_lshlrev_b32 v16,10,v7
v_lshl_add_u32 v16,v6,8,v16
v_and_b32 v6,15,v0
v_lshl_add_u32 v16,v6,4,v16
v_add_u32 v18,49152,v16
v_lshrrev_b32 v6,5,v0
v_bfe_u32 v7,v0,4,1
v_lshlrev_b32 v20,10,v7
v_lshl_add_u32 v20,v6,8,v20
v_and_b32 v6,15,v0
v_lshl_add_u32 v20,v6,4,v20
v_lshrrev_b32 v6,5,v0
v_add_u32 v6,2,v6
v_bfe_u32 v7,v0,4,1
v_lshlrev_b32 v17,10,v7
v_lshl_add_u32 v17,v6,8,v17
v_and_b32 v6,15,v0
v_lshl_add_u32 v17,v6,4,v17
v_add_u32 v19,49152,v17
v_lshrrev_b32 v6,5,v0
v_add_u32 v6,2,v6
v_bfe_u32 v7,v0,4,1
v_lshlrev_b32 v21,10,v7
v_lshl_add_u32 v21,v6,8,v21
v_and_b32 v6,15,v0
v_lshl_add_u32 v21,v6,4,v21
v_add_u32 v16,0,v1
v_add_u32 v17,1024,v1
v_add_u32 v18,49152,v1
v_add_u32 v19,50176,v1
s_mul_i32 s68,s48,52429
s_lshr_b32 s68,s68,18
s_mul_i32 s60,s68,20
s_sub_u32 s60,s56,s60
s_lshl2_add_u32 s61,s68,s46
s_lshr_b32 s62,s61,3
s_mul_i32 s62,s62,24
s_add_u32 s61,s61,s62
s_lshl_b32 s61,s61,2
v_mov_b32 v2,s61
v_bfe_u32 v6,v0,2,3
v_mul_u32_u24 v20,5120,v6
v_and_b32 v6,3,v0
v_lshl_add_u32 v20,v6,4,v20
v_lshrrev_b32 v6,5,v0
v_lshl_add_u32 v20,v6,6,v20
s_mul_i32 s58,s68,983040
s_lshl_b32 s61,s60,6
s_add_u32 s58,s58,s61
s_mul_i32 s69,s68,40960
s_lshl_b32 s60,s60,8
s_add_u32 s69,s69,s60
s_add_u32 s69,s69,175112192
s_lshl_b32 s75,s56,2
s_add_u32 s75,s75,819200
s_waitcnt vmcnt(0)
s_barrier
s_cmp_lg_u32 s46,0
s_cbranch_scc1 arr_225
v_mov_b32 v6,1
s_lshl_b32 s3,s49,2
v_mov_b32 v7,s3
s_mov_b64 exec,1
buffer_atomic_add v6,v7,s[12:15],0 offen sc1
s_mov_b64 exec,-1
arr_225:
s_lshl_b32 s3,s49,2
v_mov_b32 v7,s3
s_nop 1
ibw_226:
buffer_load_dword v6,v7,s[12:15],0 offen sc1
s_waitcnt vmcnt(0)
v_cmp_ne_u32 vcc,256,v6
s_nop 0
s_cbranch_vccz ok_227
s_sleep 8
s_sub_u32 s47,s47,1
s_cbranch_scc1 ABORT
s_branch ibw_226
ok_227:
s_cmp_lg_u32 s49,0
s_cbranch_scc1 ibok_228
v_and_b32 v7,7,v0
v_lshlrev_b32 v7,2,v7
buffer_load_dword v6,v7,s[12:15],0 offen offset:32 sc1
s_waitcnt vmcnt(0)
v_cmp_ne_u32 vcc,32,v6
s_nop 0
s_cbranch_vccz ibok_228
s_barrier
s_mov_b32 s49,1
s_mov_b32 s3,s2
s_load_dwordx16 s[16:31],s[0:1],0
s_load_dwordx8 s[32:39],s[0:1],64
s_waitcnt lgkmcnt(0)
s_branch DISPATCH
ibok_228:
s_mul_i32 s63,s46,40960
s_mov_b32 s4,s26
s_mov_b32 s5,s27
s_mov_b32 s6,7864320
s_mov_b32 s7,0x20000
v_lshrrev_b32 v9,2,v0
s_mov_b32 s64,1280
v_mul_lo_u32 v9,v9,s64
v_and_b32 v10,3,v0
v_lshl_add_u32 v6,v10,4,v9
s_add_u32 m0,s63,0
s_add_u32 s65,s58,0
buffer_load_dwordx4 v6,s[4:7],s65 offen lds
s_add_u32 m0,s63,1024
s_add_u32 s65,s58,20480
buffer_load_dwordx4 v6,s[4:7],s65 offen lds
s_add_u32 m0,s63,2048
s_add_u32 s65,s58,40960
buffer_load_dwordx4 v6,s[4:7],s65 offen lds
s_add_u32 m0,s63,3072
s_add_u32 s65,s58,61440
buffer_load_dwordx4 v6,s[4:7],s65 offen lds
s_add_u32 m0,s63,4096
s_add_u32 s65,s58,81920
buffer_load_dwordx4 v6,s[4:7],s65 offen lds
s_add_u32 m0,s63,5120
s_add_u32 s65,s58,102400
buffer_load_dwordx4 v6,s[4:7],s65 offen lds
s_add_u32 m0,s63,6144
s_add_u32 s65,s58,122880
buffer_load_dwordx4 v6,s[4:7],s65 offen lds
s_add_u32 m0,s63,7168
s_add_u32 s65,s58,143360
buffer_load_dwordx4 v6,s[4:7],s65 offen lds
s_add_u32 m0,s63,8192
s_add_u32 s65,s58,163840
buffer_load_dwordx4 v6,s[4:7],s65 offen lds
s_add_u32 m0,s63,9216
s_add_u32 s65,s58,184320
buffer_load_dwordx4 v6,s[4:7],s65 offen lds
s_add_u32 m0,s63,10240
s_add_u32 s65,s58,204800
buffer_load_dwordx4 v6,s[4:7],s65 offen lds
s_add_u32 m0,s63,11264
s_add_u32 s65,s58,225280
buffer_load_dwordx4 v6,s[4:7],s65 offen lds
s_add_u32 m0,s63,12288
s_add_u32 s65,s58,245760
buffer_load_dwordx4 v6,s[4:7],s65 offen lds
s_add_u32 m0,s63,13312
s_add_u32 s65,s58,266240
buffer_load_dwordx4 v6,s[4:7],s65 offen lds
s_add_u32 m0,s63,14336
s_add_u32 s65,s58,286720
buffer_load_dwordx4 v6,s[4:7],s65 offen lds
s_add_u32 m0,s63,15360
s_add_u32 s65,s58,307200
buffer_load_dwordx4 v6,s[4:7],s65 offen lds
s_add_u32 m0,s63,16384
s_add_u32 s65,s58,327680
buffer_load_dwordx4 v6,s[4:7],s65 offen lds
s_add_u32 m0,s63,17408
s_add_u32 s65,s58,348160
buffer_load_dwordx4 v6,s[4:7],s65 offen lds
s_add_u32 m0,s63,18432
s_add_u32 s65,s58,368640
buffer_load_dwordx4 v6,s[4:7],s65 offen lds
s_add_u32 m0,s63,19456
s_add_u32 s65,s58,389120
buffer_load_dwordx4 v6,s[4:7],s65 offen lds
s_add_u32 m0,s63,20480
s_add_u32 s65,s58,409600
buffer_load_dwordx4 v6,s[4:7],s65 offen lds
s_add_u32 m0,s63,21504
s_add_u32 s65,s58,430080
buffer_load_dwordx4 v6,s[4:7],s65 offen lds
s_add_u32 m0,s63,22528
s_add_u32 s65,s58,450560
buffer_load_dwordx4 v6,s[4:7],s65 offen lds
s_add_u32 m0,s63,23552
s_add_u32 s65,s58,471040
buffer_load_dwordx4 v6,s[4:7],s65 offen lds
s_add_u32 m0,s63,24576
s_add_u32 s65,s58,491520
buffer_load_dwordx4 v6,s[4:7],s65 offen lds
s_add_u32 m0,s63,25600
s_add_u32 s65,s58,512000
buffer_load_dwordx4 v6,s[4:7],s65 offen lds
s_add_u32 m0,s63,26624
s_add_u32 s65,s58,532480
buffer_load_dwordx4 v6,s[4:7],s65 offen lds
s_add_u32 m0,s63,27648
s_add_u32 s65,s58,552960
buffer_load_dwordx4 v6,s[4:7],s65 offen lds
s_add_u32 m0,s63,28672
s_add_u32 s65,s58,573440
buffer_load_dwordx4 v6,s[4:7],s65 offen lds
s_add_u32 m0,s63,29696
s_add_u32 s65,s58,593920
buffer_load_dwordx4 v6,s[4:7],s65 offen lds
s_add_u32 m0,s63,30720
s_add_u32 s65,s58,614400
buffer_load_dwordx4 v6,s[4:7],s65 offen lds
s_add_u32 m0,s63,31744
s_add_u32 s65,s58,634880
buffer_load_dwordx4 v6,s[4:7],s65 offen lds
s_add_u32 m0,s63,32768
s_add_u32 s65,s58,655360
buffer_load_dwordx4 v6,s[4:7],s65 offen lds
s_add_u32 m0,s63,33792
s_add_u32 s65,s58,675840
buffer_load_dwordx4 v6,s[4:7],s65 offen lds
s_add_u32 m0,s63,34816
s_add_u32 s65,s58,696320
buffer_load_dwordx4 v6,s[4:7],s65 offen lds
s_add_u32 m0,s63,35840
s_add_u32 s65,s58,716800
buffer_load_dwordx4 v6,s[4:7],s65 offen lds
s_add_u32 m0,s63,36864
s_add_u32 s65,s58,737280
buffer_load_dwordx4 v6,s[4:7],s65 offen lds
s_add_u32 m0,s63,37888
s_add_u32 s65,s58,757760
buffer_load_dwordx4 v6,s[4:7],s65 offen lds
s_add_u32 m0,s63,38912
s_add_u32 s65,s58,778240
buffer_load_dwordx4 v6,s[4:7],s65 offen lds
s_add_u32 m0,s63,39936
s_add_u32 s65,s58,798720
buffer_load_dwordx4 v6,s[4:7],s65 offen lds
s_waitcnt vmcnt(20)
v_bfe_u32 v9,v0,2,2
v_lshrrev_b32 v10,5,v0
v_lshl_add_u32 v9,v10,2,v9
v_mul_u32_u24 v9,64,v9
v_and_b32 v10,1,v0
v_lshl_add_u32 v9,v10,3,v9
v_bfe_u32 v10,v0,1,1
v_lshl_add_u32 v9,v10,5,v9
v_bfe_u32 v10,v0,4,1
v_lshl_add_u32 v9,v10,4,v9
v_add_u32 v7,s63,v9
ds_read_b64_tr_b16 a[0:1],v7 offset:0
ds_read_b64_tr_b16 a[2:3],v7 offset:1024
ds_read_b64_tr_b16 a[4:5],v7 offset:512
ds_read_b64_tr_b16 a[6:7],v7 offset:1536
ds_read_b64_tr_b16 a[8:9],v7 offset:2048
ds_read_b64_tr_b16 a[10:11],v7 offset:3072
ds_read_b64_tr_b16 a[12:13],v7 offset:2560
ds_read_b64_tr_b16 a[14:15],v7 offset:3584
ds_read_b64_tr_b16 a[16:17],v7 offset:4096
ds_read_b64_tr_b16 a[18:19],v7 offset:5120
ds_read_b64_tr_b16 a[20:21],v7 offset:4608
ds_read_b64_tr_b16 a[22:23],v7 offset:5632
s_waitcnt lgkmcnt(4)
ds_read_b64_tr_b16 a[24:25],v7 offset:6144
ds_read_b64_tr_b16 a[26:27],v7 offset:7168
ds_read_b64_tr_b16 a[28:29],v7 offset:6656
ds_read_b64_tr_b16 a[30:31],v7 offset:7680
ds_read_b64_tr_b16 a[32:33],v7 offset:8192
ds_read_b64_tr_b16 a[34:35],v7 offset:9216
ds_read_b64_tr_b16 a[36:37],v7 offset:8704
ds_read_b64_tr_b16 a[38:39],v7 offset:9728
ds_read_b64_tr_b16 a[40:41],v7 offset:10240
ds_read_b64_tr_b16 a[42:43],v7 offset:11264
ds_read_b64_tr_b16 a[44:45],v7 offset:10752
ds_read_b64_tr_b16 a[46:47],v7 offset:11776
s_waitcnt lgkmcnt(4)
ds_read_b64_tr_b16 a[48:49],v7 offset:12288
ds_read_b64_tr_b16 a[50:51],v7 offset:13312
ds_read_b64_tr_b16 a[52:53],v7 offset:12800
ds_read_b64_tr_b16 a[54:55],v7 offset:13824
ds_read_b64_tr_b16 a[56:57],v7 offset:14336
ds_read_b64_tr_b16 a[58:59],v7 offset:15360
ds_read_b64_tr_b16 a[60:61],v7 offset:14848
ds_read_b64_tr_b16 a[62:63],v7 offset:15872
ds_read_b64_tr_b16 a[64:65],v7 offset:16384
ds_read_b64_tr_b16 a[66:67],v7 offset:17408
ds_read_b64_tr_b16 a[68:69],v7 offset:16896
ds_read_b64_tr_b16 a[70:71],v7 offset:17920
s_waitcnt lgkmcnt(4)
ds_read_b64_tr_b16 a[72:73],v7 offset:18432
ds_read_b64_tr_b16 a[74:75],v7 offset:19456
ds_read_b64_tr_b16 a[76:77],v7 offset:18944
ds_read_b64_tr_b16 a[78:79],v7 offset:19968
s_waitcnt lgkmcnt(0)
s_add_u32 m0,s63,0
s_add_u32 s65,s58,819200
buffer_load_dwordx4 v6,s[4:7],s65 offen lds
s_add_u32 m0,s63,1024
s_add_u32 s65,s58,839680
buffer_load_dwordx4 v6,s[4:7],s65 offen lds
s_add_u32 m0,s63,2048
s_add_u32 s65,s58,860160
buffer_load_dwordx4 v6,s[4:7],s65 offen lds
s_add_u32 m0,s63,3072
s_add_u32 s65,s58,880640
buffer_load_dwordx4 v6,s[4:7],s65 offen lds
s_add_u32 m0,s63,4096
s_add_u32 s65,s58,901120
buffer_load_dwordx4 v6,s[4:7],s65 offen lds
s_add_u32 m0,s63,5120
s_add_u32 s65,s58,921600
buffer_load_dwordx4 v6,s[4:7],s65 offen lds
s_add_u32 m0,s63,6144
s_add_u32 s65,s58,942080
buffer_load_dwordx4 v6,s[4:7],s65 offen lds
s_add_u32 m0,s63,7168
s_add_u32 s65,s58,962560
buffer_load_dwordx4 v6,s[4:7],s65 offen lds
s_waitcnt vmcnt(8)
v_bfe_u32 v9,v0,2,2
v_lshrrev_b32 v10,5,v0
v_lshl_add_u32 v9,v10,2,v9
v_mul_u32_u24 v9,64,v9
v_and_b32 v10,1,v0
v_lshl_add_u32 v9,v10,3,v9
v_bfe_u32 v10,v0,1,1
v_lshl_add_u32 v9,v10,5,v9
v_bfe_u32 v10,v0,4,1
v_lshl_add_u32 v9,v10,4,v9
v_add_u32 v7,s63,v9
ds_read_b64_tr_b16 a[80:81],v7 offset:20480
ds_read_b64_tr_b16 a[82:83],v7 offset:21504
ds_read_b64_tr_b16 a[84:85],v7 offset:20992
ds_read_b64_tr_b16 a[86:87],v7 offset:22016
ds_read_b64_tr_b16 a[88:89],v7 offset:22528
ds_read_b64_tr_b16 a[90:91],v7 offset:23552
ds_read_b64_tr_b16 a[92:93],v7 offset:23040
ds_read_b64_tr_b16 a[94:95],v7 offset:24064
ds_read_b64_tr_b16 a[96:97],v7 offset:24576
ds_read_b64_tr_b16 a[98:99],v7 offset:25600
ds_read_b64_tr_b16 a[100:101],v7 offset:25088
ds_read_b64_tr_b16 a[102:103],v7 offset:26112
s_waitcnt lgkmcnt(4)
ds_read_b64_tr_b16 a[104:105],v7 offset:26624
ds_read_b64_tr_b16 a[106:107],v7 offset:27648
ds_read_b64_tr_b16 a[108:109],v7 offset:27136
ds_read_b64_tr_b16 a[110:111],v7 offset:28160
ds_read_b64_tr_b16 a[112:113],v7 offset:28672
ds_read_b64_tr_b16 a[114:115],v7 offset:29696
ds_read_b64_tr_b16 a[116:117],v7 offset:29184
ds_read_b64_tr_b16 a[118:119],v7 offset:30208
ds_read_b64_tr_b16 a[120:121],v7 offset:30720
ds_read_b64_tr_b16 a[122:123],v7 offset:31744
ds_read_b64_tr_b16 a[124:125],v7 offset:31232
ds_read_b64_tr_b16 a[126:127],v7 offset:32256
s_waitcnt lgkmcnt(4)
ds_read_b64_tr_b16 a[128:129],v7 offset:32768
ds_read_b64_tr_b16 a[130:131],v7 offset:33792
ds_read_b64_tr_b16 a[132:133],v7 offset:33280
ds_read_b64_tr_b16 a[134:135],v7 offset:34304
ds_read_b64_tr_b16 a[136:137],v7 offset:34816
ds_read_b64_tr_b16 a[138:139],v7 offset:35840
ds_read_b64_tr_b16 a[140:141],v7 offset:35328
ds_read_b64_tr_b16 a[142:143],v7 offset:36352
ds_read_b64_tr_b16 a[144:145],v7 offset:36864
ds_read_b64_tr_b16 a[146:147],v7 offset:37888
ds_read_b64_tr_b16 a[148:149],v7 offset:37376
ds_read_b64_tr_b16 a[150:151],v7 offset:38400
s_waitcnt lgkmcnt(4)
ds_read_b64_tr_b16 a[152:153],v7 offset:38912
ds_read_b64_tr_b16 a[154:155],v7 offset:39936
ds_read_b64_tr_b16 a[156:157],v7 offset:39424
ds_read_b64_tr_b16 a[158:159],v7 offset:40448
s_waitcnt lgkmcnt(0)
s_waitcnt vmcnt(0)
v_bfe_u32 v9,v0,2,2
v_lshrrev_b32 v10,5,v0
v_lshl_add_u32 v9,v10,2,v9
v_mul_u32_u24 v9,64,v9
v_and_b32 v10,1,v0
v_lshl_add_u32 v9,v10,3,v9
v_bfe_u32 v10,v0,1,1
v_lshl_add_u32 v9,v10,5,v9
v_bfe_u32 v10,v0,4,1
v_lshl_add_u32 v9,v10,4,v9
v_add_u32 v7,s63,v9
ds_read_b64_tr_b16 a[160:161],v7 offset:0
ds_read_b64_tr_b16 a[162:163],v7 offset:1024
ds_read_b64_tr_b16 a[164:165],v7 offset:512
ds_read_b64_tr_b16 a[166:167],v7 offset:1536
ds_read_b64_tr_b16 a[168:169],v7 offset:2048
ds_read_b64_tr_b16 a[170:171],v7 offset:3072
ds_read_b64_tr_b16 a[172:173],v7 offset:2560
ds_read_b64_tr_b16 a[174:175],v7 offset:3584
ds_read_b64_tr_b16 a[176:177],v7 offset:4096
ds_read_b64_tr_b16 a[178:179],v7 offset:5120
ds_read_b64_tr_b16 a[180:181],v7 offset:4608
ds_read_b64_tr_b16 a[182:183],v7 offset:5632
s_waitcnt lgkmcnt(4)
ds_read_b64_tr_b16 a[184:185],v7 offset:6144
ds_read_b64_tr_b16 a[186:187],v7 offset:7168
ds_read_b64_tr_b16 a[188:189],v7 offset:6656
ds_read_b64_tr_b16 a[190:191],v7 offset:7680
s_waitcnt lgkmcnt(0)
s_barrier
s_mov_b32 s50,0
s_mov_b32 s32,0
s_mov_b32 s57,0
s_mov_b32 s59,2147483648
s_mov_b32 s82,2147483648
s_mov_b32 s39,2147483648
v_mov_b32 v22,100352
v_lshl_add_u32 v22,v0,2,v22
v_mov_b32 v23,0
ds_write_b32 v22,v23
s_mov_b32 s39,1600000
v_and_b32 v72,15,v0
v_lshlrev_b32 v72,7,v72
s_mov_b64 s[76:77],-1
s_mov_b64 s[80:81],-1
s_waitcnt lgkmcnt(0)
s_barrier
s_mov_b32 s83,s100
s_min_u32 s62,s32,127
s_sub_u32 s60,s62,14
s_lshr_b32 s34,s60,1
s_and_b32 s33,s60,1
s_cmp_eq_u32 s33,0
s_cselect_b32 s61,14,0
s_add_u32 s34,s34,s61
s_sub_u32 s61,s60,50
s_cmp_ge_u32 s60,100
s_cselect_b32 s34,s61,s34
s_cselect_b32 s33,1,s33
s_cmp_lt_u32 s62,14
s_cselect_b32 s34,s62,s34
s_cselect_b32 s33,0,s33
s_lshl_b32 s35,s33,6
s_add_u32 s35,s35,s34
s_lshl_b32 s35,s35,9
s_add_u32 s35,s35,262144
s_sub_u32 s57,49152,s57
v_swap_b32 v16,v18
v_swap_b32 v17,v19
s_add_u32 s62,s32,1
s_min_u32 s62,s62,127
s_sub_u32 s60,s62,14
s_lshr_b32 s41,s60,1
s_and_b32 s40,s60,1
s_cmp_eq_u32 s40,0
s_cselect_b32 s61,14,0
s_add_u32 s41,s41,s61
s_sub_u32 s61,s60,50
s_cmp_ge_u32 s60,100
s_cselect_b32 s41,s61,s41
s_cselect_b32 s40,1,s40
s_cmp_lt_u32 s62,14
s_cselect_b32 s41,s62,s41
s_cselect_b32 s40,0,s40
s_lshl_b32 s42,s40,6
s_add_u32 s42,s42,s41
s_lshl_b32 s42,s42,9
s_add_u32 s42,s42,262144
WO_COLD:
s_mov_b32 s37,0
fb_229:
buffer_load_dword v3,v2,s[8:11],s35 offen sc1
s_waitcnt vmcnt(0)
v_cmp_eq_u32 vcc,0,v3
s_and_b64 vcc,vcc,s[76:77]
s_cbranch_scc0 ok_230
s_sleep 1
s_sub_u32 s47,s47,1
s_cbranch_scc1 ABORT
s_branch fb_229
ok_230:
WO_COLD2:
s_sub_u32 s66,49152,s57
s_mul_i32 s60,s34,393216
s_add_u32 s60,s60,s37
s_mul_i32 s61,s68,49152
s_add_u32 s60,s60,s61
s_mul_i32 s61,s46,12288
s_add_u32 s60,s60,s61
s_add_u32 s60,s60,149946368
s_add_u32 s61,s61,s66
s_add_u32 m0,s61,0
s_add_u32 s63,s60,0
buffer_load_dwordx4 v1,s[8:11],s63 offen sc1 lds
buffer_load_dwordx4 v1,s[8:11],s63 offen offset:1024 sc1 lds
buffer_load_dwordx4 v1,s[8:11],s63 offen offset:2048 sc1 lds
buffer_load_dwordx4 v1,s[8:11],s63 offen offset:3072 sc1 lds
s_add_u32 m0,s61,4096
s_add_u32 s63,s60,4096
buffer_load_dwordx4 v1,s[8:11],s63 offen sc1 lds
buffer_load_dwordx4 v1,s[8:11],s63 offen offset:1024 sc1 lds
buffer_load_dwordx4 v1,s[8:11],s63 offen offset:2048 sc1 lds
buffer_load_dwordx4 v1,s[8:11],s63 offen offset:3072 sc1 lds
s_waitcnt vmcnt(7)
s_mov_b64 exec,1
buffer_store_dword v5,v1,s[8:11],s59 offen sc1
s_mov_b64 exec,-1
s_mov_b32 s59,2147483648
s_add_u32 m0,s61,8192
s_add_u32 s63,s60,8192
buffer_load_dwordx4 v1,s[8:11],s63 offen sc1 lds
buffer_load_dwordx4 v1,s[8:11],s63 offen offset:1024 sc1 lds
buffer_load_dwordx4 v1,s[8:11],s63 offen offset:2048 sc1 lds
buffer_load_dwordx4 v1,s[8:11],s63 offen offset:3072 sc1 lds
s_mov_b32 s35,s42
buffer_load_dword v3,v2,s[8:11],s35 offen sc1
s_mov_b32 s53,s33
s_mov_b32 s54,s34
s_add_u32 s32,s32,1
s_mov_b32 s33,s40
s_mov_b32 s34,s41
s_mov_b64 s[76:77],s[80:81]
s_sub_u32 s57,49152,s57
v_swap_b32 v16,v18
v_swap_b32 v17,v19
s_mov_b32 s51,s53
s_mov_b32 s52,s54
s_mov_b32 s37,2147483648
s_waitcnt vmcnt(6)
s_branch WO_GO
WO_NEXT:
s_sub_u32 s57,49152,s57
v_swap_b32 v16,v18
v_swap_b32 v17,v19
s_mov_b32 s51,s53
s_mov_b32 s52,s54
s_waitcnt vmcnt(2)
v_cmp_eq_u32 vcc,0,v3
s_and_b64 vcc,vcc,s[76:77]
s_cselect_b32 s37,2147483648,0
s_cmp_lt_u32 s32,128
s_cselect_b32 s37,s37,2147483648
WO_GO:
s_barrier
ds_read_b128 v[24:27],v16 offset:0
ds_read_b128 v[28:31],v17 offset:0
ds_read_b128 v[32:35],v16 offset:12288
ds_read_b128 v[36:39],v17 offset:12288
ds_read_b128 v[40:43],v16 offset:24576
ds_read_b128 v[44:47],v17 offset:24576
ds_read_b128 v[48:51],v16 offset:36864
s_waitcnt lgkmcnt(6)
v_mfma_f32_32x32x16_bf16 v[56:71],a[0:3],v[24:27],0
ds_read_b128 v[52:55],v17 offset:36864
s_sub_u32 s66,49152,s57
s_mul_i32 s60,s34,393216
s_add_u32 s60,s60,s37
s_waitcnt lgkmcnt(6)
v_mfma_f32_32x32x16_bf16 v[56:71],a[4:7],v[28:31],v[56:71]
ds_read_b128 v[24:27],v16 offset:2048
s_mul_i32 s61,s68,49152
s_add_u32 s60,s60,s61
s_mul_i32 s61,s46,12288
s_waitcnt lgkmcnt(5)
v_mfma_f32_32x32x16_bf16 v[56:71],a[48:51],v[32:35],v[56:71]
ds_read_b128 v[28:31],v17 offset:2048
s_add_u32 s60,s60,s61
s_add_u32 s60,s60,149946368
s_add_u32 s61,s61,s66
s_add_u32 m0,s61,0
v_mfma_f32_32x32x16_bf16 v[56:71],a[52:55],v[36:39],v[56:71]
ds_read_b128 v[32:35],v16 offset:14336
s_add_u32 s63,s60,0
buffer_load_dwordx4 v1,s[8:11],s63 offen sc1 lds
s_waitcnt lgkmcnt(5)
v_mfma_f32_32x32x16_bf16 v[56:71],a[96:99],v[40:43],v[56:71]
ds_read_b128 v[36:39],v17 offset:14336
s_mul_i32 s71,s52,491520
s_add_u32 s71,s71,s69
s_lshl_b32 s70,s51,6
s_add_u32 s70,s70,s52
v_mfma_f32_32x32x16_bf16 v[56:71],a[100:103],v[44:47],v[56:71]
ds_read_b128 v[40:43],v16 offset:26624
buffer_load_dwordx4 v1,s[8:11],s63 offen offset:1024 sc1 lds
s_mul_i32 s70,s70,640
s_waitcnt lgkmcnt(5)
v_mfma_f32_32x32x16_bf16 v[56:71],a[144:147],v[48:51],v[56:71]
ds_read_b128 v[44:47],v17 offset:26624
s_add_u32 s82,s70,s75
v_mfma_f32_32x32x16_bf16 v[56:71],a[148:151],v[52:55],v[56:71]
ds_read_b128 v[48:51],v16 offset:38912
buffer_load_dwordx4 v1,s[8:11],s63 offen offset:2048 sc1 lds
s_waitcnt lgkmcnt(5)
v_mfma_f32_32x32x16_bf16 v[56:71],a[8:11],v[24:27],v[56:71]
ds_read_b128 v[52:55],v17 offset:38912
v_mfma_f32_32x32x16_bf16 v[56:71],a[12:15],v[28:31],v[56:71]
ds_read_b128 v[24:27],v16 offset:4096
buffer_load_dwordx4 v1,s[8:11],s63 offen offset:3072 sc1 lds
s_add_u32 m0,s61,4096
s_waitcnt lgkmcnt(5)
v_mfma_f32_32x32x16_bf16 v[56:71],a[56:59],v[32:35],v[56:71]
ds_read_b128 v[28:31],v17 offset:4096
s_add_u32 s63,s60,4096
v_mfma_f32_32x32x16_bf16 v[56:71],a[60:63],v[36:39],v[56:71]
ds_read_b128 v[32:35],v16 offset:16384
buffer_load_dwordx4 v1,s[8:11],s63 offen sc1 lds
s_waitcnt lgkmcnt(5)
v_mfma_f32_32x32x16_bf16 v[56:71],a[104:107],v[40:43],v[56:71]
ds_read_b128 v[36:39],v17 offset:16384
v_mfma_f32_32x32x16_bf16 v[56:71],a[108:111],v[44:47],v[56:71]
ds_read_b128 v[40:43],v16 offset:28672
buffer_load_dwordx4 v1,s[8:11],s63 offen offset:1024 sc1 lds
s_waitcnt lgkmcnt(5)
v_mfma_f32_32x32x16_bf16 v[56:71],a[152:155],v[48:51],v[56:71]
ds_read_b128 v[44:47],v17 offset:28672
v_mfma_f32_32x32x16_bf16 v[56:71],a[156:159],v[52:55],v[56:71]
ds_read_b128 v[48:51],v16 offset:40960
buffer_load_dwordx4 v1,s[8:11],s63 offen offset:2048 sc1 lds
s_waitcnt lgkmcnt(5)
v_mfma_f32_32x32x16_bf16 v[56:71],a[16:19],v[24:27],v[56:71]
ds_read_b128 v[52:55],v17 offset:40960
v_mfma_f32_32x32x16_bf16 v[56:71],a[20:23],v[28:31],v[56:71]
ds_read_b128 v[24:27],v16 offset:6144
buffer_load_dwordx4 v1,s[8:11],s63 offen offset:3072 sc1 lds
s_add_u32 m0,s61,8192
s_waitcnt lgkmcnt(5)
v_mfma_f32_32x32x16_bf16 v[56:71],a[64:67],v[32:35],v[56:71]
ds_read_b128 v[28:31],v17 offset:6144
s_add_u32 s63,s60,8192
v_mfma_f32_32x32x16_bf16 v[56:71],a[68:71],v[36:39],v[56:71]
ds_read_b128 v[32:35],v16 offset:18432
buffer_load_dwordx4 v1,s[8:11],s63 offen sc1 lds
s_waitcnt lgkmcnt(5)
v_mfma_f32_32x32x16_bf16 v[56:71],a[112:115],v[40:43],v[56:71]
ds_read_b128 v[36:39],v17 offset:18432
v_mfma_f32_32x32x16_bf16 v[56:71],a[116:119],v[44:47],v[56:71]
ds_read_b128 v[40:43],v16 offset:30720
buffer_load_dwordx4 v1,s[8:11],s63 offen offset:1024 sc1 lds
s_waitcnt lgkmcnt(5)
v_mfma_f32_32x32x16_bf16 v[56:71],a[160:163],v[48:51],v[56:71]
ds_read_b128 v[44:47],v17 offset:30720
v_mfma_f32_32x32x16_bf16 v[56:71],a[164:167],v[52:55],v[56:71]
ds_read_b128 v[48:51],v16 offset:43008
buffer_load_dwordx4 v1,s[8:11],s63 offen offset:2048 sc1 lds
s_waitcnt lgkmcnt(5)
v_mfma_f32_32x32x16_bf16 v[56:71],a[24:27],v[24:27],v[56:71]
ds_read_b128 v[52:55],v17 offset:43008
s_waitcnt vmcnt(11)
s_mov_b64 exec,1
buffer_store_dword v5,v1,s[8:11],s59 offen sc1
s_mov_b64 exec,-1
s_mov_b32 s59,2147483648
s_barrier
v_mfma_f32_32x32x16_bf16 v[56:71],a[28:31],v[28:31],v[56:71]
ds_read_b128 v[24:27],v16 offset:8192
buffer_load_dwordx4 v1,s[8:11],s63 offen offset:3072 sc1 lds
s_add_u32 s62,s32,1
s_waitcnt lgkmcnt(5)
v_mfma_f32_32x32x16_bf16 v[56:71],a[72:75],v[32:35],v[56:71]
ds_read_b128 v[28:31],v17 offset:8192
s_min_u32 s62,s62,127
s_sub_u32 s60,s62,14
s_lshr_b32 s41,s60,1
s_and_b32 s40,s60,1
v_mfma_f32_32x32x16_bf16 v[56:71],a[76:79],v[36:39],v[56:71]
ds_read_b128 v[32:35],v16 offset:20480
s_cmp_eq_u32 s40,0
s_cselect_b32 s61,14,0
s_add_u32 s41,s41,s61
s_waitcnt lgkmcnt(5)
v_mfma_f32_32x32x16_bf16 v[56:71],a[120:123],v[40:43],v[56:71]
ds_read_b128 v[36:39],v17 offset:20480
s_sub_u32 s61,s60,50
s_cmp_ge_u32 s60,100
s_cselect_b32 s41,s61,s41
s_cselect_b32 s40,1,s40
v_mfma_f32_32x32x16_bf16 v[56:71],a[124:127],v[44:47],v[56:71]
ds_read_b128 v[40:43],v16 offset:32768
s_cmp_lt_u32 s62,14
s_cselect_b32 s41,s62,s41
s_cselect_b32 s40,0,s40
s_waitcnt lgkmcnt(5)
v_mfma_f32_32x32x16_bf16 v[56:71],a[168:171],v[48:51],v[56:71]
ds_read_b128 v[44:47],v17 offset:32768
s_lshl_b32 s42,s40,6
s_add_u32 s42,s42,s41
s_lshl_b32 s42,s42,9
s_add_u32 s42,s42,262144
v_mfma_f32_32x32x16_bf16 v[56:71],a[172:175],v[52:55],v[56:71]
ds_read_b128 v[48:51],v16 offset:45056
s_waitcnt lgkmcnt(5)
v_mfma_f32_32x32x16_bf16 v[56:71],a[32:35],v[24:27],v[56:71]
ds_read_b128 v[52:55],v17 offset:45056
v_mfma_f32_32x32x16_bf16 v[56:71],a[36:39],v[28:31],v[56:71]
ds_read_b128 v[24:27],v16 offset:10240
s_waitcnt lgkmcnt(5)
v_mfma_f32_32x32x16_bf16 v[56:71],a[80:83],v[32:35],v[56:71]
ds_read_b128 v[28:31],v17 offset:10240
v_mfma_f32_32x32x16_bf16 v[56:71],a[84:87],v[36:39],v[56:71]
ds_read_b128 v[32:35],v16 offset:22528
s_waitcnt lgkmcnt(5)
v_mfma_f32_32x32x16_bf16 v[56:71],a[128:131],v[40:43],v[56:71]
ds_read_b128 v[36:39],v17 offset:22528
buffer_load_dword v3,v2,s[8:11],s35 offen sc1
v_mfma_f32_32x32x16_bf16 v[56:71],a[132:135],v[44:47],v[56:71]
ds_read_b128 v[40:43],v16 offset:34816
s_waitcnt lgkmcnt(5)
v_mfma_f32_32x32x16_bf16 v[56:71],a[176:179],v[48:51],v[56:71]
ds_read_b128 v[44:47],v17 offset:34816
v_mfma_f32_32x32x16_bf16 v[56:71],a[180:183],v[52:55],v[56:71]
ds_read_b128 v[48:51],v16 offset:47104
s_waitcnt lgkmcnt(5)
v_mfma_f32_32x32x16_bf16 v[56:71],a[40:43],v[24:27],v[56:71]
ds_read_b128 v[52:55],v17 offset:47104
v_mfma_f32_32x32x16_bf16 v[56:71],a[44:47],v[28:31],v[56:71]
s_waitcnt lgkmcnt(4)
v_mfma_f32_32x32x16_bf16 v[56:71],a[88:91],v[32:35],v[56:71]
v_mfma_f32_32x32x16_bf16 v[56:71],a[92:95],v[36:39],v[56:71]
s_waitcnt lgkmcnt(2)
v_mfma_f32_32x32x16_bf16 v[56:71],a[136:139],v[40:43],v[56:71]
v_mfma_f32_32x32x16_bf16 v[56:71],a[140:143],v[44:47],v[56:71]
s_waitcnt lgkmcnt(0)
v_mfma_f32_32x32x16_bf16 v[56:71],a[184:187],v[48:51],v[56:71]
v_mfma_f32_32x32x16_bf16 v[56:71],a[188:191],v[52:55],v[56:71]
s_cmp_eq_u32 s37,0
s_cbranch_scc0 sec_233
s_mov_b32 s35,s42
buffer_load_dword v3,v2,s[8:11],s35 offen sc1
s_mov_b32 s53,s33
s_mov_b32 s54,s34
s_add_u32 s32,s32,1
s_mov_b32 s33,s40
s_mov_b32 s34,s41
s_mov_b64 s[76:77],s[80:81]
s_nop 2
ep_231:
v_cvt_pk_bf16_f32 v112,v56,v57
v_cvt_pk_bf16_f32 v113,v58,v59
v_cvt_pk_bf16_f32 v114,v60,v61
v_cvt_pk_bf16_f32 v115,v62,v63
v_cvt_pk_bf16_f32 v116,v64,v65
v_cvt_pk_bf16_f32 v117,v66,v67
v_cvt_pk_bf16_f32 v118,v68,v69
v_cvt_pk_bf16_f32 v119,v70,v71
buffer_store_dwordx4 v[112:115],v20,s[8:11],s71 offen sc1
buffer_store_dwordx4 v[116:119],v20,s[8:11],s71 offen offset:128 sc1
s_mov_b32 s59,s82
s_cmp_eq_u32 s37,0
s_cbranch_scc1 WO_NEXT
s_waitcnt vmcnt(2)
v_cmp_eq_u32 vcc,0,v3
s_and_b64 vcc,vcc,s[76:77]
s_cselect_b32 s37,2147483648,0
s_cmp_lt_u32 s32,128
s_cselect_b32 s37,s37,2147483648
s_cmp_eq_u32 s37,0
s_cbranch_scc1 WO_COLD2
s_waitcnt vmcnt(0)
s_mov_b64 exec,1
buffer_store_dword v5,v1,s[8:11],s59 offen sc1
s_mov_b64 exec,-1
s_mov_b32 s59,2147483648
s_cmp_lt_u32 s32,128
s_cbranch_scc1 WO_COLD
s_branch WO_END
sec_233:
s_waitcnt vmcnt(0)
v_cmp_eq_u32 vcc,0,v3
s_and_b64 vcc,vcc,s[76:77]
s_cselect_b32 s37,2147483648,0
s_cmp_lt_u32 s32,128
s_cselect_b32 s37,s37,2147483648
s_cmp_lg_u32 s37,0
s_cbranch_scc1 nr_232
s_sub_u32 s66,49152,s57
s_mul_i32 s60,s34,393216
s_add_u32 s60,s60,s37
s_mul_i32 s61,s68,49152
s_add_u32 s60,s60,s61
s_mul_i32 s61,s46,12288
s_add_u32 s60,s60,s61
s_add_u32 s60,s60,149946368
s_add_u32 s61,s61,s66
s_add_u32 m0,s61,0
s_add_u32 s63,s60,0
buffer_load_dwordx4 v1,s[8:11],s63 offen sc1 lds
v_cvt_pk_bf16_f32 v112,v56,v57
buffer_load_dwordx4 v1,s[8:11],s63 offen offset:1024 sc1 lds
v_cvt_pk_bf16_f32 v113,v58,v59
buffer_load_dwordx4 v1,s[8:11],s63 offen offset:2048 sc1 lds
v_cvt_pk_bf16_f32 v114,v60,v61
buffer_load_dwordx4 v1,s[8:11],s63 offen offset:3072 sc1 lds
v_cvt_pk_bf16_f32 v115,v62,v63
s_add_u32 m0,s61,4096
s_add_u32 s63,s60,4096
buffer_load_dwordx4 v1,s[8:11],s63 offen sc1 lds
v_cvt_pk_bf16_f32 v116,v64,v65
buffer_load_dwordx4 v1,s[8:11],s63 offen offset:1024 sc1 lds
v_cvt_pk_bf16_f32 v117,v66,v67
buffer_load_dwordx4 v1,s[8:11],s63 offen offset:2048 sc1 lds
v_cvt_pk_bf16_f32 v118,v68,v69
buffer_load_dwordx4 v1,s[8:11],s63 offen offset:3072 sc1 lds
v_cvt_pk_bf16_f32 v119,v70,v71
s_add_u32 m0,s61,8192
s_add_u32 s63,s60,8192
buffer_load_dwordx4 v1,s[8:11],s63 offen sc1 lds
buffer_load_dwordx4 v1,s[8:11],s63 offen offset:1024 sc1 lds
buffer_load_dwordx4 v1,s[8:11],s63 offen offset:2048 sc1 lds
buffer_load_dwordx4 v1,s[8:11],s63 offen offset:3072 sc1 lds
s_mov_b32 s35,s42
buffer_load_dword v3,v2,s[8:11],s35 offen sc1
s_mov_b32 s53,s33
s_mov_b32 s54,s34
s_add_u32 s32,s32,1
s_mov_b32 s33,s40
s_mov_b32 s34,s41
s_mov_b64 s[76:77],s[80:81]
buffer_store_dwordx4 v[112:115],v20,s[8:11],s71 offen sc1
buffer_store_dwordx4 v[116:119],v20,s[8:11],s71 offen offset:128 sc1
s_mov_b32 s59,s82
s_branch WO_NEXT
nr_232:
buffer_load_dword v3,v2,s[8:11],s35 offen sc1
s_branch ep_231
WO_END:
s_endpgm
ROLE_R1:
s_lshr_b32 s68,s48,3
s_and_b32 s48,s48,7
v_lshlrev_b32 v1,4,v0
v_mov_b32 v5,1
s_lshl_b32 s56,s48,2
s_add_u32 s56,s56,s46
v_bfe_u32 v6,v0,2,2
v_lshrrev_b32 v7,4,v0
v_add_u32 v7,v6,v7
v_and_b32 v7,3,v7
v_and_b32 v15,3,v0
v_lshlrev_b32 v15,4,v15
v_lshl_add_u32 v15,v7,6,v15
v_lshl_add_u32 v15,v6,8,v15
v_lshrrev_b32 v6,4,v0
v_bfe_u32 v7,v0,2,2
v_and_b32 v8,3,v0
v_add_u32 v9,s48,v7
v_and_b32 v9,3,v9
v_lshlrev_b32 v17,6,v9
v_lshl_add_u32 v17,v8,4,v17
s_lshl_b32 s60,s48,8
s_lshl_b32 s61,s46,13
s_add_u32 s61,s61,s60
v_lshl_add_u32 v16,v6,11,v17
v_add_u32 v16,s61,v16
s_lshl_b32 s61,s46,11
s_add_u32 s61,s61,s60
s_add_u32 s61,s61,32768
v_add_u32 v17,s61,v17
v_lshl_add_u32 v18,v6,2,v17
v_mul_u32_u24 v19,40960,v6
v_and_b32 v9,0xff,v1
v_add_u32 v19,v19,v9
s_mul_i32 s60,s46,768
s_sub_u32 s60,4096,s60
v_add_u32 v19,s60,v19
s_mul_i32 s69,s48,5120
s_lshl_b32 s60,s46,10
s_add_u32 s69,s69,s60
s_add_u32 s69,s69,175112192
s_cmp_eq_u32 s68,0
s_mov_b32 s70,209518592
s_cselect_b32 s70,234749952,s70
s_mov_b32 s71,46080
s_cselect_b32 s71,40960,s71
s_mov_b32 s72,0x3f80
s_mov_b32 s73,0x3f800000
v_lshlrev_b32 v21,5,v8
s_lshl_b32 s60,s46,3
v_add_u32 v20,s60,v21
v_min_u32 v2,39,v0
v_lshlrev_b32 v2,4,v2
s_waitcnt vmcnt(0)
s_barrier
s_cmp_lg_u32 s46,0
s_cbranch_scc1 arr_234
v_mov_b32 v6,1
s_lshl_b32 s3,s49,2
v_mov_b32 v7,s3
s_mov_b64 exec,1
buffer_atomic_add v6,v7,s[12:15],0 offen sc1
s_mov_b64 exec,-1
arr_234:
s_cmp_lg_u32 s49,0
s_cbranch_scc1 vr_235
s_mov_b64 exec,1
s_lshl_b32 s60,s68,5
s_add_u32 s60,s60,s56
s_and_b32 s61,s60,7
s_lshl_b32 s61,s61,14
s_lshl_b32 s60,s60,7
s_add_u32 s60,s60,s61
s_add_u32 s60,s60,11796480
s_add_u32 s61,s60,0x2000
s_mov_b32 s62,-1
s_mov_b32 s63,-1
s_mov_b32 s50,6
vr_235l:
buffer_store_dword v5,v1,s[8:11],s60 offen sc1
buffer_store_dword v5,v1,s[8:11],s61 offen sc1
s_waitcnt vmcnt(0)
s_memtime s[64:65]
s_waitcnt lgkmcnt(0)
buffer_load_dword v3,v1,s[8:11],s60 offen sc1
s_waitcnt vmcnt(0)
s_memtime s[66:67]
s_waitcnt lgkmcnt(0)
s_sub_u32 s66,s66,s64
s_min_u32 s62,s62,s66
s_memtime s[64:65]
s_waitcnt lgkmcnt(0)
buffer_load_dword v3,v1,s[8:11],s61 offen sc1
s_waitcnt vmcnt(0)
s_memtime s[66:67]
s_waitcnt lgkmcnt(0)
s_sub_u32 s66,s66,s64
s_min_u32 s63,s63,s66
s_sub_u32 s50,s50,1
s_cmp_lg_u32 s50,0
s_cbranch_scc1 vr_235l
s_cmp_lt_u32 s63,s62
s_cselect_b32 s60,0x10001,1
v_mov_b32 v3,s60
v_mov_b32 v6,192
buffer_atomic_add v3,v6,s[12:15],0 offen sc1
s_mov_b64 exec,-1
vr_235:
s_lshl_b32 s3,s49,2
v_mov_b32 v7,s3
s_nop 1
ibw_236:
buffer_load_dword v6,v7,s[12:15],0 offen sc1
s_waitcnt vmcnt(0)
v_cmp_ne_u32 vcc,256,v6
s_nop 0
s_cbranch_vccz ok_237
s_sleep 8
s_sub_u32 s47,s47,1
s_cbranch_scc1 ABORT
s_branch ibw_236
ok_237:
s_cmp_lg_u32 s49,0
s_cbranch_scc1 ibok_238
v_and_b32 v7,7,v0
v_lshlrev_b32 v7,2,v7
buffer_load_dword v6,v7,s[12:15],0 offen offset:32 sc1
s_waitcnt vmcnt(0)
v_cmp_ne_u32 vcc,32,v6
s_nop 0
s_cbranch_vccz ibok_238
s_barrier
s_mov_b32 s49,1
s_mov_b32 s3,s2
s_load_dwordx16 s[16:31],s[0:1],0
s_load_dwordx8 s[32:39],s[0:1],64
s_waitcnt lgkmcnt(0)
s_branch DISPATCH
ibok_238:
s_mov_b32 s83,s100
s_mov_b32 s51,s68
s_mov_b32 s52,0
s_mul_i32 s35,s68,40960
s_add_u32 s35,s35,819200
R1_LOOP:
s_mul_i32 s66,s52,491520
s_add_u32 s66,s66,s69
s_mul_i32 s65,s52,s71
s_add_u32 s65,s65,s70
s_lshl_b32 s60,s51,6
s_add_u32 s60,s60,s52
s_mul_i32 s74,s60,40960
s_add_u32 s74,s74,218365952
s_mul_i32 s75,s60,46080
s_add_u32 s75,s75,223608832
s_lshl_b32 s82,s51,6
s_add_u32 s82,s82,s52
s_lshl_b32 s82,s82,9
s_add_u32 s82,s82,393216
s_lshl_b32 s61,s56,2
s_add_u32 s82,s82,s61
s_cmp_lg_u32 s46,0
s_cbranch_scc1 rp_239
rt_240:
buffer_load_dwordx4 v[24:27],v2,s[8:11],s35 offen sc1
s_waitcnt vmcnt(0)
v_min3_u32 v24,v24,v25,v26
v_min_u32 v24,v24,v27
v_cmp_eq_u32 vcc,0,v24
s_nop 0
s_cbranch_vccz ok_241
s_sleep 3
s_sub_u32 s47,s47,1
s_cbranch_scc1 ABORT
s_branch rt_240
ok_241:
rp_239:
s_barrier
s_add_u32 s63,s66,0
buffer_load_dwordx4 v[68:71],v19,s[8:11],s63 offen sc1
s_add_u32 s63,s66,163840
buffer_load_dwordx4 v[72:75],v19,s[8:11],s63 offen sc1
buffer_load_dwordx4 v[76:79],v16,s[8:11],s65 offen sc1
buffer_load_dword v80,v18,s[8:11],s65 offen sc1
s_add_u32 s63,s66,0
buffer_load_dwordx4 v[36:39],v1,s[8:11],s63 offen sc1
s_add_u32 s63,s66,40960
buffer_load_dwordx4 v[40:43],v1,s[8:11],s63 offen sc1
s_add_u32 s63,s66,81920
buffer_load_dwordx4 v[44:47],v1,s[8:11],s63 offen sc1
s_add_u32 s63,s66,122880
buffer_load_dwordx4 v[48:51],v1,s[8:11],s63 offen sc1
s_add_u32 s63,s66,163840
buffer_load_dwordx4 v[52:55],v1,s[8:11],s63 offen sc1
s_add_u32 s63,s66,204800
buffer_load_dwordx4 v[56:59],v1,s[8:11],s63 offen sc1
s_add_u32 s63,s66,245760
buffer_load_dwordx4 v[60:63],v1,s[8:11],s63 offen sc1
s_add_u32 s63,s66,286720
buffer_load_dwordx4 v[64:67],v1,s[8:11],s63 offen sc1
s_waitcnt vmcnt(11)
v_lshlrev_b32 v92,16,v68
v_and_b32 v93,0xffff0000,v68
v_lshlrev_b32 v94,16,v69
v_and_b32 v95,0xffff0000,v69
v_lshlrev_b32 v96,16,v70
v_and_b32 v97,0xffff0000,v70
v_lshlrev_b32 v98,16,v71
v_and_b32 v99,0xffff0000,v71
s_waitcnt vmcnt(10)
v_dot2c_f32_bf16 v92,s72,v72
v_dot2c_f32_bf16 v93,s73,v72
v_dot2c_f32_bf16 v94,s72,v73
v_dot2c_f32_bf16 v95,s73,v73
v_dot2c_f32_bf16 v96,s72,v74
v_dot2c_f32_bf16 v97,s73,v74
v_dot2c_f32_bf16 v98,s72,v75
v_dot2c_f32_bf16 v99,s73,v75
v_permlane32_swap_b32 v92,v96
v_permlane32_swap_b32 v93,v97
v_permlane32_swap_b32 v94,v98
v_permlane32_swap_b32 v95,v99
v_add_f32 v92,v92,v96
v_add_f32 v93,v93,v97
v_add_f32 v94,v94,v98
v_add_f32 v95,v95,v99
s_nop 0
v_permlane16_swap_b32 v92,v94
v_permlane16_swap_b32 v93,v95
v_add_f32 v90,v92,v94
v_add_f32 v91,v93,v95
s_waitcnt vmcnt(8)
v_lshlrev_b32 v100,16,v76
v_and_b32 v101,0xffff0000,v76
v_lshlrev_b32 v102,16,v77
v_and_b32 v103,0xffff0000,v77
v_lshlrev_b32 v104,16,v78
v_and_b32 v105,0xffff0000,v78
v_lshlrev_b32 v106,16,v79
v_and_b32 v107,0xffff0000,v79
v_lshlrev_b32 v108,16,v80
v_and_b32 v109,0xffff0000,v80
s_waitcnt vmcnt(7)
v_lshlrev_b32 v82,16,v36
v_and_b32 v83,0xffff0000,v36
v_lshlrev_b32 v84,16,v37
v_and_b32 v85,0xffff0000,v37
v_lshlrev_b32 v86,16,v38
v_and_b32 v87,0xffff0000,v38
v_lshlrev_b32 v88,16,v39
v_and_b32 v89,0xffff0000,v39
s_waitcnt vmcnt(6)
v_dot2c_f32_bf16 v82,s72,v40
v_dot2c_f32_bf16 v83,s73,v40
v_dot2c_f32_bf16 v84,s72,v41
v_dot2c_f32_bf16 v85,s73,v41
v_dot2c_f32_bf16 v86,s72,v42
v_dot2c_f32_bf16 v87,s73,v42
v_dot2c_f32_bf16 v88,s72,v43
v_dot2c_f32_bf16 v89,s73,v43
s_waitcnt vmcnt(5)
v_dot2c_f32_bf16 v82,s72,v44
v_dot2c_f32_bf16 v83,s73,v44
v_dot2c_f32_bf16 v84,s72,v45
v_dot2c_f32_bf16 v85,s73,v45
v_dot2c_f32_bf16 v86,s72,v46
v_dot2c_f32_bf16 v87,s73,v46
v_dot2c_f32_bf16 v88,s72,v47
v_dot2c_f32_bf16 v89,s73,v47
s_waitcnt vmcnt(4)
v_dot2c_f32_bf16 v82,s72,v48
v_dot2c_f32_bf16 v83,s73,v48
v_dot2c_f32_bf16 v84,s72,v49
v_dot2c_f32_bf16 v85,s73,v49
v_dot2c_f32_bf16 v86,s72,v50
v_dot2c_f32_bf16 v87,s73,v50
v_dot2c_f32_bf16 v88,s72,v51
v_dot2c_f32_bf16 v89,s73,v51
s_waitcnt vmcnt(3)
v_dot2c_f32_bf16 v82,s72,v52
v_dot2c_f32_bf16 v83,s73,v52
v_dot2c_f32_bf16 v84,s72,v53
v_dot2c_f32_bf16 v85,s73,v53
v_dot2c_f32_bf16 v86,s72,v54
v_dot2c_f32_bf16 v87,s73,v54
v_dot2c_f32_bf16 v88,s72,v55
v_dot2c_f32_bf16 v89,s73,v55
s_waitcnt vmcnt(2)
v_dot2c_f32_bf16 v82,s72,v56
v_dot2c_f32_bf16 v83,s73,v56
v_dot2c_f32_bf16 v84,s72,v57
v_dot2c_f32_bf16 v85,s73,v57
v_dot2c_f32_bf16 v86,s72,v58
v_dot2c_f32_bf16 v87,s73,v58
v_dot2c_f32_bf16 v88,s72,v59
v_dot2c_f32_bf16 v89,s73,v59
s_waitcnt vmcnt(1)
v_dot2c_f32_bf16 v82,s72,v60
v_dot2c_f32_bf16 v83,s73,v60
v_dot2c_f32_bf16 v84,s72,v61
v_dot2c_f32_bf16 v85,s73,v61
v_dot2c_f32_bf16 v86,s72,v62
v_dot2c_f32_bf16 v87,s73,v62
v_dot2c_f32_bf16 v88,s72,v63
v_dot2c_f32_bf16 v89,s73,v63
s_waitcnt vmcnt(0)
v_dot2c_f32_bf16 v82,s72,v64
v_dot2c_f32_bf16 v83,s73,v64
v_dot2c_f32_bf16 v84,s72,v65
v_dot2c_f32_bf16 v85,s73,v65
v_dot2c_f32_bf16 v86,s72,v66
v_dot2c_f32_bf16 v87,s73,v66
v_dot2c_f32_bf16 v88,s72,v67
v_dot2c_f32_bf16 v89,s73,v67
v_cvt_pk_bf16_f32 v6,v82,v83
v_lshlrev_b32 v82,16,v6
v_and_b32 v83,0xffff0000,v6
v_cvt_pk_bf16_f32 v8,v84,v85
v_lshlrev_b32 v84,16,v8
v_and_b32 v85,0xffff0000,v8
v_cvt_pk_bf16_f32 v6,v86,v87
v_lshlrev_b32 v86,16,v6
v_and_b32 v87,0xffff0000,v6
v_cvt_pk_bf16_f32 v8,v88,v89
v_lshlrev_b32 v88,16,v8
v_and_b32 v89,0xffff0000,v8
v_cvt_pk_bf16_f32 v6,v90,v91
v_lshlrev_b32 v90,16,v6
v_and_b32 v91,0xffff0000,v6
v_pk_add_f32 v[82:83],v[82:83],v[100:101]
v_pk_add_f32 v[84:85],v[84:85],v[102:103]
v_pk_add_f32 v[86:87],v[86:87],v[104:105]
v_pk_add_f32 v[88:89],v[88:89],v[106:107]
v_pk_add_f32 v[90:91],v[90:91],v[108:109]
v_cvt_pk_bf16_f32 v112,v82,v83
v_lshlrev_b32 v82,16,v112
v_and_b32 v83,0xffff0000,v112
v_cvt_pk_bf16_f32 v113,v84,v85
v_lshlrev_b32 v84,16,v113
v_and_b32 v85,0xffff0000,v113
v_cvt_pk_bf16_f32 v114,v86,v87
v_lshlrev_b32 v86,16,v114
v_and_b32 v87,0xffff0000,v114
v_cvt_pk_bf16_f32 v115,v88,v89
v_lshlrev_b32 v88,16,v115
v_and_b32 v89,0xffff0000,v115
v_cvt_pk_bf16_f32 v116,v90,v91
v_lshlrev_b32 v90,16,v116
v_and_b32 v91,0xffff0000,v116
v_pk_add_f32 v[32:33],v[82:83],v[84:85]
v_pk_mul_f32 v[30:31],v[82:83],v[82:83]
v_pk_fma_f32 v[30:31],v[84:85],v[84:85],v[30:31]
v_pk_add_f32 v[32:33],v[32:33],v[86:87]
v_pk_fma_f32 v[30:31],v[86:87],v[86:87],v[30:31]
v_pk_add_f32 v[32:33],v[32:33],v[88:89]
v_pk_fma_f32 v[30:31],v[88:89],v[88:89],v[30:31]
v_pk_add_f32 v[32:33],v[32:33],v[90:91]
v_pk_fma_f32 v[30:31],v[90:91],v[90:91],v[30:31]
v_add_f32 v28,v32,v33
v_add_f32 v29,v30,v31
s_nop 0
v_add_f32_dpp v28,v28,v28 row_ror:4 row_mask:0xf bank_mask:0xf
v_add_f32_dpp v29,v29,v29 row_ror:4 row_mask:0xf bank_mask:0xf
s_nop 0
v_add_f32_dpp v28,v28,v28 row_ror:8 row_mask:0xf bank_mask:0xf
v_add_f32_dpp v29,v29,v29 row_ror:8 row_mask:0xf bank_mask:0xf
v_mov_b32 v30,v28
v_mov_b32 v31,v29
s_nop 0
v_permlane32_swap_b32 v28,v30
v_permlane32_swap_b32 v29,v31
v_add_f32 v28,v28,v30
v_add_f32 v29,v29,v31
v_mov_b32 v30,v28
v_mov_b32 v31,v29
s_nop 0
v_permlane16_swap_b32 v28,v30
v_permlane16_swap_b32 v29,v31
v_add_f32 v28,v28,v30
v_add_f32 v29,v29,v31
ds_write_b64 v20,v[28:29]
s_waitcnt lgkmcnt(0)
s_barrier
ds_read_b128 v[136:139],v21
ds_read_b128 v[140:143],v21 offset:16
buffer_store_dwordx4 v[112:115],v16,s[8:11],s74 offen sc1
v_mov_b32 v117,v116
s_nop 1
v_permlane16_swap_b32 v116,v117
s_nop 1
v_permlane32_swap_b32 v116,v118
v_permlane32_swap_b32 v117,v119
s_mov_b64 exec,0xffff
buffer_store_dwordx4 v[116:119],v17,s[8:11],s74 offen sc1
s_mov_b64 exec,-1
s_waitcnt lgkmcnt(0)
v_pk_add_f32 v[136:137],v[136:137],v[138:139]
v_pk_add_f32 v[140:141],v[140:141],v[142:143]
v_pk_add_f32 v[28:29],v[136:137],v[140:141]
v_mul_f32 v28,0x3acccccd,v28
v_mul_f32 v29,0x3acccccd,v29
v_fma_f32 v29,-v28,v28,v29
v_max_f32 v29,0,v29
v_mov_b32 v32,v28
v_mov_b32 v33,v29
v_cvt_pk_bf16_f32 v6,v28,v29
v_lshlrev_b32 v28,16,v6
v_and_b32 v29,0xffff0000,v6
v_add_f32 v29,0x3727c5ac,v29
v_cvt_pk_bf16_f32 v6,v29,v29
v_lshlrev_b32 v29,16,v6
v_sqrt_f32 v29,v29
s_nop 0
v_cvt_pk_bf16_f32 v6,v29,v29
v_lshlrev_b32 v29,16,v6
v_rcp_f32 v29,v29
s_nop 0
v_pk_add_f32 v[82:83],v[82:83],v[28:29] op_sel_hi:[1,0] neg_lo:[0,1] neg_hi:[0,1]
v_pk_add_f32 v[84:85],v[84:85],v[28:29] op_sel_hi:[1,0] neg_lo:[0,1] neg_hi:[0,1]
v_pk_add_f32 v[86:87],v[86:87],v[28:29] op_sel_hi:[1,0] neg_lo:[0,1] neg_hi:[0,1]
v_pk_add_f32 v[88:89],v[88:89],v[28:29] op_sel_hi:[1,0] neg_lo:[0,1] neg_hi:[0,1]
v_pk_add_f32 v[90:91],v[90:91],v[28:29] op_sel_hi:[1,0] neg_lo:[0,1] neg_hi:[0,1]
v_cvt_pk_bf16_f32 v6,v82,v83
v_lshlrev_b32 v82,16,v6
v_and_b32 v83,0xffff0000,v6
v_cvt_pk_bf16_f32 v8,v84,v85
v_lshlrev_b32 v84,16,v8
v_and_b32 v85,0xffff0000,v8
v_cvt_pk_bf16_f32 v6,v86,v87
v_lshlrev_b32 v86,16,v6
v_and_b32 v87,0xffff0000,v6
v_cvt_pk_bf16_f32 v8,v88,v89
v_lshlrev_b32 v88,16,v8
v_and_b32 v89,0xffff0000,v8
v_cvt_pk_bf16_f32 v6,v90,v91
v_lshlrev_b32 v90,16,v6
v_and_b32 v91,0xffff0000,v6
v_pk_mul_f32 v[82:83],v[82:83],v[28:29] op_sel:[0,1] op_sel_hi:[1,1]
v_pk_mul_f32 v[84:85],v[84:85],v[28:29] op_sel:[0,1] op_sel_hi:[1,1]
v_pk_mul_f32 v[86:87],v[86:87],v[28:29] op_sel:[0,1] op_sel_hi:[1,1]
v_pk_mul_f32 v[88:89],v[88:89],v[28:29] op_sel:[0,1] op_sel_hi:[1,1]
v_pk_mul_f32 v[90:91],v[90:91],v[28:29] op_sel:[0,1] op_sel_hi:[1,1]
v_cvt_pk_bf16_f32 v124,v82,v83
v_cvt_pk_bf16_f32 v125,v84,v85
v_cvt_pk_bf16_f32 v126,v86,v87
v_cvt_pk_bf16_f32 v127,v88,v89
v_cvt_pk_bf16_f32 v128,v90,v91
buffer_store_dwordx4 v[124:127],v16,s[8:11],s75 offen sc1
v_mov_b32 v129,v128
s_nop 1
v_permlane16_swap_b32 v128,v129
s_nop 1
v_permlane32_swap_b32 v128,v130
v_permlane32_swap_b32 v129,v131
s_mov_b64 exec,0xffff
buffer_store_dwordx4 v[128:131],v17,s[8:11],s75 offen sc1
s_mov_b64 exec,-1
s_cmp_lg_u32 s46,3
s_cbranch_scc1 zs_242
v_sub_f32 v32,v32,v28
v_mul_f32 v33,v33,v29
v_mul_f32 v32,v32,v29
v_mul_f32 v33,v33,v29
v_cvt_pk_bf16_f32 v6,v32,v33
v_lshlrev_b32 v32,16,v6
v_and_b32 v33,0xffff0000,v6
v_add_f32 v33,0x3727c5ac,v33
v_cvt_pk_bf16_f32 v6,v33,v33
v_lshlrev_b32 v33,16,v6
v_sqrt_f32 v33,v33
s_nop 0
v_cvt_pk_bf16_f32 v6,v33,v33
v_lshlrev_b32 v33,16,v6
v_rcp_f32 v33,v33
s_lshl_b32 s60,s48,5
s_add_u32 s63,s75,s60
s_add_u32 s63,s63,40960
v_lshlrev_b32 v6,3,v0
s_mov_b64 exec,15
buffer_store_dwordx2 v[32:33],v6,s[8:11],s63 offen sc1
s_mov_b64 exec,-1
zs_242:
s_add_u32 s52,s52,1
s_add_u32 s35,s35,640
s_waitcnt vmcnt(0)
s_mov_b64 exec,1
buffer_store_dword v5,v1,s[8:11],s82 offen sc1
s_mov_b64 exec,-1
s_cmp_lt_u32 s52,64
s_cbranch_scc1 R1_LOOP
s_endpgm
ROLE_W1:
v_lshlrev_b32 v1,4,v0
v_mov_b32 v5,1
s_lshl_b32 s56,s48,2
s_add_u32 s56,s56,s46
v_bfe_u32 v6,v0,2,2
v_lshrrev_b32 v7,4,v0
v_add_u32 v7,v6,v7
v_and_b32 v7,3,v7
v_and_b32 v15,3,v0
v_lshlrev_b32 v15,4,v15
v_lshl_add_u32 v15,v7,6,v15
v_lshl_add_u32 v15,v6,8,v15
v_lshrrev_b32 v6,5,v0
v_bfe_u32 v7,v0,4,1
v_lshlrev_b32 v16,10,v7
v_bfe_u32 v7,v0,2,2
v_lshl_add_u32 v16,v7,8,v16
v_add_u32 v6,v6,v7
v_and_b32 v6,3,v6
v_lshl_add_u32 v16,v6,6,v16
v_and_b32 v6,3,v0
v_lshl_add_u32 v16,v6,4,v16
v_add_u32 v18,46080,v16
v_lshrrev_b32 v6,5,v0
v_bfe_u32 v7,v0,4,1
v_lshlrev_b32 v20,10,v7
v_lshl_add_u32 v20,v6,8,v20
v_and_b32 v6,15,v0
v_lshl_add_u32 v20,v6,4,v20
v_lshrrev_b32 v6,5,v0
v_add_u32 v6,2,v6
v_bfe_u32 v7,v0,4,1
v_lshlrev_b32 v17,10,v7
v_bfe_u32 v7,v0,2,2
v_lshl_add_u32 v17,v7,8,v17
v_add_u32 v6,v6,v7
v_and_b32 v6,3,v6
v_lshl_add_u32 v17,v6,6,v17
v_and_b32 v6,3,v0
v_lshl_add_u32 v17,v6,4,v17
v_add_u32 v19,46080,v17
v_lshrrev_b32 v6,5,v0
v_add_u32 v6,2,v6
v_bfe_u32 v7,v0,4,1
v_lshlrev_b32 v21,10,v7
v_lshl_add_u32 v21,v6,8,v21
v_and_b32 v6,15,v0
v_lshl_add_u32 v21,v6,4,v21
v_min_u32 v2,31,v0
v_lshlrev_b32 v2,2,v2
v_mov_b32 v112,0xc0135761
v_mov_b32 v113,0xbdd2d3e8
s_mov_b32 s68,0xbdd2d3e8
v_mov_b32 v116,0
v_mov_b32 v117,0
v_mov_b32 v118,0
v_mov_b32 v119,0
s_lshl_b32 s60,s56,11
s_add_u32 s61,s60,237699072
buffer_store_dwordx4 v[116:119],v1,s[8:11],s61 offen sc1
buffer_store_dwordx4 v[116:119],v1,s[8:11],s61 offen offset:1024 sc1
s_add_u32 s61,s60,238067712
buffer_store_dwordx4 v[116:119],v1,s[8:11],s61 offen sc1
buffer_store_dwordx4 v[116:119],v1,s[8:11],s61 offen offset:1024 sc1
s_waitcnt vmcnt(0)
s_barrier
s_cmp_lg_u32 s46,0
s_cbranch_scc1 arr_243
v_mov_b32 v6,1
s_lshl_b32 s3,s49,2
v_mov_b32 v7,s3
s_mov_b64 exec,1
buffer_atomic_add v6,v7,s[12:15],0 offen sc1
s_mov_b64 exec,-1
arr_243:
s_lshl_b32 s3,s49,2
v_mov_b32 v7,s3
s_nop 1
ibw_244:
buffer_load_dword v6,v7,s[12:15],0 offen sc1
s_waitcnt vmcnt(0)
v_cmp_ne_u32 vcc,256,v6
s_nop 0
s_cbranch_vccz ok_245
s_sleep 8
s_sub_u32 s47,s47,1
s_cbranch_scc1 ABORT
s_branch ibw_244
ok_245:
s_cmp_lg_u32 s49,0
s_cbranch_scc1 ibok_246
v_and_b32 v7,7,v0
v_lshlrev_b32 v7,2,v7
buffer_load_dword v6,v7,s[12:15],0 offen offset:32 sc1
s_waitcnt vmcnt(0)
v_cmp_ne_u32 vcc,32,v6
s_nop 0
s_cbranch_vccz ibok_246
s_barrier
s_mov_b32 s49,1
s_mov_b32 s3,s2
s_load_dwordx16 s[16:31],s[0:1],0
s_load_dwordx8 s[32:39],s[0:1],64
s_waitcnt lgkmcnt(0)
s_branch DISPATCH
ibok_246:
s_lshl_b32 s58,s56,6
s_mul_i32 s63,s46,40960
s_mov_b32 s4,s32
s_mov_b32 s5,s33
s_mov_b32 s6,819200
s_mov_b32 s7,0x20000
v_lshrrev_b32 v9,2,v0
s_mov_b32 s64,1280
v_mul_lo_u32 v9,v9,s64
v_and_b32 v10,3,v0
v_lshl_add_u32 v6,v10,4,v9
s_add_u32 m0,s63,0
s_add_u32 s65,s58,0
buffer_load_dwordx4 v6,s[4:7],s65 offen lds
s_add_u32 m0,s63,1024
s_add_u32 s65,s58,20480
buffer_load_dwordx4 v6,s[4:7],s65 offen lds
s_add_u32 m0,s63,2048
s_add_u32 s65,s58,40960
buffer_load_dwordx4 v6,s[4:7],s65 offen lds
s_add_u32 m0,s63,3072
s_add_u32 s65,s58,61440
buffer_load_dwordx4 v6,s[4:7],s65 offen lds
s_add_u32 m0,s63,4096
s_add_u32 s65,s58,81920
buffer_load_dwordx4 v6,s[4:7],s65 offen lds
s_add_u32 m0,s63,5120
s_add_u32 s65,s58,102400
buffer_load_dwordx4 v6,s[4:7],s65 offen lds
s_add_u32 m0,s63,6144
s_add_u32 s65,s58,122880
buffer_load_dwordx4 v6,s[4:7],s65 offen lds
s_add_u32 m0,s63,7168
s_add_u32 s65,s58,143360
buffer_load_dwordx4 v6,s[4:7],s65 offen lds
s_add_u32 m0,s63,8192
s_add_u32 s65,s58,163840
buffer_load_dwordx4 v6,s[4:7],s65 offen lds
s_add_u32 m0,s63,9216
s_add_u32 s65,s58,184320
buffer_load_dwordx4 v6,s[4:7],s65 offen lds
s_add_u32 m0,s63,10240
s_add_u32 s65,s58,204800
buffer_load_dwordx4 v6,s[4:7],s65 offen lds
s_add_u32 m0,s63,11264
s_add_u32 s65,s58,225280
buffer_load_dwordx4 v6,s[4:7],s65 offen lds
s_add_u32 m0,s63,12288
s_add_u32 s65,s58,245760
buffer_load_dwordx4 v6,s[4:7],s65 offen lds
s_add_u32 m0,s63,13312
s_add_u32 s65,s58,266240
buffer_load_dwordx4 v6,s[4:7],s65 offen lds
s_add_u32 m0,s63,14336
s_add_u32 s65,s58,286720
buffer_load_dwordx4 v6,s[4:7],s65 offen lds
s_add_u32 m0,s63,15360
s_add_u32 s65,s58,307200
buffer_load_dwordx4 v6,s[4:7],s65 offen lds
s_add_u32 m0,s63,16384
s_add_u32 s65,s58,327680
buffer_load_dwordx4 v6,s[4:7],s65 offen lds
s_add_u32 m0,s63,17408
s_add_u32 s65,s58,348160
buffer_load_dwordx4 v6,s[4:7],s65 offen lds
s_add_u32 m0,s63,18432
s_add_u32 s65,s58,368640
buffer_load_dwordx4 v6,s[4:7],s65 offen lds
s_add_u32 m0,s63,19456
s_add_u32 s65,s58,389120
buffer_load_dwordx4 v6,s[4:7],s65 offen lds
s_add_u32 m0,s63,20480
s_add_u32 s65,s58,409600
buffer_load_dwordx4 v6,s[4:7],s65 offen lds
s_add_u32 m0,s63,21504
s_add_u32 s65,s58,430080
buffer_load_dwordx4 v6,s[4:7],s65 offen lds
s_add_u32 m0,s63,22528
s_add_u32 s65,s58,450560
buffer_load_dwordx4 v6,s[4:7],s65 offen lds
s_add_u32 m0,s63,23552
s_add_u32 s65,s58,471040
buffer_load_dwordx4 v6,s[4:7],s65 offen lds
s_add_u32 m0,s63,24576
s_add_u32 s65,s58,491520
buffer_load_dwordx4 v6,s[4:7],s65 offen lds
s_add_u32 m0,s63,25600
s_add_u32 s65,s58,512000
buffer_load_dwordx4 v6,s[4:7],s65 offen lds
s_add_u32 m0,s63,26624
s_add_u32 s65,s58,532480
buffer_load_dwordx4 v6,s[4:7],s65 offen lds
s_add_u32 m0,s63,27648
s_add_u32 s65,s58,552960
buffer_load_dwordx4 v6,s[4:7],s65 offen lds
s_add_u32 m0,s63,28672
s_add_u32 s65,s58,573440
buffer_load_dwordx4 v6,s[4:7],s65 offen lds
s_add_u32 m0,s63,29696
s_add_u32 s65,s58,593920
buffer_load_dwordx4 v6,s[4:7],s65 offen lds
s_add_u32 m0,s63,30720
s_add_u32 s65,s58,614400
buffer_load_dwordx4 v6,s[4:7],s65 offen lds
s_add_u32 m0,s63,31744
s_add_u32 s65,s58,634880
buffer_load_dwordx4 v6,s[4:7],s65 offen lds
s_add_u32 m0,s63,32768
s_add_u32 s65,s58,655360
buffer_load_dwordx4 v6,s[4:7],s65 offen lds
s_add_u32 m0,s63,33792
s_add_u32 s65,s58,675840
buffer_load_dwordx4 v6,s[4:7],s65 offen lds
s_add_u32 m0,s63,34816
s_add_u32 s65,s58,696320
buffer_load_dwordx4 v6,s[4:7],s65 offen lds
s_add_u32 m0,s63,35840
s_add_u32 s65,s58,716800
buffer_load_dwordx4 v6,s[4:7],s65 offen lds
s_add_u32 m0,s63,36864
s_add_u32 s65,s58,737280
buffer_load_dwordx4 v6,s[4:7],s65 offen lds
s_add_u32 m0,s63,37888
s_add_u32 s65,s58,757760
buffer_load_dwordx4 v6,s[4:7],s65 offen lds
s_add_u32 m0,s63,38912
s_add_u32 s65,s58,778240
buffer_load_dwordx4 v6,s[4:7],s65 offen lds
s_add_u32 m0,s63,39936
s_add_u32 s65,s58,798720
buffer_load_dwordx4 v6,s[4:7],s65 offen lds
s_waitcnt vmcnt(20)
v_bfe_u32 v9,v0,2,2
v_lshrrev_b32 v10,5,v0
v_lshl_add_u32 v9,v10,2,v9
v_mul_u32_u24 v9,64,v9
v_and_b32 v10,1,v0
v_lshl_add_u32 v9,v10,3,v9
v_bfe_u32 v10,v0,1,1
v_lshl_add_u32 v9,v10,5,v9
v_bfe_u32 v10,v0,4,1
v_lshl_add_u32 v9,v10,4,v9
v_add_u32 v7,s63,v9
ds_read_b64_tr_b16 a[0:1],v7 offset:0
ds_read_b64_tr_b16 a[2:3],v7 offset:1024
ds_read_b64_tr_b16 a[4:5],v7 offset:512
ds_read_b64_tr_b16 a[6:7],v7 offset:1536
ds_read_b64_tr_b16 a[8:9],v7 offset:2048
ds_read_b64_tr_b16 a[10:11],v7 offset:3072
ds_read_b64_tr_b16 a[12:13],v7 offset:2560
ds_read_b64_tr_b16 a[14:15],v7 offset:3584
ds_read_b64_tr_b16 a[16:17],v7 offset:4096
ds_read_b64_tr_b16 a[18:19],v7 offset:5120
ds_read_b64_tr_b16 a[20:21],v7 offset:4608
ds_read_b64_tr_b16 a[22:23],v7 offset:5632
s_waitcnt lgkmcnt(4)
ds_read_b64_tr_b16 a[24:25],v7 offset:6144
ds_read_b64_tr_b16 a[26:27],v7 offset:7168
ds_read_b64_tr_b16 a[28:29],v7 offset:6656
ds_read_b64_tr_b16 a[30:31],v7 offset:7680
ds_read_b64_tr_b16 a[32:33],v7 offset:8192
ds_read_b64_tr_b16 a[34:35],v7 offset:9216
ds_read_b64_tr_b16 a[36:37],v7 offset:8704
ds_read_b64_tr_b16 a[38:39],v7 offset:9728
ds_read_b64_tr_b16 a[40:41],v7 offset:10240
ds_read_b64_tr_b16 a[42:43],v7 offset:11264
ds_read_b64_tr_b16 a[44:45],v7 offset:10752
ds_read_b64_tr_b16 a[46:47],v7 offset:11776
s_waitcnt lgkmcnt(4)
ds_read_b64_tr_b16 a[48:49],v7 offset:12288
ds_read_b64_tr_b16 a[50:51],v7 offset:13312
ds_read_b64_tr_b16 a[52:53],v7 offset:12800
ds_read_b64_tr_b16 a[54:55],v7 offset:13824
ds_read_b64_tr_b16 a[56:57],v7 offset:14336
ds_read_b64_tr_b16 a[58:59],v7 offset:15360
ds_read_b64_tr_b16 a[60:61],v7 offset:14848
ds_read_b64_tr_b16 a[62:63],v7 offset:15872
ds_read_b64_tr_b16 a[64:65],v7 offset:16384
ds_read_b64_tr_b16 a[66:67],v7 offset:17408
ds_read_b64_tr_b16 a[68:69],v7 offset:16896
ds_read_b64_tr_b16 a[70:71],v7 offset:17920
s_waitcnt lgkmcnt(4)
ds_read_b64_tr_b16 a[72:73],v7 offset:18432
ds_read_b64_tr_b16 a[74:75],v7 offset:19456
ds_read_b64_tr_b16 a[76:77],v7 offset:18944
ds_read_b64_tr_b16 a[78:79],v7 offset:19968
s_waitcnt lgkmcnt(0)
s_waitcnt vmcnt(0)
v_bfe_u32 v9,v0,2,2
v_lshrrev_b32 v10,5,v0
v_lshl_add_u32 v9,v10,2,v9
v_mul_u32_u24 v9,64,v9
v_and_b32 v10,1,v0
v_lshl_add_u32 v9,v10,3,v9
v_bfe_u32 v10,v0,1,1
v_lshl_add_u32 v9,v10,5,v9
v_bfe_u32 v10,v0,4,1
v_lshl_add_u32 v9,v10,4,v9
v_add_u32 v7,s63,v9
ds_read_b64_tr_b16 a[80:81],v7 offset:20480
ds_read_b64_tr_b16 a[82:83],v7 offset:21504
ds_read_b64_tr_b16 a[84:85],v7 offset:20992
ds_read_b64_tr_b16 a[86:87],v7 offset:22016
ds_read_b64_tr_b16 a[88:89],v7 offset:22528
ds_read_b64_tr_b16 a[90:91],v7 offset:23552
ds_read_b64_tr_b16 a[92:93],v7 offset:23040
ds_read_b64_tr_b16 a[94:95],v7 offset:24064
ds_read_b64_tr_b16 a[96:97],v7 offset:24576
ds_read_b64_tr_b16 a[98:99],v7 offset:25600
ds_read_b64_tr_b16 a[100:101],v7 offset:25088
ds_read_b64_tr_b16 a[102:103],v7 offset:26112
s_waitcnt lgkmcnt(4)
ds_read_b64_tr_b16 a[104:105],v7 offset:26624
ds_read_b64_tr_b16 a[106:107],v7 offset:27648
ds_read_b64_tr_b16 a[108:109],v7 offset:27136
ds_read_b64_tr_b16 a[110:111],v7 offset:28160
ds_read_b64_tr_b16 a[112:113],v7 offset:28672
ds_read_b64_tr_b16 a[114:115],v7 offset:29696
ds_read_b64_tr_b16 a[116:117],v7 offset:29184
ds_read_b64_tr_b16 a[118:119],v7 offset:30208
ds_read_b64_tr_b16 a[120:121],v7 offset:30720
ds_read_b64_tr_b16 a[122:123],v7 offset:31744
ds_read_b64_tr_b16 a[124:125],v7 offset:31232
ds_read_b64_tr_b16 a[126:127],v7 offset:32256
s_waitcnt lgkmcnt(4)
ds_read_b64_tr_b16 a[128:129],v7 offset:32768
ds_read_b64_tr_b16 a[130:131],v7 offset:33792
ds_read_b64_tr_b16 a[132:133],v7 offset:33280
ds_read_b64_tr_b16 a[134:135],v7 offset:34304
ds_read_b64_tr_b16 a[136:137],v7 offset:34816
ds_read_b64_tr_b16 a[138:139],v7 offset:35840
ds_read_b64_tr_b16 a[140:141],v7 offset:35328
ds_read_b64_tr_b16 a[142:143],v7 offset:36352
ds_read_b64_tr_b16 a[144:145],v7 offset:36864
ds_read_b64_tr_b16 a[146:147],v7 offset:37888
ds_read_b64_tr_b16 a[148:149],v7 offset:37376
ds_read_b64_tr_b16 a[150:151],v7 offset:38400
s_waitcnt lgkmcnt(4)
ds_read_b64_tr_b16 a[152:153],v7 offset:38912
ds_read_b64_tr_b16 a[154:155],v7 offset:39936
ds_read_b64_tr_b16 a[156:157],v7 offset:39424
ds_read_b64_tr_b16 a[158:159],v7 offset:40448
s_waitcnt lgkmcnt(0)
v_mov_b32 v24,0x3f803f80
v_mov_b32 v25,0x3f803f80
v_mov_b32 v26,0x3f803f80
v_mov_b32 v27,0x3f803f80
s_nop 1
v_mfma_f32_32x32x16_bf16 v[144:159],a[0:3],v[24:27],0
v_mfma_f32_32x32x16_bf16 v[144:159],a[4:7],v[24:27],v[144:159]
v_mfma_f32_32x32x16_bf16 v[144:159],a[8:11],v[24:27],v[144:159]
v_mfma_f32_32x32x16_bf16 v[144:159],a[12:15],v[24:27],v[144:159]
v_mfma_f32_32x32x16_bf16 v[144:159],a[16:19],v[24:27],v[144:159]
v_mfma_f32_32x32x16_bf16 v[144:159],a[20:23],v[24:27],v[144:159]
v_mfma_f32_32x32x16_bf16 v[144:159],a[24:27],v[24:27],v[144:159]
v_mfma_f32_32x32x16_bf16 v[144:159],a[28:31],v[24:27],v[144:159]
v_mfma_f32_32x32x16_bf16 v[144:159],a[32:35],v[24:27],v[144:159]
v_mfma_f32_32x32x16_bf16 v[144:159],a[36:39],v[24:27],v[144:159]
v_mfma_f32_32x32x16_bf16 v[144:159],a[40:43],v[24:27],v[144:159]
v_mfma_f32_32x32x16_bf16 v[144:159],a[44:47],v[24:27],v[144:159]
v_mfma_f32_32x32x16_bf16 v[144:159],a[48:51],v[24:27],v[144:159]
v_mfma_f32_32x32x16_bf16 v[144:159],a[52:55],v[24:27],v[144:159]
v_mfma_f32_32x32x16_bf16 v[144:159],a[56:59],v[24:27],v[144:159]
v_mfma_f32_32x32x16_bf16 v[144:159],a[60:63],v[24:27],v[144:159]
v_mfma_f32_32x32x16_bf16 v[144:159],a[64:67],v[24:27],v[144:159]
v_mfma_f32_32x32x16_bf16 v[144:159],a[68:71],v[24:27],v[144:159]
v_mfma_f32_32x32x16_bf16 v[144:159],a[72:75],v[24:27],v[144:159]
v_mfma_f32_32x32x16_bf16 v[144:159],a[76:79],v[24:27],v[144:159]
v_mfma_f32_32x32x16_bf16 v[144:159],a[80:83],v[24:27],v[144:159]
v_mfma_f32_32x32x16_bf16 v[144:159],a[84:87],v[24:27],v[144:159]
v_mfma_f32_32x32x16_bf16 v[144:159],a[88:91],v[24:27],v[144:159]
v_mfma_f32_32x32x16_bf16 v[144:159],a[92:95],v[24:27],v[144:159]
v_mfma_f32_32x32x16_bf16 v[144:159],a[96:99],v[24:27],v[144:159]
v_mfma_f32_32x32x16_bf16 v[144:159],a[100:103],v[24:27],v[144:159]
v_mfma_f32_32x32x16_bf16 v[144:159],a[104:107],v[24:27],v[144:159]
v_mfma_f32_32x32x16_bf16 v[144:159],a[108:111],v[24:27],v[144:159]
v_mfma_f32_32x32x16_bf16 v[144:159],a[112:115],v[24:27],v[144:159]
v_mfma_f32_32x32x16_bf16 v[144:159],a[116:119],v[24:27],v[144:159]
v_mfma_f32_32x32x16_bf16 v[144:159],a[120:123],v[24:27],v[144:159]
v_mfma_f32_32x32x16_bf16 v[144:159],a[124:127],v[24:27],v[144:159]
v_mfma_f32_32x32x16_bf16 v[144:159],a[128:131],v[24:27],v[144:159]
v_mfma_f32_32x32x16_bf16 v[144:159],a[132:135],v[24:27],v[144:159]
v_mfma_f32_32x32x16_bf16 v[144:159],a[136:139],v[24:27],v[144:159]
v_mfma_f32_32x32x16_bf16 v[144:159],a[140:143],v[24:27],v[144:159]
v_mfma_f32_32x32x16_bf16 v[144:159],a[144:147],v[24:27],v[144:159]
v_mfma_f32_32x32x16_bf16 v[144:159],a[148:151],v[24:27],v[144:159]
v_mfma_f32_32x32x16_bf16 v[144:159],a[152:155],v[24:27],v[144:159]
v_mfma_f32_32x32x16_bf16 v[144:159],a[156:159],v[24:27],v[144:159]
v_and_b32 v182,31,v0
v_lshlrev_b32 v182,3,v182
v_add_u32 v182,0xa000,v182
s_barrier
s_mov_b32 s50,0
s_mov_b32 s32,0
s_mov_b32 s57,0
s_mov_b32 s59,2147483648
s_mov_b32 s82,2147483648
s_mov_b32 s39,2147483648
v_mov_b32 v22,94208
v_lshl_add_u32 v22,v0,2,v22
v_mov_b32 v23,0
ds_write_b32 v22,v23
s_mov_b32 s39,1600000
v_and_b32 v72,15,v0
v_lshlrev_b32 v72,7,v72
v_min_u32 v6,51,v0
v_lshlrev_b32 v6,2,v6
v_add_u32 v2,0,v6
v_add_u32 v7,127360,v6
v_cmp_gt_u32 s[78:79],32,v0
s_nop 1
v_cndmask_b32 v2,v7,v2,s[78:79]
s_mov_b32 s51,0
s_mov_b32 s52,0
s_mul_i32 s62,s51,9
s_and_b32 s63,s52,7
s_add_u32 s62,s62,s63
s_mul_i32 s62,s62,40960
s_add_u32 s62,s62,237371392
s_lshl_b32 s63,s56,11
s_add_u32 s62,s62,s63
buffer_load_dword v73,v72,s[8:11],s62 offen sc1
s_mov_b32 s51,0
s_mov_b32 s52,1
s_mul_i32 s62,s51,9
s_and_b32 s63,s52,7
s_add_u32 s62,s62,s63
s_mul_i32 s62,s62,40960
s_add_u32 s62,s62,237371392
s_lshl_b32 s63,s56,11
s_add_u32 s62,s62,s63
buffer_load_dword v73,v72,s[8:11],s62 offen sc1
s_mov_b32 s51,0
s_mov_b32 s52,2
s_mul_i32 s62,s51,9
s_and_b32 s63,s52,7
s_add_u32 s62,s62,s63
s_mul_i32 s62,s62,40960
s_add_u32 s62,s62,237371392
s_lshl_b32 s63,s56,11
s_add_u32 s62,s62,s63
buffer_load_dword v73,v72,s[8:11],s62 offen sc1
s_mov_b32 s51,0
s_mov_b32 s52,3
s_mul_i32 s62,s51,9
s_and_b32 s63,s52,7
s_add_u32 s62,s62,s63
s_mul_i32 s62,s62,40960
s_add_u32 s62,s62,237371392
s_lshl_b32 s63,s56,11
s_add_u32 s62,s62,s63
buffer_load_dword v73,v72,s[8:11],s62 offen sc1
s_mov_b32 s51,0
s_mov_b32 s52,4
s_mul_i32 s62,s51,9
s_and_b32 s63,s52,7
s_add_u32 s62,s62,s63
s_mul_i32 s62,s62,40960
s_add_u32 s62,s62,237371392
s_lshl_b32 s63,s56,11
s_add_u32 s62,s62,s63
buffer_load_dword v73,v72,s[8:11],s62 offen sc1
s_mov_b32 s51,0
s_mov_b32 s52,5
s_mul_i32 s62,s51,9
s_and_b32 s63,s52,7
s_add_u32 s62,s62,s63
s_mul_i32 s62,s62,40960
s_add_u32 s62,s62,237371392
s_lshl_b32 s63,s56,11
s_add_u32 s62,s62,s63
buffer_load_dword v73,v72,s[8:11],s62 offen sc1
s_mov_b32 s51,0
s_mov_b32 s52,6
s_mul_i32 s62,s51,9
s_and_b32 s63,s52,7
s_add_u32 s62,s62,s63
s_mul_i32 s62,s62,40960
s_add_u32 s62,s62,237371392
s_lshl_b32 s63,s56,11
s_add_u32 s62,s62,s63
buffer_load_dword v73,v72,s[8:11],s62 offen sc1
s_mov_b32 s51,0
s_mov_b32 s52,7
s_mul_i32 s62,s51,9
s_and_b32 s63,s52,7
s_add_u32 s62,s62,s63
s_mul_i32 s62,s62,40960
s_add_u32 s62,s62,237371392
s_lshl_b32 s63,s56,11
s_add_u32 s62,s62,s63
buffer_load_dword v73,v72,s[8:11],s62 offen sc1
s_mov_b32 s51,1
s_mov_b32 s52,0
s_mul_i32 s62,s51,9
s_and_b32 s63,s52,7
s_add_u32 s62,s62,s63
s_mul_i32 s62,s62,40960
s_add_u32 s62,s62,237371392
s_lshl_b32 s63,s56,11
s_add_u32 s62,s62,s63
buffer_load_dword v73,v72,s[8:11],s62 offen sc1
s_mov_b32 s51,1
s_mov_b32 s52,1
s_mul_i32 s62,s51,9
s_and_b32 s63,s52,7
s_add_u32 s62,s62,s63
s_mul_i32 s62,s62,40960
s_add_u32 s62,s62,237371392
s_lshl_b32 s63,s56,11
s_add_u32 s62,s62,s63
buffer_load_dword v73,v72,s[8:11],s62 offen sc1
s_mov_b32 s51,1
s_mov_b32 s52,2
s_mul_i32 s62,s51,9
s_and_b32 s63,s52,7
s_add_u32 s62,s62,s63
s_mul_i32 s62,s62,40960
s_add_u32 s62,s62,237371392
s_lshl_b32 s63,s56,11
s_add_u32 s62,s62,s63
buffer_load_dword v73,v72,s[8:11],s62 offen sc1
s_mov_b32 s51,1
s_mov_b32 s52,3
s_mul_i32 s62,s51,9
s_and_b32 s63,s52,7
s_add_u32 s62,s62,s63
s_mul_i32 s62,s62,40960
s_add_u32 s62,s62,237371392
s_lshl_b32 s63,s56,11
s_add_u32 s62,s62,s63
buffer_load_dword v73,v72,s[8:11],s62 offen sc1
s_mov_b32 s51,1
s_mov_b32 s52,4
s_mul_i32 s62,s51,9
s_and_b32 s63,s52,7
s_add_u32 s62,s62,s63
s_mul_i32 s62,s62,40960
s_add_u32 s62,s62,237371392
s_lshl_b32 s63,s56,11
s_add_u32 s62,s62,s63
buffer_load_dword v73,v72,s[8:11],s62 offen sc1
s_mov_b32 s51,1
s_mov_b32 s52,5
s_mul_i32 s62,s51,9
s_and_b32 s63,s52,7
s_add_u32 s62,s62,s63
s_mul_i32 s62,s62,40960
s_add_u32 s62,s62,237371392
s_lshl_b32 s63,s56,11
s_add_u32 s62,s62,s63
buffer_load_dword v73,v72,s[8:11],s62 offen sc1
s_mov_b32 s51,1
s_mov_b32 s52,6
s_mul_i32 s62,s51,9
s_and_b32 s63,s52,7
s_add_u32 s62,s62,s63
s_mul_i32 s62,s62,40960
s_add_u32 s62,s62,237371392
s_lshl_b32 s63,s56,11
s_add_u32 s62,s62,s63
buffer_load_dword v73,v72,s[8:11],s62 offen sc1
s_mov_b32 s51,1
s_mov_b32 s52,7
s_mul_i32 s62,s51,9
s_and_b32 s63,s52,7
s_add_u32 s62,s62,s63
s_mul_i32 s62,s62,40960
s_add_u32 s62,s62,237371392
s_lshl_b32 s63,s56,11
s_add_u32 s62,s62,s63
buffer_load_dword v73,v72,s[8:11],s62 offen sc1
s_waitcnt vmcnt(0)
s_waitcnt lgkmcnt(0)
s_barrier
s_mov_b32 s83,s100
s_min_u32 s62,s32,127
s_sub_u32 s60,s62,15
s_lshr_b32 s34,s60,1
s_and_b32 s33,s60,1
s_cmp_eq_u32 s33,0
s_cselect_b32 s61,15,0
s_add_u32 s34,s34,s61
s_sub_u32 s61,s60,49
s_cmp_ge_u32 s60,98
s_cselect_b32 s34,s61,s34
s_cselect_b32 s33,1,s33
s_cmp_lt_u32 s62,15
s_cselect_b32 s34,s62,s34
s_cselect_b32 s33,0,s33
s_lshl_b32 s35,s33,6
s_add_u32 s35,s35,s34
s_lshl_b32 s35,s35,9
s_add_u32 s35,s35,393216
s_cmp_lt_u32 s34,7
s_cselect_b64 s[76:77],s[78:79],-1
s_sub_u32 s57,46080,s57
v_swap_b32 v16,v18
v_swap_b32 v17,v19
s_add_u32 s62,s32,1
s_min_u32 s62,s62,127
s_sub_u32 s60,s62,15
s_lshr_b32 s41,s60,1
s_and_b32 s40,s60,1
s_cmp_eq_u32 s40,0
s_cselect_b32 s61,15,0
s_add_u32 s41,s41,s61
s_sub_u32 s61,s60,49
s_cmp_ge_u32 s60,98
s_cselect_b32 s41,s61,s41
s_cselect_b32 s40,1,s40
s_cmp_lt_u32 s62,15
s_cselect_b32 s41,s62,s41
s_cselect_b32 s40,0,s40
s_lshl_b32 s42,s40,6
s_add_u32 s42,s42,s41
s_lshl_b32 s42,s42,9
s_add_u32 s42,s42,393216
s_cmp_lt_u32 s41,7
s_cselect_b64 s[80:81],s[78:79],-1
W1_COLD:
s_mov_b32 s37,0
s_cmp_lg_u32 s46,0
s_cbranch_scc1 wo_247
fb_249:
buffer_load_dword v3,v2,s[8:11],s35 offen sc1
s_waitcnt vmcnt(0)
v_cmp_eq_u32 vcc,0,v3
s_and_b64 vcc,vcc,s[76:77]
s_cbranch_scc0 ok_250
s_sleep 3
s_sub_u32 s47,s47,1
s_cbranch_scc1 ABORT
s_branch fb_249
ok_250:
W1_COLD2:
s_add_u32 s65,s32,1
s_or_b32 s65,s65,s37
v_mov_b32 v23,s65
ds_max_i32 v22,v23
s_branch wd_248
wo_247:
ds_read_b32 v23,v22
s_waitcnt lgkmcnt(0)
v_cmp_ge_u32 vcc,s32,v23
s_nop 0
s_cbranch_vccz wd_248
s_sleep 1
s_sub_u32 s39,s39,1
s_cbranch_scc1 ABORT
s_branch wo_247
wd_248:
s_sub_u32 s66,46080,s57
s_lshl_b32 s60,s33,6
s_add_u32 s60,s60,s34
s_mul_i32 s60,s60,46080
s_add_u32 s60,s60,s37
s_add_u32 s60,s60,223608832
s_mov_b32 s67,s60
s_mul_i32 s61,s46,10240
s_add_u32 s60,s60,s61
s_add_u32 s61,s61,s66
s_add_u32 m0,s61,0
s_add_u32 s63,s60,0
buffer_load_dwordx4 v1,s[8:11],s63 offen sc1 lds
buffer_load_dwordx4 v1,s[8:11],s63 offen offset:1024 sc1 lds
buffer_load_dwordx4 v1,s[8:11],s63 offen offset:2048 sc1 lds
buffer_load_dwordx4 v1,s[8:11],s63 offen offset:3072 sc1 lds
s_add_u32 m0,s61,4096
s_add_u32 s63,s60,4096
buffer_load_dwordx4 v1,s[8:11],s63 offen sc1 lds
buffer_load_dwordx4 v1,s[8:11],s63 offen offset:1024 sc1 lds
s_waitcnt vmcnt(6)
s_mov_b64 exec,1
s_cmp_lg_u32 s49,0
s_cbranch_scc0 ls_251
buffer_store_dword v5,v1,s[8:11],s59 offen sc1
s_branch ls_252
ls_251:
buffer_store_dword v5,v1,s[8:11],s59 offen
ls_252:
s_mov_b64 exec,-1
s_mov_b32 s59,2147483648
buffer_load_dwordx4 v1,s[8:11],s63 offen offset:2048 sc1 lds
buffer_load_dwordx4 v1,s[8:11],s63 offen offset:3072 sc1 lds
s_add_u32 m0,s61,8192
s_add_u32 s63,s60,8192
buffer_load_dwordx4 v1,s[8:11],s63 offen sc1 lds
buffer_load_dwordx4 v1,s[8:11],s63 offen offset:1024 sc1 lds
s_add_u32 m0,s66,40960
s_add_u32 s63,s67,40960
buffer_load_dwordx4 v1,s[8:11],s63 offen sc1 lds
s_mov_b32 s35,s42
buffer_load_dword v3,v2,s[8:11],s35 offen sc1
s_mov_b32 s53,s33
s_mov_b32 s54,s34
s_add_u32 s32,s32,1
s_mov_b32 s33,s40
s_mov_b32 s34,s41
s_mov_b64 s[76:77],s[80:81]
s_sub_u32 s57,46080,s57
v_swap_b32 v16,v18
v_swap_b32 v17,v19
s_mov_b32 s51,s53
s_mov_b32 s52,s54
s_mov_b32 s37,2147483648
s_waitcnt vmcnt(7)
s_branch W1_GO
W1_NEXT:
s_sub_u32 s57,46080,s57
v_swap_b32 v16,v18
v_swap_b32 v17,v19
s_mov_b32 s51,s53
s_mov_b32 s52,s54
s_waitcnt vmcnt(2)
v_cmp_eq_u32 vcc,0,v3
s_and_b64 vcc,vcc,s[76:77]
s_cselect_b32 s37,2147483648,0
s_cmp_lt_u32 s32,128
s_cselect_b32 s37,s37,2147483648
W1_GO:
s_barrier
ds_read_b128 v[24:27],v16 offset:0
ds_read_b128 v[28:31],v17 offset:0
ds_read_b128 v[32:35],v16 offset:10240
ds_read_b128 v[36:39],v17 offset:10240
ds_read_b128 v[40:43],v16 offset:20480
ds_read_b128 v[44:47],v17 offset:20480
ds_read_b128 v[48:51],v16 offset:30720
s_waitcnt lgkmcnt(6)
v_mfma_f32_32x32x16_bf16 v[56:71],a[0:3],v[24:27],0
ds_read_b128 v[52:55],v17 offset:30720
s_lshl_b32 s60,s51,6
s_add_u32 s60,s60,s52
s_mul_i32 s60,s60,40960
s_waitcnt lgkmcnt(6)
v_mfma_f32_32x32x16_bf16 v[56:71],a[4:7],v[28:31],v[56:71]
ds_read_b128 v[24:27],v16 offset:2048
s_lshl_b32 s61,s56,11
s_add_u32 s60,s60,s61
s_add_u32 s60,s60,218365952
s_waitcnt lgkmcnt(5)
v_mfma_f32_32x32x16_bf16 v[56:71],a[40:43],v[32:35],v[56:71]
ds_read_b128 v[28:31],v17 offset:2048
buffer_load_dword v73,v72,s[8:11],s60 offen sc1
s_add_u32 s65,s32,1
s_or_b32 s65,s65,s37
v_mfma_f32_32x32x16_bf16 v[56:71],a[44:47],v[36:39],v[56:71]
ds_read_b128 v[32:35],v16 offset:12288
v_mov_b32 v23,s65
ds_max_i32 v22,v23
s_waitcnt lgkmcnt(6)
v_mfma_f32_32x32x16_bf16 v[56:71],a[80:83],v[40:43],v[56:71]
ds_read_b128 v[36:39],v17 offset:12288
s_sub_u32 s66,46080,s57
s_lshl_b32 s60,s33,6
s_add_u32 s60,s60,s34
s_mul_i32 s60,s60,46080
v_mfma_f32_32x32x16_bf16 v[56:71],a[84:87],v[44:47],v[56:71]
ds_read_b128 v[40:43],v16 offset:22528
s_add_u32 s60,s60,s37
s_add_u32 s60,s60,223608832
s_mov_b32 s67,s60
s_waitcnt lgkmcnt(6)
v_mfma_f32_32x32x16_bf16 v[56:71],a[120:123],v[48:51],v[56:71]
ds_read_b128 v[44:47],v17 offset:22528
s_mul_i32 s61,s46,10240
s_add_u32 s60,s60,s61
s_add_u32 s61,s61,s66
s_add_u32 m0,s61,0
v_mfma_f32_32x32x16_bf16 v[56:71],a[124:127],v[52:55],v[56:71]
ds_read_b128 v[48:51],v16 offset:32768
s_add_u32 s63,s60,0
buffer_load_dwordx4 v1,s[8:11],s63 offen sc1 lds
s_waitcnt lgkmcnt(6)
v_mfma_f32_32x32x16_bf16 v[56:71],a[8:11],v[24:27],v[56:71]
ds_read_b128 v[52:55],v17 offset:32768
s_mul_i32 s71,s51,9
s_and_b32 s72,s52,7
s_add_u32 s71,s71,s72
s_mul_i32 s71,s71,40960
v_mfma_f32_32x32x16_bf16 v[56:71],a[12:15],v[28:31],v[56:71]
ds_read_b128 v[24:27],v16 offset:4096
s_add_u32 s71,s71,237371392
s_lshl_b32 s72,s56,11
s_add_u32 s71,s71,s72
s_waitcnt lgkmcnt(5)
v_mfma_f32_32x32x16_bf16 v[56:71],a[48:51],v[32:35],v[56:71]
ds_read_b128 v[28:31],v17 offset:4096
buffer_load_dword v3,v2,s[8:11],s35 offen sc1
s_lshl_b32 s82,s51,6
v_mfma_f32_32x32x16_bf16 v[56:71],a[52:55],v[36:39],v[56:71]
ds_read_b128 v[32:35],v16 offset:14336
buffer_load_dwordx4 v1,s[8:11],s63 offen offset:1024 sc1 lds
s_add_u32 s82,s82,s52
s_waitcnt lgkmcnt(5)
v_mfma_f32_32x32x16_bf16 v[56:71],a[88:91],v[40:43],v[56:71]
ds_read_b128 v[36:39],v17 offset:14336
s_waitcnt vmcnt(4)
s_mov_b64 exec,1
s_cmp_lg_u32 s49,0
s_cbranch_scc0 ls_253
buffer_store_dword v5,v1,s[8:11],s59 offen sc1
s_branch ls_254
ls_253:
buffer_store_dword v5,v1,s[8:11],s59 offen
ls_254:
s_mov_b64 exec,-1
s_mov_b32 s59,2147483648
v_mfma_f32_32x32x16_bf16 v[56:71],a[92:95],v[44:47],v[56:71]
ds_read_b128 v[40:43],v16 offset:24576
s_lshl_b32 s82,s82,9
s_add_u32 s82,s82,458752
s_lshl_b32 s70,s56,2
s_waitcnt lgkmcnt(5)
v_mfma_f32_32x32x16_bf16 v[56:71],a[128:131],v[48:51],v[56:71]
ds_read_b128 v[44:47],v17 offset:24576
buffer_load_dwordx4 v1,s[8:11],s63 offen offset:2048 sc1 lds
s_add_u32 s82,s82,s70
v_mfma_f32_32x32x16_bf16 v[56:71],a[132:135],v[52:55],v[56:71]
ds_read_b128 v[48:51],v16 offset:34816
s_waitcnt lgkmcnt(5)
v_mfma_f32_32x32x16_bf16 v[56:71],a[16:19],v[24:27],v[56:71]
ds_read_b128 v[52:55],v17 offset:34816
s_barrier
v_mfma_f32_32x32x16_bf16 v[56:71],a[20:23],v[28:31],v[56:71]
ds_read_b128 v[24:27],v16 offset:6144
v_add_u32 v183,s57,v182
buffer_load_dwordx4 v1,s[8:11],s63 offen offset:3072 sc1 lds
s_waitcnt lgkmcnt(5)
v_mfma_f32_32x32x16_bf16 v[56:71],a[56:59],v[32:35],v[56:71]
ds_read_b128 v[28:31],v17 offset:6144
ds_read_b64 v[180:181],v183
s_add_u32 m0,s61,4096
s_add_u32 s63,s60,4096
v_mfma_f32_32x32x16_bf16 v[56:71],a[60:63],v[36:39],v[56:71]
ds_read_b128 v[32:35],v16 offset:16384
s_waitcnt lgkmcnt(6)
v_mfma_f32_32x32x16_bf16 v[56:71],a[96:99],v[40:43],v[56:71]
ds_read_b128 v[36:39],v17 offset:16384
buffer_load_dwordx4 v1,s[8:11],s63 offen sc1 lds
v_mfma_f32_32x32x16_bf16 v[56:71],a[100:103],v[44:47],v[56:71]
ds_read_b128 v[40:43],v16 offset:26624
s_waitcnt lgkmcnt(6)
v_mfma_f32_32x32x16_bf16 v[56:71],a[136:139],v[48:51],v[56:71]
ds_read_b128 v[44:47],v17 offset:26624
v_mfma_f32_32x32x16_bf16 v[56:71],a[140:143],v[52:55],v[56:71]
ds_read_b128 v[48:51],v16 offset:36864
buffer_load_dwordx4 v1,s[8:11],s63 offen offset:1024 sc1 lds
s_waitcnt lgkmcnt(6)
v_mfma_f32_32x32x16_bf16 v[56:71],a[24:27],v[24:27],v[56:71]
ds_read_b128 v[52:55],v17 offset:36864
v_mfma_f32_32x32x16_bf16 v[56:71],a[28:31],v[28:31],v[56:71]
ds_read_b128 v[24:27],v16 offset:8192
s_waitcnt lgkmcnt(5)
v_mfma_f32_32x32x16_bf16 v[56:71],a[64:67],v[32:35],v[56:71]
ds_read_b128 v[28:31],v17 offset:8192
buffer_load_dwordx4 v1,s[8:11],s63 offen offset:2048 sc1 lds
v_mfma_f32_32x32x16_bf16 v[56:71],a[68:71],v[36:39],v[56:71]
ds_read_b128 v[32:35],v16 offset:18432
s_waitcnt lgkmcnt(5)
v_mfma_f32_32x32x16_bf16 v[56:71],a[104:107],v[40:43],v[56:71]
ds_read_b128 v[36:39],v17 offset:18432
v_mfma_f32_32x32x16_bf16 v[56:71],a[108:111],v[44:47],v[56:71]
ds_read_b128 v[40:43],v16 offset:28672
buffer_load_dwordx4 v1,s[8:11],s63 offen offset:3072 sc1 lds
s_add_u32 m0,s61,8192
s_waitcnt lgkmcnt(5)
v_mfma_f32_32x32x16_bf16 v[56:71],a[144:147],v[48:51],v[56:71]
ds_read_b128 v[44:47],v17 offset:28672
s_add_u32 s63,s60,8192
v_mfma_f32_32x32x16_bf16 v[56:71],a[148:151],v[52:55],v[56:71]
ds_read_b128 v[48:51],v16 offset:38912
s_waitcnt lgkmcnt(5)
v_mfma_f32_32x32x16_bf16 v[56:71],a[32:35],v[24:27],v[56:71]
ds_read_b128 v[52:55],v17 offset:38912
buffer_load_dwordx4 v1,s[8:11],s63 offen sc1 lds
v_mfma_f32_32x32x16_bf16 v[56:71],a[36:39],v[28:31],v[56:71]
s_waitcnt lgkmcnt(4)
v_mfma_f32_32x32x16_bf16 v[56:71],a[72:75],v[32:35],v[56:71]
v_mfma_f32_32x32x16_bf16 v[56:71],a[76:79],v[36:39],v[56:71]
buffer_load_dwordx4 v1,s[8:11],s63 offen offset:1024 sc1 lds
s_add_u32 m0,s66,40960
s_add_u32 s63,s67,40960
s_waitcnt lgkmcnt(2)
v_mfma_f32_32x32x16_bf16 v[56:71],a[112:115],v[40:43],v[56:71]
v_mfma_f32_32x32x16_bf16 v[56:71],a[116:119],v[44:47],v[56:71]
s_waitcnt lgkmcnt(0)
v_mfma_f32_32x32x16_bf16 v[56:71],a[152:155],v[48:51],v[56:71]
buffer_load_dwordx4 v1,s[8:11],s63 offen sc1 lds
s_add_u32 s62,s32,1
s_min_u32 s62,s62,127
s_sub_u32 s60,s62,15
s_lshr_b32 s41,s60,1
v_mfma_f32_32x32x16_bf16 v[56:71],a[156:159],v[52:55],v[56:71]
s_and_b32 s40,s60,1
s_cmp_eq_u32 s40,0
s_cselect_b32 s61,15,0
s_add_u32 s41,s41,s61
s_sub_u32 s61,s60,49
s_cmp_ge_u32 s60,98
s_cselect_b32 s41,s61,s41
s_cselect_b32 s40,1,s40
s_cmp_lt_u32 s62,15
s_cselect_b32 s41,s62,s41
s_cselect_b32 s40,0,s40
s_lshl_b32 s42,s40,6
s_add_u32 s42,s42,s41
s_lshl_b32 s42,s42,9
s_add_u32 s42,s42,393216
s_cmp_lt_u32 s41,7
s_cselect_b64 s[80:81],s[78:79],-1
s_cmp_eq_u32 s37,0
s_cbranch_scc0 sec_257
s_mov_b32 s35,s42
buffer_load_dword v3,v2,s[8:11],s35 offen sc1
s_mov_b32 s53,s33
s_mov_b32 s54,s34
s_add_u32 s32,s32,1
s_mov_b32 s33,s40
s_mov_b32 s34,s41
s_mov_b64 s[76:77],s[80:81]
s_nop 2
ep_255:
v_pk_fma_f32 v[56:57],v[144:145],v[180:181],v[56:57] op_sel_hi:[1,0,1] neg_lo:[0,1,0] neg_hi:[0,1,0]
v_pk_fma_f32 v[58:59],v[146:147],v[180:181],v[58:59] op_sel_hi:[1,0,1] neg_lo:[0,1,0] neg_hi:[0,1,0]
v_pk_fma_f32 v[60:61],v[148:149],v[180:181],v[60:61] op_sel_hi:[1,0,1] neg_lo:[0,1,0] neg_hi:[0,1,0]
v_pk_fma_f32 v[62:63],v[150:151],v[180:181],v[62:63] op_sel_hi:[1,0,1] neg_lo:[0,1,0] neg_hi:[0,1,0]
v_pk_fma_f32 v[64:65],v[152:153],v[180:181],v[64:65] op_sel_hi:[1,0,1] neg_lo:[0,1,0] neg_hi:[0,1,0]
v_pk_fma_f32 v[66:67],v[154:155],v[180:181],v[66:67] op_sel_hi:[1,0,1] neg_lo:[0,1,0] neg_hi:[0,1,0]
v_pk_fma_f32 v[68:69],v[156:157],v[180:181],v[68:69] op_sel_hi:[1,0,1] neg_lo:[0,1,0] neg_hi:[0,1,0]
v_pk_fma_f32 v[70:71],v[158:159],v[180:181],v[70:71] op_sel_hi:[1,0,1] neg_lo:[0,1,0] neg_hi:[0,1,0]
v_pk_mul_f32 v[56:57],v[56:57],v[180:181] op_sel:[0,1] op_sel_hi:[1,1]
v_pk_mul_f32 v[58:59],v[58:59],v[180:181] op_sel:[0,1] op_sel_hi:[1,1]
v_pk_mul_f32 v[60:61],v[60:61],v[180:181] op_sel:[0,1] op_sel_hi:[1,1]
v_pk_mul_f32 v[62:63],v[62:63],v[180:181] op_sel:[0,1] op_sel_hi:[1,1]
v_pk_mul_f32 v[64:65],v[64:65],v[180:181] op_sel:[0,1] op_sel_hi:[1,1]
v_pk_mul_f32 v[66:67],v[66:67],v[180:181] op_sel:[0,1] op_sel_hi:[1,1]
v_pk_mul_f32 v[68:69],v[68:69],v[180:181] op_sel:[0,1] op_sel_hi:[1,1]
v_pk_mul_f32 v[70:71],v[70:71],v[180:181] op_sel:[0,1] op_sel_hi:[1,1]
v_pk_mul_f32 v[124:125],v[56:57],v[56:57]
v_pk_mul_f32 v[126:127],v[58:59],v[58:59]
v_pk_mul_f32 v[128:129],v[60:61],v[60:61]
v_pk_mul_f32 v[130:131],v[62:63],v[62:63]
v_pk_mul_f32 v[132:133],v[64:65],v[64:65]
v_pk_mul_f32 v[134:135],v[66:67],v[66:67]
v_pk_mul_f32 v[136:137],v[68:69],v[68:69]
v_pk_mul_f32 v[138:139],v[70:71],v[70:71]
v_pk_fma_f32 v[124:125],v[124:125],v[112:113],v[112:113] op_sel:[0,1,0] op_sel_hi:[1,1,0]
v_pk_fma_f32 v[126:127],v[126:127],v[112:113],v[112:113] op_sel:[0,1,0] op_sel_hi:[1,1,0]
v_pk_fma_f32 v[128:129],v[128:129],v[112:113],v[112:113] op_sel:[0,1,0] op_sel_hi:[1,1,0]
v_pk_fma_f32 v[130:131],v[130:131],v[112:113],v[112:113] op_sel:[0,1,0] op_sel_hi:[1,1,0]
v_pk_fma_f32 v[132:133],v[132:133],v[112:113],v[112:113] op_sel:[0,1,0] op_sel_hi:[1,1,0]
v_pk_fma_f32 v[134:135],v[134:135],v[112:113],v[112:113] op_sel:[0,1,0] op_sel_hi:[1,1,0]
v_pk_fma_f32 v[136:137],v[136:137],v[112:113],v[112:113] op_sel:[0,1,0] op_sel_hi:[1,1,0]
v_pk_fma_f32 v[138:139],v[138:139],v[112:113],v[112:113] op_sel:[0,1,0] op_sel_hi:[1,1,0]
v_pk_mul_f32 v[124:125],v[124:125],v[56:57]
v_pk_mul_f32 v[126:127],v[126:127],v[58:59]
v_pk_mul_f32 v[128:129],v[128:129],v[60:61]
v_pk_mul_f32 v[130:131],v[130:131],v[62:63]
v_pk_mul_f32 v[132:133],v[132:133],v[64:65]
v_pk_mul_f32 v[134:135],v[134:135],v[66:67]
v_pk_mul_f32 v[136:137],v[136:137],v[68:69]
v_pk_mul_f32 v[138:139],v[138:139],v[70:71]
v_exp_f32 v124,v124
v_exp_f32 v125,v125
v_exp_f32 v126,v126
v_exp_f32 v127,v127
v_exp_f32 v128,v128
v_exp_f32 v129,v129
v_exp_f32 v130,v130
v_exp_f32 v131,v131
v_exp_f32 v132,v132
v_exp_f32 v133,v133
v_exp_f32 v134,v134
v_exp_f32 v135,v135
v_exp_f32 v136,v136
v_exp_f32 v137,v137
v_exp_f32 v138,v138
v_exp_f32 v139,v139
v_pk_add_f32 v[124:125],v[124:125],1.0 op_sel_hi:[1,0]
v_pk_add_f32 v[126:127],v[126:127],1.0 op_sel_hi:[1,0]
v_pk_add_f32 v[128:129],v[128:129],1.0 op_sel_hi:[1,0]
v_pk_add_f32 v[130:131],v[130:131],1.0 op_sel_hi:[1,0]
v_pk_add_f32 v[132:133],v[132:133],1.0 op_sel_hi:[1,0]
v_pk_add_f32 v[134:135],v[134:135],1.0 op_sel_hi:[1,0]
v_pk_add_f32 v[136:137],v[136:137],1.0 op_sel_hi:[1,0]
v_pk_add_f32 v[138:139],v[138:139],1.0 op_sel_hi:[1,0]
v_rcp_f32 v124,v124
v_rcp_f32 v125,v125
v_rcp_f32 v126,v126
v_rcp_f32 v127,v127
v_rcp_f32 v128,v128
v_rcp_f32 v129,v129
v_rcp_f32 v130,v130
v_rcp_f32 v131,v131
v_rcp_f32 v132,v132
v_rcp_f32 v133,v133
v_rcp_f32 v134,v134
v_rcp_f32 v135,v135
v_rcp_f32 v136,v136
v_rcp_f32 v137,v137
v_rcp_f32 v138,v138
v_rcp_f32 v139,v139
v_pk_mul_f32 v[56:57],v[56:57],v[124:125]
v_pk_mul_f32 v[58:59],v[58:59],v[126:127]
v_pk_mul_f32 v[60:61],v[60:61],v[128:129]
v_pk_mul_f32 v[62:63],v[62:63],v[130:131]
v_pk_mul_f32 v[64:65],v[64:65],v[132:133]
v_pk_mul_f32 v[66:67],v[66:67],v[134:135]
v_pk_mul_f32 v[68:69],v[68:69],v[136:137]
v_pk_mul_f32 v[70:71],v[70:71],v[138:139]
v_cvt_pk_bf16_f32 v116,v56,v57
v_cvt_pk_bf16_f32 v117,v58,v59
v_cvt_pk_bf16_f32 v118,v60,v61
v_cvt_pk_bf16_f32 v119,v62,v63
v_cvt_pk_bf16_f32 v120,v64,v65
v_cvt_pk_bf16_f32 v121,v66,v67
v_cvt_pk_bf16_f32 v122,v68,v69
v_cvt_pk_bf16_f32 v123,v70,v71
s_cmp_lg_u32 s49,0
s_cbranch_scc0 ls_258
buffer_store_dwordx4 v[116:119],v20,s[8:11],s71 offen sc1
buffer_store_dwordx4 v[120:123],v21,s[8:11],s71 offen sc1
s_branch ls_259
ls_258:
buffer_store_dwordx4 v[116:119],v20,s[8:11],s71 offen
buffer_store_dwordx4 v[120:123],v21,s[8:11],s71 offen
ls_259:
s_mov_b32 s59,s82
s_cmp_eq_u32 s37,0
s_cbranch_scc1 W1_NEXT
s_waitcnt vmcnt(2)
v_cmp_eq_u32 vcc,0,v3
s_and_b64 vcc,vcc,s[76:77]
s_cselect_b32 s37,2147483648,0
s_cmp_lt_u32 s32,128
s_cselect_b32 s37,s37,2147483648
s_cmp_eq_u32 s37,0
s_cbranch_scc1 W1_COLD2
s_waitcnt vmcnt(0)
s_mov_b64 exec,1
s_cmp_lg_u32 s49,0
s_cbranch_scc0 ls_260
buffer_store_dword v5,v1,s[8:11],s59 offen sc1
s_branch ls_261
ls_260:
buffer_store_dword v5,v1,s[8:11],s59 offen
ls_261:
s_mov_b64 exec,-1
s_mov_b32 s59,2147483648
s_cmp_lt_u32 s32,128
s_cbranch_scc1 W1_COLD
s_branch W1_END
sec_257:
s_waitcnt vmcnt(11)
v_cmp_eq_u32 vcc,0,v3
s_and_b64 vcc,vcc,s[76:77]
s_cselect_b32 s37,2147483648,0
s_cmp_lt_u32 s32,128
s_cselect_b32 s37,s37,2147483648
s_cmp_lg_u32 s37,0
s_cbranch_scc1 nr_256
s_add_u32 s65,s32,1
s_or_b32 s65,s65,s37
v_mov_b32 v23,s65
ds_max_i32 v22,v23
s_sub_u32 s66,46080,s57
s_lshl_b32 s60,s33,6
s_add_u32 s60,s60,s34
s_mul_i32 s60,s60,46080
s_add_u32 s60,s60,s37
s_add_u32 s60,s60,223608832
s_mov_b32 s67,s60
s_mul_i32 s61,s46,10240
s_add_u32 s60,s60,s61
s_add_u32 s61,s61,s66
s_add_u32 m0,s61,0
s_add_u32 s63,s60,0
buffer_load_dwordx4 v1,s[8:11],s63 offen sc1 lds
v_pk_fma_f32 v[56:57],v[144:145],v[180:181],v[56:57] op_sel_hi:[1,0,1] neg_lo:[0,1,0] neg_hi:[0,1,0]
v_pk_fma_f32 v[58:59],v[146:147],v[180:181],v[58:59] op_sel_hi:[1,0,1] neg_lo:[0,1,0] neg_hi:[0,1,0]
v_pk_fma_f32 v[60:61],v[148:149],v[180:181],v[60:61] op_sel_hi:[1,0,1] neg_lo:[0,1,0] neg_hi:[0,1,0]
v_pk_fma_f32 v[62:63],v[150:151],v[180:181],v[62:63] op_sel_hi:[1,0,1] neg_lo:[0,1,0] neg_hi:[0,1,0]
v_pk_fma_f32 v[64:65],v[152:153],v[180:181],v[64:65] op_sel_hi:[1,0,1] neg_lo:[0,1,0] neg_hi:[0,1,0]
v_pk_fma_f32 v[66:67],v[154:155],v[180:181],v[66:67] op_sel_hi:[1,0,1] neg_lo:[0,1,0] neg_hi:[0,1,0]
v_pk_fma_f32 v[68:69],v[156:157],v[180:181],v[68:69] op_sel_hi:[1,0,1] neg_lo:[0,1,0] neg_hi:[0,1,0]
buffer_load_dwordx4 v1,s[8:11],s63 offen offset:1024 sc1 lds
v_pk_fma_f32 v[70:71],v[158:159],v[180:181],v[70:71] op_sel_hi:[1,0,1] neg_lo:[0,1,0] neg_hi:[0,1,0]
v_pk_mul_f32 v[56:57],v[56:57],v[180:181] op_sel:[0,1] op_sel_hi:[1,1]
v_pk_mul_f32 v[58:59],v[58:59],v[180:181] op_sel:[0,1] op_sel_hi:[1,1]
v_pk_mul_f32 v[60:61],v[60:61],v[180:181] op_sel:[0,1] op_sel_hi:[1,1]
v_pk_mul_f32 v[62:63],v[62:63],v[180:181] op_sel:[0,1] op_sel_hi:[1,1]
v_pk_mul_f32 v[64:65],v[64:65],v[180:181] op_sel:[0,1] op_sel_hi:[1,1]
v_pk_mul_f32 v[66:67],v[66:67],v[180:181] op_sel:[0,1] op_sel_hi:[1,1]
buffer_load_dwordx4 v1,s[8:11],s63 offen offset:2048 sc1 lds
v_pk_mul_f32 v[68:69],v[68:69],v[180:181] op_sel:[0,1] op_sel_hi:[1,1]
v_pk_mul_f32 v[70:71],v[70:71],v[180:181] op_sel:[0,1] op_sel_hi:[1,1]
v_pk_mul_f32 v[124:125],v[56:57],v[56:57]
v_pk_mul_f32 v[126:127],v[58:59],v[58:59]
v_pk_mul_f32 v[128:129],v[60:61],v[60:61]
v_pk_mul_f32 v[130:131],v[62:63],v[62:63]
v_pk_mul_f32 v[132:133],v[64:65],v[64:65]
buffer_load_dwordx4 v1,s[8:11],s63 offen offset:3072 sc1 lds
v_pk_mul_f32 v[134:135],v[66:67],v[66:67]
v_pk_mul_f32 v[136:137],v[68:69],v[68:69]
v_pk_mul_f32 v[138:139],v[70:71],v[70:71]
v_pk_fma_f32 v[124:125],v[124:125],v[112:113],v[112:113] op_sel:[0,1,0] op_sel_hi:[1,1,0]
v_pk_fma_f32 v[126:127],v[126:127],v[112:113],v[112:113] op_sel:[0,1,0] op_sel_hi:[1,1,0]
v_pk_fma_f32 v[128:129],v[128:129],v[112:113],v[112:113] op_sel:[0,1,0] op_sel_hi:[1,1,0]
v_pk_fma_f32 v[130:131],v[130:131],v[112:113],v[112:113] op_sel:[0,1,0] op_sel_hi:[1,1,0]
s_add_u32 m0,s61,4096
s_add_u32 s63,s60,4096
buffer_load_dwordx4 v1,s[8:11],s63 offen sc1 lds
v_pk_fma_f32 v[132:133],v[132:133],v[112:113],v[112:113] op_sel:[0,1,0] op_sel_hi:[1,1,0]
v_pk_fma_f32 v[134:135],v[134:135],v[112:113],v[112:113] op_sel:[0,1,0] op_sel_hi:[1,1,0]
v_pk_fma_f32 v[136:137],v[136:137],v[112:113],v[112:113] op_sel:[0,1,0] op_sel_hi:[1,1,0]
v_pk_fma_f32 v[138:139],v[138:139],v[112:113],v[112:113] op_sel:[0,1,0] op_sel_hi:[1,1,0]
v_pk_mul_f32 v[124:125],v[124:125],v[56:57]
v_pk_mul_f32 v[126:127],v[126:127],v[58:59]
v_pk_mul_f32 v[128:129],v[128:129],v[60:61]
buffer_load_dwordx4 v1,s[8:11],s63 offen offset:1024 sc1 lds
v_pk_mul_f32 v[130:131],v[130:131],v[62:63]
v_pk_mul_f32 v[132:133],v[132:133],v[64:65]
v_pk_mul_f32 v[134:135],v[134:135],v[66:67]
v_pk_mul_f32 v[136:137],v[136:137],v[68:69]
v_pk_mul_f32 v[138:139],v[138:139],v[70:71]
v_exp_f32 v124,v124
v_exp_f32 v125,v125
buffer_load_dwordx4 v1,s[8:11],s63 offen offset:2048 sc1 lds
v_exp_f32 v126,v126
v_exp_f32 v127,v127
v_exp_f32 v128,v128
v_exp_f32 v129,v129
v_exp_f32 v130,v130
v_exp_f32 v131,v131
v_exp_f32 v132,v132
buffer_load_dwordx4 v1,s[8:11],s63 offen offset:3072 sc1 lds
v_exp_f32 v133,v133
v_exp_f32 v134,v134
v_exp_f32 v135,v135
v_exp_f32 v136,v136
v_exp_f32 v137,v137
v_exp_f32 v138,v138
v_exp_f32 v139,v139
s_add_u32 m0,s61,8192
s_add_u32 s63,s60,8192
buffer_load_dwordx4 v1,s[8:11],s63 offen sc1 lds
v_pk_add_f32 v[124:125],v[124:125],1.0 op_sel_hi:[1,0]
v_pk_add_f32 v[126:127],v[126:127],1.0 op_sel_hi:[1,0]
v_pk_add_f32 v[128:129],v[128:129],1.0 op_sel_hi:[1,0]
v_pk_add_f32 v[130:131],v[130:131],1.0 op_sel_hi:[1,0]
v_pk_add_f32 v[132:133],v[132:133],1.0 op_sel_hi:[1,0]
v_pk_add_f32 v[134:135],v[134:135],1.0 op_sel_hi:[1,0]
v_pk_add_f32 v[136:137],v[136:137],1.0 op_sel_hi:[1,0]
buffer_load_dwordx4 v1,s[8:11],s63 offen offset:1024 sc1 lds
v_pk_add_f32 v[138:139],v[138:139],1.0 op_sel_hi:[1,0]
v_rcp_f32 v124,v124
v_rcp_f32 v125,v125
v_rcp_f32 v126,v126
v_rcp_f32 v127,v127
v_rcp_f32 v128,v128
v_rcp_f32 v129,v129
s_add_u32 m0,s66,40960
s_add_u32 s63,s67,40960
buffer_load_dwordx4 v1,s[8:11],s63 offen sc1 lds
v_rcp_f32 v130,v130
v_rcp_f32 v131,v131
v_rcp_f32 v132,v132
v_rcp_f32 v133,v133
v_rcp_f32 v134,v134
v_rcp_f32 v135,v135
v_rcp_f32 v136,v136
s_mov_b32 s35,s42
buffer_load_dword v3,v2,s[8:11],s35 offen sc1
s_mov_b32 s53,s33
s_mov_b32 s54,s34
s_add_u32 s32,s32,1
s_mov_b32 s33,s40
s_mov_b32 s34,s41
s_mov_b64 s[76:77],s[80:81]
v_rcp_f32 v137,v137
v_rcp_f32 v138,v138
v_rcp_f32 v139,v139
v_pk_mul_f32 v[56:57],v[56:57],v[124:125]
v_pk_mul_f32 v[58:59],v[58:59],v[126:127]
v_pk_mul_f32 v[60:61],v[60:61],v[128:129]
v_pk_mul_f32 v[62:63],v[62:63],v[130:131]
v_pk_mul_f32 v[64:65],v[64:65],v[132:133]
v_pk_mul_f32 v[66:67],v[66:67],v[134:135]
v_pk_mul_f32 v[68:69],v[68:69],v[136:137]
v_pk_mul_f32 v[70:71],v[70:71],v[138:139]
v_cvt_pk_bf16_f32 v116,v56,v57
v_cvt_pk_bf16_f32 v117,v58,v59
v_cvt_pk_bf16_f32 v118,v60,v61
v_cvt_pk_bf16_f32 v119,v62,v63
v_cvt_pk_bf16_f32 v120,v64,v65
v_cvt_pk_bf16_f32 v121,v66,v67
v_cvt_pk_bf16_f32 v122,v68,v69
v_cvt_pk_bf16_f32 v123,v70,v71
s_cmp_lg_u32 s49,0
s_cbranch_scc0 ls_262
buffer_store_dwordx4 v[116:119],v20,s[8:11],s71 offen sc1
buffer_store_dwordx4 v[120:123],v21,s[8:11],s71 offen sc1
s_branch ls_263
ls_262:
buffer_store_dwordx4 v[116:119],v20,s[8:11],s71 offen
buffer_store_dwordx4 v[120:123],v21,s[8:11],s71 offen
ls_263:
s_mov_b32 s59,s82
s_branch W1_NEXT
nr_256:
buffer_load_dword v3,v2,s[8:11],s35 offen sc1
s_branch ep_255
W1_END:
s_endpgm
ROLE_W2:
v_lshlrev_b32 v1,4,v0
v_mov_b32 v5,1
s_lshl_b32 s56,s48,2
s_add_u32 s56,s56,s46
v_bfe_u32 v6,v0,2,2
v_lshrrev_b32 v7,4,v0
v_add_u32 v7,v6,v7
v_and_b32 v7,3,v7
v_and_b32 v15,3,v0
v_lshlrev_b32 v15,4,v15
v_lshl_add_u32 v15,v7,6,v15
v_lshl_add_u32 v15,v6,8,v15
v_lshrrev_b32 v6,5,v0
v_bfe_u32 v7,v0,4,1
v_lshlrev_b32 v16,10,v7
v_lshl_add_u32 v16,v6,8,v16
v_and_b32 v6,15,v0
v_lshl_add_u32 v16,v6,4,v16
v_add_u32 v18,40960,v16
v_lshrrev_b32 v6,5,v0
v_bfe_u32 v7,v0,4,1
v_lshlrev_b32 v20,10,v7
v_lshl_add_u32 v20,v6,8,v20
v_and_b32 v6,15,v0
v_lshl_add_u32 v20,v6,4,v20
v_lshrrev_b32 v6,5,v0
v_add_u32 v6,2,v6
v_bfe_u32 v7,v0,4,1
v_lshlrev_b32 v17,10,v7
v_lshl_add_u32 v17,v6,8,v17
v_and_b32 v6,15,v0
v_lshl_add_u32 v17,v6,4,v17
v_add_u32 v19,40960,v17
v_lshrrev_b32 v6,5,v0
v_add_u32 v6,2,v6
v_bfe_u32 v7,v0,4,1
v_lshlrev_b32 v21,10,v7
v_lshl_add_u32 v21,v6,8,v21
v_and_b32 v6,15,v0
v_lshl_add_u32 v21,v6,4,v21
v_min_u32 v2,19,v0
v_lshlrev_b32 v2,2,v2
s_lshr_b32 s60,s46,1
s_add_u32 s60,s60,1
s_sub_u32 s61,32,s60
s_add_u32 s60,s60,32
s_bitcmp1_b32 s46,0
s_cselect_b32 s60,s60,s61
v_and_b32 v6,15,v0
v_add_u32 v6,s60,v6
v_lshrrev_b32 v7,5,v6
v_mul_u32_u24 v112,40960,v7
v_bfe_u32 v7,v6,4,1
v_lshl_add_u32 v112,v7,10,v112
v_and_b32 v7,15,v6
v_lshl_add_u32 v112,v7,4,v112
v_lshrrev_b32 v7,4,v0
v_lshl_add_u32 v112,v7,8,v112
v_and_b32 v6,15,v0
v_add_u32 v6,s60,v6
v_add_u32 v6,16,v6
v_lshrrev_b32 v7,5,v6
v_mul_u32_u24 v113,40960,v7
v_bfe_u32 v7,v6,4,1
v_lshl_add_u32 v113,v7,10,v113
v_and_b32 v7,15,v6
v_lshl_add_u32 v113,v7,4,v113
v_lshrrev_b32 v7,4,v0
v_lshl_add_u32 v113,v7,8,v113
v_lshrrev_b32 v6,5,v0
v_and_b32 v7,15,v0
v_lshlrev_b32 v114,3,v7
v_lshl_add_u32 v114,v6,7,v114
v_and_b32 v114,31,v0
v_lshlrev_b32 v114,3,v114
v_lshrrev_b32 v6,5,v0
v_bfe_u32 v7,v0,4,1
v_lshlrev_b32 v116,10,v7
v_bfe_u32 v7,v0,2,2
v_lshl_add_u32 v116,v7,8,v116
v_add_u32 v6,v6,v7
v_and_b32 v6,3,v6
v_lshl_add_u32 v116,v6,6,v116
v_and_b32 v6,3,v0
v_lshl_add_u32 v116,v6,4,v116
v_lshrrev_b32 v6,5,v0
v_add_u32 v6,2,v6
v_bfe_u32 v7,v0,4,1
v_lshlrev_b32 v117,10,v7
v_bfe_u32 v7,v0,2,2
v_lshl_add_u32 v117,v7,8,v117
v_add_u32 v6,v6,v7
v_and_b32 v6,3,v6
v_lshl_add_u32 v117,v6,6,v117
v_and_b32 v6,3,v0
v_lshl_add_u32 v117,v6,4,v117
v_subrev_u32 v6,40960,v112
v_cmp_gt_u32 vcc,40960,v6
s_nop 1
v_cndmask_b32 v78,0,1,vcc
v_xor_b32 v76,1,v78
v_and_b32 v74,2047,v112
v_subrev_u32 v6,40960,v113
v_cmp_gt_u32 vcc,40960,v6
s_nop 1
v_cndmask_b32 v79,0,1,vcc
v_xor_b32 v77,1,v79
v_and_b32 v75,2047,v113
s_and_b32 s68,s46,1
s_lshl_b32 s68,s68,1
s_sub_u32 s68,s68,1
s_waitcnt vmcnt(0)
s_barrier
s_cmp_lg_u32 s46,0
s_cbranch_scc1 arr_264
v_mov_b32 v6,1
s_lshl_b32 s3,s49,2
v_mov_b32 v7,s3
s_mov_b64 exec,1
buffer_atomic_add v6,v7,s[12:15],0 offen sc1
s_mov_b64 exec,-1
arr_264:
s_lshl_b32 s3,s49,2
v_mov_b32 v7,s3
s_nop 1
ibw_265:
buffer_load_dword v6,v7,s[12:15],0 offen sc1
s_waitcnt vmcnt(0)
v_cmp_ne_u32 vcc,256,v6
s_nop 0
s_cbranch_vccz ok_266
s_sleep 8
s_sub_u32 s47,s47,1
s_cbranch_scc1 ABORT
s_branch ibw_265
ok_266:
s_cmp_lg_u32 s49,0
s_cbranch_scc1 ibok_267
v_and_b32 v7,7,v0
v_lshlrev_b32 v7,2,v7
buffer_load_dword v6,v7,s[12:15],0 offen offset:32 sc1
s_waitcnt vmcnt(0)
v_cmp_ne_u32 vcc,32,v6
s_nop 0
s_cbranch_vccz ibok_267
s_barrier
s_mov_b32 s49,1
s_mov_b32 s3,s2
s_load_dwordx16 s[16:31],s[0:1],0
s_load_dwordx8 s[32:39],s[0:1],64
s_waitcnt lgkmcnt(0)
s_branch DISPATCH
ibok_267:
s_lshl_b32 s58,s56,6
s_mul_i32 s63,s46,40960
s_mov_b32 s4,s34
s_mov_b32 s5,s35
s_mov_b32 s6,819200
s_mov_b32 s7,0x20000
v_lshrrev_b32 v9,2,v0
s_mov_b32 s64,1280
v_mul_lo_u32 v9,v9,s64
v_and_b32 v10,3,v0
v_lshl_add_u32 v6,v10,4,v9
s_add_u32 m0,s63,0
s_add_u32 s65,s58,0
buffer_load_dwordx4 v6,s[4:7],s65 offen lds
s_add_u32 m0,s63,1024
s_add_u32 s65,s58,20480
buffer_load_dwordx4 v6,s[4:7],s65 offen lds
s_add_u32 m0,s63,2048
s_add_u32 s65,s58,40960
buffer_load_dwordx4 v6,s[4:7],s65 offen lds
s_add_u32 m0,s63,3072
s_add_u32 s65,s58,61440
buffer_load_dwordx4 v6,s[4:7],s65 offen lds
s_add_u32 m0,s63,4096
s_add_u32 s65,s58,81920
buffer_load_dwordx4 v6,s[4:7],s65 offen lds
s_add_u32 m0,s63,5120
s_add_u32 s65,s58,102400
buffer_load_dwordx4 v6,s[4:7],s65 offen lds
s_add_u32 m0,s63,6144
s_add_u32 s65,s58,122880
buffer_load_dwordx4 v6,s[4:7],s65 offen lds
s_add_u32 m0,s63,7168
s_add_u32 s65,s58,143360
buffer_load_dwordx4 v6,s[4:7],s65 offen lds
s_add_u32 m0,s63,8192
s_add_u32 s65,s58,163840
buffer_load_dwordx4 v6,s[4:7],s65 offen lds
s_add_u32 m0,s63,9216
s_add_u32 s65,s58,184320
buffer_load_dwordx4 v6,s[4:7],s65 offen lds
s_add_u32 m0,s63,10240
s_add_u32 s65,s58,204800
buffer_load_dwordx4 v6,s[4:7],s65 offen lds
s_add_u32 m0,s63,11264
s_add_u32 s65,s58,225280
buffer_load_dwordx4 v6,s[4:7],s65 offen lds
s_add_u32 m0,s63,12288
s_add_u32 s65,s58,245760
buffer_load_dwordx4 v6,s[4:7],s65 offen lds
s_add_u32 m0,s63,13312
s_add_u32 s65,s58,266240
buffer_load_dwordx4 v6,s[4:7],s65 offen lds
s_add_u32 m0,s63,14336
s_add_u32 s65,s58,286720
buffer_load_dwordx4 v6,s[4:7],s65 offen lds
s_add_u32 m0,s63,15360
s_add_u32 s65,s58,307200
buffer_load_dwordx4 v6,s[4:7],s65 offen lds
s_add_u32 m0,s63,16384
s_add_u32 s65,s58,327680
buffer_load_dwordx4 v6,s[4:7],s65 offen lds
s_add_u32 m0,s63,17408
s_add_u32 s65,s58,348160
buffer_load_dwordx4 v6,s[4:7],s65 offen lds
s_add_u32 m0,s63,18432
s_add_u32 s65,s58,368640
buffer_load_dwordx4 v6,s[4:7],s65 offen lds
s_add_u32 m0,s63,19456
s_add_u32 s65,s58,389120
buffer_load_dwordx4 v6,s[4:7],s65 offen lds
s_add_u32 m0,s63,20480
s_add_u32 s65,s58,409600
buffer_load_dwordx4 v6,s[4:7],s65 offen lds
s_add_u32 m0,s63,21504
s_add_u32 s65,s58,430080
buffer_load_dwordx4 v6,s[4:7],s65 offen lds
s_add_u32 m0,s63,22528
s_add_u32 s65,s58,450560
buffer_load_dwordx4 v6,s[4:7],s65 offen lds
s_add_u32 m0,s63,23552
s_add_u32 s65,s58,471040
buffer_load_dwordx4 v6,s[4:7],s65 offen lds
s_add_u32 m0,s63,24576
s_add_u32 s65,s58,491520
buffer_load_dwordx4 v6,s[4:7],s65 offen lds
s_add_u32 m0,s63,25600
s_add_u32 s65,s58,512000
buffer_load_dwordx4 v6,s[4:7],s65 offen lds
s_add_u32 m0,s63,26624
s_add_u32 s65,s58,532480
buffer_load_dwordx4 v6,s[4:7],s65 offen lds
s_add_u32 m0,s63,27648
s_add_u32 s65,s58,552960
buffer_load_dwordx4 v6,s[4:7],s65 offen lds
s_add_u32 m0,s63,28672
s_add_u32 s65,s58,573440
buffer_load_dwordx4 v6,s[4:7],s65 offen lds
s_add_u32 m0,s63,29696
s_add_u32 s65,s58,593920
buffer_load_dwordx4 v6,s[4:7],s65 offen lds
s_add_u32 m0,s63,30720
s_add_u32 s65,s58,614400
buffer_load_dwordx4 v6,s[4:7],s65 offen lds
s_add_u32 m0,s63,31744
s_add_u32 s65,s58,634880
buffer_load_dwordx4 v6,s[4:7],s65 offen lds
s_add_u32 m0,s63,32768
s_add_u32 s65,s58,655360
buffer_load_dwordx4 v6,s[4:7],s65 offen lds
s_add_u32 m0,s63,33792
s_add_u32 s65,s58,675840
buffer_load_dwordx4 v6,s[4:7],s65 offen lds
s_add_u32 m0,s63,34816
s_add_u32 s65,s58,696320
buffer_load_dwordx4 v6,s[4:7],s65 offen lds
s_add_u32 m0,s63,35840
s_add_u32 s65,s58,716800
buffer_load_dwordx4 v6,s[4:7],s65 offen lds
s_add_u32 m0,s63,36864
s_add_u32 s65,s58,737280
buffer_load_dwordx4 v6,s[4:7],s65 offen lds
s_add_u32 m0,s63,37888
s_add_u32 s65,s58,757760
buffer_load_dwordx4 v6,s[4:7],s65 offen lds
s_add_u32 m0,s63,38912
s_add_u32 s65,s58,778240
buffer_load_dwordx4 v6,s[4:7],s65 offen lds
s_add_u32 m0,s63,39936
s_add_u32 s65,s58,798720
buffer_load_dwordx4 v6,s[4:7],s65 offen lds
s_waitcnt vmcnt(20)
v_bfe_u32 v9,v0,2,2
v_lshrrev_b32 v10,5,v0
v_lshl_add_u32 v9,v10,2,v9
v_mul_u32_u24 v9,64,v9
v_and_b32 v10,1,v0
v_lshl_add_u32 v9,v10,3,v9
v_bfe_u32 v10,v0,1,1
v_lshl_add_u32 v9,v10,5,v9
v_bfe_u32 v10,v0,4,1
v_lshl_add_u32 v9,v10,4,v9
v_add_u32 v7,s63,v9
ds_read_b64_tr_b16 a[0:1],v7 offset:0
ds_read_b64_tr_b16 a[2:3],v7 offset:1024
ds_read_b64_tr_b16 a[4:5],v7 offset:512
ds_read_b64_tr_b16 a[6:7],v7 offset:1536
ds_read_b64_tr_b16 a[8:9],v7 offset:2048
ds_read_b64_tr_b16 a[10:11],v7 offset:3072
ds_read_b64_tr_b16 a[12:13],v7 offset:2560
ds_read_b64_tr_b16 a[14:15],v7 offset:3584
ds_read_b64_tr_b16 a[16:17],v7 offset:4096
ds_read_b64_tr_b16 a[18:19],v7 offset:5120
ds_read_b64_tr_b16 a[20:21],v7 offset:4608
ds_read_b64_tr_b16 a[22:23],v7 offset:5632
s_waitcnt lgkmcnt(4)
ds_read_b64_tr_b16 a[24:25],v7 offset:6144
ds_read_b64_tr_b16 a[26:27],v7 offset:7168
ds_read_b64_tr_b16 a[28:29],v7 offset:6656
ds_read_b64_tr_b16 a[30:31],v7 offset:7680
ds_read_b64_tr_b16 a[32:33],v7 offset:8192
ds_read_b64_tr_b16 a[34:35],v7 offset:9216
ds_read_b64_tr_b16 a[36:37],v7 offset:8704
ds_read_b64_tr_b16 a[38:39],v7 offset:9728
ds_read_b64_tr_b16 a[40:41],v7 offset:10240
ds_read_b64_tr_b16 a[42:43],v7 offset:11264
ds_read_b64_tr_b16 a[44:45],v7 offset:10752
ds_read_b64_tr_b16 a[46:47],v7 offset:11776
s_waitcnt lgkmcnt(4)
ds_read_b64_tr_b16 a[48:49],v7 offset:12288
ds_read_b64_tr_b16 a[50:51],v7 offset:13312
ds_read_b64_tr_b16 a[52:53],v7 offset:12800
ds_read_b64_tr_b16 a[54:55],v7 offset:13824
ds_read_b64_tr_b16 a[56:57],v7 offset:14336
ds_read_b64_tr_b16 a[58:59],v7 offset:15360
ds_read_b64_tr_b16 a[60:61],v7 offset:14848
ds_read_b64_tr_b16 a[62:63],v7 offset:15872
ds_read_b64_tr_b16 a[64:65],v7 offset:16384
ds_read_b64_tr_b16 a[66:67],v7 offset:17408
ds_read_b64_tr_b16 a[68:69],v7 offset:16896
ds_read_b64_tr_b16 a[70:71],v7 offset:17920
s_waitcnt lgkmcnt(4)
ds_read_b64_tr_b16 a[72:73],v7 offset:18432
ds_read_b64_tr_b16 a[74:75],v7 offset:19456
ds_read_b64_tr_b16 a[76:77],v7 offset:18944
ds_read_b64_tr_b16 a[78:79],v7 offset:19968
s_waitcnt lgkmcnt(0)
s_waitcnt vmcnt(0)
v_bfe_u32 v9,v0,2,2
v_lshrrev_b32 v10,5,v0
v_lshl_add_u32 v9,v10,2,v9
v_mul_u32_u24 v9,64,v9
v_and_b32 v10,1,v0
v_lshl_add_u32 v9,v10,3,v9
v_bfe_u32 v10,v0,1,1
v_lshl_add_u32 v9,v10,5,v9
v_bfe_u32 v10,v0,4,1
v_lshl_add_u32 v9,v10,4,v9
v_add_u32 v7,s63,v9
ds_read_b64_tr_b16 a[80:81],v7 offset:20480
ds_read_b64_tr_b16 a[82:83],v7 offset:21504
ds_read_b64_tr_b16 a[84:85],v7 offset:20992
ds_read_b64_tr_b16 a[86:87],v7 offset:22016
ds_read_b64_tr_b16 a[88:89],v7 offset:22528
ds_read_b64_tr_b16 a[90:91],v7 offset:23552
ds_read_b64_tr_b16 a[92:93],v7 offset:23040
ds_read_b64_tr_b16 a[94:95],v7 offset:24064
ds_read_b64_tr_b16 a[96:97],v7 offset:24576
ds_read_b64_tr_b16 a[98:99],v7 offset:25600
ds_read_b64_tr_b16 a[100:101],v7 offset:25088
ds_read_b64_tr_b16 a[102:103],v7 offset:26112
s_waitcnt lgkmcnt(4)
ds_read_b64_tr_b16 a[104:105],v7 offset:26624
ds_read_b64_tr_b16 a[106:107],v7 offset:27648
ds_read_b64_tr_b16 a[108:109],v7 offset:27136
ds_read_b64_tr_b16 a[110:111],v7 offset:28160
ds_read_b64_tr_b16 a[112:113],v7 offset:28672
ds_read_b64_tr_b16 a[114:115],v7 offset:29696
ds_read_b64_tr_b16 a[116:117],v7 offset:29184
ds_read_b64_tr_b16 a[118:119],v7 offset:30208
ds_read_b64_tr_b16 a[120:121],v7 offset:30720
ds_read_b64_tr_b16 a[122:123],v7 offset:31744
ds_read_b64_tr_b16 a[124:125],v7 offset:31232
ds_read_b64_tr_b16 a[126:127],v7 offset:32256
s_waitcnt lgkmcnt(4)
ds_read_b64_tr_b16 a[128:129],v7 offset:32768
ds_read_b64_tr_b16 a[130:131],v7 offset:33792
ds_read_b64_tr_b16 a[132:133],v7 offset:33280
ds_read_b64_tr_b16 a[134:135],v7 offset:34304
ds_read_b64_tr_b16 a[136:137],v7 offset:34816
ds_read_b64_tr_b16 a[138:139],v7 offset:35840
ds_read_b64_tr_b16 a[140:141],v7 offset:35328
ds_read_b64_tr_b16 a[142:143],v7 offset:36352
ds_read_b64_tr_b16 a[144:145],v7 offset:36864
ds_read_b64_tr_b16 a[146:147],v7 offset:37888
ds_read_b64_tr_b16 a[148:149],v7 offset:37376
ds_read_b64_tr_b16 a[150:151],v7 offset:38400
s_waitcnt lgkmcnt(4)
ds_read_b64_tr_b16 a[152:153],v7 offset:38912
ds_read_b64_tr_b16 a[154:155],v7 offset:39936
ds_read_b64_tr_b16 a[156:157],v7 offset:39424
ds_read_b64_tr_b16 a[158:159],v7 offset:40448
s_waitcnt lgkmcnt(0)
s_barrier
s_mov_b32 s50,0
s_mov_b32 s32,0
s_mov_b32 s57,0
s_mov_b32 s59,2147483648
s_mov_b32 s82,2147483648
s_mov_b32 s39,2147483648
v_mov_b32 v22,83968
v_lshl_add_u32 v22,v0,2,v22
v_mov_b32 v23,0
ds_write_b32 v22,v23
s_mov_b32 s39,1600000
v_and_b32 v72,15,v0
v_lshlrev_b32 v72,7,v72
s_mul_i32 s60,s56,-1792
s_add_u32 s60,s60,40960
v_and_b32 v6,128,v72
v_add_u32 v6,s60,v6
v_cmp_lt_u32 vcc,15,v0
s_nop 1
v_cndmask_b32 v72,v72,v6,vcc
v_min_u32 v6,59,v0
v_lshlrev_b32 v6,2,v6
v_add_u32 v2,135168,v6
v_add_u32 v7,-80,v6
v_cmp_gt_u32 s[78:79],20,v0
s_nop 1
v_cndmask_b32 v2,v7,v2,s[78:79]
s_mov_b32 s51,0
s_mov_b32 s52,0
s_mul_i32 s62,s51,8
s_and_b32 s63,s52,7
s_add_u32 s62,s62,s63
s_mul_i32 s62,s62,46080
s_add_u32 s62,s62,212467712
s_lshl_b32 s63,s56,11
s_add_u32 s62,s62,s63
buffer_load_dword v73,v72,s[8:11],s62 offen sc1
s_mov_b32 s51,0
s_mov_b32 s52,1
s_mul_i32 s62,s51,8
s_and_b32 s63,s52,7
s_add_u32 s62,s62,s63
s_mul_i32 s62,s62,46080
s_add_u32 s62,s62,212467712
s_lshl_b32 s63,s56,11
s_add_u32 s62,s62,s63
buffer_load_dword v73,v72,s[8:11],s62 offen sc1
s_mov_b32 s51,0
s_mov_b32 s52,2
s_mul_i32 s62,s51,8
s_and_b32 s63,s52,7
s_add_u32 s62,s62,s63
s_mul_i32 s62,s62,46080
s_add_u32 s62,s62,212467712
s_lshl_b32 s63,s56,11
s_add_u32 s62,s62,s63
buffer_load_dword v73,v72,s[8:11],s62 offen sc1
s_mov_b32 s51,0
s_mov_b32 s52,3
s_mul_i32 s62,s51,8
s_and_b32 s63,s52,7
s_add_u32 s62,s62,s63
s_mul_i32 s62,s62,46080
s_add_u32 s62,s62,212467712
s_lshl_b32 s63,s56,11
s_add_u32 s62,s62,s63
buffer_load_dword v73,v72,s[8:11],s62 offen sc1
s_mov_b32 s51,0
s_mov_b32 s52,4
s_mul_i32 s62,s51,8
s_and_b32 s63,s52,7
s_add_u32 s62,s62,s63
s_mul_i32 s62,s62,46080
s_add_u32 s62,s62,212467712
s_lshl_b32 s63,s56,11
s_add_u32 s62,s62,s63
buffer_load_dword v73,v72,s[8:11],s62 offen sc1
s_mov_b32 s51,0
s_mov_b32 s52,5
s_mul_i32 s62,s51,8
s_and_b32 s63,s52,7
s_add_u32 s62,s62,s63
s_mul_i32 s62,s62,46080
s_add_u32 s62,s62,212467712
s_lshl_b32 s63,s56,11
s_add_u32 s62,s62,s63
buffer_load_dword v73,v72,s[8:11],s62 offen sc1
s_mov_b32 s51,0
s_mov_b32 s52,6
s_mul_i32 s62,s51,8
s_and_b32 s63,s52,7
s_add_u32 s62,s62,s63
s_mul_i32 s62,s62,46080
s_add_u32 s62,s62,212467712
s_lshl_b32 s63,s56,11
s_add_u32 s62,s62,s63
buffer_load_dword v73,v72,s[8:11],s62 offen sc1
s_mov_b32 s51,0
s_mov_b32 s52,7
s_mul_i32 s62,s51,8
s_and_b32 s63,s52,7
s_add_u32 s62,s62,s63
s_mul_i32 s62,s62,46080
s_add_u32 s62,s62,212467712
s_lshl_b32 s63,s56,11
s_add_u32 s62,s62,s63
buffer_load_dword v73,v72,s[8:11],s62 offen sc1
s_mov_b32 s51,1
s_mov_b32 s52,0
s_mul_i32 s62,s51,8
s_and_b32 s63,s52,7
s_add_u32 s62,s62,s63
s_mul_i32 s62,s62,46080
s_add_u32 s62,s62,212467712
s_lshl_b32 s63,s56,11
s_add_u32 s62,s62,s63
buffer_load_dword v73,v72,s[8:11],s62 offen sc1
s_mov_b32 s51,1
s_mov_b32 s52,1
s_mul_i32 s62,s51,8
s_and_b32 s63,s52,7
s_add_u32 s62,s62,s63
s_mul_i32 s62,s62,46080
s_add_u32 s62,s62,212467712
s_lshl_b32 s63,s56,11
s_add_u32 s62,s62,s63
buffer_load_dword v73,v72,s[8:11],s62 offen sc1
s_mov_b32 s51,1
s_mov_b32 s52,2
s_mul_i32 s62,s51,8
s_and_b32 s63,s52,7
s_add_u32 s62,s62,s63
s_mul_i32 s62,s62,46080
s_add_u32 s62,s62,212467712
s_lshl_b32 s63,s56,11
s_add_u32 s62,s62,s63
buffer_load_dword v73,v72,s[8:11],s62 offen sc1
s_mov_b32 s51,1
s_mov_b32 s52,3
s_mul_i32 s62,s51,8
s_and_b32 s63,s52,7
s_add_u32 s62,s62,s63
s_mul_i32 s62,s62,46080
s_add_u32 s62,s62,212467712
s_lshl_b32 s63,s56,11
s_add_u32 s62,s62,s63
buffer_load_dword v73,v72,s[8:11],s62 offen sc1
s_mov_b32 s51,1
s_mov_b32 s52,4
s_mul_i32 s62,s51,8
s_and_b32 s63,s52,7
s_add_u32 s62,s62,s63
s_mul_i32 s62,s62,46080
s_add_u32 s62,s62,212467712
s_lshl_b32 s63,s56,11
s_add_u32 s62,s62,s63
buffer_load_dword v73,v72,s[8:11],s62 offen sc1
s_mov_b32 s51,1
s_mov_b32 s52,5
s_mul_i32 s62,s51,8
s_and_b32 s63,s52,7
s_add_u32 s62,s62,s63
s_mul_i32 s62,s62,46080
s_add_u32 s62,s62,212467712
s_lshl_b32 s63,s56,11
s_add_u32 s62,s62,s63
buffer_load_dword v73,v72,s[8:11],s62 offen sc1
s_mov_b32 s51,1
s_mov_b32 s52,6
s_mul_i32 s62,s51,8
s_and_b32 s63,s52,7
s_add_u32 s62,s62,s63
s_mul_i32 s62,s62,46080
s_add_u32 s62,s62,212467712
s_lshl_b32 s63,s56,11
s_add_u32 s62,s62,s63
buffer_load_dword v73,v72,s[8:11],s62 offen sc1
s_mov_b32 s51,1
s_mov_b32 s52,7
s_mul_i32 s62,s51,8
s_and_b32 s63,s52,7
s_add_u32 s62,s62,s63
s_mul_i32 s62,s62,46080
s_add_u32 s62,s62,212467712
s_lshl_b32 s63,s56,11
s_add_u32 s62,s62,s63
buffer_load_dword v73,v72,s[8:11],s62 offen sc1
s_waitcnt vmcnt(0)
s_waitcnt lgkmcnt(0)
s_barrier
s_mov_b32 s83,s100
s_min_u32 s62,s32,127
s_sub_u32 s60,s62,16
s_lshr_b32 s34,s60,1
s_and_b32 s33,s60,1
s_cmp_eq_u32 s33,0
s_cselect_b32 s61,16,0
s_add_u32 s34,s34,s61
s_sub_u32 s61,s60,48
s_cmp_ge_u32 s60,96
s_cselect_b32 s34,s61,s34
s_cselect_b32 s33,1,s33
s_cmp_lt_u32 s62,16
s_cselect_b32 s34,s62,s34
s_cselect_b32 s33,0,s33
s_add_u32 s60,s34,1
s_min_u32 s60,s60,63
s_lshl_b32 s35,s33,6
s_add_u32 s35,s35,s60
s_lshl_b32 s35,s35,9
s_add_u32 s35,s35,323584
s_cmp_lt_u32 s60,8
s_cselect_b64 s[76:77],s[78:79],-1
s_sub_u32 s57,40960,s57
v_swap_b32 v16,v18
v_swap_b32 v17,v19
s_add_u32 s62,s32,1
s_min_u32 s62,s62,127
s_sub_u32 s60,s62,16
s_lshr_b32 s41,s60,1
s_and_b32 s40,s60,1
s_cmp_eq_u32 s40,0
s_cselect_b32 s61,16,0
s_add_u32 s41,s41,s61
s_sub_u32 s61,s60,48
s_cmp_ge_u32 s60,96
s_cselect_b32 s41,s61,s41
s_cselect_b32 s40,1,s40
s_cmp_lt_u32 s62,16
s_cselect_b32 s41,s62,s41
s_cselect_b32 s40,0,s40
s_add_u32 s60,s41,1
s_min_u32 s60,s60,63
s_lshl_b32 s42,s40,6
s_add_u32 s42,s42,s60
s_lshl_b32 s42,s42,9
s_add_u32 s42,s42,323584
s_cmp_lt_u32 s60,8
s_cselect_b64 s[80:81],s[78:79],-1
W2_COLD:
s_mov_b32 s37,0
fb_268:
buffer_load_dword v3,v2,s[8:11],s35 offen sc1
s_waitcnt vmcnt(0)
v_cmp_eq_u32 vcc,0,v3
s_and_b64 vcc,vcc,s[76:77]
s_cbranch_scc0 ok_269
s_sleep 1
s_sub_u32 s47,s47,1
s_cbranch_scc1 ABORT
s_branch fb_268
ok_269:
W2_COLD2:
s_sub_u32 s66,40960,s57
s_add_u32 s61,s34,s68
s_and_b32 s62,s61,7
s_cmp_lt_u32 s61,64
s_cselect_b32 s62,s62,8
s_mul_i32 s62,s62,40960
s_and_b32 s61,s34,7
s_mul_i32 s61,s61,40960
v_mad_u32_u24 v112,v76,s62,v74
v_mad_u32_u24 v112,v78,s61,v112
v_mad_u32_u24 v113,v77,s62,v75
v_mad_u32_u24 v113,v79,s61,v113
s_mov_b32 s60,s33
s_mul_i32 s60,s60,368640
s_add_u32 s60,s60,s37
s_mul_i32 s61,s46,10240
s_add_u32 s60,s60,s61
s_add_u32 s60,s60,237371392
s_add_u32 s61,s61,s66
s_add_u32 m0,s61,0
s_add_u32 s63,s60,0
buffer_load_dwordx4 v112,s[8:11],s63 offen sc1 lds
s_add_u32 m0,s61,1024
s_nop 0
buffer_load_dwordx4 v113,s[8:11],s63 offen sc1 lds
s_add_u32 m0,s61,2048
s_add_u32 s63,s60,2048
buffer_load_dwordx4 v112,s[8:11],s63 offen sc1 lds
s_add_u32 m0,s61,3072
s_nop 0
buffer_load_dwordx4 v113,s[8:11],s63 offen sc1 lds
s_add_u32 m0,s61,4096
s_add_u32 s63,s60,4096
buffer_load_dwordx4 v112,s[8:11],s63 offen sc1 lds
s_add_u32 m0,s61,5120
s_nop 0
buffer_load_dwordx4 v113,s[8:11],s63 offen sc1 lds
s_waitcnt vmcnt(5)
s_mov_b64 exec,1
s_cmp_lg_u32 s49,0
s_cbranch_scc0 ls_270
buffer_store_dword v5,v1,s[8:11],s59 offen sc1
s_branch ls_271
ls_270:
buffer_store_dword v5,v1,s[8:11],s59 offen
ls_271:
s_mov_b64 exec,-1
s_mov_b32 s59,2147483648
s_add_u32 m0,s61,6144
s_add_u32 s63,s60,6144
buffer_load_dwordx4 v112,s[8:11],s63 offen sc1 lds
s_add_u32 m0,s61,7168
s_nop 0
buffer_load_dwordx4 v113,s[8:11],s63 offen sc1 lds
s_add_u32 m0,s61,8192
s_add_u32 s63,s60,8192
buffer_load_dwordx4 v112,s[8:11],s63 offen sc1 lds
s_add_u32 m0,s61,9216
s_nop 0
buffer_load_dwordx4 v113,s[8:11],s63 offen sc1 lds
s_mov_b32 s35,s42
s_mov_b32 s53,s33
s_mov_b32 s54,s34
s_add_u32 s32,s32,1
s_mov_b32 s33,s40
s_mov_b32 s34,s41
s_mov_b64 s[76:77],s[80:81]
s_sub_u32 s57,40960,s57
v_swap_b32 v16,v18
v_swap_b32 v17,v19
s_mov_b32 s51,s53
s_mov_b32 s52,s54
s_waitcnt vmcnt(5)
s_branch W2_GO
W2_NEXT:
s_sub_u32 s57,40960,s57
v_swap_b32 v16,v18
v_swap_b32 v17,v19
s_mov_b32 s51,s53
s_mov_b32 s52,s54
s_waitcnt vmcnt(3)
W2_GO:
s_barrier
ds_read_b128 v[24:27],v16 offset:0
ds_read_b128 v[28:31],v17 offset:0
ds_read_b128 v[32:35],v16 offset:10240
ds_read_b128 v[36:39],v17 offset:10240
ds_read_b128 v[40:43],v16 offset:20480
ds_read_b128 v[44:47],v17 offset:20480
ds_read_b128 v[48:51],v16 offset:30720
buffer_load_dword v3,v2,s[8:11],s35 offen sc1
s_waitcnt lgkmcnt(6)
v_mfma_f32_32x32x16_bf16 v[56:71],a[0:3],v[24:27],0
ds_read_b128 v[52:55],v17 offset:30720
s_lshl_b32 s60,s51,6
s_add_u32 s60,s60,s52
s_mul_i32 s60,s60,46080
s_waitcnt lgkmcnt(6)
v_mfma_f32_32x32x16_bf16 v[56:71],a[4:7],v[28:31],v[56:71]
ds_read_b128 v[24:27],v16 offset:2048
s_lshl_b32 s61,s56,11
s_add_u32 s60,s60,s61
s_add_u32 s60,s60,223608832
s_waitcnt lgkmcnt(5)
v_mfma_f32_32x32x16_bf16 v[56:71],a[40:43],v[32:35],v[56:71]
ds_read_b128 v[28:31],v17 offset:2048
buffer_load_dwordx4 v[120:123],v116,s[8:11],s60 offen sc1
buffer_load_dwordx4 v[124:127],v117,s[8:11],s60 offen sc1
v_mfma_f32_32x32x16_bf16 v[56:71],a[44:47],v[36:39],v[56:71]
ds_read_b128 v[32:35],v16 offset:12288
s_add_u32 s62,s32,1
s_min_u32 s62,s62,127
s_sub_u32 s60,s62,16
s_waitcnt lgkmcnt(5)
v_mfma_f32_32x32x16_bf16 v[56:71],a[80:83],v[40:43],v[56:71]
ds_read_b128 v[36:39],v17 offset:12288
s_lshr_b32 s41,s60,1
s_and_b32 s40,s60,1
s_cmp_eq_u32 s40,0
s_cselect_b32 s61,16,0
v_mfma_f32_32x32x16_bf16 v[56:71],a[84:87],v[44:47],v[56:71]
ds_read_b128 v[40:43],v16 offset:22528
s_add_u32 s41,s41,s61
s_sub_u32 s61,s60,48
s_mul_i32 s71,s51,8
s_waitcnt lgkmcnt(5)
v_mfma_f32_32x32x16_bf16 v[56:71],a[120:123],v[48:51],v[56:71]
ds_read_b128 v[44:47],v17 offset:22528
s_cmp_ge_u32 s60,96
s_cselect_b32 s41,s61,s41
s_cselect_b32 s40,1,s40
s_and_b32 s72,s52,7
v_mfma_f32_32x32x16_bf16 v[56:71],a[124:127],v[52:55],v[56:71]
ds_read_b128 v[48:51],v16 offset:32768
s_cmp_lt_u32 s62,16
s_cselect_b32 s41,s62,s41
s_cselect_b32 s40,0,s40
s_waitcnt lgkmcnt(5)
v_mfma_f32_32x32x16_bf16 v[56:71],a[8:11],v[24:27],v[56:71]
ds_read_b128 v[52:55],v17 offset:32768
s_add_u32 s60,s41,1
s_min_u32 s60,s60,63
s_lshl_b32 s42,s40,6
s_add_u32 s42,s42,s60
v_mfma_f32_32x32x16_bf16 v[56:71],a[12:15],v[28:31],v[56:71]
ds_read_b128 v[24:27],v16 offset:4096
s_lshl_b32 s42,s42,9
s_add_u32 s42,s42,323584
s_add_u32 s71,s71,s72
s_waitcnt lgkmcnt(5)
v_mfma_f32_32x32x16_bf16 v[56:71],a[48:51],v[32:35],v[56:71]
ds_read_b128 v[28:31],v17 offset:4096
s_cmp_lt_u32 s60,8
s_cselect_b64 s[80:81],s[78:79],-1
s_mul_i32 s71,s71,46080
s_add_u32 s71,s71,212467712
v_mfma_f32_32x32x16_bf16 v[56:71],a[52:55],v[36:39],v[56:71]
ds_read_b128 v[32:35],v16 offset:14336
s_lshl_b32 s72,s56,8
s_add_u32 s72,s72,s71
s_add_u32 s72,s72,40960
s_waitcnt lgkmcnt(5)
v_mfma_f32_32x32x16_bf16 v[56:71],a[88:91],v[40:43],v[56:71]
ds_read_b128 v[36:39],v17 offset:14336
s_waitcnt vmcnt(2)
s_mov_b64 exec,1
s_cmp_lg_u32 s49,0
s_cbranch_scc0 ls_272
buffer_store_dword v5,v1,s[8:11],s59 offen sc1
s_branch ls_273
ls_272:
buffer_store_dword v5,v1,s[8:11],s59 offen
ls_273:
s_mov_b64 exec,-1
s_mov_b32 s59,2147483648
v_mfma_f32_32x32x16_bf16 v[56:71],a[92:95],v[44:47],v[56:71]
ds_read_b128 v[40:43],v16 offset:24576
v_cmp_eq_u32 vcc,0,v3
s_and_b64 vcc,vcc,s[76:77]
s_cselect_b32 s37,2147483648,0
s_waitcnt lgkmcnt(5)
v_mfma_f32_32x32x16_bf16 v[56:71],a[128:131],v[48:51],v[56:71]
ds_read_b128 v[44:47],v17 offset:24576
s_cmp_lt_u32 s32,128
s_cselect_b32 s37,s37,2147483648
s_sub_u32 s66,40960,s57
s_add_u32 s61,s34,s68
v_mfma_f32_32x32x16_bf16 v[56:71],a[132:135],v[52:55],v[56:71]
ds_read_b128 v[48:51],v16 offset:34816
s_and_b32 s62,s61,7
s_cmp_lt_u32 s61,64
s_cselect_b32 s62,s62,8
s_waitcnt lgkmcnt(5)
v_mfma_f32_32x32x16_bf16 v[56:71],a[16:19],v[24:27],v[56:71]
ds_read_b128 v[52:55],v17 offset:34816
s_mul_i32 s62,s62,40960
s_and_b32 s61,s34,7
s_mul_i32 s61,s61,40960
v_mad_u32_u24 v112,v76,s62,v74
s_barrier
v_mfma_f32_32x32x16_bf16 v[56:71],a[20:23],v[28:31],v[56:71]
ds_read_b128 v[24:27],v16 offset:6144
v_mad_u32_u24 v112,v78,s61,v112
v_mad_u32_u24 v113,v77,s62,v75
v_mad_u32_u24 v113,v79,s61,v113
s_waitcnt lgkmcnt(5)
v_mfma_f32_32x32x16_bf16 v[56:71],a[56:59],v[32:35],v[56:71]
ds_read_b128 v[28:31],v17 offset:6144
s_mov_b32 s60,s33
s_mul_i32 s60,s60,368640
s_add_u32 s60,s60,s37
s_mul_i32 s61,s46,10240
v_mfma_f32_32x32x16_bf16 v[56:71],a[60:63],v[36:39],v[56:71]
ds_read_b128 v[32:35],v16 offset:16384
s_add_u32 s60,s60,s61
s_add_u32 s60,s60,237371392
s_add_u32 s61,s61,s66
s_waitcnt lgkmcnt(5)
v_mfma_f32_32x32x16_bf16 v[56:71],a[96:99],v[40:43],v[56:71]
ds_read_b128 v[36:39],v17 offset:16384
s_add_u32 m0,s61,0
s_add_u32 s63,s60,0
buffer_load_dwordx4 v112,s[8:11],s63 offen sc1 lds
v_mfma_f32_32x32x16_bf16 v[56:71],a[100:103],v[44:47],v[56:71]
ds_read_b128 v[40:43],v16 offset:26624
s_add_u32 m0,s61,1024
s_lshl_b32 s73,s56,11
s_add_u32 s71,s71,s73
s_waitcnt lgkmcnt(5)
v_mfma_f32_32x32x16_bf16 v[56:71],a[136:139],v[48:51],v[56:71]
ds_read_b128 v[44:47],v17 offset:26624
buffer_load_dwordx4 v113,s[8:11],s63 offen sc1 lds
s_add_u32 m0,s61,2048
s_add_u32 s63,s60,2048
v_mfma_f32_32x32x16_bf16 v[56:71],a[140:143],v[52:55],v[56:71]
ds_read_b128 v[48:51],v16 offset:36864
s_lshl_b32 s82,s51,6
s_add_u32 s82,s82,s52
s_lshl_b32 s82,s82,9
s_waitcnt lgkmcnt(5)
v_mfma_f32_32x32x16_bf16 v[56:71],a[24:27],v[24:27],v[56:71]
ds_read_b128 v[52:55],v17 offset:36864
buffer_load_dwordx4 v112,s[8:11],s63 offen sc1 lds
s_add_u32 m0,s61,3072
s_add_u32 s82,s82,524288
v_mfma_f32_32x32x16_bf16 v[56:71],a[28:31],v[28:31],v[56:71]
ds_read_b128 v[24:27],v16 offset:8192
s_lshl_b32 s70,s56,2
s_add_u32 s82,s82,s70
s_waitcnt lgkmcnt(5)
v_mfma_f32_32x32x16_bf16 v[56:71],a[64:67],v[32:35],v[56:71]
ds_read_b128 v[28:31],v17 offset:8192
buffer_load_dwordx4 v113,s[8:11],s63 offen sc1 lds
s_add_u32 m0,s61,4096
s_add_u32 s63,s60,4096
v_mfma_f32_32x32x16_bf16 v[56:71],a[68:71],v[36:39],v[56:71]
ds_read_b128 v[32:35],v16 offset:18432
s_waitcnt lgkmcnt(5)
v_mfma_f32_32x32x16_bf16 v[56:71],a[104:107],v[40:43],v[56:71]
ds_read_b128 v[36:39],v17 offset:18432
buffer_load_dwordx4 v112,s[8:11],s63 offen sc1 lds
s_add_u32 m0,s61,5120
v_mfma_f32_32x32x16_bf16 v[56:71],a[108:111],v[44:47],v[56:71]
ds_read_b128 v[40:43],v16 offset:28672
s_waitcnt lgkmcnt(5)
v_mfma_f32_32x32x16_bf16 v[56:71],a[144:147],v[48:51],v[56:71]
ds_read_b128 v[44:47],v17 offset:28672
buffer_load_dword v3,v2,s[8:11],s35 offen sc1
v_mfma_f32_32x32x16_bf16 v[56:71],a[148:151],v[52:55],v[56:71]
ds_read_b128 v[48:51],v16 offset:38912
buffer_load_dwordx4 v113,s[8:11],s63 offen sc1 lds
s_add_u32 m0,s61,6144
s_waitcnt lgkmcnt(5)
v_mfma_f32_32x32x16_bf16 v[56:71],a[32:35],v[24:27],v[56:71]
ds_read_b128 v[52:55],v17 offset:38912
s_add_u32 s63,s60,6144
v_mfma_f32_32x32x16_bf16 v[56:71],a[36:39],v[28:31],v[56:71]
buffer_load_dwordx4 v112,s[8:11],s63 offen sc1 lds
s_add_u32 m0,s61,7168
s_waitcnt lgkmcnt(4)
v_mfma_f32_32x32x16_bf16 v[56:71],a[72:75],v[32:35],v[56:71]
v_mfma_f32_32x32x16_bf16 v[56:71],a[76:79],v[36:39],v[56:71]
buffer_load_dwordx4 v113,s[8:11],s63 offen sc1 lds
s_add_u32 m0,s61,8192
s_add_u32 s63,s60,8192
s_waitcnt lgkmcnt(2)
v_mfma_f32_32x32x16_bf16 v[56:71],a[112:115],v[40:43],v[56:71]
v_mfma_f32_32x32x16_bf16 v[56:71],a[116:119],v[44:47],v[56:71]
buffer_load_dwordx4 v112,s[8:11],s63 offen sc1 lds
s_add_u32 m0,s61,9216
s_waitcnt lgkmcnt(0)
v_mfma_f32_32x32x16_bf16 v[56:71],a[152:155],v[48:51],v[56:71]
v_mfma_f32_32x32x16_bf16 v[56:71],a[156:159],v[52:55],v[56:71]
buffer_load_dwordx4 v113,s[8:11],s63 offen sc1 lds
s_waitcnt vmcnt(12)
v_lshlrev_b32 v128,16,v120
v_and_b32 v129,0xffff0000,v120
v_lshlrev_b32 v130,16,v121
v_and_b32 v131,0xffff0000,v121
v_lshlrev_b32 v132,16,v122
v_and_b32 v133,0xffff0000,v122
v_lshlrev_b32 v134,16,v123
v_and_b32 v135,0xffff0000,v123
v_lshlrev_b32 v136,16,v124
v_and_b32 v137,0xffff0000,v124
v_lshlrev_b32 v138,16,v125
v_and_b32 v139,0xffff0000,v125
v_lshlrev_b32 v140,16,v126
v_and_b32 v141,0xffff0000,v126
v_lshlrev_b32 v142,16,v127
v_and_b32 v143,0xffff0000,v127
s_cmp_eq_u32 s37,0
s_cbranch_scc0 sec_276
s_mov_b32 s35,s42
s_mov_b32 s53,s33
s_mov_b32 s54,s34
s_add_u32 s32,s32,1
s_mov_b32 s33,s40
s_mov_b32 s34,s41
s_mov_b64 s[76:77],s[80:81]
s_nop 2
ep_274:
v_cvt_pk_bf16_f32 v6,v56,v57
v_lshlrev_b32 v56,16,v6
v_and_b32 v57,0xffff0000,v6
v_cvt_pk_bf16_f32 v6,v58,v59
v_lshlrev_b32 v58,16,v6
v_and_b32 v59,0xffff0000,v6
v_cvt_pk_bf16_f32 v6,v60,v61
v_lshlrev_b32 v60,16,v6
v_and_b32 v61,0xffff0000,v6
v_cvt_pk_bf16_f32 v6,v62,v63
v_lshlrev_b32 v62,16,v6
v_and_b32 v63,0xffff0000,v6
v_cvt_pk_bf16_f32 v6,v64,v65
v_lshlrev_b32 v64,16,v6
v_and_b32 v65,0xffff0000,v6
v_cvt_pk_bf16_f32 v6,v66,v67
v_lshlrev_b32 v66,16,v6
v_and_b32 v67,0xffff0000,v6
v_cvt_pk_bf16_f32 v6,v68,v69
v_lshlrev_b32 v68,16,v6
v_and_b32 v69,0xffff0000,v6
v_cvt_pk_bf16_f32 v6,v70,v71
v_lshlrev_b32 v70,16,v6
v_and_b32 v71,0xffff0000,v6
v_pk_add_f32 v[56:57],v[56:57],v[128:129]
v_pk_add_f32 v[58:59],v[58:59],v[130:131]
v_pk_add_f32 v[60:61],v[60:61],v[132:133]
v_pk_add_f32 v[62:63],v[62:63],v[134:135]
v_pk_add_f32 v[64:65],v[64:65],v[136:137]
v_pk_add_f32 v[66:67],v[66:67],v[138:139]
v_pk_add_f32 v[68:69],v[68:69],v[140:141]
v_pk_add_f32 v[70:71],v[70:71],v[142:143]
v_cvt_pk_bf16_f32 v144,v56,v57
v_lshlrev_b32 v56,16,v144
v_and_b32 v57,0xffff0000,v144
v_cvt_pk_bf16_f32 v145,v58,v59
v_lshlrev_b32 v58,16,v145
v_and_b32 v59,0xffff0000,v145
v_cvt_pk_bf16_f32 v146,v60,v61
v_lshlrev_b32 v60,16,v146
v_and_b32 v61,0xffff0000,v146
v_cvt_pk_bf16_f32 v147,v62,v63
v_lshlrev_b32 v62,16,v147
v_and_b32 v63,0xffff0000,v147
v_cvt_pk_bf16_f32 v148,v64,v65
v_lshlrev_b32 v64,16,v148
v_and_b32 v65,0xffff0000,v148
v_cvt_pk_bf16_f32 v149,v66,v67
v_lshlrev_b32 v66,16,v149
v_and_b32 v67,0xffff0000,v149
v_cvt_pk_bf16_f32 v150,v68,v69
v_lshlrev_b32 v68,16,v150
v_and_b32 v69,0xffff0000,v150
v_cvt_pk_bf16_f32 v151,v70,v71
v_lshlrev_b32 v70,16,v151
v_and_b32 v71,0xffff0000,v151
s_cmp_lg_u32 s49,0
s_cbranch_scc0 ls_277
buffer_store_dwordx4 v[144:147],v20,s[8:11],s71 offen sc1
buffer_store_dwordx4 v[148:151],v21,s[8:11],s71 offen sc1
s_branch ls_278
ls_277:
buffer_store_dwordx4 v[144:147],v20,s[8:11],s71 offen
buffer_store_dwordx4 v[148:151],v21,s[8:11],s71 offen
ls_278:
v_pk_add_f32 v[6:7],v[56:57],v[58:59]
v_pk_mul_f32 v[8:9],v[56:57],v[56:57]
v_pk_fma_f32 v[8:9],v[58:59],v[58:59],v[8:9]
v_pk_add_f32 v[6:7],v[6:7],v[60:61]
v_pk_fma_f32 v[8:9],v[60:61],v[60:61],v[8:9]
v_pk_add_f32 v[6:7],v[6:7],v[62:63]
v_pk_fma_f32 v[8:9],v[62:63],v[62:63],v[8:9]
v_pk_add_f32 v[6:7],v[6:7],v[64:65]
v_pk_fma_f32 v[8:9],v[64:65],v[64:65],v[8:9]
v_pk_add_f32 v[6:7],v[6:7],v[66:67]
v_pk_fma_f32 v[8:9],v[66:67],v[66:67],v[8:9]
v_pk_add_f32 v[6:7],v[6:7],v[68:69]
v_pk_fma_f32 v[8:9],v[68:69],v[68:69],v[8:9]
v_pk_add_f32 v[6:7],v[6:7],v[70:71]
v_pk_fma_f32 v[8:9],v[70:71],v[70:71],v[8:9]
v_add_f32 v6,v6,v7
v_add_f32 v7,v8,v9
v_mov_b32 v8,v6
v_mov_b32 v9,v7
s_nop 0
v_permlane32_swap_b32 v6,v8
v_permlane32_swap_b32 v7,v9
v_pk_add_f32 v[6:7],v[6:7],v[8:9]
s_mov_b32 exec_hi,0
s_cmp_lg_u32 s49,0
s_cbranch_scc0 ls_279
buffer_store_dwordx2 v[6:7],v114,s[8:11],s72 offen sc1
s_branch ls_280
ls_279:
buffer_store_dwordx2 v[6:7],v114,s[8:11],s72 offen
ls_280:
s_mov_b32 exec_hi,-1
s_mov_b32 s59,s82
s_cmp_eq_u32 s37,0
s_cbranch_scc1 W2_NEXT
s_waitcnt vmcnt(3)
v_cmp_eq_u32 vcc,0,v3
s_and_b64 vcc,vcc,s[76:77]
s_cselect_b32 s37,2147483648,0
s_cmp_lt_u32 s32,128
s_cselect_b32 s37,s37,2147483648
s_cmp_eq_u32 s37,0
s_cbranch_scc1 W2_COLD2
s_waitcnt vmcnt(0)
s_mov_b64 exec,1
s_cmp_lg_u32 s49,0
s_cbranch_scc0 ls_281
buffer_store_dword v5,v1,s[8:11],s59 offen sc1
s_branch ls_282
ls_281:
buffer_store_dword v5,v1,s[8:11],s59 offen
ls_282:
s_mov_b64 exec,-1
s_mov_b32 s59,2147483648
s_cmp_lt_u32 s32,128
s_cbranch_scc1 W2_COLD
s_branch W2_END
sec_276:
s_waitcnt vmcnt(5)
v_cmp_eq_u32 vcc,0,v3
s_and_b64 vcc,vcc,s[76:77]
s_cselect_b32 s37,2147483648,0
s_cmp_lt_u32 s32,128
s_cselect_b32 s37,s37,2147483648
s_cmp_lg_u32 s37,0
s_cbranch_scc1 nr_275
s_sub_u32 s66,40960,s57
s_add_u32 s61,s34,s68
s_and_b32 s62,s61,7
s_cmp_lt_u32 s61,64
s_cselect_b32 s62,s62,8
s_mul_i32 s62,s62,40960
s_and_b32 s61,s34,7
s_mul_i32 s61,s61,40960
v_mad_u32_u24 v112,v76,s62,v74
v_mad_u32_u24 v112,v78,s61,v112
v_mad_u32_u24 v113,v77,s62,v75
v_mad_u32_u24 v113,v79,s61,v113
s_mov_b32 s60,s33
s_mul_i32 s60,s60,368640
s_add_u32 s60,s60,s37
s_mul_i32 s61,s46,10240
s_add_u32 s60,s60,s61
s_add_u32 s60,s60,237371392
s_add_u32 s61,s61,s66
s_add_u32 m0,s61,0
s_add_u32 s63,s60,0
buffer_load_dwordx4 v112,s[8:11],s63 offen sc1 lds
v_cvt_pk_bf16_f32 v6,v56,v57
v_lshlrev_b32 v56,16,v6
v_and_b32 v57,0xffff0000,v6
v_cvt_pk_bf16_f32 v6,v58,v59
s_add_u32 m0,s61,1024
s_nop 0
buffer_load_dwordx4 v113,s[8:11],s63 offen sc1 lds
v_lshlrev_b32 v58,16,v6
v_and_b32 v59,0xffff0000,v6
v_cvt_pk_bf16_f32 v6,v60,v61
v_lshlrev_b32 v60,16,v6
s_add_u32 m0,s61,2048
s_add_u32 s63,s60,2048
buffer_load_dwordx4 v112,s[8:11],s63 offen sc1 lds
v_and_b32 v61,0xffff0000,v6
v_cvt_pk_bf16_f32 v6,v62,v63
v_lshlrev_b32 v62,16,v6
v_and_b32 v63,0xffff0000,v6
s_add_u32 m0,s61,3072
s_nop 0
buffer_load_dwordx4 v113,s[8:11],s63 offen sc1 lds
v_cvt_pk_bf16_f32 v6,v64,v65
v_lshlrev_b32 v64,16,v6
v_and_b32 v65,0xffff0000,v6
v_cvt_pk_bf16_f32 v6,v66,v67
s_add_u32 m0,s61,4096
s_add_u32 s63,s60,4096
buffer_load_dwordx4 v112,s[8:11],s63 offen sc1 lds
v_lshlrev_b32 v66,16,v6
v_and_b32 v67,0xffff0000,v6
v_cvt_pk_bf16_f32 v6,v68,v69
v_lshlrev_b32 v68,16,v6
s_add_u32 m0,s61,5120
s_nop 0
buffer_load_dwordx4 v113,s[8:11],s63 offen sc1 lds
v_and_b32 v69,0xffff0000,v6
v_cvt_pk_bf16_f32 v6,v70,v71
v_lshlrev_b32 v70,16,v6
v_and_b32 v71,0xffff0000,v6
s_add_u32 m0,s61,6144
s_add_u32 s63,s60,6144
buffer_load_dwordx4 v112,s[8:11],s63 offen sc1 lds
v_pk_add_f32 v[56:57],v[56:57],v[128:129]
v_pk_add_f32 v[58:59],v[58:59],v[130:131]
v_pk_add_f32 v[60:61],v[60:61],v[132:133]
v_pk_add_f32 v[62:63],v[62:63],v[134:135]
s_add_u32 m0,s61,7168
s_nop 0
buffer_load_dwordx4 v113,s[8:11],s63 offen sc1 lds
v_pk_add_f32 v[64:65],v[64:65],v[136:137]
v_pk_add_f32 v[66:67],v[66:67],v[138:139]
v_pk_add_f32 v[68:69],v[68:69],v[140:141]
v_pk_add_f32 v[70:71],v[70:71],v[142:143]
s_add_u32 m0,s61,8192
s_add_u32 s63,s60,8192
buffer_load_dwordx4 v112,s[8:11],s63 offen sc1 lds
v_cvt_pk_bf16_f32 v144,v56,v57
v_lshlrev_b32 v56,16,v144
v_and_b32 v57,0xffff0000,v144
v_cvt_pk_bf16_f32 v145,v58,v59
s_add_u32 m0,s61,9216
s_nop 0
buffer_load_dwordx4 v113,s[8:11],s63 offen sc1 lds
v_lshlrev_b32 v58,16,v145
v_and_b32 v59,0xffff0000,v145
v_cvt_pk_bf16_f32 v146,v60,v61
v_lshlrev_b32 v60,16,v146
s_mov_b32 s35,s42
s_mov_b32 s53,s33
s_mov_b32 s54,s34
s_add_u32 s32,s32,1
s_mov_b32 s33,s40
s_mov_b32 s34,s41
s_mov_b64 s[76:77],s[80:81]
v_and_b32 v61,0xffff0000,v146
v_cvt_pk_bf16_f32 v147,v62,v63
v_lshlrev_b32 v62,16,v147
v_and_b32 v63,0xffff0000,v147
v_cvt_pk_bf16_f32 v148,v64,v65
v_lshlrev_b32 v64,16,v148
v_and_b32 v65,0xffff0000,v148
v_cvt_pk_bf16_f32 v149,v66,v67
v_lshlrev_b32 v66,16,v149
v_and_b32 v67,0xffff0000,v149
v_cvt_pk_bf16_f32 v150,v68,v69
v_lshlrev_b32 v68,16,v150
v_and_b32 v69,0xffff0000,v150
v_cvt_pk_bf16_f32 v151,v70,v71
v_lshlrev_b32 v70,16,v151
v_and_b32 v71,0xffff0000,v151
s_cmp_lg_u32 s49,0
s_cbranch_scc0 ls_283
buffer_store_dwordx4 v[144:147],v20,s[8:11],s71 offen sc1
buffer_store_dwordx4 v[148:151],v21,s[8:11],s71 offen sc1
s_branch ls_284
ls_283:
buffer_store_dwordx4 v[144:147],v20,s[8:11],s71 offen
buffer_store_dwordx4 v[148:151],v21,s[8:11],s71 offen
ls_284:
v_pk_add_f32 v[6:7],v[56:57],v[58:59]
v_pk_mul_f32 v[8:9],v[56:57],v[56:57]
v_pk_fma_f32 v[8:9],v[58:59],v[58:59],v[8:9]
v_pk_add_f32 v[6:7],v[6:7],v[60:61]
v_pk_fma_f32 v[8:9],v[60:61],v[60:61],v[8:9]
v_pk_add_f32 v[6:7],v[6:7],v[62:63]
v_pk_fma_f32 v[8:9],v[62:63],v[62:63],v[8:9]
v_pk_add_f32 v[6:7],v[6:7],v[64:65]
v_pk_fma_f32 v[8:9],v[64:65],v[64:65],v[8:9]
v_pk_add_f32 v[6:7],v[6:7],v[66:67]
v_pk_fma_f32 v[8:9],v[66:67],v[66:67],v[8:9]
v_pk_add_f32 v[6:7],v[6:7],v[68:69]
v_pk_fma_f32 v[8:9],v[68:69],v[68:69],v[8:9]
v_pk_add_f32 v[6:7],v[6:7],v[70:71]
v_pk_fma_f32 v[8:9],v[70:71],v[70:71],v[8:9]
v_add_f32 v6,v6,v7
v_add_f32 v7,v8,v9
v_mov_b32 v8,v6
v_mov_b32 v9,v7
s_nop 0
v_permlane32_swap_b32 v6,v8
v_permlane32_swap_b32 v7,v9
v_pk_add_f32 v[6:7],v[6:7],v[8:9]
s_mov_b32 exec_hi,0
s_cmp_lg_u32 s49,0
s_cbranch_scc0 ls_285
buffer_store_dwordx2 v[6:7],v114,s[8:11],s72 offen sc1
s_branch ls_286
ls_285:
buffer_store_dwordx2 v[6:7],v114,s[8:11],s72 offen
ls_286:
s_mov_b32 exec_hi,-1
s_mov_b32 s59,s82
s_branch W2_NEXT
nr_275:
buffer_load_dword v3,v2,s[8:11],s35 offen sc1
s_branch ep_274
W2_END:
s_endpgm
ROLE_W3:
v_lshlrev_b32 v1,4,v0
v_mov_b32 v5,1
s_lshl_b32 s56,s48,2
s_add_u32 s56,s56,s46
v_bfe_u32 v6,v0,2,2
v_lshrrev_b32 v7,4,v0
v_add_u32 v7,v6,v7
v_and_b32 v7,3,v7
v_and_b32 v15,3,v0
v_lshlrev_b32 v15,4,v15
v_lshl_add_u32 v15,v7,6,v15
v_lshl_add_u32 v15,v6,8,v15
v_lshrrev_b32 v6,5,v0
v_bfe_u32 v7,v0,4,1
v_lshlrev_b32 v16,10,v7
v_lshl_add_u32 v16,v6,8,v16
v_and_b32 v6,15,v0
v_lshl_add_u32 v16,v6,4,v16
v_add_u32 v18,46080,v16
v_lshrrev_b32 v6,5,v0
v_bfe_u32 v7,v0,4,1
v_lshlrev_b32 v20,10,v7
v_lshl_add_u32 v20,v6,8,v20
v_and_b32 v6,15,v0
v_lshl_add_u32 v20,v6,4,v20
v_lshrrev_b32 v6,5,v0
v_add_u32 v6,2,v6
v_bfe_u32 v7,v0,4,1
v_lshlrev_b32 v17,10,v7
v_lshl_add_u32 v17,v6,8,v17
v_and_b32 v6,15,v0
v_lshl_add_u32 v17,v6,4,v17
v_add_u32 v19,46080,v17
v_lshrrev_b32 v6,5,v0
v_add_u32 v6,2,v6
v_bfe_u32 v7,v0,4,1
v_lshlrev_b32 v21,10,v7
v_lshl_add_u32 v21,v6,8,v21
v_and_b32 v6,15,v0
v_lshl_add_u32 v21,v6,4,v21
v_min_u32 v2,19,v0
v_lshlrev_b32 v2,2,v2
v_mov_b32 v112,0xc0135761
v_mov_b32 v113,0xbdd2d3e8
s_mov_b32 s68,0xbdd2d3e8
v_lshrrev_b32 v6,5,v0
v_mul_u32_u24 v182,2560,v6
v_and_b32 v6,31,v0
v_lshl_add_u32 v182,v6,3,v182
v_add_u32 v182,0xa000,v182
v_mov_b32 v20,v1
v_add_u32 v21,1024,v1
s_waitcnt vmcnt(0)
s_barrier
s_cmp_lg_u32 s46,0
s_cbranch_scc1 arr_287
v_mov_b32 v6,1
s_lshl_b32 s3,s49,2
v_mov_b32 v7,s3
s_mov_b64 exec,1
buffer_atomic_add v6,v7,s[12:15],0 offen sc1
s_mov_b64 exec,-1
arr_287:
s_lshl_b32 s3,s49,2
v_mov_b32 v7,s3
s_nop 1
ibw_288:
buffer_load_dword v6,v7,s[12:15],0 offen sc1
s_waitcnt vmcnt(0)
v_cmp_ne_u32 vcc,256,v6
s_nop 0
s_cbranch_vccz ok_289
s_sleep 8
s_sub_u32 s47,s47,1
s_cbranch_scc1 ABORT
s_branch ibw_288
ok_289:
s_cmp_lg_u32 s49,0
s_cbranch_scc1 ibok_290
v_and_b32 v7,7,v0
v_lshlrev_b32 v7,2,v7
buffer_load_dword v6,v7,s[12:15],0 offen offset:32 sc1
s_waitcnt vmcnt(0)
v_cmp_ne_u32 vcc,32,v6
s_nop 0
s_cbranch_vccz ibok_290
s_barrier
s_mov_b32 s49,1
s_mov_b32 s3,s2
s_load_dwordx16 s[16:31],s[0:1],0
s_load_dwordx8 s[32:39],s[0:1],64
s_waitcnt lgkmcnt(0)
s_branch DISPATCH
ibok_290:
s_lshl_b32 s58,s56,6
s_mul_i32 s63,s46,40960
s_mov_b32 s4,s36
s_mov_b32 s5,s37
s_mov_b32 s6,1966080
s_mov_b32 s7,0x20000
v_lshrrev_b32 v9,2,v0
s_mov_b32 s64,3072
v_mul_lo_u32 v9,v9,s64
v_and_b32 v10,3,v0
v_lshl_add_u32 v6,v10,4,v9
s_add_u32 m0,s63,0
s_add_u32 s65,s58,0
buffer_load_dwordx4 v6,s[4:7],s65 offen lds
s_add_u32 m0,s63,1024
s_add_u32 s65,s58,49152
buffer_load_dwordx4 v6,s[4:7],s65 offen lds
s_add_u32 m0,s63,2048
s_add_u32 s65,s58,98304
buffer_load_dwordx4 v6,s[4:7],s65 offen lds
s_add_u32 m0,s63,3072
s_add_u32 s65,s58,147456
buffer_load_dwordx4 v6,s[4:7],s65 offen lds
s_add_u32 m0,s63,4096
s_add_u32 s65,s58,196608
buffer_load_dwordx4 v6,s[4:7],s65 offen lds
s_add_u32 m0,s63,5120
s_add_u32 s65,s58,245760
buffer_load_dwordx4 v6,s[4:7],s65 offen lds
s_add_u32 m0,s63,6144
s_add_u32 s65,s58,294912
buffer_load_dwordx4 v6,s[4:7],s65 offen lds
s_add_u32 m0,s63,7168
s_add_u32 s65,s58,344064
buffer_load_dwordx4 v6,s[4:7],s65 offen lds
s_add_u32 m0,s63,8192
s_add_u32 s65,s58,393216
buffer_load_dwordx4 v6,s[4:7],s65 offen lds
s_add_u32 m0,s63,9216
s_add_u32 s65,s58,442368
buffer_load_dwordx4 v6,s[4:7],s65 offen lds
s_add_u32 m0,s63,10240
s_add_u32 s65,s58,491520
buffer_load_dwordx4 v6,s[4:7],s65 offen lds
s_add_u32 m0,s63,11264
s_add_u32 s65,s58,540672
buffer_load_dwordx4 v6,s[4:7],s65 offen lds
s_add_u32 m0,s63,12288
s_add_u32 s65,s58,589824
buffer_load_dwordx4 v6,s[4:7],s65 offen lds
s_add_u32 m0,s63,13312
s_add_u32 s65,s58,638976
buffer_load_dwordx4 v6,s[4:7],s65 offen lds
s_add_u32 m0,s63,14336
s_add_u32 s65,s58,688128
buffer_load_dwordx4 v6,s[4:7],s65 offen lds
s_add_u32 m0,s63,15360
s_add_u32 s65,s58,737280
buffer_load_dwordx4 v6,s[4:7],s65 offen lds
s_add_u32 m0,s63,16384
s_add_u32 s65,s58,786432
buffer_load_dwordx4 v6,s[4:7],s65 offen lds
s_add_u32 m0,s63,17408
s_add_u32 s65,s58,835584
buffer_load_dwordx4 v6,s[4:7],s65 offen lds
s_add_u32 m0,s63,18432
s_add_u32 s65,s58,884736
buffer_load_dwordx4 v6,s[4:7],s65 offen lds
s_add_u32 m0,s63,19456
s_add_u32 s65,s58,933888
buffer_load_dwordx4 v6,s[4:7],s65 offen lds
s_add_u32 m0,s63,20480
s_add_u32 s65,s58,983040
buffer_load_dwordx4 v6,s[4:7],s65 offen lds
s_add_u32 m0,s63,21504
s_add_u32 s65,s58,1032192
buffer_load_dwordx4 v6,s[4:7],s65 offen lds
s_add_u32 m0,s63,22528
s_add_u32 s65,s58,1081344
buffer_load_dwordx4 v6,s[4:7],s65 offen lds
s_add_u32 m0,s63,23552
s_add_u32 s65,s58,1130496
buffer_load_dwordx4 v6,s[4:7],s65 offen lds
s_add_u32 m0,s63,24576
s_add_u32 s65,s58,1179648
buffer_load_dwordx4 v6,s[4:7],s65 offen lds
s_add_u32 m0,s63,25600
s_add_u32 s65,s58,1228800
buffer_load_dwordx4 v6,s[4:7],s65 offen lds
s_add_u32 m0,s63,26624
s_add_u32 s65,s58,1277952
buffer_load_dwordx4 v6,s[4:7],s65 offen lds
s_add_u32 m0,s63,27648
s_add_u32 s65,s58,1327104
buffer_load_dwordx4 v6,s[4:7],s65 offen lds
s_add_u32 m0,s63,28672
s_add_u32 s65,s58,1376256
buffer_load_dwordx4 v6,s[4:7],s65 offen lds
s_add_u32 m0,s63,29696
s_add_u32 s65,s58,1425408
buffer_load_dwordx4 v6,s[4:7],s65 offen lds
s_add_u32 m0,s63,30720
s_add_u32 s65,s58,1474560
buffer_load_dwordx4 v6,s[4:7],s65 offen lds
s_add_u32 m0,s63,31744
s_add_u32 s65,s58,1523712
buffer_load_dwordx4 v6,s[4:7],s65 offen lds
s_add_u32 m0,s63,32768
s_add_u32 s65,s58,1572864
buffer_load_dwordx4 v6,s[4:7],s65 offen lds
s_add_u32 m0,s63,33792
s_add_u32 s65,s58,1622016
buffer_load_dwordx4 v6,s[4:7],s65 offen lds
s_add_u32 m0,s63,34816
s_add_u32 s65,s58,1671168
buffer_load_dwordx4 v6,s[4:7],s65 offen lds
s_add_u32 m0,s63,35840
s_add_u32 s65,s58,1720320
buffer_load_dwordx4 v6,s[4:7],s65 offen lds
s_add_u32 m0,s63,36864
s_add_u32 s65,s58,1769472
buffer_load_dwordx4 v6,s[4:7],s65 offen lds
s_add_u32 m0,s63,37888
s_add_u32 s65,s58,1818624
buffer_load_dwordx4 v6,s[4:7],s65 offen lds
s_add_u32 m0,s63,38912
s_add_u32 s65,s58,1867776
buffer_load_dwordx4 v6,s[4:7],s65 offen lds
s_add_u32 m0,s63,39936
s_add_u32 s65,s58,1916928
buffer_load_dwordx4 v6,s[4:7],s65 offen lds
s_waitcnt vmcnt(20)
v_bfe_u32 v9,v0,2,2
v_lshrrev_b32 v10,5,v0
v_lshl_add_u32 v9,v10,2,v9
v_mul_u32_u24 v9,64,v9
v_and_b32 v10,1,v0
v_lshl_add_u32 v9,v10,3,v9
v_bfe_u32 v10,v0,1,1
v_lshl_add_u32 v9,v10,5,v9
v_bfe_u32 v10,v0,4,1
v_lshl_add_u32 v9,v10,4,v9
v_add_u32 v7,s63,v9
ds_read_b64_tr_b16 a[0:1],v7 offset:0
ds_read_b64_tr_b16 a[2:3],v7 offset:1024
ds_read_b64_tr_b16 a[4:5],v7 offset:512
ds_read_b64_tr_b16 a[6:7],v7 offset:1536
ds_read_b64_tr_b16 a[8:9],v7 offset:2048
ds_read_b64_tr_b16 a[10:11],v7 offset:3072
ds_read_b64_tr_b16 a[12:13],v7 offset:2560
ds_read_b64_tr_b16 a[14:15],v7 offset:3584
ds_read_b64_tr_b16 a[16:17],v7 offset:4096
ds_read_b64_tr_b16 a[18:19],v7 offset:5120
ds_read_b64_tr_b16 a[20:21],v7 offset:4608
ds_read_b64_tr_b16 a[22:23],v7 offset:5632
s_waitcnt lgkmcnt(4)
ds_read_b64_tr_b16 a[24:25],v7 offset:6144
ds_read_b64_tr_b16 a[26:27],v7 offset:7168
ds_read_b64_tr_b16 a[28:29],v7 offset:6656
ds_read_b64_tr_b16 a[30:31],v7 offset:7680
ds_read_b64_tr_b16 a[32:33],v7 offset:8192
ds_read_b64_tr_b16 a[34:35],v7 offset:9216
ds_read_b64_tr_b16 a[36:37],v7 offset:8704
ds_read_b64_tr_b16 a[38:39],v7 offset:9728
ds_read_b64_tr_b16 a[40:41],v7 offset:10240
ds_read_b64_tr_b16 a[42:43],v7 offset:11264
ds_read_b64_tr_b16 a[44:45],v7 offset:10752
ds_read_b64_tr_b16 a[46:47],v7 offset:11776
s_waitcnt lgkmcnt(4)
ds_read_b64_tr_b16 a[48:49],v7 offset:12288
ds_read_b64_tr_b16 a[50:51],v7 offset:13312
ds_read_b64_tr_b16 a[52:53],v7 offset:12800
ds_read_b64_tr_b16 a[54:55],v7 offset:13824
ds_read_b64_tr_b16 a[56:57],v7 offset:14336
ds_read_b64_tr_b16 a[58:59],v7 offset:15360
ds_read_b64_tr_b16 a[60:61],v7 offset:14848
ds_read_b64_tr_b16 a[62:63],v7 offset:15872
ds_read_b64_tr_b16 a[64:65],v7 offset:16384
ds_read_b64_tr_b16 a[66:67],v7 offset:17408
ds_read_b64_tr_b16 a[68:69],v7 offset:16896
ds_read_b64_tr_b16 a[70:71],v7 offset:17920
s_waitcnt lgkmcnt(4)
ds_read_b64_tr_b16 a[72:73],v7 offset:18432
ds_read_b64_tr_b16 a[74:75],v7 offset:19456
ds_read_b64_tr_b16 a[76:77],v7 offset:18944
ds_read_b64_tr_b16 a[78:79],v7 offset:19968
s_waitcnt lgkmcnt(0)
s_waitcnt vmcnt(0)
v_bfe_u32 v9,v0,2,2
v_lshrrev_b32 v10,5,v0
v_lshl_add_u32 v9,v10,2,v9
v_mul_u32_u24 v9,64,v9
v_and_b32 v10,1,v0
v_lshl_add_u32 v9,v10,3,v9
v_bfe_u32 v10,v0,1,1
v_lshl_add_u32 v9,v10,5,v9
v_bfe_u32 v10,v0,4,1
v_lshl_add_u32 v9,v10,4,v9
v_add_u32 v7,s63,v9
ds_read_b64_tr_b16 a[80:81],v7 offset:20480
ds_read_b64_tr_b16 a[82:83],v7 offset:21504
ds_read_b64_tr_b16 a[84:85],v7 offset:20992
ds_read_b64_tr_b16 a[86:87],v7 offset:22016
ds_read_b64_tr_b16 a[88:89],v7 offset:22528
ds_read_b64_tr_b16 a[90:91],v7 offset:23552
ds_read_b64_tr_b16 a[92:93],v7 offset:23040
ds_read_b64_tr_b16 a[94:95],v7 offset:24064
ds_read_b64_tr_b16 a[96:97],v7 offset:24576
ds_read_b64_tr_b16 a[98:99],v7 offset:25600
ds_read_b64_tr_b16 a[100:101],v7 offset:25088
ds_read_b64_tr_b16 a[102:103],v7 offset:26112
s_waitcnt lgkmcnt(4)
ds_read_b64_tr_b16 a[104:105],v7 offset:26624
ds_read_b64_tr_b16 a[106:107],v7 offset:27648
ds_read_b64_tr_b16 a[108:109],v7 offset:27136
ds_read_b64_tr_b16 a[110:111],v7 offset:28160
ds_read_b64_tr_b16 a[112:113],v7 offset:28672
ds_read_b64_tr_b16 a[114:115],v7 offset:29696
ds_read_b64_tr_b16 a[116:117],v7 offset:29184
ds_read_b64_tr_b16 a[118:119],v7 offset:30208
ds_read_b64_tr_b16 a[120:121],v7 offset:30720
ds_read_b64_tr_b16 a[122:123],v7 offset:31744
ds_read_b64_tr_b16 a[124:125],v7 offset:31232
ds_read_b64_tr_b16 a[126:127],v7 offset:32256
s_waitcnt lgkmcnt(4)
ds_read_b64_tr_b16 a[128:129],v7 offset:32768
ds_read_b64_tr_b16 a[130:131],v7 offset:33792
ds_read_b64_tr_b16 a[132:133],v7 offset:33280
ds_read_b64_tr_b16 a[134:135],v7 offset:34304
ds_read_b64_tr_b16 a[136:137],v7 offset:34816
ds_read_b64_tr_b16 a[138:139],v7 offset:35840
ds_read_b64_tr_b16 a[140:141],v7 offset:35328
ds_read_b64_tr_b16 a[142:143],v7 offset:36352
ds_read_b64_tr_b16 a[144:145],v7 offset:36864
ds_read_b64_tr_b16 a[146:147],v7 offset:37888
ds_read_b64_tr_b16 a[148:149],v7 offset:37376
ds_read_b64_tr_b16 a[150:151],v7 offset:38400
s_waitcnt lgkmcnt(4)
ds_read_b64_tr_b16 a[152:153],v7 offset:38912
ds_read_b64_tr_b16 a[154:155],v7 offset:39936
ds_read_b64_tr_b16 a[156:157],v7 offset:39424
ds_read_b64_tr_b16 a[158:159],v7 offset:40448
s_waitcnt lgkmcnt(0)
v_mov_b32 v24,0x3f803f80
v_mov_b32 v25,0x3f803f80
v_mov_b32 v26,0x3f803f80
v_mov_b32 v27,0x3f803f80
s_nop 1
v_mfma_f32_32x32x16_bf16 v[144:159],a[0:3],v[24:27],0
v_mfma_f32_32x32x16_bf16 v[144:159],a[4:7],v[24:27],v[144:159]
v_mfma_f32_32x32x16_bf16 v[144:159],a[8:11],v[24:27],v[144:159]
v_mfma_f32_32x32x16_bf16 v[144:159],a[12:15],v[24:27],v[144:159]
v_mfma_f32_32x32x16_bf16 v[144:159],a[16:19],v[24:27],v[144:159]
v_mfma_f32_32x32x16_bf16 v[144:159],a[20:23],v[24:27],v[144:159]
v_mfma_f32_32x32x16_bf16 v[144:159],a[24:27],v[24:27],v[144:159]
v_mfma_f32_32x32x16_bf16 v[144:159],a[28:31],v[24:27],v[144:159]
v_mfma_f32_32x32x16_bf16 v[144:159],a[32:35],v[24:27],v[144:159]
v_mfma_f32_32x32x16_bf16 v[144:159],a[36:39],v[24:27],v[144:159]
v_mfma_f32_32x32x16_bf16 v[144:159],a[40:43],v[24:27],v[144:159]
v_mfma_f32_32x32x16_bf16 v[144:159],a[44:47],v[24:27],v[144:159]
v_mfma_f32_32x32x16_bf16 v[144:159],a[48:51],v[24:27],v[144:159]
v_mfma_f32_32x32x16_bf16 v[144:159],a[52:55],v[24:27],v[144:159]
v_mfma_f32_32x32x16_bf16 v[144:159],a[56:59],v[24:27],v[144:159]
v_mfma_f32_32x32x16_bf16 v[144:159],a[60:63],v[24:27],v[144:159]
v_mfma_f32_32x32x16_bf16 v[144:159],a[64:67],v[24:27],v[144:159]
v_mfma_f32_32x32x16_bf16 v[144:159],a[68:71],v[24:27],v[144:159]
v_mfma_f32_32x32x16_bf16 v[144:159],a[72:75],v[24:27],v[144:159]
v_mfma_f32_32x32x16_bf16 v[144:159],a[76:79],v[24:27],v[144:159]
v_mfma_f32_32x32x16_bf16 v[144:159],a[80:83],v[24:27],v[144:159]
v_mfma_f32_32x32x16_bf16 v[144:159],a[84:87],v[24:27],v[144:159]
v_mfma_f32_32x32x16_bf16 v[144:159],a[88:91],v[24:27],v[144:159]
v_mfma_f32_32x32x16_bf16 v[144:159],a[92:95],v[24:27],v[144:159]
v_mfma_f32_32x32x16_bf16 v[144:159],a[96:99],v[24:27],v[144:159]
v_mfma_f32_32x32x16_bf16 v[144:159],a[100:103],v[24:27],v[144:159]
v_mfma_f32_32x32x16_bf16 v[144:159],a[104:107],v[24:27],v[144:159]
v_mfma_f32_32x32x16_bf16 v[144:159],a[108:111],v[24:27],v[144:159]
v_mfma_f32_32x32x16_bf16 v[144:159],a[112:115],v[24:27],v[144:159]
v_mfma_f32_32x32x16_bf16 v[144:159],a[116:119],v[24:27],v[144:159]
v_mfma_f32_32x32x16_bf16 v[144:159],a[120:123],v[24:27],v[144:159]
v_mfma_f32_32x32x16_bf16 v[144:159],a[124:127],v[24:27],v[144:159]
v_mfma_f32_32x32x16_bf16 v[144:159],a[128:131],v[24:27],v[144:159]
v_mfma_f32_32x32x16_bf16 v[144:159],a[132:135],v[24:27],v[144:159]
v_mfma_f32_32x32x16_bf16 v[144:159],a[136:139],v[24:27],v[144:159]
v_mfma_f32_32x32x16_bf16 v[144:159],a[140:143],v[24:27],v[144:159]
v_mfma_f32_32x32x16_bf16 v[144:159],a[144:147],v[24:27],v[144:159]
v_mfma_f32_32x32x16_bf16 v[144:159],a[148:151],v[24:27],v[144:159]
v_mfma_f32_32x32x16_bf16 v[144:159],a[152:155],v[24:27],v[144:159]
v_mfma_f32_32x32x16_bf16 v[144:159],a[156:159],v[24:27],v[144:159]
s_barrier
s_mov_b32 s50,0
s_mov_b32 s32,0
s_mov_b32 s57,0
s_mov_b32 s59,2147483648
s_mov_b32 s82,2147483648
s_mov_b32 s39,2147483648
v_mov_b32 v22,94208
v_lshl_add_u32 v22,v0,2,v22
v_mov_b32 v23,0
ds_write_b32 v22,v23
s_mov_b32 s39,1600000
v_and_b32 v72,15,v0
v_lshlrev_b32 v72,7,v72
v_min_u32 v6,59,v0
v_lshlrev_b32 v6,2,v6
v_add_u32 v2,198656,v6
v_add_u32 v7,-80,v6
v_cmp_gt_u32 s[78:79],20,v0
s_nop 1
v_cndmask_b32 v2,v7,v2,s[78:79]
s_mov_b32 s51,0
s_mov_b32 s52,0
s_mul_i32 s62,s51,4
s_and_b32 s63,s52,3
s_add_u32 s62,s62,s63
s_mul_i32 s62,s62,98304
s_add_u32 s62,s62,242778112
s_lshl_b32 s63,s56,11
s_add_u32 s62,s62,s63
buffer_load_dword v73,v72,s[8:11],s62 offen sc1
s_mov_b32 s51,0
s_mov_b32 s52,1
s_mul_i32 s62,s51,4
s_and_b32 s63,s52,3
s_add_u32 s62,s62,s63
s_mul_i32 s62,s62,98304
s_add_u32 s62,s62,242778112
s_lshl_b32 s63,s56,11
s_add_u32 s62,s62,s63
buffer_load_dword v73,v72,s[8:11],s62 offen sc1
s_mov_b32 s51,0
s_mov_b32 s52,2
s_mul_i32 s62,s51,4
s_and_b32 s63,s52,3
s_add_u32 s62,s62,s63
s_mul_i32 s62,s62,98304
s_add_u32 s62,s62,242778112
s_lshl_b32 s63,s56,11
s_add_u32 s62,s62,s63
buffer_load_dword v73,v72,s[8:11],s62 offen sc1
s_mov_b32 s51,0
s_mov_b32 s52,3
s_mul_i32 s62,s51,4
s_and_b32 s63,s52,3
s_add_u32 s62,s62,s63
s_mul_i32 s62,s62,98304
s_add_u32 s62,s62,242778112
s_lshl_b32 s63,s56,11
s_add_u32 s62,s62,s63
buffer_load_dword v73,v72,s[8:11],s62 offen sc1
s_mov_b32 s51,1
s_mov_b32 s52,0
s_mul_i32 s62,s51,4
s_and_b32 s63,s52,3
s_add_u32 s62,s62,s63
s_mul_i32 s62,s62,98304
s_add_u32 s62,s62,242778112
s_lshl_b32 s63,s56,11
s_add_u32 s62,s62,s63
buffer_load_dword v73,v72,s[8:11],s62 offen sc1
s_mov_b32 s51,1
s_mov_b32 s52,1
s_mul_i32 s62,s51,4
s_and_b32 s63,s52,3
s_add_u32 s62,s62,s63
s_mul_i32 s62,s62,98304
s_add_u32 s62,s62,242778112
s_lshl_b32 s63,s56,11
s_add_u32 s62,s62,s63
buffer_load_dword v73,v72,s[8:11],s62 offen sc1
s_mov_b32 s51,1
s_mov_b32 s52,2
s_mul_i32 s62,s51,4
s_and_b32 s63,s52,3
s_add_u32 s62,s62,s63
s_mul_i32 s62,s62,98304
s_add_u32 s62,s62,242778112
s_lshl_b32 s63,s56,11
s_add_u32 s62,s62,s63
buffer_load_dword v73,v72,s[8:11],s62 offen sc1
s_mov_b32 s51,1
s_mov_b32 s52,3
s_mul_i32 s62,s51,4
s_and_b32 s63,s52,3
s_add_u32 s62,s62,s63
s_mul_i32 s62,s62,98304
s_add_u32 s62,s62,242778112
s_lshl_b32 s63,s56,11
s_add_u32 s62,s62,s63
buffer_load_dword v73,v72,s[8:11],s62 offen sc1
s_waitcnt vmcnt(0)
s_waitcnt lgkmcnt(0)
s_barrier
s_mov_b32 s83,s100
s_min_u32 s62,s32,127
s_sub_u32 s60,s62,17
s_lshr_b32 s34,s60,1
s_and_b32 s33,s60,1
s_cmp_eq_u32 s33,0
s_cselect_b32 s61,17,0
s_add_u32 s34,s34,s61
s_sub_u32 s61,s60,47
s_cmp_ge_u32 s60,94
s_cselect_b32 s34,s61,s34
s_cselect_b32 s33,1,s33
s_cmp_lt_u32 s62,17
s_cselect_b32 s34,s62,s34
s_cselect_b32 s33,0,s33
s_lshl_b32 s35,s33,6
s_add_u32 s35,s35,s34
s_lshl_b32 s35,s35,9
s_add_u32 s35,s35,325632
s_cmp_lt_u32 s34,4
s_cselect_b64 s[76:77],s[78:79],-1
s_sub_u32 s57,46080,s57
v_swap_b32 v16,v18
v_swap_b32 v17,v19
s_add_u32 s62,s32,1
s_min_u32 s62,s62,127
s_sub_u32 s60,s62,17
s_lshr_b32 s41,s60,1
s_and_b32 s40,s60,1
s_cmp_eq_u32 s40,0
s_cselect_b32 s61,17,0
s_add_u32 s41,s41,s61
s_sub_u32 s61,s60,47
s_cmp_ge_u32 s60,94
s_cselect_b32 s41,s61,s41
s_cselect_b32 s40,1,s40
s_cmp_lt_u32 s62,17
s_cselect_b32 s41,s62,s41
s_cselect_b32 s40,0,s40
s_lshl_b32 s42,s40,6
s_add_u32 s42,s42,s41
s_lshl_b32 s42,s42,9
s_add_u32 s42,s42,325632
s_cmp_lt_u32 s41,4
s_cselect_b64 s[80:81],s[78:79],-1
W3_COLD:
s_mov_b32 s37,0
fb_291:
buffer_load_dword v3,v2,s[8:11],s35 offen sc1
s_waitcnt vmcnt(0)
v_cmp_eq_u32 vcc,0,v3
s_and_b64 vcc,vcc,s[76:77]
s_cbranch_scc0 ok_292
s_sleep 1
s_sub_u32 s47,s47,1
s_cbranch_scc1 ABORT
s_branch fb_291
ok_292:
W3_COLD2:
s_sub_u32 s66,46080,s57
s_mul_i32 s60,s33,8
s_and_b32 s61,s34,7
s_add_u32 s60,s60,s61
s_mul_i32 s60,s60,46080
s_add_u32 s60,s60,s37
s_add_u32 s60,s60,212467712
s_mov_b32 s67,s60
s_mul_i32 s61,s46,10240
s_add_u32 s60,s60,s61
s_add_u32 s61,s61,s66
s_add_u32 m0,s61,0
s_add_u32 s63,s60,0
buffer_load_dwordx4 v1,s[8:11],s63 offen sc1 lds
buffer_load_dwordx4 v1,s[8:11],s63 offen offset:1024 sc1 lds
buffer_load_dwordx4 v1,s[8:11],s63 offen offset:2048 sc1 lds
buffer_load_dwordx4 v1,s[8:11],s63 offen offset:3072 sc1 lds
s_add_u32 m0,s61,4096
s_add_u32 s63,s60,4096
buffer_load_dwordx4 v1,s[8:11],s63 offen sc1 lds
buffer_load_dwordx4 v1,s[8:11],s63 offen offset:1024 sc1 lds
s_waitcnt vmcnt(5)
s_mov_b64 exec,1
s_cmp_lg_u32 s49,0
s_cbranch_scc0 ls_293
buffer_store_dword v5,v1,s[8:11],s59 offen sc1
s_branch ls_294
ls_293:
buffer_store_dword v5,v1,s[8:11],s59 offen
ls_294:
s_mov_b64 exec,-1
s_mov_b32 s59,2147483648
buffer_load_dwordx4 v1,s[8:11],s63 offen offset:2048 sc1 lds
buffer_load_dwordx4 v1,s[8:11],s63 offen offset:3072 sc1 lds
s_add_u32 m0,s61,8192
s_add_u32 s63,s60,8192
buffer_load_dwordx4 v1,s[8:11],s63 offen sc1 lds
buffer_load_dwordx4 v1,s[8:11],s63 offen offset:1024 sc1 lds
s_lshl_b32 s62,s46,10
s_add_u32 s62,s62,40960
s_add_u32 m0,s66,s62
s_add_u32 s63,s67,s62
buffer_load_dwordx4 v1,s[8:11],s63 offen sc1 lds
s_add_u32 m0,s66,45056
s_add_u32 s63,s67,45056
buffer_load_dwordx4 v1,s[8:11],s63 offen sc1 lds
s_mov_b32 s35,s42
s_mov_b32 s53,s33
s_mov_b32 s54,s34
s_add_u32 s32,s32,1
s_mov_b32 s33,s40
s_mov_b32 s34,s41
s_mov_b64 s[76:77],s[80:81]
s_sub_u32 s57,46080,s57
v_swap_b32 v16,v18
v_swap_b32 v17,v19
s_mov_b32 s51,s53
s_mov_b32 s52,s54
s_waitcnt vmcnt(7)
s_branch W3_GO
W3_NEXT:
s_sub_u32 s57,46080,s57
v_swap_b32 v16,v18
v_swap_b32 v17,v19
s_mov_b32 s51,s53
s_mov_b32 s52,s54
s_waitcnt vmcnt(2)
W3_GO:
s_barrier
ds_read_b128 v[24:27],v16 offset:0
ds_read_b128 v[28:31],v17 offset:0
ds_read_b128 v[32:35],v16 offset:10240
ds_read_b128 v[36:39],v17 offset:10240
ds_read_b128 v[40:43],v16 offset:20480
ds_read_b128 v[44:47],v17 offset:20480
ds_read_b128 v[48:51],v16 offset:30720
buffer_load_dword v3,v2,s[8:11],s35 offen sc1
s_waitcnt lgkmcnt(6)
v_mfma_f32_32x32x16_bf16 v[56:71],a[0:3],v[24:27],0
ds_read_b128 v[52:55],v17 offset:30720
s_add_u32 s62,s32,1
s_min_u32 s62,s62,127
s_sub_u32 s60,s62,17
s_waitcnt lgkmcnt(6)
v_mfma_f32_32x32x16_bf16 v[56:71],a[4:7],v[28:31],v[56:71]
ds_read_b128 v[24:27],v16 offset:2048
s_lshr_b32 s41,s60,1
s_and_b32 s40,s60,1
s_mul_i32 s71,s51,4
s_waitcnt lgkmcnt(5)
v_mfma_f32_32x32x16_bf16 v[56:71],a[40:43],v[32:35],v[56:71]
ds_read_b128 v[28:31],v17 offset:2048
s_cmp_eq_u32 s40,0
s_cselect_b32 s61,17,0
s_add_u32 s41,s41,s61
s_sub_u32 s61,s60,47
v_mfma_f32_32x32x16_bf16 v[56:71],a[44:47],v[36:39],v[56:71]
ds_read_b128 v[32:35],v16 offset:12288
s_cmp_ge_u32 s60,94
s_cselect_b32 s41,s61,s41
s_cselect_b32 s40,1,s40
s_waitcnt lgkmcnt(5)
v_mfma_f32_32x32x16_bf16 v[56:71],a[80:83],v[40:43],v[56:71]
ds_read_b128 v[36:39],v17 offset:12288
s_cmp_lt_u32 s62,17
s_cselect_b32 s41,s62,s41
s_cselect_b32 s40,0,s40
s_lshl_b32 s42,s40,6
v_mfma_f32_32x32x16_bf16 v[56:71],a[84:87],v[44:47],v[56:71]
ds_read_b128 v[40:43],v16 offset:22528
s_add_u32 s42,s42,s41
s_lshl_b32 s42,s42,9
s_add_u32 s42,s42,325632
s_waitcnt lgkmcnt(5)
v_mfma_f32_32x32x16_bf16 v[56:71],a[120:123],v[48:51],v[56:71]
ds_read_b128 v[44:47],v17 offset:22528
s_cmp_lt_u32 s41,4
s_cselect_b64 s[80:81],s[78:79],-1
s_and_b32 s72,s52,3
s_add_u32 s71,s71,s72
v_mfma_f32_32x32x16_bf16 v[56:71],a[124:127],v[52:55],v[56:71]
ds_read_b128 v[48:51],v16 offset:32768
s_mul_i32 s71,s71,98304
s_add_u32 s71,s71,242778112
s_lshl_b32 s72,s56,11
s_waitcnt lgkmcnt(5)
v_mfma_f32_32x32x16_bf16 v[56:71],a[8:11],v[24:27],v[56:71]
ds_read_b128 v[52:55],v17 offset:32768
s_add_u32 s71,s71,s72
s_lshl_b32 s82,s51,6
s_add_u32 s82,s82,s52
s_lshl_b32 s82,s82,9
v_mfma_f32_32x32x16_bf16 v[56:71],a[12:15],v[28:31],v[56:71]
ds_read_b128 v[24:27],v16 offset:4096
s_add_u32 s82,s82,589824
s_lshl_b32 s70,s56,2
s_add_u32 s82,s82,s70
s_waitcnt lgkmcnt(5)
v_mfma_f32_32x32x16_bf16 v[56:71],a[48:51],v[32:35],v[56:71]
ds_read_b128 v[28:31],v17 offset:4096
v_mfma_f32_32x32x16_bf16 v[56:71],a[52:55],v[36:39],v[56:71]
ds_read_b128 v[32:35],v16 offset:14336
s_waitcnt lgkmcnt(5)
v_mfma_f32_32x32x16_bf16 v[56:71],a[88:91],v[40:43],v[56:71]
ds_read_b128 v[36:39],v17 offset:14336
s_waitcnt vmcnt(0)
s_mov_b64 exec,1
s_cmp_lg_u32 s49,0
s_cbranch_scc0 ls_295
buffer_store_dword v5,v1,s[8:11],s59 offen sc1
s_branch ls_296
ls_295:
buffer_store_dword v5,v1,s[8:11],s59 offen
ls_296:
s_mov_b64 exec,-1
s_mov_b32 s59,2147483648
v_mfma_f32_32x32x16_bf16 v[56:71],a[92:95],v[44:47],v[56:71]
ds_read_b128 v[40:43],v16 offset:24576
v_cmp_eq_u32 vcc,0,v3
s_and_b64 vcc,vcc,s[76:77]
s_cselect_b32 s37,2147483648,0
s_waitcnt lgkmcnt(5)
v_mfma_f32_32x32x16_bf16 v[56:71],a[128:131],v[48:51],v[56:71]
ds_read_b128 v[44:47],v17 offset:24576
s_cmp_lt_u32 s32,128
s_cselect_b32 s37,s37,2147483648
s_sub_u32 s66,46080,s57
s_mul_i32 s60,s33,8
v_mfma_f32_32x32x16_bf16 v[56:71],a[132:135],v[52:55],v[56:71]
ds_read_b128 v[48:51],v16 offset:34816
s_and_b32 s61,s34,7
s_add_u32 s60,s60,s61
s_mul_i32 s60,s60,46080
s_waitcnt lgkmcnt(5)
v_mfma_f32_32x32x16_bf16 v[56:71],a[16:19],v[24:27],v[56:71]
ds_read_b128 v[52:55],v17 offset:34816
s_add_u32 s60,s60,s37
s_add_u32 s60,s60,212467712
s_mov_b32 s67,s60
s_mul_i32 s61,s46,10240
s_barrier
v_mfma_f32_32x32x16_bf16 v[56:71],a[20:23],v[28:31],v[56:71]
ds_read_b128 v[24:27],v16 offset:6144
v_add_u32 v183,s57,v182
s_add_u32 s60,s60,s61
s_add_u32 s61,s61,s66
s_waitcnt lgkmcnt(5)
v_mfma_f32_32x32x16_bf16 v[56:71],a[56:59],v[32:35],v[56:71]
ds_read_b128 v[28:31],v17 offset:6144
v_add_u32 v8,0x800,v183
s_add_u32 m0,s61,0
s_add_u32 s63,s60,0
v_mfma_f32_32x32x16_bf16 v[56:71],a[60:63],v[36:39],v[56:71]
ds_read_b128 v[32:35],v16 offset:16384
ds_read2_b64 v[160:163],v183 offset0:0 offset1:32
s_waitcnt lgkmcnt(6)
v_mfma_f32_32x32x16_bf16 v[56:71],a[96:99],v[40:43],v[56:71]
ds_read_b128 v[36:39],v17 offset:16384
ds_read2_b64 v[164:167],v183 offset0:64 offset1:96
buffer_load_dwordx4 v1,s[8:11],s63 offen sc1 lds
v_mfma_f32_32x32x16_bf16 v[56:71],a[100:103],v[44:47],v[56:71]
ds_read_b128 v[40:43],v16 offset:26624
ds_read2_b64 v[168:171],v183 offset0:128 offset1:160
s_waitcnt lgkmcnt(8)
v_mfma_f32_32x32x16_bf16 v[56:71],a[136:139],v[48:51],v[56:71]
ds_read_b128 v[44:47],v17 offset:26624
ds_read2_b64 v[172:175],v183 offset0:192 offset1:224
buffer_load_dwordx4 v1,s[8:11],s63 offen offset:1024 sc1 lds
v_mfma_f32_32x32x16_bf16 v[56:71],a[140:143],v[52:55],v[56:71]
ds_read_b128 v[48:51],v16 offset:36864
ds_read2_b64 v[176:179],v8 offset0:0 offset1:32
s_waitcnt lgkmcnt(10)
v_mfma_f32_32x32x16_bf16 v[56:71],a[24:27],v[24:27],v[56:71]
ds_read_b128 v[52:55],v17 offset:36864
buffer_load_dwordx4 v1,s[8:11],s63 offen offset:2048 sc1 lds
v_mfma_f32_32x32x16_bf16 v[56:71],a[28:31],v[28:31],v[56:71]
ds_read_b128 v[24:27],v16 offset:8192
s_waitcnt lgkmcnt(9)
v_mfma_f32_32x32x16_bf16 v[56:71],a[64:67],v[32:35],v[56:71]
ds_read_b128 v[28:31],v17 offset:8192
buffer_load_dwordx4 v1,s[8:11],s63 offen offset:3072 sc1 lds
s_add_u32 m0,s61,4096
s_add_u32 s63,s60,4096
v_mfma_f32_32x32x16_bf16 v[56:71],a[68:71],v[36:39],v[56:71]
ds_read_b128 v[32:35],v16 offset:18432
s_waitcnt lgkmcnt(4)
v_add_f32 v160,v160,v170
v_add_f32 v161,v161,v171
v_mfma_f32_32x32x16_bf16 v[56:71],a[104:107],v[40:43],v[56:71]
ds_read_b128 v[36:39],v17 offset:18432
buffer_load_dwordx4 v1,s[8:11],s63 offen sc1 lds
v_add_f32 v162,v162,v172
v_add_f32 v163,v163,v173
v_mfma_f32_32x32x16_bf16 v[56:71],a[108:111],v[44:47],v[56:71]
ds_read_b128 v[40:43],v16 offset:28672
v_add_f32 v164,v164,v174
v_add_f32 v165,v165,v175
v_add_f32 v166,v166,v176
s_waitcnt lgkmcnt(5)
v_mfma_f32_32x32x16_bf16 v[56:71],a[144:147],v[48:51],v[56:71]
ds_read_b128 v[44:47],v17 offset:28672
buffer_load_dword v3,v2,s[8:11],s35 offen sc1
v_add_f32 v167,v167,v177
v_mfma_f32_32x32x16_bf16 v[56:71],a[148:151],v[52:55],v[56:71]
ds_read_b128 v[48:51],v16 offset:38912
buffer_load_dwordx4 v1,s[8:11],s63 offen offset:1024 sc1 lds
v_add_f32 v168,v168,v178
s_waitcnt lgkmcnt(5)
v_mfma_f32_32x32x16_bf16 v[56:71],a[32:35],v[24:27],v[56:71]
ds_read_b128 v[52:55],v17 offset:38912
v_add_f32 v169,v169,v179
v_add_f32 v160,v160,v162
v_add_f32 v161,v161,v163
v_add_f32 v164,v164,v166
v_mfma_f32_32x32x16_bf16 v[56:71],a[36:39],v[28:31],v[56:71]
buffer_load_dwordx4 v1,s[8:11],s63 offen offset:2048 sc1 lds
v_add_f32 v165,v165,v167
v_add_f32 v160,v160,v164
v_add_f32 v161,v161,v165
s_waitcnt lgkmcnt(4)
v_mfma_f32_32x32x16_bf16 v[56:71],a[72:75],v[32:35],v[56:71]
v_add_f32 v160,v160,v168
v_add_f32 v161,v161,v169
v_mov_b32 v162,v160
v_mov_b32 v163,v161
s_nop 0
v_permlane32_swap_b32 v160,v162
v_mfma_f32_32x32x16_bf16 v[56:71],a[76:79],v[36:39],v[56:71]
buffer_load_dwordx4 v1,s[8:11],s63 offen offset:3072 sc1 lds
s_add_u32 m0,s61,8192
s_add_u32 s63,s60,8192
v_permlane32_swap_b32 v161,v163
s_waitcnt lgkmcnt(2)
v_mfma_f32_32x32x16_bf16 v[56:71],a[112:115],v[40:43],v[56:71]
v_add_f32 v180,v160,v162
v_add_f32 v181,v161,v163
v_mul_f32 v180,0x3acccccd,v180
v_mul_f32 v181,0x3acccccd,v181
v_fma_f32 v181,-v180,v180,v181
v_mfma_f32_32x32x16_bf16 v[56:71],a[116:119],v[44:47],v[56:71]
buffer_load_dwordx4 v1,s[8:11],s63 offen sc1 lds
v_max_f32 v181,0,v181
v_cvt_pk_bf16_f32 v8,v180,v181
v_lshlrev_b32 v180,16,v8
s_waitcnt lgkmcnt(0)
v_mfma_f32_32x32x16_bf16 v[56:71],a[152:155],v[48:51],v[56:71]
v_and_b32 v181,0xffff0000,v8
v_add_f32 v181,0x3727c5ac,v181
v_cvt_pk_bf16_f32 v8,v181,v181
v_lshlrev_b32 v181,16,v8
v_sqrt_f32 v181,v181
v_mfma_f32_32x32x16_bf16 v[56:71],a[156:159],v[52:55],v[56:71]
buffer_load_dwordx4 v1,s[8:11],s63 offen offset:1024 sc1 lds
s_lshl_b32 s62,s46,10
s_add_u32 s62,s62,40960
s_add_u32 m0,s66,s62
s_add_u32 s63,s67,s62
buffer_load_dwordx4 v1,s[8:11],s63 offen sc1 lds
s_add_u32 m0,s66,45056
s_add_u32 s63,s67,45056
buffer_load_dwordx4 v1,s[8:11],s63 offen sc1 lds
v_cvt_pk_bf16_f32 v8,v181,v181
v_lshlrev_b32 v181,16,v8
v_rcp_f32 v181,v181
s_cmp_eq_u32 s37,0
s_cbranch_scc0 sec_299
s_mov_b32 s35,s42
s_mov_b32 s53,s33
s_mov_b32 s54,s34
s_add_u32 s32,s32,1
s_mov_b32 s33,s40
s_mov_b32 s34,s41
s_mov_b64 s[76:77],s[80:81]
s_nop 2
ep_297:
v_pk_fma_f32 v[56:57],v[144:145],v[180:181],v[56:57] op_sel_hi:[1,0,1] neg_lo:[0,1,0] neg_hi:[0,1,0]
v_pk_fma_f32 v[58:59],v[146:147],v[180:181],v[58:59] op_sel_hi:[1,0,1] neg_lo:[0,1,0] neg_hi:[0,1,0]
v_pk_fma_f32 v[60:61],v[148:149],v[180:181],v[60:61] op_sel_hi:[1,0,1] neg_lo:[0,1,0] neg_hi:[0,1,0]
v_pk_fma_f32 v[62:63],v[150:151],v[180:181],v[62:63] op_sel_hi:[1,0,1] neg_lo:[0,1,0] neg_hi:[0,1,0]
v_pk_fma_f32 v[64:65],v[152:153],v[180:181],v[64:65] op_sel_hi:[1,0,1] neg_lo:[0,1,0] neg_hi:[0,1,0]
v_pk_fma_f32 v[66:67],v[154:155],v[180:181],v[66:67] op_sel_hi:[1,0,1] neg_lo:[0,1,0] neg_hi:[0,1,0]
v_pk_fma_f32 v[68:69],v[156:157],v[180:181],v[68:69] op_sel_hi:[1,0,1] neg_lo:[0,1,0] neg_hi:[0,1,0]
v_pk_fma_f32 v[70:71],v[158:159],v[180:181],v[70:71] op_sel_hi:[1,0,1] neg_lo:[0,1,0] neg_hi:[0,1,0]
v_pk_mul_f32 v[56:57],v[56:57],v[180:181] op_sel:[0,1] op_sel_hi:[1,1]
v_pk_mul_f32 v[58:59],v[58:59],v[180:181] op_sel:[0,1] op_sel_hi:[1,1]
v_pk_mul_f32 v[60:61],v[60:61],v[180:181] op_sel:[0,1] op_sel_hi:[1,1]
v_pk_mul_f32 v[62:63],v[62:63],v[180:181] op_sel:[0,1] op_sel_hi:[1,1]
v_pk_mul_f32 v[64:65],v[64:65],v[180:181] op_sel:[0,1] op_sel_hi:[1,1]
v_pk_mul_f32 v[66:67],v[66:67],v[180:181] op_sel:[0,1] op_sel_hi:[1,1]
v_pk_mul_f32 v[68:69],v[68:69],v[180:181] op_sel:[0,1] op_sel_hi:[1,1]
v_pk_mul_f32 v[70:71],v[70:71],v[180:181] op_sel:[0,1] op_sel_hi:[1,1]
v_pk_mul_f32 v[124:125],v[56:57],v[56:57]
v_pk_mul_f32 v[126:127],v[58:59],v[58:59]
v_pk_mul_f32 v[128:129],v[60:61],v[60:61]
v_pk_mul_f32 v[130:131],v[62:63],v[62:63]
v_pk_mul_f32 v[132:133],v[64:65],v[64:65]
v_pk_mul_f32 v[134:135],v[66:67],v[66:67]
v_pk_mul_f32 v[136:137],v[68:69],v[68:69]
v_pk_mul_f32 v[138:139],v[70:71],v[70:71]
v_pk_fma_f32 v[124:125],v[124:125],v[112:113],v[112:113] op_sel:[0,1,0] op_sel_hi:[1,1,0]
v_pk_fma_f32 v[126:127],v[126:127],v[112:113],v[112:113] op_sel:[0,1,0] op_sel_hi:[1,1,0]
v_pk_fma_f32 v[128:129],v[128:129],v[112:113],v[112:113] op_sel:[0,1,0] op_sel_hi:[1,1,0]
v_pk_fma_f32 v[130:131],v[130:131],v[112:113],v[112:113] op_sel:[0,1,0] op_sel_hi:[1,1,0]
v_pk_fma_f32 v[132:133],v[132:133],v[112:113],v[112:113] op_sel:[0,1,0] op_sel_hi:[1,1,0]
v_pk_fma_f32 v[134:135],v[134:135],v[112:113],v[112:113] op_sel:[0,1,0] op_sel_hi:[1,1,0]
v_pk_fma_f32 v[136:137],v[136:137],v[112:113],v[112:113] op_sel:[0,1,0] op_sel_hi:[1,1,0]
v_pk_fma_f32 v[138:139],v[138:139],v[112:113],v[112:113] op_sel:[0,1,0] op_sel_hi:[1,1,0]
v_pk_mul_f32 v[124:125],v[124:125],v[56:57]
v_pk_mul_f32 v[126:127],v[126:127],v[58:59]
v_pk_mul_f32 v[128:129],v[128:129],v[60:61]
v_pk_mul_f32 v[130:131],v[130:131],v[62:63]
v_pk_mul_f32 v[132:133],v[132:133],v[64:65]
v_pk_mul_f32 v[134:135],v[134:135],v[66:67]
v_pk_mul_f32 v[136:137],v[136:137],v[68:69]
v_pk_mul_f32 v[138:139],v[138:139],v[70:71]
v_exp_f32 v124,v124
v_exp_f32 v125,v125
v_exp_f32 v126,v126
v_exp_f32 v127,v127
v_exp_f32 v128,v128
v_exp_f32 v129,v129
v_exp_f32 v130,v130
v_exp_f32 v131,v131
v_exp_f32 v132,v132
v_exp_f32 v133,v133
v_exp_f32 v134,v134
v_exp_f32 v135,v135
v_exp_f32 v136,v136
v_exp_f32 v137,v137
v_exp_f32 v138,v138
v_exp_f32 v139,v139
v_pk_add_f32 v[124:125],v[124:125],1.0 op_sel_hi:[1,0]
v_pk_add_f32 v[126:127],v[126:127],1.0 op_sel_hi:[1,0]
v_pk_add_f32 v[128:129],v[128:129],1.0 op_sel_hi:[1,0]
v_pk_add_f32 v[130:131],v[130:131],1.0 op_sel_hi:[1,0]
v_pk_add_f32 v[132:133],v[132:133],1.0 op_sel_hi:[1,0]
v_pk_add_f32 v[134:135],v[134:135],1.0 op_sel_hi:[1,0]
v_pk_add_f32 v[136:137],v[136:137],1.0 op_sel_hi:[1,0]
v_pk_add_f32 v[138:139],v[138:139],1.0 op_sel_hi:[1,0]
v_rcp_f32 v124,v124
v_rcp_f32 v125,v125
v_rcp_f32 v126,v126
v_rcp_f32 v127,v127
v_rcp_f32 v128,v128
v_rcp_f32 v129,v129
v_rcp_f32 v130,v130
v_rcp_f32 v131,v131
v_rcp_f32 v132,v132
v_rcp_f32 v133,v133
v_rcp_f32 v134,v134
v_rcp_f32 v135,v135
v_rcp_f32 v136,v136
v_rcp_f32 v137,v137
v_rcp_f32 v138,v138
v_rcp_f32 v139,v139
v_pk_mul_f32 v[56:57],v[56:57],v[124:125]
v_pk_mul_f32 v[58:59],v[58:59],v[126:127]
v_pk_mul_f32 v[60:61],v[60:61],v[128:129]
v_pk_mul_f32 v[62:63],v[62:63],v[130:131]
v_pk_mul_f32 v[64:65],v[64:65],v[132:133]
v_pk_mul_f32 v[66:67],v[66:67],v[134:135]
v_pk_mul_f32 v[68:69],v[68:69],v[136:137]
v_pk_mul_f32 v[70:71],v[70:71],v[138:139]
v_cvt_pk_bf16_f32 v116,v56,v57
v_cvt_pk_bf16_f32 v117,v58,v59
v_cvt_pk_bf16_f32 v118,v60,v61
v_cvt_pk_bf16_f32 v119,v62,v63
v_cvt_pk_bf16_f32 v120,v64,v65
v_cvt_pk_bf16_f32 v121,v66,v67
v_cvt_pk_bf16_f32 v122,v68,v69
v_cvt_pk_bf16_f32 v123,v70,v71
s_cmp_lg_u32 s49,0
s_cbranch_scc0 ls_300
buffer_store_dwordx4 v[116:119],v20,s[8:11],s71 offen sc1
buffer_store_dwordx4 v[120:123],v21,s[8:11],s71 offen sc1
s_branch ls_301
ls_300:
buffer_store_dwordx4 v[116:119],v20,s[8:11],s71 offen
buffer_store_dwordx4 v[120:123],v21,s[8:11],s71 offen
ls_301:
s_mov_b32 s59,s82
s_cmp_eq_u32 s37,0
s_cbranch_scc1 W3_NEXT
s_waitcnt vmcnt(2)
v_cmp_eq_u32 vcc,0,v3
s_and_b64 vcc,vcc,s[76:77]
s_cselect_b32 s37,2147483648,0
s_cmp_lt_u32 s32,128
s_cselect_b32 s37,s37,2147483648
s_cmp_eq_u32 s37,0
s_cbranch_scc1 W3_COLD2
s_waitcnt vmcnt(0)
s_mov_b64 exec,1
s_cmp_lg_u32 s49,0
s_cbranch_scc0 ls_302
buffer_store_dword v5,v1,s[8:11],s59 offen sc1
s_branch ls_303
ls_302:
buffer_store_dword v5,v1,s[8:11],s59 offen
ls_303:
s_mov_b64 exec,-1
s_mov_b32 s59,2147483648
s_cmp_lt_u32 s32,128
s_cbranch_scc1 W3_COLD
s_branch W3_END
sec_299:
s_waitcnt vmcnt(7)
v_cmp_eq_u32 vcc,0,v3
s_and_b64 vcc,vcc,s[76:77]
s_cselect_b32 s37,2147483648,0
s_cmp_lt_u32 s32,128
s_cselect_b32 s37,s37,2147483648
s_cmp_lg_u32 s37,0
s_cbranch_scc1 nr_298
s_sub_u32 s66,46080,s57
s_mul_i32 s60,s33,8
s_and_b32 s61,s34,7
s_add_u32 s60,s60,s61
s_mul_i32 s60,s60,46080
s_add_u32 s60,s60,s37
s_add_u32 s60,s60,212467712
s_mov_b32 s67,s60
s_mul_i32 s61,s46,10240
s_add_u32 s60,s60,s61
s_add_u32 s61,s61,s66
s_add_u32 m0,s61,0
s_add_u32 s63,s60,0
buffer_load_dwordx4 v1,s[8:11],s63 offen sc1 lds
v_pk_fma_f32 v[56:57],v[144:145],v[180:181],v[56:57] op_sel_hi:[1,0,1] neg_lo:[0,1,0] neg_hi:[0,1,0]
v_pk_fma_f32 v[58:59],v[146:147],v[180:181],v[58:59] op_sel_hi:[1,0,1] neg_lo:[0,1,0] neg_hi:[0,1,0]
v_pk_fma_f32 v[60:61],v[148:149],v[180:181],v[60:61] op_sel_hi:[1,0,1] neg_lo:[0,1,0] neg_hi:[0,1,0]
v_pk_fma_f32 v[62:63],v[150:151],v[180:181],v[62:63] op_sel_hi:[1,0,1] neg_lo:[0,1,0] neg_hi:[0,1,0]
v_pk_fma_f32 v[64:65],v[152:153],v[180:181],v[64:65] op_sel_hi:[1,0,1] neg_lo:[0,1,0] neg_hi:[0,1,0]
v_pk_fma_f32 v[66:67],v[154:155],v[180:181],v[66:67] op_sel_hi:[1,0,1] neg_lo:[0,1,0] neg_hi:[0,1,0]
v_pk_fma_f32 v[68:69],v[156:157],v[180:181],v[68:69] op_sel_hi:[1,0,1] neg_lo:[0,1,0] neg_hi:[0,1,0]
buffer_load_dwordx4 v1,s[8:11],s63 offen offset:1024 sc1 lds
v_pk_fma_f32 v[70:71],v[158:159],v[180:181],v[70:71] op_sel_hi:[1,0,1] neg_lo:[0,1,0] neg_hi:[0,1,0]
v_pk_mul_f32 v[56:57],v[56:57],v[180:181] op_sel:[0,1] op_sel_hi:[1,1]
v_pk_mul_f32 v[58:59],v[58:59],v[180:181] op_sel:[0,1] op_sel_hi:[1,1]
v_pk_mul_f32 v[60:61],v[60:61],v[180:181] op_sel:[0,1] op_sel_hi:[1,1]
v_pk_mul_f32 v[62:63],v[62:63],v[180:181] op_sel:[0,1] op_sel_hi:[1,1]
v_pk_mul_f32 v[64:65],v[64:65],v[180:181] op_sel:[0,1] op_sel_hi:[1,1]
v_pk_mul_f32 v[66:67],v[66:67],v[180:181] op_sel:[0,1] op_sel_hi:[1,1]
buffer_load_dwordx4 v1,s[8:11],s63 offen offset:2048 sc1 lds
v_pk_mul_f32 v[68:69],v[68:69],v[180:181] op_sel:[0,1] op_sel_hi:[1,1]
v_pk_mul_f32 v[70:71],v[70:71],v[180:181] op_sel:[0,1] op_sel_hi:[1,1]
v_pk_mul_f32 v[124:125],v[56:57],v[56:57]
v_pk_mul_f32 v[126:127],v[58:59],v[58:59]
v_pk_mul_f32 v[128:129],v[60:61],v[60:61]
v_pk_mul_f32 v[130:131],v[62:63],v[62:63]
v_pk_mul_f32 v[132:133],v[64:65],v[64:65]
buffer_load_dwordx4 v1,s[8:11],s63 offen offset:3072 sc1 lds
v_pk_mul_f32 v[134:135],v[66:67],v[66:67]
v_pk_mul_f32 v[136:137],v[68:69],v[68:69]
v_pk_mul_f32 v[138:139],v[70:71],v[70:71]
v_pk_fma_f32 v[124:125],v[124:125],v[112:113],v[112:113] op_sel:[0,1,0] op_sel_hi:[1,1,0]
v_pk_fma_f32 v[126:127],v[126:127],v[112:113],v[112:113] op_sel:[0,1,0] op_sel_hi:[1,1,0]
v_pk_fma_f32 v[128:129],v[128:129],v[112:113],v[112:113] op_sel:[0,1,0] op_sel_hi:[1,1,0]
v_pk_fma_f32 v[130:131],v[130:131],v[112:113],v[112:113] op_sel:[0,1,0] op_sel_hi:[1,1,0]
s_add_u32 m0,s61,4096
s_add_u32 s63,s60,4096
buffer_load_dwordx4 v1,s[8:11],s63 offen sc1 lds
v_pk_fma_f32 v[132:133],v[132:133],v[112:113],v[112:113] op_sel:[0,1,0] op_sel_hi:[1,1,0]
v_pk_fma_f32 v[134:135],v[134:135],v[112:113],v[112:113] op_sel:[0,1,0] op_sel_hi:[1,1,0]
v_pk_fma_f32 v[136:137],v[136:137],v[112:113],v[112:113] op_sel:[0,1,0] op_sel_hi:[1,1,0]
v_pk_fma_f32 v[138:139],v[138:139],v[112:113],v[112:113] op_sel:[0,1,0] op_sel_hi:[1,1,0]
v_pk_mul_f32 v[124:125],v[124:125],v[56:57]
v_pk_mul_f32 v[126:127],v[126:127],v[58:59]
v_pk_mul_f32 v[128:129],v[128:129],v[60:61]
buffer_load_dwordx4 v1,s[8:11],s63 offen offset:1024 sc1 lds
v_pk_mul_f32 v[130:131],v[130:131],v[62:63]
v_pk_mul_f32 v[132:133],v[132:133],v[64:65]
v_pk_mul_f32 v[134:135],v[134:135],v[66:67]
v_pk_mul_f32 v[136:137],v[136:137],v[68:69]
v_pk_mul_f32 v[138:139],v[138:139],v[70:71]
v_exp_f32 v124,v124
v_exp_f32 v125,v125
buffer_load_dwordx4 v1,s[8:11],s63 offen offset:2048 sc1 lds
v_exp_f32 v126,v126
v_exp_f32 v127,v127
v_exp_f32 v128,v128
v_exp_f32 v129,v129
v_exp_f32 v130,v130
v_exp_f32 v131,v131
v_exp_f32 v132,v132
buffer_load_dwordx4 v1,s[8:11],s63 offen offset:3072 sc1 lds
v_exp_f32 v133,v133
v_exp_f32 v134,v134
v_exp_f32 v135,v135
v_exp_f32 v136,v136
v_exp_f32 v137,v137
v_exp_f32 v138,v138
v_exp_f32 v139,v139
s_add_u32 m0,s61,8192
s_add_u32 s63,s60,8192
buffer_load_dwordx4 v1,s[8:11],s63 offen sc1 lds
v_pk_add_f32 v[124:125],v[124:125],1.0 op_sel_hi:[1,0]
v_pk_add_f32 v[126:127],v[126:127],1.0 op_sel_hi:[1,0]
v_pk_add_f32 v[128:129],v[128:129],1.0 op_sel_hi:[1,0]
v_pk_add_f32 v[130:131],v[130:131],1.0 op_sel_hi:[1,0]
v_pk_add_f32 v[132:133],v[132:133],1.0 op_sel_hi:[1,0]
v_pk_add_f32 v[134:135],v[134:135],1.0 op_sel_hi:[1,0]
v_pk_add_f32 v[136:137],v[136:137],1.0 op_sel_hi:[1,0]
buffer_load_dwordx4 v1,s[8:11],s63 offen offset:1024 sc1 lds
v_pk_add_f32 v[138:139],v[138:139],1.0 op_sel_hi:[1,0]
v_rcp_f32 v124,v124
v_rcp_f32 v125,v125
v_rcp_f32 v126,v126
v_rcp_f32 v127,v127
v_rcp_f32 v128,v128
v_rcp_f32 v129,v129
s_lshl_b32 s62,s46,10
s_add_u32 s62,s62,40960
s_add_u32 m0,s66,s62
s_add_u32 s63,s67,s62
buffer_load_dwordx4 v1,s[8:11],s63 offen sc1 lds
v_rcp_f32 v130,v130
v_rcp_f32 v131,v131
v_rcp_f32 v132,v132
v_rcp_f32 v133,v133
v_rcp_f32 v134,v134
v_rcp_f32 v135,v135
v_rcp_f32 v136,v136
s_add_u32 m0,s66,45056
s_add_u32 s63,s67,45056
buffer_load_dwordx4 v1,s[8:11],s63 offen sc1 lds
v_rcp_f32 v137,v137
v_rcp_f32 v138,v138
v_rcp_f32 v139,v139
v_pk_mul_f32 v[56:57],v[56:57],v[124:125]
v_pk_mul_f32 v[58:59],v[58:59],v[126:127]
v_pk_mul_f32 v[60:61],v[60:61],v[128:129]
v_pk_mul_f32 v[62:63],v[62:63],v[130:131]
s_mov_b32 s35,s42
s_mov_b32 s53,s33
s_mov_b32 s54,s34
s_add_u32 s32,s32,1
s_mov_b32 s33,s40
s_mov_b32 s34,s41
s_mov_b64 s[76:77],s[80:81]
v_pk_mul_f32 v[64:65],v[64:65],v[132:133]
v_pk_mul_f32 v[66:67],v[66:67],v[134:135]
v_pk_mul_f32 v[68:69],v[68:69],v[136:137]
v_pk_mul_f32 v[70:71],v[70:71],v[138:139]
v_cvt_pk_bf16_f32 v116,v56,v57
v_cvt_pk_bf16_f32 v117,v58,v59
v_cvt_pk_bf16_f32 v118,v60,v61
v_cvt_pk_bf16_f32 v119,v62,v63
v_cvt_pk_bf16_f32 v120,v64,v65
v_cvt_pk_bf16_f32 v121,v66,v67
v_cvt_pk_bf16_f32 v122,v68,v69
v_cvt_pk_bf16_f32 v123,v70,v71
s_cmp_lg_u32 s49,0
s_cbranch_scc0 ls_304
buffer_store_dwordx4 v[116:119],v20,s[8:11],s71 offen sc1
buffer_store_dwordx4 v[120:123],v21,s[8:11],s71 offen sc1
s_branch ls_305
ls_304:
buffer_store_dwordx4 v[116:119],v20,s[8:11],s71 offen
buffer_store_dwordx4 v[120:123],v21,s[8:11],s71 offen
ls_305:
s_mov_b32 s59,s82
s_branch W3_NEXT
nr_298:
buffer_load_dword v3,v2,s[8:11],s35 offen sc1
s_branch ep_297
W3_END:
s_endpgm
ROLE_W4:
v_lshlrev_b32 v1,4,v0
v_mov_b32 v5,1
s_lshl_b32 s56,s48,2
s_add_u32 s56,s56,s46
v_bfe_u32 v6,v0,2,2
v_lshrrev_b32 v7,4,v0
v_add_u32 v7,v6,v7
v_and_b32 v7,3,v7
v_and_b32 v15,3,v0
v_lshlrev_b32 v15,4,v15
v_lshl_add_u32 v15,v7,6,v15
v_lshl_add_u32 v15,v6,8,v15
v_lshrrev_b32 v6,5,v0
v_bfe_u32 v7,v0,4,1
v_lshlrev_b32 v208,10,v7
v_lshl_add_u32 v208,v6,8,v208
v_and_b32 v6,15,v0
v_lshl_add_u32 v208,v6,4,v208
v_lshrrev_b32 v6,5,v0
v_add_u32 v6,2,v6
v_bfe_u32 v7,v0,4,1
v_lshlrev_b32 v209,10,v7
v_lshl_add_u32 v209,v6,8,v209
v_and_b32 v6,15,v0
v_lshl_add_u32 v209,v6,4,v209
v_min_u32 v2,11,v0
s_mul_i32 s60,s46,12
v_add_u32 v2,s60,v2
v_lshlrev_b32 v2,2,v2
s_and_b32 s60,s46,1
s_lshl_b32 s68,s48,1
s_add_u32 s68,s68,s60
s_lshr_b32 s69,s46,1
s_mul_i32 s71,s46,24576
s_mul_i32 s58,s46,491520
s_lshl_b32 s61,s48,7
s_add_u32 s58,s58,s61
s_add_u32 s71,s71,242778112
v_and_b32 v6,15,v0
v_lshlrev_b32 v204,3,v6
s_lshl_b32 s60,s69,4
v_add_u32 v6,s60,v6
v_mul_u32_u24 v205,1280,v6
v_lshrrev_b32 v6,4,v0
v_lshl_add_u32 v205,v6,3,v205
s_lshl_b32 s60,s68,6
v_add_u32 v205,s60,v205
s_mov_b32 s76,s40
s_mov_b32 s77,s41
s_mov_b32 s78,2621440
s_mov_b32 s79,0x20000
s_lshl_b32 s70,s68,1
s_add_u32 s70,s70,s69
s_lshl_b32 s70,s70,10
v_bfe_u32 v6,v0,4,1
v_lshlrev_b32 v206,14,v6
v_lshrrev_b32 v6,5,v0
v_lshl_add_u32 v206,v6,8,v206
v_and_b32 v6,15,v0
v_lshl_add_u32 v206,v6,4,v206
s_lshl_b32 s60,s46,11
v_add_u32 v206,s60,v206
s_lshl_b32 s60,s46,13
v_add_u32 v207,s60,v1
s_waitcnt vmcnt(0)
s_barrier
s_cmp_lg_u32 s46,0
s_cbranch_scc1 arr_306
v_mov_b32 v6,1
s_lshl_b32 s3,s49,2
v_mov_b32 v7,s3
s_mov_b64 exec,1
buffer_atomic_add v6,v7,s[12:15],0 offen sc1
s_mov_b64 exec,-1
arr_306:
s_lshl_b32 s3,s49,2
v_mov_b32 v7,s3
s_nop 1
ibw_307:
buffer_load_dword v6,v7,s[12:15],0 offen sc1
s_waitcnt vmcnt(0)
v_cmp_ne_u32 vcc,256,v6
s_nop 0
s_cbranch_vccz ok_308
s_sleep 8
s_sub_u32 s47,s47,1
s_cbranch_scc1 ABORT
s_branch ibw_307
ok_308:
s_cmp_lg_u32 s49,0
s_cbranch_scc1 ibok_309
v_and_b32 v7,7,v0
v_lshlrev_b32 v7,2,v7
buffer_load_dword v6,v7,s[12:15],0 offen offset:32 sc1
s_waitcnt vmcnt(0)
v_cmp_ne_u32 vcc,32,v6
s_nop 0
s_cbranch_vccz ibok_309
s_barrier
s_mov_b32 s49,1
s_mov_b32 s3,s2
s_load_dwordx16 s[16:31],s[0:1],0
s_load_dwordx8 s[32:39],s[0:1],64
s_waitcnt lgkmcnt(0)
s_branch DISPATCH
ibok_309:
s_mul_i32 s63,s46,40960
s_mov_b32 s4,s38
s_mov_b32 s5,s39
s_mov_b32 s6,1966080
s_mov_b32 s7,0x20000
v_lshrrev_b32 v9,3,v0
s_mov_b32 s64,1280
v_mul_lo_u32 v9,v9,s64
v_and_b32 v10,7,v0
v_lshl_add_u32 v6,v10,4,v9
s_add_u32 m0,s63,0
s_add_u32 s65,s58,0
buffer_load_dwordx4 v6,s[4:7],s65 offen lds
s_add_u32 m0,s63,1024
s_add_u32 s65,s58,10240
buffer_load_dwordx4 v6,s[4:7],s65 offen lds
s_add_u32 m0,s63,2048
s_add_u32 s65,s58,20480
buffer_load_dwordx4 v6,s[4:7],s65 offen lds
s_add_u32 m0,s63,3072
s_add_u32 s65,s58,30720
buffer_load_dwordx4 v6,s[4:7],s65 offen lds
s_add_u32 m0,s63,4096
s_add_u32 s65,s58,40960
buffer_load_dwordx4 v6,s[4:7],s65 offen lds
s_add_u32 m0,s63,5120
s_add_u32 s65,s58,51200
buffer_load_dwordx4 v6,s[4:7],s65 offen lds
s_add_u32 m0,s63,6144
s_add_u32 s65,s58,61440
buffer_load_dwordx4 v6,s[4:7],s65 offen lds
s_add_u32 m0,s63,7168
s_add_u32 s65,s58,71680
buffer_load_dwordx4 v6,s[4:7],s65 offen lds
s_add_u32 m0,s63,8192
s_add_u32 s65,s58,81920
buffer_load_dwordx4 v6,s[4:7],s65 offen lds
s_add_u32 m0,s63,9216
s_add_u32 s65,s58,92160
buffer_load_dwordx4 v6,s[4:7],s65 offen lds
s_add_u32 m0,s63,10240
s_add_u32 s65,s58,102400
buffer_load_dwordx4 v6,s[4:7],s65 offen lds
s_add_u32 m0,s63,11264
s_add_u32 s65,s58,112640
buffer_load_dwordx4 v6,s[4:7],s65 offen lds
s_add_u32 m0,s63,12288
s_add_u32 s65,s58,122880
buffer_load_dwordx4 v6,s[4:7],s65 offen lds
s_add_u32 m0,s63,13312
s_add_u32 s65,s58,133120
buffer_load_dwordx4 v6,s[4:7],s65 offen lds
s_add_u32 m0,s63,14336
s_add_u32 s65,s58,143360
buffer_load_dwordx4 v6,s[4:7],s65 offen lds
s_add_u32 m0,s63,15360
s_add_u32 s65,s58,153600
buffer_load_dwordx4 v6,s[4:7],s65 offen lds
s_add_u32 m0,s63,16384
s_add_u32 s65,s58,163840
buffer_load_dwordx4 v6,s[4:7],s65 offen lds
s_add_u32 m0,s63,17408
s_add_u32 s65,s58,174080
buffer_load_dwordx4 v6,s[4:7],s65 offen lds
s_add_u32 m0,s63,18432
s_add_u32 s65,s58,184320
buffer_load_dwordx4 v6,s[4:7],s65 offen lds
s_add_u32 m0,s63,19456
s_add_u32 s65,s58,194560
buffer_load_dwordx4 v6,s[4:7],s65 offen lds
s_add_u32 m0,s63,20480
s_add_u32 s65,s58,204800
buffer_load_dwordx4 v6,s[4:7],s65 offen lds
s_add_u32 m0,s63,21504
s_add_u32 s65,s58,215040
buffer_load_dwordx4 v6,s[4:7],s65 offen lds
s_add_u32 m0,s63,22528
s_add_u32 s65,s58,225280
buffer_load_dwordx4 v6,s[4:7],s65 offen lds
s_add_u32 m0,s63,23552
s_add_u32 s65,s58,235520
buffer_load_dwordx4 v6,s[4:7],s65 offen lds
s_add_u32 m0,s63,24576
s_add_u32 s65,s58,245760
buffer_load_dwordx4 v6,s[4:7],s65 offen lds
s_add_u32 m0,s63,25600
s_add_u32 s65,s58,256000
buffer_load_dwordx4 v6,s[4:7],s65 offen lds
s_add_u32 m0,s63,26624
s_add_u32 s65,s58,266240
buffer_load_dwordx4 v6,s[4:7],s65 offen lds
s_add_u32 m0,s63,27648
s_add_u32 s65,s58,276480
buffer_load_dwordx4 v6,s[4:7],s65 offen lds
s_add_u32 m0,s63,28672
s_add_u32 s65,s58,286720
buffer_load_dwordx4 v6,s[4:7],s65 offen lds
s_add_u32 m0,s63,29696
s_add_u32 s65,s58,296960
buffer_load_dwordx4 v6,s[4:7],s65 offen lds
s_add_u32 m0,s63,30720
s_add_u32 s65,s58,307200
buffer_load_dwordx4 v6,s[4:7],s65 offen lds
s_add_u32 m0,s63,31744
s_add_u32 s65,s58,317440
buffer_load_dwordx4 v6,s[4:7],s65 offen lds
s_add_u32 m0,s63,32768
s_add_u32 s65,s58,327680
buffer_load_dwordx4 v6,s[4:7],s65 offen lds
s_add_u32 m0,s63,33792
s_add_u32 s65,s58,337920
buffer_load_dwordx4 v6,s[4:7],s65 offen lds
s_add_u32 m0,s63,34816
s_add_u32 s65,s58,348160
buffer_load_dwordx4 v6,s[4:7],s65 offen lds
s_add_u32 m0,s63,35840
s_add_u32 s65,s58,358400
buffer_load_dwordx4 v6,s[4:7],s65 offen lds
s_add_u32 m0,s63,36864
s_add_u32 s65,s58,368640
buffer_load_dwordx4 v6,s[4:7],s65 offen lds
s_add_u32 m0,s63,37888
s_add_u32 s65,s58,378880
buffer_load_dwordx4 v6,s[4:7],s65 offen lds
s_add_u32 m0,s63,38912
s_add_u32 s65,s58,389120
buffer_load_dwordx4 v6,s[4:7],s65 offen lds
s_add_u32 m0,s63,39936
s_add_u32 s65,s58,399360
buffer_load_dwordx4 v6,s[4:7],s65 offen lds
s_waitcnt vmcnt(20)
v_bfe_u32 v9,v0,2,2
v_lshrrev_b32 v10,5,v0
v_lshl_add_u32 v9,v10,2,v9
v_mul_u32_u24 v9,128,v9
v_and_b32 v10,1,v0
v_lshl_add_u32 v9,v10,3,v9
v_bfe_u32 v10,v0,1,1
v_lshl_add_u32 v9,v10,5,v9
v_bfe_u32 v10,v0,4,1
v_lshl_add_u32 v9,v10,4,v9
v_add_u32 v7,s63,v9
ds_read_b64_tr_b16 a[0:1],v7 offset:0
ds_read_b64_tr_b16 a[2:3],v7 offset:2048
ds_read_b64_tr_b16 a[4:5],v7 offset:1024
ds_read_b64_tr_b16 a[6:7],v7 offset:3072
ds_read_b64_tr_b16 a[96:97],v7 offset:64
ds_read_b64_tr_b16 a[98:99],v7 offset:2112
ds_read_b64_tr_b16 a[100:101],v7 offset:1088
ds_read_b64_tr_b16 a[102:103],v7 offset:3136
ds_read_b64_tr_b16 a[8:9],v7 offset:4096
ds_read_b64_tr_b16 a[10:11],v7 offset:6144
ds_read_b64_tr_b16 a[12:13],v7 offset:5120
ds_read_b64_tr_b16 a[14:15],v7 offset:7168
s_waitcnt lgkmcnt(4)
ds_read_b64_tr_b16 a[104:105],v7 offset:4160
ds_read_b64_tr_b16 a[106:107],v7 offset:6208
ds_read_b64_tr_b16 a[108:109],v7 offset:5184
ds_read_b64_tr_b16 a[110:111],v7 offset:7232
ds_read_b64_tr_b16 a[16:17],v7 offset:8192
ds_read_b64_tr_b16 a[18:19],v7 offset:10240
ds_read_b64_tr_b16 a[20:21],v7 offset:9216
ds_read_b64_tr_b16 a[22:23],v7 offset:11264
ds_read_b64_tr_b16 a[112:113],v7 offset:8256
ds_read_b64_tr_b16 a[114:115],v7 offset:10304
ds_read_b64_tr_b16 a[116:117],v7 offset:9280
ds_read_b64_tr_b16 a[118:119],v7 offset:11328
s_waitcnt lgkmcnt(4)
ds_read_b64_tr_b16 a[24:25],v7 offset:12288
ds_read_b64_tr_b16 a[26:27],v7 offset:14336
ds_read_b64_tr_b16 a[28:29],v7 offset:13312
ds_read_b64_tr_b16 a[30:31],v7 offset:15360
ds_read_b64_tr_b16 a[120:121],v7 offset:12352
ds_read_b64_tr_b16 a[122:123],v7 offset:14400
ds_read_b64_tr_b16 a[124:125],v7 offset:13376
ds_read_b64_tr_b16 a[126:127],v7 offset:15424
ds_read_b64_tr_b16 a[32:33],v7 offset:16384
ds_read_b64_tr_b16 a[34:35],v7 offset:18432
ds_read_b64_tr_b16 a[36:37],v7 offset:17408
ds_read_b64_tr_b16 a[38:39],v7 offset:19456
s_waitcnt lgkmcnt(4)
ds_read_b64_tr_b16 a[128:129],v7 offset:16448
ds_read_b64_tr_b16 a[130:131],v7 offset:18496
ds_read_b64_tr_b16 a[132:133],v7 offset:17472
ds_read_b64_tr_b16 a[134:135],v7 offset:19520
s_waitcnt lgkmcnt(0)
s_add_u32 m0,s63,0
s_add_u32 s65,s58,409600
buffer_load_dwordx4 v6,s[4:7],s65 offen lds
s_add_u32 m0,s63,1024
s_add_u32 s65,s58,419840
buffer_load_dwordx4 v6,s[4:7],s65 offen lds
s_add_u32 m0,s63,2048
s_add_u32 s65,s58,430080
buffer_load_dwordx4 v6,s[4:7],s65 offen lds
s_add_u32 m0,s63,3072
s_add_u32 s65,s58,440320
buffer_load_dwordx4 v6,s[4:7],s65 offen lds
s_add_u32 m0,s63,4096
s_add_u32 s65,s58,450560
buffer_load_dwordx4 v6,s[4:7],s65 offen lds
s_add_u32 m0,s63,5120
s_add_u32 s65,s58,460800
buffer_load_dwordx4 v6,s[4:7],s65 offen lds
s_add_u32 m0,s63,6144
s_add_u32 s65,s58,471040
buffer_load_dwordx4 v6,s[4:7],s65 offen lds
s_add_u32 m0,s63,7168
s_add_u32 s65,s58,481280
buffer_load_dwordx4 v6,s[4:7],s65 offen lds
s_waitcnt vmcnt(8)
v_bfe_u32 v9,v0,2,2
v_lshrrev_b32 v10,5,v0
v_lshl_add_u32 v9,v10,2,v9
v_mul_u32_u24 v9,128,v9
v_and_b32 v10,1,v0
v_lshl_add_u32 v9,v10,3,v9
v_bfe_u32 v10,v0,1,1
v_lshl_add_u32 v9,v10,5,v9
v_bfe_u32 v10,v0,4,1
v_lshl_add_u32 v9,v10,4,v9
v_add_u32 v7,s63,v9
ds_read_b64_tr_b16 a[40:41],v7 offset:20480
ds_read_b64_tr_b16 a[42:43],v7 offset:22528
ds_read_b64_tr_b16 a[44:45],v7 offset:21504
ds_read_b64_tr_b16 a[46:47],v7 offset:23552
ds_read_b64_tr_b16 a[136:137],v7 offset:20544
ds_read_b64_tr_b16 a[138:139],v7 offset:22592
ds_read_b64_tr_b16 a[140:141],v7 offset:21568
ds_read_b64_tr_b16 a[142:143],v7 offset:23616
ds_read_b64_tr_b16 a[48:49],v7 offset:24576
ds_read_b64_tr_b16 a[50:51],v7 offset:26624
ds_read_b64_tr_b16 a[52:53],v7 offset:25600
ds_read_b64_tr_b16 a[54:55],v7 offset:27648
s_waitcnt lgkmcnt(4)
ds_read_b64_tr_b16 a[144:145],v7 offset:24640
ds_read_b64_tr_b16 a[146:147],v7 offset:26688
ds_read_b64_tr_b16 a[148:149],v7 offset:25664
ds_read_b64_tr_b16 a[150:151],v7 offset:27712
ds_read_b64_tr_b16 a[56:57],v7 offset:28672
ds_read_b64_tr_b16 a[58:59],v7 offset:30720
ds_read_b64_tr_b16 a[60:61],v7 offset:29696
ds_read_b64_tr_b16 a[62:63],v7 offset:31744
ds_read_b64_tr_b16 a[152:153],v7 offset:28736
ds_read_b64_tr_b16 a[154:155],v7 offset:30784
ds_read_b64_tr_b16 a[156:157],v7 offset:29760
ds_read_b64_tr_b16 a[158:159],v7 offset:31808
s_waitcnt lgkmcnt(4)
ds_read_b64_tr_b16 a[64:65],v7 offset:32768
ds_read_b64_tr_b16 a[66:67],v7 offset:34816
ds_read_b64_tr_b16 a[68:69],v7 offset:33792
ds_read_b64_tr_b16 a[70:71],v7 offset:35840
ds_read_b64_tr_b16 a[160:161],v7 offset:32832
ds_read_b64_tr_b16 a[162:163],v7 offset:34880
ds_read_b64_tr_b16 a[164:165],v7 offset:33856
ds_read_b64_tr_b16 a[166:167],v7 offset:35904
ds_read_b64_tr_b16 a[72:73],v7 offset:36864
ds_read_b64_tr_b16 a[74:75],v7 offset:38912
ds_read_b64_tr_b16 a[76:77],v7 offset:37888
ds_read_b64_tr_b16 a[78:79],v7 offset:39936
s_waitcnt lgkmcnt(4)
ds_read_b64_tr_b16 a[168:169],v7 offset:36928
ds_read_b64_tr_b16 a[170:171],v7 offset:38976
ds_read_b64_tr_b16 a[172:173],v7 offset:37952
ds_read_b64_tr_b16 a[174:175],v7 offset:40000
s_waitcnt lgkmcnt(0)
s_waitcnt vmcnt(0)
v_bfe_u32 v9,v0,2,2
v_lshrrev_b32 v10,5,v0
v_lshl_add_u32 v9,v10,2,v9
v_mul_u32_u24 v9,128,v9
v_and_b32 v10,1,v0
v_lshl_add_u32 v9,v10,3,v9
v_bfe_u32 v10,v0,1,1
v_lshl_add_u32 v9,v10,5,v9
v_bfe_u32 v10,v0,4,1
v_lshl_add_u32 v9,v10,4,v9
v_add_u32 v7,s63,v9
ds_read_b64_tr_b16 a[80:81],v7 offset:0
ds_read_b64_tr_b16 a[82:83],v7 offset:2048
ds_read_b64_tr_b16 a[84:85],v7 offset:1024
ds_read_b64_tr_b16 a[86:87],v7 offset:3072
ds_read_b64_tr_b16 a[176:177],v7 offset:64
ds_read_b64_tr_b16 a[178:179],v7 offset:2112
ds_read_b64_tr_b16 a[180:181],v7 offset:1088
ds_read_b64_tr_b16 a[182:183],v7 offset:3136
ds_read_b64_tr_b16 a[88:89],v7 offset:4096
ds_read_b64_tr_b16 a[90:91],v7 offset:6144
ds_read_b64_tr_b16 a[92:93],v7 offset:5120
ds_read_b64_tr_b16 a[94:95],v7 offset:7168
s_waitcnt lgkmcnt(4)
ds_read_b64_tr_b16 a[184:185],v7 offset:4160
ds_read_b64_tr_b16 a[186:187],v7 offset:6208
ds_read_b64_tr_b16 a[188:189],v7 offset:5184
ds_read_b64_tr_b16 a[190:191],v7 offset:7232
s_waitcnt lgkmcnt(0)
s_barrier
s_mov_b32 s83,s100
s_mov_b32 s32,0
s_mov_b32 s59,2147483648
s_min_u32 s62,s32,127
s_sub_u32 s60,s62,18
s_lshr_b32 s34,s60,1
s_and_b32 s33,s60,1
s_cmp_eq_u32 s33,0
s_cselect_b32 s61,18,0
s_add_u32 s34,s34,s61
s_sub_u32 s61,s60,46
s_cmp_ge_u32 s60,92
s_cselect_b32 s34,s61,s34
s_cselect_b32 s33,1,s33
s_cmp_lt_u32 s62,18
s_cselect_b32 s34,s62,s34
s_cselect_b32 s33,0,s33
s_lshl_b32 s35,s33,6
s_add_u32 s35,s35,s34
s_lshl_b32 s35,s35,9
s_add_u32 s35,s35,589824
s_and_b32 s60,s34,3
s_lshl2_add_u32 s60,s33,s60
s_mul_i32 s73,s60,98304
s_add_u32 s73,s73,s71
s_add_u32 s62,s32,1
s_min_u32 s62,s62,127
s_sub_u32 s60,s62,18
s_lshr_b32 s29,s60,1
s_and_b32 s28,s60,1
s_cmp_eq_u32 s28,0
s_cselect_b32 s61,18,0
s_add_u32 s29,s29,s61
s_sub_u32 s61,s60,46
s_cmp_ge_u32 s60,92
s_cselect_b32 s29,s61,s29
s_cselect_b32 s28,1,s28
s_cmp_lt_u32 s62,18
s_cselect_b32 s29,s62,s29
s_cselect_b32 s28,0,s28
s_lshl_b32 s30,s28,6
s_add_u32 s30,s30,s29
s_lshl_b32 s30,s30,9
s_add_u32 s30,s30,589824
s_and_b32 s60,s29,3
s_lshl2_add_u32 s60,s28,s60
s_mul_i32 s31,s60,98304
s_add_u32 s31,s31,s71
W4_COLD:
buffer_load_dword v3,v2,s[8:11],s35 offen sc1
s_waitcnt vmcnt(1)
s_mov_b64 exec,1
buffer_store_dword v5,v1,s[8:11],s59 offen sc1
s_mov_b64 exec,-1
s_mov_b32 s59,2147483648
s_cmp_ge_u32 s32,128
s_cbranch_scc1 W4_END
s_waitcnt vmcnt(1)
v_cmp_eq_u32 vcc,0,v3
s_nop 0
s_cbranch_vccz W4_RDY
fb_310:
buffer_load_dword v3,v2,s[8:11],s35 offen sc1
s_waitcnt vmcnt(0)
v_cmp_eq_u32 vcc,0,v3
s_nop 0
s_cbranch_vccz ok_311
s_sleep 1
s_sub_u32 s47,s47,1
s_cbranch_scc1 ABORT
s_branch fb_310
ok_311:
W4_RDY:
s_add_u32 s63,s73,0
buffer_load_dwordx4 v[16:19],v1,s[8:11],s63 offen sc1
s_nop 7
buffer_load_dwordx4 v[20:23],v1,s[8:11],s63 offen offset:1024 sc1
s_nop 7
buffer_load_dwordx4 v[24:27],v1,s[8:11],s63 offen offset:2048 sc1
s_nop 7
buffer_load_dwordx4 v[28:31],v1,s[8:11],s63 offen offset:3072 sc1
s_nop 7
s_add_u32 s63,s73,4096
buffer_load_dwordx4 v[32:35],v1,s[8:11],s63 offen sc1
s_nop 7
buffer_load_dwordx4 v[36:39],v1,s[8:11],s63 offen offset:1024 sc1
s_nop 7
buffer_load_dwordx4 v[40:43],v1,s[8:11],s63 offen offset:2048 sc1
s_nop 7
buffer_load_dwordx4 v[44:47],v1,s[8:11],s63 offen offset:3072 sc1
W4_C:
s_mov_b32 s51,s33
s_mov_b32 s52,s34
s_mov_b32 s72,s73
s_add_u32 s32,s32,1
s_mov_b32 s33,s28
s_mov_b32 s34,s29
s_mov_b32 s35,s30
s_mov_b32 s73,s31
s_waitcnt vmcnt(7)
v_mfma_f32_32x32x16_bf16 v[112:127],a[0:3],v[16:19],0
s_add_u32 s63,s72,8192
buffer_load_dwordx4 v[48:51],v1,s[8:11],s63 offen sc1
v_xor_b32 v206,0x8000,v206
v_xor_b32 v207,0x8000,v207
s_lshl_b32 s64,s51,6
v_mfma_f32_32x32x16_bf16 v[128:143],a[96:99],v[16:19],0
s_add_u32 s64,s64,s52
s_and_b32 s65,s52,7
s_lshl3_add_u32 s65,s51,s65
s_mul_i32 s65,s65,46080
s_add_u32 s65,s65,s70
s_add_u32 s65,s65,212467712
s_waitcnt vmcnt(7)
v_mfma_f32_32x32x16_bf16 v[112:127],a[4:7],v[20:23],v[112:127]
buffer_load_dwordx4 v[52:55],v1,s[8:11],s63 offen offset:1024 sc1
buffer_load_dwordx4 v[176:179],v1,s[8:11],s65 offen sc1
s_mul_i32 s65,s64,40960
s_add_u32 s65,s65,s70
v_mfma_f32_32x32x16_bf16 v[128:143],a[100:103],v[20:23],v[128:143]
s_add_u32 s65,s65,218365952
buffer_load_dwordx4 v[180:183],v15,s[8:11],s65 offen sc1
s_lshl_b32 s82,s64,9
s_lshl2_add_u32 s82,s56,s82
s_add_u32 s42,s82,32768
s_waitcnt vmcnt(9)
v_mfma_f32_32x32x16_bf16 v[112:127],a[8:11],v[24:27],v[112:127]
buffer_load_dwordx4 v[56:59],v1,s[8:11],s63 offen offset:2048 sc1
s_add_u32 s82,s82,327680
s_mul_i32 s41,s52,46080
s_add_u32 s41,s41,209518592
s_add_u32 s40,s41,s70
v_mfma_f32_32x32x16_bf16 v[128:143],a[104:107],v[24:27],v[128:143]
s_lshr_b32 s64,s70,3
s_add_u32 s41,s41,s64
s_add_u32 s41,s41,40960
s_mul_i32 s64,s52,40960
s_add_u32 s62,s32,1
s_min_u32 s62,s62,127
s_waitcnt vmcnt(9)
v_mfma_f32_32x32x16_bf16 v[112:127],a[12:15],v[28:31],v[112:127]
buffer_load_dwordx4 v[60:63],v1,s[8:11],s63 offen offset:3072 sc1
s_add_u32 s63,s72,12288
s_cmp_lg_u32 s51,0
s_cselect_b32 s40,s64,s40
s_cselect_b32 s42,2147483648,s42
v_mfma_f32_32x32x16_bf16 v[128:143],a[108:111],v[28:31],v[128:143]
s_sub_u32 s60,s62,18
s_lshr_b32 s29,s60,1
s_and_b32 s28,s60,1
s_cmp_eq_u32 s28,0
s_cselect_b32 s61,18,0
s_add_u32 s29,s29,s61
s_waitcnt vmcnt(9)
v_mfma_f32_32x32x16_bf16 v[112:127],a[16:19],v[32:35],v[112:127]
buffer_load_dwordx4 v[64:67],v1,s[8:11],s63 offen sc1
s_sub_u32 s61,s60,46
s_cmp_ge_u32 s60,92
s_cselect_b32 s29,s61,s29
s_cselect_b32 s28,1,s28
v_mfma_f32_32x32x16_bf16 v[128:143],a[112:115],v[32:35],v[128:143]
s_cmp_lt_u32 s62,18
s_cselect_b32 s29,s62,s29
s_cselect_b32 s28,0,s28
s_lshl_b32 s30,s28,6
s_add_u32 s30,s30,s29
s_lshl_b32 s30,s30,9
s_waitcnt vmcnt(9)
v_mfma_f32_32x32x16_bf16 v[112:127],a[20:23],v[36:39],v[112:127]
buffer_load_dwordx4 v[68:71],v1,s[8:11],s63 offen offset:1024 sc1
s_add_u32 s30,s30,589824
s_and_b32 s60,s29,3
s_lshl2_add_u32 s60,s28,s60
s_mul_i32 s31,s60,98304
v_mfma_f32_32x32x16_bf16 v[128:143],a[116:119],v[36:39],v[128:143]
s_add_u32 s31,s31,s71
s_waitcnt vmcnt(9)
v_mfma_f32_32x32x16_bf16 v[112:127],a[24:27],v[40:43],v[112:127]
buffer_load_dwordx4 v[72:75],v1,s[8:11],s63 offen offset:2048 sc1
v_mfma_f32_32x32x16_bf16 v[128:143],a[120:123],v[40:43],v[128:143]
s_waitcnt vmcnt(9)
v_mfma_f32_32x32x16_bf16 v[112:127],a[28:31],v[44:47],v[112:127]
buffer_load_dwordx4 v[76:79],v1,s[8:11],s63 offen offset:3072 sc1
s_add_u32 s63,s72,16384
v_mfma_f32_32x32x16_bf16 v[128:143],a[124:127],v[44:47],v[128:143]
s_waitcnt vmcnt(9)
v_mfma_f32_32x32x16_bf16 v[112:127],a[32:35],v[48:51],v[112:127]
buffer_load_dwordx4 v[80:83],v1,s[8:11],s63 offen sc1
s_mov_b64 exec,1
buffer_store_dword v5,v1,s[8:11],s59 offen sc1
s_mov_b64 exec,-1
s_mov_b32 s59,2147483648
v_mfma_f32_32x32x16_bf16 v[128:143],a[128:131],v[48:51],v[128:143]
buffer_load_dword v3,v2,s[8:11],s35 offen sc1
s_waitcnt vmcnt(11)
v_mfma_f32_32x32x16_bf16 v[112:127],a[36:39],v[52:55],v[112:127]
buffer_load_dwordx4 v[84:87],v1,s[8:11],s63 offen offset:1024 sc1
v_mfma_f32_32x32x16_bf16 v[128:143],a[132:135],v[52:55],v[128:143]
s_waitcnt vmcnt(9)
v_mfma_f32_32x32x16_bf16 v[112:127],a[40:43],v[56:59],v[112:127]
buffer_load_dwordx4 v[88:91],v1,s[8:11],s63 offen offset:2048 sc1
v_mfma_f32_32x32x16_bf16 v[128:143],a[136:139],v[56:59],v[128:143]
s_waitcnt vmcnt(9)
v_mfma_f32_32x32x16_bf16 v[112:127],a[44:47],v[60:63],v[112:127]
buffer_load_dwordx4 v[92:95],v1,s[8:11],s63 offen offset:3072 sc1
s_add_u32 s63,s72,20480
v_mfma_f32_32x32x16_bf16 v[128:143],a[140:143],v[60:63],v[128:143]
s_waitcnt vmcnt(9)
v_mfma_f32_32x32x16_bf16 v[112:127],a[48:51],v[64:67],v[112:127]
buffer_load_dwordx4 v[96:99],v1,s[8:11],s63 offen sc1
v_mfma_f32_32x32x16_bf16 v[128:143],a[144:147],v[64:67],v[128:143]
s_waitcnt vmcnt(9)
v_mfma_f32_32x32x16_bf16 v[112:127],a[52:55],v[68:71],v[112:127]
buffer_load_dwordx4 v[100:103],v1,s[8:11],s63 offen offset:1024 sc1
v_mfma_f32_32x32x16_bf16 v[128:143],a[148:151],v[68:71],v[128:143]
s_waitcnt vmcnt(9)
v_mfma_f32_32x32x16_bf16 v[112:127],a[56:59],v[72:75],v[112:127]
buffer_load_dwordx4 v[104:107],v1,s[8:11],s63 offen offset:2048 sc1
v_mfma_f32_32x32x16_bf16 v[128:143],a[152:155],v[72:75],v[128:143]
s_waitcnt vmcnt(6)
v_cmp_eq_u32 vcc,0,v3
s_cmp_eq_u64 vcc,0
s_cselect_b32 s37,0,2147483648
s_cmp_lt_u32 s32,128
s_cselect_b32 s37,s37,2147483648
v_mfma_f32_32x32x16_bf16 v[112:127],a[60:63],v[76:79],v[112:127]
buffer_load_dwordx4 v[108:111],v1,s[8:11],s63 offen offset:3072 sc1
s_cmp_eq_u32 s37,0
v_mfma_f32_32x32x16_bf16 v[128:143],a[156:159],v[76:79],v[128:143]
s_cbranch_scc0 no_312
v_mfma_f32_32x32x16_bf16 v[112:127],a[64:67],v[80:83],v[112:127]
s_add_u32 s63,s73,0
buffer_load_dwordx4 v[16:19],v1,s[8:11],s63 offen sc1
v_mfma_f32_32x32x16_bf16 v[128:143],a[160:163],v[80:83],v[128:143]
s_waitcnt vmcnt(7)
v_mfma_f32_32x32x16_bf16 v[112:127],a[68:71],v[84:87],v[112:127]
buffer_load_dwordx4 v[20:23],v1,s[8:11],s63 offen offset:1024 sc1
v_mfma_f32_32x32x16_bf16 v[128:143],a[164:167],v[84:87],v[128:143]
s_waitcnt vmcnt(7)
v_mfma_f32_32x32x16_bf16 v[112:127],a[72:75],v[88:91],v[112:127]
buffer_load_dwordx4 v[24:27],v1,s[8:11],s63 offen offset:2048 sc1
v_mfma_f32_32x32x16_bf16 v[128:143],a[168:171],v[88:91],v[128:143]
v_lshlrev_b32 v184,16,v176
v_and_b32 v185,0xffff0000,v176
v_lshlrev_b32 v186,16,v177
v_and_b32 v187,0xffff0000,v177
v_lshlrev_b32 v188,16,v178
s_waitcnt vmcnt(7)
v_mfma_f32_32x32x16_bf16 v[112:127],a[76:79],v[92:95],v[112:127]
buffer_load_dwordx4 v[28:31],v1,s[8:11],s63 offen offset:3072 sc1
s_add_u32 s63,s73,4096
v_and_b32 v189,0xffff0000,v178
v_lshlrev_b32 v190,16,v179
v_and_b32 v191,0xffff0000,v179
v_mfma_f32_32x32x16_bf16 v[128:143],a[172:175],v[92:95],v[128:143]
v_lshlrev_b32 v192,16,v180
v_and_b32 v193,0xffff0000,v180
v_lshlrev_b32 v194,16,v181
v_and_b32 v195,0xffff0000,v181
v_lshlrev_b32 v196,16,v182
s_waitcnt vmcnt(7)
v_mfma_f32_32x32x16_bf16 v[112:127],a[80:83],v[96:99],v[112:127]
buffer_load_dwordx4 v[32:35],v1,s[8:11],s63 offen sc1
v_and_b32 v197,0xffff0000,v182
v_lshlrev_b32 v198,16,v183
v_and_b32 v199,0xffff0000,v183
s_waitcnt vmcnt(7)
v_mfma_f32_32x32x16_bf16 v[112:127],a[84:87],v[100:103],v[112:127]
s_waitcnt vmcnt(6)
v_mfma_f32_32x32x16_bf16 v[112:127],a[88:91],v[104:107],v[112:127]
buffer_load_dwordx4 v[36:39],v1,s[8:11],s63 offen offset:1024 sc1
s_waitcnt vmcnt(6)
v_mfma_f32_32x32x16_bf16 v[112:127],a[92:95],v[108:111],v[112:127]
v_mfma_f32_32x32x16_bf16 v[128:143],a[176:179],v[96:99],v[128:143]
buffer_load_dwordx4 v[40:43],v1,s[8:11],s63 offen offset:2048 sc1
s_mov_b64 exec,1
s_cmp_lg_u32 s49,0
s_cbranch_scc0 ls_313
buffer_store_dword v5,v1,s[8:11],s82 offen sc1
s_branch ls_314
ls_313:
buffer_store_dword v5,v1,s[8:11],s82 offen
ls_314:
s_mov_b64 exec,-1
v_mfma_f32_32x32x16_bf16 v[128:143],a[180:183],v[100:103],v[128:143]
ds_write_b128 v206,v[112:115] offset:0
ds_write_b128 v206,v[116:119] offset:1024
ds_write_b128 v206,v[120:123] offset:512
v_mfma_f32_32x32x16_bf16 v[128:143],a[184:187],v[104:107],v[128:143]
buffer_load_dwordx4 v[44:47],v1,s[8:11],s63 offen offset:3072 sc1
ds_write_b128 v206,v[124:127] offset:1536
v_mfma_f32_32x32x16_bf16 v[128:143],a[188:191],v[108:111],v[128:143]
buffer_load_dword v3,v2,s[8:11],s30 offen sc1
s_nop 5
s_branch W4_E1
no_312:
v_mfma_f32_32x32x16_bf16 v[112:127],a[64:67],v[80:83],v[112:127]
v_mfma_f32_32x32x16_bf16 v[128:143],a[160:163],v[80:83],v[128:143]
s_waitcnt vmcnt(6)
v_mfma_f32_32x32x16_bf16 v[112:127],a[68:71],v[84:87],v[112:127]
v_mfma_f32_32x32x16_bf16 v[128:143],a[164:167],v[84:87],v[128:143]
s_waitcnt vmcnt(5)
v_mfma_f32_32x32x16_bf16 v[112:127],a[72:75],v[88:91],v[112:127]
v_mfma_f32_32x32x16_bf16 v[128:143],a[168:171],v[88:91],v[128:143]
v_lshlrev_b32 v184,16,v176
v_and_b32 v185,0xffff0000,v176
v_lshlrev_b32 v186,16,v177
v_and_b32 v187,0xffff0000,v177
v_lshlrev_b32 v188,16,v178
s_waitcnt vmcnt(4)
v_mfma_f32_32x32x16_bf16 v[112:127],a[76:79],v[92:95],v[112:127]
buffer_load_dword v3,v2,s[8:11],s35 offen sc1
v_and_b32 v189,0xffff0000,v178
v_lshlrev_b32 v190,16,v179
v_and_b32 v191,0xffff0000,v179
v_lshlrev_b32 v192,16,v180
v_mfma_f32_32x32x16_bf16 v[128:143],a[172:175],v[92:95],v[128:143]
v_and_b32 v193,0xffff0000,v180
v_lshlrev_b32 v194,16,v181
v_and_b32 v195,0xffff0000,v181
v_lshlrev_b32 v196,16,v182
v_and_b32 v197,0xffff0000,v182
s_waitcnt vmcnt(4)
v_mfma_f32_32x32x16_bf16 v[112:127],a[80:83],v[96:99],v[112:127]
v_lshlrev_b32 v198,16,v183
v_and_b32 v199,0xffff0000,v183
s_waitcnt vmcnt(3)
v_mfma_f32_32x32x16_bf16 v[112:127],a[84:87],v[100:103],v[112:127]
s_waitcnt vmcnt(2)
v_mfma_f32_32x32x16_bf16 v[112:127],a[88:91],v[104:107],v[112:127]
s_waitcnt vmcnt(1)
v_mfma_f32_32x32x16_bf16 v[112:127],a[92:95],v[108:111],v[112:127]
v_mfma_f32_32x32x16_bf16 v[128:143],a[176:179],v[96:99],v[128:143]
s_mov_b64 exec,1
s_cmp_lg_u32 s49,0
s_cbranch_scc0 ls_315
buffer_store_dword v5,v1,s[8:11],s82 offen sc1
s_branch ls_316
ls_315:
buffer_store_dword v5,v1,s[8:11],s82 offen
ls_316:
s_mov_b64 exec,-1
v_mfma_f32_32x32x16_bf16 v[128:143],a[180:183],v[100:103],v[128:143]
ds_write_b128 v206,v[112:115] offset:0
ds_write_b128 v206,v[116:119] offset:1024
ds_write_b128 v206,v[120:123] offset:512
v_mfma_f32_32x32x16_bf16 v[128:143],a[184:187],v[104:107],v[128:143]
ds_write_b128 v206,v[124:127] offset:1536
v_mfma_f32_32x32x16_bf16 v[128:143],a[188:191],v[108:111],v[128:143]
s_waitcnt vmcnt(1)
v_cmp_eq_u32 vcc,0,v3
s_cmp_eq_u64 vcc,0
s_cselect_b32 s37,0,2147483648
s_cmp_lt_u32 s32,128
s_cselect_b32 s37,s37,2147483648
s_cmp_eq_u32 s37,0
s_cbranch_scc1 W4_E2
s_branch W4_E0
W4_E2:
s_add_u32 s63,s73,0
buffer_load_dwordx4 v[16:19],v1,s[8:11],s63 offen sc1
s_nop 2
ds_write_b128 v206,v[128:131] offset:8192
ds_write_b128 v206,v[132:135] offset:9216
buffer_load_dwordx4 v[20:23],v1,s[8:11],s63 offen offset:1024 sc1
ds_write_b128 v206,v[136:139] offset:8704
ds_write_b128 v206,v[140:143] offset:9728
buffer_load_dwordx4 v[24:27],v1,s[8:11],s63 offen offset:2048 sc1
s_waitcnt lgkmcnt(0)
s_barrier
ds_read_b128 v[144:147],v207 offset:0
ds_read_b128 v[148:151],v207 offset:1024
ds_read_b128 v[152:155],v207 offset:2048
ds_read_b128 v[156:159],v207 offset:3072
ds_read_b128 v[160:163],v207 offset:4096
ds_read_b128 v[164:167],v207 offset:5120
ds_read_b128 v[168:171],v207 offset:6144
ds_read_b128 v[172:175],v207 offset:7168
buffer_load_dwordx4 v[28:31],v1,s[8:11],s63 offen offset:3072 sc1
s_add_u32 s63,s73,4096
buffer_load_dwordx4 v[32:35],v1,s[8:11],s63 offen sc1
buffer_load_dwordx4 v[36:39],v1,s[8:11],s63 offen offset:1024 sc1
s_waitcnt lgkmcnt(4)
v_pk_add_f32 v[144:145],v[144:145],v[152:153]
v_pk_add_f32 v[146:147],v[146:147],v[154:155]
v_pk_add_f32 v[148:149],v[148:149],v[156:157]
v_pk_add_f32 v[150:151],v[150:151],v[158:159]
s_waitcnt lgkmcnt(0)
v_pk_add_f32 v[160:161],v[160:161],v[168:169]
v_pk_add_f32 v[162:163],v[162:163],v[170:171]
v_pk_add_f32 v[164:165],v[164:165],v[172:173]
v_pk_add_f32 v[166:167],v[166:167],v[174:175]
buffer_load_dwordx4 v[40:43],v1,s[8:11],s63 offen offset:2048 sc1
v_pk_add_f32 v[144:145],v[144:145],v[160:161]
v_pk_add_f32 v[146:147],v[146:147],v[162:163]
v_pk_add_f32 v[148:149],v[148:149],v[164:165]
v_pk_add_f32 v[150:151],v[150:151],v[166:167]
v_cvt_pk_bf16_f32 v6,v144,v145
v_lshlrev_b32 v144,16,v6
v_and_b32 v145,0xffff0000,v6
v_cvt_pk_bf16_f32 v6,v146,v147
v_lshlrev_b32 v146,16,v6
v_and_b32 v147,0xffff0000,v6
v_cvt_pk_bf16_f32 v6,v148,v149
v_lshlrev_b32 v148,16,v6
v_and_b32 v149,0xffff0000,v6
v_cvt_pk_bf16_f32 v6,v150,v151
v_lshlrev_b32 v150,16,v6
v_and_b32 v151,0xffff0000,v6
buffer_load_dwordx4 v[44:47],v1,s[8:11],s63 offen offset:3072 sc1
v_pk_add_f32 v[144:145],v[144:145],v[184:185]
v_pk_add_f32 v[146:147],v[146:147],v[186:187]
v_pk_add_f32 v[148:149],v[148:149],v[188:189]
v_pk_add_f32 v[150:151],v[150:151],v[190:191]
v_cvt_pk_bf16_f32 v6,v144,v145
v_lshlrev_b32 v144,16,v6
v_and_b32 v145,0xffff0000,v6
v_cvt_pk_bf16_f32 v6,v146,v147
v_lshlrev_b32 v146,16,v6
v_and_b32 v147,0xffff0000,v6
v_cvt_pk_bf16_f32 v6,v148,v149
v_lshlrev_b32 v148,16,v6
v_and_b32 v149,0xffff0000,v6
v_cvt_pk_bf16_f32 v6,v150,v151
v_lshlrev_b32 v150,16,v6
v_and_b32 v151,0xffff0000,v6
v_pk_add_f32 v[144:145],v[144:145],v[192:193]
v_pk_add_f32 v[146:147],v[146:147],v[194:195]
v_pk_add_f32 v[148:149],v[148:149],v[196:197]
v_pk_add_f32 v[150:151],v[150:151],v[198:199]
v_cvt_pk_bf16_f32 v200,v144,v145
v_cvt_pk_bf16_f32 v201,v146,v147
v_cvt_pk_bf16_f32 v202,v148,v149
v_cvt_pk_bf16_f32 v203,v150,v151
s_cmp_lg_u32 s51,0
s_cbranch_scc1 w4o_317
buffer_store_dwordx4 v[200:203],v15,s[8:11],s40 offen sc1
v_lshlrev_b32 v144,16,v200
v_and_b32 v145,0xffff0000,v200
v_lshlrev_b32 v146,16,v201
v_and_b32 v147,0xffff0000,v201
v_lshlrev_b32 v148,16,v202
v_and_b32 v149,0xffff0000,v202
v_lshlrev_b32 v150,16,v203
v_and_b32 v151,0xffff0000,v203
v_pk_add_f32 v[6:7],v[144:145],v[146:147]
v_pk_mul_f32 v[8:9],v[144:145],v[144:145]
v_pk_fma_f32 v[8:9],v[146:147],v[146:147],v[8:9]
v_pk_add_f32 v[6:7],v[6:7],v[148:149]
v_pk_fma_f32 v[8:9],v[148:149],v[148:149],v[8:9]
v_pk_add_f32 v[6:7],v[6:7],v[150:151]
v_pk_fma_f32 v[8:9],v[150:151],v[150:151],v[8:9]
v_add_f32 v6,v6,v7
v_add_f32 v7,v8,v9
s_nop 1
v_permlane32_swap_b32 v6,v7
v_add_f32 v6,v6,v7
v_mov_b32 v7,v6
s_nop 1
v_permlane16_swap_b32 v6,v7
v_add_f32 v6,v6,v7
v_mov_b32 v7,v6
s_nop 1
v_permlane32_swap_b32 v6,v7
s_mov_b64 exec,0xffff
buffer_store_dwordx2 v[6:7],v204,s[8:11],s41 offen sc1
s_mov_b64 exec,-1
s_branch w4n_318
w4o_317:
buffer_store_dwordx2 v[200:201],v205,s[76:79],s40 offen
buffer_store_dwordx2 v[202:203],v205,s[76:79],s40 offen offset:32
w4n_318:
s_mov_b32 s59,s42
s_branch W4_C
W4_E1:
s_add_u32 s63,s73,8192
buffer_load_dwordx4 v[48:51],v1,s[8:11],s63 offen sc1
s_nop 2
ds_write_b128 v206,v[128:131] offset:8192
ds_write_b128 v206,v[132:135] offset:9216
buffer_load_dwordx4 v[52:55],v1,s[8:11],s63 offen offset:1024 sc1
ds_write_b128 v206,v[136:139] offset:8704
ds_write_b128 v206,v[140:143] offset:9728
buffer_load_dwordx4 v[56:59],v1,s[8:11],s63 offen offset:2048 sc1
s_waitcnt lgkmcnt(0)
s_barrier
ds_read_b128 v[144:147],v207 offset:0
ds_read_b128 v[148:151],v207 offset:1024
ds_read_b128 v[152:155],v207 offset:2048
ds_read_b128 v[156:159],v207 offset:3072
ds_read_b128 v[160:163],v207 offset:4096
ds_read_b128 v[164:167],v207 offset:5120
ds_read_b128 v[168:171],v207 offset:6144
ds_read_b128 v[172:175],v207 offset:7168
buffer_load_dwordx4 v[60:63],v1,s[8:11],s63 offen offset:3072 sc1
s_add_u32 s63,s73,12288
buffer_load_dwordx4 v[64:67],v1,s[8:11],s63 offen sc1
buffer_load_dwordx4 v[68:71],v1,s[8:11],s63 offen offset:1024 sc1
s_waitcnt lgkmcnt(4)
v_pk_add_f32 v[144:145],v[144:145],v[152:153]
v_pk_add_f32 v[146:147],v[146:147],v[154:155]
v_pk_add_f32 v[148:149],v[148:149],v[156:157]
v_pk_add_f32 v[150:151],v[150:151],v[158:159]
s_waitcnt lgkmcnt(0)
v_pk_add_f32 v[160:161],v[160:161],v[168:169]
v_pk_add_f32 v[162:163],v[162:163],v[170:171]
v_pk_add_f32 v[164:165],v[164:165],v[172:173]
v_pk_add_f32 v[166:167],v[166:167],v[174:175]
v_pk_add_f32 v[144:145],v[144:145],v[160:161]
v_pk_add_f32 v[146:147],v[146:147],v[162:163]
v_pk_add_f32 v[148:149],v[148:149],v[164:165]
v_pk_add_f32 v[150:151],v[150:151],v[166:167]
v_cvt_pk_bf16_f32 v6,v144,v145
v_lshlrev_b32 v144,16,v6
v_and_b32 v145,0xffff0000,v6
v_cvt_pk_bf16_f32 v6,v146,v147
v_lshlrev_b32 v146,16,v6
v_and_b32 v147,0xffff0000,v6
v_cvt_pk_bf16_f32 v6,v148,v149
v_lshlrev_b32 v148,16,v6
v_and_b32 v149,0xffff0000,v6
v_cvt_pk_bf16_f32 v6,v150,v151
v_lshlrev_b32 v150,16,v6
v_and_b32 v151,0xffff0000,v6
v_pk_add_f32 v[144:145],v[144:145],v[184:185]
v_pk_add_f32 v[146:147],v[146:147],v[186:187]
v_pk_add_f32 v[148:149],v[148:149],v[188:189]
v_pk_add_f32 v[150:151],v[150:151],v[190:191]
v_cvt_pk_bf16_f32 v6,v144,v145
v_lshlrev_b32 v144,16,v6
v_and_b32 v145,0xffff0000,v6
v_cvt_pk_bf16_f32 v6,v146,v147
v_lshlrev_b32 v146,16,v6
v_and_b32 v147,0xffff0000,v6
v_cvt_pk_bf16_f32 v6,v148,v149
v_lshlrev_b32 v148,16,v6
v_and_b32 v149,0xffff0000,v6
v_cvt_pk_bf16_f32 v6,v150,v151
v_lshlrev_b32 v150,16,v6
v_and_b32 v151,0xffff0000,v6
v_pk_add_f32 v[144:145],v[144:145],v[192:193]
v_pk_add_f32 v[146:147],v[146:147],v[194:195]
v_pk_add_f32 v[148:149],v[148:149],v[196:197]
v_pk_add_f32 v[150:151],v[150:151],v[198:199]
v_cvt_pk_bf16_f32 v200,v144,v145
v_cvt_pk_bf16_f32 v201,v146,v147
v_cvt_pk_bf16_f32 v202,v148,v149
v_cvt_pk_bf16_f32 v203,v150,v151
s_cmp_lg_u32 s51,0
s_cbranch_scc1 w4o_319
buffer_store_dwordx4 v[200:203],v15,s[8:11],s40 offen sc1
v_lshlrev_b32 v144,16,v200
v_and_b32 v145,0xffff0000,v200
v_lshlrev_b32 v146,16,v201
v_and_b32 v147,0xffff0000,v201
v_lshlrev_b32 v148,16,v202
v_and_b32 v149,0xffff0000,v202
v_lshlrev_b32 v150,16,v203
v_and_b32 v151,0xffff0000,v203
v_pk_add_f32 v[6:7],v[144:145],v[146:147]
v_pk_mul_f32 v[8:9],v[144:145],v[144:145]
v_pk_fma_f32 v[8:9],v[146:147],v[146:147],v[8:9]
v_pk_add_f32 v[6:7],v[6:7],v[148:149]
v_pk_fma_f32 v[8:9],v[148:149],v[148:149],v[8:9]
v_pk_add_f32 v[6:7],v[6:7],v[150:151]
v_pk_fma_f32 v[8:9],v[150:151],v[150:151],v[8:9]
v_add_f32 v6,v6,v7
v_add_f32 v7,v8,v9
s_nop 1
v_permlane32_swap_b32 v6,v7
v_add_f32 v6,v6,v7
v_mov_b32 v7,v6
s_nop 1
v_permlane16_swap_b32 v6,v7
v_add_f32 v6,v6,v7
v_mov_b32 v7,v6
s_nop 1
v_permlane32_swap_b32 v6,v7
s_mov_b64 exec,0xffff
buffer_store_dwordx2 v[6:7],v204,s[8:11],s41 offen sc1
s_mov_b64 exec,-1
s_branch w4n_320
w4o_319:
buffer_store_dwordx2 v[200:201],v205,s[76:79],s40 offen
buffer_store_dwordx2 v[202:203],v205,s[76:79],s40 offen offset:32
w4n_320:
s_mov_b32 s59,s42
s_waitcnt vmcnt(8)
s_branch W4_W
W4_E0:
s_nop 4
ds_write_b128 v206,v[128:131] offset:8192
ds_write_b128 v206,v[132:135] offset:9216
ds_write_b128 v206,v[136:139] offset:8704
ds_write_b128 v206,v[140:143] offset:9728
s_waitcnt lgkmcnt(0)
s_barrier
ds_read_b128 v[144:147],v207 offset:0
ds_read_b128 v[148:151],v207 offset:1024
ds_read_b128 v[152:155],v207 offset:2048
ds_read_b128 v[156:159],v207 offset:3072
ds_read_b128 v[160:163],v207 offset:4096
ds_read_b128 v[164:167],v207 offset:5120
ds_read_b128 v[168:171],v207 offset:6144
ds_read_b128 v[172:175],v207 offset:7168
s_waitcnt lgkmcnt(4)
v_pk_add_f32 v[144:145],v[144:145],v[152:153]
v_pk_add_f32 v[146:147],v[146:147],v[154:155]
v_pk_add_f32 v[148:149],v[148:149],v[156:157]
v_pk_add_f32 v[150:151],v[150:151],v[158:159]
s_waitcnt lgkmcnt(0)
v_pk_add_f32 v[160:161],v[160:161],v[168:169]
v_pk_add_f32 v[162:163],v[162:163],v[170:171]
v_pk_add_f32 v[164:165],v[164:165],v[172:173]
v_pk_add_f32 v[166:167],v[166:167],v[174:175]
v_pk_add_f32 v[144:145],v[144:145],v[160:161]
v_pk_add_f32 v[146:147],v[146:147],v[162:163]
v_pk_add_f32 v[148:149],v[148:149],v[164:165]
v_pk_add_f32 v[150:151],v[150:151],v[166:167]
v_cvt_pk_bf16_f32 v6,v144,v145
v_lshlrev_b32 v144,16,v6
v_and_b32 v145,0xffff0000,v6
v_cvt_pk_bf16_f32 v6,v146,v147
v_lshlrev_b32 v146,16,v6
v_and_b32 v147,0xffff0000,v6
v_cvt_pk_bf16_f32 v6,v148,v149
v_lshlrev_b32 v148,16,v6
v_and_b32 v149,0xffff0000,v6
v_cvt_pk_bf16_f32 v6,v150,v151
v_lshlrev_b32 v150,16,v6
v_and_b32 v151,0xffff0000,v6
v_pk_add_f32 v[144:145],v[144:145],v[184:185]
v_pk_add_f32 v[146:147],v[146:147],v[186:187]
v_pk_add_f32 v[148:149],v[148:149],v[188:189]
v_pk_add_f32 v[150:151],v[150:151],v[190:191]
v_cvt_pk_bf16_f32 v6,v144,v145
v_lshlrev_b32 v144,16,v6
v_and_b32 v145,0xffff0000,v6
v_cvt_pk_bf16_f32 v6,v146,v147
v_lshlrev_b32 v146,16,v6
v_and_b32 v147,0xffff0000,v6
v_cvt_pk_bf16_f32 v6,v148,v149
v_lshlrev_b32 v148,16,v6
v_and_b32 v149,0xffff0000,v6
v_cvt_pk_bf16_f32 v6,v150,v151
v_lshlrev_b32 v150,16,v6
v_and_b32 v151,0xffff0000,v6
v_pk_add_f32 v[144:145],v[144:145],v[192:193]
v_pk_add_f32 v[146:147],v[146:147],v[194:195]
v_pk_add_f32 v[148:149],v[148:149],v[196:197]
v_pk_add_f32 v[150:151],v[150:151],v[198:199]
v_cvt_pk_bf16_f32 v200,v144,v145
v_cvt_pk_bf16_f32 v201,v146,v147
v_cvt_pk_bf16_f32 v202,v148,v149
v_cvt_pk_bf16_f32 v203,v150,v151
s_cmp_lg_u32 s51,0
s_cbranch_scc1 w4o_321
buffer_store_dwordx4 v[200:203],v15,s[8:11],s40 offen sc1
v_lshlrev_b32 v144,16,v200
v_and_b32 v145,0xffff0000,v200
v_lshlrev_b32 v146,16,v201
v_and_b32 v147,0xffff0000,v201
v_lshlrev_b32 v148,16,v202
v_and_b32 v149,0xffff0000,v202
v_lshlrev_b32 v150,16,v203
v_and_b32 v151,0xffff0000,v203
v_pk_add_f32 v[6:7],v[144:145],v[146:147]
v_pk_mul_f32 v[8:9],v[144:145],v[144:145]
v_pk_fma_f32 v[8:9],v[146:147],v[146:147],v[8:9]
v_pk_add_f32 v[6:7],v[6:7],v[148:149]
v_pk_fma_f32 v[8:9],v[148:149],v[148:149],v[8:9]
v_pk_add_f32 v[6:7],v[6:7],v[150:151]
v_pk_fma_f32 v[8:9],v[150:151],v[150:151],v[8:9]
v_add_f32 v6,v6,v7
v_add_f32 v7,v8,v9
s_nop 1
v_permlane32_swap_b32 v6,v7
v_add_f32 v6,v6,v7
v_mov_b32 v7,v6
s_nop 1
v_permlane16_swap_b32 v6,v7
v_add_f32 v6,v6,v7
v_mov_b32 v7,v6
s_nop 1
v_permlane32_swap_b32 v6,v7
s_mov_b64 exec,0xffff
buffer_store_dwordx2 v[6:7],v204,s[8:11],s41 offen sc1
s_mov_b64 exec,-1
s_branch w4n_322
w4o_321:
buffer_store_dwordx2 v[200:201],v205,s[76:79],s40 offen
buffer_store_dwordx2 v[202:203],v205,s[76:79],s40 offen offset:32
w4n_322:
s_mov_b32 s59,s42
s_cmp_lg_u32 s37,0
s_cbranch_scc1 W4_COLD
s_waitcnt vmcnt(2)
W4_W:
s_mov_b32 s51,s33
s_mov_b32 s52,s34
s_mov_b32 s72,s73
s_add_u32 s32,s32,1
s_mov_b32 s33,s28
s_mov_b32 s34,s29
s_mov_b32 s35,s30
s_mov_b32 s73,s31
v_cmp_eq_u32 vcc,0,v3
s_cmp_eq_u64 vcc,0
s_cselect_b32 s37,0,2147483648
s_cmp_lt_u32 s32,128
s_cselect_b32 s37,s37,2147483648
s_cmp_lg_u32 s37,0
s_cbranch_scc1 W4_W0
s_waitcnt vmcnt(15)
v_mfma_f32_32x32x16_bf16 v[112:127],a[0:3],v[16:19],0
s_add_u32 s63,s72,12288
buffer_load_dwordx4 v[72:75],v1,s[8:11],s63 offen offset:2048 sc1
v_xor_b32 v206,0x8000,v206
v_xor_b32 v207,0x8000,v207
s_lshl_b32 s64,s51,6
v_mfma_f32_32x32x16_bf16 v[128:143],a[96:99],v[16:19],0
s_add_u32 s64,s64,s52
s_and_b32 s65,s52,7
s_lshl3_add_u32 s65,s51,s65
s_mul_i32 s65,s65,46080
s_add_u32 s65,s65,s70
s_add_u32 s65,s65,212467712
s_waitcnt vmcnt(15)
v_mfma_f32_32x32x16_bf16 v[112:127],a[4:7],v[20:23],v[112:127]
buffer_load_dwordx4 v[76:79],v1,s[8:11],s63 offen offset:3072 sc1
s_add_u32 s63,s72,16384
buffer_load_dwordx4 v[176:179],v1,s[8:11],s65 offen sc1
s_mul_i32 s65,s64,40960
v_mfma_f32_32x32x16_bf16 v[128:143],a[100:103],v[20:23],v[128:143]
s_add_u32 s65,s65,s70
s_add_u32 s65,s65,218365952
buffer_load_dwordx4 v[180:183],v15,s[8:11],s65 offen sc1
s_lshl_b32 s82,s64,9
s_lshl2_add_u32 s82,s56,s82
s_waitcnt vmcnt(17)
v_mfma_f32_32x32x16_bf16 v[112:127],a[8:11],v[24:27],v[112:127]
buffer_load_dwordx4 v[80:83],v1,s[8:11],s63 offen sc1
s_add_u32 s42,s82,32768
s_add_u32 s82,s82,327680
s_mul_i32 s41,s52,46080
s_add_u32 s41,s41,209518592
v_mfma_f32_32x32x16_bf16 v[128:143],a[104:107],v[24:27],v[128:143]
s_add_u32 s40,s41,s70
s_lshr_b32 s64,s70,3
s_add_u32 s41,s41,s64
s_add_u32 s41,s41,40960
s_mul_i32 s64,s52,40960
s_add_u32 s62,s32,1
s_waitcnt vmcnt(17)
v_mfma_f32_32x32x16_bf16 v[112:127],a[12:15],v[28:31],v[112:127]
buffer_load_dwordx4 v[84:87],v1,s[8:11],s63 offen offset:1024 sc1
s_cmp_lg_u32 s51,0
s_cselect_b32 s40,s64,s40
s_cselect_b32 s42,2147483648,s42
s_min_u32 s62,s62,127
v_mfma_f32_32x32x16_bf16 v[128:143],a[108:111],v[28:31],v[128:143]
s_sub_u32 s60,s62,18
s_lshr_b32 s29,s60,1
s_and_b32 s28,s60,1
s_cmp_eq_u32 s28,0
s_cselect_b32 s61,18,0
s_add_u32 s29,s29,s61
s_waitcnt vmcnt(17)
v_mfma_f32_32x32x16_bf16 v[112:127],a[16:19],v[32:35],v[112:127]
buffer_load_dwordx4 v[88:91],v1,s[8:11],s63 offen offset:2048 sc1
s_sub_u32 s61,s60,46
s_cmp_ge_u32 s60,92
s_cselect_b32 s29,s61,s29
s_cselect_b32 s28,1,s28
v_mfma_f32_32x32x16_bf16 v[128:143],a[112:115],v[32:35],v[128:143]
s_cmp_lt_u32 s62,18
s_cselect_b32 s29,s62,s29
s_cselect_b32 s28,0,s28
s_lshl_b32 s30,s28,6
s_add_u32 s30,s30,s29
s_lshl_b32 s30,s30,9
s_waitcnt vmcnt(17)
v_mfma_f32_32x32x16_bf16 v[112:127],a[20:23],v[36:39],v[112:127]
buffer_load_dwordx4 v[92:95],v1,s[8:11],s63 offen offset:3072 sc1
s_add_u32 s63,s72,20480
s_add_u32 s30,s30,589824
s_and_b32 s60,s29,3
s_lshl2_add_u32 s60,s28,s60
v_mfma_f32_32x32x16_bf16 v[128:143],a[116:119],v[36:39],v[128:143]
s_mul_i32 s31,s60,98304
s_add_u32 s31,s31,s71
s_waitcnt vmcnt(17)
v_mfma_f32_32x32x16_bf16 v[112:127],a[24:27],v[40:43],v[112:127]
buffer_load_dwordx4 v[96:99],v1,s[8:11],s63 offen sc1
v_mfma_f32_32x32x16_bf16 v[128:143],a[120:123],v[40:43],v[128:143]
s_waitcnt vmcnt(17)
v_mfma_f32_32x32x16_bf16 v[112:127],a[28:31],v[44:47],v[112:127]
buffer_load_dwordx4 v[100:103],v1,s[8:11],s63 offen offset:1024 sc1
v_mfma_f32_32x32x16_bf16 v[128:143],a[124:127],v[44:47],v[128:143]
s_waitcnt vmcnt(17)
v_mfma_f32_32x32x16_bf16 v[112:127],a[32:35],v[48:51],v[112:127]
buffer_load_dwordx4 v[104:107],v1,s[8:11],s63 offen offset:2048 sc1
v_mfma_f32_32x32x16_bf16 v[128:143],a[128:131],v[48:51],v[128:143]
s_waitcnt vmcnt(17)
v_mfma_f32_32x32x16_bf16 v[112:127],a[36:39],v[52:55],v[112:127]
buffer_load_dwordx4 v[108:111],v1,s[8:11],s63 offen offset:3072 sc1
s_add_u32 s63,s73,0
buffer_load_dwordx4 v[16:19],v1,s[8:11],s63 offen sc1
v_mfma_f32_32x32x16_bf16 v[128:143],a[132:135],v[52:55],v[128:143]
s_waitcnt vmcnt(18)
v_mfma_f32_32x32x16_bf16 v[112:127],a[40:43],v[56:59],v[112:127]
buffer_load_dwordx4 v[20:23],v1,s[8:11],s63 offen offset:1024 sc1
v_mfma_f32_32x32x16_bf16 v[128:143],a[136:139],v[56:59],v[128:143]
s_waitcnt vmcnt(18)
v_mfma_f32_32x32x16_bf16 v[112:127],a[44:47],v[60:63],v[112:127]
buffer_load_dwordx4 v[24:27],v1,s[8:11],s63 offen offset:2048 sc1
v_mfma_f32_32x32x16_bf16 v[128:143],a[140:143],v[60:63],v[128:143]
s_waitcnt vmcnt(18)
v_mfma_f32_32x32x16_bf16 v[112:127],a[48:51],v[64:67],v[112:127]
buffer_load_dwordx4 v[28:31],v1,s[8:11],s63 offen offset:3072 sc1
s_add_u32 s63,s73,4096
v_mfma_f32_32x32x16_bf16 v[128:143],a[144:147],v[64:67],v[128:143]
s_waitcnt vmcnt(18)
v_mfma_f32_32x32x16_bf16 v[112:127],a[52:55],v[68:71],v[112:127]
s_waitcnt vmcnt(16)
s_mov_b64 exec,1
buffer_store_dword v5,v1,s[8:11],s59 offen sc1
s_mov_b64 exec,-1
s_mov_b32 s59,2147483648
v_mfma_f32_32x32x16_bf16 v[128:143],a[148:151],v[68:71],v[128:143]
buffer_load_dwordx4 v[32:35],v1,s[8:11],s63 offen sc1
s_waitcnt vmcnt(17)
v_mfma_f32_32x32x16_bf16 v[112:127],a[56:59],v[72:75],v[112:127]
v_mfma_f32_32x32x16_bf16 v[128:143],a[152:155],v[72:75],v[128:143]
buffer_load_dwordx4 v[36:39],v1,s[8:11],s63 offen offset:1024 sc1
s_waitcnt vmcnt(17)
v_mfma_f32_32x32x16_bf16 v[112:127],a[60:63],v[76:79],v[112:127]
v_mfma_f32_32x32x16_bf16 v[128:143],a[156:159],v[76:79],v[128:143]
buffer_load_dwordx4 v[40:43],v1,s[8:11],s63 offen offset:2048 sc1
s_waitcnt vmcnt(15)
v_mfma_f32_32x32x16_bf16 v[112:127],a[64:67],v[80:83],v[112:127]
v_mfma_f32_32x32x16_bf16 v[128:143],a[160:163],v[80:83],v[128:143]
buffer_load_dwordx4 v[44:47],v1,s[8:11],s63 offen offset:3072 sc1
s_add_u32 s63,s73,8192
s_waitcnt vmcnt(15)
v_mfma_f32_32x32x16_bf16 v[112:127],a[68:71],v[84:87],v[112:127]
v_mfma_f32_32x32x16_bf16 v[128:143],a[164:167],v[84:87],v[128:143]
buffer_load_dwordx4 v[48:51],v1,s[8:11],s63 offen sc1
s_waitcnt vmcnt(15)
v_mfma_f32_32x32x16_bf16 v[112:127],a[72:75],v[88:91],v[112:127]
v_mfma_f32_32x32x16_bf16 v[128:143],a[168:171],v[88:91],v[128:143]
buffer_load_dwordx4 v[52:55],v1,s[8:11],s63 offen offset:1024 sc1
v_lshlrev_b32 v184,16,v176
v_and_b32 v185,0xffff0000,v176
v_lshlrev_b32 v186,16,v177
s_waitcnt vmcnt(15)
v_mfma_f32_32x32x16_bf16 v[112:127],a[76:79],v[92:95],v[112:127]
v_and_b32 v187,0xffff0000,v177
v_lshlrev_b32 v188,16,v178
v_and_b32 v189,0xffff0000,v178
v_lshlrev_b32 v190,16,v179
v_and_b32 v191,0xffff0000,v179
v_mfma_f32_32x32x16_bf16 v[128:143],a[172:175],v[92:95],v[128:143]
buffer_load_dwordx4 v[56:59],v1,s[8:11],s63 offen offset:2048 sc1
v_lshlrev_b32 v192,16,v180
v_and_b32 v193,0xffff0000,v180
v_lshlrev_b32 v194,16,v181
v_and_b32 v195,0xffff0000,v181
s_waitcnt vmcnt(15)
v_mfma_f32_32x32x16_bf16 v[112:127],a[80:83],v[96:99],v[112:127]
v_lshlrev_b32 v196,16,v182
v_and_b32 v197,0xffff0000,v182
v_lshlrev_b32 v198,16,v183
v_and_b32 v199,0xffff0000,v183
s_waitcnt vmcnt(14)
v_mfma_f32_32x32x16_bf16 v[112:127],a[84:87],v[100:103],v[112:127]
buffer_load_dwordx4 v[60:63],v1,s[8:11],s63 offen offset:3072 sc1
s_add_u32 s63,s73,12288
s_waitcnt vmcnt(14)
v_mfma_f32_32x32x16_bf16 v[112:127],a[88:91],v[104:107],v[112:127]
s_waitcnt vmcnt(13)
v_mfma_f32_32x32x16_bf16 v[112:127],a[92:95],v[108:111],v[112:127]
buffer_load_dwordx4 v[64:67],v1,s[8:11],s63 offen sc1
v_mfma_f32_32x32x16_bf16 v[128:143],a[176:179],v[96:99],v[128:143]
s_mov_b64 exec,1
s_cmp_lg_u32 s49,0
s_cbranch_scc0 ls_323
buffer_store_dword v5,v1,s[8:11],s82 offen sc1
s_branch ls_324
ls_323:
buffer_store_dword v5,v1,s[8:11],s82 offen
ls_324:
s_mov_b64 exec,-1
v_mfma_f32_32x32x16_bf16 v[128:143],a[180:183],v[100:103],v[128:143]
buffer_load_dwordx4 v[68:71],v1,s[8:11],s63 offen offset:1024 sc1
ds_write_b128 v206,v[112:115] offset:0
ds_write_b128 v206,v[116:119] offset:1024
v_mfma_f32_32x32x16_bf16 v[128:143],a[184:187],v[104:107],v[128:143]
ds_write_b128 v206,v[120:123] offset:512
ds_write_b128 v206,v[124:127] offset:1536
v_mfma_f32_32x32x16_bf16 v[128:143],a[188:191],v[108:111],v[128:143]
buffer_load_dword v3,v2,s[8:11],s30 offen sc1
s_nop 5
s_branch W4_E0
s_nop 3
W4_W0:
s_waitcnt vmcnt(15)
v_mfma_f32_32x32x16_bf16 v[112:127],a[0:3],v[16:19],0
s_add_u32 s63,s72,12288
buffer_load_dwordx4 v[72:75],v1,s[8:11],s63 offen offset:2048 sc1
v_xor_b32 v206,0x8000,v206
v_xor_b32 v207,0x8000,v207
s_lshl_b32 s64,s51,6
v_mfma_f32_32x32x16_bf16 v[128:143],a[96:99],v[16:19],0
s_add_u32 s64,s64,s52
s_and_b32 s65,s52,7
s_lshl3_add_u32 s65,s51,s65
s_mul_i32 s65,s65,46080
s_add_u32 s65,s65,s70
s_add_u32 s65,s65,212467712
s_waitcnt vmcnt(15)
v_mfma_f32_32x32x16_bf16 v[112:127],a[4:7],v[20:23],v[112:127]
buffer_load_dwordx4 v[76:79],v1,s[8:11],s63 offen offset:3072 sc1
s_add_u32 s63,s72,16384
buffer_load_dwordx4 v[176:179],v1,s[8:11],s65 offen sc1
s_mul_i32 s65,s64,40960
v_mfma_f32_32x32x16_bf16 v[128:143],a[100:103],v[20:23],v[128:143]
s_add_u32 s65,s65,s70
s_add_u32 s65,s65,218365952
buffer_load_dwordx4 v[180:183],v15,s[8:11],s65 offen sc1
s_lshl_b32 s82,s64,9
s_lshl2_add_u32 s82,s56,s82
s_waitcnt vmcnt(17)
v_mfma_f32_32x32x16_bf16 v[112:127],a[8:11],v[24:27],v[112:127]
buffer_load_dwordx4 v[80:83],v1,s[8:11],s63 offen sc1
s_add_u32 s42,s82,32768
s_add_u32 s82,s82,327680
s_mul_i32 s41,s52,46080
s_add_u32 s41,s41,209518592
v_mfma_f32_32x32x16_bf16 v[128:143],a[104:107],v[24:27],v[128:143]
s_add_u32 s40,s41,s70
s_lshr_b32 s64,s70,3
s_add_u32 s41,s41,s64
s_add_u32 s41,s41,40960
s_mul_i32 s64,s52,40960
s_add_u32 s62,s32,1
s_waitcnt vmcnt(17)
v_mfma_f32_32x32x16_bf16 v[112:127],a[12:15],v[28:31],v[112:127]
buffer_load_dwordx4 v[84:87],v1,s[8:11],s63 offen offset:1024 sc1
s_cmp_lg_u32 s51,0
s_cselect_b32 s40,s64,s40
s_cselect_b32 s42,2147483648,s42
s_min_u32 s62,s62,127
v_mfma_f32_32x32x16_bf16 v[128:143],a[108:111],v[28:31],v[128:143]
s_sub_u32 s60,s62,18
s_lshr_b32 s29,s60,1
s_and_b32 s28,s60,1
s_cmp_eq_u32 s28,0
s_cselect_b32 s61,18,0
s_add_u32 s29,s29,s61
s_waitcnt vmcnt(17)
v_mfma_f32_32x32x16_bf16 v[112:127],a[16:19],v[32:35],v[112:127]
buffer_load_dwordx4 v[88:91],v1,s[8:11],s63 offen offset:2048 sc1
s_sub_u32 s61,s60,46
s_cmp_ge_u32 s60,92
s_cselect_b32 s29,s61,s29
s_cselect_b32 s28,1,s28
v_mfma_f32_32x32x16_bf16 v[128:143],a[112:115],v[32:35],v[128:143]
s_cmp_lt_u32 s62,18
s_cselect_b32 s29,s62,s29
s_cselect_b32 s28,0,s28
s_lshl_b32 s30,s28,6
s_add_u32 s30,s30,s29
s_lshl_b32 s30,s30,9
s_waitcnt vmcnt(17)
v_mfma_f32_32x32x16_bf16 v[112:127],a[20:23],v[36:39],v[112:127]
buffer_load_dwordx4 v[92:95],v1,s[8:11],s63 offen offset:3072 sc1
s_add_u32 s63,s72,20480
s_add_u32 s30,s30,589824
s_and_b32 s60,s29,3
s_lshl2_add_u32 s60,s28,s60
v_mfma_f32_32x32x16_bf16 v[128:143],a[116:119],v[36:39],v[128:143]
s_mul_i32 s31,s60,98304
s_add_u32 s31,s31,s71
s_waitcnt vmcnt(17)
v_mfma_f32_32x32x16_bf16 v[112:127],a[24:27],v[40:43],v[112:127]
buffer_load_dwordx4 v[96:99],v1,s[8:11],s63 offen sc1
v_mfma_f32_32x32x16_bf16 v[128:143],a[120:123],v[40:43],v[128:143]
s_waitcnt vmcnt(17)
v_mfma_f32_32x32x16_bf16 v[112:127],a[28:31],v[44:47],v[112:127]
buffer_load_dwordx4 v[100:103],v1,s[8:11],s63 offen offset:1024 sc1
v_mfma_f32_32x32x16_bf16 v[128:143],a[124:127],v[44:47],v[128:143]
s_waitcnt vmcnt(17)
v_mfma_f32_32x32x16_bf16 v[112:127],a[32:35],v[48:51],v[112:127]
buffer_load_dwordx4 v[104:107],v1,s[8:11],s63 offen offset:2048 sc1
v_mfma_f32_32x32x16_bf16 v[128:143],a[128:131],v[48:51],v[128:143]
s_waitcnt vmcnt(17)
v_mfma_f32_32x32x16_bf16 v[112:127],a[36:39],v[52:55],v[112:127]
buffer_load_dwordx4 v[108:111],v1,s[8:11],s63 offen offset:3072 sc1
v_mfma_f32_32x32x16_bf16 v[128:143],a[132:135],v[52:55],v[128:143]
s_waitcnt vmcnt(17)
v_mfma_f32_32x32x16_bf16 v[112:127],a[40:43],v[56:59],v[112:127]
v_mfma_f32_32x32x16_bf16 v[128:143],a[136:139],v[56:59],v[128:143]
s_waitcnt vmcnt(16)
v_mfma_f32_32x32x16_bf16 v[112:127],a[44:47],v[60:63],v[112:127]
v_mfma_f32_32x32x16_bf16 v[128:143],a[140:143],v[60:63],v[128:143]
s_waitcnt vmcnt(15)
v_mfma_f32_32x32x16_bf16 v[112:127],a[48:51],v[64:67],v[112:127]
v_mfma_f32_32x32x16_bf16 v[128:143],a[144:147],v[64:67],v[128:143]
s_waitcnt vmcnt(14)
v_mfma_f32_32x32x16_bf16 v[112:127],a[52:55],v[68:71],v[112:127]
s_waitcnt vmcnt(12)
s_mov_b64 exec,1
buffer_store_dword v5,v1,s[8:11],s59 offen sc1
s_mov_b64 exec,-1
s_mov_b32 s59,2147483648
v_mfma_f32_32x32x16_bf16 v[128:143],a[148:151],v[68:71],v[128:143]
s_waitcnt vmcnt(12)
v_mfma_f32_32x32x16_bf16 v[112:127],a[56:59],v[72:75],v[112:127]
v_mfma_f32_32x32x16_bf16 v[128:143],a[152:155],v[72:75],v[128:143]
s_waitcnt vmcnt(11)
v_mfma_f32_32x32x16_bf16 v[112:127],a[60:63],v[76:79],v[112:127]
v_mfma_f32_32x32x16_bf16 v[128:143],a[156:159],v[76:79],v[128:143]
s_waitcnt vmcnt(8)
v_mfma_f32_32x32x16_bf16 v[112:127],a[64:67],v[80:83],v[112:127]
v_mfma_f32_32x32x16_bf16 v[128:143],a[160:163],v[80:83],v[128:143]
s_waitcnt vmcnt(7)
v_mfma_f32_32x32x16_bf16 v[112:127],a[68:71],v[84:87],v[112:127]
v_mfma_f32_32x32x16_bf16 v[128:143],a[164:167],v[84:87],v[128:143]
s_waitcnt vmcnt(6)
v_mfma_f32_32x32x16_bf16 v[112:127],a[72:75],v[88:91],v[112:127]
v_mfma_f32_32x32x16_bf16 v[128:143],a[168:171],v[88:91],v[128:143]
v_lshlrev_b32 v184,16,v176
v_and_b32 v185,0xffff0000,v176
v_lshlrev_b32 v186,16,v177
v_and_b32 v187,0xffff0000,v177
v_lshlrev_b32 v188,16,v178
s_waitcnt vmcnt(5)
v_mfma_f32_32x32x16_bf16 v[112:127],a[76:79],v[92:95],v[112:127]
buffer_load_dword v3,v2,s[8:11],s35 offen sc1
v_and_b32 v189,0xffff0000,v178
v_lshlrev_b32 v190,16,v179
v_and_b32 v191,0xffff0000,v179
v_lshlrev_b32 v192,16,v180
v_mfma_f32_32x32x16_bf16 v[128:143],a[172:175],v[92:95],v[128:143]
v_and_b32 v193,0xffff0000,v180
v_lshlrev_b32 v194,16,v181
v_and_b32 v195,0xffff0000,v181
v_lshlrev_b32 v196,16,v182
v_and_b32 v197,0xffff0000,v182
s_waitcnt vmcnt(5)
v_mfma_f32_32x32x16_bf16 v[112:127],a[80:83],v[96:99],v[112:127]
v_lshlrev_b32 v198,16,v183
v_and_b32 v199,0xffff0000,v183
s_waitcnt vmcnt(4)
v_mfma_f32_32x32x16_bf16 v[112:127],a[84:87],v[100:103],v[112:127]
s_waitcnt vmcnt(3)
v_mfma_f32_32x32x16_bf16 v[112:127],a[88:91],v[104:107],v[112:127]
s_waitcnt vmcnt(2)
v_mfma_f32_32x32x16_bf16 v[112:127],a[92:95],v[108:111],v[112:127]
v_mfma_f32_32x32x16_bf16 v[128:143],a[176:179],v[96:99],v[128:143]
s_mov_b64 exec,1
s_cmp_lg_u32 s49,0
s_cbranch_scc0 ls_325
buffer_store_dword v5,v1,s[8:11],s82 offen sc1
s_branch ls_326
ls_325:
buffer_store_dword v5,v1,s[8:11],s82 offen
ls_326:
s_mov_b64 exec,-1
v_mfma_f32_32x32x16_bf16 v[128:143],a[180:183],v[100:103],v[128:143]
ds_write_b128 v206,v[112:115] offset:0
ds_write_b128 v206,v[116:119] offset:1024
ds_write_b128 v206,v[120:123] offset:512
v_mfma_f32_32x32x16_bf16 v[128:143],a[184:187],v[104:107],v[128:143]
ds_write_b128 v206,v[124:127] offset:1536
v_mfma_f32_32x32x16_bf16 v[128:143],a[188:191],v[108:111],v[128:143]
s_waitcnt vmcnt(1)
v_cmp_eq_u32 vcc,0,v3
s_cmp_eq_u64 vcc,0
s_cselect_b32 s37,0,2147483648
s_cmp_lt_u32 s32,128
s_cselect_b32 s37,s37,2147483648
s_cmp_eq_u32 s37,0
s_cbranch_scc1 W4_E2
s_branch W4_E0
s_nop 2
W4_END:
s_endpgm
.section .rodata,"a"
.p2align 6
.amdhsa_kernel interleave_layers__memory_aug_recurrent_mem_tr__mixer_s_mlp__prompt_kernel
  .amdhsa_next_free_vgpr 512
  .amdhsa_next_free_sgpr 102
  .amdhsa_accum_offset 256
  .amdhsa_group_segment_fixed_size 0
  .amdhsa_kernarg_size 120
  .amdhsa_user_sgpr_count 2
  .amdhsa_user_sgpr_kernarg_segment_ptr 1
  .amdhsa_system_sgpr_workgroup_id_x 1
.end_amdhsa_kernel
```

```asm
; @launch grid=(256,1,1) block=(256,1,1) lds=163840
.amdgcn_target "amdgcn-amd-amdhsa--gfx950"
.text
.globl interleave_layers__memory_aug_recurrent_mem_tr__mixer_s_mlp__prompt_kernel
.p2align 8
.type interleave_layers__memory_aug_recurrent_mem_tr__mixer_s_mlp__prompt_kernel,@function
interleave_layers__memory_aug_recurrent_mem_tr__mixer_s_mlp__prompt_kernel:
s_cmp_ge_u32 s2,256
s_cbranch_scc1 EXIT
s_load_dwordx16 s[16:31],s[0:1],0
s_load_dwordx8 s[32:39],s[0:1],64
s_load_dwordx4 s[40:43],s[0:1],96
s_load_dwordx2 s[44:45],s[0:1],112
v_lshrrev_b32 v1,6,v0
v_and_b32 v0,63,v0
v_readfirstlane_b32 s46,v1
s_mov_b32 s47,200000
s_mov_b32 s49,0
s_getreg_b32 s4,hwreg(HW_REG_XCC_ID)
s_and_b32 s4,s4,7
s_waitcnt lgkmcnt(0)
s_mov_b32 s8,s44
s_mov_b32 s9,s45
s_mov_b32 s10,268435456
s_mov_b32 s11,0x20000
s_mov_b32 s12,s42
s_mov_b32 s13,s43
s_mov_b32 s14,256
s_mov_b32 s15,0x20000
v_lshlrev_b32 v1,4,v0
v_mov_b32 v4,0
v_mov_b32 v5,0
v_mov_b32 v6,0
v_mov_b32 v7,0
s_lshl_b32 s5,s2,2
s_add_u32 s5,s5,s46
s_lshl_b32 s5,s5,10
buffer_store_dwordx4 v[4:7],v1,s[8:11],s5 offen sc1
v_mov_b32 v2,0
s_cmp_lg_u32 s46,0
s_cbranch_scc1 TK_DONE
s_mov_b64 exec,1
v_mov_b32 v1,1
s_lshl_b32 s5,s4,2
v_mov_b32 v3,s5
buffer_atomic_add v1,v3,s[12:15],0 offen offset:32 sc0 sc1
s_waitcnt vmcnt(0)
v_readfirstlane_b32 s5,v1
s_lshl_b32 s6,s4,5
s_add_u32 s6,s6,s5
s_cmp_lt_u32 s5,32
s_cselect_b32 s6,s6,999
v_mov_b32 v1,s6
ds_write_b32 v2,v1
s_mov_b64 exec,-1
s_waitcnt lgkmcnt(0)
TK_DONE:
s_barrier
ds_read_b32 v1,v2
s_waitcnt lgkmcnt(0)
v_readfirstlane_b32 s3,v1
s_barrier
s_nop 2
s_branch DISPATCH
ROLE_CS:
s_lshr_b32 s28,s48,4
s_and_b32 s29,s48,15
s_mul_i32 s82,s28,2097152
s_add_u32 s82,s82,2097152
v_lshlrev_b32 v1,4,v0
v_and_b32 v12,1,v0
v_mul_u32_u24 v2,0xaaaa,v12
v_or_b32 v2,0x4444,v2
s_add_u32 s60,s46,1
s_and_b32 s60,s60,3
s_lshl_b32 s60,s60,11
s_add_u32 s60,s60,131072
v_add_u32 v3,s60,v1
s_add_u32 s60,s46,2
s_and_b32 s60,s60,3
s_lshl_b32 s60,s60,11
s_add_u32 s60,s60,131072
v_add_u32 v4,s60,v1
s_add_u32 s60,s46,3
s_and_b32 s60,s60,3
s_lshl_b32 s60,s60,11
s_add_u32 s60,s60,131072
v_add_u32 v5,s60,v1
v_add_u32 v59,139264,v1
s_lshl_b32 s60,s46,11
s_add_u32 s60,s60,131072
v_add_u32 v22,s60,v1
s_lshr_b32 s60,s46,1
s_lshl_b32 s60,s60,10
s_and_b32 s61,s46,1
s_lshl_b32 s61,s61,3
s_add_u32 s60,s60,s61
v_add_u32 v23,s60,v59
s_mul_i32 s60,s46,20480
v_add_u32 v21,s60,v1
v_and_b32 v11,7,v0
v_lshlrev_b32 v11,2,v11
v_bfe_u32 v12,v0,3,2
v_lshl_add_u32 v11,v12,7,v11
s_xor_b32 s60,s28,1
s_lshl_b32 s60,s60,19
s_lshl_b32 s61,s46,11
s_add_u32 s83,s60,s61
s_add_u32 s83,s83,10485760
s_mov_b32 s36,0
s_mov_b32 s88,0xcccccccc
s_mov_b32 s89,0xcccccccc
s_mov_b32 s90,0x33333333
s_mov_b32 s91,0x33333333
s_mov_b32 s87,0x3dd53b95
v_lshrrev_b32 v14,4,v0
v_and_b32 v15,15,v0
v_lshrrev_b32 v12,2,v15
v_add_u32 v12,v12,v14
v_and_b32 v12,3,v12
v_lshlrev_b32 v6,3,v12
v_lshl_add_u32 v6,v15,5,v6
s_mul_i32 s60,s46,1536
s_add_u32 s60,s60,141312
v_add_u32 v6,s60,v6
v_add_u32 v12,v0,v14
v_and_b32 v12,3,v12
v_lshlrev_b32 v7,3,v12
v_lshrrev_b32 v12,2,v0
v_lshl_add_u32 v7,v12,5,v7
v_add_u32 v7,141312,v7
s_min_u32 s62,s46,2
v_lshrrev_b32 v12,2,v15
v_and_b32 v13,1,v15
v_lshl_add_u32 v12,v12,1,v13
v_bfe_u32 v13,v15,1,1
v_lshlrev_b32 v8,8,v14
v_lshl_add_u32 v8,v12,5,v8
v_xor_b32 v16,1,v13
v_lshl_add_u32 v8,v16,4,v8
v_lshlrev_b32 v20,8,v14
v_lshl_add_u32 v20,v13,7,v20
v_and_b32 v16,3,v12
v_lshl_add_u32 v20,v16,5,v20
v_lshrrev_b32 v16,2,v12
v_lshl_add_u32 v20,v16,4,v20
v_min_u32 v12,5,v0
s_mul_i32 s60,s48,3
v_add_u32 v9,s60,v12
v_lshlrev_b32 v9,2,v9
v_add_u32 v13,65524,v9
v_cmp_lt_u32 vcc,2,v12
s_nop 1
v_cndmask_b32 v9,v9,v13,vcc
s_mul_i32 s84,s48,12288
s_add_u32 s84,s84,74448896
s_mul_i32 s60,s29,3072
s_lshl_b32 s61,s62,10
s_add_u32 s60,s60,s61
s_add_u32 s60,s60,s82
s_add_u32 s33,s60,163840
s_add_u32 s34,s60,557056
s_mul_i32 s85,s48,6144
s_add_u32 s85,s85,24117248
s_lshl_b32 s86,s48,5
s_lshl_b32 s61,s62,2
s_add_u32 s86,s86,688128
s_lshr_b32 s60,s29,2
s_lshl_b32 s60,s60,7
s_and_b32 s63,s29,3
s_mul_i32 s63,s63,12
s_add_u32 s60,s60,s63
s_add_u32 s60,s60,s61
s_add_u32 s60,s60,s82
s_add_u32 s35,s60,951296
s_cmp_eq_u32 s46,3
s_cbranch_scc1 si_1
v_mov_b32 v12,-1
v_mov_b32 v13,0
s_cmp_lg_u32 s49,0
s_cbranch_scc1 ls_2
s_add_u32 s60,s33,0
buffer_store_dword v12,v1,s[8:11],s60 offen
s_add_u32 s60,s33,49152
buffer_store_dword v12,v1,s[8:11],s60 offen
s_add_u32 s60,s33,98304
buffer_store_dword v12,v1,s[8:11],s60 offen
s_add_u32 s60,s33,147456
buffer_store_dword v12,v1,s[8:11],s60 offen
s_add_u32 s60,s33,196608
buffer_store_dword v12,v1,s[8:11],s60 offen
s_add_u32 s60,s33,245760
buffer_store_dword v12,v1,s[8:11],s60 offen
s_add_u32 s60,s33,294912
buffer_store_dword v12,v1,s[8:11],s60 offen
s_add_u32 s60,s33,344064
buffer_store_dword v12,v1,s[8:11],s60 offen
s_mov_b64 exec,1
buffer_store_dword v13,v1,s[8:11],s35 offen
buffer_store_dword v13,v1,s[8:11],s35 offen offset:512
s_mov_b64 exec,-1
s_branch ls_3
ls_2:
s_add_u32 s60,s33,0
buffer_store_dword v12,v1,s[8:11],s60 offen sc1
s_add_u32 s60,s33,49152
buffer_store_dword v12,v1,s[8:11],s60 offen sc1
s_add_u32 s60,s33,98304
buffer_store_dword v12,v1,s[8:11],s60 offen sc1
s_add_u32 s60,s33,147456
buffer_store_dword v12,v1,s[8:11],s60 offen sc1
s_add_u32 s60,s33,196608
buffer_store_dword v12,v1,s[8:11],s60 offen sc1
s_add_u32 s60,s33,245760
buffer_store_dword v12,v1,s[8:11],s60 offen sc1
s_add_u32 s60,s33,294912
buffer_store_dword v12,v1,s[8:11],s60 offen sc1
s_add_u32 s60,s33,344064
buffer_store_dword v12,v1,s[8:11],s60 offen sc1
s_mov_b64 exec,1
buffer_store_dword v13,v1,s[8:11],s35 offen sc1
buffer_store_dword v13,v1,s[8:11],s35 offen offset:512 sc1
s_mov_b64 exec,-1
ls_3:
si_1:
s_mul_i32 s73,s48,384
s_mov_b32 s74,s73
v_add_u32 v12,0,v0
v_mul_u32_u24 v13,2731,v12
v_lshrrev_b32 v13,16,v13
v_mul_u32_u24 v16,24,v13
v_sub_u32 v12,v12,v16
v_mul_u32_u24 v104,12288,v13
v_lshl_add_u32 v104,v12,4,v104
v_add_u32 v12,64,v0
v_mul_u32_u24 v13,2731,v12
v_lshrrev_b32 v13,16,v13
v_mul_u32_u24 v16,24,v13
v_sub_u32 v12,v12,v16
v_mul_u32_u24 v105,12288,v13
v_lshl_add_u32 v105,v12,4,v105
v_add_u32 v12,128,v0
v_mul_u32_u24 v13,2731,v12
v_lshrrev_b32 v13,16,v13
v_mul_u32_u24 v16,24,v13
v_sub_u32 v12,v12,v16
v_mul_u32_u24 v106,12288,v13
v_lshl_add_u32 v106,v12,4,v106
s_mov_b32 s4,s20
s_mov_b32 s5,s21
s_mov_b32 s6,7864320
s_mov_b32 s7,0x20000
s_mov_b32 s52,s22
s_mov_b32 s53,s23
s_mov_b32 s54,7864320
s_mov_b32 s55,0x20000
s_branch SV_LOAD
ROLE_CV:
s_lshr_b32 s28,s48,3
s_and_b32 s29,s48,7
s_mul_i32 s82,s28,2097152
s_add_u32 s82,s82,2097152
v_lshlrev_b32 v1,4,v0
v_and_b32 v12,1,v0
v_mul_u32_u24 v2,0xaaaa,v12
v_or_b32 v2,0x4444,v2
s_add_u32 s60,s46,1
s_and_b32 s60,s60,3
s_lshl_b32 s60,s60,11
s_add_u32 s60,s60,131072
v_add_u32 v3,s60,v1
s_add_u32 s60,s46,2
s_and_b32 s60,s60,3
s_lshl_b32 s60,s60,11
s_add_u32 s60,s60,131072
v_add_u32 v4,s60,v1
s_add_u32 s60,s46,3
s_and_b32 s60,s60,3
s_lshl_b32 s60,s60,11
s_add_u32 s60,s60,131072
v_add_u32 v5,s60,v1
v_add_u32 v59,139264,v1
s_lshl_b32 s60,s46,11
s_add_u32 s60,s60,131072
v_add_u32 v22,s60,v1
s_lshr_b32 s60,s46,1
s_lshl_b32 s60,s60,10
s_and_b32 s61,s46,1
s_lshl_b32 s61,s61,3
s_add_u32 s60,s60,s61
v_add_u32 v23,s60,v59
s_mul_i32 s60,s46,20480
v_add_u32 v21,s60,v1
v_and_b32 v11,7,v0
v_lshlrev_b32 v11,2,v11
v_bfe_u32 v12,v0,3,2
v_lshl_add_u32 v11,v12,7,v11
s_xor_b32 s60,s28,1
s_lshl_b32 s60,s60,19
s_lshl_b32 s61,s46,11
s_add_u32 s83,s60,s61
s_add_u32 s83,s83,10485760
s_mov_b32 s36,1
v_lshlrev_b32 v8,3,v0
v_lshlrev_b32 v9,3,v0
v_lshlrev_b32 v20,3,v0
s_and_b32 s62,s46,1
s_lshl_b32 s60,s62,11
v_add_u32 v6,s60,v1
s_lshl_b32 s60,s62,3
s_add_u32 s60,s60,1024
v_add_u32 v7,s60,v1
s_lshr_b32 s61,s46,1
s_lshl_b32 s60,s29,1
s_add_u32 s60,s60,s61
s_mul_i32 s60,s60,3072
s_add_u32 s60,s60,s82
s_add_u32 s34,s60,557056
s_lshl_b32 s60,s48,1
s_add_u32 s60,s60,s61
s_mul_i32 s85,s60,6144
s_add_u32 s85,s85,24120320
s_lshl_b32 s86,s60,5
s_lshl_b32 s61,s62,2
s_add_u32 s86,s86,s61
s_add_u32 s86,s86,688132
v_mov_b32 v12,-1
v_mov_b32 v13,-1
v_mov_b32 v14,-1
v_mov_b32 v15,-1
s_cmp_lg_u32 s49,0
s_cbranch_scc1 ls_4
s_add_u32 s60,s34,0
buffer_store_dwordx4 v[12:15],v6,s[8:11],s60 offen
buffer_store_dwordx2 v[12:13],v7,s[8:11],s60 offen
s_add_u32 s60,s34,49152
buffer_store_dwordx4 v[12:15],v6,s[8:11],s60 offen
buffer_store_dwordx2 v[12:13],v7,s[8:11],s60 offen
s_add_u32 s60,s34,98304
buffer_store_dwordx4 v[12:15],v6,s[8:11],s60 offen
buffer_store_dwordx2 v[12:13],v7,s[8:11],s60 offen
s_add_u32 s60,s34,147456
buffer_store_dwordx4 v[12:15],v6,s[8:11],s60 offen
buffer_store_dwordx2 v[12:13],v7,s[8:11],s60 offen
s_add_u32 s60,s34,196608
buffer_store_dwordx4 v[12:15],v6,s[8:11],s60 offen
buffer_store_dwordx2 v[12:13],v7,s[8:11],s60 offen
s_add_u32 s60,s34,245760
buffer_store_dwordx4 v[12:15],v6,s[8:11],s60 offen
buffer_store_dwordx2 v[12:13],v7,s[8:11],s60 offen
s_add_u32 s60,s34,294912
buffer_store_dwordx4 v[12:15],v6,s[8:11],s60 offen
buffer_store_dwordx2 v[12:13],v7,s[8:11],s60 offen
s_add_u32 s60,s34,344064
buffer_store_dwordx4 v[12:15],v6,s[8:11],s60 offen
buffer_store_dwordx2 v[12:13],v7,s[8:11],s60 offen
s_branch ls_5
ls_4:
s_add_u32 s60,s34,0
buffer_store_dwordx4 v[12:15],v6,s[8:11],s60 offen sc1
buffer_store_dwordx2 v[12:13],v7,s[8:11],s60 offen sc1
s_add_u32 s60,s34,49152
buffer_store_dwordx4 v[12:15],v6,s[8:11],s60 offen sc1
buffer_store_dwordx2 v[12:13],v7,s[8:11],s60 offen sc1
s_add_u32 s60,s34,98304
buffer_store_dwordx4 v[12:15],v6,s[8:11],s60 offen sc1
buffer_store_dwordx2 v[12:13],v7,s[8:11],s60 offen sc1
s_add_u32 s60,s34,147456
buffer_store_dwordx4 v[12:15],v6,s[8:11],s60 offen sc1
buffer_store_dwordx2 v[12:13],v7,s[8:11],s60 offen sc1
s_add_u32 s60,s34,196608
buffer_store_dwordx4 v[12:15],v6,s[8:11],s60 offen sc1
buffer_store_dwordx2 v[12:13],v7,s[8:11],s60 offen sc1
s_add_u32 s60,s34,245760
buffer_store_dwordx4 v[12:15],v6,s[8:11],s60 offen sc1
buffer_store_dwordx2 v[12:13],v7,s[8:11],s60 offen sc1
s_add_u32 s60,s34,294912
buffer_store_dwordx4 v[12:15],v6,s[8:11],s60 offen sc1
buffer_store_dwordx2 v[12:13],v7,s[8:11],s60 offen sc1
s_add_u32 s60,s34,344064
buffer_store_dwordx4 v[12:15],v6,s[8:11],s60 offen sc1
buffer_store_dwordx2 v[12:13],v7,s[8:11],s60 offen sc1
s_nop 0
ls_5:
s_mul_i32 s73,s48,768
s_add_u32 s74,s73,96
v_add_u32 v12,0,v0
v_mul_u32_u24 v13,2731,v12
v_lshrrev_b32 v13,16,v13
v_mul_u32_u24 v16,24,v13
v_sub_u32 v12,v12,v16
v_mul_u32_u24 v104,12288,v13
v_lshl_add_u32 v104,v12,4,v104
v_mul_u32_u24 v13,43,v12
v_lshrrev_b32 v13,8,v13
v_mul_u32_u24 v13,96,v13
v_add_u32 v104,v104,v13
v_add_u32 v12,64,v0
v_mul_u32_u24 v13,2731,v12
v_lshrrev_b32 v13,16,v13
v_mul_u32_u24 v16,24,v13
v_sub_u32 v12,v12,v16
v_mul_u32_u24 v105,12288,v13
v_lshl_add_u32 v105,v12,4,v105
v_mul_u32_u24 v13,43,v12
v_lshrrev_b32 v13,8,v13
v_mul_u32_u24 v13,96,v13
v_add_u32 v105,v105,v13
v_add_u32 v12,128,v0
v_mul_u32_u24 v13,2731,v12
v_lshrrev_b32 v13,16,v13
v_mul_u32_u24 v16,24,v13
v_sub_u32 v12,v12,v16
v_mul_u32_u24 v106,12288,v13
v_lshl_add_u32 v106,v12,4,v106
v_mul_u32_u24 v13,43,v12
v_lshrrev_b32 v13,8,v13
v_mul_u32_u24 v13,96,v13
v_add_u32 v106,v106,v13
s_mov_b32 s4,s24
s_mov_b32 s5,s25
s_mov_b32 s6,7864320
s_mov_b32 s7,0x20000
s_mov_b32 s52,s24
s_mov_b32 s53,s25
s_mov_b32 s54,7864320
s_mov_b32 s55,0x20000
SV_LOAD:
s_waitcnt vmcnt(0)
s_barrier
s_cmp_lg_u32 s46,0
s_cbranch_scc1 arr_6
v_mov_b32 v12,1
s_lshl_b32 s3,s49,2
v_mov_b32 v13,s3
s_mov_b64 exec,1
buffer_atomic_add v12,v13,s[12:15],0 offen sc1
s_mov_b64 exec,-1
arr_6:
s_and_b32 s60,s46,1
s_mul_i32 s60,s60,196608
s_lshr_b32 s61,s46,1
s_mul_i32 s75,s61,393216
s_add_u32 s75,s75,s60
s_mul_i32 s76,s61,393216
s_add_u32 s76,s76,s60
s_mul_i32 s77,s46,6144
v_lshrrev_b32 v14,4,v0
v_and_b32 v15,15,v0
v_and_b32 v12,1,v14
v_lshlrev_b32 v12,2,v12
v_lshrrev_b32 v13,1,v14
v_lshl_add_u32 v12,v13,4,v12
v_bfe_u32 v13,v0,2,1
v_add_u32 v12,v12,v13
v_bfe_u32 v13,v0,3,1
v_lshl_add_u32 v12,v13,3,v12
v_mul_u32_u24 v107,384,v12
v_and_b32 v13,3,v0
v_lshl_add_u32 v107,v13,3,v107
s_mul_i32 s60,s46,96
v_add_u32 v107,s60,v107
s_add_u32 s60,s75,s73
s_add_u32 m0,s77,0
s_add_u32 s61,s60,0
buffer_load_dwordx4 v104,s[4:7],s61 offen lds
s_add_u32 m0,s77,1024
s_add_u32 s61,s60,0
buffer_load_dwordx4 v105,s[4:7],s61 offen lds
s_add_u32 m0,s77,2048
s_add_u32 s61,s60,0
buffer_load_dwordx4 v106,s[4:7],s61 offen lds
s_add_u32 m0,s77,3072
s_add_u32 s61,s60,98304
buffer_load_dwordx4 v104,s[4:7],s61 offen lds
s_add_u32 m0,s77,4096
s_add_u32 s61,s60,98304
buffer_load_dwordx4 v105,s[4:7],s61 offen lds
s_add_u32 m0,s77,5120
s_add_u32 s61,s60,98304
buffer_load_dwordx4 v106,s[4:7],s61 offen lds
s_add_u32 s60,s75,s74
s_add_u32 m0,s77,24576
s_add_u32 s61,s60,0
buffer_load_dwordx4 v104,s[52:55],s61 offen lds
s_add_u32 m0,s77,25600
s_add_u32 s61,s60,0
buffer_load_dwordx4 v105,s[52:55],s61 offen lds
s_add_u32 m0,s77,26624
s_add_u32 s61,s60,0
buffer_load_dwordx4 v106,s[52:55],s61 offen lds
s_add_u32 m0,s77,27648
s_add_u32 s61,s60,98304
buffer_load_dwordx4 v104,s[52:55],s61 offen lds
s_add_u32 m0,s77,28672
s_add_u32 s61,s60,98304
buffer_load_dwordx4 v105,s[52:55],s61 offen lds
s_add_u32 m0,s77,29696
s_add_u32 s61,s60,98304
buffer_load_dwordx4 v106,s[52:55],s61 offen lds
s_add_u32 s60,s75,s73
s_add_u32 m0,s77,49152
s_add_u32 s61,s60,786432
buffer_load_dwordx4 v104,s[4:7],s61 offen lds
s_add_u32 m0,s77,50176
s_add_u32 s61,s60,786432
buffer_load_dwordx4 v105,s[4:7],s61 offen lds
s_add_u32 m0,s77,51200
s_add_u32 s61,s60,786432
buffer_load_dwordx4 v106,s[4:7],s61 offen lds
s_add_u32 m0,s77,52224
s_add_u32 s61,s60,884736
buffer_load_dwordx4 v104,s[4:7],s61 offen lds
s_add_u32 m0,s77,53248
s_add_u32 s61,s60,884736
buffer_load_dwordx4 v105,s[4:7],s61 offen lds
s_add_u32 m0,s77,54272
s_add_u32 s61,s60,884736
buffer_load_dwordx4 v106,s[4:7],s61 offen lds
s_add_u32 s60,s75,s74
s_add_u32 m0,s77,73728
s_add_u32 s61,s60,786432
buffer_load_dwordx4 v104,s[52:55],s61 offen lds
s_add_u32 m0,s77,74752
s_add_u32 s61,s60,786432
buffer_load_dwordx4 v105,s[52:55],s61 offen lds
s_add_u32 m0,s77,75776
s_add_u32 s61,s60,786432
buffer_load_dwordx4 v106,s[52:55],s61 offen lds
s_add_u32 m0,s77,76800
s_add_u32 s61,s60,884736
buffer_load_dwordx4 v104,s[52:55],s61 offen lds
s_add_u32 m0,s77,77824
s_add_u32 s61,s60,884736
buffer_load_dwordx4 v105,s[52:55],s61 offen lds
s_add_u32 m0,s77,78848
s_add_u32 s61,s60,884736
buffer_load_dwordx4 v106,s[52:55],s61 offen lds
s_add_u32 s60,s75,s73
s_add_u32 m0,s77,98304
s_add_u32 s61,s60,1572864
buffer_load_dwordx4 v104,s[4:7],s61 offen lds
s_add_u32 m0,s77,99328
s_add_u32 s61,s60,1572864
buffer_load_dwordx4 v105,s[4:7],s61 offen lds
s_add_u32 m0,s77,100352
s_add_u32 s61,s60,1572864
buffer_load_dwordx4 v106,s[4:7],s61 offen lds
s_add_u32 m0,s77,101376
s_add_u32 s61,s60,1671168
buffer_load_dwordx4 v104,s[4:7],s61 offen lds
s_add_u32 m0,s77,102400
s_add_u32 s61,s60,1671168
buffer_load_dwordx4 v105,s[4:7],s61 offen lds
s_add_u32 m0,s77,103424
s_add_u32 s61,s60,1671168
buffer_load_dwordx4 v106,s[4:7],s61 offen lds
s_waitcnt vmcnt(24)
s_barrier
s_add_u32 s60,s75,s74
s_add_u32 m0,s77,122880
s_add_u32 s61,s60,1572864
buffer_load_dwordx4 v104,s[52:55],s61 offen lds
s_add_u32 m0,s77,123904
s_add_u32 s61,s60,1572864
buffer_load_dwordx4 v105,s[52:55],s61 offen lds
s_add_u32 m0,s77,124928
s_add_u32 s61,s60,1572864
buffer_load_dwordx4 v106,s[52:55],s61 offen lds
s_add_u32 m0,s77,125952
s_add_u32 s61,s60,1671168
buffer_load_dwordx4 v104,s[52:55],s61 offen lds
s_add_u32 m0,s77,126976
s_add_u32 s61,s60,1671168
buffer_load_dwordx4 v105,s[52:55],s61 offen lds
s_add_u32 m0,s77,128000
s_add_u32 s61,s60,1671168
buffer_load_dwordx4 v106,s[52:55],s61 offen lds
v_add_u32 v12,0,v107
s_cmp_eq_u32 s46,1
s_cbranch_scc1 lw_9
s_cmp_eq_u32 s46,2
s_cbranch_scc1 lw_10
s_cmp_eq_u32 s46,3
s_cbranch_scc1 lw_11
lw_8:
ds_read_b64_tr_b16 a[0:1],v12 offset:0
ds_read_b64_tr_b16 a[2:3],v12 offset:768
ds_read_b64_tr_b16 a[4:5],v12 offset:12288
ds_read_b64_tr_b16 a[6:7],v12 offset:13056
ds_read_b64_tr_b16 a[8:9],v12 offset:32
ds_read_b64_tr_b16 a[10:11],v12 offset:800
ds_read_b64_tr_b16 a[12:13],v12 offset:12320
ds_read_b64_tr_b16 a[14:15],v12 offset:13088
ds_read_b64_tr_b16 a[16:17],v12 offset:64
ds_read_b64_tr_b16 a[18:19],v12 offset:832
ds_read_b64_tr_b16 a[20:21],v12 offset:12352
ds_read_b64_tr_b16 a[22:23],v12 offset:13120
s_branch ld_7
lw_9:
ds_read_b64_tr_b16 a[240:241],v12 offset:0
ds_read_b64_tr_b16 a[242:243],v12 offset:768
ds_read_b64_tr_b16 a[244:245],v12 offset:12288
ds_read_b64_tr_b16 a[246:247],v12 offset:13056
ds_read_b64_tr_b16 a[248:249],v12 offset:32
ds_read_b64_tr_b16 a[250:251],v12 offset:800
ds_read_b64_tr_b16 a[252:253],v12 offset:12320
ds_read_b64_tr_b16 a[254:255],v12 offset:13088
ds_read_b64_tr_b16 v[112:113],v12 offset:64
ds_read_b64_tr_b16 v[114:115],v12 offset:832
ds_read_b64_tr_b16 v[116:117],v12 offset:12352
ds_read_b64_tr_b16 v[118:119],v12 offset:13120
s_branch ld_7
lw_10:
ds_read_b64_tr_b16 a[160:161],v12 offset:0
ds_read_b64_tr_b16 a[162:163],v12 offset:768
ds_read_b64_tr_b16 a[164:165],v12 offset:12288
ds_read_b64_tr_b16 a[166:167],v12 offset:13056
ds_read_b64_tr_b16 a[168:169],v12 offset:32
ds_read_b64_tr_b16 a[170:171],v12 offset:800
ds_read_b64_tr_b16 a[172:173],v12 offset:12320
ds_read_b64_tr_b16 a[174:175],v12 offset:13088
ds_read_b64_tr_b16 a[176:177],v12 offset:64
ds_read_b64_tr_b16 a[178:179],v12 offset:832
ds_read_b64_tr_b16 a[180:181],v12 offset:12352
ds_read_b64_tr_b16 a[182:183],v12 offset:13120
s_branch ld_7
lw_11:
ds_read_b64_tr_b16 a[80:81],v12 offset:0
ds_read_b64_tr_b16 a[82:83],v12 offset:768
ds_read_b64_tr_b16 a[84:85],v12 offset:12288
ds_read_b64_tr_b16 a[86:87],v12 offset:13056
ds_read_b64_tr_b16 a[88:89],v12 offset:32
ds_read_b64_tr_b16 a[90:91],v12 offset:800
ds_read_b64_tr_b16 a[92:93],v12 offset:12320
ds_read_b64_tr_b16 a[94:95],v12 offset:13088
ds_read_b64_tr_b16 a[96:97],v12 offset:64
ds_read_b64_tr_b16 a[98:99],v12 offset:832
ds_read_b64_tr_b16 a[100:101],v12 offset:12352
ds_read_b64_tr_b16 a[102:103],v12 offset:13120
ld_7:
s_waitcnt lgkmcnt(0)
s_waitcnt vmcnt(24)
s_barrier
s_add_u32 s60,s75,s73
s_add_u32 m0,s77,0
s_add_u32 s61,s60,2359296
buffer_load_dwordx4 v104,s[4:7],s61 offen lds
s_add_u32 m0,s77,1024
s_add_u32 s61,s60,2359296
buffer_load_dwordx4 v105,s[4:7],s61 offen lds
s_add_u32 m0,s77,2048
s_add_u32 s61,s60,2359296
buffer_load_dwordx4 v106,s[4:7],s61 offen lds
s_add_u32 m0,s77,3072
s_add_u32 s61,s60,2457600
buffer_load_dwordx4 v104,s[4:7],s61 offen lds
s_add_u32 m0,s77,4096
s_add_u32 s61,s60,2457600
buffer_load_dwordx4 v105,s[4:7],s61 offen lds
s_add_u32 m0,s77,5120
s_add_u32 s61,s60,2457600
buffer_load_dwordx4 v106,s[4:7],s61 offen lds
v_add_u32 v12,24576,v107
s_cmp_eq_u32 s46,1
s_cbranch_scc1 lw_14
s_cmp_eq_u32 s46,2
s_cbranch_scc1 lw_15
s_cmp_eq_u32 s46,3
s_cbranch_scc1 lw_16
lw_13:
ds_read_b64_tr_b16 a[24:25],v12 offset:0
ds_read_b64_tr_b16 a[26:27],v12 offset:768
ds_read_b64_tr_b16 a[28:29],v12 offset:12288
ds_read_b64_tr_b16 a[30:31],v12 offset:13056
ds_read_b64_tr_b16 a[32:33],v12 offset:32
ds_read_b64_tr_b16 a[34:35],v12 offset:800
ds_read_b64_tr_b16 a[36:37],v12 offset:12320
ds_read_b64_tr_b16 a[38:39],v12 offset:13088
ds_read_b64_tr_b16 v[24:25],v12 offset:64
ds_read_b64_tr_b16 v[26:27],v12 offset:832
ds_read_b64_tr_b16 v[28:29],v12 offset:12352
ds_read_b64_tr_b16 v[30:31],v12 offset:13120
s_branch ld_12
lw_14:
ds_read_b64_tr_b16 v[120:121],v12 offset:0
ds_read_b64_tr_b16 v[122:123],v12 offset:768
ds_read_b64_tr_b16 v[124:125],v12 offset:12288
ds_read_b64_tr_b16 v[126:127],v12 offset:13056
ds_read_b64_tr_b16 v[128:129],v12 offset:32
ds_read_b64_tr_b16 v[130:131],v12 offset:800
ds_read_b64_tr_b16 v[132:133],v12 offset:12320
ds_read_b64_tr_b16 v[134:135],v12 offset:13088
ds_read_b64_tr_b16 v[72:73],v12 offset:64
ds_read_b64_tr_b16 v[74:75],v12 offset:832
ds_read_b64_tr_b16 v[76:77],v12 offset:12352
ds_read_b64_tr_b16 v[78:79],v12 offset:13120
s_branch ld_12
lw_15:
ds_read_b64_tr_b16 a[184:185],v12 offset:0
ds_read_b64_tr_b16 a[186:187],v12 offset:768
ds_read_b64_tr_b16 a[188:189],v12 offset:12288
ds_read_b64_tr_b16 a[190:191],v12 offset:13056
ds_read_b64_tr_b16 a[192:193],v12 offset:32
ds_read_b64_tr_b16 a[194:195],v12 offset:800
ds_read_b64_tr_b16 a[196:197],v12 offset:12320
ds_read_b64_tr_b16 a[198:199],v12 offset:13088
ds_read_b64_tr_b16 v[56:57],v12 offset:64
ds_read_b64_tr_b16 v[58:59],v12 offset:832
ds_read_b64_tr_b16 v[60:61],v12 offset:12352
ds_read_b64_tr_b16 v[62:63],v12 offset:13120
s_branch ld_12
lw_16:
ds_read_b64_tr_b16 a[104:105],v12 offset:0
ds_read_b64_tr_b16 a[106:107],v12 offset:768
ds_read_b64_tr_b16 a[108:109],v12 offset:12288
ds_read_b64_tr_b16 a[110:111],v12 offset:13056
ds_read_b64_tr_b16 a[112:113],v12 offset:32
ds_read_b64_tr_b16 a[114:115],v12 offset:800
ds_read_b64_tr_b16 a[116:117],v12 offset:12320
ds_read_b64_tr_b16 a[118:119],v12 offset:13088
ds_read_b64_tr_b16 v[40:41],v12 offset:64
ds_read_b64_tr_b16 v[42:43],v12 offset:832
ds_read_b64_tr_b16 v[44:45],v12 offset:12352
ds_read_b64_tr_b16 v[46:47],v12 offset:13120
ld_12:
s_waitcnt lgkmcnt(0)
s_waitcnt vmcnt(24)
s_barrier
s_add_u32 s60,s75,s74
s_add_u32 m0,s77,24576
s_add_u32 s61,s60,2359296
buffer_load_dwordx4 v104,s[52:55],s61 offen lds
s_add_u32 m0,s77,25600
s_add_u32 s61,s60,2359296
buffer_load_dwordx4 v105,s[52:55],s61 offen lds
s_add_u32 m0,s77,26624
s_add_u32 s61,s60,2359296
buffer_load_dwordx4 v106,s[52:55],s61 offen lds
s_add_u32 m0,s77,27648
s_add_u32 s61,s60,2457600
buffer_load_dwordx4 v104,s[52:55],s61 offen lds
s_add_u32 m0,s77,28672
s_add_u32 s61,s60,2457600
buffer_load_dwordx4 v105,s[52:55],s61 offen lds
s_add_u32 m0,s77,29696
s_add_u32 s61,s60,2457600
buffer_load_dwordx4 v106,s[52:55],s61 offen lds
v_add_u32 v12,49152,v107
s_cmp_eq_u32 s46,1
s_cbranch_scc1 lw_19
s_cmp_eq_u32 s46,2
s_cbranch_scc1 lw_20
s_cmp_eq_u32 s46,3
s_cbranch_scc1 lw_21
lw_18:
ds_read_b64_tr_b16 a[40:41],v12 offset:0
ds_read_b64_tr_b16 a[42:43],v12 offset:768
ds_read_b64_tr_b16 a[44:45],v12 offset:12288
ds_read_b64_tr_b16 a[46:47],v12 offset:13056
ds_read_b64_tr_b16 a[48:49],v12 offset:32
ds_read_b64_tr_b16 a[50:51],v12 offset:800
ds_read_b64_tr_b16 a[52:53],v12 offset:12320
ds_read_b64_tr_b16 a[54:55],v12 offset:13088
ds_read_b64_tr_b16 a[56:57],v12 offset:64
ds_read_b64_tr_b16 a[58:59],v12 offset:832
ds_read_b64_tr_b16 a[60:61],v12 offset:12352
ds_read_b64_tr_b16 a[62:63],v12 offset:13120
s_branch ld_17
lw_19:
ds_read_b64_tr_b16 v[136:137],v12 offset:0
ds_read_b64_tr_b16 v[138:139],v12 offset:768
ds_read_b64_tr_b16 v[140:141],v12 offset:12288
ds_read_b64_tr_b16 v[142:143],v12 offset:13056
ds_read_b64_tr_b16 v[144:145],v12 offset:32
ds_read_b64_tr_b16 v[146:147],v12 offset:800
ds_read_b64_tr_b16 v[148:149],v12 offset:12320
ds_read_b64_tr_b16 v[150:151],v12 offset:13088
ds_read_b64_tr_b16 v[152:153],v12 offset:64
ds_read_b64_tr_b16 v[154:155],v12 offset:832
ds_read_b64_tr_b16 v[156:157],v12 offset:12352
ds_read_b64_tr_b16 v[158:159],v12 offset:13120
s_branch ld_17
lw_20:
ds_read_b64_tr_b16 a[200:201],v12 offset:0
ds_read_b64_tr_b16 a[202:203],v12 offset:768
ds_read_b64_tr_b16 a[204:205],v12 offset:12288
ds_read_b64_tr_b16 a[206:207],v12 offset:13056
ds_read_b64_tr_b16 a[208:209],v12 offset:32
ds_read_b64_tr_b16 a[210:211],v12 offset:800
ds_read_b64_tr_b16 a[212:213],v12 offset:12320
ds_read_b64_tr_b16 a[214:215],v12 offset:13088
ds_read_b64_tr_b16 a[216:217],v12 offset:64
ds_read_b64_tr_b16 a[218:219],v12 offset:832
ds_read_b64_tr_b16 a[220:221],v12 offset:12352
ds_read_b64_tr_b16 a[222:223],v12 offset:13120
s_branch ld_17
lw_21:
ds_read_b64_tr_b16 a[120:121],v12 offset:0
ds_read_b64_tr_b16 a[122:123],v12 offset:768
ds_read_b64_tr_b16 a[124:125],v12 offset:12288
ds_read_b64_tr_b16 a[126:127],v12 offset:13056
ds_read_b64_tr_b16 a[128:129],v12 offset:32
ds_read_b64_tr_b16 a[130:131],v12 offset:800
ds_read_b64_tr_b16 a[132:133],v12 offset:12320
ds_read_b64_tr_b16 a[134:135],v12 offset:13088
ds_read_b64_tr_b16 a[136:137],v12 offset:64
ds_read_b64_tr_b16 a[138:139],v12 offset:832
ds_read_b64_tr_b16 a[140:141],v12 offset:12352
ds_read_b64_tr_b16 a[142:143],v12 offset:13120
ld_17:
s_waitcnt lgkmcnt(0)
s_waitcnt vmcnt(24)
s_barrier
s_add_u32 s60,s75,s73
s_add_u32 m0,s77,49152
s_add_u32 s61,s60,3145728
buffer_load_dwordx4 v104,s[4:7],s61 offen lds
s_add_u32 m0,s77,50176
s_add_u32 s61,s60,3145728
buffer_load_dwordx4 v105,s[4:7],s61 offen lds
s_add_u32 m0,s77,51200
s_add_u32 s61,s60,3145728
buffer_load_dwordx4 v106,s[4:7],s61 offen lds
s_add_u32 m0,s77,52224
s_add_u32 s61,s60,3244032
buffer_load_dwordx4 v104,s[4:7],s61 offen lds
s_add_u32 m0,s77,53248
s_add_u32 s61,s60,3244032
buffer_load_dwordx4 v105,s[4:7],s61 offen lds
s_add_u32 m0,s77,54272
s_add_u32 s61,s60,3244032
buffer_load_dwordx4 v106,s[4:7],s61 offen lds
v_add_u32 v12,73728,v107
s_cmp_eq_u32 s46,1
s_cbranch_scc1 lw_24
s_cmp_eq_u32 s46,2
s_cbranch_scc1 lw_25
s_cmp_eq_u32 s46,3
s_cbranch_scc1 lw_26
lw_23:
ds_read_b64_tr_b16 a[64:65],v12 offset:0
ds_read_b64_tr_b16 a[66:67],v12 offset:768
ds_read_b64_tr_b16 a[68:69],v12 offset:12288
ds_read_b64_tr_b16 a[70:71],v12 offset:13056
ds_read_b64_tr_b16 a[72:73],v12 offset:32
ds_read_b64_tr_b16 a[74:75],v12 offset:800
ds_read_b64_tr_b16 a[76:77],v12 offset:12320
ds_read_b64_tr_b16 a[78:79],v12 offset:13088
ds_read_b64_tr_b16 v[32:33],v12 offset:64
ds_read_b64_tr_b16 v[34:35],v12 offset:832
ds_read_b64_tr_b16 v[36:37],v12 offset:12352
ds_read_b64_tr_b16 v[38:39],v12 offset:13120
s_branch ld_22
lw_24:
ds_read_b64_tr_b16 v[160:161],v12 offset:0
ds_read_b64_tr_b16 v[162:163],v12 offset:768
ds_read_b64_tr_b16 v[164:165],v12 offset:12288
ds_read_b64_tr_b16 v[166:167],v12 offset:13056
ds_read_b64_tr_b16 v[168:169],v12 offset:32
ds_read_b64_tr_b16 v[170:171],v12 offset:800
ds_read_b64_tr_b16 v[172:173],v12 offset:12320
ds_read_b64_tr_b16 v[174:175],v12 offset:13088
ds_read_b64_tr_b16 v[80:81],v12 offset:64
ds_read_b64_tr_b16 v[82:83],v12 offset:832
ds_read_b64_tr_b16 v[84:85],v12 offset:12352
ds_read_b64_tr_b16 v[86:87],v12 offset:13120
s_branch ld_22
lw_25:
ds_read_b64_tr_b16 a[224:225],v12 offset:0
ds_read_b64_tr_b16 a[226:227],v12 offset:768
ds_read_b64_tr_b16 a[228:229],v12 offset:12288
ds_read_b64_tr_b16 a[230:231],v12 offset:13056
ds_read_b64_tr_b16 a[232:233],v12 offset:32
ds_read_b64_tr_b16 a[234:235],v12 offset:800
ds_read_b64_tr_b16 a[236:237],v12 offset:12320
ds_read_b64_tr_b16 a[238:239],v12 offset:13088
ds_read_b64_tr_b16 v[64:65],v12 offset:64
ds_read_b64_tr_b16 v[66:67],v12 offset:832
ds_read_b64_tr_b16 v[68:69],v12 offset:12352
ds_read_b64_tr_b16 v[70:71],v12 offset:13120
s_branch ld_22
lw_26:
ds_read_b64_tr_b16 a[144:145],v12 offset:0
ds_read_b64_tr_b16 a[146:147],v12 offset:768
ds_read_b64_tr_b16 a[148:149],v12 offset:12288
ds_read_b64_tr_b16 a[150:151],v12 offset:13056
ds_read_b64_tr_b16 a[152:153],v12 offset:32
ds_read_b64_tr_b16 a[154:155],v12 offset:800
ds_read_b64_tr_b16 a[156:157],v12 offset:12320
ds_read_b64_tr_b16 a[158:159],v12 offset:13088
ds_read_b64_tr_b16 v[48:49],v12 offset:64
ds_read_b64_tr_b16 v[50:51],v12 offset:832
ds_read_b64_tr_b16 v[52:53],v12 offset:12352
ds_read_b64_tr_b16 v[54:55],v12 offset:13120
ld_22:
s_waitcnt lgkmcnt(0)
s_waitcnt vmcnt(24)
s_barrier
s_add_u32 s60,s75,s74
s_add_u32 m0,s77,73728
s_add_u32 s61,s60,3145728
buffer_load_dwordx4 v104,s[52:55],s61 offen lds
s_add_u32 m0,s77,74752
s_add_u32 s61,s60,3145728
buffer_load_dwordx4 v105,s[52:55],s61 offen lds
s_add_u32 m0,s77,75776
s_add_u32 s61,s60,3145728
buffer_load_dwordx4 v106,s[52:55],s61 offen lds
s_add_u32 m0,s77,76800
s_add_u32 s61,s60,3244032
buffer_load_dwordx4 v104,s[52:55],s61 offen lds
s_add_u32 m0,s77,77824
s_add_u32 s61,s60,3244032
buffer_load_dwordx4 v105,s[52:55],s61 offen lds
s_add_u32 m0,s77,78848
s_add_u32 s61,s60,3244032
buffer_load_dwordx4 v106,s[52:55],s61 offen lds
v_add_u32 v12,98304,v107
s_cmp_eq_u32 s46,1
s_cbranch_scc1 lw_29
s_cmp_eq_u32 s46,2
s_cbranch_scc1 lw_30
s_cmp_eq_u32 s46,3
s_cbranch_scc1 lw_31
lw_28:
ds_read_b64_tr_b16 a[80:81],v12 offset:0
ds_read_b64_tr_b16 a[82:83],v12 offset:768
ds_read_b64_tr_b16 a[84:85],v12 offset:12288
ds_read_b64_tr_b16 a[86:87],v12 offset:13056
ds_read_b64_tr_b16 a[88:89],v12 offset:32
ds_read_b64_tr_b16 a[90:91],v12 offset:800
ds_read_b64_tr_b16 a[92:93],v12 offset:12320
ds_read_b64_tr_b16 a[94:95],v12 offset:13088
ds_read_b64_tr_b16 a[96:97],v12 offset:64
ds_read_b64_tr_b16 a[98:99],v12 offset:832
ds_read_b64_tr_b16 a[100:101],v12 offset:12352
ds_read_b64_tr_b16 a[102:103],v12 offset:13120
s_branch ld_27
lw_29:
ds_read_b64_tr_b16 a[0:1],v12 offset:0
ds_read_b64_tr_b16 a[2:3],v12 offset:768
ds_read_b64_tr_b16 a[4:5],v12 offset:12288
ds_read_b64_tr_b16 a[6:7],v12 offset:13056
ds_read_b64_tr_b16 a[8:9],v12 offset:32
ds_read_b64_tr_b16 a[10:11],v12 offset:800
ds_read_b64_tr_b16 a[12:13],v12 offset:12320
ds_read_b64_tr_b16 a[14:15],v12 offset:13088
ds_read_b64_tr_b16 a[16:17],v12 offset:64
ds_read_b64_tr_b16 a[18:19],v12 offset:832
ds_read_b64_tr_b16 a[20:21],v12 offset:12352
ds_read_b64_tr_b16 a[22:23],v12 offset:13120
s_branch ld_27
lw_30:
ds_read_b64_tr_b16 a[240:241],v12 offset:0
ds_read_b64_tr_b16 a[242:243],v12 offset:768
ds_read_b64_tr_b16 a[244:245],v12 offset:12288
ds_read_b64_tr_b16 a[246:247],v12 offset:13056
ds_read_b64_tr_b16 a[248:249],v12 offset:32
ds_read_b64_tr_b16 a[250:251],v12 offset:800
ds_read_b64_tr_b16 a[252:253],v12 offset:12320
ds_read_b64_tr_b16 a[254:255],v12 offset:13088
ds_read_b64_tr_b16 v[112:113],v12 offset:64
ds_read_b64_tr_b16 v[114:115],v12 offset:832
ds_read_b64_tr_b16 v[116:117],v12 offset:12352
ds_read_b64_tr_b16 v[118:119],v12 offset:13120
s_branch ld_27
lw_31:
ds_read_b64_tr_b16 a[160:161],v12 offset:0
ds_read_b64_tr_b16 a[162:163],v12 offset:768
ds_read_b64_tr_b16 a[164:165],v12 offset:12288
ds_read_b64_tr_b16 a[166:167],v12 offset:13056
ds_read_b64_tr_b16 a[168:169],v12 offset:32
ds_read_b64_tr_b16 a[170:171],v12 offset:800
ds_read_b64_tr_b16 a[172:173],v12 offset:12320
ds_read_b64_tr_b16 a[174:175],v12 offset:13088
ds_read_b64_tr_b16 a[176:177],v12 offset:64
ds_read_b64_tr_b16 a[178:179],v12 offset:832
ds_read_b64_tr_b16 a[180:181],v12 offset:12352
ds_read_b64_tr_b16 a[182:183],v12 offset:13120
ld_27:
s_waitcnt lgkmcnt(0)
s_waitcnt vmcnt(24)
s_barrier
s_add_u32 s60,s75,s73
s_add_u32 m0,s77,98304
s_add_u32 s61,s60,3932160
buffer_load_dwordx4 v104,s[4:7],s61 offen lds
s_add_u32 m0,s77,99328
s_add_u32 s61,s60,3932160
buffer_load_dwordx4 v105,s[4:7],s61 offen lds
s_add_u32 m0,s77,100352
s_add_u32 s61,s60,3932160
buffer_load_dwordx4 v106,s[4:7],s61 offen lds
s_add_u32 m0,s77,101376
s_add_u32 s61,s60,4030464
buffer_load_dwordx4 v104,s[4:7],s61 offen lds
s_add_u32 m0,s77,102400
s_add_u32 s61,s60,4030464
buffer_load_dwordx4 v105,s[4:7],s61 offen lds
s_add_u32 m0,s77,103424
s_add_u32 s61,s60,4030464
buffer_load_dwordx4 v106,s[4:7],s61 offen lds
v_add_u32 v12,122880,v107
s_cmp_eq_u32 s46,1
s_cbranch_scc1 lw_34
s_cmp_eq_u32 s46,2
s_cbranch_scc1 lw_35
s_cmp_eq_u32 s46,3
s_cbranch_scc1 lw_36
lw_33:
ds_read_b64_tr_b16 a[104:105],v12 offset:0
ds_read_b64_tr_b16 a[106:107],v12 offset:768
ds_read_b64_tr_b16 a[108:109],v12 offset:12288
ds_read_b64_tr_b16 a[110:111],v12 offset:13056
ds_read_b64_tr_b16 a[112:113],v12 offset:32
ds_read_b64_tr_b16 a[114:115],v12 offset:800
ds_read_b64_tr_b16 a[116:117],v12 offset:12320
ds_read_b64_tr_b16 a[118:119],v12 offset:13088
ds_read_b64_tr_b16 v[40:41],v12 offset:64
ds_read_b64_tr_b16 v[42:43],v12 offset:832
ds_read_b64_tr_b16 v[44:45],v12 offset:12352
ds_read_b64_tr_b16 v[46:47],v12 offset:13120
s_branch ld_32
lw_34:
ds_read_b64_tr_b16 a[24:25],v12 offset:0
ds_read_b64_tr_b16 a[26:27],v12 offset:768
ds_read_b64_tr_b16 a[28:29],v12 offset:12288
ds_read_b64_tr_b16 a[30:31],v12 offset:13056
ds_read_b64_tr_b16 a[32:33],v12 offset:32
ds_read_b64_tr_b16 a[34:35],v12 offset:800
ds_read_b64_tr_b16 a[36:37],v12 offset:12320
ds_read_b64_tr_b16 a[38:39],v12 offset:13088
ds_read_b64_tr_b16 v[24:25],v12 offset:64
ds_read_b64_tr_b16 v[26:27],v12 offset:832
ds_read_b64_tr_b16 v[28:29],v12 offset:12352
ds_read_b64_tr_b16 v[30:31],v12 offset:13120
s_branch ld_32
lw_35:
ds_read_b64_tr_b16 v[120:121],v12 offset:0
ds_read_b64_tr_b16 v[122:123],v12 offset:768
ds_read_b64_tr_b16 v[124:125],v12 offset:12288
ds_read_b64_tr_b16 v[126:127],v12 offset:13056
ds_read_b64_tr_b16 v[128:129],v12 offset:32
ds_read_b64_tr_b16 v[130:131],v12 offset:800
ds_read_b64_tr_b16 v[132:133],v12 offset:12320
ds_read_b64_tr_b16 v[134:135],v12 offset:13088
ds_read_b64_tr_b16 v[72:73],v12 offset:64
ds_read_b64_tr_b16 v[74:75],v12 offset:832
ds_read_b64_tr_b16 v[76:77],v12 offset:12352
ds_read_b64_tr_b16 v[78:79],v12 offset:13120
s_branch ld_32
lw_36:
ds_read_b64_tr_b16 a[184:185],v12 offset:0
ds_read_b64_tr_b16 a[186:187],v12 offset:768
ds_read_b64_tr_b16 a[188:189],v12 offset:12288
ds_read_b64_tr_b16 a[190:191],v12 offset:13056
ds_read_b64_tr_b16 a[192:193],v12 offset:32
ds_read_b64_tr_b16 a[194:195],v12 offset:800
ds_read_b64_tr_b16 a[196:197],v12 offset:12320
ds_read_b64_tr_b16 a[198:199],v12 offset:13088
ds_read_b64_tr_b16 v[56:57],v12 offset:64
ds_read_b64_tr_b16 v[58:59],v12 offset:832
ds_read_b64_tr_b16 v[60:61],v12 offset:12352
ds_read_b64_tr_b16 v[62:63],v12 offset:13120
ld_32:
s_waitcnt lgkmcnt(0)
s_waitcnt vmcnt(24)
s_barrier
s_add_u32 s60,s75,s74
s_add_u32 m0,s77,122880
s_add_u32 s61,s60,3932160
buffer_load_dwordx4 v104,s[52:55],s61 offen lds
s_add_u32 m0,s77,123904
s_add_u32 s61,s60,3932160
buffer_load_dwordx4 v105,s[52:55],s61 offen lds
s_add_u32 m0,s77,124928
s_add_u32 s61,s60,3932160
buffer_load_dwordx4 v106,s[52:55],s61 offen lds
s_add_u32 m0,s77,125952
s_add_u32 s61,s60,4030464
buffer_load_dwordx4 v104,s[52:55],s61 offen lds
s_add_u32 m0,s77,126976
s_add_u32 s61,s60,4030464
buffer_load_dwordx4 v105,s[52:55],s61 offen lds
s_add_u32 m0,s77,128000
s_add_u32 s61,s60,4030464
buffer_load_dwordx4 v106,s[52:55],s61 offen lds
v_add_u32 v12,0,v107
s_cmp_eq_u32 s46,1
s_cbranch_scc1 lw_39
s_cmp_eq_u32 s46,2
s_cbranch_scc1 lw_40
s_cmp_eq_u32 s46,3
s_cbranch_scc1 lw_41
lw_38:
ds_read_b64_tr_b16 a[120:121],v12 offset:0
ds_read_b64_tr_b16 a[122:123],v12 offset:768
ds_read_b64_tr_b16 a[124:125],v12 offset:12288
ds_read_b64_tr_b16 a[126:127],v12 offset:13056
ds_read_b64_tr_b16 a[128:129],v12 offset:32
ds_read_b64_tr_b16 a[130:131],v12 offset:800
ds_read_b64_tr_b16 a[132:133],v12 offset:12320
ds_read_b64_tr_b16 a[134:135],v12 offset:13088
ds_read_b64_tr_b16 a[136:137],v12 offset:64
ds_read_b64_tr_b16 a[138:139],v12 offset:832
ds_read_b64_tr_b16 a[140:141],v12 offset:12352
ds_read_b64_tr_b16 a[142:143],v12 offset:13120
s_branch ld_37
lw_39:
ds_read_b64_tr_b16 a[40:41],v12 offset:0
ds_read_b64_tr_b16 a[42:43],v12 offset:768
ds_read_b64_tr_b16 a[44:45],v12 offset:12288
ds_read_b64_tr_b16 a[46:47],v12 offset:13056
ds_read_b64_tr_b16 a[48:49],v12 offset:32
ds_read_b64_tr_b16 a[50:51],v12 offset:800
ds_read_b64_tr_b16 a[52:53],v12 offset:12320
ds_read_b64_tr_b16 a[54:55],v12 offset:13088
ds_read_b64_tr_b16 a[56:57],v12 offset:64
ds_read_b64_tr_b16 a[58:59],v12 offset:832
ds_read_b64_tr_b16 a[60:61],v12 offset:12352
ds_read_b64_tr_b16 a[62:63],v12 offset:13120
s_branch ld_37
lw_40:
ds_read_b64_tr_b16 v[136:137],v12 offset:0
ds_read_b64_tr_b16 v[138:139],v12 offset:768
ds_read_b64_tr_b16 v[140:141],v12 offset:12288
ds_read_b64_tr_b16 v[142:143],v12 offset:13056
ds_read_b64_tr_b16 v[144:145],v12 offset:32
ds_read_b64_tr_b16 v[146:147],v12 offset:800
ds_read_b64_tr_b16 v[148:149],v12 offset:12320
ds_read_b64_tr_b16 v[150:151],v12 offset:13088
ds_read_b64_tr_b16 v[152:153],v12 offset:64
ds_read_b64_tr_b16 v[154:155],v12 offset:832
ds_read_b64_tr_b16 v[156:157],v12 offset:12352
ds_read_b64_tr_b16 v[158:159],v12 offset:13120
s_branch ld_37
lw_41:
ds_read_b64_tr_b16 a[200:201],v12 offset:0
ds_read_b64_tr_b16 a[202:203],v12 offset:768
ds_read_b64_tr_b16 a[204:205],v12 offset:12288
ds_read_b64_tr_b16 a[206:207],v12 offset:13056
ds_read_b64_tr_b16 a[208:209],v12 offset:32
ds_read_b64_tr_b16 a[210:211],v12 offset:800
ds_read_b64_tr_b16 a[212:213],v12 offset:12320
ds_read_b64_tr_b16 a[214:215],v12 offset:13088
ds_read_b64_tr_b16 a[216:217],v12 offset:64
ds_read_b64_tr_b16 a[218:219],v12 offset:832
ds_read_b64_tr_b16 a[220:221],v12 offset:12352
ds_read_b64_tr_b16 a[222:223],v12 offset:13120
ld_37:
s_waitcnt lgkmcnt(0)
s_waitcnt vmcnt(24)
s_barrier
s_add_u32 s60,s75,s73
s_add_u32 m0,s77,0
s_add_u32 s61,s60,4718592
buffer_load_dwordx4 v104,s[4:7],s61 offen lds
s_add_u32 m0,s77,1024
s_add_u32 s61,s60,4718592
buffer_load_dwordx4 v105,s[4:7],s61 offen lds
s_add_u32 m0,s77,2048
s_add_u32 s61,s60,4718592
buffer_load_dwordx4 v106,s[4:7],s61 offen lds
s_add_u32 m0,s77,3072
s_add_u32 s61,s60,4816896
buffer_load_dwordx4 v104,s[4:7],s61 offen lds
s_add_u32 m0,s77,4096
s_add_u32 s61,s60,4816896
buffer_load_dwordx4 v105,s[4:7],s61 offen lds
s_add_u32 m0,s77,5120
s_add_u32 s61,s60,4816896
buffer_load_dwordx4 v106,s[4:7],s61 offen lds
v_add_u32 v12,24576,v107
s_cmp_eq_u32 s46,1
s_cbranch_scc1 lw_44
s_cmp_eq_u32 s46,2
s_cbranch_scc1 lw_45
s_cmp_eq_u32 s46,3
s_cbranch_scc1 lw_46
lw_43:
ds_read_b64_tr_b16 a[144:145],v12 offset:0
ds_read_b64_tr_b16 a[146:147],v12 offset:768
ds_read_b64_tr_b16 a[148:149],v12 offset:12288
ds_read_b64_tr_b16 a[150:151],v12 offset:13056
ds_read_b64_tr_b16 a[152:153],v12 offset:32
ds_read_b64_tr_b16 a[154:155],v12 offset:800
ds_read_b64_tr_b16 a[156:157],v12 offset:12320
ds_read_b64_tr_b16 a[158:159],v12 offset:13088
ds_read_b64_tr_b16 v[48:49],v12 offset:64
ds_read_b64_tr_b16 v[50:51],v12 offset:832
ds_read_b64_tr_b16 v[52:53],v12 offset:12352
ds_read_b64_tr_b16 v[54:55],v12 offset:13120
s_branch ld_42
lw_44:
ds_read_b64_tr_b16 a[64:65],v12 offset:0
ds_read_b64_tr_b16 a[66:67],v12 offset:768
ds_read_b64_tr_b16 a[68:69],v12 offset:12288
ds_read_b64_tr_b16 a[70:71],v12 offset:13056
ds_read_b64_tr_b16 a[72:73],v12 offset:32
ds_read_b64_tr_b16 a[74:75],v12 offset:800
ds_read_b64_tr_b16 a[76:77],v12 offset:12320
ds_read_b64_tr_b16 a[78:79],v12 offset:13088
ds_read_b64_tr_b16 v[32:33],v12 offset:64
ds_read_b64_tr_b16 v[34:35],v12 offset:832
ds_read_b64_tr_b16 v[36:37],v12 offset:12352
ds_read_b64_tr_b16 v[38:39],v12 offset:13120
s_branch ld_42
lw_45:
ds_read_b64_tr_b16 v[160:161],v12 offset:0
ds_read_b64_tr_b16 v[162:163],v12 offset:768
ds_read_b64_tr_b16 v[164:165],v12 offset:12288
ds_read_b64_tr_b16 v[166:167],v12 offset:13056
ds_read_b64_tr_b16 v[168:169],v12 offset:32
ds_read_b64_tr_b16 v[170:171],v12 offset:800
ds_read_b64_tr_b16 v[172:173],v12 offset:12320
ds_read_b64_tr_b16 v[174:175],v12 offset:13088
ds_read_b64_tr_b16 v[80:81],v12 offset:64
ds_read_b64_tr_b16 v[82:83],v12 offset:832
ds_read_b64_tr_b16 v[84:85],v12 offset:12352
ds_read_b64_tr_b16 v[86:87],v12 offset:13120
s_branch ld_42
lw_46:
ds_read_b64_tr_b16 a[224:225],v12 offset:0
ds_read_b64_tr_b16 a[226:227],v12 offset:768
ds_read_b64_tr_b16 a[228:229],v12 offset:12288
ds_read_b64_tr_b16 a[230:231],v12 offset:13056
ds_read_b64_tr_b16 a[232:233],v12 offset:32
ds_read_b64_tr_b16 a[234:235],v12 offset:800
ds_read_b64_tr_b16 a[236:237],v12 offset:12320
ds_read_b64_tr_b16 a[238:239],v12 offset:13088
ds_read_b64_tr_b16 v[64:65],v12 offset:64
ds_read_b64_tr_b16 v[66:67],v12 offset:832
ds_read_b64_tr_b16 v[68:69],v12 offset:12352
ds_read_b64_tr_b16 v[70:71],v12 offset:13120
ld_42:
s_waitcnt lgkmcnt(0)
s_waitcnt vmcnt(24)
s_barrier
s_add_u32 s60,s75,s74
s_add_u32 m0,s77,24576
s_add_u32 s61,s60,4718592
buffer_load_dwordx4 v104,s[52:55],s61 offen lds
s_add_u32 m0,s77,25600
s_add_u32 s61,s60,4718592
buffer_load_dwordx4 v105,s[52:55],s61 offen lds
s_add_u32 m0,s77,26624
s_add_u32 s61,s60,4718592
buffer_load_dwordx4 v106,s[52:55],s61 offen lds
s_add_u32 m0,s77,27648
s_add_u32 s61,s60,4816896
buffer_load_dwordx4 v104,s[52:55],s61 offen lds
s_add_u32 m0,s77,28672
s_add_u32 s61,s60,4816896
buffer_load_dwordx4 v105,s[52:55],s61 offen lds
s_add_u32 m0,s77,29696
s_add_u32 s61,s60,4816896
buffer_load_dwordx4 v106,s[52:55],s61 offen lds
v_add_u32 v12,49152,v107
s_cmp_eq_u32 s46,1
s_cbranch_scc1 lw_49
s_cmp_eq_u32 s46,2
s_cbranch_scc1 lw_50
s_cmp_eq_u32 s46,3
s_cbranch_scc1 lw_51
lw_48:
ds_read_b64_tr_b16 a[160:161],v12 offset:0
ds_read_b64_tr_b16 a[162:163],v12 offset:768
ds_read_b64_tr_b16 a[164:165],v12 offset:12288
ds_read_b64_tr_b16 a[166:167],v12 offset:13056
ds_read_b64_tr_b16 a[168:169],v12 offset:32
ds_read_b64_tr_b16 a[170:171],v12 offset:800
ds_read_b64_tr_b16 a[172:173],v12 offset:12320
ds_read_b64_tr_b16 a[174:175],v12 offset:13088
ds_read_b64_tr_b16 a[176:177],v12 offset:64
ds_read_b64_tr_b16 a[178:179],v12 offset:832
ds_read_b64_tr_b16 a[180:181],v12 offset:12352
ds_read_b64_tr_b16 a[182:183],v12 offset:13120
s_branch ld_47
lw_49:
ds_read_b64_tr_b16 a[80:81],v12 offset:0
ds_read_b64_tr_b16 a[82:83],v12 offset:768
ds_read_b64_tr_b16 a[84:85],v12 offset:12288
ds_read_b64_tr_b16 a[86:87],v12 offset:13056
ds_read_b64_tr_b16 a[88:89],v12 offset:32
ds_read_b64_tr_b16 a[90:91],v12 offset:800
ds_read_b64_tr_b16 a[92:93],v12 offset:12320
ds_read_b64_tr_b16 a[94:95],v12 offset:13088
ds_read_b64_tr_b16 a[96:97],v12 offset:64
ds_read_b64_tr_b16 a[98:99],v12 offset:832
ds_read_b64_tr_b16 a[100:101],v12 offset:12352
ds_read_b64_tr_b16 a[102:103],v12 offset:13120
s_branch ld_47
lw_50:
ds_read_b64_tr_b16 a[0:1],v12 offset:0
ds_read_b64_tr_b16 a[2:3],v12 offset:768
ds_read_b64_tr_b16 a[4:5],v12 offset:12288
ds_read_b64_tr_b16 a[6:7],v12 offset:13056
ds_read_b64_tr_b16 a[8:9],v12 offset:32
ds_read_b64_tr_b16 a[10:11],v12 offset:800
ds_read_b64_tr_b16 a[12:13],v12 offset:12320
ds_read_b64_tr_b16 a[14:15],v12 offset:13088
ds_read_b64_tr_b16 a[16:17],v12 offset:64
ds_read_b64_tr_b16 a[18:19],v12 offset:832
ds_read_b64_tr_b16 a[20:21],v12 offset:12352
ds_read_b64_tr_b16 a[22:23],v12 offset:13120
s_branch ld_47
lw_51:
ds_read_b64_tr_b16 a[240:241],v12 offset:0
ds_read_b64_tr_b16 a[242:243],v12 offset:768
ds_read_b64_tr_b16 a[244:245],v12 offset:12288
ds_read_b64_tr_b16 a[246:247],v12 offset:13056
ds_read_b64_tr_b16 a[248:249],v12 offset:32
ds_read_b64_tr_b16 a[250:251],v12 offset:800
ds_read_b64_tr_b16 a[252:253],v12 offset:12320
ds_read_b64_tr_b16 a[254:255],v12 offset:13088
ds_read_b64_tr_b16 v[112:113],v12 offset:64
ds_read_b64_tr_b16 v[114:115],v12 offset:832
ds_read_b64_tr_b16 v[116:117],v12 offset:12352
ds_read_b64_tr_b16 v[118:119],v12 offset:13120
ld_47:
s_waitcnt lgkmcnt(0)
s_waitcnt vmcnt(24)
s_barrier
s_add_u32 s60,s75,s73
s_add_u32 m0,s77,49152
s_add_u32 s61,s60,5505024
buffer_load_dwordx4 v104,s[4:7],s61 offen lds
s_add_u32 m0,s77,50176
s_add_u32 s61,s60,5505024
buffer_load_dwordx4 v105,s[4:7],s61 offen lds
s_add_u32 m0,s77,51200
s_add_u32 s61,s60,5505024
buffer_load_dwordx4 v106,s[4:7],s61 offen lds
s_add_u32 m0,s77,52224
s_add_u32 s61,s60,5603328
buffer_load_dwordx4 v104,s[4:7],s61 offen lds
s_add_u32 m0,s77,53248
s_add_u32 s61,s60,5603328
buffer_load_dwordx4 v105,s[4:7],s61 offen lds
s_add_u32 m0,s77,54272
s_add_u32 s61,s60,5603328
buffer_load_dwordx4 v106,s[4:7],s61 offen lds
v_add_u32 v12,73728,v107
s_cmp_eq_u32 s46,1
s_cbranch_scc1 lw_54
s_cmp_eq_u32 s46,2
s_cbranch_scc1 lw_55
s_cmp_eq_u32 s46,3
s_cbranch_scc1 lw_56
lw_53:
ds_read_b64_tr_b16 a[184:185],v12 offset:0
ds_read_b64_tr_b16 a[186:187],v12 offset:768
ds_read_b64_tr_b16 a[188:189],v12 offset:12288
ds_read_b64_tr_b16 a[190:191],v12 offset:13056
ds_read_b64_tr_b16 a[192:193],v12 offset:32
ds_read_b64_tr_b16 a[194:195],v12 offset:800
ds_read_b64_tr_b16 a[196:197],v12 offset:12320
ds_read_b64_tr_b16 a[198:199],v12 offset:13088
ds_read_b64_tr_b16 v[56:57],v12 offset:64
ds_read_b64_tr_b16 v[58:59],v12 offset:832
ds_read_b64_tr_b16 v[60:61],v12 offset:12352
ds_read_b64_tr_b16 v[62:63],v12 offset:13120
s_branch ld_52
lw_54:
ds_read_b64_tr_b16 a[104:105],v12 offset:0
ds_read_b64_tr_b16 a[106:107],v12 offset:768
ds_read_b64_tr_b16 a[108:109],v12 offset:12288
ds_read_b64_tr_b16 a[110:111],v12 offset:13056
ds_read_b64_tr_b16 a[112:113],v12 offset:32
ds_read_b64_tr_b16 a[114:115],v12 offset:800
ds_read_b64_tr_b16 a[116:117],v12 offset:12320
ds_read_b64_tr_b16 a[118:119],v12 offset:13088
ds_read_b64_tr_b16 v[40:41],v12 offset:64
ds_read_b64_tr_b16 v[42:43],v12 offset:832
ds_read_b64_tr_b16 v[44:45],v12 offset:12352
ds_read_b64_tr_b16 v[46:47],v12 offset:13120
s_branch ld_52
lw_55:
ds_read_b64_tr_b16 a[24:25],v12 offset:0
ds_read_b64_tr_b16 a[26:27],v12 offset:768
ds_read_b64_tr_b16 a[28:29],v12 offset:12288
ds_read_b64_tr_b16 a[30:31],v12 offset:13056
ds_read_b64_tr_b16 a[32:33],v12 offset:32
ds_read_b64_tr_b16 a[34:35],v12 offset:800
ds_read_b64_tr_b16 a[36:37],v12 offset:12320
ds_read_b64_tr_b16 a[38:39],v12 offset:13088
ds_read_b64_tr_b16 v[24:25],v12 offset:64
ds_read_b64_tr_b16 v[26:27],v12 offset:832
ds_read_b64_tr_b16 v[28:29],v12 offset:12352
ds_read_b64_tr_b16 v[30:31],v12 offset:13120
s_branch ld_52
lw_56:
ds_read_b64_tr_b16 v[120:121],v12 offset:0
ds_read_b64_tr_b16 v[122:123],v12 offset:768
ds_read_b64_tr_b16 v[124:125],v12 offset:12288
ds_read_b64_tr_b16 v[126:127],v12 offset:13056
ds_read_b64_tr_b16 v[128:129],v12 offset:32
ds_read_b64_tr_b16 v[130:131],v12 offset:800
ds_read_b64_tr_b16 v[132:133],v12 offset:12320
ds_read_b64_tr_b16 v[134:135],v12 offset:13088
ds_read_b64_tr_b16 v[72:73],v12 offset:64
ds_read_b64_tr_b16 v[74:75],v12 offset:832
ds_read_b64_tr_b16 v[76:77],v12 offset:12352
ds_read_b64_tr_b16 v[78:79],v12 offset:13120
ld_52:
s_waitcnt lgkmcnt(0)
s_waitcnt vmcnt(24)
s_barrier
s_add_u32 s60,s75,s74
s_add_u32 m0,s77,73728
s_add_u32 s61,s60,5505024
buffer_load_dwordx4 v104,s[52:55],s61 offen lds
s_add_u32 m0,s77,74752
s_add_u32 s61,s60,5505024
buffer_load_dwordx4 v105,s[52:55],s61 offen lds
s_add_u32 m0,s77,75776
s_add_u32 s61,s60,5505024
buffer_load_dwordx4 v106,s[52:55],s61 offen lds
s_add_u32 m0,s77,76800
s_add_u32 s61,s60,5603328
buffer_load_dwordx4 v104,s[52:55],s61 offen lds
s_add_u32 m0,s77,77824
s_add_u32 s61,s60,5603328
buffer_load_dwordx4 v105,s[52:55],s61 offen lds
s_add_u32 m0,s77,78848
s_add_u32 s61,s60,5603328
buffer_load_dwordx4 v106,s[52:55],s61 offen lds
v_add_u32 v12,98304,v107
s_cmp_eq_u32 s46,1
s_cbranch_scc1 lw_59
s_cmp_eq_u32 s46,2
s_cbranch_scc1 lw_60
s_cmp_eq_u32 s46,3
s_cbranch_scc1 lw_61
lw_58:
ds_read_b64_tr_b16 a[200:201],v12 offset:0
ds_read_b64_tr_b16 a[202:203],v12 offset:768
ds_read_b64_tr_b16 a[204:205],v12 offset:12288
ds_read_b64_tr_b16 a[206:207],v12 offset:13056
ds_read_b64_tr_b16 a[208:209],v12 offset:32
ds_read_b64_tr_b16 a[210:211],v12 offset:800
ds_read_b64_tr_b16 a[212:213],v12 offset:12320
ds_read_b64_tr_b16 a[214:215],v12 offset:13088
ds_read_b64_tr_b16 a[216:217],v12 offset:64
ds_read_b64_tr_b16 a[218:219],v12 offset:832
ds_read_b64_tr_b16 a[220:221],v12 offset:12352
ds_read_b64_tr_b16 a[222:223],v12 offset:13120
s_branch ld_57
lw_59:
ds_read_b64_tr_b16 a[120:121],v12 offset:0
ds_read_b64_tr_b16 a[122:123],v12 offset:768
ds_read_b64_tr_b16 a[124:125],v12 offset:12288
ds_read_b64_tr_b16 a[126:127],v12 offset:13056
ds_read_b64_tr_b16 a[128:129],v12 offset:32
ds_read_b64_tr_b16 a[130:131],v12 offset:800
ds_read_b64_tr_b16 a[132:133],v12 offset:12320
ds_read_b64_tr_b16 a[134:135],v12 offset:13088
ds_read_b64_tr_b16 a[136:137],v12 offset:64
ds_read_b64_tr_b16 a[138:139],v12 offset:832
ds_read_b64_tr_b16 a[140:141],v12 offset:12352
ds_read_b64_tr_b16 a[142:143],v12 offset:13120
s_branch ld_57
lw_60:
ds_read_b64_tr_b16 a[40:41],v12 offset:0
ds_read_b64_tr_b16 a[42:43],v12 offset:768
ds_read_b64_tr_b16 a[44:45],v12 offset:12288
ds_read_b64_tr_b16 a[46:47],v12 offset:13056
ds_read_b64_tr_b16 a[48:49],v12 offset:32
ds_read_b64_tr_b16 a[50:51],v12 offset:800
ds_read_b64_tr_b16 a[52:53],v12 offset:12320
ds_read_b64_tr_b16 a[54:55],v12 offset:13088
ds_read_b64_tr_b16 a[56:57],v12 offset:64
ds_read_b64_tr_b16 a[58:59],v12 offset:832
ds_read_b64_tr_b16 a[60:61],v12 offset:12352
ds_read_b64_tr_b16 a[62:63],v12 offset:13120
s_branch ld_57
lw_61:
ds_read_b64_tr_b16 v[136:137],v12 offset:0
ds_read_b64_tr_b16 v[138:139],v12 offset:768
ds_read_b64_tr_b16 v[140:141],v12 offset:12288
ds_read_b64_tr_b16 v[142:143],v12 offset:13056
ds_read_b64_tr_b16 v[144:145],v12 offset:32
ds_read_b64_tr_b16 v[146:147],v12 offset:800
ds_read_b64_tr_b16 v[148:149],v12 offset:12320
ds_read_b64_tr_b16 v[150:151],v12 offset:13088
ds_read_b64_tr_b16 v[152:153],v12 offset:64
ds_read_b64_tr_b16 v[154:155],v12 offset:832
ds_read_b64_tr_b16 v[156:157],v12 offset:12352
ds_read_b64_tr_b16 v[158:159],v12 offset:13120
ld_57:
s_waitcnt lgkmcnt(0)
s_waitcnt vmcnt(24)
s_barrier
s_add_u32 s60,s76,s73
s_add_u32 m0,s77,98304
s_add_u32 s61,s60,6291456
buffer_load_dwordx4 v104,s[4:7],s61 offen lds
s_add_u32 m0,s77,99328
s_add_u32 s61,s60,6291456
buffer_load_dwordx4 v105,s[4:7],s61 offen lds
s_add_u32 m0,s77,100352
s_add_u32 s61,s60,6291456
buffer_load_dwordx4 v106,s[4:7],s61 offen lds
s_add_u32 m0,s77,101376
s_add_u32 s61,s60,6389760
buffer_load_dwordx4 v104,s[4:7],s61 offen lds
s_add_u32 m0,s77,102400
s_add_u32 s61,s60,6389760
buffer_load_dwordx4 v105,s[4:7],s61 offen lds
s_add_u32 m0,s77,103424
s_add_u32 s61,s60,6389760
buffer_load_dwordx4 v106,s[4:7],s61 offen lds
v_add_u32 v12,122880,v107
s_cmp_eq_u32 s46,1
s_cbranch_scc1 lw_64
s_cmp_eq_u32 s46,2
s_cbranch_scc1 lw_65
s_cmp_eq_u32 s46,3
s_cbranch_scc1 lw_66
lw_63:
ds_read_b64_tr_b16 a[224:225],v12 offset:0
ds_read_b64_tr_b16 a[226:227],v12 offset:768
ds_read_b64_tr_b16 a[228:229],v12 offset:12288
ds_read_b64_tr_b16 a[230:231],v12 offset:13056
ds_read_b64_tr_b16 a[232:233],v12 offset:32
ds_read_b64_tr_b16 a[234:235],v12 offset:800
ds_read_b64_tr_b16 a[236:237],v12 offset:12320
ds_read_b64_tr_b16 a[238:239],v12 offset:13088
ds_read_b64_tr_b16 v[64:65],v12 offset:64
ds_read_b64_tr_b16 v[66:67],v12 offset:832
ds_read_b64_tr_b16 v[68:69],v12 offset:12352
ds_read_b64_tr_b16 v[70:71],v12 offset:13120
s_branch ld_62
lw_64:
ds_read_b64_tr_b16 a[144:145],v12 offset:0
ds_read_b64_tr_b16 a[146:147],v12 offset:768
ds_read_b64_tr_b16 a[148:149],v12 offset:12288
ds_read_b64_tr_b16 a[150:151],v12 offset:13056
ds_read_b64_tr_b16 a[152:153],v12 offset:32
ds_read_b64_tr_b16 a[154:155],v12 offset:800
ds_read_b64_tr_b16 a[156:157],v12 offset:12320
ds_read_b64_tr_b16 a[158:159],v12 offset:13088
ds_read_b64_tr_b16 v[48:49],v12 offset:64
ds_read_b64_tr_b16 v[50:51],v12 offset:832
ds_read_b64_tr_b16 v[52:53],v12 offset:12352
ds_read_b64_tr_b16 v[54:55],v12 offset:13120
s_branch ld_62
lw_65:
ds_read_b64_tr_b16 a[64:65],v12 offset:0
ds_read_b64_tr_b16 a[66:67],v12 offset:768
ds_read_b64_tr_b16 a[68:69],v12 offset:12288
ds_read_b64_tr_b16 a[70:71],v12 offset:13056
ds_read_b64_tr_b16 a[72:73],v12 offset:32
ds_read_b64_tr_b16 a[74:75],v12 offset:800
ds_read_b64_tr_b16 a[76:77],v12 offset:12320
ds_read_b64_tr_b16 a[78:79],v12 offset:13088
ds_read_b64_tr_b16 v[32:33],v12 offset:64
ds_read_b64_tr_b16 v[34:35],v12 offset:832
ds_read_b64_tr_b16 v[36:37],v12 offset:12352
ds_read_b64_tr_b16 v[38:39],v12 offset:13120
s_branch ld_62
lw_66:
ds_read_b64_tr_b16 v[160:161],v12 offset:0
ds_read_b64_tr_b16 v[162:163],v12 offset:768
ds_read_b64_tr_b16 v[164:165],v12 offset:12288
ds_read_b64_tr_b16 v[166:167],v12 offset:13056
ds_read_b64_tr_b16 v[168:169],v12 offset:32
ds_read_b64_tr_b16 v[170:171],v12 offset:800
ds_read_b64_tr_b16 v[172:173],v12 offset:12320
ds_read_b64_tr_b16 v[174:175],v12 offset:13088
ds_read_b64_tr_b16 v[80:81],v12 offset:64
ds_read_b64_tr_b16 v[82:83],v12 offset:832
ds_read_b64_tr_b16 v[84:85],v12 offset:12352
ds_read_b64_tr_b16 v[86:87],v12 offset:13120
ld_62:
s_waitcnt lgkmcnt(0)
s_waitcnt vmcnt(24)
s_barrier
s_add_u32 s60,s76,s74
s_add_u32 m0,s77,122880
s_add_u32 s61,s60,6291456
buffer_load_dwordx4 v104,s[52:55],s61 offen lds
s_add_u32 m0,s77,123904
s_add_u32 s61,s60,6291456
buffer_load_dwordx4 v105,s[52:55],s61 offen lds
s_add_u32 m0,s77,124928
s_add_u32 s61,s60,6291456
buffer_load_dwordx4 v106,s[52:55],s61 offen lds
s_add_u32 m0,s77,125952
s_add_u32 s61,s60,6389760
buffer_load_dwordx4 v104,s[52:55],s61 offen lds
s_add_u32 m0,s77,126976
s_add_u32 s61,s60,6389760
buffer_load_dwordx4 v105,s[52:55],s61 offen lds
s_add_u32 m0,s77,128000
s_add_u32 s61,s60,6389760
buffer_load_dwordx4 v106,s[52:55],s61 offen lds
v_add_u32 v12,0,v107
s_cmp_eq_u32 s46,1
s_cbranch_scc1 lw_69
s_cmp_eq_u32 s46,2
s_cbranch_scc1 lw_70
s_cmp_eq_u32 s46,3
s_cbranch_scc1 lw_71
lw_68:
ds_read_b64_tr_b16 a[240:241],v12 offset:0
ds_read_b64_tr_b16 a[242:243],v12 offset:768
ds_read_b64_tr_b16 a[244:245],v12 offset:12288
ds_read_b64_tr_b16 a[246:247],v12 offset:13056
ds_read_b64_tr_b16 a[248:249],v12 offset:32
ds_read_b64_tr_b16 a[250:251],v12 offset:800
ds_read_b64_tr_b16 a[252:253],v12 offset:12320
ds_read_b64_tr_b16 a[254:255],v12 offset:13088
ds_read_b64_tr_b16 v[112:113],v12 offset:64
ds_read_b64_tr_b16 v[114:115],v12 offset:832
ds_read_b64_tr_b16 v[116:117],v12 offset:12352
ds_read_b64_tr_b16 v[118:119],v12 offset:13120
s_branch ld_67
lw_69:
ds_read_b64_tr_b16 a[160:161],v12 offset:0
ds_read_b64_tr_b16 a[162:163],v12 offset:768
ds_read_b64_tr_b16 a[164:165],v12 offset:12288
ds_read_b64_tr_b16 a[166:167],v12 offset:13056
ds_read_b64_tr_b16 a[168:169],v12 offset:32
ds_read_b64_tr_b16 a[170:171],v12 offset:800
ds_read_b64_tr_b16 a[172:173],v12 offset:12320
ds_read_b64_tr_b16 a[174:175],v12 offset:13088
ds_read_b64_tr_b16 a[176:177],v12 offset:64
ds_read_b64_tr_b16 a[178:179],v12 offset:832
ds_read_b64_tr_b16 a[180:181],v12 offset:12352
ds_read_b64_tr_b16 a[182:183],v12 offset:13120
s_branch ld_67
lw_70:
ds_read_b64_tr_b16 a[80:81],v12 offset:0
ds_read_b64_tr_b16 a[82:83],v12 offset:768
ds_read_b64_tr_b16 a[84:85],v12 offset:12288
ds_read_b64_tr_b16 a[86:87],v12 offset:13056
ds_read_b64_tr_b16 a[88:89],v12 offset:32
ds_read_b64_tr_b16 a[90:91],v12 offset:800
ds_read_b64_tr_b16 a[92:93],v12 offset:12320
ds_read_b64_tr_b16 a[94:95],v12 offset:13088
ds_read_b64_tr_b16 a[96:97],v12 offset:64
ds_read_b64_tr_b16 a[98:99],v12 offset:832
ds_read_b64_tr_b16 a[100:101],v12 offset:12352
ds_read_b64_tr_b16 a[102:103],v12 offset:13120
s_branch ld_67
lw_71:
ds_read_b64_tr_b16 a[0:1],v12 offset:0
ds_read_b64_tr_b16 a[2:3],v12 offset:768
ds_read_b64_tr_b16 a[4:5],v12 offset:12288
ds_read_b64_tr_b16 a[6:7],v12 offset:13056
ds_read_b64_tr_b16 a[8:9],v12 offset:32
ds_read_b64_tr_b16 a[10:11],v12 offset:800
ds_read_b64_tr_b16 a[12:13],v12 offset:12320
ds_read_b64_tr_b16 a[14:15],v12 offset:13088
ds_read_b64_tr_b16 a[16:17],v12 offset:64
ds_read_b64_tr_b16 a[18:19],v12 offset:832
ds_read_b64_tr_b16 a[20:21],v12 offset:12352
ds_read_b64_tr_b16 a[22:23],v12 offset:13120
ld_67:
s_waitcnt lgkmcnt(0)
s_waitcnt vmcnt(24)
s_barrier
s_add_u32 s60,s76,s73
s_add_u32 m0,s77,0
s_add_u32 s61,s60,7077888
buffer_load_dwordx4 v104,s[4:7],s61 offen lds
s_add_u32 m0,s77,1024
s_add_u32 s61,s60,7077888
buffer_load_dwordx4 v105,s[4:7],s61 offen lds
s_add_u32 m0,s77,2048
s_add_u32 s61,s60,7077888
buffer_load_dwordx4 v106,s[4:7],s61 offen lds
s_add_u32 m0,s77,3072
s_add_u32 s61,s60,7176192
buffer_load_dwordx4 v104,s[4:7],s61 offen lds
s_add_u32 m0,s77,4096
s_add_u32 s61,s60,7176192
buffer_load_dwordx4 v105,s[4:7],s61 offen lds
s_add_u32 m0,s77,5120
s_add_u32 s61,s60,7176192
buffer_load_dwordx4 v106,s[4:7],s61 offen lds
v_add_u32 v12,24576,v107
s_cmp_eq_u32 s46,1
s_cbranch_scc1 lw_74
s_cmp_eq_u32 s46,2
s_cbranch_scc1 lw_75
s_cmp_eq_u32 s46,3
s_cbranch_scc1 lw_76
lw_73:
ds_read_b64_tr_b16 v[120:121],v12 offset:0
ds_read_b64_tr_b16 v[122:123],v12 offset:768
ds_read_b64_tr_b16 v[124:125],v12 offset:12288
ds_read_b64_tr_b16 v[126:127],v12 offset:13056
ds_read_b64_tr_b16 v[128:129],v12 offset:32
ds_read_b64_tr_b16 v[130:131],v12 offset:800
ds_read_b64_tr_b16 v[132:133],v12 offset:12320
ds_read_b64_tr_b16 v[134:135],v12 offset:13088
ds_read_b64_tr_b16 v[72:73],v12 offset:64
ds_read_b64_tr_b16 v[74:75],v12 offset:832
ds_read_b64_tr_b16 v[76:77],v12 offset:12352
ds_read_b64_tr_b16 v[78:79],v12 offset:13120
s_branch ld_72
lw_74:
ds_read_b64_tr_b16 a[184:185],v12 offset:0
ds_read_b64_tr_b16 a[186:187],v12 offset:768
ds_read_b64_tr_b16 a[188:189],v12 offset:12288
ds_read_b64_tr_b16 a[190:191],v12 offset:13056
ds_read_b64_tr_b16 a[192:193],v12 offset:32
ds_read_b64_tr_b16 a[194:195],v12 offset:800
ds_read_b64_tr_b16 a[196:197],v12 offset:12320
ds_read_b64_tr_b16 a[198:199],v12 offset:13088
ds_read_b64_tr_b16 v[56:57],v12 offset:64
ds_read_b64_tr_b16 v[58:59],v12 offset:832
ds_read_b64_tr_b16 v[60:61],v12 offset:12352
ds_read_b64_tr_b16 v[62:63],v12 offset:13120
s_branch ld_72
lw_75:
ds_read_b64_tr_b16 a[104:105],v12 offset:0
ds_read_b64_tr_b16 a[106:107],v12 offset:768
ds_read_b64_tr_b16 a[108:109],v12 offset:12288
ds_read_b64_tr_b16 a[110:111],v12 offset:13056
ds_read_b64_tr_b16 a[112:113],v12 offset:32
ds_read_b64_tr_b16 a[114:115],v12 offset:800
ds_read_b64_tr_b16 a[116:117],v12 offset:12320
ds_read_b64_tr_b16 a[118:119],v12 offset:13088
ds_read_b64_tr_b16 v[40:41],v12 offset:64
ds_read_b64_tr_b16 v[42:43],v12 offset:832
ds_read_b64_tr_b16 v[44:45],v12 offset:12352
ds_read_b64_tr_b16 v[46:47],v12 offset:13120
s_branch ld_72
lw_76:
ds_read_b64_tr_b16 a[24:25],v12 offset:0
ds_read_b64_tr_b16 a[26:27],v12 offset:768
ds_read_b64_tr_b16 a[28:29],v12 offset:12288
ds_read_b64_tr_b16 a[30:31],v12 offset:13056
ds_read_b64_tr_b16 a[32:33],v12 offset:32
ds_read_b64_tr_b16 a[34:35],v12 offset:800
ds_read_b64_tr_b16 a[36:37],v12 offset:12320
ds_read_b64_tr_b16 a[38:39],v12 offset:13088
ds_read_b64_tr_b16 v[24:25],v12 offset:64
ds_read_b64_tr_b16 v[26:27],v12 offset:832
ds_read_b64_tr_b16 v[28:29],v12 offset:12352
ds_read_b64_tr_b16 v[30:31],v12 offset:13120
ld_72:
s_waitcnt lgkmcnt(0)
s_waitcnt vmcnt(24)
s_barrier
s_add_u32 s60,s76,s74
s_add_u32 m0,s77,24576
s_add_u32 s61,s60,7077888
buffer_load_dwordx4 v104,s[52:55],s61 offen lds
s_add_u32 m0,s77,25600
s_add_u32 s61,s60,7077888
buffer_load_dwordx4 v105,s[52:55],s61 offen lds
s_add_u32 m0,s77,26624
s_add_u32 s61,s60,7077888
buffer_load_dwordx4 v106,s[52:55],s61 offen lds
s_add_u32 m0,s77,27648
s_add_u32 s61,s60,7176192
buffer_load_dwordx4 v104,s[52:55],s61 offen lds
s_add_u32 m0,s77,28672
s_add_u32 s61,s60,7176192
buffer_load_dwordx4 v105,s[52:55],s61 offen lds
s_add_u32 m0,s77,29696
s_add_u32 s61,s60,7176192
buffer_load_dwordx4 v106,s[52:55],s61 offen lds
v_add_u32 v12,49152,v107
s_cmp_eq_u32 s46,1
s_cbranch_scc1 lw_79
s_cmp_eq_u32 s46,2
s_cbranch_scc1 lw_80
s_cmp_eq_u32 s46,3
s_cbranch_scc1 lw_81
lw_78:
ds_read_b64_tr_b16 v[136:137],v12 offset:0
ds_read_b64_tr_b16 v[138:139],v12 offset:768
ds_read_b64_tr_b16 v[140:141],v12 offset:12288
ds_read_b64_tr_b16 v[142:143],v12 offset:13056
ds_read_b64_tr_b16 v[144:145],v12 offset:32
ds_read_b64_tr_b16 v[146:147],v12 offset:800
ds_read_b64_tr_b16 v[148:149],v12 offset:12320
ds_read_b64_tr_b16 v[150:151],v12 offset:13088
ds_read_b64_tr_b16 v[152:153],v12 offset:64
ds_read_b64_tr_b16 v[154:155],v12 offset:832
ds_read_b64_tr_b16 v[156:157],v12 offset:12352
ds_read_b64_tr_b16 v[158:159],v12 offset:13120
s_branch ld_77
lw_79:
ds_read_b64_tr_b16 a[200:201],v12 offset:0
ds_read_b64_tr_b16 a[202:203],v12 offset:768
ds_read_b64_tr_b16 a[204:205],v12 offset:12288
ds_read_b64_tr_b16 a[206:207],v12 offset:13056
ds_read_b64_tr_b16 a[208:209],v12 offset:32
ds_read_b64_tr_b16 a[210:211],v12 offset:800
ds_read_b64_tr_b16 a[212:213],v12 offset:12320
ds_read_b64_tr_b16 a[214:215],v12 offset:13088
ds_read_b64_tr_b16 a[216:217],v12 offset:64
ds_read_b64_tr_b16 a[218:219],v12 offset:832
ds_read_b64_tr_b16 a[220:221],v12 offset:12352
ds_read_b64_tr_b16 a[222:223],v12 offset:13120
s_branch ld_77
lw_80:
ds_read_b64_tr_b16 a[120:121],v12 offset:0
ds_read_b64_tr_b16 a[122:123],v12 offset:768
ds_read_b64_tr_b16 a[124:125],v12 offset:12288
ds_read_b64_tr_b16 a[126:127],v12 offset:13056
ds_read_b64_tr_b16 a[128:129],v12 offset:32
ds_read_b64_tr_b16 a[130:131],v12 offset:800
ds_read_b64_tr_b16 a[132:133],v12 offset:12320
ds_read_b64_tr_b16 a[134:135],v12 offset:13088
ds_read_b64_tr_b16 a[136:137],v12 offset:64
ds_read_b64_tr_b16 a[138:139],v12 offset:832
ds_read_b64_tr_b16 a[140:141],v12 offset:12352
ds_read_b64_tr_b16 a[142:143],v12 offset:13120
s_branch ld_77
lw_81:
ds_read_b64_tr_b16 a[40:41],v12 offset:0
ds_read_b64_tr_b16 a[42:43],v12 offset:768
ds_read_b64_tr_b16 a[44:45],v12 offset:12288
ds_read_b64_tr_b16 a[46:47],v12 offset:13056
ds_read_b64_tr_b16 a[48:49],v12 offset:32
ds_read_b64_tr_b16 a[50:51],v12 offset:800
ds_read_b64_tr_b16 a[52:53],v12 offset:12320
ds_read_b64_tr_b16 a[54:55],v12 offset:13088
ds_read_b64_tr_b16 a[56:57],v12 offset:64
ds_read_b64_tr_b16 a[58:59],v12 offset:832
ds_read_b64_tr_b16 a[60:61],v12 offset:12352
ds_read_b64_tr_b16 a[62:63],v12 offset:13120
ld_77:
s_waitcnt lgkmcnt(0)
s_waitcnt vmcnt(24)
s_barrier
v_add_u32 v12,73728,v107
s_cmp_eq_u32 s46,1
s_cbranch_scc1 lw_84
s_cmp_eq_u32 s46,2
s_cbranch_scc1 lw_85
s_cmp_eq_u32 s46,3
s_cbranch_scc1 lw_86
lw_83:
ds_read_b64_tr_b16 v[160:161],v12 offset:0
ds_read_b64_tr_b16 v[162:163],v12 offset:768
ds_read_b64_tr_b16 v[164:165],v12 offset:12288
ds_read_b64_tr_b16 v[166:167],v12 offset:13056
ds_read_b64_tr_b16 v[168:169],v12 offset:32
ds_read_b64_tr_b16 v[170:171],v12 offset:800
ds_read_b64_tr_b16 v[172:173],v12 offset:12320
ds_read_b64_tr_b16 v[174:175],v12 offset:13088
ds_read_b64_tr_b16 v[80:81],v12 offset:64
ds_read_b64_tr_b16 v[82:83],v12 offset:832
ds_read_b64_tr_b16 v[84:85],v12 offset:12352
ds_read_b64_tr_b16 v[86:87],v12 offset:13120
s_branch ld_82
lw_84:
ds_read_b64_tr_b16 a[224:225],v12 offset:0
ds_read_b64_tr_b16 a[226:227],v12 offset:768
ds_read_b64_tr_b16 a[228:229],v12 offset:12288
ds_read_b64_tr_b16 a[230:231],v12 offset:13056
ds_read_b64_tr_b16 a[232:233],v12 offset:32
ds_read_b64_tr_b16 a[234:235],v12 offset:800
ds_read_b64_tr_b16 a[236:237],v12 offset:12320
ds_read_b64_tr_b16 a[238:239],v12 offset:13088
ds_read_b64_tr_b16 v[64:65],v12 offset:64
ds_read_b64_tr_b16 v[66:67],v12 offset:832
ds_read_b64_tr_b16 v[68:69],v12 offset:12352
ds_read_b64_tr_b16 v[70:71],v12 offset:13120
s_branch ld_82
lw_85:
ds_read_b64_tr_b16 a[144:145],v12 offset:0
ds_read_b64_tr_b16 a[146:147],v12 offset:768
ds_read_b64_tr_b16 a[148:149],v12 offset:12288
ds_read_b64_tr_b16 a[150:151],v12 offset:13056
ds_read_b64_tr_b16 a[152:153],v12 offset:32
ds_read_b64_tr_b16 a[154:155],v12 offset:800
ds_read_b64_tr_b16 a[156:157],v12 offset:12320
ds_read_b64_tr_b16 a[158:159],v12 offset:13088
ds_read_b64_tr_b16 v[48:49],v12 offset:64
ds_read_b64_tr_b16 v[50:51],v12 offset:832
ds_read_b64_tr_b16 v[52:53],v12 offset:12352
ds_read_b64_tr_b16 v[54:55],v12 offset:13120
s_branch ld_82
lw_86:
ds_read_b64_tr_b16 a[64:65],v12 offset:0
ds_read_b64_tr_b16 a[66:67],v12 offset:768
ds_read_b64_tr_b16 a[68:69],v12 offset:12288
ds_read_b64_tr_b16 a[70:71],v12 offset:13056
ds_read_b64_tr_b16 a[72:73],v12 offset:32
ds_read_b64_tr_b16 a[74:75],v12 offset:800
ds_read_b64_tr_b16 a[76:77],v12 offset:12320
ds_read_b64_tr_b16 a[78:79],v12 offset:13088
ds_read_b64_tr_b16 v[32:33],v12 offset:64
ds_read_b64_tr_b16 v[34:35],v12 offset:832
ds_read_b64_tr_b16 v[36:37],v12 offset:12352
ds_read_b64_tr_b16 v[38:39],v12 offset:13120
ld_82:
s_waitcnt lgkmcnt(0)
s_waitcnt vmcnt(18)
s_barrier
v_add_u32 v12,98304,v107
ds_read_b64_tr_b16 v[176:177],v12 offset:0
ds_read_b64_tr_b16 v[178:179],v12 offset:768
ds_read_b64_tr_b16 v[180:181],v12 offset:12288
ds_read_b64_tr_b16 v[182:183],v12 offset:13056
ds_read_b64_tr_b16 v[184:185],v12 offset:32
ds_read_b64_tr_b16 v[186:187],v12 offset:800
ds_read_b64_tr_b16 v[188:189],v12 offset:12320
ds_read_b64_tr_b16 v[190:191],v12 offset:13088
ds_read_b64_tr_b16 v[192:193],v12 offset:64
ds_read_b64_tr_b16 v[194:195],v12 offset:832
ds_read_b64_tr_b16 v[196:197],v12 offset:12352
ds_read_b64_tr_b16 v[198:199],v12 offset:13120
s_waitcnt lgkmcnt(0)
s_waitcnt vmcnt(12)
s_barrier
v_add_u32 v12,122880,v107
ds_read_b64_tr_b16 v[200:201],v12 offset:0
ds_read_b64_tr_b16 v[202:203],v12 offset:768
ds_read_b64_tr_b16 v[204:205],v12 offset:12288
ds_read_b64_tr_b16 v[206:207],v12 offset:13056
ds_read_b64_tr_b16 v[208:209],v12 offset:32
ds_read_b64_tr_b16 v[210:211],v12 offset:800
ds_read_b64_tr_b16 v[212:213],v12 offset:12320
ds_read_b64_tr_b16 v[214:215],v12 offset:13088
ds_read_b64_tr_b16 v[88:89],v12 offset:64
ds_read_b64_tr_b16 v[90:91],v12 offset:832
ds_read_b64_tr_b16 v[92:93],v12 offset:12352
ds_read_b64_tr_b16 v[94:95],v12 offset:13120
s_waitcnt lgkmcnt(0)
s_waitcnt vmcnt(6)
s_barrier
v_add_u32 v12,0,v107
ds_read_b64_tr_b16 v[216:217],v12 offset:0
ds_read_b64_tr_b16 v[218:219],v12 offset:768
ds_read_b64_tr_b16 v[220:221],v12 offset:12288
ds_read_b64_tr_b16 v[222:223],v12 offset:13056
ds_read_b64_tr_b16 v[224:225],v12 offset:32
ds_read_b64_tr_b16 v[226:227],v12 offset:800
ds_read_b64_tr_b16 v[228:229],v12 offset:12320
ds_read_b64_tr_b16 v[230:231],v12 offset:13088
ds_read_b64_tr_b16 v[232:233],v12 offset:64
ds_read_b64_tr_b16 v[234:235],v12 offset:832
ds_read_b64_tr_b16 v[236:237],v12 offset:12352
ds_read_b64_tr_b16 v[238:239],v12 offset:13120
s_waitcnt lgkmcnt(0)
s_waitcnt vmcnt(0)
s_barrier
v_add_u32 v12,24576,v107
ds_read_b64_tr_b16 v[240:241],v12 offset:0
ds_read_b64_tr_b16 v[242:243],v12 offset:768
ds_read_b64_tr_b16 v[244:245],v12 offset:12288
ds_read_b64_tr_b16 v[246:247],v12 offset:13056
ds_read_b64_tr_b16 v[248:249],v12 offset:32
ds_read_b64_tr_b16 v[250:251],v12 offset:800
ds_read_b64_tr_b16 v[252:253],v12 offset:12320
ds_read_b64_tr_b16 v[254:255],v12 offset:13088
ds_read_b64_tr_b16 v[96:97],v12 offset:64
ds_read_b64_tr_b16 v[98:99],v12 offset:832
ds_read_b64_tr_b16 v[100:101],v12 offset:12352
ds_read_b64_tr_b16 v[102:103],v12 offset:13120
s_waitcnt lgkmcnt(0)
s_barrier
ds_write_b128 v21,v[24:27] offset:0
ds_write_b128 v21,v[28:31] offset:1024
ds_write_b128 v21,v[32:35] offset:2048
ds_write_b128 v21,v[36:39] offset:3072
ds_write_b128 v21,v[40:43] offset:4096
ds_write_b128 v21,v[44:47] offset:5120
ds_write_b128 v21,v[48:51] offset:6144
ds_write_b128 v21,v[52:55] offset:7168
ds_write_b128 v21,v[56:59] offset:8192
ds_write_b128 v21,v[60:63] offset:9216
ds_write_b128 v21,v[64:67] offset:10240
ds_write_b128 v21,v[68:71] offset:11264
ds_write_b128 v21,v[72:75] offset:12288
ds_write_b128 v21,v[76:79] offset:13312
ds_write_b128 v21,v[80:83] offset:14336
ds_write_b128 v21,v[84:87] offset:15360
ds_write_b128 v21,v[88:91] offset:16384
ds_write_b128 v21,v[92:95] offset:17408
ds_write_b128 v21,v[96:99] offset:18432
ds_write_b128 v21,v[100:103] offset:19456
s_waitcnt lgkmcnt(0)
v_add_u32 v59,139264,v1
s_barrier
s_lshl_b32 s3,s49,2
v_mov_b32 v13,s3
s_nop 1
ibw_87:
buffer_load_dword v12,v13,s[12:15],0 offen sc1
s_waitcnt vmcnt(0)
v_cmp_ne_u32 vcc,256,v12
s_nop 0
s_cbranch_vccz ok_88
s_sleep 8
s_sub_u32 s47,s47,1
s_cbranch_scc1 ABORT
s_branch ibw_87
ok_88:
s_cmp_lg_u32 s49,0
s_cbranch_scc1 ibok_89
v_and_b32 v13,7,v0
v_lshlrev_b32 v13,2,v13
buffer_load_dword v12,v13,s[12:15],0 offen offset:32 sc1
s_waitcnt vmcnt(0)
v_cmp_ne_u32 vcc,32,v12
s_nop 0
s_cbranch_vccz ibok_89
s_barrier
s_mov_b32 s49,1
s_mov_b32 s3,s2
s_load_dwordx16 s[16:31],s[0:1],0
s_load_dwordx8 s[32:39],s[0:1],64
s_waitcnt lgkmcnt(0)
s_branch DISPATCH
ibok_89:
v_mov_b32 v13,192
s_cmp_lg_u32 s49,0
s_cbranch_scc1 vx_91
vw_90:
buffer_load_dword v12,v13,s[12:15],0 offen sc1
s_waitcnt vmcnt(0)
v_and_b32 v14,0xffff,v12
v_cmp_ne_u32 vcc,64,v14
s_nop 0
s_cbranch_vccz ok_92
s_sleep 4
s_sub_u32 s47,s47,1
s_cbranch_scc1 ABORT
s_branch vw_90
ok_92:
v_readfirstlane_b32 s60,v12
s_cmp_gt_u32 s60,2162688
s_cselect_b32 s60,0x2000,0
s_add_u32 s83,s83,s60
s_nop 1
vx_91:
s_mul_i32 s6,s46,2048
v_sub_u32 v18,v23,v22
v_add_u32 v18,v18,v1
v_add_u32 v18,8192,v18
s_mov_b32 s37,0x3f80
s_mov_b32 s81,0x3f800000
s_add_u32 s6,s6,s82
s_mov_b32 s7,0
s_add_u32 s7,s7,s82
s_add_u32 s7,s7,950272
s_mov_b32 s50,0
s_mov_b32 s4,0
s_mov_b32 s5,0
s_mov_b32 s78,2147483648
s_mov_b32 s79,2147483648
s_mov_b32 s30,2147483648
s_sub_u32 s60,s4,s5
s_cmp_gt_i32 s60,13
s_cselect_b32 s51,1,0
s_cmp_eq_u32 s4,64
s_cselect_b32 s51,1,s51
s_cmp_eq_u32 s51,0
s_cselect_b32 s52,s4,s5
s_addc_u32 s4,s4,0
s_add_u32 s5,s5,s51
s_and_b32 s60,s52,1
s_lshl2_add_u32 s60,s51,s60
s_lshl_b32 s68,s60,16
s_add_u32 s68,s68,s83
s_mul_i32 s59,s60,20480
s_add_u32 s59,s59,s6
s_lshl_b32 s69,s51,9
s_add_u32 s69,s69,s7
s_bfe_u32 s57,s52,65537
s_add_u32 s58,s52,1
s_cmp_lg_u32 s36,0
s_cbranch_scc1 CV_START
s_cmp_eq_u32 s46,3
s_cbranch_scc1 CH_START
s_lshl_b32 s60,s46,2
s_add_u32 s60,s60,147456
v_mov_b32 v20,s60
v_mov_b32 v12,0
ds_write_b32 v20,v12
v_add_u32 v58,106496,v1
v_mov_b32 v9,147468
s_lshl_b32 s85,s46,12
s_add_u32 s84,s84,s85
s_add_u32 s74,s85,81920
s_add_u32 s75,s74,s74
s_add_u32 s75,s75,24576
s_mul_i32 s60,s29,3
s_add_u32 s60,s60,s46
v_lshlrev_b32 v13,7,v0
s_add_u32 s61,s60,0
s_min_u32 s61,s61,115
s_lshl_b32 s61,s61,13
s_add_u32 s61,s61,s82
buffer_load_dword v14,v13,s[8:11],s61 offen sc1
s_add_u32 s61,s60,48
s_min_u32 s61,s61,115
s_lshl_b32 s61,s61,13
s_add_u32 s61,s61,s82
buffer_load_dword v14,v13,s[8:11],s61 offen sc1
s_add_u32 s61,s60,96
s_min_u32 s61,s61,115
s_lshl_b32 s61,s61,13
s_add_u32 s61,s61,s82
buffer_load_dword v14,v13,s[8:11],s61 offen sc1
s_waitcnt vmcnt(0)
s_mov_b64 vcc,-1
s_waitcnt lgkmcnt(0)
v_mov_b32 v10,0
v_mov_b32 v11,0
v_mov_b32 v24,0
v_mov_b32 v25,0
v_mov_b32 v26,0
v_mov_b32 v27,0
v_mov_b32 v28,0
v_mov_b32 v29,0
v_mov_b32 v30,0
v_mov_b32 v31,0
v_mov_b32 v32,0
v_mov_b32 v33,0
v_mov_b32 v34,0
v_mov_b32 v35,0
v_mov_b32 v36,0
v_mov_b32 v37,0
v_mov_b32 v38,0
v_mov_b32 v39,0
v_mov_b32 v40,0
v_mov_b32 v41,0
v_mov_b32 v42,0
v_mov_b32 v43,0
v_mov_b32 v44,0
v_mov_b32 v45,0
v_mov_b32 v46,0
v_mov_b32 v47,0
s_cmp_lg_u32 s49,0
s_cbranch_scc1 CS_LOOP_S
CS_LOOP_F:
s_barrier
buffer_load_dwordx2 v[80:81],v18,s[8:11],s59 offen sc1
buffer_load_dwordx4 v[72:75],v1,s[8:11],s59 offen sc1
buffer_load_dwordx4 v[76:79],v1,s[8:11],s59 offen offset:1024 sc1
s_cbranch_vccz fj_95f
s_waitcnt vmcnt(2)
s_sleep 3
fj_95f:
buffer_load_dwordx2 v[90:91],v18,s[8:11],s68 offen sc1
buffer_load_dwordx4 v[82:85],v1,s[8:11],s68 offen sc1
buffer_load_dwordx4 v[86:89],v1,s[8:11],s68 offen offset:1024 sc1
v_mfma_f32_32x32x8_bf16 v[24:39],v[10:11],v[10:11],0
v_mfma_f32_16x16x16_bf16 v[40:43],v[10:11],v[10:11],0
v_mfma_f32_16x16x16_bf16 v[44:47],v[10:11],v[10:11],0
fj_95:
fa_93:
s_waitcnt vmcnt(5)
v_lshlrev_b32 v108,16,v80
v_and_b32 v109,0xffff0000,v80
v_lshlrev_b32 v110,16,v81
v_and_b32 v111,0xffff0000,v81
s_waitcnt vmcnt(4)
v_lshlrev_b32 v92,16,v72
v_and_b32 v93,0xffff0000,v72
v_lshlrev_b32 v94,16,v73
v_and_b32 v95,0xffff0000,v73
v_lshlrev_b32 v96,16,v74
v_and_b32 v97,0xffff0000,v74
v_lshlrev_b32 v98,16,v75
v_and_b32 v99,0xffff0000,v75
s_waitcnt vmcnt(3)
v_lshlrev_b32 v100,16,v76
v_and_b32 v101,0xffff0000,v76
v_lshlrev_b32 v102,16,v77
v_and_b32 v103,0xffff0000,v77
v_lshlrev_b32 v104,16,v78
v_and_b32 v105,0xffff0000,v78
v_lshlrev_b32 v106,16,v79
v_and_b32 v107,0xffff0000,v79
s_waitcnt vmcnt(2)
v_dot2c_f32_bf16 v108,s37,v90
v_dot2c_f32_bf16 v109,s81,v90
v_dot2c_f32_bf16 v110,s37,v91
v_dot2c_f32_bf16 v111,s81,v91
v_bitop3_b32 v16,v80,v90,s57 bitop3:0x7e
v_cvt_pk_bf16_f32 v56,v108,v109
s_nop 0
v_cvt_pk_bf16_f32 v57,v110,v111
ds_write_b64 v23,v[56:57]
s_waitcnt vmcnt(1)
v_dot2c_f32_bf16 v92,s37,v82
v_dot2c_f32_bf16 v93,s81,v82
v_dot2c_f32_bf16 v94,s37,v83
v_dot2c_f32_bf16 v95,s81,v83
v_dot2c_f32_bf16 v96,s37,v84
v_dot2c_f32_bf16 v97,s81,v84
v_dot2c_f32_bf16 v98,s37,v85
v_dot2c_f32_bf16 v99,s81,v85
v_bitop3_b32 v17,v72,v82,s57 bitop3:0x7e
v_or_b32 v16,v16,v17
v_cvt_pk_bf16_f32 v48,v92,v93
v_cvt_pk_bf16_f32 v49,v94,v95
v_cvt_pk_bf16_f32 v50,v96,v97
v_cvt_pk_bf16_f32 v51,v98,v99
ds_write_b128 v22,v[48:51] offset:0
s_waitcnt vmcnt(0)
v_dot2c_f32_bf16 v100,s37,v86
v_dot2c_f32_bf16 v101,s81,v86
v_dot2c_f32_bf16 v102,s37,v87
v_dot2c_f32_bf16 v103,s81,v87
v_dot2c_f32_bf16 v104,s37,v88
v_dot2c_f32_bf16 v105,s81,v88
v_dot2c_f32_bf16 v106,s37,v89
v_dot2c_f32_bf16 v107,s81,v89
v_bitop3_b32 v17,v76,v86,s57 bitop3:0x7e
v_bitop3_b32 v16,v16,v17,1 bitop3:0xa8
v_cmp_ne_u32 vcc,0,v16
v_cvt_pk_bf16_f32 v52,v100,v101
v_cvt_pk_bf16_f32 v53,v102,v103
v_cvt_pk_bf16_f32 v54,v104,v105
v_cvt_pk_bf16_f32 v55,v106,v107
ds_write_b128 v22,v[52:55] offset:1024
s_cbranch_vccnz fr_94
fj_95g:
v_smfmac_f32_16x16x64_bf16 v[24:27],v[48:51],a[0:7],v2
ds_read_b128 v[72:75],v21 offset:0
v_xor_b32 v58,57344,v58
v_smfmac_f32_16x16x64_bf16 v[28:31],v[48:51],a[8:15],v2
ds_read_b128 v[76:79],v21 offset:1024
s_sub_u32 s60,s4,s5
v_smfmac_f32_16x16x64_bf16 v[32:35],v[48:51],a[16:23],v2
ds_read_b128 v[80:83],v21 offset:2048
s_cmp_gt_i32 s60,13
v_smfmac_f32_16x16x64_bf16 v[36:39],v[48:51],a[24:31],v2
ds_read_b128 v[84:87],v21 offset:3072
s_cselect_b32 s53,1,0
s_waitcnt lgkmcnt(4)
s_barrier
v_smfmac_f32_16x16x64_bf16 v[40:43],v[48:51],a[32:39],v2
ds_read_b128 v[60:63],v3 offset:0
s_cmp_eq_u32 s4,64
v_smfmac_f32_16x16x64_bf16 v[24:27],v[52:55],a[40:47],v2
ds_read_b128 v[64:67],v3 offset:1024
s_cselect_b32 s53,1,s53
v_smfmac_f32_16x16x64_bf16 v[28:31],v[52:55],a[48:55],v2
ds_read_b128 v[68:71],v4 offset:0
s_cmp_eq_u32 s53,0
v_smfmac_f32_16x16x64_bf16 v[32:35],v[52:55],a[56:63],v2
s_cselect_b32 s54,s4,s5
s_addc_u32 s4,s4,0
s_add_u32 s5,s5,s53
v_smfmac_f32_16x16x64_bf16 v[36:39],v[52:55],a[64:71],v2
s_mul_i32 s73,s54,393216
s_add_u32 s73,s73,s84
s_sub_u32 s74,s75,s74
v_smfmac_f32_16x16x64_bf16 v[40:43],v[52:55],a[72:79],v2
s_mov_b32 m0,s74
s_and_b32 s60,s52,1
s_waitcnt lgkmcnt(5)
v_smfmac_f32_16x16x64_bf16 v[44:47],v[48:51],v[72:79],v2
ds_read_b128 v[72:75],v21 offset:4096
s_waitcnt lgkmcnt(4)
v_smfmac_f32_16x16x64_bf16 v[44:47],v[52:55],v[80:87],v2
ds_read_b128 v[76:79],v21 offset:5120
s_waitcnt lgkmcnt(4)
v_smfmac_f32_16x16x64_bf16 v[24:27],v[60:63],a[80:87],v2
ds_read_b128 v[80:83],v21 offset:6144
s_lshl2_add_u32 s60,s51,s60
v_smfmac_f32_16x16x64_bf16 v[28:31],v[60:63],a[88:95],v2
ds_read_b128 v[84:87],v21 offset:7168
s_mul_i32 s60,s60,49152
v_smfmac_f32_16x16x64_bf16 v[32:35],v[60:63],a[96:103],v2
s_add_u32 s71,s60,s34
s_add_u32 s70,s60,s33
s_lshl_b32 s60,s51,9
v_smfmac_f32_16x16x64_bf16 v[36:39],v[60:63],a[104:111],v2
s_add_u32 s72,s60,s35
buffer_load_dwordx4 v1,s[8:11],s73 offen sc1 lds
v_smfmac_f32_16x16x64_bf16 v[40:43],v[60:63],a[112:119],v2
buffer_load_dwordx4 v1,s[8:11],s73 offen offset:1024 sc1 lds
s_waitcnt lgkmcnt(2)
v_smfmac_f32_16x16x64_bf16 v[44:47],v[60:63],v[72:79],v2
ds_read_b128 v[60:63],v4 offset:1024
v_smfmac_f32_16x16x64_bf16 v[24:27],v[64:67],a[120:127],v2
ds_read_b128 v[72:75],v21 offset:8192
v_smfmac_f32_16x16x64_bf16 v[28:31],v[64:67],a[128:135],v2
ds_read_b128 v[76:79],v21 offset:9216
v_smfmac_f32_16x16x64_bf16 v[32:35],v[64:67],a[136:143],v2
buffer_load_dwordx4 v1,s[8:11],s73 offen offset:2048 sc1 lds
v_smfmac_f32_16x16x64_bf16 v[36:39],v[64:67],a[144:151],v2
buffer_load_dwordx4 v1,s[8:11],s73 offen offset:3072 sc1 lds
v_add_u32 v17,s85,v58
v_smfmac_f32_16x16x64_bf16 v[40:43],v[64:67],a[152:159],v2
v_mov_b32 v16,s58
s_and_b32 s60,s54,1
s_waitcnt lgkmcnt(3)
v_smfmac_f32_16x16x64_bf16 v[44:47],v[64:67],v[80:87],v2
ds_read_b128 v[64:67],v5 offset:0
s_lshl2_add_u32 s60,s53,s60
v_smfmac_f32_16x16x64_bf16 v[24:27],v[68:71],a[160:167],v2
ds_read_b128 v[80:83],v21 offset:10240
s_lshl_b32 s68,s60,16
v_smfmac_f32_16x16x64_bf16 v[28:31],v[68:71],a[168:175],v2
ds_read_b128 v[84:87],v21 offset:11264
s_add_u32 s68,s68,s83
v_smfmac_f32_16x16x64_bf16 v[32:35],v[68:71],a[176:183],v2
s_mul_i32 s59,s60,20480
s_add_u32 s59,s59,s6
s_lshl_b32 s69,s53,9
v_smfmac_f32_16x16x64_bf16 v[36:39],v[68:71],a[184:191],v2
s_add_u32 s69,s69,s7
s_bfe_u32 s31,s54,65537
s_add_u32 s32,s54,1
v_smfmac_f32_16x16x64_bf16 v[40:43],v[68:71],a[192:199],v2
s_add_u32 s50,s50,1
s_mov_b32 s51,s53
s_waitcnt lgkmcnt(3)
v_smfmac_f32_16x16x64_bf16 v[44:47],v[68:71],v[72:79],v2
ds_read_b128 v[68:71],v5 offset:1024
s_mov_b32 s52,s54
v_smfmac_f32_16x16x64_bf16 v[24:27],v[60:63],a[200:207],v2
ds_read_b128 v[72:75],v21 offset:12288
s_mov_b32 s58,s32
v_smfmac_f32_16x16x64_bf16 v[28:31],v[60:63],a[208:215],v2
ds_read_b128 v[76:79],v21 offset:13312
s_mov_b64 vcc,s[88:89]
v_smfmac_f32_16x16x64_bf16 v[32:35],v[60:63],a[216:223],v2
ds_read_b128 v[48:51],v58 offset:0
v_smfmac_f32_16x16x64_bf16 v[36:39],v[60:63],a[224:231],v2
v_smfmac_f32_16x16x64_bf16 v[40:43],v[60:63],a[232:239],v2
ds_read_b128 v[52:55],v58 offset:1024
s_waitcnt lgkmcnt(5)
v_smfmac_f32_16x16x64_bf16 v[44:47],v[60:63],v[80:87],v2
ds_read_b128 v[60:63],v59 offset:0
v_smfmac_f32_16x16x64_bf16 v[24:27],v[64:67],a[240:247],v2
ds_read_b128 v[80:83],v21 offset:14336
v_smfmac_f32_16x16x64_bf16 v[28:31],v[64:67],a[248:255],v2
ds_read_b128 v[84:87],v21 offset:15360
v_smfmac_f32_16x16x64_bf16 v[32:35],v[64:67],v[112:119],v2
ds_read_b128 v[88:91],v58 offset:2048
v_smfmac_f32_16x16x64_bf16 v[36:39],v[64:67],v[120:127],v2
v_smfmac_f32_16x16x64_bf16 v[40:43],v[64:67],v[128:135],v2
ds_read_b128 v[92:95],v58 offset:3072
s_waitcnt lgkmcnt(7)
v_smfmac_f32_16x16x64_bf16 v[44:47],v[64:67],v[72:79],v2
ds_read_b128 v[64:67],v59 offset:1024
v_smfmac_f32_16x16x64_bf16 v[24:27],v[68:71],v[136:143],v2
ds_read_b128 v[72:75],v21 offset:16384
v_smfmac_f32_16x16x64_bf16 v[28:31],v[68:71],v[144:151],v2
ds_read_b128 v[76:79],v21 offset:17408
v_smfmac_f32_16x16x64_bf16 v[32:35],v[68:71],v[152:159],v2
ds_read_b128 v[96:99],v58 offset:4096
v_smfmac_f32_16x16x64_bf16 v[36:39],v[68:71],v[160:167],v2
v_smfmac_f32_16x16x64_bf16 v[40:43],v[68:71],v[168:175],v2
ds_read_b128 v[100:103],v58 offset:5120
s_waitcnt lgkmcnt(7)
v_smfmac_f32_16x16x64_bf16 v[44:47],v[68:71],v[80:87],v2
ds_read_b128 v[80:83],v21 offset:18432
v_smfmac_f32_16x16x64_bf16 v[24:27],v[60:63],v[176:183],v2
ds_read_b128 v[84:87],v21 offset:19456
v_smfmac_f32_16x16x64_bf16 v[36:39],v[60:63],v[200:207],v2
ds_read_b128 v[104:107],v58 offset:6144
s_waitcnt lgkmcnt(7)
v_smfmac_f32_16x16x64_bf16 v[24:27],v[64:67],v[216:223],v2
v_smfmac_f32_16x16x64_bf16 v[36:39],v[64:67],v[240:247],v2
ds_read_b128 v[108:111],v58 offset:7168
v_smfmac_f32_16x16x64_bf16 v[28:31],v[60:63],v[184:191],v2
v_smfmac_f32_16x16x64_bf16 v[40:43],v[60:63],v[208:215],v2
v_add_f32 v24,v24,v25
v_smfmac_f32_16x16x64_bf16 v[28:31],v[64:67],v[224:231],v2
v_add_f32 v26,v26,v27
v_smfmac_f32_16x16x64_bf16 v[40:43],v[64:67],v[248:255],v2
v_add_f32 v36,v36,v37
v_smfmac_f32_16x16x64_bf16 v[32:35],v[60:63],v[192:199],v2
v_add_f32 v38,v38,v39
s_waitcnt lgkmcnt(6)
v_smfmac_f32_16x16x64_bf16 v[44:47],v[60:63],v[72:79],v2
v_cvt_pk_bf16_f32 v37,v24,v26
v_smfmac_f32_16x16x64_bf16 v[32:35],v[64:67],v[232:239],v2
v_cvt_pk_bf16_f32 v36,v36,v38
s_waitcnt lgkmcnt(2)
v_smfmac_f32_16x16x64_bf16 v[44:47],v[64:67],v[80:87],v2
ds_write_b64 v6,v[36:37] offset:0
v_add_f32 v28,v28,v29
v_add_f32 v30,v30,v31
v_add_f32 v40,v40,v41
v_add_f32 v42,v42,v43
v_cvt_pk_bf16_f32 v41,v28,v30
v_cvt_pk_bf16_f32 v40,v40,v42
ds_write_b64 v6,v[40:41] offset:512
v_add_f32 v32,v32,v33
v_add_f32 v34,v34,v35
v_add_f32 v44,v44,v45
v_add_f32 v46,v46,v47
v_cvt_pk_bf16_f32 v45,v32,v34
v_cvt_pk_bf16_f32 v44,v44,v46
ds_write_b64 v6,v[44:45] offset:1024
ds_read_b128 v[72:75],v58 offset:8192
ds_read_b128 v[76:79],v58 offset:9216
s_waitcnt lgkmcnt(2)
s_barrier
ds_read_b64_tr_b16 v[24:25],v7 offset:0
ds_read_b64_tr_b16 v[26:27],v7 offset:512
ds_read_b64_tr_b16 v[28:29],v7 offset:1024
ds_read_b64_tr_b16 v[30:31],v7 offset:1536
ds_read_b64_tr_b16 v[32:33],v7 offset:2048
ds_read_b64_tr_b16 v[34:35],v7 offset:2560
ds_read_b64_tr_b16 v[36:37],v7 offset:3072
ds_read_b64_tr_b16 v[38:39],v7 offset:3584
s_waitcnt lgkmcnt(6)
v_mfma_f32_16x16x32_bf16 v[60:63],v[48:51],v[24:27],0
ds_read_b64_tr_b16 v[40:41],v7 offset:4096
v_mfma_f32_16x16x32_bf16 v[64:67],v[52:55],v[24:27],0
ds_read_b64_tr_b16 v[42:43],v7 offset:4608
v_mfma_f32_16x16x32_bf16 v[68:71],v[24:27],v[24:27],0
ds_read_b128 v[80:83],v58 offset:10240
s_waitcnt lgkmcnt(7)
v_mfma_f32_16x16x32_bf16 v[60:63],v[88:91],v[28:31],v[60:63]
ds_read_b128 v[84:87],v58 offset:11264
v_mfma_f32_16x16x32_bf16 v[64:67],v[92:95],v[28:31],v[64:67]
ds_read_b64_tr_b16 v[44:45],v7 offset:5120
v_mfma_f32_16x16x32_bf16 v[68:71],v[28:31],v[28:31],v[68:71]
ds_read_b64_tr_b16 v[46:47],v7 offset:5632
s_waitcnt lgkmcnt(8)
v_mfma_f32_16x16x32_bf16 v[60:63],v[96:99],v[32:35],v[60:63]
ds_read_b128 v[24:27],v17 offset:12288
v_mfma_f32_16x16x32_bf16 v[64:67],v[100:103],v[32:35],v[64:67]
ds_read_b128 v[28:31],v17 offset:13312
v_mfma_f32_16x16x32_bf16 v[68:71],v[32:35],v[32:35],v[68:71]
s_waitcnt lgkmcnt(8)
v_mfma_f32_16x16x32_bf16 v[60:63],v[104:107],v[36:39],v[60:63]
ds_read_b128 v[32:35],v17 offset:14336
v_mfma_f32_16x16x32_bf16 v[64:67],v[108:111],v[36:39],v[64:67]
v_mfma_f32_16x16x32_bf16 v[68:71],v[36:39],v[36:39],v[68:71]
s_waitcnt lgkmcnt(7)
v_mfma_f32_16x16x32_bf16 v[60:63],v[72:75],v[40:43],v[60:63]
ds_read_b128 v[36:39],v17 offset:15360
v_mfma_f32_16x16x32_bf16 v[64:67],v[76:79],v[40:43],v[64:67]
v_mfma_f32_16x16x32_bf16 v[68:71],v[40:43],v[40:43],v[68:71]
s_waitcnt lgkmcnt(4)
v_mfma_f32_16x16x32_bf16 v[60:63],v[80:83],v[44:47],v[60:63]
v_mfma_f32_16x16x32_bf16 v[64:67],v[84:87],v[44:47],v[64:67]
buffer_load_dwordx4 v[48:51],v1,s[8:11],s71 offen sc1
v_mfma_f32_16x16x32_bf16 v[68:71],v[44:47],v[44:47],v[68:71]
s_nop 4
v_cndmask_b32_dpp v60,v64,v60,vcc quad_perm:[2,3,2,3] row_mask:0xf bank_mask:0xf
v_cndmask_b32_dpp v61,v65,v61,vcc quad_perm:[2,3,2,3] row_mask:0xf bank_mask:0xf
v_cndmask_b32_dpp v62,v66,v62,vcc quad_perm:[2,3,2,3] row_mask:0xf bank_mask:0xf
v_cndmask_b32_dpp v63,v67,v63,vcc quad_perm:[2,3,2,3] row_mask:0xf bank_mask:0xf
v_max3_f32 v12,v60,v61,v62
v_cndmask_b32_dpp v68,v69,v68,vcc quad_perm:[2,3,2,3] row_mask:0xf bank_mask:0xf
v_max3_f32 v12,v12,v63,v68
s_nop 1
v_max_f32_dpp v13,v12,v12 quad_perm:[2,3,0,1] row_mask:0xf bank_mask:0xf
v_max_f32_dpp v12,v12,v12 quad_perm:[2,3,0,1] row_mask:0xf bank_mask:0xf
s_nop 1
v_permlane32_swap_b32 v12,v13
v_max_f32 v15,v12,v13
v_max_f32 v12,v12,v13
s_mov_b64 exec,1
buffer_store_dword v16,v1,s[8:11],s72 offen
s_mov_b64 exec,-1
v_permlane16_swap_b32 v12,v15
v_max_f32 v12,v12,v15
v_mul_f32 v12,s87,v12
v_fma_f32 v60,v60,s87,-v12
v_fma_f32 v61,v61,s87,-v12
v_fma_f32 v62,v62,s87,-v12
v_fma_f32 v63,v63,s87,-v12
v_fma_f32 v68,v68,s87,-v12
v_exp_f32 v60,v60
v_exp_f32 v61,v61
v_exp_f32 v62,v62
v_exp_f32 v63,v63
v_exp_f32 v68,v68
v_cvt_pk_bf16_f32 v70,v60,v61
v_cvt_pk_bf16_f32 v71,v62,v63
v_cndmask_b32 v46,v70,v10,vcc
v_cndmask_b32 v47,v71,v10,vcc
v_cndmask_b32_dpp v44,v70,v10,vcc quad_perm:[2,3,0,1] row_mask:0xf bank_mask:0xf
v_cndmask_b32_dpp v45,v71,v10,vcc quad_perm:[2,3,0,1] row_mask:0xf bank_mask:0xf
s_mov_b64 vcc,s[90:91]
s_waitcnt lgkmcnt(0)
v_cndmask_b32 v40,v70,v10,vcc
v_mfma_f32_16x16x32_bf16 v[64:67],v[28:31],v[44:47],0
v_cndmask_b32 v41,v71,v10,vcc
v_cndmask_b32_dpp v42,v70,v10,vcc quad_perm:[2,3,0,1] row_mask:0xf bank_mask:0xf
v_mfma_f32_16x16x32_bf16 v[52:55],v[36:39],v[44:47],0
v_cndmask_b32_dpp v43,v71,v10,vcc quad_perm:[2,3,0,1] row_mask:0xf bank_mask:0xf
v_mov_b32_dpp v14,v68 quad_perm:[2,3,0,1] row_mask:0xf bank_mask:0xf
v_add_f32 v12,v60,v61
v_mfma_f32_16x16x32_bf16 v[64:67],v[24:27],v[40:43],v[64:67]
v_cvt_pk_bf16_f32 v56,v68,v14
v_cvt_pk_bf16_f32 v57,v14,v68
v_mfma_f32_16x16x32_bf16 v[52:55],v[32:35],v[40:43],v[52:55]
v_cndmask_b32 v56,v56,v10,vcc
v_cndmask_b32 v57,v10,v57,vcc
v_add_f32 v13,v62,v63
v_add_f32 v12,v12,v68
v_add_f32 v12,v12,v13
s_waitcnt vmcnt(1)
v_bitop3_b32 v17,v48,v50,s57 bitop3:0x7e
v_add_f32_dpp v13,v12,v12 quad_perm:[2,3,0,1] row_mask:0xf bank_mask:0xf
v_and_b32 v17,1,v17
v_add_f32_dpp v12,v12,v12 quad_perm:[2,3,0,1] row_mask:0xf bank_mask:0xf
v_cmp_ne_u32 vcc,0,v17
s_cbranch_vccnz vb_96
vo_97:
v_mfma_f32_16x16x16_bf16 v[64:67],v[48:49],v[56:57],v[64:67]
v_permlane32_swap_b32 v12,v13
v_add_f32 v15,v12,v13
v_mfma_f32_16x16x16_bf16 v[52:55],v[50:51],v[56:57],v[52:55]
v_add_f32 v12,v12,v13
s_nop 1
v_permlane16_swap_b32 v12,v15
v_add_f32 v12,v12,v15
v_rcp_f32 v12,v12
s_nop 0
v_pk_mul_f32 v[64:65],v[64:65],v[12:13] op_sel_hi:[1,0]
v_pk_mul_f32 v[66:67],v[66:67],v[12:13] op_sel_hi:[1,0]
v_pk_mul_f32 v[52:53],v[52:53],v[12:13] op_sel_hi:[1,0]
v_pk_mul_f32 v[54:55],v[54:55],v[12:13] op_sel_hi:[1,0]
v_cvt_pk_bf16_f32 v48,v64,v65
v_cvt_pk_bf16_f32 v49,v66,v67
v_cvt_pk_bf16_f32 v50,v52,v53
v_cvt_pk_bf16_f32 v51,v54,v55
v_and_or_b32 v48,v48,-2,s57
ds_read_b32 v0,v9
buffer_store_dwordx4 v[48:51],v8,s[8:11],s70 offen
s_mov_b32 s57,s31
v_mov_b32 v12,s50
s_waitcnt lgkmcnt(0)
v_cmp_ne_u32 vcc,s50,v0
ds_write_b32 v20,v12
s_cmp_lt_u32 s50,128
s_cbranch_scc1 CS_LOOP_F
s_branch CS_DONE
fr_94:
v_bitop3_b32 v12,v72,v76,s57 bitop3:0x7e
v_bitop3_b32 v13,v80,v80,s57 bitop3:0x7e
v_xor_b32 v14,s57,v80
v_or3_b32 v12,v12,v13,v14
v_and_b32 v12,1,v12
v_cmp_ne_u32 vcc,0,v12
s_cbranch_vccz sk_98
buffer_load_dwordx2 v[80:81],v18,s[8:11],s59 offen sc1
buffer_load_dwordx4 v[72:75],v1,s[8:11],s59 offen sc1
buffer_load_dwordx4 v[76:79],v1,s[8:11],s59 offen offset:1024 sc1
sk_98:
buffer_load_dwordx2 v[90:91],v18,s[8:11],s68 offen sc1
buffer_load_dwordx4 v[82:85],v1,s[8:11],s68 offen sc1
buffer_load_dwordx4 v[86:89],v1,s[8:11],s68 offen offset:1024 sc1
s_sub_u32 s47,s47,1
s_cbranch_scc1 ABORT
s_waitcnt lgkmcnt(0)
s_branch fa_93
vb_96:
s_sub_u32 s47,s47,1
s_cbranch_scc1 ABORT
buffer_load_dwordx4 v[48:51],v1,s[8:11],s71 offen sc1
s_waitcnt vmcnt(0)
v_bitop3_b32 v17,v48,v50,s57 bitop3:0x7e
v_and_b32 v17,1,v17
v_cmp_ne_u32 vcc,0,v17
s_nop 0
s_cbranch_vccnz vb_96
s_branch vo_97
CS_LOOP_S:
s_barrier
buffer_load_dwordx2 v[80:81],v18,s[8:11],s59 offen sc1
buffer_load_dwordx4 v[72:75],v1,s[8:11],s59 offen sc1
buffer_load_dwordx4 v[76:79],v1,s[8:11],s59 offen offset:1024 sc1
s_cbranch_vccz fj_101f
s_waitcnt vmcnt(2)
s_sleep 3
fj_101f:
buffer_load_dwordx2 v[90:91],v18,s[8:11],s68 offen sc1
buffer_load_dwordx4 v[82:85],v1,s[8:11],s68 offen sc1
buffer_load_dwordx4 v[86:89],v1,s[8:11],s68 offen offset:1024 sc1
v_mfma_f32_32x32x8_bf16 v[24:39],v[10:11],v[10:11],0
v_mfma_f32_16x16x16_bf16 v[40:43],v[10:11],v[10:11],0
v_mfma_f32_16x16x16_bf16 v[44:47],v[10:11],v[10:11],0
fj_101:
fa_99:
s_waitcnt vmcnt(5)
v_lshlrev_b32 v108,16,v80
v_and_b32 v109,0xffff0000,v80
v_lshlrev_b32 v110,16,v81
v_and_b32 v111,0xffff0000,v81
s_waitcnt vmcnt(4)
v_lshlrev_b32 v92,16,v72
v_and_b32 v93,0xffff0000,v72
v_lshlrev_b32 v94,16,v73
v_and_b32 v95,0xffff0000,v73
v_lshlrev_b32 v96,16,v74
v_and_b32 v97,0xffff0000,v74
v_lshlrev_b32 v98,16,v75
v_and_b32 v99,0xffff0000,v75
s_waitcnt vmcnt(3)
v_lshlrev_b32 v100,16,v76
v_and_b32 v101,0xffff0000,v76
v_lshlrev_b32 v102,16,v77
v_and_b32 v103,0xffff0000,v77
v_lshlrev_b32 v104,16,v78
v_and_b32 v105,0xffff0000,v78
v_lshlrev_b32 v106,16,v79
v_and_b32 v107,0xffff0000,v79
s_waitcnt vmcnt(2)
v_dot2c_f32_bf16 v108,s37,v90
v_dot2c_f32_bf16 v109,s81,v90
v_dot2c_f32_bf16 v110,s37,v91
v_dot2c_f32_bf16 v111,s81,v91
v_bitop3_b32 v16,v80,v90,s57 bitop3:0x7e
v_cvt_pk_bf16_f32 v56,v108,v109
s_nop 0
v_cvt_pk_bf16_f32 v57,v110,v111
ds_write_b64 v23,v[56:57]
s_waitcnt vmcnt(1)
v_dot2c_f32_bf16 v92,s37,v82
v_dot2c_f32_bf16 v93,s81,v82
v_dot2c_f32_bf16 v94,s37,v83
v_dot2c_f32_bf16 v95,s81,v83
v_dot2c_f32_bf16 v96,s37,v84
v_dot2c_f32_bf16 v97,s81,v84
v_dot2c_f32_bf16 v98,s37,v85
v_dot2c_f32_bf16 v99,s81,v85
v_bitop3_b32 v17,v72,v82,s57 bitop3:0x7e
v_or_b32 v16,v16,v17
v_cvt_pk_bf16_f32 v48,v92,v93
v_cvt_pk_bf16_f32 v49,v94,v95
v_cvt_pk_bf16_f32 v50,v96,v97
v_cvt_pk_bf16_f32 v51,v98,v99
ds_write_b128 v22,v[48:51] offset:0
s_waitcnt vmcnt(0)
v_dot2c_f32_bf16 v100,s37,v86
v_dot2c_f32_bf16 v101,s81,v86
v_dot2c_f32_bf16 v102,s37,v87
v_dot2c_f32_bf16 v103,s81,v87
v_dot2c_f32_bf16 v104,s37,v88
v_dot2c_f32_bf16 v105,s81,v88
v_dot2c_f32_bf16 v106,s37,v89
v_dot2c_f32_bf16 v107,s81,v89
v_bitop3_b32 v17,v76,v86,s57 bitop3:0x7e
v_bitop3_b32 v16,v16,v17,1 bitop3:0xa8
v_cmp_ne_u32 vcc,0,v16
v_cvt_pk_bf16_f32 v52,v100,v101
v_cvt_pk_bf16_f32 v53,v102,v103
v_cvt_pk_bf16_f32 v54,v104,v105
v_cvt_pk_bf16_f32 v55,v106,v107
ds_write_b128 v22,v[52:55] offset:1024
s_cbranch_vccnz fr_100
fj_101g:
v_smfmac_f32_16x16x64_bf16 v[24:27],v[48:51],a[0:7],v2
ds_read_b128 v[72:75],v21 offset:0
v_xor_b32 v58,57344,v58
v_smfmac_f32_16x16x64_bf16 v[28:31],v[48:51],a[8:15],v2
ds_read_b128 v[76:79],v21 offset:1024
s_sub_u32 s60,s4,s5
v_smfmac_f32_16x16x64_bf16 v[32:35],v[48:51],a[16:23],v2
ds_read_b128 v[80:83],v21 offset:2048
s_cmp_gt_i32 s60,13
v_smfmac_f32_16x16x64_bf16 v[36:39],v[48:51],a[24:31],v2
ds_read_b128 v[84:87],v21 offset:3072
s_cselect_b32 s53,1,0
s_waitcnt lgkmcnt(4)
s_barrier
v_smfmac_f32_16x16x64_bf16 v[40:43],v[48:51],a[32:39],v2
ds_read_b128 v[60:63],v3 offset:0
s_cmp_eq_u32 s4,64
v_smfmac_f32_16x16x64_bf16 v[24:27],v[52:55],a[40:47],v2
ds_read_b128 v[64:67],v3 offset:1024
s_cselect_b32 s53,1,s53
v_smfmac_f32_16x16x64_bf16 v[28:31],v[52:55],a[48:55],v2
ds_read_b128 v[68:71],v4 offset:0
s_cmp_eq_u32 s53,0
v_smfmac_f32_16x16x64_bf16 v[32:35],v[52:55],a[56:63],v2
s_cselect_b32 s54,s4,s5
s_addc_u32 s4,s4,0
s_add_u32 s5,s5,s53
v_smfmac_f32_16x16x64_bf16 v[36:39],v[52:55],a[64:71],v2
s_mul_i32 s73,s54,393216
s_add_u32 s73,s73,s84
s_sub_u32 s74,s75,s74
v_smfmac_f32_16x16x64_bf16 v[40:43],v[52:55],a[72:79],v2
s_mov_b32 m0,s74
s_and_b32 s60,s52,1
s_waitcnt lgkmcnt(5)
v_smfmac_f32_16x16x64_bf16 v[44:47],v[48:51],v[72:79],v2
ds_read_b128 v[72:75],v21 offset:4096
s_waitcnt lgkmcnt(4)
v_smfmac_f32_16x16x64_bf16 v[44:47],v[52:55],v[80:87],v2
ds_read_b128 v[76:79],v21 offset:5120
s_waitcnt lgkmcnt(4)
v_smfmac_f32_16x16x64_bf16 v[24:27],v[60:63],a[80:87],v2
ds_read_b128 v[80:83],v21 offset:6144
s_lshl2_add_u32 s60,s51,s60
v_smfmac_f32_16x16x64_bf16 v[28:31],v[60:63],a[88:95],v2
ds_read_b128 v[84:87],v21 offset:7168
s_mul_i32 s60,s60,49152
v_smfmac_f32_16x16x64_bf16 v[32:35],v[60:63],a[96:103],v2
s_add_u32 s71,s60,s34
s_add_u32 s70,s60,s33
s_lshl_b32 s60,s51,9
v_smfmac_f32_16x16x64_bf16 v[36:39],v[60:63],a[104:111],v2
s_add_u32 s72,s60,s35
buffer_load_dwordx4 v1,s[8:11],s73 offen sc1 lds
v_smfmac_f32_16x16x64_bf16 v[40:43],v[60:63],a[112:119],v2
buffer_load_dwordx4 v1,s[8:11],s73 offen offset:1024 sc1 lds
s_waitcnt lgkmcnt(2)
v_smfmac_f32_16x16x64_bf16 v[44:47],v[60:63],v[72:79],v2
ds_read_b128 v[60:63],v4 offset:1024
v_smfmac_f32_16x16x64_bf16 v[24:27],v[64:67],a[120:127],v2
ds_read_b128 v[72:75],v21 offset:8192
v_smfmac_f32_16x16x64_bf16 v[28:31],v[64:67],a[128:135],v2
ds_read_b128 v[76:79],v21 offset:9216
v_smfmac_f32_16x16x64_bf16 v[32:35],v[64:67],a[136:143],v2
buffer_load_dwordx4 v1,s[8:11],s73 offen offset:2048 sc1 lds
v_smfmac_f32_16x16x64_bf16 v[36:39],v[64:67],a[144:151],v2
buffer_load_dwordx4 v1,s[8:11],s73 offen offset:3072 sc1 lds
v_add_u32 v17,s85,v58
v_smfmac_f32_16x16x64_bf16 v[40:43],v[64:67],a[152:159],v2
v_mov_b32 v16,s58
s_and_b32 s60,s54,1
s_waitcnt lgkmcnt(3)
v_smfmac_f32_16x16x64_bf16 v[44:47],v[64:67],v[80:87],v2
ds_read_b128 v[64:67],v5 offset:0
s_lshl2_add_u32 s60,s53,s60
v_smfmac_f32_16x16x64_bf16 v[24:27],v[68:71],a[160:167],v2
ds_read_b128 v[80:83],v21 offset:10240
s_lshl_b32 s68,s60,16
v_smfmac_f32_16x16x64_bf16 v[28:31],v[68:71],a[168:175],v2
ds_read_b128 v[84:87],v21 offset:11264
s_add_u32 s68,s68,s83
v_smfmac_f32_16x16x64_bf16 v[32:35],v[68:71],a[176:183],v2
s_mul_i32 s59,s60,20480
s_add_u32 s59,s59,s6
s_lshl_b32 s69,s53,9
v_smfmac_f32_16x16x64_bf16 v[36:39],v[68:71],a[184:191],v2
s_add_u32 s69,s69,s7
s_bfe_u32 s31,s54,65537
s_add_u32 s32,s54,1
v_smfmac_f32_16x16x64_bf16 v[40:43],v[68:71],a[192:199],v2
s_add_u32 s50,s50,1
s_mov_b32 s51,s53
s_waitcnt lgkmcnt(3)
v_smfmac_f32_16x16x64_bf16 v[44:47],v[68:71],v[72:79],v2
ds_read_b128 v[68:71],v5 offset:1024
s_mov_b32 s52,s54
v_smfmac_f32_16x16x64_bf16 v[24:27],v[60:63],a[200:207],v2
ds_read_b128 v[72:75],v21 offset:12288
s_mov_b32 s58,s32
v_smfmac_f32_16x16x64_bf16 v[28:31],v[60:63],a[208:215],v2
ds_read_b128 v[76:79],v21 offset:13312
s_mov_b64 vcc,s[88:89]
v_smfmac_f32_16x16x64_bf16 v[32:35],v[60:63],a[216:223],v2
ds_read_b128 v[48:51],v58 offset:0
v_smfmac_f32_16x16x64_bf16 v[36:39],v[60:63],a[224:231],v2
v_smfmac_f32_16x16x64_bf16 v[40:43],v[60:63],a[232:239],v2
ds_read_b128 v[52:55],v58 offset:1024
s_waitcnt lgkmcnt(5)
v_smfmac_f32_16x16x64_bf16 v[44:47],v[60:63],v[80:87],v2
ds_read_b128 v[60:63],v59 offset:0
v_smfmac_f32_16x16x64_bf16 v[24:27],v[64:67],a[240:247],v2
ds_read_b128 v[80:83],v21 offset:14336
v_smfmac_f32_16x16x64_bf16 v[28:31],v[64:67],a[248:255],v2
ds_read_b128 v[84:87],v21 offset:15360
v_smfmac_f32_16x16x64_bf16 v[32:35],v[64:67],v[112:119],v2
ds_read_b128 v[88:91],v58 offset:2048
v_smfmac_f32_16x16x64_bf16 v[36:39],v[64:67],v[120:127],v2
v_smfmac_f32_16x16x64_bf16 v[40:43],v[64:67],v[128:135],v2
ds_read_b128 v[92:95],v58 offset:3072
s_waitcnt lgkmcnt(7)
v_smfmac_f32_16x16x64_bf16 v[44:47],v[64:67],v[72:79],v2
ds_read_b128 v[64:67],v59 offset:1024
v_smfmac_f32_16x16x64_bf16 v[24:27],v[68:71],v[136:143],v2
ds_read_b128 v[72:75],v21 offset:16384
v_smfmac_f32_16x16x64_bf16 v[28:31],v[68:71],v[144:151],v2
ds_read_b128 v[76:79],v21 offset:17408
v_smfmac_f32_16x16x64_bf16 v[32:35],v[68:71],v[152:159],v2
ds_read_b128 v[96:99],v58 offset:4096
v_smfmac_f32_16x16x64_bf16 v[36:39],v[68:71],v[160:167],v2
v_smfmac_f32_16x16x64_bf16 v[40:43],v[68:71],v[168:175],v2
ds_read_b128 v[100:103],v58 offset:5120
s_waitcnt lgkmcnt(7)
v_smfmac_f32_16x16x64_bf16 v[44:47],v[68:71],v[80:87],v2
ds_read_b128 v[80:83],v21 offset:18432
v_smfmac_f32_16x16x64_bf16 v[24:27],v[60:63],v[176:183],v2
ds_read_b128 v[84:87],v21 offset:19456
v_smfmac_f32_16x16x64_bf16 v[36:39],v[60:63],v[200:207],v2
ds_read_b128 v[104:107],v58 offset:6144
s_waitcnt lgkmcnt(7)
v_smfmac_f32_16x16x64_bf16 v[24:27],v[64:67],v[216:223],v2
v_smfmac_f32_16x16x64_bf16 v[36:39],v[64:67],v[240:247],v2
ds_read_b128 v[108:111],v58 offset:7168
v_smfmac_f32_16x16x64_bf16 v[28:31],v[60:63],v[184:191],v2
v_smfmac_f32_16x16x64_bf16 v[40:43],v[60:63],v[208:215],v2
v_add_f32 v24,v24,v25
v_smfmac_f32_16x16x64_bf16 v[28:31],v[64:67],v[224:231],v2
v_add_f32 v26,v26,v27
v_smfmac_f32_16x16x64_bf16 v[40:43],v[64:67],v[248:255],v2
v_add_f32 v36,v36,v37
v_smfmac_f32_16x16x64_bf16 v[32:35],v[60:63],v[192:199],v2
v_add_f32 v38,v38,v39
s_waitcnt lgkmcnt(6)
v_smfmac_f32_16x16x64_bf16 v[44:47],v[60:63],v[72:79],v2
v_cvt_pk_bf16_f32 v37,v24,v26
v_smfmac_f32_16x16x64_bf16 v[32:35],v[64:67],v[232:239],v2
v_cvt_pk_bf16_f32 v36,v36,v38
s_waitcnt lgkmcnt(2)
v_smfmac_f32_16x16x64_bf16 v[44:47],v[64:67],v[80:87],v2
ds_write_b64 v6,v[36:37] offset:0
v_add_f32 v28,v28,v29
v_add_f32 v30,v30,v31
v_add_f32 v40,v40,v41
v_add_f32 v42,v42,v43
v_cvt_pk_bf16_f32 v41,v28,v30
v_cvt_pk_bf16_f32 v40,v40,v42
ds_write_b64 v6,v[40:41] offset:512
v_add_f32 v32,v32,v33
v_add_f32 v34,v34,v35
v_add_f32 v44,v44,v45
v_add_f32 v46,v46,v47
v_cvt_pk_bf16_f32 v45,v32,v34
v_cvt_pk_bf16_f32 v44,v44,v46
ds_write_b64 v6,v[44:45] offset:1024
ds_read_b128 v[72:75],v58 offset:8192
ds_read_b128 v[76:79],v58 offset:9216
s_waitcnt lgkmcnt(2)
s_barrier
ds_read_b64_tr_b16 v[24:25],v7 offset:0
ds_read_b64_tr_b16 v[26:27],v7 offset:512
ds_read_b64_tr_b16 v[28:29],v7 offset:1024
ds_read_b64_tr_b16 v[30:31],v7 offset:1536
ds_read_b64_tr_b16 v[32:33],v7 offset:2048
ds_read_b64_tr_b16 v[34:35],v7 offset:2560
ds_read_b64_tr_b16 v[36:37],v7 offset:3072
ds_read_b64_tr_b16 v[38:39],v7 offset:3584
s_waitcnt lgkmcnt(6)
v_mfma_f32_16x16x32_bf16 v[60:63],v[48:51],v[24:27],0
ds_read_b64_tr_b16 v[40:41],v7 offset:4096
v_mfma_f32_16x16x32_bf16 v[64:67],v[52:55],v[24:27],0
ds_read_b64_tr_b16 v[42:43],v7 offset:4608
v_mfma_f32_16x16x32_bf16 v[68:71],v[24:27],v[24:27],0
ds_read_b128 v[80:83],v58 offset:10240
s_waitcnt lgkmcnt(7)
v_mfma_f32_16x16x32_bf16 v[60:63],v[88:91],v[28:31],v[60:63]
ds_read_b128 v[84:87],v58 offset:11264
v_mfma_f32_16x16x32_bf16 v[64:67],v[92:95],v[28:31],v[64:67]
ds_read_b64_tr_b16 v[44:45],v7 offset:5120
v_mfma_f32_16x16x32_bf16 v[68:71],v[28:31],v[28:31],v[68:71]
ds_read_b64_tr_b16 v[46:47],v7 offset:5632
s_waitcnt lgkmcnt(8)
v_mfma_f32_16x16x32_bf16 v[60:63],v[96:99],v[32:35],v[60:63]
ds_read_b128 v[24:27],v17 offset:12288
v_mfma_f32_16x16x32_bf16 v[64:67],v[100:103],v[32:35],v[64:67]
ds_read_b128 v[28:31],v17 offset:13312
v_mfma_f32_16x16x32_bf16 v[68:71],v[32:35],v[32:35],v[68:71]
s_waitcnt lgkmcnt(8)
v_mfma_f32_16x16x32_bf16 v[60:63],v[104:107],v[36:39],v[60:63]
ds_read_b128 v[32:35],v17 offset:14336
v_mfma_f32_16x16x32_bf16 v[64:67],v[108:111],v[36:39],v[64:67]
v_mfma_f32_16x16x32_bf16 v[68:71],v[36:39],v[36:39],v[68:71]
s_waitcnt lgkmcnt(7)
v_mfma_f32_16x16x32_bf16 v[60:63],v[72:75],v[40:43],v[60:63]
ds_read_b128 v[36:39],v17 offset:15360
v_mfma_f32_16x16x32_bf16 v[64:67],v[76:79],v[40:43],v[64:67]
v_mfma_f32_16x16x32_bf16 v[68:71],v[40:43],v[40:43],v[68:71]
s_waitcnt lgkmcnt(4)
v_mfma_f32_16x16x32_bf16 v[60:63],v[80:83],v[44:47],v[60:63]
v_mfma_f32_16x16x32_bf16 v[64:67],v[84:87],v[44:47],v[64:67]
buffer_load_dwordx4 v[48:51],v1,s[8:11],s71 offen sc1
v_mfma_f32_16x16x32_bf16 v[68:71],v[44:47],v[44:47],v[68:71]
s_nop 4
v_cndmask_b32_dpp v60,v64,v60,vcc quad_perm:[2,3,2,3] row_mask:0xf bank_mask:0xf
v_cndmask_b32_dpp v61,v65,v61,vcc quad_perm:[2,3,2,3] row_mask:0xf bank_mask:0xf
v_cndmask_b32_dpp v62,v66,v62,vcc quad_perm:[2,3,2,3] row_mask:0xf bank_mask:0xf
v_cndmask_b32_dpp v63,v67,v63,vcc quad_perm:[2,3,2,3] row_mask:0xf bank_mask:0xf
v_max3_f32 v12,v60,v61,v62
v_cndmask_b32_dpp v68,v69,v68,vcc quad_perm:[2,3,2,3] row_mask:0xf bank_mask:0xf
v_max3_f32 v12,v12,v63,v68
s_nop 1
v_max_f32_dpp v13,v12,v12 quad_perm:[2,3,0,1] row_mask:0xf bank_mask:0xf
v_max_f32_dpp v12,v12,v12 quad_perm:[2,3,0,1] row_mask:0xf bank_mask:0xf
s_nop 1
v_permlane32_swap_b32 v12,v13
v_max_f32 v15,v12,v13
v_max_f32 v12,v12,v13
s_mov_b64 exec,1
buffer_store_dword v16,v1,s[8:11],s72 offen sc1
s_mov_b64 exec,-1
v_permlane16_swap_b32 v12,v15
v_max_f32 v12,v12,v15
v_mul_f32 v12,s87,v12
v_fma_f32 v60,v60,s87,-v12
v_fma_f32 v61,v61,s87,-v12
v_fma_f32 v62,v62,s87,-v12
v_fma_f32 v63,v63,s87,-v12
v_fma_f32 v68,v68,s87,-v12
v_exp_f32 v60,v60
v_exp_f32 v61,v61
v_exp_f32 v62,v62
v_exp_f32 v63,v63
v_exp_f32 v68,v68
v_cvt_pk_bf16_f32 v70,v60,v61
v_cvt_pk_bf16_f32 v71,v62,v63
v_cndmask_b32 v46,v70,v10,vcc
v_cndmask_b32 v47,v71,v10,vcc
v_cndmask_b32_dpp v44,v70,v10,vcc quad_perm:[2,3,0,1] row_mask:0xf bank_mask:0xf
v_cndmask_b32_dpp v45,v71,v10,vcc quad_perm:[2,3,0,1] row_mask:0xf bank_mask:0xf
s_mov_b64 vcc,s[90:91]
s_waitcnt lgkmcnt(0)
v_cndmask_b32 v40,v70,v10,vcc
v_mfma_f32_16x16x32_bf16 v[64:67],v[28:31],v[44:47],0
v_cndmask_b32 v41,v71,v10,vcc
v_cndmask_b32_dpp v42,v70,v10,vcc quad_perm:[2,3,0,1] row_mask:0xf bank_mask:0xf
v_mfma_f32_16x16x32_bf16 v[52:55],v[36:39],v[44:47],0
v_cndmask_b32_dpp v43,v71,v10,vcc quad_perm:[2,3,0,1] row_mask:0xf bank_mask:0xf
v_mov_b32_dpp v14,v68 quad_perm:[2,3,0,1] row_mask:0xf bank_mask:0xf
v_add_f32 v12,v60,v61
v_mfma_f32_16x16x32_bf16 v[64:67],v[24:27],v[40:43],v[64:67]
v_cvt_pk_bf16_f32 v56,v68,v14
v_cvt_pk_bf16_f32 v57,v14,v68
v_mfma_f32_16x16x32_bf16 v[52:55],v[32:35],v[40:43],v[52:55]
v_cndmask_b32 v56,v56,v10,vcc
v_cndmask_b32 v57,v10,v57,vcc
v_add_f32 v13,v62,v63
v_add_f32 v12,v12,v68
v_add_f32 v12,v12,v13
s_waitcnt vmcnt(1)
v_bitop3_b32 v17,v48,v50,s57 bitop3:0x7e
v_add_f32_dpp v13,v12,v12 quad_perm:[2,3,0,1] row_mask:0xf bank_mask:0xf
v_and_b32 v17,1,v17
v_add_f32_dpp v12,v12,v12 quad_perm:[2,3,0,1] row_mask:0xf bank_mask:0xf
v_cmp_ne_u32 vcc,0,v17
s_cbranch_vccnz vb_102
vo_103:
v_mfma_f32_16x16x16_bf16 v[64:67],v[48:49],v[56:57],v[64:67]
v_permlane32_swap_b32 v12,v13
v_add_f32 v15,v12,v13
v_mfma_f32_16x16x16_bf16 v[52:55],v[50:51],v[56:57],v[52:55]
v_add_f32 v12,v12,v13
s_nop 1
v_permlane16_swap_b32 v12,v15
v_add_f32 v12,v12,v15
v_rcp_f32 v12,v12
s_nop 0
v_pk_mul_f32 v[64:65],v[64:65],v[12:13] op_sel_hi:[1,0]
v_pk_mul_f32 v[66:67],v[66:67],v[12:13] op_sel_hi:[1,0]
v_pk_mul_f32 v[52:53],v[52:53],v[12:13] op_sel_hi:[1,0]
v_pk_mul_f32 v[54:55],v[54:55],v[12:13] op_sel_hi:[1,0]
v_cvt_pk_bf16_f32 v48,v64,v65
v_cvt_pk_bf16_f32 v49,v66,v67
v_cvt_pk_bf16_f32 v50,v52,v53
v_cvt_pk_bf16_f32 v51,v54,v55
v_and_or_b32 v48,v48,-2,s57
ds_read_b32 v0,v9
buffer_store_dwordx4 v[48:51],v8,s[8:11],s70 offen sc1
s_mov_b32 s57,s31
v_mov_b32 v12,s50
s_waitcnt lgkmcnt(0)
v_cmp_ne_u32 vcc,s50,v0
ds_write_b32 v20,v12
s_cmp_lt_u32 s50,128
s_cbranch_scc1 CS_LOOP_S
s_branch CS_DONE
fr_100:
v_bitop3_b32 v12,v72,v76,s57 bitop3:0x7e
v_bitop3_b32 v13,v80,v80,s57 bitop3:0x7e
v_xor_b32 v14,s57,v80
v_or3_b32 v12,v12,v13,v14
v_and_b32 v12,1,v12
v_cmp_ne_u32 vcc,0,v12
s_cbranch_vccz sk_104
buffer_load_dwordx2 v[80:81],v18,s[8:11],s59 offen sc1
buffer_load_dwordx4 v[72:75],v1,s[8:11],s59 offen sc1
buffer_load_dwordx4 v[76:79],v1,s[8:11],s59 offen offset:1024 sc1
sk_104:
buffer_load_dwordx2 v[90:91],v18,s[8:11],s68 offen sc1
buffer_load_dwordx4 v[82:85],v1,s[8:11],s68 offen sc1
buffer_load_dwordx4 v[86:89],v1,s[8:11],s68 offen offset:1024 sc1
s_sub_u32 s47,s47,1
s_cbranch_scc1 ABORT
s_waitcnt lgkmcnt(0)
s_branch fa_99
vb_102:
s_sub_u32 s47,s47,1
s_cbranch_scc1 ABORT
buffer_load_dwordx4 v[48:51],v1,s[8:11],s71 offen sc1
s_waitcnt vmcnt(0)
v_bitop3_b32 v17,v48,v50,s57 bitop3:0x7e
v_and_b32 v17,1,v17
v_cmp_ne_u32 vcc,0,v17
s_nop 0
s_cbranch_vccnz vb_102
s_branch vo_103
CH_START:
s_sub_u32 s60,s4,s5
s_cmp_gt_i32 s60,13
s_cselect_b32 s53,1,0
s_cmp_eq_u32 s4,64
s_cselect_b32 s53,1,s53
s_cmp_eq_u32 s53,0
s_cselect_b32 s54,s4,s5
s_addc_u32 s4,s4,0
s_add_u32 s5,s5,s53
s_sub_u32 s60,s4,s5
s_cmp_gt_i32 s60,13
s_cselect_b32 s55,1,0
s_cmp_eq_u32 s4,64
s_cselect_b32 s55,1,s55
s_cmp_eq_u32 s55,0
s_cselect_b32 s56,s4,s5
s_addc_u32 s4,s4,0
s_add_u32 s5,s5,s55
s_mov_b32 s74,81920
s_mul_i32 s73,s52,393216
s_add_u32 s73,s73,s84
s_lshl_b32 s75,s51,6
s_add_u32 s75,s75,s52
s_lshl_b32 s75,s75,9
s_add_u32 s75,s75,131072
fl_105:
buffer_load_dword v12,v9,s[8:11],s75 offen sc1
s_waitcnt vmcnt(0)
v_cmp_eq_u32 vcc,0,v12
s_nop 0
s_cbranch_vccz ok_106
s_sleep 1
s_sub_u32 s47,s47,1
s_cbranch_scc1 ABORT
s_branch fl_105
ok_106:
s_add_u32 m0,s74,0
s_add_u32 s67,s73,0
buffer_load_dwordx4 v1,s[8:11],s67 offen sc1 lds
buffer_load_dwordx4 v1,s[8:11],s67 offen offset:1024 sc1 lds
buffer_load_dwordx4 v1,s[8:11],s67 offen offset:2048 sc1 lds
buffer_load_dwordx4 v1,s[8:11],s67 offen offset:3072 sc1 lds
s_add_u32 m0,s74,4096
s_add_u32 s67,s73,4096
buffer_load_dwordx4 v1,s[8:11],s67 offen sc1 lds
buffer_load_dwordx4 v1,s[8:11],s67 offen offset:1024 sc1 lds
buffer_load_dwordx4 v1,s[8:11],s67 offen offset:2048 sc1 lds
buffer_load_dwordx4 v1,s[8:11],s67 offen offset:3072 sc1 lds
s_add_u32 m0,s74,8192
s_add_u32 s67,s73,8192
buffer_load_dwordx4 v1,s[8:11],s67 offen sc1 lds
buffer_load_dwordx4 v1,s[8:11],s67 offen offset:1024 sc1 lds
buffer_load_dwordx4 v1,s[8:11],s67 offen offset:2048 sc1 lds
buffer_load_dwordx4 v1,s[8:11],s67 offen offset:3072 sc1 lds
s_add_u32 m0,s74,12288
s_add_u32 s67,s73,25165824
buffer_load_dwordx4 v1,s[8:11],s67 offen sc1 lds
buffer_load_dwordx4 v1,s[8:11],s67 offen offset:1024 sc1 lds
buffer_load_dwordx4 v1,s[8:11],s67 offen offset:2048 sc1 lds
buffer_load_dwordx4 v1,s[8:11],s67 offen offset:3072 sc1 lds
s_add_u32 m0,s74,16384
s_add_u32 s67,s73,25169920
buffer_load_dwordx4 v1,s[8:11],s67 offen sc1 lds
buffer_load_dwordx4 v1,s[8:11],s67 offen offset:1024 sc1 lds
buffer_load_dwordx4 v1,s[8:11],s67 offen offset:2048 sc1 lds
buffer_load_dwordx4 v1,s[8:11],s67 offen offset:3072 sc1 lds
s_add_u32 m0,s74,20480
s_add_u32 s67,s73,25174016
buffer_load_dwordx4 v1,s[8:11],s67 offen sc1 lds
buffer_load_dwordx4 v1,s[8:11],s67 offen offset:1024 sc1 lds
buffer_load_dwordx4 v1,s[8:11],s67 offen offset:2048 sc1 lds
buffer_load_dwordx4 v1,s[8:11],s67 offen offset:3072 sc1 lds
s_mov_b32 s74,106496
s_mul_i32 s73,s54,393216
s_add_u32 s73,s73,s84
s_lshl_b32 s75,s53,6
s_add_u32 s75,s75,s54
s_lshl_b32 s75,s75,9
s_add_u32 s75,s75,131072
s_lshl_b32 s76,s55,6
s_add_u32 s76,s76,s56
s_lshl_b32 s76,s76,9
s_add_u32 s76,s76,131072
s_mov_b32 s77,1
v_min_u32 v8,2,v0
v_lshlrev_b32 v8,2,v8
v_add_u32 v8,147456,v8
v_mov_b32 v58,147468
s_mov_b32 s80,0
v_mov_b32 v24,0
v_mov_b32 v25,0
v_mov_b32 v26,0
v_mov_b32 v27,0
v_mov_b32 v28,0
v_mov_b32 v29,0
v_mov_b32 v30,0
v_mov_b32 v31,0
v_mov_b32 v32,0
v_mov_b32 v33,0
v_mov_b32 v34,0
v_mov_b32 v35,0
v_mov_b32 v36,0
v_mov_b32 v37,0
v_mov_b32 v38,0
v_mov_b32 v39,0
v_mov_b32 v40,0
v_mov_b32 v41,0
v_mov_b32 v42,0
v_mov_b32 v43,0
v_mov_b32 v44,0
v_mov_b32 v45,0
v_mov_b32 v46,0
v_mov_b32 v47,0
s_nop 1
CH_LOOP:
v_mov_b32 v14,s50
s_nop 1
db_110:
buffer_load_dword v12,v11,s[8:11],s69 offen sc1
s_waitcnt vmcnt(0)
v_cmp_gt_u32 vcc,s58,v12
s_cbranch_vccz dbok_111
s_sub_u32 s47,s47,1
s_cbranch_scc1 ABORT
s_branch db_110
dbok_111:
ds_write_b32 v58,v14
buffer_load_dwordx2 v[68:69],v18,s[8:11],s59 offen sc1
buffer_load_dwordx4 v[60:63],v1,s[8:11],s59 offen sc1
buffer_load_dwordx4 v[64:67],v1,s[8:11],s59 offen offset:1024 sc1
s_barrier
s_waitcnt vmcnt(2)
s_sleep 3
fj_109f:
buffer_load_dwordx2 v[78:79],v18,s[8:11],s68 offen sc1
buffer_load_dwordx4 v[70:73],v1,s[8:11],s68 offen sc1
buffer_load_dwordx4 v[74:77],v1,s[8:11],s68 offen offset:1024 sc1
s_mov_b64 vcc,s[90:91]
ds_read_b64_tr_b16 v[100:101],v7 offset:0
ds_read_b64_tr_b16 v[102:103],v7 offset:512
ds_read_b64_tr_b16 v[48:49],v7 offset:1024
ds_read_b64_tr_b16 v[50:51],v7 offset:1536
ds_read_b64_tr_b16 v[104:105],v7 offset:2048
ds_read_b64_tr_b16 v[106:107],v7 offset:2560
ds_read_b64_tr_b16 v[52:53],v7 offset:3072
ds_read_b64_tr_b16 v[54:55],v7 offset:3584
ds_read_b64_tr_b16 v[108:109],v7 offset:4096
ds_read_b64_tr_b16 v[110:111],v7 offset:4608
ds_read_b64_tr_b16 v[12:13],v7 offset:5120
ds_read_b64_tr_b16 v[14:15],v7 offset:5632
s_waitcnt lgkmcnt(8)
v_cndmask_b32_dpp v100,v48,v100,vcc quad_perm:[0,1,0,1] row_mask:0xf bank_mask:0xf
v_cndmask_b32_dpp v101,v49,v101,vcc quad_perm:[0,1,0,1] row_mask:0xf bank_mask:0xf
v_cndmask_b32_dpp v102,v50,v102,vcc quad_perm:[0,1,0,1] row_mask:0xf bank_mask:0xf
v_cndmask_b32_dpp v103,v51,v103,vcc quad_perm:[0,1,0,1] row_mask:0xf bank_mask:0xf
s_waitcnt lgkmcnt(4)
v_cndmask_b32_dpp v104,v52,v104,vcc quad_perm:[0,1,0,1] row_mask:0xf bank_mask:0xf
v_cndmask_b32_dpp v105,v53,v105,vcc quad_perm:[0,1,0,1] row_mask:0xf bank_mask:0xf
v_cndmask_b32_dpp v106,v54,v106,vcc quad_perm:[0,1,0,1] row_mask:0xf bank_mask:0xf
v_cndmask_b32_dpp v107,v55,v107,vcc quad_perm:[0,1,0,1] row_mask:0xf bank_mask:0xf
s_waitcnt lgkmcnt(0)
v_cndmask_b32_dpp v108,v12,v108,vcc quad_perm:[0,1,0,1] row_mask:0xf bank_mask:0xf
v_cndmask_b32_dpp v109,v13,v109,vcc quad_perm:[0,1,0,1] row_mask:0xf bank_mask:0xf
v_cndmask_b32_dpp v110,v14,v110,vcc quad_perm:[0,1,0,1] row_mask:0xf bank_mask:0xf
v_cndmask_b32_dpp v111,v15,v111,vcc quad_perm:[0,1,0,1] row_mask:0xf bank_mask:0xf
fj_109:
fa_107:
s_waitcnt vmcnt(5)
v_lshlrev_b32 v96,16,v68
v_and_b32 v97,0xffff0000,v68
v_lshlrev_b32 v98,16,v69
v_and_b32 v99,0xffff0000,v69
s_waitcnt vmcnt(4)
v_lshlrev_b32 v80,16,v60
v_and_b32 v81,0xffff0000,v60
v_lshlrev_b32 v82,16,v61
v_and_b32 v83,0xffff0000,v61
v_lshlrev_b32 v84,16,v62
v_and_b32 v85,0xffff0000,v62
v_lshlrev_b32 v86,16,v63
v_and_b32 v87,0xffff0000,v63
s_waitcnt vmcnt(3)
v_lshlrev_b32 v88,16,v64
v_and_b32 v89,0xffff0000,v64
v_lshlrev_b32 v90,16,v65
v_and_b32 v91,0xffff0000,v65
v_lshlrev_b32 v92,16,v66
v_and_b32 v93,0xffff0000,v66
v_lshlrev_b32 v94,16,v67
v_and_b32 v95,0xffff0000,v67
s_waitcnt vmcnt(2)
v_dot2c_f32_bf16 v96,s37,v78
v_dot2c_f32_bf16 v97,s81,v78
v_dot2c_f32_bf16 v98,s37,v79
v_dot2c_f32_bf16 v99,s81,v79
v_bitop3_b32 v16,v68,v78,s57 bitop3:0x7e
v_cvt_pk_bf16_f32 v56,v96,v97
s_nop 0
v_cvt_pk_bf16_f32 v57,v98,v99
ds_write_b64 v23,v[56:57]
s_waitcnt vmcnt(1)
v_dot2c_f32_bf16 v80,s37,v70
v_dot2c_f32_bf16 v81,s81,v70
v_dot2c_f32_bf16 v82,s37,v71
v_dot2c_f32_bf16 v83,s81,v71
v_dot2c_f32_bf16 v84,s37,v72
v_dot2c_f32_bf16 v85,s81,v72
v_dot2c_f32_bf16 v86,s37,v73
v_dot2c_f32_bf16 v87,s81,v73
v_bitop3_b32 v17,v60,v70,s57 bitop3:0x7e
v_or_b32 v16,v16,v17
v_cvt_pk_bf16_f32 v48,v80,v81
v_cvt_pk_bf16_f32 v49,v82,v83
v_cvt_pk_bf16_f32 v50,v84,v85
v_cvt_pk_bf16_f32 v51,v86,v87
ds_write_b128 v22,v[48:51] offset:0
s_waitcnt vmcnt(0)
v_dot2c_f32_bf16 v88,s37,v74
v_dot2c_f32_bf16 v89,s81,v74
v_dot2c_f32_bf16 v90,s37,v75
v_dot2c_f32_bf16 v91,s81,v75
v_dot2c_f32_bf16 v92,s37,v76
v_dot2c_f32_bf16 v93,s81,v76
v_dot2c_f32_bf16 v94,s37,v77
v_dot2c_f32_bf16 v95,s81,v77
v_bitop3_b32 v17,v64,v74,s57 bitop3:0x7e
v_bitop3_b32 v16,v16,v17,1 bitop3:0xa8
v_cmp_ne_u32 vcc,0,v16
v_cvt_pk_bf16_f32 v52,v88,v89
v_cvt_pk_bf16_f32 v53,v90,v91
v_cvt_pk_bf16_f32 v54,v92,v93
v_cvt_pk_bf16_f32 v55,v94,v95
ds_write_b128 v22,v[52:55] offset:1024
s_cbranch_vccnz fr_108
fj_109g:
v_smfmac_f32_16x16x64_bf16 v[24:27],v[48:51],a[0:7],v2
ds_read_b128 v[72:75],v21 offset:0
s_and_b32 s60,s54,1
v_smfmac_f32_16x16x64_bf16 v[28:31],v[48:51],a[8:15],v2
ds_read_b128 v[76:79],v21 offset:1024
s_lshl2_add_u32 s60,s53,s60
v_smfmac_f32_16x16x64_bf16 v[32:35],v[48:51],a[16:23],v2
ds_read_b128 v[80:83],v21 offset:2048
s_lshl_b32 s68,s60,16
v_smfmac_f32_16x16x64_bf16 v[36:39],v[48:51],a[24:31],v2
ds_read_b128 v[84:87],v21 offset:3072
s_add_u32 s68,s68,s83
s_waitcnt lgkmcnt(4)
s_barrier
v_smfmac_f32_16x16x64_bf16 v[40:43],v[48:51],a[32:39],v2
ds_read_b128 v[60:63],v3 offset:0
s_mul_i32 s59,s60,20480
v_smfmac_f32_16x16x64_bf16 v[24:27],v[52:55],a[40:47],v2
ds_read_b128 v[64:67],v3 offset:1024
s_add_u32 s59,s59,s6
v_smfmac_f32_16x16x64_bf16 v[28:31],v[52:55],a[48:55],v2
ds_read_b128 v[68:71],v4 offset:0
s_lshl_b32 s69,s53,9
v_smfmac_f32_16x16x64_bf16 v[32:35],v[52:55],a[56:63],v2
s_add_u32 m0,s74,12288
s_add_u32 s67,s73,25165824
s_add_u32 s69,s69,s7
v_smfmac_f32_16x16x64_bf16 v[36:39],v[52:55],a[64:71],v2
buffer_load_dwordx4 v1,s[8:11],s67 offen sc1 lds
s_bfe_u32 s31,s54,65537
v_smfmac_f32_16x16x64_bf16 v[40:43],v[52:55],a[72:79],v2
buffer_load_dwordx4 v1,s[8:11],s67 offen offset:1024 sc1 lds
s_waitcnt lgkmcnt(5)
v_smfmac_f32_16x16x64_bf16 v[44:47],v[48:51],v[72:79],v2
ds_read_b128 v[72:75],v21 offset:4096
s_waitcnt lgkmcnt(4)
v_smfmac_f32_16x16x64_bf16 v[44:47],v[52:55],v[80:87],v2
ds_read_b128 v[76:79],v21 offset:5120
s_waitcnt lgkmcnt(4)
v_smfmac_f32_16x16x64_bf16 v[24:27],v[60:63],a[80:87],v2
ds_read_b128 v[80:83],v21 offset:6144
s_add_u32 s32,s54,1
v_smfmac_f32_16x16x64_bf16 v[28:31],v[60:63],a[88:95],v2
ds_read_b128 v[84:87],v21 offset:7168
v_smfmac_f32_16x16x64_bf16 v[32:35],v[60:63],a[96:103],v2
buffer_load_dwordx4 v1,s[8:11],s67 offen offset:2048 sc1 lds
v_smfmac_f32_16x16x64_bf16 v[36:39],v[60:63],a[104:111],v2
buffer_load_dwordx4 v1,s[8:11],s67 offen offset:3072 sc1 lds
v_smfmac_f32_16x16x64_bf16 v[40:43],v[60:63],a[112:119],v2
s_add_u32 m0,s74,16384
s_add_u32 s67,s73,25169920
s_waitcnt lgkmcnt(2)
v_smfmac_f32_16x16x64_bf16 v[44:47],v[60:63],v[72:79],v2
ds_read_b128 v[60:63],v4 offset:1024
v_smfmac_f32_16x16x64_bf16 v[24:27],v[64:67],a[120:127],v2
ds_read_b128 v[72:75],v21 offset:8192
v_smfmac_f32_16x16x64_bf16 v[28:31],v[64:67],a[128:135],v2
ds_read_b128 v[76:79],v21 offset:9216
v_smfmac_f32_16x16x64_bf16 v[32:35],v[64:67],a[136:143],v2
v_mov_b32 v17,1
buffer_load_dwordx4 v1,s[8:11],s67 offen sc1 lds
v_smfmac_f32_16x16x64_bf16 v[36:39],v[64:67],a[144:151],v2
s_mov_b64 exec,1
buffer_store_dword v17,v1,s[8:11],s79 offen sc1
s_mov_b64 exec,-1
v_smfmac_f32_16x16x64_bf16 v[40:43],v[64:67],a[152:159],v2
buffer_store_dwordx4 v[100:103],v1,s[8:11],s78 offen sc1
s_waitcnt lgkmcnt(3)
v_smfmac_f32_16x16x64_bf16 v[44:47],v[64:67],v[80:87],v2
ds_read_b128 v[64:67],v5 offset:0
v_smfmac_f32_16x16x64_bf16 v[24:27],v[68:71],a[160:167],v2
ds_read_b128 v[80:83],v21 offset:10240
v_smfmac_f32_16x16x64_bf16 v[28:31],v[68:71],a[168:175],v2
ds_read_b128 v[84:87],v21 offset:11264
v_smfmac_f32_16x16x64_bf16 v[32:35],v[68:71],a[176:183],v2
buffer_store_dwordx4 v[104:107],v1,s[8:11],s78 offen offset:1024 sc1
v_smfmac_f32_16x16x64_bf16 v[36:39],v[68:71],a[184:191],v2
buffer_store_dwordx4 v[108:111],v1,s[8:11],s78 offen offset:2048 sc1
s_and_b32 s79,s78,2147483648
v_smfmac_f32_16x16x64_bf16 v[40:43],v[68:71],a[192:199],v2
s_or_b32 s79,s79,s30
s_mov_b32 s78,2147483648
s_waitcnt lgkmcnt(3)
v_smfmac_f32_16x16x64_bf16 v[44:47],v[68:71],v[72:79],v2
ds_read_b128 v[68:71],v5 offset:1024
v_smfmac_f32_16x16x64_bf16 v[24:27],v[60:63],a[200:207],v2
ds_read_b128 v[72:75],v21 offset:12288
v_smfmac_f32_16x16x64_bf16 v[28:31],v[60:63],a[208:215],v2
ds_read_b128 v[76:79],v21 offset:13312
v_smfmac_f32_16x16x64_bf16 v[32:35],v[60:63],a[216:223],v2
buffer_load_dword v10,v9,s[8:11],s76 offen sc1
v_smfmac_f32_16x16x64_bf16 v[36:39],v[60:63],a[224:231],v2
buffer_load_dwordx4 v1,s[8:11],s67 offen offset:1024 sc1 lds
v_smfmac_f32_16x16x64_bf16 v[40:43],v[60:63],a[232:239],v2
buffer_load_dwordx4 v1,s[8:11],s67 offen offset:2048 sc1 lds
s_waitcnt lgkmcnt(3)
v_smfmac_f32_16x16x64_bf16 v[44:47],v[60:63],v[80:87],v2
ds_read_b128 v[60:63],v59 offset:0
v_smfmac_f32_16x16x64_bf16 v[24:27],v[64:67],a[240:247],v2
ds_read_b128 v[80:83],v21 offset:14336
v_smfmac_f32_16x16x64_bf16 v[28:31],v[64:67],a[248:255],v2
ds_read_b128 v[84:87],v21 offset:15360
v_smfmac_f32_16x16x64_bf16 v[32:35],v[64:67],v[112:119],v2
buffer_load_dwordx4 v1,s[8:11],s67 offen offset:3072 sc1 lds
v_smfmac_f32_16x16x64_bf16 v[36:39],v[64:67],v[120:127],v2
s_add_u32 m0,s74,20480
s_add_u32 s67,s73,25174016
v_smfmac_f32_16x16x64_bf16 v[40:43],v[64:67],v[128:135],v2
buffer_load_dwordx4 v1,s[8:11],s67 offen sc1 lds
s_waitcnt lgkmcnt(3)
v_smfmac_f32_16x16x64_bf16 v[44:47],v[64:67],v[72:79],v2
ds_read_b128 v[64:67],v59 offset:1024
v_smfmac_f32_16x16x64_bf16 v[24:27],v[68:71],v[136:143],v2
ds_read_b128 v[72:75],v21 offset:16384
v_smfmac_f32_16x16x64_bf16 v[28:31],v[68:71],v[144:151],v2
ds_read_b128 v[76:79],v21 offset:17408
v_smfmac_f32_16x16x64_bf16 v[32:35],v[68:71],v[152:159],v2
buffer_load_dwordx4 v1,s[8:11],s67 offen offset:1024 sc1 lds
v_smfmac_f32_16x16x64_bf16 v[36:39],v[68:71],v[160:167],v2
buffer_load_dwordx4 v1,s[8:11],s67 offen offset:2048 sc1 lds
v_smfmac_f32_16x16x64_bf16 v[40:43],v[68:71],v[168:175],v2
buffer_load_dwordx4 v1,s[8:11],s67 offen offset:3072 sc1 lds
s_waitcnt lgkmcnt(3)
v_smfmac_f32_16x16x64_bf16 v[44:47],v[68:71],v[80:87],v2
ds_read_b128 v[80:83],v21 offset:18432
v_smfmac_f32_16x16x64_bf16 v[24:27],v[60:63],v[176:183],v2
ds_read_b128 v[84:87],v21 offset:19456
v_smfmac_f32_16x16x64_bf16 v[36:39],v[60:63],v[200:207],v2
s_waitcnt lgkmcnt(4)
v_smfmac_f32_16x16x64_bf16 v[24:27],v[64:67],v[216:223],v2
v_smfmac_f32_16x16x64_bf16 v[36:39],v[64:67],v[240:247],v2
v_smfmac_f32_16x16x64_bf16 v[28:31],v[60:63],v[184:191],v2
v_smfmac_f32_16x16x64_bf16 v[40:43],v[60:63],v[208:215],v2
v_add_f32 v24,v24,v25
v_smfmac_f32_16x16x64_bf16 v[28:31],v[64:67],v[224:231],v2
v_add_f32 v26,v26,v27
v_smfmac_f32_16x16x64_bf16 v[40:43],v[64:67],v[248:255],v2
v_add_f32 v36,v36,v37
v_smfmac_f32_16x16x64_bf16 v[32:35],v[60:63],v[192:199],v2
v_add_f32 v38,v38,v39
s_waitcnt lgkmcnt(2)
v_smfmac_f32_16x16x64_bf16 v[44:47],v[60:63],v[72:79],v2
v_cvt_pk_bf16_f32 v37,v24,v26
v_smfmac_f32_16x16x64_bf16 v[32:35],v[64:67],v[232:239],v2
v_cvt_pk_bf16_f32 v36,v36,v38
s_waitcnt lgkmcnt(0)
v_smfmac_f32_16x16x64_bf16 v[44:47],v[64:67],v[80:87],v2
ds_write_b64 v6,v[36:37] offset:0
v_add_f32 v28,v28,v29
v_add_f32 v30,v30,v31
v_add_f32 v40,v40,v41
v_add_f32 v42,v42,v43
v_cvt_pk_bf16_f32 v41,v28,v30
v_cvt_pk_bf16_f32 v40,v40,v42
ds_write_b64 v6,v[40:41] offset:512
v_add_f32 v32,v32,v33
v_add_f32 v34,v34,v35
v_add_f32 v44,v44,v45
v_add_f32 v46,v46,v47
v_cvt_pk_bf16_f32 v45,v32,v34
v_cvt_pk_bf16_f32 v44,v44,v46
ds_write_b64 v6,v[44:45] offset:1024
s_waitcnt lgkmcnt(0)
s_barrier
buffer_load_dword v16,v11,s[8:11],s69 offen sc1
s_lshl_b32 s60,s51,6
s_add_u32 s60,s60,s52
s_mul_i32 s78,s60,196608
s_add_u32 s78,s78,s85
s_lshl_b32 s60,s60,10
s_add_u32 s30,s60,s86
s_cmp_ge_u32 s54,63
s_cselect_b32 s77,0,s77
s_cmp_eq_u32 s53,s51
s_cselect_b32 s60,1,s77
s_cmp_eq_u32 s60,0
s_cbranch_scc0 h1_112
h2_113:
s_add_u32 s50,s50,1
s_mov_b32 s51,s53
s_mov_b32 s52,s54
s_mov_b32 s57,s31
s_mov_b32 s58,s32
s_mov_b32 s53,s55
s_mov_b32 s54,s56
s_mov_b32 s75,s76
s_sub_u32 s60,s4,s5
s_cmp_gt_i32 s60,13
s_cselect_b32 s55,1,0
s_cmp_eq_u32 s4,64
s_cselect_b32 s55,1,s55
s_cmp_eq_u32 s55,0
s_cselect_b32 s56,s4,s5
s_addc_u32 s4,s4,0
s_add_u32 s5,s5,s55
s_lshl_b32 s76,s55,6
s_add_u32 s76,s76,s56
s_lshl_b32 s76,s76,9
s_add_u32 s76,s76,131072
s_mul_i32 s73,s54,393216
s_add_u32 s73,s73,s84
s_xor_b32 s74,s74,57344
v_mov_b32 v24,0
v_mov_b32 v25,0
v_mov_b32 v26,0
v_mov_b32 v27,0
v_mov_b32 v28,0
v_mov_b32 v29,0
v_mov_b32 v30,0
v_mov_b32 v31,0
v_mov_b32 v32,0
v_mov_b32 v33,0
v_mov_b32 v34,0
v_mov_b32 v35,0
v_mov_b32 v36,0
v_mov_b32 v37,0
v_mov_b32 v38,0
v_mov_b32 v39,0
v_mov_b32 v40,0
v_mov_b32 v41,0
v_mov_b32 v42,0
v_mov_b32 v43,0
v_mov_b32 v44,0
v_mov_b32 v45,0
v_mov_b32 v46,0
v_mov_b32 v47,0
s_waitcnt vmcnt(0)
v_cmp_eq_u32 vcc,0,v10
s_cmp_lg_u64 vcc,0
s_cselect_b32 s77,1,0
v_cmp_gt_u32 vcc,s58,v16
s_nop 0
s_cbranch_vccz CH_RUNG
s_cmp_lt_u32 s50,128
s_cbranch_scc1 CH_LOOP
s_branch CS_DONE
h1_112:
s_mov_b64 vcc,s[90:91]
ds_read_b64_tr_b16 v[100:101],v7 offset:0
ds_read_b64_tr_b16 v[102:103],v7 offset:512
ds_read_b64_tr_b16 v[48:49],v7 offset:1024
ds_read_b64_tr_b16 v[50:51],v7 offset:1536
ds_read_b64_tr_b16 v[104:105],v7 offset:2048
ds_read_b64_tr_b16 v[106:107],v7 offset:2560
ds_read_b64_tr_b16 v[52:53],v7 offset:3072
ds_read_b64_tr_b16 v[54:55],v7 offset:3584
ds_read_b64_tr_b16 v[108:109],v7 offset:4096
ds_read_b64_tr_b16 v[110:111],v7 offset:4608
ds_read_b64_tr_b16 v[12:13],v7 offset:5120
ds_read_b64_tr_b16 v[14:15],v7 offset:5632
s_waitcnt lgkmcnt(8)
v_cndmask_b32_dpp v100,v48,v100,vcc quad_perm:[0,1,0,1] row_mask:0xf bank_mask:0xf
v_cndmask_b32_dpp v101,v49,v101,vcc quad_perm:[0,1,0,1] row_mask:0xf bank_mask:0xf
v_cndmask_b32_dpp v102,v50,v102,vcc quad_perm:[0,1,0,1] row_mask:0xf bank_mask:0xf
v_cndmask_b32_dpp v103,v51,v103,vcc quad_perm:[0,1,0,1] row_mask:0xf bank_mask:0xf
s_waitcnt lgkmcnt(4)
v_cndmask_b32_dpp v104,v52,v104,vcc quad_perm:[0,1,0,1] row_mask:0xf bank_mask:0xf
v_cndmask_b32_dpp v105,v53,v105,vcc quad_perm:[0,1,0,1] row_mask:0xf bank_mask:0xf
v_cndmask_b32_dpp v106,v54,v106,vcc quad_perm:[0,1,0,1] row_mask:0xf bank_mask:0xf
v_cndmask_b32_dpp v107,v55,v107,vcc quad_perm:[0,1,0,1] row_mask:0xf bank_mask:0xf
s_waitcnt lgkmcnt(0)
v_cndmask_b32_dpp v108,v12,v108,vcc quad_perm:[0,1,0,1] row_mask:0xf bank_mask:0xf
v_cndmask_b32_dpp v109,v13,v109,vcc quad_perm:[0,1,0,1] row_mask:0xf bank_mask:0xf
v_cndmask_b32_dpp v110,v14,v110,vcc quad_perm:[0,1,0,1] row_mask:0xf bank_mask:0xf
v_cndmask_b32_dpp v111,v15,v111,vcc quad_perm:[0,1,0,1] row_mask:0xf bank_mask:0xf
s_cmp_eq_u32 s50,127
s_cbranch_scc1 sp_114x
sp_114:
ds_read_b32 v12,v8
s_waitcnt lgkmcnt(0)
v_cmp_ge_u32 vcc,s50,v12
s_nop 0
s_cbranch_vccz ok_115
s_sleep 1
s_sub_u32 s47,s47,1
s_cbranch_scc1 ABORT
s_branch sp_114
ok_115:
sp_114x:
s_waitcnt vmcnt(0)
s_cmp_ge_u32 s79,2147483648
s_cbranch_scc1 pf_116
v_mov_b32 v17,1
s_mov_b64 exec,1
buffer_store_dword v17,v1,s[8:11],s79 offen sc1
s_mov_b64 exec,-1
s_mov_b32 s79,2147483648
pf_116:
s_cmp_eq_u32 s78,2147483648
s_cbranch_scc1 pk_117
buffer_store_dwordx4 v[100:103],v1,s[8:11],s78 offen sc1
buffer_store_dwordx4 v[104:107],v1,s[8:11],s78 offen offset:1024 sc1
buffer_store_dwordx4 v[108:111],v1,s[8:11],s78 offen offset:2048 sc1
s_mov_b32 s79,s30
s_mov_b32 s78,2147483648
pk_117:
s_waitcnt vmcnt(0)
s_cmp_ge_u32 s79,2147483648
s_cbranch_scc1 pf_118
v_mov_b32 v17,1
s_mov_b64 exec,1
buffer_store_dword v17,v1,s[8:11],s79 offen sc1
s_mov_b64 exec,-1
s_mov_b32 s79,2147483648
pf_118:
s_cmp_eq_u32 s77,0
s_cbranch_scc1 h2_113
fl_119:
buffer_load_dword v12,v9,s[8:11],s75 offen sc1
s_waitcnt vmcnt(0)
v_cmp_eq_u32 vcc,0,v12
s_nop 0
s_cbranch_vccz ok_120
s_sleep 1
s_sub_u32 s47,s47,1
s_cbranch_scc1 ABORT
s_branch fl_119
ok_120:
s_add_u32 m0,s74,0
s_add_u32 s67,s73,0
buffer_load_dwordx4 v1,s[8:11],s67 offen sc1 lds
buffer_load_dwordx4 v1,s[8:11],s67 offen offset:1024 sc1 lds
buffer_load_dwordx4 v1,s[8:11],s67 offen offset:2048 sc1 lds
buffer_load_dwordx4 v1,s[8:11],s67 offen offset:3072 sc1 lds
s_add_u32 m0,s74,4096
s_add_u32 s67,s73,4096
buffer_load_dwordx4 v1,s[8:11],s67 offen sc1 lds
buffer_load_dwordx4 v1,s[8:11],s67 offen offset:1024 sc1 lds
buffer_load_dwordx4 v1,s[8:11],s67 offen offset:2048 sc1 lds
buffer_load_dwordx4 v1,s[8:11],s67 offen offset:3072 sc1 lds
s_add_u32 m0,s74,8192
s_add_u32 s67,s73,8192
buffer_load_dwordx4 v1,s[8:11],s67 offen sc1 lds
buffer_load_dwordx4 v1,s[8:11],s67 offen offset:1024 sc1 lds
buffer_load_dwordx4 v1,s[8:11],s67 offen offset:2048 sc1 lds
buffer_load_dwordx4 v1,s[8:11],s67 offen offset:3072 sc1 lds
s_add_u32 m0,s74,12288
s_add_u32 s67,s73,25165824
buffer_load_dwordx4 v1,s[8:11],s67 offen sc1 lds
buffer_load_dwordx4 v1,s[8:11],s67 offen offset:1024 sc1 lds
buffer_load_dwordx4 v1,s[8:11],s67 offen offset:2048 sc1 lds
buffer_load_dwordx4 v1,s[8:11],s67 offen offset:3072 sc1 lds
s_add_u32 m0,s74,16384
s_add_u32 s67,s73,25169920
buffer_load_dwordx4 v1,s[8:11],s67 offen sc1 lds
buffer_load_dwordx4 v1,s[8:11],s67 offen offset:1024 sc1 lds
buffer_load_dwordx4 v1,s[8:11],s67 offen offset:2048 sc1 lds
buffer_load_dwordx4 v1,s[8:11],s67 offen offset:3072 sc1 lds
s_add_u32 m0,s74,20480
s_add_u32 s67,s73,25174016
buffer_load_dwordx4 v1,s[8:11],s67 offen sc1 lds
buffer_load_dwordx4 v1,s[8:11],s67 offen offset:1024 sc1 lds
buffer_load_dwordx4 v1,s[8:11],s67 offen offset:2048 sc1 lds
buffer_load_dwordx4 v1,s[8:11],s67 offen offset:3072 sc1 lds
s_branch h2_113
fr_108:
v_bitop3_b32 v12,v60,v64,s57 bitop3:0x7e
v_bitop3_b32 v13,v68,v68,s57 bitop3:0x7e
v_xor_b32 v14,s57,v68
v_or3_b32 v12,v12,v13,v14
v_and_b32 v12,1,v12
v_cmp_ne_u32 vcc,0,v12
s_cbranch_vccz sk_121
buffer_load_dwordx2 v[68:69],v18,s[8:11],s59 offen sc1
buffer_load_dwordx4 v[60:63],v1,s[8:11],s59 offen sc1
buffer_load_dwordx4 v[64:67],v1,s[8:11],s59 offen offset:1024 sc1
sk_121:
buffer_load_dwordx2 v[78:79],v18,s[8:11],s68 offen sc1
buffer_load_dwordx4 v[70:73],v1,s[8:11],s68 offen sc1
buffer_load_dwordx4 v[74:77],v1,s[8:11],s68 offen offset:1024 sc1
s_sub_u32 s47,s47,1
s_cbranch_scc1 ABORT
s_waitcnt lgkmcnt(0)
s_branch fa_107
CH_RUNG:
v_mov_b32 v14,s50
ds_write_b32 v58,v14
buffer_load_dwordx2 v[68:69],v18,s[8:11],s59 offen sc1
buffer_load_dwordx4 v[60:63],v1,s[8:11],s59 offen sc1
buffer_load_dwordx4 v[64:67],v1,s[8:11],s59 offen offset:1024 sc1
fj_109e:
buffer_load_dwordx2 v[78:79],v18,s[8:11],s68 offen sc1
buffer_load_dwordx4 v[70:73],v1,s[8:11],s68 offen sc1
buffer_load_dwordx4 v[74:77],v1,s[8:11],s68 offen offset:1024 sc1
s_mov_b64 vcc,s[90:91]
ds_read_b64_tr_b16 v[100:101],v7 offset:0
ds_read_b64_tr_b16 v[102:103],v7 offset:512
ds_read_b64_tr_b16 v[48:49],v7 offset:1024
ds_read_b64_tr_b16 v[50:51],v7 offset:1536
ds_read_b64_tr_b16 v[104:105],v7 offset:2048
ds_read_b64_tr_b16 v[106:107],v7 offset:2560
ds_read_b64_tr_b16 v[52:53],v7 offset:3072
ds_read_b64_tr_b16 v[54:55],v7 offset:3584
ds_read_b64_tr_b16 v[108:109],v7 offset:4096
ds_read_b64_tr_b16 v[110:111],v7 offset:4608
ds_read_b64_tr_b16 v[12:13],v7 offset:5120
ds_read_b64_tr_b16 v[14:15],v7 offset:5632
s_waitcnt lgkmcnt(8)
v_cndmask_b32_dpp v100,v48,v100,vcc quad_perm:[0,1,0,1] row_mask:0xf bank_mask:0xf
v_cndmask_b32_dpp v101,v49,v101,vcc quad_perm:[0,1,0,1] row_mask:0xf bank_mask:0xf
v_cndmask_b32_dpp v102,v50,v102,vcc quad_perm:[0,1,0,1] row_mask:0xf bank_mask:0xf
v_cndmask_b32_dpp v103,v51,v103,vcc quad_perm:[0,1,0,1] row_mask:0xf bank_mask:0xf
s_waitcnt lgkmcnt(4)
v_cndmask_b32_dpp v104,v52,v104,vcc quad_perm:[0,1,0,1] row_mask:0xf bank_mask:0xf
v_cndmask_b32_dpp v105,v53,v105,vcc quad_perm:[0,1,0,1] row_mask:0xf bank_mask:0xf
v_cndmask_b32_dpp v106,v54,v106,vcc quad_perm:[0,1,0,1] row_mask:0xf bank_mask:0xf
v_cndmask_b32_dpp v107,v55,v107,vcc quad_perm:[0,1,0,1] row_mask:0xf bank_mask:0xf
s_waitcnt lgkmcnt(0)
v_cndmask_b32_dpp v108,v12,v108,vcc quad_perm:[0,1,0,1] row_mask:0xf bank_mask:0xf
v_cndmask_b32_dpp v109,v13,v109,vcc quad_perm:[0,1,0,1] row_mask:0xf bank_mask:0xf
v_cndmask_b32_dpp v110,v14,v110,vcc quad_perm:[0,1,0,1] row_mask:0xf bank_mask:0xf
v_cndmask_b32_dpp v111,v15,v111,vcc quad_perm:[0,1,0,1] row_mask:0xf bank_mask:0xf
s_barrier
s_branch fj_109
CS_DONE:
v_lshrrev_b32 v0,4,v1
s_add_u32 s61,s48,0
s_endpgm
CV_START:
s_and_b32 s60,s46,1
s_lshl1_add_u32 s60,s49,s60
s_cmp_eq_u32 s60,1
s_cbranch_scc1 CV_LOOP_F1
s_cmp_eq_u32 s60,2
s_cbranch_scc1 CV_LOOP_S0
s_cmp_eq_u32 s60,3
s_cbranch_scc1 CV_LOOP_S1
CV_LOOP_F0:
v_mov_b32 v24,0
v_mov_b32 v25,0
v_mov_b32 v26,0
v_mov_b32 v27,0
v_mov_b32 v28,0
v_mov_b32 v29,0
v_mov_b32 v30,0
v_mov_b32 v31,0
v_mov_b32 v32,0
v_mov_b32 v33,0
v_mov_b32 v34,0
v_mov_b32 v35,0
v_mov_b32 v36,0
v_mov_b32 v37,0
v_mov_b32 v38,0
v_mov_b32 v39,0
v_mov_b32 v40,0
v_mov_b32 v41,0
v_mov_b32 v42,0
v_mov_b32 v43,0
v_mov_b32 v44,0
v_mov_b32 v45,0
v_mov_b32 v46,0
v_mov_b32 v47,0
s_cmp_lg_u32 s46,0
s_cbranch_scc1 np_125
db_126:
buffer_load_dword v12,v11,s[8:11],s69 offen sc1
s_waitcnt vmcnt(0)
v_cmp_gt_u32 vcc,s58,v12
s_cbranch_vccz dbok_127
s_sub_u32 s47,s47,1
s_cbranch_scc1 ABORT
s_branch db_126
dbok_127:
np_125:
s_barrier
buffer_load_dwordx2 v[68:69],v18,s[8:11],s59 offen sc1
buffer_load_dwordx4 v[60:63],v1,s[8:11],s59 offen sc1
buffer_load_dwordx4 v[64:67],v1,s[8:11],s59 offen offset:1024 sc1
s_waitcnt vmcnt(2)
s_sleep 3
fj_124f:
buffer_load_dwordx2 v[78:79],v18,s[8:11],s68 offen sc1
buffer_load_dwordx4 v[70:73],v1,s[8:11],s68 offen sc1
buffer_load_dwordx4 v[74:77],v1,s[8:11],s68 offen offset:1024 sc1
fj_124:
fa_122:
s_waitcnt vmcnt(5)
v_lshlrev_b32 v96,16,v68
v_and_b32 v97,0xffff0000,v68
v_lshlrev_b32 v98,16,v69
v_and_b32 v99,0xffff0000,v69
s_waitcnt vmcnt(4)
v_lshlrev_b32 v80,16,v60
v_and_b32 v81,0xffff0000,v60
v_lshlrev_b32 v82,16,v61
v_and_b32 v83,0xffff0000,v61
v_lshlrev_b32 v84,16,v62
v_and_b32 v85,0xffff0000,v62
v_lshlrev_b32 v86,16,v63
v_and_b32 v87,0xffff0000,v63
s_waitcnt vmcnt(3)
v_lshlrev_b32 v88,16,v64
v_and_b32 v89,0xffff0000,v64
v_lshlrev_b32 v90,16,v65
v_and_b32 v91,0xffff0000,v65
v_lshlrev_b32 v92,16,v66
v_and_b32 v93,0xffff0000,v66
v_lshlrev_b32 v94,16,v67
v_and_b32 v95,0xffff0000,v67
s_waitcnt vmcnt(2)
v_dot2c_f32_bf16 v96,s37,v78
v_dot2c_f32_bf16 v97,s81,v78
v_dot2c_f32_bf16 v98,s37,v79
v_dot2c_f32_bf16 v99,s81,v79
v_bitop3_b32 v16,v68,v78,s57 bitop3:0x7e
v_cvt_pk_bf16_f32 v56,v96,v97
s_nop 0
v_cvt_pk_bf16_f32 v57,v98,v99
ds_write_b64 v23,v[56:57]
s_waitcnt vmcnt(1)
v_dot2c_f32_bf16 v80,s37,v70
v_dot2c_f32_bf16 v81,s81,v70
v_dot2c_f32_bf16 v82,s37,v71
v_dot2c_f32_bf16 v83,s81,v71
v_dot2c_f32_bf16 v84,s37,v72
v_dot2c_f32_bf16 v85,s81,v72
v_dot2c_f32_bf16 v86,s37,v73
v_dot2c_f32_bf16 v87,s81,v73
v_bitop3_b32 v17,v60,v70,s57 bitop3:0x7e
v_or_b32 v16,v16,v17
v_cvt_pk_bf16_f32 v48,v80,v81
v_cvt_pk_bf16_f32 v49,v82,v83
v_cvt_pk_bf16_f32 v50,v84,v85
v_cvt_pk_bf16_f32 v51,v86,v87
ds_write_b128 v22,v[48:51] offset:0
s_waitcnt vmcnt(0)
v_dot2c_f32_bf16 v88,s37,v74
v_dot2c_f32_bf16 v89,s81,v74
v_dot2c_f32_bf16 v90,s37,v75
v_dot2c_f32_bf16 v91,s81,v75
v_dot2c_f32_bf16 v92,s37,v76
v_dot2c_f32_bf16 v93,s81,v76
v_dot2c_f32_bf16 v94,s37,v77
v_dot2c_f32_bf16 v95,s81,v77
v_bitop3_b32 v17,v64,v74,s57 bitop3:0x7e
v_bitop3_b32 v16,v16,v17,1 bitop3:0xa8
v_cmp_ne_u32 vcc,0,v16
v_cvt_pk_bf16_f32 v52,v88,v89
v_cvt_pk_bf16_f32 v53,v90,v91
v_cvt_pk_bf16_f32 v54,v92,v93
v_cvt_pk_bf16_f32 v55,v94,v95
ds_write_b128 v22,v[52:55] offset:1024
s_cbranch_vccnz fr_123
fj_124g:
v_smfmac_f32_16x16x64_bf16 v[24:27],v[48:51],a[0:7],v2
ds_read_b128 v[72:75],v21 offset:0
s_and_b32 s60,s52,1
v_smfmac_f32_16x16x64_bf16 v[28:31],v[48:51],a[8:15],v2
ds_read_b128 v[76:79],v21 offset:1024
s_lshl2_add_u32 s60,s51,s60
v_smfmac_f32_16x16x64_bf16 v[32:35],v[48:51],a[16:23],v2
ds_read_b128 v[80:83],v21 offset:2048
s_mul_i32 s60,s60,49152
v_smfmac_f32_16x16x64_bf16 v[36:39],v[48:51],a[24:31],v2
ds_read_b128 v[84:87],v21 offset:3072
s_add_u32 s71,s60,s34
s_waitcnt lgkmcnt(4)
s_barrier
v_smfmac_f32_16x16x64_bf16 v[40:43],v[48:51],a[32:39],v2
ds_read_b128 v[60:63],v3 offset:0
v_smfmac_f32_16x16x64_bf16 v[24:27],v[52:55],a[40:47],v2
ds_read_b128 v[64:67],v3 offset:1024
v_mov_b32 v17,1
v_smfmac_f32_16x16x64_bf16 v[28:31],v[52:55],a[48:55],v2
ds_read_b128 v[68:71],v4 offset:0
v_smfmac_f32_16x16x64_bf16 v[32:35],v[52:55],a[56:63],v2
s_mov_b64 exec,1
buffer_store_dword v17,v1,s[8:11],s79 offen sc1
s_mov_b64 exec,-1
v_smfmac_f32_16x16x64_bf16 v[36:39],v[52:55],a[64:71],v2
buffer_store_dwordx4 v[100:103],v1,s[8:11],s78 offen sc1
v_smfmac_f32_16x16x64_bf16 v[40:43],v[52:55],a[72:79],v2
buffer_store_dwordx2 v[104:105],v8,s[8:11],s78 offen offset:1024 sc1
s_waitcnt lgkmcnt(5)
v_smfmac_f32_16x16x64_bf16 v[44:47],v[48:51],v[72:79],v2
ds_read_b128 v[72:75],v21 offset:4096
s_waitcnt lgkmcnt(4)
v_smfmac_f32_16x16x64_bf16 v[44:47],v[52:55],v[80:87],v2
ds_read_b128 v[76:79],v21 offset:5120
s_waitcnt lgkmcnt(4)
v_smfmac_f32_16x16x64_bf16 v[24:27],v[60:63],a[80:87],v2
ds_read_b128 v[80:83],v21 offset:6144
s_and_b32 s79,s78,2147483648
v_smfmac_f32_16x16x64_bf16 v[28:31],v[60:63],a[88:95],v2
ds_read_b128 v[84:87],v21 offset:7168
s_or_b32 s79,s79,s30
v_smfmac_f32_16x16x64_bf16 v[32:35],v[60:63],a[96:103],v2
s_mov_b32 s78,2147483648
v_smfmac_f32_16x16x64_bf16 v[36:39],v[60:63],a[104:111],v2
v_smfmac_f32_16x16x64_bf16 v[40:43],v[60:63],a[112:119],v2
s_waitcnt lgkmcnt(2)
v_smfmac_f32_16x16x64_bf16 v[44:47],v[60:63],v[72:79],v2
ds_read_b128 v[60:63],v4 offset:1024
v_smfmac_f32_16x16x64_bf16 v[24:27],v[64:67],a[120:127],v2
ds_read_b128 v[72:75],v21 offset:8192
v_smfmac_f32_16x16x64_bf16 v[28:31],v[64:67],a[128:135],v2
ds_read_b128 v[76:79],v21 offset:9216
v_smfmac_f32_16x16x64_bf16 v[32:35],v[64:67],a[136:143],v2
v_smfmac_f32_16x16x64_bf16 v[36:39],v[64:67],a[144:151],v2
v_smfmac_f32_16x16x64_bf16 v[40:43],v[64:67],a[152:159],v2
s_waitcnt lgkmcnt(3)
v_smfmac_f32_16x16x64_bf16 v[44:47],v[64:67],v[80:87],v2
ds_read_b128 v[64:67],v5 offset:0
v_smfmac_f32_16x16x64_bf16 v[24:27],v[68:71],a[160:167],v2
ds_read_b128 v[80:83],v21 offset:10240
v_smfmac_f32_16x16x64_bf16 v[28:31],v[68:71],a[168:175],v2
ds_read_b128 v[84:87],v21 offset:11264
v_smfmac_f32_16x16x64_bf16 v[32:35],v[68:71],a[176:183],v2
v_smfmac_f32_16x16x64_bf16 v[36:39],v[68:71],a[184:191],v2
v_smfmac_f32_16x16x64_bf16 v[40:43],v[68:71],a[192:199],v2
s_waitcnt lgkmcnt(3)
v_smfmac_f32_16x16x64_bf16 v[44:47],v[68:71],v[72:79],v2
ds_read_b128 v[68:71],v5 offset:1024
v_smfmac_f32_16x16x64_bf16 v[24:27],v[60:63],a[200:207],v2
ds_read_b128 v[72:75],v21 offset:12288
v_smfmac_f32_16x16x64_bf16 v[28:31],v[60:63],a[208:215],v2
ds_read_b128 v[76:79],v21 offset:13312
v_smfmac_f32_16x16x64_bf16 v[32:35],v[60:63],a[216:223],v2
v_smfmac_f32_16x16x64_bf16 v[36:39],v[60:63],a[224:231],v2
v_smfmac_f32_16x16x64_bf16 v[40:43],v[60:63],a[232:239],v2
s_waitcnt lgkmcnt(3)
v_smfmac_f32_16x16x64_bf16 v[44:47],v[60:63],v[80:87],v2
ds_read_b128 v[60:63],v59 offset:0
v_smfmac_f32_16x16x64_bf16 v[24:27],v[64:67],a[240:247],v2
ds_read_b128 v[80:83],v21 offset:14336
v_smfmac_f32_16x16x64_bf16 v[28:31],v[64:67],a[248:255],v2
ds_read_b128 v[84:87],v21 offset:15360
v_smfmac_f32_16x16x64_bf16 v[32:35],v[64:67],v[112:119],v2
v_smfmac_f32_16x16x64_bf16 v[36:39],v[64:67],v[120:127],v2
v_smfmac_f32_16x16x64_bf16 v[40:43],v[64:67],v[128:135],v2
s_waitcnt lgkmcnt(3)
v_smfmac_f32_16x16x64_bf16 v[44:47],v[64:67],v[72:79],v2
ds_read_b128 v[64:67],v59 offset:1024
v_smfmac_f32_16x16x64_bf16 v[24:27],v[68:71],v[136:143],v2
ds_read_b128 v[72:75],v21 offset:16384
v_smfmac_f32_16x16x64_bf16 v[28:31],v[68:71],v[144:151],v2
ds_read_b128 v[76:79],v21 offset:17408
v_smfmac_f32_16x16x64_bf16 v[32:35],v[68:71],v[152:159],v2
v_smfmac_f32_16x16x64_bf16 v[36:39],v[68:71],v[160:167],v2
v_smfmac_f32_16x16x64_bf16 v[40:43],v[68:71],v[168:175],v2
s_waitcnt lgkmcnt(3)
v_smfmac_f32_16x16x64_bf16 v[44:47],v[68:71],v[80:87],v2
ds_read_b128 v[80:83],v21 offset:18432
v_smfmac_f32_16x16x64_bf16 v[24:27],v[60:63],v[176:183],v2
ds_read_b128 v[84:87],v21 offset:19456
v_smfmac_f32_16x16x64_bf16 v[28:31],v[60:63],v[184:191],v2
s_waitcnt lgkmcnt(4)
v_smfmac_f32_16x16x64_bf16 v[24:27],v[64:67],v[216:223],v2
v_smfmac_f32_16x16x64_bf16 v[28:31],v[64:67],v[224:231],v2
v_smfmac_f32_16x16x64_bf16 v[32:35],v[60:63],v[192:199],v2
v_smfmac_f32_16x16x64_bf16 v[36:39],v[60:63],v[200:207],v2
v_add_f32 v24,v24,v25
v_smfmac_f32_16x16x64_bf16 v[32:35],v[64:67],v[232:239],v2
v_add_f32 v26,v26,v27
v_smfmac_f32_16x16x64_bf16 v[36:39],v[64:67],v[240:247],v2
v_add_f32 v28,v28,v29
v_smfmac_f32_16x16x64_bf16 v[40:43],v[60:63],v[208:215],v2
v_add_f32 v30,v30,v31
s_waitcnt lgkmcnt(2)
v_smfmac_f32_16x16x64_bf16 v[44:47],v[60:63],v[72:79],v2
v_cvt_pk_bf16_f32 v100,v24,v26
v_smfmac_f32_16x16x64_bf16 v[40:43],v[64:67],v[248:255],v2
v_cvt_pk_bf16_f32 v101,v28,v30
s_waitcnt lgkmcnt(0)
v_smfmac_f32_16x16x64_bf16 v[44:47],v[64:67],v[80:87],v2
v_and_or_b32 v100,v100,-2,s57
v_add_f32 v32,v32,v33
v_add_f32 v34,v34,v35
v_add_f32 v36,v36,v37
v_add_f32 v38,v38,v39
v_cvt_pk_bf16_f32 v102,v32,v34
v_cvt_pk_bf16_f32 v103,v36,v38
v_and_or_b32 v102,v102,-2,s57
buffer_store_dwordx4 v[100:103],v6,s[8:11],s71 offen
v_add_f32 v40,v40,v41
v_add_f32 v42,v42,v43
v_add_f32 v44,v44,v45
v_add_f32 v46,v46,v47
v_cvt_pk_bf16_f32 v104,v40,v42
v_cvt_pk_bf16_f32 v105,v44,v46
v_and_or_b32 v104,v104,-2,s57
buffer_store_dwordx2 v[104:105],v7,s[8:11],s71 offen
s_lshl_b32 s60,s51,6
s_add_u32 s60,s60,s52
s_mul_i32 s78,s60,196608
s_add_u32 s78,s78,s85
s_lshl_b32 s60,s60,10
s_add_u32 s30,s60,s86
s_sub_u32 s60,s4,s5
s_cmp_gt_i32 s60,13
s_cselect_b32 s53,1,0
s_cmp_eq_u32 s4,64
s_cselect_b32 s53,1,s53
s_cmp_eq_u32 s53,0
s_cselect_b32 s54,s4,s5
s_addc_u32 s4,s4,0
s_add_u32 s5,s5,s53
s_and_b32 s60,s54,1
s_lshl2_add_u32 s60,s53,s60
s_lshl_b32 s68,s60,16
s_add_u32 s68,s68,s83
s_mul_i32 s59,s60,20480
s_add_u32 s59,s59,s6
s_lshl_b32 s69,s53,9
s_add_u32 s69,s69,s7
s_bfe_u32 s31,s54,65537
s_add_u32 s32,s54,1
s_cmp_lg_u32 s53,s51
s_cbranch_scc1 nx_128
s_waitcnt vmcnt(0)
s_cmp_ge_u32 s79,2147483648
s_cbranch_scc1 pf_129
v_mov_b32 v17,1
s_mov_b64 exec,1
buffer_store_dword v17,v1,s[8:11],s79 offen sc1
s_mov_b64 exec,-1
s_mov_b32 s79,2147483648
pf_129:
s_cmp_eq_u32 s78,2147483648
s_cbranch_scc1 pk_130
buffer_store_dwordx4 v[100:103],v1,s[8:11],s78 offen sc1
buffer_store_dwordx2 v[104:105],v8,s[8:11],s78 offen offset:1024 sc1
s_mov_b32 s79,s30
s_mov_b32 s78,2147483648
pk_130:
s_waitcnt vmcnt(0)
s_cmp_ge_u32 s79,2147483648
s_cbranch_scc1 pf_131
v_mov_b32 v17,1
s_mov_b64 exec,1
buffer_store_dword v17,v1,s[8:11],s79 offen sc1
s_mov_b64 exec,-1
s_mov_b32 s79,2147483648
pf_131:
nx_128:
s_add_u32 s50,s50,1
s_mov_b32 s51,s53
s_mov_b32 s52,s54
s_mov_b32 s57,s31
s_mov_b32 s58,s32
s_cmp_lt_u32 s50,128
s_cbranch_scc1 CV_LOOP_F0
s_branch CV_DONE
fr_123:
v_bitop3_b32 v12,v60,v64,s57 bitop3:0x7e
v_bitop3_b32 v13,v68,v68,s57 bitop3:0x7e
v_xor_b32 v14,s57,v68
v_or3_b32 v12,v12,v13,v14
v_and_b32 v12,1,v12
v_cmp_ne_u32 vcc,0,v12
s_cbranch_vccz sk_132
buffer_load_dwordx2 v[68:69],v18,s[8:11],s59 offen sc1
buffer_load_dwordx4 v[60:63],v1,s[8:11],s59 offen sc1
buffer_load_dwordx4 v[64:67],v1,s[8:11],s59 offen offset:1024 sc1
sk_132:
buffer_load_dwordx2 v[78:79],v18,s[8:11],s68 offen sc1
buffer_load_dwordx4 v[70:73],v1,s[8:11],s68 offen sc1
buffer_load_dwordx4 v[74:77],v1,s[8:11],s68 offen offset:1024 sc1
s_sub_u32 s47,s47,1
s_cbranch_scc1 ABORT
s_waitcnt lgkmcnt(0)
s_branch fa_122
CV_LOOP_F1:
v_mov_b32 v24,0
v_mov_b32 v25,0
v_mov_b32 v26,0
v_mov_b32 v27,0
v_mov_b32 v28,0
v_mov_b32 v29,0
v_mov_b32 v30,0
v_mov_b32 v31,0
v_mov_b32 v32,0
v_mov_b32 v33,0
v_mov_b32 v34,0
v_mov_b32 v35,0
v_mov_b32 v36,0
v_mov_b32 v37,0
v_mov_b32 v38,0
v_mov_b32 v39,0
v_mov_b32 v40,0
v_mov_b32 v41,0
v_mov_b32 v42,0
v_mov_b32 v43,0
v_mov_b32 v44,0
v_mov_b32 v45,0
v_mov_b32 v46,0
v_mov_b32 v47,0
s_barrier
buffer_load_dwordx2 v[68:69],v18,s[8:11],s59 offen sc1
buffer_load_dwordx4 v[60:63],v1,s[8:11],s59 offen sc1
buffer_load_dwordx4 v[64:67],v1,s[8:11],s59 offen offset:1024 sc1
s_waitcnt vmcnt(2)
s_sleep 3
fj_135f:
buffer_load_dwordx2 v[78:79],v18,s[8:11],s68 offen sc1
buffer_load_dwordx4 v[70:73],v1,s[8:11],s68 offen sc1
buffer_load_dwordx4 v[74:77],v1,s[8:11],s68 offen offset:1024 sc1
fj_135:
fa_133:
s_waitcnt vmcnt(5)
v_lshlrev_b32 v96,16,v68
v_and_b32 v97,0xffff0000,v68
v_lshlrev_b32 v98,16,v69
v_and_b32 v99,0xffff0000,v69
s_waitcnt vmcnt(4)
v_lshlrev_b32 v80,16,v60
v_and_b32 v81,0xffff0000,v60
v_lshlrev_b32 v82,16,v61
v_and_b32 v83,0xffff0000,v61
v_lshlrev_b32 v84,16,v62
v_and_b32 v85,0xffff0000,v62
v_lshlrev_b32 v86,16,v63
v_and_b32 v87,0xffff0000,v63
s_waitcnt vmcnt(3)
v_lshlrev_b32 v88,16,v64
v_and_b32 v89,0xffff0000,v64
v_lshlrev_b32 v90,16,v65
v_and_b32 v91,0xffff0000,v65
v_lshlrev_b32 v92,16,v66
v_and_b32 v93,0xffff0000,v66
v_lshlrev_b32 v94,16,v67
v_and_b32 v95,0xffff0000,v67
s_waitcnt vmcnt(2)
v_dot2c_f32_bf16 v96,s37,v78
v_dot2c_f32_bf16 v97,s81,v78
v_dot2c_f32_bf16 v98,s37,v79
v_dot2c_f32_bf16 v99,s81,v79
v_bitop3_b32 v16,v68,v78,s57 bitop3:0x7e
v_cvt_pk_bf16_f32 v56,v96,v97
s_nop 0
v_cvt_pk_bf16_f32 v57,v98,v99
ds_write_b64 v23,v[56:57]
s_waitcnt vmcnt(1)
v_dot2c_f32_bf16 v80,s37,v70
v_dot2c_f32_bf16 v81,s81,v70
v_dot2c_f32_bf16 v82,s37,v71
v_dot2c_f32_bf16 v83,s81,v71
v_dot2c_f32_bf16 v84,s37,v72
v_dot2c_f32_bf16 v85,s81,v72
v_dot2c_f32_bf16 v86,s37,v73
v_dot2c_f32_bf16 v87,s81,v73
v_bitop3_b32 v17,v60,v70,s57 bitop3:0x7e
v_or_b32 v16,v16,v17
v_cvt_pk_bf16_f32 v48,v80,v81
v_cvt_pk_bf16_f32 v49,v82,v83
v_cvt_pk_bf16_f32 v50,v84,v85
v_cvt_pk_bf16_f32 v51,v86,v87
ds_write_b128 v22,v[48:51] offset:0
s_waitcnt vmcnt(0)
v_dot2c_f32_bf16 v88,s37,v74
v_dot2c_f32_bf16 v89,s81,v74
v_dot2c_f32_bf16 v90,s37,v75
v_dot2c_f32_bf16 v91,s81,v75
v_dot2c_f32_bf16 v92,s37,v76
v_dot2c_f32_bf16 v93,s81,v76
v_dot2c_f32_bf16 v94,s37,v77
v_dot2c_f32_bf16 v95,s81,v77
v_bitop3_b32 v17,v64,v74,s57 bitop3:0x7e
v_bitop3_b32 v16,v16,v17,1 bitop3:0xa8
v_cmp_ne_u32 vcc,0,v16
v_cvt_pk_bf16_f32 v52,v88,v89
v_cvt_pk_bf16_f32 v53,v90,v91
v_cvt_pk_bf16_f32 v54,v92,v93
v_cvt_pk_bf16_f32 v55,v94,v95
ds_write_b128 v22,v[52:55] offset:1024
s_cbranch_vccnz fr_134
fj_135g:
v_smfmac_f32_16x16x64_bf16 v[24:27],v[48:51],a[0:7],v2
ds_read_b128 v[72:75],v21 offset:0
s_and_b32 s60,s52,1
v_smfmac_f32_16x16x64_bf16 v[28:31],v[48:51],a[8:15],v2
ds_read_b128 v[76:79],v21 offset:1024
s_lshl2_add_u32 s60,s51,s60
v_smfmac_f32_16x16x64_bf16 v[32:35],v[48:51],a[16:23],v2
ds_read_b128 v[80:83],v21 offset:2048
s_mul_i32 s60,s60,49152
v_smfmac_f32_16x16x64_bf16 v[36:39],v[48:51],a[24:31],v2
ds_read_b128 v[84:87],v21 offset:3072
s_add_u32 s71,s60,s34
s_waitcnt lgkmcnt(4)
s_barrier
v_smfmac_f32_16x16x64_bf16 v[40:43],v[48:51],a[32:39],v2
ds_read_b128 v[60:63],v3 offset:0
v_smfmac_f32_16x16x64_bf16 v[24:27],v[52:55],a[40:47],v2
ds_read_b128 v[64:67],v3 offset:1024
v_mov_b32 v17,1
v_smfmac_f32_16x16x64_bf16 v[28:31],v[52:55],a[48:55],v2
ds_read_b128 v[68:71],v4 offset:0
v_smfmac_f32_16x16x64_bf16 v[32:35],v[52:55],a[56:63],v2
s_mov_b64 exec,1
buffer_store_dword v17,v1,s[8:11],s79 offen sc1
s_mov_b64 exec,-1
v_smfmac_f32_16x16x64_bf16 v[36:39],v[52:55],a[64:71],v2
buffer_store_dwordx4 v[100:103],v1,s[8:11],s78 offen offset:1536 sc1
v_smfmac_f32_16x16x64_bf16 v[40:43],v[52:55],a[72:79],v2
buffer_store_dwordx2 v[104:105],v8,s[8:11],s78 offen offset:2560 sc1
s_waitcnt lgkmcnt(5)
v_smfmac_f32_16x16x64_bf16 v[44:47],v[48:51],v[72:79],v2
ds_read_b128 v[72:75],v21 offset:4096
s_waitcnt lgkmcnt(4)
v_smfmac_f32_16x16x64_bf16 v[44:47],v[52:55],v[80:87],v2
ds_read_b128 v[76:79],v21 offset:5120
s_waitcnt lgkmcnt(4)
v_smfmac_f32_16x16x64_bf16 v[24:27],v[60:63],a[80:87],v2
ds_read_b128 v[80:83],v21 offset:6144
s_and_b32 s79,s78,2147483648
v_smfmac_f32_16x16x64_bf16 v[28:31],v[60:63],a[88:95],v2
ds_read_b128 v[84:87],v21 offset:7168
s_or_b32 s79,s79,s30
v_smfmac_f32_16x16x64_bf16 v[32:35],v[60:63],a[96:103],v2
s_mov_b32 s78,2147483648
v_smfmac_f32_16x16x64_bf16 v[36:39],v[60:63],a[104:111],v2
v_smfmac_f32_16x16x64_bf16 v[40:43],v[60:63],a[112:119],v2
s_waitcnt lgkmcnt(2)
v_smfmac_f32_16x16x64_bf16 v[44:47],v[60:63],v[72:79],v2
ds_read_b128 v[60:63],v4 offset:1024
v_smfmac_f32_16x16x64_bf16 v[24:27],v[64:67],a[120:127],v2
ds_read_b128 v[72:75],v21 offset:8192
v_smfmac_f32_16x16x64_bf16 v[28:31],v[64:67],a[128:135],v2
ds_read_b128 v[76:79],v21 offset:9216
v_smfmac_f32_16x16x64_bf16 v[32:35],v[64:67],a[136:143],v2
v_smfmac_f32_16x16x64_bf16 v[36:39],v[64:67],a[144:151],v2
v_smfmac_f32_16x16x64_bf16 v[40:43],v[64:67],a[152:159],v2
s_waitcnt lgkmcnt(3)
v_smfmac_f32_16x16x64_bf16 v[44:47],v[64:67],v[80:87],v2
ds_read_b128 v[64:67],v5 offset:0
v_smfmac_f32_16x16x64_bf16 v[24:27],v[68:71],a[160:167],v2
ds_read_b128 v[80:83],v21 offset:10240
v_smfmac_f32_16x16x64_bf16 v[28:31],v[68:71],a[168:175],v2
ds_read_b128 v[84:87],v21 offset:11264
v_smfmac_f32_16x16x64_bf16 v[32:35],v[68:71],a[176:183],v2
v_smfmac_f32_16x16x64_bf16 v[36:39],v[68:71],a[184:191],v2
v_smfmac_f32_16x16x64_bf16 v[40:43],v[68:71],a[192:199],v2
s_waitcnt lgkmcnt(3)
v_smfmac_f32_16x16x64_bf16 v[44:47],v[68:71],v[72:79],v2
ds_read_b128 v[68:71],v5 offset:1024
v_smfmac_f32_16x16x64_bf16 v[24:27],v[60:63],a[200:207],v2
ds_read_b128 v[72:75],v21 offset:12288
v_smfmac_f32_16x16x64_bf16 v[28:31],v[60:63],a[208:215],v2
ds_read_b128 v[76:79],v21 offset:13312
v_smfmac_f32_16x16x64_bf16 v[32:35],v[60:63],a[216:223],v2
v_smfmac_f32_16x16x64_bf16 v[36:39],v[60:63],a[224:231],v2
v_smfmac_f32_16x16x64_bf16 v[40:43],v[60:63],a[232:239],v2
s_waitcnt lgkmcnt(3)
v_smfmac_f32_16x16x64_bf16 v[44:47],v[60:63],v[80:87],v2
ds_read_b128 v[60:63],v59 offset:0
v_smfmac_f32_16x16x64_bf16 v[24:27],v[64:67],a[240:247],v2
ds_read_b128 v[80:83],v21 offset:14336
v_smfmac_f32_16x16x64_bf16 v[28:31],v[64:67],a[248:255],v2
ds_read_b128 v[84:87],v21 offset:15360
v_smfmac_f32_16x16x64_bf16 v[32:35],v[64:67],v[112:119],v2
v_smfmac_f32_16x16x64_bf16 v[36:39],v[64:67],v[120:127],v2
v_smfmac_f32_16x16x64_bf16 v[40:43],v[64:67],v[128:135],v2
s_waitcnt lgkmcnt(3)
v_smfmac_f32_16x16x64_bf16 v[44:47],v[64:67],v[72:79],v2
ds_read_b128 v[64:67],v59 offset:1024
v_smfmac_f32_16x16x64_bf16 v[24:27],v[68:71],v[136:143],v2
ds_read_b128 v[72:75],v21 offset:16384
v_smfmac_f32_16x16x64_bf16 v[28:31],v[68:71],v[144:151],v2
ds_read_b128 v[76:79],v21 offset:17408
v_smfmac_f32_16x16x64_bf16 v[32:35],v[68:71],v[152:159],v2
v_smfmac_f32_16x16x64_bf16 v[36:39],v[68:71],v[160:167],v2
v_smfmac_f32_16x16x64_bf16 v[40:43],v[68:71],v[168:175],v2
s_waitcnt lgkmcnt(3)
v_smfmac_f32_16x16x64_bf16 v[44:47],v[68:71],v[80:87],v2
ds_read_b128 v[80:83],v21 offset:18432
v_smfmac_f32_16x16x64_bf16 v[24:27],v[60:63],v[176:183],v2
ds_read_b128 v[84:87],v21 offset:19456
v_smfmac_f32_16x16x64_bf16 v[28:31],v[60:63],v[184:191],v2
s_waitcnt lgkmcnt(4)
v_smfmac_f32_16x16x64_bf16 v[24:27],v[64:67],v[216:223],v2
v_smfmac_f32_16x16x64_bf16 v[28:31],v[64:67],v[224:231],v2
v_smfmac_f32_16x16x64_bf16 v[32:35],v[60:63],v[192:199],v2
v_smfmac_f32_16x16x64_bf16 v[36:39],v[60:63],v[200:207],v2
v_add_f32 v24,v24,v25
v_smfmac_f32_16x16x64_bf16 v[32:35],v[64:67],v[232:239],v2
v_add_f32 v26,v26,v27
v_smfmac_f32_16x16x64_bf16 v[36:39],v[64:67],v[240:247],v2
v_add_f32 v28,v28,v29
v_smfmac_f32_16x16x64_bf16 v[40:43],v[60:63],v[208:215],v2
v_add_f32 v30,v30,v31
s_waitcnt lgkmcnt(2)
v_smfmac_f32_16x16x64_bf16 v[44:47],v[60:63],v[72:79],v2
v_cvt_pk_bf16_f32 v100,v24,v26
v_smfmac_f32_16x16x64_bf16 v[40:43],v[64:67],v[248:255],v2
v_cvt_pk_bf16_f32 v101,v28,v30
s_waitcnt lgkmcnt(0)
v_smfmac_f32_16x16x64_bf16 v[44:47],v[64:67],v[80:87],v2
v_and_or_b32 v100,v100,-2,s57
buffer_store_dwordx2 v[100:101],v7,s[8:11],s71 offen
v_add_f32 v32,v32,v33
v_add_f32 v34,v34,v35
v_add_f32 v36,v36,v37
v_add_f32 v38,v38,v39
v_cvt_pk_bf16_f32 v102,v32,v34
v_cvt_pk_bf16_f32 v103,v36,v38
v_and_or_b32 v102,v102,-2,s57
v_add_f32 v40,v40,v41
v_add_f32 v42,v42,v43
v_add_f32 v44,v44,v45
v_add_f32 v46,v46,v47
v_cvt_pk_bf16_f32 v104,v40,v42
v_cvt_pk_bf16_f32 v105,v44,v46
v_and_or_b32 v104,v104,-2,s57
buffer_store_dwordx4 v[102:105],v6,s[8:11],s71 offen
s_lshl_b32 s60,s51,6
s_add_u32 s60,s60,s52
s_mul_i32 s78,s60,196608
s_add_u32 s78,s78,s85
s_lshl_b32 s60,s60,10
s_add_u32 s30,s60,s86
s_sub_u32 s60,s4,s5
s_cmp_gt_i32 s60,13
s_cselect_b32 s53,1,0
s_cmp_eq_u32 s4,64
s_cselect_b32 s53,1,s53
s_cmp_eq_u32 s53,0
s_cselect_b32 s54,s4,s5
s_addc_u32 s4,s4,0
s_add_u32 s5,s5,s53
s_and_b32 s60,s54,1
s_lshl2_add_u32 s60,s53,s60
s_lshl_b32 s68,s60,16
s_add_u32 s68,s68,s83
s_mul_i32 s59,s60,20480
s_add_u32 s59,s59,s6
s_lshl_b32 s69,s53,9
s_add_u32 s69,s69,s7
s_bfe_u32 s31,s54,65537
s_add_u32 s32,s54,1
s_cmp_lg_u32 s53,s51
s_cbranch_scc1 nx_136
s_waitcnt vmcnt(0)
s_cmp_ge_u32 s79,2147483648
s_cbranch_scc1 pf_137
v_mov_b32 v17,1
s_mov_b64 exec,1
buffer_store_dword v17,v1,s[8:11],s79 offen sc1
s_mov_b64 exec,-1
s_mov_b32 s79,2147483648
pf_137:
s_cmp_eq_u32 s78,2147483648
s_cbranch_scc1 pk_138
buffer_store_dwordx4 v[100:103],v1,s[8:11],s78 offen offset:1536 sc1
buffer_store_dwordx2 v[104:105],v8,s[8:11],s78 offen offset:2560 sc1
s_mov_b32 s79,s30
s_mov_b32 s78,2147483648
pk_138:
s_waitcnt vmcnt(0)
s_cmp_ge_u32 s79,2147483648
s_cbranch_scc1 pf_139
v_mov_b32 v17,1
s_mov_b64 exec,1
buffer_store_dword v17,v1,s[8:11],s79 offen sc1
s_mov_b64 exec,-1
s_mov_b32 s79,2147483648
pf_139:
nx_136:
s_add_u32 s50,s50,1
s_mov_b32 s51,s53
s_mov_b32 s52,s54
s_mov_b32 s57,s31
s_mov_b32 s58,s32
s_cmp_lt_u32 s50,128
s_cbranch_scc1 CV_LOOP_F1
s_branch CV_DONE
fr_134:
v_bitop3_b32 v12,v60,v64,s57 bitop3:0x7e
v_bitop3_b32 v13,v68,v68,s57 bitop3:0x7e
v_xor_b32 v14,s57,v68
v_or3_b32 v12,v12,v13,v14
v_and_b32 v12,1,v12
v_cmp_ne_u32 vcc,0,v12
s_cbranch_vccz sk_140
buffer_load_dwordx2 v[68:69],v18,s[8:11],s59 offen sc1
buffer_load_dwordx4 v[60:63],v1,s[8:11],s59 offen sc1
buffer_load_dwordx4 v[64:67],v1,s[8:11],s59 offen offset:1024 sc1
sk_140:
buffer_load_dwordx2 v[78:79],v18,s[8:11],s68 offen sc1
buffer_load_dwordx4 v[70:73],v1,s[8:11],s68 offen sc1
buffer_load_dwordx4 v[74:77],v1,s[8:11],s68 offen offset:1024 sc1
s_sub_u32 s47,s47,1
s_cbranch_scc1 ABORT
s_waitcnt lgkmcnt(0)
s_branch fa_133
CV_LOOP_S0:
v_mov_b32 v24,0
v_mov_b32 v25,0
v_mov_b32 v26,0
v_mov_b32 v27,0
v_mov_b32 v28,0
v_mov_b32 v29,0
v_mov_b32 v30,0
v_mov_b32 v31,0
v_mov_b32 v32,0
v_mov_b32 v33,0
v_mov_b32 v34,0
v_mov_b32 v35,0
v_mov_b32 v36,0
v_mov_b32 v37,0
v_mov_b32 v38,0
v_mov_b32 v39,0
v_mov_b32 v40,0
v_mov_b32 v41,0
v_mov_b32 v42,0
v_mov_b32 v43,0
v_mov_b32 v44,0
v_mov_b32 v45,0
v_mov_b32 v46,0
v_mov_b32 v47,0
s_cmp_lg_u32 s46,0
s_cbranch_scc1 np_144
db_145:
buffer_load_dword v12,v11,s[8:11],s69 offen sc1
s_waitcnt vmcnt(0)
v_cmp_gt_u32 vcc,s58,v12
s_cbranch_vccz dbok_146
s_sub_u32 s47,s47,1
s_cbranch_scc1 ABORT
s_branch db_145
dbok_146:
np_144:
s_barrier
buffer_load_dwordx2 v[68:69],v18,s[8:11],s59 offen sc1
buffer_load_dwordx4 v[60:63],v1,s[8:11],s59 offen sc1
buffer_load_dwordx4 v[64:67],v1,s[8:11],s59 offen offset:1024 sc1
s_waitcnt vmcnt(2)
s_sleep 3
fj_143f:
buffer_load_dwordx2 v[78:79],v18,s[8:11],s68 offen sc1
buffer_load_dwordx4 v[70:73],v1,s[8:11],s68 offen sc1
buffer_load_dwordx4 v[74:77],v1,s[8:11],s68 offen offset:1024 sc1
fj_143:
fa_141:
s_waitcnt vmcnt(5)
v_lshlrev_b32 v96,16,v68
v_and_b32 v97,0xffff0000,v68
v_lshlrev_b32 v98,16,v69
v_and_b32 v99,0xffff0000,v69
s_waitcnt vmcnt(4)
v_lshlrev_b32 v80,16,v60
v_and_b32 v81,0xffff0000,v60
v_lshlrev_b32 v82,16,v61
v_and_b32 v83,0xffff0000,v61
v_lshlrev_b32 v84,16,v62
v_and_b32 v85,0xffff0000,v62
v_lshlrev_b32 v86,16,v63
v_and_b32 v87,0xffff0000,v63
s_waitcnt vmcnt(3)
v_lshlrev_b32 v88,16,v64
v_and_b32 v89,0xffff0000,v64
v_lshlrev_b32 v90,16,v65
v_and_b32 v91,0xffff0000,v65
v_lshlrev_b32 v92,16,v66
v_and_b32 v93,0xffff0000,v66
v_lshlrev_b32 v94,16,v67
v_and_b32 v95,0xffff0000,v67
s_waitcnt vmcnt(2)
v_dot2c_f32_bf16 v96,s37,v78
v_dot2c_f32_bf16 v97,s81,v78
v_dot2c_f32_bf16 v98,s37,v79
v_dot2c_f32_bf16 v99,s81,v79
v_bitop3_b32 v16,v68,v78,s57 bitop3:0x7e
v_cvt_pk_bf16_f32 v56,v96,v97
s_nop 0
v_cvt_pk_bf16_f32 v57,v98,v99
ds_write_b64 v23,v[56:57]
s_waitcnt vmcnt(1)
v_dot2c_f32_bf16 v80,s37,v70
v_dot2c_f32_bf16 v81,s81,v70
v_dot2c_f32_bf16 v82,s37,v71
v_dot2c_f32_bf16 v83,s81,v71
v_dot2c_f32_bf16 v84,s37,v72
v_dot2c_f32_bf16 v85,s81,v72
v_dot2c_f32_bf16 v86,s37,v73
v_dot2c_f32_bf16 v87,s81,v73
v_bitop3_b32 v17,v60,v70,s57 bitop3:0x7e
v_or_b32 v16,v16,v17
v_cvt_pk_bf16_f32 v48,v80,v81
v_cvt_pk_bf16_f32 v49,v82,v83
v_cvt_pk_bf16_f32 v50,v84,v85
v_cvt_pk_bf16_f32 v51,v86,v87
ds_write_b128 v22,v[48:51] offset:0
s_waitcnt vmcnt(0)
v_dot2c_f32_bf16 v88,s37,v74
v_dot2c_f32_bf16 v89,s81,v74
v_dot2c_f32_bf16 v90,s37,v75
v_dot2c_f32_bf16 v91,s81,v75
v_dot2c_f32_bf16 v92,s37,v76
v_dot2c_f32_bf16 v93,s81,v76
v_dot2c_f32_bf16 v94,s37,v77
v_dot2c_f32_bf16 v95,s81,v77
v_bitop3_b32 v17,v64,v74,s57 bitop3:0x7e
v_bitop3_b32 v16,v16,v17,1 bitop3:0xa8
v_cmp_ne_u32 vcc,0,v16
v_cvt_pk_bf16_f32 v52,v88,v89
v_cvt_pk_bf16_f32 v53,v90,v91
v_cvt_pk_bf16_f32 v54,v92,v93
v_cvt_pk_bf16_f32 v55,v94,v95
ds_write_b128 v22,v[52:55] offset:1024
s_cbranch_vccnz fr_142
fj_143g:
v_smfmac_f32_16x16x64_bf16 v[24:27],v[48:51],a[0:7],v2
ds_read_b128 v[72:75],v21 offset:0
s_and_b32 s60,s52,1
v_smfmac_f32_16x16x64_bf16 v[28:31],v[48:51],a[8:15],v2
ds_read_b128 v[76:79],v21 offset:1024
s_lshl2_add_u32 s60,s51,s60
v_smfmac_f32_16x16x64_bf16 v[32:35],v[48:51],a[16:23],v2
ds_read_b128 v[80:83],v21 offset:2048
s_mul_i32 s60,s60,49152
v_smfmac_f32_16x16x64_bf16 v[36:39],v[48:51],a[24:31],v2
ds_read_b128 v[84:87],v21 offset:3072
s_add_u32 s71,s60,s34
s_waitcnt lgkmcnt(4)
s_barrier
v_smfmac_f32_16x16x64_bf16 v[40:43],v[48:51],a[32:39],v2
ds_read_b128 v[60:63],v3 offset:0
v_smfmac_f32_16x16x64_bf16 v[24:27],v[52:55],a[40:47],v2
ds_read_b128 v[64:67],v3 offset:1024
v_mov_b32 v17,1
v_smfmac_f32_16x16x64_bf16 v[28:31],v[52:55],a[48:55],v2
ds_read_b128 v[68:71],v4 offset:0
v_smfmac_f32_16x16x64_bf16 v[32:35],v[52:55],a[56:63],v2
s_mov_b64 exec,1
buffer_store_dword v17,v1,s[8:11],s79 offen sc1
s_mov_b64 exec,-1
v_smfmac_f32_16x16x64_bf16 v[36:39],v[52:55],a[64:71],v2
buffer_store_dwordx4 v[100:103],v1,s[8:11],s78 offen sc1
v_smfmac_f32_16x16x64_bf16 v[40:43],v[52:55],a[72:79],v2
buffer_store_dwordx2 v[104:105],v8,s[8:11],s78 offen offset:1024 sc1
s_waitcnt lgkmcnt(5)
v_smfmac_f32_16x16x64_bf16 v[44:47],v[48:51],v[72:79],v2
ds_read_b128 v[72:75],v21 offset:4096
s_waitcnt lgkmcnt(4)
v_smfmac_f32_16x16x64_bf16 v[44:47],v[52:55],v[80:87],v2
ds_read_b128 v[76:79],v21 offset:5120
s_waitcnt lgkmcnt(4)
v_smfmac_f32_16x16x64_bf16 v[24:27],v[60:63],a[80:87],v2
ds_read_b128 v[80:83],v21 offset:6144
s_and_b32 s79,s78,2147483648
v_smfmac_f32_16x16x64_bf16 v[28:31],v[60:63],a[88:95],v2
ds_read_b128 v[84:87],v21 offset:7168
s_or_b32 s79,s79,s30
v_smfmac_f32_16x16x64_bf16 v[32:35],v[60:63],a[96:103],v2
s_mov_b32 s78,2147483648
v_smfmac_f32_16x16x64_bf16 v[36:39],v[60:63],a[104:111],v2
v_smfmac_f32_16x16x64_bf16 v[40:43],v[60:63],a[112:119],v2
s_waitcnt lgkmcnt(2)
v_smfmac_f32_16x16x64_bf16 v[44:47],v[60:63],v[72:79],v2
ds_read_b128 v[60:63],v4 offset:1024
v_smfmac_f32_16x16x64_bf16 v[24:27],v[64:67],a[120:127],v2
ds_read_b128 v[72:75],v21 offset:8192
v_smfmac_f32_16x16x64_bf16 v[28:31],v[64:67],a[128:135],v2
ds_read_b128 v[76:79],v21 offset:9216
v_smfmac_f32_16x16x64_bf16 v[32:35],v[64:67],a[136:143],v2
v_smfmac_f32_16x16x64_bf16 v[36:39],v[64:67],a[144:151],v2
v_smfmac_f32_16x16x64_bf16 v[40:43],v[64:67],a[152:159],v2
s_waitcnt lgkmcnt(3)
v_smfmac_f32_16x16x64_bf16 v[44:47],v[64:67],v[80:87],v2
ds_read_b128 v[64:67],v5 offset:0
v_smfmac_f32_16x16x64_bf16 v[24:27],v[68:71],a[160:167],v2
ds_read_b128 v[80:83],v21 offset:10240
v_smfmac_f32_16x16x64_bf16 v[28:31],v[68:71],a[168:175],v2
ds_read_b128 v[84:87],v21 offset:11264
v_smfmac_f32_16x16x64_bf16 v[32:35],v[68:71],a[176:183],v2
v_smfmac_f32_16x16x64_bf16 v[36:39],v[68:71],a[184:191],v2
v_smfmac_f32_16x16x64_bf16 v[40:43],v[68:71],a[192:199],v2
s_waitcnt lgkmcnt(3)
v_smfmac_f32_16x16x64_bf16 v[44:47],v[68:71],v[72:79],v2
ds_read_b128 v[68:71],v5 offset:1024
v_smfmac_f32_16x16x64_bf16 v[24:27],v[60:63],a[200:207],v2
ds_read_b128 v[72:75],v21 offset:12288
v_smfmac_f32_16x16x64_bf16 v[28:31],v[60:63],a[208:215],v2
ds_read_b128 v[76:79],v21 offset:13312
v_smfmac_f32_16x16x64_bf16 v[32:35],v[60:63],a[216:223],v2
v_smfmac_f32_16x16x64_bf16 v[36:39],v[60:63],a[224:231],v2
v_smfmac_f32_16x16x64_bf16 v[40:43],v[60:63],a[232:239],v2
s_waitcnt lgkmcnt(3)
v_smfmac_f32_16x16x64_bf16 v[44:47],v[60:63],v[80:87],v2
ds_read_b128 v[60:63],v59 offset:0
v_smfmac_f32_16x16x64_bf16 v[24:27],v[64:67],a[240:247],v2
ds_read_b128 v[80:83],v21 offset:14336
v_smfmac_f32_16x16x64_bf16 v[28:31],v[64:67],a[248:255],v2
ds_read_b128 v[84:87],v21 offset:15360
v_smfmac_f32_16x16x64_bf16 v[32:35],v[64:67],v[112:119],v2
v_smfmac_f32_16x16x64_bf16 v[36:39],v[64:67],v[120:127],v2
v_smfmac_f32_16x16x64_bf16 v[40:43],v[64:67],v[128:135],v2
s_waitcnt lgkmcnt(3)
v_smfmac_f32_16x16x64_bf16 v[44:47],v[64:67],v[72:79],v2
ds_read_b128 v[64:67],v59 offset:1024
v_smfmac_f32_16x16x64_bf16 v[24:27],v[68:71],v[136:143],v2
ds_read_b128 v[72:75],v21 offset:16384
v_smfmac_f32_16x16x64_bf16 v[28:31],v[68:71],v[144:151],v2
ds_read_b128 v[76:79],v21 offset:17408
v_smfmac_f32_16x16x64_bf16 v[32:35],v[68:71],v[152:159],v2
v_smfmac_f32_16x16x64_bf16 v[36:39],v[68:71],v[160:167],v2
v_smfmac_f32_16x16x64_bf16 v[40:43],v[68:71],v[168:175],v2
s_waitcnt lgkmcnt(3)
v_smfmac_f32_16x16x64_bf16 v[44:47],v[68:71],v[80:87],v2
ds_read_b128 v[80:83],v21 offset:18432
v_smfmac_f32_16x16x64_bf16 v[24:27],v[60:63],v[176:183],v2
ds_read_b128 v[84:87],v21 offset:19456
v_smfmac_f32_16x16x64_bf16 v[28:31],v[60:63],v[184:191],v2
s_waitcnt lgkmcnt(4)
v_smfmac_f32_16x16x64_bf16 v[24:27],v[64:67],v[216:223],v2
v_smfmac_f32_16x16x64_bf16 v[28:31],v[64:67],v[224:231],v2
v_smfmac_f32_16x16x64_bf16 v[32:35],v[60:63],v[192:199],v2
v_smfmac_f32_16x16x64_bf16 v[36:39],v[60:63],v[200:207],v2
v_add_f32 v24,v24,v25
v_smfmac_f32_16x16x64_bf16 v[32:35],v[64:67],v[232:239],v2
v_add_f32 v26,v26,v27
v_smfmac_f32_16x16x64_bf16 v[36:39],v[64:67],v[240:247],v2
v_add_f32 v28,v28,v29
v_smfmac_f32_16x16x64_bf16 v[40:43],v[60:63],v[208:215],v2
v_add_f32 v30,v30,v31
s_waitcnt lgkmcnt(2)
v_smfmac_f32_16x16x64_bf16 v[44:47],v[60:63],v[72:79],v2
v_cvt_pk_bf16_f32 v100,v24,v26
v_smfmac_f32_16x16x64_bf16 v[40:43],v[64:67],v[248:255],v2
v_cvt_pk_bf16_f32 v101,v28,v30
s_waitcnt lgkmcnt(0)
v_smfmac_f32_16x16x64_bf16 v[44:47],v[64:67],v[80:87],v2
v_and_or_b32 v100,v100,-2,s57
v_add_f32 v32,v32,v33
v_add_f32 v34,v34,v35
v_add_f32 v36,v36,v37
v_add_f32 v38,v38,v39
v_cvt_pk_bf16_f32 v102,v32,v34
v_cvt_pk_bf16_f32 v103,v36,v38
v_and_or_b32 v102,v102,-2,s57
buffer_store_dwordx4 v[100:103],v6,s[8:11],s71 offen sc1
v_add_f32 v40,v40,v41
v_add_f32 v42,v42,v43
v_add_f32 v44,v44,v45
v_add_f32 v46,v46,v47
v_cvt_pk_bf16_f32 v104,v40,v42
v_cvt_pk_bf16_f32 v105,v44,v46
v_and_or_b32 v104,v104,-2,s57
buffer_store_dwordx2 v[104:105],v7,s[8:11],s71 offen sc1
s_lshl_b32 s60,s51,6
s_add_u32 s60,s60,s52
s_mul_i32 s78,s60,196608
s_add_u32 s78,s78,s85
s_lshl_b32 s60,s60,10
s_add_u32 s30,s60,s86
s_sub_u32 s60,s4,s5
s_cmp_gt_i32 s60,13
s_cselect_b32 s53,1,0
s_cmp_eq_u32 s4,64
s_cselect_b32 s53,1,s53
s_cmp_eq_u32 s53,0
s_cselect_b32 s54,s4,s5
s_addc_u32 s4,s4,0
s_add_u32 s5,s5,s53
s_and_b32 s60,s54,1
s_lshl2_add_u32 s60,s53,s60
s_lshl_b32 s68,s60,16
s_add_u32 s68,s68,s83
s_mul_i32 s59,s60,20480
s_add_u32 s59,s59,s6
s_lshl_b32 s69,s53,9
s_add_u32 s69,s69,s7
s_bfe_u32 s31,s54,65537
s_add_u32 s32,s54,1
s_cmp_lg_u32 s53,s51
s_cbranch_scc1 nx_147
s_waitcnt vmcnt(0)
s_cmp_ge_u32 s79,2147483648
s_cbranch_scc1 pf_148
v_mov_b32 v17,1
s_mov_b64 exec,1
buffer_store_dword v17,v1,s[8:11],s79 offen sc1
s_mov_b64 exec,-1
s_mov_b32 s79,2147483648
pf_148:
s_cmp_eq_u32 s78,2147483648
s_cbranch_scc1 pk_149
buffer_store_dwordx4 v[100:103],v1,s[8:11],s78 offen sc1
buffer_store_dwordx2 v[104:105],v8,s[8:11],s78 offen offset:1024 sc1
s_mov_b32 s79,s30
s_mov_b32 s78,2147483648
pk_149:
s_waitcnt vmcnt(0)
s_cmp_ge_u32 s79,2147483648
s_cbranch_scc1 pf_150
v_mov_b32 v17,1
s_mov_b64 exec,1
buffer_store_dword v17,v1,s[8:11],s79 offen sc1
s_mov_b64 exec,-1
s_mov_b32 s79,2147483648
pf_150:
nx_147:
s_add_u32 s50,s50,1
s_mov_b32 s51,s53
s_mov_b32 s52,s54
s_mov_b32 s57,s31
s_mov_b32 s58,s32
s_cmp_lt_u32 s50,128
s_cbranch_scc1 CV_LOOP_S0
s_branch CV_DONE
fr_142:
v_bitop3_b32 v12,v60,v64,s57 bitop3:0x7e
v_bitop3_b32 v13,v68,v68,s57 bitop3:0x7e
v_xor_b32 v14,s57,v68
v_or3_b32 v12,v12,v13,v14
v_and_b32 v12,1,v12
v_cmp_ne_u32 vcc,0,v12
s_cbranch_vccz sk_151
buffer_load_dwordx2 v[68:69],v18,s[8:11],s59 offen sc1
buffer_load_dwordx4 v[60:63],v1,s[8:11],s59 offen sc1
buffer_load_dwordx4 v[64:67],v1,s[8:11],s59 offen offset:1024 sc1
sk_151:
buffer_load_dwordx2 v[78:79],v18,s[8:11],s68 offen sc1
buffer_load_dwordx4 v[70:73],v1,s[8:11],s68 offen sc1
buffer_load_dwordx4 v[74:77],v1,s[8:11],s68 offen offset:1024 sc1
s_sub_u32 s47,s47,1
s_cbranch_scc1 ABORT
s_waitcnt lgkmcnt(0)
s_branch fa_141
CV_LOOP_S1:
v_mov_b32 v24,0
v_mov_b32 v25,0
v_mov_b32 v26,0
v_mov_b32 v27,0
v_mov_b32 v28,0
v_mov_b32 v29,0
v_mov_b32 v30,0
v_mov_b32 v31,0
v_mov_b32 v32,0
v_mov_b32 v33,0
v_mov_b32 v34,0
v_mov_b32 v35,0
v_mov_b32 v36,0
v_mov_b32 v37,0
v_mov_b32 v38,0
v_mov_b32 v39,0
v_mov_b32 v40,0
v_mov_b32 v41,0
v_mov_b32 v42,0
v_mov_b32 v43,0
v_mov_b32 v44,0
v_mov_b32 v45,0
v_mov_b32 v46,0
v_mov_b32 v47,0
s_barrier
buffer_load_dwordx2 v[68:69],v18,s[8:11],s59 offen sc1
buffer_load_dwordx4 v[60:63],v1,s[8:11],s59 offen sc1
buffer_load_dwordx4 v[64:67],v1,s[8:11],s59 offen offset:1024 sc1
s_waitcnt vmcnt(2)
s_sleep 3
fj_154f:
buffer_load_dwordx2 v[78:79],v18,s[8:11],s68 offen sc1
buffer_load_dwordx4 v[70:73],v1,s[8:11],s68 offen sc1
buffer_load_dwordx4 v[74:77],v1,s[8:11],s68 offen offset:1024 sc1
fj_154:
fa_152:
s_waitcnt vmcnt(5)
v_lshlrev_b32 v96,16,v68
v_and_b32 v97,0xffff0000,v68
v_lshlrev_b32 v98,16,v69
v_and_b32 v99,0xffff0000,v69
s_waitcnt vmcnt(4)
v_lshlrev_b32 v80,16,v60
v_and_b32 v81,0xffff0000,v60
v_lshlrev_b32 v82,16,v61
v_and_b32 v83,0xffff0000,v61
v_lshlrev_b32 v84,16,v62
v_and_b32 v85,0xffff0000,v62
v_lshlrev_b32 v86,16,v63
v_and_b32 v87,0xffff0000,v63
s_waitcnt vmcnt(3)
v_lshlrev_b32 v88,16,v64
v_and_b32 v89,0xffff0000,v64
v_lshlrev_b32 v90,16,v65
v_and_b32 v91,0xffff0000,v65
v_lshlrev_b32 v92,16,v66
v_and_b32 v93,0xffff0000,v66
v_lshlrev_b32 v94,16,v67
v_and_b32 v95,0xffff0000,v67
s_waitcnt vmcnt(2)
v_dot2c_f32_bf16 v96,s37,v78
v_dot2c_f32_bf16 v97,s81,v78
v_dot2c_f32_bf16 v98,s37,v79
v_dot2c_f32_bf16 v99,s81,v79
v_bitop3_b32 v16,v68,v78,s57 bitop3:0x7e
v_cvt_pk_bf16_f32 v56,v96,v97
s_nop 0
v_cvt_pk_bf16_f32 v57,v98,v99
ds_write_b64 v23,v[56:57]
s_waitcnt vmcnt(1)
v_dot2c_f32_bf16 v80,s37,v70
v_dot2c_f32_bf16 v81,s81,v70
v_dot2c_f32_bf16 v82,s37,v71
v_dot2c_f32_bf16 v83,s81,v71
v_dot2c_f32_bf16 v84,s37,v72
v_dot2c_f32_bf16 v85,s81,v72
v_dot2c_f32_bf16 v86,s37,v73
v_dot2c_f32_bf16 v87,s81,v73
v_bitop3_b32 v17,v60,v70,s57 bitop3:0x7e
v_or_b32 v16,v16,v17
v_cvt_pk_bf16_f32 v48,v80,v81
v_cvt_pk_bf16_f32 v49,v82,v83
v_cvt_pk_bf16_f32 v50,v84,v85
v_cvt_pk_bf16_f32 v51,v86,v87
ds_write_b128 v22,v[48:51] offset:0
s_waitcnt vmcnt(0)
v_dot2c_f32_bf16 v88,s37,v74
v_dot2c_f32_bf16 v89,s81,v74
v_dot2c_f32_bf16 v90,s37,v75
v_dot2c_f32_bf16 v91,s81,v75
v_dot2c_f32_bf16 v92,s37,v76
v_dot2c_f32_bf16 v93,s81,v76
v_dot2c_f32_bf16 v94,s37,v77
v_dot2c_f32_bf16 v95,s81,v77
v_bitop3_b32 v17,v64,v74,s57 bitop3:0x7e
v_bitop3_b32 v16,v16,v17,1 bitop3:0xa8
v_cmp_ne_u32 vcc,0,v16
v_cvt_pk_bf16_f32 v52,v88,v89
v_cvt_pk_bf16_f32 v53,v90,v91
v_cvt_pk_bf16_f32 v54,v92,v93
v_cvt_pk_bf16_f32 v55,v94,v95
ds_write_b128 v22,v[52:55] offset:1024
s_cbranch_vccnz fr_153
fj_154g:
v_smfmac_f32_16x16x64_bf16 v[24:27],v[48:51],a[0:7],v2
ds_read_b128 v[72:75],v21 offset:0
s_and_b32 s60,s52,1
v_smfmac_f32_16x16x64_bf16 v[28:31],v[48:51],a[8:15],v2
ds_read_b128 v[76:79],v21 offset:1024
s_lshl2_add_u32 s60,s51,s60
v_smfmac_f32_16x16x64_bf16 v[32:35],v[48:51],a[16:23],v2
ds_read_b128 v[80:83],v21 offset:2048
s_mul_i32 s60,s60,49152
v_smfmac_f32_16x16x64_bf16 v[36:39],v[48:51],a[24:31],v2
ds_read_b128 v[84:87],v21 offset:3072
s_add_u32 s71,s60,s34
s_waitcnt lgkmcnt(4)
s_barrier
v_smfmac_f32_16x16x64_bf16 v[40:43],v[48:51],a[32:39],v2
ds_read_b128 v[60:63],v3 offset:0
v_smfmac_f32_16x16x64_bf16 v[24:27],v[52:55],a[40:47],v2
ds_read_b128 v[64:67],v3 offset:1024
v_mov_b32 v17,1
v_smfmac_f32_16x16x64_bf16 v[28:31],v[52:55],a[48:55],v2
ds_read_b128 v[68:71],v4 offset:0
v_smfmac_f32_16x16x64_bf16 v[32:35],v[52:55],a[56:63],v2
s_mov_b64 exec,1
buffer_store_dword v17,v1,s[8:11],s79 offen sc1
s_mov_b64 exec,-1
v_smfmac_f32_16x16x64_bf16 v[36:39],v[52:55],a[64:71],v2
buffer_store_dwordx4 v[100:103],v1,s[8:11],s78 offen offset:1536 sc1
v_smfmac_f32_16x16x64_bf16 v[40:43],v[52:55],a[72:79],v2
buffer_store_dwordx2 v[104:105],v8,s[8:11],s78 offen offset:2560 sc1
s_waitcnt lgkmcnt(5)
v_smfmac_f32_16x16x64_bf16 v[44:47],v[48:51],v[72:79],v2
ds_read_b128 v[72:75],v21 offset:4096
s_waitcnt lgkmcnt(4)
v_smfmac_f32_16x16x64_bf16 v[44:47],v[52:55],v[80:87],v2
ds_read_b128 v[76:79],v21 offset:5120
s_waitcnt lgkmcnt(4)
v_smfmac_f32_16x16x64_bf16 v[24:27],v[60:63],a[80:87],v2
ds_read_b128 v[80:83],v21 offset:6144
s_and_b32 s79,s78,2147483648
v_smfmac_f32_16x16x64_bf16 v[28:31],v[60:63],a[88:95],v2
ds_read_b128 v[84:87],v21 offset:7168
s_or_b32 s79,s79,s30
v_smfmac_f32_16x16x64_bf16 v[32:35],v[60:63],a[96:103],v2
s_mov_b32 s78,2147483648
v_smfmac_f32_16x16x64_bf16 v[36:39],v[60:63],a[104:111],v2
v_smfmac_f32_16x16x64_bf16 v[40:43],v[60:63],a[112:119],v2
s_waitcnt lgkmcnt(2)
v_smfmac_f32_16x16x64_bf16 v[44:47],v[60:63],v[72:79],v2
ds_read_b128 v[60:63],v4 offset:1024
v_smfmac_f32_16x16x64_bf16 v[24:27],v[64:67],a[120:127],v2
ds_read_b128 v[72:75],v21 offset:8192
v_smfmac_f32_16x16x64_bf16 v[28:31],v[64:67],a[128:135],v2
ds_read_b128 v[76:79],v21 offset:9216
v_smfmac_f32_16x16x64_bf16 v[32:35],v[64:67],a[136:143],v2
v_smfmac_f32_16x16x64_bf16 v[36:39],v[64:67],a[144:151],v2
v_smfmac_f32_16x16x64_bf16 v[40:43],v[64:67],a[152:159],v2
s_waitcnt lgkmcnt(3)
v_smfmac_f32_16x16x64_bf16 v[44:47],v[64:67],v[80:87],v2
ds_read_b128 v[64:67],v5 offset:0
v_smfmac_f32_16x16x64_bf16 v[24:27],v[68:71],a[160:167],v2
ds_read_b128 v[80:83],v21 offset:10240
v_smfmac_f32_16x16x64_bf16 v[28:31],v[68:71],a[168:175],v2
ds_read_b128 v[84:87],v21 offset:11264
v_smfmac_f32_16x16x64_bf16 v[32:35],v[68:71],a[176:183],v2
v_smfmac_f32_16x16x64_bf16 v[36:39],v[68:71],a[184:191],v2
v_smfmac_f32_16x16x64_bf16 v[40:43],v[68:71],a[192:199],v2
s_waitcnt lgkmcnt(3)
v_smfmac_f32_16x16x64_bf16 v[44:47],v[68:71],v[72:79],v2
ds_read_b128 v[68:71],v5 offset:1024
v_smfmac_f32_16x16x64_bf16 v[24:27],v[60:63],a[200:207],v2
ds_read_b128 v[72:75],v21 offset:12288
v_smfmac_f32_16x16x64_bf16 v[28:31],v[60:63],a[208:215],v2
ds_read_b128 v[76:79],v21 offset:13312
v_smfmac_f32_16x16x64_bf16 v[32:35],v[60:63],a[216:223],v2
v_smfmac_f32_16x16x64_bf16 v[36:39],v[60:63],a[224:231],v2
v_smfmac_f32_16x16x64_bf16 v[40:43],v[60:63],a[232:239],v2
s_waitcnt lgkmcnt(3)
v_smfmac_f32_16x16x64_bf16 v[44:47],v[60:63],v[80:87],v2
ds_read_b128 v[60:63],v59 offset:0
v_smfmac_f32_16x16x64_bf16 v[24:27],v[64:67],a[240:247],v2
ds_read_b128 v[80:83],v21 offset:14336
v_smfmac_f32_16x16x64_bf16 v[28:31],v[64:67],a[248:255],v2
ds_read_b128 v[84:87],v21 offset:15360
v_smfmac_f32_16x16x64_bf16 v[32:35],v[64:67],v[112:119],v2
v_smfmac_f32_16x16x64_bf16 v[36:39],v[64:67],v[120:127],v2
v_smfmac_f32_16x16x64_bf16 v[40:43],v[64:67],v[128:135],v2
s_waitcnt lgkmcnt(3)
v_smfmac_f32_16x16x64_bf16 v[44:47],v[64:67],v[72:79],v2
ds_read_b128 v[64:67],v59 offset:1024
v_smfmac_f32_16x16x64_bf16 v[24:27],v[68:71],v[136:143],v2
ds_read_b128 v[72:75],v21 offset:16384
v_smfmac_f32_16x16x64_bf16 v[28:31],v[68:71],v[144:151],v2
ds_read_b128 v[76:79],v21 offset:17408
v_smfmac_f32_16x16x64_bf16 v[32:35],v[68:71],v[152:159],v2
v_smfmac_f32_16x16x64_bf16 v[36:39],v[68:71],v[160:167],v2
v_smfmac_f32_16x16x64_bf16 v[40:43],v[68:71],v[168:175],v2
s_waitcnt lgkmcnt(3)
v_smfmac_f32_16x16x64_bf16 v[44:47],v[68:71],v[80:87],v2
ds_read_b128 v[80:83],v21 offset:18432
v_smfmac_f32_16x16x64_bf16 v[24:27],v[60:63],v[176:183],v2
ds_read_b128 v[84:87],v21 offset:19456
v_smfmac_f32_16x16x64_bf16 v[28:31],v[60:63],v[184:191],v2
s_waitcnt lgkmcnt(4)
v_smfmac_f32_16x16x64_bf16 v[24:27],v[64:67],v[216:223],v2
v_smfmac_f32_16x16x64_bf16 v[28:31],v[64:67],v[224:231],v2
v_smfmac_f32_16x16x64_bf16 v[32:35],v[60:63],v[192:199],v2
v_smfmac_f32_16x16x64_bf16 v[36:39],v[60:63],v[200:207],v2
v_add_f32 v24,v24,v25
v_smfmac_f32_16x16x64_bf16 v[32:35],v[64:67],v[232:239],v2
v_add_f32 v26,v26,v27
v_smfmac_f32_16x16x64_bf16 v[36:39],v[64:67],v[240:247],v2
v_add_f32 v28,v28,v29
v_smfmac_f32_16x16x64_bf16 v[40:43],v[60:63],v[208:215],v2
v_add_f32 v30,v30,v31
s_waitcnt lgkmcnt(2)
v_smfmac_f32_16x16x64_bf16 v[44:47],v[60:63],v[72:79],v2
v_cvt_pk_bf16_f32 v100,v24,v26
v_smfmac_f32_16x16x64_bf16 v[40:43],v[64:67],v[248:255],v2
v_cvt_pk_bf16_f32 v101,v28,v30
s_waitcnt lgkmcnt(0)
v_smfmac_f32_16x16x64_bf16 v[44:47],v[64:67],v[80:87],v2
v_and_or_b32 v100,v100,-2,s57
buffer_store_dwordx2 v[100:101],v7,s[8:11],s71 offen sc1
v_add_f32 v32,v32,v33
v_add_f32 v34,v34,v35
v_add_f32 v36,v36,v37
v_add_f32 v38,v38,v39
v_cvt_pk_bf16_f32 v102,v32,v34
v_cvt_pk_bf16_f32 v103,v36,v38
v_and_or_b32 v102,v102,-2,s57
v_add_f32 v40,v40,v41
v_add_f32 v42,v42,v43
v_add_f32 v44,v44,v45
v_add_f32 v46,v46,v47
v_cvt_pk_bf16_f32 v104,v40,v42
v_cvt_pk_bf16_f32 v105,v44,v46
v_and_or_b32 v104,v104,-2,s57
buffer_store_dwordx4 v[102:105],v6,s[8:11],s71 offen sc1
s_lshl_b32 s60,s51,6
s_add_u32 s60,s60,s52
s_mul_i32 s78,s60,196608
s_add_u32 s78,s78,s85
s_lshl_b32 s60,s60,10
s_add_u32 s30,s60,s86
s_sub_u32 s60,s4,s5
s_cmp_gt_i32 s60,13
s_cselect_b32 s53,1,0
s_cmp_eq_u32 s4,64
s_cselect_b32 s53,1,s53
s_cmp_eq_u32 s53,0
s_cselect_b32 s54,s4,s5
s_addc_u32 s4,s4,0
s_add_u32 s5,s5,s53
s_and_b32 s60,s54,1
s_lshl2_add_u32 s60,s53,s60
s_lshl_b32 s68,s60,16
s_add_u32 s68,s68,s83
s_mul_i32 s59,s60,20480
s_add_u32 s59,s59,s6
s_lshl_b32 s69,s53,9
s_add_u32 s69,s69,s7
s_bfe_u32 s31,s54,65537
s_add_u32 s32,s54,1
s_cmp_lg_u32 s53,s51
s_cbranch_scc1 nx_155
s_waitcnt vmcnt(0)
s_cmp_ge_u32 s79,2147483648
s_cbranch_scc1 pf_156
v_mov_b32 v17,1
s_mov_b64 exec,1
buffer_store_dword v17,v1,s[8:11],s79 offen sc1
s_mov_b64 exec,-1
s_mov_b32 s79,2147483648
pf_156:
s_cmp_eq_u32 s78,2147483648
s_cbranch_scc1 pk_157
buffer_store_dwordx4 v[100:103],v1,s[8:11],s78 offen offset:1536 sc1
buffer_store_dwordx2 v[104:105],v8,s[8:11],s78 offen offset:2560 sc1
s_mov_b32 s79,s30
s_mov_b32 s78,2147483648
pk_157:
s_waitcnt vmcnt(0)
s_cmp_ge_u32 s79,2147483648
s_cbranch_scc1 pf_158
v_mov_b32 v17,1
s_mov_b64 exec,1
buffer_store_dword v17,v1,s[8:11],s79 offen sc1
s_mov_b64 exec,-1
s_mov_b32 s79,2147483648
pf_158:
nx_155:
s_add_u32 s50,s50,1
s_mov_b32 s51,s53
s_mov_b32 s52,s54
s_mov_b32 s57,s31
s_mov_b32 s58,s32
s_cmp_lt_u32 s50,128
s_cbranch_scc1 CV_LOOP_S1
s_branch CV_DONE
fr_153:
v_bitop3_b32 v12,v60,v64,s57 bitop3:0x7e
v_bitop3_b32 v13,v68,v68,s57 bitop3:0x7e
v_xor_b32 v14,s57,v68
v_or3_b32 v12,v12,v13,v14
v_and_b32 v12,1,v12
v_cmp_ne_u32 vcc,0,v12
s_cbranch_vccz sk_159
buffer_load_dwordx2 v[68:69],v18,s[8:11],s59 offen sc1
buffer_load_dwordx4 v[60:63],v1,s[8:11],s59 offen sc1
buffer_load_dwordx4 v[64:67],v1,s[8:11],s59 offen offset:1024 sc1
sk_159:
buffer_load_dwordx2 v[78:79],v18,s[8:11],s68 offen sc1
buffer_load_dwordx4 v[70:73],v1,s[8:11],s68 offen sc1
buffer_load_dwordx4 v[74:77],v1,s[8:11],s68 offen offset:1024 sc1
s_sub_u32 s47,s47,1
s_cbranch_scc1 ABORT
s_waitcnt lgkmcnt(0)
s_branch fa_152
CV_DONE:
s_add_u32 s61,s48,32
s_endpgm
ROLE_CW:
s_lshr_b32 s28,s48,3
s_and_b32 s29,s48,7
s_mul_i32 s82,s28,2097152
s_add_u32 s82,s82,2097152
v_lshlrev_b32 v1,4,v0
v_and_b32 v12,1,v0
v_mul_u32_u24 v2,0xaaaa,v12
v_or_b32 v2,0x4444,v2
v_lshrrev_b32 v14,4,v0
v_and_b32 v15,15,v0
v_min_u32 v3,11,v15
v_lshlrev_b32 v3,2,v3
v_lshl_add_u32 v3,v14,7,v3
s_mul_i32 s60,s46,24576
v_add_u32 v4,s60,v1
v_mul_u32_u24 v5,704,v14
v_and_b32 v12,3,v15
v_lshl_add_u32 v5,v12,2,v5
v_bfe_u32 v12,v15,2,1
v_lshl_add_u32 v5,v12,5,v5
v_bfe_u32 v12,v15,3,1
v_lshl_add_u32 v5,v12,4,v5
s_mul_i32 s60,s46,2816
s_add_u32 s60,s60,98304
v_add_u32 v5,s60,v5
s_mul_i32 s60,s46,24
s_min_u32 s60,s60,64
s_cmp_lt_u32 s46,2
s_cselect_b32 s61,23,15
s_mov_b32 s88,0xffff
s_cselect_b32 s88,0xffffff,s88
s_mov_b32 s89,0
v_and_b32 v12,31,v0
v_min_u32 v12,s61,v12
v_add_u32 v12,s60,v12
v_lshrrev_b32 v13,5,v0
v_lshl_add_u32 v12,v12,1,v13
v_bfe_u32 v13,v12,2,3
v_mul_u32_u24 v6,352,v13
v_mul_u32_u24 v17,1280,v13
v_lshrrev_b32 v13,5,v12
v_lshl_add_u32 v6,v13,6,v6
v_lshl_add_u32 v17,v13,5,v17
v_and_b32 v13,3,v12
v_lshl_add_u32 v17,v13,3,v17
v_and_b32 v13,1,v12
v_lshl_add_u32 v6,v13,5,v6
v_bfe_u32 v13,v12,1,1
v_lshl_add_u32 v6,v13,4,v6
v_add_u32 v6,98304,v6
s_mul_i32 s60,s29,1280
v_lshlrev_b32 v9,3,v12
v_add_u32 v9,s60,v9
v_lshrrev_b32 v13,13,v9
v_lshl_add_u32 v9,v13,13,v9
v_xor_b32 v10,1,v12
v_or_b32 v10,v10,v13
v_and_b32 v10,1,v10
s_mov_b32 s4,s18
s_mov_b32 s5,s19
s_mov_b32 s6,10240
s_mov_b32 s7,0x20000
s_mul_i32 s60,s29,160
buffer_load_dwordx2 v[32:33],v17,s[4:7],s60 offen
s_mul_i32 s84,s29,0
s_add_u32 s84,s84,s82
s_lshl_b32 s83,s28,19
s_lshr_b32 s60,s29,1
s_and_b32 s61,s29,1
s_mul_i32 s62,s61,0
s_add_u32 s83,s83,s62
s_add_u32 s83,s83,10485760
s_lshl_b32 s85,s60,7
s_lshl_b32 s61,s61,2
s_add_u32 s61,s61,s46
s_lshl_b32 s61,s61,2
s_add_u32 s85,s85,s61
s_add_u32 s85,s85,s82
s_add_u32 s85,s85,950272
s_mul_i32 s33,s46,12288
s_add_u32 s33,s33,s82
s_add_u32 s33,s33,163840
s_mov_b32 s35,0
s_add_u32 s35,s35,s82
s_add_u32 s35,s35,951296
s_cmp_eq_u32 s28,0
s_cselect_b32 s63,0xffff0000,0
s_waitcnt vmcnt(0)
s_cselect_b64 vcc,-1,0
v_bfi_b32 v36,v10,0,v32
v_lshlrev_b32 v34,16,v32
v_lshlrev_b32 v35,16,v36
v_sub_f32 v34,v34,v35
v_lshrrev_b32 v34,16,v34
v_and_b32 v34,-2,v34
v_cndmask_b32 v36,v34,v36,vcc
v_cndmask_b32 v37,0,v33,vcc
s_nop 0
v_permlane32_swap_b32 v36,v38
v_permlane32_swap_b32 v37,v39
v_mov_b32 v40,-1
v_mov_b32 v41,-1
v_mov_b32 v42,-1
v_mov_b32 v43,-1
v_mov_b32 v44,1
s_mov_b64 exec,s[88:89]
s_add_u32 s60,s83,0
buffer_store_dwordx4 v[36:39],v9,s[8:11],s60 offen sc1
s_add_u32 s60,s83,8192
buffer_store_dwordx4 v[36:39],v9,s[8:11],s60 offen sc1
s_add_u32 s60,s83,65536
buffer_store_dwordx4 v[40:43],v9,s[8:11],s60 offen sc1
s_add_u32 s60,s83,73728
buffer_store_dwordx4 v[40:43],v9,s[8:11],s60 offen sc1
s_add_u32 s60,s83,131072
buffer_store_dwordx4 v[40:43],v9,s[8:11],s60 offen sc1
s_add_u32 s60,s83,139264
buffer_store_dwordx4 v[40:43],v9,s[8:11],s60 offen sc1
s_add_u32 s60,s83,196608
buffer_store_dwordx4 v[40:43],v9,s[8:11],s60 offen sc1
s_add_u32 s60,s83,204800
buffer_store_dwordx4 v[40:43],v9,s[8:11],s60 offen sc1
s_add_u32 s60,s83,262144
buffer_store_dwordx4 v[36:39],v9,s[8:11],s60 offen sc1
s_add_u32 s60,s83,270336
buffer_store_dwordx4 v[36:39],v9,s[8:11],s60 offen sc1
s_add_u32 s60,s83,327680
buffer_store_dwordx4 v[40:43],v9,s[8:11],s60 offen sc1
s_add_u32 s60,s83,335872
buffer_store_dwordx4 v[40:43],v9,s[8:11],s60 offen sc1
s_add_u32 s60,s83,393216
buffer_store_dwordx4 v[40:43],v9,s[8:11],s60 offen sc1
s_add_u32 s60,s83,401408
buffer_store_dwordx4 v[40:43],v9,s[8:11],s60 offen sc1
s_add_u32 s60,s83,458752
buffer_store_dwordx4 v[40:43],v9,s[8:11],s60 offen sc1
s_add_u32 s60,s83,466944
buffer_store_dwordx4 v[40:43],v9,s[8:11],s60 offen sc1
s_cmp_lg_u32 s49,0
s_cbranch_scc1 ls_160
s_add_u32 s60,s84,0
buffer_store_dwordx4 v[36:39],v9,s[8:11],s60 offen
s_add_u32 s60,s84,20480
buffer_store_dwordx4 v[40:43],v9,s[8:11],s60 offen
s_add_u32 s60,s84,40960
buffer_store_dwordx4 v[40:43],v9,s[8:11],s60 offen
s_add_u32 s60,s84,61440
buffer_store_dwordx4 v[40:43],v9,s[8:11],s60 offen
s_add_u32 s60,s84,81920
buffer_store_dwordx4 v[36:39],v9,s[8:11],s60 offen
s_add_u32 s60,s84,102400
buffer_store_dwordx4 v[40:43],v9,s[8:11],s60 offen
s_add_u32 s60,s84,122880
buffer_store_dwordx4 v[40:43],v9,s[8:11],s60 offen
s_add_u32 s60,s84,143360
buffer_store_dwordx4 v[40:43],v9,s[8:11],s60 offen
s_mov_b64 exec,1
buffer_store_dword v44,v1,s[8:11],s85 offen
buffer_store_dword v44,v1,s[8:11],s85 offen offset:512
s_branch ls_161
ls_160:
s_add_u32 s60,s84,0
buffer_store_dwordx4 v[36:39],v9,s[8:11],s60 offen sc1
s_add_u32 s60,s84,20480
buffer_store_dwordx4 v[40:43],v9,s[8:11],s60 offen sc1
s_add_u32 s60,s84,40960
buffer_store_dwordx4 v[40:43],v9,s[8:11],s60 offen sc1
s_add_u32 s60,s84,61440
buffer_store_dwordx4 v[40:43],v9,s[8:11],s60 offen sc1
s_add_u32 s60,s84,81920
buffer_store_dwordx4 v[36:39],v9,s[8:11],s60 offen sc1
s_add_u32 s60,s84,102400
buffer_store_dwordx4 v[40:43],v9,s[8:11],s60 offen sc1
s_add_u32 s60,s84,122880
buffer_store_dwordx4 v[40:43],v9,s[8:11],s60 offen sc1
s_add_u32 s60,s84,143360
buffer_store_dwordx4 v[40:43],v9,s[8:11],s60 offen sc1
s_mov_b64 exec,1
buffer_store_dword v44,v1,s[8:11],s85 offen sc1
buffer_store_dword v44,v1,s[8:11],s85 offen offset:512 sc1
ls_161:
s_mov_b64 exec,-1
s_waitcnt vmcnt(0)
s_barrier
s_cmp_lg_u32 s46,0
s_cbranch_scc1 arr_162
v_mov_b32 v12,1
s_lshl_b32 s3,s49,2
v_mov_b32 v13,s3
s_mov_b64 exec,1
buffer_atomic_add v12,v13,s[12:15],0 offen sc1
s_mov_b64 exec,-1
arr_162:
s_mov_b32 s4,s26
s_mov_b32 s5,s27
s_mov_b32 s6,7864320
s_mov_b32 s7,0x20000
s_lshl_b32 s60,s28,2
s_add_u32 s60,s60,s46
s_mul_i32 s73,s60,983040
s_mul_i32 s60,s29,160
s_add_u32 s73,s73,s60
s_mul_i32 s74,s46,40960
v_add_u32 v12,0,v0
v_mul_u32_u24 v13,6554,v12
v_lshrrev_b32 v13,16,v13
v_mul_u32_u24 v16,10,v13
v_sub_u32 v12,v12,v16
v_mul_u32_u24 v20,1280,v13
v_lshl_add_u32 v20,v12,4,v20
v_add_u32 v12,64,v0
v_mul_u32_u24 v13,6554,v12
v_lshrrev_b32 v13,16,v13
v_mul_u32_u24 v16,10,v13
v_sub_u32 v12,v12,v16
v_mul_u32_u24 v21,1280,v13
v_lshl_add_u32 v21,v12,4,v21
v_add_u32 v12,128,v0
v_mul_u32_u24 v13,6554,v12
v_lshrrev_b32 v13,16,v13
v_mul_u32_u24 v16,10,v13
v_sub_u32 v12,v12,v16
v_mul_u32_u24 v22,1280,v13
v_lshl_add_u32 v22,v12,4,v22
v_add_u32 v12,192,v0
v_mul_u32_u24 v13,6554,v12
v_lshrrev_b32 v13,16,v13
v_mul_u32_u24 v16,10,v13
v_sub_u32 v12,v12,v16
v_mul_u32_u24 v23,1280,v13
v_lshl_add_u32 v23,v12,4,v23
v_add_u32 v12,256,v0
v_mul_u32_u24 v13,6554,v12
v_lshrrev_b32 v13,16,v13
v_mul_u32_u24 v16,10,v13
v_sub_u32 v12,v12,v16
v_mul_u32_u24 v24,1280,v13
v_lshl_add_u32 v24,v12,4,v24
v_add_u32 v12,320,v0
v_mul_u32_u24 v13,6554,v12
v_lshrrev_b32 v13,16,v13
v_mul_u32_u24 v16,10,v13
v_sub_u32 v12,v12,v16
v_mul_u32_u24 v25,1280,v13
v_lshl_add_u32 v25,v12,4,v25
v_add_u32 v12,384,v0
v_mul_u32_u24 v13,6554,v12
v_lshrrev_b32 v13,16,v13
v_mul_u32_u24 v16,10,v13
v_sub_u32 v12,v12,v16
v_mul_u32_u24 v26,1280,v13
v_lshl_add_u32 v26,v12,4,v26
v_add_u32 v12,448,v0
v_mul_u32_u24 v13,6554,v12
v_lshrrev_b32 v13,16,v13
v_mul_u32_u24 v16,10,v13
v_sub_u32 v12,v12,v16
v_mul_u32_u24 v27,1280,v13
v_lshl_add_u32 v27,v12,4,v27
v_add_u32 v12,512,v0
v_mul_u32_u24 v13,6554,v12
v_lshrrev_b32 v13,16,v13
v_mul_u32_u24 v16,10,v13
v_sub_u32 v12,v12,v16
v_mul_u32_u24 v28,1280,v13
v_lshl_add_u32 v28,v12,4,v28
v_add_u32 v12,576,v0
v_mul_u32_u24 v13,6554,v12
v_lshrrev_b32 v13,16,v13
v_mul_u32_u24 v16,10,v13
v_sub_u32 v12,v12,v16
v_mul_u32_u24 v29,1280,v13
v_lshl_add_u32 v29,v12,4,v29
v_lshrrev_b32 v14,4,v0
v_and_b32 v12,1,v14
v_lshlrev_b32 v12,5,v12
v_lshrrev_b32 v13,1,v14
v_lshl_add_u32 v12,v13,2,v12
v_bfe_u32 v13,v0,2,1
v_add_u32 v12,v12,v13
v_bfe_u32 v13,v0,3,1
v_lshl_add_u32 v12,v13,4,v12
v_mul_u32_u24 v30,160,v12
v_and_b32 v13,3,v0
v_lshl_add_u32 v30,v13,3,v30
v_add_u32 v30,s74,v30
s_add_u32 s61,s73,0
s_add_u32 m0,s74,0
s_nop 0
buffer_load_dwordx4 v20,s[4:7],s61 offen lds
s_add_u32 m0,s74,1024
s_nop 0
buffer_load_dwordx4 v21,s[4:7],s61 offen lds
s_add_u32 m0,s74,2048
s_nop 0
buffer_load_dwordx4 v22,s[4:7],s61 offen lds
s_add_u32 m0,s74,3072
s_nop 0
buffer_load_dwordx4 v23,s[4:7],s61 offen lds
s_add_u32 m0,s74,4096
s_nop 0
buffer_load_dwordx4 v24,s[4:7],s61 offen lds
s_add_u32 m0,s74,5120
s_nop 0
buffer_load_dwordx4 v25,s[4:7],s61 offen lds
s_add_u32 m0,s74,6144
s_nop 0
buffer_load_dwordx4 v26,s[4:7],s61 offen lds
s_add_u32 m0,s74,7168
s_nop 0
buffer_load_dwordx4 v27,s[4:7],s61 offen lds
s_add_u32 m0,s74,8192
s_nop 0
buffer_load_dwordx4 v28,s[4:7],s61 offen lds
s_add_u32 m0,s74,9216
s_nop 0
buffer_load_dwordx4 v29,s[4:7],s61 offen lds
s_add_u32 s61,s73,81920
s_add_u32 m0,s74,10240
s_nop 0
buffer_load_dwordx4 v20,s[4:7],s61 offen lds
s_add_u32 m0,s74,11264
s_nop 0
buffer_load_dwordx4 v21,s[4:7],s61 offen lds
s_add_u32 m0,s74,12288
s_nop 0
buffer_load_dwordx4 v22,s[4:7],s61 offen lds
s_add_u32 m0,s74,13312
s_nop 0
buffer_load_dwordx4 v23,s[4:7],s61 offen lds
s_add_u32 m0,s74,14336
s_nop 0
buffer_load_dwordx4 v24,s[4:7],s61 offen lds
s_add_u32 m0,s74,15360
s_nop 0
buffer_load_dwordx4 v25,s[4:7],s61 offen lds
s_add_u32 m0,s74,16384
s_nop 0
buffer_load_dwordx4 v26,s[4:7],s61 offen lds
s_add_u32 m0,s74,17408
s_nop 0
buffer_load_dwordx4 v27,s[4:7],s61 offen lds
s_add_u32 m0,s74,18432
s_nop 0
buffer_load_dwordx4 v28,s[4:7],s61 offen lds
s_add_u32 m0,s74,19456
s_nop 0
buffer_load_dwordx4 v29,s[4:7],s61 offen lds
s_add_u32 s61,s73,163840
s_add_u32 m0,s74,20480
s_nop 0
buffer_load_dwordx4 v20,s[4:7],s61 offen lds
s_add_u32 m0,s74,21504
s_nop 0
buffer_load_dwordx4 v21,s[4:7],s61 offen lds
s_add_u32 m0,s74,22528
s_nop 0
buffer_load_dwordx4 v22,s[4:7],s61 offen lds
s_add_u32 m0,s74,23552
s_nop 0
buffer_load_dwordx4 v23,s[4:7],s61 offen lds
s_add_u32 m0,s74,24576
s_nop 0
buffer_load_dwordx4 v24,s[4:7],s61 offen lds
s_add_u32 m0,s74,25600
s_nop 0
buffer_load_dwordx4 v25,s[4:7],s61 offen lds
s_add_u32 m0,s74,26624
s_nop 0
buffer_load_dwordx4 v26,s[4:7],s61 offen lds
s_add_u32 m0,s74,27648
s_nop 0
buffer_load_dwordx4 v27,s[4:7],s61 offen lds
s_add_u32 m0,s74,28672
s_nop 0
buffer_load_dwordx4 v28,s[4:7],s61 offen lds
s_add_u32 m0,s74,29696
s_nop 0
buffer_load_dwordx4 v29,s[4:7],s61 offen lds
s_add_u32 s61,s73,245760
s_add_u32 m0,s74,30720
s_nop 0
buffer_load_dwordx4 v20,s[4:7],s61 offen lds
s_add_u32 m0,s74,31744
s_nop 0
buffer_load_dwordx4 v21,s[4:7],s61 offen lds
s_add_u32 m0,s74,32768
s_nop 0
buffer_load_dwordx4 v22,s[4:7],s61 offen lds
s_add_u32 m0,s74,33792
s_nop 0
buffer_load_dwordx4 v23,s[4:7],s61 offen lds
s_add_u32 m0,s74,34816
s_nop 0
buffer_load_dwordx4 v24,s[4:7],s61 offen lds
s_add_u32 m0,s74,35840
s_nop 0
buffer_load_dwordx4 v25,s[4:7],s61 offen lds
s_add_u32 m0,s74,36864
s_nop 0
buffer_load_dwordx4 v26,s[4:7],s61 offen lds
s_add_u32 m0,s74,37888
s_nop 0
buffer_load_dwordx4 v27,s[4:7],s61 offen lds
s_add_u32 m0,s74,38912
s_nop 0
buffer_load_dwordx4 v28,s[4:7],s61 offen lds
s_add_u32 m0,s74,39936
s_nop 0
buffer_load_dwordx4 v29,s[4:7],s61 offen lds
s_waitcnt vmcnt(30)
ds_read_b64_tr_b16 a[0:1],v30 offset:0
ds_read_b64_tr_b16 a[2:3],v30 offset:320
ds_read_b64_tr_b16 a[4:5],v30 offset:1280
ds_read_b64_tr_b16 a[6:7],v30 offset:1600
ds_read_b64_tr_b16 a[8:9],v30 offset:32
ds_read_b64_tr_b16 a[10:11],v30 offset:352
ds_read_b64_tr_b16 a[12:13],v30 offset:1312
ds_read_b64_tr_b16 a[14:15],v30 offset:1632
ds_read_b64_tr_b16 a[16:17],v30 offset:64
ds_read_b64_tr_b16 a[18:19],v30 offset:384
ds_read_b64_tr_b16 a[20:21],v30 offset:1344
ds_read_b64_tr_b16 a[22:23],v30 offset:1664
s_waitcnt lgkmcnt(4)
ds_read_b64_tr_b16 a[24:25],v30 offset:96
ds_read_b64_tr_b16 a[26:27],v30 offset:416
ds_read_b64_tr_b16 a[28:29],v30 offset:1376
ds_read_b64_tr_b16 a[30:31],v30 offset:1696
ds_read_b64_tr_b16 v[32:33],v30 offset:128
ds_read_b64_tr_b16 v[34:35],v30 offset:448
ds_read_b64_tr_b16 v[36:37],v30 offset:1408
ds_read_b64_tr_b16 v[38:39],v30 offset:1728
s_waitcnt lgkmcnt(0)
s_add_u32 s61,s73,327680
s_add_u32 m0,s74,0
s_nop 0
buffer_load_dwordx4 v20,s[4:7],s61 offen lds
s_add_u32 m0,s74,1024
s_nop 0
buffer_load_dwordx4 v21,s[4:7],s61 offen lds
s_add_u32 m0,s74,2048
s_nop 0
buffer_load_dwordx4 v22,s[4:7],s61 offen lds
s_add_u32 m0,s74,3072
s_nop 0
buffer_load_dwordx4 v23,s[4:7],s61 offen lds
s_add_u32 m0,s74,4096
s_nop 0
buffer_load_dwordx4 v24,s[4:7],s61 offen lds
s_add_u32 m0,s74,5120
s_nop 0
buffer_load_dwordx4 v25,s[4:7],s61 offen lds
s_add_u32 m0,s74,6144
s_nop 0
buffer_load_dwordx4 v26,s[4:7],s61 offen lds
s_add_u32 m0,s74,7168
s_nop 0
buffer_load_dwordx4 v27,s[4:7],s61 offen lds
s_add_u32 m0,s74,8192
s_nop 0
buffer_load_dwordx4 v28,s[4:7],s61 offen lds
s_add_u32 m0,s74,9216
s_nop 0
buffer_load_dwordx4 v29,s[4:7],s61 offen lds
s_waitcnt vmcnt(30)
ds_read_b64_tr_b16 a[32:33],v30 offset:10240
ds_read_b64_tr_b16 a[34:35],v30 offset:10560
ds_read_b64_tr_b16 a[36:37],v30 offset:11520
ds_read_b64_tr_b16 a[38:39],v30 offset:11840
ds_read_b64_tr_b16 a[40:41],v30 offset:10272
ds_read_b64_tr_b16 a[42:43],v30 offset:10592
ds_read_b64_tr_b16 a[44:45],v30 offset:11552
ds_read_b64_tr_b16 a[46:47],v30 offset:11872
ds_read_b64_tr_b16 a[48:49],v30 offset:10304
ds_read_b64_tr_b16 a[50:51],v30 offset:10624
ds_read_b64_tr_b16 a[52:53],v30 offset:11584
ds_read_b64_tr_b16 a[54:55],v30 offset:11904
s_waitcnt lgkmcnt(4)
ds_read_b64_tr_b16 a[56:57],v30 offset:10336
ds_read_b64_tr_b16 a[58:59],v30 offset:10656
ds_read_b64_tr_b16 a[60:61],v30 offset:11616
ds_read_b64_tr_b16 a[62:63],v30 offset:11936
ds_read_b64_tr_b16 v[40:41],v30 offset:10368
ds_read_b64_tr_b16 v[42:43],v30 offset:10688
ds_read_b64_tr_b16 v[44:45],v30 offset:11648
ds_read_b64_tr_b16 v[46:47],v30 offset:11968
s_waitcnt lgkmcnt(0)
s_add_u32 s61,s73,409600
s_add_u32 m0,s74,10240
s_nop 0
buffer_load_dwordx4 v20,s[4:7],s61 offen lds
s_add_u32 m0,s74,11264
s_nop 0
buffer_load_dwordx4 v21,s[4:7],s61 offen lds
s_add_u32 m0,s74,12288
s_nop 0
buffer_load_dwordx4 v22,s[4:7],s61 offen lds
s_add_u32 m0,s74,13312
s_nop 0
buffer_load_dwordx4 v23,s[4:7],s61 offen lds
s_add_u32 m0,s74,14336
s_nop 0
buffer_load_dwordx4 v24,s[4:7],s61 offen lds
s_add_u32 m0,s74,15360
s_nop 0
buffer_load_dwordx4 v25,s[4:7],s61 offen lds
s_add_u32 m0,s74,16384
s_nop 0
buffer_load_dwordx4 v26,s[4:7],s61 offen lds
s_add_u32 m0,s74,17408
s_nop 0
buffer_load_dwordx4 v27,s[4:7],s61 offen lds
s_add_u32 m0,s74,18432
s_nop 0
buffer_load_dwordx4 v28,s[4:7],s61 offen lds
s_add_u32 m0,s74,19456
s_nop 0
buffer_load_dwordx4 v29,s[4:7],s61 offen lds
s_waitcnt vmcnt(30)
ds_read_b64_tr_b16 a[64:65],v30 offset:20480
ds_read_b64_tr_b16 a[66:67],v30 offset:20800
ds_read_b64_tr_b16 a[68:69],v30 offset:21760
ds_read_b64_tr_b16 a[70:71],v30 offset:22080
ds_read_b64_tr_b16 a[72:73],v30 offset:20512
ds_read_b64_tr_b16 a[74:75],v30 offset:20832
ds_read_b64_tr_b16 a[76:77],v30 offset:21792
ds_read_b64_tr_b16 a[78:79],v30 offset:22112
ds_read_b64_tr_b16 a[80:81],v30 offset:20544
ds_read_b64_tr_b16 a[82:83],v30 offset:20864
ds_read_b64_tr_b16 a[84:85],v30 offset:21824
ds_read_b64_tr_b16 a[86:87],v30 offset:22144
s_waitcnt lgkmcnt(4)
ds_read_b64_tr_b16 a[88:89],v30 offset:20576
ds_read_b64_tr_b16 a[90:91],v30 offset:20896
ds_read_b64_tr_b16 a[92:93],v30 offset:21856
ds_read_b64_tr_b16 a[94:95],v30 offset:22176
ds_read_b64_tr_b16 v[48:49],v30 offset:20608
ds_read_b64_tr_b16 v[50:51],v30 offset:20928
ds_read_b64_tr_b16 v[52:53],v30 offset:21888
ds_read_b64_tr_b16 v[54:55],v30 offset:22208
s_waitcnt lgkmcnt(0)
s_add_u32 s61,s73,491520
s_add_u32 m0,s74,20480
s_nop 0
buffer_load_dwordx4 v20,s[4:7],s61 offen lds
s_add_u32 m0,s74,21504
s_nop 0
buffer_load_dwordx4 v21,s[4:7],s61 offen lds
s_add_u32 m0,s74,22528
s_nop 0
buffer_load_dwordx4 v22,s[4:7],s61 offen lds
s_add_u32 m0,s74,23552
s_nop 0
buffer_load_dwordx4 v23,s[4:7],s61 offen lds
s_add_u32 m0,s74,24576
s_nop 0
buffer_load_dwordx4 v24,s[4:7],s61 offen lds
s_add_u32 m0,s74,25600
s_nop 0
buffer_load_dwordx4 v25,s[4:7],s61 offen lds
s_add_u32 m0,s74,26624
s_nop 0
buffer_load_dwordx4 v26,s[4:7],s61 offen lds
s_add_u32 m0,s74,27648
s_nop 0
buffer_load_dwordx4 v27,s[4:7],s61 offen lds
s_add_u32 m0,s74,28672
s_nop 0
buffer_load_dwordx4 v28,s[4:7],s61 offen lds
s_add_u32 m0,s74,29696
s_nop 0
buffer_load_dwordx4 v29,s[4:7],s61 offen lds
s_waitcnt vmcnt(30)
ds_read_b64_tr_b16 a[96:97],v30 offset:30720
ds_read_b64_tr_b16 a[98:99],v30 offset:31040
ds_read_b64_tr_b16 a[100:101],v30 offset:32000
ds_read_b64_tr_b16 a[102:103],v30 offset:32320
ds_read_b64_tr_b16 a[104:105],v30 offset:30752
ds_read_b64_tr_b16 a[106:107],v30 offset:31072
ds_read_b64_tr_b16 a[108:109],v30 offset:32032
ds_read_b64_tr_b16 a[110:111],v30 offset:32352
ds_read_b64_tr_b16 a[112:113],v30 offset:30784
ds_read_b64_tr_b16 a[114:115],v30 offset:31104
ds_read_b64_tr_b16 a[116:117],v30 offset:32064
ds_read_b64_tr_b16 a[118:119],v30 offset:32384
s_waitcnt lgkmcnt(4)
ds_read_b64_tr_b16 a[120:121],v30 offset:30816
ds_read_b64_tr_b16 a[122:123],v30 offset:31136
ds_read_b64_tr_b16 a[124:125],v30 offset:32096
ds_read_b64_tr_b16 a[126:127],v30 offset:32416
ds_read_b64_tr_b16 v[56:57],v30 offset:30848
ds_read_b64_tr_b16 v[58:59],v30 offset:31168
ds_read_b64_tr_b16 v[60:61],v30 offset:32128
ds_read_b64_tr_b16 v[62:63],v30 offset:32448
s_waitcnt lgkmcnt(0)
s_add_u32 s61,s73,573440
s_add_u32 m0,s74,30720
s_nop 0
buffer_load_dwordx4 v20,s[4:7],s61 offen lds
s_add_u32 m0,s74,31744
s_nop 0
buffer_load_dwordx4 v21,s[4:7],s61 offen lds
s_add_u32 m0,s74,32768
s_nop 0
buffer_load_dwordx4 v22,s[4:7],s61 offen lds
s_add_u32 m0,s74,33792
s_nop 0
buffer_load_dwordx4 v23,s[4:7],s61 offen lds
s_add_u32 m0,s74,34816
s_nop 0
buffer_load_dwordx4 v24,s[4:7],s61 offen lds
s_add_u32 m0,s74,35840
s_nop 0
buffer_load_dwordx4 v25,s[4:7],s61 offen lds
s_add_u32 m0,s74,36864
s_nop 0
buffer_load_dwordx4 v26,s[4:7],s61 offen lds
s_add_u32 m0,s74,37888
s_nop 0
buffer_load_dwordx4 v27,s[4:7],s61 offen lds
s_add_u32 m0,s74,38912
s_nop 0
buffer_load_dwordx4 v28,s[4:7],s61 offen lds
s_add_u32 m0,s74,39936
s_nop 0
buffer_load_dwordx4 v29,s[4:7],s61 offen lds
s_waitcnt vmcnt(30)
ds_read_b64_tr_b16 a[128:129],v30 offset:0
ds_read_b64_tr_b16 a[130:131],v30 offset:320
ds_read_b64_tr_b16 a[132:133],v30 offset:1280
ds_read_b64_tr_b16 a[134:135],v30 offset:1600
ds_read_b64_tr_b16 a[136:137],v30 offset:32
ds_read_b64_tr_b16 a[138:139],v30 offset:352
ds_read_b64_tr_b16 a[140:141],v30 offset:1312
ds_read_b64_tr_b16 a[142:143],v30 offset:1632
ds_read_b64_tr_b16 a[144:145],v30 offset:64
ds_read_b64_tr_b16 a[146:147],v30 offset:384
ds_read_b64_tr_b16 a[148:149],v30 offset:1344
ds_read_b64_tr_b16 a[150:151],v30 offset:1664
s_waitcnt lgkmcnt(4)
ds_read_b64_tr_b16 a[152:153],v30 offset:96
ds_read_b64_tr_b16 a[154:155],v30 offset:416
ds_read_b64_tr_b16 a[156:157],v30 offset:1376
ds_read_b64_tr_b16 a[158:159],v30 offset:1696
ds_read_b64_tr_b16 v[64:65],v30 offset:128
ds_read_b64_tr_b16 v[66:67],v30 offset:448
ds_read_b64_tr_b16 v[68:69],v30 offset:1408
ds_read_b64_tr_b16 v[70:71],v30 offset:1728
s_waitcnt lgkmcnt(0)
s_add_u32 s61,s73,655360
s_add_u32 m0,s74,0
s_nop 0
buffer_load_dwordx4 v20,s[4:7],s61 offen lds
s_add_u32 m0,s74,1024
s_nop 0
buffer_load_dwordx4 v21,s[4:7],s61 offen lds
s_add_u32 m0,s74,2048
s_nop 0
buffer_load_dwordx4 v22,s[4:7],s61 offen lds
s_add_u32 m0,s74,3072
s_nop 0
buffer_load_dwordx4 v23,s[4:7],s61 offen lds
s_add_u32 m0,s74,4096
s_nop 0
buffer_load_dwordx4 v24,s[4:7],s61 offen lds
s_add_u32 m0,s74,5120
s_nop 0
buffer_load_dwordx4 v25,s[4:7],s61 offen lds
s_add_u32 m0,s74,6144
s_nop 0
buffer_load_dwordx4 v26,s[4:7],s61 offen lds
s_add_u32 m0,s74,7168
s_nop 0
buffer_load_dwordx4 v27,s[4:7],s61 offen lds
s_add_u32 m0,s74,8192
s_nop 0
buffer_load_dwordx4 v28,s[4:7],s61 offen lds
s_add_u32 m0,s74,9216
s_nop 0
buffer_load_dwordx4 v29,s[4:7],s61 offen lds
s_waitcnt vmcnt(30)
ds_read_b64_tr_b16 a[160:161],v30 offset:10240
ds_read_b64_tr_b16 a[162:163],v30 offset:10560
ds_read_b64_tr_b16 a[164:165],v30 offset:11520
ds_read_b64_tr_b16 a[166:167],v30 offset:11840
ds_read_b64_tr_b16 a[168:169],v30 offset:10272
ds_read_b64_tr_b16 a[170:171],v30 offset:10592
ds_read_b64_tr_b16 a[172:173],v30 offset:11552
ds_read_b64_tr_b16 a[174:175],v30 offset:11872
ds_read_b64_tr_b16 a[176:177],v30 offset:10304
ds_read_b64_tr_b16 a[178:179],v30 offset:10624
ds_read_b64_tr_b16 a[180:181],v30 offset:11584
ds_read_b64_tr_b16 a[182:183],v30 offset:11904
s_waitcnt lgkmcnt(4)
ds_read_b64_tr_b16 a[184:185],v30 offset:10336
ds_read_b64_tr_b16 a[186:187],v30 offset:10656
ds_read_b64_tr_b16 a[188:189],v30 offset:11616
ds_read_b64_tr_b16 a[190:191],v30 offset:11936
ds_read_b64_tr_b16 v[72:73],v30 offset:10368
ds_read_b64_tr_b16 v[74:75],v30 offset:10688
ds_read_b64_tr_b16 v[76:77],v30 offset:11648
ds_read_b64_tr_b16 v[78:79],v30 offset:11968
s_waitcnt lgkmcnt(0)
s_add_u32 s61,s73,737280
s_add_u32 m0,s74,10240
s_nop 0
buffer_load_dwordx4 v20,s[4:7],s61 offen lds
s_add_u32 m0,s74,11264
s_nop 0
buffer_load_dwordx4 v21,s[4:7],s61 offen lds
s_add_u32 m0,s74,12288
s_nop 0
buffer_load_dwordx4 v22,s[4:7],s61 offen lds
s_add_u32 m0,s74,13312
s_nop 0
buffer_load_dwordx4 v23,s[4:7],s61 offen lds
s_add_u32 m0,s74,14336
s_nop 0
buffer_load_dwordx4 v24,s[4:7],s61 offen lds
s_add_u32 m0,s74,15360
s_nop 0
buffer_load_dwordx4 v25,s[4:7],s61 offen lds
s_add_u32 m0,s74,16384
s_nop 0
buffer_load_dwordx4 v26,s[4:7],s61 offen lds
s_add_u32 m0,s74,17408
s_nop 0
buffer_load_dwordx4 v27,s[4:7],s61 offen lds
s_add_u32 m0,s74,18432
s_nop 0
buffer_load_dwordx4 v28,s[4:7],s61 offen lds
s_add_u32 m0,s74,19456
s_nop 0
buffer_load_dwordx4 v29,s[4:7],s61 offen lds
s_waitcnt vmcnt(30)
ds_read_b64_tr_b16 a[192:193],v30 offset:20480
ds_read_b64_tr_b16 a[194:195],v30 offset:20800
ds_read_b64_tr_b16 a[196:197],v30 offset:21760
ds_read_b64_tr_b16 a[198:199],v30 offset:22080
ds_read_b64_tr_b16 a[200:201],v30 offset:20512
ds_read_b64_tr_b16 a[202:203],v30 offset:20832
ds_read_b64_tr_b16 a[204:205],v30 offset:21792
ds_read_b64_tr_b16 a[206:207],v30 offset:22112
ds_read_b64_tr_b16 a[208:209],v30 offset:20544
ds_read_b64_tr_b16 a[210:211],v30 offset:20864
ds_read_b64_tr_b16 a[212:213],v30 offset:21824
ds_read_b64_tr_b16 a[214:215],v30 offset:22144
s_waitcnt lgkmcnt(4)
ds_read_b64_tr_b16 a[216:217],v30 offset:20576
ds_read_b64_tr_b16 a[218:219],v30 offset:20896
ds_read_b64_tr_b16 a[220:221],v30 offset:21856
ds_read_b64_tr_b16 a[222:223],v30 offset:22176
ds_read_b64_tr_b16 v[80:81],v30 offset:20608
ds_read_b64_tr_b16 v[82:83],v30 offset:20928
ds_read_b64_tr_b16 v[84:85],v30 offset:21888
ds_read_b64_tr_b16 v[86:87],v30 offset:22208
s_waitcnt lgkmcnt(0)
s_add_u32 s61,s73,819200
s_add_u32 m0,s74,20480
s_nop 0
buffer_load_dwordx4 v20,s[4:7],s61 offen lds
s_add_u32 m0,s74,21504
s_nop 0
buffer_load_dwordx4 v21,s[4:7],s61 offen lds
s_add_u32 m0,s74,22528
s_nop 0
buffer_load_dwordx4 v22,s[4:7],s61 offen lds
s_add_u32 m0,s74,23552
s_nop 0
buffer_load_dwordx4 v23,s[4:7],s61 offen lds
s_add_u32 m0,s74,24576
s_nop 0
buffer_load_dwordx4 v24,s[4:7],s61 offen lds
s_add_u32 m0,s74,25600
s_nop 0
buffer_load_dwordx4 v25,s[4:7],s61 offen lds
s_add_u32 m0,s74,26624
s_nop 0
buffer_load_dwordx4 v26,s[4:7],s61 offen lds
s_add_u32 m0,s74,27648
s_nop 0
buffer_load_dwordx4 v27,s[4:7],s61 offen lds
s_add_u32 m0,s74,28672
s_nop 0
buffer_load_dwordx4 v28,s[4:7],s61 offen lds
s_add_u32 m0,s74,29696
s_nop 0
buffer_load_dwordx4 v29,s[4:7],s61 offen lds
s_waitcnt vmcnt(30)
ds_read_b64_tr_b16 a[224:225],v30 offset:30720
ds_read_b64_tr_b16 a[226:227],v30 offset:31040
ds_read_b64_tr_b16 a[228:229],v30 offset:32000
ds_read_b64_tr_b16 a[230:231],v30 offset:32320
ds_read_b64_tr_b16 a[232:233],v30 offset:30752
ds_read_b64_tr_b16 a[234:235],v30 offset:31072
ds_read_b64_tr_b16 a[236:237],v30 offset:32032
ds_read_b64_tr_b16 a[238:239],v30 offset:32352
ds_read_b64_tr_b16 a[240:241],v30 offset:30784
ds_read_b64_tr_b16 a[242:243],v30 offset:31104
ds_read_b64_tr_b16 a[244:245],v30 offset:32064
ds_read_b64_tr_b16 a[246:247],v30 offset:32384
s_waitcnt lgkmcnt(4)
ds_read_b64_tr_b16 a[248:249],v30 offset:30816
ds_read_b64_tr_b16 a[250:251],v30 offset:31136
ds_read_b64_tr_b16 a[252:253],v30 offset:32096
ds_read_b64_tr_b16 a[254:255],v30 offset:32416
ds_read_b64_tr_b16 v[88:89],v30 offset:30848
ds_read_b64_tr_b16 v[90:91],v30 offset:31168
ds_read_b64_tr_b16 v[92:93],v30 offset:32128
ds_read_b64_tr_b16 v[94:95],v30 offset:32448
s_waitcnt lgkmcnt(0)
s_add_u32 s61,s73,901120
s_add_u32 m0,s74,30720
s_nop 0
buffer_load_dwordx4 v20,s[4:7],s61 offen lds
s_add_u32 m0,s74,31744
s_nop 0
buffer_load_dwordx4 v21,s[4:7],s61 offen lds
s_add_u32 m0,s74,32768
s_nop 0
buffer_load_dwordx4 v22,s[4:7],s61 offen lds
s_add_u32 m0,s74,33792
s_nop 0
buffer_load_dwordx4 v23,s[4:7],s61 offen lds
s_add_u32 m0,s74,34816
s_nop 0
buffer_load_dwordx4 v24,s[4:7],s61 offen lds
s_add_u32 m0,s74,35840
s_nop 0
buffer_load_dwordx4 v25,s[4:7],s61 offen lds
s_add_u32 m0,s74,36864
s_nop 0
buffer_load_dwordx4 v26,s[4:7],s61 offen lds
s_add_u32 m0,s74,37888
s_nop 0
buffer_load_dwordx4 v27,s[4:7],s61 offen lds
s_add_u32 m0,s74,38912
s_nop 0
buffer_load_dwordx4 v28,s[4:7],s61 offen lds
s_add_u32 m0,s74,39936
s_nop 0
buffer_load_dwordx4 v29,s[4:7],s61 offen lds
s_waitcnt vmcnt(30)
ds_read_b64_tr_b16 v[128:129],v30 offset:0
ds_read_b64_tr_b16 v[130:131],v30 offset:320
ds_read_b64_tr_b16 v[132:133],v30 offset:1280
ds_read_b64_tr_b16 v[134:135],v30 offset:1600
ds_read_b64_tr_b16 v[136:137],v30 offset:32
ds_read_b64_tr_b16 v[138:139],v30 offset:352
ds_read_b64_tr_b16 v[140:141],v30 offset:1312
ds_read_b64_tr_b16 v[142:143],v30 offset:1632
ds_read_b64_tr_b16 v[144:145],v30 offset:64
ds_read_b64_tr_b16 v[146:147],v30 offset:384
ds_read_b64_tr_b16 v[148:149],v30 offset:1344
ds_read_b64_tr_b16 v[150:151],v30 offset:1664
s_waitcnt lgkmcnt(4)
ds_read_b64_tr_b16 v[152:153],v30 offset:96
ds_read_b64_tr_b16 v[154:155],v30 offset:416
ds_read_b64_tr_b16 v[156:157],v30 offset:1376
ds_read_b64_tr_b16 v[158:159],v30 offset:1696
ds_read_b64_tr_b16 v[96:97],v30 offset:128
ds_read_b64_tr_b16 v[98:99],v30 offset:448
ds_read_b64_tr_b16 v[100:101],v30 offset:1408
ds_read_b64_tr_b16 v[102:103],v30 offset:1728
s_waitcnt lgkmcnt(0)
s_waitcnt vmcnt(20)
ds_read_b64_tr_b16 v[160:161],v30 offset:10240
ds_read_b64_tr_b16 v[162:163],v30 offset:10560
ds_read_b64_tr_b16 v[164:165],v30 offset:11520
ds_read_b64_tr_b16 v[166:167],v30 offset:11840
ds_read_b64_tr_b16 v[168:169],v30 offset:10272
ds_read_b64_tr_b16 v[170:171],v30 offset:10592
ds_read_b64_tr_b16 v[172:173],v30 offset:11552
ds_read_b64_tr_b16 v[174:175],v30 offset:11872
ds_read_b64_tr_b16 v[176:177],v30 offset:10304
ds_read_b64_tr_b16 v[178:179],v30 offset:10624
ds_read_b64_tr_b16 v[180:181],v30 offset:11584
ds_read_b64_tr_b16 v[182:183],v30 offset:11904
s_waitcnt lgkmcnt(4)
ds_read_b64_tr_b16 v[184:185],v30 offset:10336
ds_read_b64_tr_b16 v[186:187],v30 offset:10656
ds_read_b64_tr_b16 v[188:189],v30 offset:11616
ds_read_b64_tr_b16 v[190:191],v30 offset:11936
ds_read_b64_tr_b16 v[104:105],v30 offset:10368
ds_read_b64_tr_b16 v[106:107],v30 offset:10688
ds_read_b64_tr_b16 v[108:109],v30 offset:11648
ds_read_b64_tr_b16 v[110:111],v30 offset:11968
s_waitcnt lgkmcnt(0)
s_waitcnt vmcnt(10)
ds_read_b64_tr_b16 v[192:193],v30 offset:20480
ds_read_b64_tr_b16 v[194:195],v30 offset:20800
ds_read_b64_tr_b16 v[196:197],v30 offset:21760
ds_read_b64_tr_b16 v[198:199],v30 offset:22080
ds_read_b64_tr_b16 v[200:201],v30 offset:20512
ds_read_b64_tr_b16 v[202:203],v30 offset:20832
ds_read_b64_tr_b16 v[204:205],v30 offset:21792
ds_read_b64_tr_b16 v[206:207],v30 offset:22112
ds_read_b64_tr_b16 v[208:209],v30 offset:20544
ds_read_b64_tr_b16 v[210:211],v30 offset:20864
ds_read_b64_tr_b16 v[212:213],v30 offset:21824
ds_read_b64_tr_b16 v[214:215],v30 offset:22144
s_waitcnt lgkmcnt(4)
ds_read_b64_tr_b16 v[216:217],v30 offset:20576
ds_read_b64_tr_b16 v[218:219],v30 offset:20896
ds_read_b64_tr_b16 v[220:221],v30 offset:21856
ds_read_b64_tr_b16 v[222:223],v30 offset:22176
ds_read_b64_tr_b16 v[112:113],v30 offset:20608
ds_read_b64_tr_b16 v[114:115],v30 offset:20928
ds_read_b64_tr_b16 v[116:117],v30 offset:21888
ds_read_b64_tr_b16 v[118:119],v30 offset:22208
s_waitcnt lgkmcnt(0)
s_waitcnt vmcnt(0)
ds_read_b64_tr_b16 v[224:225],v30 offset:30720
ds_read_b64_tr_b16 v[226:227],v30 offset:31040
ds_read_b64_tr_b16 v[228:229],v30 offset:32000
ds_read_b64_tr_b16 v[230:231],v30 offset:32320
ds_read_b64_tr_b16 v[232:233],v30 offset:30752
ds_read_b64_tr_b16 v[234:235],v30 offset:31072
ds_read_b64_tr_b16 v[236:237],v30 offset:32032
ds_read_b64_tr_b16 v[238:239],v30 offset:32352
ds_read_b64_tr_b16 v[240:241],v30 offset:30784
ds_read_b64_tr_b16 v[242:243],v30 offset:31104
ds_read_b64_tr_b16 v[244:245],v30 offset:32064
ds_read_b64_tr_b16 v[246:247],v30 offset:32384
s_waitcnt lgkmcnt(4)
ds_read_b64_tr_b16 v[248:249],v30 offset:30816
ds_read_b64_tr_b16 v[250:251],v30 offset:31136
ds_read_b64_tr_b16 v[252:253],v30 offset:32096
ds_read_b64_tr_b16 v[254:255],v30 offset:32416
ds_read_b64_tr_b16 v[120:121],v30 offset:30848
ds_read_b64_tr_b16 v[122:123],v30 offset:31168
ds_read_b64_tr_b16 v[124:125],v30 offset:32128
ds_read_b64_tr_b16 v[126:127],v30 offset:32448
s_waitcnt lgkmcnt(0)
s_barrier
ds_write_b128 v4,v[32:35] offset:0
ds_write_b128 v4,v[36:39] offset:1024
ds_write_b128 v4,v[40:43] offset:2048
ds_write_b128 v4,v[44:47] offset:3072
ds_write_b128 v4,v[48:51] offset:4096
ds_write_b128 v4,v[52:55] offset:5120
ds_write_b128 v4,v[56:59] offset:6144
ds_write_b128 v4,v[60:63] offset:7168
s_waitcnt lgkmcnt(0)
ds_write_b128 v4,v[64:67] offset:8192
ds_write_b128 v4,v[68:71] offset:9216
ds_write_b128 v4,v[72:75] offset:10240
ds_write_b128 v4,v[76:79] offset:11264
ds_write_b128 v4,v[80:83] offset:12288
ds_write_b128 v4,v[84:87] offset:13312
ds_write_b128 v4,v[88:91] offset:14336
ds_write_b128 v4,v[92:95] offset:15360
s_waitcnt lgkmcnt(0)
ds_write_b128 v4,v[96:99] offset:16384
ds_write_b128 v4,v[100:103] offset:17408
ds_write_b128 v4,v[104:107] offset:18432
ds_write_b128 v4,v[108:111] offset:19456
ds_write_b128 v4,v[112:115] offset:20480
ds_write_b128 v4,v[116:119] offset:21504
ds_write_b128 v4,v[120:123] offset:22528
ds_write_b128 v4,v[124:127] offset:23552
s_waitcnt lgkmcnt(0)
s_barrier
s_lshl_b32 s3,s49,2
v_mov_b32 v13,s3
s_nop 1
ibw_163:
buffer_load_dword v12,v13,s[12:15],0 offen sc1
s_waitcnt vmcnt(0)
v_cmp_ne_u32 vcc,256,v12
s_nop 0
s_cbranch_vccz ok_164
s_sleep 8
s_sub_u32 s47,s47,1
s_cbranch_scc1 ABORT
s_branch ibw_163
ok_164:
s_cmp_lg_u32 s49,0
s_cbranch_scc1 ibok_165
v_and_b32 v13,7,v0
v_lshlrev_b32 v13,2,v13
buffer_load_dword v12,v13,s[12:15],0 offen offset:32 sc1
s_waitcnt vmcnt(0)
v_cmp_ne_u32 vcc,32,v12
s_nop 0
s_cbranch_vccz ibok_165
s_barrier
s_mov_b32 s49,1
s_mov_b32 s3,s2
s_load_dwordx16 s[16:31],s[0:1],0
s_load_dwordx8 s[32:39],s[0:1],64
s_waitcnt lgkmcnt(0)
s_branch DISPATCH
ibok_165:
v_mov_b32 v13,192
s_cmp_lg_u32 s49,0
s_cbranch_scc1 vx_167
vw_166:
buffer_load_dword v12,v13,s[12:15],0 offen sc1
s_waitcnt vmcnt(0)
v_and_b32 v14,0xffff,v12
v_cmp_ne_u32 vcc,64,v14
s_nop 0
s_cbranch_vccz ok_168
s_sleep 4
s_sub_u32 s47,s47,1
s_cbranch_scc1 ABORT
s_branch vw_166
ok_168:
v_readfirstlane_b32 s60,v12
s_cmp_gt_u32 s60,2162688
s_cselect_b32 s60,0x2000,0
s_add_u32 s83,s83,s60
s_nop 1
vx_167:
s_mov_b32 s50,0
s_mov_b32 s77,0
ds_read_b128 v[20:23],v4 offset:12288
ds_read_b128 v[24:27],v4 offset:13312
ds_read_b128 v[116:119],v4 offset:22528
ds_read_b128 v[120:123],v4 offset:23552
s_waitcnt lgkmcnt(0)
s_cmp_lg_u32 s49,0
s_cbranch_scc1 CW_LOOP_S
CW_LOOP_F:
s_sub_u32 s60,s50,13
s_lshr_b32 s52,s60,1
s_and_b32 s51,s60,1
s_cmp_eq_u32 s51,0
s_cselect_b32 s61,13,0
s_add_u32 s52,s52,s61
s_sub_u32 s61,s60,51
s_cmp_ge_u32 s60,102
s_cselect_b32 s52,s61,s52
s_cselect_b32 s51,1,s51
s_cmp_lt_u32 s50,13
s_cselect_b32 s52,s50,s52
s_cselect_b32 s51,0,s51
s_cmp_eq_u32 s52,63
s_cbranch_scc1 CW_NEXT_F
s_add_u32 s58,s52,1
s_lshl_b32 s61,s51,9
s_add_u32 s72,s61,s35
s_add_u32 s69,s61,s85
s_lshl_b32 s61,s51,2
s_and_b32 s60,s52,1
s_add_u32 s60,s60,s61
s_mul_i32 s70,s60,49152
s_add_u32 s70,s70,s33
s_add_u32 s71,s70,4096
s_add_u32 s80,s70,8192
s_bfe_u32 s57,s52,65537
s_bfe_u32 s31,s58,65537
s_and_b32 s60,s58,1
s_add_u32 s60,s60,s61
s_mul_i32 s59,s60,20480
s_add_u32 s59,s59,s84
s_lshl_b32 s68,s60,16
s_add_u32 s68,s68,s83
s_xor_b32 s77,s77,11264
v_add_u32 v7,s77,v5
v_add_u32 v8,s77,v6
s_add_u32 s60,s52,2
v_mov_b32 v16,s60
ds_read_b128 v[100:103],v4 offset:0
ds_read_b128 v[104:107],v4 offset:1024
ds_read_b128 v[108:111],v4 offset:6144
ds_read_b128 v[112:115],v4 offset:7168
s_cmp_lg_u32 s46,0
s_cbranch_scc1 np_169
db_171:
buffer_load_dword v12,v3,s[8:11],s72 offen sc1
s_waitcnt vmcnt(0)
v_cmp_gt_u32 vcc,s58,v12
s_cbranch_vccz dbok_172
s_sub_u32 s47,s47,1
s_cbranch_scc1 ABORT
s_branch db_171
dbok_172:
np_169:
s_barrier
rd_170:
buffer_load_dwordx4 v[32:35],v1,s[8:11],s70 offen sc1
v_mov_b32 v80,0
v_mov_b32 v81,0
v_mov_b32 v82,0
v_mov_b32 v83,0
v_mov_b32 v84,0
buffer_load_dwordx4 v[36:39],v1,s[8:11],s70 offen offset:3072 sc1
v_mov_b32 v85,0
v_mov_b32 v86,0
v_mov_b32 v87,0
v_mov_b32 v88,0
v_mov_b32 v89,0
buffer_load_dwordx4 v[40:43],v1,s[8:11],s71 offen offset:2048 sc1
v_mov_b32 v90,0
v_mov_b32 v91,0
v_mov_b32 v92,0
v_mov_b32 v93,0
v_mov_b32 v94,0
buffer_load_dwordx4 v[44:47],v1,s[8:11],s80 offen offset:1024 sc1
v_mov_b32 v95,0
v_mov_b32 v96,0
v_mov_b32 v97,0
v_mov_b32 v98,0
v_mov_b32 v99,0
buffer_load_dwordx4 v[48:51],v1,s[8:11],s70 offen offset:1024 sc1
s_waitcnt vmcnt(4)
v_and_b32 v12,1,v32
v_cmp_ne_u32 vcc,s57,v12
s_cbranch_vccnz ws_173
wg_179:
v_smfmac_f32_16x16x64_bf16 v[80:83],v[32:35],a[0:7],v2
buffer_load_dwordx4 v[52:55],v1,s[8:11],s71 offen sc1
v_smfmac_f32_16x16x64_bf16 v[84:87],v[32:35],a[8:15],v2
s_waitcnt vmcnt(4)
v_and_b32 v12,1,v36
v_smfmac_f32_16x16x64_bf16 v[88:91],v[32:35],a[16:23],v2
v_cmp_ne_u32 vcc,s57,v12
v_smfmac_f32_16x16x64_bf16 v[92:95],v[32:35],a[24:31],v2
s_waitcnt lgkmcnt(2)
v_smfmac_f32_16x16x64_bf16 v[96:99],v[32:35],v[100:107],v2
s_cbranch_vccnz ws_174
wg_180:
v_smfmac_f32_16x16x64_bf16 v[80:83],v[36:39],a[96:103],v2
buffer_load_dwordx4 v[56:59],v1,s[8:11],s71 offen offset:3072 sc1
v_smfmac_f32_16x16x64_bf16 v[84:87],v[36:39],a[104:111],v2
s_waitcnt vmcnt(4)
v_and_b32 v12,1,v40
v_smfmac_f32_16x16x64_bf16 v[88:91],v[36:39],a[112:119],v2
v_cmp_ne_u32 vcc,s57,v12
v_smfmac_f32_16x16x64_bf16 v[92:95],v[36:39],a[120:127],v2
s_waitcnt lgkmcnt(0)
v_smfmac_f32_16x16x64_bf16 v[96:99],v[36:39],v[108:115],v2
s_cbranch_vccnz ws_175
wg_181:
v_smfmac_f32_16x16x64_bf16 v[80:83],v[40:43],a[192:199],v2
buffer_load_dwordx4 v[60:63],v1,s[8:11],s80 offen offset:2048 sc1
v_smfmac_f32_16x16x64_bf16 v[84:87],v[40:43],a[200:207],v2
s_waitcnt vmcnt(4)
v_and_b32 v12,1,v44
v_smfmac_f32_16x16x64_bf16 v[88:91],v[40:43],a[208:215],v2
v_cmp_ne_u32 vcc,s57,v12
ds_read_b128 v[100:103],v4 offset:18432
v_smfmac_f32_16x16x64_bf16 v[92:95],v[40:43],a[216:223],v2
ds_read_b128 v[104:107],v4 offset:19456
v_smfmac_f32_16x16x64_bf16 v[96:99],v[40:43],v[20:27],v2
s_cbranch_vccnz ws_176
wg_182:
v_smfmac_f32_16x16x64_bf16 v[80:83],v[44:47],v[160:167],v2
buffer_load_dwordx4 v[64:67],v1,s[8:11],s70 offen offset:2048 sc1
v_smfmac_f32_16x16x64_bf16 v[84:87],v[44:47],v[168:175],v2
s_waitcnt vmcnt(4)
v_and_b32 v12,1,v48
v_smfmac_f32_16x16x64_bf16 v[88:91],v[44:47],v[176:183],v2
v_cmp_ne_u32 vcc,s57,v12
ds_read_b128 v[108:111],v4 offset:2048
v_smfmac_f32_16x16x64_bf16 v[92:95],v[44:47],v[184:191],v2
ds_read_b128 v[112:115],v4 offset:3072
s_waitcnt lgkmcnt(2)
v_smfmac_f32_16x16x64_bf16 v[96:99],v[44:47],v[100:107],v2
s_cbranch_vccnz ws_177
wg_183:
v_smfmac_f32_16x16x64_bf16 v[80:83],v[48:51],a[32:39],v2
buffer_load_dwordx4 v[68:71],v1,s[8:11],s71 offen offset:1024 sc1
v_smfmac_f32_16x16x64_bf16 v[84:87],v[48:51],a[40:47],v2
s_waitcnt vmcnt(4)
v_and_b32 v12,1,v52
v_smfmac_f32_16x16x64_bf16 v[88:91],v[48:51],a[48:55],v2
v_cmp_ne_u32 vcc,s57,v12
ds_read_b128 v[100:103],v4 offset:8192
v_smfmac_f32_16x16x64_bf16 v[92:95],v[48:51],a[56:63],v2
ds_read_b128 v[104:107],v4 offset:9216
s_waitcnt lgkmcnt(2)
v_smfmac_f32_16x16x64_bf16 v[96:99],v[48:51],v[108:115],v2
s_cbranch_vccnz ws_178
wg_184:
v_smfmac_f32_16x16x64_bf16 v[80:83],v[52:55],a[128:135],v2
buffer_load_dwordx4 v[72:75],v1,s[8:11],s80 offen sc1
v_smfmac_f32_16x16x64_bf16 v[84:87],v[52:55],a[136:143],v2
ds_read_b128 v[108:111],v4 offset:14336
v_smfmac_f32_16x16x64_bf16 v[88:91],v[52:55],a[144:151],v2
ds_read_b128 v[112:115],v4 offset:15360
v_smfmac_f32_16x16x64_bf16 v[92:95],v[52:55],a[152:159],v2
s_waitcnt lgkmcnt(2)
v_smfmac_f32_16x16x64_bf16 v[96:99],v[52:55],v[100:107],v2
buffer_load_dwordx4 v[76:79],v1,s[8:11],s80 offen offset:3072 sc1
s_waitcnt vmcnt(5)
v_smfmac_f32_16x16x64_bf16 v[80:83],v[56:59],a[224:231],v2
ds_read_b128 v[100:103],v4 offset:20480
v_smfmac_f32_16x16x64_bf16 v[84:87],v[56:59],a[232:239],v2
ds_read_b128 v[104:107],v4 offset:21504
v_smfmac_f32_16x16x64_bf16 v[88:91],v[56:59],a[240:247],v2
v_smfmac_f32_16x16x64_bf16 v[92:95],v[56:59],a[248:255],v2
s_waitcnt lgkmcnt(2)
v_smfmac_f32_16x16x64_bf16 v[96:99],v[56:59],v[108:115],v2
s_waitcnt vmcnt(4)
v_smfmac_f32_16x16x64_bf16 v[80:83],v[60:63],v[192:199],v2
ds_read_b128 v[108:111],v4 offset:4096
v_bitop3_b32 v13,v56,v60,s57 bitop3:0x7e
v_smfmac_f32_16x16x64_bf16 v[84:87],v[60:63],v[200:207],v2
ds_read_b128 v[112:115],v4 offset:5120
v_smfmac_f32_16x16x64_bf16 v[88:91],v[60:63],v[208:215],v2
v_smfmac_f32_16x16x64_bf16 v[92:95],v[60:63],v[216:223],v2
s_waitcnt lgkmcnt(2)
v_smfmac_f32_16x16x64_bf16 v[96:99],v[60:63],v[100:107],v2
s_waitcnt vmcnt(3)
v_smfmac_f32_16x16x64_bf16 v[80:83],v[64:67],a[64:71],v2
ds_read_b128 v[100:103],v4 offset:10240
v_smfmac_f32_16x16x64_bf16 v[84:87],v[64:67],a[72:79],v2
ds_read_b128 v[104:107],v4 offset:11264
v_smfmac_f32_16x16x64_bf16 v[88:91],v[64:67],a[80:87],v2
v_smfmac_f32_16x16x64_bf16 v[92:95],v[64:67],a[88:95],v2
s_waitcnt lgkmcnt(2)
v_smfmac_f32_16x16x64_bf16 v[96:99],v[64:67],v[108:115],v2
s_waitcnt vmcnt(0)
v_smfmac_f32_16x16x64_bf16 v[80:83],v[68:71],a[160:167],v2
ds_read_b128 v[108:111],v4 offset:16384
v_bitop3_b32 v14,v64,v68,s57 bitop3:0x7e
v_smfmac_f32_16x16x64_bf16 v[80:83],v[72:75],v[128:135],v2
ds_read_b128 v[112:115],v4 offset:17408
v_or_b32 v13,v13,v14
v_smfmac_f32_16x16x64_bf16 v[80:83],v[76:79],v[224:231],v2
v_bitop3_b32 v14,v72,v76,s57 bitop3:0x7e
v_smfmac_f32_16x16x64_bf16 v[84:87],v[68:71],a[168:175],v2
v_or_b32 v13,v13,v14
v_smfmac_f32_16x16x64_bf16 v[84:87],v[72:75],v[136:143],v2
v_and_b32 v13,1,v13
v_smfmac_f32_16x16x64_bf16 v[84:87],v[76:79],v[232:239],v2
v_cmp_ne_u32 vcc,0,v13
v_smfmac_f32_16x16x64_bf16 v[88:91],v[68:71],a[176:183],v2
s_cbranch_vccnz rd_170x
v_smfmac_f32_16x16x64_bf16 v[88:91],v[72:75],v[144:151],v2
v_add_f32 v80,v80,v81
v_smfmac_f32_16x16x64_bf16 v[88:91],v[76:79],v[240:247],v2
v_add_f32 v82,v82,v83
ds_write2_b32 v7,v80,v82 offset0:0 offset1:88
v_smfmac_f32_16x16x64_bf16 v[92:95],v[68:71],a[184:191],v2
v_add_f32 v84,v84,v85
v_smfmac_f32_16x16x64_bf16 v[92:95],v[72:75],v[152:159],v2
v_add_f32 v86,v86,v87
ds_write2_b32 v7,v84,v86 offset0:16 offset1:104
v_smfmac_f32_16x16x64_bf16 v[92:95],v[76:79],v[248:255],v2
v_add_f32 v88,v88,v89
s_waitcnt lgkmcnt(4)
v_smfmac_f32_16x16x64_bf16 v[96:99],v[68:71],v[100:107],v2
v_add_f32 v90,v90,v91
s_waitcnt lgkmcnt(2)
v_smfmac_f32_16x16x64_bf16 v[96:99],v[72:75],v[108:115],v2
ds_write2_b32 v7,v88,v90 offset0:32 offset1:120
v_smfmac_f32_16x16x64_bf16 v[96:99],v[76:79],v[116:123],v2
v_add_f32 v92,v92,v93
v_add_f32 v94,v94,v95
ds_write2_b32 v7,v92,v94 offset0:48 offset1:136
s_nop 4
v_add_f32 v96,v96,v97
v_add_f32 v98,v98,v99
ds_write2_b32 v7,v96,v98 offset0:64 offset1:152
s_waitcnt lgkmcnt(0)
s_barrier
ds_read_b128 v[32:35],v8 offset:0
ds_read_b128 v[36:39],v8 offset:2816
ds_read_b128 v[40:43],v8 offset:5632
ds_read_b128 v[44:47],v8 offset:8448
s_mov_b64 exec,1
buffer_store_dword v16,v1,s[8:11],s69 offen
s_mov_b64 exec,-1
s_waitcnt lgkmcnt(2)
v_pk_add_f32 v[32:33],v[32:33],v[36:37]
v_pk_add_f32 v[34:35],v[34:35],v[38:39]
s_waitcnt lgkmcnt(0)
v_pk_add_f32 v[40:41],v[40:41],v[44:45]
v_pk_add_f32 v[42:43],v[42:43],v[46:47]
v_pk_add_f32 v[32:33],v[32:33],v[40:41]
v_pk_add_f32 v[34:35],v[34:35],v[42:43]
v_cvt_pk_bf16_f32 v32,v32,v33
v_cvt_pk_bf16_f32 v33,v34,v35
v_bfi_b32 v32,v10,s31,v32
s_nop 0
v_permlane32_swap_b32 v33,v35
v_permlane32_swap_b32 v32,v34
s_mov_b64 exec,s[88:89]
buffer_store_dwordx4 v[32:35],v9,s[8:11],s59 offen
s_barrier
buffer_store_dwordx4 v[32:35],v9,s[8:11],s68 offen sc1
s_mov_b64 exec,-1
s_nop 0
CW_NEXT_F:
s_add_u32 s50,s50,1
s_cmp_lt_u32 s50,128
s_cbranch_scc1 CW_LOOP_F
s_branch CW_DONE
ws_173:
buffer_load_dwordx4 v[32:35],v1,s[8:11],s70 offen sc1
buffer_load_dwordx4 v[36:39],v1,s[8:11],s70 offen offset:3072 sc1
buffer_load_dwordx4 v[40:43],v1,s[8:11],s71 offen offset:2048 sc1
buffer_load_dwordx4 v[44:47],v1,s[8:11],s80 offen offset:1024 sc1
buffer_load_dwordx4 v[48:51],v1,s[8:11],s70 offen offset:1024 sc1
s_sub_u32 s47,s47,1
s_cbranch_scc1 ABORT
s_waitcnt vmcnt(4)
v_and_b32 v12,1,v32
v_cmp_ne_u32 vcc,s57,v12
s_nop 0
s_cbranch_vccnz ws_173
s_branch wg_179
ws_174:
buffer_load_dwordx4 v[36:39],v1,s[8:11],s70 offen offset:3072 sc1
buffer_load_dwordx4 v[40:43],v1,s[8:11],s71 offen offset:2048 sc1
buffer_load_dwordx4 v[44:47],v1,s[8:11],s80 offen offset:1024 sc1
buffer_load_dwordx4 v[48:51],v1,s[8:11],s70 offen offset:1024 sc1
buffer_load_dwordx4 v[52:55],v1,s[8:11],s71 offen sc1
s_sub_u32 s47,s47,1
s_cbranch_scc1 ABORT
s_waitcnt vmcnt(4)
v_and_b32 v12,1,v36
v_cmp_ne_u32 vcc,s57,v12
s_nop 0
s_cbranch_vccnz ws_174
s_branch wg_180
ws_175:
buffer_load_dwordx4 v[40:43],v1,s[8:11],s71 offen offset:2048 sc1
buffer_load_dwordx4 v[44:47],v1,s[8:11],s80 offen offset:1024 sc1
buffer_load_dwordx4 v[48:51],v1,s[8:11],s70 offen offset:1024 sc1
buffer_load_dwordx4 v[52:55],v1,s[8:11],s71 offen sc1
buffer_load_dwordx4 v[56:59],v1,s[8:11],s71 offen offset:3072 sc1
s_sub_u32 s47,s47,1
s_cbranch_scc1 ABORT
s_waitcnt vmcnt(4)
v_and_b32 v12,1,v40
v_cmp_ne_u32 vcc,s57,v12
s_nop 0
s_cbranch_vccnz ws_175
s_branch wg_181
ws_176:
buffer_load_dwordx4 v[44:47],v1,s[8:11],s80 offen offset:1024 sc1
buffer_load_dwordx4 v[48:51],v1,s[8:11],s70 offen offset:1024 sc1
buffer_load_dwordx4 v[52:55],v1,s[8:11],s71 offen sc1
buffer_load_dwordx4 v[56:59],v1,s[8:11],s71 offen offset:3072 sc1
buffer_load_dwordx4 v[60:63],v1,s[8:11],s80 offen offset:2048 sc1
s_sub_u32 s47,s47,1
s_cbranch_scc1 ABORT
s_waitcnt vmcnt(4)
v_and_b32 v12,1,v44
v_cmp_ne_u32 vcc,s57,v12
s_nop 0
s_cbranch_vccnz ws_176
s_branch wg_182
ws_177:
buffer_load_dwordx4 v[48:51],v1,s[8:11],s70 offen offset:1024 sc1
buffer_load_dwordx4 v[52:55],v1,s[8:11],s71 offen sc1
buffer_load_dwordx4 v[56:59],v1,s[8:11],s71 offen offset:3072 sc1
buffer_load_dwordx4 v[60:63],v1,s[8:11],s80 offen offset:2048 sc1
buffer_load_dwordx4 v[64:67],v1,s[8:11],s70 offen offset:2048 sc1
s_sub_u32 s47,s47,1
s_cbranch_scc1 ABORT
s_waitcnt vmcnt(4)
v_and_b32 v12,1,v48
v_cmp_ne_u32 vcc,s57,v12
s_nop 0
s_cbranch_vccnz ws_177
s_branch wg_183
ws_178:
buffer_load_dwordx4 v[52:55],v1,s[8:11],s71 offen sc1
buffer_load_dwordx4 v[56:59],v1,s[8:11],s71 offen offset:3072 sc1
buffer_load_dwordx4 v[60:63],v1,s[8:11],s80 offen offset:2048 sc1
buffer_load_dwordx4 v[64:67],v1,s[8:11],s70 offen offset:2048 sc1
buffer_load_dwordx4 v[68:71],v1,s[8:11],s71 offen offset:1024 sc1
s_sub_u32 s47,s47,1
s_cbranch_scc1 ABORT
s_waitcnt vmcnt(4)
v_and_b32 v12,1,v52
v_cmp_ne_u32 vcc,s57,v12
s_nop 0
s_cbranch_vccnz ws_178
s_branch wg_184
rd_170x:
s_sub_u32 s47,s47,1
s_cbranch_scc1 ABORT
s_waitcnt lgkmcnt(0)
s_nop 7
ds_read_b128 v[100:103],v4 offset:0
ds_read_b128 v[104:107],v4 offset:1024
ds_read_b128 v[108:111],v4 offset:6144
ds_read_b128 v[112:115],v4 offset:7168
s_branch rd_170
CW_LOOP_S:
s_sub_u32 s60,s50,13
s_lshr_b32 s52,s60,1
s_and_b32 s51,s60,1
s_cmp_eq_u32 s51,0
s_cselect_b32 s61,13,0
s_add_u32 s52,s52,s61
s_sub_u32 s61,s60,51
s_cmp_ge_u32 s60,102
s_cselect_b32 s52,s61,s52
s_cselect_b32 s51,1,s51
s_cmp_lt_u32 s50,13
s_cselect_b32 s52,s50,s52
s_cselect_b32 s51,0,s51
s_cmp_eq_u32 s52,63
s_cbranch_scc1 CW_NEXT_S
s_add_u32 s58,s52,1
s_lshl_b32 s61,s51,9
s_add_u32 s72,s61,s35
s_add_u32 s69,s61,s85
s_lshl_b32 s61,s51,2
s_and_b32 s60,s52,1
s_add_u32 s60,s60,s61
s_mul_i32 s70,s60,49152
s_add_u32 s70,s70,s33
s_add_u32 s71,s70,4096
s_add_u32 s80,s70,8192
s_bfe_u32 s57,s52,65537
s_bfe_u32 s31,s58,65537
s_and_b32 s60,s58,1
s_add_u32 s60,s60,s61
s_mul_i32 s59,s60,20480
s_add_u32 s59,s59,s84
s_lshl_b32 s68,s60,16
s_add_u32 s68,s68,s83
s_xor_b32 s77,s77,11264
v_add_u32 v7,s77,v5
v_add_u32 v8,s77,v6
s_add_u32 s60,s52,2
v_mov_b32 v16,s60
ds_read_b128 v[100:103],v4 offset:0
ds_read_b128 v[104:107],v4 offset:1024
ds_read_b128 v[108:111],v4 offset:6144
ds_read_b128 v[112:115],v4 offset:7168
s_cmp_lg_u32 s46,0
s_cbranch_scc1 np_185
db_187:
buffer_load_dword v12,v3,s[8:11],s72 offen sc1
s_waitcnt vmcnt(0)
v_cmp_gt_u32 vcc,s58,v12
s_cbranch_vccz dbok_188
s_sub_u32 s47,s47,1
s_cbranch_scc1 ABORT
s_branch db_187
dbok_188:
np_185:
s_barrier
rd_186:
buffer_load_dwordx4 v[32:35],v1,s[8:11],s70 offen sc1
v_mov_b32 v80,0
v_mov_b32 v81,0
v_mov_b32 v82,0
v_mov_b32 v83,0
v_mov_b32 v84,0
buffer_load_dwordx4 v[36:39],v1,s[8:11],s70 offen offset:3072 sc1
v_mov_b32 v85,0
v_mov_b32 v86,0
v_mov_b32 v87,0
v_mov_b32 v88,0
v_mov_b32 v89,0
buffer_load_dwordx4 v[40:43],v1,s[8:11],s71 offen offset:2048 sc1
v_mov_b32 v90,0
v_mov_b32 v91,0
v_mov_b32 v92,0
v_mov_b32 v93,0
v_mov_b32 v94,0
buffer_load_dwordx4 v[44:47],v1,s[8:11],s80 offen offset:1024 sc1
v_mov_b32 v95,0
v_mov_b32 v96,0
v_mov_b32 v97,0
v_mov_b32 v98,0
v_mov_b32 v99,0
buffer_load_dwordx4 v[48:51],v1,s[8:11],s70 offen offset:1024 sc1
s_waitcnt vmcnt(4)
v_and_b32 v12,1,v32
v_cmp_ne_u32 vcc,s57,v12
s_cbranch_vccnz ws_189
wg_195:
v_smfmac_f32_16x16x64_bf16 v[80:83],v[32:35],a[0:7],v2
buffer_load_dwordx4 v[52:55],v1,s[8:11],s71 offen sc1
v_smfmac_f32_16x16x64_bf16 v[84:87],v[32:35],a[8:15],v2
s_waitcnt vmcnt(4)
v_and_b32 v12,1,v36
v_smfmac_f32_16x16x64_bf16 v[88:91],v[32:35],a[16:23],v2
v_cmp_ne_u32 vcc,s57,v12
v_smfmac_f32_16x16x64_bf16 v[92:95],v[32:35],a[24:31],v2
s_waitcnt lgkmcnt(2)
v_smfmac_f32_16x16x64_bf16 v[96:99],v[32:35],v[100:107],v2
s_cbranch_vccnz ws_190
wg_196:
v_smfmac_f32_16x16x64_bf16 v[80:83],v[36:39],a[96:103],v2
buffer_load_dwordx4 v[56:59],v1,s[8:11],s71 offen offset:3072 sc1
v_smfmac_f32_16x16x64_bf16 v[84:87],v[36:39],a[104:111],v2
s_waitcnt vmcnt(4)
v_and_b32 v12,1,v40
v_smfmac_f32_16x16x64_bf16 v[88:91],v[36:39],a[112:119],v2
v_cmp_ne_u32 vcc,s57,v12
v_smfmac_f32_16x16x64_bf16 v[92:95],v[36:39],a[120:127],v2
s_waitcnt lgkmcnt(0)
v_smfmac_f32_16x16x64_bf16 v[96:99],v[36:39],v[108:115],v2
s_cbranch_vccnz ws_191
wg_197:
v_smfmac_f32_16x16x64_bf16 v[80:83],v[40:43],a[192:199],v2
buffer_load_dwordx4 v[60:63],v1,s[8:11],s80 offen offset:2048 sc1
v_smfmac_f32_16x16x64_bf16 v[84:87],v[40:43],a[200:207],v2
s_waitcnt vmcnt(4)
v_and_b32 v12,1,v44
v_smfmac_f32_16x16x64_bf16 v[88:91],v[40:43],a[208:215],v2
v_cmp_ne_u32 vcc,s57,v12
ds_read_b128 v[100:103],v4 offset:18432
v_smfmac_f32_16x16x64_bf16 v[92:95],v[40:43],a[216:223],v2
ds_read_b128 v[104:107],v4 offset:19456
v_smfmac_f32_16x16x64_bf16 v[96:99],v[40:43],v[20:27],v2
s_cbranch_vccnz ws_192
wg_198:
v_smfmac_f32_16x16x64_bf16 v[80:83],v[44:47],v[160:167],v2
buffer_load_dwordx4 v[64:67],v1,s[8:11],s70 offen offset:2048 sc1
v_smfmac_f32_16x16x64_bf16 v[84:87],v[44:47],v[168:175],v2
s_waitcnt vmcnt(4)
v_and_b32 v12,1,v48
v_smfmac_f32_16x16x64_bf16 v[88:91],v[44:47],v[176:183],v2
v_cmp_ne_u32 vcc,s57,v12
ds_read_b128 v[108:111],v4 offset:2048
v_smfmac_f32_16x16x64_bf16 v[92:95],v[44:47],v[184:191],v2
ds_read_b128 v[112:115],v4 offset:3072
s_waitcnt lgkmcnt(2)
v_smfmac_f32_16x16x64_bf16 v[96:99],v[44:47],v[100:107],v2
s_cbranch_vccnz ws_193
wg_199:
v_smfmac_f32_16x16x64_bf16 v[80:83],v[48:51],a[32:39],v2
buffer_load_dwordx4 v[68:71],v1,s[8:11],s71 offen offset:1024 sc1
v_smfmac_f32_16x16x64_bf16 v[84:87],v[48:51],a[40:47],v2
s_waitcnt vmcnt(4)
v_and_b32 v12,1,v52
v_smfmac_f32_16x16x64_bf16 v[88:91],v[48:51],a[48:55],v2
v_cmp_ne_u32 vcc,s57,v12
ds_read_b128 v[100:103],v4 offset:8192
v_smfmac_f32_16x16x64_bf16 v[92:95],v[48:51],a[56:63],v2
ds_read_b128 v[104:107],v4 offset:9216
s_waitcnt lgkmcnt(2)
v_smfmac_f32_16x16x64_bf16 v[96:99],v[48:51],v[108:115],v2
s_cbranch_vccnz ws_194
wg_200:
v_smfmac_f32_16x16x64_bf16 v[80:83],v[52:55],a[128:135],v2
buffer_load_dwordx4 v[72:75],v1,s[8:11],s80 offen sc1
v_smfmac_f32_16x16x64_bf16 v[84:87],v[52:55],a[136:143],v2
ds_read_b128 v[108:111],v4 offset:14336
v_smfmac_f32_16x16x64_bf16 v[88:91],v[52:55],a[144:151],v2
ds_read_b128 v[112:115],v4 offset:15360
v_smfmac_f32_16x16x64_bf16 v[92:95],v[52:55],a[152:159],v2
s_waitcnt lgkmcnt(2)
v_smfmac_f32_16x16x64_bf16 v[96:99],v[52:55],v[100:107],v2
buffer_load_dwordx4 v[76:79],v1,s[8:11],s80 offen offset:3072 sc1
s_waitcnt vmcnt(5)
v_smfmac_f32_16x16x64_bf16 v[80:83],v[56:59],a[224:231],v2
ds_read_b128 v[100:103],v4 offset:20480
v_smfmac_f32_16x16x64_bf16 v[84:87],v[56:59],a[232:239],v2
ds_read_b128 v[104:107],v4 offset:21504
v_smfmac_f32_16x16x64_bf16 v[88:91],v[56:59],a[240:247],v2
v_smfmac_f32_16x16x64_bf16 v[92:95],v[56:59],a[248:255],v2
s_waitcnt lgkmcnt(2)
v_smfmac_f32_16x16x64_bf16 v[96:99],v[56:59],v[108:115],v2
s_waitcnt vmcnt(4)
v_smfmac_f32_16x16x64_bf16 v[80:83],v[60:63],v[192:199],v2
ds_read_b128 v[108:111],v4 offset:4096
v_bitop3_b32 v13,v56,v60,s57 bitop3:0x7e
v_smfmac_f32_16x16x64_bf16 v[84:87],v[60:63],v[200:207],v2
ds_read_b128 v[112:115],v4 offset:5120
v_smfmac_f32_16x16x64_bf16 v[88:91],v[60:63],v[208:215],v2
v_smfmac_f32_16x16x64_bf16 v[92:95],v[60:63],v[216:223],v2
s_waitcnt lgkmcnt(2)
v_smfmac_f32_16x16x64_bf16 v[96:99],v[60:63],v[100:107],v2
s_waitcnt vmcnt(3)
v_smfmac_f32_16x16x64_bf16 v[80:83],v[64:67],a[64:71],v2
ds_read_b128 v[100:103],v4 offset:10240
v_smfmac_f32_16x16x64_bf16 v[84:87],v[64:67],a[72:79],v2
ds_read_b128 v[104:107],v4 offset:11264
v_smfmac_f32_16x16x64_bf16 v[88:91],v[64:67],a[80:87],v2
v_smfmac_f32_16x16x64_bf16 v[92:95],v[64:67],a[88:95],v2
s_waitcnt lgkmcnt(2)
v_smfmac_f32_16x16x64_bf16 v[96:99],v[64:67],v[108:115],v2
s_waitcnt vmcnt(0)
v_smfmac_f32_16x16x64_bf16 v[80:83],v[68:71],a[160:167],v2
ds_read_b128 v[108:111],v4 offset:16384
v_bitop3_b32 v14,v64,v68,s57 bitop3:0x7e
v_smfmac_f32_16x16x64_bf16 v[80:83],v[72:75],v[128:135],v2
ds_read_b128 v[112:115],v4 offset:17408
v_or_b32 v13,v13,v14
v_smfmac_f32_16x16x64_bf16 v[80:83],v[76:79],v[224:231],v2
v_bitop3_b32 v14,v72,v76,s57 bitop3:0x7e
v_smfmac_f32_16x16x64_bf16 v[84:87],v[68:71],a[168:175],v2
v_or_b32 v13,v13,v14
v_smfmac_f32_16x16x64_bf16 v[84:87],v[72:75],v[136:143],v2
v_and_b32 v13,1,v13
v_smfmac_f32_16x16x64_bf16 v[84:87],v[76:79],v[232:239],v2
v_cmp_ne_u32 vcc,0,v13
v_smfmac_f32_16x16x64_bf16 v[88:91],v[68:71],a[176:183],v2
s_cbranch_vccnz rd_186x
v_smfmac_f32_16x16x64_bf16 v[88:91],v[72:75],v[144:151],v2
v_add_f32 v80,v80,v81
v_smfmac_f32_16x16x64_bf16 v[88:91],v[76:79],v[240:247],v2
v_add_f32 v82,v82,v83
ds_write2_b32 v7,v80,v82 offset0:0 offset1:88
v_smfmac_f32_16x16x64_bf16 v[92:95],v[68:71],a[184:191],v2
v_add_f32 v84,v84,v85
v_smfmac_f32_16x16x64_bf16 v[92:95],v[72:75],v[152:159],v2
v_add_f32 v86,v86,v87
ds_write2_b32 v7,v84,v86 offset0:16 offset1:104
v_smfmac_f32_16x16x64_bf16 v[92:95],v[76:79],v[248:255],v2
v_add_f32 v88,v88,v89
s_waitcnt lgkmcnt(4)
v_smfmac_f32_16x16x64_bf16 v[96:99],v[68:71],v[100:107],v2
v_add_f32 v90,v90,v91
s_waitcnt lgkmcnt(2)
v_smfmac_f32_16x16x64_bf16 v[96:99],v[72:75],v[108:115],v2
ds_write2_b32 v7,v88,v90 offset0:32 offset1:120
v_smfmac_f32_16x16x64_bf16 v[96:99],v[76:79],v[116:123],v2
v_add_f32 v92,v92,v93
v_add_f32 v94,v94,v95
ds_write2_b32 v7,v92,v94 offset0:48 offset1:136
s_nop 4
v_add_f32 v96,v96,v97
v_add_f32 v98,v98,v99
ds_write2_b32 v7,v96,v98 offset0:64 offset1:152
s_waitcnt lgkmcnt(0)
s_barrier
ds_read_b128 v[32:35],v8 offset:0
ds_read_b128 v[36:39],v8 offset:2816
ds_read_b128 v[40:43],v8 offset:5632
ds_read_b128 v[44:47],v8 offset:8448
s_mov_b64 exec,1
buffer_store_dword v16,v1,s[8:11],s69 offen sc1
s_mov_b64 exec,-1
s_waitcnt lgkmcnt(2)
v_pk_add_f32 v[32:33],v[32:33],v[36:37]
v_pk_add_f32 v[34:35],v[34:35],v[38:39]
s_waitcnt lgkmcnt(0)
v_pk_add_f32 v[40:41],v[40:41],v[44:45]
v_pk_add_f32 v[42:43],v[42:43],v[46:47]
v_pk_add_f32 v[32:33],v[32:33],v[40:41]
v_pk_add_f32 v[34:35],v[34:35],v[42:43]
v_cvt_pk_bf16_f32 v32,v32,v33
v_cvt_pk_bf16_f32 v33,v34,v35
v_bfi_b32 v32,v10,s31,v32
s_nop 0
v_permlane32_swap_b32 v33,v35
v_permlane32_swap_b32 v32,v34
s_mov_b64 exec,s[88:89]
buffer_store_dwordx4 v[32:35],v9,s[8:11],s59 offen sc1
s_barrier
buffer_store_dwordx4 v[32:35],v9,s[8:11],s68 offen sc1
s_mov_b64 exec,-1
s_nop 0
CW_NEXT_S:
s_add_u32 s50,s50,1
s_cmp_lt_u32 s50,128
s_cbranch_scc1 CW_LOOP_S
s_branch CW_DONE
ws_189:
buffer_load_dwordx4 v[32:35],v1,s[8:11],s70 offen sc1
buffer_load_dwordx4 v[36:39],v1,s[8:11],s70 offen offset:3072 sc1
buffer_load_dwordx4 v[40:43],v1,s[8:11],s71 offen offset:2048 sc1
buffer_load_dwordx4 v[44:47],v1,s[8:11],s80 offen offset:1024 sc1
buffer_load_dwordx4 v[48:51],v1,s[8:11],s70 offen offset:1024 sc1
s_sub_u32 s47,s47,1
s_cbranch_scc1 ABORT
s_waitcnt vmcnt(4)
v_and_b32 v12,1,v32
v_cmp_ne_u32 vcc,s57,v12
s_nop 0
s_cbranch_vccnz ws_189
s_branch wg_195
ws_190:
buffer_load_dwordx4 v[36:39],v1,s[8:11],s70 offen offset:3072 sc1
buffer_load_dwordx4 v[40:43],v1,s[8:11],s71 offen offset:2048 sc1
buffer_load_dwordx4 v[44:47],v1,s[8:11],s80 offen offset:1024 sc1
buffer_load_dwordx4 v[48:51],v1,s[8:11],s70 offen offset:1024 sc1
buffer_load_dwordx4 v[52:55],v1,s[8:11],s71 offen sc1
s_sub_u32 s47,s47,1
s_cbranch_scc1 ABORT
s_waitcnt vmcnt(4)
v_and_b32 v12,1,v36
v_cmp_ne_u32 vcc,s57,v12
s_nop 0
s_cbranch_vccnz ws_190
s_branch wg_196
ws_191:
buffer_load_dwordx4 v[40:43],v1,s[8:11],s71 offen offset:2048 sc1
buffer_load_dwordx4 v[44:47],v1,s[8:11],s80 offen offset:1024 sc1
buffer_load_dwordx4 v[48:51],v1,s[8:11],s70 offen offset:1024 sc1
buffer_load_dwordx4 v[52:55],v1,s[8:11],s71 offen sc1
buffer_load_dwordx4 v[56:59],v1,s[8:11],s71 offen offset:3072 sc1
s_sub_u32 s47,s47,1
s_cbranch_scc1 ABORT
s_waitcnt vmcnt(4)
v_and_b32 v12,1,v40
v_cmp_ne_u32 vcc,s57,v12
s_nop 0
s_cbranch_vccnz ws_191
s_branch wg_197
ws_192:
buffer_load_dwordx4 v[44:47],v1,s[8:11],s80 offen offset:1024 sc1
buffer_load_dwordx4 v[48:51],v1,s[8:11],s70 offen offset:1024 sc1
buffer_load_dwordx4 v[52:55],v1,s[8:11],s71 offen sc1
buffer_load_dwordx4 v[56:59],v1,s[8:11],s71 offen offset:3072 sc1
buffer_load_dwordx4 v[60:63],v1,s[8:11],s80 offen offset:2048 sc1
s_sub_u32 s47,s47,1
s_cbranch_scc1 ABORT
s_waitcnt vmcnt(4)
v_and_b32 v12,1,v44
v_cmp_ne_u32 vcc,s57,v12
s_nop 0
s_cbranch_vccnz ws_192
s_branch wg_198
ws_193:
buffer_load_dwordx4 v[48:51],v1,s[8:11],s70 offen offset:1024 sc1
buffer_load_dwordx4 v[52:55],v1,s[8:11],s71 offen sc1
buffer_load_dwordx4 v[56:59],v1,s[8:11],s71 offen offset:3072 sc1
buffer_load_dwordx4 v[60:63],v1,s[8:11],s80 offen offset:2048 sc1
buffer_load_dwordx4 v[64:67],v1,s[8:11],s70 offen offset:2048 sc1
s_sub_u32 s47,s47,1
s_cbranch_scc1 ABORT
s_waitcnt vmcnt(4)
v_and_b32 v12,1,v48
v_cmp_ne_u32 vcc,s57,v12
s_nop 0
s_cbranch_vccnz ws_193
s_branch wg_199
ws_194:
buffer_load_dwordx4 v[52:55],v1,s[8:11],s71 offen sc1
buffer_load_dwordx4 v[56:59],v1,s[8:11],s71 offen offset:3072 sc1
buffer_load_dwordx4 v[60:63],v1,s[8:11],s80 offen offset:2048 sc1
buffer_load_dwordx4 v[64:67],v1,s[8:11],s70 offen offset:2048 sc1
buffer_load_dwordx4 v[68:71],v1,s[8:11],s71 offen offset:1024 sc1
s_sub_u32 s47,s47,1
s_cbranch_scc1 ABORT
s_waitcnt vmcnt(4)
v_and_b32 v12,1,v52
v_cmp_ne_u32 vcc,s57,v12
s_nop 0
s_cbranch_vccnz ws_194
s_branch wg_200
rd_186x:
s_sub_u32 s47,s47,1
s_cbranch_scc1 ABORT
s_waitcnt lgkmcnt(0)
s_nop 7
ds_read_b128 v[100:103],v4 offset:0
ds_read_b128 v[104:107],v4 offset:1024
ds_read_b128 v[108:111],v4 offset:6144
ds_read_b128 v[112:115],v4 offset:7168
s_branch rd_186
CW_DONE:
s_add_u32 s61,s48,48
s_endpgm
DISPATCH:
s_sub_u32 s48,s3,0
s_cmp_lt_u32 s3,8
s_cbranch_scc1 ROLE_CW
s_sub_u32 s48,s3,8
s_cmp_lt_u32 s3,16
s_cbranch_scc1 ROLE_CV
s_sub_u32 s48,s3,16
s_cmp_lt_u32 s3,32
s_cbranch_scc1 ROLE_CS
s_sub_u32 s48,s3,24
s_cmp_lt_u32 s3,40
s_cbranch_scc1 ROLE_CW
s_sub_u32 s48,s3,32
s_cmp_lt_u32 s3,48
s_cbranch_scc1 ROLE_CV
s_sub_u32 s48,s3,32
s_cmp_lt_u32 s3,64
s_cbranch_scc1 ROLE_CS
s_sub_u32 s48,s3,64
s_cmp_lt_u32 s3,69
s_cbranch_scc1 ROLE_W1
s_sub_u32 s48,s3,69
s_cmp_lt_u32 s3,74
s_cbranch_scc1 ROLE_W2
s_sub_u32 s48,s3,74
s_cmp_lt_u32 s3,86
s_cbranch_scc1 ROLE_W3
s_sub_u32 s48,s3,86
s_cmp_lt_u32 s3,96
s_cbranch_scc1 ROLE_W4
s_sub_u32 s48,s3,96
s_cmp_lt_u32 s3,104
s_cbranch_scc1 ROLE_QKVQ
s_sub_u32 s48,s3,104
s_cmp_lt_u32 s3,112
s_cbranch_scc1 ROLE_QKVV
s_sub_u32 s48,s3,112
s_cmp_lt_u32 s3,128
s_cbranch_scc1 ROLE_R1
s_sub_u32 s48,s3,120
s_cmp_lt_u32 s3,132
s_cbranch_scc1 ROLE_QKVV
s_sub_u32 s48,s3,124
s_cmp_lt_u32 s3,142
s_cbranch_scc1 ROLE_QKVQ
s_sub_u32 s48,s3,142
s_cmp_lt_u32 s3,150
s_cbranch_scc1 ROLE_ATT
s_sub_u32 s48,s3,150
s_cmp_lt_u32 s3,160
s_cbranch_scc1 ROLE_WO
s_sub_u32 s48,s3,148
s_cmp_lt_u32 s3,164
s_cbranch_scc1 ROLE_QKVV
s_sub_u32 s48,s3,146
s_cmp_lt_u32 s3,174
s_cbranch_scc1 ROLE_QKVQ
s_sub_u32 s48,s3,166
s_cmp_lt_u32 s3,182
s_cbranch_scc1 ROLE_ATT
s_sub_u32 s48,s3,172
s_cmp_lt_u32 s3,192
s_cbranch_scc1 ROLE_WO
s_sub_u32 s48,s3,176
s_cmp_lt_u32 s3,196
s_cbranch_scc1 ROLE_QKVV
s_sub_u32 s48,s3,168
s_cmp_lt_u32 s3,206
s_cbranch_scc1 ROLE_QKVQ
s_sub_u32 s48,s3,190
s_cmp_lt_u32 s3,214
s_cbranch_scc1 ROLE_ATT
s_sub_u32 s48,s3,194
s_cmp_lt_u32 s3,224
s_cbranch_scc1 ROLE_WO
s_sub_u32 s48,s3,204
s_cmp_lt_u32 s3,228
s_cbranch_scc1 ROLE_QKVV
s_sub_u32 s48,s3,190
s_cmp_lt_u32 s3,238
s_cbranch_scc1 ROLE_QKVQ
s_sub_u32 s48,s3,214
s_cmp_lt_u32 s3,246
s_cbranch_scc1 ROLE_ATT
s_sub_u32 s48,s3,216
s_cmp_lt_u32 s3,256
s_cbranch_scc1 ROLE_WO
s_branch ROLE_SPARE
EXIT:
s_endpgm
ABORT:
s_mov_b64 exec,1
v_mov_b32 v1,s2
v_add_u32 v1,0x10000,v1
v_mov_b32 v2,8
buffer_store_dword v1,v2,s[12:15],0 offen
s_endpgm
ROLE_SPARE:
s_waitcnt vmcnt(0)
s_barrier
s_cmp_lg_u32 s46,0
s_cbranch_scc1 arr_201
v_mov_b32 v12,1
s_lshl_b32 s3,s49,2
v_mov_b32 v13,s3
s_mov_b64 exec,1
buffer_atomic_add v12,v13,s[12:15],0 offen sc1
s_mov_b64 exec,-1
arr_201:
s_lshl_b32 s3,s49,2
v_mov_b32 v13,s3
s_nop 1
ibw_202:
buffer_load_dword v12,v13,s[12:15],0 offen sc1
s_waitcnt vmcnt(0)
v_cmp_ne_u32 vcc,256,v12
s_nop 0
s_cbranch_vccz ok_203
s_sleep 8
s_sub_u32 s47,s47,1
s_cbranch_scc1 ABORT
s_branch ibw_202
ok_203:
s_cmp_lg_u32 s49,0
s_cbranch_scc1 ibok_204
v_and_b32 v13,7,v0
v_lshlrev_b32 v13,2,v13
buffer_load_dword v12,v13,s[12:15],0 offen offset:32 sc1
s_waitcnt vmcnt(0)
v_cmp_ne_u32 vcc,32,v12
s_nop 0
s_cbranch_vccz ibok_204
s_barrier
s_mov_b32 s49,1
s_mov_b32 s3,s2
s_load_dwordx16 s[16:31],s[0:1],0
s_load_dwordx8 s[32:39],s[0:1],64
s_waitcnt lgkmcnt(0)
s_branch DISPATCH
ibok_204:
s_endpgm
ROLE_QKVQ:
v_lshlrev_b32 v1,4,v0
v_mov_b32 v5,1
s_lshl_b32 s56,s48,2
s_add_u32 s56,s56,s46
v_bfe_u32 v6,v0,2,2
v_lshrrev_b32 v7,4,v0
v_add_u32 v7,v6,v7
v_and_b32 v7,3,v7
v_and_b32 v15,3,v0
v_lshlrev_b32 v15,4,v15
v_lshl_add_u32 v15,v7,6,v15
v_lshl_add_u32 v15,v6,8,v15
v_lshrrev_b32 v6,5,v0
v_bfe_u32 v7,v0,4,1
v_lshlrev_b32 v16,10,v7
v_bfe_u32 v7,v0,2,2
v_lshl_add_u32 v16,v7,8,v16
v_add_u32 v6,v6,v7
v_and_b32 v6,3,v6
v_lshl_add_u32 v16,v6,6,v16
v_and_b32 v6,3,v0
v_lshl_add_u32 v16,v6,4,v16
v_add_u32 v18,46080,v16
v_lshrrev_b32 v6,5,v0
v_bfe_u32 v7,v0,4,1
v_lshlrev_b32 v20,10,v7
v_lshl_add_u32 v20,v6,8,v20
v_and_b32 v6,15,v0
v_lshl_add_u32 v20,v6,4,v20
v_lshrrev_b32 v6,5,v0
v_add_u32 v6,2,v6
v_bfe_u32 v7,v0,4,1
v_lshlrev_b32 v17,10,v7
v_bfe_u32 v7,v0,2,2
v_lshl_add_u32 v17,v7,8,v17
v_add_u32 v6,v6,v7
v_and_b32 v6,3,v6
v_lshl_add_u32 v17,v6,6,v17
v_and_b32 v6,3,v0
v_lshl_add_u32 v17,v6,4,v17
v_add_u32 v19,46080,v17
v_lshrrev_b32 v6,5,v0
v_add_u32 v6,2,v6
v_bfe_u32 v7,v0,4,1
v_lshlrev_b32 v21,10,v7
v_lshl_add_u32 v21,v6,8,v21
v_and_b32 v6,15,v0
v_lshl_add_u32 v21,v6,4,v21
s_cmp_ge_u32 s48,24
s_cselect_b32 s68,1,0
s_mul_i32 s60,s68,96
s_sub_u32 s69,s56,s60
s_mul_i32 s70,s68,50331648
s_add_u32 s70,s70,74448896
s_mul_i32 s60,s68,65536
s_sub_u32 s71,131072,s60
s_lshl_b32 s60,s69,12
s_add_u32 s70,s70,s60
v_lshrrev_b32 v6,5,v0
v_mul_u32_u24 v188,2560,v6
v_and_b32 v6,31,v0
v_lshl_add_u32 v188,v6,3,v188
v_add_u32 v188,0xa000,v188
v_min_u32 v4,7,v0
v_lshlrev_b32 v4,2,v4
v_min_u32 v2,39,v0
v_lshlrev_b32 v2,2,v2
v_mov_b32 v12,93184
s_waitcnt vmcnt(0)
s_barrier
s_cmp_lg_u32 s46,0
s_cbranch_scc1 arr_205
v_mov_b32 v6,1
s_lshl_b32 s3,s49,2
v_mov_b32 v7,s3
s_mov_b64 exec,1
buffer_atomic_add v6,v7,s[12:15],0 offen sc1
s_mov_b64 exec,-1
arr_205:
s_lshl_b32 s58,s69,7
s_mul_i32 s63,s46,40960
s_cmp_eq_u32 s68,0
s_cselect_b32 s4,s22,s20
s_cselect_b32 s5,s23,s21
s_mov_b32 s6,7864320
s_mov_b32 s7,0x20000
v_lshrrev_b32 v9,3,v0
s_mov_b32 s64,12288
v_mul_lo_u32 v9,v9,s64
v_and_b32 v10,7,v0
v_lshl_add_u32 v6,v10,4,v9
s_add_u32 m0,s63,0
s_add_u32 s65,s58,0
buffer_load_dwordx4 v6,s[4:7],s65 offen lds
s_add_u32 m0,s63,1024
s_add_u32 s65,s58,98304
buffer_load_dwordx4 v6,s[4:7],s65 offen lds
s_add_u32 m0,s63,2048
s_add_u32 s65,s58,196608
buffer_load_dwordx4 v6,s[4:7],s65 offen lds
s_add_u32 m0,s63,3072
s_add_u32 s65,s58,294912
buffer_load_dwordx4 v6,s[4:7],s65 offen lds
s_add_u32 m0,s63,4096
s_add_u32 s65,s58,393216
buffer_load_dwordx4 v6,s[4:7],s65 offen lds
s_add_u32 m0,s63,5120
s_add_u32 s65,s58,491520
buffer_load_dwordx4 v6,s[4:7],s65 offen lds
s_add_u32 m0,s63,6144
s_add_u32 s65,s58,589824
buffer_load_dwordx4 v6,s[4:7],s65 offen lds
s_add_u32 m0,s63,7168
s_add_u32 s65,s58,688128
buffer_load_dwordx4 v6,s[4:7],s65 offen lds
s_add_u32 m0,s63,8192
s_add_u32 s65,s58,786432
buffer_load_dwordx4 v6,s[4:7],s65 offen lds
s_add_u32 m0,s63,9216
s_add_u32 s65,s58,884736
buffer_load_dwordx4 v6,s[4:7],s65 offen lds
s_add_u32 m0,s63,10240
s_add_u32 s65,s58,983040
buffer_load_dwordx4 v6,s[4:7],s65 offen lds
s_add_u32 m0,s63,11264
s_add_u32 s65,s58,1081344
buffer_load_dwordx4 v6,s[4:7],s65 offen lds
s_add_u32 m0,s63,12288
s_add_u32 s65,s58,1179648
buffer_load_dwordx4 v6,s[4:7],s65 offen lds
s_add_u32 m0,s63,13312
s_add_u32 s65,s58,1277952
buffer_load_dwordx4 v6,s[4:7],s65 offen lds
s_add_u32 m0,s63,14336
s_add_u32 s65,s58,1376256
buffer_load_dwordx4 v6,s[4:7],s65 offen lds
s_add_u32 m0,s63,15360
s_add_u32 s65,s58,1474560
buffer_load_dwordx4 v6,s[4:7],s65 offen lds
s_add_u32 m0,s63,16384
s_add_u32 s65,s58,1572864
buffer_load_dwordx4 v6,s[4:7],s65 offen lds
s_add_u32 m0,s63,17408
s_add_u32 s65,s58,1671168
buffer_load_dwordx4 v6,s[4:7],s65 offen lds
s_add_u32 m0,s63,18432
s_add_u32 s65,s58,1769472
buffer_load_dwordx4 v6,s[4:7],s65 offen lds
s_add_u32 m0,s63,19456
s_add_u32 s65,s58,1867776
buffer_load_dwordx4 v6,s[4:7],s65 offen lds
s_add_u32 m0,s63,20480
s_add_u32 s65,s58,1966080
buffer_load_dwordx4 v6,s[4:7],s65 offen lds
s_add_u32 m0,s63,21504
s_add_u32 s65,s58,2064384
buffer_load_dwordx4 v6,s[4:7],s65 offen lds
s_add_u32 m0,s63,22528
s_add_u32 s65,s58,2162688
buffer_load_dwordx4 v6,s[4:7],s65 offen lds
s_add_u32 m0,s63,23552
s_add_u32 s65,s58,2260992
buffer_load_dwordx4 v6,s[4:7],s65 offen lds
s_add_u32 m0,s63,24576
s_add_u32 s65,s58,2359296
buffer_load_dwordx4 v6,s[4:7],s65 offen lds
s_add_u32 m0,s63,25600
s_add_u32 s65,s58,2457600
buffer_load_dwordx4 v6,s[4:7],s65 offen lds
s_add_u32 m0,s63,26624
s_add_u32 s65,s58,2555904
buffer_load_dwordx4 v6,s[4:7],s65 offen lds
s_add_u32 m0,s63,27648
s_add_u32 s65,s58,2654208
buffer_load_dwordx4 v6,s[4:7],s65 offen lds
s_add_u32 m0,s63,28672
s_add_u32 s65,s58,2752512
buffer_load_dwordx4 v6,s[4:7],s65 offen lds
s_add_u32 m0,s63,29696
s_add_u32 s65,s58,2850816
buffer_load_dwordx4 v6,s[4:7],s65 offen lds
s_add_u32 m0,s63,30720
s_add_u32 s65,s58,2949120
buffer_load_dwordx4 v6,s[4:7],s65 offen lds
s_add_u32 m0,s63,31744
s_add_u32 s65,s58,3047424
buffer_load_dwordx4 v6,s[4:7],s65 offen lds
s_add_u32 m0,s63,32768
s_add_u32 s65,s58,3145728
buffer_load_dwordx4 v6,s[4:7],s65 offen lds
s_add_u32 m0,s63,33792
s_add_u32 s65,s58,3244032
buffer_load_dwordx4 v6,s[4:7],s65 offen lds
s_add_u32 m0,s63,34816
s_add_u32 s65,s58,3342336
buffer_load_dwordx4 v6,s[4:7],s65 offen lds
s_add_u32 m0,s63,35840
s_add_u32 s65,s58,3440640
buffer_load_dwordx4 v6,s[4:7],s65 offen lds
s_add_u32 m0,s63,36864
s_add_u32 s65,s58,3538944
buffer_load_dwordx4 v6,s[4:7],s65 offen lds
s_add_u32 m0,s63,37888
s_add_u32 s65,s58,3637248
buffer_load_dwordx4 v6,s[4:7],s65 offen lds
s_add_u32 m0,s63,38912
s_add_u32 s65,s58,3735552
buffer_load_dwordx4 v6,s[4:7],s65 offen lds
s_add_u32 m0,s63,39936
s_add_u32 s65,s58,3833856
buffer_load_dwordx4 v6,s[4:7],s65 offen lds
s_waitcnt vmcnt(20)
v_bfe_u32 v9,v0,2,2
v_lshrrev_b32 v10,5,v0
v_lshl_add_u32 v9,v10,2,v9
v_mul_u32_u24 v9,128,v9
v_and_b32 v10,1,v0
v_lshl_add_u32 v9,v10,3,v9
v_bfe_u32 v10,v0,1,1
v_lshl_add_u32 v9,v10,5,v9
v_bfe_u32 v10,v0,4,1
v_lshl_add_u32 v9,v10,4,v9
v_add_u32 v7,s63,v9
ds_read_b64_tr_b16 a[0:1],v7 offset:0
ds_read_b64_tr_b16 a[2:3],v7 offset:2048
ds_read_b64_tr_b16 a[4:5],v7 offset:1024
ds_read_b64_tr_b16 a[6:7],v7 offset:3072
ds_read_b64_tr_b16 a[160:161],v7 offset:64
ds_read_b64_tr_b16 a[162:163],v7 offset:2112
ds_read_b64_tr_b16 a[164:165],v7 offset:1088
ds_read_b64_tr_b16 a[166:167],v7 offset:3136
ds_read_b64_tr_b16 a[8:9],v7 offset:4096
ds_read_b64_tr_b16 a[10:11],v7 offset:6144
ds_read_b64_tr_b16 a[12:13],v7 offset:5120
ds_read_b64_tr_b16 a[14:15],v7 offset:7168
s_waitcnt lgkmcnt(4)
ds_read_b64_tr_b16 a[168:169],v7 offset:4160
ds_read_b64_tr_b16 a[170:171],v7 offset:6208
ds_read_b64_tr_b16 a[172:173],v7 offset:5184
ds_read_b64_tr_b16 a[174:175],v7 offset:7232
ds_read_b64_tr_b16 a[16:17],v7 offset:8192
ds_read_b64_tr_b16 a[18:19],v7 offset:10240
ds_read_b64_tr_b16 a[20:21],v7 offset:9216
ds_read_b64_tr_b16 a[22:23],v7 offset:11264
ds_read_b64_tr_b16 a[176:177],v7 offset:8256
ds_read_b64_tr_b16 a[178:179],v7 offset:10304
ds_read_b64_tr_b16 a[180:181],v7 offset:9280
ds_read_b64_tr_b16 a[182:183],v7 offset:11328
s_waitcnt lgkmcnt(4)
ds_read_b64_tr_b16 a[24:25],v7 offset:12288
ds_read_b64_tr_b16 a[26:27],v7 offset:14336
ds_read_b64_tr_b16 a[28:29],v7 offset:13312
ds_read_b64_tr_b16 a[30:31],v7 offset:15360
ds_read_b64_tr_b16 a[184:185],v7 offset:12352
ds_read_b64_tr_b16 a[186:187],v7 offset:14400
ds_read_b64_tr_b16 a[188:189],v7 offset:13376
ds_read_b64_tr_b16 a[190:191],v7 offset:15424
ds_read_b64_tr_b16 a[32:33],v7 offset:16384
ds_read_b64_tr_b16 a[34:35],v7 offset:18432
ds_read_b64_tr_b16 a[36:37],v7 offset:17408
ds_read_b64_tr_b16 a[38:39],v7 offset:19456
s_waitcnt lgkmcnt(4)
ds_read_b64_tr_b16 a[192:193],v7 offset:16448
ds_read_b64_tr_b16 a[194:195],v7 offset:18496
ds_read_b64_tr_b16 a[196:197],v7 offset:17472
ds_read_b64_tr_b16 a[198:199],v7 offset:19520
s_waitcnt lgkmcnt(0)
s_add_u32 m0,s63,0
s_add_u32 s65,s58,3932160
buffer_load_dwordx4 v6,s[4:7],s65 offen lds
s_add_u32 m0,s63,1024
s_add_u32 s65,s58,4030464
buffer_load_dwordx4 v6,s[4:7],s65 offen lds
s_add_u32 m0,s63,2048
s_add_u32 s65,s58,4128768
buffer_load_dwordx4 v6,s[4:7],s65 offen lds
s_add_u32 m0,s63,3072
s_add_u32 s65,s58,4227072
buffer_load_dwordx4 v6,s[4:7],s65 offen lds
s_add_u32 m0,s63,4096
s_add_u32 s65,s58,4325376
buffer_load_dwordx4 v6,s[4:7],s65 offen lds
s_add_u32 m0,s63,5120
s_add_u32 s65,s58,4423680
buffer_load_dwordx4 v6,s[4:7],s65 offen lds
s_add_u32 m0,s63,6144
s_add_u32 s65,s58,4521984
buffer_load_dwordx4 v6,s[4:7],s65 offen lds
s_add_u32 m0,s63,7168
s_add_u32 s65,s58,4620288
buffer_load_dwordx4 v6,s[4:7],s65 offen lds
s_add_u32 m0,s63,8192
s_add_u32 s65,s58,4718592
buffer_load_dwordx4 v6,s[4:7],s65 offen lds
s_add_u32 m0,s63,9216
s_add_u32 s65,s58,4816896
buffer_load_dwordx4 v6,s[4:7],s65 offen lds
s_add_u32 m0,s63,10240
s_add_u32 s65,s58,4915200
buffer_load_dwordx4 v6,s[4:7],s65 offen lds
s_add_u32 m0,s63,11264
s_add_u32 s65,s58,5013504
buffer_load_dwordx4 v6,s[4:7],s65 offen lds
s_add_u32 m0,s63,12288
s_add_u32 s65,s58,5111808
buffer_load_dwordx4 v6,s[4:7],s65 offen lds
s_add_u32 m0,s63,13312
s_add_u32 s65,s58,5210112
buffer_load_dwordx4 v6,s[4:7],s65 offen lds
s_add_u32 m0,s63,14336
s_add_u32 s65,s58,5308416
buffer_load_dwordx4 v6,s[4:7],s65 offen lds
s_add_u32 m0,s63,15360
s_add_u32 s65,s58,5406720
buffer_load_dwordx4 v6,s[4:7],s65 offen lds
s_add_u32 m0,s63,16384
s_add_u32 s65,s58,5505024
buffer_load_dwordx4 v6,s[4:7],s65 offen lds
s_add_u32 m0,s63,17408
s_add_u32 s65,s58,5603328
buffer_load_dwordx4 v6,s[4:7],s65 offen lds
s_add_u32 m0,s63,18432
s_add_u32 s65,s58,5701632
buffer_load_dwordx4 v6,s[4:7],s65 offen lds
s_add_u32 m0,s63,19456
s_add_u32 s65,s58,5799936
buffer_load_dwordx4 v6,s[4:7],s65 offen lds
s_waitcnt vmcnt(20)
v_bfe_u32 v9,v0,2,2
v_lshrrev_b32 v10,5,v0
v_lshl_add_u32 v9,v10,2,v9
v_mul_u32_u24 v9,128,v9
v_and_b32 v10,1,v0
v_lshl_add_u32 v9,v10,3,v9
v_bfe_u32 v10,v0,1,1
v_lshl_add_u32 v9,v10,5,v9
v_bfe_u32 v10,v0,4,1
v_lshl_add_u32 v9,v10,4,v9
v_add_u32 v7,s63,v9
ds_read_b64_tr_b16 a[40:41],v7 offset:20480
ds_read_b64_tr_b16 a[42:43],v7 offset:22528
ds_read_b64_tr_b16 a[44:45],v7 offset:21504
ds_read_b64_tr_b16 a[46:47],v7 offset:23552
ds_read_b64_tr_b16 a[200:201],v7 offset:20544
ds_read_b64_tr_b16 a[202:203],v7 offset:22592
ds_read_b64_tr_b16 a[204:205],v7 offset:21568
ds_read_b64_tr_b16 a[206:207],v7 offset:23616
ds_read_b64_tr_b16 a[48:49],v7 offset:24576
ds_read_b64_tr_b16 a[50:51],v7 offset:26624
ds_read_b64_tr_b16 a[52:53],v7 offset:25600
ds_read_b64_tr_b16 a[54:55],v7 offset:27648
s_waitcnt lgkmcnt(4)
ds_read_b64_tr_b16 a[208:209],v7 offset:24640
ds_read_b64_tr_b16 a[210:211],v7 offset:26688
ds_read_b64_tr_b16 a[212:213],v7 offset:25664
ds_read_b64_tr_b16 a[214:215],v7 offset:27712
ds_read_b64_tr_b16 a[56:57],v7 offset:28672
ds_read_b64_tr_b16 a[58:59],v7 offset:30720
ds_read_b64_tr_b16 a[60:61],v7 offset:29696
ds_read_b64_tr_b16 a[62:63],v7 offset:31744
ds_read_b64_tr_b16 a[216:217],v7 offset:28736
ds_read_b64_tr_b16 a[218:219],v7 offset:30784
ds_read_b64_tr_b16 a[220:221],v7 offset:29760
ds_read_b64_tr_b16 a[222:223],v7 offset:31808
s_waitcnt lgkmcnt(4)
ds_read_b64_tr_b16 a[64:65],v7 offset:32768
ds_read_b64_tr_b16 a[66:67],v7 offset:34816
ds_read_b64_tr_b16 a[68:69],v7 offset:33792
ds_read_b64_tr_b16 a[70:71],v7 offset:35840
ds_read_b64_tr_b16 a[224:225],v7 offset:32832
ds_read_b64_tr_b16 a[226:227],v7 offset:34880
ds_read_b64_tr_b16 a[228:229],v7 offset:33856
ds_read_b64_tr_b16 a[230:231],v7 offset:35904
ds_read_b64_tr_b16 a[72:73],v7 offset:36864
ds_read_b64_tr_b16 a[74:75],v7 offset:38912
ds_read_b64_tr_b16 a[76:77],v7 offset:37888
ds_read_b64_tr_b16 a[78:79],v7 offset:39936
s_waitcnt lgkmcnt(4)
ds_read_b64_tr_b16 a[232:233],v7 offset:36928
ds_read_b64_tr_b16 a[234:235],v7 offset:38976
ds_read_b64_tr_b16 a[236:237],v7 offset:37952
ds_read_b64_tr_b16 a[238:239],v7 offset:40000
s_waitcnt lgkmcnt(0)
s_add_u32 m0,s63,20480
s_add_u32 s65,s58,5898240
buffer_load_dwordx4 v6,s[4:7],s65 offen lds
s_add_u32 m0,s63,21504
s_add_u32 s65,s58,5996544
buffer_load_dwordx4 v6,s[4:7],s65 offen lds
s_add_u32 m0,s63,22528
s_add_u32 s65,s58,6094848
buffer_load_dwordx4 v6,s[4:7],s65 offen lds
s_add_u32 m0,s63,23552
s_add_u32 s65,s58,6193152
buffer_load_dwordx4 v6,s[4:7],s65 offen lds
s_add_u32 m0,s63,24576
s_add_u32 s65,s58,6291456
buffer_load_dwordx4 v6,s[4:7],s65 offen lds
s_add_u32 m0,s63,25600
s_add_u32 s65,s58,6389760
buffer_load_dwordx4 v6,s[4:7],s65 offen lds
s_add_u32 m0,s63,26624
s_add_u32 s65,s58,6488064
buffer_load_dwordx4 v6,s[4:7],s65 offen lds
s_add_u32 m0,s63,27648
s_add_u32 s65,s58,6586368
buffer_load_dwordx4 v6,s[4:7],s65 offen lds
s_add_u32 m0,s63,28672
s_add_u32 s65,s58,6684672
buffer_load_dwordx4 v6,s[4:7],s65 offen lds
s_add_u32 m0,s63,29696
s_add_u32 s65,s58,6782976
buffer_load_dwordx4 v6,s[4:7],s65 offen lds
s_add_u32 m0,s63,30720
s_add_u32 s65,s58,6881280
buffer_load_dwordx4 v6,s[4:7],s65 offen lds
s_add_u32 m0,s63,31744
s_add_u32 s65,s58,6979584
buffer_load_dwordx4 v6,s[4:7],s65 offen lds
s_add_u32 m0,s63,32768
s_add_u32 s65,s58,7077888
buffer_load_dwordx4 v6,s[4:7],s65 offen lds
s_add_u32 m0,s63,33792
s_add_u32 s65,s58,7176192
buffer_load_dwordx4 v6,s[4:7],s65 offen lds
s_add_u32 m0,s63,34816
s_add_u32 s65,s58,7274496
buffer_load_dwordx4 v6,s[4:7],s65 offen lds
s_add_u32 m0,s63,35840
s_add_u32 s65,s58,7372800
buffer_load_dwordx4 v6,s[4:7],s65 offen lds
s_add_u32 m0,s63,36864
s_add_u32 s65,s58,7471104
buffer_load_dwordx4 v6,s[4:7],s65 offen lds
s_add_u32 m0,s63,37888
s_add_u32 s65,s58,7569408
buffer_load_dwordx4 v6,s[4:7],s65 offen lds
s_add_u32 m0,s63,38912
s_add_u32 s65,s58,7667712
buffer_load_dwordx4 v6,s[4:7],s65 offen lds
s_add_u32 m0,s63,39936
s_add_u32 s65,s58,7766016
buffer_load_dwordx4 v6,s[4:7],s65 offen lds
s_waitcnt vmcnt(20)
v_bfe_u32 v9,v0,2,2
v_lshrrev_b32 v10,5,v0
v_lshl_add_u32 v9,v10,2,v9
v_mul_u32_u24 v9,128,v9
v_and_b32 v10,1,v0
v_lshl_add_u32 v9,v10,3,v9
v_bfe_u32 v10,v0,1,1
v_lshl_add_u32 v9,v10,5,v9
v_bfe_u32 v10,v0,4,1
v_lshl_add_u32 v9,v10,4,v9
v_add_u32 v7,s63,v9
ds_read_b64_tr_b16 a[80:81],v7 offset:0
ds_read_b64_tr_b16 a[82:83],v7 offset:2048
ds_read_b64_tr_b16 a[84:85],v7 offset:1024
ds_read_b64_tr_b16 a[86:87],v7 offset:3072
ds_read_b64_tr_b16 a[240:241],v7 offset:64
ds_read_b64_tr_b16 a[242:243],v7 offset:2112
ds_read_b64_tr_b16 a[244:245],v7 offset:1088
ds_read_b64_tr_b16 a[246:247],v7 offset:3136
ds_read_b64_tr_b16 a[88:89],v7 offset:4096
ds_read_b64_tr_b16 a[90:91],v7 offset:6144
ds_read_b64_tr_b16 a[92:93],v7 offset:5120
ds_read_b64_tr_b16 a[94:95],v7 offset:7168
s_waitcnt lgkmcnt(4)
ds_read_b64_tr_b16 a[248:249],v7 offset:4160
ds_read_b64_tr_b16 a[250:251],v7 offset:6208
ds_read_b64_tr_b16 a[252:253],v7 offset:5184
ds_read_b64_tr_b16 a[254:255],v7 offset:7232
ds_read_b64_tr_b16 a[96:97],v7 offset:8192
ds_read_b64_tr_b16 a[98:99],v7 offset:10240
ds_read_b64_tr_b16 a[100:101],v7 offset:9216
ds_read_b64_tr_b16 a[102:103],v7 offset:11264
ds_read_b64_tr_b16 v[192:193],v7 offset:8256
ds_read_b64_tr_b16 v[194:195],v7 offset:10304
ds_read_b64_tr_b16 v[196:197],v7 offset:9280
ds_read_b64_tr_b16 v[198:199],v7 offset:11328
s_waitcnt lgkmcnt(4)
ds_read_b64_tr_b16 a[104:105],v7 offset:12288
ds_read_b64_tr_b16 a[106:107],v7 offset:14336
ds_read_b64_tr_b16 a[108:109],v7 offset:13312
ds_read_b64_tr_b16 a[110:111],v7 offset:15360
ds_read_b64_tr_b16 v[200:201],v7 offset:12352
ds_read_b64_tr_b16 v[202:203],v7 offset:14400
ds_read_b64_tr_b16 v[204:205],v7 offset:13376
ds_read_b64_tr_b16 v[206:207],v7 offset:15424
ds_read_b64_tr_b16 a[112:113],v7 offset:16384
ds_read_b64_tr_b16 a[114:115],v7 offset:18432
ds_read_b64_tr_b16 a[116:117],v7 offset:17408
ds_read_b64_tr_b16 a[118:119],v7 offset:19456
s_waitcnt lgkmcnt(4)
ds_read_b64_tr_b16 v[208:209],v7 offset:16448
ds_read_b64_tr_b16 v[210:211],v7 offset:18496
ds_read_b64_tr_b16 v[212:213],v7 offset:17472
ds_read_b64_tr_b16 v[214:215],v7 offset:19520
s_waitcnt lgkmcnt(0)
s_waitcnt vmcnt(0)
v_bfe_u32 v9,v0,2,2
v_lshrrev_b32 v10,5,v0
v_lshl_add_u32 v9,v10,2,v9
v_mul_u32_u24 v9,128,v9
v_and_b32 v10,1,v0
v_lshl_add_u32 v9,v10,3,v9
v_bfe_u32 v10,v0,1,1
v_lshl_add_u32 v9,v10,5,v9
v_bfe_u32 v10,v0,4,1
v_lshl_add_u32 v9,v10,4,v9
v_add_u32 v7,s63,v9
ds_read_b64_tr_b16 a[120:121],v7 offset:20480
ds_read_b64_tr_b16 a[122:123],v7 offset:22528
ds_read_b64_tr_b16 a[124:125],v7 offset:21504
ds_read_b64_tr_b16 a[126:127],v7 offset:23552
ds_read_b64_tr_b16 v[216:217],v7 offset:20544
ds_read_b64_tr_b16 v[218:219],v7 offset:22592
ds_read_b64_tr_b16 v[220:221],v7 offset:21568
ds_read_b64_tr_b16 v[222:223],v7 offset:23616
ds_read_b64_tr_b16 a[128:129],v7 offset:24576
ds_read_b64_tr_b16 a[130:131],v7 offset:26624
ds_read_b64_tr_b16 a[132:133],v7 offset:25600
ds_read_b64_tr_b16 a[134:135],v7 offset:27648
s_waitcnt lgkmcnt(4)
ds_read_b64_tr_b16 v[224:225],v7 offset:24640
ds_read_b64_tr_b16 v[226:227],v7 offset:26688
ds_read_b64_tr_b16 v[228:229],v7 offset:25664
ds_read_b64_tr_b16 v[230:231],v7 offset:27712
ds_read_b64_tr_b16 a[136:137],v7 offset:28672
ds_read_b64_tr_b16 a[138:139],v7 offset:30720
ds_read_b64_tr_b16 a[140:141],v7 offset:29696
ds_read_b64_tr_b16 a[142:143],v7 offset:31744
ds_read_b64_tr_b16 v[232:233],v7 offset:28736
ds_read_b64_tr_b16 v[234:235],v7 offset:30784
ds_read_b64_tr_b16 v[236:237],v7 offset:29760
ds_read_b64_tr_b16 v[238:239],v7 offset:31808
s_waitcnt lgkmcnt(4)
ds_read_b64_tr_b16 a[144:145],v7 offset:32768
ds_read_b64_tr_b16 a[146:147],v7 offset:34816
ds_read_b64_tr_b16 a[148:149],v7 offset:33792
ds_read_b64_tr_b16 a[150:151],v7 offset:35840
ds_read_b64_tr_b16 v[240:241],v7 offset:32832
ds_read_b64_tr_b16 v[242:243],v7 offset:34880
ds_read_b64_tr_b16 v[244:245],v7 offset:33856
ds_read_b64_tr_b16 v[246:247],v7 offset:35904
ds_read_b64_tr_b16 a[152:153],v7 offset:36864
ds_read_b64_tr_b16 a[154:155],v7 offset:38912
ds_read_b64_tr_b16 a[156:157],v7 offset:37888
ds_read_b64_tr_b16 a[158:159],v7 offset:39936
s_waitcnt lgkmcnt(4)
ds_read_b64_tr_b16 v[248:249],v7 offset:36928
ds_read_b64_tr_b16 v[250:251],v7 offset:38976
ds_read_b64_tr_b16 v[252:253],v7 offset:37952
ds_read_b64_tr_b16 v[254:255],v7 offset:40000
s_waitcnt lgkmcnt(0)
v_mov_b32 v24,0x3f803f80
v_mov_b32 v25,0x3f803f80
v_mov_b32 v26,0x3f803f80
v_mov_b32 v27,0x3f803f80
s_nop 1
v_mfma_f32_32x32x16_bf16 v[120:135],a[0:3],v[24:27],0
v_mfma_f32_32x32x16_bf16 v[136:151],a[160:163],v[24:27],0
v_mfma_f32_32x32x16_bf16 v[120:135],a[4:7],v[24:27],v[120:135]
v_mfma_f32_32x32x16_bf16 v[136:151],a[164:167],v[24:27],v[136:151]
v_mfma_f32_32x32x16_bf16 v[120:135],a[8:11],v[24:27],v[120:135]
v_mfma_f32_32x32x16_bf16 v[136:151],a[168:171],v[24:27],v[136:151]
v_mfma_f32_32x32x16_bf16 v[120:135],a[12:15],v[24:27],v[120:135]
v_mfma_f32_32x32x16_bf16 v[136:151],a[172:175],v[24:27],v[136:151]
v_mfma_f32_32x32x16_bf16 v[120:135],a[16:19],v[24:27],v[120:135]
v_mfma_f32_32x32x16_bf16 v[136:151],a[176:179],v[24:27],v[136:151]
v_mfma_f32_32x32x16_bf16 v[120:135],a[20:23],v[24:27],v[120:135]
v_mfma_f32_32x32x16_bf16 v[136:151],a[180:183],v[24:27],v[136:151]
v_mfma_f32_32x32x16_bf16 v[120:135],a[24:27],v[24:27],v[120:135]
v_mfma_f32_32x32x16_bf16 v[136:151],a[184:187],v[24:27],v[136:151]
v_mfma_f32_32x32x16_bf16 v[120:135],a[28:31],v[24:27],v[120:135]
v_mfma_f32_32x32x16_bf16 v[136:151],a[188:191],v[24:27],v[136:151]
v_mfma_f32_32x32x16_bf16 v[120:135],a[32:35],v[24:27],v[120:135]
v_mfma_f32_32x32x16_bf16 v[136:151],a[192:195],v[24:27],v[136:151]
v_mfma_f32_32x32x16_bf16 v[120:135],a[36:39],v[24:27],v[120:135]
v_mfma_f32_32x32x16_bf16 v[136:151],a[196:199],v[24:27],v[136:151]
v_mfma_f32_32x32x16_bf16 v[120:135],a[40:43],v[24:27],v[120:135]
v_mfma_f32_32x32x16_bf16 v[136:151],a[200:203],v[24:27],v[136:151]
v_mfma_f32_32x32x16_bf16 v[120:135],a[44:47],v[24:27],v[120:135]
v_mfma_f32_32x32x16_bf16 v[136:151],a[204:207],v[24:27],v[136:151]
v_mfma_f32_32x32x16_bf16 v[120:135],a[48:51],v[24:27],v[120:135]
v_mfma_f32_32x32x16_bf16 v[136:151],a[208:211],v[24:27],v[136:151]
v_mfma_f32_32x32x16_bf16 v[120:135],a[52:55],v[24:27],v[120:135]
v_mfma_f32_32x32x16_bf16 v[136:151],a[212:215],v[24:27],v[136:151]
v_mfma_f32_32x32x16_bf16 v[120:135],a[56:59],v[24:27],v[120:135]
v_mfma_f32_32x32x16_bf16 v[136:151],a[216:219],v[24:27],v[136:151]
v_mfma_f32_32x32x16_bf16 v[120:135],a[60:63],v[24:27],v[120:135]
v_mfma_f32_32x32x16_bf16 v[136:151],a[220:223],v[24:27],v[136:151]
v_mfma_f32_32x32x16_bf16 v[120:135],a[64:67],v[24:27],v[120:135]
v_mfma_f32_32x32x16_bf16 v[136:151],a[224:227],v[24:27],v[136:151]
v_mfma_f32_32x32x16_bf16 v[120:135],a[68:71],v[24:27],v[120:135]
v_mfma_f32_32x32x16_bf16 v[136:151],a[228:231],v[24:27],v[136:151]
v_mfma_f32_32x32x16_bf16 v[120:135],a[72:75],v[24:27],v[120:135]
v_mfma_f32_32x32x16_bf16 v[136:151],a[232:235],v[24:27],v[136:151]
v_mfma_f32_32x32x16_bf16 v[120:135],a[76:79],v[24:27],v[120:135]
v_mfma_f32_32x32x16_bf16 v[136:151],a[236:239],v[24:27],v[136:151]
v_mfma_f32_32x32x16_bf16 v[120:135],a[80:83],v[24:27],v[120:135]
v_mfma_f32_32x32x16_bf16 v[136:151],a[240:243],v[24:27],v[136:151]
v_mfma_f32_32x32x16_bf16 v[120:135],a[84:87],v[24:27],v[120:135]
v_mfma_f32_32x32x16_bf16 v[136:151],a[244:247],v[24:27],v[136:151]
v_mfma_f32_32x32x16_bf16 v[120:135],a[88:91],v[24:27],v[120:135]
v_mfma_f32_32x32x16_bf16 v[136:151],a[248:251],v[24:27],v[136:151]
v_mfma_f32_32x32x16_bf16 v[120:135],a[92:95],v[24:27],v[120:135]
v_mfma_f32_32x32x16_bf16 v[136:151],a[252:255],v[24:27],v[136:151]
v_mfma_f32_32x32x16_bf16 v[120:135],a[96:99],v[24:27],v[120:135]
v_mfma_f32_32x32x16_bf16 v[136:151],v[192:195],v[24:27],v[136:151]
v_mfma_f32_32x32x16_bf16 v[120:135],a[100:103],v[24:27],v[120:135]
v_mfma_f32_32x32x16_bf16 v[136:151],v[196:199],v[24:27],v[136:151]
v_mfma_f32_32x32x16_bf16 v[120:135],a[104:107],v[24:27],v[120:135]
v_mfma_f32_32x32x16_bf16 v[136:151],v[200:203],v[24:27],v[136:151]
v_mfma_f32_32x32x16_bf16 v[120:135],a[108:111],v[24:27],v[120:135]
v_mfma_f32_32x32x16_bf16 v[136:151],v[204:207],v[24:27],v[136:151]
v_mfma_f32_32x32x16_bf16 v[120:135],a[112:115],v[24:27],v[120:135]
v_mfma_f32_32x32x16_bf16 v[136:151],v[208:211],v[24:27],v[136:151]
v_mfma_f32_32x32x16_bf16 v[120:135],a[116:119],v[24:27],v[120:135]
v_mfma_f32_32x32x16_bf16 v[136:151],v[212:215],v[24:27],v[136:151]
v_mfma_f32_32x32x16_bf16 v[120:135],a[120:123],v[24:27],v[120:135]
v_mfma_f32_32x32x16_bf16 v[136:151],v[216:219],v[24:27],v[136:151]
v_mfma_f32_32x32x16_bf16 v[120:135],a[124:127],v[24:27],v[120:135]
v_mfma_f32_32x32x16_bf16 v[136:151],v[220:223],v[24:27],v[136:151]
v_mfma_f32_32x32x16_bf16 v[120:135],a[128:131],v[24:27],v[120:135]
v_mfma_f32_32x32x16_bf16 v[136:151],v[224:227],v[24:27],v[136:151]
v_mfma_f32_32x32x16_bf16 v[120:135],a[132:135],v[24:27],v[120:135]
v_mfma_f32_32x32x16_bf16 v[136:151],v[228:231],v[24:27],v[136:151]
v_mfma_f32_32x32x16_bf16 v[120:135],a[136:139],v[24:27],v[120:135]
v_mfma_f32_32x32x16_bf16 v[136:151],v[232:235],v[24:27],v[136:151]
v_mfma_f32_32x32x16_bf16 v[120:135],a[140:143],v[24:27],v[120:135]
v_mfma_f32_32x32x16_bf16 v[136:151],v[236:239],v[24:27],v[136:151]
v_mfma_f32_32x32x16_bf16 v[120:135],a[144:147],v[24:27],v[120:135]
v_mfma_f32_32x32x16_bf16 v[136:151],v[240:243],v[24:27],v[136:151]
v_mfma_f32_32x32x16_bf16 v[120:135],a[148:151],v[24:27],v[120:135]
v_mfma_f32_32x32x16_bf16 v[136:151],v[244:247],v[24:27],v[136:151]
v_mfma_f32_32x32x16_bf16 v[120:135],a[152:155],v[24:27],v[120:135]
v_mfma_f32_32x32x16_bf16 v[136:151],v[248:251],v[24:27],v[136:151]
v_mfma_f32_32x32x16_bf16 v[120:135],a[156:159],v[24:27],v[120:135]
v_mfma_f32_32x32x16_bf16 v[136:151],v[252:255],v[24:27],v[136:151]
s_barrier
s_lshl_b32 s3,s49,2
v_mov_b32 v7,s3
s_nop 8
ibw_206:
buffer_load_dword v6,v7,s[12:15],0 offen sc1
s_waitcnt vmcnt(0)
v_cmp_ne_u32 vcc,256,v6
s_nop 0
s_cbranch_vccz ok_207
s_sleep 8
s_sub_u32 s47,s47,1
s_cbranch_scc1 ABORT
s_branch ibw_206
ok_207:
s_cmp_lg_u32 s49,0
s_cbranch_scc1 ibok_208
v_and_b32 v7,7,v0
v_lshlrev_b32 v7,2,v7
buffer_load_dword v6,v7,s[12:15],0 offen offset:32 sc1
s_waitcnt vmcnt(0)
v_cmp_ne_u32 vcc,32,v6
s_nop 0
s_cbranch_vccz ibok_208
s_barrier
s_mov_b32 s49,1
s_mov_b32 s3,s2
s_load_dwordx16 s[16:31],s[0:1],0
s_load_dwordx8 s[32:39],s[0:1],64
s_waitcnt lgkmcnt(0)
s_branch DISPATCH
ibok_208:
s_mov_b32 s50,0
s_mov_b32 s32,0
s_mov_b32 s57,0
s_mov_b32 s59,2147483648
s_mov_b32 s82,2147483648
s_mov_b32 s39,2147483648
v_mov_b32 v22,94208
s_mov_b32 s72,0
s_mov_b32 s73,0
s_mov_b32 s78,0
s_mov_b32 s79,0
s_cmp_eq_u32 s46,0
s_cselect_b32 s40,0,2147483648
s_lshl_b32 s60,s46,3
v_add_u32 v13,s60,v22
s_mov_b32 s83,s100
s_lshl_b32 s41,s78,9
s_add_u32 s41,s41,s40
s_lshl_b32 s35,s79,9
s_add_u32 s35,s35,s40
s_add_u32 s35,s35,32768
s_branch QKVQ_COLD0
QKVQ_B0:
s_waitcnt lgkmcnt(3)
v_mfma_f32_32x32x16_bf16 v[56:71],a[0:3],v[24:27],0
ds_read_b128 v[44:47],v17 offset:4096
v_add_u32 v189,s57,v188
v_mfma_f32_32x32x16_bf16 v[72:87],a[160:163],v[24:27],0
v_add_u32 v8,0x800,v189
s_sub_u32 s66,46080,s57
s_lshl_b32 s60,s33,6
s_add_u32 s60,s60,s34
s_mul_i32 s60,s60,46080
s_add_u32 s60,s60,s37
v_mfma_f32_32x32x16_bf16 v[56:71],a[4:7],v[28:31],v[56:71]
ds_read_b128 v[48:51],v16 offset:6144
ds_read2_b64 v[156:159],v189 offset0:0 offset1:32
s_add_u32 s60,s60,206569472
s_lshl_b32 s62,s46,10
v_mfma_f32_32x32x16_bf16 v[72:87],a[164:167],v[28:31],v[72:87]
ds_read2_b64 v[160:163],v189 offset0:64 offset1:96
s_add_u32 s62,s62,40960
s_add_u32 m0,s66,s62
s_add_u32 s63,s60,s62
s_waitcnt lgkmcnt(5)
v_mfma_f32_32x32x16_bf16 v[56:71],a[8:11],v[32:35],v[56:71]
ds_read_b128 v[52:55],v17 offset:6144
ds_read2_b64 v[164:167],v189 offset0:128 offset1:160
buffer_load_dwordx4 v1,s[8:11],s63 offen sc1 lds
v_mfma_f32_32x32x16_bf16 v[72:87],a[168:171],v[32:35],v[72:87]
ds_read2_b64 v[168:171],v189 offset0:192 offset1:224
s_add_u32 m0,s66,45056
s_add_u32 s63,s60,45056
s_mul_i32 s74,s73,393216
s_add_u32 s74,s74,s39
v_mfma_f32_32x32x16_bf16 v[56:71],a[12:15],v[36:39],v[56:71]
ds_read_b128 v[24:27],v16 offset:8192
ds_read2_b64 v[172:175],v8 offset0:0 offset1:32
s_add_u32 s74,s74,s70
v_fma_f32 v88,-v176,v120,v88
v_mfma_f32_32x32x16_bf16 v[72:87],a[172:175],v[36:39],v[72:87]
buffer_load_dwordx4 v1,s[8:11],s63 offen sc1 lds
s_mul_i32 s61,s46,10240
s_add_u32 s60,s60,s61
s_add_u32 s61,s61,s66
s_waitcnt lgkmcnt(8)
v_mfma_f32_32x32x16_bf16 v[56:71],a[16:19],v[40:43],v[56:71]
ds_read_b128 v[28:31],v17 offset:8192
s_add_u32 m0,s61,0
s_add_u32 s63,s60,0
v_fma_f32 v89,-v176,v121,v89
v_fma_f32 v90,-v176,v122,v90
v_mfma_f32_32x32x16_bf16 v[72:87],a[176:179],v[40:43],v[72:87]
v_fma_f32 v91,-v176,v123,v91
v_fma_f32 v92,-v176,v124,v92
v_fma_f32 v93,-v176,v125,v93
v_fma_f32 v94,-v176,v126,v94
v_fma_f32 v95,-v176,v127,v95
v_mfma_f32_32x32x16_bf16 v[56:71],a[20:23],v[44:47],v[56:71]
ds_read_b128 v[32:35],v16 offset:10240
buffer_load_dwordx4 v1,s[8:11],s63 offen sc1 lds
s_mov_b32 s53,s33
s_mov_b32 s54,s34
v_mfma_f32_32x32x16_bf16 v[72:87],a[180:183],v[44:47],v[72:87]
s_add_u32 s79,s79,s33
s_or_b32 s65,s37,s33
s_cmp_eq_u32 s65,0
s_addc_u32 s78,s78,0
s_lshl_b32 s41,s78,9
s_waitcnt lgkmcnt(6)
v_mfma_f32_32x32x16_bf16 v[56:71],a[24:27],v[48:51],v[56:71]
ds_read_b128 v[36:39],v17 offset:10240
s_add_u32 s41,s41,s40
s_lshl_b32 s35,s79,9
s_add_u32 s35,s35,s40
s_add_u32 s35,s35,32768
v_mfma_f32_32x32x16_bf16 v[72:87],a[184:187],v[48:51],v[72:87]
buffer_load_dwordx4 v1,s[8:11],s63 offen offset:1024 sc1 lds
v_mul_f32 v88,v88,v177
v_mul_f32 v89,v89,v177
v_mul_f32 v90,v90,v177
v_mul_f32 v91,v91,v177
v_mfma_f32_32x32x16_bf16 v[56:71],a[28:31],v[52:55],v[56:71]
ds_read_b128 v[40:43],v16 offset:12288
v_mul_f32 v92,v92,v177
v_mul_f32 v93,v93,v177
v_mul_f32 v94,v94,v177
v_mul_f32 v95,v95,v177
v_mfma_f32_32x32x16_bf16 v[72:87],a[188:191],v[52:55],v[72:87]
v_cvt_pk_bf16_f32 v88,v88,v89
v_cvt_pk_bf16_f32 v89,v90,v91
v_cvt_pk_bf16_f32 v90,v92,v93
v_cvt_pk_bf16_f32 v91,v94,v95
v_fma_f32 v96,-v176,v128,v96
s_waitcnt lgkmcnt(3)
v_mfma_f32_32x32x16_bf16 v[56:71],a[32:35],v[24:27],v[56:71]
ds_read_b128 v[44:47],v17 offset:12288
buffer_load_dwordx4 v1,s[8:11],s63 offen offset:2048 sc1 lds
v_fma_f32 v97,-v176,v129,v97
v_fma_f32 v98,-v176,v130,v98
v_mfma_f32_32x32x16_bf16 v[72:87],a[192:195],v[24:27],v[72:87]
v_fma_f32 v99,-v176,v131,v99
v_fma_f32 v100,-v176,v132,v100
v_fma_f32 v101,-v176,v133,v101
v_fma_f32 v102,-v176,v134,v102
v_fma_f32 v103,-v176,v135,v103
v_mfma_f32_32x32x16_bf16 v[56:71],a[36:39],v[28:31],v[56:71]
ds_read_b128 v[48:51],v16 offset:14336
v_mul_f32 v96,v96,v177
v_mul_f32 v97,v97,v177
v_mul_f32 v98,v98,v177
v_mul_f32 v99,v99,v177
v_mfma_f32_32x32x16_bf16 v[72:87],a[196:199],v[28:31],v[72:87]
buffer_load_dwordx4 v1,s[8:11],s63 offen offset:3072 sc1 lds
s_add_u32 m0,s61,4096
s_add_u32 s63,s60,4096
v_mul_f32 v100,v100,v177
s_waitcnt lgkmcnt(3)
v_mfma_f32_32x32x16_bf16 v[56:71],a[40:43],v[32:35],v[56:71]
ds_read_b128 v[52:55],v17 offset:14336
v_mul_f32 v101,v101,v177
v_mul_f32 v102,v102,v177
v_mul_f32 v103,v103,v177
v_cvt_pk_bf16_f32 v96,v96,v97
v_mfma_f32_32x32x16_bf16 v[72:87],a[200:203],v[32:35],v[72:87]
v_cvt_pk_bf16_f32 v97,v98,v99
v_cvt_pk_bf16_f32 v98,v100,v101
v_cvt_pk_bf16_f32 v99,v102,v103
v_fma_f32 v104,-v176,v136,v104
v_fma_f32 v105,-v176,v137,v105
v_mfma_f32_32x32x16_bf16 v[56:71],a[44:47],v[36:39],v[56:71]
ds_read_b128 v[24:27],v16 offset:16384
buffer_load_dwordx4 v1,s[8:11],s63 offen sc1 lds
v_fma_f32 v106,-v176,v138,v106
v_fma_f32 v107,-v176,v139,v107
v_mfma_f32_32x32x16_bf16 v[72:87],a[204:207],v[36:39],v[72:87]
v_fma_f32 v108,-v176,v140,v108
v_fma_f32 v109,-v176,v141,v109
v_fma_f32 v110,-v176,v142,v110
v_fma_f32 v111,-v176,v143,v111
v_mul_f32 v104,v104,v177
s_waitcnt lgkmcnt(3)
v_mfma_f32_32x32x16_bf16 v[56:71],a[48:51],v[40:43],v[56:71]
ds_read_b128 v[28:31],v17 offset:16384
v_mul_f32 v105,v105,v177
v_mul_f32 v106,v106,v177
v_mul_f32 v107,v107,v177
v_mul_f32 v108,v108,v177
v_mfma_f32_32x32x16_bf16 v[72:87],a[208:211],v[40:43],v[72:87]
buffer_load_dwordx4 v1,s[8:11],s63 offen offset:1024 sc1 lds
v_mul_f32 v109,v109,v177
v_mul_f32 v110,v110,v177
v_mul_f32 v111,v111,v177
v_cvt_pk_bf16_f32 v104,v104,v105
v_mfma_f32_32x32x16_bf16 v[56:71],a[52:55],v[44:47],v[56:71]
ds_read_b128 v[32:35],v16 offset:18432
v_cvt_pk_bf16_f32 v105,v106,v107
v_cvt_pk_bf16_f32 v106,v108,v109
v_cvt_pk_bf16_f32 v107,v110,v111
v_fma_f32 v112,-v176,v144,v112
v_mfma_f32_32x32x16_bf16 v[72:87],a[212:215],v[44:47],v[72:87]
v_fma_f32 v113,-v176,v145,v113
v_fma_f32 v114,-v176,v146,v114
v_fma_f32 v115,-v176,v147,v115
v_fma_f32 v116,-v176,v148,v116
v_fma_f32 v117,-v176,v149,v117
s_waitcnt lgkmcnt(3)
v_mfma_f32_32x32x16_bf16 v[56:71],a[56:59],v[48:51],v[56:71]
ds_read_b128 v[36:39],v17 offset:18432
buffer_load_dwordx4 v1,s[8:11],s63 offen offset:2048 sc1 lds
v_fma_f32 v118,-v176,v150,v118
v_fma_f32 v119,-v176,v151,v119
v_mfma_f32_32x32x16_bf16 v[72:87],a[216:219],v[48:51],v[72:87]
v_mul_f32 v112,v112,v177
v_mul_f32 v113,v113,v177
v_mul_f32 v114,v114,v177
v_mul_f32 v115,v115,v177
v_mul_f32 v116,v116,v177
v_mfma_f32_32x32x16_bf16 v[56:71],a[60:63],v[52:55],v[56:71]
ds_read_b128 v[40:43],v16 offset:20480
s_waitcnt vmcnt(9)
s_mov_b64 exec,1
buffer_store_dword v5,v1,s[8:11],s59 offen sc1
s_mov_b64 exec,-1
s_mov_b32 s59,2147483648
v_mfma_f32_32x32x16_bf16 v[72:87],a[220:223],v[52:55],v[72:87]
buffer_load_dwordx4 v1,s[8:11],s63 offen offset:3072 sc1 lds
s_add_u32 m0,s61,8192
s_add_u32 s63,s60,8192
v_mul_f32 v117,v117,v177
s_waitcnt lgkmcnt(3)
v_mfma_f32_32x32x16_bf16 v[56:71],a[64:67],v[24:27],v[56:71]
ds_read_b128 v[44:47],v17 offset:20480
v_mul_f32 v118,v118,v177
v_mul_f32 v119,v119,v177
v_cvt_pk_bf16_f32 v112,v112,v113
v_cvt_pk_bf16_f32 v113,v114,v115
v_mfma_f32_32x32x16_bf16 v[72:87],a[224:227],v[24:27],v[72:87]
v_cvt_pk_bf16_f32 v114,v116,v117
v_cvt_pk_bf16_f32 v115,v118,v119
s_lshl_b32 s82,s72,6
s_add_u32 s82,s82,s73
s_lshl_b32 s82,s82,9
s_add_u32 s82,s82,s71
v_mfma_f32_32x32x16_bf16 v[56:71],a[68:71],v[28:31],v[56:71]
ds_read_b128 v[48:51],v16 offset:22528
buffer_load_dwordx4 v1,s[8:11],s63 offen sc1 lds
s_lshl_b32 s75,s69,2
s_add_u32 s82,s82,s75
v_mfma_f32_32x32x16_bf16 v[72:87],a[228:231],v[28:31],v[72:87]
buffer_load_dword v3,v2,s[8:11],s35 offen sc1
buffer_load_dword v14,v4,s[8:11],s41 offen sc1
s_add_u32 s82,s82,s39
s_waitcnt lgkmcnt(3)
v_mfma_f32_32x32x16_bf16 v[56:71],a[72:75],v[32:35],v[56:71]
ds_read_b128 v[52:55],v17 offset:22528
v_add_f32 v156,v156,v166
v_add_f32 v157,v157,v167
v_add_f32 v158,v158,v168
v_mfma_f32_32x32x16_bf16 v[72:87],a[232:235],v[32:35],v[72:87]
buffer_load_dwordx4 v1,s[8:11],s63 offen offset:1024 sc1 lds
v_add_f32 v159,v159,v169
v_add_f32 v160,v160,v170
v_add_f32 v161,v161,v171
v_add_f32 v162,v162,v172
v_mfma_f32_32x32x16_bf16 v[56:71],a[76:79],v[36:39],v[56:71]
ds_read_b128 v[24:27],v16 offset:24576
v_add_f32 v163,v163,v173
v_add_f32 v164,v164,v174
v_add_f32 v165,v165,v175
v_add_f32 v156,v156,v158
v_mfma_f32_32x32x16_bf16 v[72:87],a[236:239],v[36:39],v[72:87]
v_add_f32 v157,v157,v159
v_add_f32 v160,v160,v162
v_add_f32 v161,v161,v163
v_add_f32 v156,v156,v160
v_add_f32 v157,v157,v161
s_waitcnt lgkmcnt(3)
v_mfma_f32_32x32x16_bf16 v[56:71],a[80:83],v[40:43],v[56:71]
ds_read_b128 v[28:31],v17 offset:24576
buffer_store_dwordx4 v[88:91],v20,s[8:11],s74 offen sc1
v_add_f32 v156,v156,v164
v_add_f32 v157,v157,v165
v_mfma_f32_32x32x16_bf16 v[72:87],a[240:243],v[40:43],v[72:87]
v_mov_b32 v158,v156
v_mov_b32 v159,v157
s_nop 0
v_permlane32_swap_b32 v156,v158
v_permlane32_swap_b32 v157,v159
v_add_f32 v176,v156,v158
v_mfma_f32_32x32x16_bf16 v[56:71],a[84:87],v[44:47],v[56:71]
ds_read_b128 v[32:35],v16 offset:26624
buffer_store_dwordx4 v[96:99],v21,s[8:11],s74 offen sc1
v_add_f32 v177,v157,v159
v_mul_f32 v176,0x3acccccd,v176
v_mfma_f32_32x32x16_bf16 v[72:87],a[244:247],v[44:47],v[72:87]
v_mul_f32 v177,0x3acccccd,v177
v_fma_f32 v177,-v176,v176,v177
v_max_f32 v177,0,v177
v_cvt_pk_bf16_f32 v8,v176,v177
v_lshlrev_b32 v176,16,v8
s_waitcnt lgkmcnt(3)
v_mfma_f32_32x32x16_bf16 v[56:71],a[88:91],v[48:51],v[56:71]
ds_read_b128 v[36:39],v17 offset:26624
buffer_store_dwordx4 v[104:107],v20,s[8:11],s74 offen offset:2048 sc1
v_and_b32 v177,0xffff0000,v8
v_add_f32 v177,0x3727c5ac,v177
v_mfma_f32_32x32x16_bf16 v[72:87],a[248:251],v[48:51],v[72:87]
v_cvt_pk_bf16_f32 v8,v177,v177
v_lshlrev_b32 v177,16,v8
v_sqrt_f32 v177,v177
s_nop 0
v_cvt_pk_bf16_f32 v8,v177,v177
v_lshlrev_b32 v177,16,v8
v_mfma_f32_32x32x16_bf16 v[56:71],a[92:95],v[52:55],v[56:71]
ds_read_b128 v[40:43],v16 offset:28672
buffer_store_dwordx4 v[112:115],v21,s[8:11],s74 offen offset:2048 sc1
v_rcp_f32 v177,v177
v_mfma_f32_32x32x16_bf16 v[72:87],a[252:255],v[52:55],v[72:87]
s_cmp_eq_u32 s51,0
s_cselect_b64 s[76:77],-1,0
v_cndmask_b32 v176,v176,0,s[76:77]
v_cndmask_b32 v177,v177,1.0,s[76:77]
s_mov_b32 s72,s51
s_waitcnt lgkmcnt(3)
v_mfma_f32_32x32x16_bf16 v[56:71],a[96:99],v[24:27],v[56:71]
ds_read_b128 v[44:47],v17 offset:28672
s_mov_b32 s73,s52
v_mfma_f32_32x32x16_bf16 v[72:87],v[192:195],v[24:27],v[72:87]
v_mfma_f32_32x32x16_bf16 v[56:71],a[100:103],v[28:31],v[56:71]
ds_read_b128 v[48:51],v16 offset:30720
v_mfma_f32_32x32x16_bf16 v[72:87],v[196:199],v[28:31],v[72:87]
s_waitcnt lgkmcnt(3)
v_mfma_f32_32x32x16_bf16 v[56:71],a[104:107],v[32:35],v[56:71]
ds_read_b128 v[52:55],v17 offset:30720
v_mfma_f32_32x32x16_bf16 v[72:87],v[200:203],v[32:35],v[72:87]
v_mfma_f32_32x32x16_bf16 v[56:71],a[108:111],v[36:39],v[56:71]
ds_read_b128 v[24:27],v16 offset:32768
v_mfma_f32_32x32x16_bf16 v[72:87],v[204:207],v[36:39],v[72:87]
s_waitcnt lgkmcnt(3)
v_mfma_f32_32x32x16_bf16 v[56:71],a[112:115],v[40:43],v[56:71]
ds_read_b128 v[28:31],v17 offset:32768
v_mfma_f32_32x32x16_bf16 v[72:87],v[208:211],v[40:43],v[72:87]
v_mfma_f32_32x32x16_bf16 v[56:71],a[116:119],v[44:47],v[56:71]
ds_read_b128 v[32:35],v16 offset:34816
v_mfma_f32_32x32x16_bf16 v[72:87],v[212:215],v[44:47],v[72:87]
s_waitcnt lgkmcnt(3)
v_mfma_f32_32x32x16_bf16 v[56:71],a[120:123],v[48:51],v[56:71]
ds_read_b128 v[36:39],v17 offset:34816
v_mfma_f32_32x32x16_bf16 v[72:87],v[216:219],v[48:51],v[72:87]
v_mfma_f32_32x32x16_bf16 v[56:71],a[124:127],v[52:55],v[56:71]
ds_read_b128 v[40:43],v16 offset:36864
v_mfma_f32_32x32x16_bf16 v[72:87],v[220:223],v[52:55],v[72:87]
s_waitcnt lgkmcnt(3)
v_mfma_f32_32x32x16_bf16 v[56:71],a[128:131],v[24:27],v[56:71]
ds_read_b128 v[44:47],v17 offset:36864
s_waitcnt vmcnt(4)
v_cmp_eq_u32 vcc,0,v14
s_cmp_eq_u64 vcc,0
s_cselect_b32 s36,0,2147483648
v_mfma_f32_32x32x16_bf16 v[72:87],v[224:227],v[24:27],v[72:87]
v_cmp_eq_u32 vcc,0,v3
s_cmp_lt_u32 s78,64
s_cselect_b32 s36,s36,2147483648
s_cmp_eq_u64 vcc,0
s_cselect_b32 s60,1,s36
v_mfma_f32_32x32x16_bf16 v[56:71],a[132:135],v[28:31],v[56:71]
ds_read_b128 v[48:51],v16 offset:38912
s_cmp_lt_u32 s79,64
s_cselect_b32 s60,s60,s36
s_sub_u32 s61,s78,s79
s_or_b32 s61,s61,s36
v_mfma_f32_32x32x16_bf16 v[72:87],v[228:231],v[28:31],v[72:87]
s_cmp_lt_u32 s61,16
s_cselect_b32 s36,0,s60
v_mov_b32 v23,s36
s_waitcnt lgkmcnt(3)
v_mfma_f32_32x32x16_bf16 v[56:71],a[136:139],v[32:35],v[56:71]
ds_read_b128 v[52:55],v17 offset:38912
ds_write_b32 v13,v23
v_mfma_f32_32x32x16_bf16 v[72:87],v[232:235],v[32:35],v[72:87]
s_waitcnt lgkmcnt(0)
s_barrier
ds_read_b32 v23,v22
v_mfma_f32_32x32x16_bf16 v[56:71],a[140:143],v[36:39],v[56:71]
ds_read_b128 v[24:27],v18 offset:0
s_cmp_lt_u32 s50,2
s_cselect_b32 s42,1,0
s_cmp_ge_u32 s78,64
s_cselect_b32 s42,1,s42
v_mfma_f32_32x32x16_bf16 v[72:87],v[236:239],v[36:39],v[72:87]
s_or_b32 s42,s42,s37
s_mov_b32 s39,0
s_add_u32 s50,s50,1
s_sub_u32 s57,46080,s57
s_mov_b32 s51,s53
s_mov_b32 s52,s54
v_mfma_f32_32x32x16_bf16 v[56:71],a[144:147],v[40:43],v[56:71]
ds_read_b128 v[28:31],v19 offset:0
v_mfma_f32_32x32x16_bf16 v[72:87],v[240:243],v[40:43],v[72:87]
v_mfma_f32_32x32x16_bf16 v[56:71],a[148:151],v[44:47],v[56:71]
ds_read_b128 v[32:35],v18 offset:2048
s_waitcnt vmcnt(0)
s_mov_b64 exec,1
buffer_store_dword v5,v1,s[8:11],s82 offen sc1
s_mov_b64 exec,-1
s_mov_b32 s82,2147483648
v_mfma_f32_32x32x16_bf16 v[72:87],v[244:247],v[44:47],v[72:87]
s_waitcnt lgkmcnt(3)
v_readfirstlane_b32 s38,v23
s_and_b32 s37,s38,2147483648
s_and_b32 s33,s38,1
s_cselect_b32 s34,s79,s78
s_cmp_lg_u32 s42,0
v_mfma_f32_32x32x16_bf16 v[56:71],a[152:155],v[48:51],v[56:71]
ds_read_b128 v[36:39],v19 offset:2048
v_mfma_f32_32x32x16_bf16 v[72:87],v[248:251],v[48:51],v[72:87]
v_mfma_f32_32x32x16_bf16 v[56:71],a[156:159],v[52:55],v[56:71]
ds_read_b128 v[40:43],v18 offset:4096
v_mfma_f32_32x32x16_bf16 v[72:87],v[252:255],v[52:55],v[72:87]
s_cbranch_scc1 QKVQ_S0
QKVQ_B1:
s_waitcnt lgkmcnt(3)
v_mfma_f32_32x32x16_bf16 v[88:103],a[0:3],v[24:27],0
ds_read_b128 v[44:47],v19 offset:4096
v_add_u32 v189,s57,v188
v_mfma_f32_32x32x16_bf16 v[104:119],a[160:163],v[24:27],0
v_add_u32 v8,0x800,v189
s_sub_u32 s66,46080,s57
s_lshl_b32 s60,s33,6
s_add_u32 s60,s60,s34
s_mul_i32 s60,s60,46080
s_add_u32 s60,s60,s37
v_mfma_f32_32x32x16_bf16 v[88:103],a[4:7],v[28:31],v[88:103]
ds_read_b128 v[48:51],v18 offset:6144
ds_read2_b64 v[156:159],v189 offset0:0 offset1:32
s_add_u32 s60,s60,206569472
s_lshl_b32 s62,s46,10
v_mfma_f32_32x32x16_bf16 v[104:119],a[164:167],v[28:31],v[104:119]
ds_read2_b64 v[160:163],v189 offset0:64 offset1:96
s_add_u32 s62,s62,40960
s_add_u32 m0,s66,s62
s_add_u32 s63,s60,s62
s_waitcnt lgkmcnt(5)
v_mfma_f32_32x32x16_bf16 v[88:103],a[8:11],v[32:35],v[88:103]
ds_read_b128 v[52:55],v19 offset:6144
ds_read2_b64 v[164:167],v189 offset0:128 offset1:160
buffer_load_dwordx4 v1,s[8:11],s63 offen sc1 lds
v_mfma_f32_32x32x16_bf16 v[104:119],a[168:171],v[32:35],v[104:119]
ds_read2_b64 v[168:171],v189 offset0:192 offset1:224
s_add_u32 m0,s66,45056
s_add_u32 s63,s60,45056
s_mul_i32 s74,s73,393216
s_add_u32 s74,s74,s39
v_mfma_f32_32x32x16_bf16 v[88:103],a[12:15],v[36:39],v[88:103]
ds_read_b128 v[24:27],v18 offset:8192
ds_read2_b64 v[172:175],v8 offset0:0 offset1:32
s_add_u32 s74,s74,s70
v_fma_f32 v56,-v176,v120,v56
v_mfma_f32_32x32x16_bf16 v[104:119],a[172:175],v[36:39],v[104:119]
buffer_load_dwordx4 v1,s[8:11],s63 offen sc1 lds
s_mul_i32 s61,s46,10240
s_add_u32 s60,s60,s61
s_add_u32 s61,s61,s66
s_waitcnt lgkmcnt(8)
v_mfma_f32_32x32x16_bf16 v[88:103],a[16:19],v[40:43],v[88:103]
ds_read_b128 v[28:31],v19 offset:8192
s_add_u32 m0,s61,0
s_add_u32 s63,s60,0
v_fma_f32 v57,-v176,v121,v57
v_fma_f32 v58,-v176,v122,v58
v_mfma_f32_32x32x16_bf16 v[104:119],a[176:179],v[40:43],v[104:119]
v_fma_f32 v59,-v176,v123,v59
v_fma_f32 v60,-v176,v124,v60
v_fma_f32 v61,-v176,v125,v61
v_fma_f32 v62,-v176,v126,v62
v_fma_f32 v63,-v176,v127,v63
v_mfma_f32_32x32x16_bf16 v[88:103],a[20:23],v[44:47],v[88:103]
ds_read_b128 v[32:35],v18 offset:10240
buffer_load_dwordx4 v1,s[8:11],s63 offen sc1 lds
s_mov_b32 s53,s33
s_mov_b32 s54,s34
v_mfma_f32_32x32x16_bf16 v[104:119],a[180:183],v[44:47],v[104:119]
s_add_u32 s79,s79,s33
s_or_b32 s65,s37,s33
s_cmp_eq_u32 s65,0
s_addc_u32 s78,s78,0
s_lshl_b32 s41,s78,9
s_waitcnt lgkmcnt(6)
v_mfma_f32_32x32x16_bf16 v[88:103],a[24:27],v[48:51],v[88:103]
ds_read_b128 v[36:39],v19 offset:10240
s_add_u32 s41,s41,s40
s_lshl_b32 s35,s79,9
s_add_u32 s35,s35,s40
s_add_u32 s35,s35,32768
v_mfma_f32_32x32x16_bf16 v[104:119],a[184:187],v[48:51],v[104:119]
buffer_load_dwordx4 v1,s[8:11],s63 offen offset:1024 sc1 lds
v_mul_f32 v56,v56,v177
v_mul_f32 v57,v57,v177
v_mul_f32 v58,v58,v177
v_mul_f32 v59,v59,v177
v_mfma_f32_32x32x16_bf16 v[88:103],a[28:31],v[52:55],v[88:103]
ds_read_b128 v[40:43],v18 offset:12288
v_mul_f32 v60,v60,v177
v_mul_f32 v61,v61,v177
v_mul_f32 v62,v62,v177
v_mul_f32 v63,v63,v177
v_mfma_f32_32x32x16_bf16 v[104:119],a[188:191],v[52:55],v[104:119]
v_cvt_pk_bf16_f32 v56,v56,v57
v_cvt_pk_bf16_f32 v57,v58,v59
v_cvt_pk_bf16_f32 v58,v60,v61
v_cvt_pk_bf16_f32 v59,v62,v63
v_fma_f32 v64,-v176,v128,v64
s_waitcnt lgkmcnt(3)
v_mfma_f32_32x32x16_bf16 v[88:103],a[32:35],v[24:27],v[88:103]
ds_read_b128 v[44:47],v19 offset:12288
buffer_load_dwordx4 v1,s[8:11],s63 offen offset:2048 sc1 lds
v_fma_f32 v65,-v176,v129,v65
v_fma_f32 v66,-v176,v130,v66
v_mfma_f32_32x32x16_bf16 v[104:119],a[192:195],v[24:27],v[104:119]
v_fma_f32 v67,-v176,v131,v67
v_fma_f32 v68,-v176,v132,v68
v_fma_f32 v69,-v176,v133,v69
v_fma_f32 v70,-v176,v134,v70
v_fma_f32 v71,-v176,v135,v71
v_mfma_f32_32x32x16_bf16 v[88:103],a[36:39],v[28:31],v[88:103]
ds_read_b128 v[48:51],v18 offset:14336
v_mul_f32 v64,v64,v177
v_mul_f32 v65,v65,v177
v_mul_f32 v66,v66,v177
v_mul_f32 v67,v67,v177
v_mfma_f32_32x32x16_bf16 v[104:119],a[196:199],v[28:31],v[104:119]
buffer_load_dwordx4 v1,s[8:11],s63 offen offset:3072 sc1 lds
s_add_u32 m0,s61,4096
s_add_u32 s63,s60,4096
v_mul_f32 v68,v68,v177
s_waitcnt lgkmcnt(3)
v_mfma_f32_32x32x16_bf16 v[88:103],a[40:43],v[32:35],v[88:103]
ds_read_b128 v[52:55],v19 offset:14336
v_mul_f32 v69,v69,v177
v_mul_f32 v70,v70,v177
v_mul_f32 v71,v71,v177
v_cvt_pk_bf16_f32 v64,v64,v65
v_mfma_f32_32x32x16_bf16 v[104:119],a[200:203],v[32:35],v[104:119]
v_cvt_pk_bf16_f32 v65,v66,v67
v_cvt_pk_bf16_f32 v66,v68,v69
v_cvt_pk_bf16_f32 v67,v70,v71
v_fma_f32 v72,-v176,v136,v72
v_fma_f32 v73,-v176,v137,v73
v_mfma_f32_32x32x16_bf16 v[88:103],a[44:47],v[36:39],v[88:103]
ds_read_b128 v[24:27],v18 offset:16384
buffer_load_dwordx4 v1,s[8:11],s63 offen sc1 lds
v_fma_f32 v74,-v176,v138,v74
v_fma_f32 v75,-v176,v139,v75
v_mfma_f32_32x32x16_bf16 v[104:119],a[204:207],v[36:39],v[104:119]
v_fma_f32 v76,-v176,v140,v76
v_fma_f32 v77,-v176,v141,v77
v_fma_f32 v78,-v176,v142,v78
v_fma_f32 v79,-v176,v143,v79
v_mul_f32 v72,v72,v177
s_waitcnt lgkmcnt(3)
v_mfma_f32_32x32x16_bf16 v[88:103],a[48:51],v[40:43],v[88:103]
ds_read_b128 v[28:31],v19 offset:16384
v_mul_f32 v73,v73,v177
v_mul_f32 v74,v74,v177
v_mul_f32 v75,v75,v177
v_mul_f32 v76,v76,v177
v_mfma_f32_32x32x16_bf16 v[104:119],a[208:211],v[40:43],v[104:119]
buffer_load_dwordx4 v1,s[8:11],s63 offen offset:1024 sc1 lds
v_mul_f32 v77,v77,v177
v_mul_f32 v78,v78,v177
v_mul_f32 v79,v79,v177
v_cvt_pk_bf16_f32 v72,v72,v73
v_mfma_f32_32x32x16_bf16 v[88:103],a[52:55],v[44:47],v[88:103]
ds_read_b128 v[32:35],v18 offset:18432
v_cvt_pk_bf16_f32 v73,v74,v75
v_cvt_pk_bf16_f32 v74,v76,v77
v_cvt_pk_bf16_f32 v75,v78,v79
v_fma_f32 v80,-v176,v144,v80
v_mfma_f32_32x32x16_bf16 v[104:119],a[212:215],v[44:47],v[104:119]
v_fma_f32 v81,-v176,v145,v81
v_fma_f32 v82,-v176,v146,v82
v_fma_f32 v83,-v176,v147,v83
v_fma_f32 v84,-v176,v148,v84
v_fma_f32 v85,-v176,v149,v85
s_waitcnt lgkmcnt(3)
v_mfma_f32_32x32x16_bf16 v[88:103],a[56:59],v[48:51],v[88:103]
ds_read_b128 v[36:39],v19 offset:18432
buffer_load_dwordx4 v1,s[8:11],s63 offen offset:2048 sc1 lds
v_fma_f32 v86,-v176,v150,v86
v_fma_f32 v87,-v176,v151,v87
v_mfma_f32_32x32x16_bf16 v[104:119],a[216:219],v[48:51],v[104:119]
v_mul_f32 v80,v80,v177
v_mul_f32 v81,v81,v177
v_mul_f32 v82,v82,v177
v_mul_f32 v83,v83,v177
v_mul_f32 v84,v84,v177
v_mfma_f32_32x32x16_bf16 v[88:103],a[60:63],v[52:55],v[88:103]
ds_read_b128 v[40:43],v18 offset:20480
s_waitcnt vmcnt(9)
s_mov_b64 exec,1
buffer_store_dword v5,v1,s[8:11],s59 offen sc1
s_mov_b64 exec,-1
s_mov_b32 s59,2147483648
v_mfma_f32_32x32x16_bf16 v[104:119],a[220:223],v[52:55],v[104:119]
buffer_load_dwordx4 v1,s[8:11],s63 offen offset:3072 sc1 lds
s_add_u32 m0,s61,8192
s_add_u32 s63,s60,8192
v_mul_f32 v85,v85,v177
s_waitcnt lgkmcnt(3)
v_mfma_f32_32x32x16_bf16 v[88:103],a[64:67],v[24:27],v[88:103]
ds_read_b128 v[44:47],v19 offset:20480
v_mul_f32 v86,v86,v177
v_mul_f32 v87,v87,v177
v_cvt_pk_bf16_f32 v80,v80,v81
v_cvt_pk_bf16_f32 v81,v82,v83
v_mfma_f32_32x32x16_bf16 v[104:119],a[224:227],v[24:27],v[104:119]
v_cvt_pk_bf16_f32 v82,v84,v85
v_cvt_pk_bf16_f32 v83,v86,v87
s_lshl_b32 s82,s72,6
s_add_u32 s82,s82,s73
s_lshl_b32 s82,s82,9
s_add_u32 s82,s82,s71
v_mfma_f32_32x32x16_bf16 v[88:103],a[68:71],v[28:31],v[88:103]
ds_read_b128 v[48:51],v18 offset:22528
buffer_load_dwordx4 v1,s[8:11],s63 offen sc1 lds
s_lshl_b32 s75,s69,2
s_add_u32 s82,s82,s75
v_mfma_f32_32x32x16_bf16 v[104:119],a[228:231],v[28:31],v[104:119]
buffer_load_dword v3,v2,s[8:11],s35 offen sc1
buffer_load_dword v14,v4,s[8:11],s41 offen sc1
s_add_u32 s82,s82,s39
s_waitcnt lgkmcnt(3)
v_mfma_f32_32x32x16_bf16 v[88:103],a[72:75],v[32:35],v[88:103]
ds_read_b128 v[52:55],v19 offset:22528
v_add_f32 v156,v156,v166
v_add_f32 v157,v157,v167
v_add_f32 v158,v158,v168
v_mfma_f32_32x32x16_bf16 v[104:119],a[232:235],v[32:35],v[104:119]
buffer_load_dwordx4 v1,s[8:11],s63 offen offset:1024 sc1 lds
v_add_f32 v159,v159,v169
v_add_f32 v160,v160,v170
v_add_f32 v161,v161,v171
v_add_f32 v162,v162,v172
v_mfma_f32_32x32x16_bf16 v[88:103],a[76:79],v[36:39],v[88:103]
ds_read_b128 v[24:27],v18 offset:24576
v_add_f32 v163,v163,v173
v_add_f32 v164,v164,v174
v_add_f32 v165,v165,v175
v_add_f32 v156,v156,v158
v_mfma_f32_32x32x16_bf16 v[104:119],a[236:239],v[36:39],v[104:119]
v_add_f32 v157,v157,v159
v_add_f32 v160,v160,v162
v_add_f32 v161,v161,v163
v_add_f32 v156,v156,v160
v_add_f32 v157,v157,v161
s_waitcnt lgkmcnt(3)
v_mfma_f32_32x32x16_bf16 v[88:103],a[80:83],v[40:43],v[88:103]
ds_read_b128 v[28:31],v19 offset:24576
buffer_store_dwordx4 v[56:59],v20,s[8:11],s74 offen sc1
v_add_f32 v156,v156,v164
v_add_f32 v157,v157,v165
v_mfma_f32_32x32x16_bf16 v[104:119],a[240:243],v[40:43],v[104:119]
v_mov_b32 v158,v156
v_mov_b32 v159,v157
s_nop 0
v_permlane32_swap_b32 v156,v158
v_permlane32_swap_b32 v157,v159
v_add_f32 v176,v156,v158
v_mfma_f32_32x32x16_bf16 v[88:103],a[84:87],v[44:47],v[88:103]
ds_read_b128 v[32:35],v18 offset:26624
buffer_store_dwordx4 v[64:67],v21,s[8:11],s74 offen sc1
v_add_f32 v177,v157,v159
v_mul_f32 v176,0x3acccccd,v176
v_mfma_f32_32x32x16_bf16 v[104:119],a[244:247],v[44:47],v[104:119]
v_mul_f32 v177,0x3acccccd,v177
v_fma_f32 v177,-v176,v176,v177
v_max_f32 v177,0,v177
v_cvt_pk_bf16_f32 v8,v176,v177
v_lshlrev_b32 v176,16,v8
s_waitcnt lgkmcnt(3)
v_mfma_f32_32x32x16_bf16 v[88:103],a[88:91],v[48:51],v[88:103]
ds_read_b128 v[36:39],v19 offset:26624
buffer_store_dwordx4 v[72:75],v20,s[8:11],s74 offen offset:2048 sc1
v_and_b32 v177,0xffff0000,v8
v_add_f32 v177,0x3727c5ac,v177
v_mfma_f32_32x32x16_bf16 v[104:119],a[248:251],v[48:51],v[104:119]
v_cvt_pk_bf16_f32 v8,v177,v177
v_lshlrev_b32 v177,16,v8
v_sqrt_f32 v177,v177
s_nop 0
v_cvt_pk_bf16_f32 v8,v177,v177
v_lshlrev_b32 v177,16,v8
v_mfma_f32_32x32x16_bf16 v[88:103],a[92:95],v[52:55],v[88:103]
ds_read_b128 v[40:43],v18 offset:28672
buffer_store_dwordx4 v[80:83],v21,s[8:11],s74 offen offset:2048 sc1
v_rcp_f32 v177,v177
v_mfma_f32_32x32x16_bf16 v[104:119],a[252:255],v[52:55],v[104:119]
s_cmp_eq_u32 s51,0
s_cselect_b64 s[76:77],-1,0
v_cndmask_b32 v176,v176,0,s[76:77]
v_cndmask_b32 v177,v177,1.0,s[76:77]
s_mov_b32 s72,s51
s_waitcnt lgkmcnt(3)
v_mfma_f32_32x32x16_bf16 v[88:103],a[96:99],v[24:27],v[88:103]
ds_read_b128 v[44:47],v19 offset:28672
s_mov_b32 s73,s52
v_mfma_f32_32x32x16_bf16 v[104:119],v[192:195],v[24:27],v[104:119]
v_mfma_f32_32x32x16_bf16 v[88:103],a[100:103],v[28:31],v[88:103]
ds_read_b128 v[48:51],v18 offset:30720
v_mfma_f32_32x32x16_bf16 v[104:119],v[196:199],v[28:31],v[104:119]
s_waitcnt lgkmcnt(3)
v_mfma_f32_32x32x16_bf16 v[88:103],a[104:107],v[32:35],v[88:103]
ds_read_b128 v[52:55],v19 offset:30720
v_mfma_f32_32x32x16_bf16 v[104:119],v[200:203],v[32:35],v[104:119]
v_mfma_f32_32x32x16_bf16 v[88:103],a[108:111],v[36:39],v[88:103]
ds_read_b128 v[24:27],v18 offset:32768
v_mfma_f32_32x32x16_bf16 v[104:119],v[204:207],v[36:39],v[104:119]
s_waitcnt lgkmcnt(3)
v_mfma_f32_32x32x16_bf16 v[88:103],a[112:115],v[40:43],v[88:103]
ds_read_b128 v[28:31],v19 offset:32768
v_mfma_f32_32x32x16_bf16 v[104:119],v[208:211],v[40:43],v[104:119]
v_mfma_f32_32x32x16_bf16 v[88:103],a[116:119],v[44:47],v[88:103]
ds_read_b128 v[32:35],v18 offset:34816
v_mfma_f32_32x32x16_bf16 v[104:119],v[212:215],v[44:47],v[104:119]
s_waitcnt lgkmcnt(3)
v_mfma_f32_32x32x16_bf16 v[88:103],a[120:123],v[48:51],v[88:103]
ds_read_b128 v[36:39],v19 offset:34816
v_mfma_f32_32x32x16_bf16 v[104:119],v[216:219],v[48:51],v[104:119]
v_mfma_f32_32x32x16_bf16 v[88:103],a[124:127],v[52:55],v[88:103]
ds_read_b128 v[40:43],v18 offset:36864
v_mfma_f32_32x32x16_bf16 v[104:119],v[220:223],v[52:55],v[104:119]
s_waitcnt lgkmcnt(3)
v_mfma_f32_32x32x16_bf16 v[88:103],a[128:131],v[24:27],v[88:103]
ds_read_b128 v[44:47],v19 offset:36864
s_waitcnt vmcnt(4)
v_cmp_eq_u32 vcc,0,v14
s_cmp_eq_u64 vcc,0
s_cselect_b32 s36,0,2147483648
v_mfma_f32_32x32x16_bf16 v[104:119],v[224:227],v[24:27],v[104:119]
v_cmp_eq_u32 vcc,0,v3
s_cmp_lt_u32 s78,64
s_cselect_b32 s36,s36,2147483648
s_cmp_eq_u64 vcc,0
s_cselect_b32 s60,1,s36
v_mfma_f32_32x32x16_bf16 v[88:103],a[132:135],v[28:31],v[88:103]
ds_read_b128 v[48:51],v18 offset:38912
s_cmp_lt_u32 s79,64
s_cselect_b32 s60,s60,s36
s_sub_u32 s61,s78,s79
s_or_b32 s61,s61,s36
v_mfma_f32_32x32x16_bf16 v[104:119],v[228:231],v[28:31],v[104:119]
s_cmp_lt_u32 s61,16
s_cselect_b32 s36,0,s60
v_mov_b32 v23,s36
s_waitcnt lgkmcnt(3)
v_mfma_f32_32x32x16_bf16 v[88:103],a[136:139],v[32:35],v[88:103]
ds_read_b128 v[52:55],v19 offset:38912
ds_write_b32 v13,v23
v_mfma_f32_32x32x16_bf16 v[104:119],v[232:235],v[32:35],v[104:119]
s_waitcnt lgkmcnt(0)
s_barrier
ds_read_b32 v23,v22
v_mfma_f32_32x32x16_bf16 v[88:103],a[140:143],v[36:39],v[88:103]
ds_read_b128 v[24:27],v16 offset:0
s_cmp_lt_u32 s50,2
s_cselect_b32 s42,1,0
s_cmp_ge_u32 s78,64
s_cselect_b32 s42,1,s42
v_mfma_f32_32x32x16_bf16 v[104:119],v[236:239],v[36:39],v[104:119]
s_or_b32 s42,s42,s37
s_mov_b32 s39,0
s_add_u32 s50,s50,1
s_sub_u32 s57,46080,s57
s_mov_b32 s51,s53
s_mov_b32 s52,s54
v_mfma_f32_32x32x16_bf16 v[88:103],a[144:147],v[40:43],v[88:103]
ds_read_b128 v[28:31],v17 offset:0
v_mfma_f32_32x32x16_bf16 v[104:119],v[240:243],v[40:43],v[104:119]
v_mfma_f32_32x32x16_bf16 v[88:103],a[148:151],v[44:47],v[88:103]
ds_read_b128 v[32:35],v16 offset:2048
s_waitcnt vmcnt(0)
s_mov_b64 exec,1
buffer_store_dword v5,v1,s[8:11],s82 offen sc1
s_mov_b64 exec,-1
s_mov_b32 s82,2147483648
v_mfma_f32_32x32x16_bf16 v[104:119],v[244:247],v[44:47],v[104:119]
s_waitcnt lgkmcnt(3)
v_readfirstlane_b32 s38,v23
s_and_b32 s37,s38,2147483648
s_and_b32 s33,s38,1
s_cselect_b32 s34,s79,s78
s_cmp_lg_u32 s42,0
v_mfma_f32_32x32x16_bf16 v[88:103],a[152:155],v[48:51],v[88:103]
ds_read_b128 v[36:39],v17 offset:2048
v_mfma_f32_32x32x16_bf16 v[104:119],v[248:251],v[48:51],v[104:119]
v_mfma_f32_32x32x16_bf16 v[88:103],a[156:159],v[52:55],v[88:103]
ds_read_b128 v[40:43],v16 offset:4096
v_mfma_f32_32x32x16_bf16 v[104:119],v[252:255],v[52:55],v[104:119]
s_cbranch_scc0 QKVQ_B0
s_branch QKVQ_S1
s_nop 9
QKVQ_S0:
s_mov_b32 s55,0
s_cmp_lt_u32 s42,2
s_cbranch_scc1 nt_209
s_mov_b32 s55,2
s_cmp_lg_u32 s37,0
s_cbranch_scc1 nt_209
s_mov_b32 s55,1
s_lshl_b32 s60,s33,6
s_add_u32 s60,s60,s34
s_mul_i32 s60,s60,46080
s_add_u32 s60,s60,206569472
s_lshl_b32 s62,s46,10
s_add_u32 s62,s62,40960
s_add_u32 m0,s57,s62
s_add_u32 s63,s60,s62
buffer_load_dwordx4 v1,s[8:11],s63 offen sc1 lds
s_add_u32 m0,s57,45056
s_add_u32 s63,s60,45056
buffer_load_dwordx4 v1,s[8:11],s63 offen sc1 lds
s_mul_i32 s61,s46,10240
s_add_u32 s60,s60,s61
s_add_u32 s61,s61,s57
s_add_u32 m0,s61,0
s_add_u32 s63,s60,0
buffer_load_dwordx4 v1,s[8:11],s63 offen sc1 lds
buffer_load_dwordx4 v1,s[8:11],s63 offen offset:1024 sc1 lds
buffer_load_dwordx4 v1,s[8:11],s63 offen offset:2048 sc1 lds
buffer_load_dwordx4 v1,s[8:11],s63 offen offset:3072 sc1 lds
s_add_u32 m0,s61,4096
s_add_u32 s63,s60,4096
buffer_load_dwordx4 v1,s[8:11],s63 offen sc1 lds
buffer_load_dwordx4 v1,s[8:11],s63 offen offset:1024 sc1 lds
buffer_load_dwordx4 v1,s[8:11],s63 offen offset:2048 sc1 lds
buffer_load_dwordx4 v1,s[8:11],s63 offen offset:3072 sc1 lds
s_add_u32 m0,s61,8192
s_add_u32 s63,s60,8192
buffer_load_dwordx4 v1,s[8:11],s63 offen sc1 lds
buffer_load_dwordx4 v1,s[8:11],s63 offen offset:1024 sc1 lds
nt_209:
s_nop 4
s_mul_i32 s74,s73,393216
s_add_u32 s74,s74,s39
s_add_u32 s74,s74,s70
v_fma_f32 v56,-v176,v120,v56
v_fma_f32 v57,-v176,v121,v57
v_fma_f32 v58,-v176,v122,v58
v_fma_f32 v59,-v176,v123,v59
v_fma_f32 v60,-v176,v124,v60
v_fma_f32 v61,-v176,v125,v61
v_fma_f32 v62,-v176,v126,v62
v_fma_f32 v63,-v176,v127,v63
v_mul_f32 v56,v56,v177
v_mul_f32 v57,v57,v177
v_mul_f32 v58,v58,v177
v_mul_f32 v59,v59,v177
v_mul_f32 v60,v60,v177
v_mul_f32 v61,v61,v177
v_mul_f32 v62,v62,v177
v_mul_f32 v63,v63,v177
v_cvt_pk_bf16_f32 v56,v56,v57
v_cvt_pk_bf16_f32 v57,v58,v59
v_cvt_pk_bf16_f32 v58,v60,v61
v_cvt_pk_bf16_f32 v59,v62,v63
buffer_store_dwordx4 v[56:59],v20,s[8:11],s74 offen sc1
v_fma_f32 v64,-v176,v128,v64
v_fma_f32 v65,-v176,v129,v65
v_fma_f32 v66,-v176,v130,v66
v_fma_f32 v67,-v176,v131,v67
v_fma_f32 v68,-v176,v132,v68
v_fma_f32 v69,-v176,v133,v69
v_fma_f32 v70,-v176,v134,v70
v_fma_f32 v71,-v176,v135,v71
v_mul_f32 v64,v64,v177
v_mul_f32 v65,v65,v177
v_mul_f32 v66,v66,v177
v_mul_f32 v67,v67,v177
v_mul_f32 v68,v68,v177
v_mul_f32 v69,v69,v177
v_mul_f32 v70,v70,v177
v_mul_f32 v71,v71,v177
v_cvt_pk_bf16_f32 v64,v64,v65
v_cvt_pk_bf16_f32 v65,v66,v67
v_cvt_pk_bf16_f32 v66,v68,v69
v_cvt_pk_bf16_f32 v67,v70,v71
buffer_store_dwordx4 v[64:67],v21,s[8:11],s74 offen sc1
v_fma_f32 v72,-v176,v136,v72
v_fma_f32 v73,-v176,v137,v73
v_fma_f32 v74,-v176,v138,v74
v_fma_f32 v75,-v176,v139,v75
v_fma_f32 v76,-v176,v140,v76
v_fma_f32 v77,-v176,v141,v77
v_fma_f32 v78,-v176,v142,v78
v_fma_f32 v79,-v176,v143,v79
v_mul_f32 v72,v72,v177
v_mul_f32 v73,v73,v177
v_mul_f32 v74,v74,v177
v_mul_f32 v75,v75,v177
v_mul_f32 v76,v76,v177
v_mul_f32 v77,v77,v177
v_mul_f32 v78,v78,v177
v_mul_f32 v79,v79,v177
v_cvt_pk_bf16_f32 v72,v72,v73
v_cvt_pk_bf16_f32 v73,v74,v75
v_cvt_pk_bf16_f32 v74,v76,v77
v_cvt_pk_bf16_f32 v75,v78,v79
buffer_store_dwordx4 v[72:75],v20,s[8:11],s74 offen offset:2048 sc1
v_fma_f32 v80,-v176,v144,v80
v_fma_f32 v81,-v176,v145,v81
v_fma_f32 v82,-v176,v146,v82
v_fma_f32 v83,-v176,v147,v83
v_fma_f32 v84,-v176,v148,v84
v_fma_f32 v85,-v176,v149,v85
v_fma_f32 v86,-v176,v150,v86
v_fma_f32 v87,-v176,v151,v87
v_mul_f32 v80,v80,v177
v_mul_f32 v81,v81,v177
v_mul_f32 v82,v82,v177
v_mul_f32 v83,v83,v177
v_mul_f32 v84,v84,v177
v_mul_f32 v85,v85,v177
v_mul_f32 v86,v86,v177
v_mul_f32 v87,v87,v177
v_cvt_pk_bf16_f32 v80,v80,v81
v_cvt_pk_bf16_f32 v81,v82,v83
v_cvt_pk_bf16_f32 v82,v84,v85
v_cvt_pk_bf16_f32 v83,v86,v87
buffer_store_dwordx4 v[80:83],v21,s[8:11],s74 offen offset:2048 sc1
s_lshl_b32 s82,s72,6
s_add_u32 s82,s82,s73
s_lshl_b32 s82,s82,9
s_add_u32 s82,s82,s71
s_lshl_b32 s75,s69,2
s_add_u32 s82,s82,s75
s_add_u32 s82,s82,s39
s_mov_b32 s59,s82
s_mov_b32 s82,2147483648
s_mov_b32 s39,2147483648
s_cmp_eq_u32 s55,0
s_cbranch_scc1 QKVQ_B1
s_cmp_eq_u32 s55,1
s_cbranch_scc1 QKVQ_CD1
s_waitcnt vmcnt(0)
s_mov_b64 exec,1
buffer_store_dword v5,v1,s[8:11],s59 offen sc1
s_mov_b64 exec,-1
s_mov_b32 s59,2147483648
s_cmp_eq_u32 s50,128
s_cbranch_scc1 QKVQ_END
s_branch QKVQ_COLD1
QKVQ_COLD0:
s_cmp_lg_u32 s46,0
s_cbranch_scc1 cp_210
ct_211:
buffer_load_dword v3,v2,s[8:11],s35 offen sc1
buffer_load_dword v14,v4,s[8:11],s41 offen sc1
s_waitcnt vmcnt(0)
v_cmp_eq_u32 vcc,0,v14
s_cmp_eq_u64 vcc,0
s_cselect_b32 s36,0,2147483648
v_cmp_eq_u32 vcc,0,v3
s_cmp_lt_u32 s78,64
s_cselect_b32 s36,s36,2147483648
s_cmp_eq_u64 vcc,0
s_cselect_b32 s60,1,s36
s_cmp_lt_u32 s79,64
s_cselect_b32 s60,s60,s36
s_sub_u32 s61,s78,s79
s_or_b32 s61,s61,s36
s_cmp_lt_u32 s61,16
s_cselect_b32 s36,0,s60
v_mov_b32 v23,s36
s_cmp_lt_u32 s36,2
s_cbranch_scc1 ct_211x
s_sleep 3
s_sub_u32 s47,s47,1
s_cbranch_scc1 ABORT
s_branch ct_211
ct_211x:
ds_write_b32 v22,v23 offset:4
s_waitcnt lgkmcnt(0)
cp_210:
s_barrier
ds_read_b32 v23,v22 offset:4
s_waitcnt lgkmcnt(0)
v_readfirstlane_b32 s38,v23
s_and_b32 s38,s38,1
s_and_b32 s37,s38,2147483648
s_and_b32 s33,s38,1
s_cselect_b32 s34,s79,s78
s_lshl_b32 s60,s33,6
s_add_u32 s60,s60,s34
s_mul_i32 s60,s60,46080
s_add_u32 s60,s60,206569472
s_lshl_b32 s62,s46,10
s_add_u32 s62,s62,40960
s_add_u32 m0,s57,s62
s_add_u32 s63,s60,s62
buffer_load_dwordx4 v1,s[8:11],s63 offen sc1 lds
s_add_u32 m0,s57,45056
s_add_u32 s63,s60,45056
buffer_load_dwordx4 v1,s[8:11],s63 offen sc1 lds
s_mul_i32 s61,s46,10240
s_add_u32 s60,s60,s61
s_add_u32 s61,s61,s57
s_add_u32 m0,s61,0
s_add_u32 s63,s60,0
buffer_load_dwordx4 v1,s[8:11],s63 offen sc1 lds
buffer_load_dwordx4 v1,s[8:11],s63 offen offset:1024 sc1 lds
buffer_load_dwordx4 v1,s[8:11],s63 offen offset:2048 sc1 lds
buffer_load_dwordx4 v1,s[8:11],s63 offen offset:3072 sc1 lds
s_add_u32 m0,s61,4096
s_add_u32 s63,s60,4096
buffer_load_dwordx4 v1,s[8:11],s63 offen sc1 lds
buffer_load_dwordx4 v1,s[8:11],s63 offen offset:1024 sc1 lds
buffer_load_dwordx4 v1,s[8:11],s63 offen offset:2048 sc1 lds
buffer_load_dwordx4 v1,s[8:11],s63 offen offset:3072 sc1 lds
s_add_u32 m0,s61,8192
s_add_u32 s63,s60,8192
buffer_load_dwordx4 v1,s[8:11],s63 offen sc1 lds
buffer_load_dwordx4 v1,s[8:11],s63 offen offset:1024 sc1 lds
QKVQ_CD0:
s_mov_b32 s51,s33
s_mov_b32 s52,s34
s_mov_b32 s53,s33
s_mov_b32 s54,s34
s_add_u32 s79,s79,s33
s_or_b32 s60,s37,s33
s_cmp_eq_u32 s60,0
s_addc_u32 s78,s78,0
s_lshl_b32 s41,s78,9
s_add_u32 s41,s41,s40
s_lshl_b32 s35,s79,9
s_add_u32 s35,s35,s40
s_add_u32 s35,s35,32768
buffer_load_dword v3,v2,s[8:11],s35 offen sc1
buffer_load_dword v14,v4,s[8:11],s41 offen sc1
s_waitcnt vmcnt(0)
s_mov_b64 exec,1
buffer_store_dword v5,v1,s[8:11],s59 offen sc1
s_mov_b64 exec,-1
s_mov_b32 s59,2147483648
v_cmp_eq_u32 vcc,0,v14
s_cmp_eq_u64 vcc,0
s_cselect_b32 s36,0,2147483648
v_cmp_eq_u32 vcc,0,v3
s_cmp_lt_u32 s78,64
s_cselect_b32 s36,s36,2147483648
s_cmp_eq_u64 vcc,0
s_cselect_b32 s60,1,s36
s_cmp_lt_u32 s79,64
s_cselect_b32 s60,s60,s36
s_sub_u32 s61,s78,s79
s_or_b32 s61,s61,s36
s_cmp_lt_u32 s61,16
s_cselect_b32 s36,0,s60
v_mov_b32 v23,s36
ds_write_b32 v13,v23
s_waitcnt lgkmcnt(0)
s_barrier
ds_read_b32 v23,v22
ds_read_b128 v[24:27],v16 offset:0
ds_read_b128 v[28:31],v17 offset:0
ds_read_b128 v[32:35],v16 offset:2048
ds_read_b128 v[36:39],v17 offset:2048
ds_read_b128 v[40:43],v16 offset:4096
s_waitcnt lgkmcnt(5)
v_readfirstlane_b32 s38,v23
s_and_b32 s37,s38,2147483648
s_and_b32 s33,s38,1
s_cselect_b32 s34,s79,s78
s_nop 0
s_branch QKVQ_B0
QKVQ_S1:
s_mov_b32 s55,0
s_cmp_lt_u32 s42,2
s_cbranch_scc1 nt_212
s_mov_b32 s55,2
s_cmp_lg_u32 s37,0
s_cbranch_scc1 nt_212
s_mov_b32 s55,1
s_lshl_b32 s60,s33,6
s_add_u32 s60,s60,s34
s_mul_i32 s60,s60,46080
s_add_u32 s60,s60,206569472
s_lshl_b32 s62,s46,10
s_add_u32 s62,s62,40960
s_add_u32 m0,s57,s62
s_add_u32 s63,s60,s62
buffer_load_dwordx4 v1,s[8:11],s63 offen sc1 lds
s_add_u32 m0,s57,45056
s_add_u32 s63,s60,45056
buffer_load_dwordx4 v1,s[8:11],s63 offen sc1 lds
s_mul_i32 s61,s46,10240
s_add_u32 s60,s60,s61
s_add_u32 s61,s61,s57
s_add_u32 m0,s61,0
s_add_u32 s63,s60,0
buffer_load_dwordx4 v1,s[8:11],s63 offen sc1 lds
buffer_load_dwordx4 v1,s[8:11],s63 offen offset:1024 sc1 lds
buffer_load_dwordx4 v1,s[8:11],s63 offen offset:2048 sc1 lds
buffer_load_dwordx4 v1,s[8:11],s63 offen offset:3072 sc1 lds
s_add_u32 m0,s61,4096
s_add_u32 s63,s60,4096
buffer_load_dwordx4 v1,s[8:11],s63 offen sc1 lds
buffer_load_dwordx4 v1,s[8:11],s63 offen offset:1024 sc1 lds
buffer_load_dwordx4 v1,s[8:11],s63 offen offset:2048 sc1 lds
buffer_load_dwordx4 v1,s[8:11],s63 offen offset:3072 sc1 lds
s_add_u32 m0,s61,8192
s_add_u32 s63,s60,8192
buffer_load_dwordx4 v1,s[8:11],s63 offen sc1 lds
buffer_load_dwordx4 v1,s[8:11],s63 offen offset:1024 sc1 lds
nt_212:
s_nop 4
s_mul_i32 s74,s73,393216
s_add_u32 s74,s74,s39
s_add_u32 s74,s74,s70
v_fma_f32 v88,-v176,v120,v88
v_fma_f32 v89,-v176,v121,v89
v_fma_f32 v90,-v176,v122,v90
v_fma_f32 v91,-v176,v123,v91
v_fma_f32 v92,-v176,v124,v92
v_fma_f32 v93,-v176,v125,v93
v_fma_f32 v94,-v176,v126,v94
v_fma_f32 v95,-v176,v127,v95
v_mul_f32 v88,v88,v177
v_mul_f32 v89,v89,v177
v_mul_f32 v90,v90,v177
v_mul_f32 v91,v91,v177
v_mul_f32 v92,v92,v177
v_mul_f32 v93,v93,v177
v_mul_f32 v94,v94,v177
v_mul_f32 v95,v95,v177
v_cvt_pk_bf16_f32 v88,v88,v89
v_cvt_pk_bf16_f32 v89,v90,v91
v_cvt_pk_bf16_f32 v90,v92,v93
v_cvt_pk_bf16_f32 v91,v94,v95
buffer_store_dwordx4 v[88:91],v20,s[8:11],s74 offen sc1
v_fma_f32 v96,-v176,v128,v96
v_fma_f32 v97,-v176,v129,v97
v_fma_f32 v98,-v176,v130,v98
v_fma_f32 v99,-v176,v131,v99
v_fma_f32 v100,-v176,v132,v100
v_fma_f32 v101,-v176,v133,v101
v_fma_f32 v102,-v176,v134,v102
v_fma_f32 v103,-v176,v135,v103
v_mul_f32 v96,v96,v177
v_mul_f32 v97,v97,v177
v_mul_f32 v98,v98,v177
v_mul_f32 v99,v99,v177
v_mul_f32 v100,v100,v177
v_mul_f32 v101,v101,v177
v_mul_f32 v102,v102,v177
v_mul_f32 v103,v103,v177
v_cvt_pk_bf16_f32 v96,v96,v97
v_cvt_pk_bf16_f32 v97,v98,v99
v_cvt_pk_bf16_f32 v98,v100,v101
v_cvt_pk_bf16_f32 v99,v102,v103
buffer_store_dwordx4 v[96:99],v21,s[8:11],s74 offen sc1
v_fma_f32 v104,-v176,v136,v104
v_fma_f32 v105,-v176,v137,v105
v_fma_f32 v106,-v176,v138,v106
v_fma_f32 v107,-v176,v139,v107
v_fma_f32 v108,-v176,v140,v108
v_fma_f32 v109,-v176,v141,v109
v_fma_f32 v110,-v176,v142,v110
v_fma_f32 v111,-v176,v143,v111
v_mul_f32 v104,v104,v177
v_mul_f32 v105,v105,v177
v_mul_f32 v106,v106,v177
v_mul_f32 v107,v107,v177
v_mul_f32 v108,v108,v177
v_mul_f32 v109,v109,v177
v_mul_f32 v110,v110,v177
v_mul_f32 v111,v111,v177
v_cvt_pk_bf16_f32 v104,v104,v105
v_cvt_pk_bf16_f32 v105,v106,v107
v_cvt_pk_bf16_f32 v106,v108,v109
v_cvt_pk_bf16_f32 v107,v110,v111
buffer_store_dwordx4 v[104:107],v20,s[8:11],s74 offen offset:2048 sc1
v_fma_f32 v112,-v176,v144,v112
v_fma_f32 v113,-v176,v145,v113
v_fma_f32 v114,-v176,v146,v114
v_fma_f32 v115,-v176,v147,v115
v_fma_f32 v116,-v176,v148,v116
v_fma_f32 v117,-v176,v149,v117
v_fma_f32 v118,-v176,v150,v118
v_fma_f32 v119,-v176,v151,v119
v_mul_f32 v112,v112,v177
v_mul_f32 v113,v113,v177
v_mul_f32 v114,v114,v177
v_mul_f32 v115,v115,v177
v_mul_f32 v116,v116,v177
v_mul_f32 v117,v117,v177
v_mul_f32 v118,v118,v177
v_mul_f32 v119,v119,v177
v_cvt_pk_bf16_f32 v112,v112,v113
v_cvt_pk_bf16_f32 v113,v114,v115
v_cvt_pk_bf16_f32 v114,v116,v117
v_cvt_pk_bf16_f32 v115,v118,v119
buffer_store_dwordx4 v[112:115],v21,s[8:11],s74 offen offset:2048 sc1
s_lshl_b32 s82,s72,6
s_add_u32 s82,s82,s73
s_lshl_b32 s82,s82,9
s_add_u32 s82,s82,s71
s_lshl_b32 s75,s69,2
s_add_u32 s82,s82,s75
s_add_u32 s82,s82,s39
s_mov_b32 s59,s82
s_mov_b32 s82,2147483648
s_mov_b32 s39,2147483648
s_cmp_eq_u32 s55,0
s_cbranch_scc1 QKVQ_B0
s_cmp_eq_u32 s55,1
s_cbranch_scc1 QKVQ_CD0
s_waitcnt vmcnt(0)
s_mov_b64 exec,1
buffer_store_dword v5,v1,s[8:11],s59 offen sc1
s_mov_b64 exec,-1
s_mov_b32 s59,2147483648
s_cmp_eq_u32 s50,128
s_cbranch_scc1 QKVQ_END
s_branch QKVQ_COLD0
QKVQ_COLD1:
s_cmp_lg_u32 s46,0
s_cbranch_scc1 cp_213
ct_214:
buffer_load_dword v3,v2,s[8:11],s35 offen sc1
buffer_load_dword v14,v4,s[8:11],s41 offen sc1
s_waitcnt vmcnt(0)
v_cmp_eq_u32 vcc,0,v14
s_cmp_eq_u64 vcc,0
s_cselect_b32 s36,0,2147483648
v_cmp_eq_u32 vcc,0,v3
s_cmp_lt_u32 s78,64
s_cselect_b32 s36,s36,2147483648
s_cmp_eq_u64 vcc,0
s_cselect_b32 s60,1,s36
s_cmp_lt_u32 s79,64
s_cselect_b32 s60,s60,s36
s_sub_u32 s61,s78,s79
s_or_b32 s61,s61,s36
s_cmp_lt_u32 s61,16
s_cselect_b32 s36,0,s60
v_mov_b32 v23,s36
s_cmp_lt_u32 s36,2
s_cbranch_scc1 ct_214x
s_sleep 3
s_sub_u32 s47,s47,1
s_cbranch_scc1 ABORT
s_branch ct_214
ct_214x:
ds_write_b32 v22,v23 offset:4
s_waitcnt lgkmcnt(0)
cp_213:
s_barrier
ds_read_b32 v23,v22 offset:4
s_waitcnt lgkmcnt(0)
v_readfirstlane_b32 s38,v23
s_and_b32 s38,s38,1
s_and_b32 s37,s38,2147483648
s_and_b32 s33,s38,1
s_cselect_b32 s34,s79,s78
s_lshl_b32 s60,s33,6
s_add_u32 s60,s60,s34
s_mul_i32 s60,s60,46080
s_add_u32 s60,s60,206569472
s_lshl_b32 s62,s46,10
s_add_u32 s62,s62,40960
s_add_u32 m0,s57,s62
s_add_u32 s63,s60,s62
buffer_load_dwordx4 v1,s[8:11],s63 offen sc1 lds
s_add_u32 m0,s57,45056
s_add_u32 s63,s60,45056
buffer_load_dwordx4 v1,s[8:11],s63 offen sc1 lds
s_mul_i32 s61,s46,10240
s_add_u32 s60,s60,s61
s_add_u32 s61,s61,s57
s_add_u32 m0,s61,0
s_add_u32 s63,s60,0
buffer_load_dwordx4 v1,s[8:11],s63 offen sc1 lds
buffer_load_dwordx4 v1,s[8:11],s63 offen offset:1024 sc1 lds
buffer_load_dwordx4 v1,s[8:11],s63 offen offset:2048 sc1 lds
buffer_load_dwordx4 v1,s[8:11],s63 offen offset:3072 sc1 lds
s_add_u32 m0,s61,4096
s_add_u32 s63,s60,4096
buffer_load_dwordx4 v1,s[8:11],s63 offen sc1 lds
buffer_load_dwordx4 v1,s[8:11],s63 offen offset:1024 sc1 lds
buffer_load_dwordx4 v1,s[8:11],s63 offen offset:2048 sc1 lds
buffer_load_dwordx4 v1,s[8:11],s63 offen offset:3072 sc1 lds
s_add_u32 m0,s61,8192
s_add_u32 s63,s60,8192
buffer_load_dwordx4 v1,s[8:11],s63 offen sc1 lds
buffer_load_dwordx4 v1,s[8:11],s63 offen offset:1024 sc1 lds
QKVQ_CD1:
s_mov_b32 s51,s33
s_mov_b32 s52,s34
s_mov_b32 s53,s33
s_mov_b32 s54,s34
s_add_u32 s79,s79,s33
s_or_b32 s60,s37,s33
s_cmp_eq_u32 s60,0
s_addc_u32 s78,s78,0
s_lshl_b32 s41,s78,9
s_add_u32 s41,s41,s40
s_lshl_b32 s35,s79,9
s_add_u32 s35,s35,s40
s_add_u32 s35,s35,32768
buffer_load_dword v3,v2,s[8:11],s35 offen sc1
buffer_load_dword v14,v4,s[8:11],s41 offen sc1
s_waitcnt vmcnt(0)
s_mov_b64 exec,1
buffer_store_dword v5,v1,s[8:11],s59 offen sc1
s_mov_b64 exec,-1
s_mov_b32 s59,2147483648
v_cmp_eq_u32 vcc,0,v14
s_cmp_eq_u64 vcc,0
s_cselect_b32 s36,0,2147483648
v_cmp_eq_u32 vcc,0,v3
s_cmp_lt_u32 s78,64
s_cselect_b32 s36,s36,2147483648
s_cmp_eq_u64 vcc,0
s_cselect_b32 s60,1,s36
s_cmp_lt_u32 s79,64
s_cselect_b32 s60,s60,s36
s_sub_u32 s61,s78,s79
s_or_b32 s61,s61,s36
s_cmp_lt_u32 s61,16
s_cselect_b32 s36,0,s60
v_mov_b32 v23,s36
ds_write_b32 v13,v23
s_waitcnt lgkmcnt(0)
s_barrier
ds_read_b32 v23,v22
ds_read_b128 v[24:27],v18 offset:0
ds_read_b128 v[28:31],v19 offset:0
ds_read_b128 v[32:35],v18 offset:2048
ds_read_b128 v[36:39],v19 offset:2048
ds_read_b128 v[40:43],v18 offset:4096
s_waitcnt lgkmcnt(5)
v_readfirstlane_b32 s38,v23
s_and_b32 s37,s38,2147483648
s_and_b32 s33,s38,1
s_cselect_b32 s34,s79,s78
s_nop 0
s_branch QKVQ_B1
QKVQ_END:
s_endpgm
ROLE_QKVV:
v_lshlrev_b32 v1,4,v0
v_mov_b32 v5,1
s_lshl_b32 s56,s48,2
s_add_u32 s56,s56,s46
v_bfe_u32 v6,v0,2,2
v_lshrrev_b32 v7,4,v0
v_add_u32 v7,v6,v7
v_and_b32 v7,3,v7
v_and_b32 v15,3,v0
v_lshlrev_b32 v15,4,v15
v_lshl_add_u32 v15,v7,6,v15
v_lshl_add_u32 v15,v6,8,v15
v_lshrrev_b32 v6,5,v0
v_bfe_u32 v7,v0,4,1
v_lshlrev_b32 v16,10,v7
v_bfe_u32 v7,v0,2,2
v_lshl_add_u32 v16,v7,8,v16
v_add_u32 v6,v6,v7
v_and_b32 v6,3,v6
v_lshl_add_u32 v16,v6,6,v16
v_and_b32 v6,3,v0
v_lshl_add_u32 v16,v6,4,v16
v_add_u32 v18,46080,v16
v_lshrrev_b32 v6,5,v0
v_bfe_u32 v7,v0,4,1
v_lshlrev_b32 v20,10,v7
v_lshl_add_u32 v20,v6,8,v20
v_and_b32 v6,15,v0
v_lshl_add_u32 v20,v6,4,v20
v_lshrrev_b32 v6,5,v0
v_add_u32 v6,2,v6
v_bfe_u32 v7,v0,4,1
v_lshlrev_b32 v17,10,v7
v_bfe_u32 v7,v0,2,2
v_lshl_add_u32 v17,v7,8,v17
v_add_u32 v6,v6,v7
v_and_b32 v6,3,v6
v_lshl_add_u32 v17,v6,6,v17
v_and_b32 v6,3,v0
v_lshl_add_u32 v17,v6,4,v17
v_add_u32 v19,46080,v17
v_lshrrev_b32 v6,5,v0
v_add_u32 v6,2,v6
v_bfe_u32 v7,v0,4,1
v_lshlrev_b32 v21,10,v7
v_lshl_add_u32 v21,v6,8,v21
v_and_b32 v6,15,v0
v_lshl_add_u32 v21,v6,4,v21
s_mov_b32 s69,s56
s_mov_b32 s70,99614720
s_mov_b32 s71,196608
s_lshl_b32 s60,s69,12
s_add_u32 s70,s70,s60
v_lshrrev_b32 v6,5,v0
v_mul_u32_u24 v188,2560,v6
v_and_b32 v6,31,v0
v_lshl_add_u32 v188,v6,3,v188
v_add_u32 v188,0xa000,v188
v_min_u32 v4,7,v0
v_lshlrev_b32 v4,2,v4
v_min_u32 v2,39,v0
v_lshlrev_b32 v2,2,v2
v_mov_b32 v12,93184
s_lshl_b32 s60,s46,8
s_add_u32 s60,s60,92160
v_and_b32 v6,31,v0
v_lshlrev_b32 v190,3,v6
v_add_u32 v190,s60,v190
v_lshrrev_b32 v6,5,v0
v_lshlrev_b32 v191,5,v6
v_add_u32 v191,s60,v191
s_waitcnt vmcnt(0)
s_barrier
s_cmp_lg_u32 s46,0
s_cbranch_scc1 arr_215
v_mov_b32 v6,1
s_lshl_b32 s3,s49,2
v_mov_b32 v7,s3
s_mov_b64 exec,1
buffer_atomic_add v6,v7,s[12:15],0 offen sc1
s_mov_b64 exec,-1
arr_215:
s_lshl_b32 s58,s69,7
s_mul_i32 s63,s46,40960
s_mov_b32 s4,s24
s_mov_b32 s5,s25
s_mov_b32 s6,7864320
s_mov_b32 s7,0x20000
v_lshrrev_b32 v9,3,v0
s_mov_b32 s64,12288
v_mul_lo_u32 v9,v9,s64
v_and_b32 v10,7,v0
v_lshl_add_u32 v6,v10,4,v9
s_add_u32 m0,s63,0
s_add_u32 s65,s58,0
buffer_load_dwordx4 v6,s[4:7],s65 offen lds
s_add_u32 m0,s63,1024
s_add_u32 s65,s58,98304
buffer_load_dwordx4 v6,s[4:7],s65 offen lds
s_add_u32 m0,s63,2048
s_add_u32 s65,s58,196608
buffer_load_dwordx4 v6,s[4:7],s65 offen lds
s_add_u32 m0,s63,3072
s_add_u32 s65,s58,294912
buffer_load_dwordx4 v6,s[4:7],s65 offen lds
s_add_u32 m0,s63,4096
s_add_u32 s65,s58,393216
buffer_load_dwordx4 v6,s[4:7],s65 offen lds
s_add_u32 m0,s63,5120
s_add_u32 s65,s58,491520
buffer_load_dwordx4 v6,s[4:7],s65 offen lds
s_add_u32 m0,s63,6144
s_add_u32 s65,s58,589824
buffer_load_dwordx4 v6,s[4:7],s65 offen lds
s_add_u32 m0,s63,7168
s_add_u32 s65,s58,688128
buffer_load_dwordx4 v6,s[4:7],s65 offen lds
s_add_u32 m0,s63,8192
s_add_u32 s65,s58,786432
buffer_load_dwordx4 v6,s[4:7],s65 offen lds
s_add_u32 m0,s63,9216
s_add_u32 s65,s58,884736
buffer_load_dwordx4 v6,s[4:7],s65 offen lds
s_add_u32 m0,s63,10240
s_add_u32 s65,s58,983040
buffer_load_dwordx4 v6,s[4:7],s65 offen lds
s_add_u32 m0,s63,11264
s_add_u32 s65,s58,1081344
buffer_load_dwordx4 v6,s[4:7],s65 offen lds
s_add_u32 m0,s63,12288
s_add_u32 s65,s58,1179648
buffer_load_dwordx4 v6,s[4:7],s65 offen lds
s_add_u32 m0,s63,13312
s_add_u32 s65,s58,1277952
buffer_load_dwordx4 v6,s[4:7],s65 offen lds
s_add_u32 m0,s63,14336
s_add_u32 s65,s58,1376256
buffer_load_dwordx4 v6,s[4:7],s65 offen lds
s_add_u32 m0,s63,15360
s_add_u32 s65,s58,1474560
buffer_load_dwordx4 v6,s[4:7],s65 offen lds
s_add_u32 m0,s63,16384
s_add_u32 s65,s58,1572864
buffer_load_dwordx4 v6,s[4:7],s65 offen lds
s_add_u32 m0,s63,17408
s_add_u32 s65,s58,1671168
buffer_load_dwordx4 v6,s[4:7],s65 offen lds
s_add_u32 m0,s63,18432
s_add_u32 s65,s58,1769472
buffer_load_dwordx4 v6,s[4:7],s65 offen lds
s_add_u32 m0,s63,19456
s_add_u32 s65,s58,1867776
buffer_load_dwordx4 v6,s[4:7],s65 offen lds
s_add_u32 m0,s63,20480
s_add_u32 s65,s58,1966080
buffer_load_dwordx4 v6,s[4:7],s65 offen lds
s_add_u32 m0,s63,21504
s_add_u32 s65,s58,2064384
buffer_load_dwordx4 v6,s[4:7],s65 offen lds
s_add_u32 m0,s63,22528
s_add_u32 s65,s58,2162688
buffer_load_dwordx4 v6,s[4:7],s65 offen lds
s_add_u32 m0,s63,23552
s_add_u32 s65,s58,2260992
buffer_load_dwordx4 v6,s[4:7],s65 offen lds
s_add_u32 m0,s63,24576
s_add_u32 s65,s58,2359296
buffer_load_dwordx4 v6,s[4:7],s65 offen lds
s_add_u32 m0,s63,25600
s_add_u32 s65,s58,2457600
buffer_load_dwordx4 v6,s[4:7],s65 offen lds
s_add_u32 m0,s63,26624
s_add_u32 s65,s58,2555904
buffer_load_dwordx4 v6,s[4:7],s65 offen lds
s_add_u32 m0,s63,27648
s_add_u32 s65,s58,2654208
buffer_load_dwordx4 v6,s[4:7],s65 offen lds
s_add_u32 m0,s63,28672
s_add_u32 s65,s58,2752512
buffer_load_dwordx4 v6,s[4:7],s65 offen lds
s_add_u32 m0,s63,29696
s_add_u32 s65,s58,2850816
buffer_load_dwordx4 v6,s[4:7],s65 offen lds
s_add_u32 m0,s63,30720
s_add_u32 s65,s58,2949120
buffer_load_dwordx4 v6,s[4:7],s65 offen lds
s_add_u32 m0,s63,31744
s_add_u32 s65,s58,3047424
buffer_load_dwordx4 v6,s[4:7],s65 offen lds
s_add_u32 m0,s63,32768
s_add_u32 s65,s58,3145728
buffer_load_dwordx4 v6,s[4:7],s65 offen lds
s_add_u32 m0,s63,33792
s_add_u32 s65,s58,3244032
buffer_load_dwordx4 v6,s[4:7],s65 offen lds
s_add_u32 m0,s63,34816
s_add_u32 s65,s58,3342336
buffer_load_dwordx4 v6,s[4:7],s65 offen lds
s_add_u32 m0,s63,35840
s_add_u32 s65,s58,3440640
buffer_load_dwordx4 v6,s[4:7],s65 offen lds
s_add_u32 m0,s63,36864
s_add_u32 s65,s58,3538944
buffer_load_dwordx4 v6,s[4:7],s65 offen lds
s_add_u32 m0,s63,37888
s_add_u32 s65,s58,3637248
buffer_load_dwordx4 v6,s[4:7],s65 offen lds
s_add_u32 m0,s63,38912
s_add_u32 s65,s58,3735552
buffer_load_dwordx4 v6,s[4:7],s65 offen lds
s_add_u32 m0,s63,39936
s_add_u32 s65,s58,3833856
buffer_load_dwordx4 v6,s[4:7],s65 offen lds
s_waitcnt vmcnt(20)
v_bfe_u32 v9,v0,2,2
v_lshrrev_b32 v10,5,v0
v_lshl_add_u32 v9,v10,2,v9
v_mul_u32_u24 v9,128,v9
v_and_b32 v10,1,v0
v_lshl_add_u32 v9,v10,3,v9
v_bfe_u32 v10,v0,1,1
v_lshl_add_u32 v9,v10,4,v9
v_bfe_u32 v10,v0,4,1
v_lshl_add_u32 v9,v10,5,v9
v_add_u32 v7,s63,v9
ds_read_b64_tr_b16 a[0:1],v7 offset:0
ds_read_b64_tr_b16 a[2:3],v7 offset:2048
ds_read_b64_tr_b16 a[4:5],v7 offset:1024
ds_read_b64_tr_b16 a[6:7],v7 offset:3072
ds_read_b64_tr_b16 a[160:161],v7 offset:64
ds_read_b64_tr_b16 a[162:163],v7 offset:2112
ds_read_b64_tr_b16 a[164:165],v7 offset:1088
ds_read_b64_tr_b16 a[166:167],v7 offset:3136
ds_read_b64_tr_b16 a[8:9],v7 offset:4096
ds_read_b64_tr_b16 a[10:11],v7 offset:6144
ds_read_b64_tr_b16 a[12:13],v7 offset:5120
ds_read_b64_tr_b16 a[14:15],v7 offset:7168
s_waitcnt lgkmcnt(4)
ds_read_b64_tr_b16 a[168:169],v7 offset:4160
ds_read_b64_tr_b16 a[170:171],v7 offset:6208
ds_read_b64_tr_b16 a[172:173],v7 offset:5184
ds_read_b64_tr_b16 a[174:175],v7 offset:7232
ds_read_b64_tr_b16 a[16:17],v7 offset:8192
ds_read_b64_tr_b16 a[18:19],v7 offset:10240
ds_read_b64_tr_b16 a[20:21],v7 offset:9216
ds_read_b64_tr_b16 a[22:23],v7 offset:11264
ds_read_b64_tr_b16 a[176:177],v7 offset:8256
ds_read_b64_tr_b16 a[178:179],v7 offset:10304
ds_read_b64_tr_b16 a[180:181],v7 offset:9280
ds_read_b64_tr_b16 a[182:183],v7 offset:11328
s_waitcnt lgkmcnt(4)
ds_read_b64_tr_b16 a[24:25],v7 offset:12288
ds_read_b64_tr_b16 a[26:27],v7 offset:14336
ds_read_b64_tr_b16 a[28:29],v7 offset:13312
ds_read_b64_tr_b16 a[30:31],v7 offset:15360
ds_read_b64_tr_b16 a[184:185],v7 offset:12352
ds_read_b64_tr_b16 a[186:187],v7 offset:14400
ds_read_b64_tr_b16 a[188:189],v7 offset:13376
ds_read_b64_tr_b16 a[190:191],v7 offset:15424
ds_read_b64_tr_b16 a[32:33],v7 offset:16384
ds_read_b64_tr_b16 a[34:35],v7 offset:18432
ds_read_b64_tr_b16 a[36:37],v7 offset:17408
ds_read_b64_tr_b16 a[38:39],v7 offset:19456
s_waitcnt lgkmcnt(4)
ds_read_b64_tr_b16 a[192:193],v7 offset:16448
ds_read_b64_tr_b16 a[194:195],v7 offset:18496
ds_read_b64_tr_b16 a[196:197],v7 offset:17472
ds_read_b64_tr_b16 a[198:199],v7 offset:19520
s_waitcnt lgkmcnt(0)
s_add_u32 m0,s63,0
s_add_u32 s65,s58,3932160
buffer_load_dwordx4 v6,s[4:7],s65 offen lds
s_add_u32 m0,s63,1024
s_add_u32 s65,s58,4030464
buffer_load_dwordx4 v6,s[4:7],s65 offen lds
s_add_u32 m0,s63,2048
s_add_u32 s65,s58,4128768
buffer_load_dwordx4 v6,s[4:7],s65 offen lds
s_add_u32 m0,s63,3072
s_add_u32 s65,s58,4227072
buffer_load_dwordx4 v6,s[4:7],s65 offen lds
s_add_u32 m0,s63,4096
s_add_u32 s65,s58,4325376
buffer_load_dwordx4 v6,s[4:7],s65 offen lds
s_add_u32 m0,s63,5120
s_add_u32 s65,s58,4423680
buffer_load_dwordx4 v6,s[4:7],s65 offen lds
s_add_u32 m0,s63,6144
s_add_u32 s65,s58,4521984
buffer_load_dwordx4 v6,s[4:7],s65 offen lds
s_add_u32 m0,s63,7168
s_add_u32 s65,s58,4620288
buffer_load_dwordx4 v6,s[4:7],s65 offen lds
s_add_u32 m0,s63,8192
s_add_u32 s65,s58,4718592
buffer_load_dwordx4 v6,s[4:7],s65 offen lds
s_add_u32 m0,s63,9216
s_add_u32 s65,s58,4816896
buffer_load_dwordx4 v6,s[4:7],s65 offen lds
s_add_u32 m0,s63,10240
s_add_u32 s65,s58,4915200
buffer_load_dwordx4 v6,s[4:7],s65 offen lds
s_add_u32 m0,s63,11264
s_add_u32 s65,s58,5013504
buffer_load_dwordx4 v6,s[4:7],s65 offen lds
s_add_u32 m0,s63,12288
s_add_u32 s65,s58,5111808
buffer_load_dwordx4 v6,s[4:7],s65 offen lds
s_add_u32 m0,s63,13312
s_add_u32 s65,s58,5210112
buffer_load_dwordx4 v6,s[4:7],s65 offen lds
s_add_u32 m0,s63,14336
s_add_u32 s65,s58,5308416
buffer_load_dwordx4 v6,s[4:7],s65 offen lds
s_add_u32 m0,s63,15360
s_add_u32 s65,s58,5406720
buffer_load_dwordx4 v6,s[4:7],s65 offen lds
s_add_u32 m0,s63,16384
s_add_u32 s65,s58,5505024
buffer_load_dwordx4 v6,s[4:7],s65 offen lds
s_add_u32 m0,s63,17408
s_add_u32 s65,s58,5603328
buffer_load_dwordx4 v6,s[4:7],s65 offen lds
s_add_u32 m0,s63,18432
s_add_u32 s65,s58,5701632
buffer_load_dwordx4 v6,s[4:7],s65 offen lds
s_add_u32 m0,s63,19456
s_add_u32 s65,s58,5799936
buffer_load_dwordx4 v6,s[4:7],s65 offen lds
s_waitcnt vmcnt(20)
v_bfe_u32 v9,v0,2,2
v_lshrrev_b32 v10,5,v0
v_lshl_add_u32 v9,v10,2,v9
v_mul_u32_u24 v9,128,v9
v_and_b32 v10,1,v0
v_lshl_add_u32 v9,v10,3,v9
v_bfe_u32 v10,v0,1,1
v_lshl_add_u32 v9,v10,4,v9
v_bfe_u32 v10,v0,4,1
v_lshl_add_u32 v9,v10,5,v9
v_add_u32 v7,s63,v9
ds_read_b64_tr_b16 a[40:41],v7 offset:20480
ds_read_b64_tr_b16 a[42:43],v7 offset:22528
ds_read_b64_tr_b16 a[44:45],v7 offset:21504
ds_read_b64_tr_b16 a[46:47],v7 offset:23552
ds_read_b64_tr_b16 a[200:201],v7 offset:20544
ds_read_b64_tr_b16 a[202:203],v7 offset:22592
ds_read_b64_tr_b16 a[204:205],v7 offset:21568
ds_read_b64_tr_b16 a[206:207],v7 offset:23616
ds_read_b64_tr_b16 a[48:49],v7 offset:24576
ds_read_b64_tr_b16 a[50:51],v7 offset:26624
ds_read_b64_tr_b16 a[52:53],v7 offset:25600
ds_read_b64_tr_b16 a[54:55],v7 offset:27648
s_waitcnt lgkmcnt(4)
ds_read_b64_tr_b16 a[208:209],v7 offset:24640
ds_read_b64_tr_b16 a[210:211],v7 offset:26688
ds_read_b64_tr_b16 a[212:213],v7 offset:25664
ds_read_b64_tr_b16 a[214:215],v7 offset:27712
ds_read_b64_tr_b16 a[56:57],v7 offset:28672
ds_read_b64_tr_b16 a[58:59],v7 offset:30720
ds_read_b64_tr_b16 a[60:61],v7 offset:29696
ds_read_b64_tr_b16 a[62:63],v7 offset:31744
ds_read_b64_tr_b16 a[216:217],v7 offset:28736
ds_read_b64_tr_b16 a[218:219],v7 offset:30784
ds_read_b64_tr_b16 a[220:221],v7 offset:29760
ds_read_b64_tr_b16 a[222:223],v7 offset:31808
s_waitcnt lgkmcnt(4)
ds_read_b64_tr_b16 a[64:65],v7 offset:32768
ds_read_b64_tr_b16 a[66:67],v7 offset:34816
ds_read_b64_tr_b16 a[68:69],v7 offset:33792
ds_read_b64_tr_b16 a[70:71],v7 offset:35840
ds_read_b64_tr_b16 a[224:225],v7 offset:32832
ds_read_b64_tr_b16 a[226:227],v7 offset:34880
ds_read_b64_tr_b16 a[228:229],v7 offset:33856
ds_read_b64_tr_b16 a[230:231],v7 offset:35904
ds_read_b64_tr_b16 a[72:73],v7 offset:36864
ds_read_b64_tr_b16 a[74:75],v7 offset:38912
ds_read_b64_tr_b16 a[76:77],v7 offset:37888
ds_read_b64_tr_b16 a[78:79],v7 offset:39936
s_waitcnt lgkmcnt(4)
ds_read_b64_tr_b16 a[232:233],v7 offset:36928
ds_read_b64_tr_b16 a[234:235],v7 offset:38976
ds_read_b64_tr_b16 a[236:237],v7 offset:37952
ds_read_b64_tr_b16 a[238:239],v7 offset:40000
s_waitcnt lgkmcnt(0)
s_add_u32 m0,s63,20480
s_add_u32 s65,s58,5898240
buffer_load_dwordx4 v6,s[4:7],s65 offen lds
s_add_u32 m0,s63,21504
s_add_u32 s65,s58,5996544
buffer_load_dwordx4 v6,s[4:7],s65 offen lds
s_add_u32 m0,s63,22528
s_add_u32 s65,s58,6094848
buffer_load_dwordx4 v6,s[4:7],s65 offen lds
s_add_u32 m0,s63,23552
s_add_u32 s65,s58,6193152
buffer_load_dwordx4 v6,s[4:7],s65 offen lds
s_add_u32 m0,s63,24576
s_add_u32 s65,s58,6291456
buffer_load_dwordx4 v6,s[4:7],s65 offen lds
s_add_u32 m0,s63,25600
s_add_u32 s65,s58,6389760
buffer_load_dwordx4 v6,s[4:7],s65 offen lds
s_add_u32 m0,s63,26624
s_add_u32 s65,s58,6488064
buffer_load_dwordx4 v6,s[4:7],s65 offen lds
s_add_u32 m0,s63,27648
s_add_u32 s65,s58,6586368
buffer_load_dwordx4 v6,s[4:7],s65 offen lds
s_add_u32 m0,s63,28672
s_add_u32 s65,s58,6684672
buffer_load_dwordx4 v6,s[4:7],s65 offen lds
s_add_u32 m0,s63,29696
s_add_u32 s65,s58,6782976
buffer_load_dwordx4 v6,s[4:7],s65 offen lds
s_add_u32 m0,s63,30720
s_add_u32 s65,s58,6881280
buffer_load_dwordx4 v6,s[4:7],s65 offen lds
s_add_u32 m0,s63,31744
s_add_u32 s65,s58,6979584
buffer_load_dwordx4 v6,s[4:7],s65 offen lds
s_add_u32 m0,s63,32768
s_add_u32 s65,s58,7077888
buffer_load_dwordx4 v6,s[4:7],s65 offen lds
s_add_u32 m0,s63,33792
s_add_u32 s65,s58,7176192
buffer_load_dwordx4 v6,s[4:7],s65 offen lds
s_add_u32 m0,s63,34816
s_add_u32 s65,s58,7274496
buffer_load_dwordx4 v6,s[4:7],s65 offen lds
s_add_u32 m0,s63,35840
s_add_u32 s65,s58,7372800
buffer_load_dwordx4 v6,s[4:7],s65 offen lds
s_add_u32 m0,s63,36864
s_add_u32 s65,s58,7471104
buffer_load_dwordx4 v6,s[4:7],s65 offen lds
s_add_u32 m0,s63,37888
s_add_u32 s65,s58,7569408
buffer_load_dwordx4 v6,s[4:7],s65 offen lds
s_add_u32 m0,s63,38912
s_add_u32 s65,s58,7667712
buffer_load_dwordx4 v6,s[4:7],s65 offen lds
s_add_u32 m0,s63,39936
s_add_u32 s65,s58,7766016
buffer_load_dwordx4 v6,s[4:7],s65 offen lds
s_waitcnt vmcnt(20)
v_bfe_u32 v9,v0,2,2
v_lshrrev_b32 v10,5,v0
v_lshl_add_u32 v9,v10,2,v9
v_mul_u32_u24 v9,128,v9
v_and_b32 v10,1,v0
v_lshl_add_u32 v9,v10,3,v9
v_bfe_u32 v10,v0,1,1
v_lshl_add_u32 v9,v10,4,v9
v_bfe_u32 v10,v0,4,1
v_lshl_add_u32 v9,v10,5,v9
v_add_u32 v7,s63,v9
ds_read_b64_tr_b16 a[80:81],v7 offset:0
ds_read_b64_tr_b16 a[82:83],v7 offset:2048
ds_read_b64_tr_b16 a[84:85],v7 offset:1024
ds_read_b64_tr_b16 a[86:87],v7 offset:3072
ds_read_b64_tr_b16 a[240:241],v7 offset:64
ds_read_b64_tr_b16 a[242:243],v7 offset:2112
ds_read_b64_tr_b16 a[244:245],v7 offset:1088
ds_read_b64_tr_b16 a[246:247],v7 offset:3136
ds_read_b64_tr_b16 a[88:89],v7 offset:4096
ds_read_b64_tr_b16 a[90:91],v7 offset:6144
ds_read_b64_tr_b16 a[92:93],v7 offset:5120
ds_read_b64_tr_b16 a[94:95],v7 offset:7168
s_waitcnt lgkmcnt(4)
ds_read_b64_tr_b16 a[248:249],v7 offset:4160
ds_read_b64_tr_b16 a[250:251],v7 offset:6208
ds_read_b64_tr_b16 a[252:253],v7 offset:5184
ds_read_b64_tr_b16 a[254:255],v7 offset:7232
ds_read_b64_tr_b16 a[96:97],v7 offset:8192
ds_read_b64_tr_b16 a[98:99],v7 offset:10240
ds_read_b64_tr_b16 a[100:101],v7 offset:9216
ds_read_b64_tr_b16 a[102:103],v7 offset:11264
ds_read_b64_tr_b16 v[192:193],v7 offset:8256
ds_read_b64_tr_b16 v[194:195],v7 offset:10304
ds_read_b64_tr_b16 v[196:197],v7 offset:9280
ds_read_b64_tr_b16 v[198:199],v7 offset:11328
s_waitcnt lgkmcnt(4)
ds_read_b64_tr_b16 a[104:105],v7 offset:12288
ds_read_b64_tr_b16 a[106:107],v7 offset:14336
ds_read_b64_tr_b16 a[108:109],v7 offset:13312
ds_read_b64_tr_b16 a[110:111],v7 offset:15360
ds_read_b64_tr_b16 v[200:201],v7 offset:12352
ds_read_b64_tr_b16 v[202:203],v7 offset:14400
ds_read_b64_tr_b16 v[204:205],v7 offset:13376
ds_read_b64_tr_b16 v[206:207],v7 offset:15424
ds_read_b64_tr_b16 a[112:113],v7 offset:16384
ds_read_b64_tr_b16 a[114:115],v7 offset:18432
ds_read_b64_tr_b16 a[116:117],v7 offset:17408
ds_read_b64_tr_b16 a[118:119],v7 offset:19456
s_waitcnt lgkmcnt(4)
ds_read_b64_tr_b16 v[208:209],v7 offset:16448
ds_read_b64_tr_b16 v[210:211],v7 offset:18496
ds_read_b64_tr_b16 v[212:213],v7 offset:17472
ds_read_b64_tr_b16 v[214:215],v7 offset:19520
s_waitcnt lgkmcnt(0)
s_waitcnt vmcnt(0)
v_bfe_u32 v9,v0,2,2
v_lshrrev_b32 v10,5,v0
v_lshl_add_u32 v9,v10,2,v9
v_mul_u32_u24 v9,128,v9
v_and_b32 v10,1,v0
v_lshl_add_u32 v9,v10,3,v9
v_bfe_u32 v10,v0,1,1
v_lshl_add_u32 v9,v10,4,v9
v_bfe_u32 v10,v0,4,1
v_lshl_add_u32 v9,v10,5,v9
v_add_u32 v7,s63,v9
ds_read_b64_tr_b16 a[120:121],v7 offset:20480
ds_read_b64_tr_b16 a[122:123],v7 offset:22528
ds_read_b64_tr_b16 a[124:125],v7 offset:21504
ds_read_b64_tr_b16 a[126:127],v7 offset:23552
ds_read_b64_tr_b16 v[216:217],v7 offset:20544
ds_read_b64_tr_b16 v[218:219],v7 offset:22592
ds_read_b64_tr_b16 v[220:221],v7 offset:21568
ds_read_b64_tr_b16 v[222:223],v7 offset:23616
ds_read_b64_tr_b16 a[128:129],v7 offset:24576
ds_read_b64_tr_b16 a[130:131],v7 offset:26624
ds_read_b64_tr_b16 a[132:133],v7 offset:25600
ds_read_b64_tr_b16 a[134:135],v7 offset:27648
s_waitcnt lgkmcnt(4)
ds_read_b64_tr_b16 v[224:225],v7 offset:24640
ds_read_b64_tr_b16 v[226:227],v7 offset:26688
ds_read_b64_tr_b16 v[228:229],v7 offset:25664
ds_read_b64_tr_b16 v[230:231],v7 offset:27712
ds_read_b64_tr_b16 a[136:137],v7 offset:28672
ds_read_b64_tr_b16 a[138:139],v7 offset:30720
ds_read_b64_tr_b16 a[140:141],v7 offset:29696
ds_read_b64_tr_b16 a[142:143],v7 offset:31744
ds_read_b64_tr_b16 v[232:233],v7 offset:28736
ds_read_b64_tr_b16 v[234:235],v7 offset:30784
ds_read_b64_tr_b16 v[236:237],v7 offset:29760
ds_read_b64_tr_b16 v[238:239],v7 offset:31808
s_waitcnt lgkmcnt(4)
ds_read_b64_tr_b16 a[144:145],v7 offset:32768
ds_read_b64_tr_b16 a[146:147],v7 offset:34816
ds_read_b64_tr_b16 a[148:149],v7 offset:33792
ds_read_b64_tr_b16 a[150:151],v7 offset:35840
ds_read_b64_tr_b16 v[240:241],v7 offset:32832
ds_read_b64_tr_b16 v[242:243],v7 offset:34880
ds_read_b64_tr_b16 v[244:245],v7 offset:33856
ds_read_b64_tr_b16 v[246:247],v7 offset:35904
ds_read_b64_tr_b16 a[152:153],v7 offset:36864
ds_read_b64_tr_b16 a[154:155],v7 offset:38912
ds_read_b64_tr_b16 a[156:157],v7 offset:37888
ds_read_b64_tr_b16 a[158:159],v7 offset:39936
s_waitcnt lgkmcnt(4)
ds_read_b64_tr_b16 v[248:249],v7 offset:36928
ds_read_b64_tr_b16 v[250:251],v7 offset:38976
ds_read_b64_tr_b16 v[252:253],v7 offset:37952
ds_read_b64_tr_b16 v[254:255],v7 offset:40000
s_waitcnt lgkmcnt(0)
v_mov_b32 v24,0x3f803f80
v_mov_b32 v25,0x3f803f80
v_mov_b32 v26,0x3f803f80
v_mov_b32 v27,0x3f803f80
s_nop 1
v_mfma_f32_32x32x16_bf16 v[56:71],v[24:27],a[0:3],0
v_mfma_f32_32x32x16_bf16 v[72:87],v[24:27],a[160:163],0
v_mfma_f32_32x32x16_bf16 v[56:71],v[24:27],a[4:7],v[56:71]
v_mfma_f32_32x32x16_bf16 v[72:87],v[24:27],a[164:167],v[72:87]
v_mfma_f32_32x32x16_bf16 v[56:71],v[24:27],a[8:11],v[56:71]
v_mfma_f32_32x32x16_bf16 v[72:87],v[24:27],a[168:171],v[72:87]
v_mfma_f32_32x32x16_bf16 v[56:71],v[24:27],a[12:15],v[56:71]
v_mfma_f32_32x32x16_bf16 v[72:87],v[24:27],a[172:175],v[72:87]
v_mfma_f32_32x32x16_bf16 v[56:71],v[24:27],a[16:19],v[56:71]
v_mfma_f32_32x32x16_bf16 v[72:87],v[24:27],a[176:179],v[72:87]
v_mfma_f32_32x32x16_bf16 v[56:71],v[24:27],a[20:23],v[56:71]
v_mfma_f32_32x32x16_bf16 v[72:87],v[24:27],a[180:183],v[72:87]
v_mfma_f32_32x32x16_bf16 v[56:71],v[24:27],a[24:27],v[56:71]
v_mfma_f32_32x32x16_bf16 v[72:87],v[24:27],a[184:187],v[72:87]
v_mfma_f32_32x32x16_bf16 v[56:71],v[24:27],a[28:31],v[56:71]
v_mfma_f32_32x32x16_bf16 v[72:87],v[24:27],a[188:191],v[72:87]
v_mfma_f32_32x32x16_bf16 v[56:71],v[24:27],a[32:35],v[56:71]
v_mfma_f32_32x32x16_bf16 v[72:87],v[24:27],a[192:195],v[72:87]
v_mfma_f32_32x32x16_bf16 v[56:71],v[24:27],a[36:39],v[56:71]
v_mfma_f32_32x32x16_bf16 v[72:87],v[24:27],a[196:199],v[72:87]
v_mfma_f32_32x32x16_bf16 v[56:71],v[24:27],a[40:43],v[56:71]
v_mfma_f32_32x32x16_bf16 v[72:87],v[24:27],a[200:203],v[72:87]
v_mfma_f32_32x32x16_bf16 v[56:71],v[24:27],a[44:47],v[56:71]
v_mfma_f32_32x32x16_bf16 v[72:87],v[24:27],a[204:207],v[72:87]
v_mfma_f32_32x32x16_bf16 v[56:71],v[24:27],a[48:51],v[56:71]
v_mfma_f32_32x32x16_bf16 v[72:87],v[24:27],a[208:211],v[72:87]
v_mfma_f32_32x32x16_bf16 v[56:71],v[24:27],a[52:55],v[56:71]
v_mfma_f32_32x32x16_bf16 v[72:87],v[24:27],a[212:215],v[72:87]
v_mfma_f32_32x32x16_bf16 v[56:71],v[24:27],a[56:59],v[56:71]
v_mfma_f32_32x32x16_bf16 v[72:87],v[24:27],a[216:219],v[72:87]
v_mfma_f32_32x32x16_bf16 v[56:71],v[24:27],a[60:63],v[56:71]
v_mfma_f32_32x32x16_bf16 v[72:87],v[24:27],a[220:223],v[72:87]
v_mfma_f32_32x32x16_bf16 v[56:71],v[24:27],a[64:67],v[56:71]
v_mfma_f32_32x32x16_bf16 v[72:87],v[24:27],a[224:227],v[72:87]
v_mfma_f32_32x32x16_bf16 v[56:71],v[24:27],a[68:71],v[56:71]
v_mfma_f32_32x32x16_bf16 v[72:87],v[24:27],a[228:231],v[72:87]
v_mfma_f32_32x32x16_bf16 v[56:71],v[24:27],a[72:75],v[56:71]
v_mfma_f32_32x32x16_bf16 v[72:87],v[24:27],a[232:235],v[72:87]
v_mfma_f32_32x32x16_bf16 v[56:71],v[24:27],a[76:79],v[56:71]
v_mfma_f32_32x32x16_bf16 v[72:87],v[24:27],a[236:239],v[72:87]
v_mfma_f32_32x32x16_bf16 v[56:71],v[24:27],a[80:83],v[56:71]
v_mfma_f32_32x32x16_bf16 v[72:87],v[24:27],a[240:243],v[72:87]
v_mfma_f32_32x32x16_bf16 v[56:71],v[24:27],a[84:87],v[56:71]
v_mfma_f32_32x32x16_bf16 v[72:87],v[24:27],a[244:247],v[72:87]
v_mfma_f32_32x32x16_bf16 v[56:71],v[24:27],a[88:91],v[56:71]
v_mfma_f32_32x32x16_bf16 v[72:87],v[24:27],a[248:251],v[72:87]
v_mfma_f32_32x32x16_bf16 v[56:71],v[24:27],a[92:95],v[56:71]
v_mfma_f32_32x32x16_bf16 v[72:87],v[24:27],a[252:255],v[72:87]
v_mfma_f32_32x32x16_bf16 v[56:71],v[24:27],a[96:99],v[56:71]
v_mfma_f32_32x32x16_bf16 v[72:87],v[24:27],v[192:195],v[72:87]
v_mfma_f32_32x32x16_bf16 v[56:71],v[24:27],a[100:103],v[56:71]
v_mfma_f32_32x32x16_bf16 v[72:87],v[24:27],v[196:199],v[72:87]
v_mfma_f32_32x32x16_bf16 v[56:71],v[24:27],a[104:107],v[56:71]
v_mfma_f32_32x32x16_bf16 v[72:87],v[24:27],v[200:203],v[72:87]
v_mfma_f32_32x32x16_bf16 v[56:71],v[24:27],a[108:111],v[56:71]
v_mfma_f32_32x32x16_bf16 v[72:87],v[24:27],v[204:207],v[72:87]
v_mfma_f32_32x32x16_bf16 v[56:71],v[24:27],a[112:115],v[56:71]
v_mfma_f32_32x32x16_bf16 v[72:87],v[24:27],v[208:211],v[72:87]
v_mfma_f32_32x32x16_bf16 v[56:71],v[24:27],a[116:119],v[56:71]
v_mfma_f32_32x32x16_bf16 v[72:87],v[24:27],v[212:215],v[72:87]
v_mfma_f32_32x32x16_bf16 v[56:71],v[24:27],a[120:123],v[56:71]
v_mfma_f32_32x32x16_bf16 v[72:87],v[24:27],v[216:219],v[72:87]
v_mfma_f32_32x32x16_bf16 v[56:71],v[24:27],a[124:127],v[56:71]
v_mfma_f32_32x32x16_bf16 v[72:87],v[24:27],v[220:223],v[72:87]
v_mfma_f32_32x32x16_bf16 v[56:71],v[24:27],a[128:131],v[56:71]
v_mfma_f32_32x32x16_bf16 v[72:87],v[24:27],v[224:227],v[72:87]
v_mfma_f32_32x32x16_bf16 v[56:71],v[24:27],a[132:135],v[56:71]
v_mfma_f32_32x32x16_bf16 v[72:87],v[24:27],v[228:231],v[72:87]
v_mfma_f32_32x32x16_bf16 v[56:71],v[24:27],a[136:139],v[56:71]
v_mfma_f32_32x32x16_bf16 v[72:87],v[24:27],v[232:235],v[72:87]
v_mfma_f32_32x32x16_bf16 v[56:71],v[24:27],a[140:143],v[56:71]
v_mfma_f32_32x32x16_bf16 v[72:87],v[24:27],v[236:239],v[72:87]
v_mfma_f32_32x32x16_bf16 v[56:71],v[24:27],a[144:147],v[56:71]
v_mfma_f32_32x32x16_bf16 v[72:87],v[24:27],v[240:243],v[72:87]
v_mfma_f32_32x32x16_bf16 v[56:71],v[24:27],a[148:151],v[56:71]
v_mfma_f32_32x32x16_bf16 v[72:87],v[24:27],v[244:247],v[72:87]
v_mfma_f32_32x32x16_bf16 v[56:71],v[24:27],a[152:155],v[56:71]
v_mfma_f32_32x32x16_bf16 v[72:87],v[24:27],v[248:251],v[72:87]
v_mfma_f32_32x32x16_bf16 v[56:71],v[24:27],a[156:159],v[56:71]
v_mfma_f32_32x32x16_bf16 v[72:87],v[24:27],v[252:255],v[72:87]
s_nop 4
v_mov_b32 v120,v56
s_nop 5
v_mov_b32 v121,v72
s_barrier
s_lshl_b32 s3,s49,2
v_mov_b32 v7,s3
s_nop 1
ibw_216:
buffer_load_dword v6,v7,s[12:15],0 offen sc1
s_waitcnt vmcnt(0)
v_cmp_ne_u32 vcc,256,v6
s_nop 0
s_cbranch_vccz ok_217
s_sleep 8
s_sub_u32 s47,s47,1
s_cbranch_scc1 ABORT
s_branch ibw_216
ok_217:
s_cmp_lg_u32 s49,0
s_cbranch_scc1 ibok_218
v_and_b32 v7,7,v0
v_lshlrev_b32 v7,2,v7
buffer_load_dword v6,v7,s[12:15],0 offen offset:32 sc1
s_waitcnt vmcnt(0)
v_cmp_ne_u32 vcc,32,v6
s_nop 0
s_cbranch_vccz ibok_218
s_barrier
s_mov_b32 s49,1
s_mov_b32 s3,s2
s_load_dwordx16 s[16:31],s[0:1],0
s_load_dwordx8 s[32:39],s[0:1],64
s_waitcnt lgkmcnt(0)
s_branch DISPATCH
ibok_218:
s_mov_b32 s50,0
s_mov_b32 s32,0
s_mov_b32 s57,0
s_mov_b32 s59,2147483648
s_mov_b32 s82,2147483648
s_mov_b32 s39,2147483648
v_mov_b32 v22,94208
s_mov_b32 s72,0
s_mov_b32 s73,0
s_mov_b32 s78,0
s_mov_b32 s79,0
s_cmp_eq_u32 s46,0
s_cselect_b32 s40,0,2147483648
s_lshl_b32 s60,s46,3
v_add_u32 v13,s60,v22
s_mov_b32 s83,s100
s_lshl_b32 s41,s78,9
s_add_u32 s41,s41,s40
s_lshl_b32 s35,s79,9
s_add_u32 s35,s35,s40
s_add_u32 s35,s35,32768
s_branch QKVV_COLD0
QKVV_B0:
s_waitcnt lgkmcnt(3)
v_mfma_f32_32x32x16_bf16 v[56:71],v[24:27],a[0:3],0
ds_read_b128 v[44:47],v17 offset:4096
v_add_u32 v189,s57,v188
v_mfma_f32_32x32x16_bf16 v[72:87],v[24:27],a[160:163],0
v_add_u32 v8,0x800,v189
s_sub_u32 s66,46080,s57
s_lshl_b32 s60,s33,6
s_add_u32 s60,s60,s34
s_mul_i32 s60,s60,46080
s_add_u32 s60,s60,s37
v_mfma_f32_32x32x16_bf16 v[56:71],v[28:31],a[4:7],v[56:71]
ds_read_b128 v[48:51],v16 offset:6144
ds_read2_b64 v[156:159],v189 offset0:0 offset1:32
s_add_u32 s60,s60,206569472
s_lshl_b32 s62,s46,10
v_mfma_f32_32x32x16_bf16 v[72:87],v[28:31],a[164:167],v[72:87]
ds_read2_b64 v[160:163],v189 offset0:64 offset1:96
s_add_u32 s62,s62,40960
s_add_u32 m0,s66,s62
s_add_u32 s63,s60,s62
s_waitcnt lgkmcnt(5)
v_mfma_f32_32x32x16_bf16 v[56:71],v[32:35],a[8:11],v[56:71]
ds_read_b128 v[52:55],v17 offset:6144
ds_read2_b64 v[164:167],v189 offset0:128 offset1:160
buffer_load_dwordx4 v1,s[8:11],s63 offen sc1 lds
v_mfma_f32_32x32x16_bf16 v[72:87],v[32:35],a[168:171],v[72:87]
ds_read2_b64 v[168:171],v189 offset0:192 offset1:224
s_add_u32 m0,s66,45056
s_add_u32 s63,s60,45056
s_mul_i32 s74,s73,393216
s_add_u32 s74,s74,s39
v_mfma_f32_32x32x16_bf16 v[56:71],v[36:39],a[12:15],v[56:71]
ds_read_b128 v[24:27],v16 offset:8192
ds_read2_b64 v[172:175],v8 offset0:0 offset1:32
s_add_u32 s74,s74,s70
v_fma_f32 v88,-v124,v120,v88
v_mfma_f32_32x32x16_bf16 v[72:87],v[36:39],a[172:175],v[72:87]
buffer_load_dwordx4 v1,s[8:11],s63 offen sc1 lds
s_mul_i32 s61,s46,10240
s_add_u32 s60,s60,s61
s_add_u32 s61,s61,s66
s_waitcnt lgkmcnt(8)
v_mfma_f32_32x32x16_bf16 v[56:71],v[40:43],a[16:19],v[56:71]
ds_read_b128 v[28:31],v17 offset:8192
s_add_u32 m0,s61,0
s_add_u32 s63,s60,0
v_fma_f32 v89,-v126,v120,v89
v_fma_f32 v90,-v128,v120,v90
v_mfma_f32_32x32x16_bf16 v[72:87],v[40:43],a[176:179],v[72:87]
v_fma_f32 v91,-v130,v120,v91
v_fma_f32 v96,-v140,v120,v96
v_fma_f32 v97,-v142,v120,v97
v_fma_f32 v98,-v144,v120,v98
v_fma_f32 v99,-v146,v120,v99
v_mfma_f32_32x32x16_bf16 v[56:71],v[44:47],a[20:23],v[56:71]
ds_read_b128 v[32:35],v16 offset:10240
buffer_load_dwordx4 v1,s[8:11],s63 offen sc1 lds
s_mov_b32 s53,s33
s_mov_b32 s54,s34
v_mfma_f32_32x32x16_bf16 v[72:87],v[44:47],a[180:183],v[72:87]
s_add_u32 s79,s79,s33
s_or_b32 s65,s37,s33
s_cmp_eq_u32 s65,0
s_addc_u32 s78,s78,0
s_lshl_b32 s41,s78,9
s_waitcnt lgkmcnt(6)
v_mfma_f32_32x32x16_bf16 v[56:71],v[48:51],a[24:27],v[56:71]
ds_read_b128 v[36:39],v17 offset:10240
s_add_u32 s41,s41,s40
s_lshl_b32 s35,s79,9
s_add_u32 s35,s35,s40
s_add_u32 s35,s35,32768
v_mfma_f32_32x32x16_bf16 v[72:87],v[48:51],a[184:187],v[72:87]
buffer_load_dwordx4 v1,s[8:11],s63 offen offset:1024 sc1 lds
v_mul_f32 v88,v88,v125
v_mul_f32 v89,v89,v127
v_mul_f32 v90,v90,v129
v_mul_f32 v91,v91,v131
v_mfma_f32_32x32x16_bf16 v[56:71],v[52:55],a[28:31],v[56:71]
ds_read_b128 v[40:43],v16 offset:12288
v_mul_f32 v96,v96,v141
v_mul_f32 v97,v97,v143
v_mul_f32 v98,v98,v145
v_mul_f32 v99,v99,v147
v_mfma_f32_32x32x16_bf16 v[72:87],v[52:55],a[188:191],v[72:87]
v_cvt_pk_bf16_f32 v88,v88,v89
v_cvt_pk_bf16_f32 v89,v90,v91
v_cvt_pk_bf16_f32 v90,v96,v97
v_cvt_pk_bf16_f32 v91,v98,v99
v_fma_f32 v92,-v132,v120,v92
s_waitcnt lgkmcnt(3)
v_mfma_f32_32x32x16_bf16 v[56:71],v[24:27],a[32:35],v[56:71]
ds_read_b128 v[44:47],v17 offset:12288
buffer_load_dwordx4 v1,s[8:11],s63 offen offset:2048 sc1 lds
v_fma_f32 v93,-v134,v120,v93
v_fma_f32 v94,-v136,v120,v94
v_mfma_f32_32x32x16_bf16 v[72:87],v[24:27],a[192:195],v[72:87]
v_fma_f32 v95,-v138,v120,v95
v_fma_f32 v100,-v148,v120,v100
v_fma_f32 v101,-v150,v120,v101
v_fma_f32 v102,-v152,v120,v102
v_fma_f32 v103,-v154,v120,v103
v_mfma_f32_32x32x16_bf16 v[56:71],v[28:31],a[36:39],v[56:71]
ds_read_b128 v[48:51],v16 offset:14336
v_mul_f32 v92,v92,v133
v_mul_f32 v93,v93,v135
v_mul_f32 v94,v94,v137
v_mul_f32 v95,v95,v139
v_mfma_f32_32x32x16_bf16 v[72:87],v[28:31],a[196:199],v[72:87]
buffer_load_dwordx4 v1,s[8:11],s63 offen offset:3072 sc1 lds
s_add_u32 m0,s61,4096
s_add_u32 s63,s60,4096
v_mul_f32 v100,v100,v149
s_waitcnt lgkmcnt(3)
v_mfma_f32_32x32x16_bf16 v[56:71],v[32:35],a[40:43],v[56:71]
ds_read_b128 v[52:55],v17 offset:14336
v_mul_f32 v101,v101,v151
v_mul_f32 v102,v102,v153
v_mul_f32 v103,v103,v155
v_cvt_pk_bf16_f32 v92,v92,v93
v_mfma_f32_32x32x16_bf16 v[72:87],v[32:35],a[200:203],v[72:87]
v_cvt_pk_bf16_f32 v93,v94,v95
v_cvt_pk_bf16_f32 v94,v100,v101
v_cvt_pk_bf16_f32 v95,v102,v103
v_fma_f32 v104,-v124,v121,v104
v_fma_f32 v105,-v126,v121,v105
v_mfma_f32_32x32x16_bf16 v[56:71],v[36:39],a[44:47],v[56:71]
ds_read_b128 v[24:27],v16 offset:16384
buffer_load_dwordx4 v1,s[8:11],s63 offen sc1 lds
v_fma_f32 v106,-v128,v121,v106
v_fma_f32 v107,-v130,v121,v107
v_mfma_f32_32x32x16_bf16 v[72:87],v[36:39],a[204:207],v[72:87]
v_fma_f32 v112,-v140,v121,v112
v_fma_f32 v113,-v142,v121,v113
v_fma_f32 v114,-v144,v121,v114
v_fma_f32 v115,-v146,v121,v115
v_mul_f32 v104,v104,v125
s_waitcnt lgkmcnt(3)
v_mfma_f32_32x32x16_bf16 v[56:71],v[40:43],a[48:51],v[56:71]
ds_read_b128 v[28:31],v17 offset:16384
v_mul_f32 v105,v105,v127
v_mul_f32 v106,v106,v129
v_mul_f32 v107,v107,v131
v_mul_f32 v112,v112,v141
v_mfma_f32_32x32x16_bf16 v[72:87],v[40:43],a[208:211],v[72:87]
buffer_load_dwordx4 v1,s[8:11],s63 offen offset:1024 sc1 lds
v_mul_f32 v113,v113,v143
v_mul_f32 v114,v114,v145
v_mul_f32 v115,v115,v147
v_cvt_pk_bf16_f32 v104,v104,v105
v_mfma_f32_32x32x16_bf16 v[56:71],v[44:47],a[52:55],v[56:71]
ds_read_b128 v[32:35],v16 offset:18432
v_cvt_pk_bf16_f32 v105,v106,v107
v_cvt_pk_bf16_f32 v106,v112,v113
v_cvt_pk_bf16_f32 v107,v114,v115
v_fma_f32 v108,-v132,v121,v108
v_mfma_f32_32x32x16_bf16 v[72:87],v[44:47],a[212:215],v[72:87]
v_fma_f32 v109,-v134,v121,v109
v_fma_f32 v110,-v136,v121,v110
v_fma_f32 v111,-v138,v121,v111
v_fma_f32 v116,-v148,v121,v116
v_fma_f32 v117,-v150,v121,v117
s_waitcnt lgkmcnt(3)
v_mfma_f32_32x32x16_bf16 v[56:71],v[48:51],a[56:59],v[56:71]
ds_read_b128 v[36:39],v17 offset:18432
buffer_load_dwordx4 v1,s[8:11],s63 offen offset:2048 sc1 lds
v_fma_f32 v118,-v152,v121,v118
v_fma_f32 v119,-v154,v121,v119
v_mfma_f32_32x32x16_bf16 v[72:87],v[48:51],a[216:219],v[72:87]
v_mul_f32 v108,v108,v133
v_mul_f32 v109,v109,v135
v_mul_f32 v110,v110,v137
v_mul_f32 v111,v111,v139
v_mul_f32 v116,v116,v149
v_mfma_f32_32x32x16_bf16 v[56:71],v[52:55],a[60:63],v[56:71]
ds_read_b128 v[40:43],v16 offset:20480
s_waitcnt vmcnt(9)
s_mov_b64 exec,1
buffer_store_dword v5,v1,s[8:11],s59 offen sc1
s_mov_b64 exec,-1
s_mov_b32 s59,2147483648
v_mfma_f32_32x32x16_bf16 v[72:87],v[52:55],a[220:223],v[72:87]
buffer_load_dwordx4 v1,s[8:11],s63 offen offset:3072 sc1 lds
s_add_u32 m0,s61,8192
s_add_u32 s63,s60,8192
v_mul_f32 v117,v117,v151
s_waitcnt lgkmcnt(3)
v_mfma_f32_32x32x16_bf16 v[56:71],v[24:27],a[64:67],v[56:71]
ds_read_b128 v[44:47],v17 offset:20480
v_mul_f32 v118,v118,v153
v_mul_f32 v119,v119,v155
v_cvt_pk_bf16_f32 v108,v108,v109
v_cvt_pk_bf16_f32 v109,v110,v111
v_mfma_f32_32x32x16_bf16 v[72:87],v[24:27],a[224:227],v[72:87]
v_cvt_pk_bf16_f32 v110,v116,v117
v_cvt_pk_bf16_f32 v111,v118,v119
s_lshl_b32 s82,s72,6
s_add_u32 s82,s82,s73
s_lshl_b32 s82,s82,9
s_add_u32 s82,s82,s71
v_mfma_f32_32x32x16_bf16 v[56:71],v[28:31],a[68:71],v[56:71]
ds_read_b128 v[48:51],v16 offset:22528
buffer_load_dwordx4 v1,s[8:11],s63 offen sc1 lds
s_lshl_b32 s75,s69,2
s_add_u32 s82,s82,s75
v_mfma_f32_32x32x16_bf16 v[72:87],v[28:31],a[228:231],v[72:87]
buffer_load_dword v3,v2,s[8:11],s35 offen sc1
buffer_load_dword v14,v4,s[8:11],s41 offen sc1
s_add_u32 s82,s82,s39
s_waitcnt lgkmcnt(3)
v_mfma_f32_32x32x16_bf16 v[56:71],v[32:35],a[72:75],v[56:71]
ds_read_b128 v[52:55],v17 offset:22528
v_add_f32 v156,v156,v166
v_add_f32 v157,v157,v167
v_add_f32 v158,v158,v168
v_mfma_f32_32x32x16_bf16 v[72:87],v[32:35],a[232:235],v[72:87]
buffer_load_dwordx4 v1,s[8:11],s63 offen offset:1024 sc1 lds
v_add_f32 v159,v159,v169
v_add_f32 v160,v160,v170
v_add_f32 v161,v161,v171
v_add_f32 v162,v162,v172
v_mfma_f32_32x32x16_bf16 v[56:71],v[36:39],a[76:79],v[56:71]
ds_read_b128 v[24:27],v16 offset:24576
v_add_f32 v163,v163,v173
v_add_f32 v164,v164,v174
v_add_f32 v165,v165,v175
v_add_f32 v156,v156,v158
v_mfma_f32_32x32x16_bf16 v[72:87],v[36:39],a[236:239],v[72:87]
v_add_f32 v157,v157,v159
v_add_f32 v160,v160,v162
v_add_f32 v161,v161,v163
v_add_f32 v156,v156,v160
v_add_f32 v157,v157,v161
s_waitcnt lgkmcnt(3)
v_mfma_f32_32x32x16_bf16 v[56:71],v[40:43],a[80:83],v[56:71]
ds_read_b128 v[28:31],v17 offset:24576
buffer_store_dwordx4 v[88:91],v20,s[8:11],s74 offen sc1
v_add_f32 v156,v156,v164
v_add_f32 v157,v157,v165
v_mfma_f32_32x32x16_bf16 v[72:87],v[40:43],a[240:243],v[72:87]
v_mov_b32 v158,v156
v_mov_b32 v159,v157
s_nop 0
v_permlane32_swap_b32 v156,v158
v_permlane32_swap_b32 v157,v159
v_add_f32 v176,v156,v158
v_mfma_f32_32x32x16_bf16 v[56:71],v[44:47],a[84:87],v[56:71]
ds_read_b128 v[32:35],v16 offset:26624
buffer_store_dwordx4 v[92:95],v21,s[8:11],s74 offen sc1
v_add_f32 v177,v157,v159
v_mul_f32 v176,0x3acccccd,v176
v_mfma_f32_32x32x16_bf16 v[72:87],v[44:47],a[244:247],v[72:87]
v_mul_f32 v177,0x3acccccd,v177
v_fma_f32 v177,-v176,v176,v177
v_max_f32 v177,0,v177
v_cvt_pk_bf16_f32 v8,v176,v177
v_lshlrev_b32 v176,16,v8
s_waitcnt lgkmcnt(3)
v_mfma_f32_32x32x16_bf16 v[56:71],v[48:51],a[88:91],v[56:71]
ds_read_b128 v[36:39],v17 offset:26624
buffer_store_dwordx4 v[104:107],v20,s[8:11],s74 offen offset:2048 sc1
v_and_b32 v177,0xffff0000,v8
v_add_f32 v177,0x3727c5ac,v177
v_mfma_f32_32x32x16_bf16 v[72:87],v[48:51],a[248:251],v[72:87]
v_cvt_pk_bf16_f32 v8,v177,v177
v_lshlrev_b32 v177,16,v8
v_sqrt_f32 v177,v177
s_nop 0
v_cvt_pk_bf16_f32 v8,v177,v177
v_lshlrev_b32 v177,16,v8
v_mfma_f32_32x32x16_bf16 v[56:71],v[52:55],a[92:95],v[56:71]
ds_read_b128 v[40:43],v16 offset:28672
buffer_store_dwordx4 v[108:111],v21,s[8:11],s74 offen offset:2048 sc1
v_rcp_f32 v177,v177
v_mfma_f32_32x32x16_bf16 v[72:87],v[52:55],a[252:255],v[72:87]
s_cmp_eq_u32 s51,0
s_cselect_b64 s[76:77],-1,0
v_cndmask_b32 v176,v176,0,s[76:77]
v_cndmask_b32 v177,v177,1.0,s[76:77]
s_mov_b32 s72,s51
s_waitcnt lgkmcnt(3)
v_mfma_f32_32x32x16_bf16 v[56:71],v[24:27],a[96:99],v[56:71]
ds_read_b128 v[44:47],v17 offset:28672
s_mov_b32 s73,s52
ds_write_b64 v190,v[176:177]
v_mfma_f32_32x32x16_bf16 v[72:87],v[24:27],v[192:195],v[72:87]
ds_read_b128 v[124:127],v191 offset:0
ds_read_b128 v[128:131],v191 offset:16
ds_read_b128 v[132:135],v191 offset:64
v_mfma_f32_32x32x16_bf16 v[56:71],v[28:31],a[100:103],v[56:71]
ds_read_b128 v[48:51],v16 offset:30720
ds_read_b128 v[136:139],v191 offset:80
ds_read_b128 v[140:143],v191 offset:128
v_mfma_f32_32x32x16_bf16 v[72:87],v[28:31],v[196:199],v[72:87]
ds_read_b128 v[144:147],v191 offset:144
ds_read_b128 v[148:151],v191 offset:192
s_waitcnt lgkmcnt(11)
v_mfma_f32_32x32x16_bf16 v[56:71],v[32:35],a[104:107],v[56:71]
ds_read_b128 v[52:55],v17 offset:30720
ds_read_b128 v[152:155],v191 offset:208
v_mfma_f32_32x32x16_bf16 v[72:87],v[32:35],v[200:203],v[72:87]
v_mfma_f32_32x32x16_bf16 v[56:71],v[36:39],a[108:111],v[56:71]
ds_read_b128 v[24:27],v16 offset:32768
v_mfma_f32_32x32x16_bf16 v[72:87],v[36:39],v[204:207],v[72:87]
s_waitcnt lgkmcnt(12)
v_mfma_f32_32x32x16_bf16 v[56:71],v[40:43],a[112:115],v[56:71]
ds_read_b128 v[28:31],v17 offset:32768
v_mfma_f32_32x32x16_bf16 v[72:87],v[40:43],v[208:211],v[72:87]
v_mfma_f32_32x32x16_bf16 v[56:71],v[44:47],a[116:119],v[56:71]
ds_read_b128 v[32:35],v16 offset:34816
v_mfma_f32_32x32x16_bf16 v[72:87],v[44:47],v[212:215],v[72:87]
s_waitcnt lgkmcnt(4)
v_mfma_f32_32x32x16_bf16 v[56:71],v[48:51],a[120:123],v[56:71]
ds_read_b128 v[36:39],v17 offset:34816
v_mfma_f32_32x32x16_bf16 v[72:87],v[48:51],v[216:219],v[72:87]
v_mfma_f32_32x32x16_bf16 v[56:71],v[52:55],a[124:127],v[56:71]
ds_read_b128 v[40:43],v16 offset:36864
v_mfma_f32_32x32x16_bf16 v[72:87],v[52:55],v[220:223],v[72:87]
s_waitcnt lgkmcnt(3)
v_mfma_f32_32x32x16_bf16 v[56:71],v[24:27],a[128:131],v[56:71]
ds_read_b128 v[44:47],v17 offset:36864
s_waitcnt vmcnt(4)
v_cmp_eq_u32 vcc,0,v14
s_cmp_eq_u64 vcc,0
s_cselect_b32 s36,0,2147483648
v_mfma_f32_32x32x16_bf16 v[72:87],v[24:27],v[224:227],v[72:87]
v_cmp_eq_u32 vcc,0,v3
s_cmp_lt_u32 s78,64
s_cselect_b32 s36,s36,2147483648
s_cmp_eq_u64 vcc,0
s_cselect_b32 s60,1,s36
v_mfma_f32_32x32x16_bf16 v[56:71],v[28:31],a[132:135],v[56:71]
ds_read_b128 v[48:51],v16 offset:38912
s_cmp_lt_u32 s79,64
s_cselect_b32 s60,s60,s36
s_sub_u32 s61,s78,s79
s_or_b32 s61,s61,s36
v_mfma_f32_32x32x16_bf16 v[72:87],v[28:31],v[228:231],v[72:87]
s_cmp_lt_u32 s61,16
s_cselect_b32 s36,0,s60
v_mov_b32 v23,s36
s_waitcnt lgkmcnt(3)
v_mfma_f32_32x32x16_bf16 v[56:71],v[32:35],a[136:139],v[56:71]
ds_read_b128 v[52:55],v17 offset:38912
ds_write_b32 v13,v23
v_mfma_f32_32x32x16_bf16 v[72:87],v[32:35],v[232:235],v[72:87]
s_waitcnt lgkmcnt(0)
s_barrier
ds_read_b32 v23,v22
v_mfma_f32_32x32x16_bf16 v[56:71],v[36:39],a[140:143],v[56:71]
ds_read_b128 v[24:27],v18 offset:0
s_cmp_lt_u32 s50,2
s_cselect_b32 s42,1,0
s_cmp_ge_u32 s78,64
s_cselect_b32 s42,1,s42
v_mfma_f32_32x32x16_bf16 v[72:87],v[36:39],v[236:239],v[72:87]
s_or_b32 s42,s42,s37
s_mov_b32 s39,0
s_add_u32 s50,s50,1
s_sub_u32 s57,46080,s57
s_mov_b32 s51,s53
s_mov_b32 s52,s54
v_mfma_f32_32x32x16_bf16 v[56:71],v[40:43],a[144:147],v[56:71]
ds_read_b128 v[28:31],v19 offset:0
v_mfma_f32_32x32x16_bf16 v[72:87],v[40:43],v[240:243],v[72:87]
v_mfma_f32_32x32x16_bf16 v[56:71],v[44:47],a[148:151],v[56:71]
ds_read_b128 v[32:35],v18 offset:2048
s_waitcnt vmcnt(0)
s_mov_b64 exec,1
buffer_store_dword v5,v1,s[8:11],s82 offen sc1
s_mov_b64 exec,-1
s_mov_b32 s82,2147483648
v_mfma_f32_32x32x16_bf16 v[72:87],v[44:47],v[244:247],v[72:87]
s_waitcnt lgkmcnt(3)
v_readfirstlane_b32 s38,v23
s_and_b32 s37,s38,2147483648
s_and_b32 s33,s38,1
s_cselect_b32 s34,s79,s78
s_cmp_lg_u32 s42,0
v_mfma_f32_32x32x16_bf16 v[56:71],v[48:51],a[152:155],v[56:71]
ds_read_b128 v[36:39],v19 offset:2048
v_mfma_f32_32x32x16_bf16 v[72:87],v[48:51],v[248:251],v[72:87]
v_mfma_f32_32x32x16_bf16 v[56:71],v[52:55],a[156:159],v[56:71]
ds_read_b128 v[40:43],v18 offset:4096
v_mfma_f32_32x32x16_bf16 v[72:87],v[52:55],v[252:255],v[72:87]
s_cbranch_scc1 QKVV_S0
QKVV_B1:
s_waitcnt lgkmcnt(3)
v_mfma_f32_32x32x16_bf16 v[88:103],v[24:27],a[0:3],0
ds_read_b128 v[44:47],v19 offset:4096
v_add_u32 v189,s57,v188
v_mfma_f32_32x32x16_bf16 v[104:119],v[24:27],a[160:163],0
v_add_u32 v8,0x800,v189
s_sub_u32 s66,46080,s57
s_lshl_b32 s60,s33,6
s_add_u32 s60,s60,s34
s_mul_i32 s60,s60,46080
s_add_u32 s60,s60,s37
v_mfma_f32_32x32x16_bf16 v[88:103],v[28:31],a[4:7],v[88:103]
ds_read_b128 v[48:51],v18 offset:6144
ds_read2_b64 v[156:159],v189 offset0:0 offset1:32
s_add_u32 s60,s60,206569472
s_lshl_b32 s62,s46,10
v_mfma_f32_32x32x16_bf16 v[104:119],v[28:31],a[164:167],v[104:119]
ds_read2_b64 v[160:163],v189 offset0:64 offset1:96
s_add_u32 s62,s62,40960
s_add_u32 m0,s66,s62
s_add_u32 s63,s60,s62
s_waitcnt lgkmcnt(5)
v_mfma_f32_32x32x16_bf16 v[88:103],v[32:35],a[8:11],v[88:103]
ds_read_b128 v[52:55],v19 offset:6144
ds_read2_b64 v[164:167],v189 offset0:128 offset1:160
buffer_load_dwordx4 v1,s[8:11],s63 offen sc1 lds
v_mfma_f32_32x32x16_bf16 v[104:119],v[32:35],a[168:171],v[104:119]
ds_read2_b64 v[168:171],v189 offset0:192 offset1:224
s_add_u32 m0,s66,45056
s_add_u32 s63,s60,45056
s_mul_i32 s74,s73,393216
s_add_u32 s74,s74,s39
v_mfma_f32_32x32x16_bf16 v[88:103],v[36:39],a[12:15],v[88:103]
ds_read_b128 v[24:27],v18 offset:8192
ds_read2_b64 v[172:175],v8 offset0:0 offset1:32
s_add_u32 s74,s74,s70
v_fma_f32 v56,-v124,v120,v56
v_mfma_f32_32x32x16_bf16 v[104:119],v[36:39],a[172:175],v[104:119]
buffer_load_dwordx4 v1,s[8:11],s63 offen sc1 lds
s_mul_i32 s61,s46,10240
s_add_u32 s60,s60,s61
s_add_u32 s61,s61,s66
s_waitcnt lgkmcnt(8)
v_mfma_f32_32x32x16_bf16 v[88:103],v[40:43],a[16:19],v[88:103]
ds_read_b128 v[28:31],v19 offset:8192
s_add_u32 m0,s61,0
s_add_u32 s63,s60,0
v_fma_f32 v57,-v126,v120,v57
v_fma_f32 v58,-v128,v120,v58
v_mfma_f32_32x32x16_bf16 v[104:119],v[40:43],a[176:179],v[104:119]
v_fma_f32 v59,-v130,v120,v59
v_fma_f32 v64,-v140,v120,v64
v_fma_f32 v65,-v142,v120,v65
v_fma_f32 v66,-v144,v120,v66
v_fma_f32 v67,-v146,v120,v67
v_mfma_f32_32x32x16_bf16 v[88:103],v[44:47],a[20:23],v[88:103]
ds_read_b128 v[32:35],v18 offset:10240
buffer_load_dwordx4 v1,s[8:11],s63 offen sc1 lds
s_mov_b32 s53,s33
s_mov_b32 s54,s34
v_mfma_f32_32x32x16_bf16 v[104:119],v[44:47],a[180:183],v[104:119]
s_add_u32 s79,s79,s33
s_or_b32 s65,s37,s33
s_cmp_eq_u32 s65,0
s_addc_u32 s78,s78,0
s_lshl_b32 s41,s78,9
s_waitcnt lgkmcnt(6)
v_mfma_f32_32x32x16_bf16 v[88:103],v[48:51],a[24:27],v[88:103]
ds_read_b128 v[36:39],v19 offset:10240
s_add_u32 s41,s41,s40
s_lshl_b32 s35,s79,9
s_add_u32 s35,s35,s40
s_add_u32 s35,s35,32768
v_mfma_f32_32x32x16_bf16 v[104:119],v[48:51],a[184:187],v[104:119]
buffer_load_dwordx4 v1,s[8:11],s63 offen offset:1024 sc1 lds
v_mul_f32 v56,v56,v125
v_mul_f32 v57,v57,v127
v_mul_f32 v58,v58,v129
v_mul_f32 v59,v59,v131
v_mfma_f32_32x32x16_bf16 v[88:103],v[52:55],a[28:31],v[88:103]
ds_read_b128 v[40:43],v18 offset:12288
v_mul_f32 v64,v64,v141
v_mul_f32 v65,v65,v143
v_mul_f32 v66,v66,v145
v_mul_f32 v67,v67,v147
v_mfma_f32_32x32x16_bf16 v[104:119],v[52:55],a[188:191],v[104:119]
v_cvt_pk_bf16_f32 v56,v56,v57
v_cvt_pk_bf16_f32 v57,v58,v59
v_cvt_pk_bf16_f32 v58,v64,v65
v_cvt_pk_bf16_f32 v59,v66,v67
v_fma_f32 v60,-v132,v120,v60
s_waitcnt lgkmcnt(3)
v_mfma_f32_32x32x16_bf16 v[88:103],v[24:27],a[32:35],v[88:103]
ds_read_b128 v[44:47],v19 offset:12288
buffer_load_dwordx4 v1,s[8:11],s63 offen offset:2048 sc1 lds
v_fma_f32 v61,-v134,v120,v61
v_fma_f32 v62,-v136,v120,v62
v_mfma_f32_32x32x16_bf16 v[104:119],v[24:27],a[192:195],v[104:119]
v_fma_f32 v63,-v138,v120,v63
v_fma_f32 v68,-v148,v120,v68
v_fma_f32 v69,-v150,v120,v69
v_fma_f32 v70,-v152,v120,v70
v_fma_f32 v71,-v154,v120,v71
v_mfma_f32_32x32x16_bf16 v[88:103],v[28:31],a[36:39],v[88:103]
ds_read_b128 v[48:51],v18 offset:14336
v_mul_f32 v60,v60,v133
v_mul_f32 v61,v61,v135
v_mul_f32 v62,v62,v137
v_mul_f32 v63,v63,v139
v_mfma_f32_32x32x16_bf16 v[104:119],v[28:31],a[196:199],v[104:119]
buffer_load_dwordx4 v1,s[8:11],s63 offen offset:3072 sc1 lds
s_add_u32 m0,s61,4096
s_add_u32 s63,s60,4096
v_mul_f32 v68,v68,v149
s_waitcnt lgkmcnt(3)
v_mfma_f32_32x32x16_bf16 v[88:103],v[32:35],a[40:43],v[88:103]
ds_read_b128 v[52:55],v19 offset:14336
v_mul_f32 v69,v69,v151
v_mul_f32 v70,v70,v153
v_mul_f32 v71,v71,v155
v_cvt_pk_bf16_f32 v60,v60,v61
v_mfma_f32_32x32x16_bf16 v[104:119],v[32:35],a[200:203],v[104:119]
v_cvt_pk_bf16_f32 v61,v62,v63
v_cvt_pk_bf16_f32 v62,v68,v69
v_cvt_pk_bf16_f32 v63,v70,v71
v_fma_f32 v72,-v124,v121,v72
v_fma_f32 v73,-v126,v121,v73
v_mfma_f32_32x32x16_bf16 v[88:103],v[36:39],a[44:47],v[88:103]
ds_read_b128 v[24:27],v18 offset:16384
buffer_load_dwordx4 v1,s[8:11],s63 offen sc1 lds
v_fma_f32 v74,-v128,v121,v74
v_fma_f32 v75,-v130,v121,v75
v_mfma_f32_32x32x16_bf16 v[104:119],v[36:39],a[204:207],v[104:119]
v_fma_f32 v80,-v140,v121,v80
v_fma_f32 v81,-v142,v121,v81
v_fma_f32 v82,-v144,v121,v82
v_fma_f32 v83,-v146,v121,v83
v_mul_f32 v72,v72,v125
s_waitcnt lgkmcnt(3)
v_mfma_f32_32x32x16_bf16 v[88:103],v[40:43],a[48:51],v[88:103]
ds_read_b128 v[28:31],v19 offset:16384
v_mul_f32 v73,v73,v127
v_mul_f32 v74,v74,v129
v_mul_f32 v75,v75,v131
v_mul_f32 v80,v80,v141
v_mfma_f32_32x32x16_bf16 v[104:119],v[40:43],a[208:211],v[104:119]
buffer_load_dwordx4 v1,s[8:11],s63 offen offset:1024 sc1 lds
v_mul_f32 v81,v81,v143
v_mul_f32 v82,v82,v145
v_mul_f32 v83,v83,v147
v_cvt_pk_bf16_f32 v72,v72,v73
v_mfma_f32_32x32x16_bf16 v[88:103],v[44:47],a[52:55],v[88:103]
ds_read_b128 v[32:35],v18 offset:18432
v_cvt_pk_bf16_f32 v73,v74,v75
v_cvt_pk_bf16_f32 v74,v80,v81
v_cvt_pk_bf16_f32 v75,v82,v83
v_fma_f32 v76,-v132,v121,v76
v_mfma_f32_32x32x16_bf16 v[104:119],v[44:47],a[212:215],v[104:119]
v_fma_f32 v77,-v134,v121,v77
v_fma_f32 v78,-v136,v121,v78
v_fma_f32 v79,-v138,v121,v79
v_fma_f32 v84,-v148,v121,v84
v_fma_f32 v85,-v150,v121,v85
s_waitcnt lgkmcnt(3)
v_mfma_f32_32x32x16_bf16 v[88:103],v[48:51],a[56:59],v[88:103]
ds_read_b128 v[36:39],v19 offset:18432
buffer_load_dwordx4 v1,s[8:11],s63 offen offset:2048 sc1 lds
v_fma_f32 v86,-v152,v121,v86
v_fma_f32 v87,-v154,v121,v87
v_mfma_f32_32x32x16_bf16 v[104:119],v[48:51],a[216:219],v[104:119]
v_mul_f32 v76,v76,v133
v_mul_f32 v77,v77,v135
v_mul_f32 v78,v78,v137
v_mul_f32 v79,v79,v139
v_mul_f32 v84,v84,v149
v_mfma_f32_32x32x16_bf16 v[88:103],v[52:55],a[60:63],v[88:103]
ds_read_b128 v[40:43],v18 offset:20480
s_waitcnt vmcnt(9)
s_mov_b64 exec,1
buffer_store_dword v5,v1,s[8:11],s59 offen sc1
s_mov_b64 exec,-1
s_mov_b32 s59,2147483648
v_mfma_f32_32x32x16_bf16 v[104:119],v[52:55],a[220:223],v[104:119]
buffer_load_dwordx4 v1,s[8:11],s63 offen offset:3072 sc1 lds
s_add_u32 m0,s61,8192
s_add_u32 s63,s60,8192
v_mul_f32 v85,v85,v151
s_waitcnt lgkmcnt(3)
v_mfma_f32_32x32x16_bf16 v[88:103],v[24:27],a[64:67],v[88:103]
ds_read_b128 v[44:47],v19 offset:20480
v_mul_f32 v86,v86,v153
v_mul_f32 v87,v87,v155
v_cvt_pk_bf16_f32 v76,v76,v77
v_cvt_pk_bf16_f32 v77,v78,v79
v_mfma_f32_32x32x16_bf16 v[104:119],v[24:27],a[224:227],v[104:119]
v_cvt_pk_bf16_f32 v78,v84,v85
v_cvt_pk_bf16_f32 v79,v86,v87
s_lshl_b32 s82,s72,6
s_add_u32 s82,s82,s73
s_lshl_b32 s82,s82,9
s_add_u32 s82,s82,s71
v_mfma_f32_32x32x16_bf16 v[88:103],v[28:31],a[68:71],v[88:103]
ds_read_b128 v[48:51],v18 offset:22528
buffer_load_dwordx4 v1,s[8:11],s63 offen sc1 lds
s_lshl_b32 s75,s69,2
s_add_u32 s82,s82,s75
v_mfma_f32_32x32x16_bf16 v[104:119],v[28:31],a[228:231],v[104:119]
buffer_load_dword v3,v2,s[8:11],s35 offen sc1
buffer_load_dword v14,v4,s[8:11],s41 offen sc1
s_add_u32 s82,s82,s39
s_waitcnt lgkmcnt(3)
v_mfma_f32_32x32x16_bf16 v[88:103],v[32:35],a[72:75],v[88:103]
ds_read_b128 v[52:55],v19 offset:22528
v_add_f32 v156,v156,v166
v_add_f32 v157,v157,v167
v_add_f32 v158,v158,v168
v_mfma_f32_32x32x16_bf16 v[104:119],v[32:35],a[232:235],v[104:119]
buffer_load_dwordx4 v1,s[8:11],s63 offen offset:1024 sc1 lds
v_add_f32 v159,v159,v169
v_add_f32 v160,v160,v170
v_add_f32 v161,v161,v171
v_add_f32 v162,v162,v172
v_mfma_f32_32x32x16_bf16 v[88:103],v[36:39],a[76:79],v[88:103]
ds_read_b128 v[24:27],v18 offset:24576
v_add_f32 v163,v163,v173
v_add_f32 v164,v164,v174
v_add_f32 v165,v165,v175
v_add_f32 v156,v156,v158
v_mfma_f32_32x32x16_bf16 v[104:119],v[36:39],a[236:239],v[104:119]
v_add_f32 v157,v157,v159
v_add_f32 v160,v160,v162
v_add_f32 v161,v161,v163
v_add_f32 v156,v156,v160
v_add_f32 v157,v157,v161
s_waitcnt lgkmcnt(3)
v_mfma_f32_32x32x16_bf16 v[88:103],v[40:43],a[80:83],v[88:103]
ds_read_b128 v[28:31],v19 offset:24576
buffer_store_dwordx4 v[56:59],v20,s[8:11],s74 offen sc1
v_add_f32 v156,v156,v164
v_add_f32 v157,v157,v165
v_mfma_f32_32x32x16_bf16 v[104:119],v[40:43],a[240:243],v[104:119]
v_mov_b32 v158,v156
v_mov_b32 v159,v157
s_nop 0
v_permlane32_swap_b32 v156,v158
v_permlane32_swap_b32 v157,v159
v_add_f32 v176,v156,v158
v_mfma_f32_32x32x16_bf16 v[88:103],v[44:47],a[84:87],v[88:103]
ds_read_b128 v[32:35],v18 offset:26624
buffer_store_dwordx4 v[60:63],v21,s[8:11],s74 offen sc1
v_add_f32 v177,v157,v159
v_mul_f32 v176,0x3acccccd,v176
v_mfma_f32_32x32x16_bf16 v[104:119],v[44:47],a[244:247],v[104:119]
v_mul_f32 v177,0x3acccccd,v177
v_fma_f32 v177,-v176,v176,v177
v_max_f32 v177,0,v177
v_cvt_pk_bf16_f32 v8,v176,v177
v_lshlrev_b32 v176,16,v8
s_waitcnt lgkmcnt(3)
v_mfma_f32_32x32x16_bf16 v[88:103],v[48:51],a[88:91],v[88:103]
ds_read_b128 v[36:39],v19 offset:26624
buffer_store_dwordx4 v[72:75],v20,s[8:11],s74 offen offset:2048 sc1
v_and_b32 v177,0xffff0000,v8
v_add_f32 v177,0x3727c5ac,v177
v_mfma_f32_32x32x16_bf16 v[104:119],v[48:51],a[248:251],v[104:119]
v_cvt_pk_bf16_f32 v8,v177,v177
v_lshlrev_b32 v177,16,v8
v_sqrt_f32 v177,v177
s_nop 0
v_cvt_pk_bf16_f32 v8,v177,v177
v_lshlrev_b32 v177,16,v8
v_mfma_f32_32x32x16_bf16 v[88:103],v[52:55],a[92:95],v[88:103]
ds_read_b128 v[40:43],v18 offset:28672
buffer_store_dwordx4 v[76:79],v21,s[8:11],s74 offen offset:2048 sc1
v_rcp_f32 v177,v177
v_mfma_f32_32x32x16_bf16 v[104:119],v[52:55],a[252:255],v[104:119]
s_cmp_eq_u32 s51,0
s_cselect_b64 s[76:77],-1,0
v_cndmask_b32 v176,v176,0,s[76:77]
v_cndmask_b32 v177,v177,1.0,s[76:77]
s_mov_b32 s72,s51
s_waitcnt lgkmcnt(3)
v_mfma_f32_32x32x16_bf16 v[88:103],v[24:27],a[96:99],v[88:103]
ds_read_b128 v[44:47],v19 offset:28672
s_mov_b32 s73,s52
ds_write_b64 v190,v[176:177]
v_mfma_f32_32x32x16_bf16 v[104:119],v[24:27],v[192:195],v[104:119]
ds_read_b128 v[124:127],v191 offset:0
ds_read_b128 v[128:131],v191 offset:16
ds_read_b128 v[132:135],v191 offset:64
v_mfma_f32_32x32x16_bf16 v[88:103],v[28:31],a[100:103],v[88:103]
ds_read_b128 v[48:51],v18 offset:30720
ds_read_b128 v[136:139],v191 offset:80
ds_read_b128 v[140:143],v191 offset:128
v_mfma_f32_32x32x16_bf16 v[104:119],v[28:31],v[196:199],v[104:119]
ds_read_b128 v[144:147],v191 offset:144
ds_read_b128 v[148:151],v191 offset:192
s_waitcnt lgkmcnt(11)
v_mfma_f32_32x32x16_bf16 v[88:103],v[32:35],a[104:107],v[88:103]
ds_read_b128 v[52:55],v19 offset:30720
ds_read_b128 v[152:155],v191 offset:208
v_mfma_f32_32x32x16_bf16 v[104:119],v[32:35],v[200:203],v[104:119]
v_mfma_f32_32x32x16_bf16 v[88:103],v[36:39],a[108:111],v[88:103]
ds_read_b128 v[24:27],v18 offset:32768
v_mfma_f32_32x32x16_bf16 v[104:119],v[36:39],v[204:207],v[104:119]
s_waitcnt lgkmcnt(12)
v_mfma_f32_32x32x16_bf16 v[88:103],v[40:43],a[112:115],v[88:103]
ds_read_b128 v[28:31],v19 offset:32768
v_mfma_f32_32x32x16_bf16 v[104:119],v[40:43],v[208:211],v[104:119]
v_mfma_f32_32x32x16_bf16 v[88:103],v[44:47],a[116:119],v[88:103]
ds_read_b128 v[32:35],v18 offset:34816
v_mfma_f32_32x32x16_bf16 v[104:119],v[44:47],v[212:215],v[104:119]
s_waitcnt lgkmcnt(4)
v_mfma_f32_32x32x16_bf16 v[88:103],v[48:51],a[120:123],v[88:103]
ds_read_b128 v[36:39],v19 offset:34816
v_mfma_f32_32x32x16_bf16 v[104:119],v[48:51],v[216:219],v[104:119]
v_mfma_f32_32x32x16_bf16 v[88:103],v[52:55],a[124:127],v[88:103]
ds_read_b128 v[40:43],v18 offset:36864
v_mfma_f32_32x32x16_bf16 v[104:119],v[52:55],v[220:223],v[104:119]
s_waitcnt lgkmcnt(3)
v_mfma_f32_32x32x16_bf16 v[88:103],v[24:27],a[128:131],v[88:103]
ds_read_b128 v[44:47],v19 offset:36864
s_waitcnt vmcnt(4)
v_cmp_eq_u32 vcc,0,v14
s_cmp_eq_u64 vcc,0
s_cselect_b32 s36,0,2147483648
v_mfma_f32_32x32x16_bf16 v[104:119],v[24:27],v[224:227],v[104:119]
v_cmp_eq_u32 vcc,0,v3
s_cmp_lt_u32 s78,64
s_cselect_b32 s36,s36,2147483648
s_cmp_eq_u64 vcc,0
s_cselect_b32 s60,1,s36
v_mfma_f32_32x32x16_bf16 v[88:103],v[28:31],a[132:135],v[88:103]
ds_read_b128 v[48:51],v18 offset:38912
s_cmp_lt_u32 s79,64
s_cselect_b32 s60,s60,s36
s_sub_u32 s61,s78,s79
s_or_b32 s61,s61,s36
v_mfma_f32_32x32x16_bf16 v[104:119],v[28:31],v[228:231],v[104:119]
s_cmp_lt_u32 s61,16
s_cselect_b32 s36,0,s60
v_mov_b32 v23,s36
s_waitcnt lgkmcnt(3)
v_mfma_f32_32x32x16_bf16 v[88:103],v[32:35],a[136:139],v[88:103]
ds_read_b128 v[52:55],v19 offset:38912
ds_write_b32 v13,v23
v_mfma_f32_32x32x16_bf16 v[104:119],v[32:35],v[232:235],v[104:119]
s_waitcnt lgkmcnt(0)
s_barrier
ds_read_b32 v23,v22
v_mfma_f32_32x32x16_bf16 v[88:103],v[36:39],a[140:143],v[88:103]
ds_read_b128 v[24:27],v16 offset:0
s_cmp_lt_u32 s50,2
s_cselect_b32 s42,1,0
s_cmp_ge_u32 s78,64
s_cselect_b32 s42,1,s42
v_mfma_f32_32x32x16_bf16 v[104:119],v[36:39],v[236:239],v[104:119]
s_or_b32 s42,s42,s37
s_mov_b32 s39,0
s_add_u32 s50,s50,1
s_sub_u32 s57,46080,s57
s_mov_b32 s51,s53
s_mov_b32 s52,s54
v_mfma_f32_32x32x16_bf16 v[88:103],v[40:43],a[144:147],v[88:103]
ds_read_b128 v[28:31],v17 offset:0
v_mfma_f32_32x32x16_bf16 v[104:119],v[40:43],v[240:243],v[104:119]
v_mfma_f32_32x32x16_bf16 v[88:103],v[44:47],a[148:151],v[88:103]
ds_read_b128 v[32:35],v16 offset:2048
s_waitcnt vmcnt(0)
s_mov_b64 exec,1
buffer_store_dword v5,v1,s[8:11],s82 offen sc1
s_mov_b64 exec,-1
s_mov_b32 s82,2147483648
v_mfma_f32_32x32x16_bf16 v[104:119],v[44:47],v[244:247],v[104:119]
s_waitcnt lgkmcnt(3)
v_readfirstlane_b32 s38,v23
s_and_b32 s37,s38,2147483648
s_and_b32 s33,s38,1
s_cselect_b32 s34,s79,s78
s_cmp_lg_u32 s42,0
v_mfma_f32_32x32x16_bf16 v[88:103],v[48:51],a[152:155],v[88:103]
ds_read_b128 v[36:39],v17 offset:2048
v_mfma_f32_32x32x16_bf16 v[104:119],v[48:51],v[248:251],v[104:119]
v_mfma_f32_32x32x16_bf16 v[88:103],v[52:55],a[156:159],v[88:103]
ds_read_b128 v[40:43],v16 offset:4096
v_mfma_f32_32x32x16_bf16 v[104:119],v[52:55],v[252:255],v[104:119]
s_cbranch_scc0 QKVV_B0
s_branch QKVV_S1
s_nop 9
QKVV_S0:
s_mov_b32 s55,0
s_cmp_lt_u32 s42,2
s_cbranch_scc1 nt_219
s_mov_b32 s55,2
s_cmp_lg_u32 s37,0
s_cbranch_scc1 nt_219
s_mov_b32 s55,1
s_lshl_b32 s60,s33,6
s_add_u32 s60,s60,s34
s_mul_i32 s60,s60,46080
s_add_u32 s60,s60,206569472
s_lshl_b32 s62,s46,10
s_add_u32 s62,s62,40960
s_add_u32 m0,s57,s62
s_add_u32 s63,s60,s62
buffer_load_dwordx4 v1,s[8:11],s63 offen sc1 lds
s_add_u32 m0,s57,45056
s_add_u32 s63,s60,45056
buffer_load_dwordx4 v1,s[8:11],s63 offen sc1 lds
s_mul_i32 s61,s46,10240
s_add_u32 s60,s60,s61
s_add_u32 s61,s61,s57
s_add_u32 m0,s61,0
s_add_u32 s63,s60,0
buffer_load_dwordx4 v1,s[8:11],s63 offen sc1 lds
buffer_load_dwordx4 v1,s[8:11],s63 offen offset:1024 sc1 lds
buffer_load_dwordx4 v1,s[8:11],s63 offen offset:2048 sc1 lds
buffer_load_dwordx4 v1,s[8:11],s63 offen offset:3072 sc1 lds
s_add_u32 m0,s61,4096
s_add_u32 s63,s60,4096
buffer_load_dwordx4 v1,s[8:11],s63 offen sc1 lds
buffer_load_dwordx4 v1,s[8:11],s63 offen offset:1024 sc1 lds
buffer_load_dwordx4 v1,s[8:11],s63 offen offset:2048 sc1 lds
buffer_load_dwordx4 v1,s[8:11],s63 offen offset:3072 sc1 lds
s_add_u32 m0,s61,8192
s_add_u32 s63,s60,8192
buffer_load_dwordx4 v1,s[8:11],s63 offen sc1 lds
buffer_load_dwordx4 v1,s[8:11],s63 offen offset:1024 sc1 lds
nt_219:
s_nop 4
s_mul_i32 s74,s73,393216
s_add_u32 s74,s74,s39
s_add_u32 s74,s74,s70
v_fma_f32 v56,-v124,v120,v56
v_fma_f32 v57,-v126,v120,v57
v_fma_f32 v58,-v128,v120,v58
v_fma_f32 v59,-v130,v120,v59
v_fma_f32 v64,-v140,v120,v64
v_fma_f32 v65,-v142,v120,v65
v_fma_f32 v66,-v144,v120,v66
v_fma_f32 v67,-v146,v120,v67
v_mul_f32 v56,v56,v125
v_mul_f32 v57,v57,v127
v_mul_f32 v58,v58,v129
v_mul_f32 v59,v59,v131
v_mul_f32 v64,v64,v141
v_mul_f32 v65,v65,v143
v_mul_f32 v66,v66,v145
v_mul_f32 v67,v67,v147
v_cvt_pk_bf16_f32 v56,v56,v57
v_cvt_pk_bf16_f32 v57,v58,v59
v_cvt_pk_bf16_f32 v58,v64,v65
v_cvt_pk_bf16_f32 v59,v66,v67
buffer_store_dwordx4 v[56:59],v20,s[8:11],s74 offen sc1
v_fma_f32 v60,-v132,v120,v60
v_fma_f32 v61,-v134,v120,v61
v_fma_f32 v62,-v136,v120,v62
v_fma_f32 v63,-v138,v120,v63
v_fma_f32 v68,-v148,v120,v68
v_fma_f32 v69,-v150,v120,v69
v_fma_f32 v70,-v152,v120,v70
v_fma_f32 v71,-v154,v120,v71
v_mul_f32 v60,v60,v133
v_mul_f32 v61,v61,v135
v_mul_f32 v62,v62,v137
v_mul_f32 v63,v63,v139
v_mul_f32 v68,v68,v149
v_mul_f32 v69,v69,v151
v_mul_f32 v70,v70,v153
v_mul_f32 v71,v71,v155
v_cvt_pk_bf16_f32 v60,v60,v61
v_cvt_pk_bf16_f32 v61,v62,v63
v_cvt_pk_bf16_f32 v62,v68,v69
v_cvt_pk_bf16_f32 v63,v70,v71
buffer_store_dwordx4 v[60:63],v21,s[8:11],s74 offen sc1
v_fma_f32 v72,-v124,v121,v72
v_fma_f32 v73,-v126,v121,v73
v_fma_f32 v74,-v128,v121,v74
v_fma_f32 v75,-v130,v121,v75
v_fma_f32 v80,-v140,v121,v80
v_fma_f32 v81,-v142,v121,v81
v_fma_f32 v82,-v144,v121,v82
v_fma_f32 v83,-v146,v121,v83
v_mul_f32 v72,v72,v125
v_mul_f32 v73,v73,v127
v_mul_f32 v74,v74,v129
v_mul_f32 v75,v75,v131
v_mul_f32 v80,v80,v141
v_mul_f32 v81,v81,v143
v_mul_f32 v82,v82,v145
v_mul_f32 v83,v83,v147
v_cvt_pk_bf16_f32 v72,v72,v73
v_cvt_pk_bf16_f32 v73,v74,v75
v_cvt_pk_bf16_f32 v74,v80,v81
v_cvt_pk_bf16_f32 v75,v82,v83
buffer_store_dwordx4 v[72:75],v20,s[8:11],s74 offen offset:2048 sc1
v_fma_f32 v76,-v132,v121,v76
v_fma_f32 v77,-v134,v121,v77
v_fma_f32 v78,-v136,v121,v78
v_fma_f32 v79,-v138,v121,v79
v_fma_f32 v84,-v148,v121,v84
v_fma_f32 v85,-v150,v121,v85
v_fma_f32 v86,-v152,v121,v86
v_fma_f32 v87,-v154,v121,v87
v_mul_f32 v76,v76,v133
v_mul_f32 v77,v77,v135
v_mul_f32 v78,v78,v137
v_mul_f32 v79,v79,v139
v_mul_f32 v84,v84,v149
v_mul_f32 v85,v85,v151
v_mul_f32 v86,v86,v153
v_mul_f32 v87,v87,v155
v_cvt_pk_bf16_f32 v76,v76,v77
v_cvt_pk_bf16_f32 v77,v78,v79
v_cvt_pk_bf16_f32 v78,v84,v85
v_cvt_pk_bf16_f32 v79,v86,v87
buffer_store_dwordx4 v[76:79],v21,s[8:11],s74 offen offset:2048 sc1
s_lshl_b32 s82,s72,6
s_add_u32 s82,s82,s73
s_lshl_b32 s82,s82,9
s_add_u32 s82,s82,s71
s_lshl_b32 s75,s69,2
s_add_u32 s82,s82,s75
s_add_u32 s82,s82,s39
s_mov_b32 s59,s82
s_mov_b32 s82,2147483648
s_mov_b32 s39,2147483648
s_cmp_eq_u32 s55,0
s_cbranch_scc1 QKVV_B1
s_cmp_eq_u32 s55,1
s_cbranch_scc1 QKVV_CD1
s_waitcnt vmcnt(0)
s_mov_b64 exec,1
buffer_store_dword v5,v1,s[8:11],s59 offen sc1
s_mov_b64 exec,-1
s_mov_b32 s59,2147483648
s_cmp_eq_u32 s50,128
s_cbranch_scc1 QKVV_END
s_branch QKVV_COLD1
QKVV_COLD0:
s_cmp_lg_u32 s46,0
s_cbranch_scc1 cp_220
ct_221:
buffer_load_dword v3,v2,s[8:11],s35 offen sc1
buffer_load_dword v14,v4,s[8:11],s41 offen sc1
s_waitcnt vmcnt(0)
v_cmp_eq_u32 vcc,0,v14
s_cmp_eq_u64 vcc,0
s_cselect_b32 s36,0,2147483648
v_cmp_eq_u32 vcc,0,v3
s_cmp_lt_u32 s78,64
s_cselect_b32 s36,s36,2147483648
s_cmp_eq_u64 vcc,0
s_cselect_b32 s60,1,s36
s_cmp_lt_u32 s79,64
s_cselect_b32 s60,s60,s36
s_sub_u32 s61,s78,s79
s_or_b32 s61,s61,s36
s_cmp_lt_u32 s61,16
s_cselect_b32 s36,0,s60
v_mov_b32 v23,s36
s_cmp_lt_u32 s36,2
s_cbranch_scc1 ct_221x
s_sleep 3
s_sub_u32 s47,s47,1
s_cbranch_scc1 ABORT
s_branch ct_221
ct_221x:
ds_write_b32 v22,v23 offset:4
s_waitcnt lgkmcnt(0)
cp_220:
s_barrier
ds_read_b32 v23,v22 offset:4
s_waitcnt lgkmcnt(0)
v_readfirstlane_b32 s38,v23
s_and_b32 s38,s38,1
s_and_b32 s37,s38,2147483648
s_and_b32 s33,s38,1
s_cselect_b32 s34,s79,s78
s_lshl_b32 s60,s33,6
s_add_u32 s60,s60,s34
s_mul_i32 s60,s60,46080
s_add_u32 s60,s60,206569472
s_lshl_b32 s62,s46,10
s_add_u32 s62,s62,40960
s_add_u32 m0,s57,s62
s_add_u32 s63,s60,s62
buffer_load_dwordx4 v1,s[8:11],s63 offen sc1 lds
s_add_u32 m0,s57,45056
s_add_u32 s63,s60,45056
buffer_load_dwordx4 v1,s[8:11],s63 offen sc1 lds
s_mul_i32 s61,s46,10240
s_add_u32 s60,s60,s61
s_add_u32 s61,s61,s57
s_add_u32 m0,s61,0
s_add_u32 s63,s60,0
buffer_load_dwordx4 v1,s[8:11],s63 offen sc1 lds
buffer_load_dwordx4 v1,s[8:11],s63 offen offset:1024 sc1 lds
buffer_load_dwordx4 v1,s[8:11],s63 offen offset:2048 sc1 lds
buffer_load_dwordx4 v1,s[8:11],s63 offen offset:3072 sc1 lds
s_add_u32 m0,s61,4096
s_add_u32 s63,s60,4096
buffer_load_dwordx4 v1,s[8:11],s63 offen sc1 lds
buffer_load_dwordx4 v1,s[8:11],s63 offen offset:1024 sc1 lds
buffer_load_dwordx4 v1,s[8:11],s63 offen offset:2048 sc1 lds
buffer_load_dwordx4 v1,s[8:11],s63 offen offset:3072 sc1 lds
s_add_u32 m0,s61,8192
s_add_u32 s63,s60,8192
buffer_load_dwordx4 v1,s[8:11],s63 offen sc1 lds
buffer_load_dwordx4 v1,s[8:11],s63 offen offset:1024 sc1 lds
QKVV_CD0:
s_mov_b32 s51,s33
s_mov_b32 s52,s34
s_mov_b32 s53,s33
s_mov_b32 s54,s34
s_add_u32 s79,s79,s33
s_or_b32 s60,s37,s33
s_cmp_eq_u32 s60,0
s_addc_u32 s78,s78,0
s_lshl_b32 s41,s78,9
s_add_u32 s41,s41,s40
s_lshl_b32 s35,s79,9
s_add_u32 s35,s35,s40
s_add_u32 s35,s35,32768
buffer_load_dword v3,v2,s[8:11],s35 offen sc1
buffer_load_dword v14,v4,s[8:11],s41 offen sc1
s_waitcnt vmcnt(0)
s_mov_b64 exec,1
buffer_store_dword v5,v1,s[8:11],s59 offen sc1
s_mov_b64 exec,-1
s_mov_b32 s59,2147483648
v_cmp_eq_u32 vcc,0,v14
s_cmp_eq_u64 vcc,0
s_cselect_b32 s36,0,2147483648
v_cmp_eq_u32 vcc,0,v3
s_cmp_lt_u32 s78,64
s_cselect_b32 s36,s36,2147483648
s_cmp_eq_u64 vcc,0
s_cselect_b32 s60,1,s36
s_cmp_lt_u32 s79,64
s_cselect_b32 s60,s60,s36
s_sub_u32 s61,s78,s79
s_or_b32 s61,s61,s36
s_cmp_lt_u32 s61,16
s_cselect_b32 s36,0,s60
v_mov_b32 v23,s36
ds_write_b32 v13,v23
s_waitcnt lgkmcnt(0)
s_barrier
ds_read_b32 v23,v22
ds_read_b128 v[24:27],v16 offset:0
ds_read_b128 v[28:31],v17 offset:0
ds_read_b128 v[32:35],v16 offset:2048
ds_read_b128 v[36:39],v17 offset:2048
ds_read_b128 v[40:43],v16 offset:4096
s_waitcnt lgkmcnt(5)
v_readfirstlane_b32 s38,v23
s_and_b32 s37,s38,2147483648
s_and_b32 s33,s38,1
s_cselect_b32 s34,s79,s78
s_nop 0
s_branch QKVV_B0
QKVV_S1:
s_mov_b32 s55,0
s_cmp_lt_u32 s42,2
s_cbranch_scc1 nt_222
s_mov_b32 s55,2
s_cmp_lg_u32 s37,0
s_cbranch_scc1 nt_222
s_mov_b32 s55,1
s_lshl_b32 s60,s33,6
s_add_u32 s60,s60,s34
s_mul_i32 s60,s60,46080
s_add_u32 s60,s60,206569472
s_lshl_b32 s62,s46,10
s_add_u32 s62,s62,40960
s_add_u32 m0,s57,s62
s_add_u32 s63,s60,s62
buffer_load_dwordx4 v1,s[8:11],s63 offen sc1 lds
s_add_u32 m0,s57,45056
s_add_u32 s63,s60,45056
buffer_load_dwordx4 v1,s[8:11],s63 offen sc1 lds
s_mul_i32 s61,s46,10240
s_add_u32 s60,s60,s61
s_add_u32 s61,s61,s57
s_add_u32 m0,s61,0
s_add_u32 s63,s60,0
buffer_load_dwordx4 v1,s[8:11],s63 offen sc1 lds
buffer_load_dwordx4 v1,s[8:11],s63 offen offset:1024 sc1 lds
buffer_load_dwordx4 v1,s[8:11],s63 offen offset:2048 sc1 lds
buffer_load_dwordx4 v1,s[8:11],s63 offen offset:3072 sc1 lds
s_add_u32 m0,s61,4096
s_add_u32 s63,s60,4096
buffer_load_dwordx4 v1,s[8:11],s63 offen sc1 lds
buffer_load_dwordx4 v1,s[8:11],s63 offen offset:1024 sc1 lds
buffer_load_dwordx4 v1,s[8:11],s63 offen offset:2048 sc1 lds
buffer_load_dwordx4 v1,s[8:11],s63 offen offset:3072 sc1 lds
s_add_u32 m0,s61,8192
s_add_u32 s63,s60,8192
buffer_load_dwordx4 v1,s[8:11],s63 offen sc1 lds
buffer_load_dwordx4 v1,s[8:11],s63 offen offset:1024 sc1 lds
nt_222:
s_nop 4
s_mul_i32 s74,s73,393216
s_add_u32 s74,s74,s39
s_add_u32 s74,s74,s70
v_fma_f32 v88,-v124,v120,v88
v_fma_f32 v89,-v126,v120,v89
v_fma_f32 v90,-v128,v120,v90
v_fma_f32 v91,-v130,v120,v91
v_fma_f32 v96,-v140,v120,v96
v_fma_f32 v97,-v142,v120,v97
v_fma_f32 v98,-v144,v120,v98
v_fma_f32 v99,-v146,v120,v99
v_mul_f32 v88,v88,v125
v_mul_f32 v89,v89,v127
v_mul_f32 v90,v90,v129
v_mul_f32 v91,v91,v131
v_mul_f32 v96,v96,v141
v_mul_f32 v97,v97,v143
v_mul_f32 v98,v98,v145
v_mul_f32 v99,v99,v147
v_cvt_pk_bf16_f32 v88,v88,v89
v_cvt_pk_bf16_f32 v89,v90,v91
v_cvt_pk_bf16_f32 v90,v96,v97
v_cvt_pk_bf16_f32 v91,v98,v99
buffer_store_dwordx4 v[88:91],v20,s[8:11],s74 offen sc1
v_fma_f32 v92,-v132,v120,v92
v_fma_f32 v93,-v134,v120,v93
v_fma_f32 v94,-v136,v120,v94
v_fma_f32 v95,-v138,v120,v95
v_fma_f32 v100,-v148,v120,v100
v_fma_f32 v101,-v150,v120,v101
v_fma_f32 v102,-v152,v120,v102
v_fma_f32 v103,-v154,v120,v103
v_mul_f32 v92,v92,v133
v_mul_f32 v93,v93,v135
v_mul_f32 v94,v94,v137
v_mul_f32 v95,v95,v139
v_mul_f32 v100,v100,v149
v_mul_f32 v101,v101,v151
v_mul_f32 v102,v102,v153
v_mul_f32 v103,v103,v155
v_cvt_pk_bf16_f32 v92,v92,v93
v_cvt_pk_bf16_f32 v93,v94,v95
v_cvt_pk_bf16_f32 v94,v100,v101
v_cvt_pk_bf16_f32 v95,v102,v103
buffer_store_dwordx4 v[92:95],v21,s[8:11],s74 offen sc1
v_fma_f32 v104,-v124,v121,v104
v_fma_f32 v105,-v126,v121,v105
v_fma_f32 v106,-v128,v121,v106
v_fma_f32 v107,-v130,v121,v107
v_fma_f32 v112,-v140,v121,v112
v_fma_f32 v113,-v142,v121,v113
v_fma_f32 v114,-v144,v121,v114
v_fma_f32 v115,-v146,v121,v115
v_mul_f32 v104,v104,v125
v_mul_f32 v105,v105,v127
v_mul_f32 v106,v106,v129
v_mul_f32 v107,v107,v131
v_mul_f32 v112,v112,v141
v_mul_f32 v113,v113,v143
v_mul_f32 v114,v114,v145
v_mul_f32 v115,v115,v147
v_cvt_pk_bf16_f32 v104,v104,v105
v_cvt_pk_bf16_f32 v105,v106,v107
v_cvt_pk_bf16_f32 v106,v112,v113
v_cvt_pk_bf16_f32 v107,v114,v115
buffer_store_dwordx4 v[104:107],v20,s[8:11],s74 offen offset:2048 sc1
v_fma_f32 v108,-v132,v121,v108
v_fma_f32 v109,-v134,v121,v109
v_fma_f32 v110,-v136,v121,v110
v_fma_f32 v111,-v138,v121,v111
v_fma_f32 v116,-v148,v121,v116
v_fma_f32 v117,-v150,v121,v117
v_fma_f32 v118,-v152,v121,v118
v_fma_f32 v119,-v154,v121,v119
v_mul_f32 v108,v108,v133
v_mul_f32 v109,v109,v135
v_mul_f32 v110,v110,v137
v_mul_f32 v111,v111,v139
v_mul_f32 v116,v116,v149
v_mul_f32 v117,v117,v151
v_mul_f32 v118,v118,v153
v_mul_f32 v119,v119,v155
v_cvt_pk_bf16_f32 v108,v108,v109
v_cvt_pk_bf16_f32 v109,v110,v111
v_cvt_pk_bf16_f32 v110,v116,v117
v_cvt_pk_bf16_f32 v111,v118,v119
buffer_store_dwordx4 v[108:111],v21,s[8:11],s74 offen offset:2048 sc1
s_lshl_b32 s82,s72,6
s_add_u32 s82,s82,s73
s_lshl_b32 s82,s82,9
s_add_u32 s82,s82,s71
s_lshl_b32 s75,s69,2
s_add_u32 s82,s82,s75
s_add_u32 s82,s82,s39
s_mov_b32 s59,s82
s_mov_b32 s82,2147483648
s_mov_b32 s39,2147483648
s_cmp_eq_u32 s55,0
s_cbranch_scc1 QKVV_B0
s_cmp_eq_u32 s55,1
s_cbranch_scc1 QKVV_CD0
s_waitcnt vmcnt(0)
s_mov_b64 exec,1
buffer_store_dword v5,v1,s[8:11],s59 offen sc1
s_mov_b64 exec,-1
s_mov_b32 s59,2147483648
s_cmp_eq_u32 s50,128
s_cbranch_scc1 QKVV_END
s_branch QKVV_COLD0
QKVV_COLD1:
s_cmp_lg_u32 s46,0
s_cbranch_scc1 cp_223
ct_224:
buffer_load_dword v3,v2,s[8:11],s35 offen sc1
buffer_load_dword v14,v4,s[8:11],s41 offen sc1
s_waitcnt vmcnt(0)
v_cmp_eq_u32 vcc,0,v14
s_cmp_eq_u64 vcc,0
s_cselect_b32 s36,0,2147483648
v_cmp_eq_u32 vcc,0,v3
s_cmp_lt_u32 s78,64
s_cselect_b32 s36,s36,2147483648
s_cmp_eq_u64 vcc,0
s_cselect_b32 s60,1,s36
s_cmp_lt_u32 s79,64
s_cselect_b32 s60,s60,s36
s_sub_u32 s61,s78,s79
s_or_b32 s61,s61,s36
s_cmp_lt_u32 s61,16
s_cselect_b32 s36,0,s60
v_mov_b32 v23,s36
s_cmp_lt_u32 s36,2
s_cbranch_scc1 ct_224x
s_sleep 3
s_sub_u32 s47,s47,1
s_cbranch_scc1 ABORT
s_branch ct_224
ct_224x:
ds_write_b32 v22,v23 offset:4
s_waitcnt lgkmcnt(0)
cp_223:
s_barrier
ds_read_b32 v23,v22 offset:4
s_waitcnt lgkmcnt(0)
v_readfirstlane_b32 s38,v23
s_and_b32 s38,s38,1
s_and_b32 s37,s38,2147483648
s_and_b32 s33,s38,1
s_cselect_b32 s34,s79,s78
s_lshl_b32 s60,s33,6
s_add_u32 s60,s60,s34
s_mul_i32 s60,s60,46080
s_add_u32 s60,s60,206569472
s_lshl_b32 s62,s46,10
s_add_u32 s62,s62,40960
s_add_u32 m0,s57,s62
s_add_u32 s63,s60,s62
buffer_load_dwordx4 v1,s[8:11],s63 offen sc1 lds
s_add_u32 m0,s57,45056
s_add_u32 s63,s60,45056
buffer_load_dwordx4 v1,s[8:11],s63 offen sc1 lds
s_mul_i32 s61,s46,10240
s_add_u32 s60,s60,s61
s_add_u32 s61,s61,s57
s_add_u32 m0,s61,0
s_add_u32 s63,s60,0
buffer_load_dwordx4 v1,s[8:11],s63 offen sc1 lds
buffer_load_dwordx4 v1,s[8:11],s63 offen offset:1024 sc1 lds
buffer_load_dwordx4 v1,s[8:11],s63 offen offset:2048 sc1 lds
buffer_load_dwordx4 v1,s[8:11],s63 offen offset:3072 sc1 lds
s_add_u32 m0,s61,4096
s_add_u32 s63,s60,4096
buffer_load_dwordx4 v1,s[8:11],s63 offen sc1 lds
buffer_load_dwordx4 v1,s[8:11],s63 offen offset:1024 sc1 lds
buffer_load_dwordx4 v1,s[8:11],s63 offen offset:2048 sc1 lds
buffer_load_dwordx4 v1,s[8:11],s63 offen offset:3072 sc1 lds
s_add_u32 m0,s61,8192
s_add_u32 s63,s60,8192
buffer_load_dwordx4 v1,s[8:11],s63 offen sc1 lds
buffer_load_dwordx4 v1,s[8:11],s63 offen offset:1024 sc1 lds
QKVV_CD1:
s_mov_b32 s51,s33
s_mov_b32 s52,s34
s_mov_b32 s53,s33
s_mov_b32 s54,s34
s_add_u32 s79,s79,s33
s_or_b32 s60,s37,s33
s_cmp_eq_u32 s60,0
s_addc_u32 s78,s78,0
s_lshl_b32 s41,s78,9
s_add_u32 s41,s41,s40
s_lshl_b32 s35,s79,9
s_add_u32 s35,s35,s40
s_add_u32 s35,s35,32768
buffer_load_dword v3,v2,s[8:11],s35 offen sc1
buffer_load_dword v14,v4,s[8:11],s41 offen sc1
s_waitcnt vmcnt(0)
s_mov_b64 exec,1
buffer_store_dword v5,v1,s[8:11],s59 offen sc1
s_mov_b64 exec,-1
s_mov_b32 s59,2147483648
v_cmp_eq_u32 vcc,0,v14
s_cmp_eq_u64 vcc,0
s_cselect_b32 s36,0,2147483648
v_cmp_eq_u32 vcc,0,v3
s_cmp_lt_u32 s78,64
s_cselect_b32 s36,s36,2147483648
s_cmp_eq_u64 vcc,0
s_cselect_b32 s60,1,s36
s_cmp_lt_u32 s79,64
s_cselect_b32 s60,s60,s36
s_sub_u32 s61,s78,s79
s_or_b32 s61,s61,s36
s_cmp_lt_u32 s61,16
s_cselect_b32 s36,0,s60
v_mov_b32 v23,s36
ds_write_b32 v13,v23
s_waitcnt lgkmcnt(0)
s_barrier
ds_read_b32 v23,v22
ds_read_b128 v[24:27],v18 offset:0
ds_read_b128 v[28:31],v19 offset:0
ds_read_b128 v[32:35],v18 offset:2048
ds_read_b128 v[36:39],v19 offset:2048
ds_read_b128 v[40:43],v18 offset:4096
s_waitcnt lgkmcnt(5)
v_readfirstlane_b32 s38,v23
s_and_b32 s37,s38,2147483648
s_and_b32 s33,s38,1
s_cselect_b32 s34,s79,s78
s_nop 0
s_branch QKVV_B1
QKVV_END:
s_endpgm
ROLE_ATT:
v_lshlrev_b32 v1,4,v0
v_mov_b32 v5,1
s_lshl_b32 s56,s48,2
s_add_u32 s56,s56,s46
v_bfe_u32 v6,v0,2,2
v_lshrrev_b32 v7,4,v0
v_add_u32 v7,v6,v7
v_and_b32 v7,3,v7
v_and_b32 v15,3,v0
v_lshlrev_b32 v15,4,v15
v_lshl_add_u32 v15,v7,6,v15
v_lshl_add_u32 v15,v6,8,v15
s_mov_b32 s68,s48
s_and_b32 s51,s46,1
s_lshr_b32 s86,s46,1
s_lshr_b32 s87,s68,3
s_lshl_b32 s87,s87,5
s_and_b32 s60,s68,7
s_add_u32 s87,s87,s60
v_lshlrev_b32 v229,3,v0
v_and_b32 v229,0x300,v1
v_add_u32 v229,v229,v1
v_mov_b32 v230,0xff800000
s_mov_b32 s80,-1
s_mov_b32 s81,0
s_mov_b32 s84,0x3d93cd3a
s_mov_b32 s85,0x3fb8aa3b
v_min_u32 v6,8,v0
v_mul_u32_u24 v7,86,v6
v_lshrrev_b32 v7,8,v7
v_mul_u32_u24 v8,3,v7
v_sub_u32 v6,v6,v8
s_mul_i32 s60,s68,3
v_add_u32 v6,s60,v6
v_lshlrev_b32 v2,2,v6
v_lshl_add_u32 v2,v7,16,v2
v_min_u32 v228,2,v0
v_lshlrev_b32 v228,2,v228
v_lshrrev_b32 v6,4,v0
v_lshlrev_b32 v6,2,v6
v_and_b32 v7,15,v0
v_add_u32 v8,0,v6
v_cmp_le_u32 s[72:73],v8,v7
v_add_u32 v8,1,v6
v_cmp_le_u32 s[74:75],v8,v7
v_add_u32 v8,2,v6
v_cmp_le_u32 s[76:77],v8,v7
v_add_u32 v8,3,v6
v_cmp_le_u32 s[78:79],v8,v7
s_mul_i32 s71,s68,12288
s_mul_i32 s60,s51,13
s_mul_i32 s69,s60,589824
s_mul_i32 s61,s68,18432
s_add_u32 s69,s69,s61
s_mul_i32 s61,s51,9216
s_add_u32 s69,s69,s61
s_add_u32 s69,s69,24120320
s_mul_i32 s70,s60,2048
s_lshl_b32 s61,s68,6
s_add_u32 s70,s70,s61
s_add_u32 s70,s70,688128
s_mul_i32 s69,s51,12582912
s_mul_i32 s61,s68,6144
s_add_u32 s69,s69,s61
s_add_u32 s69,s69,24117248
s_mul_i32 s70,s51,65536
s_lshl_b32 s61,s68,5
s_add_u32 s70,s70,s61
s_add_u32 s70,s70,688128
s_waitcnt vmcnt(0)
s_barrier
s_cmp_lg_u32 s46,0
s_cbranch_scc1 arr_225
v_mov_b32 v6,1
s_lshl_b32 s3,s49,2
v_mov_b32 v7,s3
s_mov_b64 exec,1
buffer_atomic_add v6,v7,s[12:15],0 offen sc1
s_mov_b64 exec,-1
arr_225:
s_mov_b32 s66,s56
s_and_b32 s53,s66,7
s_lshr_b32 s54,s66,3
v_lshrrev_b32 v6,4,v0
v_bfe_u32 v7,v0,2,2
v_and_b32 v8,3,v0
s_and_b32 s61,s53,3
s_lshl_b32 s60,s53,8
v_lshlrev_b32 v132,11,v6
v_lshrrev_b32 v9,1,v6
v_lshlrev_b32 v132,11,v9
v_and_b32 v9,1,v6
v_lshl_add_u32 v132,v9,12,v132
v_add_u32 v9,s61,v7
v_and_b32 v9,3,v9
v_lshl_add_u32 v132,v9,6,v132
v_lshl_add_u32 v132,v8,4,v132
v_add_u32 v132,s60,v132
s_lshl_b32 s60,s53,2
v_add_u32 v9,s60,v8
v_mul_u32_u24 v133,1280,v9
v_lshl_add_u32 v133,v6,5,v133
v_lshl_add_u32 v133,v7,3,v133
s_mov_b32 s4,s16
s_mov_b32 s5,s17
s_mov_b32 s6,2621440
s_mov_b32 s7,0x20000
s_mov_b32 s55,0
s_mul_i32 s62,s54,40960
buffer_load_dwordx2 v[32:33],v133,s[4:7],s62 offen offset:0
buffer_load_dwordx2 v[34:35],v133,s[4:7],s62 offen offset:128
buffer_load_dwordx2 v[36:37],v133,s[4:7],s62 offen offset:256
buffer_load_dwordx2 v[38:39],v133,s[4:7],s62 offen offset:384
buffer_load_dwordx2 v[40:41],v133,s[4:7],s62 offen offset:512
buffer_load_dwordx2 v[42:43],v133,s[4:7],s62 offen offset:640
buffer_load_dwordx2 v[44:45],v133,s[4:7],s62 offen offset:768
buffer_load_dwordx2 v[46:47],v133,s[4:7],s62 offen offset:896
buffer_load_dwordx2 v[48:49],v133,s[4:7],s62 offen offset:1024
buffer_load_dwordx2 v[50:51],v133,s[4:7],s62 offen offset:1152
s_add_u32 s66,s54,16
s_min_u32 s66,s66,63
s_mul_i32 s62,s66,40960
buffer_load_dwordx2 v[52:53],v133,s[4:7],s62 offen offset:0
buffer_load_dwordx2 v[54:55],v133,s[4:7],s62 offen offset:128
buffer_load_dwordx2 v[56:57],v133,s[4:7],s62 offen offset:256
buffer_load_dwordx2 v[58:59],v133,s[4:7],s62 offen offset:384
buffer_load_dwordx2 v[60:61],v133,s[4:7],s62 offen offset:512
buffer_load_dwordx2 v[62:63],v133,s[4:7],s62 offen offset:640
buffer_load_dwordx2 v[64:65],v133,s[4:7],s62 offen offset:768
buffer_load_dwordx2 v[66:67],v133,s[4:7],s62 offen offset:896
buffer_load_dwordx2 v[68:69],v133,s[4:7],s62 offen offset:1024
buffer_load_dwordx2 v[70:71],v133,s[4:7],s62 offen offset:1152
s_mul_i32 s64,s54,40960
s_add_u32 s64,s64,234749952
s_mul_i32 s65,s54,46080
s_add_u32 s65,s65,206569472
s_waitcnt vmcnt(10)
v_lshlrev_b32 v72,16,v32
v_and_b32 v73,0xffff0000,v32
v_lshlrev_b32 v74,16,v33
v_and_b32 v75,0xffff0000,v33
v_lshlrev_b32 v76,16,v34
v_and_b32 v77,0xffff0000,v34
v_lshlrev_b32 v78,16,v35
v_and_b32 v79,0xffff0000,v35
v_lshlrev_b32 v80,16,v36
v_and_b32 v81,0xffff0000,v36
v_lshlrev_b32 v82,16,v37
v_and_b32 v83,0xffff0000,v37
v_lshlrev_b32 v84,16,v38
v_and_b32 v85,0xffff0000,v38
v_lshlrev_b32 v86,16,v39
v_and_b32 v87,0xffff0000,v39
v_lshlrev_b32 v88,16,v40
v_and_b32 v89,0xffff0000,v40
v_lshlrev_b32 v90,16,v41
v_and_b32 v91,0xffff0000,v41
v_lshlrev_b32 v92,16,v42
v_and_b32 v93,0xffff0000,v42
v_lshlrev_b32 v94,16,v43
v_and_b32 v95,0xffff0000,v43
v_lshlrev_b32 v96,16,v44
v_and_b32 v97,0xffff0000,v44
v_lshlrev_b32 v98,16,v45
v_and_b32 v99,0xffff0000,v45
v_lshlrev_b32 v100,16,v46
v_and_b32 v101,0xffff0000,v46
v_lshlrev_b32 v102,16,v47
v_and_b32 v103,0xffff0000,v47
v_lshlrev_b32 v104,16,v48
v_and_b32 v105,0xffff0000,v48
v_lshlrev_b32 v106,16,v49
v_and_b32 v107,0xffff0000,v49
v_lshlrev_b32 v108,16,v50
v_and_b32 v109,0xffff0000,v50
v_lshlrev_b32 v110,16,v51
v_and_b32 v111,0xffff0000,v51
v_pk_add_f32 v[28:29],v[72:73],v[74:75]
v_pk_mul_f32 v[26:27],v[72:73],v[72:73]
v_pk_fma_f32 v[26:27],v[74:75],v[74:75],v[26:27]
v_pk_add_f32 v[28:29],v[28:29],v[76:77]
v_pk_fma_f32 v[26:27],v[76:77],v[76:77],v[26:27]
v_pk_add_f32 v[28:29],v[28:29],v[78:79]
v_pk_fma_f32 v[26:27],v[78:79],v[78:79],v[26:27]
v_pk_add_f32 v[28:29],v[28:29],v[80:81]
v_pk_fma_f32 v[26:27],v[80:81],v[80:81],v[26:27]
v_pk_add_f32 v[28:29],v[28:29],v[82:83]
v_pk_fma_f32 v[26:27],v[82:83],v[82:83],v[26:27]
v_pk_add_f32 v[28:29],v[28:29],v[84:85]
v_pk_fma_f32 v[26:27],v[84:85],v[84:85],v[26:27]
v_pk_add_f32 v[28:29],v[28:29],v[86:87]
v_pk_fma_f32 v[26:27],v[86:87],v[86:87],v[26:27]
v_pk_add_f32 v[28:29],v[28:29],v[88:89]
v_pk_fma_f32 v[26:27],v[88:89],v[88:89],v[26:27]
v_pk_add_f32 v[28:29],v[28:29],v[90:91]
v_pk_fma_f32 v[26:27],v[90:91],v[90:91],v[26:27]
v_pk_add_f32 v[28:29],v[28:29],v[92:93]
v_pk_fma_f32 v[26:27],v[92:93],v[92:93],v[26:27]
v_pk_add_f32 v[28:29],v[28:29],v[94:95]
v_pk_fma_f32 v[26:27],v[94:95],v[94:95],v[26:27]
v_pk_add_f32 v[28:29],v[28:29],v[96:97]
v_pk_fma_f32 v[26:27],v[96:97],v[96:97],v[26:27]
v_pk_add_f32 v[28:29],v[28:29],v[98:99]
v_pk_fma_f32 v[26:27],v[98:99],v[98:99],v[26:27]
v_pk_add_f32 v[28:29],v[28:29],v[100:101]
v_pk_fma_f32 v[26:27],v[100:101],v[100:101],v[26:27]
v_pk_add_f32 v[28:29],v[28:29],v[102:103]
v_pk_fma_f32 v[26:27],v[102:103],v[102:103],v[26:27]
v_pk_add_f32 v[28:29],v[28:29],v[104:105]
v_pk_fma_f32 v[26:27],v[104:105],v[104:105],v[26:27]
v_pk_add_f32 v[28:29],v[28:29],v[106:107]
v_pk_fma_f32 v[26:27],v[106:107],v[106:107],v[26:27]
v_pk_add_f32 v[28:29],v[28:29],v[108:109]
v_pk_fma_f32 v[26:27],v[108:109],v[108:109],v[26:27]
v_pk_add_f32 v[28:29],v[28:29],v[110:111]
v_pk_fma_f32 v[26:27],v[110:111],v[110:111],v[26:27]
v_add_f32 v24,v28,v29
v_add_f32 v25,v26,v27
s_nop 0
v_add_f32_dpp v24,v24,v24 row_ror:4 row_mask:0xf bank_mask:0xf
v_add_f32_dpp v25,v25,v25 row_ror:4 row_mask:0xf bank_mask:0xf
s_nop 0
v_add_f32_dpp v24,v24,v24 row_ror:8 row_mask:0xf bank_mask:0xf
v_add_f32_dpp v25,v25,v25 row_ror:8 row_mask:0xf bank_mask:0xf
v_mov_b32 v26,v24
v_mov_b32 v27,v25
s_nop 0
v_permlane32_swap_b32 v24,v26
v_permlane32_swap_b32 v25,v27
v_add_f32 v24,v24,v26
v_add_f32 v25,v25,v27
v_mov_b32 v26,v24
v_mov_b32 v27,v25
s_nop 0
v_permlane16_swap_b32 v24,v26
v_permlane16_swap_b32 v25,v27
v_add_f32 v24,v24,v26
v_add_f32 v25,v25,v27
v_mul_f32 v24,0x3acccccd,v24
v_mul_f32 v25,0x3acccccd,v25
v_fma_f32 v25,-v24,v24,v25
v_max_f32 v25,0,v25
v_cvt_pk_bf16_f32 v6,v24,v25
v_lshlrev_b32 v24,16,v6
v_and_b32 v25,0xffff0000,v6
v_add_f32 v25,0x3727c5ac,v25
v_cvt_pk_bf16_f32 v6,v25,v25
v_lshlrev_b32 v25,16,v6
v_sqrt_f32 v25,v25
s_nop 0
v_cvt_pk_bf16_f32 v6,v25,v25
v_lshlrev_b32 v25,16,v6
v_rcp_f32 v25,v25
s_nop 0
v_pk_add_f32 v[72:73],v[72:73],v[24:25] op_sel_hi:[1,0] neg_lo:[0,1] neg_hi:[0,1]
v_pk_add_f32 v[74:75],v[74:75],v[24:25] op_sel_hi:[1,0] neg_lo:[0,1] neg_hi:[0,1]
v_pk_add_f32 v[76:77],v[76:77],v[24:25] op_sel_hi:[1,0] neg_lo:[0,1] neg_hi:[0,1]
v_pk_add_f32 v[78:79],v[78:79],v[24:25] op_sel_hi:[1,0] neg_lo:[0,1] neg_hi:[0,1]
v_pk_add_f32 v[80:81],v[80:81],v[24:25] op_sel_hi:[1,0] neg_lo:[0,1] neg_hi:[0,1]
v_pk_add_f32 v[82:83],v[82:83],v[24:25] op_sel_hi:[1,0] neg_lo:[0,1] neg_hi:[0,1]
v_pk_add_f32 v[84:85],v[84:85],v[24:25] op_sel_hi:[1,0] neg_lo:[0,1] neg_hi:[0,1]
v_pk_add_f32 v[86:87],v[86:87],v[24:25] op_sel_hi:[1,0] neg_lo:[0,1] neg_hi:[0,1]
v_pk_add_f32 v[88:89],v[88:89],v[24:25] op_sel_hi:[1,0] neg_lo:[0,1] neg_hi:[0,1]
v_pk_add_f32 v[90:91],v[90:91],v[24:25] op_sel_hi:[1,0] neg_lo:[0,1] neg_hi:[0,1]
v_pk_add_f32 v[92:93],v[92:93],v[24:25] op_sel_hi:[1,0] neg_lo:[0,1] neg_hi:[0,1]
v_pk_add_f32 v[94:95],v[94:95],v[24:25] op_sel_hi:[1,0] neg_lo:[0,1] neg_hi:[0,1]
v_pk_add_f32 v[96:97],v[96:97],v[24:25] op_sel_hi:[1,0] neg_lo:[0,1] neg_hi:[0,1]
v_pk_add_f32 v[98:99],v[98:99],v[24:25] op_sel_hi:[1,0] neg_lo:[0,1] neg_hi:[0,1]
v_pk_add_f32 v[100:101],v[100:101],v[24:25] op_sel_hi:[1,0] neg_lo:[0,1] neg_hi:[0,1]
v_pk_add_f32 v[102:103],v[102:103],v[24:25] op_sel_hi:[1,0] neg_lo:[0,1] neg_hi:[0,1]
v_pk_add_f32 v[104:105],v[104:105],v[24:25] op_sel_hi:[1,0] neg_lo:[0,1] neg_hi:[0,1]
v_pk_add_f32 v[106:107],v[106:107],v[24:25] op_sel_hi:[1,0] neg_lo:[0,1] neg_hi:[0,1]
v_pk_add_f32 v[108:109],v[108:109],v[24:25] op_sel_hi:[1,0] neg_lo:[0,1] neg_hi:[0,1]
v_pk_add_f32 v[110:111],v[110:111],v[24:25] op_sel_hi:[1,0] neg_lo:[0,1] neg_hi:[0,1]
v_cvt_pk_bf16_f32 v6,v72,v73
v_lshlrev_b32 v72,16,v6
v_and_b32 v73,0xffff0000,v6
v_cvt_pk_bf16_f32 v8,v74,v75
v_lshlrev_b32 v74,16,v8
v_and_b32 v75,0xffff0000,v8
v_cvt_pk_bf16_f32 v6,v76,v77
v_lshlrev_b32 v76,16,v6
v_and_b32 v77,0xffff0000,v6
v_cvt_pk_bf16_f32 v8,v78,v79
v_lshlrev_b32 v78,16,v8
v_and_b32 v79,0xffff0000,v8
v_cvt_pk_bf16_f32 v6,v80,v81
v_lshlrev_b32 v80,16,v6
v_and_b32 v81,0xffff0000,v6
v_cvt_pk_bf16_f32 v8,v82,v83
v_lshlrev_b32 v82,16,v8
v_and_b32 v83,0xffff0000,v8
v_cvt_pk_bf16_f32 v6,v84,v85
v_lshlrev_b32 v84,16,v6
v_and_b32 v85,0xffff0000,v6
v_cvt_pk_bf16_f32 v8,v86,v87
v_lshlrev_b32 v86,16,v8
v_and_b32 v87,0xffff0000,v8
v_cvt_pk_bf16_f32 v6,v88,v89
v_lshlrev_b32 v88,16,v6
v_and_b32 v89,0xffff0000,v6
v_cvt_pk_bf16_f32 v8,v90,v91
v_lshlrev_b32 v90,16,v8
v_and_b32 v91,0xffff0000,v8
v_cvt_pk_bf16_f32 v6,v92,v93
v_lshlrev_b32 v92,16,v6
v_and_b32 v93,0xffff0000,v6
v_cvt_pk_bf16_f32 v8,v94,v95
v_lshlrev_b32 v94,16,v8
v_and_b32 v95,0xffff0000,v8
v_cvt_pk_bf16_f32 v6,v96,v97
v_lshlrev_b32 v96,16,v6
v_and_b32 v97,0xffff0000,v6
v_cvt_pk_bf16_f32 v8,v98,v99
v_lshlrev_b32 v98,16,v8
v_and_b32 v99,0xffff0000,v8
v_cvt_pk_bf16_f32 v6,v100,v101
v_lshlrev_b32 v100,16,v6
v_and_b32 v101,0xffff0000,v6
v_cvt_pk_bf16_f32 v8,v102,v103
v_lshlrev_b32 v102,16,v8
v_and_b32 v103,0xffff0000,v8
v_cvt_pk_bf16_f32 v6,v104,v105
v_lshlrev_b32 v104,16,v6
v_and_b32 v105,0xffff0000,v6
v_cvt_pk_bf16_f32 v8,v106,v107
v_lshlrev_b32 v106,16,v8
v_and_b32 v107,0xffff0000,v8
v_cvt_pk_bf16_f32 v6,v108,v109
v_lshlrev_b32 v108,16,v6
v_and_b32 v109,0xffff0000,v6
v_cvt_pk_bf16_f32 v8,v110,v111
v_lshlrev_b32 v110,16,v8
v_and_b32 v111,0xffff0000,v8
v_pk_mul_f32 v[72:73],v[72:73],v[24:25] op_sel:[0,1] op_sel_hi:[1,1]
v_pk_mul_f32 v[74:75],v[74:75],v[24:25] op_sel:[0,1] op_sel_hi:[1,1]
v_pk_mul_f32 v[76:77],v[76:77],v[24:25] op_sel:[0,1] op_sel_hi:[1,1]
v_pk_mul_f32 v[78:79],v[78:79],v[24:25] op_sel:[0,1] op_sel_hi:[1,1]
v_pk_mul_f32 v[80:81],v[80:81],v[24:25] op_sel:[0,1] op_sel_hi:[1,1]
v_pk_mul_f32 v[82:83],v[82:83],v[24:25] op_sel:[0,1] op_sel_hi:[1,1]
v_pk_mul_f32 v[84:85],v[84:85],v[24:25] op_sel:[0,1] op_sel_hi:[1,1]
v_pk_mul_f32 v[86:87],v[86:87],v[24:25] op_sel:[0,1] op_sel_hi:[1,1]
v_pk_mul_f32 v[88:89],v[88:89],v[24:25] op_sel:[0,1] op_sel_hi:[1,1]
v_pk_mul_f32 v[90:91],v[90:91],v[24:25] op_sel:[0,1] op_sel_hi:[1,1]
v_pk_mul_f32 v[92:93],v[92:93],v[24:25] op_sel:[0,1] op_sel_hi:[1,1]
v_pk_mul_f32 v[94:95],v[94:95],v[24:25] op_sel:[0,1] op_sel_hi:[1,1]
v_pk_mul_f32 v[96:97],v[96:97],v[24:25] op_sel:[0,1] op_sel_hi:[1,1]
v_pk_mul_f32 v[98:99],v[98:99],v[24:25] op_sel:[0,1] op_sel_hi:[1,1]
v_pk_mul_f32 v[100:101],v[100:101],v[24:25] op_sel:[0,1] op_sel_hi:[1,1]
v_pk_mul_f32 v[102:103],v[102:103],v[24:25] op_sel:[0,1] op_sel_hi:[1,1]
v_pk_mul_f32 v[104:105],v[104:105],v[24:25] op_sel:[0,1] op_sel_hi:[1,1]
v_pk_mul_f32 v[106:107],v[106:107],v[24:25] op_sel:[0,1] op_sel_hi:[1,1]
v_pk_mul_f32 v[108:109],v[108:109],v[24:25] op_sel:[0,1] op_sel_hi:[1,1]
v_pk_mul_f32 v[110:111],v[110:111],v[24:25] op_sel:[0,1] op_sel_hi:[1,1]
v_cvt_pk_bf16_f32 v112,v72,v73
v_lshlrev_b32 v72,16,v112
v_and_b32 v73,0xffff0000,v112
v_cvt_pk_bf16_f32 v113,v74,v75
v_lshlrev_b32 v74,16,v113
v_and_b32 v75,0xffff0000,v113
v_cvt_pk_bf16_f32 v114,v76,v77
v_lshlrev_b32 v76,16,v114
v_and_b32 v77,0xffff0000,v114
v_cvt_pk_bf16_f32 v115,v78,v79
v_lshlrev_b32 v78,16,v115
v_and_b32 v79,0xffff0000,v115
v_cvt_pk_bf16_f32 v116,v80,v81
v_lshlrev_b32 v80,16,v116
v_and_b32 v81,0xffff0000,v116
v_cvt_pk_bf16_f32 v117,v82,v83
v_lshlrev_b32 v82,16,v117
v_and_b32 v83,0xffff0000,v117
v_cvt_pk_bf16_f32 v118,v84,v85
v_lshlrev_b32 v84,16,v118
v_and_b32 v85,0xffff0000,v118
v_cvt_pk_bf16_f32 v119,v86,v87
v_lshlrev_b32 v86,16,v119
v_and_b32 v87,0xffff0000,v119
v_cvt_pk_bf16_f32 v120,v88,v89
v_lshlrev_b32 v88,16,v120
v_and_b32 v89,0xffff0000,v120
v_cvt_pk_bf16_f32 v121,v90,v91
v_lshlrev_b32 v90,16,v121
v_and_b32 v91,0xffff0000,v121
v_cvt_pk_bf16_f32 v122,v92,v93
v_lshlrev_b32 v92,16,v122
v_and_b32 v93,0xffff0000,v122
v_cvt_pk_bf16_f32 v123,v94,v95
v_lshlrev_b32 v94,16,v123
v_and_b32 v95,0xffff0000,v123
v_cvt_pk_bf16_f32 v124,v96,v97
v_lshlrev_b32 v96,16,v124
v_and_b32 v97,0xffff0000,v124
v_cvt_pk_bf16_f32 v125,v98,v99
v_lshlrev_b32 v98,16,v125
v_and_b32 v99,0xffff0000,v125
v_cvt_pk_bf16_f32 v126,v100,v101
v_lshlrev_b32 v100,16,v126
v_and_b32 v101,0xffff0000,v126
v_cvt_pk_bf16_f32 v127,v102,v103
v_lshlrev_b32 v102,16,v127
v_and_b32 v103,0xffff0000,v127
v_cvt_pk_bf16_f32 v128,v104,v105
v_lshlrev_b32 v104,16,v128
v_and_b32 v105,0xffff0000,v128
v_cvt_pk_bf16_f32 v129,v106,v107
v_lshlrev_b32 v106,16,v129
v_and_b32 v107,0xffff0000,v129
v_cvt_pk_bf16_f32 v130,v108,v109
v_lshlrev_b32 v108,16,v130
v_and_b32 v109,0xffff0000,v130
v_cvt_pk_bf16_f32 v131,v110,v111
v_lshlrev_b32 v110,16,v131
v_and_b32 v111,0xffff0000,v131
s_add_u32 s63,s65,0
v_permlane16_swap_b32 v112,v114
v_permlane16_swap_b32 v113,v115
buffer_store_dwordx4 v[112:115],v132,s[8:11],s63 offen sc1
s_add_u32 s63,s65,8192
v_permlane16_swap_b32 v116,v118
v_permlane16_swap_b32 v117,v119
buffer_store_dwordx4 v[116:119],v132,s[8:11],s63 offen sc1
s_add_u32 s63,s65,16384
v_permlane16_swap_b32 v120,v122
v_permlane16_swap_b32 v121,v123
buffer_store_dwordx4 v[120:123],v132,s[8:11],s63 offen sc1
s_add_u32 s63,s65,24576
v_permlane16_swap_b32 v124,v126
v_permlane16_swap_b32 v125,v127
buffer_store_dwordx4 v[124:127],v132,s[8:11],s63 offen sc1
s_add_u32 s63,s65,32768
v_permlane16_swap_b32 v128,v130
v_permlane16_swap_b32 v129,v131
buffer_store_dwordx4 v[128:131],v132,s[8:11],s63 offen sc1
s_add_u32 s63,s64,0
v_permlane16_swap_b32 v32,v34
v_permlane16_swap_b32 v33,v35
buffer_store_dwordx4 v[32:35],v132,s[8:11],s63 offen sc1
s_add_u32 s63,s64,8192
v_permlane16_swap_b32 v36,v38
v_permlane16_swap_b32 v37,v39
buffer_store_dwordx4 v[36:39],v132,s[8:11],s63 offen sc1
s_add_u32 s63,s64,16384
v_permlane16_swap_b32 v40,v42
v_permlane16_swap_b32 v41,v43
buffer_store_dwordx4 v[40:43],v132,s[8:11],s63 offen sc1
s_add_u32 s63,s64,24576
v_permlane16_swap_b32 v44,v46
v_permlane16_swap_b32 v45,v47
buffer_store_dwordx4 v[44:47],v132,s[8:11],s63 offen sc1
s_add_u32 s63,s64,32768
v_permlane16_swap_b32 v48,v50
v_permlane16_swap_b32 v49,v51
buffer_store_dwordx4 v[48:51],v132,s[8:11],s63 offen sc1
s_lshl_b32 s82,s55,6
s_add_u32 s82,s82,s54
s_lshl_b32 s82,s82,9
s_add_u32 s82,s82,0
s_lshl_b32 s61,s53,2
s_add_u32 s82,s82,s61
s_add_u32 s54,s54,16
s_lshl_b32 s3,s49,2
v_mov_b32 v7,s3
s_nop 1
ibw_226:
buffer_load_dword v6,v7,s[12:15],0 offen sc1
s_waitcnt vmcnt(0)
v_cmp_ne_u32 vcc,256,v6
s_nop 0
s_cbranch_vccz ok_227
s_sleep 8
s_sub_u32 s47,s47,1
s_cbranch_scc1 ABORT
s_branch ibw_226
ok_227:
s_cmp_lg_u32 s49,0
s_cbranch_scc1 ibok_228
v_and_b32 v7,7,v0
v_lshlrev_b32 v7,2,v7
buffer_load_dword v6,v7,s[12:15],0 offen offset:32 sc1
s_waitcnt vmcnt(0)
v_cmp_ne_u32 vcc,32,v6
s_nop 0
s_cbranch_vccz ibok_228
s_barrier
s_mov_b32 s49,1
s_mov_b32 s3,s2
s_load_dwordx16 s[16:31],s[0:1],0
s_load_dwordx8 s[32:39],s[0:1],64
s_waitcnt lgkmcnt(0)
s_branch DISPATCH
ibok_228:
s_mov_b64 exec,1
buffer_store_dword v5,v1,s[8:11],s82 offen sc1
s_mov_b64 exec,-1
s_add_u32 s66,s54,16
s_min_u32 s66,s66,63
s_mul_i32 s62,s66,40960
buffer_load_dwordx2 v[32:33],v133,s[4:7],s62 offen offset:0
buffer_load_dwordx2 v[34:35],v133,s[4:7],s62 offen offset:128
buffer_load_dwordx2 v[36:37],v133,s[4:7],s62 offen offset:256
buffer_load_dwordx2 v[38:39],v133,s[4:7],s62 offen offset:384
buffer_load_dwordx2 v[40:41],v133,s[4:7],s62 offen offset:512
buffer_load_dwordx2 v[42:43],v133,s[4:7],s62 offen offset:640
buffer_load_dwordx2 v[44:45],v133,s[4:7],s62 offen offset:768
buffer_load_dwordx2 v[46:47],v133,s[4:7],s62 offen offset:896
buffer_load_dwordx2 v[48:49],v133,s[4:7],s62 offen offset:1024
buffer_load_dwordx2 v[50:51],v133,s[4:7],s62 offen offset:1152
s_mul_i32 s64,s54,40960
s_add_u32 s64,s64,234749952
s_mul_i32 s65,s54,46080
s_add_u32 s65,s65,206569472
s_waitcnt vmcnt(10)
v_lshlrev_b32 v72,16,v52
v_and_b32 v73,0xffff0000,v52
v_lshlrev_b32 v74,16,v53
v_and_b32 v75,0xffff0000,v53
v_lshlrev_b32 v76,16,v54
v_and_b32 v77,0xffff0000,v54
v_lshlrev_b32 v78,16,v55
v_and_b32 v79,0xffff0000,v55
v_lshlrev_b32 v80,16,v56
v_and_b32 v81,0xffff0000,v56
v_lshlrev_b32 v82,16,v57
v_and_b32 v83,0xffff0000,v57
v_lshlrev_b32 v84,16,v58
v_and_b32 v85,0xffff0000,v58
v_lshlrev_b32 v86,16,v59
v_and_b32 v87,0xffff0000,v59
v_lshlrev_b32 v88,16,v60
v_and_b32 v89,0xffff0000,v60
v_lshlrev_b32 v90,16,v61
v_and_b32 v91,0xffff0000,v61
v_lshlrev_b32 v92,16,v62
v_and_b32 v93,0xffff0000,v62
v_lshlrev_b32 v94,16,v63
v_and_b32 v95,0xffff0000,v63
v_lshlrev_b32 v96,16,v64
v_and_b32 v97,0xffff0000,v64
v_lshlrev_b32 v98,16,v65
v_and_b32 v99,0xffff0000,v65
v_lshlrev_b32 v100,16,v66
v_and_b32 v101,0xffff0000,v66
v_lshlrev_b32 v102,16,v67
v_and_b32 v103,0xffff0000,v67
v_lshlrev_b32 v104,16,v68
v_and_b32 v105,0xffff0000,v68
v_lshlrev_b32 v106,16,v69
v_and_b32 v107,0xffff0000,v69
v_lshlrev_b32 v108,16,v70
v_and_b32 v109,0xffff0000,v70
v_lshlrev_b32 v110,16,v71
v_and_b32 v111,0xffff0000,v71
v_pk_add_f32 v[28:29],v[72:73],v[74:75]
v_pk_mul_f32 v[26:27],v[72:73],v[72:73]
v_pk_fma_f32 v[26:27],v[74:75],v[74:75],v[26:27]
v_pk_add_f32 v[28:29],v[28:29],v[76:77]
v_pk_fma_f32 v[26:27],v[76:77],v[76:77],v[26:27]
v_pk_add_f32 v[28:29],v[28:29],v[78:79]
v_pk_fma_f32 v[26:27],v[78:79],v[78:79],v[26:27]
v_pk_add_f32 v[28:29],v[28:29],v[80:81]
v_pk_fma_f32 v[26:27],v[80:81],v[80:81],v[26:27]
v_pk_add_f32 v[28:29],v[28:29],v[82:83]
v_pk_fma_f32 v[26:27],v[82:83],v[82:83],v[26:27]
v_pk_add_f32 v[28:29],v[28:29],v[84:85]
v_pk_fma_f32 v[26:27],v[84:85],v[84:85],v[26:27]
v_pk_add_f32 v[28:29],v[28:29],v[86:87]
v_pk_fma_f32 v[26:27],v[86:87],v[86:87],v[26:27]
v_pk_add_f32 v[28:29],v[28:29],v[88:89]
v_pk_fma_f32 v[26:27],v[88:89],v[88:89],v[26:27]
v_pk_add_f32 v[28:29],v[28:29],v[90:91]
v_pk_fma_f32 v[26:27],v[90:91],v[90:91],v[26:27]
v_pk_add_f32 v[28:29],v[28:29],v[92:93]
v_pk_fma_f32 v[26:27],v[92:93],v[92:93],v[26:27]
v_pk_add_f32 v[28:29],v[28:29],v[94:95]
v_pk_fma_f32 v[26:27],v[94:95],v[94:95],v[26:27]
v_pk_add_f32 v[28:29],v[28:29],v[96:97]
v_pk_fma_f32 v[26:27],v[96:97],v[96:97],v[26:27]
v_pk_add_f32 v[28:29],v[28:29],v[98:99]
v_pk_fma_f32 v[26:27],v[98:99],v[98:99],v[26:27]
v_pk_add_f32 v[28:29],v[28:29],v[100:101]
v_pk_fma_f32 v[26:27],v[100:101],v[100:101],v[26:27]
v_pk_add_f32 v[28:29],v[28:29],v[102:103]
v_pk_fma_f32 v[26:27],v[102:103],v[102:103],v[26:27]
v_pk_add_f32 v[28:29],v[28:29],v[104:105]
v_pk_fma_f32 v[26:27],v[104:105],v[104:105],v[26:27]
v_pk_add_f32 v[28:29],v[28:29],v[106:107]
v_pk_fma_f32 v[26:27],v[106:107],v[106:107],v[26:27]
v_pk_add_f32 v[28:29],v[28:29],v[108:109]
v_pk_fma_f32 v[26:27],v[108:109],v[108:109],v[26:27]
v_pk_add_f32 v[28:29],v[28:29],v[110:111]
v_pk_fma_f32 v[26:27],v[110:111],v[110:111],v[26:27]
v_add_f32 v24,v28,v29
v_add_f32 v25,v26,v27
s_nop 0
v_add_f32_dpp v24,v24,v24 row_ror:4 row_mask:0xf bank_mask:0xf
v_add_f32_dpp v25,v25,v25 row_ror:4 row_mask:0xf bank_mask:0xf
s_nop 0
v_add_f32_dpp v24,v24,v24 row_ror:8 row_mask:0xf bank_mask:0xf
v_add_f32_dpp v25,v25,v25 row_ror:8 row_mask:0xf bank_mask:0xf
v_mov_b32 v26,v24
v_mov_b32 v27,v25
s_nop 0
v_permlane32_swap_b32 v24,v26
v_permlane32_swap_b32 v25,v27
v_add_f32 v24,v24,v26
v_add_f32 v25,v25,v27
v_mov_b32 v26,v24
v_mov_b32 v27,v25
s_nop 0
v_permlane16_swap_b32 v24,v26
v_permlane16_swap_b32 v25,v27
v_add_f32 v24,v24,v26
v_add_f32 v25,v25,v27
v_mul_f32 v24,0x3acccccd,v24
v_mul_f32 v25,0x3acccccd,v25
v_fma_f32 v25,-v24,v24,v25
v_max_f32 v25,0,v25
v_cvt_pk_bf16_f32 v6,v24,v25
v_lshlrev_b32 v24,16,v6
v_and_b32 v25,0xffff0000,v6
v_add_f32 v25,0x3727c5ac,v25
v_cvt_pk_bf16_f32 v6,v25,v25
v_lshlrev_b32 v25,16,v6
v_sqrt_f32 v25,v25
s_nop 0
v_cvt_pk_bf16_f32 v6,v25,v25
v_lshlrev_b32 v25,16,v6
v_rcp_f32 v25,v25
s_nop 0
v_pk_add_f32 v[72:73],v[72:73],v[24:25] op_sel_hi:[1,0] neg_lo:[0,1] neg_hi:[0,1]
v_pk_add_f32 v[74:75],v[74:75],v[24:25] op_sel_hi:[1,0] neg_lo:[0,1] neg_hi:[0,1]
v_pk_add_f32 v[76:77],v[76:77],v[24:25] op_sel_hi:[1,0] neg_lo:[0,1] neg_hi:[0,1]
v_pk_add_f32 v[78:79],v[78:79],v[24:25] op_sel_hi:[1,0] neg_lo:[0,1] neg_hi:[0,1]
v_pk_add_f32 v[80:81],v[80:81],v[24:25] op_sel_hi:[1,0] neg_lo:[0,1] neg_hi:[0,1]
v_pk_add_f32 v[82:83],v[82:83],v[24:25] op_sel_hi:[1,0] neg_lo:[0,1] neg_hi:[0,1]
v_pk_add_f32 v[84:85],v[84:85],v[24:25] op_sel_hi:[1,0] neg_lo:[0,1] neg_hi:[0,1]
v_pk_add_f32 v[86:87],v[86:87],v[24:25] op_sel_hi:[1,0] neg_lo:[0,1] neg_hi:[0,1]
v_pk_add_f32 v[88:89],v[88:89],v[24:25] op_sel_hi:[1,0] neg_lo:[0,1] neg_hi:[0,1]
v_pk_add_f32 v[90:91],v[90:91],v[24:25] op_sel_hi:[1,0] neg_lo:[0,1] neg_hi:[0,1]
v_pk_add_f32 v[92:93],v[92:93],v[24:25] op_sel_hi:[1,0] neg_lo:[0,1] neg_hi:[0,1]
v_pk_add_f32 v[94:95],v[94:95],v[24:25] op_sel_hi:[1,0] neg_lo:[0,1] neg_hi:[0,1]
v_pk_add_f32 v[96:97],v[96:97],v[24:25] op_sel_hi:[1,0] neg_lo:[0,1] neg_hi:[0,1]
v_pk_add_f32 v[98:99],v[98:99],v[24:25] op_sel_hi:[1,0] neg_lo:[0,1] neg_hi:[0,1]
v_pk_add_f32 v[100:101],v[100:101],v[24:25] op_sel_hi:[1,0] neg_lo:[0,1] neg_hi:[0,1]
v_pk_add_f32 v[102:103],v[102:103],v[24:25] op_sel_hi:[1,0] neg_lo:[0,1] neg_hi:[0,1]
v_pk_add_f32 v[104:105],v[104:105],v[24:25] op_sel_hi:[1,0] neg_lo:[0,1] neg_hi:[0,1]
v_pk_add_f32 v[106:107],v[106:107],v[24:25] op_sel_hi:[1,0] neg_lo:[0,1] neg_hi:[0,1]
v_pk_add_f32 v[108:109],v[108:109],v[24:25] op_sel_hi:[1,0] neg_lo:[0,1] neg_hi:[0,1]
v_pk_add_f32 v[110:111],v[110:111],v[24:25] op_sel_hi:[1,0] neg_lo:[0,1] neg_hi:[0,1]
v_cvt_pk_bf16_f32 v6,v72,v73
v_lshlrev_b32 v72,16,v6
v_and_b32 v73,0xffff0000,v6
v_cvt_pk_bf16_f32 v8,v74,v75
v_lshlrev_b32 v74,16,v8
v_and_b32 v75,0xffff0000,v8
v_cvt_pk_bf16_f32 v6,v76,v77
v_lshlrev_b32 v76,16,v6
v_and_b32 v77,0xffff0000,v6
v_cvt_pk_bf16_f32 v8,v78,v79
v_lshlrev_b32 v78,16,v8
v_and_b32 v79,0xffff0000,v8
v_cvt_pk_bf16_f32 v6,v80,v81
v_lshlrev_b32 v80,16,v6
v_and_b32 v81,0xffff0000,v6
v_cvt_pk_bf16_f32 v8,v82,v83
v_lshlrev_b32 v82,16,v8
v_and_b32 v83,0xffff0000,v8
v_cvt_pk_bf16_f32 v6,v84,v85
v_lshlrev_b32 v84,16,v6
v_and_b32 v85,0xffff0000,v6
v_cvt_pk_bf16_f32 v8,v86,v87
v_lshlrev_b32 v86,16,v8
v_and_b32 v87,0xffff0000,v8
v_cvt_pk_bf16_f32 v6,v88,v89
v_lshlrev_b32 v88,16,v6
v_and_b32 v89,0xffff0000,v6
v_cvt_pk_bf16_f32 v8,v90,v91
v_lshlrev_b32 v90,16,v8
v_and_b32 v91,0xffff0000,v8
v_cvt_pk_bf16_f32 v6,v92,v93
v_lshlrev_b32 v92,16,v6
v_and_b32 v93,0xffff0000,v6
v_cvt_pk_bf16_f32 v8,v94,v95
v_lshlrev_b32 v94,16,v8
v_and_b32 v95,0xffff0000,v8
v_cvt_pk_bf16_f32 v6,v96,v97
v_lshlrev_b32 v96,16,v6
v_and_b32 v97,0xffff0000,v6
v_cvt_pk_bf16_f32 v8,v98,v99
v_lshlrev_b32 v98,16,v8
v_and_b32 v99,0xffff0000,v8
v_cvt_pk_bf16_f32 v6,v100,v101
v_lshlrev_b32 v100,16,v6
v_and_b32 v101,0xffff0000,v6
v_cvt_pk_bf16_f32 v8,v102,v103
v_lshlrev_b32 v102,16,v8
v_and_b32 v103,0xffff0000,v8
v_cvt_pk_bf16_f32 v6,v104,v105
v_lshlrev_b32 v104,16,v6
v_and_b32 v105,0xffff0000,v6
v_cvt_pk_bf16_f32 v8,v106,v107
v_lshlrev_b32 v106,16,v8
v_and_b32 v107,0xffff0000,v8
v_cvt_pk_bf16_f32 v6,v108,v109
v_lshlrev_b32 v108,16,v6
v_and_b32 v109,0xffff0000,v6
v_cvt_pk_bf16_f32 v8,v110,v111
v_lshlrev_b32 v110,16,v8
v_and_b32 v111,0xffff0000,v8
v_pk_mul_f32 v[72:73],v[72:73],v[24:25] op_sel:[0,1] op_sel_hi:[1,1]
v_pk_mul_f32 v[74:75],v[74:75],v[24:25] op_sel:[0,1] op_sel_hi:[1,1]
v_pk_mul_f32 v[76:77],v[76:77],v[24:25] op_sel:[0,1] op_sel_hi:[1,1]
v_pk_mul_f32 v[78:79],v[78:79],v[24:25] op_sel:[0,1] op_sel_hi:[1,1]
v_pk_mul_f32 v[80:81],v[80:81],v[24:25] op_sel:[0,1] op_sel_hi:[1,1]
v_pk_mul_f32 v[82:83],v[82:83],v[24:25] op_sel:[0,1] op_sel_hi:[1,1]
v_pk_mul_f32 v[84:85],v[84:85],v[24:25] op_sel:[0,1] op_sel_hi:[1,1]
v_pk_mul_f32 v[86:87],v[86:87],v[24:25] op_sel:[0,1] op_sel_hi:[1,1]
v_pk_mul_f32 v[88:89],v[88:89],v[24:25] op_sel:[0,1] op_sel_hi:[1,1]
v_pk_mul_f32 v[90:91],v[90:91],v[24:25] op_sel:[0,1] op_sel_hi:[1,1]
v_pk_mul_f32 v[92:93],v[92:93],v[24:25] op_sel:[0,1] op_sel_hi:[1,1]
v_pk_mul_f32 v[94:95],v[94:95],v[24:25] op_sel:[0,1] op_sel_hi:[1,1]
v_pk_mul_f32 v[96:97],v[96:97],v[24:25] op_sel:[0,1] op_sel_hi:[1,1]
v_pk_mul_f32 v[98:99],v[98:99],v[24:25] op_sel:[0,1] op_sel_hi:[1,1]
v_pk_mul_f32 v[100:101],v[100:101],v[24:25] op_sel:[0,1] op_sel_hi:[1,1]
v_pk_mul_f32 v[102:103],v[102:103],v[24:25] op_sel:[0,1] op_sel_hi:[1,1]
v_pk_mul_f32 v[104:105],v[104:105],v[24:25] op_sel:[0,1] op_sel_hi:[1,1]
v_pk_mul_f32 v[106:107],v[106:107],v[24:25] op_sel:[0,1] op_sel_hi:[1,1]
v_pk_mul_f32 v[108:109],v[108:109],v[24:25] op_sel:[0,1] op_sel_hi:[1,1]
v_pk_mul_f32 v[110:111],v[110:111],v[24:25] op_sel:[0,1] op_sel_hi:[1,1]
v_cvt_pk_bf16_f32 v112,v72,v73
v_lshlrev_b32 v72,16,v112
v_and_b32 v73,0xffff0000,v112
v_cvt_pk_bf16_f32 v113,v74,v75
v_lshlrev_b32 v74,16,v113
v_and_b32 v75,0xffff0000,v113
v_cvt_pk_bf16_f32 v114,v76,v77
v_lshlrev_b32 v76,16,v114
v_and_b32 v77,0xffff0000,v114
v_cvt_pk_bf16_f32 v115,v78,v79
v_lshlrev_b32 v78,16,v115
v_and_b32 v79,0xffff0000,v115
v_cvt_pk_bf16_f32 v116,v80,v81
v_lshlrev_b32 v80,16,v116
v_and_b32 v81,0xffff0000,v116
v_cvt_pk_bf16_f32 v117,v82,v83
v_lshlrev_b32 v82,16,v117
v_and_b32 v83,0xffff0000,v117
v_cvt_pk_bf16_f32 v118,v84,v85
v_lshlrev_b32 v84,16,v118
v_and_b32 v85,0xffff0000,v118
v_cvt_pk_bf16_f32 v119,v86,v87
v_lshlrev_b32 v86,16,v119
v_and_b32 v87,0xffff0000,v119
v_cvt_pk_bf16_f32 v120,v88,v89
v_lshlrev_b32 v88,16,v120
v_and_b32 v89,0xffff0000,v120
v_cvt_pk_bf16_f32 v121,v90,v91
v_lshlrev_b32 v90,16,v121
v_and_b32 v91,0xffff0000,v121
v_cvt_pk_bf16_f32 v122,v92,v93
v_lshlrev_b32 v92,16,v122
v_and_b32 v93,0xffff0000,v122
v_cvt_pk_bf16_f32 v123,v94,v95
v_lshlrev_b32 v94,16,v123
v_and_b32 v95,0xffff0000,v123
v_cvt_pk_bf16_f32 v124,v96,v97
v_lshlrev_b32 v96,16,v124
v_and_b32 v97,0xffff0000,v124
v_cvt_pk_bf16_f32 v125,v98,v99
v_lshlrev_b32 v98,16,v125
v_and_b32 v99,0xffff0000,v125
v_cvt_pk_bf16_f32 v126,v100,v101
v_lshlrev_b32 v100,16,v126
v_and_b32 v101,0xffff0000,v126
v_cvt_pk_bf16_f32 v127,v102,v103
v_lshlrev_b32 v102,16,v127
v_and_b32 v103,0xffff0000,v127
v_cvt_pk_bf16_f32 v128,v104,v105
v_lshlrev_b32 v104,16,v128
v_and_b32 v105,0xffff0000,v128
v_cvt_pk_bf16_f32 v129,v106,v107
v_lshlrev_b32 v106,16,v129
v_and_b32 v107,0xffff0000,v129
v_cvt_pk_bf16_f32 v130,v108,v109
v_lshlrev_b32 v108,16,v130
v_and_b32 v109,0xffff0000,v130
v_cvt_pk_bf16_f32 v131,v110,v111
v_lshlrev_b32 v110,16,v131
v_and_b32 v111,0xffff0000,v131
s_add_u32 s63,s65,0
v_permlane16_swap_b32 v112,v114
v_permlane16_swap_b32 v113,v115
buffer_store_dwordx4 v[112:115],v132,s[8:11],s63 offen sc1
s_add_u32 s63,s65,8192
v_permlane16_swap_b32 v116,v118
v_permlane16_swap_b32 v117,v119
buffer_store_dwordx4 v[116:119],v132,s[8:11],s63 offen sc1
s_add_u32 s63,s65,16384
v_permlane16_swap_b32 v120,v122
v_permlane16_swap_b32 v121,v123
buffer_store_dwordx4 v[120:123],v132,s[8:11],s63 offen sc1
s_add_u32 s63,s65,24576
v_permlane16_swap_b32 v124,v126
v_permlane16_swap_b32 v125,v127
buffer_store_dwordx4 v[124:127],v132,s[8:11],s63 offen sc1
s_add_u32 s63,s65,32768
v_permlane16_swap_b32 v128,v130
v_permlane16_swap_b32 v129,v131
buffer_store_dwordx4 v[128:131],v132,s[8:11],s63 offen sc1
s_add_u32 s63,s64,0
v_permlane16_swap_b32 v52,v54
v_permlane16_swap_b32 v53,v55
buffer_store_dwordx4 v[52:55],v132,s[8:11],s63 offen sc1
s_add_u32 s63,s64,8192
v_permlane16_swap_b32 v56,v58
v_permlane16_swap_b32 v57,v59
buffer_store_dwordx4 v[56:59],v132,s[8:11],s63 offen sc1
s_add_u32 s63,s64,16384
v_permlane16_swap_b32 v60,v62
v_permlane16_swap_b32 v61,v63
buffer_store_dwordx4 v[60:63],v132,s[8:11],s63 offen sc1
s_add_u32 s63,s64,24576
v_permlane16_swap_b32 v64,v66
v_permlane16_swap_b32 v65,v67
buffer_store_dwordx4 v[64:67],v132,s[8:11],s63 offen sc1
s_add_u32 s63,s64,32768
v_permlane16_swap_b32 v68,v70
v_permlane16_swap_b32 v69,v71
buffer_store_dwordx4 v[68:71],v132,s[8:11],s63 offen sc1
s_lshl_b32 s82,s55,6
s_add_u32 s82,s82,s54
s_lshl_b32 s82,s82,9
s_add_u32 s82,s82,0
s_lshl_b32 s61,s53,2
s_add_u32 s82,s82,s61
s_add_u32 s54,s54,16
R0_LOOPA:
s_add_u32 s66,s54,16
s_min_u32 s66,s66,63
s_mul_i32 s62,s66,40960
buffer_load_dwordx2 v[52:53],v133,s[4:7],s62 offen offset:0
buffer_load_dwordx2 v[54:55],v133,s[4:7],s62 offen offset:128
buffer_load_dwordx2 v[56:57],v133,s[4:7],s62 offen offset:256
buffer_load_dwordx2 v[58:59],v133,s[4:7],s62 offen offset:384
buffer_load_dwordx2 v[60:61],v133,s[4:7],s62 offen offset:512
buffer_load_dwordx2 v[62:63],v133,s[4:7],s62 offen offset:640
buffer_load_dwordx2 v[64:65],v133,s[4:7],s62 offen offset:768
buffer_load_dwordx2 v[66:67],v133,s[4:7],s62 offen offset:896
buffer_load_dwordx2 v[68:69],v133,s[4:7],s62 offen offset:1024
buffer_load_dwordx2 v[70:71],v133,s[4:7],s62 offen offset:1152
s_mul_i32 s64,s54,40960
s_add_u32 s64,s64,234749952
s_mul_i32 s65,s54,46080
s_add_u32 s65,s65,206569472
s_waitcnt vmcnt(10)
s_mov_b64 exec,1
buffer_store_dword v5,v1,s[8:11],s82 offen sc1
s_mov_b64 exec,-1
v_lshlrev_b32 v72,16,v32
v_and_b32 v73,0xffff0000,v32
v_lshlrev_b32 v74,16,v33
v_and_b32 v75,0xffff0000,v33
v_lshlrev_b32 v76,16,v34
v_and_b32 v77,0xffff0000,v34
v_lshlrev_b32 v78,16,v35
v_and_b32 v79,0xffff0000,v35
v_lshlrev_b32 v80,16,v36
v_and_b32 v81,0xffff0000,v36
v_lshlrev_b32 v82,16,v37
v_and_b32 v83,0xffff0000,v37
v_lshlrev_b32 v84,16,v38
v_and_b32 v85,0xffff0000,v38
v_lshlrev_b32 v86,16,v39
v_and_b32 v87,0xffff0000,v39
v_lshlrev_b32 v88,16,v40
v_and_b32 v89,0xffff0000,v40
v_lshlrev_b32 v90,16,v41
v_and_b32 v91,0xffff0000,v41
v_lshlrev_b32 v92,16,v42
v_and_b32 v93,0xffff0000,v42
v_lshlrev_b32 v94,16,v43
v_and_b32 v95,0xffff0000,v43
v_lshlrev_b32 v96,16,v44
v_and_b32 v97,0xffff0000,v44
v_lshlrev_b32 v98,16,v45
v_and_b32 v99,0xffff0000,v45
v_lshlrev_b32 v100,16,v46
v_and_b32 v101,0xffff0000,v46
v_lshlrev_b32 v102,16,v47
v_and_b32 v103,0xffff0000,v47
v_lshlrev_b32 v104,16,v48
v_and_b32 v105,0xffff0000,v48
v_lshlrev_b32 v106,16,v49
v_and_b32 v107,0xffff0000,v49
v_lshlrev_b32 v108,16,v50
v_and_b32 v109,0xffff0000,v50
v_lshlrev_b32 v110,16,v51
v_and_b32 v111,0xffff0000,v51
v_pk_add_f32 v[28:29],v[72:73],v[74:75]
v_pk_mul_f32 v[26:27],v[72:73],v[72:73]
v_pk_fma_f32 v[26:27],v[74:75],v[74:75],v[26:27]
v_pk_add_f32 v[28:29],v[28:29],v[76:77]
v_pk_fma_f32 v[26:27],v[76:77],v[76:77],v[26:27]
v_pk_add_f32 v[28:29],v[28:29],v[78:79]
v_pk_fma_f32 v[26:27],v[78:79],v[78:79],v[26:27]
v_pk_add_f32 v[28:29],v[28:29],v[80:81]
v_pk_fma_f32 v[26:27],v[80:81],v[80:81],v[26:27]
v_pk_add_f32 v[28:29],v[28:29],v[82:83]
v_pk_fma_f32 v[26:27],v[82:83],v[82:83],v[26:27]
v_pk_add_f32 v[28:29],v[28:29],v[84:85]
v_pk_fma_f32 v[26:27],v[84:85],v[84:85],v[26:27]
v_pk_add_f32 v[28:29],v[28:29],v[86:87]
v_pk_fma_f32 v[26:27],v[86:87],v[86:87],v[26:27]
v_pk_add_f32 v[28:29],v[28:29],v[88:89]
v_pk_fma_f32 v[26:27],v[88:89],v[88:89],v[26:27]
v_pk_add_f32 v[28:29],v[28:29],v[90:91]
v_pk_fma_f32 v[26:27],v[90:91],v[90:91],v[26:27]
v_pk_add_f32 v[28:29],v[28:29],v[92:93]
v_pk_fma_f32 v[26:27],v[92:93],v[92:93],v[26:27]
v_pk_add_f32 v[28:29],v[28:29],v[94:95]
v_pk_fma_f32 v[26:27],v[94:95],v[94:95],v[26:27]
v_pk_add_f32 v[28:29],v[28:29],v[96:97]
v_pk_fma_f32 v[26:27],v[96:97],v[96:97],v[26:27]
v_pk_add_f32 v[28:29],v[28:29],v[98:99]
v_pk_fma_f32 v[26:27],v[98:99],v[98:99],v[26:27]
v_pk_add_f32 v[28:29],v[28:29],v[100:101]
v_pk_fma_f32 v[26:27],v[100:101],v[100:101],v[26:27]
v_pk_add_f32 v[28:29],v[28:29],v[102:103]
v_pk_fma_f32 v[26:27],v[102:103],v[102:103],v[26:27]
v_pk_add_f32 v[28:29],v[28:29],v[104:105]
v_pk_fma_f32 v[26:27],v[104:105],v[104:105],v[26:27]
v_pk_add_f32 v[28:29],v[28:29],v[106:107]
v_pk_fma_f32 v[26:27],v[106:107],v[106:107],v[26:27]
v_pk_add_f32 v[28:29],v[28:29],v[108:109]
v_pk_fma_f32 v[26:27],v[108:109],v[108:109],v[26:27]
v_pk_add_f32 v[28:29],v[28:29],v[110:111]
v_pk_fma_f32 v[26:27],v[110:111],v[110:111],v[26:27]
v_add_f32 v24,v28,v29
v_add_f32 v25,v26,v27
s_nop 0
v_add_f32_dpp v24,v24,v24 row_ror:4 row_mask:0xf bank_mask:0xf
v_add_f32_dpp v25,v25,v25 row_ror:4 row_mask:0xf bank_mask:0xf
s_nop 0
v_add_f32_dpp v24,v24,v24 row_ror:8 row_mask:0xf bank_mask:0xf
v_add_f32_dpp v25,v25,v25 row_ror:8 row_mask:0xf bank_mask:0xf
v_mov_b32 v26,v24
v_mov_b32 v27,v25
s_nop 0
v_permlane32_swap_b32 v24,v26
v_permlane32_swap_b32 v25,v27
v_add_f32 v24,v24,v26
v_add_f32 v25,v25,v27
v_mov_b32 v26,v24
v_mov_b32 v27,v25
s_nop 0
v_permlane16_swap_b32 v24,v26
v_permlane16_swap_b32 v25,v27
v_add_f32 v24,v24,v26
v_add_f32 v25,v25,v27
v_mul_f32 v24,0x3acccccd,v24
v_mul_f32 v25,0x3acccccd,v25
v_fma_f32 v25,-v24,v24,v25
v_max_f32 v25,0,v25
v_cvt_pk_bf16_f32 v6,v24,v25
v_lshlrev_b32 v24,16,v6
v_and_b32 v25,0xffff0000,v6
v_add_f32 v25,0x3727c5ac,v25
v_cvt_pk_bf16_f32 v6,v25,v25
v_lshlrev_b32 v25,16,v6
v_sqrt_f32 v25,v25
s_nop 0
v_cvt_pk_bf16_f32 v6,v25,v25
v_lshlrev_b32 v25,16,v6
v_rcp_f32 v25,v25
s_nop 0
v_pk_add_f32 v[72:73],v[72:73],v[24:25] op_sel_hi:[1,0] neg_lo:[0,1] neg_hi:[0,1]
v_pk_add_f32 v[74:75],v[74:75],v[24:25] op_sel_hi:[1,0] neg_lo:[0,1] neg_hi:[0,1]
v_pk_add_f32 v[76:77],v[76:77],v[24:25] op_sel_hi:[1,0] neg_lo:[0,1] neg_hi:[0,1]
v_pk_add_f32 v[78:79],v[78:79],v[24:25] op_sel_hi:[1,0] neg_lo:[0,1] neg_hi:[0,1]
v_pk_add_f32 v[80:81],v[80:81],v[24:25] op_sel_hi:[1,0] neg_lo:[0,1] neg_hi:[0,1]
v_pk_add_f32 v[82:83],v[82:83],v[24:25] op_sel_hi:[1,0] neg_lo:[0,1] neg_hi:[0,1]
v_pk_add_f32 v[84:85],v[84:85],v[24:25] op_sel_hi:[1,0] neg_lo:[0,1] neg_hi:[0,1]
v_pk_add_f32 v[86:87],v[86:87],v[24:25] op_sel_hi:[1,0] neg_lo:[0,1] neg_hi:[0,1]
v_pk_add_f32 v[88:89],v[88:89],v[24:25] op_sel_hi:[1,0] neg_lo:[0,1] neg_hi:[0,1]
v_pk_add_f32 v[90:91],v[90:91],v[24:25] op_sel_hi:[1,0] neg_lo:[0,1] neg_hi:[0,1]
v_pk_add_f32 v[92:93],v[92:93],v[24:25] op_sel_hi:[1,0] neg_lo:[0,1] neg_hi:[0,1]
v_pk_add_f32 v[94:95],v[94:95],v[24:25] op_sel_hi:[1,0] neg_lo:[0,1] neg_hi:[0,1]
v_pk_add_f32 v[96:97],v[96:97],v[24:25] op_sel_hi:[1,0] neg_lo:[0,1] neg_hi:[0,1]
v_pk_add_f32 v[98:99],v[98:99],v[24:25] op_sel_hi:[1,0] neg_lo:[0,1] neg_hi:[0,1]
v_pk_add_f32 v[100:101],v[100:101],v[24:25] op_sel_hi:[1,0] neg_lo:[0,1] neg_hi:[0,1]
v_pk_add_f32 v[102:103],v[102:103],v[24:25] op_sel_hi:[1,0] neg_lo:[0,1] neg_hi:[0,1]
v_pk_add_f32 v[104:105],v[104:105],v[24:25] op_sel_hi:[1,0] neg_lo:[0,1] neg_hi:[0,1]
v_pk_add_f32 v[106:107],v[106:107],v[24:25] op_sel_hi:[1,0] neg_lo:[0,1] neg_hi:[0,1]
v_pk_add_f32 v[108:109],v[108:109],v[24:25] op_sel_hi:[1,0] neg_lo:[0,1] neg_hi:[0,1]
v_pk_add_f32 v[110:111],v[110:111],v[24:25] op_sel_hi:[1,0] neg_lo:[0,1] neg_hi:[0,1]
v_cvt_pk_bf16_f32 v6,v72,v73
v_lshlrev_b32 v72,16,v6
v_and_b32 v73,0xffff0000,v6
v_cvt_pk_bf16_f32 v8,v74,v75
v_lshlrev_b32 v74,16,v8
v_and_b32 v75,0xffff0000,v8
v_cvt_pk_bf16_f32 v6,v76,v77
v_lshlrev_b32 v76,16,v6
v_and_b32 v77,0xffff0000,v6
v_cvt_pk_bf16_f32 v8,v78,v79
v_lshlrev_b32 v78,16,v8
v_and_b32 v79,0xffff0000,v8
v_cvt_pk_bf16_f32 v6,v80,v81
v_lshlrev_b32 v80,16,v6
v_and_b32 v81,0xffff0000,v6
v_cvt_pk_bf16_f32 v8,v82,v83
v_lshlrev_b32 v82,16,v8
v_and_b32 v83,0xffff0000,v8
v_cvt_pk_bf16_f32 v6,v84,v85
v_lshlrev_b32 v84,16,v6
v_and_b32 v85,0xffff0000,v6
v_cvt_pk_bf16_f32 v8,v86,v87
v_lshlrev_b32 v86,16,v8
v_and_b32 v87,0xffff0000,v8
v_cvt_pk_bf16_f32 v6,v88,v89
v_lshlrev_b32 v88,16,v6
v_and_b32 v89,0xffff0000,v6
v_cvt_pk_bf16_f32 v8,v90,v91
v_lshlrev_b32 v90,16,v8
v_and_b32 v91,0xffff0000,v8
v_cvt_pk_bf16_f32 v6,v92,v93
v_lshlrev_b32 v92,16,v6
v_and_b32 v93,0xffff0000,v6
v_cvt_pk_bf16_f32 v8,v94,v95
v_lshlrev_b32 v94,16,v8
v_and_b32 v95,0xffff0000,v8
v_cvt_pk_bf16_f32 v6,v96,v97
v_lshlrev_b32 v96,16,v6
v_and_b32 v97,0xffff0000,v6
v_cvt_pk_bf16_f32 v8,v98,v99
v_lshlrev_b32 v98,16,v8
v_and_b32 v99,0xffff0000,v8
v_cvt_pk_bf16_f32 v6,v100,v101
v_lshlrev_b32 v100,16,v6
v_and_b32 v101,0xffff0000,v6
v_cvt_pk_bf16_f32 v8,v102,v103
v_lshlrev_b32 v102,16,v8
v_and_b32 v103,0xffff0000,v8
v_cvt_pk_bf16_f32 v6,v104,v105
v_lshlrev_b32 v104,16,v6
v_and_b32 v105,0xffff0000,v6
v_cvt_pk_bf16_f32 v8,v106,v107
v_lshlrev_b32 v106,16,v8
v_and_b32 v107,0xffff0000,v8
v_cvt_pk_bf16_f32 v6,v108,v109
v_lshlrev_b32 v108,16,v6
v_and_b32 v109,0xffff0000,v6
v_cvt_pk_bf16_f32 v8,v110,v111
v_lshlrev_b32 v110,16,v8
v_and_b32 v111,0xffff0000,v8
v_pk_mul_f32 v[72:73],v[72:73],v[24:25] op_sel:[0,1] op_sel_hi:[1,1]
v_pk_mul_f32 v[74:75],v[74:75],v[24:25] op_sel:[0,1] op_sel_hi:[1,1]
v_pk_mul_f32 v[76:77],v[76:77],v[24:25] op_sel:[0,1] op_sel_hi:[1,1]
v_pk_mul_f32 v[78:79],v[78:79],v[24:25] op_sel:[0,1] op_sel_hi:[1,1]
v_pk_mul_f32 v[80:81],v[80:81],v[24:25] op_sel:[0,1] op_sel_hi:[1,1]
v_pk_mul_f32 v[82:83],v[82:83],v[24:25] op_sel:[0,1] op_sel_hi:[1,1]
v_pk_mul_f32 v[84:85],v[84:85],v[24:25] op_sel:[0,1] op_sel_hi:[1,1]
v_pk_mul_f32 v[86:87],v[86:87],v[24:25] op_sel:[0,1] op_sel_hi:[1,1]
v_pk_mul_f32 v[88:89],v[88:89],v[24:25] op_sel:[0,1] op_sel_hi:[1,1]
v_pk_mul_f32 v[90:91],v[90:91],v[24:25] op_sel:[0,1] op_sel_hi:[1,1]
v_pk_mul_f32 v[92:93],v[92:93],v[24:25] op_sel:[0,1] op_sel_hi:[1,1]
v_pk_mul_f32 v[94:95],v[94:95],v[24:25] op_sel:[0,1] op_sel_hi:[1,1]
v_pk_mul_f32 v[96:97],v[96:97],v[24:25] op_sel:[0,1] op_sel_hi:[1,1]
v_pk_mul_f32 v[98:99],v[98:99],v[24:25] op_sel:[0,1] op_sel_hi:[1,1]
v_pk_mul_f32 v[100:101],v[100:101],v[24:25] op_sel:[0,1] op_sel_hi:[1,1]
v_pk_mul_f32 v[102:103],v[102:103],v[24:25] op_sel:[0,1] op_sel_hi:[1,1]
v_pk_mul_f32 v[104:105],v[104:105],v[24:25] op_sel:[0,1] op_sel_hi:[1,1]
v_pk_mul_f32 v[106:107],v[106:107],v[24:25] op_sel:[0,1] op_sel_hi:[1,1]
v_pk_mul_f32 v[108:109],v[108:109],v[24:25] op_sel:[0,1] op_sel_hi:[1,1]
v_pk_mul_f32 v[110:111],v[110:111],v[24:25] op_sel:[0,1] op_sel_hi:[1,1]
v_cvt_pk_bf16_f32 v112,v72,v73
v_lshlrev_b32 v72,16,v112
v_and_b32 v73,0xffff0000,v112
v_cvt_pk_bf16_f32 v113,v74,v75
v_lshlrev_b32 v74,16,v113
v_and_b32 v75,0xffff0000,v113
v_cvt_pk_bf16_f32 v114,v76,v77
v_lshlrev_b32 v76,16,v114
v_and_b32 v77,0xffff0000,v114
v_cvt_pk_bf16_f32 v115,v78,v79
v_lshlrev_b32 v78,16,v115
v_and_b32 v79,0xffff0000,v115
v_cvt_pk_bf16_f32 v116,v80,v81
v_lshlrev_b32 v80,16,v116
v_and_b32 v81,0xffff0000,v116
v_cvt_pk_bf16_f32 v117,v82,v83
v_lshlrev_b32 v82,16,v117
v_and_b32 v83,0xffff0000,v117
v_cvt_pk_bf16_f32 v118,v84,v85
v_lshlrev_b32 v84,16,v118
v_and_b32 v85,0xffff0000,v118
v_cvt_pk_bf16_f32 v119,v86,v87
v_lshlrev_b32 v86,16,v119
v_and_b32 v87,0xffff0000,v119
v_cvt_pk_bf16_f32 v120,v88,v89
v_lshlrev_b32 v88,16,v120
v_and_b32 v89,0xffff0000,v120
v_cvt_pk_bf16_f32 v121,v90,v91
v_lshlrev_b32 v90,16,v121
v_and_b32 v91,0xffff0000,v121
v_cvt_pk_bf16_f32 v122,v92,v93
v_lshlrev_b32 v92,16,v122
v_and_b32 v93,0xffff0000,v122
v_cvt_pk_bf16_f32 v123,v94,v95
v_lshlrev_b32 v94,16,v123
v_and_b32 v95,0xffff0000,v123
v_cvt_pk_bf16_f32 v124,v96,v97
v_lshlrev_b32 v96,16,v124
v_and_b32 v97,0xffff0000,v124
v_cvt_pk_bf16_f32 v125,v98,v99
v_lshlrev_b32 v98,16,v125
v_and_b32 v99,0xffff0000,v125
v_cvt_pk_bf16_f32 v126,v100,v101
v_lshlrev_b32 v100,16,v126
v_and_b32 v101,0xffff0000,v126
v_cvt_pk_bf16_f32 v127,v102,v103
v_lshlrev_b32 v102,16,v127
v_and_b32 v103,0xffff0000,v127
v_cvt_pk_bf16_f32 v128,v104,v105
v_lshlrev_b32 v104,16,v128
v_and_b32 v105,0xffff0000,v128
v_cvt_pk_bf16_f32 v129,v106,v107
v_lshlrev_b32 v106,16,v129
v_and_b32 v107,0xffff0000,v129
v_cvt_pk_bf16_f32 v130,v108,v109
v_lshlrev_b32 v108,16,v130
v_and_b32 v109,0xffff0000,v130
v_cvt_pk_bf16_f32 v131,v110,v111
v_lshlrev_b32 v110,16,v131
v_and_b32 v111,0xffff0000,v131
s_add_u32 s63,s65,0
v_permlane16_swap_b32 v112,v114
v_permlane16_swap_b32 v113,v115
buffer_store_dwordx4 v[112:115],v132,s[8:11],s63 offen sc1
s_add_u32 s63,s65,8192
v_permlane16_swap_b32 v116,v118
v_permlane16_swap_b32 v117,v119
buffer_store_dwordx4 v[116:119],v132,s[8:11],s63 offen sc1
s_add_u32 s63,s65,16384
v_permlane16_swap_b32 v120,v122
v_permlane16_swap_b32 v121,v123
buffer_store_dwordx4 v[120:123],v132,s[8:11],s63 offen sc1
s_add_u32 s63,s65,24576
v_permlane16_swap_b32 v124,v126
v_permlane16_swap_b32 v125,v127
buffer_store_dwordx4 v[124:127],v132,s[8:11],s63 offen sc1
s_add_u32 s63,s65,32768
v_permlane16_swap_b32 v128,v130
v_permlane16_swap_b32 v129,v131
buffer_store_dwordx4 v[128:131],v132,s[8:11],s63 offen sc1
s_add_u32 s63,s64,0
v_permlane16_swap_b32 v32,v34
v_permlane16_swap_b32 v33,v35
buffer_store_dwordx4 v[32:35],v132,s[8:11],s63 offen sc1
s_add_u32 s63,s64,8192
v_permlane16_swap_b32 v36,v38
v_permlane16_swap_b32 v37,v39
buffer_store_dwordx4 v[36:39],v132,s[8:11],s63 offen sc1
s_add_u32 s63,s64,16384
v_permlane16_swap_b32 v40,v42
v_permlane16_swap_b32 v41,v43
buffer_store_dwordx4 v[40:43],v132,s[8:11],s63 offen sc1
s_add_u32 s63,s64,24576
v_permlane16_swap_b32 v44,v46
v_permlane16_swap_b32 v45,v47
buffer_store_dwordx4 v[44:47],v132,s[8:11],s63 offen sc1
s_add_u32 s63,s64,32768
v_permlane16_swap_b32 v48,v50
v_permlane16_swap_b32 v49,v51
buffer_store_dwordx4 v[48:51],v132,s[8:11],s63 offen sc1
s_lshl_b32 s82,s55,6
s_add_u32 s82,s82,s54
s_lshl_b32 s82,s82,9
s_add_u32 s82,s82,0
s_lshl_b32 s61,s53,2
s_add_u32 s82,s82,s61
s_add_u32 s54,s54,16
s_cmp_ge_u32 s54,64
s_cbranch_scc1 R0_ENDA
s_add_u32 s66,s54,16
s_min_u32 s66,s66,63
s_mul_i32 s62,s66,40960
buffer_load_dwordx2 v[32:33],v133,s[4:7],s62 offen offset:0
buffer_load_dwordx2 v[34:35],v133,s[4:7],s62 offen offset:128
buffer_load_dwordx2 v[36:37],v133,s[4:7],s62 offen offset:256
buffer_load_dwordx2 v[38:39],v133,s[4:7],s62 offen offset:384
buffer_load_dwordx2 v[40:41],v133,s[4:7],s62 offen offset:512
buffer_load_dwordx2 v[42:43],v133,s[4:7],s62 offen offset:640
buffer_load_dwordx2 v[44:45],v133,s[4:7],s62 offen offset:768
buffer_load_dwordx2 v[46:47],v133,s[4:7],s62 offen offset:896
buffer_load_dwordx2 v[48:49],v133,s[4:7],s62 offen offset:1024
buffer_load_dwordx2 v[50:51],v133,s[4:7],s62 offen offset:1152
s_mul_i32 s64,s54,40960
s_add_u32 s64,s64,234749952
s_mul_i32 s65,s54,46080
s_add_u32 s65,s65,206569472
s_waitcnt vmcnt(10)
s_mov_b64 exec,1
buffer_store_dword v5,v1,s[8:11],s82 offen sc1
s_mov_b64 exec,-1
v_lshlrev_b32 v72,16,v52
v_and_b32 v73,0xffff0000,v52
v_lshlrev_b32 v74,16,v53
v_and_b32 v75,0xffff0000,v53
v_lshlrev_b32 v76,16,v54
v_and_b32 v77,0xffff0000,v54
v_lshlrev_b32 v78,16,v55
v_and_b32 v79,0xffff0000,v55
v_lshlrev_b32 v80,16,v56
v_and_b32 v81,0xffff0000,v56
v_lshlrev_b32 v82,16,v57
v_and_b32 v83,0xffff0000,v57
v_lshlrev_b32 v84,16,v58
v_and_b32 v85,0xffff0000,v58
v_lshlrev_b32 v86,16,v59
v_and_b32 v87,0xffff0000,v59
v_lshlrev_b32 v88,16,v60
v_and_b32 v89,0xffff0000,v60
v_lshlrev_b32 v90,16,v61
v_and_b32 v91,0xffff0000,v61
v_lshlrev_b32 v92,16,v62
v_and_b32 v93,0xffff0000,v62
v_lshlrev_b32 v94,16,v63
v_and_b32 v95,0xffff0000,v63
v_lshlrev_b32 v96,16,v64
v_and_b32 v97,0xffff0000,v64
v_lshlrev_b32 v98,16,v65
v_and_b32 v99,0xffff0000,v65
v_lshlrev_b32 v100,16,v66
v_and_b32 v101,0xffff0000,v66
v_lshlrev_b32 v102,16,v67
v_and_b32 v103,0xffff0000,v67
v_lshlrev_b32 v104,16,v68
v_and_b32 v105,0xffff0000,v68
v_lshlrev_b32 v106,16,v69
v_and_b32 v107,0xffff0000,v69
v_lshlrev_b32 v108,16,v70
v_and_b32 v109,0xffff0000,v70
v_lshlrev_b32 v110,16,v71
v_and_b32 v111,0xffff0000,v71
v_pk_add_f32 v[28:29],v[72:73],v[74:75]
v_pk_mul_f32 v[26:27],v[72:73],v[72:73]
v_pk_fma_f32 v[26:27],v[74:75],v[74:75],v[26:27]
v_pk_add_f32 v[28:29],v[28:29],v[76:77]
v_pk_fma_f32 v[26:27],v[76:77],v[76:77],v[26:27]
v_pk_add_f32 v[28:29],v[28:29],v[78:79]
v_pk_fma_f32 v[26:27],v[78:79],v[78:79],v[26:27]
v_pk_add_f32 v[28:29],v[28:29],v[80:81]
v_pk_fma_f32 v[26:27],v[80:81],v[80:81],v[26:27]
v_pk_add_f32 v[28:29],v[28:29],v[82:83]
v_pk_fma_f32 v[26:27],v[82:83],v[82:83],v[26:27]
v_pk_add_f32 v[28:29],v[28:29],v[84:85]
v_pk_fma_f32 v[26:27],v[84:85],v[84:85],v[26:27]
v_pk_add_f32 v[28:29],v[28:29],v[86:87]
v_pk_fma_f32 v[26:27],v[86:87],v[86:87],v[26:27]
v_pk_add_f32 v[28:29],v[28:29],v[88:89]
v_pk_fma_f32 v[26:27],v[88:89],v[88:89],v[26:27]
v_pk_add_f32 v[28:29],v[28:29],v[90:91]
v_pk_fma_f32 v[26:27],v[90:91],v[90:91],v[26:27]
v_pk_add_f32 v[28:29],v[28:29],v[92:93]
v_pk_fma_f32 v[26:27],v[92:93],v[92:93],v[26:27]
v_pk_add_f32 v[28:29],v[28:29],v[94:95]
v_pk_fma_f32 v[26:27],v[94:95],v[94:95],v[26:27]
v_pk_add_f32 v[28:29],v[28:29],v[96:97]
v_pk_fma_f32 v[26:27],v[96:97],v[96:97],v[26:27]
v_pk_add_f32 v[28:29],v[28:29],v[98:99]
v_pk_fma_f32 v[26:27],v[98:99],v[98:99],v[26:27]
v_pk_add_f32 v[28:29],v[28:29],v[100:101]
v_pk_fma_f32 v[26:27],v[100:101],v[100:101],v[26:27]
v_pk_add_f32 v[28:29],v[28:29],v[102:103]
v_pk_fma_f32 v[26:27],v[102:103],v[102:103],v[26:27]
v_pk_add_f32 v[28:29],v[28:29],v[104:105]
v_pk_fma_f32 v[26:27],v[104:105],v[104:105],v[26:27]
v_pk_add_f32 v[28:29],v[28:29],v[106:107]
v_pk_fma_f32 v[26:27],v[106:107],v[106:107],v[26:27]
v_pk_add_f32 v[28:29],v[28:29],v[108:109]
v_pk_fma_f32 v[26:27],v[108:109],v[108:109],v[26:27]
v_pk_add_f32 v[28:29],v[28:29],v[110:111]
v_pk_fma_f32 v[26:27],v[110:111],v[110:111],v[26:27]
v_add_f32 v24,v28,v29
v_add_f32 v25,v26,v27
s_nop 0
v_add_f32_dpp v24,v24,v24 row_ror:4 row_mask:0xf bank_mask:0xf
v_add_f32_dpp v25,v25,v25 row_ror:4 row_mask:0xf bank_mask:0xf
s_nop 0
v_add_f32_dpp v24,v24,v24 row_ror:8 row_mask:0xf bank_mask:0xf
v_add_f32_dpp v25,v25,v25 row_ror:8 row_mask:0xf bank_mask:0xf
v_mov_b32 v26,v24
v_mov_b32 v27,v25
s_nop 0
v_permlane32_swap_b32 v24,v26
v_permlane32_swap_b32 v25,v27
v_add_f32 v24,v24,v26
v_add_f32 v25,v25,v27
v_mov_b32 v26,v24
v_mov_b32 v27,v25
s_nop 0
v_permlane16_swap_b32 v24,v26
v_permlane16_swap_b32 v25,v27
v_add_f32 v24,v24,v26
v_add_f32 v25,v25,v27
v_mul_f32 v24,0x3acccccd,v24
v_mul_f32 v25,0x3acccccd,v25
v_fma_f32 v25,-v24,v24,v25
v_max_f32 v25,0,v25
v_cvt_pk_bf16_f32 v6,v24,v25
v_lshlrev_b32 v24,16,v6
v_and_b32 v25,0xffff0000,v6
v_add_f32 v25,0x3727c5ac,v25
v_cvt_pk_bf16_f32 v6,v25,v25
v_lshlrev_b32 v25,16,v6
v_sqrt_f32 v25,v25
s_nop 0
v_cvt_pk_bf16_f32 v6,v25,v25
v_lshlrev_b32 v25,16,v6
v_rcp_f32 v25,v25
s_nop 0
v_pk_add_f32 v[72:73],v[72:73],v[24:25] op_sel_hi:[1,0] neg_lo:[0,1] neg_hi:[0,1]
v_pk_add_f32 v[74:75],v[74:75],v[24:25] op_sel_hi:[1,0] neg_lo:[0,1] neg_hi:[0,1]
v_pk_add_f32 v[76:77],v[76:77],v[24:25] op_sel_hi:[1,0] neg_lo:[0,1] neg_hi:[0,1]
v_pk_add_f32 v[78:79],v[78:79],v[24:25] op_sel_hi:[1,0] neg_lo:[0,1] neg_hi:[0,1]
v_pk_add_f32 v[80:81],v[80:81],v[24:25] op_sel_hi:[1,0] neg_lo:[0,1] neg_hi:[0,1]
v_pk_add_f32 v[82:83],v[82:83],v[24:25] op_sel_hi:[1,0] neg_lo:[0,1] neg_hi:[0,1]
v_pk_add_f32 v[84:85],v[84:85],v[24:25] op_sel_hi:[1,0] neg_lo:[0,1] neg_hi:[0,1]
v_pk_add_f32 v[86:87],v[86:87],v[24:25] op_sel_hi:[1,0] neg_lo:[0,1] neg_hi:[0,1]
v_pk_add_f32 v[88:89],v[88:89],v[24:25] op_sel_hi:[1,0] neg_lo:[0,1] neg_hi:[0,1]
v_pk_add_f32 v[90:91],v[90:91],v[24:25] op_sel_hi:[1,0] neg_lo:[0,1] neg_hi:[0,1]
v_pk_add_f32 v[92:93],v[92:93],v[24:25] op_sel_hi:[1,0] neg_lo:[0,1] neg_hi:[0,1]
v_pk_add_f32 v[94:95],v[94:95],v[24:25] op_sel_hi:[1,0] neg_lo:[0,1] neg_hi:[0,1]
v_pk_add_f32 v[96:97],v[96:97],v[24:25] op_sel_hi:[1,0] neg_lo:[0,1] neg_hi:[0,1]
v_pk_add_f32 v[98:99],v[98:99],v[24:25] op_sel_hi:[1,0] neg_lo:[0,1] neg_hi:[0,1]
v_pk_add_f32 v[100:101],v[100:101],v[24:25] op_sel_hi:[1,0] neg_lo:[0,1] neg_hi:[0,1]
v_pk_add_f32 v[102:103],v[102:103],v[24:25] op_sel_hi:[1,0] neg_lo:[0,1] neg_hi:[0,1]
v_pk_add_f32 v[104:105],v[104:105],v[24:25] op_sel_hi:[1,0] neg_lo:[0,1] neg_hi:[0,1]
v_pk_add_f32 v[106:107],v[106:107],v[24:25] op_sel_hi:[1,0] neg_lo:[0,1] neg_hi:[0,1]
v_pk_add_f32 v[108:109],v[108:109],v[24:25] op_sel_hi:[1,0] neg_lo:[0,1] neg_hi:[0,1]
v_pk_add_f32 v[110:111],v[110:111],v[24:25] op_sel_hi:[1,0] neg_lo:[0,1] neg_hi:[0,1]
v_cvt_pk_bf16_f32 v6,v72,v73
v_lshlrev_b32 v72,16,v6
v_and_b32 v73,0xffff0000,v6
v_cvt_pk_bf16_f32 v8,v74,v75
v_lshlrev_b32 v74,16,v8
v_and_b32 v75,0xffff0000,v8
v_cvt_pk_bf16_f32 v6,v76,v77
v_lshlrev_b32 v76,16,v6
v_and_b32 v77,0xffff0000,v6
v_cvt_pk_bf16_f32 v8,v78,v79
v_lshlrev_b32 v78,16,v8
v_and_b32 v79,0xffff0000,v8
v_cvt_pk_bf16_f32 v6,v80,v81
v_lshlrev_b32 v80,16,v6
v_and_b32 v81,0xffff0000,v6
v_cvt_pk_bf16_f32 v8,v82,v83
v_lshlrev_b32 v82,16,v8
v_and_b32 v83,0xffff0000,v8
v_cvt_pk_bf16_f32 v6,v84,v85
v_lshlrev_b32 v84,16,v6
v_and_b32 v85,0xffff0000,v6
v_cvt_pk_bf16_f32 v8,v86,v87
v_lshlrev_b32 v86,16,v8
v_and_b32 v87,0xffff0000,v8
v_cvt_pk_bf16_f32 v6,v88,v89
v_lshlrev_b32 v88,16,v6
v_and_b32 v89,0xffff0000,v6
v_cvt_pk_bf16_f32 v8,v90,v91
v_lshlrev_b32 v90,16,v8
v_and_b32 v91,0xffff0000,v8
v_cvt_pk_bf16_f32 v6,v92,v93
v_lshlrev_b32 v92,16,v6
v_and_b32 v93,0xffff0000,v6
v_cvt_pk_bf16_f32 v8,v94,v95
v_lshlrev_b32 v94,16,v8
v_and_b32 v95,0xffff0000,v8
v_cvt_pk_bf16_f32 v6,v96,v97
v_lshlrev_b32 v96,16,v6
v_and_b32 v97,0xffff0000,v6
v_cvt_pk_bf16_f32 v8,v98,v99
v_lshlrev_b32 v98,16,v8
v_and_b32 v99,0xffff0000,v8
v_cvt_pk_bf16_f32 v6,v100,v101
v_lshlrev_b32 v100,16,v6
v_and_b32 v101,0xffff0000,v6
v_cvt_pk_bf16_f32 v8,v102,v103
v_lshlrev_b32 v102,16,v8
v_and_b32 v103,0xffff0000,v8
v_cvt_pk_bf16_f32 v6,v104,v105
v_lshlrev_b32 v104,16,v6
v_and_b32 v105,0xffff0000,v6
v_cvt_pk_bf16_f32 v8,v106,v107
v_lshlrev_b32 v106,16,v8
v_and_b32 v107,0xffff0000,v8
v_cvt_pk_bf16_f32 v6,v108,v109
v_lshlrev_b32 v108,16,v6
v_and_b32 v109,0xffff0000,v6
v_cvt_pk_bf16_f32 v8,v110,v111
v_lshlrev_b32 v110,16,v8
v_and_b32 v111,0xffff0000,v8
v_pk_mul_f32 v[72:73],v[72:73],v[24:25] op_sel:[0,1] op_sel_hi:[1,1]
v_pk_mul_f32 v[74:75],v[74:75],v[24:25] op_sel:[0,1] op_sel_hi:[1,1]
v_pk_mul_f32 v[76:77],v[76:77],v[24:25] op_sel:[0,1] op_sel_hi:[1,1]
v_pk_mul_f32 v[78:79],v[78:79],v[24:25] op_sel:[0,1] op_sel_hi:[1,1]
v_pk_mul_f32 v[80:81],v[80:81],v[24:25] op_sel:[0,1] op_sel_hi:[1,1]
v_pk_mul_f32 v[82:83],v[82:83],v[24:25] op_sel:[0,1] op_sel_hi:[1,1]
v_pk_mul_f32 v[84:85],v[84:85],v[24:25] op_sel:[0,1] op_sel_hi:[1,1]
v_pk_mul_f32 v[86:87],v[86:87],v[24:25] op_sel:[0,1] op_sel_hi:[1,1]
v_pk_mul_f32 v[88:89],v[88:89],v[24:25] op_sel:[0,1] op_sel_hi:[1,1]
v_pk_mul_f32 v[90:91],v[90:91],v[24:25] op_sel:[0,1] op_sel_hi:[1,1]
v_pk_mul_f32 v[92:93],v[92:93],v[24:25] op_sel:[0,1] op_sel_hi:[1,1]
v_pk_mul_f32 v[94:95],v[94:95],v[24:25] op_sel:[0,1] op_sel_hi:[1,1]
v_pk_mul_f32 v[96:97],v[96:97],v[24:25] op_sel:[0,1] op_sel_hi:[1,1]
v_pk_mul_f32 v[98:99],v[98:99],v[24:25] op_sel:[0,1] op_sel_hi:[1,1]
v_pk_mul_f32 v[100:101],v[100:101],v[24:25] op_sel:[0,1] op_sel_hi:[1,1]
v_pk_mul_f32 v[102:103],v[102:103],v[24:25] op_sel:[0,1] op_sel_hi:[1,1]
v_pk_mul_f32 v[104:105],v[104:105],v[24:25] op_sel:[0,1] op_sel_hi:[1,1]
v_pk_mul_f32 v[106:107],v[106:107],v[24:25] op_sel:[0,1] op_sel_hi:[1,1]
v_pk_mul_f32 v[108:109],v[108:109],v[24:25] op_sel:[0,1] op_sel_hi:[1,1]
v_pk_mul_f32 v[110:111],v[110:111],v[24:25] op_sel:[0,1] op_sel_hi:[1,1]
v_cvt_pk_bf16_f32 v112,v72,v73
v_lshlrev_b32 v72,16,v112
v_and_b32 v73,0xffff0000,v112
v_cvt_pk_bf16_f32 v113,v74,v75
v_lshlrev_b32 v74,16,v113
v_and_b32 v75,0xffff0000,v113
v_cvt_pk_bf16_f32 v114,v76,v77
v_lshlrev_b32 v76,16,v114
v_and_b32 v77,0xffff0000,v114
v_cvt_pk_bf16_f32 v115,v78,v79
v_lshlrev_b32 v78,16,v115
v_and_b32 v79,0xffff0000,v115
v_cvt_pk_bf16_f32 v116,v80,v81
v_lshlrev_b32 v80,16,v116
v_and_b32 v81,0xffff0000,v116
v_cvt_pk_bf16_f32 v117,v82,v83
v_lshlrev_b32 v82,16,v117
v_and_b32 v83,0xffff0000,v117
v_cvt_pk_bf16_f32 v118,v84,v85
v_lshlrev_b32 v84,16,v118
v_and_b32 v85,0xffff0000,v118
v_cvt_pk_bf16_f32 v119,v86,v87
v_lshlrev_b32 v86,16,v119
v_and_b32 v87,0xffff0000,v119
v_cvt_pk_bf16_f32 v120,v88,v89
v_lshlrev_b32 v88,16,v120
v_and_b32 v89,0xffff0000,v120
v_cvt_pk_bf16_f32 v121,v90,v91
v_lshlrev_b32 v90,16,v121
v_and_b32 v91,0xffff0000,v121
v_cvt_pk_bf16_f32 v122,v92,v93
v_lshlrev_b32 v92,16,v122
v_and_b32 v93,0xffff0000,v122
v_cvt_pk_bf16_f32 v123,v94,v95
v_lshlrev_b32 v94,16,v123
v_and_b32 v95,0xffff0000,v123
v_cvt_pk_bf16_f32 v124,v96,v97
v_lshlrev_b32 v96,16,v124
v_and_b32 v97,0xffff0000,v124
v_cvt_pk_bf16_f32 v125,v98,v99
v_lshlrev_b32 v98,16,v125
v_and_b32 v99,0xffff0000,v125
v_cvt_pk_bf16_f32 v126,v100,v101
v_lshlrev_b32 v100,16,v126
v_and_b32 v101,0xffff0000,v126
v_cvt_pk_bf16_f32 v127,v102,v103
v_lshlrev_b32 v102,16,v127
v_and_b32 v103,0xffff0000,v127
v_cvt_pk_bf16_f32 v128,v104,v105
v_lshlrev_b32 v104,16,v128
v_and_b32 v105,0xffff0000,v128
v_cvt_pk_bf16_f32 v129,v106,v107
v_lshlrev_b32 v106,16,v129
v_and_b32 v107,0xffff0000,v129
v_cvt_pk_bf16_f32 v130,v108,v109
v_lshlrev_b32 v108,16,v130
v_and_b32 v109,0xffff0000,v130
v_cvt_pk_bf16_f32 v131,v110,v111
v_lshlrev_b32 v110,16,v131
v_and_b32 v111,0xffff0000,v131
s_add_u32 s63,s65,0
v_permlane16_swap_b32 v112,v114
v_permlane16_swap_b32 v113,v115
buffer_store_dwordx4 v[112:115],v132,s[8:11],s63 offen sc1
s_add_u32 s63,s65,8192
v_permlane16_swap_b32 v116,v118
v_permlane16_swap_b32 v117,v119
buffer_store_dwordx4 v[116:119],v132,s[8:11],s63 offen sc1
s_add_u32 s63,s65,16384
v_permlane16_swap_b32 v120,v122
v_permlane16_swap_b32 v121,v123
buffer_store_dwordx4 v[120:123],v132,s[8:11],s63 offen sc1
s_add_u32 s63,s65,24576
v_permlane16_swap_b32 v124,v126
v_permlane16_swap_b32 v125,v127
buffer_store_dwordx4 v[124:127],v132,s[8:11],s63 offen sc1
s_add_u32 s63,s65,32768
v_permlane16_swap_b32 v128,v130
v_permlane16_swap_b32 v129,v131
buffer_store_dwordx4 v[128:131],v132,s[8:11],s63 offen sc1
s_add_u32 s63,s64,0
v_permlane16_swap_b32 v52,v54
v_permlane16_swap_b32 v53,v55
buffer_store_dwordx4 v[52:55],v132,s[8:11],s63 offen sc1
s_add_u32 s63,s64,8192
v_permlane16_swap_b32 v56,v58
v_permlane16_swap_b32 v57,v59
buffer_store_dwordx4 v[56:59],v132,s[8:11],s63 offen sc1
s_add_u32 s63,s64,16384
v_permlane16_swap_b32 v60,v62
v_permlane16_swap_b32 v61,v63
buffer_store_dwordx4 v[60:63],v132,s[8:11],s63 offen sc1
s_add_u32 s63,s64,24576
v_permlane16_swap_b32 v64,v66
v_permlane16_swap_b32 v65,v67
buffer_store_dwordx4 v[64:67],v132,s[8:11],s63 offen sc1
s_add_u32 s63,s64,32768
v_permlane16_swap_b32 v68,v70
v_permlane16_swap_b32 v69,v71
buffer_store_dwordx4 v[68:71],v132,s[8:11],s63 offen sc1
s_lshl_b32 s82,s55,6
s_add_u32 s82,s82,s54
s_lshl_b32 s82,s82,9
s_add_u32 s82,s82,0
s_lshl_b32 s61,s53,2
s_add_u32 s82,s82,s61
s_add_u32 s54,s54,16
s_cmp_lt_u32 s54,64
s_cbranch_scc1 R0_LOOPA
R0_ENDA:
s_waitcnt vmcnt(0)
s_mov_b64 exec,1
buffer_store_dword v5,v1,s[8:11],s82 offen sc1
s_mov_b64 exec,-1
s_mov_b32 s52,s86
s_mul_i32 s60,s86,196608
s_add_u32 s69,s69,s60
s_mul_i32 s60,s86,1024
s_add_u32 s70,s70,s60
v_mov_b32 v231,0
s_mov_b32 s83,s100
s_nop 0
ATT_LOOP:
s_lshl_b32 s67,s51,6
s_add_u32 s67,s67,s52
s_lshl_b32 s67,s67,9
s_add_u32 s67,s67,65536
s_mul_i32 s66,s52,393216
s_add_u32 s66,s66,s71
v_cmp_eq_u32 vcc,0,v231
s_nop 0
s_cbranch_vccz ATT_RDY
fb_229:
buffer_load_dword v3,v2,s[8:11],s67 offen sc1
s_waitcnt vmcnt(0)
v_cmp_eq_u32 vcc,0,v3
s_nop 0
s_cbranch_vccz ok_230
s_sleep 20
s_sub_u32 s47,s47,1
s_cbranch_scc1 ABORT
s_branch fb_229
ok_230:
ATT_RDY:
s_add_u32 s63,s66,124780544
buffer_load_dwordx4 v[16:19],v1,s[8:11],s63 offen sc1
buffer_load_dwordx4 v[20:23],v1,s[8:11],s63 offen offset:1024 sc1
buffer_load_dwordx4 v[24:27],v1,s[8:11],s63 offen offset:2048 sc1
buffer_load_dwordx4 v[28:31],v1,s[8:11],s63 offen offset:3072 sc1
s_add_u32 s63,s66,124784640
buffer_load_dwordx4 v[32:35],v1,s[8:11],s63 offen sc1
buffer_load_dwordx4 v[36:39],v1,s[8:11],s63 offen offset:1024 sc1
buffer_load_dwordx4 v[40:43],v1,s[8:11],s63 offen offset:2048 sc1
buffer_load_dwordx4 v[44:47],v1,s[8:11],s63 offen offset:3072 sc1
s_add_u32 s63,s66,124788736
buffer_load_dwordx4 v[48:51],v1,s[8:11],s63 offen sc1
buffer_load_dwordx4 v[52:55],v1,s[8:11],s63 offen offset:1024 sc1
buffer_load_dwordx4 v[56:59],v1,s[8:11],s63 offen offset:2048 sc1
buffer_load_dwordx4 v[60:63],v1,s[8:11],s63 offen offset:3072 sc1
s_add_u32 s63,s66,74448896
buffer_load_dwordx4 v[64:67],v1,s[8:11],s63 offen sc1
buffer_load_dwordx4 v[68:71],v1,s[8:11],s63 offen offset:1024 sc1
buffer_load_dwordx4 v[72:75],v1,s[8:11],s63 offen offset:2048 sc1
buffer_load_dwordx4 v[76:79],v1,s[8:11],s63 offen offset:3072 sc1
s_add_u32 s63,s66,74452992
buffer_load_dwordx4 v[80:83],v1,s[8:11],s63 offen sc1
buffer_load_dwordx4 v[84:87],v1,s[8:11],s63 offen offset:1024 sc1
buffer_load_dwordx4 v[88:91],v1,s[8:11],s63 offen offset:2048 sc1
buffer_load_dwordx4 v[92:95],v1,s[8:11],s63 offen offset:3072 sc1
s_add_u32 s63,s66,74457088
buffer_load_dwordx4 v[96:99],v1,s[8:11],s63 offen sc1
buffer_load_dwordx4 v[100:103],v1,s[8:11],s63 offen offset:1024 sc1
buffer_load_dwordx4 v[104:107],v1,s[8:11],s63 offen offset:2048 sc1
buffer_load_dwordx4 v[108:111],v1,s[8:11],s63 offen offset:3072 sc1
s_add_u32 s63,s66,99614720
buffer_load_dwordx4 v[112:115],v1,s[8:11],s63 offen sc1
buffer_load_dwordx4 v[116:119],v1,s[8:11],s63 offen offset:1024 sc1
buffer_load_dwordx4 v[120:123],v1,s[8:11],s63 offen offset:2048 sc1
buffer_load_dwordx4 v[124:127],v1,s[8:11],s63 offen offset:3072 sc1
s_add_u32 s63,s66,99618816
buffer_load_dwordx4 v[128:131],v1,s[8:11],s63 offen sc1
buffer_load_dwordx4 v[132:135],v1,s[8:11],s63 offen offset:1024 sc1
buffer_load_dwordx4 v[136:139],v1,s[8:11],s63 offen offset:2048 sc1
buffer_load_dwordx4 v[140:143],v1,s[8:11],s63 offen offset:3072 sc1
s_add_u32 s63,s66,99622912
buffer_load_dwordx4 v[144:147],v1,s[8:11],s63 offen sc1
buffer_load_dwordx4 v[148:151],v1,s[8:11],s63 offen offset:1024 sc1
buffer_load_dwordx4 v[152:155],v1,s[8:11],s63 offen offset:2048 sc1
buffer_load_dwordx4 v[156:159],v1,s[8:11],s63 offen offset:3072 sc1
v_lshlrev_b32 v232,7,v0
s_add_u32 s63,s66,149946368
buffer_load_dword v233,v232,s[8:11],s63 offen sc1
s_add_u32 s63,s66,149950464
buffer_load_dword v233,v232,s[8:11],s63 offen sc1
s_waitcnt vmcnt(14)
v_mfma_f32_16x16x32_bf16 v[184:187],v[64:67],v[16:19],0
v_mfma_f32_16x16x32_bf16 v[188:191],v[64:67],v[20:23],0
v_mfma_f32_16x16x32_bf16 v[192:195],v[68:71],v[20:23],0
v_mfma_f32_16x16x32_bf16 v[184:187],v[72:75],v[24:27],v[184:187]
v_mfma_f32_16x16x32_bf16 v[188:191],v[72:75],v[28:31],v[188:191]
v_mfma_f32_16x16x32_bf16 v[192:195],v[76:79],v[28:31],v[192:195]
v_mfma_f32_16x16x32_bf16 v[184:187],v[80:83],v[32:35],v[184:187]
v_mfma_f32_16x16x32_bf16 v[188:191],v[80:83],v[36:39],v[188:191]
v_mfma_f32_16x16x32_bf16 v[192:195],v[84:87],v[36:39],v[192:195]
v_mfma_f32_16x16x32_bf16 v[184:187],v[88:91],v[40:43],v[184:187]
v_mfma_f32_16x16x32_bf16 v[188:191],v[88:91],v[44:47],v[188:191]
v_mfma_f32_16x16x32_bf16 v[192:195],v[92:95],v[44:47],v[192:195]
v_mfma_f32_16x16x32_bf16 v[184:187],v[96:99],v[48:51],v[184:187]
v_mfma_f32_16x16x32_bf16 v[188:191],v[96:99],v[52:55],v[188:191]
v_mfma_f32_16x16x32_bf16 v[192:195],v[100:103],v[52:55],v[192:195]
v_mfma_f32_16x16x32_bf16 v[184:187],v[104:107],v[56:59],v[184:187]
v_mfma_f32_16x16x32_bf16 v[188:191],v[104:107],v[60:63],v[188:191]
v_mfma_f32_16x16x32_bf16 v[192:195],v[108:111],v[60:63],v[192:195]
s_nop 1
v_cvt_pk_bf16_f32 v6,v184,v185
v_lshlrev_b32 v184,16,v6
v_and_b32 v185,0xffff0000,v6
v_cvt_pk_bf16_f32 v6,v186,v187
v_lshlrev_b32 v186,16,v6
v_and_b32 v187,0xffff0000,v6
v_cvt_pk_bf16_f32 v6,v188,v189
v_lshlrev_b32 v188,16,v6
v_and_b32 v189,0xffff0000,v6
v_cvt_pk_bf16_f32 v6,v190,v191
v_lshlrev_b32 v190,16,v6
v_and_b32 v191,0xffff0000,v6
v_cvt_pk_bf16_f32 v6,v192,v193
v_lshlrev_b32 v192,16,v6
v_and_b32 v193,0xffff0000,v6
v_cvt_pk_bf16_f32 v6,v194,v195
v_lshlrev_b32 v194,16,v6
v_and_b32 v195,0xffff0000,v6
v_mul_f32 v184,s84,v184
v_mul_f32 v185,s84,v185
v_mul_f32 v186,s84,v186
v_mul_f32 v187,s84,v187
v_mul_f32 v188,s84,v188
v_mul_f32 v189,s84,v189
v_mul_f32 v190,s84,v190
v_mul_f32 v191,s84,v191
v_mul_f32 v192,s84,v192
v_mul_f32 v193,s84,v193
v_mul_f32 v194,s84,v194
v_mul_f32 v195,s84,v195
v_cvt_pk_bf16_f32 v6,v184,v185
v_lshlrev_b32 v184,16,v6
v_and_b32 v185,0xffff0000,v6
v_cvt_pk_bf16_f32 v6,v186,v187
v_lshlrev_b32 v186,16,v6
v_and_b32 v187,0xffff0000,v6
v_cvt_pk_bf16_f32 v6,v188,v189
v_lshlrev_b32 v188,16,v6
v_and_b32 v189,0xffff0000,v6
v_cvt_pk_bf16_f32 v6,v190,v191
v_lshlrev_b32 v190,16,v6
v_and_b32 v191,0xffff0000,v6
v_cvt_pk_bf16_f32 v6,v192,v193
v_lshlrev_b32 v192,16,v6
v_and_b32 v193,0xffff0000,v6
v_cvt_pk_bf16_f32 v6,v194,v195
v_lshlrev_b32 v194,16,v6
v_and_b32 v195,0xffff0000,v6
v_cndmask_b32 v184,v230,v184,s[72:73]
v_cndmask_b32 v185,v230,v185,s[74:75]
v_cndmask_b32 v186,v230,v186,s[76:77]
v_cndmask_b32 v187,v230,v187,s[78:79]
v_cndmask_b32 v192,v230,v192,s[72:73]
v_cndmask_b32 v193,v230,v193,s[74:75]
v_cndmask_b32 v194,v230,v194,s[76:77]
v_cndmask_b32 v195,v230,v195,s[78:79]
v_max3_f32 v241,v188,v189,v190
v_max3_f32 v240,v184,v185,v186
v_max3_f32 v241,v241,v191,v192
v_max_f32 v240,v240,v187
v_max3_f32 v241,v241,v193,v194
v_mov_b32 v244,v240
v_max_f32 v241,v241,v195
s_nop 0
v_permlane32_swap_b32 v240,v244
v_mov_b32 v248,v241
v_max_f32 v240,v240,v244
s_nop 0
v_permlane32_swap_b32 v241,v248
v_mov_b32 v244,v240
v_max_f32 v241,v241,v248
s_nop 0
v_permlane16_swap_b32 v240,v244
v_mov_b32 v248,v241
v_max_f32 v240,v240,v244
s_nop 0
v_permlane16_swap_b32 v241,v248
v_mul_f32 v244,s85,v240
v_max_f32 v241,v241,v248
v_fma_f32 v184,v184,s85,-v244
v_mul_f32 v248,s85,v241
v_fma_f32 v185,v185,s85,-v244
v_fma_f32 v188,v188,s85,-v248
v_fma_f32 v186,v186,s85,-v244
v_fma_f32 v189,v189,s85,-v248
v_fma_f32 v187,v187,s85,-v244
v_fma_f32 v190,v190,s85,-v248
v_exp_f32 v184,v184
v_fma_f32 v191,v191,s85,-v248
v_exp_f32 v185,v185
v_fma_f32 v192,v192,s85,-v248
v_exp_f32 v186,v186
v_fma_f32 v193,v193,s85,-v248
v_exp_f32 v187,v187
v_fma_f32 v194,v194,s85,-v248
v_add_f32 v242,v184,v185
v_fma_f32 v195,v195,s85,-v248
v_add_f32 v242,v242,v186
v_exp_f32 v188,v188
v_add_f32 v242,v242,v187
v_exp_f32 v189,v189
v_exp_f32 v190,v190
v_exp_f32 v191,v191
v_exp_f32 v192,v192
v_exp_f32 v193,v193
v_exp_f32 v194,v194
v_exp_f32 v195,v195
v_add_f32 v243,v188,v189
v_add_f32 v243,v243,v190
v_add_f32 v243,v243,v191
v_add_f32 v243,v243,v192
v_add_f32 v243,v243,v193
v_add_f32 v243,v243,v194
v_add_f32 v243,v243,v195
v_mov_b32 v215,0
v_mov_b32 v225,0
v_mov_b32 v226,0
s_add_u32 s66,s66,149946368
s_lshl_b32 s82,s51,6
s_add_u32 s82,s82,s52
s_lshl_b32 s82,s82,9
s_add_u32 s82,s82,262144
s_lshl_b32 s61,s87,2
s_add_u32 s82,s82,s61
fb_231:
buffer_load_dword v3,v228,s[8:11],s70 offen sc1
s_waitcnt vmcnt(0)
v_cmp_eq_u32 vcc,0,v3
s_nop 0
s_cbranch_vccz ok_232
s_sleep 4
s_sub_u32 s47,s47,1
s_cbranch_scc1 ABORT
s_branch fb_231
ok_232:
buffer_load_dwordx4 v[160:163],v1,s[8:11],s69 offen sc1
buffer_load_dwordx4 v[164:167],v1,s[8:11],s69 offen offset:1024 sc1
buffer_load_dwordx4 v[168:171],v1,s[8:11],s69 offen offset:2048 sc1
s_add_u32 s63,s69,3072
v_lshlrev_b32 v3,3,v0
buffer_load_dwordx4 v[172:175],v1,s[8:11],s63 offen sc1
buffer_load_dwordx2 v[176:177],v3,s[8:11],s63 offen offset:1024 sc1
buffer_load_dwordx4 v[178:181],v1,s[8:11],s63 offen offset:1536 sc1
buffer_load_dwordx2 v[182:183],v3,s[8:11],s63 offen offset:2560 sc1
buffer_load_dword v231,v2,s[8:11],s67 offen offset:1024 sc1
s_waitcnt vmcnt(5)
v_mfma_f32_16x16x32_bf16 v[196:199],v[160:163],v[16:19],0
v_mfma_f32_16x16x32_bf16 v[200:203],v[160:163],v[24:27],0
v_mfma_f32_16x16x32_bf16 v[204:207],v[160:163],v[20:23],0
v_mfma_f32_16x16x32_bf16 v[208:211],v[160:163],v[28:31],0
v_mfma_f32_16x16x32_bf16 v[196:199],v[164:167],v[32:35],v[196:199]
v_mfma_f32_16x16x32_bf16 v[200:203],v[164:167],v[40:43],v[200:203]
v_mfma_f32_16x16x32_bf16 v[204:207],v[164:167],v[36:39],v[204:207]
v_mfma_f32_16x16x32_bf16 v[208:211],v[164:167],v[44:47],v[208:211]
v_mfma_f32_16x16x32_bf16 v[196:199],v[168:171],v[48:51],v[196:199]
v_mfma_f32_16x16x32_bf16 v[200:203],v[168:171],v[56:59],v[200:203]
v_mfma_f32_16x16x32_bf16 v[204:207],v[168:171],v[52:55],v[204:207]
v_mfma_f32_16x16x32_bf16 v[208:211],v[168:171],v[60:63],v[208:211]
s_nop 7
v_add_f32 v204,v204,v210
v_add_f32 v196,v196,v202
v_add_f32 v205,v205,v211
v_add_f32 v197,v197,v203
v_cvt_pk_bf16_f32 v248,v204,v205
v_cvt_pk_bf16_f32 v244,v196,v197
v_lshlrev_b32 v204,16,v248
v_lshlrev_b32 v196,16,v244
v_and_b32 v205,0xffff0000,v248
v_and_b32 v197,0xffff0000,v244
v_mul_f32 v204,s84,v204
v_mul_f32 v196,s84,v196
v_mul_f32 v205,s84,v205
v_mul_f32 v197,s84,v197
v_cvt_pk_bf16_f32 v248,v204,v205
v_cvt_pk_bf16_f32 v244,v196,v197
v_lshlrev_b32 v204,16,v248
v_lshlrev_b32 v196,16,v244
v_and_b32 v205,0xffff0000,v248
v_and_b32 v197,0xffff0000,v244
v_max3_f32 v248,v204,v205,v241
v_max3_f32 v244,v196,v197,v240
v_mov_b32 v249,v248
v_mov_b32 v245,v244
s_nop 0
v_permlane32_swap_b32 v248,v249
v_permlane32_swap_b32 v244,v245
v_max_f32 v248,v248,v249
v_max_f32 v244,v244,v245
v_mov_b32 v249,v248
v_mov_b32 v245,v244
s_nop 0
v_permlane16_swap_b32 v248,v249
v_permlane16_swap_b32 v244,v245
v_max_f32 v248,v248,v249
v_max_f32 v244,v244,v245
v_mul_f32 v248,s85,v248
v_mul_f32 v244,s85,v244
v_fma_f32 v250,v241,s85,-v248
v_fma_f32 v246,v240,s85,-v244
v_fma_f32 v204,v204,s85,-v248
v_fma_f32 v196,v196,s85,-v244
v_fma_f32 v205,v205,s85,-v248
v_fma_f32 v197,v197,s85,-v244
v_exp_f32 v250,v250
v_exp_f32 v246,v246
v_exp_f32 v204,v204
v_exp_f32 v196,v196
v_exp_f32 v205,v205
v_exp_f32 v197,v197
v_fma_f32 v248,v250,v243,v204
v_fma_f32 v244,v246,v242,v196
v_add_f32 v248,v248,v205
v_add_f32 v244,v244,v197
v_mov_b32 v249,v248
v_mov_b32 v245,v244
s_nop 0
v_permlane32_swap_b32 v248,v249
v_permlane32_swap_b32 v244,v245
v_add_f32 v248,v248,v249
v_add_f32 v244,v244,v245
v_mov_b32 v249,v248
v_mov_b32 v245,v244
s_nop 0
v_permlane16_swap_b32 v248,v249
v_permlane16_swap_b32 v244,v245
v_add_f32 v248,v248,v249
v_add_f32 v244,v244,v245
v_rcp_f32 v248,v248
v_rcp_f32 v244,v244
v_mul_f32 v250,v250,v248
v_mul_f32 v246,v246,v244
v_mul_f32 v188,v188,v250
v_mul_f32 v184,v184,v246
v_mul_f32 v189,v189,v250
v_mul_f32 v185,v185,v246
v_mul_f32 v190,v190,v250
v_mul_f32 v186,v186,v246
v_mul_f32 v191,v191,v250
v_mul_f32 v187,v187,v246
v_mul_f32 v192,v192,v250
v_cvt_pk_bf16_f32 v212,v184,v185
v_mul_f32 v193,v193,v250
v_cvt_pk_bf16_f32 v213,v186,v187
v_mul_f32 v194,v194,v250
v_mul_f32 v196,v196,v244
v_mul_f32 v195,v195,v250
v_mul_f32 v197,v197,v244
v_cvt_pk_bf16_f32 v220,v188,v189
v_cvt_pk_bf16_f32 v214,v196,v197
v_cvt_pk_bf16_f32 v221,v190,v191
v_cvt_pk_bf16_f32 v222,v192,v193
v_cvt_pk_bf16_f32 v223,v194,v195
v_mul_f32 v204,v204,v248
v_mul_f32 v205,v205,v248
v_cvt_pk_bf16_f32 v224,v204,v205
v_cvt_pk_bf16_f32 v227,v204,v205
s_waitcnt vmcnt(1)
s_cmp_lg_u32 s49,0
s_cbranch_scc1 ATT_OS
v_mfma_f32_16x16x32_bf16 v[64:67],v[112:115],v[220:223],0
v_mfma_f32_16x16x32_bf16 v[68:71],v[116:119],v[220:223],0
v_mfma_f32_16x16x16_bf16 v[64:67],v[172:173],v[224:225],v[64:67]
v_mov_b32 v114,v172
v_mov_b32 v118,v173
v_mfma_f32_16x16x16_bf16 v[68:71],v[172:173],v[226:227],v[68:71]
v_mfma_f32_16x16x32_bf16 v[72:75],v[120:123],v[220:223],0
v_mfma_f32_16x16x32_bf16 v[76:79],v[124:127],v[220:223],0
v_cvt_pk_bf16_f32 v232,v64,v65
v_cvt_pk_bf16_f32 v233,v66,v67
v_mfma_f32_16x16x16_bf16 v[72:75],v[174:175],v[224:225],v[72:75]
v_mov_b32 v122,v174
v_mov_b32 v126,v175
v_mfma_f32_16x16x16_bf16 v[76:79],v[174:175],v[226:227],v[76:79]
v_cvt_pk_bf16_f32 v234,v68,v69
v_cvt_pk_bf16_f32 v235,v70,v71
s_add_u32 s63,s66,256
v_mfma_f32_16x16x32_bf16 v[80:83],v[128:131],v[220:223],0
buffer_store_dwordx4 v[232:235],v229,s[8:11],s63 offen offset:0
v_mfma_f32_16x16x32_bf16 v[84:87],v[132:135],v[220:223],0
v_cvt_pk_bf16_f32 v236,v72,v73
v_cvt_pk_bf16_f32 v237,v74,v75
v_mfma_f32_16x16x16_bf16 v[80:83],v[176:177],v[224:225],v[80:83]
v_mov_b32 v130,v176
v_mov_b32 v134,v177
v_mfma_f32_16x16x16_bf16 v[84:87],v[176:177],v[226:227],v[84:87]
v_cvt_pk_bf16_f32 v238,v76,v77
v_cvt_pk_bf16_f32 v239,v78,v79
v_mfma_f32_16x16x32_bf16 v[88:91],v[136:139],v[220:223],0
buffer_store_dwordx4 v[236:239],v229,s[8:11],s63 offen offset:2048
v_mfma_f32_16x16x32_bf16 v[92:95],v[140:143],v[220:223],0
v_cvt_pk_bf16_f32 v232,v80,v81
v_cvt_pk_bf16_f32 v233,v82,v83
v_mfma_f32_16x16x16_bf16 v[88:91],v[178:179],v[224:225],v[88:91]
v_mov_b32 v138,v178
v_mov_b32 v142,v179
v_mfma_f32_16x16x16_bf16 v[92:95],v[178:179],v[226:227],v[92:95]
v_cvt_pk_bf16_f32 v234,v84,v85
v_cvt_pk_bf16_f32 v235,v86,v87
s_add_u32 s63,s66,4352
v_mfma_f32_16x16x32_bf16 v[96:99],v[144:147],v[220:223],0
buffer_store_dwordx4 v[232:235],v229,s[8:11],s63 offen offset:0
v_mfma_f32_16x16x32_bf16 v[100:103],v[148:151],v[220:223],0
v_cvt_pk_bf16_f32 v236,v88,v89
v_cvt_pk_bf16_f32 v237,v90,v91
v_mfma_f32_16x16x16_bf16 v[96:99],v[180:181],v[224:225],v[96:99]
v_mov_b32 v146,v180
v_mov_b32 v150,v181
v_mfma_f32_16x16x16_bf16 v[100:103],v[180:181],v[226:227],v[100:103]
v_cvt_pk_bf16_f32 v238,v92,v93
v_cvt_pk_bf16_f32 v239,v94,v95
v_mfma_f32_16x16x32_bf16 v[104:107],v[152:155],v[220:223],0
buffer_store_dwordx4 v[236:239],v229,s[8:11],s63 offen offset:2048
v_mfma_f32_16x16x32_bf16 v[108:111],v[156:159],v[220:223],0
v_cvt_pk_bf16_f32 v232,v96,v97
v_cvt_pk_bf16_f32 v233,v98,v99
v_mfma_f32_16x16x16_bf16 v[104:107],v[182:183],v[224:225],v[104:107]
v_mov_b32 v154,v182
v_mov_b32 v158,v183
v_mfma_f32_16x16x16_bf16 v[108:111],v[182:183],v[226:227],v[108:111]
v_cvt_pk_bf16_f32 v234,v100,v101
v_cvt_pk_bf16_f32 v235,v102,v103
s_add_u32 s63,s66,8448
v_mfma_f32_16x16x32_bf16 v[16:19],v[112:115],v[212:215],0
buffer_store_dwordx4 v[232:235],v229,s[8:11],s63 offen offset:0
v_mfma_f32_16x16x32_bf16 v[20:23],v[116:119],v[212:215],0
v_cvt_pk_bf16_f32 v236,v104,v105
v_cvt_pk_bf16_f32 v237,v106,v107
v_mfma_f32_16x16x32_bf16 v[24:27],v[120:123],v[212:215],0
v_cvt_pk_bf16_f32 v238,v108,v109
v_cvt_pk_bf16_f32 v239,v110,v111
v_mfma_f32_16x16x32_bf16 v[28:31],v[124:127],v[212:215],0
buffer_store_dwordx4 v[236:239],v229,s[8:11],s63 offen offset:2048
v_cvt_pk_bf16_f32 v232,v16,v17
v_mfma_f32_16x16x32_bf16 v[32:35],v[128:131],v[212:215],0
v_cvt_pk_bf16_f32 v233,v18,v19
v_cvt_pk_bf16_f32 v234,v20,v21
v_mfma_f32_16x16x32_bf16 v[36:39],v[132:135],v[212:215],0
v_cvt_pk_bf16_f32 v235,v22,v23
s_add_u32 s63,s66,0
v_mfma_f32_16x16x32_bf16 v[40:43],v[136:139],v[212:215],0
buffer_store_dwordx4 v[232:235],v229,s[8:11],s63 offen offset:0
v_cvt_pk_bf16_f32 v236,v24,v25
v_mfma_f32_16x16x32_bf16 v[44:47],v[140:143],v[212:215],0
v_cvt_pk_bf16_f32 v237,v26,v27
v_cvt_pk_bf16_f32 v238,v28,v29
v_mfma_f32_16x16x32_bf16 v[48:51],v[144:147],v[212:215],0
v_cvt_pk_bf16_f32 v239,v30,v31
buffer_store_dwordx4 v[236:239],v229,s[8:11],s63 offen offset:2048
v_mfma_f32_16x16x32_bf16 v[52:55],v[148:151],v[212:215],0
v_cvt_pk_bf16_f32 v232,v32,v33
v_cvt_pk_bf16_f32 v233,v34,v35
v_mfma_f32_16x16x32_bf16 v[56:59],v[152:155],v[212:215],0
v_cvt_pk_bf16_f32 v234,v36,v37
v_cvt_pk_bf16_f32 v235,v38,v39
s_add_u32 s63,s66,4096
v_mfma_f32_16x16x32_bf16 v[60:63],v[156:159],v[212:215],0
buffer_store_dwordx4 v[232:235],v229,s[8:11],s63 offen offset:0
v_cvt_pk_bf16_f32 v236,v40,v41
v_cvt_pk_bf16_f32 v237,v42,v43
v_cvt_pk_bf16_f32 v238,v44,v45
v_cvt_pk_bf16_f32 v239,v46,v47
buffer_store_dwordx4 v[236:239],v229,s[8:11],s63 offen offset:2048
v_cvt_pk_bf16_f32 v232,v48,v49
v_cvt_pk_bf16_f32 v233,v50,v51
v_cvt_pk_bf16_f32 v234,v52,v53
v_cvt_pk_bf16_f32 v235,v54,v55
s_add_u32 s63,s66,8192
buffer_store_dwordx4 v[232:235],v229,s[8:11],s63 offen offset:0
v_cvt_pk_bf16_f32 v236,v56,v57
v_cvt_pk_bf16_f32 v237,v58,v59
v_cvt_pk_bf16_f32 v238,v60,v61
v_cvt_pk_bf16_f32 v239,v62,v63
buffer_store_dwordx4 v[236:239],v229,s[8:11],s63 offen offset:2048
s_waitcnt vmcnt(0)
s_mov_b64 exec,1
buffer_store_dword v5,v1,s[8:11],s82 offen
s_mov_b64 exec,-1
s_branch ATT_OJ
ATT_OS:
v_mfma_f32_16x16x32_bf16 v[64:67],v[112:115],v[220:223],0
v_mfma_f32_16x16x32_bf16 v[68:71],v[116:119],v[220:223],0
v_mfma_f32_16x16x16_bf16 v[64:67],v[172:173],v[224:225],v[64:67]
v_mov_b32 v114,v172
v_mov_b32 v118,v173
v_mfma_f32_16x16x16_bf16 v[68:71],v[172:173],v[226:227],v[68:71]
v_mfma_f32_16x16x32_bf16 v[72:75],v[120:123],v[220:223],0
v_mfma_f32_16x16x32_bf16 v[76:79],v[124:127],v[220:223],0
v_cvt_pk_bf16_f32 v232,v64,v65
v_cvt_pk_bf16_f32 v233,v66,v67
v_mfma_f32_16x16x16_bf16 v[72:75],v[174:175],v[224:225],v[72:75]
v_mov_b32 v122,v174
v_mov_b32 v126,v175
v_mfma_f32_16x16x16_bf16 v[76:79],v[174:175],v[226:227],v[76:79]
v_cvt_pk_bf16_f32 v234,v68,v69
v_cvt_pk_bf16_f32 v235,v70,v71
s_add_u32 s63,s66,256
v_mfma_f32_16x16x32_bf16 v[80:83],v[128:131],v[220:223],0
buffer_store_dwordx4 v[232:235],v229,s[8:11],s63 offen sc1
v_mfma_f32_16x16x32_bf16 v[84:87],v[132:135],v[220:223],0
v_cvt_pk_bf16_f32 v236,v72,v73
v_cvt_pk_bf16_f32 v237,v74,v75
v_mfma_f32_16x16x16_bf16 v[80:83],v[176:177],v[224:225],v[80:83]
v_mov_b32 v130,v176
v_mov_b32 v134,v177
v_mfma_f32_16x16x16_bf16 v[84:87],v[176:177],v[226:227],v[84:87]
v_cvt_pk_bf16_f32 v238,v76,v77
v_cvt_pk_bf16_f32 v239,v78,v79
v_mfma_f32_16x16x32_bf16 v[88:91],v[136:139],v[220:223],0
buffer_store_dwordx4 v[236:239],v229,s[8:11],s63 offen offset:2048 sc1
v_mfma_f32_16x16x32_bf16 v[92:95],v[140:143],v[220:223],0
v_cvt_pk_bf16_f32 v232,v80,v81
v_cvt_pk_bf16_f32 v233,v82,v83
v_mfma_f32_16x16x16_bf16 v[88:91],v[178:179],v[224:225],v[88:91]
v_mov_b32 v138,v178
v_mov_b32 v142,v179
v_mfma_f32_16x16x16_bf16 v[92:95],v[178:179],v[226:227],v[92:95]
v_cvt_pk_bf16_f32 v234,v84,v85
v_cvt_pk_bf16_f32 v235,v86,v87
s_add_u32 s63,s66,4352
v_mfma_f32_16x16x32_bf16 v[96:99],v[144:147],v[220:223],0
buffer_store_dwordx4 v[232:235],v229,s[8:11],s63 offen sc1
v_mfma_f32_16x16x32_bf16 v[100:103],v[148:151],v[220:223],0
v_cvt_pk_bf16_f32 v236,v88,v89
v_cvt_pk_bf16_f32 v237,v90,v91
v_mfma_f32_16x16x16_bf16 v[96:99],v[180:181],v[224:225],v[96:99]
v_mov_b32 v146,v180
v_mov_b32 v150,v181
v_mfma_f32_16x16x16_bf16 v[100:103],v[180:181],v[226:227],v[100:103]
v_cvt_pk_bf16_f32 v238,v92,v93
v_cvt_pk_bf16_f32 v239,v94,v95
v_mfma_f32_16x16x32_bf16 v[104:107],v[152:155],v[220:223],0
buffer_store_dwordx4 v[236:239],v229,s[8:11],s63 offen offset:2048 sc1
v_mfma_f32_16x16x32_bf16 v[108:111],v[156:159],v[220:223],0
v_cvt_pk_bf16_f32 v232,v96,v97
v_cvt_pk_bf16_f32 v233,v98,v99
v_mfma_f32_16x16x16_bf16 v[104:107],v[182:183],v[224:225],v[104:107]
v_mov_b32 v154,v182
v_mov_b32 v158,v183
v_mfma_f32_16x16x16_bf16 v[108:111],v[182:183],v[226:227],v[108:111]
v_cvt_pk_bf16_f32 v234,v100,v101
v_cvt_pk_bf16_f32 v235,v102,v103
s_add_u32 s63,s66,8448
v_mfma_f32_16x16x32_bf16 v[16:19],v[112:115],v[212:215],0
buffer_store_dwordx4 v[232:235],v229,s[8:11],s63 offen sc1
v_mfma_f32_16x16x32_bf16 v[20:23],v[116:119],v[212:215],0
v_cvt_pk_bf16_f32 v236,v104,v105
v_cvt_pk_bf16_f32 v237,v106,v107
v_mfma_f32_16x16x32_bf16 v[24:27],v[120:123],v[212:215],0
v_cvt_pk_bf16_f32 v238,v108,v109
v_cvt_pk_bf16_f32 v239,v110,v111
v_mfma_f32_16x16x32_bf16 v[28:31],v[124:127],v[212:215],0
buffer_store_dwordx4 v[236:239],v229,s[8:11],s63 offen offset:2048 sc1
v_cvt_pk_bf16_f32 v232,v16,v17
v_mfma_f32_16x16x32_bf16 v[32:35],v[128:131],v[212:215],0
v_cvt_pk_bf16_f32 v233,v18,v19
v_cvt_pk_bf16_f32 v234,v20,v21
v_mfma_f32_16x16x32_bf16 v[36:39],v[132:135],v[212:215],0
v_cvt_pk_bf16_f32 v235,v22,v23
s_add_u32 s63,s66,0
v_mfma_f32_16x16x32_bf16 v[40:43],v[136:139],v[212:215],0
buffer_store_dwordx4 v[232:235],v229,s[8:11],s63 offen sc1
v_cvt_pk_bf16_f32 v236,v24,v25
v_mfma_f32_16x16x32_bf16 v[44:47],v[140:143],v[212:215],0
v_cvt_pk_bf16_f32 v237,v26,v27
v_cvt_pk_bf16_f32 v238,v28,v29
v_mfma_f32_16x16x32_bf16 v[48:51],v[144:147],v[212:215],0
v_cvt_pk_bf16_f32 v239,v30,v31
buffer_store_dwordx4 v[236:239],v229,s[8:11],s63 offen offset:2048 sc1
v_mfma_f32_16x16x32_bf16 v[52:55],v[148:151],v[212:215],0
v_cvt_pk_bf16_f32 v232,v32,v33
v_cvt_pk_bf16_f32 v233,v34,v35
v_mfma_f32_16x16x32_bf16 v[56:59],v[152:155],v[212:215],0
v_cvt_pk_bf16_f32 v234,v36,v37
v_cvt_pk_bf16_f32 v235,v38,v39
s_add_u32 s63,s66,4096
v_mfma_f32_16x16x32_bf16 v[60:63],v[156:159],v[212:215],0
buffer_store_dwordx4 v[232:235],v229,s[8:11],s63 offen sc1
v_cvt_pk_bf16_f32 v236,v40,v41
v_cvt_pk_bf16_f32 v237,v42,v43
v_cvt_pk_bf16_f32 v238,v44,v45
v_cvt_pk_bf16_f32 v239,v46,v47
buffer_store_dwordx4 v[236:239],v229,s[8:11],s63 offen offset:2048 sc1
v_cvt_pk_bf16_f32 v232,v48,v49
v_cvt_pk_bf16_f32 v233,v50,v51
v_cvt_pk_bf16_f32 v234,v52,v53
v_cvt_pk_bf16_f32 v235,v54,v55
s_add_u32 s63,s66,8192
buffer_store_dwordx4 v[232:235],v229,s[8:11],s63 offen sc1
v_cvt_pk_bf16_f32 v236,v56,v57
v_cvt_pk_bf16_f32 v237,v58,v59
v_cvt_pk_bf16_f32 v238,v60,v61
v_cvt_pk_bf16_f32 v239,v62,v63
buffer_store_dwordx4 v[236:239],v229,s[8:11],s63 offen offset:2048 sc1
s_waitcnt vmcnt(0)
s_mov_b64 exec,1
buffer_store_dword v5,v1,s[8:11],s82 offen sc1
s_mov_b64 exec,-1
ATT_OJ:
s_add_u32 s69,s69,393216
s_add_u32 s70,s70,2048
s_add_u32 s52,s52,2
s_cmp_lt_u32 s52,64
s_cbranch_scc1 ATT_LOOP
s_endpgm
ROLE_WO:
v_lshlrev_b32 v1,4,v0
v_mov_b32 v5,1
s_lshl_b32 s56,s48,2
s_add_u32 s56,s56,s46
v_bfe_u32 v6,v0,2,2
v_lshrrev_b32 v7,4,v0
v_add_u32 v7,v6,v7
v_and_b32 v7,3,v7
v_and_b32 v15,3,v0
v_lshlrev_b32 v15,4,v15
v_lshl_add_u32 v15,v7,6,v15
v_lshl_add_u32 v15,v6,8,v15
v_lshrrev_b32 v6,5,v0
v_bfe_u32 v7,v0,4,1
v_lshlrev_b32 v16,10,v7
v_lshl_add_u32 v16,v6,8,v16
v_and_b32 v6,15,v0
v_lshl_add_u32 v16,v6,4,v16
v_add_u32 v18,49152,v16
v_lshrrev_b32 v6,5,v0
v_bfe_u32 v7,v0,4,1
v_lshlrev_b32 v20,10,v7
v_lshl_add_u32 v20,v6,8,v20
v_and_b32 v6,15,v0
v_lshl_add_u32 v20,v6,4,v20
v_lshrrev_b32 v6,5,v0
v_add_u32 v6,2,v6
v_bfe_u32 v7,v0,4,1
v_lshlrev_b32 v17,10,v7
v_lshl_add_u32 v17,v6,8,v17
v_and_b32 v6,15,v0
v_lshl_add_u32 v17,v6,4,v17
v_add_u32 v19,49152,v17
v_lshrrev_b32 v6,5,v0
v_add_u32 v6,2,v6
v_bfe_u32 v7,v0,4,1
v_lshlrev_b32 v21,10,v7
v_lshl_add_u32 v21,v6,8,v21
v_and_b32 v6,15,v0
v_lshl_add_u32 v21,v6,4,v21
v_add_u32 v16,0,v1
v_add_u32 v17,1024,v1
v_add_u32 v18,49152,v1
v_add_u32 v19,50176,v1
s_mul_i32 s68,s48,52429
s_lshr_b32 s68,s68,18
s_mul_i32 s60,s68,20
s_sub_u32 s60,s56,s60
s_lshl2_add_u32 s61,s68,s46
s_lshr_b32 s62,s61,3
s_mul_i32 s62,s62,24
s_add_u32 s61,s61,s62
s_lshl_b32 s61,s61,2
v_mov_b32 v2,s61
v_bfe_u32 v6,v0,2,3
v_mul_u32_u24 v20,5120,v6
v_and_b32 v6,3,v0
v_lshl_add_u32 v20,v6,4,v20
v_lshrrev_b32 v6,5,v0
v_lshl_add_u32 v20,v6,6,v20
s_mul_i32 s58,s68,983040
s_lshl_b32 s61,s60,6
s_add_u32 s58,s58,s61
s_mul_i32 s69,s68,40960
s_lshl_b32 s60,s60,8
s_add_u32 s69,s69,s60
s_add_u32 s69,s69,175112192
s_lshl_b32 s75,s56,2
s_add_u32 s75,s75,819200
s_waitcnt vmcnt(0)
s_barrier
s_cmp_lg_u32 s46,0
s_cbranch_scc1 arr_233
v_mov_b32 v6,1
s_lshl_b32 s3,s49,2
v_mov_b32 v7,s3
s_mov_b64 exec,1
buffer_atomic_add v6,v7,s[12:15],0 offen sc1
s_mov_b64 exec,-1
arr_233:
s_lshl_b32 s3,s49,2
v_mov_b32 v7,s3
s_nop 1
ibw_234:
buffer_load_dword v6,v7,s[12:15],0 offen sc1
s_waitcnt vmcnt(0)
v_cmp_ne_u32 vcc,256,v6
s_nop 0
s_cbranch_vccz ok_235
s_sleep 8
s_sub_u32 s47,s47,1
s_cbranch_scc1 ABORT
s_branch ibw_234
ok_235:
s_cmp_lg_u32 s49,0
s_cbranch_scc1 ibok_236
v_and_b32 v7,7,v0
v_lshlrev_b32 v7,2,v7
buffer_load_dword v6,v7,s[12:15],0 offen offset:32 sc1
s_waitcnt vmcnt(0)
v_cmp_ne_u32 vcc,32,v6
s_nop 0
s_cbranch_vccz ibok_236
s_barrier
s_mov_b32 s49,1
s_mov_b32 s3,s2
s_load_dwordx16 s[16:31],s[0:1],0
s_load_dwordx8 s[32:39],s[0:1],64
s_waitcnt lgkmcnt(0)
s_branch DISPATCH
ibok_236:
s_mul_i32 s63,s46,40960
s_mov_b32 s4,s26
s_mov_b32 s5,s27
s_mov_b32 s6,7864320
s_mov_b32 s7,0x20000
v_lshrrev_b32 v9,2,v0
s_mov_b32 s64,1280
v_mul_lo_u32 v9,v9,s64
v_and_b32 v10,3,v0
v_lshl_add_u32 v6,v10,4,v9
s_add_u32 m0,s63,0
s_add_u32 s65,s58,0
buffer_load_dwordx4 v6,s[4:7],s65 offen lds
s_add_u32 m0,s63,1024
s_add_u32 s65,s58,20480
buffer_load_dwordx4 v6,s[4:7],s65 offen lds
s_add_u32 m0,s63,2048
s_add_u32 s65,s58,40960
buffer_load_dwordx4 v6,s[4:7],s65 offen lds
s_add_u32 m0,s63,3072
s_add_u32 s65,s58,61440
buffer_load_dwordx4 v6,s[4:7],s65 offen lds
s_add_u32 m0,s63,4096
s_add_u32 s65,s58,81920
buffer_load_dwordx4 v6,s[4:7],s65 offen lds
s_add_u32 m0,s63,5120
s_add_u32 s65,s58,102400
buffer_load_dwordx4 v6,s[4:7],s65 offen lds
s_add_u32 m0,s63,6144
s_add_u32 s65,s58,122880
buffer_load_dwordx4 v6,s[4:7],s65 offen lds
s_add_u32 m0,s63,7168
s_add_u32 s65,s58,143360
buffer_load_dwordx4 v6,s[4:7],s65 offen lds
s_add_u32 m0,s63,8192
s_add_u32 s65,s58,163840
buffer_load_dwordx4 v6,s[4:7],s65 offen lds
s_add_u32 m0,s63,9216
s_add_u32 s65,s58,184320
buffer_load_dwordx4 v6,s[4:7],s65 offen lds
s_add_u32 m0,s63,10240
s_add_u32 s65,s58,204800
buffer_load_dwordx4 v6,s[4:7],s65 offen lds
s_add_u32 m0,s63,11264
s_add_u32 s65,s58,225280
buffer_load_dwordx4 v6,s[4:7],s65 offen lds
s_add_u32 m0,s63,12288
s_add_u32 s65,s58,245760
buffer_load_dwordx4 v6,s[4:7],s65 offen lds
s_add_u32 m0,s63,13312
s_add_u32 s65,s58,266240
buffer_load_dwordx4 v6,s[4:7],s65 offen lds
s_add_u32 m0,s63,14336
s_add_u32 s65,s58,286720
buffer_load_dwordx4 v6,s[4:7],s65 offen lds
s_add_u32 m0,s63,15360
s_add_u32 s65,s58,307200
buffer_load_dwordx4 v6,s[4:7],s65 offen lds
s_add_u32 m0,s63,16384
s_add_u32 s65,s58,327680
buffer_load_dwordx4 v6,s[4:7],s65 offen lds
s_add_u32 m0,s63,17408
s_add_u32 s65,s58,348160
buffer_load_dwordx4 v6,s[4:7],s65 offen lds
s_add_u32 m0,s63,18432
s_add_u32 s65,s58,368640
buffer_load_dwordx4 v6,s[4:7],s65 offen lds
s_add_u32 m0,s63,19456
s_add_u32 s65,s58,389120
buffer_load_dwordx4 v6,s[4:7],s65 offen lds
s_add_u32 m0,s63,20480
s_add_u32 s65,s58,409600
buffer_load_dwordx4 v6,s[4:7],s65 offen lds
s_add_u32 m0,s63,21504
s_add_u32 s65,s58,430080
buffer_load_dwordx4 v6,s[4:7],s65 offen lds
s_add_u32 m0,s63,22528
s_add_u32 s65,s58,450560
buffer_load_dwordx4 v6,s[4:7],s65 offen lds
s_add_u32 m0,s63,23552
s_add_u32 s65,s58,471040
buffer_load_dwordx4 v6,s[4:7],s65 offen lds
s_add_u32 m0,s63,24576
s_add_u32 s65,s58,491520
buffer_load_dwordx4 v6,s[4:7],s65 offen lds
s_add_u32 m0,s63,25600
s_add_u32 s65,s58,512000
buffer_load_dwordx4 v6,s[4:7],s65 offen lds
s_add_u32 m0,s63,26624
s_add_u32 s65,s58,532480
buffer_load_dwordx4 v6,s[4:7],s65 offen lds
s_add_u32 m0,s63,27648
s_add_u32 s65,s58,552960
buffer_load_dwordx4 v6,s[4:7],s65 offen lds
s_add_u32 m0,s63,28672
s_add_u32 s65,s58,573440
buffer_load_dwordx4 v6,s[4:7],s65 offen lds
s_add_u32 m0,s63,29696
s_add_u32 s65,s58,593920
buffer_load_dwordx4 v6,s[4:7],s65 offen lds
s_add_u32 m0,s63,30720
s_add_u32 s65,s58,614400
buffer_load_dwordx4 v6,s[4:7],s65 offen lds
s_add_u32 m0,s63,31744
s_add_u32 s65,s58,634880
buffer_load_dwordx4 v6,s[4:7],s65 offen lds
s_add_u32 m0,s63,32768
s_add_u32 s65,s58,655360
buffer_load_dwordx4 v6,s[4:7],s65 offen lds
s_add_u32 m0,s63,33792
s_add_u32 s65,s58,675840
buffer_load_dwordx4 v6,s[4:7],s65 offen lds
s_add_u32 m0,s63,34816
s_add_u32 s65,s58,696320
buffer_load_dwordx4 v6,s[4:7],s65 offen lds
s_add_u32 m0,s63,35840
s_add_u32 s65,s58,716800
buffer_load_dwordx4 v6,s[4:7],s65 offen lds
s_add_u32 m0,s63,36864
s_add_u32 s65,s58,737280
buffer_load_dwordx4 v6,s[4:7],s65 offen lds
s_add_u32 m0,s63,37888
s_add_u32 s65,s58,757760
buffer_load_dwordx4 v6,s[4:7],s65 offen lds
s_add_u32 m0,s63,38912
s_add_u32 s65,s58,778240
buffer_load_dwordx4 v6,s[4:7],s65 offen lds
s_add_u32 m0,s63,39936
s_add_u32 s65,s58,798720
buffer_load_dwordx4 v6,s[4:7],s65 offen lds
s_waitcnt vmcnt(20)
v_bfe_u32 v9,v0,2,2
v_lshrrev_b32 v10,5,v0
v_lshl_add_u32 v9,v10,2,v9
v_mul_u32_u24 v9,64,v9
v_and_b32 v10,1,v0
v_lshl_add_u32 v9,v10,3,v9
v_bfe_u32 v10,v0,1,1
v_lshl_add_u32 v9,v10,5,v9
v_bfe_u32 v10,v0,4,1
v_lshl_add_u32 v9,v10,4,v9
v_add_u32 v7,s63,v9
ds_read_b64_tr_b16 a[0:1],v7 offset:0
ds_read_b64_tr_b16 a[2:3],v7 offset:1024
ds_read_b64_tr_b16 a[4:5],v7 offset:512
ds_read_b64_tr_b16 a[6:7],v7 offset:1536
ds_read_b64_tr_b16 a[8:9],v7 offset:2048
ds_read_b64_tr_b16 a[10:11],v7 offset:3072
ds_read_b64_tr_b16 a[12:13],v7 offset:2560
ds_read_b64_tr_b16 a[14:15],v7 offset:3584
ds_read_b64_tr_b16 a[16:17],v7 offset:4096
ds_read_b64_tr_b16 a[18:19],v7 offset:5120
ds_read_b64_tr_b16 a[20:21],v7 offset:4608
ds_read_b64_tr_b16 a[22:23],v7 offset:5632
s_waitcnt lgkmcnt(4)
ds_read_b64_tr_b16 a[24:25],v7 offset:6144
ds_read_b64_tr_b16 a[26:27],v7 offset:7168
ds_read_b64_tr_b16 a[28:29],v7 offset:6656
ds_read_b64_tr_b16 a[30:31],v7 offset:7680
ds_read_b64_tr_b16 a[32:33],v7 offset:8192
ds_read_b64_tr_b16 a[34:35],v7 offset:9216
ds_read_b64_tr_b16 a[36:37],v7 offset:8704
ds_read_b64_tr_b16 a[38:39],v7 offset:9728
ds_read_b64_tr_b16 a[40:41],v7 offset:10240
ds_read_b64_tr_b16 a[42:43],v7 offset:11264
ds_read_b64_tr_b16 a[44:45],v7 offset:10752
ds_read_b64_tr_b16 a[46:47],v7 offset:11776
s_waitcnt lgkmcnt(4)
ds_read_b64_tr_b16 a[48:49],v7 offset:12288
ds_read_b64_tr_b16 a[50:51],v7 offset:13312
ds_read_b64_tr_b16 a[52:53],v7 offset:12800
ds_read_b64_tr_b16 a[54:55],v7 offset:13824
ds_read_b64_tr_b16 a[56:57],v7 offset:14336
ds_read_b64_tr_b16 a[58:59],v7 offset:15360
ds_read_b64_tr_b16 a[60:61],v7 offset:14848
ds_read_b64_tr_b16 a[62:63],v7 offset:15872
ds_read_b64_tr_b16 a[64:65],v7 offset:16384
ds_read_b64_tr_b16 a[66:67],v7 offset:17408
ds_read_b64_tr_b16 a[68:69],v7 offset:16896
ds_read_b64_tr_b16 a[70:71],v7 offset:17920
s_waitcnt lgkmcnt(4)
ds_read_b64_tr_b16 a[72:73],v7 offset:18432
ds_read_b64_tr_b16 a[74:75],v7 offset:19456
ds_read_b64_tr_b16 a[76:77],v7 offset:18944
ds_read_b64_tr_b16 a[78:79],v7 offset:19968
s_waitcnt lgkmcnt(0)
s_add_u32 m0,s63,0
s_add_u32 s65,s58,819200
buffer_load_dwordx4 v6,s[4:7],s65 offen lds
s_add_u32 m0,s63,1024
s_add_u32 s65,s58,839680
buffer_load_dwordx4 v6,s[4:7],s65 offen lds
s_add_u32 m0,s63,2048
s_add_u32 s65,s58,860160
buffer_load_dwordx4 v6,s[4:7],s65 offen lds
s_add_u32 m0,s63,3072
s_add_u32 s65,s58,880640
buffer_load_dwordx4 v6,s[4:7],s65 offen lds
s_add_u32 m0,s63,4096
s_add_u32 s65,s58,901120
buffer_load_dwordx4 v6,s[4:7],s65 offen lds
s_add_u32 m0,s63,5120
s_add_u32 s65,s58,921600
buffer_load_dwordx4 v6,s[4:7],s65 offen lds
s_add_u32 m0,s63,6144
s_add_u32 s65,s58,942080
buffer_load_dwordx4 v6,s[4:7],s65 offen lds
s_add_u32 m0,s63,7168
s_add_u32 s65,s58,962560
buffer_load_dwordx4 v6,s[4:7],s65 offen lds
s_waitcnt vmcnt(8)
v_bfe_u32 v9,v0,2,2
v_lshrrev_b32 v10,5,v0
v_lshl_add_u32 v9,v10,2,v9
v_mul_u32_u24 v9,64,v9
v_and_b32 v10,1,v0
v_lshl_add_u32 v9,v10,3,v9
v_bfe_u32 v10,v0,1,1
v_lshl_add_u32 v9,v10,5,v9
v_bfe_u32 v10,v0,4,1
v_lshl_add_u32 v9,v10,4,v9
v_add_u32 v7,s63,v9
ds_read_b64_tr_b16 a[80:81],v7 offset:20480
ds_read_b64_tr_b16 a[82:83],v7 offset:21504
ds_read_b64_tr_b16 a[84:85],v7 offset:20992
ds_read_b64_tr_b16 a[86:87],v7 offset:22016
ds_read_b64_tr_b16 a[88:89],v7 offset:22528
ds_read_b64_tr_b16 a[90:91],v7 offset:23552
ds_read_b64_tr_b16 a[92:93],v7 offset:23040
ds_read_b64_tr_b16 a[94:95],v7 offset:24064
ds_read_b64_tr_b16 a[96:97],v7 offset:24576
ds_read_b64_tr_b16 a[98:99],v7 offset:25600
ds_read_b64_tr_b16 a[100:101],v7 offset:25088
ds_read_b64_tr_b16 a[102:103],v7 offset:26112
s_waitcnt lgkmcnt(4)
ds_read_b64_tr_b16 a[104:105],v7 offset:26624
ds_read_b64_tr_b16 a[106:107],v7 offset:27648
ds_read_b64_tr_b16 a[108:109],v7 offset:27136
ds_read_b64_tr_b16 a[110:111],v7 offset:28160
ds_read_b64_tr_b16 a[112:113],v7 offset:28672
ds_read_b64_tr_b16 a[114:115],v7 offset:29696
ds_read_b64_tr_b16 a[116:117],v7 offset:29184
ds_read_b64_tr_b16 a[118:119],v7 offset:30208
ds_read_b64_tr_b16 a[120:121],v7 offset:30720
ds_read_b64_tr_b16 a[122:123],v7 offset:31744
ds_read_b64_tr_b16 a[124:125],v7 offset:31232
ds_read_b64_tr_b16 a[126:127],v7 offset:32256
s_waitcnt lgkmcnt(4)
ds_read_b64_tr_b16 a[128:129],v7 offset:32768
ds_read_b64_tr_b16 a[130:131],v7 offset:33792
ds_read_b64_tr_b16 a[132:133],v7 offset:33280
ds_read_b64_tr_b16 a[134:135],v7 offset:34304
ds_read_b64_tr_b16 a[136:137],v7 offset:34816
ds_read_b64_tr_b16 a[138:139],v7 offset:35840
ds_read_b64_tr_b16 a[140:141],v7 offset:35328
ds_read_b64_tr_b16 a[142:143],v7 offset:36352
ds_read_b64_tr_b16 a[144:145],v7 offset:36864
ds_read_b64_tr_b16 a[146:147],v7 offset:37888
ds_read_b64_tr_b16 a[148:149],v7 offset:37376
ds_read_b64_tr_b16 a[150:151],v7 offset:38400
s_waitcnt lgkmcnt(4)
ds_read_b64_tr_b16 a[152:153],v7 offset:38912
ds_read_b64_tr_b16 a[154:155],v7 offset:39936
ds_read_b64_tr_b16 a[156:157],v7 offset:39424
ds_read_b64_tr_b16 a[158:159],v7 offset:40448
s_waitcnt lgkmcnt(0)
s_waitcnt vmcnt(0)
v_bfe_u32 v9,v0,2,2
v_lshrrev_b32 v10,5,v0
v_lshl_add_u32 v9,v10,2,v9
v_mul_u32_u24 v9,64,v9
v_and_b32 v10,1,v0
v_lshl_add_u32 v9,v10,3,v9
v_bfe_u32 v10,v0,1,1
v_lshl_add_u32 v9,v10,5,v9
v_bfe_u32 v10,v0,4,1
v_lshl_add_u32 v9,v10,4,v9
v_add_u32 v7,s63,v9
ds_read_b64_tr_b16 a[160:161],v7 offset:0
ds_read_b64_tr_b16 a[162:163],v7 offset:1024
ds_read_b64_tr_b16 a[164:165],v7 offset:512
ds_read_b64_tr_b16 a[166:167],v7 offset:1536
ds_read_b64_tr_b16 a[168:169],v7 offset:2048
ds_read_b64_tr_b16 a[170:171],v7 offset:3072
ds_read_b64_tr_b16 a[172:173],v7 offset:2560
ds_read_b64_tr_b16 a[174:175],v7 offset:3584
ds_read_b64_tr_b16 a[176:177],v7 offset:4096
ds_read_b64_tr_b16 a[178:179],v7 offset:5120
ds_read_b64_tr_b16 a[180:181],v7 offset:4608
ds_read_b64_tr_b16 a[182:183],v7 offset:5632
s_waitcnt lgkmcnt(4)
ds_read_b64_tr_b16 a[184:185],v7 offset:6144
ds_read_b64_tr_b16 a[186:187],v7 offset:7168
ds_read_b64_tr_b16 a[188:189],v7 offset:6656
ds_read_b64_tr_b16 a[190:191],v7 offset:7680
s_waitcnt lgkmcnt(0)
s_barrier
s_mov_b32 s50,0
s_mov_b32 s32,0
s_mov_b32 s57,0
s_mov_b32 s59,2147483648
s_mov_b32 s82,2147483648
s_mov_b32 s39,2147483648
v_mov_b32 v22,100352
v_lshl_add_u32 v22,v0,2,v22
v_mov_b32 v23,0
ds_write_b32 v22,v23
s_mov_b32 s39,1600000
v_and_b32 v72,15,v0
v_lshlrev_b32 v72,7,v72
s_mov_b64 s[76:77],-1
s_mov_b64 s[80:81],-1
s_waitcnt lgkmcnt(0)
s_barrier
s_mov_b32 s83,s100
s_min_u32 s62,s32,127
s_sub_u32 s60,s62,14
s_lshr_b32 s34,s60,1
s_and_b32 s33,s60,1
s_cmp_eq_u32 s33,0
s_cselect_b32 s61,14,0
s_add_u32 s34,s34,s61
s_sub_u32 s61,s60,50
s_cmp_ge_u32 s60,100
s_cselect_b32 s34,s61,s34
s_cselect_b32 s33,1,s33
s_cmp_lt_u32 s62,14
s_cselect_b32 s34,s62,s34
s_cselect_b32 s33,0,s33
s_lshl_b32 s35,s33,6
s_add_u32 s35,s35,s34
s_lshl_b32 s35,s35,9
s_add_u32 s35,s35,262144
s_sub_u32 s57,49152,s57
v_swap_b32 v16,v18
v_swap_b32 v17,v19
s_add_u32 s62,s32,1
s_min_u32 s62,s62,127
s_sub_u32 s60,s62,14
s_lshr_b32 s41,s60,1
s_and_b32 s40,s60,1
s_cmp_eq_u32 s40,0
s_cselect_b32 s61,14,0
s_add_u32 s41,s41,s61
s_sub_u32 s61,s60,50
s_cmp_ge_u32 s60,100
s_cselect_b32 s41,s61,s41
s_cselect_b32 s40,1,s40
s_cmp_lt_u32 s62,14
s_cselect_b32 s41,s62,s41
s_cselect_b32 s40,0,s40
s_lshl_b32 s42,s40,6
s_add_u32 s42,s42,s41
s_lshl_b32 s42,s42,9
s_add_u32 s42,s42,262144
WO_COLD:
s_mov_b32 s37,0
fb_237:
buffer_load_dword v3,v2,s[8:11],s35 offen sc1
s_waitcnt vmcnt(0)
v_cmp_eq_u32 vcc,0,v3
s_and_b64 vcc,vcc,s[76:77]
s_cbranch_scc0 ok_238
s_sleep 1
s_sub_u32 s47,s47,1
s_cbranch_scc1 ABORT
s_branch fb_237
ok_238:
WO_COLD2:
s_sub_u32 s66,49152,s57
s_mul_i32 s60,s34,393216
s_add_u32 s60,s60,s37
s_mul_i32 s61,s68,49152
s_add_u32 s60,s60,s61
s_mul_i32 s61,s46,12288
s_add_u32 s60,s60,s61
s_add_u32 s60,s60,149946368
s_add_u32 s61,s61,s66
s_add_u32 m0,s61,0
s_add_u32 s63,s60,0
buffer_load_dwordx4 v1,s[8:11],s63 offen sc1 lds
buffer_load_dwordx4 v1,s[8:11],s63 offen offset:1024 sc1 lds
buffer_load_dwordx4 v1,s[8:11],s63 offen offset:2048 sc1 lds
buffer_load_dwordx4 v1,s[8:11],s63 offen offset:3072 sc1 lds
s_add_u32 m0,s61,4096
s_add_u32 s63,s60,4096
buffer_load_dwordx4 v1,s[8:11],s63 offen sc1 lds
buffer_load_dwordx4 v1,s[8:11],s63 offen offset:1024 sc1 lds
buffer_load_dwordx4 v1,s[8:11],s63 offen offset:2048 sc1 lds
buffer_load_dwordx4 v1,s[8:11],s63 offen offset:3072 sc1 lds
s_waitcnt vmcnt(7)
s_mov_b64 exec,1
buffer_store_dword v5,v1,s[8:11],s59 offen sc1
s_mov_b64 exec,-1
s_mov_b32 s59,2147483648
s_add_u32 m0,s61,8192
s_add_u32 s63,s60,8192
buffer_load_dwordx4 v1,s[8:11],s63 offen sc1 lds
buffer_load_dwordx4 v1,s[8:11],s63 offen offset:1024 sc1 lds
buffer_load_dwordx4 v1,s[8:11],s63 offen offset:2048 sc1 lds
buffer_load_dwordx4 v1,s[8:11],s63 offen offset:3072 sc1 lds
s_mov_b32 s35,s42
buffer_load_dword v3,v2,s[8:11],s35 offen sc1
s_mov_b32 s53,s33
s_mov_b32 s54,s34
s_add_u32 s32,s32,1
s_mov_b32 s33,s40
s_mov_b32 s34,s41
s_mov_b64 s[76:77],s[80:81]
s_sub_u32 s57,49152,s57
v_swap_b32 v16,v18
v_swap_b32 v17,v19
s_mov_b32 s51,s53
s_mov_b32 s52,s54
s_mov_b32 s37,2147483648
s_waitcnt vmcnt(6)
s_branch WO_GO
WO_NEXT:
s_sub_u32 s57,49152,s57
v_swap_b32 v16,v18
v_swap_b32 v17,v19
s_mov_b32 s51,s53
s_mov_b32 s52,s54
s_waitcnt vmcnt(2)
v_cmp_eq_u32 vcc,0,v3
s_and_b64 vcc,vcc,s[76:77]
s_cselect_b32 s37,2147483648,0
s_cmp_lt_u32 s32,128
s_cselect_b32 s37,s37,2147483648
WO_GO:
s_barrier
ds_read_b128 v[24:27],v16 offset:0
ds_read_b128 v[28:31],v17 offset:0
ds_read_b128 v[32:35],v16 offset:12288
ds_read_b128 v[36:39],v17 offset:12288
ds_read_b128 v[40:43],v16 offset:24576
ds_read_b128 v[44:47],v17 offset:24576
ds_read_b128 v[48:51],v16 offset:36864
s_waitcnt lgkmcnt(6)
v_mfma_f32_32x32x16_bf16 v[56:71],a[0:3],v[24:27],0
ds_read_b128 v[52:55],v17 offset:36864
s_sub_u32 s66,49152,s57
s_mul_i32 s60,s34,393216
s_add_u32 s60,s60,s37
s_waitcnt lgkmcnt(6)
v_mfma_f32_32x32x16_bf16 v[56:71],a[4:7],v[28:31],v[56:71]
ds_read_b128 v[24:27],v16 offset:2048
s_mul_i32 s61,s68,49152
s_add_u32 s60,s60,s61
s_mul_i32 s61,s46,12288
s_waitcnt lgkmcnt(5)
v_mfma_f32_32x32x16_bf16 v[56:71],a[48:51],v[32:35],v[56:71]
ds_read_b128 v[28:31],v17 offset:2048
s_add_u32 s60,s60,s61
s_add_u32 s60,s60,149946368
s_add_u32 s61,s61,s66
s_add_u32 m0,s61,0
v_mfma_f32_32x32x16_bf16 v[56:71],a[52:55],v[36:39],v[56:71]
ds_read_b128 v[32:35],v16 offset:14336
s_add_u32 s63,s60,0
buffer_load_dwordx4 v1,s[8:11],s63 offen sc1 lds
s_waitcnt lgkmcnt(5)
v_mfma_f32_32x32x16_bf16 v[56:71],a[96:99],v[40:43],v[56:71]
ds_read_b128 v[36:39],v17 offset:14336
s_mul_i32 s71,s52,491520
s_add_u32 s71,s71,s69
s_lshl_b32 s70,s51,6
s_add_u32 s70,s70,s52
v_mfma_f32_32x32x16_bf16 v[56:71],a[100:103],v[44:47],v[56:71]
ds_read_b128 v[40:43],v16 offset:26624
buffer_load_dwordx4 v1,s[8:11],s63 offen offset:1024 sc1 lds
s_mul_i32 s70,s70,640
s_waitcnt lgkmcnt(5)
v_mfma_f32_32x32x16_bf16 v[56:71],a[144:147],v[48:51],v[56:71]
ds_read_b128 v[44:47],v17 offset:26624
s_add_u32 s82,s70,s75
v_mfma_f32_32x32x16_bf16 v[56:71],a[148:151],v[52:55],v[56:71]
ds_read_b128 v[48:51],v16 offset:38912
buffer_load_dwordx4 v1,s[8:11],s63 offen offset:2048 sc1 lds
s_waitcnt lgkmcnt(5)
v_mfma_f32_32x32x16_bf16 v[56:71],a[8:11],v[24:27],v[56:71]
ds_read_b128 v[52:55],v17 offset:38912
v_mfma_f32_32x32x16_bf16 v[56:71],a[12:15],v[28:31],v[56:71]
ds_read_b128 v[24:27],v16 offset:4096
buffer_load_dwordx4 v1,s[8:11],s63 offen offset:3072 sc1 lds
s_add_u32 m0,s61,4096
s_waitcnt lgkmcnt(5)
v_mfma_f32_32x32x16_bf16 v[56:71],a[56:59],v[32:35],v[56:71]
ds_read_b128 v[28:31],v17 offset:4096
s_add_u32 s63,s60,4096
v_mfma_f32_32x32x16_bf16 v[56:71],a[60:63],v[36:39],v[56:71]
ds_read_b128 v[32:35],v16 offset:16384
buffer_load_dwordx4 v1,s[8:11],s63 offen sc1 lds
s_waitcnt lgkmcnt(5)
v_mfma_f32_32x32x16_bf16 v[56:71],a[104:107],v[40:43],v[56:71]
ds_read_b128 v[36:39],v17 offset:16384
v_mfma_f32_32x32x16_bf16 v[56:71],a[108:111],v[44:47],v[56:71]
ds_read_b128 v[40:43],v16 offset:28672
buffer_load_dwordx4 v1,s[8:11],s63 offen offset:1024 sc1 lds
s_waitcnt lgkmcnt(5)
v_mfma_f32_32x32x16_bf16 v[56:71],a[152:155],v[48:51],v[56:71]
ds_read_b128 v[44:47],v17 offset:28672
v_mfma_f32_32x32x16_bf16 v[56:71],a[156:159],v[52:55],v[56:71]
ds_read_b128 v[48:51],v16 offset:40960
buffer_load_dwordx4 v1,s[8:11],s63 offen offset:2048 sc1 lds
s_waitcnt lgkmcnt(5)
v_mfma_f32_32x32x16_bf16 v[56:71],a[16:19],v[24:27],v[56:71]
ds_read_b128 v[52:55],v17 offset:40960
v_mfma_f32_32x32x16_bf16 v[56:71],a[20:23],v[28:31],v[56:71]
ds_read_b128 v[24:27],v16 offset:6144
buffer_load_dwordx4 v1,s[8:11],s63 offen offset:3072 sc1 lds
s_add_u32 m0,s61,8192
s_waitcnt lgkmcnt(5)
v_mfma_f32_32x32x16_bf16 v[56:71],a[64:67],v[32:35],v[56:71]
ds_read_b128 v[28:31],v17 offset:6144
s_add_u32 s63,s60,8192
v_mfma_f32_32x32x16_bf16 v[56:71],a[68:71],v[36:39],v[56:71]
ds_read_b128 v[32:35],v16 offset:18432
buffer_load_dwordx4 v1,s[8:11],s63 offen sc1 lds
s_waitcnt lgkmcnt(5)
v_mfma_f32_32x32x16_bf16 v[56:71],a[112:115],v[40:43],v[56:71]
ds_read_b128 v[36:39],v17 offset:18432
v_mfma_f32_32x32x16_bf16 v[56:71],a[116:119],v[44:47],v[56:71]
ds_read_b128 v[40:43],v16 offset:30720
buffer_load_dwordx4 v1,s[8:11],s63 offen offset:1024 sc1 lds
s_waitcnt lgkmcnt(5)
v_mfma_f32_32x32x16_bf16 v[56:71],a[160:163],v[48:51],v[56:71]
ds_read_b128 v[44:47],v17 offset:30720
v_mfma_f32_32x32x16_bf16 v[56:71],a[164:167],v[52:55],v[56:71]
ds_read_b128 v[48:51],v16 offset:43008
buffer_load_dwordx4 v1,s[8:11],s63 offen offset:2048 sc1 lds
s_waitcnt lgkmcnt(5)
v_mfma_f32_32x32x16_bf16 v[56:71],a[24:27],v[24:27],v[56:71]
ds_read_b128 v[52:55],v17 offset:43008
s_waitcnt vmcnt(11)
s_mov_b64 exec,1
buffer_store_dword v5,v1,s[8:11],s59 offen sc1
s_mov_b64 exec,-1
s_mov_b32 s59,2147483648
s_barrier
v_mfma_f32_32x32x16_bf16 v[56:71],a[28:31],v[28:31],v[56:71]
ds_read_b128 v[24:27],v16 offset:8192
buffer_load_dwordx4 v1,s[8:11],s63 offen offset:3072 sc1 lds
s_add_u32 s62,s32,1
s_waitcnt lgkmcnt(5)
v_mfma_f32_32x32x16_bf16 v[56:71],a[72:75],v[32:35],v[56:71]
ds_read_b128 v[28:31],v17 offset:8192
s_min_u32 s62,s62,127
s_sub_u32 s60,s62,14
s_lshr_b32 s41,s60,1
s_and_b32 s40,s60,1
v_mfma_f32_32x32x16_bf16 v[56:71],a[76:79],v[36:39],v[56:71]
ds_read_b128 v[32:35],v16 offset:20480
s_cmp_eq_u32 s40,0
s_cselect_b32 s61,14,0
s_add_u32 s41,s41,s61
s_waitcnt lgkmcnt(5)
v_mfma_f32_32x32x16_bf16 v[56:71],a[120:123],v[40:43],v[56:71]
ds_read_b128 v[36:39],v17 offset:20480
s_sub_u32 s61,s60,50
s_cmp_ge_u32 s60,100
s_cselect_b32 s41,s61,s41
s_cselect_b32 s40,1,s40
v_mfma_f32_32x32x16_bf16 v[56:71],a[124:127],v[44:47],v[56:71]
ds_read_b128 v[40:43],v16 offset:32768
s_cmp_lt_u32 s62,14
s_cselect_b32 s41,s62,s41
s_cselect_b32 s40,0,s40
s_waitcnt lgkmcnt(5)
v_mfma_f32_32x32x16_bf16 v[56:71],a[168:171],v[48:51],v[56:71]
ds_read_b128 v[44:47],v17 offset:32768
s_lshl_b32 s42,s40,6
s_add_u32 s42,s42,s41
s_lshl_b32 s42,s42,9
s_add_u32 s42,s42,262144
v_mfma_f32_32x32x16_bf16 v[56:71],a[172:175],v[52:55],v[56:71]
ds_read_b128 v[48:51],v16 offset:45056
s_waitcnt lgkmcnt(5)
v_mfma_f32_32x32x16_bf16 v[56:71],a[32:35],v[24:27],v[56:71]
ds_read_b128 v[52:55],v17 offset:45056
v_mfma_f32_32x32x16_bf16 v[56:71],a[36:39],v[28:31],v[56:71]
ds_read_b128 v[24:27],v16 offset:10240
s_waitcnt lgkmcnt(5)
v_mfma_f32_32x32x16_bf16 v[56:71],a[80:83],v[32:35],v[56:71]
ds_read_b128 v[28:31],v17 offset:10240
v_mfma_f32_32x32x16_bf16 v[56:71],a[84:87],v[36:39],v[56:71]
ds_read_b128 v[32:35],v16 offset:22528
s_waitcnt lgkmcnt(5)
v_mfma_f32_32x32x16_bf16 v[56:71],a[128:131],v[40:43],v[56:71]
ds_read_b128 v[36:39],v17 offset:22528
buffer_load_dword v3,v2,s[8:11],s35 offen sc1
v_mfma_f32_32x32x16_bf16 v[56:71],a[132:135],v[44:47],v[56:71]
ds_read_b128 v[40:43],v16 offset:34816
s_waitcnt lgkmcnt(5)
v_mfma_f32_32x32x16_bf16 v[56:71],a[176:179],v[48:51],v[56:71]
ds_read_b128 v[44:47],v17 offset:34816
v_mfma_f32_32x32x16_bf16 v[56:71],a[180:183],v[52:55],v[56:71]
ds_read_b128 v[48:51],v16 offset:47104
s_waitcnt lgkmcnt(5)
v_mfma_f32_32x32x16_bf16 v[56:71],a[40:43],v[24:27],v[56:71]
ds_read_b128 v[52:55],v17 offset:47104
v_mfma_f32_32x32x16_bf16 v[56:71],a[44:47],v[28:31],v[56:71]
s_waitcnt lgkmcnt(4)
v_mfma_f32_32x32x16_bf16 v[56:71],a[88:91],v[32:35],v[56:71]
v_mfma_f32_32x32x16_bf16 v[56:71],a[92:95],v[36:39],v[56:71]
s_waitcnt lgkmcnt(2)
v_mfma_f32_32x32x16_bf16 v[56:71],a[136:139],v[40:43],v[56:71]
v_mfma_f32_32x32x16_bf16 v[56:71],a[140:143],v[44:47],v[56:71]
s_waitcnt lgkmcnt(0)
v_mfma_f32_32x32x16_bf16 v[56:71],a[184:187],v[48:51],v[56:71]
v_mfma_f32_32x32x16_bf16 v[56:71],a[188:191],v[52:55],v[56:71]
s_cmp_eq_u32 s37,0
s_cbranch_scc0 sec_241
s_mov_b32 s35,s42
buffer_load_dword v3,v2,s[8:11],s35 offen sc1
s_mov_b32 s53,s33
s_mov_b32 s54,s34
s_add_u32 s32,s32,1
s_mov_b32 s33,s40
s_mov_b32 s34,s41
s_mov_b64 s[76:77],s[80:81]
s_nop 2
ep_239:
v_cvt_pk_bf16_f32 v112,v56,v57
v_cvt_pk_bf16_f32 v113,v58,v59
v_cvt_pk_bf16_f32 v114,v60,v61
v_cvt_pk_bf16_f32 v115,v62,v63
v_cvt_pk_bf16_f32 v116,v64,v65
v_cvt_pk_bf16_f32 v117,v66,v67
v_cvt_pk_bf16_f32 v118,v68,v69
v_cvt_pk_bf16_f32 v119,v70,v71
buffer_store_dwordx4 v[112:115],v20,s[8:11],s71 offen sc1
buffer_store_dwordx4 v[116:119],v20,s[8:11],s71 offen offset:128 sc1
s_mov_b32 s59,s82
s_cmp_eq_u32 s37,0
s_cbranch_scc1 WO_NEXT
s_waitcnt vmcnt(2)
v_cmp_eq_u32 vcc,0,v3
s_and_b64 vcc,vcc,s[76:77]
s_cselect_b32 s37,2147483648,0
s_cmp_lt_u32 s32,128
s_cselect_b32 s37,s37,2147483648
s_cmp_eq_u32 s37,0
s_cbranch_scc1 WO_COLD2
s_waitcnt vmcnt(0)
s_mov_b64 exec,1
buffer_store_dword v5,v1,s[8:11],s59 offen sc1
s_mov_b64 exec,-1
s_mov_b32 s59,2147483648
s_cmp_lt_u32 s32,128
s_cbranch_scc1 WO_COLD
s_branch WO_END
sec_241:
s_waitcnt vmcnt(0)
v_cmp_eq_u32 vcc,0,v3
s_and_b64 vcc,vcc,s[76:77]
s_cselect_b32 s37,2147483648,0
s_cmp_lt_u32 s32,128
s_cselect_b32 s37,s37,2147483648
s_cmp_lg_u32 s37,0
s_cbranch_scc1 nr_240
s_sub_u32 s66,49152,s57
s_mul_i32 s60,s34,393216
s_add_u32 s60,s60,s37
s_mul_i32 s61,s68,49152
s_add_u32 s60,s60,s61
s_mul_i32 s61,s46,12288
s_add_u32 s60,s60,s61
s_add_u32 s60,s60,149946368
s_add_u32 s61,s61,s66
s_add_u32 m0,s61,0
s_add_u32 s63,s60,0
buffer_load_dwordx4 v1,s[8:11],s63 offen sc1 lds
v_cvt_pk_bf16_f32 v112,v56,v57
buffer_load_dwordx4 v1,s[8:11],s63 offen offset:1024 sc1 lds
v_cvt_pk_bf16_f32 v113,v58,v59
buffer_load_dwordx4 v1,s[8:11],s63 offen offset:2048 sc1 lds
v_cvt_pk_bf16_f32 v114,v60,v61
buffer_load_dwordx4 v1,s[8:11],s63 offen offset:3072 sc1 lds
v_cvt_pk_bf16_f32 v115,v62,v63
s_add_u32 m0,s61,4096
s_add_u32 s63,s60,4096
buffer_load_dwordx4 v1,s[8:11],s63 offen sc1 lds
v_cvt_pk_bf16_f32 v116,v64,v65
buffer_load_dwordx4 v1,s[8:11],s63 offen offset:1024 sc1 lds
v_cvt_pk_bf16_f32 v117,v66,v67
buffer_load_dwordx4 v1,s[8:11],s63 offen offset:2048 sc1 lds
v_cvt_pk_bf16_f32 v118,v68,v69
buffer_load_dwordx4 v1,s[8:11],s63 offen offset:3072 sc1 lds
v_cvt_pk_bf16_f32 v119,v70,v71
s_add_u32 m0,s61,8192
s_add_u32 s63,s60,8192
buffer_load_dwordx4 v1,s[8:11],s63 offen sc1 lds
buffer_load_dwordx4 v1,s[8:11],s63 offen offset:1024 sc1 lds
buffer_load_dwordx4 v1,s[8:11],s63 offen offset:2048 sc1 lds
buffer_load_dwordx4 v1,s[8:11],s63 offen offset:3072 sc1 lds
s_mov_b32 s35,s42
buffer_load_dword v3,v2,s[8:11],s35 offen sc1
s_mov_b32 s53,s33
s_mov_b32 s54,s34
s_add_u32 s32,s32,1
s_mov_b32 s33,s40
s_mov_b32 s34,s41
s_mov_b64 s[76:77],s[80:81]
buffer_store_dwordx4 v[112:115],v20,s[8:11],s71 offen sc1
buffer_store_dwordx4 v[116:119],v20,s[8:11],s71 offen offset:128 sc1
s_mov_b32 s59,s82
s_branch WO_NEXT
nr_240:
buffer_load_dword v3,v2,s[8:11],s35 offen sc1
s_branch ep_239
WO_END:
s_endpgm
ROLE_R1:
s_lshr_b32 s68,s48,3
s_and_b32 s48,s48,7
v_lshlrev_b32 v1,4,v0
v_mov_b32 v5,1
s_lshl_b32 s56,s48,2
s_add_u32 s56,s56,s46
v_bfe_u32 v6,v0,2,2
v_lshrrev_b32 v7,4,v0
v_add_u32 v7,v6,v7
v_and_b32 v7,3,v7
v_and_b32 v15,3,v0
v_lshlrev_b32 v15,4,v15
v_lshl_add_u32 v15,v7,6,v15
v_lshl_add_u32 v15,v6,8,v15
v_lshrrev_b32 v6,4,v0
v_bfe_u32 v7,v0,2,2
v_and_b32 v8,3,v0
v_add_u32 v9,s48,v7
v_and_b32 v9,3,v9
v_lshlrev_b32 v17,6,v9
v_lshl_add_u32 v17,v8,4,v17
s_lshl_b32 s60,s48,8
s_lshl_b32 s61,s46,13
s_add_u32 s61,s61,s60
v_lshl_add_u32 v16,v6,11,v17
v_add_u32 v16,s61,v16
s_lshl_b32 s61,s46,11
s_add_u32 s61,s61,s60
s_add_u32 s61,s61,32768
v_add_u32 v17,s61,v17
v_lshl_add_u32 v18,v6,2,v17
v_mul_u32_u24 v19,40960,v6
v_and_b32 v9,0xff,v1
v_add_u32 v19,v19,v9
s_mul_i32 s60,s46,768
s_sub_u32 s60,4096,s60
v_add_u32 v19,s60,v19
s_mul_i32 s69,s48,5120
s_lshl_b32 s60,s46,10
s_add_u32 s69,s69,s60
s_add_u32 s69,s69,175112192
s_cmp_eq_u32 s68,0
s_mov_b32 s70,209518592
s_cselect_b32 s70,234749952,s70
s_mov_b32 s71,46080
s_cselect_b32 s71,40960,s71
s_mov_b32 s72,0x3f80
s_mov_b32 s73,0x3f800000
v_lshlrev_b32 v21,5,v8
s_lshl_b32 s60,s46,3
v_add_u32 v20,s60,v21
v_min_u32 v2,39,v0
v_lshlrev_b32 v2,4,v2
s_waitcnt vmcnt(0)
s_barrier
s_cmp_lg_u32 s46,0
s_cbranch_scc1 arr_242
v_mov_b32 v6,1
s_lshl_b32 s3,s49,2
v_mov_b32 v7,s3
s_mov_b64 exec,1
buffer_atomic_add v6,v7,s[12:15],0 offen sc1
s_mov_b64 exec,-1
arr_242:
s_cmp_lg_u32 s49,0
s_cbranch_scc1 vr_243
s_mov_b64 exec,1
s_lshl_b32 s60,s68,5
s_add_u32 s60,s60,s56
s_and_b32 s61,s60,7
s_lshl_b32 s61,s61,14
s_lshl_b32 s60,s60,7
s_add_u32 s60,s60,s61
s_add_u32 s60,s60,11796480
s_add_u32 s61,s60,0x2000
s_mov_b32 s62,-1
s_mov_b32 s63,-1
s_mov_b32 s50,6
vr_243l:
buffer_store_dword v5,v1,s[8:11],s60 offen sc1
buffer_store_dword v5,v1,s[8:11],s61 offen sc1
s_waitcnt vmcnt(0)
s_memtime s[64:65]
s_waitcnt lgkmcnt(0)
buffer_load_dword v3,v1,s[8:11],s60 offen sc1
s_waitcnt vmcnt(0)
s_memtime s[66:67]
s_waitcnt lgkmcnt(0)
s_sub_u32 s66,s66,s64
s_min_u32 s62,s62,s66
s_memtime s[64:65]
s_waitcnt lgkmcnt(0)
buffer_load_dword v3,v1,s[8:11],s61 offen sc1
s_waitcnt vmcnt(0)
s_memtime s[66:67]
s_waitcnt lgkmcnt(0)
s_sub_u32 s66,s66,s64
s_min_u32 s63,s63,s66
s_sub_u32 s50,s50,1
s_cmp_lg_u32 s50,0
s_cbranch_scc1 vr_243l
s_cmp_lt_u32 s63,s62
s_cselect_b32 s60,0x10001,1
v_mov_b32 v3,s60
v_mov_b32 v6,192
buffer_atomic_add v3,v6,s[12:15],0 offen sc1
s_mov_b64 exec,-1
vr_243:
s_lshl_b32 s3,s49,2
v_mov_b32 v7,s3
s_nop 1
ibw_244:
buffer_load_dword v6,v7,s[12:15],0 offen sc1
s_waitcnt vmcnt(0)
v_cmp_ne_u32 vcc,256,v6
s_nop 0
s_cbranch_vccz ok_245
s_sleep 8
s_sub_u32 s47,s47,1
s_cbranch_scc1 ABORT
s_branch ibw_244
ok_245:
s_cmp_lg_u32 s49,0
s_cbranch_scc1 ibok_246
v_and_b32 v7,7,v0
v_lshlrev_b32 v7,2,v7
buffer_load_dword v6,v7,s[12:15],0 offen offset:32 sc1
s_waitcnt vmcnt(0)
v_cmp_ne_u32 vcc,32,v6
s_nop 0
s_cbranch_vccz ibok_246
s_barrier
s_mov_b32 s49,1
s_mov_b32 s3,s2
s_load_dwordx16 s[16:31],s[0:1],0
s_load_dwordx8 s[32:39],s[0:1],64
s_waitcnt lgkmcnt(0)
s_branch DISPATCH
ibok_246:
s_mov_b32 s83,s100
s_mov_b32 s51,s68
s_mov_b32 s52,0
s_mul_i32 s35,s68,40960
s_add_u32 s35,s35,819200
R1_LOOP:
s_mul_i32 s66,s52,491520
s_add_u32 s66,s66,s69
s_mul_i32 s65,s52,s71
s_add_u32 s65,s65,s70
s_lshl_b32 s60,s51,6
s_add_u32 s60,s60,s52
s_mul_i32 s74,s60,40960
s_add_u32 s74,s74,218365952
s_mul_i32 s75,s60,46080
s_add_u32 s75,s75,223608832
s_lshl_b32 s82,s51,6
s_add_u32 s82,s82,s52
s_lshl_b32 s82,s82,9
s_add_u32 s82,s82,393216
s_lshl_b32 s61,s56,2
s_add_u32 s82,s82,s61
s_cmp_lg_u32 s46,0
s_cbranch_scc1 rp_247
rt_248:
buffer_load_dwordx4 v[24:27],v2,s[8:11],s35 offen sc1
s_waitcnt vmcnt(0)
v_min3_u32 v24,v24,v25,v26
v_min_u32 v24,v24,v27
v_cmp_eq_u32 vcc,0,v24
s_nop 0
s_cbranch_vccz ok_249
s_sleep 3
s_sub_u32 s47,s47,1
s_cbranch_scc1 ABORT
s_branch rt_248
ok_249:
rp_247:
s_barrier
s_add_u32 s63,s66,0
buffer_load_dwordx4 v[68:71],v19,s[8:11],s63 offen sc1
s_add_u32 s63,s66,163840
buffer_load_dwordx4 v[72:75],v19,s[8:11],s63 offen sc1
buffer_load_dwordx4 v[76:79],v16,s[8:11],s65 offen sc1
buffer_load_dword v80,v18,s[8:11],s65 offen sc1
s_add_u32 s63,s66,0
buffer_load_dwordx4 v[36:39],v1,s[8:11],s63 offen sc1
s_add_u32 s63,s66,40960
buffer_load_dwordx4 v[40:43],v1,s[8:11],s63 offen sc1
s_add_u32 s63,s66,81920
buffer_load_dwordx4 v[44:47],v1,s[8:11],s63 offen sc1
s_add_u32 s63,s66,122880
buffer_load_dwordx4 v[48:51],v1,s[8:11],s63 offen sc1
s_add_u32 s63,s66,163840
buffer_load_dwordx4 v[52:55],v1,s[8:11],s63 offen sc1
s_add_u32 s63,s66,204800
buffer_load_dwordx4 v[56:59],v1,s[8:11],s63 offen sc1
s_add_u32 s63,s66,245760
buffer_load_dwordx4 v[60:63],v1,s[8:11],s63 offen sc1
s_add_u32 s63,s66,286720
buffer_load_dwordx4 v[64:67],v1,s[8:11],s63 offen sc1
s_waitcnt vmcnt(11)
v_lshlrev_b32 v92,16,v68
v_and_b32 v93,0xffff0000,v68
v_lshlrev_b32 v94,16,v69
v_and_b32 v95,0xffff0000,v69
v_lshlrev_b32 v96,16,v70
v_and_b32 v97,0xffff0000,v70
v_lshlrev_b32 v98,16,v71
v_and_b32 v99,0xffff0000,v71
s_waitcnt vmcnt(10)
v_dot2c_f32_bf16 v92,s72,v72
v_dot2c_f32_bf16 v93,s73,v72
v_dot2c_f32_bf16 v94,s72,v73
v_dot2c_f32_bf16 v95,s73,v73
v_dot2c_f32_bf16 v96,s72,v74
v_dot2c_f32_bf16 v97,s73,v74
v_dot2c_f32_bf16 v98,s72,v75
v_dot2c_f32_bf16 v99,s73,v75
v_permlane32_swap_b32 v92,v96
v_permlane32_swap_b32 v93,v97
v_permlane32_swap_b32 v94,v98
v_permlane32_swap_b32 v95,v99
v_add_f32 v92,v92,v96
v_add_f32 v93,v93,v97
v_add_f32 v94,v94,v98
v_add_f32 v95,v95,v99
s_nop 0
v_permlane16_swap_b32 v92,v94
v_permlane16_swap_b32 v93,v95
v_add_f32 v90,v92,v94
v_add_f32 v91,v93,v95
s_waitcnt vmcnt(8)
v_lshlrev_b32 v100,16,v76
v_and_b32 v101,0xffff0000,v76
v_lshlrev_b32 v102,16,v77
v_and_b32 v103,0xffff0000,v77
v_lshlrev_b32 v104,16,v78
v_and_b32 v105,0xffff0000,v78
v_lshlrev_b32 v106,16,v79
v_and_b32 v107,0xffff0000,v79
v_lshlrev_b32 v108,16,v80
v_and_b32 v109,0xffff0000,v80
s_waitcnt vmcnt(7)
v_lshlrev_b32 v82,16,v36
v_and_b32 v83,0xffff0000,v36
v_lshlrev_b32 v84,16,v37
v_and_b32 v85,0xffff0000,v37
v_lshlrev_b32 v86,16,v38
v_and_b32 v87,0xffff0000,v38
v_lshlrev_b32 v88,16,v39
v_and_b32 v89,0xffff0000,v39
s_waitcnt vmcnt(6)
v_dot2c_f32_bf16 v82,s72,v40
v_dot2c_f32_bf16 v83,s73,v40
v_dot2c_f32_bf16 v84,s72,v41
v_dot2c_f32_bf16 v85,s73,v41
v_dot2c_f32_bf16 v86,s72,v42
v_dot2c_f32_bf16 v87,s73,v42
v_dot2c_f32_bf16 v88,s72,v43
v_dot2c_f32_bf16 v89,s73,v43
s_waitcnt vmcnt(5)
v_dot2c_f32_bf16 v82,s72,v44
v_dot2c_f32_bf16 v83,s73,v44
v_dot2c_f32_bf16 v84,s72,v45
v_dot2c_f32_bf16 v85,s73,v45
v_dot2c_f32_bf16 v86,s72,v46
v_dot2c_f32_bf16 v87,s73,v46
v_dot2c_f32_bf16 v88,s72,v47
v_dot2c_f32_bf16 v89,s73,v47
s_waitcnt vmcnt(4)
v_dot2c_f32_bf16 v82,s72,v48
v_dot2c_f32_bf16 v83,s73,v48
v_dot2c_f32_bf16 v84,s72,v49
v_dot2c_f32_bf16 v85,s73,v49
v_dot2c_f32_bf16 v86,s72,v50
v_dot2c_f32_bf16 v87,s73,v50
v_dot2c_f32_bf16 v88,s72,v51
v_dot2c_f32_bf16 v89,s73,v51
s_waitcnt vmcnt(3)
v_dot2c_f32_bf16 v82,s72,v52
v_dot2c_f32_bf16 v83,s73,v52
v_dot2c_f32_bf16 v84,s72,v53
v_dot2c_f32_bf16 v85,s73,v53
v_dot2c_f32_bf16 v86,s72,v54
v_dot2c_f32_bf16 v87,s73,v54
v_dot2c_f32_bf16 v88,s72,v55
v_dot2c_f32_bf16 v89,s73,v55
s_waitcnt vmcnt(2)
v_dot2c_f32_bf16 v82,s72,v56
v_dot2c_f32_bf16 v83,s73,v56
v_dot2c_f32_bf16 v84,s72,v57
v_dot2c_f32_bf16 v85,s73,v57
v_dot2c_f32_bf16 v86,s72,v58
v_dot2c_f32_bf16 v87,s73,v58
v_dot2c_f32_bf16 v88,s72,v59
v_dot2c_f32_bf16 v89,s73,v59
s_waitcnt vmcnt(1)
v_dot2c_f32_bf16 v82,s72,v60
v_dot2c_f32_bf16 v83,s73,v60
v_dot2c_f32_bf16 v84,s72,v61
v_dot2c_f32_bf16 v85,s73,v61
v_dot2c_f32_bf16 v86,s72,v62
v_dot2c_f32_bf16 v87,s73,v62
v_dot2c_f32_bf16 v88,s72,v63
v_dot2c_f32_bf16 v89,s73,v63
s_waitcnt vmcnt(0)
v_dot2c_f32_bf16 v82,s72,v64
v_dot2c_f32_bf16 v83,s73,v64
v_dot2c_f32_bf16 v84,s72,v65
v_dot2c_f32_bf16 v85,s73,v65
v_dot2c_f32_bf16 v86,s72,v66
v_dot2c_f32_bf16 v87,s73,v66
v_dot2c_f32_bf16 v88,s72,v67
v_dot2c_f32_bf16 v89,s73,v67
v_cvt_pk_bf16_f32 v6,v82,v83
v_lshlrev_b32 v82,16,v6
v_and_b32 v83,0xffff0000,v6
v_cvt_pk_bf16_f32 v8,v84,v85
v_lshlrev_b32 v84,16,v8
v_and_b32 v85,0xffff0000,v8
v_cvt_pk_bf16_f32 v6,v86,v87
v_lshlrev_b32 v86,16,v6
v_and_b32 v87,0xffff0000,v6
v_cvt_pk_bf16_f32 v8,v88,v89
v_lshlrev_b32 v88,16,v8
v_and_b32 v89,0xffff0000,v8
v_cvt_pk_bf16_f32 v6,v90,v91
v_lshlrev_b32 v90,16,v6
v_and_b32 v91,0xffff0000,v6
v_pk_add_f32 v[82:83],v[82:83],v[100:101]
v_pk_add_f32 v[84:85],v[84:85],v[102:103]
v_pk_add_f32 v[86:87],v[86:87],v[104:105]
v_pk_add_f32 v[88:89],v[88:89],v[106:107]
v_pk_add_f32 v[90:91],v[90:91],v[108:109]
v_cvt_pk_bf16_f32 v112,v82,v83
v_lshlrev_b32 v82,16,v112
v_and_b32 v83,0xffff0000,v112
v_cvt_pk_bf16_f32 v113,v84,v85
v_lshlrev_b32 v84,16,v113
v_and_b32 v85,0xffff0000,v113
v_cvt_pk_bf16_f32 v114,v86,v87
v_lshlrev_b32 v86,16,v114
v_and_b32 v87,0xffff0000,v114
v_cvt_pk_bf16_f32 v115,v88,v89
v_lshlrev_b32 v88,16,v115
v_and_b32 v89,0xffff0000,v115
v_cvt_pk_bf16_f32 v116,v90,v91
v_lshlrev_b32 v90,16,v116
v_and_b32 v91,0xffff0000,v116
v_pk_add_f32 v[32:33],v[82:83],v[84:85]
v_pk_mul_f32 v[30:31],v[82:83],v[82:83]
v_pk_fma_f32 v[30:31],v[84:85],v[84:85],v[30:31]
v_pk_add_f32 v[32:33],v[32:33],v[86:87]
v_pk_fma_f32 v[30:31],v[86:87],v[86:87],v[30:31]
v_pk_add_f32 v[32:33],v[32:33],v[88:89]
v_pk_fma_f32 v[30:31],v[88:89],v[88:89],v[30:31]
v_pk_add_f32 v[32:33],v[32:33],v[90:91]
v_pk_fma_f32 v[30:31],v[90:91],v[90:91],v[30:31]
v_add_f32 v28,v32,v33
v_add_f32 v29,v30,v31
s_nop 0
v_add_f32_dpp v28,v28,v28 row_ror:4 row_mask:0xf bank_mask:0xf
v_add_f32_dpp v29,v29,v29 row_ror:4 row_mask:0xf bank_mask:0xf
s_nop 0
v_add_f32_dpp v28,v28,v28 row_ror:8 row_mask:0xf bank_mask:0xf
v_add_f32_dpp v29,v29,v29 row_ror:8 row_mask:0xf bank_mask:0xf
v_mov_b32 v30,v28
v_mov_b32 v31,v29
s_nop 0
v_permlane32_swap_b32 v28,v30
v_permlane32_swap_b32 v29,v31
v_add_f32 v28,v28,v30
v_add_f32 v29,v29,v31
v_mov_b32 v30,v28
v_mov_b32 v31,v29
s_nop 0
v_permlane16_swap_b32 v28,v30
v_permlane16_swap_b32 v29,v31
v_add_f32 v28,v28,v30
v_add_f32 v29,v29,v31
ds_write_b64 v20,v[28:29]
s_waitcnt lgkmcnt(0)
s_barrier
ds_read_b128 v[136:139],v21
ds_read_b128 v[140:143],v21 offset:16
buffer_store_dwordx4 v[112:115],v16,s[8:11],s74 offen sc1
v_mov_b32 v117,v116
s_nop 1
v_permlane16_swap_b32 v116,v117
s_nop 1
v_permlane32_swap_b32 v116,v118
v_permlane32_swap_b32 v117,v119
s_mov_b64 exec,0xffff
buffer_store_dwordx4 v[116:119],v17,s[8:11],s74 offen sc1
s_mov_b64 exec,-1
s_waitcnt lgkmcnt(0)
v_pk_add_f32 v[136:137],v[136:137],v[138:139]
v_pk_add_f32 v[140:141],v[140:141],v[142:143]
v_pk_add_f32 v[28:29],v[136:137],v[140:141]
v_mul_f32 v28,0x3acccccd,v28
v_mul_f32 v29,0x3acccccd,v29
v_fma_f32 v29,-v28,v28,v29
v_max_f32 v29,0,v29
v_mov_b32 v32,v28
v_mov_b32 v33,v29
v_cvt_pk_bf16_f32 v6,v28,v29
v_lshlrev_b32 v28,16,v6
v_and_b32 v29,0xffff0000,v6
v_add_f32 v29,0x3727c5ac,v29
v_cvt_pk_bf16_f32 v6,v29,v29
v_lshlrev_b32 v29,16,v6
v_sqrt_f32 v29,v29
s_nop 0
v_cvt_pk_bf16_f32 v6,v29,v29
v_lshlrev_b32 v29,16,v6
v_rcp_f32 v29,v29
s_nop 0
v_pk_add_f32 v[82:83],v[82:83],v[28:29] op_sel_hi:[1,0] neg_lo:[0,1] neg_hi:[0,1]
v_pk_add_f32 v[84:85],v[84:85],v[28:29] op_sel_hi:[1,0] neg_lo:[0,1] neg_hi:[0,1]
v_pk_add_f32 v[86:87],v[86:87],v[28:29] op_sel_hi:[1,0] neg_lo:[0,1] neg_hi:[0,1]
v_pk_add_f32 v[88:89],v[88:89],v[28:29] op_sel_hi:[1,0] neg_lo:[0,1] neg_hi:[0,1]
v_pk_add_f32 v[90:91],v[90:91],v[28:29] op_sel_hi:[1,0] neg_lo:[0,1] neg_hi:[0,1]
v_cvt_pk_bf16_f32 v6,v82,v83
v_lshlrev_b32 v82,16,v6
v_and_b32 v83,0xffff0000,v6
v_cvt_pk_bf16_f32 v8,v84,v85
v_lshlrev_b32 v84,16,v8
v_and_b32 v85,0xffff0000,v8
v_cvt_pk_bf16_f32 v6,v86,v87
v_lshlrev_b32 v86,16,v6
v_and_b32 v87,0xffff0000,v6
v_cvt_pk_bf16_f32 v8,v88,v89
v_lshlrev_b32 v88,16,v8
v_and_b32 v89,0xffff0000,v8
v_cvt_pk_bf16_f32 v6,v90,v91
v_lshlrev_b32 v90,16,v6
v_and_b32 v91,0xffff0000,v6
v_pk_mul_f32 v[82:83],v[82:83],v[28:29] op_sel:[0,1] op_sel_hi:[1,1]
v_pk_mul_f32 v[84:85],v[84:85],v[28:29] op_sel:[0,1] op_sel_hi:[1,1]
v_pk_mul_f32 v[86:87],v[86:87],v[28:29] op_sel:[0,1] op_sel_hi:[1,1]
v_pk_mul_f32 v[88:89],v[88:89],v[28:29] op_sel:[0,1] op_sel_hi:[1,1]
v_pk_mul_f32 v[90:91],v[90:91],v[28:29] op_sel:[0,1] op_sel_hi:[1,1]
v_cvt_pk_bf16_f32 v124,v82,v83
v_cvt_pk_bf16_f32 v125,v84,v85
v_cvt_pk_bf16_f32 v126,v86,v87
v_cvt_pk_bf16_f32 v127,v88,v89
v_cvt_pk_bf16_f32 v128,v90,v91
buffer_store_dwordx4 v[124:127],v16,s[8:11],s75 offen sc1
v_mov_b32 v129,v128
s_nop 1
v_permlane16_swap_b32 v128,v129
s_nop 1
v_permlane32_swap_b32 v128,v130
v_permlane32_swap_b32 v129,v131
s_mov_b64 exec,0xffff
buffer_store_dwordx4 v[128:131],v17,s[8:11],s75 offen sc1
s_mov_b64 exec,-1
s_cmp_lg_u32 s46,3
s_cbranch_scc1 zs_250
v_sub_f32 v32,v32,v28
v_mul_f32 v33,v33,v29
v_mul_f32 v32,v32,v29
v_mul_f32 v33,v33,v29
v_cvt_pk_bf16_f32 v6,v32,v33
v_lshlrev_b32 v32,16,v6
v_and_b32 v33,0xffff0000,v6
v_add_f32 v33,0x3727c5ac,v33
v_cvt_pk_bf16_f32 v6,v33,v33
v_lshlrev_b32 v33,16,v6
v_sqrt_f32 v33,v33
s_nop 0
v_cvt_pk_bf16_f32 v6,v33,v33
v_lshlrev_b32 v33,16,v6
v_rcp_f32 v33,v33
s_lshl_b32 s60,s48,5
s_add_u32 s63,s75,s60
s_add_u32 s63,s63,40960
v_lshlrev_b32 v6,3,v0
s_mov_b64 exec,15
buffer_store_dwordx2 v[32:33],v6,s[8:11],s63 offen sc1
s_mov_b64 exec,-1
zs_250:
s_add_u32 s52,s52,1
s_add_u32 s35,s35,640
s_waitcnt vmcnt(0)
s_mov_b64 exec,1
buffer_store_dword v5,v1,s[8:11],s82 offen sc1
s_mov_b64 exec,-1
s_cmp_lt_u32 s52,64
s_cbranch_scc1 R1_LOOP
s_endpgm
ROLE_W1:
v_lshlrev_b32 v1,4,v0
v_mov_b32 v5,1
s_lshl_b32 s56,s48,2
s_add_u32 s56,s56,s46
v_bfe_u32 v6,v0,2,2
v_lshrrev_b32 v7,4,v0
v_add_u32 v7,v6,v7
v_and_b32 v7,3,v7
v_and_b32 v15,3,v0
v_lshlrev_b32 v15,4,v15
v_lshl_add_u32 v15,v7,6,v15
v_lshl_add_u32 v15,v6,8,v15
v_lshrrev_b32 v6,5,v0
v_bfe_u32 v7,v0,4,1
v_lshlrev_b32 v16,10,v7
v_bfe_u32 v7,v0,2,2
v_lshl_add_u32 v16,v7,8,v16
v_add_u32 v6,v6,v7
v_and_b32 v6,3,v6
v_lshl_add_u32 v16,v6,6,v16
v_and_b32 v6,3,v0
v_lshl_add_u32 v16,v6,4,v16
v_add_u32 v18,46080,v16
v_lshrrev_b32 v6,5,v0
v_bfe_u32 v7,v0,4,1
v_lshlrev_b32 v20,10,v7
v_lshl_add_u32 v20,v6,8,v20
v_and_b32 v6,15,v0
v_lshl_add_u32 v20,v6,4,v20
v_lshrrev_b32 v6,5,v0
v_add_u32 v6,2,v6
v_bfe_u32 v7,v0,4,1
v_lshlrev_b32 v17,10,v7
v_bfe_u32 v7,v0,2,2
v_lshl_add_u32 v17,v7,8,v17
v_add_u32 v6,v6,v7
v_and_b32 v6,3,v6
v_lshl_add_u32 v17,v6,6,v17
v_and_b32 v6,3,v0
v_lshl_add_u32 v17,v6,4,v17
v_add_u32 v19,46080,v17
v_lshrrev_b32 v6,5,v0
v_add_u32 v6,2,v6
v_bfe_u32 v7,v0,4,1
v_lshlrev_b32 v21,10,v7
v_lshl_add_u32 v21,v6,8,v21
v_and_b32 v6,15,v0
v_lshl_add_u32 v21,v6,4,v21
v_min_u32 v2,31,v0
v_lshlrev_b32 v2,2,v2
v_mov_b32 v112,0xc0135761
v_mov_b32 v113,0xbdd2d3e8
s_mov_b32 s68,0xbdd2d3e8
v_mov_b32 v116,0
v_mov_b32 v117,0
v_mov_b32 v118,0
v_mov_b32 v119,0
s_lshl_b32 s60,s56,11
s_add_u32 s61,s60,237699072
buffer_store_dwordx4 v[116:119],v1,s[8:11],s61 offen sc1
buffer_store_dwordx4 v[116:119],v1,s[8:11],s61 offen offset:1024 sc1
s_add_u32 s61,s60,238067712
buffer_store_dwordx4 v[116:119],v1,s[8:11],s61 offen sc1
buffer_store_dwordx4 v[116:119],v1,s[8:11],s61 offen offset:1024 sc1
s_waitcnt vmcnt(0)
s_barrier
s_cmp_lg_u32 s46,0
s_cbranch_scc1 arr_251
v_mov_b32 v6,1
s_lshl_b32 s3,s49,2
v_mov_b32 v7,s3
s_mov_b64 exec,1
buffer_atomic_add v6,v7,s[12:15],0 offen sc1
s_mov_b64 exec,-1
arr_251:
s_lshl_b32 s3,s49,2
v_mov_b32 v7,s3
s_nop 1
ibw_252:
buffer_load_dword v6,v7,s[12:15],0 offen sc1
s_waitcnt vmcnt(0)
v_cmp_ne_u32 vcc,256,v6
s_nop 0
s_cbranch_vccz ok_253
s_sleep 8
s_sub_u32 s47,s47,1
s_cbranch_scc1 ABORT
s_branch ibw_252
ok_253:
s_cmp_lg_u32 s49,0
s_cbranch_scc1 ibok_254
v_and_b32 v7,7,v0
v_lshlrev_b32 v7,2,v7
buffer_load_dword v6,v7,s[12:15],0 offen offset:32 sc1
s_waitcnt vmcnt(0)
v_cmp_ne_u32 vcc,32,v6
s_nop 0
s_cbranch_vccz ibok_254
s_barrier
s_mov_b32 s49,1
s_mov_b32 s3,s2
s_load_dwordx16 s[16:31],s[0:1],0
s_load_dwordx8 s[32:39],s[0:1],64
s_waitcnt lgkmcnt(0)
s_branch DISPATCH
ibok_254:
s_lshl_b32 s58,s56,6
s_mul_i32 s63,s46,40960
s_mov_b32 s4,s32
s_mov_b32 s5,s33
s_mov_b32 s6,819200
s_mov_b32 s7,0x20000
v_lshrrev_b32 v9,2,v0
s_mov_b32 s64,1280
v_mul_lo_u32 v9,v9,s64
v_and_b32 v10,3,v0
v_lshl_add_u32 v6,v10,4,v9
s_add_u32 m0,s63,0
s_add_u32 s65,s58,0
buffer_load_dwordx4 v6,s[4:7],s65 offen lds
s_add_u32 m0,s63,1024
s_add_u32 s65,s58,20480
buffer_load_dwordx4 v6,s[4:7],s65 offen lds
s_add_u32 m0,s63,2048
s_add_u32 s65,s58,40960
buffer_load_dwordx4 v6,s[4:7],s65 offen lds
s_add_u32 m0,s63,3072
s_add_u32 s65,s58,61440
buffer_load_dwordx4 v6,s[4:7],s65 offen lds
s_add_u32 m0,s63,4096
s_add_u32 s65,s58,81920
buffer_load_dwordx4 v6,s[4:7],s65 offen lds
s_add_u32 m0,s63,5120
s_add_u32 s65,s58,102400
buffer_load_dwordx4 v6,s[4:7],s65 offen lds
s_add_u32 m0,s63,6144
s_add_u32 s65,s58,122880
buffer_load_dwordx4 v6,s[4:7],s65 offen lds
s_add_u32 m0,s63,7168
s_add_u32 s65,s58,143360
buffer_load_dwordx4 v6,s[4:7],s65 offen lds
s_add_u32 m0,s63,8192
s_add_u32 s65,s58,163840
buffer_load_dwordx4 v6,s[4:7],s65 offen lds
s_add_u32 m0,s63,9216
s_add_u32 s65,s58,184320
buffer_load_dwordx4 v6,s[4:7],s65 offen lds
s_add_u32 m0,s63,10240
s_add_u32 s65,s58,204800
buffer_load_dwordx4 v6,s[4:7],s65 offen lds
s_add_u32 m0,s63,11264
s_add_u32 s65,s58,225280
buffer_load_dwordx4 v6,s[4:7],s65 offen lds
s_add_u32 m0,s63,12288
s_add_u32 s65,s58,245760
buffer_load_dwordx4 v6,s[4:7],s65 offen lds
s_add_u32 m0,s63,13312
s_add_u32 s65,s58,266240
buffer_load_dwordx4 v6,s[4:7],s65 offen lds
s_add_u32 m0,s63,14336
s_add_u32 s65,s58,286720
buffer_load_dwordx4 v6,s[4:7],s65 offen lds
s_add_u32 m0,s63,15360
s_add_u32 s65,s58,307200
buffer_load_dwordx4 v6,s[4:7],s65 offen lds
s_add_u32 m0,s63,16384
s_add_u32 s65,s58,327680
buffer_load_dwordx4 v6,s[4:7],s65 offen lds
s_add_u32 m0,s63,17408
s_add_u32 s65,s58,348160
buffer_load_dwordx4 v6,s[4:7],s65 offen lds
s_add_u32 m0,s63,18432
s_add_u32 s65,s58,368640
buffer_load_dwordx4 v6,s[4:7],s65 offen lds
s_add_u32 m0,s63,19456
s_add_u32 s65,s58,389120
buffer_load_dwordx4 v6,s[4:7],s65 offen lds
s_add_u32 m0,s63,20480
s_add_u32 s65,s58,409600
buffer_load_dwordx4 v6,s[4:7],s65 offen lds
s_add_u32 m0,s63,21504
s_add_u32 s65,s58,430080
buffer_load_dwordx4 v6,s[4:7],s65 offen lds
s_add_u32 m0,s63,22528
s_add_u32 s65,s58,450560
buffer_load_dwordx4 v6,s[4:7],s65 offen lds
s_add_u32 m0,s63,23552
s_add_u32 s65,s58,471040
buffer_load_dwordx4 v6,s[4:7],s65 offen lds
s_add_u32 m0,s63,24576
s_add_u32 s65,s58,491520
buffer_load_dwordx4 v6,s[4:7],s65 offen lds
s_add_u32 m0,s63,25600
s_add_u32 s65,s58,512000
buffer_load_dwordx4 v6,s[4:7],s65 offen lds
s_add_u32 m0,s63,26624
s_add_u32 s65,s58,532480
buffer_load_dwordx4 v6,s[4:7],s65 offen lds
s_add_u32 m0,s63,27648
s_add_u32 s65,s58,552960
buffer_load_dwordx4 v6,s[4:7],s65 offen lds
s_add_u32 m0,s63,28672
s_add_u32 s65,s58,573440
buffer_load_dwordx4 v6,s[4:7],s65 offen lds
s_add_u32 m0,s63,29696
s_add_u32 s65,s58,593920
buffer_load_dwordx4 v6,s[4:7],s65 offen lds
s_add_u32 m0,s63,30720
s_add_u32 s65,s58,614400
buffer_load_dwordx4 v6,s[4:7],s65 offen lds
s_add_u32 m0,s63,31744
s_add_u32 s65,s58,634880
buffer_load_dwordx4 v6,s[4:7],s65 offen lds
s_add_u32 m0,s63,32768
s_add_u32 s65,s58,655360
buffer_load_dwordx4 v6,s[4:7],s65 offen lds
s_add_u32 m0,s63,33792
s_add_u32 s65,s58,675840
buffer_load_dwordx4 v6,s[4:7],s65 offen lds
s_add_u32 m0,s63,34816
s_add_u32 s65,s58,696320
buffer_load_dwordx4 v6,s[4:7],s65 offen lds
s_add_u32 m0,s63,35840
s_add_u32 s65,s58,716800
buffer_load_dwordx4 v6,s[4:7],s65 offen lds
s_add_u32 m0,s63,36864
s_add_u32 s65,s58,737280
buffer_load_dwordx4 v6,s[4:7],s65 offen lds
s_add_u32 m0,s63,37888
s_add_u32 s65,s58,757760
buffer_load_dwordx4 v6,s[4:7],s65 offen lds
s_add_u32 m0,s63,38912
s_add_u32 s65,s58,778240
buffer_load_dwordx4 v6,s[4:7],s65 offen lds
s_add_u32 m0,s63,39936
s_add_u32 s65,s58,798720
buffer_load_dwordx4 v6,s[4:7],s65 offen lds
s_waitcnt vmcnt(20)
v_bfe_u32 v9,v0,2,2
v_lshrrev_b32 v10,5,v0
v_lshl_add_u32 v9,v10,2,v9
v_mul_u32_u24 v9,64,v9
v_and_b32 v10,1,v0
v_lshl_add_u32 v9,v10,3,v9
v_bfe_u32 v10,v0,1,1
v_lshl_add_u32 v9,v10,5,v9
v_bfe_u32 v10,v0,4,1
v_lshl_add_u32 v9,v10,4,v9
v_add_u32 v7,s63,v9
ds_read_b64_tr_b16 a[0:1],v7 offset:0
ds_read_b64_tr_b16 a[2:3],v7 offset:1024
ds_read_b64_tr_b16 a[4:5],v7 offset:512
ds_read_b64_tr_b16 a[6:7],v7 offset:1536
ds_read_b64_tr_b16 a[8:9],v7 offset:2048
ds_read_b64_tr_b16 a[10:11],v7 offset:3072
ds_read_b64_tr_b16 a[12:13],v7 offset:2560
ds_read_b64_tr_b16 a[14:15],v7 offset:3584
ds_read_b64_tr_b16 a[16:17],v7 offset:4096
ds_read_b64_tr_b16 a[18:19],v7 offset:5120
ds_read_b64_tr_b16 a[20:21],v7 offset:4608
ds_read_b64_tr_b16 a[22:23],v7 offset:5632
s_waitcnt lgkmcnt(4)
ds_read_b64_tr_b16 a[24:25],v7 offset:6144
ds_read_b64_tr_b16 a[26:27],v7 offset:7168
ds_read_b64_tr_b16 a[28:29],v7 offset:6656
ds_read_b64_tr_b16 a[30:31],v7 offset:7680
ds_read_b64_tr_b16 a[32:33],v7 offset:8192
ds_read_b64_tr_b16 a[34:35],v7 offset:9216
ds_read_b64_tr_b16 a[36:37],v7 offset:8704
ds_read_b64_tr_b16 a[38:39],v7 offset:9728
ds_read_b64_tr_b16 a[40:41],v7 offset:10240
ds_read_b64_tr_b16 a[42:43],v7 offset:11264
ds_read_b64_tr_b16 a[44:45],v7 offset:10752
ds_read_b64_tr_b16 a[46:47],v7 offset:11776
s_waitcnt lgkmcnt(4)
ds_read_b64_tr_b16 a[48:49],v7 offset:12288
ds_read_b64_tr_b16 a[50:51],v7 offset:13312
ds_read_b64_tr_b16 a[52:53],v7 offset:12800
ds_read_b64_tr_b16 a[54:55],v7 offset:13824
ds_read_b64_tr_b16 a[56:57],v7 offset:14336
ds_read_b64_tr_b16 a[58:59],v7 offset:15360
ds_read_b64_tr_b16 a[60:61],v7 offset:14848
ds_read_b64_tr_b16 a[62:63],v7 offset:15872
ds_read_b64_tr_b16 a[64:65],v7 offset:16384
ds_read_b64_tr_b16 a[66:67],v7 offset:17408
ds_read_b64_tr_b16 a[68:69],v7 offset:16896
ds_read_b64_tr_b16 a[70:71],v7 offset:17920
s_waitcnt lgkmcnt(4)
ds_read_b64_tr_b16 a[72:73],v7 offset:18432
ds_read_b64_tr_b16 a[74:75],v7 offset:19456
ds_read_b64_tr_b16 a[76:77],v7 offset:18944
ds_read_b64_tr_b16 a[78:79],v7 offset:19968
s_waitcnt lgkmcnt(0)
s_waitcnt vmcnt(0)
v_bfe_u32 v9,v0,2,2
v_lshrrev_b32 v10,5,v0
v_lshl_add_u32 v9,v10,2,v9
v_mul_u32_u24 v9,64,v9
v_and_b32 v10,1,v0
v_lshl_add_u32 v9,v10,3,v9
v_bfe_u32 v10,v0,1,1
v_lshl_add_u32 v9,v10,5,v9
v_bfe_u32 v10,v0,4,1
v_lshl_add_u32 v9,v10,4,v9
v_add_u32 v7,s63,v9
ds_read_b64_tr_b16 a[80:81],v7 offset:20480
ds_read_b64_tr_b16 a[82:83],v7 offset:21504
ds_read_b64_tr_b16 a[84:85],v7 offset:20992
ds_read_b64_tr_b16 a[86:87],v7 offset:22016
ds_read_b64_tr_b16 a[88:89],v7 offset:22528
ds_read_b64_tr_b16 a[90:91],v7 offset:23552
ds_read_b64_tr_b16 a[92:93],v7 offset:23040
ds_read_b64_tr_b16 a[94:95],v7 offset:24064
ds_read_b64_tr_b16 a[96:97],v7 offset:24576
ds_read_b64_tr_b16 a[98:99],v7 offset:25600
ds_read_b64_tr_b16 a[100:101],v7 offset:25088
ds_read_b64_tr_b16 a[102:103],v7 offset:26112
s_waitcnt lgkmcnt(4)
ds_read_b64_tr_b16 a[104:105],v7 offset:26624
ds_read_b64_tr_b16 a[106:107],v7 offset:27648
ds_read_b64_tr_b16 a[108:109],v7 offset:27136
ds_read_b64_tr_b16 a[110:111],v7 offset:28160
ds_read_b64_tr_b16 a[112:113],v7 offset:28672
ds_read_b64_tr_b16 a[114:115],v7 offset:29696
ds_read_b64_tr_b16 a[116:117],v7 offset:29184
ds_read_b64_tr_b16 a[118:119],v7 offset:30208
ds_read_b64_tr_b16 a[120:121],v7 offset:30720
ds_read_b64_tr_b16 a[122:123],v7 offset:31744
ds_read_b64_tr_b16 a[124:125],v7 offset:31232
ds_read_b64_tr_b16 a[126:127],v7 offset:32256
s_waitcnt lgkmcnt(4)
ds_read_b64_tr_b16 a[128:129],v7 offset:32768
ds_read_b64_tr_b16 a[130:131],v7 offset:33792
ds_read_b64_tr_b16 a[132:133],v7 offset:33280
ds_read_b64_tr_b16 a[134:135],v7 offset:34304
ds_read_b64_tr_b16 a[136:137],v7 offset:34816
ds_read_b64_tr_b16 a[138:139],v7 offset:35840
ds_read_b64_tr_b16 a[140:141],v7 offset:35328
ds_read_b64_tr_b16 a[142:143],v7 offset:36352
ds_read_b64_tr_b16 a[144:145],v7 offset:36864
ds_read_b64_tr_b16 a[146:147],v7 offset:37888
ds_read_b64_tr_b16 a[148:149],v7 offset:37376
ds_read_b64_tr_b16 a[150:151],v7 offset:38400
s_waitcnt lgkmcnt(4)
ds_read_b64_tr_b16 a[152:153],v7 offset:38912
ds_read_b64_tr_b16 a[154:155],v7 offset:39936
ds_read_b64_tr_b16 a[156:157],v7 offset:39424
ds_read_b64_tr_b16 a[158:159],v7 offset:40448
s_waitcnt lgkmcnt(0)
v_mov_b32 v24,0x3f803f80
v_mov_b32 v25,0x3f803f80
v_mov_b32 v26,0x3f803f80
v_mov_b32 v27,0x3f803f80
s_nop 1
v_mfma_f32_32x32x16_bf16 v[144:159],a[0:3],v[24:27],0
v_mfma_f32_32x32x16_bf16 v[144:159],a[4:7],v[24:27],v[144:159]
v_mfma_f32_32x32x16_bf16 v[144:159],a[8:11],v[24:27],v[144:159]
v_mfma_f32_32x32x16_bf16 v[144:159],a[12:15],v[24:27],v[144:159]
v_mfma_f32_32x32x16_bf16 v[144:159],a[16:19],v[24:27],v[144:159]
v_mfma_f32_32x32x16_bf16 v[144:159],a[20:23],v[24:27],v[144:159]
v_mfma_f32_32x32x16_bf16 v[144:159],a[24:27],v[24:27],v[144:159]
v_mfma_f32_32x32x16_bf16 v[144:159],a[28:31],v[24:27],v[144:159]
v_mfma_f32_32x32x16_bf16 v[144:159],a[32:35],v[24:27],v[144:159]
v_mfma_f32_32x32x16_bf16 v[144:159],a[36:39],v[24:27],v[144:159]
v_mfma_f32_32x32x16_bf16 v[144:159],a[40:43],v[24:27],v[144:159]
v_mfma_f32_32x32x16_bf16 v[144:159],a[44:47],v[24:27],v[144:159]
v_mfma_f32_32x32x16_bf16 v[144:159],a[48:51],v[24:27],v[144:159]
v_mfma_f32_32x32x16_bf16 v[144:159],a[52:55],v[24:27],v[144:159]
v_mfma_f32_32x32x16_bf16 v[144:159],a[56:59],v[24:27],v[144:159]
v_mfma_f32_32x32x16_bf16 v[144:159],a[60:63],v[24:27],v[144:159]
v_mfma_f32_32x32x16_bf16 v[144:159],a[64:67],v[24:27],v[144:159]
v_mfma_f32_32x32x16_bf16 v[144:159],a[68:71],v[24:27],v[144:159]
v_mfma_f32_32x32x16_bf16 v[144:159],a[72:75],v[24:27],v[144:159]
v_mfma_f32_32x32x16_bf16 v[144:159],a[76:79],v[24:27],v[144:159]
v_mfma_f32_32x32x16_bf16 v[144:159],a[80:83],v[24:27],v[144:159]
v_mfma_f32_32x32x16_bf16 v[144:159],a[84:87],v[24:27],v[144:159]
v_mfma_f32_32x32x16_bf16 v[144:159],a[88:91],v[24:27],v[144:159]
v_mfma_f32_32x32x16_bf16 v[144:159],a[92:95],v[24:27],v[144:159]
v_mfma_f32_32x32x16_bf16 v[144:159],a[96:99],v[24:27],v[144:159]
v_mfma_f32_32x32x16_bf16 v[144:159],a[100:103],v[24:27],v[144:159]
v_mfma_f32_32x32x16_bf16 v[144:159],a[104:107],v[24:27],v[144:159]
v_mfma_f32_32x32x16_bf16 v[144:159],a[108:111],v[24:27],v[144:159]
v_mfma_f32_32x32x16_bf16 v[144:159],a[112:115],v[24:27],v[144:159]
v_mfma_f32_32x32x16_bf16 v[144:159],a[116:119],v[24:27],v[144:159]
v_mfma_f32_32x32x16_bf16 v[144:159],a[120:123],v[24:27],v[144:159]
v_mfma_f32_32x32x16_bf16 v[144:159],a[124:127],v[24:27],v[144:159]
v_mfma_f32_32x32x16_bf16 v[144:159],a[128:131],v[24:27],v[144:159]
v_mfma_f32_32x32x16_bf16 v[144:159],a[132:135],v[24:27],v[144:159]
v_mfma_f32_32x32x16_bf16 v[144:159],a[136:139],v[24:27],v[144:159]
v_mfma_f32_32x32x16_bf16 v[144:159],a[140:143],v[24:27],v[144:159]
v_mfma_f32_32x32x16_bf16 v[144:159],a[144:147],v[24:27],v[144:159]
v_mfma_f32_32x32x16_bf16 v[144:159],a[148:151],v[24:27],v[144:159]
v_mfma_f32_32x32x16_bf16 v[144:159],a[152:155],v[24:27],v[144:159]
v_mfma_f32_32x32x16_bf16 v[144:159],a[156:159],v[24:27],v[144:159]
v_and_b32 v182,31,v0
v_lshlrev_b32 v182,3,v182
v_add_u32 v182,0xa000,v182
s_barrier
s_mov_b32 s50,0
s_mov_b32 s32,0
s_mov_b32 s57,0
s_mov_b32 s59,2147483648
s_mov_b32 s82,2147483648
s_mov_b32 s39,2147483648
v_mov_b32 v22,94208
v_lshl_add_u32 v22,v0,2,v22
v_mov_b32 v23,0
ds_write_b32 v22,v23
s_mov_b32 s39,1600000
v_and_b32 v72,15,v0
v_lshlrev_b32 v72,7,v72
v_min_u32 v6,51,v0
v_lshlrev_b32 v6,2,v6
v_add_u32 v2,0,v6
v_add_u32 v7,127360,v6
v_cmp_gt_u32 s[78:79],32,v0
s_nop 1
v_cndmask_b32 v2,v7,v2,s[78:79]
s_mov_b32 s51,0
s_mov_b32 s52,0
s_mul_i32 s62,s51,9
s_and_b32 s63,s52,7
s_add_u32 s62,s62,s63
s_mul_i32 s62,s62,40960
s_add_u32 s62,s62,237371392
s_lshl_b32 s63,s56,11
s_add_u32 s62,s62,s63
buffer_load_dword v73,v72,s[8:11],s62 offen sc1
s_mov_b32 s51,0
s_mov_b32 s52,1
s_mul_i32 s62,s51,9
s_and_b32 s63,s52,7
s_add_u32 s62,s62,s63
s_mul_i32 s62,s62,40960
s_add_u32 s62,s62,237371392
s_lshl_b32 s63,s56,11
s_add_u32 s62,s62,s63
buffer_load_dword v73,v72,s[8:11],s62 offen sc1
s_mov_b32 s51,0
s_mov_b32 s52,2
s_mul_i32 s62,s51,9
s_and_b32 s63,s52,7
s_add_u32 s62,s62,s63
s_mul_i32 s62,s62,40960
s_add_u32 s62,s62,237371392
s_lshl_b32 s63,s56,11
s_add_u32 s62,s62,s63
buffer_load_dword v73,v72,s[8:11],s62 offen sc1
s_mov_b32 s51,0
s_mov_b32 s52,3
s_mul_i32 s62,s51,9
s_and_b32 s63,s52,7
s_add_u32 s62,s62,s63
s_mul_i32 s62,s62,40960
s_add_u32 s62,s62,237371392
s_lshl_b32 s63,s56,11
s_add_u32 s62,s62,s63
buffer_load_dword v73,v72,s[8:11],s62 offen sc1
s_mov_b32 s51,0
s_mov_b32 s52,4
s_mul_i32 s62,s51,9
s_and_b32 s63,s52,7
s_add_u32 s62,s62,s63
s_mul_i32 s62,s62,40960
s_add_u32 s62,s62,237371392
s_lshl_b32 s63,s56,11
s_add_u32 s62,s62,s63
buffer_load_dword v73,v72,s[8:11],s62 offen sc1
s_mov_b32 s51,0
s_mov_b32 s52,5
s_mul_i32 s62,s51,9
s_and_b32 s63,s52,7
s_add_u32 s62,s62,s63
s_mul_i32 s62,s62,40960
s_add_u32 s62,s62,237371392
s_lshl_b32 s63,s56,11
s_add_u32 s62,s62,s63
buffer_load_dword v73,v72,s[8:11],s62 offen sc1
s_mov_b32 s51,0
s_mov_b32 s52,6
s_mul_i32 s62,s51,9
s_and_b32 s63,s52,7
s_add_u32 s62,s62,s63
s_mul_i32 s62,s62,40960
s_add_u32 s62,s62,237371392
s_lshl_b32 s63,s56,11
s_add_u32 s62,s62,s63
buffer_load_dword v73,v72,s[8:11],s62 offen sc1
s_mov_b32 s51,0
s_mov_b32 s52,7
s_mul_i32 s62,s51,9
s_and_b32 s63,s52,7
s_add_u32 s62,s62,s63
s_mul_i32 s62,s62,40960
s_add_u32 s62,s62,237371392
s_lshl_b32 s63,s56,11
s_add_u32 s62,s62,s63
buffer_load_dword v73,v72,s[8:11],s62 offen sc1
s_mov_b32 s51,1
s_mov_b32 s52,0
s_mul_i32 s62,s51,9
s_and_b32 s63,s52,7
s_add_u32 s62,s62,s63
s_mul_i32 s62,s62,40960
s_add_u32 s62,s62,237371392
s_lshl_b32 s63,s56,11
s_add_u32 s62,s62,s63
buffer_load_dword v73,v72,s[8:11],s62 offen sc1
s_mov_b32 s51,1
s_mov_b32 s52,1
s_mul_i32 s62,s51,9
s_and_b32 s63,s52,7
s_add_u32 s62,s62,s63
s_mul_i32 s62,s62,40960
s_add_u32 s62,s62,237371392
s_lshl_b32 s63,s56,11
s_add_u32 s62,s62,s63
buffer_load_dword v73,v72,s[8:11],s62 offen sc1
s_mov_b32 s51,1
s_mov_b32 s52,2
s_mul_i32 s62,s51,9
s_and_b32 s63,s52,7
s_add_u32 s62,s62,s63
s_mul_i32 s62,s62,40960
s_add_u32 s62,s62,237371392
s_lshl_b32 s63,s56,11
s_add_u32 s62,s62,s63
buffer_load_dword v73,v72,s[8:11],s62 offen sc1
s_mov_b32 s51,1
s_mov_b32 s52,3
s_mul_i32 s62,s51,9
s_and_b32 s63,s52,7
s_add_u32 s62,s62,s63
s_mul_i32 s62,s62,40960
s_add_u32 s62,s62,237371392
s_lshl_b32 s63,s56,11
s_add_u32 s62,s62,s63
buffer_load_dword v73,v72,s[8:11],s62 offen sc1
s_mov_b32 s51,1
s_mov_b32 s52,4
s_mul_i32 s62,s51,9
s_and_b32 s63,s52,7
s_add_u32 s62,s62,s63
s_mul_i32 s62,s62,40960
s_add_u32 s62,s62,237371392
s_lshl_b32 s63,s56,11
s_add_u32 s62,s62,s63
buffer_load_dword v73,v72,s[8:11],s62 offen sc1
s_mov_b32 s51,1
s_mov_b32 s52,5
s_mul_i32 s62,s51,9
s_and_b32 s63,s52,7
s_add_u32 s62,s62,s63
s_mul_i32 s62,s62,40960
s_add_u32 s62,s62,237371392
s_lshl_b32 s63,s56,11
s_add_u32 s62,s62,s63
buffer_load_dword v73,v72,s[8:11],s62 offen sc1
s_mov_b32 s51,1
s_mov_b32 s52,6
s_mul_i32 s62,s51,9
s_and_b32 s63,s52,7
s_add_u32 s62,s62,s63
s_mul_i32 s62,s62,40960
s_add_u32 s62,s62,237371392
s_lshl_b32 s63,s56,11
s_add_u32 s62,s62,s63
buffer_load_dword v73,v72,s[8:11],s62 offen sc1
s_mov_b32 s51,1
s_mov_b32 s52,7
s_mul_i32 s62,s51,9
s_and_b32 s63,s52,7
s_add_u32 s62,s62,s63
s_mul_i32 s62,s62,40960
s_add_u32 s62,s62,237371392
s_lshl_b32 s63,s56,11
s_add_u32 s62,s62,s63
buffer_load_dword v73,v72,s[8:11],s62 offen sc1
s_waitcnt vmcnt(0)
s_waitcnt lgkmcnt(0)
s_barrier
s_mov_b32 s83,s100
s_min_u32 s62,s32,127
s_sub_u32 s60,s62,15
s_lshr_b32 s34,s60,1
s_and_b32 s33,s60,1
s_cmp_eq_u32 s33,0
s_cselect_b32 s61,15,0
s_add_u32 s34,s34,s61
s_sub_u32 s61,s60,49
s_cmp_ge_u32 s60,98
s_cselect_b32 s34,s61,s34
s_cselect_b32 s33,1,s33
s_cmp_lt_u32 s62,15
s_cselect_b32 s34,s62,s34
s_cselect_b32 s33,0,s33
s_lshl_b32 s35,s33,6
s_add_u32 s35,s35,s34
s_lshl_b32 s35,s35,9
s_add_u32 s35,s35,393216
s_cmp_lt_u32 s34,7
s_cselect_b64 s[76:77],s[78:79],-1
s_sub_u32 s57,46080,s57
v_swap_b32 v16,v18
v_swap_b32 v17,v19
s_add_u32 s62,s32,1
s_min_u32 s62,s62,127
s_sub_u32 s60,s62,15
s_lshr_b32 s41,s60,1
s_and_b32 s40,s60,1
s_cmp_eq_u32 s40,0
s_cselect_b32 s61,15,0
s_add_u32 s41,s41,s61
s_sub_u32 s61,s60,49
s_cmp_ge_u32 s60,98
s_cselect_b32 s41,s61,s41
s_cselect_b32 s40,1,s40
s_cmp_lt_u32 s62,15
s_cselect_b32 s41,s62,s41
s_cselect_b32 s40,0,s40
s_lshl_b32 s42,s40,6
s_add_u32 s42,s42,s41
s_lshl_b32 s42,s42,9
s_add_u32 s42,s42,393216
s_cmp_lt_u32 s41,7
s_cselect_b64 s[80:81],s[78:79],-1
W1_COLD:
s_mov_b32 s37,0
s_cmp_lg_u32 s46,0
s_cbranch_scc1 wo_255
fb_257:
buffer_load_dword v3,v2,s[8:11],s35 offen sc1
s_waitcnt vmcnt(0)
v_cmp_eq_u32 vcc,0,v3
s_and_b64 vcc,vcc,s[76:77]
s_cbranch_scc0 ok_258
s_sleep 3
s_sub_u32 s47,s47,1
s_cbranch_scc1 ABORT
s_branch fb_257
ok_258:
W1_COLD2:
s_add_u32 s65,s32,1
s_or_b32 s65,s65,s37
v_mov_b32 v23,s65
ds_max_i32 v22,v23
s_branch wd_256
wo_255:
ds_read_b32 v23,v22
s_waitcnt lgkmcnt(0)
v_cmp_ge_u32 vcc,s32,v23
s_nop 0
s_cbranch_vccz wd_256
s_sleep 1
s_sub_u32 s39,s39,1
s_cbranch_scc1 ABORT
s_branch wo_255
wd_256:
s_sub_u32 s66,46080,s57
s_lshl_b32 s60,s33,6
s_add_u32 s60,s60,s34
s_mul_i32 s60,s60,46080
s_add_u32 s60,s60,s37
s_add_u32 s60,s60,223608832
s_mov_b32 s67,s60
s_mul_i32 s61,s46,10240
s_add_u32 s60,s60,s61
s_add_u32 s61,s61,s66
s_add_u32 m0,s61,0
s_add_u32 s63,s60,0
buffer_load_dwordx4 v1,s[8:11],s63 offen sc1 lds
buffer_load_dwordx4 v1,s[8:11],s63 offen offset:1024 sc1 lds
buffer_load_dwordx4 v1,s[8:11],s63 offen offset:2048 sc1 lds
buffer_load_dwordx4 v1,s[8:11],s63 offen offset:3072 sc1 lds
s_add_u32 m0,s61,4096
s_add_u32 s63,s60,4096
buffer_load_dwordx4 v1,s[8:11],s63 offen sc1 lds
buffer_load_dwordx4 v1,s[8:11],s63 offen offset:1024 sc1 lds
s_waitcnt vmcnt(6)
s_mov_b64 exec,1
s_cmp_lg_u32 s49,0
s_cbranch_scc0 ls_259
buffer_store_dword v5,v1,s[8:11],s59 offen sc1
s_branch ls_260
ls_259:
buffer_store_dword v5,v1,s[8:11],s59 offen
ls_260:
s_mov_b64 exec,-1
s_mov_b32 s59,2147483648
buffer_load_dwordx4 v1,s[8:11],s63 offen offset:2048 sc1 lds
buffer_load_dwordx4 v1,s[8:11],s63 offen offset:3072 sc1 lds
s_add_u32 m0,s61,8192
s_add_u32 s63,s60,8192
buffer_load_dwordx4 v1,s[8:11],s63 offen sc1 lds
buffer_load_dwordx4 v1,s[8:11],s63 offen offset:1024 sc1 lds
s_add_u32 m0,s66,40960
s_add_u32 s63,s67,40960
buffer_load_dwordx4 v1,s[8:11],s63 offen sc1 lds
s_mov_b32 s35,s42
buffer_load_dword v3,v2,s[8:11],s35 offen sc1
s_mov_b32 s53,s33
s_mov_b32 s54,s34
s_add_u32 s32,s32,1
s_mov_b32 s33,s40
s_mov_b32 s34,s41
s_mov_b64 s[76:77],s[80:81]
s_sub_u32 s57,46080,s57
v_swap_b32 v16,v18
v_swap_b32 v17,v19
s_mov_b32 s51,s53
s_mov_b32 s52,s54
s_mov_b32 s37,2147483648
s_waitcnt vmcnt(7)
s_branch W1_GO
W1_NEXT:
s_sub_u32 s57,46080,s57
v_swap_b32 v16,v18
v_swap_b32 v17,v19
s_mov_b32 s51,s53
s_mov_b32 s52,s54
s_waitcnt vmcnt(2)
v_cmp_eq_u32 vcc,0,v3
s_and_b64 vcc,vcc,s[76:77]
s_cselect_b32 s37,2147483648,0
s_cmp_lt_u32 s32,128
s_cselect_b32 s37,s37,2147483648
W1_GO:
s_barrier
ds_read_b128 v[24:27],v16 offset:0
ds_read_b128 v[28:31],v17 offset:0
ds_read_b128 v[32:35],v16 offset:10240
ds_read_b128 v[36:39],v17 offset:10240
ds_read_b128 v[40:43],v16 offset:20480
ds_read_b128 v[44:47],v17 offset:20480
ds_read_b128 v[48:51],v16 offset:30720
s_waitcnt lgkmcnt(6)
v_mfma_f32_32x32x16_bf16 v[56:71],a[0:3],v[24:27],0
ds_read_b128 v[52:55],v17 offset:30720
s_lshl_b32 s60,s51,6
s_add_u32 s60,s60,s52
s_mul_i32 s60,s60,40960
s_waitcnt lgkmcnt(6)
v_mfma_f32_32x32x16_bf16 v[56:71],a[4:7],v[28:31],v[56:71]
ds_read_b128 v[24:27],v16 offset:2048
s_lshl_b32 s61,s56,11
s_add_u32 s60,s60,s61
s_add_u32 s60,s60,218365952
s_waitcnt lgkmcnt(5)
v_mfma_f32_32x32x16_bf16 v[56:71],a[40:43],v[32:35],v[56:71]
ds_read_b128 v[28:31],v17 offset:2048
buffer_load_dword v73,v72,s[8:11],s60 offen sc1
s_add_u32 s65,s32,1
s_or_b32 s65,s65,s37
v_mfma_f32_32x32x16_bf16 v[56:71],a[44:47],v[36:39],v[56:71]
ds_read_b128 v[32:35],v16 offset:12288
v_mov_b32 v23,s65
ds_max_i32 v22,v23
s_waitcnt lgkmcnt(6)
v_mfma_f32_32x32x16_bf16 v[56:71],a[80:83],v[40:43],v[56:71]
ds_read_b128 v[36:39],v17 offset:12288
s_sub_u32 s66,46080,s57
s_lshl_b32 s60,s33,6
s_add_u32 s60,s60,s34
s_mul_i32 s60,s60,46080
v_mfma_f32_32x32x16_bf16 v[56:71],a[84:87],v[44:47],v[56:71]
ds_read_b128 v[40:43],v16 offset:22528
s_add_u32 s60,s60,s37
s_add_u32 s60,s60,223608832
s_mov_b32 s67,s60
s_waitcnt lgkmcnt(6)
v_mfma_f32_32x32x16_bf16 v[56:71],a[120:123],v[48:51],v[56:71]
ds_read_b128 v[44:47],v17 offset:22528
s_mul_i32 s61,s46,10240
s_add_u32 s60,s60,s61
s_add_u32 s61,s61,s66
s_add_u32 m0,s61,0
v_mfma_f32_32x32x16_bf16 v[56:71],a[124:127],v[52:55],v[56:71]
ds_read_b128 v[48:51],v16 offset:32768
s_add_u32 s63,s60,0
buffer_load_dwordx4 v1,s[8:11],s63 offen sc1 lds
s_waitcnt lgkmcnt(6)
v_mfma_f32_32x32x16_bf16 v[56:71],a[8:11],v[24:27],v[56:71]
ds_read_b128 v[52:55],v17 offset:32768
s_mul_i32 s71,s51,9
s_and_b32 s72,s52,7
s_add_u32 s71,s71,s72
s_mul_i32 s71,s71,40960
v_mfma_f32_32x32x16_bf16 v[56:71],a[12:15],v[28:31],v[56:71]
ds_read_b128 v[24:27],v16 offset:4096
s_add_u32 s71,s71,237371392
s_lshl_b32 s72,s56,11
s_add_u32 s71,s71,s72
s_waitcnt lgkmcnt(5)
v_mfma_f32_32x32x16_bf16 v[56:71],a[48:51],v[32:35],v[56:71]
ds_read_b128 v[28:31],v17 offset:4096
buffer_load_dword v3,v2,s[8:11],s35 offen sc1
s_lshl_b32 s82,s51,6
v_mfma_f32_32x32x16_bf16 v[56:71],a[52:55],v[36:39],v[56:71]
ds_read_b128 v[32:35],v16 offset:14336
buffer_load_dwordx4 v1,s[8:11],s63 offen offset:1024 sc1 lds
s_add_u32 s82,s82,s52
s_waitcnt lgkmcnt(5)
v_mfma_f32_32x32x16_bf16 v[56:71],a[88:91],v[40:43],v[56:71]
ds_read_b128 v[36:39],v17 offset:14336
s_waitcnt vmcnt(4)
s_mov_b64 exec,1
s_cmp_lg_u32 s49,0
s_cbranch_scc0 ls_261
buffer_store_dword v5,v1,s[8:11],s59 offen sc1
s_branch ls_262
ls_261:
buffer_store_dword v5,v1,s[8:11],s59 offen
ls_262:
s_mov_b64 exec,-1
s_mov_b32 s59,2147483648
v_mfma_f32_32x32x16_bf16 v[56:71],a[92:95],v[44:47],v[56:71]
ds_read_b128 v[40:43],v16 offset:24576
s_lshl_b32 s82,s82,9
s_add_u32 s82,s82,458752
s_lshl_b32 s70,s56,2
s_waitcnt lgkmcnt(5)
v_mfma_f32_32x32x16_bf16 v[56:71],a[128:131],v[48:51],v[56:71]
ds_read_b128 v[44:47],v17 offset:24576
buffer_load_dwordx4 v1,s[8:11],s63 offen offset:2048 sc1 lds
s_add_u32 s82,s82,s70
v_mfma_f32_32x32x16_bf16 v[56:71],a[132:135],v[52:55],v[56:71]
ds_read_b128 v[48:51],v16 offset:34816
s_waitcnt lgkmcnt(5)
v_mfma_f32_32x32x16_bf16 v[56:71],a[16:19],v[24:27],v[56:71]
ds_read_b128 v[52:55],v17 offset:34816
s_barrier
v_mfma_f32_32x32x16_bf16 v[56:71],a[20:23],v[28:31],v[56:71]
ds_read_b128 v[24:27],v16 offset:6144
v_add_u32 v183,s57,v182
buffer_load_dwordx4 v1,s[8:11],s63 offen offset:3072 sc1 lds
s_waitcnt lgkmcnt(5)
v_mfma_f32_32x32x16_bf16 v[56:71],a[56:59],v[32:35],v[56:71]
ds_read_b128 v[28:31],v17 offset:6144
ds_read_b64 v[180:181],v183
s_add_u32 m0,s61,4096
s_add_u32 s63,s60,4096
v_mfma_f32_32x32x16_bf16 v[56:71],a[60:63],v[36:39],v[56:71]
ds_read_b128 v[32:35],v16 offset:16384
s_waitcnt lgkmcnt(6)
v_mfma_f32_32x32x16_bf16 v[56:71],a[96:99],v[40:43],v[56:71]
ds_read_b128 v[36:39],v17 offset:16384
buffer_load_dwordx4 v1,s[8:11],s63 offen sc1 lds
v_mfma_f32_32x32x16_bf16 v[56:71],a[100:103],v[44:47],v[56:71]
ds_read_b128 v[40:43],v16 offset:26624
s_waitcnt lgkmcnt(6)
v_mfma_f32_32x32x16_bf16 v[56:71],a[136:139],v[48:51],v[56:71]
ds_read_b128 v[44:47],v17 offset:26624
v_mfma_f32_32x32x16_bf16 v[56:71],a[140:143],v[52:55],v[56:71]
ds_read_b128 v[48:51],v16 offset:36864
buffer_load_dwordx4 v1,s[8:11],s63 offen offset:1024 sc1 lds
s_waitcnt lgkmcnt(6)
v_mfma_f32_32x32x16_bf16 v[56:71],a[24:27],v[24:27],v[56:71]
ds_read_b128 v[52:55],v17 offset:36864
v_mfma_f32_32x32x16_bf16 v[56:71],a[28:31],v[28:31],v[56:71]
ds_read_b128 v[24:27],v16 offset:8192
s_waitcnt lgkmcnt(5)
v_mfma_f32_32x32x16_bf16 v[56:71],a[64:67],v[32:35],v[56:71]
ds_read_b128 v[28:31],v17 offset:8192
buffer_load_dwordx4 v1,s[8:11],s63 offen offset:2048 sc1 lds
v_mfma_f32_32x32x16_bf16 v[56:71],a[68:71],v[36:39],v[56:71]
ds_read_b128 v[32:35],v16 offset:18432
s_waitcnt lgkmcnt(5)
v_mfma_f32_32x32x16_bf16 v[56:71],a[104:107],v[40:43],v[56:71]
ds_read_b128 v[36:39],v17 offset:18432
v_mfma_f32_32x32x16_bf16 v[56:71],a[108:111],v[44:47],v[56:71]
ds_read_b128 v[40:43],v16 offset:28672
buffer_load_dwordx4 v1,s[8:11],s63 offen offset:3072 sc1 lds
s_add_u32 m0,s61,8192
s_waitcnt lgkmcnt(5)
v_mfma_f32_32x32x16_bf16 v[56:71],a[144:147],v[48:51],v[56:71]
ds_read_b128 v[44:47],v17 offset:28672
s_add_u32 s63,s60,8192
v_mfma_f32_32x32x16_bf16 v[56:71],a[148:151],v[52:55],v[56:71]
ds_read_b128 v[48:51],v16 offset:38912
s_waitcnt lgkmcnt(5)
v_mfma_f32_32x32x16_bf16 v[56:71],a[32:35],v[24:27],v[56:71]
ds_read_b128 v[52:55],v17 offset:38912
buffer_load_dwordx4 v1,s[8:11],s63 offen sc1 lds
v_mfma_f32_32x32x16_bf16 v[56:71],a[36:39],v[28:31],v[56:71]
s_waitcnt lgkmcnt(4)
v_mfma_f32_32x32x16_bf16 v[56:71],a[72:75],v[32:35],v[56:71]
v_mfma_f32_32x32x16_bf16 v[56:71],a[76:79],v[36:39],v[56:71]
buffer_load_dwordx4 v1,s[8:11],s63 offen offset:1024 sc1 lds
s_add_u32 m0,s66,40960
s_add_u32 s63,s67,40960
s_waitcnt lgkmcnt(2)
v_mfma_f32_32x32x16_bf16 v[56:71],a[112:115],v[40:43],v[56:71]
v_mfma_f32_32x32x16_bf16 v[56:71],a[116:119],v[44:47],v[56:71]
s_waitcnt lgkmcnt(0)
v_mfma_f32_32x32x16_bf16 v[56:71],a[152:155],v[48:51],v[56:71]
buffer_load_dwordx4 v1,s[8:11],s63 offen sc1 lds
s_add_u32 s62,s32,1
s_min_u32 s62,s62,127
s_sub_u32 s60,s62,15
s_lshr_b32 s41,s60,1
v_mfma_f32_32x32x16_bf16 v[56:71],a[156:159],v[52:55],v[56:71]
s_and_b32 s40,s60,1
s_cmp_eq_u32 s40,0
s_cselect_b32 s61,15,0
s_add_u32 s41,s41,s61
s_sub_u32 s61,s60,49
s_cmp_ge_u32 s60,98
s_cselect_b32 s41,s61,s41
s_cselect_b32 s40,1,s40
s_cmp_lt_u32 s62,15
s_cselect_b32 s41,s62,s41
s_cselect_b32 s40,0,s40
s_lshl_b32 s42,s40,6
s_add_u32 s42,s42,s41
s_lshl_b32 s42,s42,9
s_add_u32 s42,s42,393216
s_cmp_lt_u32 s41,7
s_cselect_b64 s[80:81],s[78:79],-1
s_cmp_eq_u32 s37,0
s_cbranch_scc0 sec_265
s_mov_b32 s35,s42
buffer_load_dword v3,v2,s[8:11],s35 offen sc1
s_mov_b32 s53,s33
s_mov_b32 s54,s34
s_add_u32 s32,s32,1
s_mov_b32 s33,s40
s_mov_b32 s34,s41
s_mov_b64 s[76:77],s[80:81]
s_nop 2
ep_263:
v_pk_fma_f32 v[56:57],v[144:145],v[180:181],v[56:57] op_sel_hi:[1,0,1] neg_lo:[0,1,0] neg_hi:[0,1,0]
v_pk_fma_f32 v[58:59],v[146:147],v[180:181],v[58:59] op_sel_hi:[1,0,1] neg_lo:[0,1,0] neg_hi:[0,1,0]
v_pk_fma_f32 v[60:61],v[148:149],v[180:181],v[60:61] op_sel_hi:[1,0,1] neg_lo:[0,1,0] neg_hi:[0,1,0]
v_pk_fma_f32 v[62:63],v[150:151],v[180:181],v[62:63] op_sel_hi:[1,0,1] neg_lo:[0,1,0] neg_hi:[0,1,0]
v_pk_fma_f32 v[64:65],v[152:153],v[180:181],v[64:65] op_sel_hi:[1,0,1] neg_lo:[0,1,0] neg_hi:[0,1,0]
v_pk_fma_f32 v[66:67],v[154:155],v[180:181],v[66:67] op_sel_hi:[1,0,1] neg_lo:[0,1,0] neg_hi:[0,1,0]
v_pk_fma_f32 v[68:69],v[156:157],v[180:181],v[68:69] op_sel_hi:[1,0,1] neg_lo:[0,1,0] neg_hi:[0,1,0]
v_pk_fma_f32 v[70:71],v[158:159],v[180:181],v[70:71] op_sel_hi:[1,0,1] neg_lo:[0,1,0] neg_hi:[0,1,0]
v_pk_mul_f32 v[56:57],v[56:57],v[180:181] op_sel:[0,1] op_sel_hi:[1,1]
v_pk_mul_f32 v[58:59],v[58:59],v[180:181] op_sel:[0,1] op_sel_hi:[1,1]
v_pk_mul_f32 v[60:61],v[60:61],v[180:181] op_sel:[0,1] op_sel_hi:[1,1]
v_pk_mul_f32 v[62:63],v[62:63],v[180:181] op_sel:[0,1] op_sel_hi:[1,1]
v_pk_mul_f32 v[64:65],v[64:65],v[180:181] op_sel:[0,1] op_sel_hi:[1,1]
v_pk_mul_f32 v[66:67],v[66:67],v[180:181] op_sel:[0,1] op_sel_hi:[1,1]
v_pk_mul_f32 v[68:69],v[68:69],v[180:181] op_sel:[0,1] op_sel_hi:[1,1]
v_pk_mul_f32 v[70:71],v[70:71],v[180:181] op_sel:[0,1] op_sel_hi:[1,1]
v_pk_mul_f32 v[124:125],v[56:57],v[56:57]
v_pk_mul_f32 v[126:127],v[58:59],v[58:59]
v_pk_mul_f32 v[128:129],v[60:61],v[60:61]
v_pk_mul_f32 v[130:131],v[62:63],v[62:63]
v_pk_mul_f32 v[132:133],v[64:65],v[64:65]
v_pk_mul_f32 v[134:135],v[66:67],v[66:67]
v_pk_mul_f32 v[136:137],v[68:69],v[68:69]
v_pk_mul_f32 v[138:139],v[70:71],v[70:71]
v_pk_fma_f32 v[124:125],v[124:125],v[112:113],v[112:113] op_sel:[0,1,0] op_sel_hi:[1,1,0]
v_pk_fma_f32 v[126:127],v[126:127],v[112:113],v[112:113] op_sel:[0,1,0] op_sel_hi:[1,1,0]
v_pk_fma_f32 v[128:129],v[128:129],v[112:113],v[112:113] op_sel:[0,1,0] op_sel_hi:[1,1,0]
v_pk_fma_f32 v[130:131],v[130:131],v[112:113],v[112:113] op_sel:[0,1,0] op_sel_hi:[1,1,0]
v_pk_fma_f32 v[132:133],v[132:133],v[112:113],v[112:113] op_sel:[0,1,0] op_sel_hi:[1,1,0]
v_pk_fma_f32 v[134:135],v[134:135],v[112:113],v[112:113] op_sel:[0,1,0] op_sel_hi:[1,1,0]
v_pk_fma_f32 v[136:137],v[136:137],v[112:113],v[112:113] op_sel:[0,1,0] op_sel_hi:[1,1,0]
v_pk_fma_f32 v[138:139],v[138:139],v[112:113],v[112:113] op_sel:[0,1,0] op_sel_hi:[1,1,0]
v_pk_mul_f32 v[124:125],v[124:125],v[56:57]
v_pk_mul_f32 v[126:127],v[126:127],v[58:59]
v_pk_mul_f32 v[128:129],v[128:129],v[60:61]
v_pk_mul_f32 v[130:131],v[130:131],v[62:63]
v_pk_mul_f32 v[132:133],v[132:133],v[64:65]
v_pk_mul_f32 v[134:135],v[134:135],v[66:67]
v_pk_mul_f32 v[136:137],v[136:137],v[68:69]
v_pk_mul_f32 v[138:139],v[138:139],v[70:71]
v_exp_f32 v124,v124
v_exp_f32 v125,v125
v_exp_f32 v126,v126
v_exp_f32 v127,v127
v_exp_f32 v128,v128
v_exp_f32 v129,v129
v_exp_f32 v130,v130
v_exp_f32 v131,v131
v_exp_f32 v132,v132
v_exp_f32 v133,v133
v_exp_f32 v134,v134
v_exp_f32 v135,v135
v_exp_f32 v136,v136
v_exp_f32 v137,v137
v_exp_f32 v138,v138
v_exp_f32 v139,v139
v_pk_add_f32 v[124:125],v[124:125],1.0 op_sel_hi:[1,0]
v_pk_add_f32 v[126:127],v[126:127],1.0 op_sel_hi:[1,0]
v_pk_add_f32 v[128:129],v[128:129],1.0 op_sel_hi:[1,0]
v_pk_add_f32 v[130:131],v[130:131],1.0 op_sel_hi:[1,0]
v_pk_add_f32 v[132:133],v[132:133],1.0 op_sel_hi:[1,0]
v_pk_add_f32 v[134:135],v[134:135],1.0 op_sel_hi:[1,0]
v_pk_add_f32 v[136:137],v[136:137],1.0 op_sel_hi:[1,0]
v_pk_add_f32 v[138:139],v[138:139],1.0 op_sel_hi:[1,0]
v_rcp_f32 v124,v124
v_rcp_f32 v125,v125
v_rcp_f32 v126,v126
v_rcp_f32 v127,v127
v_rcp_f32 v128,v128
v_rcp_f32 v129,v129
v_rcp_f32 v130,v130
v_rcp_f32 v131,v131
v_rcp_f32 v132,v132
v_rcp_f32 v133,v133
v_rcp_f32 v134,v134
v_rcp_f32 v135,v135
v_rcp_f32 v136,v136
v_rcp_f32 v137,v137
v_rcp_f32 v138,v138
v_rcp_f32 v139,v139
v_pk_mul_f32 v[56:57],v[56:57],v[124:125]
v_pk_mul_f32 v[58:59],v[58:59],v[126:127]
v_pk_mul_f32 v[60:61],v[60:61],v[128:129]
v_pk_mul_f32 v[62:63],v[62:63],v[130:131]
v_pk_mul_f32 v[64:65],v[64:65],v[132:133]
v_pk_mul_f32 v[66:67],v[66:67],v[134:135]
v_pk_mul_f32 v[68:69],v[68:69],v[136:137]
v_pk_mul_f32 v[70:71],v[70:71],v[138:139]
v_cvt_pk_bf16_f32 v116,v56,v57
v_cvt_pk_bf16_f32 v117,v58,v59
v_cvt_pk_bf16_f32 v118,v60,v61
v_cvt_pk_bf16_f32 v119,v62,v63
v_cvt_pk_bf16_f32 v120,v64,v65
v_cvt_pk_bf16_f32 v121,v66,v67
v_cvt_pk_bf16_f32 v122,v68,v69
v_cvt_pk_bf16_f32 v123,v70,v71
s_cmp_lg_u32 s49,0
s_cbranch_scc0 ls_266
buffer_store_dwordx4 v[116:119],v20,s[8:11],s71 offen sc1
buffer_store_dwordx4 v[120:123],v21,s[8:11],s71 offen sc1
s_branch ls_267
ls_266:
buffer_store_dwordx4 v[116:119],v20,s[8:11],s71 offen
buffer_store_dwordx4 v[120:123],v21,s[8:11],s71 offen
ls_267:
s_mov_b32 s59,s82
s_cmp_eq_u32 s37,0
s_cbranch_scc1 W1_NEXT
s_waitcnt vmcnt(2)
v_cmp_eq_u32 vcc,0,v3
s_and_b64 vcc,vcc,s[76:77]
s_cselect_b32 s37,2147483648,0
s_cmp_lt_u32 s32,128
s_cselect_b32 s37,s37,2147483648
s_cmp_eq_u32 s37,0
s_cbranch_scc1 W1_COLD2
s_waitcnt vmcnt(0)
s_mov_b64 exec,1
s_cmp_lg_u32 s49,0
s_cbranch_scc0 ls_268
buffer_store_dword v5,v1,s[8:11],s59 offen sc1
s_branch ls_269
ls_268:
buffer_store_dword v5,v1,s[8:11],s59 offen
ls_269:
s_mov_b64 exec,-1
s_mov_b32 s59,2147483648
s_cmp_lt_u32 s32,128
s_cbranch_scc1 W1_COLD
s_branch W1_END
sec_265:
s_waitcnt vmcnt(11)
v_cmp_eq_u32 vcc,0,v3
s_and_b64 vcc,vcc,s[76:77]
s_cselect_b32 s37,2147483648,0
s_cmp_lt_u32 s32,128
s_cselect_b32 s37,s37,2147483648
s_cmp_lg_u32 s37,0
s_cbranch_scc1 nr_264
s_add_u32 s65,s32,1
s_or_b32 s65,s65,s37
v_mov_b32 v23,s65
ds_max_i32 v22,v23
s_sub_u32 s66,46080,s57
s_lshl_b32 s60,s33,6
s_add_u32 s60,s60,s34
s_mul_i32 s60,s60,46080
s_add_u32 s60,s60,s37
s_add_u32 s60,s60,223608832
s_mov_b32 s67,s60
s_mul_i32 s61,s46,10240
s_add_u32 s60,s60,s61
s_add_u32 s61,s61,s66
s_add_u32 m0,s61,0
s_add_u32 s63,s60,0
buffer_load_dwordx4 v1,s[8:11],s63 offen sc1 lds
v_pk_fma_f32 v[56:57],v[144:145],v[180:181],v[56:57] op_sel_hi:[1,0,1] neg_lo:[0,1,0] neg_hi:[0,1,0]
v_pk_fma_f32 v[58:59],v[146:147],v[180:181],v[58:59] op_sel_hi:[1,0,1] neg_lo:[0,1,0] neg_hi:[0,1,0]
v_pk_fma_f32 v[60:61],v[148:149],v[180:181],v[60:61] op_sel_hi:[1,0,1] neg_lo:[0,1,0] neg_hi:[0,1,0]
v_pk_fma_f32 v[62:63],v[150:151],v[180:181],v[62:63] op_sel_hi:[1,0,1] neg_lo:[0,1,0] neg_hi:[0,1,0]
v_pk_fma_f32 v[64:65],v[152:153],v[180:181],v[64:65] op_sel_hi:[1,0,1] neg_lo:[0,1,0] neg_hi:[0,1,0]
v_pk_fma_f32 v[66:67],v[154:155],v[180:181],v[66:67] op_sel_hi:[1,0,1] neg_lo:[0,1,0] neg_hi:[0,1,0]
v_pk_fma_f32 v[68:69],v[156:157],v[180:181],v[68:69] op_sel_hi:[1,0,1] neg_lo:[0,1,0] neg_hi:[0,1,0]
buffer_load_dwordx4 v1,s[8:11],s63 offen offset:1024 sc1 lds
v_pk_fma_f32 v[70:71],v[158:159],v[180:181],v[70:71] op_sel_hi:[1,0,1] neg_lo:[0,1,0] neg_hi:[0,1,0]
v_pk_mul_f32 v[56:57],v[56:57],v[180:181] op_sel:[0,1] op_sel_hi:[1,1]
v_pk_mul_f32 v[58:59],v[58:59],v[180:181] op_sel:[0,1] op_sel_hi:[1,1]
v_pk_mul_f32 v[60:61],v[60:61],v[180:181] op_sel:[0,1] op_sel_hi:[1,1]
v_pk_mul_f32 v[62:63],v[62:63],v[180:181] op_sel:[0,1] op_sel_hi:[1,1]
v_pk_mul_f32 v[64:65],v[64:65],v[180:181] op_sel:[0,1] op_sel_hi:[1,1]
v_pk_mul_f32 v[66:67],v[66:67],v[180:181] op_sel:[0,1] op_sel_hi:[1,1]
buffer_load_dwordx4 v1,s[8:11],s63 offen offset:2048 sc1 lds
v_pk_mul_f32 v[68:69],v[68:69],v[180:181] op_sel:[0,1] op_sel_hi:[1,1]
v_pk_mul_f32 v[70:71],v[70:71],v[180:181] op_sel:[0,1] op_sel_hi:[1,1]
v_pk_mul_f32 v[124:125],v[56:57],v[56:57]
v_pk_mul_f32 v[126:127],v[58:59],v[58:59]
v_pk_mul_f32 v[128:129],v[60:61],v[60:61]
v_pk_mul_f32 v[130:131],v[62:63],v[62:63]
v_pk_mul_f32 v[132:133],v[64:65],v[64:65]
buffer_load_dwordx4 v1,s[8:11],s63 offen offset:3072 sc1 lds
v_pk_mul_f32 v[134:135],v[66:67],v[66:67]
v_pk_mul_f32 v[136:137],v[68:69],v[68:69]
v_pk_mul_f32 v[138:139],v[70:71],v[70:71]
v_pk_fma_f32 v[124:125],v[124:125],v[112:113],v[112:113] op_sel:[0,1,0] op_sel_hi:[1,1,0]
v_pk_fma_f32 v[126:127],v[126:127],v[112:113],v[112:113] op_sel:[0,1,0] op_sel_hi:[1,1,0]
v_pk_fma_f32 v[128:129],v[128:129],v[112:113],v[112:113] op_sel:[0,1,0] op_sel_hi:[1,1,0]
v_pk_fma_f32 v[130:131],v[130:131],v[112:113],v[112:113] op_sel:[0,1,0] op_sel_hi:[1,1,0]
s_add_u32 m0,s61,4096
s_add_u32 s63,s60,4096
buffer_load_dwordx4 v1,s[8:11],s63 offen sc1 lds
v_pk_fma_f32 v[132:133],v[132:133],v[112:113],v[112:113] op_sel:[0,1,0] op_sel_hi:[1,1,0]
v_pk_fma_f32 v[134:135],v[134:135],v[112:113],v[112:113] op_sel:[0,1,0] op_sel_hi:[1,1,0]
v_pk_fma_f32 v[136:137],v[136:137],v[112:113],v[112:113] op_sel:[0,1,0] op_sel_hi:[1,1,0]
v_pk_fma_f32 v[138:139],v[138:139],v[112:113],v[112:113] op_sel:[0,1,0] op_sel_hi:[1,1,0]
v_pk_mul_f32 v[124:125],v[124:125],v[56:57]
v_pk_mul_f32 v[126:127],v[126:127],v[58:59]
v_pk_mul_f32 v[128:129],v[128:129],v[60:61]
buffer_load_dwordx4 v1,s[8:11],s63 offen offset:1024 sc1 lds
v_pk_mul_f32 v[130:131],v[130:131],v[62:63]
v_pk_mul_f32 v[132:133],v[132:133],v[64:65]
v_pk_mul_f32 v[134:135],v[134:135],v[66:67]
v_pk_mul_f32 v[136:137],v[136:137],v[68:69]
v_pk_mul_f32 v[138:139],v[138:139],v[70:71]
v_exp_f32 v124,v124
v_exp_f32 v125,v125
buffer_load_dwordx4 v1,s[8:11],s63 offen offset:2048 sc1 lds
v_exp_f32 v126,v126
v_exp_f32 v127,v127
v_exp_f32 v128,v128
v_exp_f32 v129,v129
v_exp_f32 v130,v130
v_exp_f32 v131,v131
v_exp_f32 v132,v132
buffer_load_dwordx4 v1,s[8:11],s63 offen offset:3072 sc1 lds
v_exp_f32 v133,v133
v_exp_f32 v134,v134
v_exp_f32 v135,v135
v_exp_f32 v136,v136
v_exp_f32 v137,v137
v_exp_f32 v138,v138
v_exp_f32 v139,v139
s_add_u32 m0,s61,8192
s_add_u32 s63,s60,8192
buffer_load_dwordx4 v1,s[8:11],s63 offen sc1 lds
v_pk_add_f32 v[124:125],v[124:125],1.0 op_sel_hi:[1,0]
v_pk_add_f32 v[126:127],v[126:127],1.0 op_sel_hi:[1,0]
v_pk_add_f32 v[128:129],v[128:129],1.0 op_sel_hi:[1,0]
v_pk_add_f32 v[130:131],v[130:131],1.0 op_sel_hi:[1,0]
v_pk_add_f32 v[132:133],v[132:133],1.0 op_sel_hi:[1,0]
v_pk_add_f32 v[134:135],v[134:135],1.0 op_sel_hi:[1,0]
v_pk_add_f32 v[136:137],v[136:137],1.0 op_sel_hi:[1,0]
buffer_load_dwordx4 v1,s[8:11],s63 offen offset:1024 sc1 lds
v_pk_add_f32 v[138:139],v[138:139],1.0 op_sel_hi:[1,0]
v_rcp_f32 v124,v124
v_rcp_f32 v125,v125
v_rcp_f32 v126,v126
v_rcp_f32 v127,v127
v_rcp_f32 v128,v128
v_rcp_f32 v129,v129
s_add_u32 m0,s66,40960
s_add_u32 s63,s67,40960
buffer_load_dwordx4 v1,s[8:11],s63 offen sc1 lds
v_rcp_f32 v130,v130
v_rcp_f32 v131,v131
v_rcp_f32 v132,v132
v_rcp_f32 v133,v133
v_rcp_f32 v134,v134
v_rcp_f32 v135,v135
v_rcp_f32 v136,v136
s_mov_b32 s35,s42
buffer_load_dword v3,v2,s[8:11],s35 offen sc1
s_mov_b32 s53,s33
s_mov_b32 s54,s34
s_add_u32 s32,s32,1
s_mov_b32 s33,s40
s_mov_b32 s34,s41
s_mov_b64 s[76:77],s[80:81]
v_rcp_f32 v137,v137
v_rcp_f32 v138,v138
v_rcp_f32 v139,v139
v_pk_mul_f32 v[56:57],v[56:57],v[124:125]
v_pk_mul_f32 v[58:59],v[58:59],v[126:127]
v_pk_mul_f32 v[60:61],v[60:61],v[128:129]
v_pk_mul_f32 v[62:63],v[62:63],v[130:131]
v_pk_mul_f32 v[64:65],v[64:65],v[132:133]
v_pk_mul_f32 v[66:67],v[66:67],v[134:135]
v_pk_mul_f32 v[68:69],v[68:69],v[136:137]
v_pk_mul_f32 v[70:71],v[70:71],v[138:139]
v_cvt_pk_bf16_f32 v116,v56,v57
v_cvt_pk_bf16_f32 v117,v58,v59
v_cvt_pk_bf16_f32 v118,v60,v61
v_cvt_pk_bf16_f32 v119,v62,v63
v_cvt_pk_bf16_f32 v120,v64,v65
v_cvt_pk_bf16_f32 v121,v66,v67
v_cvt_pk_bf16_f32 v122,v68,v69
v_cvt_pk_bf16_f32 v123,v70,v71
s_cmp_lg_u32 s49,0
s_cbranch_scc0 ls_270
buffer_store_dwordx4 v[116:119],v20,s[8:11],s71 offen sc1
buffer_store_dwordx4 v[120:123],v21,s[8:11],s71 offen sc1
s_branch ls_271
ls_270:
buffer_store_dwordx4 v[116:119],v20,s[8:11],s71 offen
buffer_store_dwordx4 v[120:123],v21,s[8:11],s71 offen
ls_271:
s_mov_b32 s59,s82
s_branch W1_NEXT
nr_264:
buffer_load_dword v3,v2,s[8:11],s35 offen sc1
s_branch ep_263
W1_END:
s_endpgm
ROLE_W2:
v_lshlrev_b32 v1,4,v0
v_mov_b32 v5,1
s_lshl_b32 s56,s48,2
s_add_u32 s56,s56,s46
v_bfe_u32 v6,v0,2,2
v_lshrrev_b32 v7,4,v0
v_add_u32 v7,v6,v7
v_and_b32 v7,3,v7
v_and_b32 v15,3,v0
v_lshlrev_b32 v15,4,v15
v_lshl_add_u32 v15,v7,6,v15
v_lshl_add_u32 v15,v6,8,v15
v_lshrrev_b32 v6,5,v0
v_bfe_u32 v7,v0,4,1
v_lshlrev_b32 v16,10,v7
v_lshl_add_u32 v16,v6,8,v16
v_and_b32 v6,15,v0
v_lshl_add_u32 v16,v6,4,v16
v_add_u32 v18,40960,v16
v_lshrrev_b32 v6,5,v0
v_bfe_u32 v7,v0,4,1
v_lshlrev_b32 v20,10,v7
v_lshl_add_u32 v20,v6,8,v20
v_and_b32 v6,15,v0
v_lshl_add_u32 v20,v6,4,v20
v_lshrrev_b32 v6,5,v0
v_add_u32 v6,2,v6
v_bfe_u32 v7,v0,4,1
v_lshlrev_b32 v17,10,v7
v_lshl_add_u32 v17,v6,8,v17
v_and_b32 v6,15,v0
v_lshl_add_u32 v17,v6,4,v17
v_add_u32 v19,40960,v17
v_lshrrev_b32 v6,5,v0
v_add_u32 v6,2,v6
v_bfe_u32 v7,v0,4,1
v_lshlrev_b32 v21,10,v7
v_lshl_add_u32 v21,v6,8,v21
v_and_b32 v6,15,v0
v_lshl_add_u32 v21,v6,4,v21
v_min_u32 v2,19,v0
v_lshlrev_b32 v2,2,v2
s_lshr_b32 s60,s46,1
s_add_u32 s60,s60,1
s_sub_u32 s61,32,s60
s_add_u32 s60,s60,32
s_bitcmp1_b32 s46,0
s_cselect_b32 s60,s60,s61
v_and_b32 v6,15,v0
v_add_u32 v6,s60,v6
v_lshrrev_b32 v7,5,v6
v_mul_u32_u24 v112,40960,v7
v_bfe_u32 v7,v6,4,1
v_lshl_add_u32 v112,v7,10,v112
v_and_b32 v7,15,v6
v_lshl_add_u32 v112,v7,4,v112
v_lshrrev_b32 v7,4,v0
v_lshl_add_u32 v112,v7,8,v112
v_and_b32 v6,15,v0
v_add_u32 v6,s60,v6
v_add_u32 v6,16,v6
v_lshrrev_b32 v7,5,v6
v_mul_u32_u24 v113,40960,v7
v_bfe_u32 v7,v6,4,1
v_lshl_add_u32 v113,v7,10,v113
v_and_b32 v7,15,v6
v_lshl_add_u32 v113,v7,4,v113
v_lshrrev_b32 v7,4,v0
v_lshl_add_u32 v113,v7,8,v113
v_lshrrev_b32 v6,5,v0
v_and_b32 v7,15,v0
v_lshlrev_b32 v114,3,v7
v_lshl_add_u32 v114,v6,7,v114
v_and_b32 v114,31,v0
v_lshlrev_b32 v114,3,v114
v_lshrrev_b32 v6,5,v0
v_bfe_u32 v7,v0,4,1
v_lshlrev_b32 v116,10,v7
v_bfe_u32 v7,v0,2,2
v_lshl_add_u32 v116,v7,8,v116
v_add_u32 v6,v6,v7
v_and_b32 v6,3,v6
v_lshl_add_u32 v116,v6,6,v116
v_and_b32 v6,3,v0
v_lshl_add_u32 v116,v6,4,v116
v_lshrrev_b32 v6,5,v0
v_add_u32 v6,2,v6
v_bfe_u32 v7,v0,4,1
v_lshlrev_b32 v117,10,v7
v_bfe_u32 v7,v0,2,2
v_lshl_add_u32 v117,v7,8,v117
v_add_u32 v6,v6,v7
v_and_b32 v6,3,v6
v_lshl_add_u32 v117,v6,6,v117
v_and_b32 v6,3,v0
v_lshl_add_u32 v117,v6,4,v117
v_subrev_u32 v6,40960,v112
v_cmp_gt_u32 vcc,40960,v6
s_nop 1
v_cndmask_b32 v78,0,1,vcc
v_xor_b32 v76,1,v78
v_and_b32 v74,2047,v112
v_subrev_u32 v6,40960,v113
v_cmp_gt_u32 vcc,40960,v6
s_nop 1
v_cndmask_b32 v79,0,1,vcc
v_xor_b32 v77,1,v79
v_and_b32 v75,2047,v113
s_and_b32 s68,s46,1
s_lshl_b32 s68,s68,1
s_sub_u32 s68,s68,1
s_waitcnt vmcnt(0)
s_barrier
s_cmp_lg_u32 s46,0
s_cbranch_scc1 arr_272
v_mov_b32 v6,1
s_lshl_b32 s3,s49,2
v_mov_b32 v7,s3
s_mov_b64 exec,1
buffer_atomic_add v6,v7,s[12:15],0 offen sc1
s_mov_b64 exec,-1
arr_272:
s_lshl_b32 s3,s49,2
v_mov_b32 v7,s3
s_nop 1
ibw_273:
buffer_load_dword v6,v7,s[12:15],0 offen sc1
s_waitcnt vmcnt(0)
v_cmp_ne_u32 vcc,256,v6
s_nop 0
s_cbranch_vccz ok_274
s_sleep 8
s_sub_u32 s47,s47,1
s_cbranch_scc1 ABORT
s_branch ibw_273
ok_274:
s_cmp_lg_u32 s49,0
s_cbranch_scc1 ibok_275
v_and_b32 v7,7,v0
v_lshlrev_b32 v7,2,v7
buffer_load_dword v6,v7,s[12:15],0 offen offset:32 sc1
s_waitcnt vmcnt(0)
v_cmp_ne_u32 vcc,32,v6
s_nop 0
s_cbranch_vccz ibok_275
s_barrier
s_mov_b32 s49,1
s_mov_b32 s3,s2
s_load_dwordx16 s[16:31],s[0:1],0
s_load_dwordx8 s[32:39],s[0:1],64
s_waitcnt lgkmcnt(0)
s_branch DISPATCH
ibok_275:
s_lshl_b32 s58,s56,6
s_mul_i32 s63,s46,40960
s_mov_b32 s4,s34
s_mov_b32 s5,s35
s_mov_b32 s6,819200
s_mov_b32 s7,0x20000
v_lshrrev_b32 v9,2,v0
s_mov_b32 s64,1280
v_mul_lo_u32 v9,v9,s64
v_and_b32 v10,3,v0
v_lshl_add_u32 v6,v10,4,v9
s_add_u32 m0,s63,0
s_add_u32 s65,s58,0
buffer_load_dwordx4 v6,s[4:7],s65 offen lds
s_add_u32 m0,s63,1024
s_add_u32 s65,s58,20480
buffer_load_dwordx4 v6,s[4:7],s65 offen lds
s_add_u32 m0,s63,2048
s_add_u32 s65,s58,40960
buffer_load_dwordx4 v6,s[4:7],s65 offen lds
s_add_u32 m0,s63,3072
s_add_u32 s65,s58,61440
buffer_load_dwordx4 v6,s[4:7],s65 offen lds
s_add_u32 m0,s63,4096
s_add_u32 s65,s58,81920
buffer_load_dwordx4 v6,s[4:7],s65 offen lds
s_add_u32 m0,s63,5120
s_add_u32 s65,s58,102400
buffer_load_dwordx4 v6,s[4:7],s65 offen lds
s_add_u32 m0,s63,6144
s_add_u32 s65,s58,122880
buffer_load_dwordx4 v6,s[4:7],s65 offen lds
s_add_u32 m0,s63,7168
s_add_u32 s65,s58,143360
buffer_load_dwordx4 v6,s[4:7],s65 offen lds
s_add_u32 m0,s63,8192
s_add_u32 s65,s58,163840
buffer_load_dwordx4 v6,s[4:7],s65 offen lds
s_add_u32 m0,s63,9216
s_add_u32 s65,s58,184320
buffer_load_dwordx4 v6,s[4:7],s65 offen lds
s_add_u32 m0,s63,10240
s_add_u32 s65,s58,204800
buffer_load_dwordx4 v6,s[4:7],s65 offen lds
s_add_u32 m0,s63,11264
s_add_u32 s65,s58,225280
buffer_load_dwordx4 v6,s[4:7],s65 offen lds
s_add_u32 m0,s63,12288
s_add_u32 s65,s58,245760
buffer_load_dwordx4 v6,s[4:7],s65 offen lds
s_add_u32 m0,s63,13312
s_add_u32 s65,s58,266240
buffer_load_dwordx4 v6,s[4:7],s65 offen lds
s_add_u32 m0,s63,14336
s_add_u32 s65,s58,286720
buffer_load_dwordx4 v6,s[4:7],s65 offen lds
s_add_u32 m0,s63,15360
s_add_u32 s65,s58,307200
buffer_load_dwordx4 v6,s[4:7],s65 offen lds
s_add_u32 m0,s63,16384
s_add_u32 s65,s58,327680
buffer_load_dwordx4 v6,s[4:7],s65 offen lds
s_add_u32 m0,s63,17408
s_add_u32 s65,s58,348160
buffer_load_dwordx4 v6,s[4:7],s65 offen lds
s_add_u32 m0,s63,18432
s_add_u32 s65,s58,368640
buffer_load_dwordx4 v6,s[4:7],s65 offen lds
s_add_u32 m0,s63,19456
s_add_u32 s65,s58,389120
buffer_load_dwordx4 v6,s[4:7],s65 offen lds
s_add_u32 m0,s63,20480
s_add_u32 s65,s58,409600
buffer_load_dwordx4 v6,s[4:7],s65 offen lds
s_add_u32 m0,s63,21504
s_add_u32 s65,s58,430080
buffer_load_dwordx4 v6,s[4:7],s65 offen lds
s_add_u32 m0,s63,22528
s_add_u32 s65,s58,450560
buffer_load_dwordx4 v6,s[4:7],s65 offen lds
s_add_u32 m0,s63,23552
s_add_u32 s65,s58,471040
buffer_load_dwordx4 v6,s[4:7],s65 offen lds
s_add_u32 m0,s63,24576
s_add_u32 s65,s58,491520
buffer_load_dwordx4 v6,s[4:7],s65 offen lds
s_add_u32 m0,s63,25600
s_add_u32 s65,s58,512000
buffer_load_dwordx4 v6,s[4:7],s65 offen lds
s_add_u32 m0,s63,26624
s_add_u32 s65,s58,532480
buffer_load_dwordx4 v6,s[4:7],s65 offen lds
s_add_u32 m0,s63,27648
s_add_u32 s65,s58,552960
buffer_load_dwordx4 v6,s[4:7],s65 offen lds
s_add_u32 m0,s63,28672
s_add_u32 s65,s58,573440
buffer_load_dwordx4 v6,s[4:7],s65 offen lds
s_add_u32 m0,s63,29696
s_add_u32 s65,s58,593920
buffer_load_dwordx4 v6,s[4:7],s65 offen lds
s_add_u32 m0,s63,30720
s_add_u32 s65,s58,614400
buffer_load_dwordx4 v6,s[4:7],s65 offen lds
s_add_u32 m0,s63,31744
s_add_u32 s65,s58,634880
buffer_load_dwordx4 v6,s[4:7],s65 offen lds
s_add_u32 m0,s63,32768
s_add_u32 s65,s58,655360
buffer_load_dwordx4 v6,s[4:7],s65 offen lds
s_add_u32 m0,s63,33792
s_add_u32 s65,s58,675840
buffer_load_dwordx4 v6,s[4:7],s65 offen lds
s_add_u32 m0,s63,34816
s_add_u32 s65,s58,696320
buffer_load_dwordx4 v6,s[4:7],s65 offen lds
s_add_u32 m0,s63,35840
s_add_u32 s65,s58,716800
buffer_load_dwordx4 v6,s[4:7],s65 offen lds
s_add_u32 m0,s63,36864
s_add_u32 s65,s58,737280
buffer_load_dwordx4 v6,s[4:7],s65 offen lds
s_add_u32 m0,s63,37888
s_add_u32 s65,s58,757760
buffer_load_dwordx4 v6,s[4:7],s65 offen lds
s_add_u32 m0,s63,38912
s_add_u32 s65,s58,778240
buffer_load_dwordx4 v6,s[4:7],s65 offen lds
s_add_u32 m0,s63,39936
s_add_u32 s65,s58,798720
buffer_load_dwordx4 v6,s[4:7],s65 offen lds
s_waitcnt vmcnt(20)
v_bfe_u32 v9,v0,2,2
v_lshrrev_b32 v10,5,v0
v_lshl_add_u32 v9,v10,2,v9
v_mul_u32_u24 v9,64,v9
v_and_b32 v10,1,v0
v_lshl_add_u32 v9,v10,3,v9
v_bfe_u32 v10,v0,1,1
v_lshl_add_u32 v9,v10,5,v9
v_bfe_u32 v10,v0,4,1
v_lshl_add_u32 v9,v10,4,v9
v_add_u32 v7,s63,v9
ds_read_b64_tr_b16 a[0:1],v7 offset:0
ds_read_b64_tr_b16 a[2:3],v7 offset:1024
ds_read_b64_tr_b16 a[4:5],v7 offset:512
ds_read_b64_tr_b16 a[6:7],v7 offset:1536
ds_read_b64_tr_b16 a[8:9],v7 offset:2048
ds_read_b64_tr_b16 a[10:11],v7 offset:3072
ds_read_b64_tr_b16 a[12:13],v7 offset:2560
ds_read_b64_tr_b16 a[14:15],v7 offset:3584
ds_read_b64_tr_b16 a[16:17],v7 offset:4096
ds_read_b64_tr_b16 a[18:19],v7 offset:5120
ds_read_b64_tr_b16 a[20:21],v7 offset:4608
ds_read_b64_tr_b16 a[22:23],v7 offset:5632
s_waitcnt lgkmcnt(4)
ds_read_b64_tr_b16 a[24:25],v7 offset:6144
ds_read_b64_tr_b16 a[26:27],v7 offset:7168
ds_read_b64_tr_b16 a[28:29],v7 offset:6656
ds_read_b64_tr_b16 a[30:31],v7 offset:7680
ds_read_b64_tr_b16 a[32:33],v7 offset:8192
ds_read_b64_tr_b16 a[34:35],v7 offset:9216
ds_read_b64_tr_b16 a[36:37],v7 offset:8704
ds_read_b64_tr_b16 a[38:39],v7 offset:9728
ds_read_b64_tr_b16 a[40:41],v7 offset:10240
ds_read_b64_tr_b16 a[42:43],v7 offset:11264
ds_read_b64_tr_b16 a[44:45],v7 offset:10752
ds_read_b64_tr_b16 a[46:47],v7 offset:11776
s_waitcnt lgkmcnt(4)
ds_read_b64_tr_b16 a[48:49],v7 offset:12288
ds_read_b64_tr_b16 a[50:51],v7 offset:13312
ds_read_b64_tr_b16 a[52:53],v7 offset:12800
ds_read_b64_tr_b16 a[54:55],v7 offset:13824
ds_read_b64_tr_b16 a[56:57],v7 offset:14336
ds_read_b64_tr_b16 a[58:59],v7 offset:15360
ds_read_b64_tr_b16 a[60:61],v7 offset:14848
ds_read_b64_tr_b16 a[62:63],v7 offset:15872
ds_read_b64_tr_b16 a[64:65],v7 offset:16384
ds_read_b64_tr_b16 a[66:67],v7 offset:17408
ds_read_b64_tr_b16 a[68:69],v7 offset:16896
ds_read_b64_tr_b16 a[70:71],v7 offset:17920
s_waitcnt lgkmcnt(4)
ds_read_b64_tr_b16 a[72:73],v7 offset:18432
ds_read_b64_tr_b16 a[74:75],v7 offset:19456
ds_read_b64_tr_b16 a[76:77],v7 offset:18944
ds_read_b64_tr_b16 a[78:79],v7 offset:19968
s_waitcnt lgkmcnt(0)
s_waitcnt vmcnt(0)
v_bfe_u32 v9,v0,2,2
v_lshrrev_b32 v10,5,v0
v_lshl_add_u32 v9,v10,2,v9
v_mul_u32_u24 v9,64,v9
v_and_b32 v10,1,v0
v_lshl_add_u32 v9,v10,3,v9
v_bfe_u32 v10,v0,1,1
v_lshl_add_u32 v9,v10,5,v9
v_bfe_u32 v10,v0,4,1
v_lshl_add_u32 v9,v10,4,v9
v_add_u32 v7,s63,v9
ds_read_b64_tr_b16 a[80:81],v7 offset:20480
ds_read_b64_tr_b16 a[82:83],v7 offset:21504
ds_read_b64_tr_b16 a[84:85],v7 offset:20992
ds_read_b64_tr_b16 a[86:87],v7 offset:22016
ds_read_b64_tr_b16 a[88:89],v7 offset:22528
ds_read_b64_tr_b16 a[90:91],v7 offset:23552
ds_read_b64_tr_b16 a[92:93],v7 offset:23040
ds_read_b64_tr_b16 a[94:95],v7 offset:24064
ds_read_b64_tr_b16 a[96:97],v7 offset:24576
ds_read_b64_tr_b16 a[98:99],v7 offset:25600
ds_read_b64_tr_b16 a[100:101],v7 offset:25088
ds_read_b64_tr_b16 a[102:103],v7 offset:26112
s_waitcnt lgkmcnt(4)
ds_read_b64_tr_b16 a[104:105],v7 offset:26624
ds_read_b64_tr_b16 a[106:107],v7 offset:27648
ds_read_b64_tr_b16 a[108:109],v7 offset:27136
ds_read_b64_tr_b16 a[110:111],v7 offset:28160
ds_read_b64_tr_b16 a[112:113],v7 offset:28672
ds_read_b64_tr_b16 a[114:115],v7 offset:29696
ds_read_b64_tr_b16 a[116:117],v7 offset:29184
ds_read_b64_tr_b16 a[118:119],v7 offset:30208
ds_read_b64_tr_b16 a[120:121],v7 offset:30720
ds_read_b64_tr_b16 a[122:123],v7 offset:31744
ds_read_b64_tr_b16 a[124:125],v7 offset:31232
ds_read_b64_tr_b16 a[126:127],v7 offset:32256
s_waitcnt lgkmcnt(4)
ds_read_b64_tr_b16 a[128:129],v7 offset:32768
ds_read_b64_tr_b16 a[130:131],v7 offset:33792
ds_read_b64_tr_b16 a[132:133],v7 offset:33280
ds_read_b64_tr_b16 a[134:135],v7 offset:34304
ds_read_b64_tr_b16 a[136:137],v7 offset:34816
ds_read_b64_tr_b16 a[138:139],v7 offset:35840
ds_read_b64_tr_b16 a[140:141],v7 offset:35328
ds_read_b64_tr_b16 a[142:143],v7 offset:36352
ds_read_b64_tr_b16 a[144:145],v7 offset:36864
ds_read_b64_tr_b16 a[146:147],v7 offset:37888
ds_read_b64_tr_b16 a[148:149],v7 offset:37376
ds_read_b64_tr_b16 a[150:151],v7 offset:38400
s_waitcnt lgkmcnt(4)
ds_read_b64_tr_b16 a[152:153],v7 offset:38912
ds_read_b64_tr_b16 a[154:155],v7 offset:39936
ds_read_b64_tr_b16 a[156:157],v7 offset:39424
ds_read_b64_tr_b16 a[158:159],v7 offset:40448
s_waitcnt lgkmcnt(0)
s_barrier
s_mov_b32 s50,0
s_mov_b32 s32,0
s_mov_b32 s57,0
s_mov_b32 s59,2147483648
s_mov_b32 s82,2147483648
s_mov_b32 s39,2147483648
v_mov_b32 v22,83968
v_lshl_add_u32 v22,v0,2,v22
v_mov_b32 v23,0
ds_write_b32 v22,v23
s_mov_b32 s39,1600000
v_and_b32 v72,15,v0
v_lshlrev_b32 v72,7,v72
s_mul_i32 s60,s56,-1792
s_add_u32 s60,s60,40960
v_and_b32 v6,128,v72
v_add_u32 v6,s60,v6
v_cmp_lt_u32 vcc,15,v0
s_nop 1
v_cndmask_b32 v72,v72,v6,vcc
v_min_u32 v6,59,v0
v_lshlrev_b32 v6,2,v6
v_add_u32 v2,135168,v6
v_add_u32 v7,-80,v6
v_cmp_gt_u32 s[78:79],20,v0
s_nop 1
v_cndmask_b32 v2,v7,v2,s[78:79]
s_mov_b32 s51,0
s_mov_b32 s52,0
s_mul_i32 s62,s51,8
s_and_b32 s63,s52,7
s_add_u32 s62,s62,s63
s_mul_i32 s62,s62,46080
s_add_u32 s62,s62,212467712
s_lshl_b32 s63,s56,11
s_add_u32 s62,s62,s63
buffer_load_dword v73,v72,s[8:11],s62 offen sc1
s_mov_b32 s51,0
s_mov_b32 s52,1
s_mul_i32 s62,s51,8
s_and_b32 s63,s52,7
s_add_u32 s62,s62,s63
s_mul_i32 s62,s62,46080
s_add_u32 s62,s62,212467712
s_lshl_b32 s63,s56,11
s_add_u32 s62,s62,s63
buffer_load_dword v73,v72,s[8:11],s62 offen sc1
s_mov_b32 s51,0
s_mov_b32 s52,2
s_mul_i32 s62,s51,8
s_and_b32 s63,s52,7
s_add_u32 s62,s62,s63
s_mul_i32 s62,s62,46080
s_add_u32 s62,s62,212467712
s_lshl_b32 s63,s56,11
s_add_u32 s62,s62,s63
buffer_load_dword v73,v72,s[8:11],s62 offen sc1
s_mov_b32 s51,0
s_mov_b32 s52,3
s_mul_i32 s62,s51,8
s_and_b32 s63,s52,7
s_add_u32 s62,s62,s63
s_mul_i32 s62,s62,46080
s_add_u32 s62,s62,212467712
s_lshl_b32 s63,s56,11
s_add_u32 s62,s62,s63
buffer_load_dword v73,v72,s[8:11],s62 offen sc1
s_mov_b32 s51,0
s_mov_b32 s52,4
s_mul_i32 s62,s51,8
s_and_b32 s63,s52,7
s_add_u32 s62,s62,s63
s_mul_i32 s62,s62,46080
s_add_u32 s62,s62,212467712
s_lshl_b32 s63,s56,11
s_add_u32 s62,s62,s63
buffer_load_dword v73,v72,s[8:11],s62 offen sc1
s_mov_b32 s51,0
s_mov_b32 s52,5
s_mul_i32 s62,s51,8
s_and_b32 s63,s52,7
s_add_u32 s62,s62,s63
s_mul_i32 s62,s62,46080
s_add_u32 s62,s62,212467712
s_lshl_b32 s63,s56,11
s_add_u32 s62,s62,s63
buffer_load_dword v73,v72,s[8:11],s62 offen sc1
s_mov_b32 s51,0
s_mov_b32 s52,6
s_mul_i32 s62,s51,8
s_and_b32 s63,s52,7
s_add_u32 s62,s62,s63
s_mul_i32 s62,s62,46080
s_add_u32 s62,s62,212467712
s_lshl_b32 s63,s56,11
s_add_u32 s62,s62,s63
buffer_load_dword v73,v72,s[8:11],s62 offen sc1
s_mov_b32 s51,0
s_mov_b32 s52,7
s_mul_i32 s62,s51,8
s_and_b32 s63,s52,7
s_add_u32 s62,s62,s63
s_mul_i32 s62,s62,46080
s_add_u32 s62,s62,212467712
s_lshl_b32 s63,s56,11
s_add_u32 s62,s62,s63
buffer_load_dword v73,v72,s[8:11],s62 offen sc1
s_mov_b32 s51,1
s_mov_b32 s52,0
s_mul_i32 s62,s51,8
s_and_b32 s63,s52,7
s_add_u32 s62,s62,s63
s_mul_i32 s62,s62,46080
s_add_u32 s62,s62,212467712
s_lshl_b32 s63,s56,11
s_add_u32 s62,s62,s63
buffer_load_dword v73,v72,s[8:11],s62 offen sc1
s_mov_b32 s51,1
s_mov_b32 s52,1
s_mul_i32 s62,s51,8
s_and_b32 s63,s52,7
s_add_u32 s62,s62,s63
s_mul_i32 s62,s62,46080
s_add_u32 s62,s62,212467712
s_lshl_b32 s63,s56,11
s_add_u32 s62,s62,s63
buffer_load_dword v73,v72,s[8:11],s62 offen sc1
s_mov_b32 s51,1
s_mov_b32 s52,2
s_mul_i32 s62,s51,8
s_and_b32 s63,s52,7
s_add_u32 s62,s62,s63
s_mul_i32 s62,s62,46080
s_add_u32 s62,s62,212467712
s_lshl_b32 s63,s56,11
s_add_u32 s62,s62,s63
buffer_load_dword v73,v72,s[8:11],s62 offen sc1
s_mov_b32 s51,1
s_mov_b32 s52,3
s_mul_i32 s62,s51,8
s_and_b32 s63,s52,7
s_add_u32 s62,s62,s63
s_mul_i32 s62,s62,46080
s_add_u32 s62,s62,212467712
s_lshl_b32 s63,s56,11
s_add_u32 s62,s62,s63
buffer_load_dword v73,v72,s[8:11],s62 offen sc1
s_mov_b32 s51,1
s_mov_b32 s52,4
s_mul_i32 s62,s51,8
s_and_b32 s63,s52,7
s_add_u32 s62,s62,s63
s_mul_i32 s62,s62,46080
s_add_u32 s62,s62,212467712
s_lshl_b32 s63,s56,11
s_add_u32 s62,s62,s63
buffer_load_dword v73,v72,s[8:11],s62 offen sc1
s_mov_b32 s51,1
s_mov_b32 s52,5
s_mul_i32 s62,s51,8
s_and_b32 s63,s52,7
s_add_u32 s62,s62,s63
s_mul_i32 s62,s62,46080
s_add_u32 s62,s62,212467712
s_lshl_b32 s63,s56,11
s_add_u32 s62,s62,s63
buffer_load_dword v73,v72,s[8:11],s62 offen sc1
s_mov_b32 s51,1
s_mov_b32 s52,6
s_mul_i32 s62,s51,8
s_and_b32 s63,s52,7
s_add_u32 s62,s62,s63
s_mul_i32 s62,s62,46080
s_add_u32 s62,s62,212467712
s_lshl_b32 s63,s56,11
s_add_u32 s62,s62,s63
buffer_load_dword v73,v72,s[8:11],s62 offen sc1
s_mov_b32 s51,1
s_mov_b32 s52,7
s_mul_i32 s62,s51,8
s_and_b32 s63,s52,7
s_add_u32 s62,s62,s63
s_mul_i32 s62,s62,46080
s_add_u32 s62,s62,212467712
s_lshl_b32 s63,s56,11
s_add_u32 s62,s62,s63
buffer_load_dword v73,v72,s[8:11],s62 offen sc1
s_waitcnt vmcnt(0)
s_waitcnt lgkmcnt(0)
s_barrier
s_mov_b32 s83,s100
s_min_u32 s62,s32,127
s_sub_u32 s60,s62,16
s_lshr_b32 s34,s60,1
s_and_b32 s33,s60,1
s_cmp_eq_u32 s33,0
s_cselect_b32 s61,16,0
s_add_u32 s34,s34,s61
s_sub_u32 s61,s60,48
s_cmp_ge_u32 s60,96
s_cselect_b32 s34,s61,s34
s_cselect_b32 s33,1,s33
s_cmp_lt_u32 s62,16
s_cselect_b32 s34,s62,s34
s_cselect_b32 s33,0,s33
s_add_u32 s60,s34,1
s_min_u32 s60,s60,63
s_lshl_b32 s35,s33,6
s_add_u32 s35,s35,s60
s_lshl_b32 s35,s35,9
s_add_u32 s35,s35,323584
s_cmp_lt_u32 s60,8
s_cselect_b64 s[76:77],s[78:79],-1
s_sub_u32 s57,40960,s57
v_swap_b32 v16,v18
v_swap_b32 v17,v19
s_add_u32 s62,s32,1
s_min_u32 s62,s62,127
s_sub_u32 s60,s62,16
s_lshr_b32 s41,s60,1
s_and_b32 s40,s60,1
s_cmp_eq_u32 s40,0
s_cselect_b32 s61,16,0
s_add_u32 s41,s41,s61
s_sub_u32 s61,s60,48
s_cmp_ge_u32 s60,96
s_cselect_b32 s41,s61,s41
s_cselect_b32 s40,1,s40
s_cmp_lt_u32 s62,16
s_cselect_b32 s41,s62,s41
s_cselect_b32 s40,0,s40
s_add_u32 s60,s41,1
s_min_u32 s60,s60,63
s_lshl_b32 s42,s40,6
s_add_u32 s42,s42,s60
s_lshl_b32 s42,s42,9
s_add_u32 s42,s42,323584
s_cmp_lt_u32 s60,8
s_cselect_b64 s[80:81],s[78:79],-1
W2_COLD:
s_mov_b32 s37,0
fb_276:
buffer_load_dword v3,v2,s[8:11],s35 offen sc1
s_waitcnt vmcnt(0)
v_cmp_eq_u32 vcc,0,v3
s_and_b64 vcc,vcc,s[76:77]
s_cbranch_scc0 ok_277
s_sleep 1
s_sub_u32 s47,s47,1
s_cbranch_scc1 ABORT
s_branch fb_276
ok_277:
W2_COLD2:
s_sub_u32 s66,40960,s57
s_add_u32 s61,s34,s68
s_and_b32 s62,s61,7
s_cmp_lt_u32 s61,64
s_cselect_b32 s62,s62,8
s_mul_i32 s62,s62,40960
s_and_b32 s61,s34,7
s_mul_i32 s61,s61,40960
v_mad_u32_u24 v112,v76,s62,v74
v_mad_u32_u24 v112,v78,s61,v112
v_mad_u32_u24 v113,v77,s62,v75
v_mad_u32_u24 v113,v79,s61,v113
s_mov_b32 s60,s33
s_mul_i32 s60,s60,368640
s_add_u32 s60,s60,s37
s_mul_i32 s61,s46,10240
s_add_u32 s60,s60,s61
s_add_u32 s60,s60,237371392
s_add_u32 s61,s61,s66
s_add_u32 m0,s61,0
s_add_u32 s63,s60,0
buffer_load_dwordx4 v112,s[8:11],s63 offen sc1 lds
s_add_u32 m0,s61,1024
s_nop 0
buffer_load_dwordx4 v113,s[8:11],s63 offen sc1 lds
s_add_u32 m0,s61,2048
s_add_u32 s63,s60,2048
buffer_load_dwordx4 v112,s[8:11],s63 offen sc1 lds
s_add_u32 m0,s61,3072
s_nop 0
buffer_load_dwordx4 v113,s[8:11],s63 offen sc1 lds
s_add_u32 m0,s61,4096
s_add_u32 s63,s60,4096
buffer_load_dwordx4 v112,s[8:11],s63 offen sc1 lds
s_add_u32 m0,s61,5120
s_nop 0
buffer_load_dwordx4 v113,s[8:11],s63 offen sc1 lds
s_waitcnt vmcnt(5)
s_mov_b64 exec,1
s_cmp_lg_u32 s49,0
s_cbranch_scc0 ls_278
buffer_store_dword v5,v1,s[8:11],s59 offen sc1
s_branch ls_279
ls_278:
buffer_store_dword v5,v1,s[8:11],s59 offen
ls_279:
s_mov_b64 exec,-1
s_mov_b32 s59,2147483648
s_add_u32 m0,s61,6144
s_add_u32 s63,s60,6144
buffer_load_dwordx4 v112,s[8:11],s63 offen sc1 lds
s_add_u32 m0,s61,7168
s_nop 0
buffer_load_dwordx4 v113,s[8:11],s63 offen sc1 lds
s_add_u32 m0,s61,8192
s_add_u32 s63,s60,8192
buffer_load_dwordx4 v112,s[8:11],s63 offen sc1 lds
s_add_u32 m0,s61,9216
s_nop 0
buffer_load_dwordx4 v113,s[8:11],s63 offen sc1 lds
s_mov_b32 s35,s42
s_mov_b32 s53,s33
s_mov_b32 s54,s34
s_add_u32 s32,s32,1
s_mov_b32 s33,s40
s_mov_b32 s34,s41
s_mov_b64 s[76:77],s[80:81]
s_sub_u32 s57,40960,s57
v_swap_b32 v16,v18
v_swap_b32 v17,v19
s_mov_b32 s51,s53
s_mov_b32 s52,s54
s_waitcnt vmcnt(5)
s_branch W2_GO
W2_NEXT:
s_sub_u32 s57,40960,s57
v_swap_b32 v16,v18
v_swap_b32 v17,v19
s_mov_b32 s51,s53
s_mov_b32 s52,s54
s_waitcnt vmcnt(3)
W2_GO:
s_barrier
ds_read_b128 v[24:27],v16 offset:0
ds_read_b128 v[28:31],v17 offset:0
ds_read_b128 v[32:35],v16 offset:10240
ds_read_b128 v[36:39],v17 offset:10240
ds_read_b128 v[40:43],v16 offset:20480
ds_read_b128 v[44:47],v17 offset:20480
ds_read_b128 v[48:51],v16 offset:30720
buffer_load_dword v3,v2,s[8:11],s35 offen sc1
s_waitcnt lgkmcnt(6)
v_mfma_f32_32x32x16_bf16 v[56:71],a[0:3],v[24:27],0
ds_read_b128 v[52:55],v17 offset:30720
s_lshl_b32 s60,s51,6
s_add_u32 s60,s60,s52
s_mul_i32 s60,s60,46080
s_waitcnt lgkmcnt(6)
v_mfma_f32_32x32x16_bf16 v[56:71],a[4:7],v[28:31],v[56:71]
ds_read_b128 v[24:27],v16 offset:2048
s_lshl_b32 s61,s56,11
s_add_u32 s60,s60,s61
s_add_u32 s60,s60,223608832
s_waitcnt lgkmcnt(5)
v_mfma_f32_32x32x16_bf16 v[56:71],a[40:43],v[32:35],v[56:71]
ds_read_b128 v[28:31],v17 offset:2048
buffer_load_dwordx4 v[120:123],v116,s[8:11],s60 offen sc1
buffer_load_dwordx4 v[124:127],v117,s[8:11],s60 offen sc1
v_mfma_f32_32x32x16_bf16 v[56:71],a[44:47],v[36:39],v[56:71]
ds_read_b128 v[32:35],v16 offset:12288
s_add_u32 s62,s32,1
s_min_u32 s62,s62,127
s_sub_u32 s60,s62,16
s_waitcnt lgkmcnt(5)
v_mfma_f32_32x32x16_bf16 v[56:71],a[80:83],v[40:43],v[56:71]
ds_read_b128 v[36:39],v17 offset:12288
s_lshr_b32 s41,s60,1
s_and_b32 s40,s60,1
s_cmp_eq_u32 s40,0
s_cselect_b32 s61,16,0
v_mfma_f32_32x32x16_bf16 v[56:71],a[84:87],v[44:47],v[56:71]
ds_read_b128 v[40:43],v16 offset:22528
s_add_u32 s41,s41,s61
s_sub_u32 s61,s60,48
s_mul_i32 s71,s51,8
s_waitcnt lgkmcnt(5)
v_mfma_f32_32x32x16_bf16 v[56:71],a[120:123],v[48:51],v[56:71]
ds_read_b128 v[44:47],v17 offset:22528
s_cmp_ge_u32 s60,96
s_cselect_b32 s41,s61,s41
s_cselect_b32 s40,1,s40
s_and_b32 s72,s52,7
v_mfma_f32_32x32x16_bf16 v[56:71],a[124:127],v[52:55],v[56:71]
ds_read_b128 v[48:51],v16 offset:32768
s_cmp_lt_u32 s62,16
s_cselect_b32 s41,s62,s41
s_cselect_b32 s40,0,s40
s_waitcnt lgkmcnt(5)
v_mfma_f32_32x32x16_bf16 v[56:71],a[8:11],v[24:27],v[56:71]
ds_read_b128 v[52:55],v17 offset:32768
s_add_u32 s60,s41,1
s_min_u32 s60,s60,63
s_lshl_b32 s42,s40,6
s_add_u32 s42,s42,s60
v_mfma_f32_32x32x16_bf16 v[56:71],a[12:15],v[28:31],v[56:71]
ds_read_b128 v[24:27],v16 offset:4096
s_lshl_b32 s42,s42,9
s_add_u32 s42,s42,323584
s_add_u32 s71,s71,s72
s_waitcnt lgkmcnt(5)
v_mfma_f32_32x32x16_bf16 v[56:71],a[48:51],v[32:35],v[56:71]
ds_read_b128 v[28:31],v17 offset:4096
s_cmp_lt_u32 s60,8
s_cselect_b64 s[80:81],s[78:79],-1
s_mul_i32 s71,s71,46080
s_add_u32 s71,s71,212467712
v_mfma_f32_32x32x16_bf16 v[56:71],a[52:55],v[36:39],v[56:71]
ds_read_b128 v[32:35],v16 offset:14336
s_lshl_b32 s72,s56,8
s_add_u32 s72,s72,s71
s_add_u32 s72,s72,40960
s_waitcnt lgkmcnt(5)
v_mfma_f32_32x32x16_bf16 v[56:71],a[88:91],v[40:43],v[56:71]
ds_read_b128 v[36:39],v17 offset:14336
s_waitcnt vmcnt(2)
s_mov_b64 exec,1
s_cmp_lg_u32 s49,0
s_cbranch_scc0 ls_280
buffer_store_dword v5,v1,s[8:11],s59 offen sc1
s_branch ls_281
ls_280:
buffer_store_dword v5,v1,s[8:11],s59 offen
ls_281:
s_mov_b64 exec,-1
s_mov_b32 s59,2147483648
v_mfma_f32_32x32x16_bf16 v[56:71],a[92:95],v[44:47],v[56:71]
ds_read_b128 v[40:43],v16 offset:24576
v_cmp_eq_u32 vcc,0,v3
s_and_b64 vcc,vcc,s[76:77]
s_cselect_b32 s37,2147483648,0
s_waitcnt lgkmcnt(5)
v_mfma_f32_32x32x16_bf16 v[56:71],a[128:131],v[48:51],v[56:71]
ds_read_b128 v[44:47],v17 offset:24576
s_cmp_lt_u32 s32,128
s_cselect_b32 s37,s37,2147483648
s_sub_u32 s66,40960,s57
s_add_u32 s61,s34,s68
v_mfma_f32_32x32x16_bf16 v[56:71],a[132:135],v[52:55],v[56:71]
ds_read_b128 v[48:51],v16 offset:34816
s_and_b32 s62,s61,7
s_cmp_lt_u32 s61,64
s_cselect_b32 s62,s62,8
s_waitcnt lgkmcnt(5)
v_mfma_f32_32x32x16_bf16 v[56:71],a[16:19],v[24:27],v[56:71]
ds_read_b128 v[52:55],v17 offset:34816
s_mul_i32 s62,s62,40960
s_and_b32 s61,s34,7
s_mul_i32 s61,s61,40960
v_mad_u32_u24 v112,v76,s62,v74
s_barrier
v_mfma_f32_32x32x16_bf16 v[56:71],a[20:23],v[28:31],v[56:71]
ds_read_b128 v[24:27],v16 offset:6144
v_mad_u32_u24 v112,v78,s61,v112
v_mad_u32_u24 v113,v77,s62,v75
v_mad_u32_u24 v113,v79,s61,v113
s_waitcnt lgkmcnt(5)
v_mfma_f32_32x32x16_bf16 v[56:71],a[56:59],v[32:35],v[56:71]
ds_read_b128 v[28:31],v17 offset:6144
s_mov_b32 s60,s33
s_mul_i32 s60,s60,368640
s_add_u32 s60,s60,s37
s_mul_i32 s61,s46,10240
v_mfma_f32_32x32x16_bf16 v[56:71],a[60:63],v[36:39],v[56:71]
ds_read_b128 v[32:35],v16 offset:16384
s_add_u32 s60,s60,s61
s_add_u32 s60,s60,237371392
s_add_u32 s61,s61,s66
s_waitcnt lgkmcnt(5)
v_mfma_f32_32x32x16_bf16 v[56:71],a[96:99],v[40:43],v[56:71]
ds_read_b128 v[36:39],v17 offset:16384
s_add_u32 m0,s61,0
s_add_u32 s63,s60,0
buffer_load_dwordx4 v112,s[8:11],s63 offen sc1 lds
v_mfma_f32_32x32x16_bf16 v[56:71],a[100:103],v[44:47],v[56:71]
ds_read_b128 v[40:43],v16 offset:26624
s_add_u32 m0,s61,1024
s_lshl_b32 s73,s56,11
s_add_u32 s71,s71,s73
s_waitcnt lgkmcnt(5)
v_mfma_f32_32x32x16_bf16 v[56:71],a[136:139],v[48:51],v[56:71]
ds_read_b128 v[44:47],v17 offset:26624
buffer_load_dwordx4 v113,s[8:11],s63 offen sc1 lds
s_add_u32 m0,s61,2048
s_add_u32 s63,s60,2048
v_mfma_f32_32x32x16_bf16 v[56:71],a[140:143],v[52:55],v[56:71]
ds_read_b128 v[48:51],v16 offset:36864
s_lshl_b32 s82,s51,6
s_add_u32 s82,s82,s52
s_lshl_b32 s82,s82,9
s_waitcnt lgkmcnt(5)
v_mfma_f32_32x32x16_bf16 v[56:71],a[24:27],v[24:27],v[56:71]
ds_read_b128 v[52:55],v17 offset:36864
buffer_load_dwordx4 v112,s[8:11],s63 offen sc1 lds
s_add_u32 m0,s61,3072
s_add_u32 s82,s82,524288
v_mfma_f32_32x32x16_bf16 v[56:71],a[28:31],v[28:31],v[56:71]
ds_read_b128 v[24:27],v16 offset:8192
s_lshl_b32 s70,s56,2
s_add_u32 s82,s82,s70
s_waitcnt lgkmcnt(5)
v_mfma_f32_32x32x16_bf16 v[56:71],a[64:67],v[32:35],v[56:71]
ds_read_b128 v[28:31],v17 offset:8192
buffer_load_dwordx4 v113,s[8:11],s63 offen sc1 lds
s_add_u32 m0,s61,4096
s_add_u32 s63,s60,4096
v_mfma_f32_32x32x16_bf16 v[56:71],a[68:71],v[36:39],v[56:71]
ds_read_b128 v[32:35],v16 offset:18432
s_waitcnt lgkmcnt(5)
v_mfma_f32_32x32x16_bf16 v[56:71],a[104:107],v[40:43],v[56:71]
ds_read_b128 v[36:39],v17 offset:18432
buffer_load_dwordx4 v112,s[8:11],s63 offen sc1 lds
s_add_u32 m0,s61,5120
v_mfma_f32_32x32x16_bf16 v[56:71],a[108:111],v[44:47],v[56:71]
ds_read_b128 v[40:43],v16 offset:28672
s_waitcnt lgkmcnt(5)
v_mfma_f32_32x32x16_bf16 v[56:71],a[144:147],v[48:51],v[56:71]
ds_read_b128 v[44:47],v17 offset:28672
buffer_load_dword v3,v2,s[8:11],s35 offen sc1
v_mfma_f32_32x32x16_bf16 v[56:71],a[148:151],v[52:55],v[56:71]
ds_read_b128 v[48:51],v16 offset:38912
buffer_load_dwordx4 v113,s[8:11],s63 offen sc1 lds
s_add_u32 m0,s61,6144
s_waitcnt lgkmcnt(5)
v_mfma_f32_32x32x16_bf16 v[56:71],a[32:35],v[24:27],v[56:71]
ds_read_b128 v[52:55],v17 offset:38912
s_add_u32 s63,s60,6144
v_mfma_f32_32x32x16_bf16 v[56:71],a[36:39],v[28:31],v[56:71]
buffer_load_dwordx4 v112,s[8:11],s63 offen sc1 lds
s_add_u32 m0,s61,7168
s_waitcnt lgkmcnt(4)
v_mfma_f32_32x32x16_bf16 v[56:71],a[72:75],v[32:35],v[56:71]
v_mfma_f32_32x32x16_bf16 v[56:71],a[76:79],v[36:39],v[56:71]
buffer_load_dwordx4 v113,s[8:11],s63 offen sc1 lds
s_add_u32 m0,s61,8192
s_add_u32 s63,s60,8192
s_waitcnt lgkmcnt(2)
v_mfma_f32_32x32x16_bf16 v[56:71],a[112:115],v[40:43],v[56:71]
v_mfma_f32_32x32x16_bf16 v[56:71],a[116:119],v[44:47],v[56:71]
buffer_load_dwordx4 v112,s[8:11],s63 offen sc1 lds
s_add_u32 m0,s61,9216
s_waitcnt lgkmcnt(0)
v_mfma_f32_32x32x16_bf16 v[56:71],a[152:155],v[48:51],v[56:71]
v_mfma_f32_32x32x16_bf16 v[56:71],a[156:159],v[52:55],v[56:71]
buffer_load_dwordx4 v113,s[8:11],s63 offen sc1 lds
s_waitcnt vmcnt(12)
v_lshlrev_b32 v128,16,v120
v_and_b32 v129,0xffff0000,v120
v_lshlrev_b32 v130,16,v121
v_and_b32 v131,0xffff0000,v121
v_lshlrev_b32 v132,16,v122
v_and_b32 v133,0xffff0000,v122
v_lshlrev_b32 v134,16,v123
v_and_b32 v135,0xffff0000,v123
v_lshlrev_b32 v136,16,v124
v_and_b32 v137,0xffff0000,v124
v_lshlrev_b32 v138,16,v125
v_and_b32 v139,0xffff0000,v125
v_lshlrev_b32 v140,16,v126
v_and_b32 v141,0xffff0000,v126
v_lshlrev_b32 v142,16,v127
v_and_b32 v143,0xffff0000,v127
s_cmp_eq_u32 s37,0
s_cbranch_scc0 sec_284
s_mov_b32 s35,s42
s_mov_b32 s53,s33
s_mov_b32 s54,s34
s_add_u32 s32,s32,1
s_mov_b32 s33,s40
s_mov_b32 s34,s41
s_mov_b64 s[76:77],s[80:81]
s_nop 2
ep_282:
v_cvt_pk_bf16_f32 v6,v56,v57
v_lshlrev_b32 v56,16,v6
v_and_b32 v57,0xffff0000,v6
v_cvt_pk_bf16_f32 v6,v58,v59
v_lshlrev_b32 v58,16,v6
v_and_b32 v59,0xffff0000,v6
v_cvt_pk_bf16_f32 v6,v60,v61
v_lshlrev_b32 v60,16,v6
v_and_b32 v61,0xffff0000,v6
v_cvt_pk_bf16_f32 v6,v62,v63
v_lshlrev_b32 v62,16,v6
v_and_b32 v63,0xffff0000,v6
v_cvt_pk_bf16_f32 v6,v64,v65
v_lshlrev_b32 v64,16,v6
v_and_b32 v65,0xffff0000,v6
v_cvt_pk_bf16_f32 v6,v66,v67
v_lshlrev_b32 v66,16,v6
v_and_b32 v67,0xffff0000,v6
v_cvt_pk_bf16_f32 v6,v68,v69
v_lshlrev_b32 v68,16,v6
v_and_b32 v69,0xffff0000,v6
v_cvt_pk_bf16_f32 v6,v70,v71
v_lshlrev_b32 v70,16,v6
v_and_b32 v71,0xffff0000,v6
v_pk_add_f32 v[56:57],v[56:57],v[128:129]
v_pk_add_f32 v[58:59],v[58:59],v[130:131]
v_pk_add_f32 v[60:61],v[60:61],v[132:133]
v_pk_add_f32 v[62:63],v[62:63],v[134:135]
v_pk_add_f32 v[64:65],v[64:65],v[136:137]
v_pk_add_f32 v[66:67],v[66:67],v[138:139]
v_pk_add_f32 v[68:69],v[68:69],v[140:141]
v_pk_add_f32 v[70:71],v[70:71],v[142:143]
v_cvt_pk_bf16_f32 v144,v56,v57
v_lshlrev_b32 v56,16,v144
v_and_b32 v57,0xffff0000,v144
v_cvt_pk_bf16_f32 v145,v58,v59
v_lshlrev_b32 v58,16,v145
v_and_b32 v59,0xffff0000,v145
v_cvt_pk_bf16_f32 v146,v60,v61
v_lshlrev_b32 v60,16,v146
v_and_b32 v61,0xffff0000,v146
v_cvt_pk_bf16_f32 v147,v62,v63
v_lshlrev_b32 v62,16,v147
v_and_b32 v63,0xffff0000,v147
v_cvt_pk_bf16_f32 v148,v64,v65
v_lshlrev_b32 v64,16,v148
v_and_b32 v65,0xffff0000,v148
v_cvt_pk_bf16_f32 v149,v66,v67
v_lshlrev_b32 v66,16,v149
v_and_b32 v67,0xffff0000,v149
v_cvt_pk_bf16_f32 v150,v68,v69
v_lshlrev_b32 v68,16,v150
v_and_b32 v69,0xffff0000,v150
v_cvt_pk_bf16_f32 v151,v70,v71
v_lshlrev_b32 v70,16,v151
v_and_b32 v71,0xffff0000,v151
s_cmp_lg_u32 s49,0
s_cbranch_scc0 ls_285
buffer_store_dwordx4 v[144:147],v20,s[8:11],s71 offen sc1
buffer_store_dwordx4 v[148:151],v21,s[8:11],s71 offen sc1
s_branch ls_286
ls_285:
buffer_store_dwordx4 v[144:147],v20,s[8:11],s71 offen
buffer_store_dwordx4 v[148:151],v21,s[8:11],s71 offen
ls_286:
v_pk_add_f32 v[6:7],v[56:57],v[58:59]
v_pk_mul_f32 v[8:9],v[56:57],v[56:57]
v_pk_fma_f32 v[8:9],v[58:59],v[58:59],v[8:9]
v_pk_add_f32 v[6:7],v[6:7],v[60:61]
v_pk_fma_f32 v[8:9],v[60:61],v[60:61],v[8:9]
v_pk_add_f32 v[6:7],v[6:7],v[62:63]
v_pk_fma_f32 v[8:9],v[62:63],v[62:63],v[8:9]
v_pk_add_f32 v[6:7],v[6:7],v[64:65]
v_pk_fma_f32 v[8:9],v[64:65],v[64:65],v[8:9]
v_pk_add_f32 v[6:7],v[6:7],v[66:67]
v_pk_fma_f32 v[8:9],v[66:67],v[66:67],v[8:9]
v_pk_add_f32 v[6:7],v[6:7],v[68:69]
v_pk_fma_f32 v[8:9],v[68:69],v[68:69],v[8:9]
v_pk_add_f32 v[6:7],v[6:7],v[70:71]
v_pk_fma_f32 v[8:9],v[70:71],v[70:71],v[8:9]
v_add_f32 v6,v6,v7
v_add_f32 v7,v8,v9
v_mov_b32 v8,v6
v_mov_b32 v9,v7
s_nop 0
v_permlane32_swap_b32 v6,v8
v_permlane32_swap_b32 v7,v9
v_pk_add_f32 v[6:7],v[6:7],v[8:9]
s_mov_b32 exec_hi,0
s_cmp_lg_u32 s49,0
s_cbranch_scc0 ls_287
buffer_store_dwordx2 v[6:7],v114,s[8:11],s72 offen sc1
s_branch ls_288
ls_287:
buffer_store_dwordx2 v[6:7],v114,s[8:11],s72 offen
ls_288:
s_mov_b32 exec_hi,-1
s_mov_b32 s59,s82
s_cmp_eq_u32 s37,0
s_cbranch_scc1 W2_NEXT
s_waitcnt vmcnt(3)
v_cmp_eq_u32 vcc,0,v3
s_and_b64 vcc,vcc,s[76:77]
s_cselect_b32 s37,2147483648,0
s_cmp_lt_u32 s32,128
s_cselect_b32 s37,s37,2147483648
s_cmp_eq_u32 s37,0
s_cbranch_scc1 W2_COLD2
s_waitcnt vmcnt(0)
s_mov_b64 exec,1
s_cmp_lg_u32 s49,0
s_cbranch_scc0 ls_289
buffer_store_dword v5,v1,s[8:11],s59 offen sc1
s_branch ls_290
ls_289:
buffer_store_dword v5,v1,s[8:11],s59 offen
ls_290:
s_mov_b64 exec,-1
s_mov_b32 s59,2147483648
s_cmp_lt_u32 s32,128
s_cbranch_scc1 W2_COLD
s_branch W2_END
sec_284:
s_waitcnt vmcnt(5)
v_cmp_eq_u32 vcc,0,v3
s_and_b64 vcc,vcc,s[76:77]
s_cselect_b32 s37,2147483648,0
s_cmp_lt_u32 s32,128
s_cselect_b32 s37,s37,2147483648
s_cmp_lg_u32 s37,0
s_cbranch_scc1 nr_283
s_sub_u32 s66,40960,s57
s_add_u32 s61,s34,s68
s_and_b32 s62,s61,7
s_cmp_lt_u32 s61,64
s_cselect_b32 s62,s62,8
s_mul_i32 s62,s62,40960
s_and_b32 s61,s34,7
s_mul_i32 s61,s61,40960
v_mad_u32_u24 v112,v76,s62,v74
v_mad_u32_u24 v112,v78,s61,v112
v_mad_u32_u24 v113,v77,s62,v75
v_mad_u32_u24 v113,v79,s61,v113
s_mov_b32 s60,s33
s_mul_i32 s60,s60,368640
s_add_u32 s60,s60,s37
s_mul_i32 s61,s46,10240
s_add_u32 s60,s60,s61
s_add_u32 s60,s60,237371392
s_add_u32 s61,s61,s66
s_add_u32 m0,s61,0
s_add_u32 s63,s60,0
buffer_load_dwordx4 v112,s[8:11],s63 offen sc1 lds
v_cvt_pk_bf16_f32 v6,v56,v57
v_lshlrev_b32 v56,16,v6
v_and_b32 v57,0xffff0000,v6
v_cvt_pk_bf16_f32 v6,v58,v59
s_add_u32 m0,s61,1024
s_nop 0
buffer_load_dwordx4 v113,s[8:11],s63 offen sc1 lds
v_lshlrev_b32 v58,16,v6
v_and_b32 v59,0xffff0000,v6
v_cvt_pk_bf16_f32 v6,v60,v61
v_lshlrev_b32 v60,16,v6
s_add_u32 m0,s61,2048
s_add_u32 s63,s60,2048
buffer_load_dwordx4 v112,s[8:11],s63 offen sc1 lds
v_and_b32 v61,0xffff0000,v6
v_cvt_pk_bf16_f32 v6,v62,v63
v_lshlrev_b32 v62,16,v6
v_and_b32 v63,0xffff0000,v6
s_add_u32 m0,s61,3072
s_nop 0
buffer_load_dwordx4 v113,s[8:11],s63 offen sc1 lds
v_cvt_pk_bf16_f32 v6,v64,v65
v_lshlrev_b32 v64,16,v6
v_and_b32 v65,0xffff0000,v6
v_cvt_pk_bf16_f32 v6,v66,v67
s_add_u32 m0,s61,4096
s_add_u32 s63,s60,4096
buffer_load_dwordx4 v112,s[8:11],s63 offen sc1 lds
v_lshlrev_b32 v66,16,v6
v_and_b32 v67,0xffff0000,v6
v_cvt_pk_bf16_f32 v6,v68,v69
v_lshlrev_b32 v68,16,v6
s_add_u32 m0,s61,5120
s_nop 0
buffer_load_dwordx4 v113,s[8:11],s63 offen sc1 lds
v_and_b32 v69,0xffff0000,v6
v_cvt_pk_bf16_f32 v6,v70,v71
v_lshlrev_b32 v70,16,v6
v_and_b32 v71,0xffff0000,v6
s_add_u32 m0,s61,6144
s_add_u32 s63,s60,6144
buffer_load_dwordx4 v112,s[8:11],s63 offen sc1 lds
v_pk_add_f32 v[56:57],v[56:57],v[128:129]
v_pk_add_f32 v[58:59],v[58:59],v[130:131]
v_pk_add_f32 v[60:61],v[60:61],v[132:133]
v_pk_add_f32 v[62:63],v[62:63],v[134:135]
s_add_u32 m0,s61,7168
s_nop 0
buffer_load_dwordx4 v113,s[8:11],s63 offen sc1 lds
v_pk_add_f32 v[64:65],v[64:65],v[136:137]
v_pk_add_f32 v[66:67],v[66:67],v[138:139]
v_pk_add_f32 v[68:69],v[68:69],v[140:141]
v_pk_add_f32 v[70:71],v[70:71],v[142:143]
s_add_u32 m0,s61,8192
s_add_u32 s63,s60,8192
buffer_load_dwordx4 v112,s[8:11],s63 offen sc1 lds
v_cvt_pk_bf16_f32 v144,v56,v57
v_lshlrev_b32 v56,16,v144
v_and_b32 v57,0xffff0000,v144
v_cvt_pk_bf16_f32 v145,v58,v59
s_add_u32 m0,s61,9216
s_nop 0
buffer_load_dwordx4 v113,s[8:11],s63 offen sc1 lds
v_lshlrev_b32 v58,16,v145
v_and_b32 v59,0xffff0000,v145
v_cvt_pk_bf16_f32 v146,v60,v61
v_lshlrev_b32 v60,16,v146
s_mov_b32 s35,s42
s_mov_b32 s53,s33
s_mov_b32 s54,s34
s_add_u32 s32,s32,1
s_mov_b32 s33,s40
s_mov_b32 s34,s41
s_mov_b64 s[76:77],s[80:81]
v_and_b32 v61,0xffff0000,v146
v_cvt_pk_bf16_f32 v147,v62,v63
v_lshlrev_b32 v62,16,v147
v_and_b32 v63,0xffff0000,v147
v_cvt_pk_bf16_f32 v148,v64,v65
v_lshlrev_b32 v64,16,v148
v_and_b32 v65,0xffff0000,v148
v_cvt_pk_bf16_f32 v149,v66,v67
v_lshlrev_b32 v66,16,v149
v_and_b32 v67,0xffff0000,v149
v_cvt_pk_bf16_f32 v150,v68,v69
v_lshlrev_b32 v68,16,v150
v_and_b32 v69,0xffff0000,v150
v_cvt_pk_bf16_f32 v151,v70,v71
v_lshlrev_b32 v70,16,v151
v_and_b32 v71,0xffff0000,v151
s_cmp_lg_u32 s49,0
s_cbranch_scc0 ls_291
buffer_store_dwordx4 v[144:147],v20,s[8:11],s71 offen sc1
buffer_store_dwordx4 v[148:151],v21,s[8:11],s71 offen sc1
s_branch ls_292
ls_291:
buffer_store_dwordx4 v[144:147],v20,s[8:11],s71 offen
buffer_store_dwordx4 v[148:151],v21,s[8:11],s71 offen
ls_292:
v_pk_add_f32 v[6:7],v[56:57],v[58:59]
v_pk_mul_f32 v[8:9],v[56:57],v[56:57]
v_pk_fma_f32 v[8:9],v[58:59],v[58:59],v[8:9]
v_pk_add_f32 v[6:7],v[6:7],v[60:61]
v_pk_fma_f32 v[8:9],v[60:61],v[60:61],v[8:9]
v_pk_add_f32 v[6:7],v[6:7],v[62:63]
v_pk_fma_f32 v[8:9],v[62:63],v[62:63],v[8:9]
v_pk_add_f32 v[6:7],v[6:7],v[64:65]
v_pk_fma_f32 v[8:9],v[64:65],v[64:65],v[8:9]
v_pk_add_f32 v[6:7],v[6:7],v[66:67]
v_pk_fma_f32 v[8:9],v[66:67],v[66:67],v[8:9]
v_pk_add_f32 v[6:7],v[6:7],v[68:69]
v_pk_fma_f32 v[8:9],v[68:69],v[68:69],v[8:9]
v_pk_add_f32 v[6:7],v[6:7],v[70:71]
v_pk_fma_f32 v[8:9],v[70:71],v[70:71],v[8:9]
v_add_f32 v6,v6,v7
v_add_f32 v7,v8,v9
v_mov_b32 v8,v6
v_mov_b32 v9,v7
s_nop 0
v_permlane32_swap_b32 v6,v8
v_permlane32_swap_b32 v7,v9
v_pk_add_f32 v[6:7],v[6:7],v[8:9]
s_mov_b32 exec_hi,0
s_cmp_lg_u32 s49,0
s_cbranch_scc0 ls_293
buffer_store_dwordx2 v[6:7],v114,s[8:11],s72 offen sc1
s_branch ls_294
ls_293:
buffer_store_dwordx2 v[6:7],v114,s[8:11],s72 offen
ls_294:
s_mov_b32 exec_hi,-1
s_mov_b32 s59,s82
s_branch W2_NEXT
nr_283:
buffer_load_dword v3,v2,s[8:11],s35 offen sc1
s_branch ep_282
W2_END:
s_endpgm
ROLE_W3:
v_lshlrev_b32 v1,4,v0
v_mov_b32 v5,1
s_lshl_b32 s56,s48,2
s_add_u32 s56,s56,s46
v_bfe_u32 v6,v0,2,2
v_lshrrev_b32 v7,4,v0
v_add_u32 v7,v6,v7
v_and_b32 v7,3,v7
v_and_b32 v15,3,v0
v_lshlrev_b32 v15,4,v15
v_lshl_add_u32 v15,v7,6,v15
v_lshl_add_u32 v15,v6,8,v15
v_lshrrev_b32 v6,5,v0
v_bfe_u32 v7,v0,4,1
v_lshlrev_b32 v16,10,v7
v_lshl_add_u32 v16,v6,8,v16
v_and_b32 v6,15,v0
v_lshl_add_u32 v16,v6,4,v16
v_add_u32 v18,46080,v16
v_lshrrev_b32 v6,5,v0
v_bfe_u32 v7,v0,4,1
v_lshlrev_b32 v20,10,v7
v_lshl_add_u32 v20,v6,8,v20
v_and_b32 v6,15,v0
v_lshl_add_u32 v20,v6,4,v20
v_lshrrev_b32 v6,5,v0
v_add_u32 v6,2,v6
v_bfe_u32 v7,v0,4,1
v_lshlrev_b32 v17,10,v7
v_lshl_add_u32 v17,v6,8,v17
v_and_b32 v6,15,v0
v_lshl_add_u32 v17,v6,4,v17
v_add_u32 v19,46080,v17
v_lshrrev_b32 v6,5,v0
v_add_u32 v6,2,v6
v_bfe_u32 v7,v0,4,1
v_lshlrev_b32 v21,10,v7
v_lshl_add_u32 v21,v6,8,v21
v_and_b32 v6,15,v0
v_lshl_add_u32 v21,v6,4,v21
v_min_u32 v2,19,v0
v_lshlrev_b32 v2,2,v2
v_mov_b32 v112,0xc0135761
v_mov_b32 v113,0xbdd2d3e8
s_mov_b32 s68,0xbdd2d3e8
v_lshrrev_b32 v6,5,v0
v_mul_u32_u24 v182,2560,v6
v_and_b32 v6,31,v0
v_lshl_add_u32 v182,v6,3,v182
v_add_u32 v182,0xa000,v182
v_mov_b32 v20,v1
v_add_u32 v21,1024,v1
s_waitcnt vmcnt(0)
s_barrier
s_cmp_lg_u32 s46,0
s_cbranch_scc1 arr_295
v_mov_b32 v6,1
s_lshl_b32 s3,s49,2
v_mov_b32 v7,s3
s_mov_b64 exec,1
buffer_atomic_add v6,v7,s[12:15],0 offen sc1
s_mov_b64 exec,-1
arr_295:
s_lshl_b32 s3,s49,2
v_mov_b32 v7,s3
s_nop 1
ibw_296:
buffer_load_dword v6,v7,s[12:15],0 offen sc1
s_waitcnt vmcnt(0)
v_cmp_ne_u32 vcc,256,v6
s_nop 0
s_cbranch_vccz ok_297
s_sleep 8
s_sub_u32 s47,s47,1
s_cbranch_scc1 ABORT
s_branch ibw_296
ok_297:
s_cmp_lg_u32 s49,0
s_cbranch_scc1 ibok_298
v_and_b32 v7,7,v0
v_lshlrev_b32 v7,2,v7
buffer_load_dword v6,v7,s[12:15],0 offen offset:32 sc1
s_waitcnt vmcnt(0)
v_cmp_ne_u32 vcc,32,v6
s_nop 0
s_cbranch_vccz ibok_298
s_barrier
s_mov_b32 s49,1
s_mov_b32 s3,s2
s_load_dwordx16 s[16:31],s[0:1],0
s_load_dwordx8 s[32:39],s[0:1],64
s_waitcnt lgkmcnt(0)
s_branch DISPATCH
ibok_298:
s_lshl_b32 s58,s56,6
s_mul_i32 s63,s46,40960
s_mov_b32 s4,s36
s_mov_b32 s5,s37
s_mov_b32 s6,1966080
s_mov_b32 s7,0x20000
v_lshrrev_b32 v9,2,v0
s_mov_b32 s64,3072
v_mul_lo_u32 v9,v9,s64
v_and_b32 v10,3,v0
v_lshl_add_u32 v6,v10,4,v9
s_add_u32 m0,s63,0
s_add_u32 s65,s58,0
buffer_load_dwordx4 v6,s[4:7],s65 offen lds
s_add_u32 m0,s63,1024
s_add_u32 s65,s58,49152
buffer_load_dwordx4 v6,s[4:7],s65 offen lds
s_add_u32 m0,s63,2048
s_add_u32 s65,s58,98304
buffer_load_dwordx4 v6,s[4:7],s65 offen lds
s_add_u32 m0,s63,3072
s_add_u32 s65,s58,147456
buffer_load_dwordx4 v6,s[4:7],s65 offen lds
s_add_u32 m0,s63,4096
s_add_u32 s65,s58,196608
buffer_load_dwordx4 v6,s[4:7],s65 offen lds
s_add_u32 m0,s63,5120
s_add_u32 s65,s58,245760
buffer_load_dwordx4 v6,s[4:7],s65 offen lds
s_add_u32 m0,s63,6144
s_add_u32 s65,s58,294912
buffer_load_dwordx4 v6,s[4:7],s65 offen lds
s_add_u32 m0,s63,7168
s_add_u32 s65,s58,344064
buffer_load_dwordx4 v6,s[4:7],s65 offen lds
s_add_u32 m0,s63,8192
s_add_u32 s65,s58,393216
buffer_load_dwordx4 v6,s[4:7],s65 offen lds
s_add_u32 m0,s63,9216
s_add_u32 s65,s58,442368
buffer_load_dwordx4 v6,s[4:7],s65 offen lds
s_add_u32 m0,s63,10240
s_add_u32 s65,s58,491520
buffer_load_dwordx4 v6,s[4:7],s65 offen lds
s_add_u32 m0,s63,11264
s_add_u32 s65,s58,540672
buffer_load_dwordx4 v6,s[4:7],s65 offen lds
s_add_u32 m0,s63,12288
s_add_u32 s65,s58,589824
buffer_load_dwordx4 v6,s[4:7],s65 offen lds
s_add_u32 m0,s63,13312
s_add_u32 s65,s58,638976
buffer_load_dwordx4 v6,s[4:7],s65 offen lds
s_add_u32 m0,s63,14336
s_add_u32 s65,s58,688128
buffer_load_dwordx4 v6,s[4:7],s65 offen lds
s_add_u32 m0,s63,15360
s_add_u32 s65,s58,737280
buffer_load_dwordx4 v6,s[4:7],s65 offen lds
s_add_u32 m0,s63,16384
s_add_u32 s65,s58,786432
buffer_load_dwordx4 v6,s[4:7],s65 offen lds
s_add_u32 m0,s63,17408
s_add_u32 s65,s58,835584
buffer_load_dwordx4 v6,s[4:7],s65 offen lds
s_add_u32 m0,s63,18432
s_add_u32 s65,s58,884736
buffer_load_dwordx4 v6,s[4:7],s65 offen lds
s_add_u32 m0,s63,19456
s_add_u32 s65,s58,933888
buffer_load_dwordx4 v6,s[4:7],s65 offen lds
s_add_u32 m0,s63,20480
s_add_u32 s65,s58,983040
buffer_load_dwordx4 v6,s[4:7],s65 offen lds
s_add_u32 m0,s63,21504
s_add_u32 s65,s58,1032192
buffer_load_dwordx4 v6,s[4:7],s65 offen lds
s_add_u32 m0,s63,22528
s_add_u32 s65,s58,1081344
buffer_load_dwordx4 v6,s[4:7],s65 offen lds
s_add_u32 m0,s63,23552
s_add_u32 s65,s58,1130496
buffer_load_dwordx4 v6,s[4:7],s65 offen lds
s_add_u32 m0,s63,24576
s_add_u32 s65,s58,1179648
buffer_load_dwordx4 v6,s[4:7],s65 offen lds
s_add_u32 m0,s63,25600
s_add_u32 s65,s58,1228800
buffer_load_dwordx4 v6,s[4:7],s65 offen lds
s_add_u32 m0,s63,26624
s_add_u32 s65,s58,1277952
buffer_load_dwordx4 v6,s[4:7],s65 offen lds
s_add_u32 m0,s63,27648
s_add_u32 s65,s58,1327104
buffer_load_dwordx4 v6,s[4:7],s65 offen lds
s_add_u32 m0,s63,28672
s_add_u32 s65,s58,1376256
buffer_load_dwordx4 v6,s[4:7],s65 offen lds
s_add_u32 m0,s63,29696
s_add_u32 s65,s58,1425408
buffer_load_dwordx4 v6,s[4:7],s65 offen lds
s_add_u32 m0,s63,30720
s_add_u32 s65,s58,1474560
buffer_load_dwordx4 v6,s[4:7],s65 offen lds
s_add_u32 m0,s63,31744
s_add_u32 s65,s58,1523712
buffer_load_dwordx4 v6,s[4:7],s65 offen lds
s_add_u32 m0,s63,32768
s_add_u32 s65,s58,1572864
buffer_load_dwordx4 v6,s[4:7],s65 offen lds
s_add_u32 m0,s63,33792
s_add_u32 s65,s58,1622016
buffer_load_dwordx4 v6,s[4:7],s65 offen lds
s_add_u32 m0,s63,34816
s_add_u32 s65,s58,1671168
buffer_load_dwordx4 v6,s[4:7],s65 offen lds
s_add_u32 m0,s63,35840
s_add_u32 s65,s58,1720320
buffer_load_dwordx4 v6,s[4:7],s65 offen lds
s_add_u32 m0,s63,36864
s_add_u32 s65,s58,1769472
buffer_load_dwordx4 v6,s[4:7],s65 offen lds
s_add_u32 m0,s63,37888
s_add_u32 s65,s58,1818624
buffer_load_dwordx4 v6,s[4:7],s65 offen lds
s_add_u32 m0,s63,38912
s_add_u32 s65,s58,1867776
buffer_load_dwordx4 v6,s[4:7],s65 offen lds
s_add_u32 m0,s63,39936
s_add_u32 s65,s58,1916928
buffer_load_dwordx4 v6,s[4:7],s65 offen lds
s_waitcnt vmcnt(20)
v_bfe_u32 v9,v0,2,2
v_lshrrev_b32 v10,5,v0
v_lshl_add_u32 v9,v10,2,v9
v_mul_u32_u24 v9,64,v9
v_and_b32 v10,1,v0
v_lshl_add_u32 v9,v10,3,v9
v_bfe_u32 v10,v0,1,1
v_lshl_add_u32 v9,v10,5,v9
v_bfe_u32 v10,v0,4,1
v_lshl_add_u32 v9,v10,4,v9
v_add_u32 v7,s63,v9
ds_read_b64_tr_b16 a[0:1],v7 offset:0
ds_read_b64_tr_b16 a[2:3],v7 offset:1024
ds_read_b64_tr_b16 a[4:5],v7 offset:512
ds_read_b64_tr_b16 a[6:7],v7 offset:1536
ds_read_b64_tr_b16 a[8:9],v7 offset:2048
ds_read_b64_tr_b16 a[10:11],v7 offset:3072
ds_read_b64_tr_b16 a[12:13],v7 offset:2560
ds_read_b64_tr_b16 a[14:15],v7 offset:3584
ds_read_b64_tr_b16 a[16:17],v7 offset:4096
ds_read_b64_tr_b16 a[18:19],v7 offset:5120
ds_read_b64_tr_b16 a[20:21],v7 offset:4608
ds_read_b64_tr_b16 a[22:23],v7 offset:5632
s_waitcnt lgkmcnt(4)
ds_read_b64_tr_b16 a[24:25],v7 offset:6144
ds_read_b64_tr_b16 a[26:27],v7 offset:7168
ds_read_b64_tr_b16 a[28:29],v7 offset:6656
ds_read_b64_tr_b16 a[30:31],v7 offset:7680
ds_read_b64_tr_b16 a[32:33],v7 offset:8192
ds_read_b64_tr_b16 a[34:35],v7 offset:9216
ds_read_b64_tr_b16 a[36:37],v7 offset:8704
ds_read_b64_tr_b16 a[38:39],v7 offset:9728
ds_read_b64_tr_b16 a[40:41],v7 offset:10240
ds_read_b64_tr_b16 a[42:43],v7 offset:11264
ds_read_b64_tr_b16 a[44:45],v7 offset:10752
ds_read_b64_tr_b16 a[46:47],v7 offset:11776
s_waitcnt lgkmcnt(4)
ds_read_b64_tr_b16 a[48:49],v7 offset:12288
ds_read_b64_tr_b16 a[50:51],v7 offset:13312
ds_read_b64_tr_b16 a[52:53],v7 offset:12800
ds_read_b64_tr_b16 a[54:55],v7 offset:13824
ds_read_b64_tr_b16 a[56:57],v7 offset:14336
ds_read_b64_tr_b16 a[58:59],v7 offset:15360
ds_read_b64_tr_b16 a[60:61],v7 offset:14848
ds_read_b64_tr_b16 a[62:63],v7 offset:15872
ds_read_b64_tr_b16 a[64:65],v7 offset:16384
ds_read_b64_tr_b16 a[66:67],v7 offset:17408
ds_read_b64_tr_b16 a[68:69],v7 offset:16896
ds_read_b64_tr_b16 a[70:71],v7 offset:17920
s_waitcnt lgkmcnt(4)
ds_read_b64_tr_b16 a[72:73],v7 offset:18432
ds_read_b64_tr_b16 a[74:75],v7 offset:19456
ds_read_b64_tr_b16 a[76:77],v7 offset:18944
ds_read_b64_tr_b16 a[78:79],v7 offset:19968
s_waitcnt lgkmcnt(0)
s_waitcnt vmcnt(0)
v_bfe_u32 v9,v0,2,2
v_lshrrev_b32 v10,5,v0
v_lshl_add_u32 v9,v10,2,v9
v_mul_u32_u24 v9,64,v9
v_and_b32 v10,1,v0
v_lshl_add_u32 v9,v10,3,v9
v_bfe_u32 v10,v0,1,1
v_lshl_add_u32 v9,v10,5,v9
v_bfe_u32 v10,v0,4,1
v_lshl_add_u32 v9,v10,4,v9
v_add_u32 v7,s63,v9
ds_read_b64_tr_b16 a[80:81],v7 offset:20480
ds_read_b64_tr_b16 a[82:83],v7 offset:21504
ds_read_b64_tr_b16 a[84:85],v7 offset:20992
ds_read_b64_tr_b16 a[86:87],v7 offset:22016
ds_read_b64_tr_b16 a[88:89],v7 offset:22528
ds_read_b64_tr_b16 a[90:91],v7 offset:23552
ds_read_b64_tr_b16 a[92:93],v7 offset:23040
ds_read_b64_tr_b16 a[94:95],v7 offset:24064
ds_read_b64_tr_b16 a[96:97],v7 offset:24576
ds_read_b64_tr_b16 a[98:99],v7 offset:25600
ds_read_b64_tr_b16 a[100:101],v7 offset:25088
ds_read_b64_tr_b16 a[102:103],v7 offset:26112
s_waitcnt lgkmcnt(4)
ds_read_b64_tr_b16 a[104:105],v7 offset:26624
ds_read_b64_tr_b16 a[106:107],v7 offset:27648
ds_read_b64_tr_b16 a[108:109],v7 offset:27136
ds_read_b64_tr_b16 a[110:111],v7 offset:28160
ds_read_b64_tr_b16 a[112:113],v7 offset:28672
ds_read_b64_tr_b16 a[114:115],v7 offset:29696
ds_read_b64_tr_b16 a[116:117],v7 offset:29184
ds_read_b64_tr_b16 a[118:119],v7 offset:30208
ds_read_b64_tr_b16 a[120:121],v7 offset:30720
ds_read_b64_tr_b16 a[122:123],v7 offset:31744
ds_read_b64_tr_b16 a[124:125],v7 offset:31232
ds_read_b64_tr_b16 a[126:127],v7 offset:32256
s_waitcnt lgkmcnt(4)
ds_read_b64_tr_b16 a[128:129],v7 offset:32768
ds_read_b64_tr_b16 a[130:131],v7 offset:33792
ds_read_b64_tr_b16 a[132:133],v7 offset:33280
ds_read_b64_tr_b16 a[134:135],v7 offset:34304
ds_read_b64_tr_b16 a[136:137],v7 offset:34816
ds_read_b64_tr_b16 a[138:139],v7 offset:35840
ds_read_b64_tr_b16 a[140:141],v7 offset:35328
ds_read_b64_tr_b16 a[142:143],v7 offset:36352
ds_read_b64_tr_b16 a[144:145],v7 offset:36864
ds_read_b64_tr_b16 a[146:147],v7 offset:37888
ds_read_b64_tr_b16 a[148:149],v7 offset:37376
ds_read_b64_tr_b16 a[150:151],v7 offset:38400
s_waitcnt lgkmcnt(4)
ds_read_b64_tr_b16 a[152:153],v7 offset:38912
ds_read_b64_tr_b16 a[154:155],v7 offset:39936
ds_read_b64_tr_b16 a[156:157],v7 offset:39424
ds_read_b64_tr_b16 a[158:159],v7 offset:40448
s_waitcnt lgkmcnt(0)
v_mov_b32 v24,0x3f803f80
v_mov_b32 v25,0x3f803f80
v_mov_b32 v26,0x3f803f80
v_mov_b32 v27,0x3f803f80
s_nop 1
v_mfma_f32_32x32x16_bf16 v[144:159],a[0:3],v[24:27],0
v_mfma_f32_32x32x16_bf16 v[144:159],a[4:7],v[24:27],v[144:159]
v_mfma_f32_32x32x16_bf16 v[144:159],a[8:11],v[24:27],v[144:159]
v_mfma_f32_32x32x16_bf16 v[144:159],a[12:15],v[24:27],v[144:159]
v_mfma_f32_32x32x16_bf16 v[144:159],a[16:19],v[24:27],v[144:159]
v_mfma_f32_32x32x16_bf16 v[144:159],a[20:23],v[24:27],v[144:159]
v_mfma_f32_32x32x16_bf16 v[144:159],a[24:27],v[24:27],v[144:159]
v_mfma_f32_32x32x16_bf16 v[144:159],a[28:31],v[24:27],v[144:159]
v_mfma_f32_32x32x16_bf16 v[144:159],a[32:35],v[24:27],v[144:159]
v_mfma_f32_32x32x16_bf16 v[144:159],a[36:39],v[24:27],v[144:159]
v_mfma_f32_32x32x16_bf16 v[144:159],a[40:43],v[24:27],v[144:159]
v_mfma_f32_32x32x16_bf16 v[144:159],a[44:47],v[24:27],v[144:159]
v_mfma_f32_32x32x16_bf16 v[144:159],a[48:51],v[24:27],v[144:159]
v_mfma_f32_32x32x16_bf16 v[144:159],a[52:55],v[24:27],v[144:159]
v_mfma_f32_32x32x16_bf16 v[144:159],a[56:59],v[24:27],v[144:159]
v_mfma_f32_32x32x16_bf16 v[144:159],a[60:63],v[24:27],v[144:159]
v_mfma_f32_32x32x16_bf16 v[144:159],a[64:67],v[24:27],v[144:159]
v_mfma_f32_32x32x16_bf16 v[144:159],a[68:71],v[24:27],v[144:159]
v_mfma_f32_32x32x16_bf16 v[144:159],a[72:75],v[24:27],v[144:159]
v_mfma_f32_32x32x16_bf16 v[144:159],a[76:79],v[24:27],v[144:159]
v_mfma_f32_32x32x16_bf16 v[144:159],a[80:83],v[24:27],v[144:159]
v_mfma_f32_32x32x16_bf16 v[144:159],a[84:87],v[24:27],v[144:159]
v_mfma_f32_32x32x16_bf16 v[144:159],a[88:91],v[24:27],v[144:159]
v_mfma_f32_32x32x16_bf16 v[144:159],a[92:95],v[24:27],v[144:159]
v_mfma_f32_32x32x16_bf16 v[144:159],a[96:99],v[24:27],v[144:159]
v_mfma_f32_32x32x16_bf16 v[144:159],a[100:103],v[24:27],v[144:159]
v_mfma_f32_32x32x16_bf16 v[144:159],a[104:107],v[24:27],v[144:159]
v_mfma_f32_32x32x16_bf16 v[144:159],a[108:111],v[24:27],v[144:159]
v_mfma_f32_32x32x16_bf16 v[144:159],a[112:115],v[24:27],v[144:159]
v_mfma_f32_32x32x16_bf16 v[144:159],a[116:119],v[24:27],v[144:159]
v_mfma_f32_32x32x16_bf16 v[144:159],a[120:123],v[24:27],v[144:159]
v_mfma_f32_32x32x16_bf16 v[144:159],a[124:127],v[24:27],v[144:159]
v_mfma_f32_32x32x16_bf16 v[144:159],a[128:131],v[24:27],v[144:159]
v_mfma_f32_32x32x16_bf16 v[144:159],a[132:135],v[24:27],v[144:159]
v_mfma_f32_32x32x16_bf16 v[144:159],a[136:139],v[24:27],v[144:159]
v_mfma_f32_32x32x16_bf16 v[144:159],a[140:143],v[24:27],v[144:159]
v_mfma_f32_32x32x16_bf16 v[144:159],a[144:147],v[24:27],v[144:159]
v_mfma_f32_32x32x16_bf16 v[144:159],a[148:151],v[24:27],v[144:159]
v_mfma_f32_32x32x16_bf16 v[144:159],a[152:155],v[24:27],v[144:159]
v_mfma_f32_32x32x16_bf16 v[144:159],a[156:159],v[24:27],v[144:159]
s_barrier
s_mov_b32 s50,0
s_mov_b32 s32,0
s_mov_b32 s57,0
s_mov_b32 s59,2147483648
s_mov_b32 s82,2147483648
s_mov_b32 s39,2147483648
v_mov_b32 v22,94208
v_lshl_add_u32 v22,v0,2,v22
v_mov_b32 v23,0
ds_write_b32 v22,v23
s_mov_b32 s39,1600000
v_and_b32 v72,15,v0
v_lshlrev_b32 v72,7,v72
v_min_u32 v6,59,v0
v_lshlrev_b32 v6,2,v6
v_add_u32 v2,198656,v6
v_add_u32 v7,-80,v6
v_cmp_gt_u32 s[78:79],20,v0
s_nop 1
v_cndmask_b32 v2,v7,v2,s[78:79]
s_mov_b32 s51,0
s_mov_b32 s52,0
s_mul_i32 s62,s51,4
s_and_b32 s63,s52,3
s_add_u32 s62,s62,s63
s_mul_i32 s62,s62,98304
s_add_u32 s62,s62,242778112
s_lshl_b32 s63,s56,11
s_add_u32 s62,s62,s63
buffer_load_dword v73,v72,s[8:11],s62 offen sc1
s_mov_b32 s51,0
s_mov_b32 s52,1
s_mul_i32 s62,s51,4
s_and_b32 s63,s52,3
s_add_u32 s62,s62,s63
s_mul_i32 s62,s62,98304
s_add_u32 s62,s62,242778112
s_lshl_b32 s63,s56,11
s_add_u32 s62,s62,s63
buffer_load_dword v73,v72,s[8:11],s62 offen sc1
s_mov_b32 s51,0
s_mov_b32 s52,2
s_mul_i32 s62,s51,4
s_and_b32 s63,s52,3
s_add_u32 s62,s62,s63
s_mul_i32 s62,s62,98304
s_add_u32 s62,s62,242778112
s_lshl_b32 s63,s56,11
s_add_u32 s62,s62,s63
buffer_load_dword v73,v72,s[8:11],s62 offen sc1
s_mov_b32 s51,0
s_mov_b32 s52,3
s_mul_i32 s62,s51,4
s_and_b32 s63,s52,3
s_add_u32 s62,s62,s63
s_mul_i32 s62,s62,98304
s_add_u32 s62,s62,242778112
s_lshl_b32 s63,s56,11
s_add_u32 s62,s62,s63
buffer_load_dword v73,v72,s[8:11],s62 offen sc1
s_mov_b32 s51,1
s_mov_b32 s52,0
s_mul_i32 s62,s51,4
s_and_b32 s63,s52,3
s_add_u32 s62,s62,s63
s_mul_i32 s62,s62,98304
s_add_u32 s62,s62,242778112
s_lshl_b32 s63,s56,11
s_add_u32 s62,s62,s63
buffer_load_dword v73,v72,s[8:11],s62 offen sc1
s_mov_b32 s51,1
s_mov_b32 s52,1
s_mul_i32 s62,s51,4
s_and_b32 s63,s52,3
s_add_u32 s62,s62,s63
s_mul_i32 s62,s62,98304
s_add_u32 s62,s62,242778112
s_lshl_b32 s63,s56,11
s_add_u32 s62,s62,s63
buffer_load_dword v73,v72,s[8:11],s62 offen sc1
s_mov_b32 s51,1
s_mov_b32 s52,2
s_mul_i32 s62,s51,4
s_and_b32 s63,s52,3
s_add_u32 s62,s62,s63
s_mul_i32 s62,s62,98304
s_add_u32 s62,s62,242778112
s_lshl_b32 s63,s56,11
s_add_u32 s62,s62,s63
buffer_load_dword v73,v72,s[8:11],s62 offen sc1
s_mov_b32 s51,1
s_mov_b32 s52,3
s_mul_i32 s62,s51,4
s_and_b32 s63,s52,3
s_add_u32 s62,s62,s63
s_mul_i32 s62,s62,98304
s_add_u32 s62,s62,242778112
s_lshl_b32 s63,s56,11
s_add_u32 s62,s62,s63
buffer_load_dword v73,v72,s[8:11],s62 offen sc1
s_waitcnt vmcnt(0)
s_waitcnt lgkmcnt(0)
s_barrier
s_mov_b32 s83,s100
s_min_u32 s62,s32,127
s_sub_u32 s60,s62,17
s_lshr_b32 s34,s60,1
s_and_b32 s33,s60,1
s_cmp_eq_u32 s33,0
s_cselect_b32 s61,17,0
s_add_u32 s34,s34,s61
s_sub_u32 s61,s60,47
s_cmp_ge_u32 s60,94
s_cselect_b32 s34,s61,s34
s_cselect_b32 s33,1,s33
s_cmp_lt_u32 s62,17
s_cselect_b32 s34,s62,s34
s_cselect_b32 s33,0,s33
s_lshl_b32 s35,s33,6
s_add_u32 s35,s35,s34
s_lshl_b32 s35,s35,9
s_add_u32 s35,s35,325632
s_cmp_lt_u32 s34,4
s_cselect_b64 s[76:77],s[78:79],-1
s_sub_u32 s57,46080,s57
v_swap_b32 v16,v18
v_swap_b32 v17,v19
s_add_u32 s62,s32,1
s_min_u32 s62,s62,127
s_sub_u32 s60,s62,17
s_lshr_b32 s41,s60,1
s_and_b32 s40,s60,1
s_cmp_eq_u32 s40,0
s_cselect_b32 s61,17,0
s_add_u32 s41,s41,s61
s_sub_u32 s61,s60,47
s_cmp_ge_u32 s60,94
s_cselect_b32 s41,s61,s41
s_cselect_b32 s40,1,s40
s_cmp_lt_u32 s62,17
s_cselect_b32 s41,s62,s41
s_cselect_b32 s40,0,s40
s_lshl_b32 s42,s40,6
s_add_u32 s42,s42,s41
s_lshl_b32 s42,s42,9
s_add_u32 s42,s42,325632
s_cmp_lt_u32 s41,4
s_cselect_b64 s[80:81],s[78:79],-1
W3_COLD:
s_mov_b32 s37,0
fb_299:
buffer_load_dword v3,v2,s[8:11],s35 offen sc1
s_waitcnt vmcnt(0)
v_cmp_eq_u32 vcc,0,v3
s_and_b64 vcc,vcc,s[76:77]
s_cbranch_scc0 ok_300
s_sleep 1
s_sub_u32 s47,s47,1
s_cbranch_scc1 ABORT
s_branch fb_299
ok_300:
W3_COLD2:
s_sub_u32 s66,46080,s57
s_mul_i32 s60,s33,8
s_and_b32 s61,s34,7
s_add_u32 s60,s60,s61
s_mul_i32 s60,s60,46080
s_add_u32 s60,s60,s37
s_add_u32 s60,s60,212467712
s_mov_b32 s67,s60
s_mul_i32 s61,s46,10240
s_add_u32 s60,s60,s61
s_add_u32 s61,s61,s66
s_add_u32 m0,s61,0
s_add_u32 s63,s60,0
buffer_load_dwordx4 v1,s[8:11],s63 offen sc1 lds
buffer_load_dwordx4 v1,s[8:11],s63 offen offset:1024 sc1 lds
buffer_load_dwordx4 v1,s[8:11],s63 offen offset:2048 sc1 lds
buffer_load_dwordx4 v1,s[8:11],s63 offen offset:3072 sc1 lds
s_add_u32 m0,s61,4096
s_add_u32 s63,s60,4096
buffer_load_dwordx4 v1,s[8:11],s63 offen sc1 lds
buffer_load_dwordx4 v1,s[8:11],s63 offen offset:1024 sc1 lds
s_waitcnt vmcnt(5)
s_mov_b64 exec,1
s_cmp_lg_u32 s49,0
s_cbranch_scc0 ls_301
buffer_store_dword v5,v1,s[8:11],s59 offen sc1
s_branch ls_302
ls_301:
buffer_store_dword v5,v1,s[8:11],s59 offen
ls_302:
s_mov_b64 exec,-1
s_mov_b32 s59,2147483648
buffer_load_dwordx4 v1,s[8:11],s63 offen offset:2048 sc1 lds
buffer_load_dwordx4 v1,s[8:11],s63 offen offset:3072 sc1 lds
s_add_u32 m0,s61,8192
s_add_u32 s63,s60,8192
buffer_load_dwordx4 v1,s[8:11],s63 offen sc1 lds
buffer_load_dwordx4 v1,s[8:11],s63 offen offset:1024 sc1 lds
s_lshl_b32 s62,s46,10
s_add_u32 s62,s62,40960
s_add_u32 m0,s66,s62
s_add_u32 s63,s67,s62
buffer_load_dwordx4 v1,s[8:11],s63 offen sc1 lds
s_add_u32 m0,s66,45056
s_add_u32 s63,s67,45056
buffer_load_dwordx4 v1,s[8:11],s63 offen sc1 lds
s_mov_b32 s35,s42
s_mov_b32 s53,s33
s_mov_b32 s54,s34
s_add_u32 s32,s32,1
s_mov_b32 s33,s40
s_mov_b32 s34,s41
s_mov_b64 s[76:77],s[80:81]
s_sub_u32 s57,46080,s57
v_swap_b32 v16,v18
v_swap_b32 v17,v19
s_mov_b32 s51,s53
s_mov_b32 s52,s54
s_waitcnt vmcnt(7)
s_branch W3_GO
W3_NEXT:
s_sub_u32 s57,46080,s57
v_swap_b32 v16,v18
v_swap_b32 v17,v19
s_mov_b32 s51,s53
s_mov_b32 s52,s54
s_waitcnt vmcnt(2)
W3_GO:
s_barrier
ds_read_b128 v[24:27],v16 offset:0
ds_read_b128 v[28:31],v17 offset:0
ds_read_b128 v[32:35],v16 offset:10240
ds_read_b128 v[36:39],v17 offset:10240
ds_read_b128 v[40:43],v16 offset:20480
ds_read_b128 v[44:47],v17 offset:20480
ds_read_b128 v[48:51],v16 offset:30720
buffer_load_dword v3,v2,s[8:11],s35 offen sc1
s_waitcnt lgkmcnt(6)
v_mfma_f32_32x32x16_bf16 v[56:71],a[0:3],v[24:27],0
ds_read_b128 v[52:55],v17 offset:30720
s_add_u32 s62,s32,1
s_min_u32 s62,s62,127
s_sub_u32 s60,s62,17
s_waitcnt lgkmcnt(6)
v_mfma_f32_32x32x16_bf16 v[56:71],a[4:7],v[28:31],v[56:71]
ds_read_b128 v[24:27],v16 offset:2048
s_lshr_b32 s41,s60,1
s_and_b32 s40,s60,1
s_mul_i32 s71,s51,4
s_waitcnt lgkmcnt(5)
v_mfma_f32_32x32x16_bf16 v[56:71],a[40:43],v[32:35],v[56:71]
ds_read_b128 v[28:31],v17 offset:2048
s_cmp_eq_u32 s40,0
s_cselect_b32 s61,17,0
s_add_u32 s41,s41,s61
s_sub_u32 s61,s60,47
v_mfma_f32_32x32x16_bf16 v[56:71],a[44:47],v[36:39],v[56:71]
ds_read_b128 v[32:35],v16 offset:12288
s_cmp_ge_u32 s60,94
s_cselect_b32 s41,s61,s41
s_cselect_b32 s40,1,s40
s_waitcnt lgkmcnt(5)
v_mfma_f32_32x32x16_bf16 v[56:71],a[80:83],v[40:43],v[56:71]
ds_read_b128 v[36:39],v17 offset:12288
s_cmp_lt_u32 s62,17
s_cselect_b32 s41,s62,s41
s_cselect_b32 s40,0,s40
s_lshl_b32 s42,s40,6
v_mfma_f32_32x32x16_bf16 v[56:71],a[84:87],v[44:47],v[56:71]
ds_read_b128 v[40:43],v16 offset:22528
s_add_u32 s42,s42,s41
s_lshl_b32 s42,s42,9
s_add_u32 s42,s42,325632
s_waitcnt lgkmcnt(5)
v_mfma_f32_32x32x16_bf16 v[56:71],a[120:123],v[48:51],v[56:71]
ds_read_b128 v[44:47],v17 offset:22528
s_cmp_lt_u32 s41,4
s_cselect_b64 s[80:81],s[78:79],-1
s_and_b32 s72,s52,3
s_add_u32 s71,s71,s72
v_mfma_f32_32x32x16_bf16 v[56:71],a[124:127],v[52:55],v[56:71]
ds_read_b128 v[48:51],v16 offset:32768
s_mul_i32 s71,s71,98304
s_add_u32 s71,s71,242778112
s_lshl_b32 s72,s56,11
s_waitcnt lgkmcnt(5)
v_mfma_f32_32x32x16_bf16 v[56:71],a[8:11],v[24:27],v[56:71]
ds_read_b128 v[52:55],v17 offset:32768
s_add_u32 s71,s71,s72
s_lshl_b32 s82,s51,6
s_add_u32 s82,s82,s52
s_lshl_b32 s82,s82,9
v_mfma_f32_32x32x16_bf16 v[56:71],a[12:15],v[28:31],v[56:71]
ds_read_b128 v[24:27],v16 offset:4096
s_add_u32 s82,s82,589824
s_lshl_b32 s70,s56,2
s_add_u32 s82,s82,s70
s_waitcnt lgkmcnt(5)
v_mfma_f32_32x32x16_bf16 v[56:71],a[48:51],v[32:35],v[56:71]
ds_read_b128 v[28:31],v17 offset:4096
v_mfma_f32_32x32x16_bf16 v[56:71],a[52:55],v[36:39],v[56:71]
ds_read_b128 v[32:35],v16 offset:14336
s_waitcnt lgkmcnt(5)
v_mfma_f32_32x32x16_bf16 v[56:71],a[88:91],v[40:43],v[56:71]
ds_read_b128 v[36:39],v17 offset:14336
s_waitcnt vmcnt(0)
s_mov_b64 exec,1
s_cmp_lg_u32 s49,0
s_cbranch_scc0 ls_303
buffer_store_dword v5,v1,s[8:11],s59 offen sc1
s_branch ls_304
ls_303:
buffer_store_dword v5,v1,s[8:11],s59 offen
ls_304:
s_mov_b64 exec,-1
s_mov_b32 s59,2147483648
v_mfma_f32_32x32x16_bf16 v[56:71],a[92:95],v[44:47],v[56:71]
ds_read_b128 v[40:43],v16 offset:24576
v_cmp_eq_u32 vcc,0,v3
s_and_b64 vcc,vcc,s[76:77]
s_cselect_b32 s37,2147483648,0
s_waitcnt lgkmcnt(5)
v_mfma_f32_32x32x16_bf16 v[56:71],a[128:131],v[48:51],v[56:71]
ds_read_b128 v[44:47],v17 offset:24576
s_cmp_lt_u32 s32,128
s_cselect_b32 s37,s37,2147483648
s_sub_u32 s66,46080,s57
s_mul_i32 s60,s33,8
v_mfma_f32_32x32x16_bf16 v[56:71],a[132:135],v[52:55],v[56:71]
ds_read_b128 v[48:51],v16 offset:34816
s_and_b32 s61,s34,7
s_add_u32 s60,s60,s61
s_mul_i32 s60,s60,46080
s_waitcnt lgkmcnt(5)
v_mfma_f32_32x32x16_bf16 v[56:71],a[16:19],v[24:27],v[56:71]
ds_read_b128 v[52:55],v17 offset:34816
s_add_u32 s60,s60,s37
s_add_u32 s60,s60,212467712
s_mov_b32 s67,s60
s_mul_i32 s61,s46,10240
s_barrier
v_mfma_f32_32x32x16_bf16 v[56:71],a[20:23],v[28:31],v[56:71]
ds_read_b128 v[24:27],v16 offset:6144
v_add_u32 v183,s57,v182
s_add_u32 s60,s60,s61
s_add_u32 s61,s61,s66
s_waitcnt lgkmcnt(5)
v_mfma_f32_32x32x16_bf16 v[56:71],a[56:59],v[32:35],v[56:71]
ds_read_b128 v[28:31],v17 offset:6144
v_add_u32 v8,0x800,v183
s_add_u32 m0,s61,0
s_add_u32 s63,s60,0
v_mfma_f32_32x32x16_bf16 v[56:71],a[60:63],v[36:39],v[56:71]
ds_read_b128 v[32:35],v16 offset:16384
ds_read2_b64 v[160:163],v183 offset0:0 offset1:32
s_waitcnt lgkmcnt(6)
v_mfma_f32_32x32x16_bf16 v[56:71],a[96:99],v[40:43],v[56:71]
ds_read_b128 v[36:39],v17 offset:16384
ds_read2_b64 v[164:167],v183 offset0:64 offset1:96
buffer_load_dwordx4 v1,s[8:11],s63 offen sc1 lds
v_mfma_f32_32x32x16_bf16 v[56:71],a[100:103],v[44:47],v[56:71]
ds_read_b128 v[40:43],v16 offset:26624
ds_read2_b64 v[168:171],v183 offset0:128 offset1:160
s_waitcnt lgkmcnt(8)
v_mfma_f32_32x32x16_bf16 v[56:71],a[136:139],v[48:51],v[56:71]
ds_read_b128 v[44:47],v17 offset:26624
ds_read2_b64 v[172:175],v183 offset0:192 offset1:224
buffer_load_dwordx4 v1,s[8:11],s63 offen offset:1024 sc1 lds
v_mfma_f32_32x32x16_bf16 v[56:71],a[140:143],v[52:55],v[56:71]
ds_read_b128 v[48:51],v16 offset:36864
ds_read2_b64 v[176:179],v8 offset0:0 offset1:32
s_waitcnt lgkmcnt(10)
v_mfma_f32_32x32x16_bf16 v[56:71],a[24:27],v[24:27],v[56:71]
ds_read_b128 v[52:55],v17 offset:36864
buffer_load_dwordx4 v1,s[8:11],s63 offen offset:2048 sc1 lds
v_mfma_f32_32x32x16_bf16 v[56:71],a[28:31],v[28:31],v[56:71]
ds_read_b128 v[24:27],v16 offset:8192
s_waitcnt lgkmcnt(9)
v_mfma_f32_32x32x16_bf16 v[56:71],a[64:67],v[32:35],v[56:71]
ds_read_b128 v[28:31],v17 offset:8192
buffer_load_dwordx4 v1,s[8:11],s63 offen offset:3072 sc1 lds
s_add_u32 m0,s61,4096
s_add_u32 s63,s60,4096
v_mfma_f32_32x32x16_bf16 v[56:71],a[68:71],v[36:39],v[56:71]
ds_read_b128 v[32:35],v16 offset:18432
s_waitcnt lgkmcnt(4)
v_add_f32 v160,v160,v170
v_add_f32 v161,v161,v171
v_mfma_f32_32x32x16_bf16 v[56:71],a[104:107],v[40:43],v[56:71]
ds_read_b128 v[36:39],v17 offset:18432
buffer_load_dwordx4 v1,s[8:11],s63 offen sc1 lds
v_add_f32 v162,v162,v172
v_add_f32 v163,v163,v173
v_mfma_f32_32x32x16_bf16 v[56:71],a[108:111],v[44:47],v[56:71]
ds_read_b128 v[40:43],v16 offset:28672
v_add_f32 v164,v164,v174
v_add_f32 v165,v165,v175
v_add_f32 v166,v166,v176
s_waitcnt lgkmcnt(5)
v_mfma_f32_32x32x16_bf16 v[56:71],a[144:147],v[48:51],v[56:71]
ds_read_b128 v[44:47],v17 offset:28672
buffer_load_dword v3,v2,s[8:11],s35 offen sc1
v_add_f32 v167,v167,v177
v_mfma_f32_32x32x16_bf16 v[56:71],a[148:151],v[52:55],v[56:71]
ds_read_b128 v[48:51],v16 offset:38912
buffer_load_dwordx4 v1,s[8:11],s63 offen offset:1024 sc1 lds
v_add_f32 v168,v168,v178
s_waitcnt lgkmcnt(5)
v_mfma_f32_32x32x16_bf16 v[56:71],a[32:35],v[24:27],v[56:71]
ds_read_b128 v[52:55],v17 offset:38912
v_add_f32 v169,v169,v179
v_add_f32 v160,v160,v162
v_add_f32 v161,v161,v163
v_add_f32 v164,v164,v166
v_mfma_f32_32x32x16_bf16 v[56:71],a[36:39],v[28:31],v[56:71]
buffer_load_dwordx4 v1,s[8:11],s63 offen offset:2048 sc1 lds
v_add_f32 v165,v165,v167
v_add_f32 v160,v160,v164
v_add_f32 v161,v161,v165
s_waitcnt lgkmcnt(4)
v_mfma_f32_32x32x16_bf16 v[56:71],a[72:75],v[32:35],v[56:71]
v_add_f32 v160,v160,v168
v_add_f32 v161,v161,v169
v_mov_b32 v162,v160
v_mov_b32 v163,v161
s_nop 0
v_permlane32_swap_b32 v160,v162
v_mfma_f32_32x32x16_bf16 v[56:71],a[76:79],v[36:39],v[56:71]
buffer_load_dwordx4 v1,s[8:11],s63 offen offset:3072 sc1 lds
s_add_u32 m0,s61,8192
s_add_u32 s63,s60,8192
v_permlane32_swap_b32 v161,v163
s_waitcnt lgkmcnt(2)
v_mfma_f32_32x32x16_bf16 v[56:71],a[112:115],v[40:43],v[56:71]
v_add_f32 v180,v160,v162
v_add_f32 v181,v161,v163
v_mul_f32 v180,0x3acccccd,v180
v_mul_f32 v181,0x3acccccd,v181
v_fma_f32 v181,-v180,v180,v181
v_mfma_f32_32x32x16_bf16 v[56:71],a[116:119],v[44:47],v[56:71]
buffer_load_dwordx4 v1,s[8:11],s63 offen sc1 lds
v_max_f32 v181,0,v181
v_cvt_pk_bf16_f32 v8,v180,v181
v_lshlrev_b32 v180,16,v8
s_waitcnt lgkmcnt(0)
v_mfma_f32_32x32x16_bf16 v[56:71],a[152:155],v[48:51],v[56:71]
v_and_b32 v181,0xffff0000,v8
v_add_f32 v181,0x3727c5ac,v181
v_cvt_pk_bf16_f32 v8,v181,v181
v_lshlrev_b32 v181,16,v8
v_sqrt_f32 v181,v181
v_mfma_f32_32x32x16_bf16 v[56:71],a[156:159],v[52:55],v[56:71]
buffer_load_dwordx4 v1,s[8:11],s63 offen offset:1024 sc1 lds
s_lshl_b32 s62,s46,10
s_add_u32 s62,s62,40960
s_add_u32 m0,s66,s62
s_add_u32 s63,s67,s62
buffer_load_dwordx4 v1,s[8:11],s63 offen sc1 lds
s_add_u32 m0,s66,45056
s_add_u32 s63,s67,45056
buffer_load_dwordx4 v1,s[8:11],s63 offen sc1 lds
v_cvt_pk_bf16_f32 v8,v181,v181
v_lshlrev_b32 v181,16,v8
v_rcp_f32 v181,v181
s_cmp_eq_u32 s37,0
s_cbranch_scc0 sec_307
s_mov_b32 s35,s42
s_mov_b32 s53,s33
s_mov_b32 s54,s34
s_add_u32 s32,s32,1
s_mov_b32 s33,s40
s_mov_b32 s34,s41
s_mov_b64 s[76:77],s[80:81]
s_nop 2
ep_305:
v_pk_fma_f32 v[56:57],v[144:145],v[180:181],v[56:57] op_sel_hi:[1,0,1] neg_lo:[0,1,0] neg_hi:[0,1,0]
v_pk_fma_f32 v[58:59],v[146:147],v[180:181],v[58:59] op_sel_hi:[1,0,1] neg_lo:[0,1,0] neg_hi:[0,1,0]
v_pk_fma_f32 v[60:61],v[148:149],v[180:181],v[60:61] op_sel_hi:[1,0,1] neg_lo:[0,1,0] neg_hi:[0,1,0]
v_pk_fma_f32 v[62:63],v[150:151],v[180:181],v[62:63] op_sel_hi:[1,0,1] neg_lo:[0,1,0] neg_hi:[0,1,0]
v_pk_fma_f32 v[64:65],v[152:153],v[180:181],v[64:65] op_sel_hi:[1,0,1] neg_lo:[0,1,0] neg_hi:[0,1,0]
v_pk_fma_f32 v[66:67],v[154:155],v[180:181],v[66:67] op_sel_hi:[1,0,1] neg_lo:[0,1,0] neg_hi:[0,1,0]
v_pk_fma_f32 v[68:69],v[156:157],v[180:181],v[68:69] op_sel_hi:[1,0,1] neg_lo:[0,1,0] neg_hi:[0,1,0]
v_pk_fma_f32 v[70:71],v[158:159],v[180:181],v[70:71] op_sel_hi:[1,0,1] neg_lo:[0,1,0] neg_hi:[0,1,0]
v_pk_mul_f32 v[56:57],v[56:57],v[180:181] op_sel:[0,1] op_sel_hi:[1,1]
v_pk_mul_f32 v[58:59],v[58:59],v[180:181] op_sel:[0,1] op_sel_hi:[1,1]
v_pk_mul_f32 v[60:61],v[60:61],v[180:181] op_sel:[0,1] op_sel_hi:[1,1]
v_pk_mul_f32 v[62:63],v[62:63],v[180:181] op_sel:[0,1] op_sel_hi:[1,1]
v_pk_mul_f32 v[64:65],v[64:65],v[180:181] op_sel:[0,1] op_sel_hi:[1,1]
v_pk_mul_f32 v[66:67],v[66:67],v[180:181] op_sel:[0,1] op_sel_hi:[1,1]
v_pk_mul_f32 v[68:69],v[68:69],v[180:181] op_sel:[0,1] op_sel_hi:[1,1]
v_pk_mul_f32 v[70:71],v[70:71],v[180:181] op_sel:[0,1] op_sel_hi:[1,1]
v_pk_mul_f32 v[124:125],v[56:57],v[56:57]
v_pk_mul_f32 v[126:127],v[58:59],v[58:59]
v_pk_mul_f32 v[128:129],v[60:61],v[60:61]
v_pk_mul_f32 v[130:131],v[62:63],v[62:63]
v_pk_mul_f32 v[132:133],v[64:65],v[64:65]
v_pk_mul_f32 v[134:135],v[66:67],v[66:67]
v_pk_mul_f32 v[136:137],v[68:69],v[68:69]
v_pk_mul_f32 v[138:139],v[70:71],v[70:71]
v_pk_fma_f32 v[124:125],v[124:125],v[112:113],v[112:113] op_sel:[0,1,0] op_sel_hi:[1,1,0]
v_pk_fma_f32 v[126:127],v[126:127],v[112:113],v[112:113] op_sel:[0,1,0] op_sel_hi:[1,1,0]
v_pk_fma_f32 v[128:129],v[128:129],v[112:113],v[112:113] op_sel:[0,1,0] op_sel_hi:[1,1,0]
v_pk_fma_f32 v[130:131],v[130:131],v[112:113],v[112:113] op_sel:[0,1,0] op_sel_hi:[1,1,0]
v_pk_fma_f32 v[132:133],v[132:133],v[112:113],v[112:113] op_sel:[0,1,0] op_sel_hi:[1,1,0]
v_pk_fma_f32 v[134:135],v[134:135],v[112:113],v[112:113] op_sel:[0,1,0] op_sel_hi:[1,1,0]
v_pk_fma_f32 v[136:137],v[136:137],v[112:113],v[112:113] op_sel:[0,1,0] op_sel_hi:[1,1,0]
v_pk_fma_f32 v[138:139],v[138:139],v[112:113],v[112:113] op_sel:[0,1,0] op_sel_hi:[1,1,0]
v_pk_mul_f32 v[124:125],v[124:125],v[56:57]
v_pk_mul_f32 v[126:127],v[126:127],v[58:59]
v_pk_mul_f32 v[128:129],v[128:129],v[60:61]
v_pk_mul_f32 v[130:131],v[130:131],v[62:63]
v_pk_mul_f32 v[132:133],v[132:133],v[64:65]
v_pk_mul_f32 v[134:135],v[134:135],v[66:67]
v_pk_mul_f32 v[136:137],v[136:137],v[68:69]
v_pk_mul_f32 v[138:139],v[138:139],v[70:71]
v_exp_f32 v124,v124
v_exp_f32 v125,v125
v_exp_f32 v126,v126
v_exp_f32 v127,v127
v_exp_f32 v128,v128
v_exp_f32 v129,v129
v_exp_f32 v130,v130
v_exp_f32 v131,v131
v_exp_f32 v132,v132
v_exp_f32 v133,v133
v_exp_f32 v134,v134
v_exp_f32 v135,v135
v_exp_f32 v136,v136
v_exp_f32 v137,v137
v_exp_f32 v138,v138
v_exp_f32 v139,v139
v_pk_add_f32 v[124:125],v[124:125],1.0 op_sel_hi:[1,0]
v_pk_add_f32 v[126:127],v[126:127],1.0 op_sel_hi:[1,0]
v_pk_add_f32 v[128:129],v[128:129],1.0 op_sel_hi:[1,0]
v_pk_add_f32 v[130:131],v[130:131],1.0 op_sel_hi:[1,0]
v_pk_add_f32 v[132:133],v[132:133],1.0 op_sel_hi:[1,0]
v_pk_add_f32 v[134:135],v[134:135],1.0 op_sel_hi:[1,0]
v_pk_add_f32 v[136:137],v[136:137],1.0 op_sel_hi:[1,0]
v_pk_add_f32 v[138:139],v[138:139],1.0 op_sel_hi:[1,0]
v_rcp_f32 v124,v124
v_rcp_f32 v125,v125
v_rcp_f32 v126,v126
v_rcp_f32 v127,v127
v_rcp_f32 v128,v128
v_rcp_f32 v129,v129
v_rcp_f32 v130,v130
v_rcp_f32 v131,v131
v_rcp_f32 v132,v132
v_rcp_f32 v133,v133
v_rcp_f32 v134,v134
v_rcp_f32 v135,v135
v_rcp_f32 v136,v136
v_rcp_f32 v137,v137
v_rcp_f32 v138,v138
v_rcp_f32 v139,v139
v_pk_mul_f32 v[56:57],v[56:57],v[124:125]
v_pk_mul_f32 v[58:59],v[58:59],v[126:127]
v_pk_mul_f32 v[60:61],v[60:61],v[128:129]
v_pk_mul_f32 v[62:63],v[62:63],v[130:131]
v_pk_mul_f32 v[64:65],v[64:65],v[132:133]
v_pk_mul_f32 v[66:67],v[66:67],v[134:135]
v_pk_mul_f32 v[68:69],v[68:69],v[136:137]
v_pk_mul_f32 v[70:71],v[70:71],v[138:139]
v_cvt_pk_bf16_f32 v116,v56,v57
v_cvt_pk_bf16_f32 v117,v58,v59
v_cvt_pk_bf16_f32 v118,v60,v61
v_cvt_pk_bf16_f32 v119,v62,v63
v_cvt_pk_bf16_f32 v120,v64,v65
v_cvt_pk_bf16_f32 v121,v66,v67
v_cvt_pk_bf16_f32 v122,v68,v69
v_cvt_pk_bf16_f32 v123,v70,v71
s_cmp_lg_u32 s49,0
s_cbranch_scc0 ls_308
buffer_store_dwordx4 v[116:119],v20,s[8:11],s71 offen sc1
buffer_store_dwordx4 v[120:123],v21,s[8:11],s71 offen sc1
s_branch ls_309
ls_308:
buffer_store_dwordx4 v[116:119],v20,s[8:11],s71 offen
buffer_store_dwordx4 v[120:123],v21,s[8:11],s71 offen
ls_309:
s_mov_b32 s59,s82
s_cmp_eq_u32 s37,0
s_cbranch_scc1 W3_NEXT
s_waitcnt vmcnt(2)
v_cmp_eq_u32 vcc,0,v3
s_and_b64 vcc,vcc,s[76:77]
s_cselect_b32 s37,2147483648,0
s_cmp_lt_u32 s32,128
s_cselect_b32 s37,s37,2147483648
s_cmp_eq_u32 s37,0
s_cbranch_scc1 W3_COLD2
s_waitcnt vmcnt(0)
s_mov_b64 exec,1
s_cmp_lg_u32 s49,0
s_cbranch_scc0 ls_310
buffer_store_dword v5,v1,s[8:11],s59 offen sc1
s_branch ls_311
ls_310:
buffer_store_dword v5,v1,s[8:11],s59 offen
ls_311:
s_mov_b64 exec,-1
s_mov_b32 s59,2147483648
s_cmp_lt_u32 s32,128
s_cbranch_scc1 W3_COLD
s_branch W3_END
sec_307:
s_waitcnt vmcnt(7)
v_cmp_eq_u32 vcc,0,v3
s_and_b64 vcc,vcc,s[76:77]
s_cselect_b32 s37,2147483648,0
s_cmp_lt_u32 s32,128
s_cselect_b32 s37,s37,2147483648
s_cmp_lg_u32 s37,0
s_cbranch_scc1 nr_306
s_sub_u32 s66,46080,s57
s_mul_i32 s60,s33,8
s_and_b32 s61,s34,7
s_add_u32 s60,s60,s61
s_mul_i32 s60,s60,46080
s_add_u32 s60,s60,s37
s_add_u32 s60,s60,212467712
s_mov_b32 s67,s60
s_mul_i32 s61,s46,10240
s_add_u32 s60,s60,s61
s_add_u32 s61,s61,s66
s_add_u32 m0,s61,0
s_add_u32 s63,s60,0
buffer_load_dwordx4 v1,s[8:11],s63 offen sc1 lds
v_pk_fma_f32 v[56:57],v[144:145],v[180:181],v[56:57] op_sel_hi:[1,0,1] neg_lo:[0,1,0] neg_hi:[0,1,0]
v_pk_fma_f32 v[58:59],v[146:147],v[180:181],v[58:59] op_sel_hi:[1,0,1] neg_lo:[0,1,0] neg_hi:[0,1,0]
v_pk_fma_f32 v[60:61],v[148:149],v[180:181],v[60:61] op_sel_hi:[1,0,1] neg_lo:[0,1,0] neg_hi:[0,1,0]
v_pk_fma_f32 v[62:63],v[150:151],v[180:181],v[62:63] op_sel_hi:[1,0,1] neg_lo:[0,1,0] neg_hi:[0,1,0]
v_pk_fma_f32 v[64:65],v[152:153],v[180:181],v[64:65] op_sel_hi:[1,0,1] neg_lo:[0,1,0] neg_hi:[0,1,0]
v_pk_fma_f32 v[66:67],v[154:155],v[180:181],v[66:67] op_sel_hi:[1,0,1] neg_lo:[0,1,0] neg_hi:[0,1,0]
v_pk_fma_f32 v[68:69],v[156:157],v[180:181],v[68:69] op_sel_hi:[1,0,1] neg_lo:[0,1,0] neg_hi:[0,1,0]
buffer_load_dwordx4 v1,s[8:11],s63 offen offset:1024 sc1 lds
v_pk_fma_f32 v[70:71],v[158:159],v[180:181],v[70:71] op_sel_hi:[1,0,1] neg_lo:[0,1,0] neg_hi:[0,1,0]
v_pk_mul_f32 v[56:57],v[56:57],v[180:181] op_sel:[0,1] op_sel_hi:[1,1]
v_pk_mul_f32 v[58:59],v[58:59],v[180:181] op_sel:[0,1] op_sel_hi:[1,1]
v_pk_mul_f32 v[60:61],v[60:61],v[180:181] op_sel:[0,1] op_sel_hi:[1,1]
v_pk_mul_f32 v[62:63],v[62:63],v[180:181] op_sel:[0,1] op_sel_hi:[1,1]
v_pk_mul_f32 v[64:65],v[64:65],v[180:181] op_sel:[0,1] op_sel_hi:[1,1]
v_pk_mul_f32 v[66:67],v[66:67],v[180:181] op_sel:[0,1] op_sel_hi:[1,1]
buffer_load_dwordx4 v1,s[8:11],s63 offen offset:2048 sc1 lds
v_pk_mul_f32 v[68:69],v[68:69],v[180:181] op_sel:[0,1] op_sel_hi:[1,1]
v_pk_mul_f32 v[70:71],v[70:71],v[180:181] op_sel:[0,1] op_sel_hi:[1,1]
v_pk_mul_f32 v[124:125],v[56:57],v[56:57]
v_pk_mul_f32 v[126:127],v[58:59],v[58:59]
v_pk_mul_f32 v[128:129],v[60:61],v[60:61]
v_pk_mul_f32 v[130:131],v[62:63],v[62:63]
v_pk_mul_f32 v[132:133],v[64:65],v[64:65]
buffer_load_dwordx4 v1,s[8:11],s63 offen offset:3072 sc1 lds
v_pk_mul_f32 v[134:135],v[66:67],v[66:67]
v_pk_mul_f32 v[136:137],v[68:69],v[68:69]
v_pk_mul_f32 v[138:139],v[70:71],v[70:71]
v_pk_fma_f32 v[124:125],v[124:125],v[112:113],v[112:113] op_sel:[0,1,0] op_sel_hi:[1,1,0]
v_pk_fma_f32 v[126:127],v[126:127],v[112:113],v[112:113] op_sel:[0,1,0] op_sel_hi:[1,1,0]
v_pk_fma_f32 v[128:129],v[128:129],v[112:113],v[112:113] op_sel:[0,1,0] op_sel_hi:[1,1,0]
v_pk_fma_f32 v[130:131],v[130:131],v[112:113],v[112:113] op_sel:[0,1,0] op_sel_hi:[1,1,0]
s_add_u32 m0,s61,4096
s_add_u32 s63,s60,4096
buffer_load_dwordx4 v1,s[8:11],s63 offen sc1 lds
v_pk_fma_f32 v[132:133],v[132:133],v[112:113],v[112:113] op_sel:[0,1,0] op_sel_hi:[1,1,0]
v_pk_fma_f32 v[134:135],v[134:135],v[112:113],v[112:113] op_sel:[0,1,0] op_sel_hi:[1,1,0]
v_pk_fma_f32 v[136:137],v[136:137],v[112:113],v[112:113] op_sel:[0,1,0] op_sel_hi:[1,1,0]
v_pk_fma_f32 v[138:139],v[138:139],v[112:113],v[112:113] op_sel:[0,1,0] op_sel_hi:[1,1,0]
v_pk_mul_f32 v[124:125],v[124:125],v[56:57]
v_pk_mul_f32 v[126:127],v[126:127],v[58:59]
v_pk_mul_f32 v[128:129],v[128:129],v[60:61]
buffer_load_dwordx4 v1,s[8:11],s63 offen offset:1024 sc1 lds
v_pk_mul_f32 v[130:131],v[130:131],v[62:63]
v_pk_mul_f32 v[132:133],v[132:133],v[64:65]
v_pk_mul_f32 v[134:135],v[134:135],v[66:67]
v_pk_mul_f32 v[136:137],v[136:137],v[68:69]
v_pk_mul_f32 v[138:139],v[138:139],v[70:71]
v_exp_f32 v124,v124
v_exp_f32 v125,v125
buffer_load_dwordx4 v1,s[8:11],s63 offen offset:2048 sc1 lds
v_exp_f32 v126,v126
v_exp_f32 v127,v127
v_exp_f32 v128,v128
v_exp_f32 v129,v129
v_exp_f32 v130,v130
v_exp_f32 v131,v131
v_exp_f32 v132,v132
buffer_load_dwordx4 v1,s[8:11],s63 offen offset:3072 sc1 lds
v_exp_f32 v133,v133
v_exp_f32 v134,v134
v_exp_f32 v135,v135
v_exp_f32 v136,v136
v_exp_f32 v137,v137
v_exp_f32 v138,v138
v_exp_f32 v139,v139
s_add_u32 m0,s61,8192
s_add_u32 s63,s60,8192
buffer_load_dwordx4 v1,s[8:11],s63 offen sc1 lds
v_pk_add_f32 v[124:125],v[124:125],1.0 op_sel_hi:[1,0]
v_pk_add_f32 v[126:127],v[126:127],1.0 op_sel_hi:[1,0]
v_pk_add_f32 v[128:129],v[128:129],1.0 op_sel_hi:[1,0]
v_pk_add_f32 v[130:131],v[130:131],1.0 op_sel_hi:[1,0]
v_pk_add_f32 v[132:133],v[132:133],1.0 op_sel_hi:[1,0]
v_pk_add_f32 v[134:135],v[134:135],1.0 op_sel_hi:[1,0]
v_pk_add_f32 v[136:137],v[136:137],1.0 op_sel_hi:[1,0]
buffer_load_dwordx4 v1,s[8:11],s63 offen offset:1024 sc1 lds
v_pk_add_f32 v[138:139],v[138:139],1.0 op_sel_hi:[1,0]
v_rcp_f32 v124,v124
v_rcp_f32 v125,v125
v_rcp_f32 v126,v126
v_rcp_f32 v127,v127
v_rcp_f32 v128,v128
v_rcp_f32 v129,v129
s_lshl_b32 s62,s46,10
s_add_u32 s62,s62,40960
s_add_u32 m0,s66,s62
s_add_u32 s63,s67,s62
buffer_load_dwordx4 v1,s[8:11],s63 offen sc1 lds
v_rcp_f32 v130,v130
v_rcp_f32 v131,v131
v_rcp_f32 v132,v132
v_rcp_f32 v133,v133
v_rcp_f32 v134,v134
v_rcp_f32 v135,v135
v_rcp_f32 v136,v136
s_add_u32 m0,s66,45056
s_add_u32 s63,s67,45056
buffer_load_dwordx4 v1,s[8:11],s63 offen sc1 lds
v_rcp_f32 v137,v137
v_rcp_f32 v138,v138
v_rcp_f32 v139,v139
v_pk_mul_f32 v[56:57],v[56:57],v[124:125]
v_pk_mul_f32 v[58:59],v[58:59],v[126:127]
v_pk_mul_f32 v[60:61],v[60:61],v[128:129]
v_pk_mul_f32 v[62:63],v[62:63],v[130:131]
s_mov_b32 s35,s42
s_mov_b32 s53,s33
s_mov_b32 s54,s34
s_add_u32 s32,s32,1
s_mov_b32 s33,s40
s_mov_b32 s34,s41
s_mov_b64 s[76:77],s[80:81]
v_pk_mul_f32 v[64:65],v[64:65],v[132:133]
v_pk_mul_f32 v[66:67],v[66:67],v[134:135]
v_pk_mul_f32 v[68:69],v[68:69],v[136:137]
v_pk_mul_f32 v[70:71],v[70:71],v[138:139]
v_cvt_pk_bf16_f32 v116,v56,v57
v_cvt_pk_bf16_f32 v117,v58,v59
v_cvt_pk_bf16_f32 v118,v60,v61
v_cvt_pk_bf16_f32 v119,v62,v63
v_cvt_pk_bf16_f32 v120,v64,v65
v_cvt_pk_bf16_f32 v121,v66,v67
v_cvt_pk_bf16_f32 v122,v68,v69
v_cvt_pk_bf16_f32 v123,v70,v71
s_cmp_lg_u32 s49,0
s_cbranch_scc0 ls_312
buffer_store_dwordx4 v[116:119],v20,s[8:11],s71 offen sc1
buffer_store_dwordx4 v[120:123],v21,s[8:11],s71 offen sc1
s_branch ls_313
ls_312:
buffer_store_dwordx4 v[116:119],v20,s[8:11],s71 offen
buffer_store_dwordx4 v[120:123],v21,s[8:11],s71 offen
ls_313:
s_mov_b32 s59,s82
s_branch W3_NEXT
nr_306:
buffer_load_dword v3,v2,s[8:11],s35 offen sc1
s_branch ep_305
W3_END:
s_endpgm
ROLE_W4:
v_lshlrev_b32 v1,4,v0
v_mov_b32 v5,1
s_lshl_b32 s56,s48,2
s_add_u32 s56,s56,s46
v_bfe_u32 v6,v0,2,2
v_lshrrev_b32 v7,4,v0
v_add_u32 v7,v6,v7
v_and_b32 v7,3,v7
v_and_b32 v15,3,v0
v_lshlrev_b32 v15,4,v15
v_lshl_add_u32 v15,v7,6,v15
v_lshl_add_u32 v15,v6,8,v15
v_lshrrev_b32 v6,5,v0
v_bfe_u32 v7,v0,4,1
v_lshlrev_b32 v208,10,v7
v_lshl_add_u32 v208,v6,8,v208
v_and_b32 v6,15,v0
v_lshl_add_u32 v208,v6,4,v208
v_lshrrev_b32 v6,5,v0
v_add_u32 v6,2,v6
v_bfe_u32 v7,v0,4,1
v_lshlrev_b32 v209,10,v7
v_lshl_add_u32 v209,v6,8,v209
v_and_b32 v6,15,v0
v_lshl_add_u32 v209,v6,4,v209
v_min_u32 v2,11,v0
s_mul_i32 s60,s46,12
v_add_u32 v2,s60,v2
v_lshlrev_b32 v2,2,v2
s_and_b32 s60,s46,1
s_lshl_b32 s68,s48,1
s_add_u32 s68,s68,s60
s_lshr_b32 s69,s46,1
s_mul_i32 s71,s46,24576
s_mul_i32 s58,s46,491520
s_lshl_b32 s61,s48,7
s_add_u32 s58,s58,s61
s_add_u32 s71,s71,242778112
v_and_b32 v6,15,v0
v_lshlrev_b32 v204,3,v6
s_lshl_b32 s60,s69,4
v_add_u32 v6,s60,v6
v_mul_u32_u24 v205,1280,v6
v_bfe_u32 v6,v0,4,1
v_lshl_add_u32 v205,v6,5,v205
v_lshrrev_b32 v6,5,v0
v_lshl_add_u32 v205,v6,4,v205
s_lshl_b32 s60,s68,6
v_add_u32 v205,s60,v205
s_mov_b32 s76,s40
s_mov_b32 s77,s41
s_mov_b32 s78,2621440
s_mov_b32 s79,0x20000
s_lshl_b32 s70,s68,1
s_add_u32 s70,s70,s69
s_lshl_b32 s70,s70,10
v_bfe_u32 v6,v0,4,1
v_lshlrev_b32 v206,14,v6
v_lshrrev_b32 v6,5,v0
v_lshl_add_u32 v206,v6,8,v206
v_and_b32 v6,15,v0
v_lshl_add_u32 v206,v6,4,v206
s_lshl_b32 s60,s46,11
v_add_u32 v206,s60,v206
s_lshl_b32 s60,s46,13
v_add_u32 v207,s60,v1
s_waitcnt vmcnt(0)
s_barrier
s_cmp_lg_u32 s46,0
s_cbranch_scc1 arr_314
v_mov_b32 v6,1
s_lshl_b32 s3,s49,2
v_mov_b32 v7,s3
s_mov_b64 exec,1
buffer_atomic_add v6,v7,s[12:15],0 offen sc1
s_mov_b64 exec,-1
arr_314:
s_lshl_b32 s3,s49,2
v_mov_b32 v7,s3
s_nop 1
ibw_315:
buffer_load_dword v6,v7,s[12:15],0 offen sc1
s_waitcnt vmcnt(0)
v_cmp_ne_u32 vcc,256,v6
s_nop 0
s_cbranch_vccz ok_316
s_sleep 8
s_sub_u32 s47,s47,1
s_cbranch_scc1 ABORT
s_branch ibw_315
ok_316:
s_cmp_lg_u32 s49,0
s_cbranch_scc1 ibok_317
v_and_b32 v7,7,v0
v_lshlrev_b32 v7,2,v7
buffer_load_dword v6,v7,s[12:15],0 offen offset:32 sc1
s_waitcnt vmcnt(0)
v_cmp_ne_u32 vcc,32,v6
s_nop 0
s_cbranch_vccz ibok_317
s_barrier
s_mov_b32 s49,1
s_mov_b32 s3,s2
s_load_dwordx16 s[16:31],s[0:1],0
s_load_dwordx8 s[32:39],s[0:1],64
s_waitcnt lgkmcnt(0)
s_branch DISPATCH
ibok_317:
s_mul_i32 s63,s46,40960
s_mov_b32 s4,s38
s_mov_b32 s5,s39
s_mov_b32 s6,1966080
s_mov_b32 s7,0x20000
v_lshrrev_b32 v9,3,v0
s_mov_b32 s64,1280
v_mul_lo_u32 v9,v9,s64
v_and_b32 v10,7,v0
v_lshl_add_u32 v6,v10,4,v9
s_add_u32 m0,s63,0
s_add_u32 s65,s58,0
buffer_load_dwordx4 v6,s[4:7],s65 offen lds
s_add_u32 m0,s63,1024
s_add_u32 s65,s58,10240
buffer_load_dwordx4 v6,s[4:7],s65 offen lds
s_add_u32 m0,s63,2048
s_add_u32 s65,s58,20480
buffer_load_dwordx4 v6,s[4:7],s65 offen lds
s_add_u32 m0,s63,3072
s_add_u32 s65,s58,30720
buffer_load_dwordx4 v6,s[4:7],s65 offen lds
s_add_u32 m0,s63,4096
s_add_u32 s65,s58,40960
buffer_load_dwordx4 v6,s[4:7],s65 offen lds
s_add_u32 m0,s63,5120
s_add_u32 s65,s58,51200
buffer_load_dwordx4 v6,s[4:7],s65 offen lds
s_add_u32 m0,s63,6144
s_add_u32 s65,s58,61440
buffer_load_dwordx4 v6,s[4:7],s65 offen lds
s_add_u32 m0,s63,7168
s_add_u32 s65,s58,71680
buffer_load_dwordx4 v6,s[4:7],s65 offen lds
s_add_u32 m0,s63,8192
s_add_u32 s65,s58,81920
buffer_load_dwordx4 v6,s[4:7],s65 offen lds
s_add_u32 m0,s63,9216
s_add_u32 s65,s58,92160
buffer_load_dwordx4 v6,s[4:7],s65 offen lds
s_add_u32 m0,s63,10240
s_add_u32 s65,s58,102400
buffer_load_dwordx4 v6,s[4:7],s65 offen lds
s_add_u32 m0,s63,11264
s_add_u32 s65,s58,112640
buffer_load_dwordx4 v6,s[4:7],s65 offen lds
s_add_u32 m0,s63,12288
s_add_u32 s65,s58,122880
buffer_load_dwordx4 v6,s[4:7],s65 offen lds
s_add_u32 m0,s63,13312
s_add_u32 s65,s58,133120
buffer_load_dwordx4 v6,s[4:7],s65 offen lds
s_add_u32 m0,s63,14336
s_add_u32 s65,s58,143360
buffer_load_dwordx4 v6,s[4:7],s65 offen lds
s_add_u32 m0,s63,15360
s_add_u32 s65,s58,153600
buffer_load_dwordx4 v6,s[4:7],s65 offen lds
s_add_u32 m0,s63,16384
s_add_u32 s65,s58,163840
buffer_load_dwordx4 v6,s[4:7],s65 offen lds
s_add_u32 m0,s63,17408
s_add_u32 s65,s58,174080
buffer_load_dwordx4 v6,s[4:7],s65 offen lds
s_add_u32 m0,s63,18432
s_add_u32 s65,s58,184320
buffer_load_dwordx4 v6,s[4:7],s65 offen lds
s_add_u32 m0,s63,19456
s_add_u32 s65,s58,194560
buffer_load_dwordx4 v6,s[4:7],s65 offen lds
s_add_u32 m0,s63,20480
s_add_u32 s65,s58,204800
buffer_load_dwordx4 v6,s[4:7],s65 offen lds
s_add_u32 m0,s63,21504
s_add_u32 s65,s58,215040
buffer_load_dwordx4 v6,s[4:7],s65 offen lds
s_add_u32 m0,s63,22528
s_add_u32 s65,s58,225280
buffer_load_dwordx4 v6,s[4:7],s65 offen lds
s_add_u32 m0,s63,23552
s_add_u32 s65,s58,235520
buffer_load_dwordx4 v6,s[4:7],s65 offen lds
s_add_u32 m0,s63,24576
s_add_u32 s65,s58,245760
buffer_load_dwordx4 v6,s[4:7],s65 offen lds
s_add_u32 m0,s63,25600
s_add_u32 s65,s58,256000
buffer_load_dwordx4 v6,s[4:7],s65 offen lds
s_add_u32 m0,s63,26624
s_add_u32 s65,s58,266240
buffer_load_dwordx4 v6,s[4:7],s65 offen lds
s_add_u32 m0,s63,27648
s_add_u32 s65,s58,276480
buffer_load_dwordx4 v6,s[4:7],s65 offen lds
s_add_u32 m0,s63,28672
s_add_u32 s65,s58,286720
buffer_load_dwordx4 v6,s[4:7],s65 offen lds
s_add_u32 m0,s63,29696
s_add_u32 s65,s58,296960
buffer_load_dwordx4 v6,s[4:7],s65 offen lds
s_add_u32 m0,s63,30720
s_add_u32 s65,s58,307200
buffer_load_dwordx4 v6,s[4:7],s65 offen lds
s_add_u32 m0,s63,31744
s_add_u32 s65,s58,317440
buffer_load_dwordx4 v6,s[4:7],s65 offen lds
s_add_u32 m0,s63,32768
s_add_u32 s65,s58,327680
buffer_load_dwordx4 v6,s[4:7],s65 offen lds
s_add_u32 m0,s63,33792
s_add_u32 s65,s58,337920
buffer_load_dwordx4 v6,s[4:7],s65 offen lds
s_add_u32 m0,s63,34816
s_add_u32 s65,s58,348160
buffer_load_dwordx4 v6,s[4:7],s65 offen lds
s_add_u32 m0,s63,35840
s_add_u32 s65,s58,358400
buffer_load_dwordx4 v6,s[4:7],s65 offen lds
s_add_u32 m0,s63,36864
s_add_u32 s65,s58,368640
buffer_load_dwordx4 v6,s[4:7],s65 offen lds
s_add_u32 m0,s63,37888
s_add_u32 s65,s58,378880
buffer_load_dwordx4 v6,s[4:7],s65 offen lds
s_add_u32 m0,s63,38912
s_add_u32 s65,s58,389120
buffer_load_dwordx4 v6,s[4:7],s65 offen lds
s_add_u32 m0,s63,39936
s_add_u32 s65,s58,399360
buffer_load_dwordx4 v6,s[4:7],s65 offen lds
s_waitcnt vmcnt(20)
v_bfe_u32 v9,v0,2,2
v_lshrrev_b32 v10,5,v0
v_lshl_add_u32 v9,v10,2,v9
v_mul_u32_u24 v9,128,v9
v_and_b32 v10,1,v0
v_lshl_add_u32 v9,v10,3,v9
v_bfe_u32 v10,v0,1,1
v_lshl_add_u32 v9,v10,5,v9
v_bfe_u32 v10,v0,4,1
v_lshl_add_u32 v9,v10,4,v9
v_add_u32 v7,s63,v9
ds_read_b64_tr_b16 a[0:1],v7 offset:0
ds_read_b64_tr_b16 a[2:3],v7 offset:2048
ds_read_b64_tr_b16 a[4:5],v7 offset:1024
ds_read_b64_tr_b16 a[6:7],v7 offset:3072
ds_read_b64_tr_b16 a[96:97],v7 offset:64
ds_read_b64_tr_b16 a[98:99],v7 offset:2112
ds_read_b64_tr_b16 a[100:101],v7 offset:1088
ds_read_b64_tr_b16 a[102:103],v7 offset:3136
ds_read_b64_tr_b16 a[8:9],v7 offset:4096
ds_read_b64_tr_b16 a[10:11],v7 offset:6144
ds_read_b64_tr_b16 a[12:13],v7 offset:5120
ds_read_b64_tr_b16 a[14:15],v7 offset:7168
s_waitcnt lgkmcnt(4)
ds_read_b64_tr_b16 a[104:105],v7 offset:4160
ds_read_b64_tr_b16 a[106:107],v7 offset:6208
ds_read_b64_tr_b16 a[108:109],v7 offset:5184
ds_read_b64_tr_b16 a[110:111],v7 offset:7232
ds_read_b64_tr_b16 a[16:17],v7 offset:8192
ds_read_b64_tr_b16 a[18:19],v7 offset:10240
ds_read_b64_tr_b16 a[20:21],v7 offset:9216
ds_read_b64_tr_b16 a[22:23],v7 offset:11264
ds_read_b64_tr_b16 a[112:113],v7 offset:8256
ds_read_b64_tr_b16 a[114:115],v7 offset:10304
ds_read_b64_tr_b16 a[116:117],v7 offset:9280
ds_read_b64_tr_b16 a[118:119],v7 offset:11328
s_waitcnt lgkmcnt(4)
ds_read_b64_tr_b16 a[24:25],v7 offset:12288
ds_read_b64_tr_b16 a[26:27],v7 offset:14336
ds_read_b64_tr_b16 a[28:29],v7 offset:13312
ds_read_b64_tr_b16 a[30:31],v7 offset:15360
ds_read_b64_tr_b16 a[120:121],v7 offset:12352
ds_read_b64_tr_b16 a[122:123],v7 offset:14400
ds_read_b64_tr_b16 a[124:125],v7 offset:13376
ds_read_b64_tr_b16 a[126:127],v7 offset:15424
ds_read_b64_tr_b16 a[32:33],v7 offset:16384
ds_read_b64_tr_b16 a[34:35],v7 offset:18432
ds_read_b64_tr_b16 a[36:37],v7 offset:17408
ds_read_b64_tr_b16 a[38:39],v7 offset:19456
s_waitcnt lgkmcnt(4)
ds_read_b64_tr_b16 a[128:129],v7 offset:16448
ds_read_b64_tr_b16 a[130:131],v7 offset:18496
ds_read_b64_tr_b16 a[132:133],v7 offset:17472
ds_read_b64_tr_b16 a[134:135],v7 offset:19520
s_waitcnt lgkmcnt(0)
s_add_u32 m0,s63,0
s_add_u32 s65,s58,409600
buffer_load_dwordx4 v6,s[4:7],s65 offen lds
s_add_u32 m0,s63,1024
s_add_u32 s65,s58,419840
buffer_load_dwordx4 v6,s[4:7],s65 offen lds
s_add_u32 m0,s63,2048
s_add_u32 s65,s58,430080
buffer_load_dwordx4 v6,s[4:7],s65 offen lds
s_add_u32 m0,s63,3072
s_add_u32 s65,s58,440320
buffer_load_dwordx4 v6,s[4:7],s65 offen lds
s_add_u32 m0,s63,4096
s_add_u32 s65,s58,450560
buffer_load_dwordx4 v6,s[4:7],s65 offen lds
s_add_u32 m0,s63,5120
s_add_u32 s65,s58,460800
buffer_load_dwordx4 v6,s[4:7],s65 offen lds
s_add_u32 m0,s63,6144
s_add_u32 s65,s58,471040
buffer_load_dwordx4 v6,s[4:7],s65 offen lds
s_add_u32 m0,s63,7168
s_add_u32 s65,s58,481280
buffer_load_dwordx4 v6,s[4:7],s65 offen lds
s_waitcnt vmcnt(8)
v_bfe_u32 v9,v0,2,2
v_lshrrev_b32 v10,5,v0
v_lshl_add_u32 v9,v10,2,v9
v_mul_u32_u24 v9,128,v9
v_and_b32 v10,1,v0
v_lshl_add_u32 v9,v10,3,v9
v_bfe_u32 v10,v0,1,1
v_lshl_add_u32 v9,v10,5,v9
v_bfe_u32 v10,v0,4,1
v_lshl_add_u32 v9,v10,4,v9
v_add_u32 v7,s63,v9
ds_read_b64_tr_b16 a[40:41],v7 offset:20480
ds_read_b64_tr_b16 a[42:43],v7 offset:22528
ds_read_b64_tr_b16 a[44:45],v7 offset:21504
ds_read_b64_tr_b16 a[46:47],v7 offset:23552
ds_read_b64_tr_b16 a[136:137],v7 offset:20544
ds_read_b64_tr_b16 a[138:139],v7 offset:22592
ds_read_b64_tr_b16 a[140:141],v7 offset:21568
ds_read_b64_tr_b16 a[142:143],v7 offset:23616
ds_read_b64_tr_b16 a[48:49],v7 offset:24576
ds_read_b64_tr_b16 a[50:51],v7 offset:26624
ds_read_b64_tr_b16 a[52:53],v7 offset:25600
ds_read_b64_tr_b16 a[54:55],v7 offset:27648
s_waitcnt lgkmcnt(4)
ds_read_b64_tr_b16 a[144:145],v7 offset:24640
ds_read_b64_tr_b16 a[146:147],v7 offset:26688
ds_read_b64_tr_b16 a[148:149],v7 offset:25664
ds_read_b64_tr_b16 a[150:151],v7 offset:27712
ds_read_b64_tr_b16 a[56:57],v7 offset:28672
ds_read_b64_tr_b16 a[58:59],v7 offset:30720
ds_read_b64_tr_b16 a[60:61],v7 offset:29696
ds_read_b64_tr_b16 a[62:63],v7 offset:31744
ds_read_b64_tr_b16 a[152:153],v7 offset:28736
ds_read_b64_tr_b16 a[154:155],v7 offset:30784
ds_read_b64_tr_b16 a[156:157],v7 offset:29760
ds_read_b64_tr_b16 a[158:159],v7 offset:31808
s_waitcnt lgkmcnt(4)
ds_read_b64_tr_b16 a[64:65],v7 offset:32768
ds_read_b64_tr_b16 a[66:67],v7 offset:34816
ds_read_b64_tr_b16 a[68:69],v7 offset:33792
ds_read_b64_tr_b16 a[70:71],v7 offset:35840
ds_read_b64_tr_b16 a[160:161],v7 offset:32832
ds_read_b64_tr_b16 a[162:163],v7 offset:34880
ds_read_b64_tr_b16 a[164:165],v7 offset:33856
ds_read_b64_tr_b16 a[166:167],v7 offset:35904
ds_read_b64_tr_b16 a[72:73],v7 offset:36864
ds_read_b64_tr_b16 a[74:75],v7 offset:38912
ds_read_b64_tr_b16 a[76:77],v7 offset:37888
ds_read_b64_tr_b16 a[78:79],v7 offset:39936
s_waitcnt lgkmcnt(4)
ds_read_b64_tr_b16 a[168:169],v7 offset:36928
ds_read_b64_tr_b16 a[170:171],v7 offset:38976
ds_read_b64_tr_b16 a[172:173],v7 offset:37952
ds_read_b64_tr_b16 a[174:175],v7 offset:40000
s_waitcnt lgkmcnt(0)
s_waitcnt vmcnt(0)
v_bfe_u32 v9,v0,2,2
v_lshrrev_b32 v10,5,v0
v_lshl_add_u32 v9,v10,2,v9
v_mul_u32_u24 v9,128,v9
v_and_b32 v10,1,v0
v_lshl_add_u32 v9,v10,3,v9
v_bfe_u32 v10,v0,1,1
v_lshl_add_u32 v9,v10,5,v9
v_bfe_u32 v10,v0,4,1
v_lshl_add_u32 v9,v10,4,v9
v_add_u32 v7,s63,v9
ds_read_b64_tr_b16 a[80:81],v7 offset:0
ds_read_b64_tr_b16 a[82:83],v7 offset:2048
ds_read_b64_tr_b16 a[84:85],v7 offset:1024
ds_read_b64_tr_b16 a[86:87],v7 offset:3072
ds_read_b64_tr_b16 a[176:177],v7 offset:64
ds_read_b64_tr_b16 a[178:179],v7 offset:2112
ds_read_b64_tr_b16 a[180:181],v7 offset:1088
ds_read_b64_tr_b16 a[182:183],v7 offset:3136
ds_read_b64_tr_b16 a[88:89],v7 offset:4096
ds_read_b64_tr_b16 a[90:91],v7 offset:6144
ds_read_b64_tr_b16 a[92:93],v7 offset:5120
ds_read_b64_tr_b16 a[94:95],v7 offset:7168
s_waitcnt lgkmcnt(4)
ds_read_b64_tr_b16 a[184:185],v7 offset:4160
ds_read_b64_tr_b16 a[186:187],v7 offset:6208
ds_read_b64_tr_b16 a[188:189],v7 offset:5184
ds_read_b64_tr_b16 a[190:191],v7 offset:7232
s_waitcnt lgkmcnt(0)
s_barrier
s_mov_b32 s83,s100
s_mov_b32 s32,0
s_mov_b32 s59,2147483648
s_min_u32 s62,s32,127
s_sub_u32 s60,s62,18
s_lshr_b32 s34,s60,1
s_and_b32 s33,s60,1
s_cmp_eq_u32 s33,0
s_cselect_b32 s61,18,0
s_add_u32 s34,s34,s61
s_sub_u32 s61,s60,46
s_cmp_ge_u32 s60,92
s_cselect_b32 s34,s61,s34
s_cselect_b32 s33,1,s33
s_cmp_lt_u32 s62,18
s_cselect_b32 s34,s62,s34
s_cselect_b32 s33,0,s33
s_lshl_b32 s35,s33,6
s_add_u32 s35,s35,s34
s_lshl_b32 s35,s35,9
s_add_u32 s35,s35,589824
s_and_b32 s60,s34,3
s_lshl2_add_u32 s60,s33,s60
s_mul_i32 s73,s60,98304
s_add_u32 s73,s73,s71
s_add_u32 s62,s32,1
s_min_u32 s62,s62,127
s_sub_u32 s60,s62,18
s_lshr_b32 s29,s60,1
s_and_b32 s28,s60,1
s_cmp_eq_u32 s28,0
s_cselect_b32 s61,18,0
s_add_u32 s29,s29,s61
s_sub_u32 s61,s60,46
s_cmp_ge_u32 s60,92
s_cselect_b32 s29,s61,s29
s_cselect_b32 s28,1,s28
s_cmp_lt_u32 s62,18
s_cselect_b32 s29,s62,s29
s_cselect_b32 s28,0,s28
s_lshl_b32 s30,s28,6
s_add_u32 s30,s30,s29
s_lshl_b32 s30,s30,9
s_add_u32 s30,s30,589824
s_and_b32 s60,s29,3
s_lshl2_add_u32 s60,s28,s60
s_mul_i32 s31,s60,98304
s_add_u32 s31,s31,s71
W4_COLD:
buffer_load_dword v3,v2,s[8:11],s35 offen sc1
s_waitcnt vmcnt(1)
s_mov_b64 exec,1
buffer_store_dword v5,v1,s[8:11],s59 offen sc1
s_mov_b64 exec,-1
s_mov_b32 s59,2147483648
s_cmp_ge_u32 s32,128
s_cbranch_scc1 W4_END
s_waitcnt vmcnt(1)
v_cmp_eq_u32 vcc,0,v3
s_nop 0
s_cbranch_vccz W4_RDY
fb_318:
buffer_load_dword v3,v2,s[8:11],s35 offen sc1
s_waitcnt vmcnt(0)
v_cmp_eq_u32 vcc,0,v3
s_nop 0
s_cbranch_vccz ok_319
s_sleep 1
s_sub_u32 s47,s47,1
s_cbranch_scc1 ABORT
s_branch fb_318
ok_319:
W4_RDY:
s_add_u32 s63,s73,0
buffer_load_dwordx4 v[16:19],v1,s[8:11],s63 offen sc1
s_nop 7
buffer_load_dwordx4 v[20:23],v1,s[8:11],s63 offen offset:1024 sc1
s_nop 7
buffer_load_dwordx4 v[24:27],v1,s[8:11],s63 offen offset:2048 sc1
s_nop 7
buffer_load_dwordx4 v[28:31],v1,s[8:11],s63 offen offset:3072 sc1
s_nop 7
s_add_u32 s63,s73,4096
buffer_load_dwordx4 v[32:35],v1,s[8:11],s63 offen sc1
s_nop 7
buffer_load_dwordx4 v[36:39],v1,s[8:11],s63 offen offset:1024 sc1
s_nop 7
buffer_load_dwordx4 v[40:43],v1,s[8:11],s63 offen offset:2048 sc1
s_nop 7
buffer_load_dwordx4 v[44:47],v1,s[8:11],s63 offen offset:3072 sc1
W4_C:
s_mov_b32 s51,s33
s_mov_b32 s52,s34
s_mov_b32 s72,s73
s_add_u32 s32,s32,1
s_mov_b32 s33,s28
s_mov_b32 s34,s29
s_mov_b32 s35,s30
s_mov_b32 s73,s31
s_waitcnt vmcnt(7)
v_mfma_f32_32x32x16_bf16 v[112:127],a[0:3],v[16:19],0
s_add_u32 s63,s72,8192
buffer_load_dwordx4 v[48:51],v1,s[8:11],s63 offen sc1
v_xor_b32 v206,0x8000,v206
v_xor_b32 v207,0x8000,v207
s_lshl_b32 s64,s51,6
v_mfma_f32_32x32x16_bf16 v[128:143],a[96:99],v[16:19],0
s_add_u32 s64,s64,s52
s_and_b32 s65,s52,7
s_lshl3_add_u32 s65,s51,s65
s_mul_i32 s65,s65,46080
s_add_u32 s65,s65,s70
s_add_u32 s65,s65,212467712
s_waitcnt vmcnt(7)
v_mfma_f32_32x32x16_bf16 v[112:127],a[4:7],v[20:23],v[112:127]
buffer_load_dwordx4 v[52:55],v1,s[8:11],s63 offen offset:1024 sc1
buffer_load_dwordx4 v[176:179],v1,s[8:11],s65 offen sc1
s_mul_i32 s65,s64,40960
s_add_u32 s65,s65,s70
v_mfma_f32_32x32x16_bf16 v[128:143],a[100:103],v[20:23],v[128:143]
s_add_u32 s65,s65,218365952
s_mov_b32 s43,s65
s_lshl_b32 s82,s64,9
s_lshl2_add_u32 s82,s56,s82
s_add_u32 s42,s82,32768
s_add_u32 s82,s82,327680
s_waitcnt vmcnt(8)
v_mfma_f32_32x32x16_bf16 v[112:127],a[8:11],v[24:27],v[112:127]
buffer_load_dwordx4 v[56:59],v1,s[8:11],s63 offen offset:2048 sc1
s_mul_i32 s41,s52,46080
s_add_u32 s41,s41,209518592
s_add_u32 s40,s41,s70
s_lshr_b32 s64,s70,3
v_mfma_f32_32x32x16_bf16 v[128:143],a[104:107],v[24:27],v[128:143]
s_add_u32 s41,s41,s64
s_add_u32 s41,s41,40960
s_mul_i32 s64,s52,40960
s_cmp_lg_u32 s51,0
s_cselect_b32 s40,s64,s40
s_cselect_b32 s42,2147483648,s42
s_waitcnt vmcnt(8)
v_mfma_f32_32x32x16_bf16 v[112:127],a[12:15],v[28:31],v[112:127]
buffer_load_dwordx4 v[60:63],v1,s[8:11],s63 offen offset:3072 sc1
s_add_u32 s63,s72,12288
s_add_u32 s62,s32,1
s_min_u32 s62,s62,127
s_sub_u32 s60,s62,18
v_mfma_f32_32x32x16_bf16 v[128:143],a[108:111],v[28:31],v[128:143]
s_lshr_b32 s29,s60,1
s_and_b32 s28,s60,1
s_cmp_eq_u32 s28,0
s_cselect_b32 s61,18,0
s_add_u32 s29,s29,s61
s_sub_u32 s61,s60,46
s_waitcnt vmcnt(8)
v_mfma_f32_32x32x16_bf16 v[112:127],a[16:19],v[32:35],v[112:127]
buffer_load_dwordx4 v[64:67],v1,s[8:11],s63 offen sc1
s_cmp_ge_u32 s60,92
s_cselect_b32 s29,s61,s29
s_cselect_b32 s28,1,s28
v_mfma_f32_32x32x16_bf16 v[128:143],a[112:115],v[32:35],v[128:143]
s_cmp_lt_u32 s62,18
s_cselect_b32 s29,s62,s29
s_cselect_b32 s28,0,s28
s_lshl_b32 s30,s28,6
s_add_u32 s30,s30,s29
s_lshl_b32 s30,s30,9
s_waitcnt vmcnt(8)
v_mfma_f32_32x32x16_bf16 v[112:127],a[20:23],v[36:39],v[112:127]
buffer_load_dwordx4 v[68:71],v1,s[8:11],s63 offen offset:1024 sc1
s_add_u32 s30,s30,589824
s_and_b32 s60,s29,3
s_lshl2_add_u32 s60,s28,s60
s_mul_i32 s31,s60,98304
v_mfma_f32_32x32x16_bf16 v[128:143],a[116:119],v[36:39],v[128:143]
s_add_u32 s31,s31,s71
s_waitcnt vmcnt(8)
v_mfma_f32_32x32x16_bf16 v[112:127],a[24:27],v[40:43],v[112:127]
buffer_load_dwordx4 v[72:75],v1,s[8:11],s63 offen offset:2048 sc1
v_mfma_f32_32x32x16_bf16 v[128:143],a[120:123],v[40:43],v[128:143]
s_waitcnt vmcnt(8)
v_mfma_f32_32x32x16_bf16 v[112:127],a[28:31],v[44:47],v[112:127]
buffer_load_dwordx4 v[76:79],v1,s[8:11],s63 offen offset:3072 sc1
s_add_u32 s63,s72,16384
v_mfma_f32_32x32x16_bf16 v[128:143],a[124:127],v[44:47],v[128:143]
s_waitcnt vmcnt(8)
v_mfma_f32_32x32x16_bf16 v[112:127],a[32:35],v[48:51],v[112:127]
buffer_load_dwordx4 v[80:83],v1,s[8:11],s63 offen sc1
s_mov_b64 exec,1
buffer_store_dword v5,v1,s[8:11],s59 offen sc1
s_mov_b64 exec,-1
s_mov_b32 s59,2147483648
v_mfma_f32_32x32x16_bf16 v[128:143],a[128:131],v[48:51],v[128:143]
buffer_load_dword v3,v2,s[8:11],s35 offen sc1
s_waitcnt vmcnt(10)
v_mfma_f32_32x32x16_bf16 v[112:127],a[36:39],v[52:55],v[112:127]
buffer_load_dwordx4 v[84:87],v1,s[8:11],s63 offen offset:1024 sc1
v_mfma_f32_32x32x16_bf16 v[128:143],a[132:135],v[52:55],v[128:143]
s_waitcnt vmcnt(9)
v_mfma_f32_32x32x16_bf16 v[112:127],a[40:43],v[56:59],v[112:127]
buffer_load_dwordx4 v[88:91],v1,s[8:11],s63 offen offset:2048 sc1
v_mfma_f32_32x32x16_bf16 v[128:143],a[136:139],v[56:59],v[128:143]
s_waitcnt vmcnt(9)
v_mfma_f32_32x32x16_bf16 v[112:127],a[44:47],v[60:63],v[112:127]
buffer_load_dwordx4 v[92:95],v1,s[8:11],s63 offen offset:3072 sc1
s_add_u32 s63,s72,20480
v_mfma_f32_32x32x16_bf16 v[128:143],a[140:143],v[60:63],v[128:143]
s_waitcnt vmcnt(9)
v_mfma_f32_32x32x16_bf16 v[112:127],a[48:51],v[64:67],v[112:127]
buffer_load_dwordx4 v[96:99],v1,s[8:11],s63 offen sc1
v_mfma_f32_32x32x16_bf16 v[128:143],a[144:147],v[64:67],v[128:143]
s_waitcnt vmcnt(9)
v_mfma_f32_32x32x16_bf16 v[112:127],a[52:55],v[68:71],v[112:127]
buffer_load_dwordx4 v[100:103],v1,s[8:11],s63 offen offset:1024 sc1
v_mfma_f32_32x32x16_bf16 v[128:143],a[148:151],v[68:71],v[128:143]
s_waitcnt vmcnt(9)
v_mfma_f32_32x32x16_bf16 v[112:127],a[56:59],v[72:75],v[112:127]
buffer_load_dwordx4 v[104:107],v1,s[8:11],s63 offen offset:2048 sc1
v_mfma_f32_32x32x16_bf16 v[128:143],a[152:155],v[72:75],v[128:143]
s_waitcnt vmcnt(6)
v_cmp_eq_u32 vcc,0,v3
s_cmp_eq_u64 vcc,0
s_cselect_b32 s37,0,2147483648
s_cmp_lt_u32 s32,128
s_cselect_b32 s37,s37,2147483648
v_mfma_f32_32x32x16_bf16 v[112:127],a[60:63],v[76:79],v[112:127]
buffer_load_dwordx4 v[108:111],v1,s[8:11],s63 offen offset:3072 sc1
buffer_load_dwordx4 v[180:183],v15,s[8:11],s43 offen sc1
s_cmp_eq_u32 s37,0
v_mfma_f32_32x32x16_bf16 v[128:143],a[156:159],v[76:79],v[128:143]
s_cbranch_scc0 no_320
v_mfma_f32_32x32x16_bf16 v[112:127],a[64:67],v[80:83],v[112:127]
s_add_u32 s63,s73,0
buffer_load_dwordx4 v[16:19],v1,s[8:11],s63 offen sc1
v_mfma_f32_32x32x16_bf16 v[128:143],a[160:163],v[80:83],v[128:143]
s_waitcnt vmcnt(8)
v_mfma_f32_32x32x16_bf16 v[112:127],a[68:71],v[84:87],v[112:127]
buffer_load_dwordx4 v[20:23],v1,s[8:11],s63 offen offset:1024 sc1
v_mfma_f32_32x32x16_bf16 v[128:143],a[164:167],v[84:87],v[128:143]
s_waitcnt vmcnt(8)
v_mfma_f32_32x32x16_bf16 v[112:127],a[72:75],v[88:91],v[112:127]
buffer_load_dwordx4 v[24:27],v1,s[8:11],s63 offen offset:2048 sc1
v_mfma_f32_32x32x16_bf16 v[128:143],a[168:171],v[88:91],v[128:143]
v_lshlrev_b32 v184,16,v176
v_and_b32 v185,0xffff0000,v176
v_lshlrev_b32 v186,16,v177
v_and_b32 v187,0xffff0000,v177
v_lshlrev_b32 v188,16,v178
s_waitcnt vmcnt(8)
v_mfma_f32_32x32x16_bf16 v[112:127],a[76:79],v[92:95],v[112:127]
buffer_load_dwordx4 v[28:31],v1,s[8:11],s63 offen offset:3072 sc1
s_add_u32 s63,s73,4096
v_and_b32 v189,0xffff0000,v178
v_lshlrev_b32 v190,16,v179
v_and_b32 v191,0xffff0000,v179
v_mfma_f32_32x32x16_bf16 v[128:143],a[172:175],v[92:95],v[128:143]
s_waitcnt vmcnt(8)
v_mfma_f32_32x32x16_bf16 v[112:127],a[80:83],v[96:99],v[112:127]
buffer_load_dwordx4 v[32:35],v1,s[8:11],s63 offen sc1
s_waitcnt vmcnt(8)
v_mfma_f32_32x32x16_bf16 v[112:127],a[84:87],v[100:103],v[112:127]
s_waitcnt vmcnt(7)
v_mfma_f32_32x32x16_bf16 v[112:127],a[88:91],v[104:107],v[112:127]
buffer_load_dwordx4 v[36:39],v1,s[8:11],s63 offen offset:1024 sc1
s_waitcnt vmcnt(7)
v_mfma_f32_32x32x16_bf16 v[112:127],a[92:95],v[108:111],v[112:127]
v_mfma_f32_32x32x16_bf16 v[128:143],a[176:179],v[96:99],v[128:143]
buffer_load_dwordx4 v[40:43],v1,s[8:11],s63 offen offset:2048 sc1
s_mov_b64 exec,1
s_cmp_lg_u32 s49,0
s_cbranch_scc0 ls_321
buffer_store_dword v5,v1,s[8:11],s82 offen sc1
s_branch ls_322
ls_321:
buffer_store_dword v5,v1,s[8:11],s82 offen
ls_322:
s_mov_b64 exec,-1
v_mfma_f32_32x32x16_bf16 v[128:143],a[180:183],v[100:103],v[128:143]
ds_write_b128 v206,v[112:115] offset:0
ds_write_b128 v206,v[116:119] offset:1024
ds_write_b128 v206,v[120:123] offset:512
v_mfma_f32_32x32x16_bf16 v[128:143],a[184:187],v[104:107],v[128:143]
buffer_load_dwordx4 v[44:47],v1,s[8:11],s63 offen offset:3072 sc1
ds_write_b128 v206,v[124:127] offset:1536
v_mfma_f32_32x32x16_bf16 v[128:143],a[188:191],v[108:111],v[128:143]
buffer_load_dword v3,v2,s[8:11],s30 offen sc1
s_nop 5
s_branch W4_E1
no_320:
v_mfma_f32_32x32x16_bf16 v[112:127],a[64:67],v[80:83],v[112:127]
v_mfma_f32_32x32x16_bf16 v[128:143],a[160:163],v[80:83],v[128:143]
s_waitcnt vmcnt(7)
v_mfma_f32_32x32x16_bf16 v[112:127],a[68:71],v[84:87],v[112:127]
v_mfma_f32_32x32x16_bf16 v[128:143],a[164:167],v[84:87],v[128:143]
s_waitcnt vmcnt(6)
v_mfma_f32_32x32x16_bf16 v[112:127],a[72:75],v[88:91],v[112:127]
v_mfma_f32_32x32x16_bf16 v[128:143],a[168:171],v[88:91],v[128:143]
v_lshlrev_b32 v184,16,v176
v_and_b32 v185,0xffff0000,v176
v_lshlrev_b32 v186,16,v177
v_and_b32 v187,0xffff0000,v177
v_lshlrev_b32 v188,16,v178
s_waitcnt vmcnt(5)
v_mfma_f32_32x32x16_bf16 v[112:127],a[76:79],v[92:95],v[112:127]
buffer_load_dword v3,v2,s[8:11],s35 offen sc1
v_and_b32 v189,0xffff0000,v178
v_lshlrev_b32 v190,16,v179
v_and_b32 v191,0xffff0000,v179
v_mfma_f32_32x32x16_bf16 v[128:143],a[172:175],v[92:95],v[128:143]
s_waitcnt vmcnt(5)
v_mfma_f32_32x32x16_bf16 v[112:127],a[80:83],v[96:99],v[112:127]
s_waitcnt vmcnt(4)
v_mfma_f32_32x32x16_bf16 v[112:127],a[84:87],v[100:103],v[112:127]
s_waitcnt vmcnt(3)
v_mfma_f32_32x32x16_bf16 v[112:127],a[88:91],v[104:107],v[112:127]
s_waitcnt vmcnt(2)
v_mfma_f32_32x32x16_bf16 v[112:127],a[92:95],v[108:111],v[112:127]
v_mfma_f32_32x32x16_bf16 v[128:143],a[176:179],v[96:99],v[128:143]
s_mov_b64 exec,1
s_cmp_lg_u32 s49,0
s_cbranch_scc0 ls_323
buffer_store_dword v5,v1,s[8:11],s82 offen sc1
s_branch ls_324
ls_323:
buffer_store_dword v5,v1,s[8:11],s82 offen
ls_324:
s_mov_b64 exec,-1
v_mfma_f32_32x32x16_bf16 v[128:143],a[180:183],v[100:103],v[128:143]
ds_write_b128 v206,v[112:115] offset:0
ds_write_b128 v206,v[116:119] offset:1024
ds_write_b128 v206,v[120:123] offset:512
v_mfma_f32_32x32x16_bf16 v[128:143],a[184:187],v[104:107],v[128:143]
ds_write_b128 v206,v[124:127] offset:1536
v_mfma_f32_32x32x16_bf16 v[128:143],a[188:191],v[108:111],v[128:143]
s_waitcnt vmcnt(1)
v_cmp_eq_u32 vcc,0,v3
s_cmp_eq_u64 vcc,0
s_cselect_b32 s37,0,2147483648
s_cmp_lt_u32 s32,128
s_cselect_b32 s37,s37,2147483648
s_cmp_eq_u32 s37,0
s_cbranch_scc1 W4_E2
s_branch W4_E0
W4_E2:
s_add_u32 s63,s73,0
buffer_load_dwordx4 v[16:19],v1,s[8:11],s63 offen sc1
s_nop 2
ds_write_b128 v206,v[128:131] offset:8192
ds_write_b128 v206,v[132:135] offset:9216
buffer_load_dwordx4 v[20:23],v1,s[8:11],s63 offen offset:1024 sc1
ds_write_b128 v206,v[136:139] offset:8704
ds_write_b128 v206,v[140:143] offset:9728
buffer_load_dwordx4 v[24:27],v1,s[8:11],s63 offen offset:2048 sc1
s_waitcnt lgkmcnt(0)
s_barrier
ds_read_b128 v[144:147],v207 offset:0
ds_read_b128 v[148:151],v207 offset:1024
ds_read_b128 v[152:155],v207 offset:2048
ds_read_b128 v[156:159],v207 offset:3072
ds_read_b128 v[160:163],v207 offset:4096
ds_read_b128 v[164:167],v207 offset:5120
ds_read_b128 v[168:171],v207 offset:6144
ds_read_b128 v[172:175],v207 offset:7168
s_waitcnt vmcnt(43)
v_lshlrev_b32 v192,16,v180
v_and_b32 v193,0xffff0000,v180
v_lshlrev_b32 v194,16,v181
v_and_b32 v195,0xffff0000,v181
v_lshlrev_b32 v196,16,v182
v_and_b32 v197,0xffff0000,v182
v_lshlrev_b32 v198,16,v183
v_and_b32 v199,0xffff0000,v183
buffer_load_dwordx4 v[28:31],v1,s[8:11],s63 offen offset:3072 sc1
s_add_u32 s63,s73,4096
buffer_load_dwordx4 v[32:35],v1,s[8:11],s63 offen sc1
buffer_load_dwordx4 v[36:39],v1,s[8:11],s63 offen offset:1024 sc1
s_waitcnt lgkmcnt(4)
v_pk_add_f32 v[144:145],v[144:145],v[152:153]
v_pk_add_f32 v[146:147],v[146:147],v[154:155]
v_pk_add_f32 v[148:149],v[148:149],v[156:157]
v_pk_add_f32 v[150:151],v[150:151],v[158:159]
s_waitcnt lgkmcnt(0)
v_pk_add_f32 v[160:161],v[160:161],v[168:169]
v_pk_add_f32 v[162:163],v[162:163],v[170:171]
v_pk_add_f32 v[164:165],v[164:165],v[172:173]
v_pk_add_f32 v[166:167],v[166:167],v[174:175]
buffer_load_dwordx4 v[40:43],v1,s[8:11],s63 offen offset:2048 sc1
v_pk_add_f32 v[144:145],v[144:145],v[160:161]
v_pk_add_f32 v[146:147],v[146:147],v[162:163]
v_pk_add_f32 v[148:149],v[148:149],v[164:165]
v_pk_add_f32 v[150:151],v[150:151],v[166:167]
v_cvt_pk_bf16_f32 v6,v144,v145
v_lshlrev_b32 v144,16,v6
v_and_b32 v145,0xffff0000,v6
v_cvt_pk_bf16_f32 v6,v146,v147
v_lshlrev_b32 v146,16,v6
v_and_b32 v147,0xffff0000,v6
v_cvt_pk_bf16_f32 v6,v148,v149
v_lshlrev_b32 v148,16,v6
v_and_b32 v149,0xffff0000,v6
v_cvt_pk_bf16_f32 v6,v150,v151
v_lshlrev_b32 v150,16,v6
v_and_b32 v151,0xffff0000,v6
buffer_load_dwordx4 v[44:47],v1,s[8:11],s63 offen offset:3072 sc1
v_pk_add_f32 v[144:145],v[144:145],v[184:185]
v_pk_add_f32 v[146:147],v[146:147],v[186:187]
v_pk_add_f32 v[148:149],v[148:149],v[188:189]
v_pk_add_f32 v[150:151],v[150:151],v[190:191]
v_cvt_pk_bf16_f32 v6,v144,v145
v_lshlrev_b32 v144,16,v6
v_and_b32 v145,0xffff0000,v6
v_cvt_pk_bf16_f32 v6,v146,v147
v_lshlrev_b32 v146,16,v6
v_and_b32 v147,0xffff0000,v6
v_cvt_pk_bf16_f32 v6,v148,v149
v_lshlrev_b32 v148,16,v6
v_and_b32 v149,0xffff0000,v6
v_cvt_pk_bf16_f32 v6,v150,v151
v_lshlrev_b32 v150,16,v6
v_and_b32 v151,0xffff0000,v6
v_pk_add_f32 v[144:145],v[144:145],v[192:193]
v_pk_add_f32 v[146:147],v[146:147],v[194:195]
v_pk_add_f32 v[148:149],v[148:149],v[196:197]
v_pk_add_f32 v[150:151],v[150:151],v[198:199]
v_cvt_pk_bf16_f32 v200,v144,v145
v_cvt_pk_bf16_f32 v201,v146,v147
v_cvt_pk_bf16_f32 v202,v148,v149
v_cvt_pk_bf16_f32 v203,v150,v151
s_cmp_lg_u32 s51,0
s_cbranch_scc1 w4o_325
buffer_store_dwordx4 v[200:203],v15,s[8:11],s40 offen sc1
v_lshlrev_b32 v144,16,v200
v_and_b32 v145,0xffff0000,v200
v_lshlrev_b32 v146,16,v201
v_and_b32 v147,0xffff0000,v201
v_lshlrev_b32 v148,16,v202
v_and_b32 v149,0xffff0000,v202
v_lshlrev_b32 v150,16,v203
v_and_b32 v151,0xffff0000,v203
v_pk_add_f32 v[6:7],v[144:145],v[146:147]
v_pk_mul_f32 v[8:9],v[144:145],v[144:145]
v_pk_fma_f32 v[8:9],v[146:147],v[146:147],v[8:9]
v_pk_add_f32 v[6:7],v[6:7],v[148:149]
v_pk_fma_f32 v[8:9],v[148:149],v[148:149],v[8:9]
v_pk_add_f32 v[6:7],v[6:7],v[150:151]
v_pk_fma_f32 v[8:9],v[150:151],v[150:151],v[8:9]
v_add_f32 v6,v6,v7
v_add_f32 v7,v8,v9
s_nop 1
v_permlane32_swap_b32 v6,v7
v_add_f32 v6,v6,v7
v_mov_b32 v7,v6
s_nop 1
v_permlane16_swap_b32 v6,v7
v_add_f32 v6,v6,v7
v_mov_b32 v7,v6
s_nop 1
v_permlane32_swap_b32 v6,v7
s_mov_b64 exec,0xffff
buffer_store_dwordx2 v[6:7],v204,s[8:11],s41 offen sc1
s_mov_b64 exec,-1
s_branch w4n_326
w4o_325:
v_permlane16_swap_b32 v200,v202
v_permlane16_swap_b32 v201,v203
buffer_store_dwordx4 v[200:203],v205,s[76:79],s40 offen
s_mov_b64 exec,1
buffer_store_dword v5,v1,s[8:11],s42 offen
s_mov_b64 exec,-1
w4n_326:
s_mov_b32 s59,s42
s_branch W4_C
W4_E1:
s_add_u32 s63,s73,8192
buffer_load_dwordx4 v[48:51],v1,s[8:11],s63 offen sc1
s_nop 2
ds_write_b128 v206,v[128:131] offset:8192
ds_write_b128 v206,v[132:135] offset:9216
buffer_load_dwordx4 v[52:55],v1,s[8:11],s63 offen offset:1024 sc1
ds_write_b128 v206,v[136:139] offset:8704
ds_write_b128 v206,v[140:143] offset:9728
buffer_load_dwordx4 v[56:59],v1,s[8:11],s63 offen offset:2048 sc1
s_waitcnt lgkmcnt(0)
s_barrier
ds_read_b128 v[144:147],v207 offset:0
ds_read_b128 v[148:151],v207 offset:1024
ds_read_b128 v[152:155],v207 offset:2048
ds_read_b128 v[156:159],v207 offset:3072
ds_read_b128 v[160:163],v207 offset:4096
ds_read_b128 v[164:167],v207 offset:5120
ds_read_b128 v[168:171],v207 offset:6144
ds_read_b128 v[172:175],v207 offset:7168
s_waitcnt vmcnt(13)
v_lshlrev_b32 v192,16,v180
v_and_b32 v193,0xffff0000,v180
v_lshlrev_b32 v194,16,v181
v_and_b32 v195,0xffff0000,v181
v_lshlrev_b32 v196,16,v182
v_and_b32 v197,0xffff0000,v182
v_lshlrev_b32 v198,16,v183
v_and_b32 v199,0xffff0000,v183
buffer_load_dwordx4 v[60:63],v1,s[8:11],s63 offen offset:3072 sc1
s_add_u32 s63,s73,12288
buffer_load_dwordx4 v[64:67],v1,s[8:11],s63 offen sc1
buffer_load_dwordx4 v[68:71],v1,s[8:11],s63 offen offset:1024 sc1
s_waitcnt lgkmcnt(4)
v_pk_add_f32 v[144:145],v[144:145],v[152:153]
v_pk_add_f32 v[146:147],v[146:147],v[154:155]
v_pk_add_f32 v[148:149],v[148:149],v[156:157]
v_pk_add_f32 v[150:151],v[150:151],v[158:159]
s_waitcnt lgkmcnt(0)
v_pk_add_f32 v[160:161],v[160:161],v[168:169]
v_pk_add_f32 v[162:163],v[162:163],v[170:171]
v_pk_add_f32 v[164:165],v[164:165],v[172:173]
v_pk_add_f32 v[166:167],v[166:167],v[174:175]
v_pk_add_f32 v[144:145],v[144:145],v[160:161]
v_pk_add_f32 v[146:147],v[146:147],v[162:163]
v_pk_add_f32 v[148:149],v[148:149],v[164:165]
v_pk_add_f32 v[150:151],v[150:151],v[166:167]
v_cvt_pk_bf16_f32 v6,v144,v145
v_lshlrev_b32 v144,16,v6
v_and_b32 v145,0xffff0000,v6
v_cvt_pk_bf16_f32 v6,v146,v147
v_lshlrev_b32 v146,16,v6
v_and_b32 v147,0xffff0000,v6
v_cvt_pk_bf16_f32 v6,v148,v149
v_lshlrev_b32 v148,16,v6
v_and_b32 v149,0xffff0000,v6
v_cvt_pk_bf16_f32 v6,v150,v151
v_lshlrev_b32 v150,16,v6
v_and_b32 v151,0xffff0000,v6
v_pk_add_f32 v[144:145],v[144:145],v[184:185]
v_pk_add_f32 v[146:147],v[146:147],v[186:187]
v_pk_add_f32 v[148:149],v[148:149],v[188:189]
v_pk_add_f32 v[150:151],v[150:151],v[190:191]
v_cvt_pk_bf16_f32 v6,v144,v145
v_lshlrev_b32 v144,16,v6
v_and_b32 v145,0xffff0000,v6
v_cvt_pk_bf16_f32 v6,v146,v147
v_lshlrev_b32 v146,16,v6
v_and_b32 v147,0xffff0000,v6
v_cvt_pk_bf16_f32 v6,v148,v149
v_lshlrev_b32 v148,16,v6
v_and_b32 v149,0xffff0000,v6
v_cvt_pk_bf16_f32 v6,v150,v151
v_lshlrev_b32 v150,16,v6
v_and_b32 v151,0xffff0000,v6
v_pk_add_f32 v[144:145],v[144:145],v[192:193]
v_pk_add_f32 v[146:147],v[146:147],v[194:195]
v_pk_add_f32 v[148:149],v[148:149],v[196:197]
v_pk_add_f32 v[150:151],v[150:151],v[198:199]
v_cvt_pk_bf16_f32 v200,v144,v145
v_cvt_pk_bf16_f32 v201,v146,v147
v_cvt_pk_bf16_f32 v202,v148,v149
v_cvt_pk_bf16_f32 v203,v150,v151
s_cmp_lg_u32 s51,0
s_cbranch_scc1 w4o_327
buffer_store_dwordx4 v[200:203],v15,s[8:11],s40 offen sc1
v_lshlrev_b32 v144,16,v200
v_and_b32 v145,0xffff0000,v200
v_lshlrev_b32 v146,16,v201
v_and_b32 v147,0xffff0000,v201
v_lshlrev_b32 v148,16,v202
v_and_b32 v149,0xffff0000,v202
v_lshlrev_b32 v150,16,v203
v_and_b32 v151,0xffff0000,v203
v_pk_add_f32 v[6:7],v[144:145],v[146:147]
v_pk_mul_f32 v[8:9],v[144:145],v[144:145]
v_pk_fma_f32 v[8:9],v[146:147],v[146:147],v[8:9]
v_pk_add_f32 v[6:7],v[6:7],v[148:149]
v_pk_fma_f32 v[8:9],v[148:149],v[148:149],v[8:9]
v_pk_add_f32 v[6:7],v[6:7],v[150:151]
v_pk_fma_f32 v[8:9],v[150:151],v[150:151],v[8:9]
v_add_f32 v6,v6,v7
v_add_f32 v7,v8,v9
s_nop 1
v_permlane32_swap_b32 v6,v7
v_add_f32 v6,v6,v7
v_mov_b32 v7,v6
s_nop 1
v_permlane16_swap_b32 v6,v7
v_add_f32 v6,v6,v7
v_mov_b32 v7,v6
s_nop 1
v_permlane32_swap_b32 v6,v7
s_mov_b64 exec,0xffff
buffer_store_dwordx2 v[6:7],v204,s[8:11],s41 offen sc1
s_mov_b64 exec,-1
s_branch w4n_328
w4o_327:
v_permlane16_swap_b32 v200,v202
v_permlane16_swap_b32 v201,v203
buffer_store_dwordx4 v[200:203],v205,s[76:79],s40 offen
s_mov_b64 exec,1
buffer_store_dword v5,v1,s[8:11],s42 offen
s_mov_b64 exec,-1
w4n_328:
s_mov_b32 s59,s42
s_waitcnt vmcnt(8)
s_branch W4_W
W4_E0:
s_nop 4
ds_write_b128 v206,v[128:131] offset:8192
ds_write_b128 v206,v[132:135] offset:9216
ds_write_b128 v206,v[136:139] offset:8704
ds_write_b128 v206,v[140:143] offset:9728
s_waitcnt lgkmcnt(0)
s_barrier
ds_read_b128 v[144:147],v207 offset:0
ds_read_b128 v[148:151],v207 offset:1024
ds_read_b128 v[152:155],v207 offset:2048
ds_read_b128 v[156:159],v207 offset:3072
ds_read_b128 v[160:163],v207 offset:4096
ds_read_b128 v[164:167],v207 offset:5120
ds_read_b128 v[168:171],v207 offset:6144
ds_read_b128 v[172:175],v207 offset:7168
s_waitcnt vmcnt(16)
v_lshlrev_b32 v192,16,v180
v_and_b32 v193,0xffff0000,v180
v_lshlrev_b32 v194,16,v181
v_and_b32 v195,0xffff0000,v181
v_lshlrev_b32 v196,16,v182
v_and_b32 v197,0xffff0000,v182
v_lshlrev_b32 v198,16,v183
v_and_b32 v199,0xffff0000,v183
s_waitcnt lgkmcnt(4)
v_pk_add_f32 v[144:145],v[144:145],v[152:153]
v_pk_add_f32 v[146:147],v[146:147],v[154:155]
v_pk_add_f32 v[148:149],v[148:149],v[156:157]
v_pk_add_f32 v[150:151],v[150:151],v[158:159]
s_waitcnt lgkmcnt(0)
v_pk_add_f32 v[160:161],v[160:161],v[168:169]
v_pk_add_f32 v[162:163],v[162:163],v[170:171]
v_pk_add_f32 v[164:165],v[164:165],v[172:173]
v_pk_add_f32 v[166:167],v[166:167],v[174:175]
v_pk_add_f32 v[144:145],v[144:145],v[160:161]
v_pk_add_f32 v[146:147],v[146:147],v[162:163]
v_pk_add_f32 v[148:149],v[148:149],v[164:165]
v_pk_add_f32 v[150:151],v[150:151],v[166:167]
v_cvt_pk_bf16_f32 v6,v144,v145
v_lshlrev_b32 v144,16,v6
v_and_b32 v145,0xffff0000,v6
v_cvt_pk_bf16_f32 v6,v146,v147
v_lshlrev_b32 v146,16,v6
v_and_b32 v147,0xffff0000,v6
v_cvt_pk_bf16_f32 v6,v148,v149
v_lshlrev_b32 v148,16,v6
v_and_b32 v149,0xffff0000,v6
v_cvt_pk_bf16_f32 v6,v150,v151
v_lshlrev_b32 v150,16,v6
v_and_b32 v151,0xffff0000,v6
v_pk_add_f32 v[144:145],v[144:145],v[184:185]
v_pk_add_f32 v[146:147],v[146:147],v[186:187]
v_pk_add_f32 v[148:149],v[148:149],v[188:189]
v_pk_add_f32 v[150:151],v[150:151],v[190:191]
v_cvt_pk_bf16_f32 v6,v144,v145
v_lshlrev_b32 v144,16,v6
v_and_b32 v145,0xffff0000,v6
v_cvt_pk_bf16_f32 v6,v146,v147
v_lshlrev_b32 v146,16,v6
v_and_b32 v147,0xffff0000,v6
v_cvt_pk_bf16_f32 v6,v148,v149
v_lshlrev_b32 v148,16,v6
v_and_b32 v149,0xffff0000,v6
v_cvt_pk_bf16_f32 v6,v150,v151
v_lshlrev_b32 v150,16,v6
v_and_b32 v151,0xffff0000,v6
v_pk_add_f32 v[144:145],v[144:145],v[192:193]
v_pk_add_f32 v[146:147],v[146:147],v[194:195]
v_pk_add_f32 v[148:149],v[148:149],v[196:197]
v_pk_add_f32 v[150:151],v[150:151],v[198:199]
v_cvt_pk_bf16_f32 v200,v144,v145
v_cvt_pk_bf16_f32 v201,v146,v147
v_cvt_pk_bf16_f32 v202,v148,v149
v_cvt_pk_bf16_f32 v203,v150,v151
s_cmp_lg_u32 s51,0
s_cbranch_scc1 w4o_329
buffer_store_dwordx4 v[200:203],v15,s[8:11],s40 offen sc1
v_lshlrev_b32 v144,16,v200
v_and_b32 v145,0xffff0000,v200
v_lshlrev_b32 v146,16,v201
v_and_b32 v147,0xffff0000,v201
v_lshlrev_b32 v148,16,v202
v_and_b32 v149,0xffff0000,v202
v_lshlrev_b32 v150,16,v203
v_and_b32 v151,0xffff0000,v203
v_pk_add_f32 v[6:7],v[144:145],v[146:147]
v_pk_mul_f32 v[8:9],v[144:145],v[144:145]
v_pk_fma_f32 v[8:9],v[146:147],v[146:147],v[8:9]
v_pk_add_f32 v[6:7],v[6:7],v[148:149]
v_pk_fma_f32 v[8:9],v[148:149],v[148:149],v[8:9]
v_pk_add_f32 v[6:7],v[6:7],v[150:151]
v_pk_fma_f32 v[8:9],v[150:151],v[150:151],v[8:9]
v_add_f32 v6,v6,v7
v_add_f32 v7,v8,v9
s_nop 1
v_permlane32_swap_b32 v6,v7
v_add_f32 v6,v6,v7
v_mov_b32 v7,v6
s_nop 1
v_permlane16_swap_b32 v6,v7
v_add_f32 v6,v6,v7
v_mov_b32 v7,v6
s_nop 1
v_permlane32_swap_b32 v6,v7
s_mov_b64 exec,0xffff
buffer_store_dwordx2 v[6:7],v204,s[8:11],s41 offen sc1
s_mov_b64 exec,-1
s_branch w4n_330
w4o_329:
v_permlane16_swap_b32 v200,v202
v_permlane16_swap_b32 v201,v203
buffer_store_dwordx4 v[200:203],v205,s[76:79],s40 offen
s_mov_b64 exec,1
buffer_store_dword v5,v1,s[8:11],s42 offen
s_mov_b64 exec,-1
w4n_330:
s_mov_b32 s59,s42
s_cmp_lg_u32 s37,0
s_cbranch_scc1 W4_COLD
s_waitcnt vmcnt(2)
W4_W:
s_mov_b32 s51,s33
s_mov_b32 s52,s34
s_mov_b32 s72,s73
s_add_u32 s32,s32,1
s_mov_b32 s33,s28
s_mov_b32 s34,s29
s_mov_b32 s35,s30
s_mov_b32 s73,s31
v_cmp_eq_u32 vcc,0,v3
s_cmp_eq_u64 vcc,0
s_cselect_b32 s37,0,2147483648
s_cmp_lt_u32 s32,128
s_cselect_b32 s37,s37,2147483648
s_cmp_lg_u32 s37,0
s_cbranch_scc1 W4_W0
s_waitcnt vmcnt(15)
v_mfma_f32_32x32x16_bf16 v[112:127],a[0:3],v[16:19],0
s_add_u32 s63,s72,12288
buffer_load_dwordx4 v[72:75],v1,s[8:11],s63 offen offset:2048 sc1
v_xor_b32 v206,0x8000,v206
v_xor_b32 v207,0x8000,v207
s_lshl_b32 s64,s51,6
v_mfma_f32_32x32x16_bf16 v[128:143],a[96:99],v[16:19],0
s_add_u32 s64,s64,s52
s_and_b32 s65,s52,7
s_lshl3_add_u32 s65,s51,s65
s_mul_i32 s65,s65,46080
s_add_u32 s65,s65,s70
s_add_u32 s65,s65,212467712
s_waitcnt vmcnt(15)
v_mfma_f32_32x32x16_bf16 v[112:127],a[4:7],v[20:23],v[112:127]
buffer_load_dwordx4 v[76:79],v1,s[8:11],s63 offen offset:3072 sc1
s_add_u32 s63,s72,16384
buffer_load_dwordx4 v[176:179],v1,s[8:11],s65 offen sc1
s_mul_i32 s65,s64,40960
v_mfma_f32_32x32x16_bf16 v[128:143],a[100:103],v[20:23],v[128:143]
s_add_u32 s65,s65,s70
s_add_u32 s65,s65,218365952
s_mov_b32 s43,s65
s_lshl_b32 s82,s64,9
s_lshl2_add_u32 s82,s56,s82
s_add_u32 s42,s82,32768
s_waitcnt vmcnt(16)
v_mfma_f32_32x32x16_bf16 v[112:127],a[8:11],v[24:27],v[112:127]
buffer_load_dwordx4 v[80:83],v1,s[8:11],s63 offen sc1
s_add_u32 s82,s82,327680
s_mul_i32 s41,s52,46080
s_add_u32 s41,s41,209518592
s_add_u32 s40,s41,s70
v_mfma_f32_32x32x16_bf16 v[128:143],a[104:107],v[24:27],v[128:143]
s_lshr_b32 s64,s70,3
s_add_u32 s41,s41,s64
s_add_u32 s41,s41,40960
s_mul_i32 s64,s52,40960
s_add_u32 s62,s32,1
s_min_u32 s62,s62,127
s_waitcnt vmcnt(16)
v_mfma_f32_32x32x16_bf16 v[112:127],a[12:15],v[28:31],v[112:127]
buffer_load_dwordx4 v[84:87],v1,s[8:11],s63 offen offset:1024 sc1
s_cmp_lg_u32 s51,0
s_cselect_b32 s40,s64,s40
s_cselect_b32 s42,2147483648,s42
s_sub_u32 s60,s62,18
v_mfma_f32_32x32x16_bf16 v[128:143],a[108:111],v[28:31],v[128:143]
s_lshr_b32 s29,s60,1
s_and_b32 s28,s60,1
s_cmp_eq_u32 s28,0
s_cselect_b32 s61,18,0
s_add_u32 s29,s29,s61
s_sub_u32 s61,s60,46
s_waitcnt vmcnt(16)
v_mfma_f32_32x32x16_bf16 v[112:127],a[16:19],v[32:35],v[112:127]
buffer_load_dwordx4 v[88:91],v1,s[8:11],s63 offen offset:2048 sc1
s_cmp_ge_u32 s60,92
s_cselect_b32 s29,s61,s29
s_cselect_b32 s28,1,s28
v_mfma_f32_32x32x16_bf16 v[128:143],a[112:115],v[32:35],v[128:143]
s_cmp_lt_u32 s62,18
s_cselect_b32 s29,s62,s29
s_cselect_b32 s28,0,s28
s_lshl_b32 s30,s28,6
s_add_u32 s30,s30,s29
s_lshl_b32 s30,s30,9
s_waitcnt vmcnt(16)
v_mfma_f32_32x32x16_bf16 v[112:127],a[20:23],v[36:39],v[112:127]
buffer_load_dwordx4 v[92:95],v1,s[8:11],s63 offen offset:3072 sc1
s_add_u32 s63,s72,20480
s_add_u32 s30,s30,589824
s_and_b32 s60,s29,3
s_lshl2_add_u32 s60,s28,s60
v_mfma_f32_32x32x16_bf16 v[128:143],a[116:119],v[36:39],v[128:143]
s_mul_i32 s31,s60,98304
s_add_u32 s31,s31,s71
s_waitcnt vmcnt(16)
v_mfma_f32_32x32x16_bf16 v[112:127],a[24:27],v[40:43],v[112:127]
buffer_load_dwordx4 v[96:99],v1,s[8:11],s63 offen sc1
v_mfma_f32_32x32x16_bf16 v[128:143],a[120:123],v[40:43],v[128:143]
s_waitcnt vmcnt(16)
v_mfma_f32_32x32x16_bf16 v[112:127],a[28:31],v[44:47],v[112:127]
buffer_load_dwordx4 v[100:103],v1,s[8:11],s63 offen offset:1024 sc1
v_mfma_f32_32x32x16_bf16 v[128:143],a[124:127],v[44:47],v[128:143]
s_waitcnt vmcnt(16)
v_mfma_f32_32x32x16_bf16 v[112:127],a[32:35],v[48:51],v[112:127]
buffer_load_dwordx4 v[104:107],v1,s[8:11],s63 offen offset:2048 sc1
v_mfma_f32_32x32x16_bf16 v[128:143],a[128:131],v[48:51],v[128:143]
s_waitcnt vmcnt(16)
v_mfma_f32_32x32x16_bf16 v[112:127],a[36:39],v[52:55],v[112:127]
buffer_load_dwordx4 v[108:111],v1,s[8:11],s63 offen offset:3072 sc1
buffer_load_dwordx4 v[180:183],v15,s[8:11],s43 offen sc1
s_add_u32 s63,s73,0
v_mfma_f32_32x32x16_bf16 v[128:143],a[132:135],v[52:55],v[128:143]
buffer_load_dwordx4 v[16:19],v1,s[8:11],s63 offen sc1
s_waitcnt vmcnt(18)
v_mfma_f32_32x32x16_bf16 v[112:127],a[40:43],v[56:59],v[112:127]
v_mfma_f32_32x32x16_bf16 v[128:143],a[136:139],v[56:59],v[128:143]
buffer_load_dwordx4 v[20:23],v1,s[8:11],s63 offen offset:1024 sc1
s_waitcnt vmcnt(18)
v_mfma_f32_32x32x16_bf16 v[112:127],a[44:47],v[60:63],v[112:127]
v_mfma_f32_32x32x16_bf16 v[128:143],a[140:143],v[60:63],v[128:143]
buffer_load_dwordx4 v[24:27],v1,s[8:11],s63 offen offset:2048 sc1
s_waitcnt vmcnt(18)
v_mfma_f32_32x32x16_bf16 v[112:127],a[48:51],v[64:67],v[112:127]
v_mfma_f32_32x32x16_bf16 v[128:143],a[144:147],v[64:67],v[128:143]
buffer_load_dwordx4 v[28:31],v1,s[8:11],s63 offen offset:3072 sc1
s_add_u32 s63,s73,4096
s_waitcnt vmcnt(18)
v_mfma_f32_32x32x16_bf16 v[112:127],a[52:55],v[68:71],v[112:127]
s_waitcnt vmcnt(16)
s_mov_b64 exec,1
buffer_store_dword v5,v1,s[8:11],s59 offen sc1
s_mov_b64 exec,-1
s_mov_b32 s59,2147483648
v_mfma_f32_32x32x16_bf16 v[128:143],a[148:151],v[68:71],v[128:143]
buffer_load_dwordx4 v[32:35],v1,s[8:11],s63 offen sc1
s_waitcnt vmcnt(17)
v_mfma_f32_32x32x16_bf16 v[112:127],a[56:59],v[72:75],v[112:127]
v_mfma_f32_32x32x16_bf16 v[128:143],a[152:155],v[72:75],v[128:143]
buffer_load_dwordx4 v[36:39],v1,s[8:11],s63 offen offset:1024 sc1
s_waitcnt vmcnt(17)
v_mfma_f32_32x32x16_bf16 v[112:127],a[60:63],v[76:79],v[112:127]
v_mfma_f32_32x32x16_bf16 v[128:143],a[156:159],v[76:79],v[128:143]
buffer_load_dwordx4 v[40:43],v1,s[8:11],s63 offen offset:2048 sc1
s_waitcnt vmcnt(16)
v_mfma_f32_32x32x16_bf16 v[112:127],a[64:67],v[80:83],v[112:127]
v_mfma_f32_32x32x16_bf16 v[128:143],a[160:163],v[80:83],v[128:143]
buffer_load_dwordx4 v[44:47],v1,s[8:11],s63 offen offset:3072 sc1
s_add_u32 s63,s73,8192
s_waitcnt vmcnt(16)
v_mfma_f32_32x32x16_bf16 v[112:127],a[68:71],v[84:87],v[112:127]
v_mfma_f32_32x32x16_bf16 v[128:143],a[164:167],v[84:87],v[128:143]
buffer_load_dwordx4 v[48:51],v1,s[8:11],s63 offen sc1
s_waitcnt vmcnt(16)
v_mfma_f32_32x32x16_bf16 v[112:127],a[72:75],v[88:91],v[112:127]
v_mfma_f32_32x32x16_bf16 v[128:143],a[168:171],v[88:91],v[128:143]
buffer_load_dwordx4 v[52:55],v1,s[8:11],s63 offen offset:1024 sc1
v_lshlrev_b32 v184,16,v176
v_and_b32 v185,0xffff0000,v176
v_lshlrev_b32 v186,16,v177
s_waitcnt vmcnt(16)
v_mfma_f32_32x32x16_bf16 v[112:127],a[76:79],v[92:95],v[112:127]
v_and_b32 v187,0xffff0000,v177
v_lshlrev_b32 v188,16,v178
v_and_b32 v189,0xffff0000,v178
v_lshlrev_b32 v190,16,v179
v_and_b32 v191,0xffff0000,v179
v_mfma_f32_32x32x16_bf16 v[128:143],a[172:175],v[92:95],v[128:143]
buffer_load_dwordx4 v[56:59],v1,s[8:11],s63 offen offset:2048 sc1
s_waitcnt vmcnt(16)
v_mfma_f32_32x32x16_bf16 v[112:127],a[80:83],v[96:99],v[112:127]
s_waitcnt vmcnt(15)
v_mfma_f32_32x32x16_bf16 v[112:127],a[84:87],v[100:103],v[112:127]
buffer_load_dwordx4 v[60:63],v1,s[8:11],s63 offen offset:3072 sc1
s_add_u32 s63,s73,12288
s_waitcnt vmcnt(15)
v_mfma_f32_32x32x16_bf16 v[112:127],a[88:91],v[104:107],v[112:127]
s_waitcnt vmcnt(14)
v_mfma_f32_32x32x16_bf16 v[112:127],a[92:95],v[108:111],v[112:127]
buffer_load_dwordx4 v[64:67],v1,s[8:11],s63 offen sc1
v_mfma_f32_32x32x16_bf16 v[128:143],a[176:179],v[96:99],v[128:143]
s_mov_b64 exec,1
s_cmp_lg_u32 s49,0
s_cbranch_scc0 ls_331
buffer_store_dword v5,v1,s[8:11],s82 offen sc1
s_branch ls_332
ls_331:
buffer_store_dword v5,v1,s[8:11],s82 offen
ls_332:
s_mov_b64 exec,-1
v_mfma_f32_32x32x16_bf16 v[128:143],a[180:183],v[100:103],v[128:143]
buffer_load_dwordx4 v[68:71],v1,s[8:11],s63 offen offset:1024 sc1
ds_write_b128 v206,v[112:115] offset:0
ds_write_b128 v206,v[116:119] offset:1024
v_mfma_f32_32x32x16_bf16 v[128:143],a[184:187],v[104:107],v[128:143]
ds_write_b128 v206,v[120:123] offset:512
ds_write_b128 v206,v[124:127] offset:1536
v_mfma_f32_32x32x16_bf16 v[128:143],a[188:191],v[108:111],v[128:143]
buffer_load_dword v3,v2,s[8:11],s30 offen sc1
s_nop 5
s_branch W4_E0
s_nop 3
W4_W0:
s_waitcnt vmcnt(15)
v_mfma_f32_32x32x16_bf16 v[112:127],a[0:3],v[16:19],0
s_add_u32 s63,s72,12288
buffer_load_dwordx4 v[72:75],v1,s[8:11],s63 offen offset:2048 sc1
v_xor_b32 v206,0x8000,v206
v_xor_b32 v207,0x8000,v207
s_lshl_b32 s64,s51,6
v_mfma_f32_32x32x16_bf16 v[128:143],a[96:99],v[16:19],0
s_add_u32 s64,s64,s52
s_and_b32 s65,s52,7
s_lshl3_add_u32 s65,s51,s65
s_mul_i32 s65,s65,46080
s_add_u32 s65,s65,s70
s_add_u32 s65,s65,212467712
s_waitcnt vmcnt(15)
v_mfma_f32_32x32x16_bf16 v[112:127],a[4:7],v[20:23],v[112:127]
buffer_load_dwordx4 v[76:79],v1,s[8:11],s63 offen offset:3072 sc1
s_add_u32 s63,s72,16384
buffer_load_dwordx4 v[176:179],v1,s[8:11],s65 offen sc1
s_mul_i32 s65,s64,40960
v_mfma_f32_32x32x16_bf16 v[128:143],a[100:103],v[20:23],v[128:143]
s_add_u32 s65,s65,s70
s_add_u32 s65,s65,218365952
s_mov_b32 s43,s65
s_lshl_b32 s82,s64,9
s_lshl2_add_u32 s82,s56,s82
s_add_u32 s42,s82,32768
s_waitcnt vmcnt(16)
v_mfma_f32_32x32x16_bf16 v[112:127],a[8:11],v[24:27],v[112:127]
buffer_load_dwordx4 v[80:83],v1,s[8:11],s63 offen sc1
s_add_u32 s82,s82,327680
s_mul_i32 s41,s52,46080
s_add_u32 s41,s41,209518592
s_add_u32 s40,s41,s70
v_mfma_f32_32x32x16_bf16 v[128:143],a[104:107],v[24:27],v[128:143]
s_lshr_b32 s64,s70,3
s_add_u32 s41,s41,s64
s_add_u32 s41,s41,40960
s_mul_i32 s64,s52,40960
s_add_u32 s62,s32,1
s_min_u32 s62,s62,127
s_waitcnt vmcnt(16)
v_mfma_f32_32x32x16_bf16 v[112:127],a[12:15],v[28:31],v[112:127]
buffer_load_dwordx4 v[84:87],v1,s[8:11],s63 offen offset:1024 sc1
s_cmp_lg_u32 s51,0
s_cselect_b32 s40,s64,s40
s_cselect_b32 s42,2147483648,s42
s_sub_u32 s60,s62,18
v_mfma_f32_32x32x16_bf16 v[128:143],a[108:111],v[28:31],v[128:143]
s_lshr_b32 s29,s60,1
s_and_b32 s28,s60,1
s_cmp_eq_u32 s28,0
s_cselect_b32 s61,18,0
s_add_u32 s29,s29,s61
s_sub_u32 s61,s60,46
s_waitcnt vmcnt(16)
v_mfma_f32_32x32x16_bf16 v[112:127],a[16:19],v[32:35],v[112:127]
buffer_load_dwordx4 v[88:91],v1,s[8:11],s63 offen offset:2048 sc1
s_cmp_ge_u32 s60,92
s_cselect_b32 s29,s61,s29
s_cselect_b32 s28,1,s28
v_mfma_f32_32x32x16_bf16 v[128:143],a[112:115],v[32:35],v[128:143]
s_cmp_lt_u32 s62,18
s_cselect_b32 s29,s62,s29
s_cselect_b32 s28,0,s28
s_lshl_b32 s30,s28,6
s_add_u32 s30,s30,s29
s_lshl_b32 s30,s30,9
s_waitcnt vmcnt(16)
v_mfma_f32_32x32x16_bf16 v[112:127],a[20:23],v[36:39],v[112:127]
buffer_load_dwordx4 v[92:95],v1,s[8:11],s63 offen offset:3072 sc1
s_add_u32 s63,s72,20480
s_add_u32 s30,s30,589824
s_and_b32 s60,s29,3
s_lshl2_add_u32 s60,s28,s60
v_mfma_f32_32x32x16_bf16 v[128:143],a[116:119],v[36:39],v[128:143]
s_mul_i32 s31,s60,98304
s_add_u32 s31,s31,s71
s_waitcnt vmcnt(16)
v_mfma_f32_32x32x16_bf16 v[112:127],a[24:27],v[40:43],v[112:127]
buffer_load_dwordx4 v[96:99],v1,s[8:11],s63 offen sc1
v_mfma_f32_32x32x16_bf16 v[128:143],a[120:123],v[40:43],v[128:143]
s_waitcnt vmcnt(16)
v_mfma_f32_32x32x16_bf16 v[112:127],a[28:31],v[44:47],v[112:127]
buffer_load_dwordx4 v[100:103],v1,s[8:11],s63 offen offset:1024 sc1
v_mfma_f32_32x32x16_bf16 v[128:143],a[124:127],v[44:47],v[128:143]
s_waitcnt vmcnt(16)
v_mfma_f32_32x32x16_bf16 v[112:127],a[32:35],v[48:51],v[112:127]
buffer_load_dwordx4 v[104:107],v1,s[8:11],s63 offen offset:2048 sc1
v_mfma_f32_32x32x16_bf16 v[128:143],a[128:131],v[48:51],v[128:143]
s_waitcnt vmcnt(16)
v_mfma_f32_32x32x16_bf16 v[112:127],a[36:39],v[52:55],v[112:127]
buffer_load_dwordx4 v[108:111],v1,s[8:11],s63 offen offset:3072 sc1
buffer_load_dwordx4 v[180:183],v15,s[8:11],s43 offen sc1
v_mfma_f32_32x32x16_bf16 v[128:143],a[132:135],v[52:55],v[128:143]
s_waitcnt vmcnt(17)
v_mfma_f32_32x32x16_bf16 v[112:127],a[40:43],v[56:59],v[112:127]
v_mfma_f32_32x32x16_bf16 v[128:143],a[136:139],v[56:59],v[128:143]
s_waitcnt vmcnt(16)
v_mfma_f32_32x32x16_bf16 v[112:127],a[44:47],v[60:63],v[112:127]
v_mfma_f32_32x32x16_bf16 v[128:143],a[140:143],v[60:63],v[128:143]
s_waitcnt vmcnt(15)
v_mfma_f32_32x32x16_bf16 v[112:127],a[48:51],v[64:67],v[112:127]
v_mfma_f32_32x32x16_bf16 v[128:143],a[144:147],v[64:67],v[128:143]
s_waitcnt vmcnt(14)
v_mfma_f32_32x32x16_bf16 v[112:127],a[52:55],v[68:71],v[112:127]
s_waitcnt vmcnt(12)
s_mov_b64 exec,1
buffer_store_dword v5,v1,s[8:11],s59 offen sc1
s_mov_b64 exec,-1
s_mov_b32 s59,2147483648
v_mfma_f32_32x32x16_bf16 v[128:143],a[148:151],v[68:71],v[128:143]
s_waitcnt vmcnt(12)
v_mfma_f32_32x32x16_bf16 v[112:127],a[56:59],v[72:75],v[112:127]
v_mfma_f32_32x32x16_bf16 v[128:143],a[152:155],v[72:75],v[128:143]
s_waitcnt vmcnt(11)
v_mfma_f32_32x32x16_bf16 v[112:127],a[60:63],v[76:79],v[112:127]
v_mfma_f32_32x32x16_bf16 v[128:143],a[156:159],v[76:79],v[128:143]
s_waitcnt vmcnt(9)
v_mfma_f32_32x32x16_bf16 v[112:127],a[64:67],v[80:83],v[112:127]
v_mfma_f32_32x32x16_bf16 v[128:143],a[160:163],v[80:83],v[128:143]
s_waitcnt vmcnt(8)
v_mfma_f32_32x32x16_bf16 v[112:127],a[68:71],v[84:87],v[112:127]
v_mfma_f32_32x32x16_bf16 v[128:143],a[164:167],v[84:87],v[128:143]
s_waitcnt vmcnt(7)
v_mfma_f32_32x32x16_bf16 v[112:127],a[72:75],v[88:91],v[112:127]
v_mfma_f32_32x32x16_bf16 v[128:143],a[168:171],v[88:91],v[128:143]
v_lshlrev_b32 v184,16,v176
v_and_b32 v185,0xffff0000,v176
v_lshlrev_b32 v186,16,v177
v_and_b32 v187,0xffff0000,v177
v_lshlrev_b32 v188,16,v178
s_waitcnt vmcnt(6)
v_mfma_f32_32x32x16_bf16 v[112:127],a[76:79],v[92:95],v[112:127]
buffer_load_dword v3,v2,s[8:11],s35 offen sc1
v_and_b32 v189,0xffff0000,v178
v_lshlrev_b32 v190,16,v179
v_and_b32 v191,0xffff0000,v179
v_mfma_f32_32x32x16_bf16 v[128:143],a[172:175],v[92:95],v[128:143]
s_waitcnt vmcnt(6)
v_mfma_f32_32x32x16_bf16 v[112:127],a[80:83],v[96:99],v[112:127]
s_waitcnt vmcnt(5)
v_mfma_f32_32x32x16_bf16 v[112:127],a[84:87],v[100:103],v[112:127]
s_waitcnt vmcnt(4)
v_mfma_f32_32x32x16_bf16 v[112:127],a[88:91],v[104:107],v[112:127]
s_waitcnt vmcnt(3)
v_mfma_f32_32x32x16_bf16 v[112:127],a[92:95],v[108:111],v[112:127]
v_mfma_f32_32x32x16_bf16 v[128:143],a[176:179],v[96:99],v[128:143]
s_mov_b64 exec,1
s_cmp_lg_u32 s49,0
s_cbranch_scc0 ls_333
buffer_store_dword v5,v1,s[8:11],s82 offen sc1
s_branch ls_334
ls_333:
buffer_store_dword v5,v1,s[8:11],s82 offen
ls_334:
s_mov_b64 exec,-1
v_mfma_f32_32x32x16_bf16 v[128:143],a[180:183],v[100:103],v[128:143]
ds_write_b128 v206,v[112:115] offset:0
ds_write_b128 v206,v[116:119] offset:1024
ds_write_b128 v206,v[120:123] offset:512
v_mfma_f32_32x32x16_bf16 v[128:143],a[184:187],v[104:107],v[128:143]
ds_write_b128 v206,v[124:127] offset:1536
v_mfma_f32_32x32x16_bf16 v[128:143],a[188:191],v[108:111],v[128:143]
s_waitcnt vmcnt(1)
v_cmp_eq_u32 vcc,0,v3
s_cmp_eq_u64 vcc,0
s_cselect_b32 s37,0,2147483648
s_cmp_lt_u32 s32,128
s_cselect_b32 s37,s37,2147483648
s_cmp_eq_u32 s37,0
s_cbranch_scc1 W4_E2
s_branch W4_E0
s_nop 2
W4_END:
s_endpgm
.section .rodata,"a"
.p2align 6
.amdhsa_kernel interleave_layers__memory_aug_recurrent_mem_tr__mixer_s_mlp__prompt_kernel
  .amdhsa_next_free_vgpr 512
  .amdhsa_next_free_sgpr 102
  .amdhsa_accum_offset 256
  .amdhsa_group_segment_fixed_size 0
  .amdhsa_kernarg_size 120
  .amdhsa_user_sgpr_count 2
  .amdhsa_user_sgpr_kernarg_segment_ptr 1
  .amdhsa_system_sgpr_workgroup_id_x 1
.end_amdhsa_kernel
```

```asm
; @launch grid=(256,1,1) block=(256,1,1) lds=163840
.amdgcn_target "amdgcn-amd-amdhsa--gfx950"
.text
.globl interleave_layers__memory_aug_recurrent_mem_tr__mixer_s_mlp__prompt_kernel
.p2align 8
.type interleave_layers__memory_aug_recurrent_mem_tr__mixer_s_mlp__prompt_kernel,@function
interleave_layers__memory_aug_recurrent_mem_tr__mixer_s_mlp__prompt_kernel:
s_cmp_ge_u32 s2,256
s_cbranch_scc1 EXIT
s_load_dwordx16 s[16:31],s[0:1],0
s_load_dwordx8 s[32:39],s[0:1],64
s_load_dwordx4 s[40:43],s[0:1],96
s_load_dwordx2 s[44:45],s[0:1],112
v_lshrrev_b32 v1,6,v0
v_and_b32 v0,63,v0
v_readfirstlane_b32 s46,v1
s_mov_b32 s47,200000
s_mov_b32 s49,0
s_getreg_b32 s4,hwreg(HW_REG_XCC_ID)
s_and_b32 s4,s4,7
s_waitcnt lgkmcnt(0)
s_mov_b32 s8,s44
s_mov_b32 s9,s45
s_mov_b32 s10,268435456
s_mov_b32 s11,0x20000
s_mov_b32 s12,s42
s_mov_b32 s13,s43
s_mov_b32 s14,256
s_mov_b32 s15,0x20000
v_lshlrev_b32 v1,4,v0
v_mov_b32 v4,0
v_mov_b32 v5,0
v_mov_b32 v6,0
v_mov_b32 v7,0
s_lshl_b32 s5,s2,2
s_add_u32 s5,s5,s46
s_lshl_b32 s5,s5,10
buffer_store_dwordx4 v[4:7],v1,s[8:11],s5 offen sc1
v_mov_b32 v2,0
s_cmp_lg_u32 s46,0
s_cbranch_scc1 TK_DONE
s_mov_b64 exec,1
v_mov_b32 v1,1
s_lshl_b32 s5,s4,2
v_mov_b32 v3,s5
buffer_atomic_add v1,v3,s[12:15],0 offen offset:32 sc0 sc1
s_waitcnt vmcnt(0)
v_readfirstlane_b32 s5,v1
s_lshl_b32 s6,s4,5
s_add_u32 s6,s6,s5
s_cmp_lt_u32 s5,32
s_cselect_b32 s6,s6,999
v_mov_b32 v1,s6
ds_write_b32 v2,v1
s_mov_b64 exec,-1
s_waitcnt lgkmcnt(0)
TK_DONE:
s_barrier
ds_read_b32 v1,v2
s_waitcnt lgkmcnt(0)
v_readfirstlane_b32 s3,v1
s_barrier
s_nop 2
s_branch DISPATCH
ROLE_CS:
s_lshr_b32 s28,s48,4
s_and_b32 s29,s48,15
s_mul_i32 s82,s28,2097152
s_add_u32 s82,s82,2097152
v_lshlrev_b32 v1,4,v0
v_and_b32 v12,1,v0
v_mul_u32_u24 v2,0xaaaa,v12
v_or_b32 v2,0x4444,v2
s_add_u32 s60,s46,1
s_and_b32 s60,s60,3
s_lshl_b32 s60,s60,11
s_add_u32 s60,s60,131072
v_add_u32 v3,s60,v1
s_add_u32 s60,s46,2
s_and_b32 s60,s60,3
s_lshl_b32 s60,s60,11
s_add_u32 s60,s60,131072
v_add_u32 v4,s60,v1
s_add_u32 s60,s46,3
s_and_b32 s60,s60,3
s_lshl_b32 s60,s60,11
s_add_u32 s60,s60,131072
v_add_u32 v5,s60,v1
v_add_u32 v59,139264,v1
s_lshl_b32 s60,s46,11
s_add_u32 s60,s60,131072
v_add_u32 v22,s60,v1
s_lshr_b32 s60,s46,1
s_lshl_b32 s60,s60,10
s_and_b32 s61,s46,1
s_lshl_b32 s61,s61,3
s_add_u32 s60,s60,s61
v_add_u32 v23,s60,v59
s_mul_i32 s60,s46,20480
v_add_u32 v21,s60,v1
v_and_b32 v11,7,v0
v_lshlrev_b32 v11,2,v11
v_bfe_u32 v12,v0,3,2
v_lshl_add_u32 v11,v12,7,v11
s_xor_b32 s60,s28,1
s_lshl_b32 s60,s60,19
s_lshl_b32 s61,s46,11
s_add_u32 s83,s60,s61
s_add_u32 s83,s83,10485760
s_mov_b32 s36,0
s_mov_b32 s88,0xcccccccc
s_mov_b32 s89,0xcccccccc
s_mov_b32 s90,0x33333333
s_mov_b32 s91,0x33333333
s_mov_b32 s87,0x3dd53b95
v_lshrrev_b32 v14,4,v0
v_and_b32 v15,15,v0
v_lshrrev_b32 v12,2,v15
v_add_u32 v12,v12,v14
v_and_b32 v12,3,v12
v_lshlrev_b32 v6,3,v12
v_lshl_add_u32 v6,v15,5,v6
s_mul_i32 s60,s46,1536
s_add_u32 s60,s60,141312
v_add_u32 v6,s60,v6
v_add_u32 v12,v0,v14
v_and_b32 v12,3,v12
v_lshlrev_b32 v7,3,v12
v_lshrrev_b32 v12,2,v0
v_lshl_add_u32 v7,v12,5,v7
v_add_u32 v7,141312,v7
s_min_u32 s62,s46,2
v_lshrrev_b32 v12,2,v15
v_and_b32 v13,1,v15
v_lshl_add_u32 v12,v12,1,v13
v_bfe_u32 v13,v15,1,1
v_lshlrev_b32 v8,8,v14
v_lshl_add_u32 v8,v12,5,v8
v_xor_b32 v16,1,v13
v_lshl_add_u32 v8,v16,4,v8
v_lshlrev_b32 v20,8,v14
v_lshl_add_u32 v20,v13,7,v20
v_and_b32 v16,3,v12
v_lshl_add_u32 v20,v16,5,v20
v_lshrrev_b32 v16,2,v12
v_lshl_add_u32 v20,v16,4,v20
v_min_u32 v12,5,v0
s_mul_i32 s60,s48,3
v_add_u32 v9,s60,v12
v_lshlrev_b32 v9,2,v9
v_add_u32 v13,65524,v9
v_cmp_lt_u32 vcc,2,v12
s_nop 1
v_cndmask_b32 v9,v9,v13,vcc
s_mul_i32 s84,s48,12288
s_add_u32 s84,s84,74448896
s_mul_i32 s60,s29,3072
s_lshl_b32 s61,s62,10
s_add_u32 s60,s60,s61
s_add_u32 s60,s60,s82
s_add_u32 s33,s60,163840
s_add_u32 s34,s60,557056
s_mul_i32 s85,s48,6144
s_add_u32 s85,s85,24117248
s_lshl_b32 s86,s48,5
s_lshl_b32 s61,s62,2
s_add_u32 s86,s86,688128
s_lshr_b32 s60,s29,2
s_lshl_b32 s60,s60,7
s_and_b32 s63,s29,3
s_mul_i32 s63,s63,12
s_add_u32 s60,s60,s63
s_add_u32 s60,s60,s61
s_add_u32 s60,s60,s82
s_add_u32 s35,s60,951296
s_cmp_eq_u32 s46,3
s_cbranch_scc1 si_1
v_mov_b32 v12,-1
v_mov_b32 v13,0
s_cmp_lg_u32 s49,0
s_cbranch_scc1 ls_2
s_add_u32 s60,s33,0
buffer_store_dword v12,v1,s[8:11],s60 offen
s_add_u32 s60,s33,49152
buffer_store_dword v12,v1,s[8:11],s60 offen
s_add_u32 s60,s33,98304
buffer_store_dword v12,v1,s[8:11],s60 offen
s_add_u32 s60,s33,147456
buffer_store_dword v12,v1,s[8:11],s60 offen
s_add_u32 s60,s33,196608
buffer_store_dword v12,v1,s[8:11],s60 offen
s_add_u32 s60,s33,245760
buffer_store_dword v12,v1,s[8:11],s60 offen
s_add_u32 s60,s33,294912
buffer_store_dword v12,v1,s[8:11],s60 offen
s_add_u32 s60,s33,344064
buffer_store_dword v12,v1,s[8:11],s60 offen
s_mov_b64 exec,1
buffer_store_dword v13,v1,s[8:11],s35 offen
buffer_store_dword v13,v1,s[8:11],s35 offen offset:512
s_mov_b64 exec,-1
s_branch ls_3
ls_2:
s_add_u32 s60,s33,0
buffer_store_dword v12,v1,s[8:11],s60 offen sc1
s_add_u32 s60,s33,49152
buffer_store_dword v12,v1,s[8:11],s60 offen sc1
s_add_u32 s60,s33,98304
buffer_store_dword v12,v1,s[8:11],s60 offen sc1
s_add_u32 s60,s33,147456
buffer_store_dword v12,v1,s[8:11],s60 offen sc1
s_add_u32 s60,s33,196608
buffer_store_dword v12,v1,s[8:11],s60 offen sc1
s_add_u32 s60,s33,245760
buffer_store_dword v12,v1,s[8:11],s60 offen sc1
s_add_u32 s60,s33,294912
buffer_store_dword v12,v1,s[8:11],s60 offen sc1
s_add_u32 s60,s33,344064
buffer_store_dword v12,v1,s[8:11],s60 offen sc1
s_mov_b64 exec,1
buffer_store_dword v13,v1,s[8:11],s35 offen sc1
buffer_store_dword v13,v1,s[8:11],s35 offen offset:512 sc1
s_mov_b64 exec,-1
ls_3:
si_1:
s_mul_i32 s73,s48,384
s_mov_b32 s74,s73
v_add_u32 v12,0,v0
v_mul_u32_u24 v13,2731,v12
v_lshrrev_b32 v13,16,v13
v_mul_u32_u24 v16,24,v13
v_sub_u32 v12,v12,v16
v_mul_u32_u24 v104,12288,v13
v_lshl_add_u32 v104,v12,4,v104
v_add_u32 v12,64,v0
v_mul_u32_u24 v13,2731,v12
v_lshrrev_b32 v13,16,v13
v_mul_u32_u24 v16,24,v13
v_sub_u32 v12,v12,v16
v_mul_u32_u24 v105,12288,v13
v_lshl_add_u32 v105,v12,4,v105
v_add_u32 v12,128,v0
v_mul_u32_u24 v13,2731,v12
v_lshrrev_b32 v13,16,v13
v_mul_u32_u24 v16,24,v13
v_sub_u32 v12,v12,v16
v_mul_u32_u24 v106,12288,v13
v_lshl_add_u32 v106,v12,4,v106
s_mov_b32 s4,s20
s_mov_b32 s5,s21
s_mov_b32 s6,7864320
s_mov_b32 s7,0x20000
s_mov_b32 s52,s22
s_mov_b32 s53,s23
s_mov_b32 s54,7864320
s_mov_b32 s55,0x20000
s_branch SV_LOAD
ROLE_CV:
s_lshr_b32 s28,s48,3
s_and_b32 s29,s48,7
s_mul_i32 s82,s28,2097152
s_add_u32 s82,s82,2097152
v_lshlrev_b32 v1,4,v0
v_and_b32 v12,1,v0
v_mul_u32_u24 v2,0xaaaa,v12
v_or_b32 v2,0x4444,v2
s_add_u32 s60,s46,1
s_and_b32 s60,s60,3
s_lshl_b32 s60,s60,11
s_add_u32 s60,s60,131072
v_add_u32 v3,s60,v1
s_add_u32 s60,s46,2
s_and_b32 s60,s60,3
s_lshl_b32 s60,s60,11
s_add_u32 s60,s60,131072
v_add_u32 v4,s60,v1
s_add_u32 s60,s46,3
s_and_b32 s60,s60,3
s_lshl_b32 s60,s60,11
s_add_u32 s60,s60,131072
v_add_u32 v5,s60,v1
v_add_u32 v59,139264,v1
s_lshl_b32 s60,s46,11
s_add_u32 s60,s60,131072
v_add_u32 v22,s60,v1
s_lshr_b32 s60,s46,1
s_lshl_b32 s60,s60,10
s_and_b32 s61,s46,1
s_lshl_b32 s61,s61,3
s_add_u32 s60,s60,s61
v_add_u32 v23,s60,v59
s_mul_i32 s60,s46,20480
v_add_u32 v21,s60,v1
v_and_b32 v11,7,v0
v_lshlrev_b32 v11,2,v11
v_bfe_u32 v12,v0,3,2
v_lshl_add_u32 v11,v12,7,v11
s_xor_b32 s60,s28,1
s_lshl_b32 s60,s60,19
s_lshl_b32 s61,s46,11
s_add_u32 s83,s60,s61
s_add_u32 s83,s83,10485760
s_mov_b32 s36,1
v_lshlrev_b32 v8,3,v0
v_lshlrev_b32 v9,3,v0
v_lshlrev_b32 v20,3,v0
s_and_b32 s62,s46,1
s_lshl_b32 s60,s62,11
v_add_u32 v6,s60,v1
s_lshl_b32 s60,s62,3
s_add_u32 s60,s60,1024
v_add_u32 v7,s60,v1
s_lshr_b32 s61,s46,1
s_lshl_b32 s60,s29,1
s_add_u32 s60,s60,s61
s_mul_i32 s60,s60,3072
s_add_u32 s60,s60,s82
s_add_u32 s34,s60,557056
s_lshl_b32 s60,s48,1
s_add_u32 s60,s60,s61
s_mul_i32 s85,s60,6144
s_add_u32 s85,s85,24120320
s_lshl_b32 s86,s60,5
s_lshl_b32 s61,s62,2
s_add_u32 s86,s86,s61
s_add_u32 s86,s86,688132
v_mov_b32 v12,-1
v_mov_b32 v13,-1
v_mov_b32 v14,-1
v_mov_b32 v15,-1
s_cmp_lg_u32 s49,0
s_cbranch_scc1 ls_4
s_add_u32 s60,s34,0
buffer_store_dwordx4 v[12:15],v6,s[8:11],s60 offen
buffer_store_dwordx2 v[12:13],v7,s[8:11],s60 offen
s_add_u32 s60,s34,49152
buffer_store_dwordx4 v[12:15],v6,s[8:11],s60 offen
buffer_store_dwordx2 v[12:13],v7,s[8:11],s60 offen
s_add_u32 s60,s34,98304
buffer_store_dwordx4 v[12:15],v6,s[8:11],s60 offen
buffer_store_dwordx2 v[12:13],v7,s[8:11],s60 offen
s_add_u32 s60,s34,147456
buffer_store_dwordx4 v[12:15],v6,s[8:11],s60 offen
buffer_store_dwordx2 v[12:13],v7,s[8:11],s60 offen
s_add_u32 s60,s34,196608
buffer_store_dwordx4 v[12:15],v6,s[8:11],s60 offen
buffer_store_dwordx2 v[12:13],v7,s[8:11],s60 offen
s_add_u32 s60,s34,245760
buffer_store_dwordx4 v[12:15],v6,s[8:11],s60 offen
buffer_store_dwordx2 v[12:13],v7,s[8:11],s60 offen
s_add_u32 s60,s34,294912
buffer_store_dwordx4 v[12:15],v6,s[8:11],s60 offen
buffer_store_dwordx2 v[12:13],v7,s[8:11],s60 offen
s_add_u32 s60,s34,344064
buffer_store_dwordx4 v[12:15],v6,s[8:11],s60 offen
buffer_store_dwordx2 v[12:13],v7,s[8:11],s60 offen
s_branch ls_5
ls_4:
s_add_u32 s60,s34,0
buffer_store_dwordx4 v[12:15],v6,s[8:11],s60 offen sc1
buffer_store_dwordx2 v[12:13],v7,s[8:11],s60 offen sc1
s_add_u32 s60,s34,49152
buffer_store_dwordx4 v[12:15],v6,s[8:11],s60 offen sc1
buffer_store_dwordx2 v[12:13],v7,s[8:11],s60 offen sc1
s_add_u32 s60,s34,98304
buffer_store_dwordx4 v[12:15],v6,s[8:11],s60 offen sc1
buffer_store_dwordx2 v[12:13],v7,s[8:11],s60 offen sc1
s_add_u32 s60,s34,147456
buffer_store_dwordx4 v[12:15],v6,s[8:11],s60 offen sc1
buffer_store_dwordx2 v[12:13],v7,s[8:11],s60 offen sc1
s_add_u32 s60,s34,196608
buffer_store_dwordx4 v[12:15],v6,s[8:11],s60 offen sc1
buffer_store_dwordx2 v[12:13],v7,s[8:11],s60 offen sc1
s_add_u32 s60,s34,245760
buffer_store_dwordx4 v[12:15],v6,s[8:11],s60 offen sc1
buffer_store_dwordx2 v[12:13],v7,s[8:11],s60 offen sc1
s_add_u32 s60,s34,294912
buffer_store_dwordx4 v[12:15],v6,s[8:11],s60 offen sc1
buffer_store_dwordx2 v[12:13],v7,s[8:11],s60 offen sc1
s_add_u32 s60,s34,344064
buffer_store_dwordx4 v[12:15],v6,s[8:11],s60 offen sc1
buffer_store_dwordx2 v[12:13],v7,s[8:11],s60 offen sc1
s_nop 0
ls_5:
s_mul_i32 s73,s48,768
s_add_u32 s74,s73,96
v_add_u32 v12,0,v0
v_mul_u32_u24 v13,2731,v12
v_lshrrev_b32 v13,16,v13
v_mul_u32_u24 v16,24,v13
v_sub_u32 v12,v12,v16
v_mul_u32_u24 v104,12288,v13
v_lshl_add_u32 v104,v12,4,v104
v_mul_u32_u24 v13,43,v12
v_lshrrev_b32 v13,8,v13
v_mul_u32_u24 v13,96,v13
v_add_u32 v104,v104,v13
v_add_u32 v12,64,v0
v_mul_u32_u24 v13,2731,v12
v_lshrrev_b32 v13,16,v13
v_mul_u32_u24 v16,24,v13
v_sub_u32 v12,v12,v16
v_mul_u32_u24 v105,12288,v13
v_lshl_add_u32 v105,v12,4,v105
v_mul_u32_u24 v13,43,v12
v_lshrrev_b32 v13,8,v13
v_mul_u32_u24 v13,96,v13
v_add_u32 v105,v105,v13
v_add_u32 v12,128,v0
v_mul_u32_u24 v13,2731,v12
v_lshrrev_b32 v13,16,v13
v_mul_u32_u24 v16,24,v13
v_sub_u32 v12,v12,v16
v_mul_u32_u24 v106,12288,v13
v_lshl_add_u32 v106,v12,4,v106
v_mul_u32_u24 v13,43,v12
v_lshrrev_b32 v13,8,v13
v_mul_u32_u24 v13,96,v13
v_add_u32 v106,v106,v13
s_mov_b32 s4,s24
s_mov_b32 s5,s25
s_mov_b32 s6,7864320
s_mov_b32 s7,0x20000
s_mov_b32 s52,s24
s_mov_b32 s53,s25
s_mov_b32 s54,7864320
s_mov_b32 s55,0x20000
SV_LOAD:
s_waitcnt vmcnt(0)
s_barrier
s_cmp_lg_u32 s46,0
s_cbranch_scc1 arr_6
v_mov_b32 v12,1
s_lshl_b32 s3,s49,2
v_mov_b32 v13,s3
s_mov_b64 exec,1
buffer_atomic_add v12,v13,s[12:15],0 offen sc1
s_mov_b64 exec,-1
arr_6:
s_and_b32 s60,s46,1
s_mul_i32 s60,s60,196608
s_lshr_b32 s61,s46,1
s_mul_i32 s75,s61,393216
s_add_u32 s75,s75,s60
s_mul_i32 s76,s61,393216
s_add_u32 s76,s76,s60
s_mul_i32 s77,s46,6144
v_lshrrev_b32 v14,4,v0
v_and_b32 v15,15,v0
v_and_b32 v12,1,v14
v_lshlrev_b32 v12,2,v12
v_lshrrev_b32 v13,1,v14
v_lshl_add_u32 v12,v13,4,v12
v_bfe_u32 v13,v0,2,1
v_add_u32 v12,v12,v13
v_bfe_u32 v13,v0,3,1
v_lshl_add_u32 v12,v13,3,v12
v_mul_u32_u24 v107,384,v12
v_and_b32 v13,3,v0
v_lshl_add_u32 v107,v13,3,v107
s_mul_i32 s60,s46,96
v_add_u32 v107,s60,v107
s_add_u32 s60,s75,s73
s_add_u32 m0,s77,0
s_add_u32 s61,s60,0
buffer_load_dwordx4 v104,s[4:7],s61 offen lds
s_add_u32 m0,s77,1024
s_add_u32 s61,s60,0
buffer_load_dwordx4 v105,s[4:7],s61 offen lds
s_add_u32 m0,s77,2048
s_add_u32 s61,s60,0
buffer_load_dwordx4 v106,s[4:7],s61 offen lds
s_add_u32 m0,s77,3072
s_add_u32 s61,s60,98304
buffer_load_dwordx4 v104,s[4:7],s61 offen lds
s_add_u32 m0,s77,4096
s_add_u32 s61,s60,98304
buffer_load_dwordx4 v105,s[4:7],s61 offen lds
s_add_u32 m0,s77,5120
s_add_u32 s61,s60,98304
buffer_load_dwordx4 v106,s[4:7],s61 offen lds
s_add_u32 s60,s75,s74
s_add_u32 m0,s77,24576
s_add_u32 s61,s60,0
buffer_load_dwordx4 v104,s[52:55],s61 offen lds
s_add_u32 m0,s77,25600
s_add_u32 s61,s60,0
buffer_load_dwordx4 v105,s[52:55],s61 offen lds
s_add_u32 m0,s77,26624
s_add_u32 s61,s60,0
buffer_load_dwordx4 v106,s[52:55],s61 offen lds
s_add_u32 m0,s77,27648
s_add_u32 s61,s60,98304
buffer_load_dwordx4 v104,s[52:55],s61 offen lds
s_add_u32 m0,s77,28672
s_add_u32 s61,s60,98304
buffer_load_dwordx4 v105,s[52:55],s61 offen lds
s_add_u32 m0,s77,29696
s_add_u32 s61,s60,98304
buffer_load_dwordx4 v106,s[52:55],s61 offen lds
s_add_u32 s60,s75,s73
s_add_u32 m0,s77,49152
s_add_u32 s61,s60,786432
buffer_load_dwordx4 v104,s[4:7],s61 offen lds
s_add_u32 m0,s77,50176
s_add_u32 s61,s60,786432
buffer_load_dwordx4 v105,s[4:7],s61 offen lds
s_add_u32 m0,s77,51200
s_add_u32 s61,s60,786432
buffer_load_dwordx4 v106,s[4:7],s61 offen lds
s_add_u32 m0,s77,52224
s_add_u32 s61,s60,884736
buffer_load_dwordx4 v104,s[4:7],s61 offen lds
s_add_u32 m0,s77,53248
s_add_u32 s61,s60,884736
buffer_load_dwordx4 v105,s[4:7],s61 offen lds
s_add_u32 m0,s77,54272
s_add_u32 s61,s60,884736
buffer_load_dwordx4 v106,s[4:7],s61 offen lds
s_add_u32 s60,s75,s74
s_add_u32 m0,s77,73728
s_add_u32 s61,s60,786432
buffer_load_dwordx4 v104,s[52:55],s61 offen lds
s_add_u32 m0,s77,74752
s_add_u32 s61,s60,786432
buffer_load_dwordx4 v105,s[52:55],s61 offen lds
s_add_u32 m0,s77,75776
s_add_u32 s61,s60,786432
buffer_load_dwordx4 v106,s[52:55],s61 offen lds
s_add_u32 m0,s77,76800
s_add_u32 s61,s60,884736
buffer_load_dwordx4 v104,s[52:55],s61 offen lds
s_add_u32 m0,s77,77824
s_add_u32 s61,s60,884736
buffer_load_dwordx4 v105,s[52:55],s61 offen lds
s_add_u32 m0,s77,78848
s_add_u32 s61,s60,884736
buffer_load_dwordx4 v106,s[52:55],s61 offen lds
s_add_u32 s60,s75,s73
s_add_u32 m0,s77,98304
s_add_u32 s61,s60,1572864
buffer_load_dwordx4 v104,s[4:7],s61 offen lds
s_add_u32 m0,s77,99328
s_add_u32 s61,s60,1572864
buffer_load_dwordx4 v105,s[4:7],s61 offen lds
s_add_u32 m0,s77,100352
s_add_u32 s61,s60,1572864
buffer_load_dwordx4 v106,s[4:7],s61 offen lds
s_add_u32 m0,s77,101376
s_add_u32 s61,s60,1671168
buffer_load_dwordx4 v104,s[4:7],s61 offen lds
s_add_u32 m0,s77,102400
s_add_u32 s61,s60,1671168
buffer_load_dwordx4 v105,s[4:7],s61 offen lds
s_add_u32 m0,s77,103424
s_add_u32 s61,s60,1671168
buffer_load_dwordx4 v106,s[4:7],s61 offen lds
s_waitcnt vmcnt(24)
s_barrier
s_add_u32 s60,s75,s74
s_add_u32 m0,s77,122880
s_add_u32 s61,s60,1572864
buffer_load_dwordx4 v104,s[52:55],s61 offen lds
s_add_u32 m0,s77,123904
s_add_u32 s61,s60,1572864
buffer_load_dwordx4 v105,s[52:55],s61 offen lds
s_add_u32 m0,s77,124928
s_add_u32 s61,s60,1572864
buffer_load_dwordx4 v106,s[52:55],s61 offen lds
s_add_u32 m0,s77,125952
s_add_u32 s61,s60,1671168
buffer_load_dwordx4 v104,s[52:55],s61 offen lds
s_add_u32 m0,s77,126976
s_add_u32 s61,s60,1671168
buffer_load_dwordx4 v105,s[52:55],s61 offen lds
s_add_u32 m0,s77,128000
s_add_u32 s61,s60,1671168
buffer_load_dwordx4 v106,s[52:55],s61 offen lds
v_add_u32 v12,0,v107
s_cmp_eq_u32 s46,1
s_cbranch_scc1 lw_9
s_cmp_eq_u32 s46,2
s_cbranch_scc1 lw_10
s_cmp_eq_u32 s46,3
s_cbranch_scc1 lw_11
lw_8:
ds_read_b64_tr_b16 a[0:1],v12 offset:0
ds_read_b64_tr_b16 a[2:3],v12 offset:768
ds_read_b64_tr_b16 a[4:5],v12 offset:12288
ds_read_b64_tr_b16 a[6:7],v12 offset:13056
ds_read_b64_tr_b16 a[8:9],v12 offset:32
ds_read_b64_tr_b16 a[10:11],v12 offset:800
ds_read_b64_tr_b16 a[12:13],v12 offset:12320
ds_read_b64_tr_b16 a[14:15],v12 offset:13088
ds_read_b64_tr_b16 a[16:17],v12 offset:64
ds_read_b64_tr_b16 a[18:19],v12 offset:832
ds_read_b64_tr_b16 a[20:21],v12 offset:12352
ds_read_b64_tr_b16 a[22:23],v12 offset:13120
s_branch ld_7
lw_9:
ds_read_b64_tr_b16 a[240:241],v12 offset:0
ds_read_b64_tr_b16 a[242:243],v12 offset:768
ds_read_b64_tr_b16 a[244:245],v12 offset:12288
ds_read_b64_tr_b16 a[246:247],v12 offset:13056
ds_read_b64_tr_b16 a[248:249],v12 offset:32
ds_read_b64_tr_b16 a[250:251],v12 offset:800
ds_read_b64_tr_b16 a[252:253],v12 offset:12320
ds_read_b64_tr_b16 a[254:255],v12 offset:13088
ds_read_b64_tr_b16 v[112:113],v12 offset:64
ds_read_b64_tr_b16 v[114:115],v12 offset:832
ds_read_b64_tr_b16 v[116:117],v12 offset:12352
ds_read_b64_tr_b16 v[118:119],v12 offset:13120
s_branch ld_7
lw_10:
ds_read_b64_tr_b16 a[160:161],v12 offset:0
ds_read_b64_tr_b16 a[162:163],v12 offset:768
ds_read_b64_tr_b16 a[164:165],v12 offset:12288
ds_read_b64_tr_b16 a[166:167],v12 offset:13056
ds_read_b64_tr_b16 a[168:169],v12 offset:32
ds_read_b64_tr_b16 a[170:171],v12 offset:800
ds_read_b64_tr_b16 a[172:173],v12 offset:12320
ds_read_b64_tr_b16 a[174:175],v12 offset:13088
ds_read_b64_tr_b16 a[176:177],v12 offset:64
ds_read_b64_tr_b16 a[178:179],v12 offset:832
ds_read_b64_tr_b16 a[180:181],v12 offset:12352
ds_read_b64_tr_b16 a[182:183],v12 offset:13120
s_branch ld_7
lw_11:
ds_read_b64_tr_b16 a[80:81],v12 offset:0
ds_read_b64_tr_b16 a[82:83],v12 offset:768
ds_read_b64_tr_b16 a[84:85],v12 offset:12288
ds_read_b64_tr_b16 a[86:87],v12 offset:13056
ds_read_b64_tr_b16 a[88:89],v12 offset:32
ds_read_b64_tr_b16 a[90:91],v12 offset:800
ds_read_b64_tr_b16 a[92:93],v12 offset:12320
ds_read_b64_tr_b16 a[94:95],v12 offset:13088
ds_read_b64_tr_b16 a[96:97],v12 offset:64
ds_read_b64_tr_b16 a[98:99],v12 offset:832
ds_read_b64_tr_b16 a[100:101],v12 offset:12352
ds_read_b64_tr_b16 a[102:103],v12 offset:13120
ld_7:
s_waitcnt lgkmcnt(0)
s_waitcnt vmcnt(24)
s_barrier
s_add_u32 s60,s75,s73
s_add_u32 m0,s77,0
s_add_u32 s61,s60,2359296
buffer_load_dwordx4 v104,s[4:7],s61 offen lds
s_add_u32 m0,s77,1024
s_add_u32 s61,s60,2359296
buffer_load_dwordx4 v105,s[4:7],s61 offen lds
s_add_u32 m0,s77,2048
s_add_u32 s61,s60,2359296
buffer_load_dwordx4 v106,s[4:7],s61 offen lds
s_add_u32 m0,s77,3072
s_add_u32 s61,s60,2457600
buffer_load_dwordx4 v104,s[4:7],s61 offen lds
s_add_u32 m0,s77,4096
s_add_u32 s61,s60,2457600
buffer_load_dwordx4 v105,s[4:7],s61 offen lds
s_add_u32 m0,s77,5120
s_add_u32 s61,s60,2457600
buffer_load_dwordx4 v106,s[4:7],s61 offen lds
v_add_u32 v12,24576,v107
s_cmp_eq_u32 s46,1
s_cbranch_scc1 lw_14
s_cmp_eq_u32 s46,2
s_cbranch_scc1 lw_15
s_cmp_eq_u32 s46,3
s_cbranch_scc1 lw_16
lw_13:
ds_read_b64_tr_b16 a[24:25],v12 offset:0
ds_read_b64_tr_b16 a[26:27],v12 offset:768
ds_read_b64_tr_b16 a[28:29],v12 offset:12288
ds_read_b64_tr_b16 a[30:31],v12 offset:13056
ds_read_b64_tr_b16 a[32:33],v12 offset:32
ds_read_b64_tr_b16 a[34:35],v12 offset:800
ds_read_b64_tr_b16 a[36:37],v12 offset:12320
ds_read_b64_tr_b16 a[38:39],v12 offset:13088
ds_read_b64_tr_b16 v[24:25],v12 offset:64
ds_read_b64_tr_b16 v[26:27],v12 offset:832
ds_read_b64_tr_b16 v[28:29],v12 offset:12352
ds_read_b64_tr_b16 v[30:31],v12 offset:13120
s_branch ld_12
lw_14:
ds_read_b64_tr_b16 v[120:121],v12 offset:0
ds_read_b64_tr_b16 v[122:123],v12 offset:768
ds_read_b64_tr_b16 v[124:125],v12 offset:12288
ds_read_b64_tr_b16 v[126:127],v12 offset:13056
ds_read_b64_tr_b16 v[128:129],v12 offset:32
ds_read_b64_tr_b16 v[130:131],v12 offset:800
ds_read_b64_tr_b16 v[132:133],v12 offset:12320
ds_read_b64_tr_b16 v[134:135],v12 offset:13088
ds_read_b64_tr_b16 v[72:73],v12 offset:64
ds_read_b64_tr_b16 v[74:75],v12 offset:832
ds_read_b64_tr_b16 v[76:77],v12 offset:12352
ds_read_b64_tr_b16 v[78:79],v12 offset:13120
s_branch ld_12
lw_15:
ds_read_b64_tr_b16 a[184:185],v12 offset:0
ds_read_b64_tr_b16 a[186:187],v12 offset:768
ds_read_b64_tr_b16 a[188:189],v12 offset:12288
ds_read_b64_tr_b16 a[190:191],v12 offset:13056
ds_read_b64_tr_b16 a[192:193],v12 offset:32
ds_read_b64_tr_b16 a[194:195],v12 offset:800
ds_read_b64_tr_b16 a[196:197],v12 offset:12320
ds_read_b64_tr_b16 a[198:199],v12 offset:13088
ds_read_b64_tr_b16 v[56:57],v12 offset:64
ds_read_b64_tr_b16 v[58:59],v12 offset:832
ds_read_b64_tr_b16 v[60:61],v12 offset:12352
ds_read_b64_tr_b16 v[62:63],v12 offset:13120
s_branch ld_12
lw_16:
ds_read_b64_tr_b16 a[104:105],v12 offset:0
ds_read_b64_tr_b16 a[106:107],v12 offset:768
ds_read_b64_tr_b16 a[108:109],v12 offset:12288
ds_read_b64_tr_b16 a[110:111],v12 offset:13056
ds_read_b64_tr_b16 a[112:113],v12 offset:32
ds_read_b64_tr_b16 a[114:115],v12 offset:800
ds_read_b64_tr_b16 a[116:117],v12 offset:12320
ds_read_b64_tr_b16 a[118:119],v12 offset:13088
ds_read_b64_tr_b16 v[40:41],v12 offset:64
ds_read_b64_tr_b16 v[42:43],v12 offset:832
ds_read_b64_tr_b16 v[44:45],v12 offset:12352
ds_read_b64_tr_b16 v[46:47],v12 offset:13120
ld_12:
s_waitcnt lgkmcnt(0)
s_waitcnt vmcnt(24)
s_barrier
s_add_u32 s60,s75,s74
s_add_u32 m0,s77,24576
s_add_u32 s61,s60,2359296
buffer_load_dwordx4 v104,s[52:55],s61 offen lds
s_add_u32 m0,s77,25600
s_add_u32 s61,s60,2359296
buffer_load_dwordx4 v105,s[52:55],s61 offen lds
s_add_u32 m0,s77,26624
s_add_u32 s61,s60,2359296
buffer_load_dwordx4 v106,s[52:55],s61 offen lds
s_add_u32 m0,s77,27648
s_add_u32 s61,s60,2457600
buffer_load_dwordx4 v104,s[52:55],s61 offen lds
s_add_u32 m0,s77,28672
s_add_u32 s61,s60,2457600
buffer_load_dwordx4 v105,s[52:55],s61 offen lds
s_add_u32 m0,s77,29696
s_add_u32 s61,s60,2457600
buffer_load_dwordx4 v106,s[52:55],s61 offen lds
v_add_u32 v12,49152,v107
s_cmp_eq_u32 s46,1
s_cbranch_scc1 lw_19
s_cmp_eq_u32 s46,2
s_cbranch_scc1 lw_20
s_cmp_eq_u32 s46,3
s_cbranch_scc1 lw_21
lw_18:
ds_read_b64_tr_b16 a[40:41],v12 offset:0
ds_read_b64_tr_b16 a[42:43],v12 offset:768
ds_read_b64_tr_b16 a[44:45],v12 offset:12288
ds_read_b64_tr_b16 a[46:47],v12 offset:13056
ds_read_b64_tr_b16 a[48:49],v12 offset:32
ds_read_b64_tr_b16 a[50:51],v12 offset:800
ds_read_b64_tr_b16 a[52:53],v12 offset:12320
ds_read_b64_tr_b16 a[54:55],v12 offset:13088
ds_read_b64_tr_b16 a[56:57],v12 offset:64
ds_read_b64_tr_b16 a[58:59],v12 offset:832
ds_read_b64_tr_b16 a[60:61],v12 offset:12352
ds_read_b64_tr_b16 a[62:63],v12 offset:13120
s_branch ld_17
lw_19:
ds_read_b64_tr_b16 v[136:137],v12 offset:0
ds_read_b64_tr_b16 v[138:139],v12 offset:768
ds_read_b64_tr_b16 v[140:141],v12 offset:12288
ds_read_b64_tr_b16 v[142:143],v12 offset:13056
ds_read_b64_tr_b16 v[144:145],v12 offset:32
ds_read_b64_tr_b16 v[146:147],v12 offset:800
ds_read_b64_tr_b16 v[148:149],v12 offset:12320
ds_read_b64_tr_b16 v[150:151],v12 offset:13088
ds_read_b64_tr_b16 v[152:153],v12 offset:64
ds_read_b64_tr_b16 v[154:155],v12 offset:832
ds_read_b64_tr_b16 v[156:157],v12 offset:12352
ds_read_b64_tr_b16 v[158:159],v12 offset:13120
s_branch ld_17
lw_20:
ds_read_b64_tr_b16 a[200:201],v12 offset:0
ds_read_b64_tr_b16 a[202:203],v12 offset:768
ds_read_b64_tr_b16 a[204:205],v12 offset:12288
ds_read_b64_tr_b16 a[206:207],v12 offset:13056
ds_read_b64_tr_b16 a[208:209],v12 offset:32
ds_read_b64_tr_b16 a[210:211],v12 offset:800
ds_read_b64_tr_b16 a[212:213],v12 offset:12320
ds_read_b64_tr_b16 a[214:215],v12 offset:13088
ds_read_b64_tr_b16 a[216:217],v12 offset:64
ds_read_b64_tr_b16 a[218:219],v12 offset:832
ds_read_b64_tr_b16 a[220:221],v12 offset:12352
ds_read_b64_tr_b16 a[222:223],v12 offset:13120
s_branch ld_17
lw_21:
ds_read_b64_tr_b16 a[120:121],v12 offset:0
ds_read_b64_tr_b16 a[122:123],v12 offset:768
ds_read_b64_tr_b16 a[124:125],v12 offset:12288
ds_read_b64_tr_b16 a[126:127],v12 offset:13056
ds_read_b64_tr_b16 a[128:129],v12 offset:32
ds_read_b64_tr_b16 a[130:131],v12 offset:800
ds_read_b64_tr_b16 a[132:133],v12 offset:12320
ds_read_b64_tr_b16 a[134:135],v12 offset:13088
ds_read_b64_tr_b16 a[136:137],v12 offset:64
ds_read_b64_tr_b16 a[138:139],v12 offset:832
ds_read_b64_tr_b16 a[140:141],v12 offset:12352
ds_read_b64_tr_b16 a[142:143],v12 offset:13120
ld_17:
s_waitcnt lgkmcnt(0)
s_waitcnt vmcnt(24)
s_barrier
s_add_u32 s60,s75,s73
s_add_u32 m0,s77,49152
s_add_u32 s61,s60,3145728
buffer_load_dwordx4 v104,s[4:7],s61 offen lds
s_add_u32 m0,s77,50176
s_add_u32 s61,s60,3145728
buffer_load_dwordx4 v105,s[4:7],s61 offen lds
s_add_u32 m0,s77,51200
s_add_u32 s61,s60,3145728
buffer_load_dwordx4 v106,s[4:7],s61 offen lds
s_add_u32 m0,s77,52224
s_add_u32 s61,s60,3244032
buffer_load_dwordx4 v104,s[4:7],s61 offen lds
s_add_u32 m0,s77,53248
s_add_u32 s61,s60,3244032
buffer_load_dwordx4 v105,s[4:7],s61 offen lds
s_add_u32 m0,s77,54272
s_add_u32 s61,s60,3244032
buffer_load_dwordx4 v106,s[4:7],s61 offen lds
v_add_u32 v12,73728,v107
s_cmp_eq_u32 s46,1
s_cbranch_scc1 lw_24
s_cmp_eq_u32 s46,2
s_cbranch_scc1 lw_25
s_cmp_eq_u32 s46,3
s_cbranch_scc1 lw_26
lw_23:
ds_read_b64_tr_b16 a[64:65],v12 offset:0
ds_read_b64_tr_b16 a[66:67],v12 offset:768
ds_read_b64_tr_b16 a[68:69],v12 offset:12288
ds_read_b64_tr_b16 a[70:71],v12 offset:13056
ds_read_b64_tr_b16 a[72:73],v12 offset:32
ds_read_b64_tr_b16 a[74:75],v12 offset:800
ds_read_b64_tr_b16 a[76:77],v12 offset:12320
ds_read_b64_tr_b16 a[78:79],v12 offset:13088
ds_read_b64_tr_b16 v[32:33],v12 offset:64
ds_read_b64_tr_b16 v[34:35],v12 offset:832
ds_read_b64_tr_b16 v[36:37],v12 offset:12352
ds_read_b64_tr_b16 v[38:39],v12 offset:13120
s_branch ld_22
lw_24:
ds_read_b64_tr_b16 v[160:161],v12 offset:0
ds_read_b64_tr_b16 v[162:163],v12 offset:768
ds_read_b64_tr_b16 v[164:165],v12 offset:12288
ds_read_b64_tr_b16 v[166:167],v12 offset:13056
ds_read_b64_tr_b16 v[168:169],v12 offset:32
ds_read_b64_tr_b16 v[170:171],v12 offset:800
ds_read_b64_tr_b16 v[172:173],v12 offset:12320
ds_read_b64_tr_b16 v[174:175],v12 offset:13088
ds_read_b64_tr_b16 v[80:81],v12 offset:64
ds_read_b64_tr_b16 v[82:83],v12 offset:832
ds_read_b64_tr_b16 v[84:85],v12 offset:12352
ds_read_b64_tr_b16 v[86:87],v12 offset:13120
s_branch ld_22
lw_25:
ds_read_b64_tr_b16 a[224:225],v12 offset:0
ds_read_b64_tr_b16 a[226:227],v12 offset:768
ds_read_b64_tr_b16 a[228:229],v12 offset:12288
ds_read_b64_tr_b16 a[230:231],v12 offset:13056
ds_read_b64_tr_b16 a[232:233],v12 offset:32
ds_read_b64_tr_b16 a[234:235],v12 offset:800
ds_read_b64_tr_b16 a[236:237],v12 offset:12320
ds_read_b64_tr_b16 a[238:239],v12 offset:13088
ds_read_b64_tr_b16 v[64:65],v12 offset:64
ds_read_b64_tr_b16 v[66:67],v12 offset:832
ds_read_b64_tr_b16 v[68:69],v12 offset:12352
ds_read_b64_tr_b16 v[70:71],v12 offset:13120
s_branch ld_22
lw_26:
ds_read_b64_tr_b16 a[144:145],v12 offset:0
ds_read_b64_tr_b16 a[146:147],v12 offset:768
ds_read_b64_tr_b16 a[148:149],v12 offset:12288
ds_read_b64_tr_b16 a[150:151],v12 offset:13056
ds_read_b64_tr_b16 a[152:153],v12 offset:32
ds_read_b64_tr_b16 a[154:155],v12 offset:800
ds_read_b64_tr_b16 a[156:157],v12 offset:12320
ds_read_b64_tr_b16 a[158:159],v12 offset:13088
ds_read_b64_tr_b16 v[48:49],v12 offset:64
ds_read_b64_tr_b16 v[50:51],v12 offset:832
ds_read_b64_tr_b16 v[52:53],v12 offset:12352
ds_read_b64_tr_b16 v[54:55],v12 offset:13120
ld_22:
s_waitcnt lgkmcnt(0)
s_waitcnt vmcnt(24)
s_barrier
s_add_u32 s60,s75,s74
s_add_u32 m0,s77,73728
s_add_u32 s61,s60,3145728
buffer_load_dwordx4 v104,s[52:55],s61 offen lds
s_add_u32 m0,s77,74752
s_add_u32 s61,s60,3145728
buffer_load_dwordx4 v105,s[52:55],s61 offen lds
s_add_u32 m0,s77,75776
s_add_u32 s61,s60,3145728
buffer_load_dwordx4 v106,s[52:55],s61 offen lds
s_add_u32 m0,s77,76800
s_add_u32 s61,s60,3244032
buffer_load_dwordx4 v104,s[52:55],s61 offen lds
s_add_u32 m0,s77,77824
s_add_u32 s61,s60,3244032
buffer_load_dwordx4 v105,s[52:55],s61 offen lds
s_add_u32 m0,s77,78848
s_add_u32 s61,s60,3244032
buffer_load_dwordx4 v106,s[52:55],s61 offen lds
v_add_u32 v12,98304,v107
s_cmp_eq_u32 s46,1
s_cbranch_scc1 lw_29
s_cmp_eq_u32 s46,2
s_cbranch_scc1 lw_30
s_cmp_eq_u32 s46,3
s_cbranch_scc1 lw_31
lw_28:
ds_read_b64_tr_b16 a[80:81],v12 offset:0
ds_read_b64_tr_b16 a[82:83],v12 offset:768
ds_read_b64_tr_b16 a[84:85],v12 offset:12288
ds_read_b64_tr_b16 a[86:87],v12 offset:13056
ds_read_b64_tr_b16 a[88:89],v12 offset:32
ds_read_b64_tr_b16 a[90:91],v12 offset:800
ds_read_b64_tr_b16 a[92:93],v12 offset:12320
ds_read_b64_tr_b16 a[94:95],v12 offset:13088
ds_read_b64_tr_b16 a[96:97],v12 offset:64
ds_read_b64_tr_b16 a[98:99],v12 offset:832
ds_read_b64_tr_b16 a[100:101],v12 offset:12352
ds_read_b64_tr_b16 a[102:103],v12 offset:13120
s_branch ld_27
lw_29:
ds_read_b64_tr_b16 a[0:1],v12 offset:0
ds_read_b64_tr_b16 a[2:3],v12 offset:768
ds_read_b64_tr_b16 a[4:5],v12 offset:12288
ds_read_b64_tr_b16 a[6:7],v12 offset:13056
ds_read_b64_tr_b16 a[8:9],v12 offset:32
ds_read_b64_tr_b16 a[10:11],v12 offset:800
ds_read_b64_tr_b16 a[12:13],v12 offset:12320
ds_read_b64_tr_b16 a[14:15],v12 offset:13088
ds_read_b64_tr_b16 a[16:17],v12 offset:64
ds_read_b64_tr_b16 a[18:19],v12 offset:832
ds_read_b64_tr_b16 a[20:21],v12 offset:12352
ds_read_b64_tr_b16 a[22:23],v12 offset:13120
s_branch ld_27
lw_30:
ds_read_b64_tr_b16 a[240:241],v12 offset:0
ds_read_b64_tr_b16 a[242:243],v12 offset:768
ds_read_b64_tr_b16 a[244:245],v12 offset:12288
ds_read_b64_tr_b16 a[246:247],v12 offset:13056
ds_read_b64_tr_b16 a[248:249],v12 offset:32
ds_read_b64_tr_b16 a[250:251],v12 offset:800
ds_read_b64_tr_b16 a[252:253],v12 offset:12320
ds_read_b64_tr_b16 a[254:255],v12 offset:13088
ds_read_b64_tr_b16 v[112:113],v12 offset:64
ds_read_b64_tr_b16 v[114:115],v12 offset:832
ds_read_b64_tr_b16 v[116:117],v12 offset:12352
ds_read_b64_tr_b16 v[118:119],v12 offset:13120
s_branch ld_27
lw_31:
ds_read_b64_tr_b16 a[160:161],v12 offset:0
ds_read_b64_tr_b16 a[162:163],v12 offset:768
ds_read_b64_tr_b16 a[164:165],v12 offset:12288
ds_read_b64_tr_b16 a[166:167],v12 offset:13056
ds_read_b64_tr_b16 a[168:169],v12 offset:32
ds_read_b64_tr_b16 a[170:171],v12 offset:800
ds_read_b64_tr_b16 a[172:173],v12 offset:12320
ds_read_b64_tr_b16 a[174:175],v12 offset:13088
ds_read_b64_tr_b16 a[176:177],v12 offset:64
ds_read_b64_tr_b16 a[178:179],v12 offset:832
ds_read_b64_tr_b16 a[180:181],v12 offset:12352
ds_read_b64_tr_b16 a[182:183],v12 offset:13120
ld_27:
s_waitcnt lgkmcnt(0)
s_waitcnt vmcnt(24)
s_barrier
s_add_u32 s60,s75,s73
s_add_u32 m0,s77,98304
s_add_u32 s61,s60,3932160
buffer_load_dwordx4 v104,s[4:7],s61 offen lds
s_add_u32 m0,s77,99328
s_add_u32 s61,s60,3932160
buffer_load_dwordx4 v105,s[4:7],s61 offen lds
s_add_u32 m0,s77,100352
s_add_u32 s61,s60,3932160
buffer_load_dwordx4 v106,s[4:7],s61 offen lds
s_add_u32 m0,s77,101376
s_add_u32 s61,s60,4030464
buffer_load_dwordx4 v104,s[4:7],s61 offen lds
s_add_u32 m0,s77,102400
s_add_u32 s61,s60,4030464
buffer_load_dwordx4 v105,s[4:7],s61 offen lds
s_add_u32 m0,s77,103424
s_add_u32 s61,s60,4030464
buffer_load_dwordx4 v106,s[4:7],s61 offen lds
v_add_u32 v12,122880,v107
s_cmp_eq_u32 s46,1
s_cbranch_scc1 lw_34
s_cmp_eq_u32 s46,2
s_cbranch_scc1 lw_35
s_cmp_eq_u32 s46,3
s_cbranch_scc1 lw_36
lw_33:
ds_read_b64_tr_b16 a[104:105],v12 offset:0
ds_read_b64_tr_b16 a[106:107],v12 offset:768
ds_read_b64_tr_b16 a[108:109],v12 offset:12288
ds_read_b64_tr_b16 a[110:111],v12 offset:13056
ds_read_b64_tr_b16 a[112:113],v12 offset:32
ds_read_b64_tr_b16 a[114:115],v12 offset:800
ds_read_b64_tr_b16 a[116:117],v12 offset:12320
ds_read_b64_tr_b16 a[118:119],v12 offset:13088
ds_read_b64_tr_b16 v[40:41],v12 offset:64
ds_read_b64_tr_b16 v[42:43],v12 offset:832
ds_read_b64_tr_b16 v[44:45],v12 offset:12352
ds_read_b64_tr_b16 v[46:47],v12 offset:13120
s_branch ld_32
lw_34:
ds_read_b64_tr_b16 a[24:25],v12 offset:0
ds_read_b64_tr_b16 a[26:27],v12 offset:768
ds_read_b64_tr_b16 a[28:29],v12 offset:12288
ds_read_b64_tr_b16 a[30:31],v12 offset:13056
ds_read_b64_tr_b16 a[32:33],v12 offset:32
ds_read_b64_tr_b16 a[34:35],v12 offset:800
ds_read_b64_tr_b16 a[36:37],v12 offset:12320
ds_read_b64_tr_b16 a[38:39],v12 offset:13088
ds_read_b64_tr_b16 v[24:25],v12 offset:64
ds_read_b64_tr_b16 v[26:27],v12 offset:832
ds_read_b64_tr_b16 v[28:29],v12 offset:12352
ds_read_b64_tr_b16 v[30:31],v12 offset:13120
s_branch ld_32
lw_35:
ds_read_b64_tr_b16 v[120:121],v12 offset:0
ds_read_b64_tr_b16 v[122:123],v12 offset:768
ds_read_b64_tr_b16 v[124:125],v12 offset:12288
ds_read_b64_tr_b16 v[126:127],v12 offset:13056
ds_read_b64_tr_b16 v[128:129],v12 offset:32
ds_read_b64_tr_b16 v[130:131],v12 offset:800
ds_read_b64_tr_b16 v[132:133],v12 offset:12320
ds_read_b64_tr_b16 v[134:135],v12 offset:13088
ds_read_b64_tr_b16 v[72:73],v12 offset:64
ds_read_b64_tr_b16 v[74:75],v12 offset:832
ds_read_b64_tr_b16 v[76:77],v12 offset:12352
ds_read_b64_tr_b16 v[78:79],v12 offset:13120
s_branch ld_32
lw_36:
ds_read_b64_tr_b16 a[184:185],v12 offset:0
ds_read_b64_tr_b16 a[186:187],v12 offset:768
ds_read_b64_tr_b16 a[188:189],v12 offset:12288
ds_read_b64_tr_b16 a[190:191],v12 offset:13056
ds_read_b64_tr_b16 a[192:193],v12 offset:32
ds_read_b64_tr_b16 a[194:195],v12 offset:800
ds_read_b64_tr_b16 a[196:197],v12 offset:12320
ds_read_b64_tr_b16 a[198:199],v12 offset:13088
ds_read_b64_tr_b16 v[56:57],v12 offset:64
ds_read_b64_tr_b16 v[58:59],v12 offset:832
ds_read_b64_tr_b16 v[60:61],v12 offset:12352
ds_read_b64_tr_b16 v[62:63],v12 offset:13120
ld_32:
s_waitcnt lgkmcnt(0)
s_waitcnt vmcnt(24)
s_barrier
s_add_u32 s60,s75,s74
s_add_u32 m0,s77,122880
s_add_u32 s61,s60,3932160
buffer_load_dwordx4 v104,s[52:55],s61 offen lds
s_add_u32 m0,s77,123904
s_add_u32 s61,s60,3932160
buffer_load_dwordx4 v105,s[52:55],s61 offen lds
s_add_u32 m0,s77,124928
s_add_u32 s61,s60,3932160
buffer_load_dwordx4 v106,s[52:55],s61 offen lds
s_add_u32 m0,s77,125952
s_add_u32 s61,s60,4030464
buffer_load_dwordx4 v104,s[52:55],s61 offen lds
s_add_u32 m0,s77,126976
s_add_u32 s61,s60,4030464
buffer_load_dwordx4 v105,s[52:55],s61 offen lds
s_add_u32 m0,s77,128000
s_add_u32 s61,s60,4030464
buffer_load_dwordx4 v106,s[52:55],s61 offen lds
v_add_u32 v12,0,v107
s_cmp_eq_u32 s46,1
s_cbranch_scc1 lw_39
s_cmp_eq_u32 s46,2
s_cbranch_scc1 lw_40
s_cmp_eq_u32 s46,3
s_cbranch_scc1 lw_41
lw_38:
ds_read_b64_tr_b16 a[120:121],v12 offset:0
ds_read_b64_tr_b16 a[122:123],v12 offset:768
ds_read_b64_tr_b16 a[124:125],v12 offset:12288
ds_read_b64_tr_b16 a[126:127],v12 offset:13056
ds_read_b64_tr_b16 a[128:129],v12 offset:32
ds_read_b64_tr_b16 a[130:131],v12 offset:800
ds_read_b64_tr_b16 a[132:133],v12 offset:12320
ds_read_b64_tr_b16 a[134:135],v12 offset:13088
ds_read_b64_tr_b16 a[136:137],v12 offset:64
ds_read_b64_tr_b16 a[138:139],v12 offset:832
ds_read_b64_tr_b16 a[140:141],v12 offset:12352
ds_read_b64_tr_b16 a[142:143],v12 offset:13120
s_branch ld_37
lw_39:
ds_read_b64_tr_b16 a[40:41],v12 offset:0
ds_read_b64_tr_b16 a[42:43],v12 offset:768
ds_read_b64_tr_b16 a[44:45],v12 offset:12288
ds_read_b64_tr_b16 a[46:47],v12 offset:13056
ds_read_b64_tr_b16 a[48:49],v12 offset:32
ds_read_b64_tr_b16 a[50:51],v12 offset:800
ds_read_b64_tr_b16 a[52:53],v12 offset:12320
ds_read_b64_tr_b16 a[54:55],v12 offset:13088
ds_read_b64_tr_b16 a[56:57],v12 offset:64
ds_read_b64_tr_b16 a[58:59],v12 offset:832
ds_read_b64_tr_b16 a[60:61],v12 offset:12352
ds_read_b64_tr_b16 a[62:63],v12 offset:13120
s_branch ld_37
lw_40:
ds_read_b64_tr_b16 v[136:137],v12 offset:0
ds_read_b64_tr_b16 v[138:139],v12 offset:768
ds_read_b64_tr_b16 v[140:141],v12 offset:12288
ds_read_b64_tr_b16 v[142:143],v12 offset:13056
ds_read_b64_tr_b16 v[144:145],v12 offset:32
ds_read_b64_tr_b16 v[146:147],v12 offset:800
ds_read_b64_tr_b16 v[148:149],v12 offset:12320
ds_read_b64_tr_b16 v[150:151],v12 offset:13088
ds_read_b64_tr_b16 v[152:153],v12 offset:64
ds_read_b64_tr_b16 v[154:155],v12 offset:832
ds_read_b64_tr_b16 v[156:157],v12 offset:12352
ds_read_b64_tr_b16 v[158:159],v12 offset:13120
s_branch ld_37
lw_41:
ds_read_b64_tr_b16 a[200:201],v12 offset:0
ds_read_b64_tr_b16 a[202:203],v12 offset:768
ds_read_b64_tr_b16 a[204:205],v12 offset:12288
ds_read_b64_tr_b16 a[206:207],v12 offset:13056
ds_read_b64_tr_b16 a[208:209],v12 offset:32
ds_read_b64_tr_b16 a[210:211],v12 offset:800
ds_read_b64_tr_b16 a[212:213],v12 offset:12320
ds_read_b64_tr_b16 a[214:215],v12 offset:13088
ds_read_b64_tr_b16 a[216:217],v12 offset:64
ds_read_b64_tr_b16 a[218:219],v12 offset:832
ds_read_b64_tr_b16 a[220:221],v12 offset:12352
ds_read_b64_tr_b16 a[222:223],v12 offset:13120
ld_37:
s_waitcnt lgkmcnt(0)
s_waitcnt vmcnt(24)
s_barrier
s_add_u32 s60,s75,s73
s_add_u32 m0,s77,0
s_add_u32 s61,s60,4718592
buffer_load_dwordx4 v104,s[4:7],s61 offen lds
s_add_u32 m0,s77,1024
s_add_u32 s61,s60,4718592
buffer_load_dwordx4 v105,s[4:7],s61 offen lds
s_add_u32 m0,s77,2048
s_add_u32 s61,s60,4718592
buffer_load_dwordx4 v106,s[4:7],s61 offen lds
s_add_u32 m0,s77,3072
s_add_u32 s61,s60,4816896
buffer_load_dwordx4 v104,s[4:7],s61 offen lds
s_add_u32 m0,s77,4096
s_add_u32 s61,s60,4816896
buffer_load_dwordx4 v105,s[4:7],s61 offen lds
s_add_u32 m0,s77,5120
s_add_u32 s61,s60,4816896
buffer_load_dwordx4 v106,s[4:7],s61 offen lds
v_add_u32 v12,24576,v107
s_cmp_eq_u32 s46,1
s_cbranch_scc1 lw_44
s_cmp_eq_u32 s46,2
s_cbranch_scc1 lw_45
s_cmp_eq_u32 s46,3
s_cbranch_scc1 lw_46
lw_43:
ds_read_b64_tr_b16 a[144:145],v12 offset:0
ds_read_b64_tr_b16 a[146:147],v12 offset:768
ds_read_b64_tr_b16 a[148:149],v12 offset:12288
ds_read_b64_tr_b16 a[150:151],v12 offset:13056
ds_read_b64_tr_b16 a[152:153],v12 offset:32
ds_read_b64_tr_b16 a[154:155],v12 offset:800
ds_read_b64_tr_b16 a[156:157],v12 offset:12320
ds_read_b64_tr_b16 a[158:159],v12 offset:13088
ds_read_b64_tr_b16 v[48:49],v12 offset:64
ds_read_b64_tr_b16 v[50:51],v12 offset:832
ds_read_b64_tr_b16 v[52:53],v12 offset:12352
ds_read_b64_tr_b16 v[54:55],v12 offset:13120
s_branch ld_42
lw_44:
ds_read_b64_tr_b16 a[64:65],v12 offset:0
ds_read_b64_tr_b16 a[66:67],v12 offset:768
ds_read_b64_tr_b16 a[68:69],v12 offset:12288
ds_read_b64_tr_b16 a[70:71],v12 offset:13056
ds_read_b64_tr_b16 a[72:73],v12 offset:32
ds_read_b64_tr_b16 a[74:75],v12 offset:800
ds_read_b64_tr_b16 a[76:77],v12 offset:12320
ds_read_b64_tr_b16 a[78:79],v12 offset:13088
ds_read_b64_tr_b16 v[32:33],v12 offset:64
ds_read_b64_tr_b16 v[34:35],v12 offset:832
ds_read_b64_tr_b16 v[36:37],v12 offset:12352
ds_read_b64_tr_b16 v[38:39],v12 offset:13120
s_branch ld_42
lw_45:
ds_read_b64_tr_b16 v[160:161],v12 offset:0
ds_read_b64_tr_b16 v[162:163],v12 offset:768
ds_read_b64_tr_b16 v[164:165],v12 offset:12288
ds_read_b64_tr_b16 v[166:167],v12 offset:13056
ds_read_b64_tr_b16 v[168:169],v12 offset:32
ds_read_b64_tr_b16 v[170:171],v12 offset:800
ds_read_b64_tr_b16 v[172:173],v12 offset:12320
ds_read_b64_tr_b16 v[174:175],v12 offset:13088
ds_read_b64_tr_b16 v[80:81],v12 offset:64
ds_read_b64_tr_b16 v[82:83],v12 offset:832
ds_read_b64_tr_b16 v[84:85],v12 offset:12352
ds_read_b64_tr_b16 v[86:87],v12 offset:13120
s_branch ld_42
lw_46:
ds_read_b64_tr_b16 a[224:225],v12 offset:0
ds_read_b64_tr_b16 a[226:227],v12 offset:768
ds_read_b64_tr_b16 a[228:229],v12 offset:12288
ds_read_b64_tr_b16 a[230:231],v12 offset:13056
ds_read_b64_tr_b16 a[232:233],v12 offset:32
ds_read_b64_tr_b16 a[234:235],v12 offset:800
ds_read_b64_tr_b16 a[236:237],v12 offset:12320
ds_read_b64_tr_b16 a[238:239],v12 offset:13088
ds_read_b64_tr_b16 v[64:65],v12 offset:64
ds_read_b64_tr_b16 v[66:67],v12 offset:832
ds_read_b64_tr_b16 v[68:69],v12 offset:12352
ds_read_b64_tr_b16 v[70:71],v12 offset:13120
ld_42:
s_waitcnt lgkmcnt(0)
s_waitcnt vmcnt(24)
s_barrier
s_add_u32 s60,s75,s74
s_add_u32 m0,s77,24576
s_add_u32 s61,s60,4718592
buffer_load_dwordx4 v104,s[52:55],s61 offen lds
s_add_u32 m0,s77,25600
s_add_u32 s61,s60,4718592
buffer_load_dwordx4 v105,s[52:55],s61 offen lds
s_add_u32 m0,s77,26624
s_add_u32 s61,s60,4718592
buffer_load_dwordx4 v106,s[52:55],s61 offen lds
s_add_u32 m0,s77,27648
s_add_u32 s61,s60,4816896
buffer_load_dwordx4 v104,s[52:55],s61 offen lds
s_add_u32 m0,s77,28672
s_add_u32 s61,s60,4816896
buffer_load_dwordx4 v105,s[52:55],s61 offen lds
s_add_u32 m0,s77,29696
s_add_u32 s61,s60,4816896
buffer_load_dwordx4 v106,s[52:55],s61 offen lds
v_add_u32 v12,49152,v107
s_cmp_eq_u32 s46,1
s_cbranch_scc1 lw_49
s_cmp_eq_u32 s46,2
s_cbranch_scc1 lw_50
s_cmp_eq_u32 s46,3
s_cbranch_scc1 lw_51
lw_48:
ds_read_b64_tr_b16 a[160:161],v12 offset:0
ds_read_b64_tr_b16 a[162:163],v12 offset:768
ds_read_b64_tr_b16 a[164:165],v12 offset:12288
ds_read_b64_tr_b16 a[166:167],v12 offset:13056
ds_read_b64_tr_b16 a[168:169],v12 offset:32
ds_read_b64_tr_b16 a[170:171],v12 offset:800
ds_read_b64_tr_b16 a[172:173],v12 offset:12320
ds_read_b64_tr_b16 a[174:175],v12 offset:13088
ds_read_b64_tr_b16 a[176:177],v12 offset:64
ds_read_b64_tr_b16 a[178:179],v12 offset:832
ds_read_b64_tr_b16 a[180:181],v12 offset:12352
ds_read_b64_tr_b16 a[182:183],v12 offset:13120
s_branch ld_47
lw_49:
ds_read_b64_tr_b16 a[80:81],v12 offset:0
ds_read_b64_tr_b16 a[82:83],v12 offset:768
ds_read_b64_tr_b16 a[84:85],v12 offset:12288
ds_read_b64_tr_b16 a[86:87],v12 offset:13056
ds_read_b64_tr_b16 a[88:89],v12 offset:32
ds_read_b64_tr_b16 a[90:91],v12 offset:800
ds_read_b64_tr_b16 a[92:93],v12 offset:12320
ds_read_b64_tr_b16 a[94:95],v12 offset:13088
ds_read_b64_tr_b16 a[96:97],v12 offset:64
ds_read_b64_tr_b16 a[98:99],v12 offset:832
ds_read_b64_tr_b16 a[100:101],v12 offset:12352
ds_read_b64_tr_b16 a[102:103],v12 offset:13120
s_branch ld_47
lw_50:
ds_read_b64_tr_b16 a[0:1],v12 offset:0
ds_read_b64_tr_b16 a[2:3],v12 offset:768
ds_read_b64_tr_b16 a[4:5],v12 offset:12288
ds_read_b64_tr_b16 a[6:7],v12 offset:13056
ds_read_b64_tr_b16 a[8:9],v12 offset:32
ds_read_b64_tr_b16 a[10:11],v12 offset:800
ds_read_b64_tr_b16 a[12:13],v12 offset:12320
ds_read_b64_tr_b16 a[14:15],v12 offset:13088
ds_read_b64_tr_b16 a[16:17],v12 offset:64
ds_read_b64_tr_b16 a[18:19],v12 offset:832
ds_read_b64_tr_b16 a[20:21],v12 offset:12352
ds_read_b64_tr_b16 a[22:23],v12 offset:13120
s_branch ld_47
lw_51:
ds_read_b64_tr_b16 a[240:241],v12 offset:0
ds_read_b64_tr_b16 a[242:243],v12 offset:768
ds_read_b64_tr_b16 a[244:245],v12 offset:12288
ds_read_b64_tr_b16 a[246:247],v12 offset:13056
ds_read_b64_tr_b16 a[248:249],v12 offset:32
ds_read_b64_tr_b16 a[250:251],v12 offset:800
ds_read_b64_tr_b16 a[252:253],v12 offset:12320
ds_read_b64_tr_b16 a[254:255],v12 offset:13088
ds_read_b64_tr_b16 v[112:113],v12 offset:64
ds_read_b64_tr_b16 v[114:115],v12 offset:832
ds_read_b64_tr_b16 v[116:117],v12 offset:12352
ds_read_b64_tr_b16 v[118:119],v12 offset:13120
ld_47:
s_waitcnt lgkmcnt(0)
s_waitcnt vmcnt(24)
s_barrier
s_add_u32 s60,s75,s73
s_add_u32 m0,s77,49152
s_add_u32 s61,s60,5505024
buffer_load_dwordx4 v104,s[4:7],s61 offen lds
s_add_u32 m0,s77,50176
s_add_u32 s61,s60,5505024
buffer_load_dwordx4 v105,s[4:7],s61 offen lds
s_add_u32 m0,s77,51200
s_add_u32 s61,s60,5505024
buffer_load_dwordx4 v106,s[4:7],s61 offen lds
s_add_u32 m0,s77,52224
s_add_u32 s61,s60,5603328
buffer_load_dwordx4 v104,s[4:7],s61 offen lds
s_add_u32 m0,s77,53248
s_add_u32 s61,s60,5603328
buffer_load_dwordx4 v105,s[4:7],s61 offen lds
s_add_u32 m0,s77,54272
s_add_u32 s61,s60,5603328
buffer_load_dwordx4 v106,s[4:7],s61 offen lds
v_add_u32 v12,73728,v107
s_cmp_eq_u32 s46,1
s_cbranch_scc1 lw_54
s_cmp_eq_u32 s46,2
s_cbranch_scc1 lw_55
s_cmp_eq_u32 s46,3
s_cbranch_scc1 lw_56
lw_53:
ds_read_b64_tr_b16 a[184:185],v12 offset:0
ds_read_b64_tr_b16 a[186:187],v12 offset:768
ds_read_b64_tr_b16 a[188:189],v12 offset:12288
ds_read_b64_tr_b16 a[190:191],v12 offset:13056
ds_read_b64_tr_b16 a[192:193],v12 offset:32
ds_read_b64_tr_b16 a[194:195],v12 offset:800
ds_read_b64_tr_b16 a[196:197],v12 offset:12320
ds_read_b64_tr_b16 a[198:199],v12 offset:13088
ds_read_b64_tr_b16 v[56:57],v12 offset:64
ds_read_b64_tr_b16 v[58:59],v12 offset:832
ds_read_b64_tr_b16 v[60:61],v12 offset:12352
ds_read_b64_tr_b16 v[62:63],v12 offset:13120
s_branch ld_52
lw_54:
ds_read_b64_tr_b16 a[104:105],v12 offset:0
ds_read_b64_tr_b16 a[106:107],v12 offset:768
ds_read_b64_tr_b16 a[108:109],v12 offset:12288
ds_read_b64_tr_b16 a[110:111],v12 offset:13056
ds_read_b64_tr_b16 a[112:113],v12 offset:32
ds_read_b64_tr_b16 a[114:115],v12 offset:800
ds_read_b64_tr_b16 a[116:117],v12 offset:12320
ds_read_b64_tr_b16 a[118:119],v12 offset:13088
ds_read_b64_tr_b16 v[40:41],v12 offset:64
ds_read_b64_tr_b16 v[42:43],v12 offset:832
ds_read_b64_tr_b16 v[44:45],v12 offset:12352
ds_read_b64_tr_b16 v[46:47],v12 offset:13120
s_branch ld_52
lw_55:
ds_read_b64_tr_b16 a[24:25],v12 offset:0
ds_read_b64_tr_b16 a[26:27],v12 offset:768
ds_read_b64_tr_b16 a[28:29],v12 offset:12288
ds_read_b64_tr_b16 a[30:31],v12 offset:13056
ds_read_b64_tr_b16 a[32:33],v12 offset:32
ds_read_b64_tr_b16 a[34:35],v12 offset:800
ds_read_b64_tr_b16 a[36:37],v12 offset:12320
ds_read_b64_tr_b16 a[38:39],v12 offset:13088
ds_read_b64_tr_b16 v[24:25],v12 offset:64
ds_read_b64_tr_b16 v[26:27],v12 offset:832
ds_read_b64_tr_b16 v[28:29],v12 offset:12352
ds_read_b64_tr_b16 v[30:31],v12 offset:13120
s_branch ld_52
lw_56:
ds_read_b64_tr_b16 v[120:121],v12 offset:0
ds_read_b64_tr_b16 v[122:123],v12 offset:768
ds_read_b64_tr_b16 v[124:125],v12 offset:12288
ds_read_b64_tr_b16 v[126:127],v12 offset:13056
ds_read_b64_tr_b16 v[128:129],v12 offset:32
ds_read_b64_tr_b16 v[130:131],v12 offset:800
ds_read_b64_tr_b16 v[132:133],v12 offset:12320
ds_read_b64_tr_b16 v[134:135],v12 offset:13088
ds_read_b64_tr_b16 v[72:73],v12 offset:64
ds_read_b64_tr_b16 v[74:75],v12 offset:832
ds_read_b64_tr_b16 v[76:77],v12 offset:12352
ds_read_b64_tr_b16 v[78:79],v12 offset:13120
ld_52:
s_waitcnt lgkmcnt(0)
s_waitcnt vmcnt(24)
s_barrier
s_add_u32 s60,s75,s74
s_add_u32 m0,s77,73728
s_add_u32 s61,s60,5505024
buffer_load_dwordx4 v104,s[52:55],s61 offen lds
s_add_u32 m0,s77,74752
s_add_u32 s61,s60,5505024
buffer_load_dwordx4 v105,s[52:55],s61 offen lds
s_add_u32 m0,s77,75776
s_add_u32 s61,s60,5505024
buffer_load_dwordx4 v106,s[52:55],s61 offen lds
s_add_u32 m0,s77,76800
s_add_u32 s61,s60,5603328
buffer_load_dwordx4 v104,s[52:55],s61 offen lds
s_add_u32 m0,s77,77824
s_add_u32 s61,s60,5603328
buffer_load_dwordx4 v105,s[52:55],s61 offen lds
s_add_u32 m0,s77,78848
s_add_u32 s61,s60,5603328
buffer_load_dwordx4 v106,s[52:55],s61 offen lds
v_add_u32 v12,98304,v107
s_cmp_eq_u32 s46,1
s_cbranch_scc1 lw_59
s_cmp_eq_u32 s46,2
s_cbranch_scc1 lw_60
s_cmp_eq_u32 s46,3
s_cbranch_scc1 lw_61
lw_58:
ds_read_b64_tr_b16 a[200:201],v12 offset:0
ds_read_b64_tr_b16 a[202:203],v12 offset:768
ds_read_b64_tr_b16 a[204:205],v12 offset:12288
ds_read_b64_tr_b16 a[206:207],v12 offset:13056
ds_read_b64_tr_b16 a[208:209],v12 offset:32
ds_read_b64_tr_b16 a[210:211],v12 offset:800
ds_read_b64_tr_b16 a[212:213],v12 offset:12320
ds_read_b64_tr_b16 a[214:215],v12 offset:13088
ds_read_b64_tr_b16 a[216:217],v12 offset:64
ds_read_b64_tr_b16 a[218:219],v12 offset:832
ds_read_b64_tr_b16 a[220:221],v12 offset:12352
ds_read_b64_tr_b16 a[222:223],v12 offset:13120
s_branch ld_57
lw_59:
ds_read_b64_tr_b16 a[120:121],v12 offset:0
ds_read_b64_tr_b16 a[122:123],v12 offset:768
ds_read_b64_tr_b16 a[124:125],v12 offset:12288
ds_read_b64_tr_b16 a[126:127],v12 offset:13056
ds_read_b64_tr_b16 a[128:129],v12 offset:32
ds_read_b64_tr_b16 a[130:131],v12 offset:800
ds_read_b64_tr_b16 a[132:133],v12 offset:12320
ds_read_b64_tr_b16 a[134:135],v12 offset:13088
ds_read_b64_tr_b16 a[136:137],v12 offset:64
ds_read_b64_tr_b16 a[138:139],v12 offset:832
ds_read_b64_tr_b16 a[140:141],v12 offset:12352
ds_read_b64_tr_b16 a[142:143],v12 offset:13120
s_branch ld_57
lw_60:
ds_read_b64_tr_b16 a[40:41],v12 offset:0
ds_read_b64_tr_b16 a[42:43],v12 offset:768
ds_read_b64_tr_b16 a[44:45],v12 offset:12288
ds_read_b64_tr_b16 a[46:47],v12 offset:13056
ds_read_b64_tr_b16 a[48:49],v12 offset:32
ds_read_b64_tr_b16 a[50:51],v12 offset:800
ds_read_b64_tr_b16 a[52:53],v12 offset:12320
ds_read_b64_tr_b16 a[54:55],v12 offset:13088
ds_read_b64_tr_b16 a[56:57],v12 offset:64
ds_read_b64_tr_b16 a[58:59],v12 offset:832
ds_read_b64_tr_b16 a[60:61],v12 offset:12352
ds_read_b64_tr_b16 a[62:63],v12 offset:13120
s_branch ld_57
lw_61:
ds_read_b64_tr_b16 v[136:137],v12 offset:0
ds_read_b64_tr_b16 v[138:139],v12 offset:768
ds_read_b64_tr_b16 v[140:141],v12 offset:12288
ds_read_b64_tr_b16 v[142:143],v12 offset:13056
ds_read_b64_tr_b16 v[144:145],v12 offset:32
ds_read_b64_tr_b16 v[146:147],v12 offset:800
ds_read_b64_tr_b16 v[148:149],v12 offset:12320
ds_read_b64_tr_b16 v[150:151],v12 offset:13088
ds_read_b64_tr_b16 v[152:153],v12 offset:64
ds_read_b64_tr_b16 v[154:155],v12 offset:832
ds_read_b64_tr_b16 v[156:157],v12 offset:12352
ds_read_b64_tr_b16 v[158:159],v12 offset:13120
ld_57:
s_waitcnt lgkmcnt(0)
s_waitcnt vmcnt(24)
s_barrier
s_add_u32 s60,s76,s73
s_add_u32 m0,s77,98304
s_add_u32 s61,s60,6291456
buffer_load_dwordx4 v104,s[4:7],s61 offen lds
s_add_u32 m0,s77,99328
s_add_u32 s61,s60,6291456
buffer_load_dwordx4 v105,s[4:7],s61 offen lds
s_add_u32 m0,s77,100352
s_add_u32 s61,s60,6291456
buffer_load_dwordx4 v106,s[4:7],s61 offen lds
s_add_u32 m0,s77,101376
s_add_u32 s61,s60,6389760
buffer_load_dwordx4 v104,s[4:7],s61 offen lds
s_add_u32 m0,s77,102400
s_add_u32 s61,s60,6389760
buffer_load_dwordx4 v105,s[4:7],s61 offen lds
s_add_u32 m0,s77,103424
s_add_u32 s61,s60,6389760
buffer_load_dwordx4 v106,s[4:7],s61 offen lds
v_add_u32 v12,122880,v107
s_cmp_eq_u32 s46,1
s_cbranch_scc1 lw_64
s_cmp_eq_u32 s46,2
s_cbranch_scc1 lw_65
s_cmp_eq_u32 s46,3
s_cbranch_scc1 lw_66
lw_63:
ds_read_b64_tr_b16 a[224:225],v12 offset:0
ds_read_b64_tr_b16 a[226:227],v12 offset:768
ds_read_b64_tr_b16 a[228:229],v12 offset:12288
ds_read_b64_tr_b16 a[230:231],v12 offset:13056
ds_read_b64_tr_b16 a[232:233],v12 offset:32
ds_read_b64_tr_b16 a[234:235],v12 offset:800
ds_read_b64_tr_b16 a[236:237],v12 offset:12320
ds_read_b64_tr_b16 a[238:239],v12 offset:13088
ds_read_b64_tr_b16 v[64:65],v12 offset:64
ds_read_b64_tr_b16 v[66:67],v12 offset:832
ds_read_b64_tr_b16 v[68:69],v12 offset:12352
ds_read_b64_tr_b16 v[70:71],v12 offset:13120
s_branch ld_62
lw_64:
ds_read_b64_tr_b16 a[144:145],v12 offset:0
ds_read_b64_tr_b16 a[146:147],v12 offset:768
ds_read_b64_tr_b16 a[148:149],v12 offset:12288
ds_read_b64_tr_b16 a[150:151],v12 offset:13056
ds_read_b64_tr_b16 a[152:153],v12 offset:32
ds_read_b64_tr_b16 a[154:155],v12 offset:800
ds_read_b64_tr_b16 a[156:157],v12 offset:12320
ds_read_b64_tr_b16 a[158:159],v12 offset:13088
ds_read_b64_tr_b16 v[48:49],v12 offset:64
ds_read_b64_tr_b16 v[50:51],v12 offset:832
ds_read_b64_tr_b16 v[52:53],v12 offset:12352
ds_read_b64_tr_b16 v[54:55],v12 offset:13120
s_branch ld_62
lw_65:
ds_read_b64_tr_b16 a[64:65],v12 offset:0
ds_read_b64_tr_b16 a[66:67],v12 offset:768
ds_read_b64_tr_b16 a[68:69],v12 offset:12288
ds_read_b64_tr_b16 a[70:71],v12 offset:13056
ds_read_b64_tr_b16 a[72:73],v12 offset:32
ds_read_b64_tr_b16 a[74:75],v12 offset:800
ds_read_b64_tr_b16 a[76:77],v12 offset:12320
ds_read_b64_tr_b16 a[78:79],v12 offset:13088
ds_read_b64_tr_b16 v[32:33],v12 offset:64
ds_read_b64_tr_b16 v[34:35],v12 offset:832
ds_read_b64_tr_b16 v[36:37],v12 offset:12352
ds_read_b64_tr_b16 v[38:39],v12 offset:13120
s_branch ld_62
lw_66:
ds_read_b64_tr_b16 v[160:161],v12 offset:0
ds_read_b64_tr_b16 v[162:163],v12 offset:768
ds_read_b64_tr_b16 v[164:165],v12 offset:12288
ds_read_b64_tr_b16 v[166:167],v12 offset:13056
ds_read_b64_tr_b16 v[168:169],v12 offset:32
ds_read_b64_tr_b16 v[170:171],v12 offset:800
ds_read_b64_tr_b16 v[172:173],v12 offset:12320
ds_read_b64_tr_b16 v[174:175],v12 offset:13088
ds_read_b64_tr_b16 v[80:81],v12 offset:64
ds_read_b64_tr_b16 v[82:83],v12 offset:832
ds_read_b64_tr_b16 v[84:85],v12 offset:12352
ds_read_b64_tr_b16 v[86:87],v12 offset:13120
ld_62:
s_waitcnt lgkmcnt(0)
s_waitcnt vmcnt(24)
s_barrier
s_add_u32 s60,s76,s74
s_add_u32 m0,s77,122880
s_add_u32 s61,s60,6291456
buffer_load_dwordx4 v104,s[52:55],s61 offen lds
s_add_u32 m0,s77,123904
s_add_u32 s61,s60,6291456
buffer_load_dwordx4 v105,s[52:55],s61 offen lds
s_add_u32 m0,s77,124928
s_add_u32 s61,s60,6291456
buffer_load_dwordx4 v106,s[52:55],s61 offen lds
s_add_u32 m0,s77,125952
s_add_u32 s61,s60,6389760
buffer_load_dwordx4 v104,s[52:55],s61 offen lds
s_add_u32 m0,s77,126976
s_add_u32 s61,s60,6389760
buffer_load_dwordx4 v105,s[52:55],s61 offen lds
s_add_u32 m0,s77,128000
s_add_u32 s61,s60,6389760
buffer_load_dwordx4 v106,s[52:55],s61 offen lds
v_add_u32 v12,0,v107
s_cmp_eq_u32 s46,1
s_cbranch_scc1 lw_69
s_cmp_eq_u32 s46,2
s_cbranch_scc1 lw_70
s_cmp_eq_u32 s46,3
s_cbranch_scc1 lw_71
lw_68:
ds_read_b64_tr_b16 a[240:241],v12 offset:0
ds_read_b64_tr_b16 a[242:243],v12 offset:768
ds_read_b64_tr_b16 a[244:245],v12 offset:12288
ds_read_b64_tr_b16 a[246:247],v12 offset:13056
ds_read_b64_tr_b16 a[248:249],v12 offset:32
ds_read_b64_tr_b16 a[250:251],v12 offset:800
ds_read_b64_tr_b16 a[252:253],v12 offset:12320
ds_read_b64_tr_b16 a[254:255],v12 offset:13088
ds_read_b64_tr_b16 v[112:113],v12 offset:64
ds_read_b64_tr_b16 v[114:115],v12 offset:832
ds_read_b64_tr_b16 v[116:117],v12 offset:12352
ds_read_b64_tr_b16 v[118:119],v12 offset:13120
s_branch ld_67
lw_69:
ds_read_b64_tr_b16 a[160:161],v12 offset:0
ds_read_b64_tr_b16 a[162:163],v12 offset:768
ds_read_b64_tr_b16 a[164:165],v12 offset:12288
ds_read_b64_tr_b16 a[166:167],v12 offset:13056
ds_read_b64_tr_b16 a[168:169],v12 offset:32
ds_read_b64_tr_b16 a[170:171],v12 offset:800
ds_read_b64_tr_b16 a[172:173],v12 offset:12320
ds_read_b64_tr_b16 a[174:175],v12 offset:13088
ds_read_b64_tr_b16 a[176:177],v12 offset:64
ds_read_b64_tr_b16 a[178:179],v12 offset:832
ds_read_b64_tr_b16 a[180:181],v12 offset:12352
ds_read_b64_tr_b16 a[182:183],v12 offset:13120
s_branch ld_67
lw_70:
ds_read_b64_tr_b16 a[80:81],v12 offset:0
ds_read_b64_tr_b16 a[82:83],v12 offset:768
ds_read_b64_tr_b16 a[84:85],v12 offset:12288
ds_read_b64_tr_b16 a[86:87],v12 offset:13056
ds_read_b64_tr_b16 a[88:89],v12 offset:32
ds_read_b64_tr_b16 a[90:91],v12 offset:800
ds_read_b64_tr_b16 a[92:93],v12 offset:12320
ds_read_b64_tr_b16 a[94:95],v12 offset:13088
ds_read_b64_tr_b16 a[96:97],v12 offset:64
ds_read_b64_tr_b16 a[98:99],v12 offset:832
ds_read_b64_tr_b16 a[100:101],v12 offset:12352
ds_read_b64_tr_b16 a[102:103],v12 offset:13120
s_branch ld_67
lw_71:
ds_read_b64_tr_b16 a[0:1],v12 offset:0
ds_read_b64_tr_b16 a[2:3],v12 offset:768
ds_read_b64_tr_b16 a[4:5],v12 offset:12288
ds_read_b64_tr_b16 a[6:7],v12 offset:13056
ds_read_b64_tr_b16 a[8:9],v12 offset:32
ds_read_b64_tr_b16 a[10:11],v12 offset:800
ds_read_b64_tr_b16 a[12:13],v12 offset:12320
ds_read_b64_tr_b16 a[14:15],v12 offset:13088
ds_read_b64_tr_b16 a[16:17],v12 offset:64
ds_read_b64_tr_b16 a[18:19],v12 offset:832
ds_read_b64_tr_b16 a[20:21],v12 offset:12352
ds_read_b64_tr_b16 a[22:23],v12 offset:13120
ld_67:
s_waitcnt lgkmcnt(0)
s_waitcnt vmcnt(24)
s_barrier
s_add_u32 s60,s76,s73
s_add_u32 m0,s77,0
s_add_u32 s61,s60,7077888
buffer_load_dwordx4 v104,s[4:7],s61 offen lds
s_add_u32 m0,s77,1024
s_add_u32 s61,s60,7077888
buffer_load_dwordx4 v105,s[4:7],s61 offen lds
s_add_u32 m0,s77,2048
s_add_u32 s61,s60,7077888
buffer_load_dwordx4 v106,s[4:7],s61 offen lds
s_add_u32 m0,s77,3072
s_add_u32 s61,s60,7176192
buffer_load_dwordx4 v104,s[4:7],s61 offen lds
s_add_u32 m0,s77,4096
s_add_u32 s61,s60,7176192
buffer_load_dwordx4 v105,s[4:7],s61 offen lds
s_add_u32 m0,s77,5120
s_add_u32 s61,s60,7176192
buffer_load_dwordx4 v106,s[4:7],s61 offen lds
v_add_u32 v12,24576,v107
s_cmp_eq_u32 s46,1
s_cbranch_scc1 lw_74
s_cmp_eq_u32 s46,2
s_cbranch_scc1 lw_75
s_cmp_eq_u32 s46,3
s_cbranch_scc1 lw_76
lw_73:
ds_read_b64_tr_b16 v[120:121],v12 offset:0
ds_read_b64_tr_b16 v[122:123],v12 offset:768
ds_read_b64_tr_b16 v[124:125],v12 offset:12288
ds_read_b64_tr_b16 v[126:127],v12 offset:13056
ds_read_b64_tr_b16 v[128:129],v12 offset:32
ds_read_b64_tr_b16 v[130:131],v12 offset:800
ds_read_b64_tr_b16 v[132:133],v12 offset:12320
ds_read_b64_tr_b16 v[134:135],v12 offset:13088
ds_read_b64_tr_b16 v[72:73],v12 offset:64
ds_read_b64_tr_b16 v[74:75],v12 offset:832
ds_read_b64_tr_b16 v[76:77],v12 offset:12352
ds_read_b64_tr_b16 v[78:79],v12 offset:13120
s_branch ld_72
lw_74:
ds_read_b64_tr_b16 a[184:185],v12 offset:0
ds_read_b64_tr_b16 a[186:187],v12 offset:768
ds_read_b64_tr_b16 a[188:189],v12 offset:12288
ds_read_b64_tr_b16 a[190:191],v12 offset:13056
ds_read_b64_tr_b16 a[192:193],v12 offset:32
ds_read_b64_tr_b16 a[194:195],v12 offset:800
ds_read_b64_tr_b16 a[196:197],v12 offset:12320
ds_read_b64_tr_b16 a[198:199],v12 offset:13088
ds_read_b64_tr_b16 v[56:57],v12 offset:64
ds_read_b64_tr_b16 v[58:59],v12 offset:832
ds_read_b64_tr_b16 v[60:61],v12 offset:12352
ds_read_b64_tr_b16 v[62:63],v12 offset:13120
s_branch ld_72
lw_75:
ds_read_b64_tr_b16 a[104:105],v12 offset:0
ds_read_b64_tr_b16 a[106:107],v12 offset:768
ds_read_b64_tr_b16 a[108:109],v12 offset:12288
ds_read_b64_tr_b16 a[110:111],v12 offset:13056
ds_read_b64_tr_b16 a[112:113],v12 offset:32
ds_read_b64_tr_b16 a[114:115],v12 offset:800
ds_read_b64_tr_b16 a[116:117],v12 offset:12320
ds_read_b64_tr_b16 a[118:119],v12 offset:13088
ds_read_b64_tr_b16 v[40:41],v12 offset:64
ds_read_b64_tr_b16 v[42:43],v12 offset:832
ds_read_b64_tr_b16 v[44:45],v12 offset:12352
ds_read_b64_tr_b16 v[46:47],v12 offset:13120
s_branch ld_72
lw_76:
ds_read_b64_tr_b16 a[24:25],v12 offset:0
ds_read_b64_tr_b16 a[26:27],v12 offset:768
ds_read_b64_tr_b16 a[28:29],v12 offset:12288
ds_read_b64_tr_b16 a[30:31],v12 offset:13056
ds_read_b64_tr_b16 a[32:33],v12 offset:32
ds_read_b64_tr_b16 a[34:35],v12 offset:800
ds_read_b64_tr_b16 a[36:37],v12 offset:12320
ds_read_b64_tr_b16 a[38:39],v12 offset:13088
ds_read_b64_tr_b16 v[24:25],v12 offset:64
ds_read_b64_tr_b16 v[26:27],v12 offset:832
ds_read_b64_tr_b16 v[28:29],v12 offset:12352
ds_read_b64_tr_b16 v[30:31],v12 offset:13120
ld_72:
s_waitcnt lgkmcnt(0)
s_waitcnt vmcnt(24)
s_barrier
s_add_u32 s60,s76,s74
s_add_u32 m0,s77,24576
s_add_u32 s61,s60,7077888
buffer_load_dwordx4 v104,s[52:55],s61 offen lds
s_add_u32 m0,s77,25600
s_add_u32 s61,s60,7077888
buffer_load_dwordx4 v105,s[52:55],s61 offen lds
s_add_u32 m0,s77,26624
s_add_u32 s61,s60,7077888
buffer_load_dwordx4 v106,s[52:55],s61 offen lds
s_add_u32 m0,s77,27648
s_add_u32 s61,s60,7176192
buffer_load_dwordx4 v104,s[52:55],s61 offen lds
s_add_u32 m0,s77,28672
s_add_u32 s61,s60,7176192
buffer_load_dwordx4 v105,s[52:55],s61 offen lds
s_add_u32 m0,s77,29696
s_add_u32 s61,s60,7176192
buffer_load_dwordx4 v106,s[52:55],s61 offen lds
v_add_u32 v12,49152,v107
s_cmp_eq_u32 s46,1
s_cbranch_scc1 lw_79
s_cmp_eq_u32 s46,2
s_cbranch_scc1 lw_80
s_cmp_eq_u32 s46,3
s_cbranch_scc1 lw_81
lw_78:
ds_read_b64_tr_b16 v[136:137],v12 offset:0
ds_read_b64_tr_b16 v[138:139],v12 offset:768
ds_read_b64_tr_b16 v[140:141],v12 offset:12288
ds_read_b64_tr_b16 v[142:143],v12 offset:13056
ds_read_b64_tr_b16 v[144:145],v12 offset:32
ds_read_b64_tr_b16 v[146:147],v12 offset:800
ds_read_b64_tr_b16 v[148:149],v12 offset:12320
ds_read_b64_tr_b16 v[150:151],v12 offset:13088
ds_read_b64_tr_b16 v[152:153],v12 offset:64
ds_read_b64_tr_b16 v[154:155],v12 offset:832
ds_read_b64_tr_b16 v[156:157],v12 offset:12352
ds_read_b64_tr_b16 v[158:159],v12 offset:13120
s_branch ld_77
lw_79:
ds_read_b64_tr_b16 a[200:201],v12 offset:0
ds_read_b64_tr_b16 a[202:203],v12 offset:768
ds_read_b64_tr_b16 a[204:205],v12 offset:12288
ds_read_b64_tr_b16 a[206:207],v12 offset:13056
ds_read_b64_tr_b16 a[208:209],v12 offset:32
ds_read_b64_tr_b16 a[210:211],v12 offset:800
ds_read_b64_tr_b16 a[212:213],v12 offset:12320
ds_read_b64_tr_b16 a[214:215],v12 offset:13088
ds_read_b64_tr_b16 a[216:217],v12 offset:64
ds_read_b64_tr_b16 a[218:219],v12 offset:832
ds_read_b64_tr_b16 a[220:221],v12 offset:12352
ds_read_b64_tr_b16 a[222:223],v12 offset:13120
s_branch ld_77
lw_80:
ds_read_b64_tr_b16 a[120:121],v12 offset:0
ds_read_b64_tr_b16 a[122:123],v12 offset:768
ds_read_b64_tr_b16 a[124:125],v12 offset:12288
ds_read_b64_tr_b16 a[126:127],v12 offset:13056
ds_read_b64_tr_b16 a[128:129],v12 offset:32
ds_read_b64_tr_b16 a[130:131],v12 offset:800
ds_read_b64_tr_b16 a[132:133],v12 offset:12320
ds_read_b64_tr_b16 a[134:135],v12 offset:13088
ds_read_b64_tr_b16 a[136:137],v12 offset:64
ds_read_b64_tr_b16 a[138:139],v12 offset:832
ds_read_b64_tr_b16 a[140:141],v12 offset:12352
ds_read_b64_tr_b16 a[142:143],v12 offset:13120
s_branch ld_77
lw_81:
ds_read_b64_tr_b16 a[40:41],v12 offset:0
ds_read_b64_tr_b16 a[42:43],v12 offset:768
ds_read_b64_tr_b16 a[44:45],v12 offset:12288
ds_read_b64_tr_b16 a[46:47],v12 offset:13056
ds_read_b64_tr_b16 a[48:49],v12 offset:32
ds_read_b64_tr_b16 a[50:51],v12 offset:800
ds_read_b64_tr_b16 a[52:53],v12 offset:12320
ds_read_b64_tr_b16 a[54:55],v12 offset:13088
ds_read_b64_tr_b16 a[56:57],v12 offset:64
ds_read_b64_tr_b16 a[58:59],v12 offset:832
ds_read_b64_tr_b16 a[60:61],v12 offset:12352
ds_read_b64_tr_b16 a[62:63],v12 offset:13120
ld_77:
s_waitcnt lgkmcnt(0)
s_waitcnt vmcnt(24)
s_barrier
v_add_u32 v12,73728,v107
s_cmp_eq_u32 s46,1
s_cbranch_scc1 lw_84
s_cmp_eq_u32 s46,2
s_cbranch_scc1 lw_85
s_cmp_eq_u32 s46,3
s_cbranch_scc1 lw_86
lw_83:
ds_read_b64_tr_b16 v[160:161],v12 offset:0
ds_read_b64_tr_b16 v[162:163],v12 offset:768
ds_read_b64_tr_b16 v[164:165],v12 offset:12288
ds_read_b64_tr_b16 v[166:167],v12 offset:13056
ds_read_b64_tr_b16 v[168:169],v12 offset:32
ds_read_b64_tr_b16 v[170:171],v12 offset:800
ds_read_b64_tr_b16 v[172:173],v12 offset:12320
ds_read_b64_tr_b16 v[174:175],v12 offset:13088
ds_read_b64_tr_b16 v[80:81],v12 offset:64
ds_read_b64_tr_b16 v[82:83],v12 offset:832
ds_read_b64_tr_b16 v[84:85],v12 offset:12352
ds_read_b64_tr_b16 v[86:87],v12 offset:13120
s_branch ld_82
lw_84:
ds_read_b64_tr_b16 a[224:225],v12 offset:0
ds_read_b64_tr_b16 a[226:227],v12 offset:768
ds_read_b64_tr_b16 a[228:229],v12 offset:12288
ds_read_b64_tr_b16 a[230:231],v12 offset:13056
ds_read_b64_tr_b16 a[232:233],v12 offset:32
ds_read_b64_tr_b16 a[234:235],v12 offset:800
ds_read_b64_tr_b16 a[236:237],v12 offset:12320
ds_read_b64_tr_b16 a[238:239],v12 offset:13088
ds_read_b64_tr_b16 v[64:65],v12 offset:64
ds_read_b64_tr_b16 v[66:67],v12 offset:832
ds_read_b64_tr_b16 v[68:69],v12 offset:12352
ds_read_b64_tr_b16 v[70:71],v12 offset:13120
s_branch ld_82
lw_85:
ds_read_b64_tr_b16 a[144:145],v12 offset:0
ds_read_b64_tr_b16 a[146:147],v12 offset:768
ds_read_b64_tr_b16 a[148:149],v12 offset:12288
ds_read_b64_tr_b16 a[150:151],v12 offset:13056
ds_read_b64_tr_b16 a[152:153],v12 offset:32
ds_read_b64_tr_b16 a[154:155],v12 offset:800
ds_read_b64_tr_b16 a[156:157],v12 offset:12320
ds_read_b64_tr_b16 a[158:159],v12 offset:13088
ds_read_b64_tr_b16 v[48:49],v12 offset:64
ds_read_b64_tr_b16 v[50:51],v12 offset:832
ds_read_b64_tr_b16 v[52:53],v12 offset:12352
ds_read_b64_tr_b16 v[54:55],v12 offset:13120
s_branch ld_82
lw_86:
ds_read_b64_tr_b16 a[64:65],v12 offset:0
ds_read_b64_tr_b16 a[66:67],v12 offset:768
ds_read_b64_tr_b16 a[68:69],v12 offset:12288
ds_read_b64_tr_b16 a[70:71],v12 offset:13056
ds_read_b64_tr_b16 a[72:73],v12 offset:32
ds_read_b64_tr_b16 a[74:75],v12 offset:800
ds_read_b64_tr_b16 a[76:77],v12 offset:12320
ds_read_b64_tr_b16 a[78:79],v12 offset:13088
ds_read_b64_tr_b16 v[32:33],v12 offset:64
ds_read_b64_tr_b16 v[34:35],v12 offset:832
ds_read_b64_tr_b16 v[36:37],v12 offset:12352
ds_read_b64_tr_b16 v[38:39],v12 offset:13120
ld_82:
s_waitcnt lgkmcnt(0)
s_waitcnt vmcnt(18)
s_barrier
v_add_u32 v12,98304,v107
ds_read_b64_tr_b16 v[176:177],v12 offset:0
ds_read_b64_tr_b16 v[178:179],v12 offset:768
ds_read_b64_tr_b16 v[180:181],v12 offset:12288
ds_read_b64_tr_b16 v[182:183],v12 offset:13056
ds_read_b64_tr_b16 v[184:185],v12 offset:32
ds_read_b64_tr_b16 v[186:187],v12 offset:800
ds_read_b64_tr_b16 v[188:189],v12 offset:12320
ds_read_b64_tr_b16 v[190:191],v12 offset:13088
ds_read_b64_tr_b16 v[192:193],v12 offset:64
ds_read_b64_tr_b16 v[194:195],v12 offset:832
ds_read_b64_tr_b16 v[196:197],v12 offset:12352
ds_read_b64_tr_b16 v[198:199],v12 offset:13120
s_waitcnt lgkmcnt(0)
s_waitcnt vmcnt(12)
s_barrier
v_add_u32 v12,122880,v107
ds_read_b64_tr_b16 v[200:201],v12 offset:0
ds_read_b64_tr_b16 v[202:203],v12 offset:768
ds_read_b64_tr_b16 v[204:205],v12 offset:12288
ds_read_b64_tr_b16 v[206:207],v12 offset:13056
ds_read_b64_tr_b16 v[208:209],v12 offset:32
ds_read_b64_tr_b16 v[210:211],v12 offset:800
ds_read_b64_tr_b16 v[212:213],v12 offset:12320
ds_read_b64_tr_b16 v[214:215],v12 offset:13088
ds_read_b64_tr_b16 v[88:89],v12 offset:64
ds_read_b64_tr_b16 v[90:91],v12 offset:832
ds_read_b64_tr_b16 v[92:93],v12 offset:12352
ds_read_b64_tr_b16 v[94:95],v12 offset:13120
s_waitcnt lgkmcnt(0)
s_waitcnt vmcnt(6)
s_barrier
v_add_u32 v12,0,v107
ds_read_b64_tr_b16 v[216:217],v12 offset:0
ds_read_b64_tr_b16 v[218:219],v12 offset:768
ds_read_b64_tr_b16 v[220:221],v12 offset:12288
ds_read_b64_tr_b16 v[222:223],v12 offset:13056
ds_read_b64_tr_b16 v[224:225],v12 offset:32
ds_read_b64_tr_b16 v[226:227],v12 offset:800
ds_read_b64_tr_b16 v[228:229],v12 offset:12320
ds_read_b64_tr_b16 v[230:231],v12 offset:13088
ds_read_b64_tr_b16 v[232:233],v12 offset:64
ds_read_b64_tr_b16 v[234:235],v12 offset:832
ds_read_b64_tr_b16 v[236:237],v12 offset:12352
ds_read_b64_tr_b16 v[238:239],v12 offset:13120
s_waitcnt lgkmcnt(0)
s_waitcnt vmcnt(0)
s_barrier
v_add_u32 v12,24576,v107
ds_read_b64_tr_b16 v[240:241],v12 offset:0
ds_read_b64_tr_b16 v[242:243],v12 offset:768
ds_read_b64_tr_b16 v[244:245],v12 offset:12288
ds_read_b64_tr_b16 v[246:247],v12 offset:13056
ds_read_b64_tr_b16 v[248:249],v12 offset:32
ds_read_b64_tr_b16 v[250:251],v12 offset:800
ds_read_b64_tr_b16 v[252:253],v12 offset:12320
ds_read_b64_tr_b16 v[254:255],v12 offset:13088
ds_read_b64_tr_b16 v[96:97],v12 offset:64
ds_read_b64_tr_b16 v[98:99],v12 offset:832
ds_read_b64_tr_b16 v[100:101],v12 offset:12352
ds_read_b64_tr_b16 v[102:103],v12 offset:13120
s_waitcnt lgkmcnt(0)
s_barrier
ds_write_b128 v21,v[24:27] offset:0
ds_write_b128 v21,v[28:31] offset:1024
ds_write_b128 v21,v[32:35] offset:2048
ds_write_b128 v21,v[36:39] offset:3072
ds_write_b128 v21,v[40:43] offset:4096
ds_write_b128 v21,v[44:47] offset:5120
ds_write_b128 v21,v[48:51] offset:6144
ds_write_b128 v21,v[52:55] offset:7168
ds_write_b128 v21,v[56:59] offset:8192
ds_write_b128 v21,v[60:63] offset:9216
ds_write_b128 v21,v[64:67] offset:10240
ds_write_b128 v21,v[68:71] offset:11264
ds_write_b128 v21,v[72:75] offset:12288
ds_write_b128 v21,v[76:79] offset:13312
ds_write_b128 v21,v[80:83] offset:14336
ds_write_b128 v21,v[84:87] offset:15360
ds_write_b128 v21,v[88:91] offset:16384
ds_write_b128 v21,v[92:95] offset:17408
ds_write_b128 v21,v[96:99] offset:18432
ds_write_b128 v21,v[100:103] offset:19456
s_waitcnt lgkmcnt(0)
v_add_u32 v59,139264,v1
s_barrier
s_lshl_b32 s3,s49,2
v_mov_b32 v13,s3
s_nop 1
ibw_87:
buffer_load_dword v12,v13,s[12:15],0 offen sc1
s_waitcnt vmcnt(0)
v_cmp_ne_u32 vcc,256,v12
s_nop 0
s_cbranch_vccz ok_88
s_sleep 8
s_sub_u32 s47,s47,1
s_cbranch_scc1 ABORT
s_branch ibw_87
ok_88:
s_cmp_lg_u32 s49,0
s_cbranch_scc1 ibok_89
v_and_b32 v13,7,v0
v_lshlrev_b32 v13,2,v13
buffer_load_dword v12,v13,s[12:15],0 offen offset:32 sc1
s_waitcnt vmcnt(0)
v_cmp_ne_u32 vcc,32,v12
s_nop 0
s_cbranch_vccz ibok_89
s_barrier
s_mov_b32 s49,1
s_mov_b32 s3,s2
s_load_dwordx16 s[16:31],s[0:1],0
s_load_dwordx8 s[32:39],s[0:1],64
s_waitcnt lgkmcnt(0)
s_branch DISPATCH
ibok_89:
v_mov_b32 v13,192
s_cmp_lg_u32 s49,0
s_cbranch_scc1 vx_91
vw_90:
buffer_load_dword v12,v13,s[12:15],0 offen sc1
s_waitcnt vmcnt(0)
v_and_b32 v14,0xffff,v12
v_cmp_ne_u32 vcc,64,v14
s_nop 0
s_cbranch_vccz ok_92
s_sleep 4
s_sub_u32 s47,s47,1
s_cbranch_scc1 ABORT
s_branch vw_90
ok_92:
v_readfirstlane_b32 s60,v12
s_cmp_gt_u32 s60,2162688
s_cselect_b32 s60,0x2000,0
s_add_u32 s83,s83,s60
s_nop 1
vx_91:
s_mul_i32 s6,s46,2048
v_sub_u32 v18,v23,v22
v_add_u32 v18,v18,v1
v_add_u32 v18,8192,v18
s_mov_b32 s37,0x3f80
s_mov_b32 s81,0x3f800000
s_add_u32 s6,s6,s82
s_mov_b32 s7,0
s_add_u32 s7,s7,s82
s_add_u32 s7,s7,950272
s_mov_b32 s50,0
s_mov_b32 s4,0
s_mov_b32 s5,0
s_mov_b32 s78,2147483648
s_mov_b32 s79,2147483648
s_mov_b32 s30,2147483648
s_sub_u32 s60,s4,s5
s_cmp_gt_i32 s60,13
s_cselect_b32 s51,1,0
s_cmp_eq_u32 s4,64
s_cselect_b32 s51,1,s51
s_cmp_eq_u32 s51,0
s_cselect_b32 s52,s4,s5
s_addc_u32 s4,s4,0
s_add_u32 s5,s5,s51
s_and_b32 s60,s52,1
s_lshl2_add_u32 s60,s51,s60
s_lshl_b32 s68,s60,16
s_add_u32 s68,s68,s83
s_mul_i32 s59,s60,20480
s_add_u32 s59,s59,s6
s_lshl_b32 s69,s51,9
s_add_u32 s69,s69,s7
s_bfe_u32 s57,s52,65537
s_add_u32 s58,s52,1
s_cmp_lg_u32 s36,0
s_cbranch_scc1 CV_START
s_cmp_eq_u32 s46,3
s_cbranch_scc1 CH_START
s_lshl_b32 s60,s46,2
s_add_u32 s60,s60,147456
v_mov_b32 v20,s60
v_mov_b32 v12,0
ds_write_b32 v20,v12
v_add_u32 v58,106496,v1
v_mov_b32 v9,147468
s_lshl_b32 s85,s46,12
s_add_u32 s84,s84,s85
s_add_u32 s74,s85,81920
s_add_u32 s75,s74,s74
s_add_u32 s75,s75,24576
s_mul_i32 s60,s29,3
s_add_u32 s60,s60,s46
v_lshlrev_b32 v13,7,v0
s_add_u32 s61,s60,0
s_min_u32 s61,s61,115
s_lshl_b32 s61,s61,13
s_add_u32 s61,s61,s82
buffer_load_dword v14,v13,s[8:11],s61 offen sc1
s_add_u32 s61,s60,48
s_min_u32 s61,s61,115
s_lshl_b32 s61,s61,13
s_add_u32 s61,s61,s82
buffer_load_dword v14,v13,s[8:11],s61 offen sc1
s_add_u32 s61,s60,96
s_min_u32 s61,s61,115
s_lshl_b32 s61,s61,13
s_add_u32 s61,s61,s82
buffer_load_dword v14,v13,s[8:11],s61 offen sc1
s_waitcnt vmcnt(0)
s_mov_b64 vcc,-1
s_waitcnt lgkmcnt(0)
v_mov_b32 v10,0
v_mov_b32 v11,0
v_mov_b32 v24,0
v_mov_b32 v25,0
v_mov_b32 v26,0
v_mov_b32 v27,0
v_mov_b32 v28,0
v_mov_b32 v29,0
v_mov_b32 v30,0
v_mov_b32 v31,0
v_mov_b32 v32,0
v_mov_b32 v33,0
v_mov_b32 v34,0
v_mov_b32 v35,0
v_mov_b32 v36,0
v_mov_b32 v37,0
v_mov_b32 v38,0
v_mov_b32 v39,0
v_mov_b32 v40,0
v_mov_b32 v41,0
v_mov_b32 v42,0
v_mov_b32 v43,0
v_mov_b32 v44,0
v_mov_b32 v45,0
v_mov_b32 v46,0
v_mov_b32 v47,0
s_cmp_lg_u32 s49,0
s_cbranch_scc1 CS_LOOP_S
CS_LOOP_F:
s_barrier
buffer_load_dwordx2 v[80:81],v18,s[8:11],s59 offen sc1
buffer_load_dwordx4 v[72:75],v1,s[8:11],s59 offen sc1
buffer_load_dwordx4 v[76:79],v1,s[8:11],s59 offen offset:1024 sc1
s_cbranch_vccz fj_95f
s_waitcnt vmcnt(2)
s_sleep 3
fj_95f:
buffer_load_dwordx2 v[90:91],v18,s[8:11],s68 offen sc1
buffer_load_dwordx4 v[82:85],v1,s[8:11],s68 offen sc1
buffer_load_dwordx4 v[86:89],v1,s[8:11],s68 offen offset:1024 sc1
v_mfma_f32_32x32x8_bf16 v[24:39],v[10:11],v[10:11],0
v_mfma_f32_16x16x16_bf16 v[40:43],v[10:11],v[10:11],0
v_mfma_f32_16x16x16_bf16 v[44:47],v[10:11],v[10:11],0
fj_95:
fa_93:
s_waitcnt vmcnt(5)
v_lshlrev_b32 v108,16,v80
v_and_b32 v109,0xffff0000,v80
v_lshlrev_b32 v110,16,v81
v_and_b32 v111,0xffff0000,v81
s_waitcnt vmcnt(4)
v_lshlrev_b32 v92,16,v72
v_and_b32 v93,0xffff0000,v72
v_lshlrev_b32 v94,16,v73
v_and_b32 v95,0xffff0000,v73
v_lshlrev_b32 v96,16,v74
v_and_b32 v97,0xffff0000,v74
v_lshlrev_b32 v98,16,v75
v_and_b32 v99,0xffff0000,v75
s_waitcnt vmcnt(3)
v_lshlrev_b32 v100,16,v76
v_and_b32 v101,0xffff0000,v76
v_lshlrev_b32 v102,16,v77
v_and_b32 v103,0xffff0000,v77
v_lshlrev_b32 v104,16,v78
v_and_b32 v105,0xffff0000,v78
v_lshlrev_b32 v106,16,v79
v_and_b32 v107,0xffff0000,v79
s_waitcnt vmcnt(2)
v_dot2c_f32_bf16 v108,s37,v90
v_dot2c_f32_bf16 v109,s81,v90
v_dot2c_f32_bf16 v110,s37,v91
v_dot2c_f32_bf16 v111,s81,v91
v_bitop3_b32 v16,v80,v90,s57 bitop3:0x7e
v_cvt_pk_bf16_f32 v56,v108,v109
s_nop 0
v_cvt_pk_bf16_f32 v57,v110,v111
ds_write_b64 v23,v[56:57]
s_waitcnt vmcnt(1)
v_dot2c_f32_bf16 v92,s37,v82
v_dot2c_f32_bf16 v93,s81,v82
v_dot2c_f32_bf16 v94,s37,v83
v_dot2c_f32_bf16 v95,s81,v83
v_dot2c_f32_bf16 v96,s37,v84
v_dot2c_f32_bf16 v97,s81,v84
v_dot2c_f32_bf16 v98,s37,v85
v_dot2c_f32_bf16 v99,s81,v85
v_bitop3_b32 v17,v72,v82,s57 bitop3:0x7e
v_or_b32 v16,v16,v17
v_cvt_pk_bf16_f32 v48,v92,v93
v_cvt_pk_bf16_f32 v49,v94,v95
v_cvt_pk_bf16_f32 v50,v96,v97
v_cvt_pk_bf16_f32 v51,v98,v99
ds_write_b128 v22,v[48:51] offset:0
s_waitcnt vmcnt(0)
v_dot2c_f32_bf16 v100,s37,v86
v_dot2c_f32_bf16 v101,s81,v86
v_dot2c_f32_bf16 v102,s37,v87
v_dot2c_f32_bf16 v103,s81,v87
v_dot2c_f32_bf16 v104,s37,v88
v_dot2c_f32_bf16 v105,s81,v88
v_dot2c_f32_bf16 v106,s37,v89
v_dot2c_f32_bf16 v107,s81,v89
v_bitop3_b32 v17,v76,v86,s57 bitop3:0x7e
v_bitop3_b32 v16,v16,v17,1 bitop3:0xa8
v_cmp_ne_u32 vcc,0,v16
v_cvt_pk_bf16_f32 v52,v100,v101
v_cvt_pk_bf16_f32 v53,v102,v103
v_cvt_pk_bf16_f32 v54,v104,v105
v_cvt_pk_bf16_f32 v55,v106,v107
ds_write_b128 v22,v[52:55] offset:1024
s_cbranch_vccnz fr_94
fj_95g:
v_smfmac_f32_16x16x64_bf16 v[24:27],v[48:51],a[0:7],v2
ds_read_b128 v[72:75],v21 offset:0
v_xor_b32 v58,57344,v58
v_smfmac_f32_16x16x64_bf16 v[28:31],v[48:51],a[8:15],v2
ds_read_b128 v[76:79],v21 offset:1024
s_sub_u32 s60,s4,s5
v_smfmac_f32_16x16x64_bf16 v[32:35],v[48:51],a[16:23],v2
ds_read_b128 v[80:83],v21 offset:2048
s_cmp_gt_i32 s60,13
v_smfmac_f32_16x16x64_bf16 v[36:39],v[48:51],a[24:31],v2
ds_read_b128 v[84:87],v21 offset:3072
s_cselect_b32 s53,1,0
s_waitcnt lgkmcnt(4)
s_barrier
v_smfmac_f32_16x16x64_bf16 v[40:43],v[48:51],a[32:39],v2
ds_read_b128 v[60:63],v3 offset:0
s_cmp_eq_u32 s4,64
v_smfmac_f32_16x16x64_bf16 v[24:27],v[52:55],a[40:47],v2
ds_read_b128 v[64:67],v3 offset:1024
s_cselect_b32 s53,1,s53
v_smfmac_f32_16x16x64_bf16 v[28:31],v[52:55],a[48:55],v2
ds_read_b128 v[68:71],v4 offset:0
s_cmp_eq_u32 s53,0
v_smfmac_f32_16x16x64_bf16 v[32:35],v[52:55],a[56:63],v2
s_cselect_b32 s54,s4,s5
s_addc_u32 s4,s4,0
s_add_u32 s5,s5,s53
v_smfmac_f32_16x16x64_bf16 v[36:39],v[52:55],a[64:71],v2
s_mul_i32 s73,s54,393216
s_add_u32 s73,s73,s84
s_sub_u32 s74,s75,s74
v_smfmac_f32_16x16x64_bf16 v[40:43],v[52:55],a[72:79],v2
s_mov_b32 m0,s74
s_and_b32 s60,s52,1
s_waitcnt lgkmcnt(5)
v_smfmac_f32_16x16x64_bf16 v[44:47],v[48:51],v[72:79],v2
ds_read_b128 v[72:75],v21 offset:4096
s_waitcnt lgkmcnt(4)
v_smfmac_f32_16x16x64_bf16 v[44:47],v[52:55],v[80:87],v2
ds_read_b128 v[76:79],v21 offset:5120
s_waitcnt lgkmcnt(4)
v_smfmac_f32_16x16x64_bf16 v[24:27],v[60:63],a[80:87],v2
ds_read_b128 v[80:83],v21 offset:6144
s_lshl2_add_u32 s60,s51,s60
v_smfmac_f32_16x16x64_bf16 v[28:31],v[60:63],a[88:95],v2
ds_read_b128 v[84:87],v21 offset:7168
s_mul_i32 s60,s60,49152
v_smfmac_f32_16x16x64_bf16 v[32:35],v[60:63],a[96:103],v2
s_add_u32 s71,s60,s34
s_add_u32 s70,s60,s33
s_lshl_b32 s60,s51,9
v_smfmac_f32_16x16x64_bf16 v[36:39],v[60:63],a[104:111],v2
s_add_u32 s72,s60,s35
buffer_load_dwordx4 v1,s[8:11],s73 offen sc1 lds
v_smfmac_f32_16x16x64_bf16 v[40:43],v[60:63],a[112:119],v2
buffer_load_dwordx4 v1,s[8:11],s73 offen offset:1024 sc1 lds
s_waitcnt lgkmcnt(2)
v_smfmac_f32_16x16x64_bf16 v[44:47],v[60:63],v[72:79],v2
ds_read_b128 v[60:63],v4 offset:1024
v_smfmac_f32_16x16x64_bf16 v[24:27],v[64:67],a[120:127],v2
ds_read_b128 v[72:75],v21 offset:8192
v_smfmac_f32_16x16x64_bf16 v[28:31],v[64:67],a[128:135],v2
ds_read_b128 v[76:79],v21 offset:9216
v_smfmac_f32_16x16x64_bf16 v[32:35],v[64:67],a[136:143],v2
buffer_load_dwordx4 v1,s[8:11],s73 offen offset:2048 sc1 lds
v_smfmac_f32_16x16x64_bf16 v[36:39],v[64:67],a[144:151],v2
buffer_load_dwordx4 v1,s[8:11],s73 offen offset:3072 sc1 lds
v_add_u32 v17,s85,v58
v_smfmac_f32_16x16x64_bf16 v[40:43],v[64:67],a[152:159],v2
v_mov_b32 v16,s58
s_and_b32 s60,s54,1
s_waitcnt lgkmcnt(3)
v_smfmac_f32_16x16x64_bf16 v[44:47],v[64:67],v[80:87],v2
ds_read_b128 v[64:67],v5 offset:0
s_lshl2_add_u32 s60,s53,s60
v_smfmac_f32_16x16x64_bf16 v[24:27],v[68:71],a[160:167],v2
ds_read_b128 v[80:83],v21 offset:10240
s_lshl_b32 s68,s60,16
v_smfmac_f32_16x16x64_bf16 v[28:31],v[68:71],a[168:175],v2
ds_read_b128 v[84:87],v21 offset:11264
s_add_u32 s68,s68,s83
v_smfmac_f32_16x16x64_bf16 v[32:35],v[68:71],a[176:183],v2
s_mul_i32 s59,s60,20480
s_add_u32 s59,s59,s6
s_lshl_b32 s69,s53,9
v_smfmac_f32_16x16x64_bf16 v[36:39],v[68:71],a[184:191],v2
s_add_u32 s69,s69,s7
s_bfe_u32 s31,s54,65537
s_add_u32 s32,s54,1
v_smfmac_f32_16x16x64_bf16 v[40:43],v[68:71],a[192:199],v2
s_add_u32 s50,s50,1
s_mov_b32 s51,s53
s_waitcnt lgkmcnt(3)
v_smfmac_f32_16x16x64_bf16 v[44:47],v[68:71],v[72:79],v2
ds_read_b128 v[68:71],v5 offset:1024
s_mov_b32 s52,s54
v_smfmac_f32_16x16x64_bf16 v[24:27],v[60:63],a[200:207],v2
ds_read_b128 v[72:75],v21 offset:12288
s_mov_b32 s58,s32
v_smfmac_f32_16x16x64_bf16 v[28:31],v[60:63],a[208:215],v2
ds_read_b128 v[76:79],v21 offset:13312
s_mov_b64 vcc,s[88:89]
v_smfmac_f32_16x16x64_bf16 v[32:35],v[60:63],a[216:223],v2
ds_read_b128 v[48:51],v58 offset:0
v_smfmac_f32_16x16x64_bf16 v[36:39],v[60:63],a[224:231],v2
v_smfmac_f32_16x16x64_bf16 v[40:43],v[60:63],a[232:239],v2
ds_read_b128 v[52:55],v58 offset:1024
s_waitcnt lgkmcnt(5)
v_smfmac_f32_16x16x64_bf16 v[44:47],v[60:63],v[80:87],v2
ds_read_b128 v[60:63],v59 offset:0
v_smfmac_f32_16x16x64_bf16 v[24:27],v[64:67],a[240:247],v2
ds_read_b128 v[80:83],v21 offset:14336
v_smfmac_f32_16x16x64_bf16 v[28:31],v[64:67],a[248:255],v2
ds_read_b128 v[84:87],v21 offset:15360
v_smfmac_f32_16x16x64_bf16 v[32:35],v[64:67],v[112:119],v2
ds_read_b128 v[88:91],v58 offset:2048
v_smfmac_f32_16x16x64_bf16 v[36:39],v[64:67],v[120:127],v2
v_smfmac_f32_16x16x64_bf16 v[40:43],v[64:67],v[128:135],v2
ds_read_b128 v[92:95],v58 offset:3072
s_waitcnt lgkmcnt(7)
v_smfmac_f32_16x16x64_bf16 v[44:47],v[64:67],v[72:79],v2
ds_read_b128 v[64:67],v59 offset:1024
v_smfmac_f32_16x16x64_bf16 v[24:27],v[68:71],v[136:143],v2
ds_read_b128 v[72:75],v21 offset:16384
v_smfmac_f32_16x16x64_bf16 v[28:31],v[68:71],v[144:151],v2
ds_read_b128 v[76:79],v21 offset:17408
v_smfmac_f32_16x16x64_bf16 v[32:35],v[68:71],v[152:159],v2
ds_read_b128 v[96:99],v58 offset:4096
v_smfmac_f32_16x16x64_bf16 v[36:39],v[68:71],v[160:167],v2
v_smfmac_f32_16x16x64_bf16 v[40:43],v[68:71],v[168:175],v2
ds_read_b128 v[100:103],v58 offset:5120
s_waitcnt lgkmcnt(7)
v_smfmac_f32_16x16x64_bf16 v[44:47],v[68:71],v[80:87],v2
ds_read_b128 v[80:83],v21 offset:18432
v_smfmac_f32_16x16x64_bf16 v[24:27],v[60:63],v[176:183],v2
ds_read_b128 v[84:87],v21 offset:19456
v_smfmac_f32_16x16x64_bf16 v[36:39],v[60:63],v[200:207],v2
ds_read_b128 v[104:107],v58 offset:6144
s_waitcnt lgkmcnt(7)
v_smfmac_f32_16x16x64_bf16 v[24:27],v[64:67],v[216:223],v2
v_smfmac_f32_16x16x64_bf16 v[36:39],v[64:67],v[240:247],v2
ds_read_b128 v[108:111],v58 offset:7168
v_smfmac_f32_16x16x64_bf16 v[28:31],v[60:63],v[184:191],v2
v_smfmac_f32_16x16x64_bf16 v[40:43],v[60:63],v[208:215],v2
v_add_f32 v24,v24,v25
v_smfmac_f32_16x16x64_bf16 v[28:31],v[64:67],v[224:231],v2
v_add_f32 v26,v26,v27
v_smfmac_f32_16x16x64_bf16 v[40:43],v[64:67],v[248:255],v2
v_add_f32 v36,v36,v37
v_smfmac_f32_16x16x64_bf16 v[32:35],v[60:63],v[192:199],v2
v_add_f32 v38,v38,v39
s_waitcnt lgkmcnt(6)
v_smfmac_f32_16x16x64_bf16 v[44:47],v[60:63],v[72:79],v2
v_cvt_pk_bf16_f32 v37,v24,v26
v_smfmac_f32_16x16x64_bf16 v[32:35],v[64:67],v[232:239],v2
v_cvt_pk_bf16_f32 v36,v36,v38
s_waitcnt lgkmcnt(2)
v_smfmac_f32_16x16x64_bf16 v[44:47],v[64:67],v[80:87],v2
ds_write_b64 v6,v[36:37] offset:0
v_add_f32 v28,v28,v29
v_add_f32 v30,v30,v31
v_add_f32 v40,v40,v41
v_add_f32 v42,v42,v43
v_cvt_pk_bf16_f32 v41,v28,v30
v_cvt_pk_bf16_f32 v40,v40,v42
ds_write_b64 v6,v[40:41] offset:512
v_add_f32 v32,v32,v33
v_add_f32 v34,v34,v35
v_add_f32 v44,v44,v45
v_add_f32 v46,v46,v47
v_cvt_pk_bf16_f32 v45,v32,v34
v_cvt_pk_bf16_f32 v44,v44,v46
ds_write_b64 v6,v[44:45] offset:1024
ds_read_b128 v[72:75],v58 offset:8192
ds_read_b128 v[76:79],v58 offset:9216
s_waitcnt lgkmcnt(2)
s_barrier
ds_read_b64_tr_b16 v[24:25],v7 offset:0
ds_read_b64_tr_b16 v[26:27],v7 offset:512
ds_read_b64_tr_b16 v[28:29],v7 offset:1024
ds_read_b64_tr_b16 v[30:31],v7 offset:1536
ds_read_b64_tr_b16 v[32:33],v7 offset:2048
ds_read_b64_tr_b16 v[34:35],v7 offset:2560
ds_read_b64_tr_b16 v[36:37],v7 offset:3072
ds_read_b64_tr_b16 v[38:39],v7 offset:3584
s_waitcnt lgkmcnt(6)
v_mfma_f32_16x16x32_bf16 v[60:63],v[48:51],v[24:27],0
ds_read_b64_tr_b16 v[40:41],v7 offset:4096
v_mfma_f32_16x16x32_bf16 v[64:67],v[52:55],v[24:27],0
ds_read_b64_tr_b16 v[42:43],v7 offset:4608
v_mfma_f32_16x16x32_bf16 v[68:71],v[24:27],v[24:27],0
ds_read_b128 v[80:83],v58 offset:10240
s_waitcnt lgkmcnt(7)
v_mfma_f32_16x16x32_bf16 v[60:63],v[88:91],v[28:31],v[60:63]
ds_read_b128 v[84:87],v58 offset:11264
v_mfma_f32_16x16x32_bf16 v[64:67],v[92:95],v[28:31],v[64:67]
ds_read_b64_tr_b16 v[44:45],v7 offset:5120
v_mfma_f32_16x16x32_bf16 v[68:71],v[28:31],v[28:31],v[68:71]
ds_read_b64_tr_b16 v[46:47],v7 offset:5632
s_waitcnt lgkmcnt(8)
v_mfma_f32_16x16x32_bf16 v[60:63],v[96:99],v[32:35],v[60:63]
ds_read_b128 v[24:27],v17 offset:12288
v_mfma_f32_16x16x32_bf16 v[64:67],v[100:103],v[32:35],v[64:67]
ds_read_b128 v[28:31],v17 offset:13312
v_mfma_f32_16x16x32_bf16 v[68:71],v[32:35],v[32:35],v[68:71]
s_waitcnt lgkmcnt(8)
v_mfma_f32_16x16x32_bf16 v[60:63],v[104:107],v[36:39],v[60:63]
ds_read_b128 v[32:35],v17 offset:14336
v_mfma_f32_16x16x32_bf16 v[64:67],v[108:111],v[36:39],v[64:67]
v_mfma_f32_16x16x32_bf16 v[68:71],v[36:39],v[36:39],v[68:71]
s_waitcnt lgkmcnt(7)
v_mfma_f32_16x16x32_bf16 v[60:63],v[72:75],v[40:43],v[60:63]
ds_read_b128 v[36:39],v17 offset:15360
v_mfma_f32_16x16x32_bf16 v[64:67],v[76:79],v[40:43],v[64:67]
v_mfma_f32_16x16x32_bf16 v[68:71],v[40:43],v[40:43],v[68:71]
s_waitcnt lgkmcnt(4)
v_mfma_f32_16x16x32_bf16 v[60:63],v[80:83],v[44:47],v[60:63]
v_mfma_f32_16x16x32_bf16 v[64:67],v[84:87],v[44:47],v[64:67]
buffer_load_dwordx4 v[48:51],v1,s[8:11],s71 offen sc1
v_mfma_f32_16x16x32_bf16 v[68:71],v[44:47],v[44:47],v[68:71]
s_nop 4
v_cndmask_b32_dpp v60,v64,v60,vcc quad_perm:[2,3,2,3] row_mask:0xf bank_mask:0xf
v_cndmask_b32_dpp v61,v65,v61,vcc quad_perm:[2,3,2,3] row_mask:0xf bank_mask:0xf
v_cndmask_b32_dpp v62,v66,v62,vcc quad_perm:[2,3,2,3] row_mask:0xf bank_mask:0xf
v_cndmask_b32_dpp v63,v67,v63,vcc quad_perm:[2,3,2,3] row_mask:0xf bank_mask:0xf
v_max3_f32 v12,v60,v61,v62
v_cndmask_b32_dpp v68,v69,v68,vcc quad_perm:[2,3,2,3] row_mask:0xf bank_mask:0xf
v_max3_f32 v12,v12,v63,v68
s_nop 1
v_max_f32_dpp v13,v12,v12 quad_perm:[2,3,0,1] row_mask:0xf bank_mask:0xf
v_max_f32_dpp v12,v12,v12 quad_perm:[2,3,0,1] row_mask:0xf bank_mask:0xf
s_nop 1
v_permlane32_swap_b32 v12,v13
v_max_f32 v15,v12,v13
v_max_f32 v12,v12,v13
s_mov_b64 exec,1
buffer_store_dword v16,v1,s[8:11],s72 offen
s_mov_b64 exec,-1
v_permlane16_swap_b32 v12,v15
v_max_f32 v12,v12,v15
v_mul_f32 v12,s87,v12
v_fma_f32 v60,v60,s87,-v12
v_fma_f32 v61,v61,s87,-v12
v_fma_f32 v62,v62,s87,-v12
v_fma_f32 v63,v63,s87,-v12
v_fma_f32 v68,v68,s87,-v12
v_exp_f32 v60,v60
v_exp_f32 v61,v61
v_exp_f32 v62,v62
v_exp_f32 v63,v63
v_exp_f32 v68,v68
v_cvt_pk_bf16_f32 v70,v60,v61
v_cvt_pk_bf16_f32 v71,v62,v63
v_cndmask_b32 v46,v70,v10,vcc
v_cndmask_b32 v47,v71,v10,vcc
v_cndmask_b32_dpp v44,v70,v10,vcc quad_perm:[2,3,0,1] row_mask:0xf bank_mask:0xf
v_cndmask_b32_dpp v45,v71,v10,vcc quad_perm:[2,3,0,1] row_mask:0xf bank_mask:0xf
s_mov_b64 vcc,s[90:91]
s_waitcnt lgkmcnt(0)
v_cndmask_b32 v40,v70,v10,vcc
v_mfma_f32_16x16x32_bf16 v[64:67],v[28:31],v[44:47],0
v_cndmask_b32 v41,v71,v10,vcc
v_cndmask_b32_dpp v42,v70,v10,vcc quad_perm:[2,3,0,1] row_mask:0xf bank_mask:0xf
v_mfma_f32_16x16x32_bf16 v[52:55],v[36:39],v[44:47],0
v_cndmask_b32_dpp v43,v71,v10,vcc quad_perm:[2,3,0,1] row_mask:0xf bank_mask:0xf
v_mov_b32_dpp v14,v68 quad_perm:[2,3,0,1] row_mask:0xf bank_mask:0xf
v_add_f32 v12,v60,v61
v_mfma_f32_16x16x32_bf16 v[64:67],v[24:27],v[40:43],v[64:67]
v_cvt_pk_bf16_f32 v56,v68,v14
v_cvt_pk_bf16_f32 v57,v14,v68
v_mfma_f32_16x16x32_bf16 v[52:55],v[32:35],v[40:43],v[52:55]
v_cndmask_b32 v56,v56,v10,vcc
v_cndmask_b32 v57,v10,v57,vcc
v_add_f32 v13,v62,v63
v_add_f32 v12,v12,v68
v_add_f32 v12,v12,v13
s_waitcnt vmcnt(1)
v_bitop3_b32 v17,v48,v50,s57 bitop3:0x7e
v_add_f32_dpp v13,v12,v12 quad_perm:[2,3,0,1] row_mask:0xf bank_mask:0xf
v_and_b32 v17,1,v17
v_add_f32_dpp v12,v12,v12 quad_perm:[2,3,0,1] row_mask:0xf bank_mask:0xf
v_cmp_ne_u32 vcc,0,v17
s_cbranch_vccnz vb_96
vo_97:
v_mfma_f32_16x16x16_bf16 v[64:67],v[48:49],v[56:57],v[64:67]
v_permlane32_swap_b32 v12,v13
v_add_f32 v15,v12,v13
v_mfma_f32_16x16x16_bf16 v[52:55],v[50:51],v[56:57],v[52:55]
v_add_f32 v12,v12,v13
s_nop 1
v_permlane16_swap_b32 v12,v15
v_add_f32 v12,v12,v15
v_rcp_f32 v12,v12
s_nop 0
v_pk_mul_f32 v[64:65],v[64:65],v[12:13] op_sel_hi:[1,0]
v_pk_mul_f32 v[66:67],v[66:67],v[12:13] op_sel_hi:[1,0]
v_pk_mul_f32 v[52:53],v[52:53],v[12:13] op_sel_hi:[1,0]
v_pk_mul_f32 v[54:55],v[54:55],v[12:13] op_sel_hi:[1,0]
v_cvt_pk_bf16_f32 v48,v64,v65
v_cvt_pk_bf16_f32 v49,v66,v67
v_cvt_pk_bf16_f32 v50,v52,v53
v_cvt_pk_bf16_f32 v51,v54,v55
v_and_or_b32 v48,v48,-2,s57
ds_read_b32 v0,v9
buffer_store_dwordx4 v[48:51],v8,s[8:11],s70 offen
s_mov_b32 s57,s31
v_mov_b32 v12,s50
s_waitcnt lgkmcnt(0)
v_cmp_ne_u32 vcc,s50,v0
ds_write_b32 v20,v12
s_cmp_lt_u32 s50,128
s_cbranch_scc1 CS_LOOP_F
s_branch CS_DONE
fr_94:
v_bitop3_b32 v12,v72,v76,s57 bitop3:0x7e
v_bitop3_b32 v13,v80,v80,s57 bitop3:0x7e
v_xor_b32 v14,s57,v80
v_or3_b32 v12,v12,v13,v14
v_and_b32 v12,1,v12
v_cmp_ne_u32 vcc,0,v12
s_cbranch_vccz sk_98
buffer_load_dwordx2 v[80:81],v18,s[8:11],s59 offen sc1
buffer_load_dwordx4 v[72:75],v1,s[8:11],s59 offen sc1
buffer_load_dwordx4 v[76:79],v1,s[8:11],s59 offen offset:1024 sc1
sk_98:
buffer_load_dwordx2 v[90:91],v18,s[8:11],s68 offen sc1
buffer_load_dwordx4 v[82:85],v1,s[8:11],s68 offen sc1
buffer_load_dwordx4 v[86:89],v1,s[8:11],s68 offen offset:1024 sc1
s_sub_u32 s47,s47,1
s_cbranch_scc1 ABORT
s_waitcnt lgkmcnt(0)
s_branch fa_93
vb_96:
s_sub_u32 s47,s47,1
s_cbranch_scc1 ABORT
buffer_load_dwordx4 v[48:51],v1,s[8:11],s71 offen sc1
s_waitcnt vmcnt(0)
v_bitop3_b32 v17,v48,v50,s57 bitop3:0x7e
v_and_b32 v17,1,v17
v_cmp_ne_u32 vcc,0,v17
s_nop 0
s_cbranch_vccnz vb_96
s_branch vo_97
CS_LOOP_S:
s_barrier
buffer_load_dwordx2 v[80:81],v18,s[8:11],s59 offen sc1
buffer_load_dwordx4 v[72:75],v1,s[8:11],s59 offen sc1
buffer_load_dwordx4 v[76:79],v1,s[8:11],s59 offen offset:1024 sc1
s_cbranch_vccz fj_101f
s_waitcnt vmcnt(2)
s_sleep 3
fj_101f:
buffer_load_dwordx2 v[90:91],v18,s[8:11],s68 offen sc1
buffer_load_dwordx4 v[82:85],v1,s[8:11],s68 offen sc1
buffer_load_dwordx4 v[86:89],v1,s[8:11],s68 offen offset:1024 sc1
v_mfma_f32_32x32x8_bf16 v[24:39],v[10:11],v[10:11],0
v_mfma_f32_16x16x16_bf16 v[40:43],v[10:11],v[10:11],0
v_mfma_f32_16x16x16_bf16 v[44:47],v[10:11],v[10:11],0
fj_101:
fa_99:
s_waitcnt vmcnt(5)
v_lshlrev_b32 v108,16,v80
v_and_b32 v109,0xffff0000,v80
v_lshlrev_b32 v110,16,v81
v_and_b32 v111,0xffff0000,v81
s_waitcnt vmcnt(4)
v_lshlrev_b32 v92,16,v72
v_and_b32 v93,0xffff0000,v72
v_lshlrev_b32 v94,16,v73
v_and_b32 v95,0xffff0000,v73
v_lshlrev_b32 v96,16,v74
v_and_b32 v97,0xffff0000,v74
v_lshlrev_b32 v98,16,v75
v_and_b32 v99,0xffff0000,v75
s_waitcnt vmcnt(3)
v_lshlrev_b32 v100,16,v76
v_and_b32 v101,0xffff0000,v76
v_lshlrev_b32 v102,16,v77
v_and_b32 v103,0xffff0000,v77
v_lshlrev_b32 v104,16,v78
v_and_b32 v105,0xffff0000,v78
v_lshlrev_b32 v106,16,v79
v_and_b32 v107,0xffff0000,v79
s_waitcnt vmcnt(2)
v_dot2c_f32_bf16 v108,s37,v90
v_dot2c_f32_bf16 v109,s81,v90
v_dot2c_f32_bf16 v110,s37,v91
v_dot2c_f32_bf16 v111,s81,v91
v_bitop3_b32 v16,v80,v90,s57 bitop3:0x7e
v_cvt_pk_bf16_f32 v56,v108,v109
s_nop 0
v_cvt_pk_bf16_f32 v57,v110,v111
ds_write_b64 v23,v[56:57]
s_waitcnt vmcnt(1)
v_dot2c_f32_bf16 v92,s37,v82
v_dot2c_f32_bf16 v93,s81,v82
v_dot2c_f32_bf16 v94,s37,v83
v_dot2c_f32_bf16 v95,s81,v83
v_dot2c_f32_bf16 v96,s37,v84
v_dot2c_f32_bf16 v97,s81,v84
v_dot2c_f32_bf16 v98,s37,v85
v_dot2c_f32_bf16 v99,s81,v85
v_bitop3_b32 v17,v72,v82,s57 bitop3:0x7e
v_or_b32 v16,v16,v17
v_cvt_pk_bf16_f32 v48,v92,v93
v_cvt_pk_bf16_f32 v49,v94,v95
v_cvt_pk_bf16_f32 v50,v96,v97
v_cvt_pk_bf16_f32 v51,v98,v99
ds_write_b128 v22,v[48:51] offset:0
s_waitcnt vmcnt(0)
v_dot2c_f32_bf16 v100,s37,v86
v_dot2c_f32_bf16 v101,s81,v86
v_dot2c_f32_bf16 v102,s37,v87
v_dot2c_f32_bf16 v103,s81,v87
v_dot2c_f32_bf16 v104,s37,v88
v_dot2c_f32_bf16 v105,s81,v88
v_dot2c_f32_bf16 v106,s37,v89
v_dot2c_f32_bf16 v107,s81,v89
v_bitop3_b32 v17,v76,v86,s57 bitop3:0x7e
v_bitop3_b32 v16,v16,v17,1 bitop3:0xa8
v_cmp_ne_u32 vcc,0,v16
v_cvt_pk_bf16_f32 v52,v100,v101
v_cvt_pk_bf16_f32 v53,v102,v103
v_cvt_pk_bf16_f32 v54,v104,v105
v_cvt_pk_bf16_f32 v55,v106,v107
ds_write_b128 v22,v[52:55] offset:1024
s_cbranch_vccnz fr_100
fj_101g:
v_smfmac_f32_16x16x64_bf16 v[24:27],v[48:51],a[0:7],v2
ds_read_b128 v[72:75],v21 offset:0
v_xor_b32 v58,57344,v58
v_smfmac_f32_16x16x64_bf16 v[28:31],v[48:51],a[8:15],v2
ds_read_b128 v[76:79],v21 offset:1024
s_sub_u32 s60,s4,s5
v_smfmac_f32_16x16x64_bf16 v[32:35],v[48:51],a[16:23],v2
ds_read_b128 v[80:83],v21 offset:2048
s_cmp_gt_i32 s60,13
v_smfmac_f32_16x16x64_bf16 v[36:39],v[48:51],a[24:31],v2
ds_read_b128 v[84:87],v21 offset:3072
s_cselect_b32 s53,1,0
s_waitcnt lgkmcnt(4)
s_barrier
v_smfmac_f32_16x16x64_bf16 v[40:43],v[48:51],a[32:39],v2
ds_read_b128 v[60:63],v3 offset:0
s_cmp_eq_u32 s4,64
v_smfmac_f32_16x16x64_bf16 v[24:27],v[52:55],a[40:47],v2
ds_read_b128 v[64:67],v3 offset:1024
s_cselect_b32 s53,1,s53
v_smfmac_f32_16x16x64_bf16 v[28:31],v[52:55],a[48:55],v2
ds_read_b128 v[68:71],v4 offset:0
s_cmp_eq_u32 s53,0
v_smfmac_f32_16x16x64_bf16 v[32:35],v[52:55],a[56:63],v2
s_cselect_b32 s54,s4,s5
s_addc_u32 s4,s4,0
s_add_u32 s5,s5,s53
v_smfmac_f32_16x16x64_bf16 v[36:39],v[52:55],a[64:71],v2
s_mul_i32 s73,s54,393216
s_add_u32 s73,s73,s84
s_sub_u32 s74,s75,s74
v_smfmac_f32_16x16x64_bf16 v[40:43],v[52:55],a[72:79],v2
s_mov_b32 m0,s74
s_and_b32 s60,s52,1
s_waitcnt lgkmcnt(5)
v_smfmac_f32_16x16x64_bf16 v[44:47],v[48:51],v[72:79],v2
ds_read_b128 v[72:75],v21 offset:4096
s_waitcnt lgkmcnt(4)
v_smfmac_f32_16x16x64_bf16 v[44:47],v[52:55],v[80:87],v2
ds_read_b128 v[76:79],v21 offset:5120
s_waitcnt lgkmcnt(4)
v_smfmac_f32_16x16x64_bf16 v[24:27],v[60:63],a[80:87],v2
ds_read_b128 v[80:83],v21 offset:6144
s_lshl2_add_u32 s60,s51,s60
v_smfmac_f32_16x16x64_bf16 v[28:31],v[60:63],a[88:95],v2
ds_read_b128 v[84:87],v21 offset:7168
s_mul_i32 s60,s60,49152
v_smfmac_f32_16x16x64_bf16 v[32:35],v[60:63],a[96:103],v2
s_add_u32 s71,s60,s34
s_add_u32 s70,s60,s33
s_lshl_b32 s60,s51,9
v_smfmac_f32_16x16x64_bf16 v[36:39],v[60:63],a[104:111],v2
s_add_u32 s72,s60,s35
buffer_load_dwordx4 v1,s[8:11],s73 offen sc1 lds
v_smfmac_f32_16x16x64_bf16 v[40:43],v[60:63],a[112:119],v2
buffer_load_dwordx4 v1,s[8:11],s73 offen offset:1024 sc1 lds
s_waitcnt lgkmcnt(2)
v_smfmac_f32_16x16x64_bf16 v[44:47],v[60:63],v[72:79],v2
ds_read_b128 v[60:63],v4 offset:1024
v_smfmac_f32_16x16x64_bf16 v[24:27],v[64:67],a[120:127],v2
ds_read_b128 v[72:75],v21 offset:8192
v_smfmac_f32_16x16x64_bf16 v[28:31],v[64:67],a[128:135],v2
ds_read_b128 v[76:79],v21 offset:9216
v_smfmac_f32_16x16x64_bf16 v[32:35],v[64:67],a[136:143],v2
buffer_load_dwordx4 v1,s[8:11],s73 offen offset:2048 sc1 lds
v_smfmac_f32_16x16x64_bf16 v[36:39],v[64:67],a[144:151],v2
buffer_load_dwordx4 v1,s[8:11],s73 offen offset:3072 sc1 lds
v_add_u32 v17,s85,v58
v_smfmac_f32_16x16x64_bf16 v[40:43],v[64:67],a[152:159],v2
v_mov_b32 v16,s58
s_and_b32 s60,s54,1
s_waitcnt lgkmcnt(3)
v_smfmac_f32_16x16x64_bf16 v[44:47],v[64:67],v[80:87],v2
ds_read_b128 v[64:67],v5 offset:0
s_lshl2_add_u32 s60,s53,s60
v_smfmac_f32_16x16x64_bf16 v[24:27],v[68:71],a[160:167],v2
ds_read_b128 v[80:83],v21 offset:10240
s_lshl_b32 s68,s60,16
v_smfmac_f32_16x16x64_bf16 v[28:31],v[68:71],a[168:175],v2
ds_read_b128 v[84:87],v21 offset:11264
s_add_u32 s68,s68,s83
v_smfmac_f32_16x16x64_bf16 v[32:35],v[68:71],a[176:183],v2
s_mul_i32 s59,s60,20480
s_add_u32 s59,s59,s6
s_lshl_b32 s69,s53,9
v_smfmac_f32_16x16x64_bf16 v[36:39],v[68:71],a[184:191],v2
s_add_u32 s69,s69,s7
s_bfe_u32 s31,s54,65537
s_add_u32 s32,s54,1
v_smfmac_f32_16x16x64_bf16 v[40:43],v[68:71],a[192:199],v2
s_add_u32 s50,s50,1
s_mov_b32 s51,s53
s_waitcnt lgkmcnt(3)
v_smfmac_f32_16x16x64_bf16 v[44:47],v[68:71],v[72:79],v2
ds_read_b128 v[68:71],v5 offset:1024
s_mov_b32 s52,s54
v_smfmac_f32_16x16x64_bf16 v[24:27],v[60:63],a[200:207],v2
ds_read_b128 v[72:75],v21 offset:12288
s_mov_b32 s58,s32
v_smfmac_f32_16x16x64_bf16 v[28:31],v[60:63],a[208:215],v2
ds_read_b128 v[76:79],v21 offset:13312
s_mov_b64 vcc,s[88:89]
v_smfmac_f32_16x16x64_bf16 v[32:35],v[60:63],a[216:223],v2
ds_read_b128 v[48:51],v58 offset:0
v_smfmac_f32_16x16x64_bf16 v[36:39],v[60:63],a[224:231],v2
v_smfmac_f32_16x16x64_bf16 v[40:43],v[60:63],a[232:239],v2
ds_read_b128 v[52:55],v58 offset:1024
s_waitcnt lgkmcnt(5)
v_smfmac_f32_16x16x64_bf16 v[44:47],v[60:63],v[80:87],v2
ds_read_b128 v[60:63],v59 offset:0
v_smfmac_f32_16x16x64_bf16 v[24:27],v[64:67],a[240:247],v2
ds_read_b128 v[80:83],v21 offset:14336
v_smfmac_f32_16x16x64_bf16 v[28:31],v[64:67],a[248:255],v2
ds_read_b128 v[84:87],v21 offset:15360
v_smfmac_f32_16x16x64_bf16 v[32:35],v[64:67],v[112:119],v2
ds_read_b128 v[88:91],v58 offset:2048
v_smfmac_f32_16x16x64_bf16 v[36:39],v[64:67],v[120:127],v2
v_smfmac_f32_16x16x64_bf16 v[40:43],v[64:67],v[128:135],v2
ds_read_b128 v[92:95],v58 offset:3072
s_waitcnt lgkmcnt(7)
v_smfmac_f32_16x16x64_bf16 v[44:47],v[64:67],v[72:79],v2
ds_read_b128 v[64:67],v59 offset:1024
v_smfmac_f32_16x16x64_bf16 v[24:27],v[68:71],v[136:143],v2
ds_read_b128 v[72:75],v21 offset:16384
v_smfmac_f32_16x16x64_bf16 v[28:31],v[68:71],v[144:151],v2
ds_read_b128 v[76:79],v21 offset:17408
v_smfmac_f32_16x16x64_bf16 v[32:35],v[68:71],v[152:159],v2
ds_read_b128 v[96:99],v58 offset:4096
v_smfmac_f32_16x16x64_bf16 v[36:39],v[68:71],v[160:167],v2
v_smfmac_f32_16x16x64_bf16 v[40:43],v[68:71],v[168:175],v2
ds_read_b128 v[100:103],v58 offset:5120
s_waitcnt lgkmcnt(7)
v_smfmac_f32_16x16x64_bf16 v[44:47],v[68:71],v[80:87],v2
ds_read_b128 v[80:83],v21 offset:18432
v_smfmac_f32_16x16x64_bf16 v[24:27],v[60:63],v[176:183],v2
ds_read_b128 v[84:87],v21 offset:19456
v_smfmac_f32_16x16x64_bf16 v[36:39],v[60:63],v[200:207],v2
ds_read_b128 v[104:107],v58 offset:6144
s_waitcnt lgkmcnt(7)
v_smfmac_f32_16x16x64_bf16 v[24:27],v[64:67],v[216:223],v2
v_smfmac_f32_16x16x64_bf16 v[36:39],v[64:67],v[240:247],v2
ds_read_b128 v[108:111],v58 offset:7168
v_smfmac_f32_16x16x64_bf16 v[28:31],v[60:63],v[184:191],v2
v_smfmac_f32_16x16x64_bf16 v[40:43],v[60:63],v[208:215],v2
v_add_f32 v24,v24,v25
v_smfmac_f32_16x16x64_bf16 v[28:31],v[64:67],v[224:231],v2
v_add_f32 v26,v26,v27
v_smfmac_f32_16x16x64_bf16 v[40:43],v[64:67],v[248:255],v2
v_add_f32 v36,v36,v37
v_smfmac_f32_16x16x64_bf16 v[32:35],v[60:63],v[192:199],v2
v_add_f32 v38,v38,v39
s_waitcnt lgkmcnt(6)
v_smfmac_f32_16x16x64_bf16 v[44:47],v[60:63],v[72:79],v2
v_cvt_pk_bf16_f32 v37,v24,v26
v_smfmac_f32_16x16x64_bf16 v[32:35],v[64:67],v[232:239],v2
v_cvt_pk_bf16_f32 v36,v36,v38
s_waitcnt lgkmcnt(2)
v_smfmac_f32_16x16x64_bf16 v[44:47],v[64:67],v[80:87],v2
ds_write_b64 v6,v[36:37] offset:0
v_add_f32 v28,v28,v29
v_add_f32 v30,v30,v31
v_add_f32 v40,v40,v41
v_add_f32 v42,v42,v43
v_cvt_pk_bf16_f32 v41,v28,v30
v_cvt_pk_bf16_f32 v40,v40,v42
ds_write_b64 v6,v[40:41] offset:512
v_add_f32 v32,v32,v33
v_add_f32 v34,v34,v35
v_add_f32 v44,v44,v45
v_add_f32 v46,v46,v47
v_cvt_pk_bf16_f32 v45,v32,v34
v_cvt_pk_bf16_f32 v44,v44,v46
ds_write_b64 v6,v[44:45] offset:1024
ds_read_b128 v[72:75],v58 offset:8192
ds_read_b128 v[76:79],v58 offset:9216
s_waitcnt lgkmcnt(2)
s_barrier
ds_read_b64_tr_b16 v[24:25],v7 offset:0
ds_read_b64_tr_b16 v[26:27],v7 offset:512
ds_read_b64_tr_b16 v[28:29],v7 offset:1024
ds_read_b64_tr_b16 v[30:31],v7 offset:1536
ds_read_b64_tr_b16 v[32:33],v7 offset:2048
ds_read_b64_tr_b16 v[34:35],v7 offset:2560
ds_read_b64_tr_b16 v[36:37],v7 offset:3072
ds_read_b64_tr_b16 v[38:39],v7 offset:3584
s_waitcnt lgkmcnt(6)
v_mfma_f32_16x16x32_bf16 v[60:63],v[48:51],v[24:27],0
ds_read_b64_tr_b16 v[40:41],v7 offset:4096
v_mfma_f32_16x16x32_bf16 v[64:67],v[52:55],v[24:27],0
ds_read_b64_tr_b16 v[42:43],v7 offset:4608
v_mfma_f32_16x16x32_bf16 v[68:71],v[24:27],v[24:27],0
ds_read_b128 v[80:83],v58 offset:10240
s_waitcnt lgkmcnt(7)
v_mfma_f32_16x16x32_bf16 v[60:63],v[88:91],v[28:31],v[60:63]
ds_read_b128 v[84:87],v58 offset:11264
v_mfma_f32_16x16x32_bf16 v[64:67],v[92:95],v[28:31],v[64:67]
ds_read_b64_tr_b16 v[44:45],v7 offset:5120
v_mfma_f32_16x16x32_bf16 v[68:71],v[28:31],v[28:31],v[68:71]
ds_read_b64_tr_b16 v[46:47],v7 offset:5632
s_waitcnt lgkmcnt(8)
v_mfma_f32_16x16x32_bf16 v[60:63],v[96:99],v[32:35],v[60:63]
ds_read_b128 v[24:27],v17 offset:12288
v_mfma_f32_16x16x32_bf16 v[64:67],v[100:103],v[32:35],v[64:67]
ds_read_b128 v[28:31],v17 offset:13312
v_mfma_f32_16x16x32_bf16 v[68:71],v[32:35],v[32:35],v[68:71]
s_waitcnt lgkmcnt(8)
v_mfma_f32_16x16x32_bf16 v[60:63],v[104:107],v[36:39],v[60:63]
ds_read_b128 v[32:35],v17 offset:14336
v_mfma_f32_16x16x32_bf16 v[64:67],v[108:111],v[36:39],v[64:67]
v_mfma_f32_16x16x32_bf16 v[68:71],v[36:39],v[36:39],v[68:71]
s_waitcnt lgkmcnt(7)
v_mfma_f32_16x16x32_bf16 v[60:63],v[72:75],v[40:43],v[60:63]
ds_read_b128 v[36:39],v17 offset:15360
v_mfma_f32_16x16x32_bf16 v[64:67],v[76:79],v[40:43],v[64:67]
v_mfma_f32_16x16x32_bf16 v[68:71],v[40:43],v[40:43],v[68:71]
s_waitcnt lgkmcnt(4)
v_mfma_f32_16x16x32_bf16 v[60:63],v[80:83],v[44:47],v[60:63]
v_mfma_f32_16x16x32_bf16 v[64:67],v[84:87],v[44:47],v[64:67]
buffer_load_dwordx4 v[48:51],v1,s[8:11],s71 offen sc1
v_mfma_f32_16x16x32_bf16 v[68:71],v[44:47],v[44:47],v[68:71]
s_nop 4
v_cndmask_b32_dpp v60,v64,v60,vcc quad_perm:[2,3,2,3] row_mask:0xf bank_mask:0xf
v_cndmask_b32_dpp v61,v65,v61,vcc quad_perm:[2,3,2,3] row_mask:0xf bank_mask:0xf
v_cndmask_b32_dpp v62,v66,v62,vcc quad_perm:[2,3,2,3] row_mask:0xf bank_mask:0xf
v_cndmask_b32_dpp v63,v67,v63,vcc quad_perm:[2,3,2,3] row_mask:0xf bank_mask:0xf
v_max3_f32 v12,v60,v61,v62
v_cndmask_b32_dpp v68,v69,v68,vcc quad_perm:[2,3,2,3] row_mask:0xf bank_mask:0xf
v_max3_f32 v12,v12,v63,v68
s_nop 1
v_max_f32_dpp v13,v12,v12 quad_perm:[2,3,0,1] row_mask:0xf bank_mask:0xf
v_max_f32_dpp v12,v12,v12 quad_perm:[2,3,0,1] row_mask:0xf bank_mask:0xf
s_nop 1
v_permlane32_swap_b32 v12,v13
v_max_f32 v15,v12,v13
v_max_f32 v12,v12,v13
s_mov_b64 exec,1
buffer_store_dword v16,v1,s[8:11],s72 offen sc1
s_mov_b64 exec,-1
v_permlane16_swap_b32 v12,v15
v_max_f32 v12,v12,v15
v_mul_f32 v12,s87,v12
v_fma_f32 v60,v60,s87,-v12
v_fma_f32 v61,v61,s87,-v12
v_fma_f32 v62,v62,s87,-v12
v_fma_f32 v63,v63,s87,-v12
v_fma_f32 v68,v68,s87,-v12
v_exp_f32 v60,v60
v_exp_f32 v61,v61
v_exp_f32 v62,v62
v_exp_f32 v63,v63
v_exp_f32 v68,v68
v_cvt_pk_bf16_f32 v70,v60,v61
v_cvt_pk_bf16_f32 v71,v62,v63
v_cndmask_b32 v46,v70,v10,vcc
v_cndmask_b32 v47,v71,v10,vcc
v_cndmask_b32_dpp v44,v70,v10,vcc quad_perm:[2,3,0,1] row_mask:0xf bank_mask:0xf
v_cndmask_b32_dpp v45,v71,v10,vcc quad_perm:[2,3,0,1] row_mask:0xf bank_mask:0xf
s_mov_b64 vcc,s[90:91]
s_waitcnt lgkmcnt(0)
v_cndmask_b32 v40,v70,v10,vcc
v_mfma_f32_16x16x32_bf16 v[64:67],v[28:31],v[44:47],0
v_cndmask_b32 v41,v71,v10,vcc
v_cndmask_b32_dpp v42,v70,v10,vcc quad_perm:[2,3,0,1] row_mask:0xf bank_mask:0xf
v_mfma_f32_16x16x32_bf16 v[52:55],v[36:39],v[44:47],0
v_cndmask_b32_dpp v43,v71,v10,vcc quad_perm:[2,3,0,1] row_mask:0xf bank_mask:0xf
v_mov_b32_dpp v14,v68 quad_perm:[2,3,0,1] row_mask:0xf bank_mask:0xf
v_add_f32 v12,v60,v61
v_mfma_f32_16x16x32_bf16 v[64:67],v[24:27],v[40:43],v[64:67]
v_cvt_pk_bf16_f32 v56,v68,v14
v_cvt_pk_bf16_f32 v57,v14,v68
v_mfma_f32_16x16x32_bf16 v[52:55],v[32:35],v[40:43],v[52:55]
v_cndmask_b32 v56,v56,v10,vcc
v_cndmask_b32 v57,v10,v57,vcc
v_add_f32 v13,v62,v63
v_add_f32 v12,v12,v68
v_add_f32 v12,v12,v13
s_waitcnt vmcnt(1)
v_bitop3_b32 v17,v48,v50,s57 bitop3:0x7e
v_add_f32_dpp v13,v12,v12 quad_perm:[2,3,0,1] row_mask:0xf bank_mask:0xf
v_and_b32 v17,1,v17
v_add_f32_dpp v12,v12,v12 quad_perm:[2,3,0,1] row_mask:0xf bank_mask:0xf
v_cmp_ne_u32 vcc,0,v17
s_cbranch_vccnz vb_102
vo_103:
v_mfma_f32_16x16x16_bf16 v[64:67],v[48:49],v[56:57],v[64:67]
v_permlane32_swap_b32 v12,v13
v_add_f32 v15,v12,v13
v_mfma_f32_16x16x16_bf16 v[52:55],v[50:51],v[56:57],v[52:55]
v_add_f32 v12,v12,v13
s_nop 1
v_permlane16_swap_b32 v12,v15
v_add_f32 v12,v12,v15
v_rcp_f32 v12,v12
s_nop 0
v_pk_mul_f32 v[64:65],v[64:65],v[12:13] op_sel_hi:[1,0]
v_pk_mul_f32 v[66:67],v[66:67],v[12:13] op_sel_hi:[1,0]
v_pk_mul_f32 v[52:53],v[52:53],v[12:13] op_sel_hi:[1,0]
v_pk_mul_f32 v[54:55],v[54:55],v[12:13] op_sel_hi:[1,0]
v_cvt_pk_bf16_f32 v48,v64,v65
v_cvt_pk_bf16_f32 v49,v66,v67
v_cvt_pk_bf16_f32 v50,v52,v53
v_cvt_pk_bf16_f32 v51,v54,v55
v_and_or_b32 v48,v48,-2,s57
ds_read_b32 v0,v9
buffer_store_dwordx4 v[48:51],v8,s[8:11],s70 offen sc1
s_mov_b32 s57,s31
v_mov_b32 v12,s50
s_waitcnt lgkmcnt(0)
v_cmp_ne_u32 vcc,s50,v0
ds_write_b32 v20,v12
s_cmp_lt_u32 s50,128
s_cbranch_scc1 CS_LOOP_S
s_branch CS_DONE
fr_100:
v_bitop3_b32 v12,v72,v76,s57 bitop3:0x7e
v_bitop3_b32 v13,v80,v80,s57 bitop3:0x7e
v_xor_b32 v14,s57,v80
v_or3_b32 v12,v12,v13,v14
v_and_b32 v12,1,v12
v_cmp_ne_u32 vcc,0,v12
s_cbranch_vccz sk_104
buffer_load_dwordx2 v[80:81],v18,s[8:11],s59 offen sc1
buffer_load_dwordx4 v[72:75],v1,s[8:11],s59 offen sc1
buffer_load_dwordx4 v[76:79],v1,s[8:11],s59 offen offset:1024 sc1
sk_104:
buffer_load_dwordx2 v[90:91],v18,s[8:11],s68 offen sc1
buffer_load_dwordx4 v[82:85],v1,s[8:11],s68 offen sc1
buffer_load_dwordx4 v[86:89],v1,s[8:11],s68 offen offset:1024 sc1
s_sub_u32 s47,s47,1
s_cbranch_scc1 ABORT
s_waitcnt lgkmcnt(0)
s_branch fa_99
vb_102:
s_sub_u32 s47,s47,1
s_cbranch_scc1 ABORT
buffer_load_dwordx4 v[48:51],v1,s[8:11],s71 offen sc1
s_waitcnt vmcnt(0)
v_bitop3_b32 v17,v48,v50,s57 bitop3:0x7e
v_and_b32 v17,1,v17
v_cmp_ne_u32 vcc,0,v17
s_nop 0
s_cbranch_vccnz vb_102
s_branch vo_103
CH_START:
s_sub_u32 s60,s4,s5
s_cmp_gt_i32 s60,13
s_cselect_b32 s53,1,0
s_cmp_eq_u32 s4,64
s_cselect_b32 s53,1,s53
s_cmp_eq_u32 s53,0
s_cselect_b32 s54,s4,s5
s_addc_u32 s4,s4,0
s_add_u32 s5,s5,s53
s_sub_u32 s60,s4,s5
s_cmp_gt_i32 s60,13
s_cselect_b32 s55,1,0
s_cmp_eq_u32 s4,64
s_cselect_b32 s55,1,s55
s_cmp_eq_u32 s55,0
s_cselect_b32 s56,s4,s5
s_addc_u32 s4,s4,0
s_add_u32 s5,s5,s55
s_mov_b32 s74,81920
s_mul_i32 s73,s52,393216
s_add_u32 s73,s73,s84
s_lshl_b32 s75,s51,6
s_add_u32 s75,s75,s52
s_lshl_b32 s75,s75,9
s_add_u32 s75,s75,131072
fl_105:
buffer_load_dword v12,v9,s[8:11],s75 offen sc1
s_waitcnt vmcnt(0)
v_cmp_eq_u32 vcc,0,v12
s_nop 0
s_cbranch_vccz ok_106
s_sleep 1
s_sub_u32 s47,s47,1
s_cbranch_scc1 ABORT
s_branch fl_105
ok_106:
s_add_u32 m0,s74,0
s_add_u32 s67,s73,0
buffer_load_dwordx4 v1,s[8:11],s67 offen sc1 lds
buffer_load_dwordx4 v1,s[8:11],s67 offen offset:1024 sc1 lds
buffer_load_dwordx4 v1,s[8:11],s67 offen offset:2048 sc1 lds
buffer_load_dwordx4 v1,s[8:11],s67 offen offset:3072 sc1 lds
s_add_u32 m0,s74,4096
s_add_u32 s67,s73,4096
buffer_load_dwordx4 v1,s[8:11],s67 offen sc1 lds
buffer_load_dwordx4 v1,s[8:11],s67 offen offset:1024 sc1 lds
buffer_load_dwordx4 v1,s[8:11],s67 offen offset:2048 sc1 lds
buffer_load_dwordx4 v1,s[8:11],s67 offen offset:3072 sc1 lds
s_add_u32 m0,s74,8192
s_add_u32 s67,s73,8192
buffer_load_dwordx4 v1,s[8:11],s67 offen sc1 lds
buffer_load_dwordx4 v1,s[8:11],s67 offen offset:1024 sc1 lds
buffer_load_dwordx4 v1,s[8:11],s67 offen offset:2048 sc1 lds
buffer_load_dwordx4 v1,s[8:11],s67 offen offset:3072 sc1 lds
s_add_u32 m0,s74,12288
s_add_u32 s67,s73,25165824
buffer_load_dwordx4 v1,s[8:11],s67 offen sc1 lds
buffer_load_dwordx4 v1,s[8:11],s67 offen offset:1024 sc1 lds
buffer_load_dwordx4 v1,s[8:11],s67 offen offset:2048 sc1 lds
buffer_load_dwordx4 v1,s[8:11],s67 offen offset:3072 sc1 lds
s_add_u32 m0,s74,16384
s_add_u32 s67,s73,25169920
buffer_load_dwordx4 v1,s[8:11],s67 offen sc1 lds
buffer_load_dwordx4 v1,s[8:11],s67 offen offset:1024 sc1 lds
buffer_load_dwordx4 v1,s[8:11],s67 offen offset:2048 sc1 lds
buffer_load_dwordx4 v1,s[8:11],s67 offen offset:3072 sc1 lds
s_add_u32 m0,s74,20480
s_add_u32 s67,s73,25174016
buffer_load_dwordx4 v1,s[8:11],s67 offen sc1 lds
buffer_load_dwordx4 v1,s[8:11],s67 offen offset:1024 sc1 lds
buffer_load_dwordx4 v1,s[8:11],s67 offen offset:2048 sc1 lds
buffer_load_dwordx4 v1,s[8:11],s67 offen offset:3072 sc1 lds
s_mov_b32 s74,106496
s_mul_i32 s73,s54,393216
s_add_u32 s73,s73,s84
s_lshl_b32 s75,s53,6
s_add_u32 s75,s75,s54
s_lshl_b32 s75,s75,9
s_add_u32 s75,s75,131072
s_lshl_b32 s76,s55,6
s_add_u32 s76,s76,s56
s_lshl_b32 s76,s76,9
s_add_u32 s76,s76,131072
s_mov_b32 s77,1
v_min_u32 v8,2,v0
v_lshlrev_b32 v8,2,v8
v_add_u32 v8,147456,v8
v_mov_b32 v58,147468
s_mov_b32 s80,0
v_mov_b32 v24,0
v_mov_b32 v25,0
v_mov_b32 v26,0
v_mov_b32 v27,0
v_mov_b32 v28,0
v_mov_b32 v29,0
v_mov_b32 v30,0
v_mov_b32 v31,0
v_mov_b32 v32,0
v_mov_b32 v33,0
v_mov_b32 v34,0
v_mov_b32 v35,0
v_mov_b32 v36,0
v_mov_b32 v37,0
v_mov_b32 v38,0
v_mov_b32 v39,0
v_mov_b32 v40,0
v_mov_b32 v41,0
v_mov_b32 v42,0
v_mov_b32 v43,0
v_mov_b32 v44,0
v_mov_b32 v45,0
v_mov_b32 v46,0
v_mov_b32 v47,0
s_nop 1
CH_LOOP:
v_mov_b32 v14,s50
s_nop 1
db_110:
buffer_load_dword v12,v11,s[8:11],s69 offen sc1
s_waitcnt vmcnt(0)
v_cmp_gt_u32 vcc,s58,v12
s_cbranch_vccz dbok_111
s_sub_u32 s47,s47,1
s_cbranch_scc1 ABORT
s_branch db_110
dbok_111:
ds_write_b32 v58,v14
buffer_load_dwordx2 v[68:69],v18,s[8:11],s59 offen sc1
buffer_load_dwordx4 v[60:63],v1,s[8:11],s59 offen sc1
buffer_load_dwordx4 v[64:67],v1,s[8:11],s59 offen offset:1024 sc1
s_barrier
s_waitcnt vmcnt(2)
s_sleep 3
fj_109f:
buffer_load_dwordx2 v[78:79],v18,s[8:11],s68 offen sc1
buffer_load_dwordx4 v[70:73],v1,s[8:11],s68 offen sc1
buffer_load_dwordx4 v[74:77],v1,s[8:11],s68 offen offset:1024 sc1
s_mov_b64 vcc,s[90:91]
ds_read_b64_tr_b16 v[100:101],v7 offset:0
ds_read_b64_tr_b16 v[102:103],v7 offset:512
ds_read_b64_tr_b16 v[48:49],v7 offset:1024
ds_read_b64_tr_b16 v[50:51],v7 offset:1536
ds_read_b64_tr_b16 v[104:105],v7 offset:2048
ds_read_b64_tr_b16 v[106:107],v7 offset:2560
ds_read_b64_tr_b16 v[52:53],v7 offset:3072
ds_read_b64_tr_b16 v[54:55],v7 offset:3584
ds_read_b64_tr_b16 v[108:109],v7 offset:4096
ds_read_b64_tr_b16 v[110:111],v7 offset:4608
ds_read_b64_tr_b16 v[12:13],v7 offset:5120
ds_read_b64_tr_b16 v[14:15],v7 offset:5632
s_waitcnt lgkmcnt(8)
v_cndmask_b32_dpp v100,v48,v100,vcc quad_perm:[0,1,0,1] row_mask:0xf bank_mask:0xf
v_cndmask_b32_dpp v101,v49,v101,vcc quad_perm:[0,1,0,1] row_mask:0xf bank_mask:0xf
v_cndmask_b32_dpp v102,v50,v102,vcc quad_perm:[0,1,0,1] row_mask:0xf bank_mask:0xf
v_cndmask_b32_dpp v103,v51,v103,vcc quad_perm:[0,1,0,1] row_mask:0xf bank_mask:0xf
s_waitcnt lgkmcnt(4)
v_cndmask_b32_dpp v104,v52,v104,vcc quad_perm:[0,1,0,1] row_mask:0xf bank_mask:0xf
v_cndmask_b32_dpp v105,v53,v105,vcc quad_perm:[0,1,0,1] row_mask:0xf bank_mask:0xf
v_cndmask_b32_dpp v106,v54,v106,vcc quad_perm:[0,1,0,1] row_mask:0xf bank_mask:0xf
v_cndmask_b32_dpp v107,v55,v107,vcc quad_perm:[0,1,0,1] row_mask:0xf bank_mask:0xf
s_waitcnt lgkmcnt(0)
v_cndmask_b32_dpp v108,v12,v108,vcc quad_perm:[0,1,0,1] row_mask:0xf bank_mask:0xf
v_cndmask_b32_dpp v109,v13,v109,vcc quad_perm:[0,1,0,1] row_mask:0xf bank_mask:0xf
v_cndmask_b32_dpp v110,v14,v110,vcc quad_perm:[0,1,0,1] row_mask:0xf bank_mask:0xf
v_cndmask_b32_dpp v111,v15,v111,vcc quad_perm:[0,1,0,1] row_mask:0xf bank_mask:0xf
fj_109:
fa_107:
s_waitcnt vmcnt(5)
v_lshlrev_b32 v96,16,v68
v_and_b32 v97,0xffff0000,v68
v_lshlrev_b32 v98,16,v69
v_and_b32 v99,0xffff0000,v69
s_waitcnt vmcnt(4)
v_lshlrev_b32 v80,16,v60
v_and_b32 v81,0xffff0000,v60
v_lshlrev_b32 v82,16,v61
v_and_b32 v83,0xffff0000,v61
v_lshlrev_b32 v84,16,v62
v_and_b32 v85,0xffff0000,v62
v_lshlrev_b32 v86,16,v63
v_and_b32 v87,0xffff0000,v63
s_waitcnt vmcnt(3)
v_lshlrev_b32 v88,16,v64
v_and_b32 v89,0xffff0000,v64
v_lshlrev_b32 v90,16,v65
v_and_b32 v91,0xffff0000,v65
v_lshlrev_b32 v92,16,v66
v_and_b32 v93,0xffff0000,v66
v_lshlrev_b32 v94,16,v67
v_and_b32 v95,0xffff0000,v67
s_waitcnt vmcnt(2)
v_dot2c_f32_bf16 v96,s37,v78
v_dot2c_f32_bf16 v97,s81,v78
v_dot2c_f32_bf16 v98,s37,v79
v_dot2c_f32_bf16 v99,s81,v79
v_bitop3_b32 v16,v68,v78,s57 bitop3:0x7e
v_cvt_pk_bf16_f32 v56,v96,v97
s_nop 0
v_cvt_pk_bf16_f32 v57,v98,v99
ds_write_b64 v23,v[56:57]
s_waitcnt vmcnt(1)
v_dot2c_f32_bf16 v80,s37,v70
v_dot2c_f32_bf16 v81,s81,v70
v_dot2c_f32_bf16 v82,s37,v71
v_dot2c_f32_bf16 v83,s81,v71
v_dot2c_f32_bf16 v84,s37,v72
v_dot2c_f32_bf16 v85,s81,v72
v_dot2c_f32_bf16 v86,s37,v73
v_dot2c_f32_bf16 v87,s81,v73
v_bitop3_b32 v17,v60,v70,s57 bitop3:0x7e
v_or_b32 v16,v16,v17
v_cvt_pk_bf16_f32 v48,v80,v81
v_cvt_pk_bf16_f32 v49,v82,v83
v_cvt_pk_bf16_f32 v50,v84,v85
v_cvt_pk_bf16_f32 v51,v86,v87
ds_write_b128 v22,v[48:51] offset:0
s_waitcnt vmcnt(0)
v_dot2c_f32_bf16 v88,s37,v74
v_dot2c_f32_bf16 v89,s81,v74
v_dot2c_f32_bf16 v90,s37,v75
v_dot2c_f32_bf16 v91,s81,v75
v_dot2c_f32_bf16 v92,s37,v76
v_dot2c_f32_bf16 v93,s81,v76
v_dot2c_f32_bf16 v94,s37,v77
v_dot2c_f32_bf16 v95,s81,v77
v_bitop3_b32 v17,v64,v74,s57 bitop3:0x7e
v_bitop3_b32 v16,v16,v17,1 bitop3:0xa8
v_cmp_ne_u32 vcc,0,v16
v_cvt_pk_bf16_f32 v52,v88,v89
v_cvt_pk_bf16_f32 v53,v90,v91
v_cvt_pk_bf16_f32 v54,v92,v93
v_cvt_pk_bf16_f32 v55,v94,v95
ds_write_b128 v22,v[52:55] offset:1024
s_cbranch_vccnz fr_108
fj_109g:
v_smfmac_f32_16x16x64_bf16 v[24:27],v[48:51],a[0:7],v2
ds_read_b128 v[72:75],v21 offset:0
s_and_b32 s60,s54,1
v_smfmac_f32_16x16x64_bf16 v[28:31],v[48:51],a[8:15],v2
ds_read_b128 v[76:79],v21 offset:1024
s_lshl2_add_u32 s60,s53,s60
v_smfmac_f32_16x16x64_bf16 v[32:35],v[48:51],a[16:23],v2
ds_read_b128 v[80:83],v21 offset:2048
s_lshl_b32 s68,s60,16
v_smfmac_f32_16x16x64_bf16 v[36:39],v[48:51],a[24:31],v2
ds_read_b128 v[84:87],v21 offset:3072
s_add_u32 s68,s68,s83
s_waitcnt lgkmcnt(4)
s_barrier
v_smfmac_f32_16x16x64_bf16 v[40:43],v[48:51],a[32:39],v2
ds_read_b128 v[60:63],v3 offset:0
s_mul_i32 s59,s60,20480
v_smfmac_f32_16x16x64_bf16 v[24:27],v[52:55],a[40:47],v2
ds_read_b128 v[64:67],v3 offset:1024
s_add_u32 s59,s59,s6
v_smfmac_f32_16x16x64_bf16 v[28:31],v[52:55],a[48:55],v2
ds_read_b128 v[68:71],v4 offset:0
s_lshl_b32 s69,s53,9
v_smfmac_f32_16x16x64_bf16 v[32:35],v[52:55],a[56:63],v2
s_add_u32 m0,s74,12288
s_add_u32 s67,s73,25165824
s_add_u32 s69,s69,s7
v_smfmac_f32_16x16x64_bf16 v[36:39],v[52:55],a[64:71],v2
buffer_load_dwordx4 v1,s[8:11],s67 offen sc1 lds
s_bfe_u32 s31,s54,65537
v_smfmac_f32_16x16x64_bf16 v[40:43],v[52:55],a[72:79],v2
buffer_load_dwordx4 v1,s[8:11],s67 offen offset:1024 sc1 lds
s_waitcnt lgkmcnt(5)
v_smfmac_f32_16x16x64_bf16 v[44:47],v[48:51],v[72:79],v2
ds_read_b128 v[72:75],v21 offset:4096
s_waitcnt lgkmcnt(4)
v_smfmac_f32_16x16x64_bf16 v[44:47],v[52:55],v[80:87],v2
ds_read_b128 v[76:79],v21 offset:5120
s_waitcnt lgkmcnt(4)
v_smfmac_f32_16x16x64_bf16 v[24:27],v[60:63],a[80:87],v2
ds_read_b128 v[80:83],v21 offset:6144
s_add_u32 s32,s54,1
v_smfmac_f32_16x16x64_bf16 v[28:31],v[60:63],a[88:95],v2
ds_read_b128 v[84:87],v21 offset:7168
v_smfmac_f32_16x16x64_bf16 v[32:35],v[60:63],a[96:103],v2
buffer_load_dwordx4 v1,s[8:11],s67 offen offset:2048 sc1 lds
v_smfmac_f32_16x16x64_bf16 v[36:39],v[60:63],a[104:111],v2
buffer_load_dwordx4 v1,s[8:11],s67 offen offset:3072 sc1 lds
v_smfmac_f32_16x16x64_bf16 v[40:43],v[60:63],a[112:119],v2
s_add_u32 m0,s74,16384
s_add_u32 s67,s73,25169920
s_waitcnt lgkmcnt(2)
v_smfmac_f32_16x16x64_bf16 v[44:47],v[60:63],v[72:79],v2
ds_read_b128 v[60:63],v4 offset:1024
v_smfmac_f32_16x16x64_bf16 v[24:27],v[64:67],a[120:127],v2
ds_read_b128 v[72:75],v21 offset:8192
v_smfmac_f32_16x16x64_bf16 v[28:31],v[64:67],a[128:135],v2
ds_read_b128 v[76:79],v21 offset:9216
v_smfmac_f32_16x16x64_bf16 v[32:35],v[64:67],a[136:143],v2
v_mov_b32 v17,1
buffer_load_dwordx4 v1,s[8:11],s67 offen sc1 lds
v_smfmac_f32_16x16x64_bf16 v[36:39],v[64:67],a[144:151],v2
s_mov_b64 exec,1
buffer_store_dword v17,v1,s[8:11],s79 offen sc1
s_mov_b64 exec,-1
v_smfmac_f32_16x16x64_bf16 v[40:43],v[64:67],a[152:159],v2
buffer_store_dwordx4 v[100:103],v1,s[8:11],s78 offen sc1
s_waitcnt lgkmcnt(3)
v_smfmac_f32_16x16x64_bf16 v[44:47],v[64:67],v[80:87],v2
ds_read_b128 v[64:67],v5 offset:0
v_smfmac_f32_16x16x64_bf16 v[24:27],v[68:71],a[160:167],v2
ds_read_b128 v[80:83],v21 offset:10240
v_smfmac_f32_16x16x64_bf16 v[28:31],v[68:71],a[168:175],v2
ds_read_b128 v[84:87],v21 offset:11264
v_smfmac_f32_16x16x64_bf16 v[32:35],v[68:71],a[176:183],v2
buffer_store_dwordx4 v[104:107],v1,s[8:11],s78 offen offset:1024 sc1
v_smfmac_f32_16x16x64_bf16 v[36:39],v[68:71],a[184:191],v2
buffer_store_dwordx4 v[108:111],v1,s[8:11],s78 offen offset:2048 sc1
s_and_b32 s79,s78,2147483648
v_smfmac_f32_16x16x64_bf16 v[40:43],v[68:71],a[192:199],v2
s_or_b32 s79,s79,s30
s_mov_b32 s78,2147483648
s_waitcnt lgkmcnt(3)
v_smfmac_f32_16x16x64_bf16 v[44:47],v[68:71],v[72:79],v2
ds_read_b128 v[68:71],v5 offset:1024
v_smfmac_f32_16x16x64_bf16 v[24:27],v[60:63],a[200:207],v2
ds_read_b128 v[72:75],v21 offset:12288
v_smfmac_f32_16x16x64_bf16 v[28:31],v[60:63],a[208:215],v2
ds_read_b128 v[76:79],v21 offset:13312
v_smfmac_f32_16x16x64_bf16 v[32:35],v[60:63],a[216:223],v2
buffer_load_dword v10,v9,s[8:11],s76 offen sc1
v_smfmac_f32_16x16x64_bf16 v[36:39],v[60:63],a[224:231],v2
buffer_load_dwordx4 v1,s[8:11],s67 offen offset:1024 sc1 lds
v_smfmac_f32_16x16x64_bf16 v[40:43],v[60:63],a[232:239],v2
buffer_load_dwordx4 v1,s[8:11],s67 offen offset:2048 sc1 lds
s_waitcnt lgkmcnt(3)
v_smfmac_f32_16x16x64_bf16 v[44:47],v[60:63],v[80:87],v2
ds_read_b128 v[60:63],v59 offset:0
v_smfmac_f32_16x16x64_bf16 v[24:27],v[64:67],a[240:247],v2
ds_read_b128 v[80:83],v21 offset:14336
v_smfmac_f32_16x16x64_bf16 v[28:31],v[64:67],a[248:255],v2
ds_read_b128 v[84:87],v21 offset:15360
v_smfmac_f32_16x16x64_bf16 v[32:35],v[64:67],v[112:119],v2
buffer_load_dwordx4 v1,s[8:11],s67 offen offset:3072 sc1 lds
v_smfmac_f32_16x16x64_bf16 v[36:39],v[64:67],v[120:127],v2
s_add_u32 m0,s74,20480
s_add_u32 s67,s73,25174016
v_smfmac_f32_16x16x64_bf16 v[40:43],v[64:67],v[128:135],v2
buffer_load_dwordx4 v1,s[8:11],s67 offen sc1 lds
s_waitcnt lgkmcnt(3)
v_smfmac_f32_16x16x64_bf16 v[44:47],v[64:67],v[72:79],v2
ds_read_b128 v[64:67],v59 offset:1024
v_smfmac_f32_16x16x64_bf16 v[24:27],v[68:71],v[136:143],v2
ds_read_b128 v[72:75],v21 offset:16384
v_smfmac_f32_16x16x64_bf16 v[28:31],v[68:71],v[144:151],v2
ds_read_b128 v[76:79],v21 offset:17408
v_smfmac_f32_16x16x64_bf16 v[32:35],v[68:71],v[152:159],v2
buffer_load_dwordx4 v1,s[8:11],s67 offen offset:1024 sc1 lds
v_smfmac_f32_16x16x64_bf16 v[36:39],v[68:71],v[160:167],v2
buffer_load_dwordx4 v1,s[8:11],s67 offen offset:2048 sc1 lds
v_smfmac_f32_16x16x64_bf16 v[40:43],v[68:71],v[168:175],v2
buffer_load_dwordx4 v1,s[8:11],s67 offen offset:3072 sc1 lds
s_waitcnt lgkmcnt(3)
v_smfmac_f32_16x16x64_bf16 v[44:47],v[68:71],v[80:87],v2
ds_read_b128 v[80:83],v21 offset:18432
v_smfmac_f32_16x16x64_bf16 v[24:27],v[60:63],v[176:183],v2
ds_read_b128 v[84:87],v21 offset:19456
v_smfmac_f32_16x16x64_bf16 v[36:39],v[60:63],v[200:207],v2
s_waitcnt lgkmcnt(4)
v_smfmac_f32_16x16x64_bf16 v[24:27],v[64:67],v[216:223],v2
v_smfmac_f32_16x16x64_bf16 v[36:39],v[64:67],v[240:247],v2
v_smfmac_f32_16x16x64_bf16 v[28:31],v[60:63],v[184:191],v2
v_smfmac_f32_16x16x64_bf16 v[40:43],v[60:63],v[208:215],v2
v_add_f32 v24,v24,v25
v_smfmac_f32_16x16x64_bf16 v[28:31],v[64:67],v[224:231],v2
v_add_f32 v26,v26,v27
v_smfmac_f32_16x16x64_bf16 v[40:43],v[64:67],v[248:255],v2
v_add_f32 v36,v36,v37
v_smfmac_f32_16x16x64_bf16 v[32:35],v[60:63],v[192:199],v2
v_add_f32 v38,v38,v39
s_waitcnt lgkmcnt(2)
v_smfmac_f32_16x16x64_bf16 v[44:47],v[60:63],v[72:79],v2
v_cvt_pk_bf16_f32 v37,v24,v26
v_smfmac_f32_16x16x64_bf16 v[32:35],v[64:67],v[232:239],v2
v_cvt_pk_bf16_f32 v36,v36,v38
s_waitcnt lgkmcnt(0)
v_smfmac_f32_16x16x64_bf16 v[44:47],v[64:67],v[80:87],v2
ds_write_b64 v6,v[36:37] offset:0
v_add_f32 v28,v28,v29
v_add_f32 v30,v30,v31
v_add_f32 v40,v40,v41
v_add_f32 v42,v42,v43
v_cvt_pk_bf16_f32 v41,v28,v30
v_cvt_pk_bf16_f32 v40,v40,v42
ds_write_b64 v6,v[40:41] offset:512
v_add_f32 v32,v32,v33
v_add_f32 v34,v34,v35
v_add_f32 v44,v44,v45
v_add_f32 v46,v46,v47
v_cvt_pk_bf16_f32 v45,v32,v34
v_cvt_pk_bf16_f32 v44,v44,v46
ds_write_b64 v6,v[44:45] offset:1024
s_waitcnt lgkmcnt(0)
s_barrier
buffer_load_dword v16,v11,s[8:11],s69 offen sc1
s_lshl_b32 s60,s51,6
s_add_u32 s60,s60,s52
s_mul_i32 s78,s60,196608
s_add_u32 s78,s78,s85
s_lshl_b32 s60,s60,10
s_add_u32 s30,s60,s86
s_cmp_ge_u32 s54,63
s_cselect_b32 s77,0,s77
s_cmp_eq_u32 s53,s51
s_cselect_b32 s60,1,s77
s_cmp_eq_u32 s60,0
s_cbranch_scc0 h1_112
h2_113:
s_add_u32 s50,s50,1
s_mov_b32 s51,s53
s_mov_b32 s52,s54
s_mov_b32 s57,s31
s_mov_b32 s58,s32
s_mov_b32 s53,s55
s_mov_b32 s54,s56
s_mov_b32 s75,s76
s_sub_u32 s60,s4,s5
s_cmp_gt_i32 s60,13
s_cselect_b32 s55,1,0
s_cmp_eq_u32 s4,64
s_cselect_b32 s55,1,s55
s_cmp_eq_u32 s55,0
s_cselect_b32 s56,s4,s5
s_addc_u32 s4,s4,0
s_add_u32 s5,s5,s55
s_lshl_b32 s76,s55,6
s_add_u32 s76,s76,s56
s_lshl_b32 s76,s76,9
s_add_u32 s76,s76,131072
s_mul_i32 s73,s54,393216
s_add_u32 s73,s73,s84
s_xor_b32 s74,s74,57344
v_mov_b32 v24,0
v_mov_b32 v25,0
v_mov_b32 v26,0
v_mov_b32 v27,0
v_mov_b32 v28,0
v_mov_b32 v29,0
v_mov_b32 v30,0
v_mov_b32 v31,0
v_mov_b32 v32,0
v_mov_b32 v33,0
v_mov_b32 v34,0
v_mov_b32 v35,0
v_mov_b32 v36,0
v_mov_b32 v37,0
v_mov_b32 v38,0
v_mov_b32 v39,0
v_mov_b32 v40,0
v_mov_b32 v41,0
v_mov_b32 v42,0
v_mov_b32 v43,0
v_mov_b32 v44,0
v_mov_b32 v45,0
v_mov_b32 v46,0
v_mov_b32 v47,0
s_waitcnt vmcnt(0)
v_cmp_eq_u32 vcc,0,v10
s_cmp_lg_u64 vcc,0
s_cselect_b32 s77,1,0
v_cmp_gt_u32 vcc,s58,v16
s_nop 0
s_cbranch_vccz CH_RUNG
s_cmp_lt_u32 s50,128
s_cbranch_scc1 CH_LOOP
s_branch CS_DONE
h1_112:
s_mov_b64 vcc,s[90:91]
ds_read_b64_tr_b16 v[100:101],v7 offset:0
ds_read_b64_tr_b16 v[102:103],v7 offset:512
ds_read_b64_tr_b16 v[48:49],v7 offset:1024
ds_read_b64_tr_b16 v[50:51],v7 offset:1536
ds_read_b64_tr_b16 v[104:105],v7 offset:2048
ds_read_b64_tr_b16 v[106:107],v7 offset:2560
ds_read_b64_tr_b16 v[52:53],v7 offset:3072
ds_read_b64_tr_b16 v[54:55],v7 offset:3584
ds_read_b64_tr_b16 v[108:109],v7 offset:4096
ds_read_b64_tr_b16 v[110:111],v7 offset:4608
ds_read_b64_tr_b16 v[12:13],v7 offset:5120
ds_read_b64_tr_b16 v[14:15],v7 offset:5632
s_waitcnt lgkmcnt(8)
v_cndmask_b32_dpp v100,v48,v100,vcc quad_perm:[0,1,0,1] row_mask:0xf bank_mask:0xf
v_cndmask_b32_dpp v101,v49,v101,vcc quad_perm:[0,1,0,1] row_mask:0xf bank_mask:0xf
v_cndmask_b32_dpp v102,v50,v102,vcc quad_perm:[0,1,0,1] row_mask:0xf bank_mask:0xf
v_cndmask_b32_dpp v103,v51,v103,vcc quad_perm:[0,1,0,1] row_mask:0xf bank_mask:0xf
s_waitcnt lgkmcnt(4)
v_cndmask_b32_dpp v104,v52,v104,vcc quad_perm:[0,1,0,1] row_mask:0xf bank_mask:0xf
v_cndmask_b32_dpp v105,v53,v105,vcc quad_perm:[0,1,0,1] row_mask:0xf bank_mask:0xf
v_cndmask_b32_dpp v106,v54,v106,vcc quad_perm:[0,1,0,1] row_mask:0xf bank_mask:0xf
v_cndmask_b32_dpp v107,v55,v107,vcc quad_perm:[0,1,0,1] row_mask:0xf bank_mask:0xf
s_waitcnt lgkmcnt(0)
v_cndmask_b32_dpp v108,v12,v108,vcc quad_perm:[0,1,0,1] row_mask:0xf bank_mask:0xf
v_cndmask_b32_dpp v109,v13,v109,vcc quad_perm:[0,1,0,1] row_mask:0xf bank_mask:0xf
v_cndmask_b32_dpp v110,v14,v110,vcc quad_perm:[0,1,0,1] row_mask:0xf bank_mask:0xf
v_cndmask_b32_dpp v111,v15,v111,vcc quad_perm:[0,1,0,1] row_mask:0xf bank_mask:0xf
s_cmp_eq_u32 s50,127
s_cbranch_scc1 sp_114x
sp_114:
ds_read_b32 v12,v8
s_waitcnt lgkmcnt(0)
v_cmp_ge_u32 vcc,s50,v12
s_nop 0
s_cbranch_vccz ok_115
s_sleep 1
s_sub_u32 s47,s47,1
s_cbranch_scc1 ABORT
s_branch sp_114
ok_115:
sp_114x:
s_waitcnt vmcnt(0)
s_cmp_ge_u32 s79,2147483648
s_cbranch_scc1 pf_116
v_mov_b32 v17,1
s_mov_b64 exec,1
buffer_store_dword v17,v1,s[8:11],s79 offen sc1
s_mov_b64 exec,-1
s_mov_b32 s79,2147483648
pf_116:
s_cmp_eq_u32 s78,2147483648
s_cbranch_scc1 pk_117
buffer_store_dwordx4 v[100:103],v1,s[8:11],s78 offen sc1
buffer_store_dwordx4 v[104:107],v1,s[8:11],s78 offen offset:1024 sc1
buffer_store_dwordx4 v[108:111],v1,s[8:11],s78 offen offset:2048 sc1
s_mov_b32 s79,s30
s_mov_b32 s78,2147483648
pk_117:
s_waitcnt vmcnt(0)
s_cmp_ge_u32 s79,2147483648
s_cbranch_scc1 pf_118
v_mov_b32 v17,1
s_mov_b64 exec,1
buffer_store_dword v17,v1,s[8:11],s79 offen sc1
s_mov_b64 exec,-1
s_mov_b32 s79,2147483648
pf_118:
s_cmp_eq_u32 s77,0
s_cbranch_scc1 h2_113
fl_119:
buffer_load_dword v12,v9,s[8:11],s75 offen sc1
s_waitcnt vmcnt(0)
v_cmp_eq_u32 vcc,0,v12
s_nop 0
s_cbranch_vccz ok_120
s_sleep 1
s_sub_u32 s47,s47,1
s_cbranch_scc1 ABORT
s_branch fl_119
ok_120:
s_add_u32 m0,s74,0
s_add_u32 s67,s73,0
buffer_load_dwordx4 v1,s[8:11],s67 offen sc1 lds
buffer_load_dwordx4 v1,s[8:11],s67 offen offset:1024 sc1 lds
buffer_load_dwordx4 v1,s[8:11],s67 offen offset:2048 sc1 lds
buffer_load_dwordx4 v1,s[8:11],s67 offen offset:3072 sc1 lds
s_add_u32 m0,s74,4096
s_add_u32 s67,s73,4096
buffer_load_dwordx4 v1,s[8:11],s67 offen sc1 lds
buffer_load_dwordx4 v1,s[8:11],s67 offen offset:1024 sc1 lds
buffer_load_dwordx4 v1,s[8:11],s67 offen offset:2048 sc1 lds
buffer_load_dwordx4 v1,s[8:11],s67 offen offset:3072 sc1 lds
s_add_u32 m0,s74,8192
s_add_u32 s67,s73,8192
buffer_load_dwordx4 v1,s[8:11],s67 offen sc1 lds
buffer_load_dwordx4 v1,s[8:11],s67 offen offset:1024 sc1 lds
buffer_load_dwordx4 v1,s[8:11],s67 offen offset:2048 sc1 lds
buffer_load_dwordx4 v1,s[8:11],s67 offen offset:3072 sc1 lds
s_add_u32 m0,s74,12288
s_add_u32 s67,s73,25165824
buffer_load_dwordx4 v1,s[8:11],s67 offen sc1 lds
buffer_load_dwordx4 v1,s[8:11],s67 offen offset:1024 sc1 lds
buffer_load_dwordx4 v1,s[8:11],s67 offen offset:2048 sc1 lds
buffer_load_dwordx4 v1,s[8:11],s67 offen offset:3072 sc1 lds
s_add_u32 m0,s74,16384
s_add_u32 s67,s73,25169920
buffer_load_dwordx4 v1,s[8:11],s67 offen sc1 lds
buffer_load_dwordx4 v1,s[8:11],s67 offen offset:1024 sc1 lds
buffer_load_dwordx4 v1,s[8:11],s67 offen offset:2048 sc1 lds
buffer_load_dwordx4 v1,s[8:11],s67 offen offset:3072 sc1 lds
s_add_u32 m0,s74,20480
s_add_u32 s67,s73,25174016
buffer_load_dwordx4 v1,s[8:11],s67 offen sc1 lds
buffer_load_dwordx4 v1,s[8:11],s67 offen offset:1024 sc1 lds
buffer_load_dwordx4 v1,s[8:11],s67 offen offset:2048 sc1 lds
buffer_load_dwordx4 v1,s[8:11],s67 offen offset:3072 sc1 lds
s_branch h2_113
fr_108:
v_bitop3_b32 v12,v60,v64,s57 bitop3:0x7e
v_bitop3_b32 v13,v68,v68,s57 bitop3:0x7e
v_xor_b32 v14,s57,v68
v_or3_b32 v12,v12,v13,v14
v_and_b32 v12,1,v12
v_cmp_ne_u32 vcc,0,v12
s_cbranch_vccz sk_121
buffer_load_dwordx2 v[68:69],v18,s[8:11],s59 offen sc1
buffer_load_dwordx4 v[60:63],v1,s[8:11],s59 offen sc1
buffer_load_dwordx4 v[64:67],v1,s[8:11],s59 offen offset:1024 sc1
sk_121:
buffer_load_dwordx2 v[78:79],v18,s[8:11],s68 offen sc1
buffer_load_dwordx4 v[70:73],v1,s[8:11],s68 offen sc1
buffer_load_dwordx4 v[74:77],v1,s[8:11],s68 offen offset:1024 sc1
s_sub_u32 s47,s47,1
s_cbranch_scc1 ABORT
s_waitcnt lgkmcnt(0)
s_branch fa_107
CH_RUNG:
v_mov_b32 v14,s50
ds_write_b32 v58,v14
buffer_load_dwordx2 v[68:69],v18,s[8:11],s59 offen sc1
buffer_load_dwordx4 v[60:63],v1,s[8:11],s59 offen sc1
buffer_load_dwordx4 v[64:67],v1,s[8:11],s59 offen offset:1024 sc1
fj_109e:
buffer_load_dwordx2 v[78:79],v18,s[8:11],s68 offen sc1
buffer_load_dwordx4 v[70:73],v1,s[8:11],s68 offen sc1
buffer_load_dwordx4 v[74:77],v1,s[8:11],s68 offen offset:1024 sc1
s_mov_b64 vcc,s[90:91]
ds_read_b64_tr_b16 v[100:101],v7 offset:0
ds_read_b64_tr_b16 v[102:103],v7 offset:512
ds_read_b64_tr_b16 v[48:49],v7 offset:1024
ds_read_b64_tr_b16 v[50:51],v7 offset:1536
ds_read_b64_tr_b16 v[104:105],v7 offset:2048
ds_read_b64_tr_b16 v[106:107],v7 offset:2560
ds_read_b64_tr_b16 v[52:53],v7 offset:3072
ds_read_b64_tr_b16 v[54:55],v7 offset:3584
ds_read_b64_tr_b16 v[108:109],v7 offset:4096
ds_read_b64_tr_b16 v[110:111],v7 offset:4608
ds_read_b64_tr_b16 v[12:13],v7 offset:5120
ds_read_b64_tr_b16 v[14:15],v7 offset:5632
s_waitcnt lgkmcnt(8)
v_cndmask_b32_dpp v100,v48,v100,vcc quad_perm:[0,1,0,1] row_mask:0xf bank_mask:0xf
v_cndmask_b32_dpp v101,v49,v101,vcc quad_perm:[0,1,0,1] row_mask:0xf bank_mask:0xf
v_cndmask_b32_dpp v102,v50,v102,vcc quad_perm:[0,1,0,1] row_mask:0xf bank_mask:0xf
v_cndmask_b32_dpp v103,v51,v103,vcc quad_perm:[0,1,0,1] row_mask:0xf bank_mask:0xf
s_waitcnt lgkmcnt(4)
v_cndmask_b32_dpp v104,v52,v104,vcc quad_perm:[0,1,0,1] row_mask:0xf bank_mask:0xf
v_cndmask_b32_dpp v105,v53,v105,vcc quad_perm:[0,1,0,1] row_mask:0xf bank_mask:0xf
v_cndmask_b32_dpp v106,v54,v106,vcc quad_perm:[0,1,0,1] row_mask:0xf bank_mask:0xf
v_cndmask_b32_dpp v107,v55,v107,vcc quad_perm:[0,1,0,1] row_mask:0xf bank_mask:0xf
s_waitcnt lgkmcnt(0)
v_cndmask_b32_dpp v108,v12,v108,vcc quad_perm:[0,1,0,1] row_mask:0xf bank_mask:0xf
v_cndmask_b32_dpp v109,v13,v109,vcc quad_perm:[0,1,0,1] row_mask:0xf bank_mask:0xf
v_cndmask_b32_dpp v110,v14,v110,vcc quad_perm:[0,1,0,1] row_mask:0xf bank_mask:0xf
v_cndmask_b32_dpp v111,v15,v111,vcc quad_perm:[0,1,0,1] row_mask:0xf bank_mask:0xf
s_barrier
s_branch fj_109
CS_DONE:
v_lshrrev_b32 v0,4,v1
s_add_u32 s61,s48,0
s_endpgm
CV_START:
s_and_b32 s60,s46,1
s_lshl1_add_u32 s60,s49,s60
s_cmp_eq_u32 s60,1
s_cbranch_scc1 CV_LOOP_F1
s_cmp_eq_u32 s60,2
s_cbranch_scc1 CV_LOOP_S0
s_cmp_eq_u32 s60,3
s_cbranch_scc1 CV_LOOP_S1
CV_LOOP_F0:
v_mov_b32 v24,0
v_mov_b32 v25,0
v_mov_b32 v26,0
v_mov_b32 v27,0
v_mov_b32 v28,0
v_mov_b32 v29,0
v_mov_b32 v30,0
v_mov_b32 v31,0
v_mov_b32 v32,0
v_mov_b32 v33,0
v_mov_b32 v34,0
v_mov_b32 v35,0
v_mov_b32 v36,0
v_mov_b32 v37,0
v_mov_b32 v38,0
v_mov_b32 v39,0
v_mov_b32 v40,0
v_mov_b32 v41,0
v_mov_b32 v42,0
v_mov_b32 v43,0
v_mov_b32 v44,0
v_mov_b32 v45,0
v_mov_b32 v46,0
v_mov_b32 v47,0
s_cmp_lg_u32 s46,0
s_cbranch_scc1 np_125
db_126:
buffer_load_dword v12,v11,s[8:11],s69 offen sc1
s_waitcnt vmcnt(0)
v_cmp_gt_u32 vcc,s58,v12
s_cbranch_vccz dbok_127
s_sub_u32 s47,s47,1
s_cbranch_scc1 ABORT
s_branch db_126
dbok_127:
np_125:
s_barrier
buffer_load_dwordx2 v[68:69],v18,s[8:11],s59 offen sc1
buffer_load_dwordx4 v[60:63],v1,s[8:11],s59 offen sc1
buffer_load_dwordx4 v[64:67],v1,s[8:11],s59 offen offset:1024 sc1
s_waitcnt vmcnt(2)
s_sleep 3
fj_124f:
buffer_load_dwordx2 v[78:79],v18,s[8:11],s68 offen sc1
buffer_load_dwordx4 v[70:73],v1,s[8:11],s68 offen sc1
buffer_load_dwordx4 v[74:77],v1,s[8:11],s68 offen offset:1024 sc1
fj_124:
fa_122:
s_waitcnt vmcnt(5)
v_lshlrev_b32 v96,16,v68
v_and_b32 v97,0xffff0000,v68
v_lshlrev_b32 v98,16,v69
v_and_b32 v99,0xffff0000,v69
s_waitcnt vmcnt(4)
v_lshlrev_b32 v80,16,v60
v_and_b32 v81,0xffff0000,v60
v_lshlrev_b32 v82,16,v61
v_and_b32 v83,0xffff0000,v61
v_lshlrev_b32 v84,16,v62
v_and_b32 v85,0xffff0000,v62
v_lshlrev_b32 v86,16,v63
v_and_b32 v87,0xffff0000,v63
s_waitcnt vmcnt(3)
v_lshlrev_b32 v88,16,v64
v_and_b32 v89,0xffff0000,v64
v_lshlrev_b32 v90,16,v65
v_and_b32 v91,0xffff0000,v65
v_lshlrev_b32 v92,16,v66
v_and_b32 v93,0xffff0000,v66
v_lshlrev_b32 v94,16,v67
v_and_b32 v95,0xffff0000,v67
s_waitcnt vmcnt(2)
v_dot2c_f32_bf16 v96,s37,v78
v_dot2c_f32_bf16 v97,s81,v78
v_dot2c_f32_bf16 v98,s37,v79
v_dot2c_f32_bf16 v99,s81,v79
v_bitop3_b32 v16,v68,v78,s57 bitop3:0x7e
v_cvt_pk_bf16_f32 v56,v96,v97
s_nop 0
v_cvt_pk_bf16_f32 v57,v98,v99
ds_write_b64 v23,v[56:57]
s_waitcnt vmcnt(1)
v_dot2c_f32_bf16 v80,s37,v70
v_dot2c_f32_bf16 v81,s81,v70
v_dot2c_f32_bf16 v82,s37,v71
v_dot2c_f32_bf16 v83,s81,v71
v_dot2c_f32_bf16 v84,s37,v72
v_dot2c_f32_bf16 v85,s81,v72
v_dot2c_f32_bf16 v86,s37,v73
v_dot2c_f32_bf16 v87,s81,v73
v_bitop3_b32 v17,v60,v70,s57 bitop3:0x7e
v_or_b32 v16,v16,v17
v_cvt_pk_bf16_f32 v48,v80,v81
v_cvt_pk_bf16_f32 v49,v82,v83
v_cvt_pk_bf16_f32 v50,v84,v85
v_cvt_pk_bf16_f32 v51,v86,v87
ds_write_b128 v22,v[48:51] offset:0
s_waitcnt vmcnt(0)
v_dot2c_f32_bf16 v88,s37,v74
v_dot2c_f32_bf16 v89,s81,v74
v_dot2c_f32_bf16 v90,s37,v75
v_dot2c_f32_bf16 v91,s81,v75
v_dot2c_f32_bf16 v92,s37,v76
v_dot2c_f32_bf16 v93,s81,v76
v_dot2c_f32_bf16 v94,s37,v77
v_dot2c_f32_bf16 v95,s81,v77
v_bitop3_b32 v17,v64,v74,s57 bitop3:0x7e
v_bitop3_b32 v16,v16,v17,1 bitop3:0xa8
v_cmp_ne_u32 vcc,0,v16
v_cvt_pk_bf16_f32 v52,v88,v89
v_cvt_pk_bf16_f32 v53,v90,v91
v_cvt_pk_bf16_f32 v54,v92,v93
v_cvt_pk_bf16_f32 v55,v94,v95
ds_write_b128 v22,v[52:55] offset:1024
s_cbranch_vccnz fr_123
fj_124g:
v_smfmac_f32_16x16x64_bf16 v[24:27],v[48:51],a[0:7],v2
ds_read_b128 v[72:75],v21 offset:0
s_and_b32 s60,s52,1
v_smfmac_f32_16x16x64_bf16 v[28:31],v[48:51],a[8:15],v2
ds_read_b128 v[76:79],v21 offset:1024
s_lshl2_add_u32 s60,s51,s60
v_smfmac_f32_16x16x64_bf16 v[32:35],v[48:51],a[16:23],v2
ds_read_b128 v[80:83],v21 offset:2048
s_mul_i32 s60,s60,49152
v_smfmac_f32_16x16x64_bf16 v[36:39],v[48:51],a[24:31],v2
ds_read_b128 v[84:87],v21 offset:3072
s_add_u32 s71,s60,s34
s_waitcnt lgkmcnt(4)
s_barrier
v_smfmac_f32_16x16x64_bf16 v[40:43],v[48:51],a[32:39],v2
ds_read_b128 v[60:63],v3 offset:0
v_smfmac_f32_16x16x64_bf16 v[24:27],v[52:55],a[40:47],v2
ds_read_b128 v[64:67],v3 offset:1024
v_mov_b32 v17,1
v_smfmac_f32_16x16x64_bf16 v[28:31],v[52:55],a[48:55],v2
ds_read_b128 v[68:71],v4 offset:0
v_smfmac_f32_16x16x64_bf16 v[32:35],v[52:55],a[56:63],v2
s_mov_b64 exec,1
buffer_store_dword v17,v1,s[8:11],s79 offen sc1
s_mov_b64 exec,-1
v_smfmac_f32_16x16x64_bf16 v[36:39],v[52:55],a[64:71],v2
buffer_store_dwordx4 v[100:103],v1,s[8:11],s78 offen sc1
v_smfmac_f32_16x16x64_bf16 v[40:43],v[52:55],a[72:79],v2
buffer_store_dwordx2 v[104:105],v8,s[8:11],s78 offen offset:1024 sc1
s_waitcnt lgkmcnt(5)
v_smfmac_f32_16x16x64_bf16 v[44:47],v[48:51],v[72:79],v2
ds_read_b128 v[72:75],v21 offset:4096
s_waitcnt lgkmcnt(4)
v_smfmac_f32_16x16x64_bf16 v[44:47],v[52:55],v[80:87],v2
ds_read_b128 v[76:79],v21 offset:5120
s_waitcnt lgkmcnt(4)
v_smfmac_f32_16x16x64_bf16 v[24:27],v[60:63],a[80:87],v2
ds_read_b128 v[80:83],v21 offset:6144
s_and_b32 s79,s78,2147483648
v_smfmac_f32_16x16x64_bf16 v[28:31],v[60:63],a[88:95],v2
ds_read_b128 v[84:87],v21 offset:7168
s_or_b32 s79,s79,s30
v_smfmac_f32_16x16x64_bf16 v[32:35],v[60:63],a[96:103],v2
s_mov_b32 s78,2147483648
v_smfmac_f32_16x16x64_bf16 v[36:39],v[60:63],a[104:111],v2
v_smfmac_f32_16x16x64_bf16 v[40:43],v[60:63],a[112:119],v2
s_waitcnt lgkmcnt(2)
v_smfmac_f32_16x16x64_bf16 v[44:47],v[60:63],v[72:79],v2
ds_read_b128 v[60:63],v4 offset:1024
v_smfmac_f32_16x16x64_bf16 v[24:27],v[64:67],a[120:127],v2
ds_read_b128 v[72:75],v21 offset:8192
v_smfmac_f32_16x16x64_bf16 v[28:31],v[64:67],a[128:135],v2
ds_read_b128 v[76:79],v21 offset:9216
v_smfmac_f32_16x16x64_bf16 v[32:35],v[64:67],a[136:143],v2
v_smfmac_f32_16x16x64_bf16 v[36:39],v[64:67],a[144:151],v2
v_smfmac_f32_16x16x64_bf16 v[40:43],v[64:67],a[152:159],v2
s_waitcnt lgkmcnt(3)
v_smfmac_f32_16x16x64_bf16 v[44:47],v[64:67],v[80:87],v2
ds_read_b128 v[64:67],v5 offset:0
v_smfmac_f32_16x16x64_bf16 v[24:27],v[68:71],a[160:167],v2
ds_read_b128 v[80:83],v21 offset:10240
v_smfmac_f32_16x16x64_bf16 v[28:31],v[68:71],a[168:175],v2
ds_read_b128 v[84:87],v21 offset:11264
v_smfmac_f32_16x16x64_bf16 v[32:35],v[68:71],a[176:183],v2
v_smfmac_f32_16x16x64_bf16 v[36:39],v[68:71],a[184:191],v2
v_smfmac_f32_16x16x64_bf16 v[40:43],v[68:71],a[192:199],v2
s_waitcnt lgkmcnt(3)
v_smfmac_f32_16x16x64_bf16 v[44:47],v[68:71],v[72:79],v2
ds_read_b128 v[68:71],v5 offset:1024
v_smfmac_f32_16x16x64_bf16 v[24:27],v[60:63],a[200:207],v2
ds_read_b128 v[72:75],v21 offset:12288
v_smfmac_f32_16x16x64_bf16 v[28:31],v[60:63],a[208:215],v2
ds_read_b128 v[76:79],v21 offset:13312
v_smfmac_f32_16x16x64_bf16 v[32:35],v[60:63],a[216:223],v2
v_smfmac_f32_16x16x64_bf16 v[36:39],v[60:63],a[224:231],v2
v_smfmac_f32_16x16x64_bf16 v[40:43],v[60:63],a[232:239],v2
s_waitcnt lgkmcnt(3)
v_smfmac_f32_16x16x64_bf16 v[44:47],v[60:63],v[80:87],v2
ds_read_b128 v[60:63],v59 offset:0
v_smfmac_f32_16x16x64_bf16 v[24:27],v[64:67],a[240:247],v2
ds_read_b128 v[80:83],v21 offset:14336
v_smfmac_f32_16x16x64_bf16 v[28:31],v[64:67],a[248:255],v2
ds_read_b128 v[84:87],v21 offset:15360
v_smfmac_f32_16x16x64_bf16 v[32:35],v[64:67],v[112:119],v2
v_smfmac_f32_16x16x64_bf16 v[36:39],v[64:67],v[120:127],v2
v_smfmac_f32_16x16x64_bf16 v[40:43],v[64:67],v[128:135],v2
s_waitcnt lgkmcnt(3)
v_smfmac_f32_16x16x64_bf16 v[44:47],v[64:67],v[72:79],v2
ds_read_b128 v[64:67],v59 offset:1024
v_smfmac_f32_16x16x64_bf16 v[24:27],v[68:71],v[136:143],v2
ds_read_b128 v[72:75],v21 offset:16384
v_smfmac_f32_16x16x64_bf16 v[28:31],v[68:71],v[144:151],v2
ds_read_b128 v[76:79],v21 offset:17408
v_smfmac_f32_16x16x64_bf16 v[32:35],v[68:71],v[152:159],v2
v_smfmac_f32_16x16x64_bf16 v[36:39],v[68:71],v[160:167],v2
v_smfmac_f32_16x16x64_bf16 v[40:43],v[68:71],v[168:175],v2
s_waitcnt lgkmcnt(3)
v_smfmac_f32_16x16x64_bf16 v[44:47],v[68:71],v[80:87],v2
ds_read_b128 v[80:83],v21 offset:18432
v_smfmac_f32_16x16x64_bf16 v[24:27],v[60:63],v[176:183],v2
ds_read_b128 v[84:87],v21 offset:19456
v_smfmac_f32_16x16x64_bf16 v[28:31],v[60:63],v[184:191],v2
s_waitcnt lgkmcnt(4)
v_smfmac_f32_16x16x64_bf16 v[24:27],v[64:67],v[216:223],v2
v_smfmac_f32_16x16x64_bf16 v[28:31],v[64:67],v[224:231],v2
v_smfmac_f32_16x16x64_bf16 v[32:35],v[60:63],v[192:199],v2
v_smfmac_f32_16x16x64_bf16 v[36:39],v[60:63],v[200:207],v2
v_add_f32 v24,v24,v25
v_smfmac_f32_16x16x64_bf16 v[32:35],v[64:67],v[232:239],v2
v_add_f32 v26,v26,v27
v_smfmac_f32_16x16x64_bf16 v[36:39],v[64:67],v[240:247],v2
v_add_f32 v28,v28,v29
v_smfmac_f32_16x16x64_bf16 v[40:43],v[60:63],v[208:215],v2
v_add_f32 v30,v30,v31
s_waitcnt lgkmcnt(2)
v_smfmac_f32_16x16x64_bf16 v[44:47],v[60:63],v[72:79],v2
v_cvt_pk_bf16_f32 v100,v24,v26
v_smfmac_f32_16x16x64_bf16 v[40:43],v[64:67],v[248:255],v2
v_cvt_pk_bf16_f32 v101,v28,v30
s_waitcnt lgkmcnt(0)
v_smfmac_f32_16x16x64_bf16 v[44:47],v[64:67],v[80:87],v2
v_and_or_b32 v100,v100,-2,s57
v_add_f32 v32,v32,v33
v_add_f32 v34,v34,v35
v_add_f32 v36,v36,v37
v_add_f32 v38,v38,v39
v_cvt_pk_bf16_f32 v102,v32,v34
v_cvt_pk_bf16_f32 v103,v36,v38
v_and_or_b32 v102,v102,-2,s57
buffer_store_dwordx4 v[100:103],v6,s[8:11],s71 offen
v_add_f32 v40,v40,v41
v_add_f32 v42,v42,v43
v_add_f32 v44,v44,v45
v_add_f32 v46,v46,v47
v_cvt_pk_bf16_f32 v104,v40,v42
v_cvt_pk_bf16_f32 v105,v44,v46
v_and_or_b32 v104,v104,-2,s57
buffer_store_dwordx2 v[104:105],v7,s[8:11],s71 offen
s_lshl_b32 s60,s51,6
s_add_u32 s60,s60,s52
s_mul_i32 s78,s60,196608
s_add_u32 s78,s78,s85
s_lshl_b32 s60,s60,10
s_add_u32 s30,s60,s86
s_sub_u32 s60,s4,s5
s_cmp_gt_i32 s60,13
s_cselect_b32 s53,1,0
s_cmp_eq_u32 s4,64
s_cselect_b32 s53,1,s53
s_cmp_eq_u32 s53,0
s_cselect_b32 s54,s4,s5
s_addc_u32 s4,s4,0
s_add_u32 s5,s5,s53
s_and_b32 s60,s54,1
s_lshl2_add_u32 s60,s53,s60
s_lshl_b32 s68,s60,16
s_add_u32 s68,s68,s83
s_mul_i32 s59,s60,20480
s_add_u32 s59,s59,s6
s_lshl_b32 s69,s53,9
s_add_u32 s69,s69,s7
s_bfe_u32 s31,s54,65537
s_add_u32 s32,s54,1
s_cmp_lg_u32 s53,s51
s_cbranch_scc1 nx_128
s_waitcnt vmcnt(0)
s_cmp_ge_u32 s79,2147483648
s_cbranch_scc1 pf_129
v_mov_b32 v17,1
s_mov_b64 exec,1
buffer_store_dword v17,v1,s[8:11],s79 offen sc1
s_mov_b64 exec,-1
s_mov_b32 s79,2147483648
pf_129:
s_cmp_eq_u32 s78,2147483648
s_cbranch_scc1 pk_130
buffer_store_dwordx4 v[100:103],v1,s[8:11],s78 offen sc1
buffer_store_dwordx2 v[104:105],v8,s[8:11],s78 offen offset:1024 sc1
s_mov_b32 s79,s30
s_mov_b32 s78,2147483648
pk_130:
s_waitcnt vmcnt(0)
s_cmp_ge_u32 s79,2147483648
s_cbranch_scc1 pf_131
v_mov_b32 v17,1
s_mov_b64 exec,1
buffer_store_dword v17,v1,s[8:11],s79 offen sc1
s_mov_b64 exec,-1
s_mov_b32 s79,2147483648
pf_131:
nx_128:
s_add_u32 s50,s50,1
s_mov_b32 s51,s53
s_mov_b32 s52,s54
s_mov_b32 s57,s31
s_mov_b32 s58,s32
s_cmp_lt_u32 s50,128
s_cbranch_scc1 CV_LOOP_F0
s_branch CV_DONE
fr_123:
v_bitop3_b32 v12,v60,v64,s57 bitop3:0x7e
v_bitop3_b32 v13,v68,v68,s57 bitop3:0x7e
v_xor_b32 v14,s57,v68
v_or3_b32 v12,v12,v13,v14
v_and_b32 v12,1,v12
v_cmp_ne_u32 vcc,0,v12
s_cbranch_vccz sk_132
buffer_load_dwordx2 v[68:69],v18,s[8:11],s59 offen sc1
buffer_load_dwordx4 v[60:63],v1,s[8:11],s59 offen sc1
buffer_load_dwordx4 v[64:67],v1,s[8:11],s59 offen offset:1024 sc1
sk_132:
buffer_load_dwordx2 v[78:79],v18,s[8:11],s68 offen sc1
buffer_load_dwordx4 v[70:73],v1,s[8:11],s68 offen sc1
buffer_load_dwordx4 v[74:77],v1,s[8:11],s68 offen offset:1024 sc1
s_sub_u32 s47,s47,1
s_cbranch_scc1 ABORT
s_waitcnt lgkmcnt(0)
s_branch fa_122
CV_LOOP_F1:
v_mov_b32 v24,0
v_mov_b32 v25,0
v_mov_b32 v26,0
v_mov_b32 v27,0
v_mov_b32 v28,0
v_mov_b32 v29,0
v_mov_b32 v30,0
v_mov_b32 v31,0
v_mov_b32 v32,0
v_mov_b32 v33,0
v_mov_b32 v34,0
v_mov_b32 v35,0
v_mov_b32 v36,0
v_mov_b32 v37,0
v_mov_b32 v38,0
v_mov_b32 v39,0
v_mov_b32 v40,0
v_mov_b32 v41,0
v_mov_b32 v42,0
v_mov_b32 v43,0
v_mov_b32 v44,0
v_mov_b32 v45,0
v_mov_b32 v46,0
v_mov_b32 v47,0
s_barrier
buffer_load_dwordx2 v[68:69],v18,s[8:11],s59 offen sc1
buffer_load_dwordx4 v[60:63],v1,s[8:11],s59 offen sc1
buffer_load_dwordx4 v[64:67],v1,s[8:11],s59 offen offset:1024 sc1
s_waitcnt vmcnt(2)
s_sleep 3
fj_135f:
buffer_load_dwordx2 v[78:79],v18,s[8:11],s68 offen sc1
buffer_load_dwordx4 v[70:73],v1,s[8:11],s68 offen sc1
buffer_load_dwordx4 v[74:77],v1,s[8:11],s68 offen offset:1024 sc1
fj_135:
fa_133:
s_waitcnt vmcnt(5)
v_lshlrev_b32 v96,16,v68
v_and_b32 v97,0xffff0000,v68
v_lshlrev_b32 v98,16,v69
v_and_b32 v99,0xffff0000,v69
s_waitcnt vmcnt(4)
v_lshlrev_b32 v80,16,v60
v_and_b32 v81,0xffff0000,v60
v_lshlrev_b32 v82,16,v61
v_and_b32 v83,0xffff0000,v61
v_lshlrev_b32 v84,16,v62
v_and_b32 v85,0xffff0000,v62
v_lshlrev_b32 v86,16,v63
v_and_b32 v87,0xffff0000,v63
s_waitcnt vmcnt(3)
v_lshlrev_b32 v88,16,v64
v_and_b32 v89,0xffff0000,v64
v_lshlrev_b32 v90,16,v65
v_and_b32 v91,0xffff0000,v65
v_lshlrev_b32 v92,16,v66
v_and_b32 v93,0xffff0000,v66
v_lshlrev_b32 v94,16,v67
v_and_b32 v95,0xffff0000,v67
s_waitcnt vmcnt(2)
v_dot2c_f32_bf16 v96,s37,v78
v_dot2c_f32_bf16 v97,s81,v78
v_dot2c_f32_bf16 v98,s37,v79
v_dot2c_f32_bf16 v99,s81,v79
v_bitop3_b32 v16,v68,v78,s57 bitop3:0x7e
v_cvt_pk_bf16_f32 v56,v96,v97
s_nop 0
v_cvt_pk_bf16_f32 v57,v98,v99
ds_write_b64 v23,v[56:57]
s_waitcnt vmcnt(1)
v_dot2c_f32_bf16 v80,s37,v70
v_dot2c_f32_bf16 v81,s81,v70
v_dot2c_f32_bf16 v82,s37,v71
v_dot2c_f32_bf16 v83,s81,v71
v_dot2c_f32_bf16 v84,s37,v72
v_dot2c_f32_bf16 v85,s81,v72
v_dot2c_f32_bf16 v86,s37,v73
v_dot2c_f32_bf16 v87,s81,v73
v_bitop3_b32 v17,v60,v70,s57 bitop3:0x7e
v_or_b32 v16,v16,v17
v_cvt_pk_bf16_f32 v48,v80,v81
v_cvt_pk_bf16_f32 v49,v82,v83
v_cvt_pk_bf16_f32 v50,v84,v85
v_cvt_pk_bf16_f32 v51,v86,v87
ds_write_b128 v22,v[48:51] offset:0
s_waitcnt vmcnt(0)
v_dot2c_f32_bf16 v88,s37,v74
v_dot2c_f32_bf16 v89,s81,v74
v_dot2c_f32_bf16 v90,s37,v75
v_dot2c_f32_bf16 v91,s81,v75
v_dot2c_f32_bf16 v92,s37,v76
v_dot2c_f32_bf16 v93,s81,v76
v_dot2c_f32_bf16 v94,s37,v77
v_dot2c_f32_bf16 v95,s81,v77
v_bitop3_b32 v17,v64,v74,s57 bitop3:0x7e
v_bitop3_b32 v16,v16,v17,1 bitop3:0xa8
v_cmp_ne_u32 vcc,0,v16
v_cvt_pk_bf16_f32 v52,v88,v89
v_cvt_pk_bf16_f32 v53,v90,v91
v_cvt_pk_bf16_f32 v54,v92,v93
v_cvt_pk_bf16_f32 v55,v94,v95
ds_write_b128 v22,v[52:55] offset:1024
s_cbranch_vccnz fr_134
fj_135g:
v_smfmac_f32_16x16x64_bf16 v[24:27],v[48:51],a[0:7],v2
ds_read_b128 v[72:75],v21 offset:0
s_and_b32 s60,s52,1
v_smfmac_f32_16x16x64_bf16 v[28:31],v[48:51],a[8:15],v2
ds_read_b128 v[76:79],v21 offset:1024
s_lshl2_add_u32 s60,s51,s60
v_smfmac_f32_16x16x64_bf16 v[32:35],v[48:51],a[16:23],v2
ds_read_b128 v[80:83],v21 offset:2048
s_mul_i32 s60,s60,49152
v_smfmac_f32_16x16x64_bf16 v[36:39],v[48:51],a[24:31],v2
ds_read_b128 v[84:87],v21 offset:3072
s_add_u32 s71,s60,s34
s_waitcnt lgkmcnt(4)
s_barrier
v_smfmac_f32_16x16x64_bf16 v[40:43],v[48:51],a[32:39],v2
ds_read_b128 v[60:63],v3 offset:0
v_smfmac_f32_16x16x64_bf16 v[24:27],v[52:55],a[40:47],v2
ds_read_b128 v[64:67],v3 offset:1024
v_mov_b32 v17,1
v_smfmac_f32_16x16x64_bf16 v[28:31],v[52:55],a[48:55],v2
ds_read_b128 v[68:71],v4 offset:0
v_smfmac_f32_16x16x64_bf16 v[32:35],v[52:55],a[56:63],v2
s_mov_b64 exec,1
buffer_store_dword v17,v1,s[8:11],s79 offen sc1
s_mov_b64 exec,-1
v_smfmac_f32_16x16x64_bf16 v[36:39],v[52:55],a[64:71],v2
buffer_store_dwordx4 v[100:103],v1,s[8:11],s78 offen offset:1536 sc1
v_smfmac_f32_16x16x64_bf16 v[40:43],v[52:55],a[72:79],v2
buffer_store_dwordx2 v[104:105],v8,s[8:11],s78 offen offset:2560 sc1
s_waitcnt lgkmcnt(5)
v_smfmac_f32_16x16x64_bf16 v[44:47],v[48:51],v[72:79],v2
ds_read_b128 v[72:75],v21 offset:4096
s_waitcnt lgkmcnt(4)
v_smfmac_f32_16x16x64_bf16 v[44:47],v[52:55],v[80:87],v2
ds_read_b128 v[76:79],v21 offset:5120
s_waitcnt lgkmcnt(4)
v_smfmac_f32_16x16x64_bf16 v[24:27],v[60:63],a[80:87],v2
ds_read_b128 v[80:83],v21 offset:6144
s_and_b32 s79,s78,2147483648
v_smfmac_f32_16x16x64_bf16 v[28:31],v[60:63],a[88:95],v2
ds_read_b128 v[84:87],v21 offset:7168
s_or_b32 s79,s79,s30
v_smfmac_f32_16x16x64_bf16 v[32:35],v[60:63],a[96:103],v2
s_mov_b32 s78,2147483648
v_smfmac_f32_16x16x64_bf16 v[36:39],v[60:63],a[104:111],v2
v_smfmac_f32_16x16x64_bf16 v[40:43],v[60:63],a[112:119],v2
s_waitcnt lgkmcnt(2)
v_smfmac_f32_16x16x64_bf16 v[44:47],v[60:63],v[72:79],v2
ds_read_b128 v[60:63],v4 offset:1024
v_smfmac_f32_16x16x64_bf16 v[24:27],v[64:67],a[120:127],v2
ds_read_b128 v[72:75],v21 offset:8192
v_smfmac_f32_16x16x64_bf16 v[28:31],v[64:67],a[128:135],v2
ds_read_b128 v[76:79],v21 offset:9216
v_smfmac_f32_16x16x64_bf16 v[32:35],v[64:67],a[136:143],v2
v_smfmac_f32_16x16x64_bf16 v[36:39],v[64:67],a[144:151],v2
v_smfmac_f32_16x16x64_bf16 v[40:43],v[64:67],a[152:159],v2
s_waitcnt lgkmcnt(3)
v_smfmac_f32_16x16x64_bf16 v[44:47],v[64:67],v[80:87],v2
ds_read_b128 v[64:67],v5 offset:0
v_smfmac_f32_16x16x64_bf16 v[24:27],v[68:71],a[160:167],v2
ds_read_b128 v[80:83],v21 offset:10240
v_smfmac_f32_16x16x64_bf16 v[28:31],v[68:71],a[168:175],v2
ds_read_b128 v[84:87],v21 offset:11264
v_smfmac_f32_16x16x64_bf16 v[32:35],v[68:71],a[176:183],v2
v_smfmac_f32_16x16x64_bf16 v[36:39],v[68:71],a[184:191],v2
v_smfmac_f32_16x16x64_bf16 v[40:43],v[68:71],a[192:199],v2
s_waitcnt lgkmcnt(3)
v_smfmac_f32_16x16x64_bf16 v[44:47],v[68:71],v[72:79],v2
ds_read_b128 v[68:71],v5 offset:1024
v_smfmac_f32_16x16x64_bf16 v[24:27],v[60:63],a[200:207],v2
ds_read_b128 v[72:75],v21 offset:12288
v_smfmac_f32_16x16x64_bf16 v[28:31],v[60:63],a[208:215],v2
ds_read_b128 v[76:79],v21 offset:13312
v_smfmac_f32_16x16x64_bf16 v[32:35],v[60:63],a[216:223],v2
v_smfmac_f32_16x16x64_bf16 v[36:39],v[60:63],a[224:231],v2
v_smfmac_f32_16x16x64_bf16 v[40:43],v[60:63],a[232:239],v2
s_waitcnt lgkmcnt(3)
v_smfmac_f32_16x16x64_bf16 v[44:47],v[60:63],v[80:87],v2
ds_read_b128 v[60:63],v59 offset:0
v_smfmac_f32_16x16x64_bf16 v[24:27],v[64:67],a[240:247],v2
ds_read_b128 v[80:83],v21 offset:14336
v_smfmac_f32_16x16x64_bf16 v[28:31],v[64:67],a[248:255],v2
ds_read_b128 v[84:87],v21 offset:15360
v_smfmac_f32_16x16x64_bf16 v[32:35],v[64:67],v[112:119],v2
v_smfmac_f32_16x16x64_bf16 v[36:39],v[64:67],v[120:127],v2
v_smfmac_f32_16x16x64_bf16 v[40:43],v[64:67],v[128:135],v2
s_waitcnt lgkmcnt(3)
v_smfmac_f32_16x16x64_bf16 v[44:47],v[64:67],v[72:79],v2
ds_read_b128 v[64:67],v59 offset:1024
v_smfmac_f32_16x16x64_bf16 v[24:27],v[68:71],v[136:143],v2
ds_read_b128 v[72:75],v21 offset:16384
v_smfmac_f32_16x16x64_bf16 v[28:31],v[68:71],v[144:151],v2
ds_read_b128 v[76:79],v21 offset:17408
v_smfmac_f32_16x16x64_bf16 v[32:35],v[68:71],v[152:159],v2
v_smfmac_f32_16x16x64_bf16 v[36:39],v[68:71],v[160:167],v2
v_smfmac_f32_16x16x64_bf16 v[40:43],v[68:71],v[168:175],v2
s_waitcnt lgkmcnt(3)
v_smfmac_f32_16x16x64_bf16 v[44:47],v[68:71],v[80:87],v2
ds_read_b128 v[80:83],v21 offset:18432
v_smfmac_f32_16x16x64_bf16 v[24:27],v[60:63],v[176:183],v2
ds_read_b128 v[84:87],v21 offset:19456
v_smfmac_f32_16x16x64_bf16 v[28:31],v[60:63],v[184:191],v2
s_waitcnt lgkmcnt(4)
v_smfmac_f32_16x16x64_bf16 v[24:27],v[64:67],v[216:223],v2
v_smfmac_f32_16x16x64_bf16 v[28:31],v[64:67],v[224:231],v2
v_smfmac_f32_16x16x64_bf16 v[32:35],v[60:63],v[192:199],v2
v_smfmac_f32_16x16x64_bf16 v[36:39],v[60:63],v[200:207],v2
v_add_f32 v24,v24,v25
v_smfmac_f32_16x16x64_bf16 v[32:35],v[64:67],v[232:239],v2
v_add_f32 v26,v26,v27
v_smfmac_f32_16x16x64_bf16 v[36:39],v[64:67],v[240:247],v2
v_add_f32 v28,v28,v29
v_smfmac_f32_16x16x64_bf16 v[40:43],v[60:63],v[208:215],v2
v_add_f32 v30,v30,v31
s_waitcnt lgkmcnt(2)
v_smfmac_f32_16x16x64_bf16 v[44:47],v[60:63],v[72:79],v2
v_cvt_pk_bf16_f32 v100,v24,v26
v_smfmac_f32_16x16x64_bf16 v[40:43],v[64:67],v[248:255],v2
v_cvt_pk_bf16_f32 v101,v28,v30
s_waitcnt lgkmcnt(0)
v_smfmac_f32_16x16x64_bf16 v[44:47],v[64:67],v[80:87],v2
v_and_or_b32 v100,v100,-2,s57
buffer_store_dwordx2 v[100:101],v7,s[8:11],s71 offen
v_add_f32 v32,v32,v33
v_add_f32 v34,v34,v35
v_add_f32 v36,v36,v37
v_add_f32 v38,v38,v39
v_cvt_pk_bf16_f32 v102,v32,v34
v_cvt_pk_bf16_f32 v103,v36,v38
v_and_or_b32 v102,v102,-2,s57
v_add_f32 v40,v40,v41
v_add_f32 v42,v42,v43
v_add_f32 v44,v44,v45
v_add_f32 v46,v46,v47
v_cvt_pk_bf16_f32 v104,v40,v42
v_cvt_pk_bf16_f32 v105,v44,v46
v_and_or_b32 v104,v104,-2,s57
buffer_store_dwordx4 v[102:105],v6,s[8:11],s71 offen
s_lshl_b32 s60,s51,6
s_add_u32 s60,s60,s52
s_mul_i32 s78,s60,196608
s_add_u32 s78,s78,s85
s_lshl_b32 s60,s60,10
s_add_u32 s30,s60,s86
s_sub_u32 s60,s4,s5
s_cmp_gt_i32 s60,13
s_cselect_b32 s53,1,0
s_cmp_eq_u32 s4,64
s_cselect_b32 s53,1,s53
s_cmp_eq_u32 s53,0
s_cselect_b32 s54,s4,s5
s_addc_u32 s4,s4,0
s_add_u32 s5,s5,s53
s_and_b32 s60,s54,1
s_lshl2_add_u32 s60,s53,s60
s_lshl_b32 s68,s60,16
s_add_u32 s68,s68,s83
s_mul_i32 s59,s60,20480
s_add_u32 s59,s59,s6
s_lshl_b32 s69,s53,9
s_add_u32 s69,s69,s7
s_bfe_u32 s31,s54,65537
s_add_u32 s32,s54,1
s_cmp_lg_u32 s53,s51
s_cbranch_scc1 nx_136
s_waitcnt vmcnt(0)
s_cmp_ge_u32 s79,2147483648
s_cbranch_scc1 pf_137
v_mov_b32 v17,1
s_mov_b64 exec,1
buffer_store_dword v17,v1,s[8:11],s79 offen sc1
s_mov_b64 exec,-1
s_mov_b32 s79,2147483648
pf_137:
s_cmp_eq_u32 s78,2147483648
s_cbranch_scc1 pk_138
buffer_store_dwordx4 v[100:103],v1,s[8:11],s78 offen offset:1536 sc1
buffer_store_dwordx2 v[104:105],v8,s[8:11],s78 offen offset:2560 sc1
s_mov_b32 s79,s30
s_mov_b32 s78,2147483648
pk_138:
s_waitcnt vmcnt(0)
s_cmp_ge_u32 s79,2147483648
s_cbranch_scc1 pf_139
v_mov_b32 v17,1
s_mov_b64 exec,1
buffer_store_dword v17,v1,s[8:11],s79 offen sc1
s_mov_b64 exec,-1
s_mov_b32 s79,2147483648
pf_139:
nx_136:
s_add_u32 s50,s50,1
s_mov_b32 s51,s53
s_mov_b32 s52,s54
s_mov_b32 s57,s31
s_mov_b32 s58,s32
s_cmp_lt_u32 s50,128
s_cbranch_scc1 CV_LOOP_F1
s_branch CV_DONE
fr_134:
v_bitop3_b32 v12,v60,v64,s57 bitop3:0x7e
v_bitop3_b32 v13,v68,v68,s57 bitop3:0x7e
v_xor_b32 v14,s57,v68
v_or3_b32 v12,v12,v13,v14
v_and_b32 v12,1,v12
v_cmp_ne_u32 vcc,0,v12
s_cbranch_vccz sk_140
buffer_load_dwordx2 v[68:69],v18,s[8:11],s59 offen sc1
buffer_load_dwordx4 v[60:63],v1,s[8:11],s59 offen sc1
buffer_load_dwordx4 v[64:67],v1,s[8:11],s59 offen offset:1024 sc1
sk_140:
buffer_load_dwordx2 v[78:79],v18,s[8:11],s68 offen sc1
buffer_load_dwordx4 v[70:73],v1,s[8:11],s68 offen sc1
buffer_load_dwordx4 v[74:77],v1,s[8:11],s68 offen offset:1024 sc1
s_sub_u32 s47,s47,1
s_cbranch_scc1 ABORT
s_waitcnt lgkmcnt(0)
s_branch fa_133
CV_LOOP_S0:
v_mov_b32 v24,0
v_mov_b32 v25,0
v_mov_b32 v26,0
v_mov_b32 v27,0
v_mov_b32 v28,0
v_mov_b32 v29,0
v_mov_b32 v30,0
v_mov_b32 v31,0
v_mov_b32 v32,0
v_mov_b32 v33,0
v_mov_b32 v34,0
v_mov_b32 v35,0
v_mov_b32 v36,0
v_mov_b32 v37,0
v_mov_b32 v38,0
v_mov_b32 v39,0
v_mov_b32 v40,0
v_mov_b32 v41,0
v_mov_b32 v42,0
v_mov_b32 v43,0
v_mov_b32 v44,0
v_mov_b32 v45,0
v_mov_b32 v46,0
v_mov_b32 v47,0
s_cmp_lg_u32 s46,0
s_cbranch_scc1 np_144
db_145:
buffer_load_dword v12,v11,s[8:11],s69 offen sc1
s_waitcnt vmcnt(0)
v_cmp_gt_u32 vcc,s58,v12
s_cbranch_vccz dbok_146
s_sub_u32 s47,s47,1
s_cbranch_scc1 ABORT
s_branch db_145
dbok_146:
np_144:
s_barrier
buffer_load_dwordx2 v[68:69],v18,s[8:11],s59 offen sc1
buffer_load_dwordx4 v[60:63],v1,s[8:11],s59 offen sc1
buffer_load_dwordx4 v[64:67],v1,s[8:11],s59 offen offset:1024 sc1
s_waitcnt vmcnt(2)
s_sleep 3
fj_143f:
buffer_load_dwordx2 v[78:79],v18,s[8:11],s68 offen sc1
buffer_load_dwordx4 v[70:73],v1,s[8:11],s68 offen sc1
buffer_load_dwordx4 v[74:77],v1,s[8:11],s68 offen offset:1024 sc1
fj_143:
fa_141:
s_waitcnt vmcnt(5)
v_lshlrev_b32 v96,16,v68
v_and_b32 v97,0xffff0000,v68
v_lshlrev_b32 v98,16,v69
v_and_b32 v99,0xffff0000,v69
s_waitcnt vmcnt(4)
v_lshlrev_b32 v80,16,v60
v_and_b32 v81,0xffff0000,v60
v_lshlrev_b32 v82,16,v61
v_and_b32 v83,0xffff0000,v61
v_lshlrev_b32 v84,16,v62
v_and_b32 v85,0xffff0000,v62
v_lshlrev_b32 v86,16,v63
v_and_b32 v87,0xffff0000,v63
s_waitcnt vmcnt(3)
v_lshlrev_b32 v88,16,v64
v_and_b32 v89,0xffff0000,v64
v_lshlrev_b32 v90,16,v65
v_and_b32 v91,0xffff0000,v65
v_lshlrev_b32 v92,16,v66
v_and_b32 v93,0xffff0000,v66
v_lshlrev_b32 v94,16,v67
v_and_b32 v95,0xffff0000,v67
s_waitcnt vmcnt(2)
v_dot2c_f32_bf16 v96,s37,v78
v_dot2c_f32_bf16 v97,s81,v78
v_dot2c_f32_bf16 v98,s37,v79
v_dot2c_f32_bf16 v99,s81,v79
v_bitop3_b32 v16,v68,v78,s57 bitop3:0x7e
v_cvt_pk_bf16_f32 v56,v96,v97
s_nop 0
v_cvt_pk_bf16_f32 v57,v98,v99
ds_write_b64 v23,v[56:57]
s_waitcnt vmcnt(1)
v_dot2c_f32_bf16 v80,s37,v70
v_dot2c_f32_bf16 v81,s81,v70
v_dot2c_f32_bf16 v82,s37,v71
v_dot2c_f32_bf16 v83,s81,v71
v_dot2c_f32_bf16 v84,s37,v72
v_dot2c_f32_bf16 v85,s81,v72
v_dot2c_f32_bf16 v86,s37,v73
v_dot2c_f32_bf16 v87,s81,v73
v_bitop3_b32 v17,v60,v70,s57 bitop3:0x7e
v_or_b32 v16,v16,v17
v_cvt_pk_bf16_f32 v48,v80,v81
v_cvt_pk_bf16_f32 v49,v82,v83
v_cvt_pk_bf16_f32 v50,v84,v85
v_cvt_pk_bf16_f32 v51,v86,v87
ds_write_b128 v22,v[48:51] offset:0
s_waitcnt vmcnt(0)
v_dot2c_f32_bf16 v88,s37,v74
v_dot2c_f32_bf16 v89,s81,v74
v_dot2c_f32_bf16 v90,s37,v75
v_dot2c_f32_bf16 v91,s81,v75
v_dot2c_f32_bf16 v92,s37,v76
v_dot2c_f32_bf16 v93,s81,v76
v_dot2c_f32_bf16 v94,s37,v77
v_dot2c_f32_bf16 v95,s81,v77
v_bitop3_b32 v17,v64,v74,s57 bitop3:0x7e
v_bitop3_b32 v16,v16,v17,1 bitop3:0xa8
v_cmp_ne_u32 vcc,0,v16
v_cvt_pk_bf16_f32 v52,v88,v89
v_cvt_pk_bf16_f32 v53,v90,v91
v_cvt_pk_bf16_f32 v54,v92,v93
v_cvt_pk_bf16_f32 v55,v94,v95
ds_write_b128 v22,v[52:55] offset:1024
s_cbranch_vccnz fr_142
fj_143g:
v_smfmac_f32_16x16x64_bf16 v[24:27],v[48:51],a[0:7],v2
ds_read_b128 v[72:75],v21 offset:0
s_and_b32 s60,s52,1
v_smfmac_f32_16x16x64_bf16 v[28:31],v[48:51],a[8:15],v2
ds_read_b128 v[76:79],v21 offset:1024
s_lshl2_add_u32 s60,s51,s60
v_smfmac_f32_16x16x64_bf16 v[32:35],v[48:51],a[16:23],v2
ds_read_b128 v[80:83],v21 offset:2048
s_mul_i32 s60,s60,49152
v_smfmac_f32_16x16x64_bf16 v[36:39],v[48:51],a[24:31],v2
ds_read_b128 v[84:87],v21 offset:3072
s_add_u32 s71,s60,s34
s_waitcnt lgkmcnt(4)
s_barrier
v_smfmac_f32_16x16x64_bf16 v[40:43],v[48:51],a[32:39],v2
ds_read_b128 v[60:63],v3 offset:0
v_smfmac_f32_16x16x64_bf16 v[24:27],v[52:55],a[40:47],v2
ds_read_b128 v[64:67],v3 offset:1024
v_mov_b32 v17,1
v_smfmac_f32_16x16x64_bf16 v[28:31],v[52:55],a[48:55],v2
ds_read_b128 v[68:71],v4 offset:0
v_smfmac_f32_16x16x64_bf16 v[32:35],v[52:55],a[56:63],v2
s_mov_b64 exec,1
buffer_store_dword v17,v1,s[8:11],s79 offen sc1
s_mov_b64 exec,-1
v_smfmac_f32_16x16x64_bf16 v[36:39],v[52:55],a[64:71],v2
buffer_store_dwordx4 v[100:103],v1,s[8:11],s78 offen sc1
v_smfmac_f32_16x16x64_bf16 v[40:43],v[52:55],a[72:79],v2
buffer_store_dwordx2 v[104:105],v8,s[8:11],s78 offen offset:1024 sc1
s_waitcnt lgkmcnt(5)
v_smfmac_f32_16x16x64_bf16 v[44:47],v[48:51],v[72:79],v2
ds_read_b128 v[72:75],v21 offset:4096
s_waitcnt lgkmcnt(4)
v_smfmac_f32_16x16x64_bf16 v[44:47],v[52:55],v[80:87],v2
ds_read_b128 v[76:79],v21 offset:5120
s_waitcnt lgkmcnt(4)
v_smfmac_f32_16x16x64_bf16 v[24:27],v[60:63],a[80:87],v2
ds_read_b128 v[80:83],v21 offset:6144
s_and_b32 s79,s78,2147483648
v_smfmac_f32_16x16x64_bf16 v[28:31],v[60:63],a[88:95],v2
ds_read_b128 v[84:87],v21 offset:7168
s_or_b32 s79,s79,s30
v_smfmac_f32_16x16x64_bf16 v[32:35],v[60:63],a[96:103],v2
s_mov_b32 s78,2147483648
v_smfmac_f32_16x16x64_bf16 v[36:39],v[60:63],a[104:111],v2
v_smfmac_f32_16x16x64_bf16 v[40:43],v[60:63],a[112:119],v2
s_waitcnt lgkmcnt(2)
v_smfmac_f32_16x16x64_bf16 v[44:47],v[60:63],v[72:79],v2
ds_read_b128 v[60:63],v4 offset:1024
v_smfmac_f32_16x16x64_bf16 v[24:27],v[64:67],a[120:127],v2
ds_read_b128 v[72:75],v21 offset:8192
v_smfmac_f32_16x16x64_bf16 v[28:31],v[64:67],a[128:135],v2
ds_read_b128 v[76:79],v21 offset:9216
v_smfmac_f32_16x16x64_bf16 v[32:35],v[64:67],a[136:143],v2
v_smfmac_f32_16x16x64_bf16 v[36:39],v[64:67],a[144:151],v2
v_smfmac_f32_16x16x64_bf16 v[40:43],v[64:67],a[152:159],v2
s_waitcnt lgkmcnt(3)
v_smfmac_f32_16x16x64_bf16 v[44:47],v[64:67],v[80:87],v2
ds_read_b128 v[64:67],v5 offset:0
v_smfmac_f32_16x16x64_bf16 v[24:27],v[68:71],a[160:167],v2
ds_read_b128 v[80:83],v21 offset:10240
v_smfmac_f32_16x16x64_bf16 v[28:31],v[68:71],a[168:175],v2
ds_read_b128 v[84:87],v21 offset:11264
v_smfmac_f32_16x16x64_bf16 v[32:35],v[68:71],a[176:183],v2
v_smfmac_f32_16x16x64_bf16 v[36:39],v[68:71],a[184:191],v2
v_smfmac_f32_16x16x64_bf16 v[40:43],v[68:71],a[192:199],v2
s_waitcnt lgkmcnt(3)
v_smfmac_f32_16x16x64_bf16 v[44:47],v[68:71],v[72:79],v2
ds_read_b128 v[68:71],v5 offset:1024
v_smfmac_f32_16x16x64_bf16 v[24:27],v[60:63],a[200:207],v2
ds_read_b128 v[72:75],v21 offset:12288
v_smfmac_f32_16x16x64_bf16 v[28:31],v[60:63],a[208:215],v2
ds_read_b128 v[76:79],v21 offset:13312
v_smfmac_f32_16x16x64_bf16 v[32:35],v[60:63],a[216:223],v2
v_smfmac_f32_16x16x64_bf16 v[36:39],v[60:63],a[224:231],v2
v_smfmac_f32_16x16x64_bf16 v[40:43],v[60:63],a[232:239],v2
s_waitcnt lgkmcnt(3)
v_smfmac_f32_16x16x64_bf16 v[44:47],v[60:63],v[80:87],v2
ds_read_b128 v[60:63],v59 offset:0
v_smfmac_f32_16x16x64_bf16 v[24:27],v[64:67],a[240:247],v2
ds_read_b128 v[80:83],v21 offset:14336
v_smfmac_f32_16x16x64_bf16 v[28:31],v[64:67],a[248:255],v2
ds_read_b128 v[84:87],v21 offset:15360
v_smfmac_f32_16x16x64_bf16 v[32:35],v[64:67],v[112:119],v2
v_smfmac_f32_16x16x64_bf16 v[36:39],v[64:67],v[120:127],v2
v_smfmac_f32_16x16x64_bf16 v[40:43],v[64:67],v[128:135],v2
s_waitcnt lgkmcnt(3)
v_smfmac_f32_16x16x64_bf16 v[44:47],v[64:67],v[72:79],v2
ds_read_b128 v[64:67],v59 offset:1024
v_smfmac_f32_16x16x64_bf16 v[24:27],v[68:71],v[136:143],v2
ds_read_b128 v[72:75],v21 offset:16384
v_smfmac_f32_16x16x64_bf16 v[28:31],v[68:71],v[144:151],v2
ds_read_b128 v[76:79],v21 offset:17408
v_smfmac_f32_16x16x64_bf16 v[32:35],v[68:71],v[152:159],v2
v_smfmac_f32_16x16x64_bf16 v[36:39],v[68:71],v[160:167],v2
v_smfmac_f32_16x16x64_bf16 v[40:43],v[68:71],v[168:175],v2
s_waitcnt lgkmcnt(3)
v_smfmac_f32_16x16x64_bf16 v[44:47],v[68:71],v[80:87],v2
ds_read_b128 v[80:83],v21 offset:18432
v_smfmac_f32_16x16x64_bf16 v[24:27],v[60:63],v[176:183],v2
ds_read_b128 v[84:87],v21 offset:19456
v_smfmac_f32_16x16x64_bf16 v[28:31],v[60:63],v[184:191],v2
s_waitcnt lgkmcnt(4)
v_smfmac_f32_16x16x64_bf16 v[24:27],v[64:67],v[216:223],v2
v_smfmac_f32_16x16x64_bf16 v[28:31],v[64:67],v[224:231],v2
v_smfmac_f32_16x16x64_bf16 v[32:35],v[60:63],v[192:199],v2
v_smfmac_f32_16x16x64_bf16 v[36:39],v[60:63],v[200:207],v2
v_add_f32 v24,v24,v25
v_smfmac_f32_16x16x64_bf16 v[32:35],v[64:67],v[232:239],v2
v_add_f32 v26,v26,v27
v_smfmac_f32_16x16x64_bf16 v[36:39],v[64:67],v[240:247],v2
v_add_f32 v28,v28,v29
v_smfmac_f32_16x16x64_bf16 v[40:43],v[60:63],v[208:215],v2
v_add_f32 v30,v30,v31
s_waitcnt lgkmcnt(2)
v_smfmac_f32_16x16x64_bf16 v[44:47],v[60:63],v[72:79],v2
v_cvt_pk_bf16_f32 v100,v24,v26
v_smfmac_f32_16x16x64_bf16 v[40:43],v[64:67],v[248:255],v2
v_cvt_pk_bf16_f32 v101,v28,v30
s_waitcnt lgkmcnt(0)
v_smfmac_f32_16x16x64_bf16 v[44:47],v[64:67],v[80:87],v2
v_and_or_b32 v100,v100,-2,s57
v_add_f32 v32,v32,v33
v_add_f32 v34,v34,v35
v_add_f32 v36,v36,v37
v_add_f32 v38,v38,v39
v_cvt_pk_bf16_f32 v102,v32,v34
v_cvt_pk_bf16_f32 v103,v36,v38
v_and_or_b32 v102,v102,-2,s57
buffer_store_dwordx4 v[100:103],v6,s[8:11],s71 offen sc1
v_add_f32 v40,v40,v41
v_add_f32 v42,v42,v43
v_add_f32 v44,v44,v45
v_add_f32 v46,v46,v47
v_cvt_pk_bf16_f32 v104,v40,v42
v_cvt_pk_bf16_f32 v105,v44,v46
v_and_or_b32 v104,v104,-2,s57
buffer_store_dwordx2 v[104:105],v7,s[8:11],s71 offen sc1
s_lshl_b32 s60,s51,6
s_add_u32 s60,s60,s52
s_mul_i32 s78,s60,196608
s_add_u32 s78,s78,s85
s_lshl_b32 s60,s60,10
s_add_u32 s30,s60,s86
s_sub_u32 s60,s4,s5
s_cmp_gt_i32 s60,13
s_cselect_b32 s53,1,0
s_cmp_eq_u32 s4,64
s_cselect_b32 s53,1,s53
s_cmp_eq_u32 s53,0
s_cselect_b32 s54,s4,s5
s_addc_u32 s4,s4,0
s_add_u32 s5,s5,s53
s_and_b32 s60,s54,1
s_lshl2_add_u32 s60,s53,s60
s_lshl_b32 s68,s60,16
s_add_u32 s68,s68,s83
s_mul_i32 s59,s60,20480
s_add_u32 s59,s59,s6
s_lshl_b32 s69,s53,9
s_add_u32 s69,s69,s7
s_bfe_u32 s31,s54,65537
s_add_u32 s32,s54,1
s_cmp_lg_u32 s53,s51
s_cbranch_scc1 nx_147
s_waitcnt vmcnt(0)
s_cmp_ge_u32 s79,2147483648
s_cbranch_scc1 pf_148
v_mov_b32 v17,1
s_mov_b64 exec,1
buffer_store_dword v17,v1,s[8:11],s79 offen sc1
s_mov_b64 exec,-1
s_mov_b32 s79,2147483648
pf_148:
s_cmp_eq_u32 s78,2147483648
s_cbranch_scc1 pk_149
buffer_store_dwordx4 v[100:103],v1,s[8:11],s78 offen sc1
buffer_store_dwordx2 v[104:105],v8,s[8:11],s78 offen offset:1024 sc1
s_mov_b32 s79,s30
s_mov_b32 s78,2147483648
pk_149:
s_waitcnt vmcnt(0)
s_cmp_ge_u32 s79,2147483648
s_cbranch_scc1 pf_150
v_mov_b32 v17,1
s_mov_b64 exec,1
buffer_store_dword v17,v1,s[8:11],s79 offen sc1
s_mov_b64 exec,-1
s_mov_b32 s79,2147483648
pf_150:
nx_147:
s_add_u32 s50,s50,1
s_mov_b32 s51,s53
s_mov_b32 s52,s54
s_mov_b32 s57,s31
s_mov_b32 s58,s32
s_cmp_lt_u32 s50,128
s_cbranch_scc1 CV_LOOP_S0
s_branch CV_DONE
fr_142:
v_bitop3_b32 v12,v60,v64,s57 bitop3:0x7e
v_bitop3_b32 v13,v68,v68,s57 bitop3:0x7e
v_xor_b32 v14,s57,v68
v_or3_b32 v12,v12,v13,v14
v_and_b32 v12,1,v12
v_cmp_ne_u32 vcc,0,v12
s_cbranch_vccz sk_151
buffer_load_dwordx2 v[68:69],v18,s[8:11],s59 offen sc1
buffer_load_dwordx4 v[60:63],v1,s[8:11],s59 offen sc1
buffer_load_dwordx4 v[64:67],v1,s[8:11],s59 offen offset:1024 sc1
sk_151:
buffer_load_dwordx2 v[78:79],v18,s[8:11],s68 offen sc1
buffer_load_dwordx4 v[70:73],v1,s[8:11],s68 offen sc1
buffer_load_dwordx4 v[74:77],v1,s[8:11],s68 offen offset:1024 sc1
s_sub_u32 s47,s47,1
s_cbranch_scc1 ABORT
s_waitcnt lgkmcnt(0)
s_branch fa_141
CV_LOOP_S1:
v_mov_b32 v24,0
v_mov_b32 v25,0
v_mov_b32 v26,0
v_mov_b32 v27,0
v_mov_b32 v28,0
v_mov_b32 v29,0
v_mov_b32 v30,0
v_mov_b32 v31,0
v_mov_b32 v32,0
v_mov_b32 v33,0
v_mov_b32 v34,0
v_mov_b32 v35,0
v_mov_b32 v36,0
v_mov_b32 v37,0
v_mov_b32 v38,0
v_mov_b32 v39,0
v_mov_b32 v40,0
v_mov_b32 v41,0
v_mov_b32 v42,0
v_mov_b32 v43,0
v_mov_b32 v44,0
v_mov_b32 v45,0
v_mov_b32 v46,0
v_mov_b32 v47,0
s_barrier
buffer_load_dwordx2 v[68:69],v18,s[8:11],s59 offen sc1
buffer_load_dwordx4 v[60:63],v1,s[8:11],s59 offen sc1
buffer_load_dwordx4 v[64:67],v1,s[8:11],s59 offen offset:1024 sc1
s_waitcnt vmcnt(2)
s_sleep 3
fj_154f:
buffer_load_dwordx2 v[78:79],v18,s[8:11],s68 offen sc1
buffer_load_dwordx4 v[70:73],v1,s[8:11],s68 offen sc1
buffer_load_dwordx4 v[74:77],v1,s[8:11],s68 offen offset:1024 sc1
fj_154:
fa_152:
s_waitcnt vmcnt(5)
v_lshlrev_b32 v96,16,v68
v_and_b32 v97,0xffff0000,v68
v_lshlrev_b32 v98,16,v69
v_and_b32 v99,0xffff0000,v69
s_waitcnt vmcnt(4)
v_lshlrev_b32 v80,16,v60
v_and_b32 v81,0xffff0000,v60
v_lshlrev_b32 v82,16,v61
v_and_b32 v83,0xffff0000,v61
v_lshlrev_b32 v84,16,v62
v_and_b32 v85,0xffff0000,v62
v_lshlrev_b32 v86,16,v63
v_and_b32 v87,0xffff0000,v63
s_waitcnt vmcnt(3)
v_lshlrev_b32 v88,16,v64
v_and_b32 v89,0xffff0000,v64
v_lshlrev_b32 v90,16,v65
v_and_b32 v91,0xffff0000,v65
v_lshlrev_b32 v92,16,v66
v_and_b32 v93,0xffff0000,v66
v_lshlrev_b32 v94,16,v67
v_and_b32 v95,0xffff0000,v67
s_waitcnt vmcnt(2)
v_dot2c_f32_bf16 v96,s37,v78
v_dot2c_f32_bf16 v97,s81,v78
v_dot2c_f32_bf16 v98,s37,v79
v_dot2c_f32_bf16 v99,s81,v79
v_bitop3_b32 v16,v68,v78,s57 bitop3:0x7e
v_cvt_pk_bf16_f32 v56,v96,v97
s_nop 0
v_cvt_pk_bf16_f32 v57,v98,v99
ds_write_b64 v23,v[56:57]
s_waitcnt vmcnt(1)
v_dot2c_f32_bf16 v80,s37,v70
v_dot2c_f32_bf16 v81,s81,v70
v_dot2c_f32_bf16 v82,s37,v71
v_dot2c_f32_bf16 v83,s81,v71
v_dot2c_f32_bf16 v84,s37,v72
v_dot2c_f32_bf16 v85,s81,v72
v_dot2c_f32_bf16 v86,s37,v73
v_dot2c_f32_bf16 v87,s81,v73
v_bitop3_b32 v17,v60,v70,s57 bitop3:0x7e
v_or_b32 v16,v16,v17
v_cvt_pk_bf16_f32 v48,v80,v81
v_cvt_pk_bf16_f32 v49,v82,v83
v_cvt_pk_bf16_f32 v50,v84,v85
v_cvt_pk_bf16_f32 v51,v86,v87
ds_write_b128 v22,v[48:51] offset:0
s_waitcnt vmcnt(0)
v_dot2c_f32_bf16 v88,s37,v74
v_dot2c_f32_bf16 v89,s81,v74
v_dot2c_f32_bf16 v90,s37,v75
v_dot2c_f32_bf16 v91,s81,v75
v_dot2c_f32_bf16 v92,s37,v76
v_dot2c_f32_bf16 v93,s81,v76
v_dot2c_f32_bf16 v94,s37,v77
v_dot2c_f32_bf16 v95,s81,v77
v_bitop3_b32 v17,v64,v74,s57 bitop3:0x7e
v_bitop3_b32 v16,v16,v17,1 bitop3:0xa8
v_cmp_ne_u32 vcc,0,v16
v_cvt_pk_bf16_f32 v52,v88,v89
v_cvt_pk_bf16_f32 v53,v90,v91
v_cvt_pk_bf16_f32 v54,v92,v93
v_cvt_pk_bf16_f32 v55,v94,v95
ds_write_b128 v22,v[52:55] offset:1024
s_cbranch_vccnz fr_153
fj_154g:
v_smfmac_f32_16x16x64_bf16 v[24:27],v[48:51],a[0:7],v2
ds_read_b128 v[72:75],v21 offset:0
s_and_b32 s60,s52,1
v_smfmac_f32_16x16x64_bf16 v[28:31],v[48:51],a[8:15],v2
ds_read_b128 v[76:79],v21 offset:1024
s_lshl2_add_u32 s60,s51,s60
v_smfmac_f32_16x16x64_bf16 v[32:35],v[48:51],a[16:23],v2
ds_read_b128 v[80:83],v21 offset:2048
s_mul_i32 s60,s60,49152
v_smfmac_f32_16x16x64_bf16 v[36:39],v[48:51],a[24:31],v2
ds_read_b128 v[84:87],v21 offset:3072
s_add_u32 s71,s60,s34
s_waitcnt lgkmcnt(4)
s_barrier
v_smfmac_f32_16x16x64_bf16 v[40:43],v[48:51],a[32:39],v2
ds_read_b128 v[60:63],v3 offset:0
v_smfmac_f32_16x16x64_bf16 v[24:27],v[52:55],a[40:47],v2
ds_read_b128 v[64:67],v3 offset:1024
v_mov_b32 v17,1
v_smfmac_f32_16x16x64_bf16 v[28:31],v[52:55],a[48:55],v2
ds_read_b128 v[68:71],v4 offset:0
v_smfmac_f32_16x16x64_bf16 v[32:35],v[52:55],a[56:63],v2
s_mov_b64 exec,1
buffer_store_dword v17,v1,s[8:11],s79 offen sc1
s_mov_b64 exec,-1
v_smfmac_f32_16x16x64_bf16 v[36:39],v[52:55],a[64:71],v2
buffer_store_dwordx4 v[100:103],v1,s[8:11],s78 offen offset:1536 sc1
v_smfmac_f32_16x16x64_bf16 v[40:43],v[52:55],a[72:79],v2
buffer_store_dwordx2 v[104:105],v8,s[8:11],s78 offen offset:2560 sc1
s_waitcnt lgkmcnt(5)
v_smfmac_f32_16x16x64_bf16 v[44:47],v[48:51],v[72:79],v2
ds_read_b128 v[72:75],v21 offset:4096
s_waitcnt lgkmcnt(4)
v_smfmac_f32_16x16x64_bf16 v[44:47],v[52:55],v[80:87],v2
ds_read_b128 v[76:79],v21 offset:5120
s_waitcnt lgkmcnt(4)
v_smfmac_f32_16x16x64_bf16 v[24:27],v[60:63],a[80:87],v2
ds_read_b128 v[80:83],v21 offset:6144
s_and_b32 s79,s78,2147483648
v_smfmac_f32_16x16x64_bf16 v[28:31],v[60:63],a[88:95],v2
ds_read_b128 v[84:87],v21 offset:7168
s_or_b32 s79,s79,s30
v_smfmac_f32_16x16x64_bf16 v[32:35],v[60:63],a[96:103],v2
s_mov_b32 s78,2147483648
v_smfmac_f32_16x16x64_bf16 v[36:39],v[60:63],a[104:111],v2
v_smfmac_f32_16x16x64_bf16 v[40:43],v[60:63],a[112:119],v2
s_waitcnt lgkmcnt(2)
v_smfmac_f32_16x16x64_bf16 v[44:47],v[60:63],v[72:79],v2
ds_read_b128 v[60:63],v4 offset:1024
v_smfmac_f32_16x16x64_bf16 v[24:27],v[64:67],a[120:127],v2
ds_read_b128 v[72:75],v21 offset:8192
v_smfmac_f32_16x16x64_bf16 v[28:31],v[64:67],a[128:135],v2
ds_read_b128 v[76:79],v21 offset:9216
v_smfmac_f32_16x16x64_bf16 v[32:35],v[64:67],a[136:143],v2
v_smfmac_f32_16x16x64_bf16 v[36:39],v[64:67],a[144:151],v2
v_smfmac_f32_16x16x64_bf16 v[40:43],v[64:67],a[152:159],v2
s_waitcnt lgkmcnt(3)
v_smfmac_f32_16x16x64_bf16 v[44:47],v[64:67],v[80:87],v2
ds_read_b128 v[64:67],v5 offset:0
v_smfmac_f32_16x16x64_bf16 v[24:27],v[68:71],a[160:167],v2
ds_read_b128 v[80:83],v21 offset:10240
v_smfmac_f32_16x16x64_bf16 v[28:31],v[68:71],a[168:175],v2
ds_read_b128 v[84:87],v21 offset:11264
v_smfmac_f32_16x16x64_bf16 v[32:35],v[68:71],a[176:183],v2
v_smfmac_f32_16x16x64_bf16 v[36:39],v[68:71],a[184:191],v2
v_smfmac_f32_16x16x64_bf16 v[40:43],v[68:71],a[192:199],v2
s_waitcnt lgkmcnt(3)
v_smfmac_f32_16x16x64_bf16 v[44:47],v[68:71],v[72:79],v2
ds_read_b128 v[68:71],v5 offset:1024
v_smfmac_f32_16x16x64_bf16 v[24:27],v[60:63],a[200:207],v2
ds_read_b128 v[72:75],v21 offset:12288
v_smfmac_f32_16x16x64_bf16 v[28:31],v[60:63],a[208:215],v2
ds_read_b128 v[76:79],v21 offset:13312
v_smfmac_f32_16x16x64_bf16 v[32:35],v[60:63],a[216:223],v2
v_smfmac_f32_16x16x64_bf16 v[36:39],v[60:63],a[224:231],v2
v_smfmac_f32_16x16x64_bf16 v[40:43],v[60:63],a[232:239],v2
s_waitcnt lgkmcnt(3)
v_smfmac_f32_16x16x64_bf16 v[44:47],v[60:63],v[80:87],v2
ds_read_b128 v[60:63],v59 offset:0
v_smfmac_f32_16x16x64_bf16 v[24:27],v[64:67],a[240:247],v2
ds_read_b128 v[80:83],v21 offset:14336
v_smfmac_f32_16x16x64_bf16 v[28:31],v[64:67],a[248:255],v2
ds_read_b128 v[84:87],v21 offset:15360
v_smfmac_f32_16x16x64_bf16 v[32:35],v[64:67],v[112:119],v2
v_smfmac_f32_16x16x64_bf16 v[36:39],v[64:67],v[120:127],v2
v_smfmac_f32_16x16x64_bf16 v[40:43],v[64:67],v[128:135],v2
s_waitcnt lgkmcnt(3)
v_smfmac_f32_16x16x64_bf16 v[44:47],v[64:67],v[72:79],v2
ds_read_b128 v[64:67],v59 offset:1024
v_smfmac_f32_16x16x64_bf16 v[24:27],v[68:71],v[136:143],v2
ds_read_b128 v[72:75],v21 offset:16384
v_smfmac_f32_16x16x64_bf16 v[28:31],v[68:71],v[144:151],v2
ds_read_b128 v[76:79],v21 offset:17408
v_smfmac_f32_16x16x64_bf16 v[32:35],v[68:71],v[152:159],v2
v_smfmac_f32_16x16x64_bf16 v[36:39],v[68:71],v[160:167],v2
v_smfmac_f32_16x16x64_bf16 v[40:43],v[68:71],v[168:175],v2
s_waitcnt lgkmcnt(3)
v_smfmac_f32_16x16x64_bf16 v[44:47],v[68:71],v[80:87],v2
ds_read_b128 v[80:83],v21 offset:18432
v_smfmac_f32_16x16x64_bf16 v[24:27],v[60:63],v[176:183],v2
ds_read_b128 v[84:87],v21 offset:19456
v_smfmac_f32_16x16x64_bf16 v[28:31],v[60:63],v[184:191],v2
s_waitcnt lgkmcnt(4)
v_smfmac_f32_16x16x64_bf16 v[24:27],v[64:67],v[216:223],v2
v_smfmac_f32_16x16x64_bf16 v[28:31],v[64:67],v[224:231],v2
v_smfmac_f32_16x16x64_bf16 v[32:35],v[60:63],v[192:199],v2
v_smfmac_f32_16x16x64_bf16 v[36:39],v[60:63],v[200:207],v2
v_add_f32 v24,v24,v25
v_smfmac_f32_16x16x64_bf16 v[32:35],v[64:67],v[232:239],v2
v_add_f32 v26,v26,v27
v_smfmac_f32_16x16x64_bf16 v[36:39],v[64:67],v[240:247],v2
v_add_f32 v28,v28,v29
v_smfmac_f32_16x16x64_bf16 v[40:43],v[60:63],v[208:215],v2
v_add_f32 v30,v30,v31
s_waitcnt lgkmcnt(2)
v_smfmac_f32_16x16x64_bf16 v[44:47],v[60:63],v[72:79],v2
v_cvt_pk_bf16_f32 v100,v24,v26
v_smfmac_f32_16x16x64_bf16 v[40:43],v[64:67],v[248:255],v2
v_cvt_pk_bf16_f32 v101,v28,v30
s_waitcnt lgkmcnt(0)
v_smfmac_f32_16x16x64_bf16 v[44:47],v[64:67],v[80:87],v2
v_and_or_b32 v100,v100,-2,s57
buffer_store_dwordx2 v[100:101],v7,s[8:11],s71 offen sc1
v_add_f32 v32,v32,v33
v_add_f32 v34,v34,v35
v_add_f32 v36,v36,v37
v_add_f32 v38,v38,v39
v_cvt_pk_bf16_f32 v102,v32,v34
v_cvt_pk_bf16_f32 v103,v36,v38
v_and_or_b32 v102,v102,-2,s57
v_add_f32 v40,v40,v41
v_add_f32 v42,v42,v43
v_add_f32 v44,v44,v45
v_add_f32 v46,v46,v47
v_cvt_pk_bf16_f32 v104,v40,v42
v_cvt_pk_bf16_f32 v105,v44,v46
v_and_or_b32 v104,v104,-2,s57
buffer_store_dwordx4 v[102:105],v6,s[8:11],s71 offen sc1
s_lshl_b32 s60,s51,6
s_add_u32 s60,s60,s52
s_mul_i32 s78,s60,196608
s_add_u32 s78,s78,s85
s_lshl_b32 s60,s60,10
s_add_u32 s30,s60,s86
s_sub_u32 s60,s4,s5
s_cmp_gt_i32 s60,13
s_cselect_b32 s53,1,0
s_cmp_eq_u32 s4,64
s_cselect_b32 s53,1,s53
s_cmp_eq_u32 s53,0
s_cselect_b32 s54,s4,s5
s_addc_u32 s4,s4,0
s_add_u32 s5,s5,s53
s_and_b32 s60,s54,1
s_lshl2_add_u32 s60,s53,s60
s_lshl_b32 s68,s60,16
s_add_u32 s68,s68,s83
s_mul_i32 s59,s60,20480
s_add_u32 s59,s59,s6
s_lshl_b32 s69,s53,9
s_add_u32 s69,s69,s7
s_bfe_u32 s31,s54,65537
s_add_u32 s32,s54,1
s_cmp_lg_u32 s53,s51
s_cbranch_scc1 nx_155
s_waitcnt vmcnt(0)
s_cmp_ge_u32 s79,2147483648
s_cbranch_scc1 pf_156
v_mov_b32 v17,1
s_mov_b64 exec,1
buffer_store_dword v17,v1,s[8:11],s79 offen sc1
s_mov_b64 exec,-1
s_mov_b32 s79,2147483648
pf_156:
s_cmp_eq_u32 s78,2147483648
s_cbranch_scc1 pk_157
buffer_store_dwordx4 v[100:103],v1,s[8:11],s78 offen offset:1536 sc1
buffer_store_dwordx2 v[104:105],v8,s[8:11],s78 offen offset:2560 sc1
s_mov_b32 s79,s30
s_mov_b32 s78,2147483648
pk_157:
s_waitcnt vmcnt(0)
s_cmp_ge_u32 s79,2147483648
s_cbranch_scc1 pf_158
v_mov_b32 v17,1
s_mov_b64 exec,1
buffer_store_dword v17,v1,s[8:11],s79 offen sc1
s_mov_b64 exec,-1
s_mov_b32 s79,2147483648
pf_158:
nx_155:
s_add_u32 s50,s50,1
s_mov_b32 s51,s53
s_mov_b32 s52,s54
s_mov_b32 s57,s31
s_mov_b32 s58,s32
s_cmp_lt_u32 s50,128
s_cbranch_scc1 CV_LOOP_S1
s_branch CV_DONE
fr_153:
v_bitop3_b32 v12,v60,v64,s57 bitop3:0x7e
v_bitop3_b32 v13,v68,v68,s57 bitop3:0x7e
v_xor_b32 v14,s57,v68
v_or3_b32 v12,v12,v13,v14
v_and_b32 v12,1,v12
v_cmp_ne_u32 vcc,0,v12
s_cbranch_vccz sk_159
buffer_load_dwordx2 v[68:69],v18,s[8:11],s59 offen sc1
buffer_load_dwordx4 v[60:63],v1,s[8:11],s59 offen sc1
buffer_load_dwordx4 v[64:67],v1,s[8:11],s59 offen offset:1024 sc1
sk_159:
buffer_load_dwordx2 v[78:79],v18,s[8:11],s68 offen sc1
buffer_load_dwordx4 v[70:73],v1,s[8:11],s68 offen sc1
buffer_load_dwordx4 v[74:77],v1,s[8:11],s68 offen offset:1024 sc1
s_sub_u32 s47,s47,1
s_cbranch_scc1 ABORT
s_waitcnt lgkmcnt(0)
s_branch fa_152
CV_DONE:
s_add_u32 s61,s48,32
s_endpgm
ROLE_CW:
s_lshr_b32 s28,s48,3
s_and_b32 s29,s48,7
s_mul_i32 s82,s28,2097152
s_add_u32 s82,s82,2097152
v_lshlrev_b32 v1,4,v0
v_and_b32 v12,1,v0
v_mul_u32_u24 v2,0xaaaa,v12
v_or_b32 v2,0x4444,v2
v_lshrrev_b32 v14,4,v0
v_and_b32 v15,15,v0
v_min_u32 v3,11,v15
v_lshlrev_b32 v3,2,v3
v_lshl_add_u32 v3,v14,7,v3
s_mul_i32 s60,s46,24576
v_add_u32 v4,s60,v1
v_mul_u32_u24 v5,704,v14
v_and_b32 v12,3,v15
v_lshl_add_u32 v5,v12,2,v5
v_bfe_u32 v12,v15,2,1
v_lshl_add_u32 v5,v12,5,v5
v_bfe_u32 v12,v15,3,1
v_lshl_add_u32 v5,v12,4,v5
s_mul_i32 s60,s46,2816
s_add_u32 s60,s60,98304
v_add_u32 v5,s60,v5
s_mul_i32 s60,s46,24
s_min_u32 s60,s60,64
s_cmp_lt_u32 s46,2
s_cselect_b32 s61,23,15
s_mov_b32 s88,0xffff
s_cselect_b32 s88,0xffffff,s88
s_mov_b32 s89,0
v_and_b32 v12,31,v0
v_min_u32 v12,s61,v12
v_add_u32 v12,s60,v12
v_lshrrev_b32 v13,5,v0
v_lshl_add_u32 v12,v12,1,v13
v_bfe_u32 v13,v12,2,3
v_mul_u32_u24 v6,352,v13
v_mul_u32_u24 v17,1280,v13
v_lshrrev_b32 v13,5,v12
v_lshl_add_u32 v6,v13,6,v6
v_lshl_add_u32 v17,v13,5,v17
v_and_b32 v13,3,v12
v_lshl_add_u32 v17,v13,3,v17
v_and_b32 v13,1,v12
v_lshl_add_u32 v6,v13,5,v6
v_bfe_u32 v13,v12,1,1
v_lshl_add_u32 v6,v13,4,v6
v_add_u32 v6,98304,v6
s_mul_i32 s60,s29,1280
v_lshlrev_b32 v9,3,v12
v_add_u32 v9,s60,v9
v_lshrrev_b32 v13,13,v9
v_lshl_add_u32 v9,v13,13,v9
v_xor_b32 v10,1,v12
v_or_b32 v10,v10,v13
v_and_b32 v10,1,v10
s_mov_b32 s4,s18
s_mov_b32 s5,s19
s_mov_b32 s6,10240
s_mov_b32 s7,0x20000
s_mul_i32 s60,s29,160
buffer_load_dwordx2 v[32:33],v17,s[4:7],s60 offen
s_mul_i32 s84,s29,0
s_add_u32 s84,s84,s82
s_lshl_b32 s83,s28,19
s_lshr_b32 s60,s29,1
s_and_b32 s61,s29,1
s_mul_i32 s62,s61,0
s_add_u32 s83,s83,s62
s_add_u32 s83,s83,10485760
s_lshl_b32 s85,s60,7
s_lshl_b32 s61,s61,2
s_add_u32 s61,s61,s46
s_lshl_b32 s61,s61,2
s_add_u32 s85,s85,s61
s_add_u32 s85,s85,s82
s_add_u32 s85,s85,950272
s_mul_i32 s33,s46,12288
s_add_u32 s33,s33,s82
s_add_u32 s33,s33,163840
s_mov_b32 s35,0
s_add_u32 s35,s35,s82
s_add_u32 s35,s35,951296
s_cmp_eq_u32 s28,0
s_cselect_b32 s63,0xffff0000,0
s_waitcnt vmcnt(0)
s_cselect_b64 vcc,-1,0
v_bfi_b32 v36,v10,0,v32
v_lshlrev_b32 v34,16,v32
v_lshlrev_b32 v35,16,v36
v_sub_f32 v34,v34,v35
v_lshrrev_b32 v34,16,v34
v_and_b32 v34,-2,v34
v_cndmask_b32 v36,v34,v36,vcc
v_cndmask_b32 v37,0,v33,vcc
s_nop 0
v_permlane32_swap_b32 v36,v38
v_permlane32_swap_b32 v37,v39
v_mov_b32 v40,-1
v_mov_b32 v41,-1
v_mov_b32 v42,-1
v_mov_b32 v43,-1
v_mov_b32 v44,1
s_mov_b64 exec,s[88:89]
s_add_u32 s60,s83,0
buffer_store_dwordx4 v[36:39],v9,s[8:11],s60 offen sc1
s_add_u32 s60,s83,8192
buffer_store_dwordx4 v[36:39],v9,s[8:11],s60 offen sc1
s_add_u32 s60,s83,65536
buffer_store_dwordx4 v[40:43],v9,s[8:11],s60 offen sc1
s_add_u32 s60,s83,73728
buffer_store_dwordx4 v[40:43],v9,s[8:11],s60 offen sc1
s_add_u32 s60,s83,131072
buffer_store_dwordx4 v[40:43],v9,s[8:11],s60 offen sc1
s_add_u32 s60,s83,139264
buffer_store_dwordx4 v[40:43],v9,s[8:11],s60 offen sc1
s_add_u32 s60,s83,196608
buffer_store_dwordx4 v[40:43],v9,s[8:11],s60 offen sc1
s_add_u32 s60,s83,204800
buffer_store_dwordx4 v[40:43],v9,s[8:11],s60 offen sc1
s_add_u32 s60,s83,262144
buffer_store_dwordx4 v[36:39],v9,s[8:11],s60 offen sc1
s_add_u32 s60,s83,270336
buffer_store_dwordx4 v[36:39],v9,s[8:11],s60 offen sc1
s_add_u32 s60,s83,327680
buffer_store_dwordx4 v[40:43],v9,s[8:11],s60 offen sc1
s_add_u32 s60,s83,335872
buffer_store_dwordx4 v[40:43],v9,s[8:11],s60 offen sc1
s_add_u32 s60,s83,393216
buffer_store_dwordx4 v[40:43],v9,s[8:11],s60 offen sc1
s_add_u32 s60,s83,401408
buffer_store_dwordx4 v[40:43],v9,s[8:11],s60 offen sc1
s_add_u32 s60,s83,458752
buffer_store_dwordx4 v[40:43],v9,s[8:11],s60 offen sc1
s_add_u32 s60,s83,466944
buffer_store_dwordx4 v[40:43],v9,s[8:11],s60 offen sc1
s_cmp_lg_u32 s49,0
s_cbranch_scc1 ls_160
s_add_u32 s60,s84,0
buffer_store_dwordx4 v[36:39],v9,s[8:11],s60 offen
s_add_u32 s60,s84,20480
buffer_store_dwordx4 v[40:43],v9,s[8:11],s60 offen
s_add_u32 s60,s84,40960
buffer_store_dwordx4 v[40:43],v9,s[8:11],s60 offen
s_add_u32 s60,s84,61440
buffer_store_dwordx4 v[40:43],v9,s[8:11],s60 offen
s_add_u32 s60,s84,81920
buffer_store_dwordx4 v[36:39],v9,s[8:11],s60 offen
s_add_u32 s60,s84,102400
buffer_store_dwordx4 v[40:43],v9,s[8:11],s60 offen
s_add_u32 s60,s84,122880
buffer_store_dwordx4 v[40:43],v9,s[8:11],s60 offen
s_add_u32 s60,s84,143360
buffer_store_dwordx4 v[40:43],v9,s[8:11],s60 offen
s_mov_b64 exec,1
buffer_store_dword v44,v1,s[8:11],s85 offen
buffer_store_dword v44,v1,s[8:11],s85 offen offset:512
s_branch ls_161
ls_160:
s_add_u32 s60,s84,0
buffer_store_dwordx4 v[36:39],v9,s[8:11],s60 offen sc1
s_add_u32 s60,s84,20480
buffer_store_dwordx4 v[40:43],v9,s[8:11],s60 offen sc1
s_add_u32 s60,s84,40960
buffer_store_dwordx4 v[40:43],v9,s[8:11],s60 offen sc1
s_add_u32 s60,s84,61440
buffer_store_dwordx4 v[40:43],v9,s[8:11],s60 offen sc1
s_add_u32 s60,s84,81920
buffer_store_dwordx4 v[36:39],v9,s[8:11],s60 offen sc1
s_add_u32 s60,s84,102400
buffer_store_dwordx4 v[40:43],v9,s[8:11],s60 offen sc1
s_add_u32 s60,s84,122880
buffer_store_dwordx4 v[40:43],v9,s[8:11],s60 offen sc1
s_add_u32 s60,s84,143360
buffer_store_dwordx4 v[40:43],v9,s[8:11],s60 offen sc1
s_mov_b64 exec,1
buffer_store_dword v44,v1,s[8:11],s85 offen sc1
buffer_store_dword v44,v1,s[8:11],s85 offen offset:512 sc1
ls_161:
s_mov_b64 exec,-1
s_waitcnt vmcnt(0)
s_barrier
s_cmp_lg_u32 s46,0
s_cbranch_scc1 arr_162
v_mov_b32 v12,1
s_lshl_b32 s3,s49,2
v_mov_b32 v13,s3
s_mov_b64 exec,1
buffer_atomic_add v12,v13,s[12:15],0 offen sc1
s_mov_b64 exec,-1
arr_162:
s_mov_b32 s4,s26
s_mov_b32 s5,s27
s_mov_b32 s6,7864320
s_mov_b32 s7,0x20000
s_lshl_b32 s60,s28,2
s_add_u32 s60,s60,s46
s_mul_i32 s73,s60,983040
s_mul_i32 s60,s29,160
s_add_u32 s73,s73,s60
s_mul_i32 s74,s46,40960
v_add_u32 v12,0,v0
v_mul_u32_u24 v13,6554,v12
v_lshrrev_b32 v13,16,v13
v_mul_u32_u24 v16,10,v13
v_sub_u32 v12,v12,v16
v_mul_u32_u24 v20,1280,v13
v_lshl_add_u32 v20,v12,4,v20
v_add_u32 v12,64,v0
v_mul_u32_u24 v13,6554,v12
v_lshrrev_b32 v13,16,v13
v_mul_u32_u24 v16,10,v13
v_sub_u32 v12,v12,v16
v_mul_u32_u24 v21,1280,v13
v_lshl_add_u32 v21,v12,4,v21
v_add_u32 v12,128,v0
v_mul_u32_u24 v13,6554,v12
v_lshrrev_b32 v13,16,v13
v_mul_u32_u24 v16,10,v13
v_sub_u32 v12,v12,v16
v_mul_u32_u24 v22,1280,v13
v_lshl_add_u32 v22,v12,4,v22
v_add_u32 v12,192,v0
v_mul_u32_u24 v13,6554,v12
v_lshrrev_b32 v13,16,v13
v_mul_u32_u24 v16,10,v13
v_sub_u32 v12,v12,v16
v_mul_u32_u24 v23,1280,v13
v_lshl_add_u32 v23,v12,4,v23
v_add_u32 v12,256,v0
v_mul_u32_u24 v13,6554,v12
v_lshrrev_b32 v13,16,v13
v_mul_u32_u24 v16,10,v13
v_sub_u32 v12,v12,v16
v_mul_u32_u24 v24,1280,v13
v_lshl_add_u32 v24,v12,4,v24
v_add_u32 v12,320,v0
v_mul_u32_u24 v13,6554,v12
v_lshrrev_b32 v13,16,v13
v_mul_u32_u24 v16,10,v13
v_sub_u32 v12,v12,v16
v_mul_u32_u24 v25,1280,v13
v_lshl_add_u32 v25,v12,4,v25
v_add_u32 v12,384,v0
v_mul_u32_u24 v13,6554,v12
v_lshrrev_b32 v13,16,v13
v_mul_u32_u24 v16,10,v13
v_sub_u32 v12,v12,v16
v_mul_u32_u24 v26,1280,v13
v_lshl_add_u32 v26,v12,4,v26
v_add_u32 v12,448,v0
v_mul_u32_u24 v13,6554,v12
v_lshrrev_b32 v13,16,v13
v_mul_u32_u24 v16,10,v13
v_sub_u32 v12,v12,v16
v_mul_u32_u24 v27,1280,v13
v_lshl_add_u32 v27,v12,4,v27
v_add_u32 v12,512,v0
v_mul_u32_u24 v13,6554,v12
v_lshrrev_b32 v13,16,v13
v_mul_u32_u24 v16,10,v13
v_sub_u32 v12,v12,v16
v_mul_u32_u24 v28,1280,v13
v_lshl_add_u32 v28,v12,4,v28
v_add_u32 v12,576,v0
v_mul_u32_u24 v13,6554,v12
v_lshrrev_b32 v13,16,v13
v_mul_u32_u24 v16,10,v13
v_sub_u32 v12,v12,v16
v_mul_u32_u24 v29,1280,v13
v_lshl_add_u32 v29,v12,4,v29
v_lshrrev_b32 v14,4,v0
v_and_b32 v12,1,v14
v_lshlrev_b32 v12,5,v12
v_lshrrev_b32 v13,1,v14
v_lshl_add_u32 v12,v13,2,v12
v_bfe_u32 v13,v0,2,1
v_add_u32 v12,v12,v13
v_bfe_u32 v13,v0,3,1
v_lshl_add_u32 v12,v13,4,v12
v_mul_u32_u24 v30,160,v12
v_and_b32 v13,3,v0
v_lshl_add_u32 v30,v13,3,v30
v_add_u32 v30,s74,v30
s_add_u32 s61,s73,0
s_add_u32 m0,s74,0
s_nop 0
buffer_load_dwordx4 v20,s[4:7],s61 offen lds
s_add_u32 m0,s74,1024
s_nop 0
buffer_load_dwordx4 v21,s[4:7],s61 offen lds
s_add_u32 m0,s74,2048
s_nop 0
buffer_load_dwordx4 v22,s[4:7],s61 offen lds
s_add_u32 m0,s74,3072
s_nop 0
buffer_load_dwordx4 v23,s[4:7],s61 offen lds
s_add_u32 m0,s74,4096
s_nop 0
buffer_load_dwordx4 v24,s[4:7],s61 offen lds
s_add_u32 m0,s74,5120
s_nop 0
buffer_load_dwordx4 v25,s[4:7],s61 offen lds
s_add_u32 m0,s74,6144
s_nop 0
buffer_load_dwordx4 v26,s[4:7],s61 offen lds
s_add_u32 m0,s74,7168
s_nop 0
buffer_load_dwordx4 v27,s[4:7],s61 offen lds
s_add_u32 m0,s74,8192
s_nop 0
buffer_load_dwordx4 v28,s[4:7],s61 offen lds
s_add_u32 m0,s74,9216
s_nop 0
buffer_load_dwordx4 v29,s[4:7],s61 offen lds
s_add_u32 s61,s73,81920
s_add_u32 m0,s74,10240
s_nop 0
buffer_load_dwordx4 v20,s[4:7],s61 offen lds
s_add_u32 m0,s74,11264
s_nop 0
buffer_load_dwordx4 v21,s[4:7],s61 offen lds
s_add_u32 m0,s74,12288
s_nop 0
buffer_load_dwordx4 v22,s[4:7],s61 offen lds
s_add_u32 m0,s74,13312
s_nop 0
buffer_load_dwordx4 v23,s[4:7],s61 offen lds
s_add_u32 m0,s74,14336
s_nop 0
buffer_load_dwordx4 v24,s[4:7],s61 offen lds
s_add_u32 m0,s74,15360
s_nop 0
buffer_load_dwordx4 v25,s[4:7],s61 offen lds
s_add_u32 m0,s74,16384
s_nop 0
buffer_load_dwordx4 v26,s[4:7],s61 offen lds
s_add_u32 m0,s74,17408
s_nop 0
buffer_load_dwordx4 v27,s[4:7],s61 offen lds
s_add_u32 m0,s74,18432
s_nop 0
buffer_load_dwordx4 v28,s[4:7],s61 offen lds
s_add_u32 m0,s74,19456
s_nop 0
buffer_load_dwordx4 v29,s[4:7],s61 offen lds
s_add_u32 s61,s73,163840
s_add_u32 m0,s74,20480
s_nop 0
buffer_load_dwordx4 v20,s[4:7],s61 offen lds
s_add_u32 m0,s74,21504
s_nop 0
buffer_load_dwordx4 v21,s[4:7],s61 offen lds
s_add_u32 m0,s74,22528
s_nop 0
buffer_load_dwordx4 v22,s[4:7],s61 offen lds
s_add_u32 m0,s74,23552
s_nop 0
buffer_load_dwordx4 v23,s[4:7],s61 offen lds
s_add_u32 m0,s74,24576
s_nop 0
buffer_load_dwordx4 v24,s[4:7],s61 offen lds
s_add_u32 m0,s74,25600
s_nop 0
buffer_load_dwordx4 v25,s[4:7],s61 offen lds
s_add_u32 m0,s74,26624
s_nop 0
buffer_load_dwordx4 v26,s[4:7],s61 offen lds
s_add_u32 m0,s74,27648
s_nop 0
buffer_load_dwordx4 v27,s[4:7],s61 offen lds
s_add_u32 m0,s74,28672
s_nop 0
buffer_load_dwordx4 v28,s[4:7],s61 offen lds
s_add_u32 m0,s74,29696
s_nop 0
buffer_load_dwordx4 v29,s[4:7],s61 offen lds
s_add_u32 s61,s73,245760
s_add_u32 m0,s74,30720
s_nop 0
buffer_load_dwordx4 v20,s[4:7],s61 offen lds
s_add_u32 m0,s74,31744
s_nop 0
buffer_load_dwordx4 v21,s[4:7],s61 offen lds
s_add_u32 m0,s74,32768
s_nop 0
buffer_load_dwordx4 v22,s[4:7],s61 offen lds
s_add_u32 m0,s74,33792
s_nop 0
buffer_load_dwordx4 v23,s[4:7],s61 offen lds
s_add_u32 m0,s74,34816
s_nop 0
buffer_load_dwordx4 v24,s[4:7],s61 offen lds
s_add_u32 m0,s74,35840
s_nop 0
buffer_load_dwordx4 v25,s[4:7],s61 offen lds
s_add_u32 m0,s74,36864
s_nop 0
buffer_load_dwordx4 v26,s[4:7],s61 offen lds
s_add_u32 m0,s74,37888
s_nop 0
buffer_load_dwordx4 v27,s[4:7],s61 offen lds
s_add_u32 m0,s74,38912
s_nop 0
buffer_load_dwordx4 v28,s[4:7],s61 offen lds
s_add_u32 m0,s74,39936
s_nop 0
buffer_load_dwordx4 v29,s[4:7],s61 offen lds
s_waitcnt vmcnt(30)
ds_read_b64_tr_b16 a[0:1],v30 offset:0
ds_read_b64_tr_b16 a[2:3],v30 offset:320
ds_read_b64_tr_b16 a[4:5],v30 offset:1280
ds_read_b64_tr_b16 a[6:7],v30 offset:1600
ds_read_b64_tr_b16 a[8:9],v30 offset:32
ds_read_b64_tr_b16 a[10:11],v30 offset:352
ds_read_b64_tr_b16 a[12:13],v30 offset:1312
ds_read_b64_tr_b16 a[14:15],v30 offset:1632
ds_read_b64_tr_b16 a[16:17],v30 offset:64
ds_read_b64_tr_b16 a[18:19],v30 offset:384
ds_read_b64_tr_b16 a[20:21],v30 offset:1344
ds_read_b64_tr_b16 a[22:23],v30 offset:1664
s_waitcnt lgkmcnt(4)
ds_read_b64_tr_b16 a[24:25],v30 offset:96
ds_read_b64_tr_b16 a[26:27],v30 offset:416
ds_read_b64_tr_b16 a[28:29],v30 offset:1376
ds_read_b64_tr_b16 a[30:31],v30 offset:1696
ds_read_b64_tr_b16 v[32:33],v30 offset:128
ds_read_b64_tr_b16 v[34:35],v30 offset:448
ds_read_b64_tr_b16 v[36:37],v30 offset:1408
ds_read_b64_tr_b16 v[38:39],v30 offset:1728
s_waitcnt lgkmcnt(0)
s_add_u32 s61,s73,327680
s_add_u32 m0,s74,0
s_nop 0
buffer_load_dwordx4 v20,s[4:7],s61 offen lds
s_add_u32 m0,s74,1024
s_nop 0
buffer_load_dwordx4 v21,s[4:7],s61 offen lds
s_add_u32 m0,s74,2048
s_nop 0
buffer_load_dwordx4 v22,s[4:7],s61 offen lds
s_add_u32 m0,s74,3072
s_nop 0
buffer_load_dwordx4 v23,s[4:7],s61 offen lds
s_add_u32 m0,s74,4096
s_nop 0
buffer_load_dwordx4 v24,s[4:7],s61 offen lds
s_add_u32 m0,s74,5120
s_nop 0
buffer_load_dwordx4 v25,s[4:7],s61 offen lds
s_add_u32 m0,s74,6144
s_nop 0
buffer_load_dwordx4 v26,s[4:7],s61 offen lds
s_add_u32 m0,s74,7168
s_nop 0
buffer_load_dwordx4 v27,s[4:7],s61 offen lds
s_add_u32 m0,s74,8192
s_nop 0
buffer_load_dwordx4 v28,s[4:7],s61 offen lds
s_add_u32 m0,s74,9216
s_nop 0
buffer_load_dwordx4 v29,s[4:7],s61 offen lds
s_waitcnt vmcnt(30)
ds_read_b64_tr_b16 a[32:33],v30 offset:10240
ds_read_b64_tr_b16 a[34:35],v30 offset:10560
ds_read_b64_tr_b16 a[36:37],v30 offset:11520
ds_read_b64_tr_b16 a[38:39],v30 offset:11840
ds_read_b64_tr_b16 a[40:41],v30 offset:10272
ds_read_b64_tr_b16 a[42:43],v30 offset:10592
ds_read_b64_tr_b16 a[44:45],v30 offset:11552
ds_read_b64_tr_b16 a[46:47],v30 offset:11872
ds_read_b64_tr_b16 a[48:49],v30 offset:10304
ds_read_b64_tr_b16 a[50:51],v30 offset:10624
ds_read_b64_tr_b16 a[52:53],v30 offset:11584
ds_read_b64_tr_b16 a[54:55],v30 offset:11904
s_waitcnt lgkmcnt(4)
ds_read_b64_tr_b16 a[56:57],v30 offset:10336
ds_read_b64_tr_b16 a[58:59],v30 offset:10656
ds_read_b64_tr_b16 a[60:61],v30 offset:11616
ds_read_b64_tr_b16 a[62:63],v30 offset:11936
ds_read_b64_tr_b16 v[40:41],v30 offset:10368
ds_read_b64_tr_b16 v[42:43],v30 offset:10688
ds_read_b64_tr_b16 v[44:45],v30 offset:11648
ds_read_b64_tr_b16 v[46:47],v30 offset:11968
s_waitcnt lgkmcnt(0)
s_add_u32 s61,s73,409600
s_add_u32 m0,s74,10240
s_nop 0
buffer_load_dwordx4 v20,s[4:7],s61 offen lds
s_add_u32 m0,s74,11264
s_nop 0
buffer_load_dwordx4 v21,s[4:7],s61 offen lds
s_add_u32 m0,s74,12288
s_nop 0
buffer_load_dwordx4 v22,s[4:7],s61 offen lds
s_add_u32 m0,s74,13312
s_nop 0
buffer_load_dwordx4 v23,s[4:7],s61 offen lds
s_add_u32 m0,s74,14336
s_nop 0
buffer_load_dwordx4 v24,s[4:7],s61 offen lds
s_add_u32 m0,s74,15360
s_nop 0
buffer_load_dwordx4 v25,s[4:7],s61 offen lds
s_add_u32 m0,s74,16384
s_nop 0
buffer_load_dwordx4 v26,s[4:7],s61 offen lds
s_add_u32 m0,s74,17408
s_nop 0
buffer_load_dwordx4 v27,s[4:7],s61 offen lds
s_add_u32 m0,s74,18432
s_nop 0
buffer_load_dwordx4 v28,s[4:7],s61 offen lds
s_add_u32 m0,s74,19456
s_nop 0
buffer_load_dwordx4 v29,s[4:7],s61 offen lds
s_waitcnt vmcnt(30)
ds_read_b64_tr_b16 a[64:65],v30 offset:20480
ds_read_b64_tr_b16 a[66:67],v30 offset:20800
ds_read_b64_tr_b16 a[68:69],v30 offset:21760
ds_read_b64_tr_b16 a[70:71],v30 offset:22080
ds_read_b64_tr_b16 a[72:73],v30 offset:20512
ds_read_b64_tr_b16 a[74:75],v30 offset:20832
ds_read_b64_tr_b16 a[76:77],v30 offset:21792
ds_read_b64_tr_b16 a[78:79],v30 offset:22112
ds_read_b64_tr_b16 a[80:81],v30 offset:20544
ds_read_b64_tr_b16 a[82:83],v30 offset:20864
ds_read_b64_tr_b16 a[84:85],v30 offset:21824
ds_read_b64_tr_b16 a[86:87],v30 offset:22144
s_waitcnt lgkmcnt(4)
ds_read_b64_tr_b16 a[88:89],v30 offset:20576
ds_read_b64_tr_b16 a[90:91],v30 offset:20896
ds_read_b64_tr_b16 a[92:93],v30 offset:21856
ds_read_b64_tr_b16 a[94:95],v30 offset:22176
ds_read_b64_tr_b16 v[48:49],v30 offset:20608
ds_read_b64_tr_b16 v[50:51],v30 offset:20928
ds_read_b64_tr_b16 v[52:53],v30 offset:21888
ds_read_b64_tr_b16 v[54:55],v30 offset:22208
s_waitcnt lgkmcnt(0)
s_add_u32 s61,s73,491520
s_add_u32 m0,s74,20480
s_nop 0
buffer_load_dwordx4 v20,s[4:7],s61 offen lds
s_add_u32 m0,s74,21504
s_nop 0
buffer_load_dwordx4 v21,s[4:7],s61 offen lds
s_add_u32 m0,s74,22528
s_nop 0
buffer_load_dwordx4 v22,s[4:7],s61 offen lds
s_add_u32 m0,s74,23552
s_nop 0
buffer_load_dwordx4 v23,s[4:7],s61 offen lds
s_add_u32 m0,s74,24576
s_nop 0
buffer_load_dwordx4 v24,s[4:7],s61 offen lds
s_add_u32 m0,s74,25600
s_nop 0
buffer_load_dwordx4 v25,s[4:7],s61 offen lds
s_add_u32 m0,s74,26624
s_nop 0
buffer_load_dwordx4 v26,s[4:7],s61 offen lds
s_add_u32 m0,s74,27648
s_nop 0
buffer_load_dwordx4 v27,s[4:7],s61 offen lds
s_add_u32 m0,s74,28672
s_nop 0
buffer_load_dwordx4 v28,s[4:7],s61 offen lds
s_add_u32 m0,s74,29696
s_nop 0
buffer_load_dwordx4 v29,s[4:7],s61 offen lds
s_waitcnt vmcnt(30)
ds_read_b64_tr_b16 a[96:97],v30 offset:30720
ds_read_b64_tr_b16 a[98:99],v30 offset:31040
ds_read_b64_tr_b16 a[100:101],v30 offset:32000
ds_read_b64_tr_b16 a[102:103],v30 offset:32320
ds_read_b64_tr_b16 a[104:105],v30 offset:30752
ds_read_b64_tr_b16 a[106:107],v30 offset:31072
ds_read_b64_tr_b16 a[108:109],v30 offset:32032
ds_read_b64_tr_b16 a[110:111],v30 offset:32352
ds_read_b64_tr_b16 a[112:113],v30 offset:30784
ds_read_b64_tr_b16 a[114:115],v30 offset:31104
ds_read_b64_tr_b16 a[116:117],v30 offset:32064
ds_read_b64_tr_b16 a[118:119],v30 offset:32384
s_waitcnt lgkmcnt(4)
ds_read_b64_tr_b16 a[120:121],v30 offset:30816
ds_read_b64_tr_b16 a[122:123],v30 offset:31136
ds_read_b64_tr_b16 a[124:125],v30 offset:32096
ds_read_b64_tr_b16 a[126:127],v30 offset:32416
ds_read_b64_tr_b16 v[56:57],v30 offset:30848
ds_read_b64_tr_b16 v[58:59],v30 offset:31168
ds_read_b64_tr_b16 v[60:61],v30 offset:32128
ds_read_b64_tr_b16 v[62:63],v30 offset:32448
s_waitcnt lgkmcnt(0)
s_add_u32 s61,s73,573440
s_add_u32 m0,s74,30720
s_nop 0
buffer_load_dwordx4 v20,s[4:7],s61 offen lds
s_add_u32 m0,s74,31744
s_nop 0
buffer_load_dwordx4 v21,s[4:7],s61 offen lds
s_add_u32 m0,s74,32768
s_nop 0
buffer_load_dwordx4 v22,s[4:7],s61 offen lds
s_add_u32 m0,s74,33792
s_nop 0
buffer_load_dwordx4 v23,s[4:7],s61 offen lds
s_add_u32 m0,s74,34816
s_nop 0
buffer_load_dwordx4 v24,s[4:7],s61 offen lds
s_add_u32 m0,s74,35840
s_nop 0
buffer_load_dwordx4 v25,s[4:7],s61 offen lds
s_add_u32 m0,s74,36864
s_nop 0
buffer_load_dwordx4 v26,s[4:7],s61 offen lds
s_add_u32 m0,s74,37888
s_nop 0
buffer_load_dwordx4 v27,s[4:7],s61 offen lds
s_add_u32 m0,s74,38912
s_nop 0
buffer_load_dwordx4 v28,s[4:7],s61 offen lds
s_add_u32 m0,s74,39936
s_nop 0
buffer_load_dwordx4 v29,s[4:7],s61 offen lds
s_waitcnt vmcnt(30)
ds_read_b64_tr_b16 a[128:129],v30 offset:0
ds_read_b64_tr_b16 a[130:131],v30 offset:320
ds_read_b64_tr_b16 a[132:133],v30 offset:1280
ds_read_b64_tr_b16 a[134:135],v30 offset:1600
ds_read_b64_tr_b16 a[136:137],v30 offset:32
ds_read_b64_tr_b16 a[138:139],v30 offset:352
ds_read_b64_tr_b16 a[140:141],v30 offset:1312
ds_read_b64_tr_b16 a[142:143],v30 offset:1632
ds_read_b64_tr_b16 a[144:145],v30 offset:64
ds_read_b64_tr_b16 a[146:147],v30 offset:384
ds_read_b64_tr_b16 a[148:149],v30 offset:1344
ds_read_b64_tr_b16 a[150:151],v30 offset:1664
s_waitcnt lgkmcnt(4)
ds_read_b64_tr_b16 a[152:153],v30 offset:96
ds_read_b64_tr_b16 a[154:155],v30 offset:416
ds_read_b64_tr_b16 a[156:157],v30 offset:1376
ds_read_b64_tr_b16 a[158:159],v30 offset:1696
ds_read_b64_tr_b16 v[64:65],v30 offset:128
ds_read_b64_tr_b16 v[66:67],v30 offset:448
ds_read_b64_tr_b16 v[68:69],v30 offset:1408
ds_read_b64_tr_b16 v[70:71],v30 offset:1728
s_waitcnt lgkmcnt(0)
s_add_u32 s61,s73,655360
s_add_u32 m0,s74,0
s_nop 0
buffer_load_dwordx4 v20,s[4:7],s61 offen lds
s_add_u32 m0,s74,1024
s_nop 0
buffer_load_dwordx4 v21,s[4:7],s61 offen lds
s_add_u32 m0,s74,2048
s_nop 0
buffer_load_dwordx4 v22,s[4:7],s61 offen lds
s_add_u32 m0,s74,3072
s_nop 0
buffer_load_dwordx4 v23,s[4:7],s61 offen lds
s_add_u32 m0,s74,4096
s_nop 0
buffer_load_dwordx4 v24,s[4:7],s61 offen lds
s_add_u32 m0,s74,5120
s_nop 0
buffer_load_dwordx4 v25,s[4:7],s61 offen lds
s_add_u32 m0,s74,6144
s_nop 0
buffer_load_dwordx4 v26,s[4:7],s61 offen lds
s_add_u32 m0,s74,7168
s_nop 0
buffer_load_dwordx4 v27,s[4:7],s61 offen lds
s_add_u32 m0,s74,8192
s_nop 0
buffer_load_dwordx4 v28,s[4:7],s61 offen lds
s_add_u32 m0,s74,9216
s_nop 0
buffer_load_dwordx4 v29,s[4:7],s61 offen lds
s_waitcnt vmcnt(30)
ds_read_b64_tr_b16 a[160:161],v30 offset:10240
ds_read_b64_tr_b16 a[162:163],v30 offset:10560
ds_read_b64_tr_b16 a[164:165],v30 offset:11520
ds_read_b64_tr_b16 a[166:167],v30 offset:11840
ds_read_b64_tr_b16 a[168:169],v30 offset:10272
ds_read_b64_tr_b16 a[170:171],v30 offset:10592
ds_read_b64_tr_b16 a[172:173],v30 offset:11552
ds_read_b64_tr_b16 a[174:175],v30 offset:11872
ds_read_b64_tr_b16 a[176:177],v30 offset:10304
ds_read_b64_tr_b16 a[178:179],v30 offset:10624
ds_read_b64_tr_b16 a[180:181],v30 offset:11584
ds_read_b64_tr_b16 a[182:183],v30 offset:11904
s_waitcnt lgkmcnt(4)
ds_read_b64_tr_b16 a[184:185],v30 offset:10336
ds_read_b64_tr_b16 a[186:187],v30 offset:10656
ds_read_b64_tr_b16 a[188:189],v30 offset:11616
ds_read_b64_tr_b16 a[190:191],v30 offset:11936
ds_read_b64_tr_b16 v[72:73],v30 offset:10368
ds_read_b64_tr_b16 v[74:75],v30 offset:10688
ds_read_b64_tr_b16 v[76:77],v30 offset:11648
ds_read_b64_tr_b16 v[78:79],v30 offset:11968
s_waitcnt lgkmcnt(0)
s_add_u32 s61,s73,737280
s_add_u32 m0,s74,10240
s_nop 0
buffer_load_dwordx4 v20,s[4:7],s61 offen lds
s_add_u32 m0,s74,11264
s_nop 0
buffer_load_dwordx4 v21,s[4:7],s61 offen lds
s_add_u32 m0,s74,12288
s_nop 0
buffer_load_dwordx4 v22,s[4:7],s61 offen lds
s_add_u32 m0,s74,13312
s_nop 0
buffer_load_dwordx4 v23,s[4:7],s61 offen lds
s_add_u32 m0,s74,14336
s_nop 0
buffer_load_dwordx4 v24,s[4:7],s61 offen lds
s_add_u32 m0,s74,15360
s_nop 0
buffer_load_dwordx4 v25,s[4:7],s61 offen lds
s_add_u32 m0,s74,16384
s_nop 0
buffer_load_dwordx4 v26,s[4:7],s61 offen lds
s_add_u32 m0,s74,17408
s_nop 0
buffer_load_dwordx4 v27,s[4:7],s61 offen lds
s_add_u32 m0,s74,18432
s_nop 0
buffer_load_dwordx4 v28,s[4:7],s61 offen lds
s_add_u32 m0,s74,19456
s_nop 0
buffer_load_dwordx4 v29,s[4:7],s61 offen lds
s_waitcnt vmcnt(30)
ds_read_b64_tr_b16 a[192:193],v30 offset:20480
ds_read_b64_tr_b16 a[194:195],v30 offset:20800
ds_read_b64_tr_b16 a[196:197],v30 offset:21760
ds_read_b64_tr_b16 a[198:199],v30 offset:22080
ds_read_b64_tr_b16 a[200:201],v30 offset:20512
ds_read_b64_tr_b16 a[202:203],v30 offset:20832
ds_read_b64_tr_b16 a[204:205],v30 offset:21792
ds_read_b64_tr_b16 a[206:207],v30 offset:22112
ds_read_b64_tr_b16 a[208:209],v30 offset:20544
ds_read_b64_tr_b16 a[210:211],v30 offset:20864
ds_read_b64_tr_b16 a[212:213],v30 offset:21824
ds_read_b64_tr_b16 a[214:215],v30 offset:22144
s_waitcnt lgkmcnt(4)
ds_read_b64_tr_b16 a[216:217],v30 offset:20576
ds_read_b64_tr_b16 a[218:219],v30 offset:20896
ds_read_b64_tr_b16 a[220:221],v30 offset:21856
ds_read_b64_tr_b16 a[222:223],v30 offset:22176
ds_read_b64_tr_b16 v[80:81],v30 offset:20608
ds_read_b64_tr_b16 v[82:83],v30 offset:20928
ds_read_b64_tr_b16 v[84:85],v30 offset:21888
ds_read_b64_tr_b16 v[86:87],v30 offset:22208
s_waitcnt lgkmcnt(0)
s_add_u32 s61,s73,819200
s_add_u32 m0,s74,20480
s_nop 0
buffer_load_dwordx4 v20,s[4:7],s61 offen lds
s_add_u32 m0,s74,21504
s_nop 0
buffer_load_dwordx4 v21,s[4:7],s61 offen lds
s_add_u32 m0,s74,22528
s_nop 0
buffer_load_dwordx4 v22,s[4:7],s61 offen lds
s_add_u32 m0,s74,23552
s_nop 0
buffer_load_dwordx4 v23,s[4:7],s61 offen lds
s_add_u32 m0,s74,24576
s_nop 0
buffer_load_dwordx4 v24,s[4:7],s61 offen lds
s_add_u32 m0,s74,25600
s_nop 0
buffer_load_dwordx4 v25,s[4:7],s61 offen lds
s_add_u32 m0,s74,26624
s_nop 0
buffer_load_dwordx4 v26,s[4:7],s61 offen lds
s_add_u32 m0,s74,27648
s_nop 0
buffer_load_dwordx4 v27,s[4:7],s61 offen lds
s_add_u32 m0,s74,28672
s_nop 0
buffer_load_dwordx4 v28,s[4:7],s61 offen lds
s_add_u32 m0,s74,29696
s_nop 0
buffer_load_dwordx4 v29,s[4:7],s61 offen lds
s_waitcnt vmcnt(30)
ds_read_b64_tr_b16 a[224:225],v30 offset:30720
ds_read_b64_tr_b16 a[226:227],v30 offset:31040
ds_read_b64_tr_b16 a[228:229],v30 offset:32000
ds_read_b64_tr_b16 a[230:231],v30 offset:32320
ds_read_b64_tr_b16 a[232:233],v30 offset:30752
ds_read_b64_tr_b16 a[234:235],v30 offset:31072
ds_read_b64_tr_b16 a[236:237],v30 offset:32032
ds_read_b64_tr_b16 a[238:239],v30 offset:32352
ds_read_b64_tr_b16 a[240:241],v30 offset:30784
ds_read_b64_tr_b16 a[242:243],v30 offset:31104
ds_read_b64_tr_b16 a[244:245],v30 offset:32064
ds_read_b64_tr_b16 a[246:247],v30 offset:32384
s_waitcnt lgkmcnt(4)
ds_read_b64_tr_b16 a[248:249],v30 offset:30816
ds_read_b64_tr_b16 a[250:251],v30 offset:31136
ds_read_b64_tr_b16 a[252:253],v30 offset:32096
ds_read_b64_tr_b16 a[254:255],v30 offset:32416
ds_read_b64_tr_b16 v[88:89],v30 offset:30848
ds_read_b64_tr_b16 v[90:91],v30 offset:31168
ds_read_b64_tr_b16 v[92:93],v30 offset:32128
ds_read_b64_tr_b16 v[94:95],v30 offset:32448
s_waitcnt lgkmcnt(0)
s_add_u32 s61,s73,901120
s_add_u32 m0,s74,30720
s_nop 0
buffer_load_dwordx4 v20,s[4:7],s61 offen lds
s_add_u32 m0,s74,31744
s_nop 0
buffer_load_dwordx4 v21,s[4:7],s61 offen lds
s_add_u32 m0,s74,32768
s_nop 0
buffer_load_dwordx4 v22,s[4:7],s61 offen lds
s_add_u32 m0,s74,33792
s_nop 0
buffer_load_dwordx4 v23,s[4:7],s61 offen lds
s_add_u32 m0,s74,34816
s_nop 0
buffer_load_dwordx4 v24,s[4:7],s61 offen lds
s_add_u32 m0,s74,35840
s_nop 0
buffer_load_dwordx4 v25,s[4:7],s61 offen lds
s_add_u32 m0,s74,36864
s_nop 0
buffer_load_dwordx4 v26,s[4:7],s61 offen lds
s_add_u32 m0,s74,37888
s_nop 0
buffer_load_dwordx4 v27,s[4:7],s61 offen lds
s_add_u32 m0,s74,38912
s_nop 0
buffer_load_dwordx4 v28,s[4:7],s61 offen lds
s_add_u32 m0,s74,39936
s_nop 0
buffer_load_dwordx4 v29,s[4:7],s61 offen lds
s_waitcnt vmcnt(30)
ds_read_b64_tr_b16 v[128:129],v30 offset:0
ds_read_b64_tr_b16 v[130:131],v30 offset:320
ds_read_b64_tr_b16 v[132:133],v30 offset:1280
ds_read_b64_tr_b16 v[134:135],v30 offset:1600
ds_read_b64_tr_b16 v[136:137],v30 offset:32
ds_read_b64_tr_b16 v[138:139],v30 offset:352
ds_read_b64_tr_b16 v[140:141],v30 offset:1312
ds_read_b64_tr_b16 v[142:143],v30 offset:1632
ds_read_b64_tr_b16 v[144:145],v30 offset:64
ds_read_b64_tr_b16 v[146:147],v30 offset:384
ds_read_b64_tr_b16 v[148:149],v30 offset:1344
ds_read_b64_tr_b16 v[150:151],v30 offset:1664
s_waitcnt lgkmcnt(4)
ds_read_b64_tr_b16 v[152:153],v30 offset:96
ds_read_b64_tr_b16 v[154:155],v30 offset:416
ds_read_b64_tr_b16 v[156:157],v30 offset:1376
ds_read_b64_tr_b16 v[158:159],v30 offset:1696
ds_read_b64_tr_b16 v[96:97],v30 offset:128
ds_read_b64_tr_b16 v[98:99],v30 offset:448
ds_read_b64_tr_b16 v[100:101],v30 offset:1408
ds_read_b64_tr_b16 v[102:103],v30 offset:1728
s_waitcnt lgkmcnt(0)
s_waitcnt vmcnt(20)
ds_read_b64_tr_b16 v[160:161],v30 offset:10240
ds_read_b64_tr_b16 v[162:163],v30 offset:10560
ds_read_b64_tr_b16 v[164:165],v30 offset:11520
ds_read_b64_tr_b16 v[166:167],v30 offset:11840
ds_read_b64_tr_b16 v[168:169],v30 offset:10272
ds_read_b64_tr_b16 v[170:171],v30 offset:10592
ds_read_b64_tr_b16 v[172:173],v30 offset:11552
ds_read_b64_tr_b16 v[174:175],v30 offset:11872
ds_read_b64_tr_b16 v[176:177],v30 offset:10304
ds_read_b64_tr_b16 v[178:179],v30 offset:10624
ds_read_b64_tr_b16 v[180:181],v30 offset:11584
ds_read_b64_tr_b16 v[182:183],v30 offset:11904
s_waitcnt lgkmcnt(4)
ds_read_b64_tr_b16 v[184:185],v30 offset:10336
ds_read_b64_tr_b16 v[186:187],v30 offset:10656
ds_read_b64_tr_b16 v[188:189],v30 offset:11616
ds_read_b64_tr_b16 v[190:191],v30 offset:11936
ds_read_b64_tr_b16 v[104:105],v30 offset:10368
ds_read_b64_tr_b16 v[106:107],v30 offset:10688
ds_read_b64_tr_b16 v[108:109],v30 offset:11648
ds_read_b64_tr_b16 v[110:111],v30 offset:11968
s_waitcnt lgkmcnt(0)
s_waitcnt vmcnt(10)
ds_read_b64_tr_b16 v[192:193],v30 offset:20480
ds_read_b64_tr_b16 v[194:195],v30 offset:20800
ds_read_b64_tr_b16 v[196:197],v30 offset:21760
ds_read_b64_tr_b16 v[198:199],v30 offset:22080
ds_read_b64_tr_b16 v[200:201],v30 offset:20512
ds_read_b64_tr_b16 v[202:203],v30 offset:20832
ds_read_b64_tr_b16 v[204:205],v30 offset:21792
ds_read_b64_tr_b16 v[206:207],v30 offset:22112
ds_read_b64_tr_b16 v[208:209],v30 offset:20544
ds_read_b64_tr_b16 v[210:211],v30 offset:20864
ds_read_b64_tr_b16 v[212:213],v30 offset:21824
ds_read_b64_tr_b16 v[214:215],v30 offset:22144
s_waitcnt lgkmcnt(4)
ds_read_b64_tr_b16 v[216:217],v30 offset:20576
ds_read_b64_tr_b16 v[218:219],v30 offset:20896
ds_read_b64_tr_b16 v[220:221],v30 offset:21856
ds_read_b64_tr_b16 v[222:223],v30 offset:22176
ds_read_b64_tr_b16 v[112:113],v30 offset:20608
ds_read_b64_tr_b16 v[114:115],v30 offset:20928
ds_read_b64_tr_b16 v[116:117],v30 offset:21888
ds_read_b64_tr_b16 v[118:119],v30 offset:22208
s_waitcnt lgkmcnt(0)
s_waitcnt vmcnt(0)
ds_read_b64_tr_b16 v[224:225],v30 offset:30720
ds_read_b64_tr_b16 v[226:227],v30 offset:31040
ds_read_b64_tr_b16 v[228:229],v30 offset:32000
ds_read_b64_tr_b16 v[230:231],v30 offset:32320
ds_read_b64_tr_b16 v[232:233],v30 offset:30752
ds_read_b64_tr_b16 v[234:235],v30 offset:31072
ds_read_b64_tr_b16 v[236:237],v30 offset:32032
ds_read_b64_tr_b16 v[238:239],v30 offset:32352
ds_read_b64_tr_b16 v[240:241],v30 offset:30784
ds_read_b64_tr_b16 v[242:243],v30 offset:31104
ds_read_b64_tr_b16 v[244:245],v30 offset:32064
ds_read_b64_tr_b16 v[246:247],v30 offset:32384
s_waitcnt lgkmcnt(4)
ds_read_b64_tr_b16 v[248:249],v30 offset:30816
ds_read_b64_tr_b16 v[250:251],v30 offset:31136
ds_read_b64_tr_b16 v[252:253],v30 offset:32096
ds_read_b64_tr_b16 v[254:255],v30 offset:32416
ds_read_b64_tr_b16 v[120:121],v30 offset:30848
ds_read_b64_tr_b16 v[122:123],v30 offset:31168
ds_read_b64_tr_b16 v[124:125],v30 offset:32128
ds_read_b64_tr_b16 v[126:127],v30 offset:32448
s_waitcnt lgkmcnt(0)
s_barrier
ds_write_b128 v4,v[32:35] offset:0
ds_write_b128 v4,v[36:39] offset:1024
ds_write_b128 v4,v[40:43] offset:2048
ds_write_b128 v4,v[44:47] offset:3072
ds_write_b128 v4,v[48:51] offset:4096
ds_write_b128 v4,v[52:55] offset:5120
ds_write_b128 v4,v[56:59] offset:6144
ds_write_b128 v4,v[60:63] offset:7168
s_waitcnt lgkmcnt(0)
ds_write_b128 v4,v[64:67] offset:8192
ds_write_b128 v4,v[68:71] offset:9216
ds_write_b128 v4,v[72:75] offset:10240
ds_write_b128 v4,v[76:79] offset:11264
ds_write_b128 v4,v[80:83] offset:12288
ds_write_b128 v4,v[84:87] offset:13312
ds_write_b128 v4,v[88:91] offset:14336
ds_write_b128 v4,v[92:95] offset:15360
s_waitcnt lgkmcnt(0)
ds_write_b128 v4,v[96:99] offset:16384
ds_write_b128 v4,v[100:103] offset:17408
ds_write_b128 v4,v[104:107] offset:18432
ds_write_b128 v4,v[108:111] offset:19456
ds_write_b128 v4,v[112:115] offset:20480
ds_write_b128 v4,v[116:119] offset:21504
ds_write_b128 v4,v[120:123] offset:22528
ds_write_b128 v4,v[124:127] offset:23552
s_waitcnt lgkmcnt(0)
s_barrier
s_lshl_b32 s3,s49,2
v_mov_b32 v13,s3
s_nop 1
ibw_163:
buffer_load_dword v12,v13,s[12:15],0 offen sc1
s_waitcnt vmcnt(0)
v_cmp_ne_u32 vcc,256,v12
s_nop 0
s_cbranch_vccz ok_164
s_sleep 8
s_sub_u32 s47,s47,1
s_cbranch_scc1 ABORT
s_branch ibw_163
ok_164:
s_cmp_lg_u32 s49,0
s_cbranch_scc1 ibok_165
v_and_b32 v13,7,v0
v_lshlrev_b32 v13,2,v13
buffer_load_dword v12,v13,s[12:15],0 offen offset:32 sc1
s_waitcnt vmcnt(0)
v_cmp_ne_u32 vcc,32,v12
s_nop 0
s_cbranch_vccz ibok_165
s_barrier
s_mov_b32 s49,1
s_mov_b32 s3,s2
s_load_dwordx16 s[16:31],s[0:1],0
s_load_dwordx8 s[32:39],s[0:1],64
s_waitcnt lgkmcnt(0)
s_branch DISPATCH
ibok_165:
v_mov_b32 v13,192
s_cmp_lg_u32 s49,0
s_cbranch_scc1 vx_167
vw_166:
buffer_load_dword v12,v13,s[12:15],0 offen sc1
s_waitcnt vmcnt(0)
v_and_b32 v14,0xffff,v12
v_cmp_ne_u32 vcc,64,v14
s_nop 0
s_cbranch_vccz ok_168
s_sleep 4
s_sub_u32 s47,s47,1
s_cbranch_scc1 ABORT
s_branch vw_166
ok_168:
v_readfirstlane_b32 s60,v12
s_cmp_gt_u32 s60,2162688
s_cselect_b32 s60,0x2000,0
s_add_u32 s83,s83,s60
s_nop 1
vx_167:
s_mov_b32 s50,0
s_mov_b32 s77,0
ds_read_b128 v[20:23],v4 offset:12288
ds_read_b128 v[24:27],v4 offset:13312
ds_read_b128 v[116:119],v4 offset:22528
ds_read_b128 v[120:123],v4 offset:23552
s_waitcnt lgkmcnt(0)
s_cmp_lg_u32 s49,0
s_cbranch_scc1 CW_LOOP_S
CW_LOOP_F:
s_sub_u32 s60,s50,13
s_lshr_b32 s52,s60,1
s_and_b32 s51,s60,1
s_cmp_eq_u32 s51,0
s_cselect_b32 s61,13,0
s_add_u32 s52,s52,s61
s_sub_u32 s61,s60,51
s_cmp_ge_u32 s60,102
s_cselect_b32 s52,s61,s52
s_cselect_b32 s51,1,s51
s_cmp_lt_u32 s50,13
s_cselect_b32 s52,s50,s52
s_cselect_b32 s51,0,s51
s_cmp_eq_u32 s52,63
s_cbranch_scc1 CW_NEXT_F
s_add_u32 s58,s52,1
s_lshl_b32 s61,s51,9
s_add_u32 s72,s61,s35
s_add_u32 s69,s61,s85
s_lshl_b32 s61,s51,2
s_and_b32 s60,s52,1
s_add_u32 s60,s60,s61
s_mul_i32 s70,s60,49152
s_add_u32 s70,s70,s33
s_add_u32 s71,s70,4096
s_add_u32 s80,s70,8192
s_bfe_u32 s57,s52,65537
s_bfe_u32 s31,s58,65537
s_and_b32 s60,s58,1
s_add_u32 s60,s60,s61
s_mul_i32 s59,s60,20480
s_add_u32 s59,s59,s84
s_lshl_b32 s68,s60,16
s_add_u32 s68,s68,s83
s_xor_b32 s77,s77,11264
v_add_u32 v7,s77,v5
v_add_u32 v8,s77,v6
s_add_u32 s60,s52,2
v_mov_b32 v16,s60
ds_read_b128 v[100:103],v4 offset:0
ds_read_b128 v[104:107],v4 offset:1024
ds_read_b128 v[108:111],v4 offset:6144
ds_read_b128 v[112:115],v4 offset:7168
s_cmp_lg_u32 s46,0
s_cbranch_scc1 np_169
db_171:
buffer_load_dword v12,v3,s[8:11],s72 offen sc1
s_waitcnt vmcnt(0)
v_cmp_gt_u32 vcc,s58,v12
s_cbranch_vccz dbok_172
s_sub_u32 s47,s47,1
s_cbranch_scc1 ABORT
s_branch db_171
dbok_172:
np_169:
s_barrier
rd_170:
buffer_load_dwordx4 v[32:35],v1,s[8:11],s70 offen sc1
v_mov_b32 v80,0
v_mov_b32 v81,0
v_mov_b32 v82,0
v_mov_b32 v83,0
v_mov_b32 v84,0
buffer_load_dwordx4 v[36:39],v1,s[8:11],s70 offen offset:3072 sc1
v_mov_b32 v85,0
v_mov_b32 v86,0
v_mov_b32 v87,0
v_mov_b32 v88,0
v_mov_b32 v89,0
buffer_load_dwordx4 v[40:43],v1,s[8:11],s71 offen offset:2048 sc1
v_mov_b32 v90,0
v_mov_b32 v91,0
v_mov_b32 v92,0
v_mov_b32 v93,0
v_mov_b32 v94,0
buffer_load_dwordx4 v[44:47],v1,s[8:11],s80 offen offset:1024 sc1
v_mov_b32 v95,0
v_mov_b32 v96,0
v_mov_b32 v97,0
v_mov_b32 v98,0
v_mov_b32 v99,0
buffer_load_dwordx4 v[48:51],v1,s[8:11],s70 offen offset:1024 sc1
s_waitcnt vmcnt(4)
v_and_b32 v12,1,v32
v_cmp_ne_u32 vcc,s57,v12
s_cbranch_vccnz ws_173
wg_179:
v_smfmac_f32_16x16x64_bf16 v[80:83],v[32:35],a[0:7],v2
buffer_load_dwordx4 v[52:55],v1,s[8:11],s71 offen sc1
v_smfmac_f32_16x16x64_bf16 v[84:87],v[32:35],a[8:15],v2
s_waitcnt vmcnt(4)
v_and_b32 v12,1,v36
v_smfmac_f32_16x16x64_bf16 v[88:91],v[32:35],a[16:23],v2
v_cmp_ne_u32 vcc,s57,v12
v_smfmac_f32_16x16x64_bf16 v[92:95],v[32:35],a[24:31],v2
s_waitcnt lgkmcnt(2)
v_smfmac_f32_16x16x64_bf16 v[96:99],v[32:35],v[100:107],v2
s_cbranch_vccnz ws_174
wg_180:
v_smfmac_f32_16x16x64_bf16 v[80:83],v[36:39],a[96:103],v2
buffer_load_dwordx4 v[56:59],v1,s[8:11],s71 offen offset:3072 sc1
v_smfmac_f32_16x16x64_bf16 v[84:87],v[36:39],a[104:111],v2
s_waitcnt vmcnt(4)
v_and_b32 v12,1,v40
v_smfmac_f32_16x16x64_bf16 v[88:91],v[36:39],a[112:119],v2
v_cmp_ne_u32 vcc,s57,v12
v_smfmac_f32_16x16x64_bf16 v[92:95],v[36:39],a[120:127],v2
s_waitcnt lgkmcnt(0)
v_smfmac_f32_16x16x64_bf16 v[96:99],v[36:39],v[108:115],v2
s_cbranch_vccnz ws_175
wg_181:
v_smfmac_f32_16x16x64_bf16 v[80:83],v[40:43],a[192:199],v2
buffer_load_dwordx4 v[60:63],v1,s[8:11],s80 offen offset:2048 sc1
v_smfmac_f32_16x16x64_bf16 v[84:87],v[40:43],a[200:207],v2
s_waitcnt vmcnt(4)
v_and_b32 v12,1,v44
v_smfmac_f32_16x16x64_bf16 v[88:91],v[40:43],a[208:215],v2
v_cmp_ne_u32 vcc,s57,v12
ds_read_b128 v[100:103],v4 offset:18432
v_smfmac_f32_16x16x64_bf16 v[92:95],v[40:43],a[216:223],v2
ds_read_b128 v[104:107],v4 offset:19456
v_smfmac_f32_16x16x64_bf16 v[96:99],v[40:43],v[20:27],v2
s_cbranch_vccnz ws_176
wg_182:
v_smfmac_f32_16x16x64_bf16 v[80:83],v[44:47],v[160:167],v2
buffer_load_dwordx4 v[64:67],v1,s[8:11],s70 offen offset:2048 sc1
v_smfmac_f32_16x16x64_bf16 v[84:87],v[44:47],v[168:175],v2
s_waitcnt vmcnt(4)
v_and_b32 v12,1,v48
v_smfmac_f32_16x16x64_bf16 v[88:91],v[44:47],v[176:183],v2
v_cmp_ne_u32 vcc,s57,v12
ds_read_b128 v[108:111],v4 offset:2048
v_smfmac_f32_16x16x64_bf16 v[92:95],v[44:47],v[184:191],v2
ds_read_b128 v[112:115],v4 offset:3072
s_waitcnt lgkmcnt(2)
v_smfmac_f32_16x16x64_bf16 v[96:99],v[44:47],v[100:107],v2
s_cbranch_vccnz ws_177
wg_183:
v_smfmac_f32_16x16x64_bf16 v[80:83],v[48:51],a[32:39],v2
buffer_load_dwordx4 v[68:71],v1,s[8:11],s71 offen offset:1024 sc1
v_smfmac_f32_16x16x64_bf16 v[84:87],v[48:51],a[40:47],v2
s_waitcnt vmcnt(4)
v_and_b32 v12,1,v52
v_smfmac_f32_16x16x64_bf16 v[88:91],v[48:51],a[48:55],v2
v_cmp_ne_u32 vcc,s57,v12
ds_read_b128 v[100:103],v4 offset:8192
v_smfmac_f32_16x16x64_bf16 v[92:95],v[48:51],a[56:63],v2
ds_read_b128 v[104:107],v4 offset:9216
s_waitcnt lgkmcnt(2)
v_smfmac_f32_16x16x64_bf16 v[96:99],v[48:51],v[108:115],v2
s_cbranch_vccnz ws_178
wg_184:
v_smfmac_f32_16x16x64_bf16 v[80:83],v[52:55],a[128:135],v2
buffer_load_dwordx4 v[72:75],v1,s[8:11],s80 offen sc1
v_smfmac_f32_16x16x64_bf16 v[84:87],v[52:55],a[136:143],v2
ds_read_b128 v[108:111],v4 offset:14336
v_smfmac_f32_16x16x64_bf16 v[88:91],v[52:55],a[144:151],v2
ds_read_b128 v[112:115],v4 offset:15360
v_smfmac_f32_16x16x64_bf16 v[92:95],v[52:55],a[152:159],v2
s_waitcnt lgkmcnt(2)
v_smfmac_f32_16x16x64_bf16 v[96:99],v[52:55],v[100:107],v2
buffer_load_dwordx4 v[76:79],v1,s[8:11],s80 offen offset:3072 sc1
s_waitcnt vmcnt(5)
v_smfmac_f32_16x16x64_bf16 v[80:83],v[56:59],a[224:231],v2
ds_read_b128 v[100:103],v4 offset:20480
v_smfmac_f32_16x16x64_bf16 v[84:87],v[56:59],a[232:239],v2
ds_read_b128 v[104:107],v4 offset:21504
v_smfmac_f32_16x16x64_bf16 v[88:91],v[56:59],a[240:247],v2
v_smfmac_f32_16x16x64_bf16 v[92:95],v[56:59],a[248:255],v2
s_waitcnt lgkmcnt(2)
v_smfmac_f32_16x16x64_bf16 v[96:99],v[56:59],v[108:115],v2
s_waitcnt vmcnt(4)
v_smfmac_f32_16x16x64_bf16 v[80:83],v[60:63],v[192:199],v2
ds_read_b128 v[108:111],v4 offset:4096
v_bitop3_b32 v13,v56,v60,s57 bitop3:0x7e
v_smfmac_f32_16x16x64_bf16 v[84:87],v[60:63],v[200:207],v2
ds_read_b128 v[112:115],v4 offset:5120
v_smfmac_f32_16x16x64_bf16 v[88:91],v[60:63],v[208:215],v2
v_smfmac_f32_16x16x64_bf16 v[92:95],v[60:63],v[216:223],v2
s_waitcnt lgkmcnt(2)
v_smfmac_f32_16x16x64_bf16 v[96:99],v[60:63],v[100:107],v2
s_waitcnt vmcnt(3)
v_smfmac_f32_16x16x64_bf16 v[80:83],v[64:67],a[64:71],v2
ds_read_b128 v[100:103],v4 offset:10240
v_smfmac_f32_16x16x64_bf16 v[84:87],v[64:67],a[72:79],v2
ds_read_b128 v[104:107],v4 offset:11264
v_smfmac_f32_16x16x64_bf16 v[88:91],v[64:67],a[80:87],v2
v_smfmac_f32_16x16x64_bf16 v[92:95],v[64:67],a[88:95],v2
s_waitcnt lgkmcnt(2)
v_smfmac_f32_16x16x64_bf16 v[96:99],v[64:67],v[108:115],v2
s_waitcnt vmcnt(0)
v_smfmac_f32_16x16x64_bf16 v[80:83],v[68:71],a[160:167],v2
ds_read_b128 v[108:111],v4 offset:16384
v_bitop3_b32 v14,v64,v68,s57 bitop3:0x7e
v_smfmac_f32_16x16x64_bf16 v[80:83],v[72:75],v[128:135],v2
ds_read_b128 v[112:115],v4 offset:17408
v_or_b32 v13,v13,v14
v_smfmac_f32_16x16x64_bf16 v[80:83],v[76:79],v[224:231],v2
v_bitop3_b32 v14,v72,v76,s57 bitop3:0x7e
v_smfmac_f32_16x16x64_bf16 v[84:87],v[68:71],a[168:175],v2
v_or_b32 v13,v13,v14
v_smfmac_f32_16x16x64_bf16 v[84:87],v[72:75],v[136:143],v2
v_and_b32 v13,1,v13
v_smfmac_f32_16x16x64_bf16 v[84:87],v[76:79],v[232:239],v2
v_cmp_ne_u32 vcc,0,v13
v_smfmac_f32_16x16x64_bf16 v[88:91],v[68:71],a[176:183],v2
s_cbranch_vccnz rd_170x
v_smfmac_f32_16x16x64_bf16 v[88:91],v[72:75],v[144:151],v2
v_add_f32 v80,v80,v81
v_smfmac_f32_16x16x64_bf16 v[88:91],v[76:79],v[240:247],v2
v_add_f32 v82,v82,v83
ds_write2_b32 v7,v80,v82 offset0:0 offset1:88
v_smfmac_f32_16x16x64_bf16 v[92:95],v[68:71],a[184:191],v2
v_add_f32 v84,v84,v85
v_smfmac_f32_16x16x64_bf16 v[92:95],v[72:75],v[152:159],v2
v_add_f32 v86,v86,v87
ds_write2_b32 v7,v84,v86 offset0:16 offset1:104
v_smfmac_f32_16x16x64_bf16 v[92:95],v[76:79],v[248:255],v2
v_add_f32 v88,v88,v89
s_waitcnt lgkmcnt(4)
v_smfmac_f32_16x16x64_bf16 v[96:99],v[68:71],v[100:107],v2
v_add_f32 v90,v90,v91
s_waitcnt lgkmcnt(2)
v_smfmac_f32_16x16x64_bf16 v[96:99],v[72:75],v[108:115],v2
ds_write2_b32 v7,v88,v90 offset0:32 offset1:120
v_smfmac_f32_16x16x64_bf16 v[96:99],v[76:79],v[116:123],v2
v_add_f32 v92,v92,v93
v_add_f32 v94,v94,v95
ds_write2_b32 v7,v92,v94 offset0:48 offset1:136
s_nop 4
v_add_f32 v96,v96,v97
v_add_f32 v98,v98,v99
ds_write2_b32 v7,v96,v98 offset0:64 offset1:152
s_waitcnt lgkmcnt(0)
s_barrier
ds_read_b128 v[32:35],v8 offset:0
ds_read_b128 v[36:39],v8 offset:2816
ds_read_b128 v[40:43],v8 offset:5632
ds_read_b128 v[44:47],v8 offset:8448
s_mov_b64 exec,1
buffer_store_dword v16,v1,s[8:11],s69 offen
s_mov_b64 exec,-1
s_waitcnt lgkmcnt(2)
v_pk_add_f32 v[32:33],v[32:33],v[36:37]
v_pk_add_f32 v[34:35],v[34:35],v[38:39]
s_waitcnt lgkmcnt(0)
v_pk_add_f32 v[40:41],v[40:41],v[44:45]
v_pk_add_f32 v[42:43],v[42:43],v[46:47]
v_pk_add_f32 v[32:33],v[32:33],v[40:41]
v_pk_add_f32 v[34:35],v[34:35],v[42:43]
v_cvt_pk_bf16_f32 v32,v32,v33
v_cvt_pk_bf16_f32 v33,v34,v35
v_bfi_b32 v32,v10,s31,v32
s_nop 0
v_permlane32_swap_b32 v33,v35
v_permlane32_swap_b32 v32,v34
s_mov_b64 exec,s[88:89]
buffer_store_dwordx4 v[32:35],v9,s[8:11],s59 offen
s_barrier
buffer_store_dwordx4 v[32:35],v9,s[8:11],s68 offen sc1
s_mov_b64 exec,-1
s_nop 0
CW_NEXT_F:
s_add_u32 s50,s50,1
s_cmp_lt_u32 s50,128
s_cbranch_scc1 CW_LOOP_F
s_branch CW_DONE
ws_173:
buffer_load_dwordx4 v[32:35],v1,s[8:11],s70 offen sc1
buffer_load_dwordx4 v[36:39],v1,s[8:11],s70 offen offset:3072 sc1
buffer_load_dwordx4 v[40:43],v1,s[8:11],s71 offen offset:2048 sc1
buffer_load_dwordx4 v[44:47],v1,s[8:11],s80 offen offset:1024 sc1
buffer_load_dwordx4 v[48:51],v1,s[8:11],s70 offen offset:1024 sc1
s_sub_u32 s47,s47,1
s_cbranch_scc1 ABORT
s_waitcnt vmcnt(4)
v_and_b32 v12,1,v32
v_cmp_ne_u32 vcc,s57,v12
s_nop 0
s_cbranch_vccnz ws_173
s_branch wg_179
ws_174:
buffer_load_dwordx4 v[36:39],v1,s[8:11],s70 offen offset:3072 sc1
buffer_load_dwordx4 v[40:43],v1,s[8:11],s71 offen offset:2048 sc1
buffer_load_dwordx4 v[44:47],v1,s[8:11],s80 offen offset:1024 sc1
buffer_load_dwordx4 v[48:51],v1,s[8:11],s70 offen offset:1024 sc1
buffer_load_dwordx4 v[52:55],v1,s[8:11],s71 offen sc1
s_sub_u32 s47,s47,1
s_cbranch_scc1 ABORT
s_waitcnt vmcnt(4)
v_and_b32 v12,1,v36
v_cmp_ne_u32 vcc,s57,v12
s_nop 0
s_cbranch_vccnz ws_174
s_branch wg_180
ws_175:
buffer_load_dwordx4 v[40:43],v1,s[8:11],s71 offen offset:2048 sc1
buffer_load_dwordx4 v[44:47],v1,s[8:11],s80 offen offset:1024 sc1
buffer_load_dwordx4 v[48:51],v1,s[8:11],s70 offen offset:1024 sc1
buffer_load_dwordx4 v[52:55],v1,s[8:11],s71 offen sc1
buffer_load_dwordx4 v[56:59],v1,s[8:11],s71 offen offset:3072 sc1
s_sub_u32 s47,s47,1
s_cbranch_scc1 ABORT
s_waitcnt vmcnt(4)
v_and_b32 v12,1,v40
v_cmp_ne_u32 vcc,s57,v12
s_nop 0
s_cbranch_vccnz ws_175
s_branch wg_181
ws_176:
buffer_load_dwordx4 v[44:47],v1,s[8:11],s80 offen offset:1024 sc1
buffer_load_dwordx4 v[48:51],v1,s[8:11],s70 offen offset:1024 sc1
buffer_load_dwordx4 v[52:55],v1,s[8:11],s71 offen sc1
buffer_load_dwordx4 v[56:59],v1,s[8:11],s71 offen offset:3072 sc1
buffer_load_dwordx4 v[60:63],v1,s[8:11],s80 offen offset:2048 sc1
s_sub_u32 s47,s47,1
s_cbranch_scc1 ABORT
s_waitcnt vmcnt(4)
v_and_b32 v12,1,v44
v_cmp_ne_u32 vcc,s57,v12
s_nop 0
s_cbranch_vccnz ws_176
s_branch wg_182
ws_177:
buffer_load_dwordx4 v[48:51],v1,s[8:11],s70 offen offset:1024 sc1
buffer_load_dwordx4 v[52:55],v1,s[8:11],s71 offen sc1
buffer_load_dwordx4 v[56:59],v1,s[8:11],s71 offen offset:3072 sc1
buffer_load_dwordx4 v[60:63],v1,s[8:11],s80 offen offset:2048 sc1
buffer_load_dwordx4 v[64:67],v1,s[8:11],s70 offen offset:2048 sc1
s_sub_u32 s47,s47,1
s_cbranch_scc1 ABORT
s_waitcnt vmcnt(4)
v_and_b32 v12,1,v48
v_cmp_ne_u32 vcc,s57,v12
s_nop 0
s_cbranch_vccnz ws_177
s_branch wg_183
ws_178:
buffer_load_dwordx4 v[52:55],v1,s[8:11],s71 offen sc1
buffer_load_dwordx4 v[56:59],v1,s[8:11],s71 offen offset:3072 sc1
buffer_load_dwordx4 v[60:63],v1,s[8:11],s80 offen offset:2048 sc1
buffer_load_dwordx4 v[64:67],v1,s[8:11],s70 offen offset:2048 sc1
buffer_load_dwordx4 v[68:71],v1,s[8:11],s71 offen offset:1024 sc1
s_sub_u32 s47,s47,1
s_cbranch_scc1 ABORT
s_waitcnt vmcnt(4)
v_and_b32 v12,1,v52
v_cmp_ne_u32 vcc,s57,v12
s_nop 0
s_cbranch_vccnz ws_178
s_branch wg_184
rd_170x:
s_sub_u32 s47,s47,1
s_cbranch_scc1 ABORT
s_waitcnt lgkmcnt(0)
s_nop 7
ds_read_b128 v[100:103],v4 offset:0
ds_read_b128 v[104:107],v4 offset:1024
ds_read_b128 v[108:111],v4 offset:6144
ds_read_b128 v[112:115],v4 offset:7168
s_branch rd_170
CW_LOOP_S:
s_sub_u32 s60,s50,13
s_lshr_b32 s52,s60,1
s_and_b32 s51,s60,1
s_cmp_eq_u32 s51,0
s_cselect_b32 s61,13,0
s_add_u32 s52,s52,s61
s_sub_u32 s61,s60,51
s_cmp_ge_u32 s60,102
s_cselect_b32 s52,s61,s52
s_cselect_b32 s51,1,s51
s_cmp_lt_u32 s50,13
s_cselect_b32 s52,s50,s52
s_cselect_b32 s51,0,s51
s_cmp_eq_u32 s52,63
s_cbranch_scc1 CW_NEXT_S
s_add_u32 s58,s52,1
s_lshl_b32 s61,s51,9
s_add_u32 s72,s61,s35
s_add_u32 s69,s61,s85
s_lshl_b32 s61,s51,2
s_and_b32 s60,s52,1
s_add_u32 s60,s60,s61
s_mul_i32 s70,s60,49152
s_add_u32 s70,s70,s33
s_add_u32 s71,s70,4096
s_add_u32 s80,s70,8192
s_bfe_u32 s57,s52,65537
s_bfe_u32 s31,s58,65537
s_and_b32 s60,s58,1
s_add_u32 s60,s60,s61
s_mul_i32 s59,s60,20480
s_add_u32 s59,s59,s84
s_lshl_b32 s68,s60,16
s_add_u32 s68,s68,s83
s_xor_b32 s77,s77,11264
v_add_u32 v7,s77,v5
v_add_u32 v8,s77,v6
s_add_u32 s60,s52,2
v_mov_b32 v16,s60
ds_read_b128 v[100:103],v4 offset:0
ds_read_b128 v[104:107],v4 offset:1024
ds_read_b128 v[108:111],v4 offset:6144
ds_read_b128 v[112:115],v4 offset:7168
s_cmp_lg_u32 s46,0
s_cbranch_scc1 np_185
db_187:
buffer_load_dword v12,v3,s[8:11],s72 offen sc1
s_waitcnt vmcnt(0)
v_cmp_gt_u32 vcc,s58,v12
s_cbranch_vccz dbok_188
s_sub_u32 s47,s47,1
s_cbranch_scc1 ABORT
s_branch db_187
dbok_188:
np_185:
s_barrier
rd_186:
buffer_load_dwordx4 v[32:35],v1,s[8:11],s70 offen sc1
v_mov_b32 v80,0
v_mov_b32 v81,0
v_mov_b32 v82,0
v_mov_b32 v83,0
v_mov_b32 v84,0
buffer_load_dwordx4 v[36:39],v1,s[8:11],s70 offen offset:3072 sc1
v_mov_b32 v85,0
v_mov_b32 v86,0
v_mov_b32 v87,0
v_mov_b32 v88,0
v_mov_b32 v89,0
buffer_load_dwordx4 v[40:43],v1,s[8:11],s71 offen offset:2048 sc1
v_mov_b32 v90,0
v_mov_b32 v91,0
v_mov_b32 v92,0
v_mov_b32 v93,0
v_mov_b32 v94,0
buffer_load_dwordx4 v[44:47],v1,s[8:11],s80 offen offset:1024 sc1
v_mov_b32 v95,0
v_mov_b32 v96,0
v_mov_b32 v97,0
v_mov_b32 v98,0
v_mov_b32 v99,0
buffer_load_dwordx4 v[48:51],v1,s[8:11],s70 offen offset:1024 sc1
s_waitcnt vmcnt(4)
v_and_b32 v12,1,v32
v_cmp_ne_u32 vcc,s57,v12
s_cbranch_vccnz ws_189
wg_195:
v_smfmac_f32_16x16x64_bf16 v[80:83],v[32:35],a[0:7],v2
buffer_load_dwordx4 v[52:55],v1,s[8:11],s71 offen sc1
v_smfmac_f32_16x16x64_bf16 v[84:87],v[32:35],a[8:15],v2
s_waitcnt vmcnt(4)
v_and_b32 v12,1,v36
v_smfmac_f32_16x16x64_bf16 v[88:91],v[32:35],a[16:23],v2
v_cmp_ne_u32 vcc,s57,v12
v_smfmac_f32_16x16x64_bf16 v[92:95],v[32:35],a[24:31],v2
s_waitcnt lgkmcnt(2)
v_smfmac_f32_16x16x64_bf16 v[96:99],v[32:35],v[100:107],v2
s_cbranch_vccnz ws_190
wg_196:
v_smfmac_f32_16x16x64_bf16 v[80:83],v[36:39],a[96:103],v2
buffer_load_dwordx4 v[56:59],v1,s[8:11],s71 offen offset:3072 sc1
v_smfmac_f32_16x16x64_bf16 v[84:87],v[36:39],a[104:111],v2
s_waitcnt vmcnt(4)
v_and_b32 v12,1,v40
v_smfmac_f32_16x16x64_bf16 v[88:91],v[36:39],a[112:119],v2
v_cmp_ne_u32 vcc,s57,v12
v_smfmac_f32_16x16x64_bf16 v[92:95],v[36:39],a[120:127],v2
s_waitcnt lgkmcnt(0)
v_smfmac_f32_16x16x64_bf16 v[96:99],v[36:39],v[108:115],v2
s_cbranch_vccnz ws_191
wg_197:
v_smfmac_f32_16x16x64_bf16 v[80:83],v[40:43],a[192:199],v2
buffer_load_dwordx4 v[60:63],v1,s[8:11],s80 offen offset:2048 sc1
v_smfmac_f32_16x16x64_bf16 v[84:87],v[40:43],a[200:207],v2
s_waitcnt vmcnt(4)
v_and_b32 v12,1,v44
v_smfmac_f32_16x16x64_bf16 v[88:91],v[40:43],a[208:215],v2
v_cmp_ne_u32 vcc,s57,v12
ds_read_b128 v[100:103],v4 offset:18432
v_smfmac_f32_16x16x64_bf16 v[92:95],v[40:43],a[216:223],v2
ds_read_b128 v[104:107],v4 offset:19456
v_smfmac_f32_16x16x64_bf16 v[96:99],v[40:43],v[20:27],v2
s_cbranch_vccnz ws_192
wg_198:
v_smfmac_f32_16x16x64_bf16 v[80:83],v[44:47],v[160:167],v2
buffer_load_dwordx4 v[64:67],v1,s[8:11],s70 offen offset:2048 sc1
v_smfmac_f32_16x16x64_bf16 v[84:87],v[44:47],v[168:175],v2
s_waitcnt vmcnt(4)
v_and_b32 v12,1,v48
v_smfmac_f32_16x16x64_bf16 v[88:91],v[44:47],v[176:183],v2
v_cmp_ne_u32 vcc,s57,v12
ds_read_b128 v[108:111],v4 offset:2048
v_smfmac_f32_16x16x64_bf16 v[92:95],v[44:47],v[184:191],v2
ds_read_b128 v[112:115],v4 offset:3072
s_waitcnt lgkmcnt(2)
v_smfmac_f32_16x16x64_bf16 v[96:99],v[44:47],v[100:107],v2
s_cbranch_vccnz ws_193
wg_199:
v_smfmac_f32_16x16x64_bf16 v[80:83],v[48:51],a[32:39],v2
buffer_load_dwordx4 v[68:71],v1,s[8:11],s71 offen offset:1024 sc1
v_smfmac_f32_16x16x64_bf16 v[84:87],v[48:51],a[40:47],v2
s_waitcnt vmcnt(4)
v_and_b32 v12,1,v52
v_smfmac_f32_16x16x64_bf16 v[88:91],v[48:51],a[48:55],v2
v_cmp_ne_u32 vcc,s57,v12
ds_read_b128 v[100:103],v4 offset:8192
v_smfmac_f32_16x16x64_bf16 v[92:95],v[48:51],a[56:63],v2
ds_read_b128 v[104:107],v4 offset:9216
s_waitcnt lgkmcnt(2)
v_smfmac_f32_16x16x64_bf16 v[96:99],v[48:51],v[108:115],v2
s_cbranch_vccnz ws_194
wg_200:
v_smfmac_f32_16x16x64_bf16 v[80:83],v[52:55],a[128:135],v2
buffer_load_dwordx4 v[72:75],v1,s[8:11],s80 offen sc1
v_smfmac_f32_16x16x64_bf16 v[84:87],v[52:55],a[136:143],v2
ds_read_b128 v[108:111],v4 offset:14336
v_smfmac_f32_16x16x64_bf16 v[88:91],v[52:55],a[144:151],v2
ds_read_b128 v[112:115],v4 offset:15360
v_smfmac_f32_16x16x64_bf16 v[92:95],v[52:55],a[152:159],v2
s_waitcnt lgkmcnt(2)
v_smfmac_f32_16x16x64_bf16 v[96:99],v[52:55],v[100:107],v2
buffer_load_dwordx4 v[76:79],v1,s[8:11],s80 offen offset:3072 sc1
s_waitcnt vmcnt(5)
v_smfmac_f32_16x16x64_bf16 v[80:83],v[56:59],a[224:231],v2
ds_read_b128 v[100:103],v4 offset:20480
v_smfmac_f32_16x16x64_bf16 v[84:87],v[56:59],a[232:239],v2
ds_read_b128 v[104:107],v4 offset:21504
v_smfmac_f32_16x16x64_bf16 v[88:91],v[56:59],a[240:247],v2
v_smfmac_f32_16x16x64_bf16 v[92:95],v[56:59],a[248:255],v2
s_waitcnt lgkmcnt(2)
v_smfmac_f32_16x16x64_bf16 v[96:99],v[56:59],v[108:115],v2
s_waitcnt vmcnt(4)
v_smfmac_f32_16x16x64_bf16 v[80:83],v[60:63],v[192:199],v2
ds_read_b128 v[108:111],v4 offset:4096
v_bitop3_b32 v13,v56,v60,s57 bitop3:0x7e
v_smfmac_f32_16x16x64_bf16 v[84:87],v[60:63],v[200:207],v2
ds_read_b128 v[112:115],v4 offset:5120
v_smfmac_f32_16x16x64_bf16 v[88:91],v[60:63],v[208:215],v2
v_smfmac_f32_16x16x64_bf16 v[92:95],v[60:63],v[216:223],v2
s_waitcnt lgkmcnt(2)
v_smfmac_f32_16x16x64_bf16 v[96:99],v[60:63],v[100:107],v2
s_waitcnt vmcnt(3)
v_smfmac_f32_16x16x64_bf16 v[80:83],v[64:67],a[64:71],v2
ds_read_b128 v[100:103],v4 offset:10240
v_smfmac_f32_16x16x64_bf16 v[84:87],v[64:67],a[72:79],v2
ds_read_b128 v[104:107],v4 offset:11264
v_smfmac_f32_16x16x64_bf16 v[88:91],v[64:67],a[80:87],v2
v_smfmac_f32_16x16x64_bf16 v[92:95],v[64:67],a[88:95],v2
s_waitcnt lgkmcnt(2)
v_smfmac_f32_16x16x64_bf16 v[96:99],v[64:67],v[108:115],v2
s_waitcnt vmcnt(0)
v_smfmac_f32_16x16x64_bf16 v[80:83],v[68:71],a[160:167],v2
ds_read_b128 v[108:111],v4 offset:16384
v_bitop3_b32 v14,v64,v68,s57 bitop3:0x7e
v_smfmac_f32_16x16x64_bf16 v[80:83],v[72:75],v[128:135],v2
ds_read_b128 v[112:115],v4 offset:17408
v_or_b32 v13,v13,v14
v_smfmac_f32_16x16x64_bf16 v[80:83],v[76:79],v[224:231],v2
v_bitop3_b32 v14,v72,v76,s57 bitop3:0x7e
v_smfmac_f32_16x16x64_bf16 v[84:87],v[68:71],a[168:175],v2
v_or_b32 v13,v13,v14
v_smfmac_f32_16x16x64_bf16 v[84:87],v[72:75],v[136:143],v2
v_and_b32 v13,1,v13
v_smfmac_f32_16x16x64_bf16 v[84:87],v[76:79],v[232:239],v2
v_cmp_ne_u32 vcc,0,v13
v_smfmac_f32_16x16x64_bf16 v[88:91],v[68:71],a[176:183],v2
s_cbranch_vccnz rd_186x
v_smfmac_f32_16x16x64_bf16 v[88:91],v[72:75],v[144:151],v2
v_add_f32 v80,v80,v81
v_smfmac_f32_16x16x64_bf16 v[88:91],v[76:79],v[240:247],v2
v_add_f32 v82,v82,v83
ds_write2_b32 v7,v80,v82 offset0:0 offset1:88
v_smfmac_f32_16x16x64_bf16 v[92:95],v[68:71],a[184:191],v2
v_add_f32 v84,v84,v85
v_smfmac_f32_16x16x64_bf16 v[92:95],v[72:75],v[152:159],v2
v_add_f32 v86,v86,v87
ds_write2_b32 v7,v84,v86 offset0:16 offset1:104
v_smfmac_f32_16x16x64_bf16 v[92:95],v[76:79],v[248:255],v2
v_add_f32 v88,v88,v89
s_waitcnt lgkmcnt(4)
v_smfmac_f32_16x16x64_bf16 v[96:99],v[68:71],v[100:107],v2
v_add_f32 v90,v90,v91
s_waitcnt lgkmcnt(2)
v_smfmac_f32_16x16x64_bf16 v[96:99],v[72:75],v[108:115],v2
ds_write2_b32 v7,v88,v90 offset0:32 offset1:120
v_smfmac_f32_16x16x64_bf16 v[96:99],v[76:79],v[116:123],v2
v_add_f32 v92,v92,v93
v_add_f32 v94,v94,v95
ds_write2_b32 v7,v92,v94 offset0:48 offset1:136
s_nop 4
v_add_f32 v96,v96,v97
v_add_f32 v98,v98,v99
ds_write2_b32 v7,v96,v98 offset0:64 offset1:152
s_waitcnt lgkmcnt(0)
s_barrier
ds_read_b128 v[32:35],v8 offset:0
ds_read_b128 v[36:39],v8 offset:2816
ds_read_b128 v[40:43],v8 offset:5632
ds_read_b128 v[44:47],v8 offset:8448
s_mov_b64 exec,1
buffer_store_dword v16,v1,s[8:11],s69 offen sc1
s_mov_b64 exec,-1
s_waitcnt lgkmcnt(2)
v_pk_add_f32 v[32:33],v[32:33],v[36:37]
v_pk_add_f32 v[34:35],v[34:35],v[38:39]
s_waitcnt lgkmcnt(0)
v_pk_add_f32 v[40:41],v[40:41],v[44:45]
v_pk_add_f32 v[42:43],v[42:43],v[46:47]
v_pk_add_f32 v[32:33],v[32:33],v[40:41]
v_pk_add_f32 v[34:35],v[34:35],v[42:43]
v_cvt_pk_bf16_f32 v32,v32,v33
v_cvt_pk_bf16_f32 v33,v34,v35
v_bfi_b32 v32,v10,s31,v32
s_nop 0
v_permlane32_swap_b32 v33,v35
v_permlane32_swap_b32 v32,v34
s_mov_b64 exec,s[88:89]
buffer_store_dwordx4 v[32:35],v9,s[8:11],s59 offen sc1
s_barrier
buffer_store_dwordx4 v[32:35],v9,s[8:11],s68 offen sc1
s_mov_b64 exec,-1
s_nop 0
CW_NEXT_S:
s_add_u32 s50,s50,1
s_cmp_lt_u32 s50,128
s_cbranch_scc1 CW_LOOP_S
s_branch CW_DONE
ws_189:
buffer_load_dwordx4 v[32:35],v1,s[8:11],s70 offen sc1
buffer_load_dwordx4 v[36:39],v1,s[8:11],s70 offen offset:3072 sc1
buffer_load_dwordx4 v[40:43],v1,s[8:11],s71 offen offset:2048 sc1
buffer_load_dwordx4 v[44:47],v1,s[8:11],s80 offen offset:1024 sc1
buffer_load_dwordx4 v[48:51],v1,s[8:11],s70 offen offset:1024 sc1
s_sub_u32 s47,s47,1
s_cbranch_scc1 ABORT
s_waitcnt vmcnt(4)
v_and_b32 v12,1,v32
v_cmp_ne_u32 vcc,s57,v12
s_nop 0
s_cbranch_vccnz ws_189
s_branch wg_195
ws_190:
buffer_load_dwordx4 v[36:39],v1,s[8:11],s70 offen offset:3072 sc1
buffer_load_dwordx4 v[40:43],v1,s[8:11],s71 offen offset:2048 sc1
buffer_load_dwordx4 v[44:47],v1,s[8:11],s80 offen offset:1024 sc1
buffer_load_dwordx4 v[48:51],v1,s[8:11],s70 offen offset:1024 sc1
buffer_load_dwordx4 v[52:55],v1,s[8:11],s71 offen sc1
s_sub_u32 s47,s47,1
s_cbranch_scc1 ABORT
s_waitcnt vmcnt(4)
v_and_b32 v12,1,v36
v_cmp_ne_u32 vcc,s57,v12
s_nop 0
s_cbranch_vccnz ws_190
s_branch wg_196
ws_191:
buffer_load_dwordx4 v[40:43],v1,s[8:11],s71 offen offset:2048 sc1
buffer_load_dwordx4 v[44:47],v1,s[8:11],s80 offen offset:1024 sc1
buffer_load_dwordx4 v[48:51],v1,s[8:11],s70 offen offset:1024 sc1
buffer_load_dwordx4 v[52:55],v1,s[8:11],s71 offen sc1
buffer_load_dwordx4 v[56:59],v1,s[8:11],s71 offen offset:3072 sc1
s_sub_u32 s47,s47,1
s_cbranch_scc1 ABORT
s_waitcnt vmcnt(4)
v_and_b32 v12,1,v40
v_cmp_ne_u32 vcc,s57,v12
s_nop 0
s_cbranch_vccnz ws_191
s_branch wg_197
ws_192:
buffer_load_dwordx4 v[44:47],v1,s[8:11],s80 offen offset:1024 sc1
buffer_load_dwordx4 v[48:51],v1,s[8:11],s70 offen offset:1024 sc1
buffer_load_dwordx4 v[52:55],v1,s[8:11],s71 offen sc1
buffer_load_dwordx4 v[56:59],v1,s[8:11],s71 offen offset:3072 sc1
buffer_load_dwordx4 v[60:63],v1,s[8:11],s80 offen offset:2048 sc1
s_sub_u32 s47,s47,1
s_cbranch_scc1 ABORT
s_waitcnt vmcnt(4)
v_and_b32 v12,1,v44
v_cmp_ne_u32 vcc,s57,v12
s_nop 0
s_cbranch_vccnz ws_192
s_branch wg_198
ws_193:
buffer_load_dwordx4 v[48:51],v1,s[8:11],s70 offen offset:1024 sc1
buffer_load_dwordx4 v[52:55],v1,s[8:11],s71 offen sc1
buffer_load_dwordx4 v[56:59],v1,s[8:11],s71 offen offset:3072 sc1
buffer_load_dwordx4 v[60:63],v1,s[8:11],s80 offen offset:2048 sc1
buffer_load_dwordx4 v[64:67],v1,s[8:11],s70 offen offset:2048 sc1
s_sub_u32 s47,s47,1
s_cbranch_scc1 ABORT
s_waitcnt vmcnt(4)
v_and_b32 v12,1,v48
v_cmp_ne_u32 vcc,s57,v12
s_nop 0
s_cbranch_vccnz ws_193
s_branch wg_199
ws_194:
buffer_load_dwordx4 v[52:55],v1,s[8:11],s71 offen sc1
buffer_load_dwordx4 v[56:59],v1,s[8:11],s71 offen offset:3072 sc1
buffer_load_dwordx4 v[60:63],v1,s[8:11],s80 offen offset:2048 sc1
buffer_load_dwordx4 v[64:67],v1,s[8:11],s70 offen offset:2048 sc1
buffer_load_dwordx4 v[68:71],v1,s[8:11],s71 offen offset:1024 sc1
s_sub_u32 s47,s47,1
s_cbranch_scc1 ABORT
s_waitcnt vmcnt(4)
v_and_b32 v12,1,v52
v_cmp_ne_u32 vcc,s57,v12
s_nop 0
s_cbranch_vccnz ws_194
s_branch wg_200
rd_186x:
s_sub_u32 s47,s47,1
s_cbranch_scc1 ABORT
s_waitcnt lgkmcnt(0)
s_nop 7
ds_read_b128 v[100:103],v4 offset:0
ds_read_b128 v[104:107],v4 offset:1024
ds_read_b128 v[108:111],v4 offset:6144
ds_read_b128 v[112:115],v4 offset:7168
s_branch rd_186
CW_DONE:
s_add_u32 s61,s48,48
s_endpgm
DISPATCH:
s_sub_u32 s48,s3,0
s_cmp_lt_u32 s3,8
s_cbranch_scc1 ROLE_CW
s_sub_u32 s48,s3,8
s_cmp_lt_u32 s3,16
s_cbranch_scc1 ROLE_CV
s_sub_u32 s48,s3,16
s_cmp_lt_u32 s3,32
s_cbranch_scc1 ROLE_CS
s_sub_u32 s48,s3,24
s_cmp_lt_u32 s3,40
s_cbranch_scc1 ROLE_CW
s_sub_u32 s48,s3,32
s_cmp_lt_u32 s3,48
s_cbranch_scc1 ROLE_CV
s_sub_u32 s48,s3,32
s_cmp_lt_u32 s3,64
s_cbranch_scc1 ROLE_CS
s_sub_u32 s48,s3,64
s_cmp_lt_u32 s3,69
s_cbranch_scc1 ROLE_W1
s_sub_u32 s48,s3,69
s_cmp_lt_u32 s3,74
s_cbranch_scc1 ROLE_W2
s_sub_u32 s48,s3,74
s_cmp_lt_u32 s3,86
s_cbranch_scc1 ROLE_W3
s_sub_u32 s48,s3,86
s_cmp_lt_u32 s3,96
s_cbranch_scc1 ROLE_W4
s_sub_u32 s48,s3,96
s_cmp_lt_u32 s3,108
s_cbranch_scc1 ROLE_QKVQ
s_sub_u32 s48,s3,108
s_cmp_lt_u32 s3,116
s_cbranch_scc1 ROLE_QKVV
s_sub_u32 s48,s3,116
s_cmp_lt_u32 s3,128
s_cbranch_scc1 ROLE_R1
s_sub_u32 s48,s3,120
s_cmp_lt_u32 s3,132
s_cbranch_scc1 ROLE_QKVV
s_sub_u32 s48,s3,120
s_cmp_lt_u32 s3,141
s_cbranch_scc1 ROLE_QKVQ
s_sub_u32 s48,s3,141
s_cmp_lt_u32 s3,149
s_cbranch_scc1 ROLE_ATT
s_sub_u32 s48,s3,149
s_cmp_lt_u32 s3,159
s_cbranch_scc1 ROLE_WO
s_sub_u32 s48,s3,147
s_cmp_lt_u32 s3,160
s_cbranch_scc1 ROLE_R1
s_sub_u32 s48,s3,148
s_cmp_lt_u32 s3,164
s_cbranch_scc1 ROLE_QKVV
s_sub_u32 s48,s3,143
s_cmp_lt_u32 s3,173
s_cbranch_scc1 ROLE_QKVQ
s_sub_u32 s48,s3,165
s_cmp_lt_u32 s3,181
s_cbranch_scc1 ROLE_ATT
s_sub_u32 s48,s3,171
s_cmp_lt_u32 s3,191
s_cbranch_scc1 ROLE_WO
s_sub_u32 s48,s3,178
s_cmp_lt_u32 s3,192
s_cbranch_scc1 ROLE_R1
s_sub_u32 s48,s3,176
s_cmp_lt_u32 s3,196
s_cbranch_scc1 ROLE_QKVV
s_sub_u32 s48,s3,166
s_cmp_lt_u32 s3,205
s_cbranch_scc1 ROLE_QKVQ
s_sub_u32 s48,s3,189
s_cmp_lt_u32 s3,213
s_cbranch_scc1 ROLE_ATT
s_sub_u32 s48,s3,193
s_cmp_lt_u32 s3,223
s_cbranch_scc1 ROLE_WO
s_sub_u32 s48,s3,209
s_cmp_lt_u32 s3,224
s_cbranch_scc1 ROLE_R1
s_sub_u32 s48,s3,204
s_cmp_lt_u32 s3,228
s_cbranch_scc1 ROLE_QKVV
s_sub_u32 s48,s3,189
s_cmp_lt_u32 s3,237
s_cbranch_scc1 ROLE_QKVQ
s_sub_u32 s48,s3,213
s_cmp_lt_u32 s3,245
s_cbranch_scc1 ROLE_ATT
s_sub_u32 s48,s3,215
s_cmp_lt_u32 s3,255
s_cbranch_scc1 ROLE_WO
s_sub_u32 s48,s3,240
s_cmp_lt_u32 s3,256
s_cbranch_scc1 ROLE_R1
s_branch ROLE_SPARE
EXIT:
s_endpgm
ABORT:
s_mov_b64 exec,1
v_mov_b32 v1,s2
v_add_u32 v1,0x10000,v1
v_mov_b32 v2,8
buffer_store_dword v1,v2,s[12:15],0 offen
s_endpgm
ROLE_SPARE:
s_waitcnt vmcnt(0)
s_barrier
s_cmp_lg_u32 s46,0
s_cbranch_scc1 arr_201
v_mov_b32 v12,1
s_lshl_b32 s3,s49,2
v_mov_b32 v13,s3
s_mov_b64 exec,1
buffer_atomic_add v12,v13,s[12:15],0 offen sc1
s_mov_b64 exec,-1
arr_201:
s_lshl_b32 s3,s49,2
v_mov_b32 v13,s3
s_nop 1
ibw_202:
buffer_load_dword v12,v13,s[12:15],0 offen sc1
s_waitcnt vmcnt(0)
v_cmp_ne_u32 vcc,256,v12
s_nop 0
s_cbranch_vccz ok_203
s_sleep 8
s_sub_u32 s47,s47,1
s_cbranch_scc1 ABORT
s_branch ibw_202
ok_203:
s_cmp_lg_u32 s49,0
s_cbranch_scc1 ibok_204
v_and_b32 v13,7,v0
v_lshlrev_b32 v13,2,v13
buffer_load_dword v12,v13,s[12:15],0 offen offset:32 sc1
s_waitcnt vmcnt(0)
v_cmp_ne_u32 vcc,32,v12
s_nop 0
s_cbranch_vccz ibok_204
s_barrier
s_mov_b32 s49,1
s_mov_b32 s3,s2
s_load_dwordx16 s[16:31],s[0:1],0
s_load_dwordx8 s[32:39],s[0:1],64
s_waitcnt lgkmcnt(0)
s_branch DISPATCH
ibok_204:
s_endpgm
ROLE_QKVQ:
v_lshlrev_b32 v1,4,v0
v_mov_b32 v5,1
s_lshl_b32 s56,s48,2
s_add_u32 s56,s56,s46
v_bfe_u32 v6,v0,2,2
v_lshrrev_b32 v7,4,v0
v_add_u32 v7,v6,v7
v_and_b32 v7,3,v7
v_and_b32 v15,3,v0
v_lshlrev_b32 v15,4,v15
v_lshl_add_u32 v15,v7,6,v15
v_lshl_add_u32 v15,v6,8,v15
v_lshrrev_b32 v6,5,v0
v_bfe_u32 v7,v0,4,1
v_lshlrev_b32 v16,10,v7
v_bfe_u32 v7,v0,2,2
v_lshl_add_u32 v16,v7,8,v16
v_add_u32 v6,v6,v7
v_and_b32 v6,3,v6
v_lshl_add_u32 v16,v6,6,v16
v_and_b32 v6,3,v0
v_lshl_add_u32 v16,v6,4,v16
v_add_u32 v18,46080,v16
v_lshrrev_b32 v6,5,v0
v_bfe_u32 v7,v0,4,1
v_lshlrev_b32 v20,10,v7
v_lshl_add_u32 v20,v6,8,v20
v_and_b32 v6,15,v0
v_lshl_add_u32 v20,v6,4,v20
v_lshrrev_b32 v6,5,v0
v_add_u32 v6,2,v6
v_bfe_u32 v7,v0,4,1
v_lshlrev_b32 v17,10,v7
v_bfe_u32 v7,v0,2,2
v_lshl_add_u32 v17,v7,8,v17
v_add_u32 v6,v6,v7
v_and_b32 v6,3,v6
v_lshl_add_u32 v17,v6,6,v17
v_and_b32 v6,3,v0
v_lshl_add_u32 v17,v6,4,v17
v_add_u32 v19,46080,v17
v_lshrrev_b32 v6,5,v0
v_add_u32 v6,2,v6
v_bfe_u32 v7,v0,4,1
v_lshlrev_b32 v21,10,v7
v_lshl_add_u32 v21,v6,8,v21
v_and_b32 v6,15,v0
v_lshl_add_u32 v21,v6,4,v21
s_cmp_ge_u32 s48,24
s_cselect_b32 s68,1,0
s_mul_i32 s60,s68,96
s_sub_u32 s69,s56,s60
s_mul_i32 s70,s68,50331648
s_add_u32 s70,s70,74448896
s_mul_i32 s60,s68,65536
s_sub_u32 s71,131072,s60
s_lshl_b32 s60,s69,12
s_add_u32 s70,s70,s60
v_lshrrev_b32 v6,5,v0
v_mul_u32_u24 v188,2560,v6
v_and_b32 v6,31,v0
v_lshl_add_u32 v188,v6,3,v188
v_add_u32 v188,0xa000,v188
v_min_u32 v4,7,v0
v_lshlrev_b32 v4,2,v4
v_min_u32 v2,39,v0
v_lshlrev_b32 v2,2,v2
v_mov_b32 v12,93184
s_waitcnt vmcnt(0)
s_barrier
s_cmp_lg_u32 s46,0
s_cbranch_scc1 arr_205
v_mov_b32 v6,1
s_lshl_b32 s3,s49,2
v_mov_b32 v7,s3
s_mov_b64 exec,1
buffer_atomic_add v6,v7,s[12:15],0 offen sc1
s_mov_b64 exec,-1
arr_205:
s_lshl_b32 s58,s69,7
s_mul_i32 s63,s46,40960
s_cmp_eq_u32 s68,0
s_cselect_b32 s4,s22,s20
s_cselect_b32 s5,s23,s21
s_mov_b32 s6,7864320
s_mov_b32 s7,0x20000
v_lshrrev_b32 v9,3,v0
s_mov_b32 s64,12288
v_mul_lo_u32 v9,v9,s64
v_and_b32 v10,7,v0
v_lshl_add_u32 v6,v10,4,v9
s_add_u32 m0,s63,0
s_add_u32 s65,s58,0
buffer_load_dwordx4 v6,s[4:7],s65 offen lds
s_add_u32 m0,s63,1024
s_add_u32 s65,s58,98304
buffer_load_dwordx4 v6,s[4:7],s65 offen lds
s_add_u32 m0,s63,2048
s_add_u32 s65,s58,196608
buffer_load_dwordx4 v6,s[4:7],s65 offen lds
s_add_u32 m0,s63,3072
s_add_u32 s65,s58,294912
buffer_load_dwordx4 v6,s[4:7],s65 offen lds
s_add_u32 m0,s63,4096
s_add_u32 s65,s58,393216
buffer_load_dwordx4 v6,s[4:7],s65 offen lds
s_add_u32 m0,s63,5120
s_add_u32 s65,s58,491520
buffer_load_dwordx4 v6,s[4:7],s65 offen lds
s_add_u32 m0,s63,6144
s_add_u32 s65,s58,589824
buffer_load_dwordx4 v6,s[4:7],s65 offen lds
s_add_u32 m0,s63,7168
s_add_u32 s65,s58,688128
buffer_load_dwordx4 v6,s[4:7],s65 offen lds
s_add_u32 m0,s63,8192
s_add_u32 s65,s58,786432
buffer_load_dwordx4 v6,s[4:7],s65 offen lds
s_add_u32 m0,s63,9216
s_add_u32 s65,s58,884736
buffer_load_dwordx4 v6,s[4:7],s65 offen lds
s_add_u32 m0,s63,10240
s_add_u32 s65,s58,983040
buffer_load_dwordx4 v6,s[4:7],s65 offen lds
s_add_u32 m0,s63,11264
s_add_u32 s65,s58,1081344
buffer_load_dwordx4 v6,s[4:7],s65 offen lds
s_add_u32 m0,s63,12288
s_add_u32 s65,s58,1179648
buffer_load_dwordx4 v6,s[4:7],s65 offen lds
s_add_u32 m0,s63,13312
s_add_u32 s65,s58,1277952
buffer_load_dwordx4 v6,s[4:7],s65 offen lds
s_add_u32 m0,s63,14336
s_add_u32 s65,s58,1376256
buffer_load_dwordx4 v6,s[4:7],s65 offen lds
s_add_u32 m0,s63,15360
s_add_u32 s65,s58,1474560
buffer_load_dwordx4 v6,s[4:7],s65 offen lds
s_add_u32 m0,s63,16384
s_add_u32 s65,s58,1572864
buffer_load_dwordx4 v6,s[4:7],s65 offen lds
s_add_u32 m0,s63,17408
s_add_u32 s65,s58,1671168
buffer_load_dwordx4 v6,s[4:7],s65 offen lds
s_add_u32 m0,s63,18432
s_add_u32 s65,s58,1769472
buffer_load_dwordx4 v6,s[4:7],s65 offen lds
s_add_u32 m0,s63,19456
s_add_u32 s65,s58,1867776
buffer_load_dwordx4 v6,s[4:7],s65 offen lds
s_add_u32 m0,s63,20480
s_add_u32 s65,s58,1966080
buffer_load_dwordx4 v6,s[4:7],s65 offen lds
s_add_u32 m0,s63,21504
s_add_u32 s65,s58,2064384
buffer_load_dwordx4 v6,s[4:7],s65 offen lds
s_add_u32 m0,s63,22528
s_add_u32 s65,s58,2162688
buffer_load_dwordx4 v6,s[4:7],s65 offen lds
s_add_u32 m0,s63,23552
s_add_u32 s65,s58,2260992
buffer_load_dwordx4 v6,s[4:7],s65 offen lds
s_add_u32 m0,s63,24576
s_add_u32 s65,s58,2359296
buffer_load_dwordx4 v6,s[4:7],s65 offen lds
s_add_u32 m0,s63,25600
s_add_u32 s65,s58,2457600
buffer_load_dwordx4 v6,s[4:7],s65 offen lds
s_add_u32 m0,s63,26624
s_add_u32 s65,s58,2555904
buffer_load_dwordx4 v6,s[4:7],s65 offen lds
s_add_u32 m0,s63,27648
s_add_u32 s65,s58,2654208
buffer_load_dwordx4 v6,s[4:7],s65 offen lds
s_add_u32 m0,s63,28672
s_add_u32 s65,s58,2752512
buffer_load_dwordx4 v6,s[4:7],s65 offen lds
s_add_u32 m0,s63,29696
s_add_u32 s65,s58,2850816
buffer_load_dwordx4 v6,s[4:7],s65 offen lds
s_add_u32 m0,s63,30720
s_add_u32 s65,s58,2949120
buffer_load_dwordx4 v6,s[4:7],s65 offen lds
s_add_u32 m0,s63,31744
s_add_u32 s65,s58,3047424
buffer_load_dwordx4 v6,s[4:7],s65 offen lds
s_add_u32 m0,s63,32768
s_add_u32 s65,s58,3145728
buffer_load_dwordx4 v6,s[4:7],s65 offen lds
s_add_u32 m0,s63,33792
s_add_u32 s65,s58,3244032
buffer_load_dwordx4 v6,s[4:7],s65 offen lds
s_add_u32 m0,s63,34816
s_add_u32 s65,s58,3342336
buffer_load_dwordx4 v6,s[4:7],s65 offen lds
s_add_u32 m0,s63,35840
s_add_u32 s65,s58,3440640
buffer_load_dwordx4 v6,s[4:7],s65 offen lds
s_add_u32 m0,s63,36864
s_add_u32 s65,s58,3538944
buffer_load_dwordx4 v6,s[4:7],s65 offen lds
s_add_u32 m0,s63,37888
s_add_u32 s65,s58,3637248
buffer_load_dwordx4 v6,s[4:7],s65 offen lds
s_add_u32 m0,s63,38912
s_add_u32 s65,s58,3735552
buffer_load_dwordx4 v6,s[4:7],s65 offen lds
s_add_u32 m0,s63,39936
s_add_u32 s65,s58,3833856
buffer_load_dwordx4 v6,s[4:7],s65 offen lds
s_waitcnt vmcnt(20)
v_bfe_u32 v9,v0,2,2
v_lshrrev_b32 v10,5,v0
v_lshl_add_u32 v9,v10,2,v9
v_mul_u32_u24 v9,128,v9
v_and_b32 v10,1,v0
v_lshl_add_u32 v9,v10,3,v9
v_bfe_u32 v10,v0,1,1
v_lshl_add_u32 v9,v10,5,v9
v_bfe_u32 v10,v0,4,1
v_lshl_add_u32 v9,v10,4,v9
v_add_u32 v7,s63,v9
ds_read_b64_tr_b16 a[0:1],v7 offset:0
ds_read_b64_tr_b16 a[2:3],v7 offset:2048
ds_read_b64_tr_b16 a[4:5],v7 offset:1024
ds_read_b64_tr_b16 a[6:7],v7 offset:3072
ds_read_b64_tr_b16 a[160:161],v7 offset:64
ds_read_b64_tr_b16 a[162:163],v7 offset:2112
ds_read_b64_tr_b16 a[164:165],v7 offset:1088
ds_read_b64_tr_b16 a[166:167],v7 offset:3136
ds_read_b64_tr_b16 a[8:9],v7 offset:4096
ds_read_b64_tr_b16 a[10:11],v7 offset:6144
ds_read_b64_tr_b16 a[12:13],v7 offset:5120
ds_read_b64_tr_b16 a[14:15],v7 offset:7168
s_waitcnt lgkmcnt(4)
ds_read_b64_tr_b16 a[168:169],v7 offset:4160
ds_read_b64_tr_b16 a[170:171],v7 offset:6208
ds_read_b64_tr_b16 a[172:173],v7 offset:5184
ds_read_b64_tr_b16 a[174:175],v7 offset:7232
ds_read_b64_tr_b16 a[16:17],v7 offset:8192
ds_read_b64_tr_b16 a[18:19],v7 offset:10240
ds_read_b64_tr_b16 a[20:21],v7 offset:9216
ds_read_b64_tr_b16 a[22:23],v7 offset:11264
ds_read_b64_tr_b16 a[176:177],v7 offset:8256
ds_read_b64_tr_b16 a[178:179],v7 offset:10304
ds_read_b64_tr_b16 a[180:181],v7 offset:9280
ds_read_b64_tr_b16 a[182:183],v7 offset:11328
s_waitcnt lgkmcnt(4)
ds_read_b64_tr_b16 a[24:25],v7 offset:12288
ds_read_b64_tr_b16 a[26:27],v7 offset:14336
ds_read_b64_tr_b16 a[28:29],v7 offset:13312
ds_read_b64_tr_b16 a[30:31],v7 offset:15360
ds_read_b64_tr_b16 a[184:185],v7 offset:12352
ds_read_b64_tr_b16 a[186:187],v7 offset:14400
ds_read_b64_tr_b16 a[188:189],v7 offset:13376
ds_read_b64_tr_b16 a[190:191],v7 offset:15424
ds_read_b64_tr_b16 a[32:33],v7 offset:16384
ds_read_b64_tr_b16 a[34:35],v7 offset:18432
ds_read_b64_tr_b16 a[36:37],v7 offset:17408
ds_read_b64_tr_b16 a[38:39],v7 offset:19456
s_waitcnt lgkmcnt(4)
ds_read_b64_tr_b16 a[192:193],v7 offset:16448
ds_read_b64_tr_b16 a[194:195],v7 offset:18496
ds_read_b64_tr_b16 a[196:197],v7 offset:17472
ds_read_b64_tr_b16 a[198:199],v7 offset:19520
s_waitcnt lgkmcnt(0)
s_add_u32 m0,s63,0
s_add_u32 s65,s58,3932160
buffer_load_dwordx4 v6,s[4:7],s65 offen lds
s_add_u32 m0,s63,1024
s_add_u32 s65,s58,4030464
buffer_load_dwordx4 v6,s[4:7],s65 offen lds
s_add_u32 m0,s63,2048
s_add_u32 s65,s58,4128768
buffer_load_dwordx4 v6,s[4:7],s65 offen lds
s_add_u32 m0,s63,3072
s_add_u32 s65,s58,4227072
buffer_load_dwordx4 v6,s[4:7],s65 offen lds
s_add_u32 m0,s63,4096
s_add_u32 s65,s58,4325376
buffer_load_dwordx4 v6,s[4:7],s65 offen lds
s_add_u32 m0,s63,5120
s_add_u32 s65,s58,4423680
buffer_load_dwordx4 v6,s[4:7],s65 offen lds
s_add_u32 m0,s63,6144
s_add_u32 s65,s58,4521984
buffer_load_dwordx4 v6,s[4:7],s65 offen lds
s_add_u32 m0,s63,7168
s_add_u32 s65,s58,4620288
buffer_load_dwordx4 v6,s[4:7],s65 offen lds
s_add_u32 m0,s63,8192
s_add_u32 s65,s58,4718592
buffer_load_dwordx4 v6,s[4:7],s65 offen lds
s_add_u32 m0,s63,9216
s_add_u32 s65,s58,4816896
buffer_load_dwordx4 v6,s[4:7],s65 offen lds
s_add_u32 m0,s63,10240
s_add_u32 s65,s58,4915200
buffer_load_dwordx4 v6,s[4:7],s65 offen lds
s_add_u32 m0,s63,11264
s_add_u32 s65,s58,5013504
buffer_load_dwordx4 v6,s[4:7],s65 offen lds
s_add_u32 m0,s63,12288
s_add_u32 s65,s58,5111808
buffer_load_dwordx4 v6,s[4:7],s65 offen lds
s_add_u32 m0,s63,13312
s_add_u32 s65,s58,5210112
buffer_load_dwordx4 v6,s[4:7],s65 offen lds
s_add_u32 m0,s63,14336
s_add_u32 s65,s58,5308416
buffer_load_dwordx4 v6,s[4:7],s65 offen lds
s_add_u32 m0,s63,15360
s_add_u32 s65,s58,5406720
buffer_load_dwordx4 v6,s[4:7],s65 offen lds
s_add_u32 m0,s63,16384
s_add_u32 s65,s58,5505024
buffer_load_dwordx4 v6,s[4:7],s65 offen lds
s_add_u32 m0,s63,17408
s_add_u32 s65,s58,5603328
buffer_load_dwordx4 v6,s[4:7],s65 offen lds
s_add_u32 m0,s63,18432
s_add_u32 s65,s58,5701632
buffer_load_dwordx4 v6,s[4:7],s65 offen lds
s_add_u32 m0,s63,19456
s_add_u32 s65,s58,5799936
buffer_load_dwordx4 v6,s[4:7],s65 offen lds
s_waitcnt vmcnt(20)
v_bfe_u32 v9,v0,2,2
v_lshrrev_b32 v10,5,v0
v_lshl_add_u32 v9,v10,2,v9
v_mul_u32_u24 v9,128,v9
v_and_b32 v10,1,v0
v_lshl_add_u32 v9,v10,3,v9
v_bfe_u32 v10,v0,1,1
v_lshl_add_u32 v9,v10,5,v9
v_bfe_u32 v10,v0,4,1
v_lshl_add_u32 v9,v10,4,v9
v_add_u32 v7,s63,v9
ds_read_b64_tr_b16 a[40:41],v7 offset:20480
ds_read_b64_tr_b16 a[42:43],v7 offset:22528
ds_read_b64_tr_b16 a[44:45],v7 offset:21504
ds_read_b64_tr_b16 a[46:47],v7 offset:23552
ds_read_b64_tr_b16 a[200:201],v7 offset:20544
ds_read_b64_tr_b16 a[202:203],v7 offset:22592
ds_read_b64_tr_b16 a[204:205],v7 offset:21568
ds_read_b64_tr_b16 a[206:207],v7 offset:23616
ds_read_b64_tr_b16 a[48:49],v7 offset:24576
ds_read_b64_tr_b16 a[50:51],v7 offset:26624
ds_read_b64_tr_b16 a[52:53],v7 offset:25600
ds_read_b64_tr_b16 a[54:55],v7 offset:27648
s_waitcnt lgkmcnt(4)
ds_read_b64_tr_b16 a[208:209],v7 offset:24640
ds_read_b64_tr_b16 a[210:211],v7 offset:26688
ds_read_b64_tr_b16 a[212:213],v7 offset:25664
ds_read_b64_tr_b16 a[214:215],v7 offset:27712
ds_read_b64_tr_b16 a[56:57],v7 offset:28672
ds_read_b64_tr_b16 a[58:59],v7 offset:30720
ds_read_b64_tr_b16 a[60:61],v7 offset:29696
ds_read_b64_tr_b16 a[62:63],v7 offset:31744
ds_read_b64_tr_b16 a[216:217],v7 offset:28736
ds_read_b64_tr_b16 a[218:219],v7 offset:30784
ds_read_b64_tr_b16 a[220:221],v7 offset:29760
ds_read_b64_tr_b16 a[222:223],v7 offset:31808
s_waitcnt lgkmcnt(4)
ds_read_b64_tr_b16 a[64:65],v7 offset:32768
ds_read_b64_tr_b16 a[66:67],v7 offset:34816
ds_read_b64_tr_b16 a[68:69],v7 offset:33792
ds_read_b64_tr_b16 a[70:71],v7 offset:35840
ds_read_b64_tr_b16 a[224:225],v7 offset:32832
ds_read_b64_tr_b16 a[226:227],v7 offset:34880
ds_read_b64_tr_b16 a[228:229],v7 offset:33856
ds_read_b64_tr_b16 a[230:231],v7 offset:35904
ds_read_b64_tr_b16 a[72:73],v7 offset:36864
ds_read_b64_tr_b16 a[74:75],v7 offset:38912
ds_read_b64_tr_b16 a[76:77],v7 offset:37888
ds_read_b64_tr_b16 a[78:79],v7 offset:39936
s_waitcnt lgkmcnt(4)
ds_read_b64_tr_b16 a[232:233],v7 offset:36928
ds_read_b64_tr_b16 a[234:235],v7 offset:38976
ds_read_b64_tr_b16 a[236:237],v7 offset:37952
ds_read_b64_tr_b16 a[238:239],v7 offset:40000
s_waitcnt lgkmcnt(0)
s_add_u32 m0,s63,20480
s_add_u32 s65,s58,5898240
buffer_load_dwordx4 v6,s[4:7],s65 offen lds
s_add_u32 m0,s63,21504
s_add_u32 s65,s58,5996544
buffer_load_dwordx4 v6,s[4:7],s65 offen lds
s_add_u32 m0,s63,22528
s_add_u32 s65,s58,6094848
buffer_load_dwordx4 v6,s[4:7],s65 offen lds
s_add_u32 m0,s63,23552
s_add_u32 s65,s58,6193152
buffer_load_dwordx4 v6,s[4:7],s65 offen lds
s_add_u32 m0,s63,24576
s_add_u32 s65,s58,6291456
buffer_load_dwordx4 v6,s[4:7],s65 offen lds
s_add_u32 m0,s63,25600
s_add_u32 s65,s58,6389760
buffer_load_dwordx4 v6,s[4:7],s65 offen lds
s_add_u32 m0,s63,26624
s_add_u32 s65,s58,6488064
buffer_load_dwordx4 v6,s[4:7],s65 offen lds
s_add_u32 m0,s63,27648
s_add_u32 s65,s58,6586368
buffer_load_dwordx4 v6,s[4:7],s65 offen lds
s_add_u32 m0,s63,28672
s_add_u32 s65,s58,6684672
buffer_load_dwordx4 v6,s[4:7],s65 offen lds
s_add_u32 m0,s63,29696
s_add_u32 s65,s58,6782976
buffer_load_dwordx4 v6,s[4:7],s65 offen lds
s_add_u32 m0,s63,30720
s_add_u32 s65,s58,6881280
buffer_load_dwordx4 v6,s[4:7],s65 offen lds
s_add_u32 m0,s63,31744
s_add_u32 s65,s58,6979584
buffer_load_dwordx4 v6,s[4:7],s65 offen lds
s_add_u32 m0,s63,32768
s_add_u32 s65,s58,7077888
buffer_load_dwordx4 v6,s[4:7],s65 offen lds
s_add_u32 m0,s63,33792
s_add_u32 s65,s58,7176192
buffer_load_dwordx4 v6,s[4:7],s65 offen lds
s_add_u32 m0,s63,34816
s_add_u32 s65,s58,7274496
buffer_load_dwordx4 v6,s[4:7],s65 offen lds
s_add_u32 m0,s63,35840
s_add_u32 s65,s58,7372800
buffer_load_dwordx4 v6,s[4:7],s65 offen lds
s_add_u32 m0,s63,36864
s_add_u32 s65,s58,7471104
buffer_load_dwordx4 v6,s[4:7],s65 offen lds
s_add_u32 m0,s63,37888
s_add_u32 s65,s58,7569408
buffer_load_dwordx4 v6,s[4:7],s65 offen lds
s_add_u32 m0,s63,38912
s_add_u32 s65,s58,7667712
buffer_load_dwordx4 v6,s[4:7],s65 offen lds
s_add_u32 m0,s63,39936
s_add_u32 s65,s58,7766016
buffer_load_dwordx4 v6,s[4:7],s65 offen lds
s_waitcnt vmcnt(20)
v_bfe_u32 v9,v0,2,2
v_lshrrev_b32 v10,5,v0
v_lshl_add_u32 v9,v10,2,v9
v_mul_u32_u24 v9,128,v9
v_and_b32 v10,1,v0
v_lshl_add_u32 v9,v10,3,v9
v_bfe_u32 v10,v0,1,1
v_lshl_add_u32 v9,v10,5,v9
v_bfe_u32 v10,v0,4,1
v_lshl_add_u32 v9,v10,4,v9
v_add_u32 v7,s63,v9
ds_read_b64_tr_b16 a[80:81],v7 offset:0
ds_read_b64_tr_b16 a[82:83],v7 offset:2048
ds_read_b64_tr_b16 a[84:85],v7 offset:1024
ds_read_b64_tr_b16 a[86:87],v7 offset:3072
ds_read_b64_tr_b16 a[240:241],v7 offset:64
ds_read_b64_tr_b16 a[242:243],v7 offset:2112
ds_read_b64_tr_b16 a[244:245],v7 offset:1088
ds_read_b64_tr_b16 a[246:247],v7 offset:3136
ds_read_b64_tr_b16 a[88:89],v7 offset:4096
ds_read_b64_tr_b16 a[90:91],v7 offset:6144
ds_read_b64_tr_b16 a[92:93],v7 offset:5120
ds_read_b64_tr_b16 a[94:95],v7 offset:7168
s_waitcnt lgkmcnt(4)
ds_read_b64_tr_b16 a[248:249],v7 offset:4160
ds_read_b64_tr_b16 a[250:251],v7 offset:6208
ds_read_b64_tr_b16 a[252:253],v7 offset:5184
ds_read_b64_tr_b16 a[254:255],v7 offset:7232
ds_read_b64_tr_b16 a[96:97],v7 offset:8192
ds_read_b64_tr_b16 a[98:99],v7 offset:10240
ds_read_b64_tr_b16 a[100:101],v7 offset:9216
ds_read_b64_tr_b16 a[102:103],v7 offset:11264
ds_read_b64_tr_b16 v[192:193],v7 offset:8256
ds_read_b64_tr_b16 v[194:195],v7 offset:10304
ds_read_b64_tr_b16 v[196:197],v7 offset:9280
ds_read_b64_tr_b16 v[198:199],v7 offset:11328
s_waitcnt lgkmcnt(4)
ds_read_b64_tr_b16 a[104:105],v7 offset:12288
ds_read_b64_tr_b16 a[106:107],v7 offset:14336
ds_read_b64_tr_b16 a[108:109],v7 offset:13312
ds_read_b64_tr_b16 a[110:111],v7 offset:15360
ds_read_b64_tr_b16 v[200:201],v7 offset:12352
ds_read_b64_tr_b16 v[202:203],v7 offset:14400
ds_read_b64_tr_b16 v[204:205],v7 offset:13376
ds_read_b64_tr_b16 v[206:207],v7 offset:15424
ds_read_b64_tr_b16 a[112:113],v7 offset:16384
ds_read_b64_tr_b16 a[114:115],v7 offset:18432
ds_read_b64_tr_b16 a[116:117],v7 offset:17408
ds_read_b64_tr_b16 a[118:119],v7 offset:19456
s_waitcnt lgkmcnt(4)
ds_read_b64_tr_b16 v[208:209],v7 offset:16448
ds_read_b64_tr_b16 v[210:211],v7 offset:18496
ds_read_b64_tr_b16 v[212:213],v7 offset:17472
ds_read_b64_tr_b16 v[214:215],v7 offset:19520
s_waitcnt lgkmcnt(0)
s_waitcnt vmcnt(0)
v_bfe_u32 v9,v0,2,2
v_lshrrev_b32 v10,5,v0
v_lshl_add_u32 v9,v10,2,v9
v_mul_u32_u24 v9,128,v9
v_and_b32 v10,1,v0
v_lshl_add_u32 v9,v10,3,v9
v_bfe_u32 v10,v0,1,1
v_lshl_add_u32 v9,v10,5,v9
v_bfe_u32 v10,v0,4,1
v_lshl_add_u32 v9,v10,4,v9
v_add_u32 v7,s63,v9
ds_read_b64_tr_b16 a[120:121],v7 offset:20480
ds_read_b64_tr_b16 a[122:123],v7 offset:22528
ds_read_b64_tr_b16 a[124:125],v7 offset:21504
ds_read_b64_tr_b16 a[126:127],v7 offset:23552
ds_read_b64_tr_b16 v[216:217],v7 offset:20544
ds_read_b64_tr_b16 v[218:219],v7 offset:22592
ds_read_b64_tr_b16 v[220:221],v7 offset:21568
ds_read_b64_tr_b16 v[222:223],v7 offset:23616
ds_read_b64_tr_b16 a[128:129],v7 offset:24576
ds_read_b64_tr_b16 a[130:131],v7 offset:26624
ds_read_b64_tr_b16 a[132:133],v7 offset:25600
ds_read_b64_tr_b16 a[134:135],v7 offset:27648
s_waitcnt lgkmcnt(4)
ds_read_b64_tr_b16 v[224:225],v7 offset:24640
ds_read_b64_tr_b16 v[226:227],v7 offset:26688
ds_read_b64_tr_b16 v[228:229],v7 offset:25664
ds_read_b64_tr_b16 v[230:231],v7 offset:27712
ds_read_b64_tr_b16 a[136:137],v7 offset:28672
ds_read_b64_tr_b16 a[138:139],v7 offset:30720
ds_read_b64_tr_b16 a[140:141],v7 offset:29696
ds_read_b64_tr_b16 a[142:143],v7 offset:31744
ds_read_b64_tr_b16 v[232:233],v7 offset:28736
ds_read_b64_tr_b16 v[234:235],v7 offset:30784
ds_read_b64_tr_b16 v[236:237],v7 offset:29760
ds_read_b64_tr_b16 v[238:239],v7 offset:31808
s_waitcnt lgkmcnt(4)
ds_read_b64_tr_b16 a[144:145],v7 offset:32768
ds_read_b64_tr_b16 a[146:147],v7 offset:34816
ds_read_b64_tr_b16 a[148:149],v7 offset:33792
ds_read_b64_tr_b16 a[150:151],v7 offset:35840
ds_read_b64_tr_b16 v[240:241],v7 offset:32832
ds_read_b64_tr_b16 v[242:243],v7 offset:34880
ds_read_b64_tr_b16 v[244:245],v7 offset:33856
ds_read_b64_tr_b16 v[246:247],v7 offset:35904
ds_read_b64_tr_b16 a[152:153],v7 offset:36864
ds_read_b64_tr_b16 a[154:155],v7 offset:38912
ds_read_b64_tr_b16 a[156:157],v7 offset:37888
ds_read_b64_tr_b16 a[158:159],v7 offset:39936
s_waitcnt lgkmcnt(4)
ds_read_b64_tr_b16 v[248:249],v7 offset:36928
ds_read_b64_tr_b16 v[250:251],v7 offset:38976
ds_read_b64_tr_b16 v[252:253],v7 offset:37952
ds_read_b64_tr_b16 v[254:255],v7 offset:40000
s_waitcnt lgkmcnt(0)
v_mov_b32 v24,0x3f803f80
v_mov_b32 v25,0x3f803f80
v_mov_b32 v26,0x3f803f80
v_mov_b32 v27,0x3f803f80
s_nop 1
v_mfma_f32_32x32x16_bf16 v[120:135],a[0:3],v[24:27],0
v_mfma_f32_32x32x16_bf16 v[136:151],a[160:163],v[24:27],0
v_mfma_f32_32x32x16_bf16 v[120:135],a[4:7],v[24:27],v[120:135]
v_mfma_f32_32x32x16_bf16 v[136:151],a[164:167],v[24:27],v[136:151]
v_mfma_f32_32x32x16_bf16 v[120:135],a[8:11],v[24:27],v[120:135]
v_mfma_f32_32x32x16_bf16 v[136:151],a[168:171],v[24:27],v[136:151]
v_mfma_f32_32x32x16_bf16 v[120:135],a[12:15],v[24:27],v[120:135]
v_mfma_f32_32x32x16_bf16 v[136:151],a[172:175],v[24:27],v[136:151]
v_mfma_f32_32x32x16_bf16 v[120:135],a[16:19],v[24:27],v[120:135]
v_mfma_f32_32x32x16_bf16 v[136:151],a[176:179],v[24:27],v[136:151]
v_mfma_f32_32x32x16_bf16 v[120:135],a[20:23],v[24:27],v[120:135]
v_mfma_f32_32x32x16_bf16 v[136:151],a[180:183],v[24:27],v[136:151]
v_mfma_f32_32x32x16_bf16 v[120:135],a[24:27],v[24:27],v[120:135]
v_mfma_f32_32x32x16_bf16 v[136:151],a[184:187],v[24:27],v[136:151]
v_mfma_f32_32x32x16_bf16 v[120:135],a[28:31],v[24:27],v[120:135]
v_mfma_f32_32x32x16_bf16 v[136:151],a[188:191],v[24:27],v[136:151]
v_mfma_f32_32x32x16_bf16 v[120:135],a[32:35],v[24:27],v[120:135]
v_mfma_f32_32x32x16_bf16 v[136:151],a[192:195],v[24:27],v[136:151]
v_mfma_f32_32x32x16_bf16 v[120:135],a[36:39],v[24:27],v[120:135]
v_mfma_f32_32x32x16_bf16 v[136:151],a[196:199],v[24:27],v[136:151]
v_mfma_f32_32x32x16_bf16 v[120:135],a[40:43],v[24:27],v[120:135]
v_mfma_f32_32x32x16_bf16 v[136:151],a[200:203],v[24:27],v[136:151]
v_mfma_f32_32x32x16_bf16 v[120:135],a[44:47],v[24:27],v[120:135]
v_mfma_f32_32x32x16_bf16 v[136:151],a[204:207],v[24:27],v[136:151]
v_mfma_f32_32x32x16_bf16 v[120:135],a[48:51],v[24:27],v[120:135]
v_mfma_f32_32x32x16_bf16 v[136:151],a[208:211],v[24:27],v[136:151]
v_mfma_f32_32x32x16_bf16 v[120:135],a[52:55],v[24:27],v[120:135]
v_mfma_f32_32x32x16_bf16 v[136:151],a[212:215],v[24:27],v[136:151]
v_mfma_f32_32x32x16_bf16 v[120:135],a[56:59],v[24:27],v[120:135]
v_mfma_f32_32x32x16_bf16 v[136:151],a[216:219],v[24:27],v[136:151]
v_mfma_f32_32x32x16_bf16 v[120:135],a[60:63],v[24:27],v[120:135]
v_mfma_f32_32x32x16_bf16 v[136:151],a[220:223],v[24:27],v[136:151]
v_mfma_f32_32x32x16_bf16 v[120:135],a[64:67],v[24:27],v[120:135]
v_mfma_f32_32x32x16_bf16 v[136:151],a[224:227],v[24:27],v[136:151]
v_mfma_f32_32x32x16_bf16 v[120:135],a[68:71],v[24:27],v[120:135]
v_mfma_f32_32x32x16_bf16 v[136:151],a[228:231],v[24:27],v[136:151]
v_mfma_f32_32x32x16_bf16 v[120:135],a[72:75],v[24:27],v[120:135]
v_mfma_f32_32x32x16_bf16 v[136:151],a[232:235],v[24:27],v[136:151]
v_mfma_f32_32x32x16_bf16 v[120:135],a[76:79],v[24:27],v[120:135]
v_mfma_f32_32x32x16_bf16 v[136:151],a[236:239],v[24:27],v[136:151]
v_mfma_f32_32x32x16_bf16 v[120:135],a[80:83],v[24:27],v[120:135]
v_mfma_f32_32x32x16_bf16 v[136:151],a[240:243],v[24:27],v[136:151]
v_mfma_f32_32x32x16_bf16 v[120:135],a[84:87],v[24:27],v[120:135]
v_mfma_f32_32x32x16_bf16 v[136:151],a[244:247],v[24:27],v[136:151]
v_mfma_f32_32x32x16_bf16 v[120:135],a[88:91],v[24:27],v[120:135]
v_mfma_f32_32x32x16_bf16 v[136:151],a[248:251],v[24:27],v[136:151]
v_mfma_f32_32x32x16_bf16 v[120:135],a[92:95],v[24:27],v[120:135]
v_mfma_f32_32x32x16_bf16 v[136:151],a[252:255],v[24:27],v[136:151]
v_mfma_f32_32x32x16_bf16 v[120:135],a[96:99],v[24:27],v[120:135]
v_mfma_f32_32x32x16_bf16 v[136:151],v[192:195],v[24:27],v[136:151]
v_mfma_f32_32x32x16_bf16 v[120:135],a[100:103],v[24:27],v[120:135]
v_mfma_f32_32x32x16_bf16 v[136:151],v[196:199],v[24:27],v[136:151]
v_mfma_f32_32x32x16_bf16 v[120:135],a[104:107],v[24:27],v[120:135]
v_mfma_f32_32x32x16_bf16 v[136:151],v[200:203],v[24:27],v[136:151]
v_mfma_f32_32x32x16_bf16 v[120:135],a[108:111],v[24:27],v[120:135]
v_mfma_f32_32x32x16_bf16 v[136:151],v[204:207],v[24:27],v[136:151]
v_mfma_f32_32x32x16_bf16 v[120:135],a[112:115],v[24:27],v[120:135]
v_mfma_f32_32x32x16_bf16 v[136:151],v[208:211],v[24:27],v[136:151]
v_mfma_f32_32x32x16_bf16 v[120:135],a[116:119],v[24:27],v[120:135]
v_mfma_f32_32x32x16_bf16 v[136:151],v[212:215],v[24:27],v[136:151]
v_mfma_f32_32x32x16_bf16 v[120:135],a[120:123],v[24:27],v[120:135]
v_mfma_f32_32x32x16_bf16 v[136:151],v[216:219],v[24:27],v[136:151]
v_mfma_f32_32x32x16_bf16 v[120:135],a[124:127],v[24:27],v[120:135]
v_mfma_f32_32x32x16_bf16 v[136:151],v[220:223],v[24:27],v[136:151]
v_mfma_f32_32x32x16_bf16 v[120:135],a[128:131],v[24:27],v[120:135]
v_mfma_f32_32x32x16_bf16 v[136:151],v[224:227],v[24:27],v[136:151]
v_mfma_f32_32x32x16_bf16 v[120:135],a[132:135],v[24:27],v[120:135]
v_mfma_f32_32x32x16_bf16 v[136:151],v[228:231],v[24:27],v[136:151]
v_mfma_f32_32x32x16_bf16 v[120:135],a[136:139],v[24:27],v[120:135]
v_mfma_f32_32x32x16_bf16 v[136:151],v[232:235],v[24:27],v[136:151]
v_mfma_f32_32x32x16_bf16 v[120:135],a[140:143],v[24:27],v[120:135]
v_mfma_f32_32x32x16_bf16 v[136:151],v[236:239],v[24:27],v[136:151]
v_mfma_f32_32x32x16_bf16 v[120:135],a[144:147],v[24:27],v[120:135]
v_mfma_f32_32x32x16_bf16 v[136:151],v[240:243],v[24:27],v[136:151]
v_mfma_f32_32x32x16_bf16 v[120:135],a[148:151],v[24:27],v[120:135]
v_mfma_f32_32x32x16_bf16 v[136:151],v[244:247],v[24:27],v[136:151]
v_mfma_f32_32x32x16_bf16 v[120:135],a[152:155],v[24:27],v[120:135]
v_mfma_f32_32x32x16_bf16 v[136:151],v[248:251],v[24:27],v[136:151]
v_mfma_f32_32x32x16_bf16 v[120:135],a[156:159],v[24:27],v[120:135]
v_mfma_f32_32x32x16_bf16 v[136:151],v[252:255],v[24:27],v[136:151]
s_barrier
s_lshl_b32 s3,s49,2
v_mov_b32 v7,s3
s_nop 8
ibw_206:
buffer_load_dword v6,v7,s[12:15],0 offen sc1
s_waitcnt vmcnt(0)
v_cmp_ne_u32 vcc,256,v6
s_nop 0
s_cbranch_vccz ok_207
s_sleep 8
s_sub_u32 s47,s47,1
s_cbranch_scc1 ABORT
s_branch ibw_206
ok_207:
s_cmp_lg_u32 s49,0
s_cbranch_scc1 ibok_208
v_and_b32 v7,7,v0
v_lshlrev_b32 v7,2,v7
buffer_load_dword v6,v7,s[12:15],0 offen offset:32 sc1
s_waitcnt vmcnt(0)
v_cmp_ne_u32 vcc,32,v6
s_nop 0
s_cbranch_vccz ibok_208
s_barrier
s_mov_b32 s49,1
s_mov_b32 s3,s2
s_load_dwordx16 s[16:31],s[0:1],0
s_load_dwordx8 s[32:39],s[0:1],64
s_waitcnt lgkmcnt(0)
s_branch DISPATCH
ibok_208:
s_mov_b32 s50,0
s_mov_b32 s32,0
s_mov_b32 s57,0
s_mov_b32 s59,2147483648
s_mov_b32 s82,2147483648
s_mov_b32 s39,2147483648
v_mov_b32 v22,94208
s_mov_b32 s72,0
s_mov_b32 s73,0
s_mov_b32 s78,0
s_mov_b32 s79,0
s_cmp_eq_u32 s46,0
s_cselect_b32 s40,0,2147483648
s_lshl_b32 s60,s46,3
v_add_u32 v13,s60,v22
s_mov_b32 s83,s100
s_lshl_b32 s41,s78,9
s_add_u32 s41,s41,s40
s_lshl_b32 s35,s79,9
s_add_u32 s35,s35,s40
s_add_u32 s35,s35,32768
s_branch QKVQ_COLD0
QKVQ_B0:
s_waitcnt lgkmcnt(3)
v_mfma_f32_32x32x16_bf16 v[56:71],a[0:3],v[24:27],0
ds_read_b128 v[44:47],v17 offset:4096
v_add_u32 v189,s57,v188
v_mfma_f32_32x32x16_bf16 v[72:87],a[160:163],v[24:27],0
v_add_u32 v8,0x800,v189
s_sub_u32 s66,46080,s57
s_lshl_b32 s60,s33,6
s_add_u32 s60,s60,s34
s_mul_i32 s60,s60,46080
s_add_u32 s60,s60,s37
v_mfma_f32_32x32x16_bf16 v[56:71],a[4:7],v[28:31],v[56:71]
ds_read_b128 v[48:51],v16 offset:6144
ds_read2_b64 v[156:159],v189 offset0:0 offset1:32
s_add_u32 s60,s60,206569472
v_mfma_f32_32x32x16_bf16 v[72:87],a[164:167],v[28:31],v[72:87]
ds_read2_b64 v[160:163],v189 offset0:64 offset1:96
s_cmp_eq_u32 s33,0
s_cselect_b32 s67,2147483648,s60
s_mul_i32 s61,s46,10240
s_waitcnt lgkmcnt(5)
v_mfma_f32_32x32x16_bf16 v[56:71],a[8:11],v[32:35],v[56:71]
ds_read_b128 v[52:55],v17 offset:6144
ds_read2_b64 v[164:167],v189 offset0:128 offset1:160
s_add_u32 s60,s60,s61
s_add_u32 s61,s61,s66
v_mfma_f32_32x32x16_bf16 v[72:87],a[168:171],v[32:35],v[72:87]
ds_read2_b64 v[168:171],v189 offset0:192 offset1:224
s_add_u32 m0,s61,0
s_add_u32 s63,s60,0
buffer_load_dwordx4 v1,s[8:11],s63 offen sc1 lds
v_mfma_f32_32x32x16_bf16 v[56:71],a[12:15],v[36:39],v[56:71]
ds_read_b128 v[24:27],v16 offset:8192
ds_read2_b64 v[172:175],v8 offset0:0 offset1:32
s_mul_i32 s74,s73,393216
s_add_u32 s74,s74,s39
v_mfma_f32_32x32x16_bf16 v[72:87],a[172:175],v[36:39],v[72:87]
s_add_u32 s74,s74,s70
v_fma_f32 v88,-v176,v120,v88
v_fma_f32 v89,-v176,v121,v89
v_fma_f32 v90,-v176,v122,v90
v_fma_f32 v91,-v176,v123,v91
s_waitcnt lgkmcnt(8)
v_mfma_f32_32x32x16_bf16 v[56:71],a[16:19],v[40:43],v[56:71]
ds_read_b128 v[28:31],v17 offset:8192
buffer_load_dwordx4 v1,s[8:11],s63 offen offset:1024 sc1 lds
v_fma_f32 v92,-v176,v124,v92
v_fma_f32 v93,-v176,v125,v93
v_mfma_f32_32x32x16_bf16 v[72:87],a[176:179],v[40:43],v[72:87]
v_fma_f32 v94,-v176,v126,v94
v_fma_f32 v95,-v176,v127,v95
v_mul_f32 v88,v88,v177
v_mul_f32 v89,v89,v177
v_mul_f32 v90,v90,v177
v_mfma_f32_32x32x16_bf16 v[56:71],a[20:23],v[44:47],v[56:71]
ds_read_b128 v[32:35],v16 offset:10240
s_mov_b32 s53,s33
s_mov_b32 s54,s34
s_add_u32 s79,s79,s33
s_or_b32 s65,s37,s33
v_mfma_f32_32x32x16_bf16 v[72:87],a[180:183],v[44:47],v[72:87]
buffer_load_dwordx4 v1,s[8:11],s63 offen offset:2048 sc1 lds
s_cmp_eq_u32 s65,0
s_addc_u32 s78,s78,0
s_lshl_b32 s41,s78,9
s_waitcnt lgkmcnt(6)
v_mfma_f32_32x32x16_bf16 v[56:71],a[24:27],v[48:51],v[56:71]
ds_read_b128 v[36:39],v17 offset:10240
s_add_u32 s41,s41,s40
s_lshl_b32 s35,s79,9
s_add_u32 s35,s35,s40
s_add_u32 s35,s35,32768
v_mfma_f32_32x32x16_bf16 v[72:87],a[184:187],v[48:51],v[72:87]
v_mul_f32 v91,v91,v177
v_mul_f32 v92,v92,v177
v_mul_f32 v93,v93,v177
v_mul_f32 v94,v94,v177
v_mul_f32 v95,v95,v177
v_mfma_f32_32x32x16_bf16 v[56:71],a[28:31],v[52:55],v[56:71]
ds_read_b128 v[40:43],v16 offset:12288
buffer_load_dwordx4 v1,s[8:11],s63 offen offset:3072 sc1 lds
s_add_u32 m0,s61,4096
s_add_u32 s63,s60,4096
v_mfma_f32_32x32x16_bf16 v[72:87],a[188:191],v[52:55],v[72:87]
v_cvt_pk_bf16_f32 v88,v88,v89
v_cvt_pk_bf16_f32 v89,v90,v91
v_cvt_pk_bf16_f32 v90,v92,v93
v_cvt_pk_bf16_f32 v91,v94,v95
v_fma_f32 v96,-v176,v128,v96
s_waitcnt lgkmcnt(3)
v_mfma_f32_32x32x16_bf16 v[56:71],a[32:35],v[24:27],v[56:71]
ds_read_b128 v[44:47],v17 offset:12288
v_fma_f32 v97,-v176,v129,v97
v_fma_f32 v98,-v176,v130,v98
v_fma_f32 v99,-v176,v131,v99
v_fma_f32 v100,-v176,v132,v100
v_mfma_f32_32x32x16_bf16 v[72:87],a[192:195],v[24:27],v[72:87]
buffer_load_dwordx4 v1,s[8:11],s63 offen sc1 lds
v_fma_f32 v101,-v176,v133,v101
v_fma_f32 v102,-v176,v134,v102
v_fma_f32 v103,-v176,v135,v103
v_mul_f32 v96,v96,v177
v_mfma_f32_32x32x16_bf16 v[56:71],a[36:39],v[28:31],v[56:71]
ds_read_b128 v[48:51],v16 offset:14336
v_mul_f32 v97,v97,v177
v_mul_f32 v98,v98,v177
v_mul_f32 v99,v99,v177
v_mul_f32 v100,v100,v177
v_mfma_f32_32x32x16_bf16 v[72:87],a[196:199],v[28:31],v[72:87]
v_mul_f32 v101,v101,v177
v_mul_f32 v102,v102,v177
v_mul_f32 v103,v103,v177
v_cvt_pk_bf16_f32 v96,v96,v97
v_cvt_pk_bf16_f32 v97,v98,v99
s_waitcnt lgkmcnt(3)
v_mfma_f32_32x32x16_bf16 v[56:71],a[40:43],v[32:35],v[56:71]
ds_read_b128 v[52:55],v17 offset:14336
buffer_load_dwordx4 v1,s[8:11],s63 offen offset:1024 sc1 lds
v_cvt_pk_bf16_f32 v98,v100,v101
v_cvt_pk_bf16_f32 v99,v102,v103
v_mfma_f32_32x32x16_bf16 v[72:87],a[200:203],v[32:35],v[72:87]
v_fma_f32 v104,-v176,v136,v104
v_fma_f32 v105,-v176,v137,v105
v_fma_f32 v106,-v176,v138,v106
v_fma_f32 v107,-v176,v139,v107
v_fma_f32 v108,-v176,v140,v108
v_mfma_f32_32x32x16_bf16 v[56:71],a[44:47],v[36:39],v[56:71]
ds_read_b128 v[24:27],v16 offset:16384
v_fma_f32 v109,-v176,v141,v109
v_fma_f32 v110,-v176,v142,v110
v_fma_f32 v111,-v176,v143,v111
v_mul_f32 v104,v104,v177
v_mfma_f32_32x32x16_bf16 v[72:87],a[204:207],v[36:39],v[72:87]
buffer_load_dwordx4 v1,s[8:11],s63 offen offset:2048 sc1 lds
v_mul_f32 v105,v105,v177
v_mul_f32 v106,v106,v177
v_mul_f32 v107,v107,v177
s_waitcnt lgkmcnt(3)
v_mfma_f32_32x32x16_bf16 v[56:71],a[48:51],v[40:43],v[56:71]
ds_read_b128 v[28:31],v17 offset:16384
v_mul_f32 v108,v108,v177
v_mul_f32 v109,v109,v177
v_mul_f32 v110,v110,v177
v_mul_f32 v111,v111,v177
v_mfma_f32_32x32x16_bf16 v[72:87],a[208:211],v[40:43],v[72:87]
v_cvt_pk_bf16_f32 v104,v104,v105
v_cvt_pk_bf16_f32 v105,v106,v107
v_cvt_pk_bf16_f32 v106,v108,v109
v_cvt_pk_bf16_f32 v107,v110,v111
v_fma_f32 v112,-v176,v144,v112
v_mfma_f32_32x32x16_bf16 v[56:71],a[52:55],v[44:47],v[56:71]
ds_read_b128 v[32:35],v16 offset:18432
buffer_load_dwordx4 v1,s[8:11],s63 offen offset:3072 sc1 lds
s_add_u32 m0,s61,8192
s_add_u32 s63,s60,8192
v_mfma_f32_32x32x16_bf16 v[72:87],a[212:215],v[44:47],v[72:87]
v_fma_f32 v113,-v176,v145,v113
v_fma_f32 v114,-v176,v146,v114
v_fma_f32 v115,-v176,v147,v115
v_fma_f32 v116,-v176,v148,v116
v_fma_f32 v117,-v176,v149,v117
s_waitcnt lgkmcnt(3)
v_mfma_f32_32x32x16_bf16 v[56:71],a[56:59],v[48:51],v[56:71]
ds_read_b128 v[36:39],v17 offset:18432
v_fma_f32 v118,-v176,v150,v118
v_fma_f32 v119,-v176,v151,v119
v_mul_f32 v112,v112,v177
v_mul_f32 v113,v113,v177
v_mfma_f32_32x32x16_bf16 v[72:87],a[216:219],v[48:51],v[72:87]
buffer_load_dwordx4 v1,s[8:11],s63 offen sc1 lds
v_mul_f32 v114,v114,v177
v_mul_f32 v115,v115,v177
v_mul_f32 v116,v116,v177
v_mul_f32 v117,v117,v177
v_mfma_f32_32x32x16_bf16 v[56:71],a[60:63],v[52:55],v[56:71]
ds_read_b128 v[40:43],v16 offset:20480
s_waitcnt vmcnt(9)
s_mov_b64 exec,1
buffer_store_dword v5,v1,s[8:11],s59 offen sc1
s_mov_b64 exec,-1
s_mov_b32 s59,2147483648
v_mfma_f32_32x32x16_bf16 v[72:87],a[220:223],v[52:55],v[72:87]
v_mul_f32 v118,v118,v177
v_mul_f32 v119,v119,v177
v_cvt_pk_bf16_f32 v112,v112,v113
v_cvt_pk_bf16_f32 v113,v114,v115
v_cvt_pk_bf16_f32 v114,v116,v117
s_waitcnt lgkmcnt(3)
v_mfma_f32_32x32x16_bf16 v[56:71],a[64:67],v[24:27],v[56:71]
ds_read_b128 v[44:47],v17 offset:20480
buffer_load_dwordx4 v1,s[8:11],s63 offen offset:1024 sc1 lds
s_lshl_b32 s62,s46,10
s_add_u32 s62,s62,40960
v_mfma_f32_32x32x16_bf16 v[72:87],a[224:227],v[24:27],v[72:87]
s_add_u32 m0,s66,s62
s_add_u32 s63,s67,s62
v_cvt_pk_bf16_f32 v115,v118,v119
s_lshl_b32 s82,s72,6
s_add_u32 s82,s82,s73
s_lshl_b32 s82,s82,9
v_mfma_f32_32x32x16_bf16 v[56:71],a[68:71],v[28:31],v[56:71]
ds_read_b128 v[48:51],v16 offset:22528
s_add_u32 s82,s82,s71
s_lshl_b32 s75,s69,2
s_add_u32 s82,s82,s75
s_add_u32 s82,s82,s39
v_mfma_f32_32x32x16_bf16 v[72:87],a[228:231],v[28:31],v[72:87]
buffer_load_dwordx4 v1,s[8:11],s63 offen sc1 lds
s_add_u32 m0,s66,45056
s_add_u32 s63,s67,45056
s_waitcnt lgkmcnt(3)
v_mfma_f32_32x32x16_bf16 v[56:71],a[72:75],v[32:35],v[56:71]
ds_read_b128 v[52:55],v17 offset:22528
buffer_load_dword v3,v2,s[8:11],s35 offen sc1
buffer_load_dword v14,v4,s[8:11],s41 offen sc1
v_mfma_f32_32x32x16_bf16 v[72:87],a[232:235],v[32:35],v[72:87]
v_add_f32 v156,v156,v166
v_add_f32 v157,v157,v167
v_add_f32 v158,v158,v168
v_add_f32 v159,v159,v169
v_add_f32 v160,v160,v170
v_mfma_f32_32x32x16_bf16 v[56:71],a[76:79],v[36:39],v[56:71]
ds_read_b128 v[24:27],v16 offset:24576
buffer_load_dwordx4 v1,s[8:11],s63 offen sc1 lds
v_add_f32 v161,v161,v171
v_add_f32 v162,v162,v172
v_mfma_f32_32x32x16_bf16 v[72:87],a[236:239],v[36:39],v[72:87]
v_add_f32 v163,v163,v173
v_add_f32 v164,v164,v174
v_add_f32 v165,v165,v175
v_add_f32 v156,v156,v158
v_add_f32 v157,v157,v159
s_waitcnt lgkmcnt(3)
v_mfma_f32_32x32x16_bf16 v[56:71],a[80:83],v[40:43],v[56:71]
ds_read_b128 v[28:31],v17 offset:24576
buffer_store_dwordx4 v[88:91],v20,s[8:11],s74 offen sc1
v_add_f32 v160,v160,v162
v_add_f32 v161,v161,v163
v_mfma_f32_32x32x16_bf16 v[72:87],a[240:243],v[40:43],v[72:87]
v_add_f32 v156,v156,v160
v_add_f32 v157,v157,v161
v_add_f32 v156,v156,v164
v_add_f32 v157,v157,v165
v_mov_b32 v158,v156
v_mfma_f32_32x32x16_bf16 v[56:71],a[84:87],v[44:47],v[56:71]
ds_read_b128 v[32:35],v16 offset:26624
buffer_store_dwordx4 v[96:99],v21,s[8:11],s74 offen sc1
v_mov_b32 v159,v157
v_permlane32_swap_b32 v156,v158
v_mfma_f32_32x32x16_bf16 v[72:87],a[244:247],v[44:47],v[72:87]
v_permlane32_swap_b32 v157,v159
v_add_f32 v176,v156,v158
v_add_f32 v177,v157,v159
v_mul_f32 v176,0x3acccccd,v176
v_mul_f32 v177,0x3acccccd,v177
s_waitcnt lgkmcnt(3)
v_mfma_f32_32x32x16_bf16 v[56:71],a[88:91],v[48:51],v[56:71]
ds_read_b128 v[36:39],v17 offset:26624
buffer_store_dwordx4 v[104:107],v20,s[8:11],s74 offen offset:2048 sc1
v_fma_f32 v177,-v176,v176,v177
v_max_f32 v177,0,v177
v_mfma_f32_32x32x16_bf16 v[72:87],a[248:251],v[48:51],v[72:87]
v_cvt_pk_bf16_f32 v8,v176,v177
v_lshlrev_b32 v176,16,v8
v_and_b32 v177,0xffff0000,v8
v_add_f32 v177,0x3727c5ac,v177
v_cvt_pk_bf16_f32 v8,v177,v177
v_mfma_f32_32x32x16_bf16 v[56:71],a[92:95],v[52:55],v[56:71]
ds_read_b128 v[40:43],v16 offset:28672
buffer_store_dwordx4 v[112:115],v21,s[8:11],s74 offen offset:2048 sc1
v_lshlrev_b32 v177,16,v8
v_mfma_f32_32x32x16_bf16 v[72:87],a[252:255],v[52:55],v[72:87]
v_sqrt_f32 v177,v177
s_nop 0
v_cvt_pk_bf16_f32 v8,v177,v177
v_lshlrev_b32 v177,16,v8
s_waitcnt lgkmcnt(3)
v_mfma_f32_32x32x16_bf16 v[56:71],a[96:99],v[24:27],v[56:71]
ds_read_b128 v[44:47],v17 offset:28672
v_rcp_f32 v177,v177
s_cmp_eq_u32 s51,0
s_cselect_b64 s[76:77],-1,0
v_mfma_f32_32x32x16_bf16 v[72:87],v[192:195],v[24:27],v[72:87]
v_cndmask_b32 v176,v176,0,s[76:77]
v_cndmask_b32 v177,v177,1.0,s[76:77]
s_mov_b32 s72,s51
s_mov_b32 s73,s52
v_mfma_f32_32x32x16_bf16 v[56:71],a[100:103],v[28:31],v[56:71]
ds_read_b128 v[48:51],v16 offset:30720
v_mfma_f32_32x32x16_bf16 v[72:87],v[196:199],v[28:31],v[72:87]
s_waitcnt lgkmcnt(3)
v_mfma_f32_32x32x16_bf16 v[56:71],a[104:107],v[32:35],v[56:71]
ds_read_b128 v[52:55],v17 offset:30720
v_mfma_f32_32x32x16_bf16 v[72:87],v[200:203],v[32:35],v[72:87]
v_mfma_f32_32x32x16_bf16 v[56:71],a[108:111],v[36:39],v[56:71]
ds_read_b128 v[24:27],v16 offset:32768
v_mfma_f32_32x32x16_bf16 v[72:87],v[204:207],v[36:39],v[72:87]
s_waitcnt lgkmcnt(3)
v_mfma_f32_32x32x16_bf16 v[56:71],a[112:115],v[40:43],v[56:71]
ds_read_b128 v[28:31],v17 offset:32768
v_mfma_f32_32x32x16_bf16 v[72:87],v[208:211],v[40:43],v[72:87]
v_mfma_f32_32x32x16_bf16 v[56:71],a[116:119],v[44:47],v[56:71]
ds_read_b128 v[32:35],v16 offset:34816
v_mfma_f32_32x32x16_bf16 v[72:87],v[212:215],v[44:47],v[72:87]
s_waitcnt lgkmcnt(3)
v_mfma_f32_32x32x16_bf16 v[56:71],a[120:123],v[48:51],v[56:71]
ds_read_b128 v[36:39],v17 offset:34816
v_mfma_f32_32x32x16_bf16 v[72:87],v[216:219],v[48:51],v[72:87]
v_mfma_f32_32x32x16_bf16 v[56:71],a[124:127],v[52:55],v[56:71]
ds_read_b128 v[40:43],v16 offset:36864
v_mfma_f32_32x32x16_bf16 v[72:87],v[220:223],v[52:55],v[72:87]
s_waitcnt lgkmcnt(3)
v_mfma_f32_32x32x16_bf16 v[56:71],a[128:131],v[24:27],v[56:71]
ds_read_b128 v[44:47],v17 offset:36864
s_waitcnt vmcnt(4)
v_cmp_eq_u32 vcc,0,v14
s_cmp_eq_u64 vcc,0
s_cselect_b32 s36,0,2147483648
v_mfma_f32_32x32x16_bf16 v[72:87],v[224:227],v[24:27],v[72:87]
v_cmp_eq_u32 vcc,0,v3
s_cmp_lt_u32 s78,64
s_cselect_b32 s36,s36,2147483648
s_cmp_eq_u64 vcc,0
s_cselect_b32 s60,1,s36
v_mfma_f32_32x32x16_bf16 v[56:71],a[132:135],v[28:31],v[56:71]
ds_read_b128 v[48:51],v16 offset:38912
s_cmp_lt_u32 s79,64
s_cselect_b32 s60,s60,s36
s_sub_u32 s61,s78,s79
s_or_b32 s61,s61,s36
v_mfma_f32_32x32x16_bf16 v[72:87],v[228:231],v[28:31],v[72:87]
s_cmp_lt_u32 s61,16
s_cselect_b32 s36,0,s60
v_mov_b32 v23,s36
s_waitcnt lgkmcnt(3)
v_mfma_f32_32x32x16_bf16 v[56:71],a[136:139],v[32:35],v[56:71]
ds_read_b128 v[52:55],v17 offset:38912
ds_write_b32 v13,v23
v_mfma_f32_32x32x16_bf16 v[72:87],v[232:235],v[32:35],v[72:87]
s_waitcnt lgkmcnt(0)
s_barrier
ds_read_b32 v23,v22
v_mfma_f32_32x32x16_bf16 v[56:71],a[140:143],v[36:39],v[56:71]
ds_read_b128 v[24:27],v18 offset:0
s_cmp_lt_u32 s50,2
s_cselect_b32 s42,1,0
s_cmp_ge_u32 s78,64
s_cselect_b32 s42,1,s42
v_mfma_f32_32x32x16_bf16 v[72:87],v[236:239],v[36:39],v[72:87]
s_or_b32 s42,s42,s37
s_mov_b32 s39,0
s_add_u32 s50,s50,1
s_sub_u32 s57,46080,s57
s_mov_b32 s51,s53
s_mov_b32 s52,s54
v_mfma_f32_32x32x16_bf16 v[56:71],a[144:147],v[40:43],v[56:71]
ds_read_b128 v[28:31],v19 offset:0
v_mfma_f32_32x32x16_bf16 v[72:87],v[240:243],v[40:43],v[72:87]
v_mfma_f32_32x32x16_bf16 v[56:71],a[148:151],v[44:47],v[56:71]
ds_read_b128 v[32:35],v18 offset:2048
s_waitcnt vmcnt(0)
s_mov_b64 exec,1
buffer_store_dword v5,v1,s[8:11],s82 offen sc1
s_mov_b64 exec,-1
s_mov_b32 s82,2147483648
v_mfma_f32_32x32x16_bf16 v[72:87],v[244:247],v[44:47],v[72:87]
s_waitcnt lgkmcnt(3)
v_readfirstlane_b32 s38,v23
s_and_b32 s37,s38,2147483648
s_and_b32 s33,s38,1
s_cselect_b32 s34,s79,s78
s_cmp_lg_u32 s42,0
v_mfma_f32_32x32x16_bf16 v[56:71],a[152:155],v[48:51],v[56:71]
ds_read_b128 v[36:39],v19 offset:2048
v_mfma_f32_32x32x16_bf16 v[72:87],v[248:251],v[48:51],v[72:87]
v_mfma_f32_32x32x16_bf16 v[56:71],a[156:159],v[52:55],v[56:71]
ds_read_b128 v[40:43],v18 offset:4096
v_mfma_f32_32x32x16_bf16 v[72:87],v[252:255],v[52:55],v[72:87]
s_cbranch_scc1 QKVQ_S0
QKVQ_B1:
s_waitcnt lgkmcnt(3)
v_mfma_f32_32x32x16_bf16 v[88:103],a[0:3],v[24:27],0
ds_read_b128 v[44:47],v19 offset:4096
v_add_u32 v189,s57,v188
v_mfma_f32_32x32x16_bf16 v[104:119],a[160:163],v[24:27],0
v_add_u32 v8,0x800,v189
s_sub_u32 s66,46080,s57
s_lshl_b32 s60,s33,6
s_add_u32 s60,s60,s34
s_mul_i32 s60,s60,46080
s_add_u32 s60,s60,s37
v_mfma_f32_32x32x16_bf16 v[88:103],a[4:7],v[28:31],v[88:103]
ds_read_b128 v[48:51],v18 offset:6144
ds_read2_b64 v[156:159],v189 offset0:0 offset1:32
s_add_u32 s60,s60,206569472
v_mfma_f32_32x32x16_bf16 v[104:119],a[164:167],v[28:31],v[104:119]
ds_read2_b64 v[160:163],v189 offset0:64 offset1:96
s_cmp_eq_u32 s33,0
s_cselect_b32 s67,2147483648,s60
s_mul_i32 s61,s46,10240
s_waitcnt lgkmcnt(5)
v_mfma_f32_32x32x16_bf16 v[88:103],a[8:11],v[32:35],v[88:103]
ds_read_b128 v[52:55],v19 offset:6144
ds_read2_b64 v[164:167],v189 offset0:128 offset1:160
s_add_u32 s60,s60,s61
s_add_u32 s61,s61,s66
v_mfma_f32_32x32x16_bf16 v[104:119],a[168:171],v[32:35],v[104:119]
ds_read2_b64 v[168:171],v189 offset0:192 offset1:224
s_add_u32 m0,s61,0
s_add_u32 s63,s60,0
buffer_load_dwordx4 v1,s[8:11],s63 offen sc1 lds
v_mfma_f32_32x32x16_bf16 v[88:103],a[12:15],v[36:39],v[88:103]
ds_read_b128 v[24:27],v18 offset:8192
ds_read2_b64 v[172:175],v8 offset0:0 offset1:32
s_mul_i32 s74,s73,393216
s_add_u32 s74,s74,s39
v_mfma_f32_32x32x16_bf16 v[104:119],a[172:175],v[36:39],v[104:119]
s_add_u32 s74,s74,s70
v_fma_f32 v56,-v176,v120,v56
v_fma_f32 v57,-v176,v121,v57
v_fma_f32 v58,-v176,v122,v58
v_fma_f32 v59,-v176,v123,v59
s_waitcnt lgkmcnt(8)
v_mfma_f32_32x32x16_bf16 v[88:103],a[16:19],v[40:43],v[88:103]
ds_read_b128 v[28:31],v19 offset:8192
buffer_load_dwordx4 v1,s[8:11],s63 offen offset:1024 sc1 lds
v_fma_f32 v60,-v176,v124,v60
v_fma_f32 v61,-v176,v125,v61
v_mfma_f32_32x32x16_bf16 v[104:119],a[176:179],v[40:43],v[104:119]
v_fma_f32 v62,-v176,v126,v62
v_fma_f32 v63,-v176,v127,v63
v_mul_f32 v56,v56,v177
v_mul_f32 v57,v57,v177
v_mul_f32 v58,v58,v177
v_mfma_f32_32x32x16_bf16 v[88:103],a[20:23],v[44:47],v[88:103]
ds_read_b128 v[32:35],v18 offset:10240
s_mov_b32 s53,s33
s_mov_b32 s54,s34
s_add_u32 s79,s79,s33
s_or_b32 s65,s37,s33
v_mfma_f32_32x32x16_bf16 v[104:119],a[180:183],v[44:47],v[104:119]
buffer_load_dwordx4 v1,s[8:11],s63 offen offset:2048 sc1 lds
s_cmp_eq_u32 s65,0
s_addc_u32 s78,s78,0
s_lshl_b32 s41,s78,9
s_waitcnt lgkmcnt(6)
v_mfma_f32_32x32x16_bf16 v[88:103],a[24:27],v[48:51],v[88:103]
ds_read_b128 v[36:39],v19 offset:10240
s_add_u32 s41,s41,s40
s_lshl_b32 s35,s79,9
s_add_u32 s35,s35,s40
s_add_u32 s35,s35,32768
v_mfma_f32_32x32x16_bf16 v[104:119],a[184:187],v[48:51],v[104:119]
v_mul_f32 v59,v59,v177
v_mul_f32 v60,v60,v177
v_mul_f32 v61,v61,v177
v_mul_f32 v62,v62,v177
v_mul_f32 v63,v63,v177
v_mfma_f32_32x32x16_bf16 v[88:103],a[28:31],v[52:55],v[88:103]
ds_read_b128 v[40:43],v18 offset:12288
buffer_load_dwordx4 v1,s[8:11],s63 offen offset:3072 sc1 lds
s_add_u32 m0,s61,4096
s_add_u32 s63,s60,4096
v_mfma_f32_32x32x16_bf16 v[104:119],a[188:191],v[52:55],v[104:119]
v_cvt_pk_bf16_f32 v56,v56,v57
v_cvt_pk_bf16_f32 v57,v58,v59
v_cvt_pk_bf16_f32 v58,v60,v61
v_cvt_pk_bf16_f32 v59,v62,v63
v_fma_f32 v64,-v176,v128,v64
s_waitcnt lgkmcnt(3)
v_mfma_f32_32x32x16_bf16 v[88:103],a[32:35],v[24:27],v[88:103]
ds_read_b128 v[44:47],v19 offset:12288
v_fma_f32 v65,-v176,v129,v65
v_fma_f32 v66,-v176,v130,v66
v_fma_f32 v67,-v176,v131,v67
v_fma_f32 v68,-v176,v132,v68
v_mfma_f32_32x32x16_bf16 v[104:119],a[192:195],v[24:27],v[104:119]
buffer_load_dwordx4 v1,s[8:11],s63 offen sc1 lds
v_fma_f32 v69,-v176,v133,v69
v_fma_f32 v70,-v176,v134,v70
v_fma_f32 v71,-v176,v135,v71
v_mul_f32 v64,v64,v177
v_mfma_f32_32x32x16_bf16 v[88:103],a[36:39],v[28:31],v[88:103]
ds_read_b128 v[48:51],v18 offset:14336
v_mul_f32 v65,v65,v177
v_mul_f32 v66,v66,v177
v_mul_f32 v67,v67,v177
v_mul_f32 v68,v68,v177
v_mfma_f32_32x32x16_bf16 v[104:119],a[196:199],v[28:31],v[104:119]
v_mul_f32 v69,v69,v177
v_mul_f32 v70,v70,v177
v_mul_f32 v71,v71,v177
v_cvt_pk_bf16_f32 v64,v64,v65
v_cvt_pk_bf16_f32 v65,v66,v67
s_waitcnt lgkmcnt(3)
v_mfma_f32_32x32x16_bf16 v[88:103],a[40:43],v[32:35],v[88:103]
ds_read_b128 v[52:55],v19 offset:14336
buffer_load_dwordx4 v1,s[8:11],s63 offen offset:1024 sc1 lds
v_cvt_pk_bf16_f32 v66,v68,v69
v_cvt_pk_bf16_f32 v67,v70,v71
v_mfma_f32_32x32x16_bf16 v[104:119],a[200:203],v[32:35],v[104:119]
v_fma_f32 v72,-v176,v136,v72
v_fma_f32 v73,-v176,v137,v73
v_fma_f32 v74,-v176,v138,v74
v_fma_f32 v75,-v176,v139,v75
v_fma_f32 v76,-v176,v140,v76
v_mfma_f32_32x32x16_bf16 v[88:103],a[44:47],v[36:39],v[88:103]
ds_read_b128 v[24:27],v18 offset:16384
v_fma_f32 v77,-v176,v141,v77
v_fma_f32 v78,-v176,v142,v78
v_fma_f32 v79,-v176,v143,v79
v_mul_f32 v72,v72,v177
v_mfma_f32_32x32x16_bf16 v[104:119],a[204:207],v[36:39],v[104:119]
buffer_load_dwordx4 v1,s[8:11],s63 offen offset:2048 sc1 lds
v_mul_f32 v73,v73,v177
v_mul_f32 v74,v74,v177
v_mul_f32 v75,v75,v177
s_waitcnt lgkmcnt(3)
v_mfma_f32_32x32x16_bf16 v[88:103],a[48:51],v[40:43],v[88:103]
ds_read_b128 v[28:31],v19 offset:16384
v_mul_f32 v76,v76,v177
v_mul_f32 v77,v77,v177
v_mul_f32 v78,v78,v177
v_mul_f32 v79,v79,v177
v_mfma_f32_32x32x16_bf16 v[104:119],a[208:211],v[40:43],v[104:119]
v_cvt_pk_bf16_f32 v72,v72,v73
v_cvt_pk_bf16_f32 v73,v74,v75
v_cvt_pk_bf16_f32 v74,v76,v77
v_cvt_pk_bf16_f32 v75,v78,v79
v_fma_f32 v80,-v176,v144,v80
v_mfma_f32_32x32x16_bf16 v[88:103],a[52:55],v[44:47],v[88:103]
ds_read_b128 v[32:35],v18 offset:18432
buffer_load_dwordx4 v1,s[8:11],s63 offen offset:3072 sc1 lds
s_add_u32 m0,s61,8192
s_add_u32 s63,s60,8192
v_mfma_f32_32x32x16_bf16 v[104:119],a[212:215],v[44:47],v[104:119]
v_fma_f32 v81,-v176,v145,v81
v_fma_f32 v82,-v176,v146,v82
v_fma_f32 v83,-v176,v147,v83
v_fma_f32 v84,-v176,v148,v84
v_fma_f32 v85,-v176,v149,v85
s_waitcnt lgkmcnt(3)
v_mfma_f32_32x32x16_bf16 v[88:103],a[56:59],v[48:51],v[88:103]
ds_read_b128 v[36:39],v19 offset:18432
v_fma_f32 v86,-v176,v150,v86
v_fma_f32 v87,-v176,v151,v87
v_mul_f32 v80,v80,v177
v_mul_f32 v81,v81,v177
v_mfma_f32_32x32x16_bf16 v[104:119],a[216:219],v[48:51],v[104:119]
buffer_load_dwordx4 v1,s[8:11],s63 offen sc1 lds
v_mul_f32 v82,v82,v177
v_mul_f32 v83,v83,v177
v_mul_f32 v84,v84,v177
v_mul_f32 v85,v85,v177
v_mfma_f32_32x32x16_bf16 v[88:103],a[60:63],v[52:55],v[88:103]
ds_read_b128 v[40:43],v18 offset:20480
s_waitcnt vmcnt(9)
s_mov_b64 exec,1
buffer_store_dword v5,v1,s[8:11],s59 offen sc1
s_mov_b64 exec,-1
s_mov_b32 s59,2147483648
v_mfma_f32_32x32x16_bf16 v[104:119],a[220:223],v[52:55],v[104:119]
v_mul_f32 v86,v86,v177
v_mul_f32 v87,v87,v177
v_cvt_pk_bf16_f32 v80,v80,v81
v_cvt_pk_bf16_f32 v81,v82,v83
v_cvt_pk_bf16_f32 v82,v84,v85
s_waitcnt lgkmcnt(3)
v_mfma_f32_32x32x16_bf16 v[88:103],a[64:67],v[24:27],v[88:103]
ds_read_b128 v[44:47],v19 offset:20480
buffer_load_dwordx4 v1,s[8:11],s63 offen offset:1024 sc1 lds
s_lshl_b32 s62,s46,10
s_add_u32 s62,s62,40960
v_mfma_f32_32x32x16_bf16 v[104:119],a[224:227],v[24:27],v[104:119]
s_add_u32 m0,s66,s62
s_add_u32 s63,s67,s62
v_cvt_pk_bf16_f32 v83,v86,v87
s_lshl_b32 s82,s72,6
s_add_u32 s82,s82,s73
s_lshl_b32 s82,s82,9
v_mfma_f32_32x32x16_bf16 v[88:103],a[68:71],v[28:31],v[88:103]
ds_read_b128 v[48:51],v18 offset:22528
s_add_u32 s82,s82,s71
s_lshl_b32 s75,s69,2
s_add_u32 s82,s82,s75
s_add_u32 s82,s82,s39
v_mfma_f32_32x32x16_bf16 v[104:119],a[228:231],v[28:31],v[104:119]
buffer_load_dwordx4 v1,s[8:11],s63 offen sc1 lds
s_add_u32 m0,s66,45056
s_add_u32 s63,s67,45056
s_waitcnt lgkmcnt(3)
v_mfma_f32_32x32x16_bf16 v[88:103],a[72:75],v[32:35],v[88:103]
ds_read_b128 v[52:55],v19 offset:22528
buffer_load_dword v3,v2,s[8:11],s35 offen sc1
buffer_load_dword v14,v4,s[8:11],s41 offen sc1
v_mfma_f32_32x32x16_bf16 v[104:119],a[232:235],v[32:35],v[104:119]
v_add_f32 v156,v156,v166
v_add_f32 v157,v157,v167
v_add_f32 v158,v158,v168
v_add_f32 v159,v159,v169
v_add_f32 v160,v160,v170
v_mfma_f32_32x32x16_bf16 v[88:103],a[76:79],v[36:39],v[88:103]
ds_read_b128 v[24:27],v18 offset:24576
buffer_load_dwordx4 v1,s[8:11],s63 offen sc1 lds
v_add_f32 v161,v161,v171
v_add_f32 v162,v162,v172
v_mfma_f32_32x32x16_bf16 v[104:119],a[236:239],v[36:39],v[104:119]
v_add_f32 v163,v163,v173
v_add_f32 v164,v164,v174
v_add_f32 v165,v165,v175
v_add_f32 v156,v156,v158
v_add_f32 v157,v157,v159
s_waitcnt lgkmcnt(3)
v_mfma_f32_32x32x16_bf16 v[88:103],a[80:83],v[40:43],v[88:103]
ds_read_b128 v[28:31],v19 offset:24576
buffer_store_dwordx4 v[56:59],v20,s[8:11],s74 offen sc1
v_add_f32 v160,v160,v162
v_add_f32 v161,v161,v163
v_mfma_f32_32x32x16_bf16 v[104:119],a[240:243],v[40:43],v[104:119]
v_add_f32 v156,v156,v160
v_add_f32 v157,v157,v161
v_add_f32 v156,v156,v164
v_add_f32 v157,v157,v165
v_mov_b32 v158,v156
v_mfma_f32_32x32x16_bf16 v[88:103],a[84:87],v[44:47],v[88:103]
ds_read_b128 v[32:35],v18 offset:26624
buffer_store_dwordx4 v[64:67],v21,s[8:11],s74 offen sc1
v_mov_b32 v159,v157
v_permlane32_swap_b32 v156,v158
v_mfma_f32_32x32x16_bf16 v[104:119],a[244:247],v[44:47],v[104:119]
v_permlane32_swap_b32 v157,v159
v_add_f32 v176,v156,v158
v_add_f32 v177,v157,v159
v_mul_f32 v176,0x3acccccd,v176
v_mul_f32 v177,0x3acccccd,v177
s_waitcnt lgkmcnt(3)
v_mfma_f32_32x32x16_bf16 v[88:103],a[88:91],v[48:51],v[88:103]
ds_read_b128 v[36:39],v19 offset:26624
buffer_store_dwordx4 v[72:75],v20,s[8:11],s74 offen offset:2048 sc1
v_fma_f32 v177,-v176,v176,v177
v_max_f32 v177,0,v177
v_mfma_f32_32x32x16_bf16 v[104:119],a[248:251],v[48:51],v[104:119]
v_cvt_pk_bf16_f32 v8,v176,v177
v_lshlrev_b32 v176,16,v8
v_and_b32 v177,0xffff0000,v8
v_add_f32 v177,0x3727c5ac,v177
v_cvt_pk_bf16_f32 v8,v177,v177
v_mfma_f32_32x32x16_bf16 v[88:103],a[92:95],v[52:55],v[88:103]
ds_read_b128 v[40:43],v18 offset:28672
buffer_store_dwordx4 v[80:83],v21,s[8:11],s74 offen offset:2048 sc1
v_lshlrev_b32 v177,16,v8
v_mfma_f32_32x32x16_bf16 v[104:119],a[252:255],v[52:55],v[104:119]
v_sqrt_f32 v177,v177
s_nop 0
v_cvt_pk_bf16_f32 v8,v177,v177
v_lshlrev_b32 v177,16,v8
s_waitcnt lgkmcnt(3)
v_mfma_f32_32x32x16_bf16 v[88:103],a[96:99],v[24:27],v[88:103]
ds_read_b128 v[44:47],v19 offset:28672
v_rcp_f32 v177,v177
s_cmp_eq_u32 s51,0
s_cselect_b64 s[76:77],-1,0
v_mfma_f32_32x32x16_bf16 v[104:119],v[192:195],v[24:27],v[104:119]
v_cndmask_b32 v176,v176,0,s[76:77]
v_cndmask_b32 v177,v177,1.0,s[76:77]
s_mov_b32 s72,s51
s_mov_b32 s73,s52
v_mfma_f32_32x32x16_bf16 v[88:103],a[100:103],v[28:31],v[88:103]
ds_read_b128 v[48:51],v18 offset:30720
v_mfma_f32_32x32x16_bf16 v[104:119],v[196:199],v[28:31],v[104:119]
s_waitcnt lgkmcnt(3)
v_mfma_f32_32x32x16_bf16 v[88:103],a[104:107],v[32:35],v[88:103]
ds_read_b128 v[52:55],v19 offset:30720
v_mfma_f32_32x32x16_bf16 v[104:119],v[200:203],v[32:35],v[104:119]
v_mfma_f32_32x32x16_bf16 v[88:103],a[108:111],v[36:39],v[88:103]
ds_read_b128 v[24:27],v18 offset:32768
v_mfma_f32_32x32x16_bf16 v[104:119],v[204:207],v[36:39],v[104:119]
s_waitcnt lgkmcnt(3)
v_mfma_f32_32x32x16_bf16 v[88:103],a[112:115],v[40:43],v[88:103]
ds_read_b128 v[28:31],v19 offset:32768
v_mfma_f32_32x32x16_bf16 v[104:119],v[208:211],v[40:43],v[104:119]
v_mfma_f32_32x32x16_bf16 v[88:103],a[116:119],v[44:47],v[88:103]
ds_read_b128 v[32:35],v18 offset:34816
v_mfma_f32_32x32x16_bf16 v[104:119],v[212:215],v[44:47],v[104:119]
s_waitcnt lgkmcnt(3)
v_mfma_f32_32x32x16_bf16 v[88:103],a[120:123],v[48:51],v[88:103]
ds_read_b128 v[36:39],v19 offset:34816
v_mfma_f32_32x32x16_bf16 v[104:119],v[216:219],v[48:51],v[104:119]
v_mfma_f32_32x32x16_bf16 v[88:103],a[124:127],v[52:55],v[88:103]
ds_read_b128 v[40:43],v18 offset:36864
v_mfma_f32_32x32x16_bf16 v[104:119],v[220:223],v[52:55],v[104:119]
s_waitcnt lgkmcnt(3)
v_mfma_f32_32x32x16_bf16 v[88:103],a[128:131],v[24:27],v[88:103]
ds_read_b128 v[44:47],v19 offset:36864
s_waitcnt vmcnt(4)
v_cmp_eq_u32 vcc,0,v14
s_cmp_eq_u64 vcc,0
s_cselect_b32 s36,0,2147483648
v_mfma_f32_32x32x16_bf16 v[104:119],v[224:227],v[24:27],v[104:119]
v_cmp_eq_u32 vcc,0,v3
s_cmp_lt_u32 s78,64
s_cselect_b32 s36,s36,2147483648
s_cmp_eq_u64 vcc,0
s_cselect_b32 s60,1,s36
v_mfma_f32_32x32x16_bf16 v[88:103],a[132:135],v[28:31],v[88:103]
ds_read_b128 v[48:51],v18 offset:38912
s_cmp_lt_u32 s79,64
s_cselect_b32 s60,s60,s36
s_sub_u32 s61,s78,s79
s_or_b32 s61,s61,s36
v_mfma_f32_32x32x16_bf16 v[104:119],v[228:231],v[28:31],v[104:119]
s_cmp_lt_u32 s61,16
s_cselect_b32 s36,0,s60
v_mov_b32 v23,s36
s_waitcnt lgkmcnt(3)
v_mfma_f32_32x32x16_bf16 v[88:103],a[136:139],v[32:35],v[88:103]
ds_read_b128 v[52:55],v19 offset:38912
ds_write_b32 v13,v23
v_mfma_f32_32x32x16_bf16 v[104:119],v[232:235],v[32:35],v[104:119]
s_waitcnt lgkmcnt(0)
s_barrier
ds_read_b32 v23,v22
v_mfma_f32_32x32x16_bf16 v[88:103],a[140:143],v[36:39],v[88:103]
ds_read_b128 v[24:27],v16 offset:0
s_cmp_lt_u32 s50,2
s_cselect_b32 s42,1,0
s_cmp_ge_u32 s78,64
s_cselect_b32 s42,1,s42
v_mfma_f32_32x32x16_bf16 v[104:119],v[236:239],v[36:39],v[104:119]
s_or_b32 s42,s42,s37
s_mov_b32 s39,0
s_add_u32 s50,s50,1
s_sub_u32 s57,46080,s57
s_mov_b32 s51,s53
s_mov_b32 s52,s54
v_mfma_f32_32x32x16_bf16 v[88:103],a[144:147],v[40:43],v[88:103]
ds_read_b128 v[28:31],v17 offset:0
v_mfma_f32_32x32x16_bf16 v[104:119],v[240:243],v[40:43],v[104:119]
v_mfma_f32_32x32x16_bf16 v[88:103],a[148:151],v[44:47],v[88:103]
ds_read_b128 v[32:35],v16 offset:2048
s_waitcnt vmcnt(0)
s_mov_b64 exec,1
buffer_store_dword v5,v1,s[8:11],s82 offen sc1
s_mov_b64 exec,-1
s_mov_b32 s82,2147483648
v_mfma_f32_32x32x16_bf16 v[104:119],v[244:247],v[44:47],v[104:119]
s_waitcnt lgkmcnt(3)
v_readfirstlane_b32 s38,v23
s_and_b32 s37,s38,2147483648
s_and_b32 s33,s38,1
s_cselect_b32 s34,s79,s78
s_cmp_lg_u32 s42,0
v_mfma_f32_32x32x16_bf16 v[88:103],a[152:155],v[48:51],v[88:103]
ds_read_b128 v[36:39],v17 offset:2048
v_mfma_f32_32x32x16_bf16 v[104:119],v[248:251],v[48:51],v[104:119]
v_mfma_f32_32x32x16_bf16 v[88:103],a[156:159],v[52:55],v[88:103]
ds_read_b128 v[40:43],v16 offset:4096
v_mfma_f32_32x32x16_bf16 v[104:119],v[252:255],v[52:55],v[104:119]
s_cbranch_scc0 QKVQ_B0
s_branch QKVQ_S1
s_nop 9
QKVQ_S0:
s_mov_b32 s55,0
s_cmp_lt_u32 s42,2
s_cbranch_scc1 nt_209
s_mov_b32 s55,2
s_cmp_lg_u32 s37,0
s_cbranch_scc1 nt_209
s_mov_b32 s55,1
s_lshl_b32 s60,s33,6
s_add_u32 s60,s60,s34
s_mul_i32 s60,s60,46080
s_add_u32 s60,s60,206569472
s_cmp_eq_u32 s33,0
s_cselect_b32 s67,2147483648,s60
s_mul_i32 s61,s46,10240
s_add_u32 s60,s60,s61
s_add_u32 s61,s61,s57
s_add_u32 m0,s61,0
s_add_u32 s63,s60,0
buffer_load_dwordx4 v1,s[8:11],s63 offen sc1 lds
buffer_load_dwordx4 v1,s[8:11],s63 offen offset:1024 sc1 lds
buffer_load_dwordx4 v1,s[8:11],s63 offen offset:2048 sc1 lds
buffer_load_dwordx4 v1,s[8:11],s63 offen offset:3072 sc1 lds
s_add_u32 m0,s61,4096
s_add_u32 s63,s60,4096
buffer_load_dwordx4 v1,s[8:11],s63 offen sc1 lds
buffer_load_dwordx4 v1,s[8:11],s63 offen offset:1024 sc1 lds
buffer_load_dwordx4 v1,s[8:11],s63 offen offset:2048 sc1 lds
buffer_load_dwordx4 v1,s[8:11],s63 offen offset:3072 sc1 lds
s_add_u32 m0,s61,8192
s_add_u32 s63,s60,8192
buffer_load_dwordx4 v1,s[8:11],s63 offen sc1 lds
buffer_load_dwordx4 v1,s[8:11],s63 offen offset:1024 sc1 lds
s_lshl_b32 s62,s46,10
s_add_u32 s62,s62,40960
s_add_u32 m0,s57,s62
s_add_u32 s63,s67,s62
buffer_load_dwordx4 v1,s[8:11],s63 offen sc1 lds
s_add_u32 m0,s57,45056
s_add_u32 s63,s67,45056
buffer_load_dwordx4 v1,s[8:11],s63 offen sc1 lds
nt_209:
s_nop 4
s_mul_i32 s74,s73,393216
s_add_u32 s74,s74,s39
s_add_u32 s74,s74,s70
v_fma_f32 v56,-v176,v120,v56
v_fma_f32 v57,-v176,v121,v57
v_fma_f32 v58,-v176,v122,v58
v_fma_f32 v59,-v176,v123,v59
v_fma_f32 v60,-v176,v124,v60
v_fma_f32 v61,-v176,v125,v61
v_fma_f32 v62,-v176,v126,v62
v_fma_f32 v63,-v176,v127,v63
v_mul_f32 v56,v56,v177
v_mul_f32 v57,v57,v177
v_mul_f32 v58,v58,v177
v_mul_f32 v59,v59,v177
v_mul_f32 v60,v60,v177
v_mul_f32 v61,v61,v177
v_mul_f32 v62,v62,v177
v_mul_f32 v63,v63,v177
v_cvt_pk_bf16_f32 v56,v56,v57
v_cvt_pk_bf16_f32 v57,v58,v59
v_cvt_pk_bf16_f32 v58,v60,v61
v_cvt_pk_bf16_f32 v59,v62,v63
buffer_store_dwordx4 v[56:59],v20,s[8:11],s74 offen sc1
v_fma_f32 v64,-v176,v128,v64
v_fma_f32 v65,-v176,v129,v65
v_fma_f32 v66,-v176,v130,v66
v_fma_f32 v67,-v176,v131,v67
v_fma_f32 v68,-v176,v132,v68
v_fma_f32 v69,-v176,v133,v69
v_fma_f32 v70,-v176,v134,v70
v_fma_f32 v71,-v176,v135,v71
v_mul_f32 v64,v64,v177
v_mul_f32 v65,v65,v177
v_mul_f32 v66,v66,v177
v_mul_f32 v67,v67,v177
v_mul_f32 v68,v68,v177
v_mul_f32 v69,v69,v177
v_mul_f32 v70,v70,v177
v_mul_f32 v71,v71,v177
v_cvt_pk_bf16_f32 v64,v64,v65
v_cvt_pk_bf16_f32 v65,v66,v67
v_cvt_pk_bf16_f32 v66,v68,v69
v_cvt_pk_bf16_f32 v67,v70,v71
buffer_store_dwordx4 v[64:67],v21,s[8:11],s74 offen sc1
v_fma_f32 v72,-v176,v136,v72
v_fma_f32 v73,-v176,v137,v73
v_fma_f32 v74,-v176,v138,v74
v_fma_f32 v75,-v176,v139,v75
v_fma_f32 v76,-v176,v140,v76
v_fma_f32 v77,-v176,v141,v77
v_fma_f32 v78,-v176,v142,v78
v_fma_f32 v79,-v176,v143,v79
v_mul_f32 v72,v72,v177
v_mul_f32 v73,v73,v177
v_mul_f32 v74,v74,v177
v_mul_f32 v75,v75,v177
v_mul_f32 v76,v76,v177
v_mul_f32 v77,v77,v177
v_mul_f32 v78,v78,v177
v_mul_f32 v79,v79,v177
v_cvt_pk_bf16_f32 v72,v72,v73
v_cvt_pk_bf16_f32 v73,v74,v75
v_cvt_pk_bf16_f32 v74,v76,v77
v_cvt_pk_bf16_f32 v75,v78,v79
buffer_store_dwordx4 v[72:75],v20,s[8:11],s74 offen offset:2048 sc1
v_fma_f32 v80,-v176,v144,v80
v_fma_f32 v81,-v176,v145,v81
v_fma_f32 v82,-v176,v146,v82
v_fma_f32 v83,-v176,v147,v83
v_fma_f32 v84,-v176,v148,v84
v_fma_f32 v85,-v176,v149,v85
v_fma_f32 v86,-v176,v150,v86
v_fma_f32 v87,-v176,v151,v87
v_mul_f32 v80,v80,v177
v_mul_f32 v81,v81,v177
v_mul_f32 v82,v82,v177
v_mul_f32 v83,v83,v177
v_mul_f32 v84,v84,v177
v_mul_f32 v85,v85,v177
v_mul_f32 v86,v86,v177
v_mul_f32 v87,v87,v177
v_cvt_pk_bf16_f32 v80,v80,v81
v_cvt_pk_bf16_f32 v81,v82,v83
v_cvt_pk_bf16_f32 v82,v84,v85
v_cvt_pk_bf16_f32 v83,v86,v87
buffer_store_dwordx4 v[80:83],v21,s[8:11],s74 offen offset:2048 sc1
s_lshl_b32 s82,s72,6
s_add_u32 s82,s82,s73
s_lshl_b32 s82,s82,9
s_add_u32 s82,s82,s71
s_lshl_b32 s75,s69,2
s_add_u32 s82,s82,s75
s_add_u32 s82,s82,s39
s_mov_b32 s59,s82
s_mov_b32 s82,2147483648
s_mov_b32 s39,2147483648
s_cmp_eq_u32 s55,0
s_cbranch_scc1 QKVQ_B1
s_cmp_eq_u32 s55,1
s_cbranch_scc1 QKVQ_CD1
s_waitcnt vmcnt(0)
s_mov_b64 exec,1
buffer_store_dword v5,v1,s[8:11],s59 offen sc1
s_mov_b64 exec,-1
s_mov_b32 s59,2147483648
s_cmp_eq_u32 s50,128
s_cbranch_scc1 QKVQ_END
s_branch QKVQ_COLD1
QKVQ_COLD0:
s_cmp_lg_u32 s46,0
s_cbranch_scc1 cp_210
ct_211:
buffer_load_dword v3,v2,s[8:11],s35 offen sc1
buffer_load_dword v14,v4,s[8:11],s41 offen sc1
s_waitcnt vmcnt(0)
v_cmp_eq_u32 vcc,0,v14
s_cmp_eq_u64 vcc,0
s_cselect_b32 s36,0,2147483648
v_cmp_eq_u32 vcc,0,v3
s_cmp_lt_u32 s78,64
s_cselect_b32 s36,s36,2147483648
s_cmp_eq_u64 vcc,0
s_cselect_b32 s60,1,s36
s_cmp_lt_u32 s79,64
s_cselect_b32 s60,s60,s36
s_sub_u32 s61,s78,s79
s_or_b32 s61,s61,s36
s_cmp_lt_u32 s61,16
s_cselect_b32 s36,0,s60
v_mov_b32 v23,s36
s_cmp_lt_u32 s36,2
s_cbranch_scc1 ct_211x
s_sleep 3
s_sub_u32 s47,s47,1
s_cbranch_scc1 ABORT
s_branch ct_211
ct_211x:
ds_write_b32 v22,v23 offset:4
s_waitcnt lgkmcnt(0)
cp_210:
s_barrier
ds_read_b32 v23,v22 offset:4
s_waitcnt lgkmcnt(0)
v_readfirstlane_b32 s38,v23
s_and_b32 s38,s38,1
s_and_b32 s37,s38,2147483648
s_and_b32 s33,s38,1
s_cselect_b32 s34,s79,s78
s_lshl_b32 s60,s33,6
s_add_u32 s60,s60,s34
s_mul_i32 s60,s60,46080
s_add_u32 s60,s60,206569472
s_cmp_eq_u32 s33,0
s_cselect_b32 s67,2147483648,s60
s_mul_i32 s61,s46,10240
s_add_u32 s60,s60,s61
s_add_u32 s61,s61,s57
s_add_u32 m0,s61,0
s_add_u32 s63,s60,0
buffer_load_dwordx4 v1,s[8:11],s63 offen sc1 lds
buffer_load_dwordx4 v1,s[8:11],s63 offen offset:1024 sc1 lds
buffer_load_dwordx4 v1,s[8:11],s63 offen offset:2048 sc1 lds
buffer_load_dwordx4 v1,s[8:11],s63 offen offset:3072 sc1 lds
s_add_u32 m0,s61,4096
s_add_u32 s63,s60,4096
buffer_load_dwordx4 v1,s[8:11],s63 offen sc1 lds
buffer_load_dwordx4 v1,s[8:11],s63 offen offset:1024 sc1 lds
buffer_load_dwordx4 v1,s[8:11],s63 offen offset:2048 sc1 lds
buffer_load_dwordx4 v1,s[8:11],s63 offen offset:3072 sc1 lds
s_add_u32 m0,s61,8192
s_add_u32 s63,s60,8192
buffer_load_dwordx4 v1,s[8:11],s63 offen sc1 lds
buffer_load_dwordx4 v1,s[8:11],s63 offen offset:1024 sc1 lds
s_lshl_b32 s62,s46,10
s_add_u32 s62,s62,40960
s_add_u32 m0,s57,s62
s_add_u32 s63,s67,s62
buffer_load_dwordx4 v1,s[8:11],s63 offen sc1 lds
s_add_u32 m0,s57,45056
s_add_u32 s63,s67,45056
buffer_load_dwordx4 v1,s[8:11],s63 offen sc1 lds
QKVQ_CD0:
s_mov_b32 s51,s33
s_mov_b32 s52,s34
s_mov_b32 s53,s33
s_mov_b32 s54,s34
s_add_u32 s79,s79,s33
s_or_b32 s60,s37,s33
s_cmp_eq_u32 s60,0
s_addc_u32 s78,s78,0
s_lshl_b32 s41,s78,9
s_add_u32 s41,s41,s40
s_lshl_b32 s35,s79,9
s_add_u32 s35,s35,s40
s_add_u32 s35,s35,32768
buffer_load_dword v3,v2,s[8:11],s35 offen sc1
buffer_load_dword v14,v4,s[8:11],s41 offen sc1
s_waitcnt vmcnt(0)
s_mov_b64 exec,1
buffer_store_dword v5,v1,s[8:11],s59 offen sc1
s_mov_b64 exec,-1
s_mov_b32 s59,2147483648
v_cmp_eq_u32 vcc,0,v14
s_cmp_eq_u64 vcc,0
s_cselect_b32 s36,0,2147483648
v_cmp_eq_u32 vcc,0,v3
s_cmp_lt_u32 s78,64
s_cselect_b32 s36,s36,2147483648
s_cmp_eq_u64 vcc,0
s_cselect_b32 s60,1,s36
s_cmp_lt_u32 s79,64
s_cselect_b32 s60,s60,s36
s_sub_u32 s61,s78,s79
s_or_b32 s61,s61,s36
s_cmp_lt_u32 s61,16
s_cselect_b32 s36,0,s60
v_mov_b32 v23,s36
ds_write_b32 v13,v23
s_waitcnt lgkmcnt(0)
s_barrier
ds_read_b32 v23,v22
ds_read_b128 v[24:27],v16 offset:0
ds_read_b128 v[28:31],v17 offset:0
ds_read_b128 v[32:35],v16 offset:2048
ds_read_b128 v[36:39],v17 offset:2048
ds_read_b128 v[40:43],v16 offset:4096
s_waitcnt lgkmcnt(5)
v_readfirstlane_b32 s38,v23
s_and_b32 s37,s38,2147483648
s_and_b32 s33,s38,1
s_cselect_b32 s34,s79,s78
s_nop 0
s_branch QKVQ_B0
QKVQ_S1:
s_mov_b32 s55,0
s_cmp_lt_u32 s42,2
s_cbranch_scc1 nt_212
s_mov_b32 s55,2
s_cmp_lg_u32 s37,0
s_cbranch_scc1 nt_212
s_mov_b32 s55,1
s_lshl_b32 s60,s33,6
s_add_u32 s60,s60,s34
s_mul_i32 s60,s60,46080
s_add_u32 s60,s60,206569472
s_cmp_eq_u32 s33,0
s_cselect_b32 s67,2147483648,s60
s_mul_i32 s61,s46,10240
s_add_u32 s60,s60,s61
s_add_u32 s61,s61,s57
s_add_u32 m0,s61,0
s_add_u32 s63,s60,0
buffer_load_dwordx4 v1,s[8:11],s63 offen sc1 lds
buffer_load_dwordx4 v1,s[8:11],s63 offen offset:1024 sc1 lds
buffer_load_dwordx4 v1,s[8:11],s63 offen offset:2048 sc1 lds
buffer_load_dwordx4 v1,s[8:11],s63 offen offset:3072 sc1 lds
s_add_u32 m0,s61,4096
s_add_u32 s63,s60,4096
buffer_load_dwordx4 v1,s[8:11],s63 offen sc1 lds
buffer_load_dwordx4 v1,s[8:11],s63 offen offset:1024 sc1 lds
buffer_load_dwordx4 v1,s[8:11],s63 offen offset:2048 sc1 lds
buffer_load_dwordx4 v1,s[8:11],s63 offen offset:3072 sc1 lds
s_add_u32 m0,s61,8192
s_add_u32 s63,s60,8192
buffer_load_dwordx4 v1,s[8:11],s63 offen sc1 lds
buffer_load_dwordx4 v1,s[8:11],s63 offen offset:1024 sc1 lds
s_lshl_b32 s62,s46,10
s_add_u32 s62,s62,40960
s_add_u32 m0,s57,s62
s_add_u32 s63,s67,s62
buffer_load_dwordx4 v1,s[8:11],s63 offen sc1 lds
s_add_u32 m0,s57,45056
s_add_u32 s63,s67,45056
buffer_load_dwordx4 v1,s[8:11],s63 offen sc1 lds
nt_212:
s_nop 4
s_mul_i32 s74,s73,393216
s_add_u32 s74,s74,s39
s_add_u32 s74,s74,s70
v_fma_f32 v88,-v176,v120,v88
v_fma_f32 v89,-v176,v121,v89
v_fma_f32 v90,-v176,v122,v90
v_fma_f32 v91,-v176,v123,v91
v_fma_f32 v92,-v176,v124,v92
v_fma_f32 v93,-v176,v125,v93
v_fma_f32 v94,-v176,v126,v94
v_fma_f32 v95,-v176,v127,v95
v_mul_f32 v88,v88,v177
v_mul_f32 v89,v89,v177
v_mul_f32 v90,v90,v177
v_mul_f32 v91,v91,v177
v_mul_f32 v92,v92,v177
v_mul_f32 v93,v93,v177
v_mul_f32 v94,v94,v177
v_mul_f32 v95,v95,v177
v_cvt_pk_bf16_f32 v88,v88,v89
v_cvt_pk_bf16_f32 v89,v90,v91
v_cvt_pk_bf16_f32 v90,v92,v93
v_cvt_pk_bf16_f32 v91,v94,v95
buffer_store_dwordx4 v[88:91],v20,s[8:11],s74 offen sc1
v_fma_f32 v96,-v176,v128,v96
v_fma_f32 v97,-v176,v129,v97
v_fma_f32 v98,-v176,v130,v98
v_fma_f32 v99,-v176,v131,v99
v_fma_f32 v100,-v176,v132,v100
v_fma_f32 v101,-v176,v133,v101
v_fma_f32 v102,-v176,v134,v102
v_fma_f32 v103,-v176,v135,v103
v_mul_f32 v96,v96,v177
v_mul_f32 v97,v97,v177
v_mul_f32 v98,v98,v177
v_mul_f32 v99,v99,v177
v_mul_f32 v100,v100,v177
v_mul_f32 v101,v101,v177
v_mul_f32 v102,v102,v177
v_mul_f32 v103,v103,v177
v_cvt_pk_bf16_f32 v96,v96,v97
v_cvt_pk_bf16_f32 v97,v98,v99
v_cvt_pk_bf16_f32 v98,v100,v101
v_cvt_pk_bf16_f32 v99,v102,v103
buffer_store_dwordx4 v[96:99],v21,s[8:11],s74 offen sc1
v_fma_f32 v104,-v176,v136,v104
v_fma_f32 v105,-v176,v137,v105
v_fma_f32 v106,-v176,v138,v106
v_fma_f32 v107,-v176,v139,v107
v_fma_f32 v108,-v176,v140,v108
v_fma_f32 v109,-v176,v141,v109
v_fma_f32 v110,-v176,v142,v110
v_fma_f32 v111,-v176,v143,v111
v_mul_f32 v104,v104,v177
v_mul_f32 v105,v105,v177
v_mul_f32 v106,v106,v177
v_mul_f32 v107,v107,v177
v_mul_f32 v108,v108,v177
v_mul_f32 v109,v109,v177
v_mul_f32 v110,v110,v177
v_mul_f32 v111,v111,v177
v_cvt_pk_bf16_f32 v104,v104,v105
v_cvt_pk_bf16_f32 v105,v106,v107
v_cvt_pk_bf16_f32 v106,v108,v109
v_cvt_pk_bf16_f32 v107,v110,v111
buffer_store_dwordx4 v[104:107],v20,s[8:11],s74 offen offset:2048 sc1
v_fma_f32 v112,-v176,v144,v112
v_fma_f32 v113,-v176,v145,v113
v_fma_f32 v114,-v176,v146,v114
v_fma_f32 v115,-v176,v147,v115
v_fma_f32 v116,-v176,v148,v116
v_fma_f32 v117,-v176,v149,v117
v_fma_f32 v118,-v176,v150,v118
v_fma_f32 v119,-v176,v151,v119
v_mul_f32 v112,v112,v177
v_mul_f32 v113,v113,v177
v_mul_f32 v114,v114,v177
v_mul_f32 v115,v115,v177
v_mul_f32 v116,v116,v177
v_mul_f32 v117,v117,v177
v_mul_f32 v118,v118,v177
v_mul_f32 v119,v119,v177
v_cvt_pk_bf16_f32 v112,v112,v113
v_cvt_pk_bf16_f32 v113,v114,v115
v_cvt_pk_bf16_f32 v114,v116,v117
v_cvt_pk_bf16_f32 v115,v118,v119
buffer_store_dwordx4 v[112:115],v21,s[8:11],s74 offen offset:2048 sc1
s_lshl_b32 s82,s72,6
s_add_u32 s82,s82,s73
s_lshl_b32 s82,s82,9
s_add_u32 s82,s82,s71
s_lshl_b32 s75,s69,2
s_add_u32 s82,s82,s75
s_add_u32 s82,s82,s39
s_mov_b32 s59,s82
s_mov_b32 s82,2147483648
s_mov_b32 s39,2147483648
s_cmp_eq_u32 s55,0
s_cbranch_scc1 QKVQ_B0
s_cmp_eq_u32 s55,1
s_cbranch_scc1 QKVQ_CD0
s_waitcnt vmcnt(0)
s_mov_b64 exec,1
buffer_store_dword v5,v1,s[8:11],s59 offen sc1
s_mov_b64 exec,-1
s_mov_b32 s59,2147483648
s_cmp_eq_u32 s50,128
s_cbranch_scc1 QKVQ_END
s_branch QKVQ_COLD0
QKVQ_COLD1:
s_cmp_lg_u32 s46,0
s_cbranch_scc1 cp_213
ct_214:
buffer_load_dword v3,v2,s[8:11],s35 offen sc1
buffer_load_dword v14,v4,s[8:11],s41 offen sc1
s_waitcnt vmcnt(0)
v_cmp_eq_u32 vcc,0,v14
s_cmp_eq_u64 vcc,0
s_cselect_b32 s36,0,2147483648
v_cmp_eq_u32 vcc,0,v3
s_cmp_lt_u32 s78,64
s_cselect_b32 s36,s36,2147483648
s_cmp_eq_u64 vcc,0
s_cselect_b32 s60,1,s36
s_cmp_lt_u32 s79,64
s_cselect_b32 s60,s60,s36
s_sub_u32 s61,s78,s79
s_or_b32 s61,s61,s36
s_cmp_lt_u32 s61,16
s_cselect_b32 s36,0,s60
v_mov_b32 v23,s36
s_cmp_lt_u32 s36,2
s_cbranch_scc1 ct_214x
s_sleep 3
s_sub_u32 s47,s47,1
s_cbranch_scc1 ABORT
s_branch ct_214
ct_214x:
ds_write_b32 v22,v23 offset:4
s_waitcnt lgkmcnt(0)
cp_213:
s_barrier
ds_read_b32 v23,v22 offset:4
s_waitcnt lgkmcnt(0)
v_readfirstlane_b32 s38,v23
s_and_b32 s38,s38,1
s_and_b32 s37,s38,2147483648
s_and_b32 s33,s38,1
s_cselect_b32 s34,s79,s78
s_lshl_b32 s60,s33,6
s_add_u32 s60,s60,s34
s_mul_i32 s60,s60,46080
s_add_u32 s60,s60,206569472
s_cmp_eq_u32 s33,0
s_cselect_b32 s67,2147483648,s60
s_mul_i32 s61,s46,10240
s_add_u32 s60,s60,s61
s_add_u32 s61,s61,s57
s_add_u32 m0,s61,0
s_add_u32 s63,s60,0
buffer_load_dwordx4 v1,s[8:11],s63 offen sc1 lds
buffer_load_dwordx4 v1,s[8:11],s63 offen offset:1024 sc1 lds
buffer_load_dwordx4 v1,s[8:11],s63 offen offset:2048 sc1 lds
buffer_load_dwordx4 v1,s[8:11],s63 offen offset:3072 sc1 lds
s_add_u32 m0,s61,4096
s_add_u32 s63,s60,4096
buffer_load_dwordx4 v1,s[8:11],s63 offen sc1 lds
buffer_load_dwordx4 v1,s[8:11],s63 offen offset:1024 sc1 lds
buffer_load_dwordx4 v1,s[8:11],s63 offen offset:2048 sc1 lds
buffer_load_dwordx4 v1,s[8:11],s63 offen offset:3072 sc1 lds
s_add_u32 m0,s61,8192
s_add_u32 s63,s60,8192
buffer_load_dwordx4 v1,s[8:11],s63 offen sc1 lds
buffer_load_dwordx4 v1,s[8:11],s63 offen offset:1024 sc1 lds
s_lshl_b32 s62,s46,10
s_add_u32 s62,s62,40960
s_add_u32 m0,s57,s62
s_add_u32 s63,s67,s62
buffer_load_dwordx4 v1,s[8:11],s63 offen sc1 lds
s_add_u32 m0,s57,45056
s_add_u32 s63,s67,45056
buffer_load_dwordx4 v1,s[8:11],s63 offen sc1 lds
QKVQ_CD1:
s_mov_b32 s51,s33
s_mov_b32 s52,s34
s_mov_b32 s53,s33
s_mov_b32 s54,s34
s_add_u32 s79,s79,s33
s_or_b32 s60,s37,s33
s_cmp_eq_u32 s60,0
s_addc_u32 s78,s78,0
s_lshl_b32 s41,s78,9
s_add_u32 s41,s41,s40
s_lshl_b32 s35,s79,9
s_add_u32 s35,s35,s40
s_add_u32 s35,s35,32768
buffer_load_dword v3,v2,s[8:11],s35 offen sc1
buffer_load_dword v14,v4,s[8:11],s41 offen sc1
s_waitcnt vmcnt(0)
s_mov_b64 exec,1
buffer_store_dword v5,v1,s[8:11],s59 offen sc1
s_mov_b64 exec,-1
s_mov_b32 s59,2147483648
v_cmp_eq_u32 vcc,0,v14
s_cmp_eq_u64 vcc,0
s_cselect_b32 s36,0,2147483648
v_cmp_eq_u32 vcc,0,v3
s_cmp_lt_u32 s78,64
s_cselect_b32 s36,s36,2147483648
s_cmp_eq_u64 vcc,0
s_cselect_b32 s60,1,s36
s_cmp_lt_u32 s79,64
s_cselect_b32 s60,s60,s36
s_sub_u32 s61,s78,s79
s_or_b32 s61,s61,s36
s_cmp_lt_u32 s61,16
s_cselect_b32 s36,0,s60
v_mov_b32 v23,s36
ds_write_b32 v13,v23
s_waitcnt lgkmcnt(0)
s_barrier
ds_read_b32 v23,v22
ds_read_b128 v[24:27],v18 offset:0
ds_read_b128 v[28:31],v19 offset:0
ds_read_b128 v[32:35],v18 offset:2048
ds_read_b128 v[36:39],v19 offset:2048
ds_read_b128 v[40:43],v18 offset:4096
s_waitcnt lgkmcnt(5)
v_readfirstlane_b32 s38,v23
s_and_b32 s37,s38,2147483648
s_and_b32 s33,s38,1
s_cselect_b32 s34,s79,s78
s_nop 0
s_branch QKVQ_B1
QKVQ_END:
s_endpgm
ROLE_QKVV:
v_lshlrev_b32 v1,4,v0
v_mov_b32 v5,1
s_lshl_b32 s56,s48,2
s_add_u32 s56,s56,s46
v_bfe_u32 v6,v0,2,2
v_lshrrev_b32 v7,4,v0
v_add_u32 v7,v6,v7
v_and_b32 v7,3,v7
v_and_b32 v15,3,v0
v_lshlrev_b32 v15,4,v15
v_lshl_add_u32 v15,v7,6,v15
v_lshl_add_u32 v15,v6,8,v15
v_lshrrev_b32 v6,5,v0
v_bfe_u32 v7,v0,4,1
v_lshlrev_b32 v16,10,v7
v_bfe_u32 v7,v0,2,2
v_lshl_add_u32 v16,v7,8,v16
v_add_u32 v6,v6,v7
v_and_b32 v6,3,v6
v_lshl_add_u32 v16,v6,6,v16
v_and_b32 v6,3,v0
v_lshl_add_u32 v16,v6,4,v16
v_add_u32 v18,46080,v16
v_lshrrev_b32 v6,5,v0
v_bfe_u32 v7,v0,4,1
v_lshlrev_b32 v20,10,v7
v_lshl_add_u32 v20,v6,8,v20
v_and_b32 v6,15,v0
v_lshl_add_u32 v20,v6,4,v20
v_lshrrev_b32 v6,5,v0
v_add_u32 v6,2,v6
v_bfe_u32 v7,v0,4,1
v_lshlrev_b32 v17,10,v7
v_bfe_u32 v7,v0,2,2
v_lshl_add_u32 v17,v7,8,v17
v_add_u32 v6,v6,v7
v_and_b32 v6,3,v6
v_lshl_add_u32 v17,v6,6,v17
v_and_b32 v6,3,v0
v_lshl_add_u32 v17,v6,4,v17
v_add_u32 v19,46080,v17
v_lshrrev_b32 v6,5,v0
v_add_u32 v6,2,v6
v_bfe_u32 v7,v0,4,1
v_lshlrev_b32 v21,10,v7
v_lshl_add_u32 v21,v6,8,v21
v_and_b32 v6,15,v0
v_lshl_add_u32 v21,v6,4,v21
s_mov_b32 s69,s56
s_mov_b32 s70,99614720
s_mov_b32 s71,196608
s_lshl_b32 s60,s69,12
s_add_u32 s70,s70,s60
v_lshrrev_b32 v6,5,v0
v_mul_u32_u24 v188,2560,v6
v_and_b32 v6,31,v0
v_lshl_add_u32 v188,v6,3,v188
v_add_u32 v188,0xa000,v188
v_min_u32 v4,7,v0
v_lshlrev_b32 v4,2,v4
v_min_u32 v2,39,v0
v_lshlrev_b32 v2,2,v2
v_mov_b32 v12,93184
s_lshl_b32 s60,s46,8
s_add_u32 s60,s60,92160
v_and_b32 v6,31,v0
v_lshlrev_b32 v190,3,v6
v_add_u32 v190,s60,v190
v_lshrrev_b32 v6,5,v0
v_lshlrev_b32 v191,5,v6
v_add_u32 v191,s60,v191
s_waitcnt vmcnt(0)
s_barrier
s_cmp_lg_u32 s46,0
s_cbranch_scc1 arr_215
v_mov_b32 v6,1
s_lshl_b32 s3,s49,2
v_mov_b32 v7,s3
s_mov_b64 exec,1
buffer_atomic_add v6,v7,s[12:15],0 offen sc1
s_mov_b64 exec,-1
arr_215:
s_lshl_b32 s58,s69,7
s_mul_i32 s63,s46,40960
s_mov_b32 s4,s24
s_mov_b32 s5,s25
s_mov_b32 s6,7864320
s_mov_b32 s7,0x20000
v_lshrrev_b32 v9,3,v0
s_mov_b32 s64,12288
v_mul_lo_u32 v9,v9,s64
v_and_b32 v10,7,v0
v_lshl_add_u32 v6,v10,4,v9
s_add_u32 m0,s63,0
s_add_u32 s65,s58,0
buffer_load_dwordx4 v6,s[4:7],s65 offen lds
s_add_u32 m0,s63,1024
s_add_u32 s65,s58,98304
buffer_load_dwordx4 v6,s[4:7],s65 offen lds
s_add_u32 m0,s63,2048
s_add_u32 s65,s58,196608
buffer_load_dwordx4 v6,s[4:7],s65 offen lds
s_add_u32 m0,s63,3072
s_add_u32 s65,s58,294912
buffer_load_dwordx4 v6,s[4:7],s65 offen lds
s_add_u32 m0,s63,4096
s_add_u32 s65,s58,393216
buffer_load_dwordx4 v6,s[4:7],s65 offen lds
s_add_u32 m0,s63,5120
s_add_u32 s65,s58,491520
buffer_load_dwordx4 v6,s[4:7],s65 offen lds
s_add_u32 m0,s63,6144
s_add_u32 s65,s58,589824
buffer_load_dwordx4 v6,s[4:7],s65 offen lds
s_add_u32 m0,s63,7168
s_add_u32 s65,s58,688128
buffer_load_dwordx4 v6,s[4:7],s65 offen lds
s_add_u32 m0,s63,8192
s_add_u32 s65,s58,786432
buffer_load_dwordx4 v6,s[4:7],s65 offen lds
s_add_u32 m0,s63,9216
s_add_u32 s65,s58,884736
buffer_load_dwordx4 v6,s[4:7],s65 offen lds
s_add_u32 m0,s63,10240
s_add_u32 s65,s58,983040
buffer_load_dwordx4 v6,s[4:7],s65 offen lds
s_add_u32 m0,s63,11264
s_add_u32 s65,s58,1081344
buffer_load_dwordx4 v6,s[4:7],s65 offen lds
s_add_u32 m0,s63,12288
s_add_u32 s65,s58,1179648
buffer_load_dwordx4 v6,s[4:7],s65 offen lds
s_add_u32 m0,s63,13312
s_add_u32 s65,s58,1277952
buffer_load_dwordx4 v6,s[4:7],s65 offen lds
s_add_u32 m0,s63,14336
s_add_u32 s65,s58,1376256
buffer_load_dwordx4 v6,s[4:7],s65 offen lds
s_add_u32 m0,s63,15360
s_add_u32 s65,s58,1474560
buffer_load_dwordx4 v6,s[4:7],s65 offen lds
s_add_u32 m0,s63,16384
s_add_u32 s65,s58,1572864
buffer_load_dwordx4 v6,s[4:7],s65 offen lds
s_add_u32 m0,s63,17408
s_add_u32 s65,s58,1671168
buffer_load_dwordx4 v6,s[4:7],s65 offen lds
s_add_u32 m0,s63,18432
s_add_u32 s65,s58,1769472
buffer_load_dwordx4 v6,s[4:7],s65 offen lds
s_add_u32 m0,s63,19456
s_add_u32 s65,s58,1867776
buffer_load_dwordx4 v6,s[4:7],s65 offen lds
s_add_u32 m0,s63,20480
s_add_u32 s65,s58,1966080
buffer_load_dwordx4 v6,s[4:7],s65 offen lds
s_add_u32 m0,s63,21504
s_add_u32 s65,s58,2064384
buffer_load_dwordx4 v6,s[4:7],s65 offen lds
s_add_u32 m0,s63,22528
s_add_u32 s65,s58,2162688
buffer_load_dwordx4 v6,s[4:7],s65 offen lds
s_add_u32 m0,s63,23552
s_add_u32 s65,s58,2260992
buffer_load_dwordx4 v6,s[4:7],s65 offen lds
s_add_u32 m0,s63,24576
s_add_u32 s65,s58,2359296
buffer_load_dwordx4 v6,s[4:7],s65 offen lds
s_add_u32 m0,s63,25600
s_add_u32 s65,s58,2457600
buffer_load_dwordx4 v6,s[4:7],s65 offen lds
s_add_u32 m0,s63,26624
s_add_u32 s65,s58,2555904
buffer_load_dwordx4 v6,s[4:7],s65 offen lds
s_add_u32 m0,s63,27648
s_add_u32 s65,s58,2654208
buffer_load_dwordx4 v6,s[4:7],s65 offen lds
s_add_u32 m0,s63,28672
s_add_u32 s65,s58,2752512
buffer_load_dwordx4 v6,s[4:7],s65 offen lds
s_add_u32 m0,s63,29696
s_add_u32 s65,s58,2850816
buffer_load_dwordx4 v6,s[4:7],s65 offen lds
s_add_u32 m0,s63,30720
s_add_u32 s65,s58,2949120
buffer_load_dwordx4 v6,s[4:7],s65 offen lds
s_add_u32 m0,s63,31744
s_add_u32 s65,s58,3047424
buffer_load_dwordx4 v6,s[4:7],s65 offen lds
s_add_u32 m0,s63,32768
s_add_u32 s65,s58,3145728
buffer_load_dwordx4 v6,s[4:7],s65 offen lds
s_add_u32 m0,s63,33792
s_add_u32 s65,s58,3244032
buffer_load_dwordx4 v6,s[4:7],s65 offen lds
s_add_u32 m0,s63,34816
s_add_u32 s65,s58,3342336
buffer_load_dwordx4 v6,s[4:7],s65 offen lds
s_add_u32 m0,s63,35840
s_add_u32 s65,s58,3440640
buffer_load_dwordx4 v6,s[4:7],s65 offen lds
s_add_u32 m0,s63,36864
s_add_u32 s65,s58,3538944
buffer_load_dwordx4 v6,s[4:7],s65 offen lds
s_add_u32 m0,s63,37888
s_add_u32 s65,s58,3637248
buffer_load_dwordx4 v6,s[4:7],s65 offen lds
s_add_u32 m0,s63,38912
s_add_u32 s65,s58,3735552
buffer_load_dwordx4 v6,s[4:7],s65 offen lds
s_add_u32 m0,s63,39936
s_add_u32 s65,s58,3833856
buffer_load_dwordx4 v6,s[4:7],s65 offen lds
s_waitcnt vmcnt(20)
v_bfe_u32 v9,v0,2,2
v_lshrrev_b32 v10,5,v0
v_lshl_add_u32 v9,v10,2,v9
v_mul_u32_u24 v9,128,v9
v_and_b32 v10,1,v0
v_lshl_add_u32 v9,v10,3,v9
v_bfe_u32 v10,v0,1,1
v_lshl_add_u32 v9,v10,4,v9
v_bfe_u32 v10,v0,4,1
v_lshl_add_u32 v9,v10,5,v9
v_add_u32 v7,s63,v9
ds_read_b64_tr_b16 a[0:1],v7 offset:0
ds_read_b64_tr_b16 a[2:3],v7 offset:2048
ds_read_b64_tr_b16 a[4:5],v7 offset:1024
ds_read_b64_tr_b16 a[6:7],v7 offset:3072
ds_read_b64_tr_b16 a[160:161],v7 offset:64
ds_read_b64_tr_b16 a[162:163],v7 offset:2112
ds_read_b64_tr_b16 a[164:165],v7 offset:1088
ds_read_b64_tr_b16 a[166:167],v7 offset:3136
ds_read_b64_tr_b16 a[8:9],v7 offset:4096
ds_read_b64_tr_b16 a[10:11],v7 offset:6144
ds_read_b64_tr_b16 a[12:13],v7 offset:5120
ds_read_b64_tr_b16 a[14:15],v7 offset:7168
s_waitcnt lgkmcnt(4)
ds_read_b64_tr_b16 a[168:169],v7 offset:4160
ds_read_b64_tr_b16 a[170:171],v7 offset:6208
ds_read_b64_tr_b16 a[172:173],v7 offset:5184
ds_read_b64_tr_b16 a[174:175],v7 offset:7232
ds_read_b64_tr_b16 a[16:17],v7 offset:8192
ds_read_b64_tr_b16 a[18:19],v7 offset:10240
ds_read_b64_tr_b16 a[20:21],v7 offset:9216
ds_read_b64_tr_b16 a[22:23],v7 offset:11264
ds_read_b64_tr_b16 a[176:177],v7 offset:8256
ds_read_b64_tr_b16 a[178:179],v7 offset:10304
ds_read_b64_tr_b16 a[180:181],v7 offset:9280
ds_read_b64_tr_b16 a[182:183],v7 offset:11328
s_waitcnt lgkmcnt(4)
ds_read_b64_tr_b16 a[24:25],v7 offset:12288
ds_read_b64_tr_b16 a[26:27],v7 offset:14336
ds_read_b64_tr_b16 a[28:29],v7 offset:13312
ds_read_b64_tr_b16 a[30:31],v7 offset:15360
ds_read_b64_tr_b16 a[184:185],v7 offset:12352
ds_read_b64_tr_b16 a[186:187],v7 offset:14400
ds_read_b64_tr_b16 a[188:189],v7 offset:13376
ds_read_b64_tr_b16 a[190:191],v7 offset:15424
ds_read_b64_tr_b16 a[32:33],v7 offset:16384
ds_read_b64_tr_b16 a[34:35],v7 offset:18432
ds_read_b64_tr_b16 a[36:37],v7 offset:17408
ds_read_b64_tr_b16 a[38:39],v7 offset:19456
s_waitcnt lgkmcnt(4)
ds_read_b64_tr_b16 a[192:193],v7 offset:16448
ds_read_b64_tr_b16 a[194:195],v7 offset:18496
ds_read_b64_tr_b16 a[196:197],v7 offset:17472
ds_read_b64_tr_b16 a[198:199],v7 offset:19520
s_waitcnt lgkmcnt(0)
s_add_u32 m0,s63,0
s_add_u32 s65,s58,3932160
buffer_load_dwordx4 v6,s[4:7],s65 offen lds
s_add_u32 m0,s63,1024
s_add_u32 s65,s58,4030464
buffer_load_dwordx4 v6,s[4:7],s65 offen lds
s_add_u32 m0,s63,2048
s_add_u32 s65,s58,4128768
buffer_load_dwordx4 v6,s[4:7],s65 offen lds
s_add_u32 m0,s63,3072
s_add_u32 s65,s58,4227072
buffer_load_dwordx4 v6,s[4:7],s65 offen lds
s_add_u32 m0,s63,4096
s_add_u32 s65,s58,4325376
buffer_load_dwordx4 v6,s[4:7],s65 offen lds
s_add_u32 m0,s63,5120
s_add_u32 s65,s58,4423680
buffer_load_dwordx4 v6,s[4:7],s65 offen lds
s_add_u32 m0,s63,6144
s_add_u32 s65,s58,4521984
buffer_load_dwordx4 v6,s[4:7],s65 offen lds
s_add_u32 m0,s63,7168
s_add_u32 s65,s58,4620288
buffer_load_dwordx4 v6,s[4:7],s65 offen lds
s_add_u32 m0,s63,8192
s_add_u32 s65,s58,4718592
buffer_load_dwordx4 v6,s[4:7],s65 offen lds
s_add_u32 m0,s63,9216
s_add_u32 s65,s58,4816896
buffer_load_dwordx4 v6,s[4:7],s65 offen lds
s_add_u32 m0,s63,10240
s_add_u32 s65,s58,4915200
buffer_load_dwordx4 v6,s[4:7],s65 offen lds
s_add_u32 m0,s63,11264
s_add_u32 s65,s58,5013504
buffer_load_dwordx4 v6,s[4:7],s65 offen lds
s_add_u32 m0,s63,12288
s_add_u32 s65,s58,5111808
buffer_load_dwordx4 v6,s[4:7],s65 offen lds
s_add_u32 m0,s63,13312
s_add_u32 s65,s58,5210112
buffer_load_dwordx4 v6,s[4:7],s65 offen lds
s_add_u32 m0,s63,14336
s_add_u32 s65,s58,5308416
buffer_load_dwordx4 v6,s[4:7],s65 offen lds
s_add_u32 m0,s63,15360
s_add_u32 s65,s58,5406720
buffer_load_dwordx4 v6,s[4:7],s65 offen lds
s_add_u32 m0,s63,16384
s_add_u32 s65,s58,5505024
buffer_load_dwordx4 v6,s[4:7],s65 offen lds
s_add_u32 m0,s63,17408
s_add_u32 s65,s58,5603328
buffer_load_dwordx4 v6,s[4:7],s65 offen lds
s_add_u32 m0,s63,18432
s_add_u32 s65,s58,5701632
buffer_load_dwordx4 v6,s[4:7],s65 offen lds
s_add_u32 m0,s63,19456
s_add_u32 s65,s58,5799936
buffer_load_dwordx4 v6,s[4:7],s65 offen lds
s_waitcnt vmcnt(20)
v_bfe_u32 v9,v0,2,2
v_lshrrev_b32 v10,5,v0
v_lshl_add_u32 v9,v10,2,v9
v_mul_u32_u24 v9,128,v9
v_and_b32 v10,1,v0
v_lshl_add_u32 v9,v10,3,v9
v_bfe_u32 v10,v0,1,1
v_lshl_add_u32 v9,v10,4,v9
v_bfe_u32 v10,v0,4,1
v_lshl_add_u32 v9,v10,5,v9
v_add_u32 v7,s63,v9
ds_read_b64_tr_b16 a[40:41],v7 offset:20480
ds_read_b64_tr_b16 a[42:43],v7 offset:22528
ds_read_b64_tr_b16 a[44:45],v7 offset:21504
ds_read_b64_tr_b16 a[46:47],v7 offset:23552
ds_read_b64_tr_b16 a[200:201],v7 offset:20544
ds_read_b64_tr_b16 a[202:203],v7 offset:22592
ds_read_b64_tr_b16 a[204:205],v7 offset:21568
ds_read_b64_tr_b16 a[206:207],v7 offset:23616
ds_read_b64_tr_b16 a[48:49],v7 offset:24576
ds_read_b64_tr_b16 a[50:51],v7 offset:26624
ds_read_b64_tr_b16 a[52:53],v7 offset:25600
ds_read_b64_tr_b16 a[54:55],v7 offset:27648
s_waitcnt lgkmcnt(4)
ds_read_b64_tr_b16 a[208:209],v7 offset:24640
ds_read_b64_tr_b16 a[210:211],v7 offset:26688
ds_read_b64_tr_b16 a[212:213],v7 offset:25664
ds_read_b64_tr_b16 a[214:215],v7 offset:27712
ds_read_b64_tr_b16 a[56:57],v7 offset:28672
ds_read_b64_tr_b16 a[58:59],v7 offset:30720
ds_read_b64_tr_b16 a[60:61],v7 offset:29696
ds_read_b64_tr_b16 a[62:63],v7 offset:31744
ds_read_b64_tr_b16 a[216:217],v7 offset:28736
ds_read_b64_tr_b16 a[218:219],v7 offset:30784
ds_read_b64_tr_b16 a[220:221],v7 offset:29760
ds_read_b64_tr_b16 a[222:223],v7 offset:31808
s_waitcnt lgkmcnt(4)
ds_read_b64_tr_b16 a[64:65],v7 offset:32768
ds_read_b64_tr_b16 a[66:67],v7 offset:34816
ds_read_b64_tr_b16 a[68:69],v7 offset:33792
ds_read_b64_tr_b16 a[70:71],v7 offset:35840
ds_read_b64_tr_b16 a[224:225],v7 offset:32832
ds_read_b64_tr_b16 a[226:227],v7 offset:34880
ds_read_b64_tr_b16 a[228:229],v7 offset:33856
ds_read_b64_tr_b16 a[230:231],v7 offset:35904
ds_read_b64_tr_b16 a[72:73],v7 offset:36864
ds_read_b64_tr_b16 a[74:75],v7 offset:38912
ds_read_b64_tr_b16 a[76:77],v7 offset:37888
ds_read_b64_tr_b16 a[78:79],v7 offset:39936
s_waitcnt lgkmcnt(4)
ds_read_b64_tr_b16 a[232:233],v7 offset:36928
ds_read_b64_tr_b16 a[234:235],v7 offset:38976
ds_read_b64_tr_b16 a[236:237],v7 offset:37952
ds_read_b64_tr_b16 a[238:239],v7 offset:40000
s_waitcnt lgkmcnt(0)
s_add_u32 m0,s63,20480
s_add_u32 s65,s58,5898240
buffer_load_dwordx4 v6,s[4:7],s65 offen lds
s_add_u32 m0,s63,21504
s_add_u32 s65,s58,5996544
buffer_load_dwordx4 v6,s[4:7],s65 offen lds
s_add_u32 m0,s63,22528
s_add_u32 s65,s58,6094848
buffer_load_dwordx4 v6,s[4:7],s65 offen lds
s_add_u32 m0,s63,23552
s_add_u32 s65,s58,6193152
buffer_load_dwordx4 v6,s[4:7],s65 offen lds
s_add_u32 m0,s63,24576
s_add_u32 s65,s58,6291456
buffer_load_dwordx4 v6,s[4:7],s65 offen lds
s_add_u32 m0,s63,25600
s_add_u32 s65,s58,6389760
buffer_load_dwordx4 v6,s[4:7],s65 offen lds
s_add_u32 m0,s63,26624
s_add_u32 s65,s58,6488064
buffer_load_dwordx4 v6,s[4:7],s65 offen lds
s_add_u32 m0,s63,27648
s_add_u32 s65,s58,6586368
buffer_load_dwordx4 v6,s[4:7],s65 offen lds
s_add_u32 m0,s63,28672
s_add_u32 s65,s58,6684672
buffer_load_dwordx4 v6,s[4:7],s65 offen lds
s_add_u32 m0,s63,29696
s_add_u32 s65,s58,6782976
buffer_load_dwordx4 v6,s[4:7],s65 offen lds
s_add_u32 m0,s63,30720
s_add_u32 s65,s58,6881280
buffer_load_dwordx4 v6,s[4:7],s65 offen lds
s_add_u32 m0,s63,31744
s_add_u32 s65,s58,6979584
buffer_load_dwordx4 v6,s[4:7],s65 offen lds
s_add_u32 m0,s63,32768
s_add_u32 s65,s58,7077888
buffer_load_dwordx4 v6,s[4:7],s65 offen lds
s_add_u32 m0,s63,33792
s_add_u32 s65,s58,7176192
buffer_load_dwordx4 v6,s[4:7],s65 offen lds
s_add_u32 m0,s63,34816
s_add_u32 s65,s58,7274496
buffer_load_dwordx4 v6,s[4:7],s65 offen lds
s_add_u32 m0,s63,35840
s_add_u32 s65,s58,7372800
buffer_load_dwordx4 v6,s[4:7],s65 offen lds
s_add_u32 m0,s63,36864
s_add_u32 s65,s58,7471104
buffer_load_dwordx4 v6,s[4:7],s65 offen lds
s_add_u32 m0,s63,37888
s_add_u32 s65,s58,7569408
buffer_load_dwordx4 v6,s[4:7],s65 offen lds
s_add_u32 m0,s63,38912
s_add_u32 s65,s58,7667712
buffer_load_dwordx4 v6,s[4:7],s65 offen lds
s_add_u32 m0,s63,39936
s_add_u32 s65,s58,7766016
buffer_load_dwordx4 v6,s[4:7],s65 offen lds
s_waitcnt vmcnt(20)
v_bfe_u32 v9,v0,2,2
v_lshrrev_b32 v10,5,v0
v_lshl_add_u32 v9,v10,2,v9
v_mul_u32_u24 v9,128,v9
v_and_b32 v10,1,v0
v_lshl_add_u32 v9,v10,3,v9
v_bfe_u32 v10,v0,1,1
v_lshl_add_u32 v9,v10,4,v9
v_bfe_u32 v10,v0,4,1
v_lshl_add_u32 v9,v10,5,v9
v_add_u32 v7,s63,v9
ds_read_b64_tr_b16 a[80:81],v7 offset:0
ds_read_b64_tr_b16 a[82:83],v7 offset:2048
ds_read_b64_tr_b16 a[84:85],v7 offset:1024
ds_read_b64_tr_b16 a[86:87],v7 offset:3072
ds_read_b64_tr_b16 a[240:241],v7 offset:64
ds_read_b64_tr_b16 a[242:243],v7 offset:2112
ds_read_b64_tr_b16 a[244:245],v7 offset:1088
ds_read_b64_tr_b16 a[246:247],v7 offset:3136
ds_read_b64_tr_b16 a[88:89],v7 offset:4096
ds_read_b64_tr_b16 a[90:91],v7 offset:6144
ds_read_b64_tr_b16 a[92:93],v7 offset:5120
ds_read_b64_tr_b16 a[94:95],v7 offset:7168
s_waitcnt lgkmcnt(4)
ds_read_b64_tr_b16 a[248:249],v7 offset:4160
ds_read_b64_tr_b16 a[250:251],v7 offset:6208
ds_read_b64_tr_b16 a[252:253],v7 offset:5184
ds_read_b64_tr_b16 a[254:255],v7 offset:7232
ds_read_b64_tr_b16 a[96:97],v7 offset:8192
ds_read_b64_tr_b16 a[98:99],v7 offset:10240
ds_read_b64_tr_b16 a[100:101],v7 offset:9216
ds_read_b64_tr_b16 a[102:103],v7 offset:11264
ds_read_b64_tr_b16 v[192:193],v7 offset:8256
ds_read_b64_tr_b16 v[194:195],v7 offset:10304
ds_read_b64_tr_b16 v[196:197],v7 offset:9280
ds_read_b64_tr_b16 v[198:199],v7 offset:11328
s_waitcnt lgkmcnt(4)
ds_read_b64_tr_b16 a[104:105],v7 offset:12288
ds_read_b64_tr_b16 a[106:107],v7 offset:14336
ds_read_b64_tr_b16 a[108:109],v7 offset:13312
ds_read_b64_tr_b16 a[110:111],v7 offset:15360
ds_read_b64_tr_b16 v[200:201],v7 offset:12352
ds_read_b64_tr_b16 v[202:203],v7 offset:14400
ds_read_b64_tr_b16 v[204:205],v7 offset:13376
ds_read_b64_tr_b16 v[206:207],v7 offset:15424
ds_read_b64_tr_b16 a[112:113],v7 offset:16384
ds_read_b64_tr_b16 a[114:115],v7 offset:18432
ds_read_b64_tr_b16 a[116:117],v7 offset:17408
ds_read_b64_tr_b16 a[118:119],v7 offset:19456
s_waitcnt lgkmcnt(4)
ds_read_b64_tr_b16 v[208:209],v7 offset:16448
ds_read_b64_tr_b16 v[210:211],v7 offset:18496
ds_read_b64_tr_b16 v[212:213],v7 offset:17472
ds_read_b64_tr_b16 v[214:215],v7 offset:19520
s_waitcnt lgkmcnt(0)
s_waitcnt vmcnt(0)
v_bfe_u32 v9,v0,2,2
v_lshrrev_b32 v10,5,v0
v_lshl_add_u32 v9,v10,2,v9
v_mul_u32_u24 v9,128,v9
v_and_b32 v10,1,v0
v_lshl_add_u32 v9,v10,3,v9
v_bfe_u32 v10,v0,1,1
v_lshl_add_u32 v9,v10,4,v9
v_bfe_u32 v10,v0,4,1
v_lshl_add_u32 v9,v10,5,v9
v_add_u32 v7,s63,v9
ds_read_b64_tr_b16 a[120:121],v7 offset:20480
ds_read_b64_tr_b16 a[122:123],v7 offset:22528
ds_read_b64_tr_b16 a[124:125],v7 offset:21504
ds_read_b64_tr_b16 a[126:127],v7 offset:23552
ds_read_b64_tr_b16 v[216:217],v7 offset:20544
ds_read_b64_tr_b16 v[218:219],v7 offset:22592
ds_read_b64_tr_b16 v[220:221],v7 offset:21568
ds_read_b64_tr_b16 v[222:223],v7 offset:23616
ds_read_b64_tr_b16 a[128:129],v7 offset:24576
ds_read_b64_tr_b16 a[130:131],v7 offset:26624
ds_read_b64_tr_b16 a[132:133],v7 offset:25600
ds_read_b64_tr_b16 a[134:135],v7 offset:27648
s_waitcnt lgkmcnt(4)
ds_read_b64_tr_b16 v[224:225],v7 offset:24640
ds_read_b64_tr_b16 v[226:227],v7 offset:26688
ds_read_b64_tr_b16 v[228:229],v7 offset:25664
ds_read_b64_tr_b16 v[230:231],v7 offset:27712
ds_read_b64_tr_b16 a[136:137],v7 offset:28672
ds_read_b64_tr_b16 a[138:139],v7 offset:30720
ds_read_b64_tr_b16 a[140:141],v7 offset:29696
ds_read_b64_tr_b16 a[142:143],v7 offset:31744
ds_read_b64_tr_b16 v[232:233],v7 offset:28736
ds_read_b64_tr_b16 v[234:235],v7 offset:30784
ds_read_b64_tr_b16 v[236:237],v7 offset:29760
ds_read_b64_tr_b16 v[238:239],v7 offset:31808
s_waitcnt lgkmcnt(4)
ds_read_b64_tr_b16 a[144:145],v7 offset:32768
ds_read_b64_tr_b16 a[146:147],v7 offset:34816
ds_read_b64_tr_b16 a[148:149],v7 offset:33792
ds_read_b64_tr_b16 a[150:151],v7 offset:35840
ds_read_b64_tr_b16 v[240:241],v7 offset:32832
ds_read_b64_tr_b16 v[242:243],v7 offset:34880
ds_read_b64_tr_b16 v[244:245],v7 offset:33856
ds_read_b64_tr_b16 v[246:247],v7 offset:35904
ds_read_b64_tr_b16 a[152:153],v7 offset:36864
ds_read_b64_tr_b16 a[154:155],v7 offset:38912
ds_read_b64_tr_b16 a[156:157],v7 offset:37888
ds_read_b64_tr_b16 a[158:159],v7 offset:39936
s_waitcnt lgkmcnt(4)
ds_read_b64_tr_b16 v[248:249],v7 offset:36928
ds_read_b64_tr_b16 v[250:251],v7 offset:38976
ds_read_b64_tr_b16 v[252:253],v7 offset:37952
ds_read_b64_tr_b16 v[254:255],v7 offset:40000
s_waitcnt lgkmcnt(0)
v_mov_b32 v24,0x3f803f80
v_mov_b32 v25,0x3f803f80
v_mov_b32 v26,0x3f803f80
v_mov_b32 v27,0x3f803f80
s_nop 1
v_mfma_f32_32x32x16_bf16 v[56:71],v[24:27],a[0:3],0
v_mfma_f32_32x32x16_bf16 v[72:87],v[24:27],a[160:163],0
v_mfma_f32_32x32x16_bf16 v[56:71],v[24:27],a[4:7],v[56:71]
v_mfma_f32_32x32x16_bf16 v[72:87],v[24:27],a[164:167],v[72:87]
v_mfma_f32_32x32x16_bf16 v[56:71],v[24:27],a[8:11],v[56:71]
v_mfma_f32_32x32x16_bf16 v[72:87],v[24:27],a[168:171],v[72:87]
v_mfma_f32_32x32x16_bf16 v[56:71],v[24:27],a[12:15],v[56:71]
v_mfma_f32_32x32x16_bf16 v[72:87],v[24:27],a[172:175],v[72:87]
v_mfma_f32_32x32x16_bf16 v[56:71],v[24:27],a[16:19],v[56:71]
v_mfma_f32_32x32x16_bf16 v[72:87],v[24:27],a[176:179],v[72:87]
v_mfma_f32_32x32x16_bf16 v[56:71],v[24:27],a[20:23],v[56:71]
v_mfma_f32_32x32x16_bf16 v[72:87],v[24:27],a[180:183],v[72:87]
v_mfma_f32_32x32x16_bf16 v[56:71],v[24:27],a[24:27],v[56:71]
v_mfma_f32_32x32x16_bf16 v[72:87],v[24:27],a[184:187],v[72:87]
v_mfma_f32_32x32x16_bf16 v[56:71],v[24:27],a[28:31],v[56:71]
v_mfma_f32_32x32x16_bf16 v[72:87],v[24:27],a[188:191],v[72:87]
v_mfma_f32_32x32x16_bf16 v[56:71],v[24:27],a[32:35],v[56:71]
v_mfma_f32_32x32x16_bf16 v[72:87],v[24:27],a[192:195],v[72:87]
v_mfma_f32_32x32x16_bf16 v[56:71],v[24:27],a[36:39],v[56:71]
v_mfma_f32_32x32x16_bf16 v[72:87],v[24:27],a[196:199],v[72:87]
v_mfma_f32_32x32x16_bf16 v[56:71],v[24:27],a[40:43],v[56:71]
v_mfma_f32_32x32x16_bf16 v[72:87],v[24:27],a[200:203],v[72:87]
v_mfma_f32_32x32x16_bf16 v[56:71],v[24:27],a[44:47],v[56:71]
v_mfma_f32_32x32x16_bf16 v[72:87],v[24:27],a[204:207],v[72:87]
v_mfma_f32_32x32x16_bf16 v[56:71],v[24:27],a[48:51],v[56:71]
v_mfma_f32_32x32x16_bf16 v[72:87],v[24:27],a[208:211],v[72:87]
v_mfma_f32_32x32x16_bf16 v[56:71],v[24:27],a[52:55],v[56:71]
v_mfma_f32_32x32x16_bf16 v[72:87],v[24:27],a[212:215],v[72:87]
v_mfma_f32_32x32x16_bf16 v[56:71],v[24:27],a[56:59],v[56:71]
v_mfma_f32_32x32x16_bf16 v[72:87],v[24:27],a[216:219],v[72:87]
v_mfma_f32_32x32x16_bf16 v[56:71],v[24:27],a[60:63],v[56:71]
v_mfma_f32_32x32x16_bf16 v[72:87],v[24:27],a[220:223],v[72:87]
v_mfma_f32_32x32x16_bf16 v[56:71],v[24:27],a[64:67],v[56:71]
v_mfma_f32_32x32x16_bf16 v[72:87],v[24:27],a[224:227],v[72:87]
v_mfma_f32_32x32x16_bf16 v[56:71],v[24:27],a[68:71],v[56:71]
v_mfma_f32_32x32x16_bf16 v[72:87],v[24:27],a[228:231],v[72:87]
v_mfma_f32_32x32x16_bf16 v[56:71],v[24:27],a[72:75],v[56:71]
v_mfma_f32_32x32x16_bf16 v[72:87],v[24:27],a[232:235],v[72:87]
v_mfma_f32_32x32x16_bf16 v[56:71],v[24:27],a[76:79],v[56:71]
v_mfma_f32_32x32x16_bf16 v[72:87],v[24:27],a[236:239],v[72:87]
v_mfma_f32_32x32x16_bf16 v[56:71],v[24:27],a[80:83],v[56:71]
v_mfma_f32_32x32x16_bf16 v[72:87],v[24:27],a[240:243],v[72:87]
v_mfma_f32_32x32x16_bf16 v[56:71],v[24:27],a[84:87],v[56:71]
v_mfma_f32_32x32x16_bf16 v[72:87],v[24:27],a[244:247],v[72:87]
v_mfma_f32_32x32x16_bf16 v[56:71],v[24:27],a[88:91],v[56:71]
v_mfma_f32_32x32x16_bf16 v[72:87],v[24:27],a[248:251],v[72:87]
v_mfma_f32_32x32x16_bf16 v[56:71],v[24:27],a[92:95],v[56:71]
v_mfma_f32_32x32x16_bf16 v[72:87],v[24:27],a[252:255],v[72:87]
v_mfma_f32_32x32x16_bf16 v[56:71],v[24:27],a[96:99],v[56:71]
v_mfma_f32_32x32x16_bf16 v[72:87],v[24:27],v[192:195],v[72:87]
v_mfma_f32_32x32x16_bf16 v[56:71],v[24:27],a[100:103],v[56:71]
v_mfma_f32_32x32x16_bf16 v[72:87],v[24:27],v[196:199],v[72:87]
v_mfma_f32_32x32x16_bf16 v[56:71],v[24:27],a[104:107],v[56:71]
v_mfma_f32_32x32x16_bf16 v[72:87],v[24:27],v[200:203],v[72:87]
v_mfma_f32_32x32x16_bf16 v[56:71],v[24:27],a[108:111],v[56:71]
v_mfma_f32_32x32x16_bf16 v[72:87],v[24:27],v[204:207],v[72:87]
v_mfma_f32_32x32x16_bf16 v[56:71],v[24:27],a[112:115],v[56:71]
v_mfma_f32_32x32x16_bf16 v[72:87],v[24:27],v[208:211],v[72:87]
v_mfma_f32_32x32x16_bf16 v[56:71],v[24:27],a[116:119],v[56:71]
v_mfma_f32_32x32x16_bf16 v[72:87],v[24:27],v[212:215],v[72:87]
v_mfma_f32_32x32x16_bf16 v[56:71],v[24:27],a[120:123],v[56:71]
v_mfma_f32_32x32x16_bf16 v[72:87],v[24:27],v[216:219],v[72:87]
v_mfma_f32_32x32x16_bf16 v[56:71],v[24:27],a[124:127],v[56:71]
v_mfma_f32_32x32x16_bf16 v[72:87],v[24:27],v[220:223],v[72:87]
v_mfma_f32_32x32x16_bf16 v[56:71],v[24:27],a[128:131],v[56:71]
v_mfma_f32_32x32x16_bf16 v[72:87],v[24:27],v[224:227],v[72:87]
v_mfma_f32_32x32x16_bf16 v[56:71],v[24:27],a[132:135],v[56:71]
v_mfma_f32_32x32x16_bf16 v[72:87],v[24:27],v[228:231],v[72:87]
v_mfma_f32_32x32x16_bf16 v[56:71],v[24:27],a[136:139],v[56:71]
v_mfma_f32_32x32x16_bf16 v[72:87],v[24:27],v[232:235],v[72:87]
v_mfma_f32_32x32x16_bf16 v[56:71],v[24:27],a[140:143],v[56:71]
v_mfma_f32_32x32x16_bf16 v[72:87],v[24:27],v[236:239],v[72:87]
v_mfma_f32_32x32x16_bf16 v[56:71],v[24:27],a[144:147],v[56:71]
v_mfma_f32_32x32x16_bf16 v[72:87],v[24:27],v[240:243],v[72:87]
v_mfma_f32_32x32x16_bf16 v[56:71],v[24:27],a[148:151],v[56:71]
v_mfma_f32_32x32x16_bf16 v[72:87],v[24:27],v[244:247],v[72:87]
v_mfma_f32_32x32x16_bf16 v[56:71],v[24:27],a[152:155],v[56:71]
v_mfma_f32_32x32x16_bf16 v[72:87],v[24:27],v[248:251],v[72:87]
v_mfma_f32_32x32x16_bf16 v[56:71],v[24:27],a[156:159],v[56:71]
v_mfma_f32_32x32x16_bf16 v[72:87],v[24:27],v[252:255],v[72:87]
s_nop 4
v_mov_b32 v120,v56
s_nop 5
v_mov_b32 v121,v72
s_barrier
s_lshl_b32 s3,s49,2
v_mov_b32 v7,s3
s_nop 1
ibw_216:
buffer_load_dword v6,v7,s[12:15],0 offen sc1
s_waitcnt vmcnt(0)
v_cmp_ne_u32 vcc,256,v6
s_nop 0
s_cbranch_vccz ok_217
s_sleep 8
s_sub_u32 s47,s47,1
s_cbranch_scc1 ABORT
s_branch ibw_216
ok_217:
s_cmp_lg_u32 s49,0
s_cbranch_scc1 ibok_218
v_and_b32 v7,7,v0
v_lshlrev_b32 v7,2,v7
buffer_load_dword v6,v7,s[12:15],0 offen offset:32 sc1
s_waitcnt vmcnt(0)
v_cmp_ne_u32 vcc,32,v6
s_nop 0
s_cbranch_vccz ibok_218
s_barrier
s_mov_b32 s49,1
s_mov_b32 s3,s2
s_load_dwordx16 s[16:31],s[0:1],0
s_load_dwordx8 s[32:39],s[0:1],64
s_waitcnt lgkmcnt(0)
s_branch DISPATCH
ibok_218:
s_mov_b32 s50,0
s_mov_b32 s32,0
s_mov_b32 s57,0
s_mov_b32 s59,2147483648
s_mov_b32 s82,2147483648
s_mov_b32 s39,2147483648
v_mov_b32 v22,94208
s_mov_b32 s72,0
s_mov_b32 s73,0
s_mov_b32 s78,0
s_mov_b32 s79,0
s_cmp_eq_u32 s46,0
s_cselect_b32 s40,0,2147483648
s_lshl_b32 s60,s46,3
v_add_u32 v13,s60,v22
s_mov_b32 s83,s100
s_lshl_b32 s41,s78,9
s_add_u32 s41,s41,s40
s_lshl_b32 s35,s79,9
s_add_u32 s35,s35,s40
s_add_u32 s35,s35,32768
s_branch QKVV_COLD0
QKVV_B0:
s_waitcnt lgkmcnt(3)
v_mfma_f32_32x32x16_bf16 v[56:71],v[24:27],a[0:3],0
ds_read_b128 v[44:47],v17 offset:4096
v_add_u32 v189,s57,v188
v_mfma_f32_32x32x16_bf16 v[72:87],v[24:27],a[160:163],0
v_add_u32 v8,0x800,v189
s_sub_u32 s66,46080,s57
s_lshl_b32 s60,s33,6
s_add_u32 s60,s60,s34
s_mul_i32 s60,s60,46080
s_add_u32 s60,s60,s37
v_mfma_f32_32x32x16_bf16 v[56:71],v[28:31],a[4:7],v[56:71]
ds_read_b128 v[48:51],v16 offset:6144
ds_read2_b64 v[156:159],v189 offset0:0 offset1:32
s_add_u32 s60,s60,206569472
v_mfma_f32_32x32x16_bf16 v[72:87],v[28:31],a[164:167],v[72:87]
ds_read2_b64 v[160:163],v189 offset0:64 offset1:96
s_cmp_eq_u32 s33,0
s_cselect_b32 s67,2147483648,s60
s_mul_i32 s61,s46,10240
s_waitcnt lgkmcnt(5)
v_mfma_f32_32x32x16_bf16 v[56:71],v[32:35],a[8:11],v[56:71]
ds_read_b128 v[52:55],v17 offset:6144
ds_read2_b64 v[164:167],v189 offset0:128 offset1:160
s_add_u32 s60,s60,s61
s_add_u32 s61,s61,s66
v_mfma_f32_32x32x16_bf16 v[72:87],v[32:35],a[168:171],v[72:87]
ds_read2_b64 v[168:171],v189 offset0:192 offset1:224
s_add_u32 m0,s61,0
s_add_u32 s63,s60,0
buffer_load_dwordx4 v1,s[8:11],s63 offen sc1 lds
v_mfma_f32_32x32x16_bf16 v[56:71],v[36:39],a[12:15],v[56:71]
ds_read_b128 v[24:27],v16 offset:8192
ds_read2_b64 v[172:175],v8 offset0:0 offset1:32
s_mul_i32 s74,s73,393216
s_add_u32 s74,s74,s39
v_mfma_f32_32x32x16_bf16 v[72:87],v[36:39],a[172:175],v[72:87]
s_add_u32 s74,s74,s70
v_fma_f32 v88,-v124,v120,v88
v_fma_f32 v89,-v126,v120,v89
v_fma_f32 v90,-v128,v120,v90
v_fma_f32 v91,-v130,v120,v91
s_waitcnt lgkmcnt(8)
v_mfma_f32_32x32x16_bf16 v[56:71],v[40:43],a[16:19],v[56:71]
ds_read_b128 v[28:31],v17 offset:8192
buffer_load_dwordx4 v1,s[8:11],s63 offen offset:1024 sc1 lds
v_fma_f32 v96,-v140,v120,v96
v_fma_f32 v97,-v142,v120,v97
v_mfma_f32_32x32x16_bf16 v[72:87],v[40:43],a[176:179],v[72:87]
v_fma_f32 v98,-v144,v120,v98
v_fma_f32 v99,-v146,v120,v99
v_mul_f32 v88,v88,v125
v_mul_f32 v89,v89,v127
v_mul_f32 v90,v90,v129
v_mfma_f32_32x32x16_bf16 v[56:71],v[44:47],a[20:23],v[56:71]
ds_read_b128 v[32:35],v16 offset:10240
s_mov_b32 s53,s33
s_mov_b32 s54,s34
s_add_u32 s79,s79,s33
s_or_b32 s65,s37,s33
v_mfma_f32_32x32x16_bf16 v[72:87],v[44:47],a[180:183],v[72:87]
buffer_load_dwordx4 v1,s[8:11],s63 offen offset:2048 sc1 lds
s_cmp_eq_u32 s65,0
s_addc_u32 s78,s78,0
s_lshl_b32 s41,s78,9
s_waitcnt lgkmcnt(6)
v_mfma_f32_32x32x16_bf16 v[56:71],v[48:51],a[24:27],v[56:71]
ds_read_b128 v[36:39],v17 offset:10240
s_add_u32 s41,s41,s40
s_lshl_b32 s35,s79,9
s_add_u32 s35,s35,s40
s_add_u32 s35,s35,32768
v_mfma_f32_32x32x16_bf16 v[72:87],v[48:51],a[184:187],v[72:87]
v_mul_f32 v91,v91,v131
v_mul_f32 v96,v96,v141
v_mul_f32 v97,v97,v143
v_mul_f32 v98,v98,v145
v_mul_f32 v99,v99,v147
v_mfma_f32_32x32x16_bf16 v[56:71],v[52:55],a[28:31],v[56:71]
ds_read_b128 v[40:43],v16 offset:12288
buffer_load_dwordx4 v1,s[8:11],s63 offen offset:3072 sc1 lds
s_add_u32 m0,s61,4096
s_add_u32 s63,s60,4096
v_mfma_f32_32x32x16_bf16 v[72:87],v[52:55],a[188:191],v[72:87]
v_cvt_pk_bf16_f32 v88,v88,v89
v_cvt_pk_bf16_f32 v89,v90,v91
v_cvt_pk_bf16_f32 v90,v96,v97
v_cvt_pk_bf16_f32 v91,v98,v99
v_fma_f32 v92,-v132,v120,v92
s_waitcnt lgkmcnt(3)
v_mfma_f32_32x32x16_bf16 v[56:71],v[24:27],a[32:35],v[56:71]
ds_read_b128 v[44:47],v17 offset:12288
v_fma_f32 v93,-v134,v120,v93
v_fma_f32 v94,-v136,v120,v94
v_fma_f32 v95,-v138,v120,v95
v_fma_f32 v100,-v148,v120,v100
v_mfma_f32_32x32x16_bf16 v[72:87],v[24:27],a[192:195],v[72:87]
buffer_load_dwordx4 v1,s[8:11],s63 offen sc1 lds
v_fma_f32 v101,-v150,v120,v101
v_fma_f32 v102,-v152,v120,v102
v_fma_f32 v103,-v154,v120,v103
v_mul_f32 v92,v92,v133
v_mfma_f32_32x32x16_bf16 v[56:71],v[28:31],a[36:39],v[56:71]
ds_read_b128 v[48:51],v16 offset:14336
v_mul_f32 v93,v93,v135
v_mul_f32 v94,v94,v137
v_mul_f32 v95,v95,v139
v_mul_f32 v100,v100,v149
v_mfma_f32_32x32x16_bf16 v[72:87],v[28:31],a[196:199],v[72:87]
v_mul_f32 v101,v101,v151
v_mul_f32 v102,v102,v153
v_mul_f32 v103,v103,v155
v_cvt_pk_bf16_f32 v92,v92,v93
v_cvt_pk_bf16_f32 v93,v94,v95
s_waitcnt lgkmcnt(3)
v_mfma_f32_32x32x16_bf16 v[56:71],v[32:35],a[40:43],v[56:71]
ds_read_b128 v[52:55],v17 offset:14336
buffer_load_dwordx4 v1,s[8:11],s63 offen offset:1024 sc1 lds
v_cvt_pk_bf16_f32 v94,v100,v101
v_cvt_pk_bf16_f32 v95,v102,v103
v_mfma_f32_32x32x16_bf16 v[72:87],v[32:35],a[200:203],v[72:87]
v_fma_f32 v104,-v124,v121,v104
v_fma_f32 v105,-v126,v121,v105
v_fma_f32 v106,-v128,v121,v106
v_fma_f32 v107,-v130,v121,v107
v_fma_f32 v112,-v140,v121,v112
v_mfma_f32_32x32x16_bf16 v[56:71],v[36:39],a[44:47],v[56:71]
ds_read_b128 v[24:27],v16 offset:16384
v_fma_f32 v113,-v142,v121,v113
v_fma_f32 v114,-v144,v121,v114
v_fma_f32 v115,-v146,v121,v115
v_mul_f32 v104,v104,v125
v_mfma_f32_32x32x16_bf16 v[72:87],v[36:39],a[204:207],v[72:87]
buffer_load_dwordx4 v1,s[8:11],s63 offen offset:2048 sc1 lds
v_mul_f32 v105,v105,v127
v_mul_f32 v106,v106,v129
v_mul_f32 v107,v107,v131
s_waitcnt lgkmcnt(3)
v_mfma_f32_32x32x16_bf16 v[56:71],v[40:43],a[48:51],v[56:71]
ds_read_b128 v[28:31],v17 offset:16384
v_mul_f32 v112,v112,v141
v_mul_f32 v113,v113,v143
v_mul_f32 v114,v114,v145
v_mul_f32 v115,v115,v147
v_mfma_f32_32x32x16_bf16 v[72:87],v[40:43],a[208:211],v[72:87]
v_cvt_pk_bf16_f32 v104,v104,v105
v_cvt_pk_bf16_f32 v105,v106,v107
v_cvt_pk_bf16_f32 v106,v112,v113
v_cvt_pk_bf16_f32 v107,v114,v115
v_fma_f32 v108,-v132,v121,v108
v_mfma_f32_32x32x16_bf16 v[56:71],v[44:47],a[52:55],v[56:71]
ds_read_b128 v[32:35],v16 offset:18432
buffer_load_dwordx4 v1,s[8:11],s63 offen offset:3072 sc1 lds
s_add_u32 m0,s61,8192
s_add_u32 s63,s60,8192
v_mfma_f32_32x32x16_bf16 v[72:87],v[44:47],a[212:215],v[72:87]
v_fma_f32 v109,-v134,v121,v109
v_fma_f32 v110,-v136,v121,v110
v_fma_f32 v111,-v138,v121,v111
v_fma_f32 v116,-v148,v121,v116
v_fma_f32 v117,-v150,v121,v117
s_waitcnt lgkmcnt(3)
v_mfma_f32_32x32x16_bf16 v[56:71],v[48:51],a[56:59],v[56:71]
ds_read_b128 v[36:39],v17 offset:18432
v_fma_f32 v118,-v152,v121,v118
v_fma_f32 v119,-v154,v121,v119
v_mul_f32 v108,v108,v133
v_mul_f32 v109,v109,v135
v_mfma_f32_32x32x16_bf16 v[72:87],v[48:51],a[216:219],v[72:87]
buffer_load_dwordx4 v1,s[8:11],s63 offen sc1 lds
v_mul_f32 v110,v110,v137
v_mul_f32 v111,v111,v139
v_mul_f32 v116,v116,v149
v_mul_f32 v117,v117,v151
v_mfma_f32_32x32x16_bf16 v[56:71],v[52:55],a[60:63],v[56:71]
ds_read_b128 v[40:43],v16 offset:20480
s_waitcnt vmcnt(9)
s_mov_b64 exec,1
buffer_store_dword v5,v1,s[8:11],s59 offen sc1
s_mov_b64 exec,-1
s_mov_b32 s59,2147483648
v_mfma_f32_32x32x16_bf16 v[72:87],v[52:55],a[220:223],v[72:87]
v_mul_f32 v118,v118,v153
v_mul_f32 v119,v119,v155
v_cvt_pk_bf16_f32 v108,v108,v109
v_cvt_pk_bf16_f32 v109,v110,v111
v_cvt_pk_bf16_f32 v110,v116,v117
s_waitcnt lgkmcnt(3)
v_mfma_f32_32x32x16_bf16 v[56:71],v[24:27],a[64:67],v[56:71]
ds_read_b128 v[44:47],v17 offset:20480
buffer_load_dwordx4 v1,s[8:11],s63 offen offset:1024 sc1 lds
s_lshl_b32 s62,s46,10
s_add_u32 s62,s62,40960
v_mfma_f32_32x32x16_bf16 v[72:87],v[24:27],a[224:227],v[72:87]
s_add_u32 m0,s66,s62
s_add_u32 s63,s67,s62
v_cvt_pk_bf16_f32 v111,v118,v119
s_lshl_b32 s82,s72,6
s_add_u32 s82,s82,s73
s_lshl_b32 s82,s82,9
v_mfma_f32_32x32x16_bf16 v[56:71],v[28:31],a[68:71],v[56:71]
ds_read_b128 v[48:51],v16 offset:22528
s_add_u32 s82,s82,s71
s_lshl_b32 s75,s69,2
s_add_u32 s82,s82,s75
s_add_u32 s82,s82,s39
v_mfma_f32_32x32x16_bf16 v[72:87],v[28:31],a[228:231],v[72:87]
buffer_load_dwordx4 v1,s[8:11],s63 offen sc1 lds
s_add_u32 m0,s66,45056
s_add_u32 s63,s67,45056
s_waitcnt lgkmcnt(3)
v_mfma_f32_32x32x16_bf16 v[56:71],v[32:35],a[72:75],v[56:71]
ds_read_b128 v[52:55],v17 offset:22528
buffer_load_dword v3,v2,s[8:11],s35 offen sc1
buffer_load_dword v14,v4,s[8:11],s41 offen sc1
v_mfma_f32_32x32x16_bf16 v[72:87],v[32:35],a[232:235],v[72:87]
v_add_f32 v156,v156,v166
v_add_f32 v157,v157,v167
v_add_f32 v158,v158,v168
v_add_f32 v159,v159,v169
v_add_f32 v160,v160,v170
v_mfma_f32_32x32x16_bf16 v[56:71],v[36:39],a[76:79],v[56:71]
ds_read_b128 v[24:27],v16 offset:24576
buffer_load_dwordx4 v1,s[8:11],s63 offen sc1 lds
v_add_f32 v161,v161,v171
v_add_f32 v162,v162,v172
v_mfma_f32_32x32x16_bf16 v[72:87],v[36:39],a[236:239],v[72:87]
v_add_f32 v163,v163,v173
v_add_f32 v164,v164,v174
v_add_f32 v165,v165,v175
v_add_f32 v156,v156,v158
v_add_f32 v157,v157,v159
s_waitcnt lgkmcnt(3)
v_mfma_f32_32x32x16_bf16 v[56:71],v[40:43],a[80:83],v[56:71]
ds_read_b128 v[28:31],v17 offset:24576
buffer_store_dwordx4 v[88:91],v20,s[8:11],s74 offen sc1
v_add_f32 v160,v160,v162
v_add_f32 v161,v161,v163
v_mfma_f32_32x32x16_bf16 v[72:87],v[40:43],a[240:243],v[72:87]
v_add_f32 v156,v156,v160
v_add_f32 v157,v157,v161
v_add_f32 v156,v156,v164
v_add_f32 v157,v157,v165
v_mov_b32 v158,v156
v_mfma_f32_32x32x16_bf16 v[56:71],v[44:47],a[84:87],v[56:71]
ds_read_b128 v[32:35],v16 offset:26624
buffer_store_dwordx4 v[92:95],v21,s[8:11],s74 offen sc1
v_mov_b32 v159,v157
v_permlane32_swap_b32 v156,v158
v_mfma_f32_32x32x16_bf16 v[72:87],v[44:47],a[244:247],v[72:87]
v_permlane32_swap_b32 v157,v159
v_add_f32 v176,v156,v158
v_add_f32 v177,v157,v159
v_mul_f32 v176,0x3acccccd,v176
v_mul_f32 v177,0x3acccccd,v177
s_waitcnt lgkmcnt(3)
v_mfma_f32_32x32x16_bf16 v[56:71],v[48:51],a[88:91],v[56:71]
ds_read_b128 v[36:39],v17 offset:26624
buffer_store_dwordx4 v[104:107],v20,s[8:11],s74 offen offset:2048 sc1
v_fma_f32 v177,-v176,v176,v177
v_max_f32 v177,0,v177
v_mfma_f32_32x32x16_bf16 v[72:87],v[48:51],a[248:251],v[72:87]
v_cvt_pk_bf16_f32 v8,v176,v177
v_lshlrev_b32 v176,16,v8
v_and_b32 v177,0xffff0000,v8
v_add_f32 v177,0x3727c5ac,v177
v_cvt_pk_bf16_f32 v8,v177,v177
v_mfma_f32_32x32x16_bf16 v[56:71],v[52:55],a[92:95],v[56:71]
ds_read_b128 v[40:43],v16 offset:28672
buffer_store_dwordx4 v[108:111],v21,s[8:11],s74 offen offset:2048 sc1
v_lshlrev_b32 v177,16,v8
v_mfma_f32_32x32x16_bf16 v[72:87],v[52:55],a[252:255],v[72:87]
v_sqrt_f32 v177,v177
s_nop 0
v_cvt_pk_bf16_f32 v8,v177,v177
v_lshlrev_b32 v177,16,v8
s_waitcnt lgkmcnt(3)
v_mfma_f32_32x32x16_bf16 v[56:71],v[24:27],a[96:99],v[56:71]
ds_read_b128 v[44:47],v17 offset:28672
v_rcp_f32 v177,v177
s_cmp_eq_u32 s51,0
s_cselect_b64 s[76:77],-1,0
v_mfma_f32_32x32x16_bf16 v[72:87],v[24:27],v[192:195],v[72:87]
v_cndmask_b32 v176,v176,0,s[76:77]
v_cndmask_b32 v177,v177,1.0,s[76:77]
s_mov_b32 s72,s51
s_mov_b32 s73,s52
ds_write_b64 v190,v[176:177]
v_mfma_f32_32x32x16_bf16 v[56:71],v[28:31],a[100:103],v[56:71]
ds_read_b128 v[48:51],v16 offset:30720
ds_read_b128 v[124:127],v191 offset:0
ds_read_b128 v[128:131],v191 offset:16
v_mfma_f32_32x32x16_bf16 v[72:87],v[28:31],v[196:199],v[72:87]
ds_read_b128 v[132:135],v191 offset:64
ds_read_b128 v[136:139],v191 offset:80
s_waitcnt lgkmcnt(8)
v_mfma_f32_32x32x16_bf16 v[56:71],v[32:35],a[104:107],v[56:71]
ds_read_b128 v[52:55],v17 offset:30720
ds_read_b128 v[140:143],v191 offset:128
ds_read_b128 v[144:147],v191 offset:144
v_mfma_f32_32x32x16_bf16 v[72:87],v[32:35],v[200:203],v[72:87]
ds_read_b128 v[148:151],v191 offset:192
ds_read_b128 v[152:155],v191 offset:208
v_mfma_f32_32x32x16_bf16 v[56:71],v[36:39],a[108:111],v[56:71]
ds_read_b128 v[24:27],v16 offset:32768
v_mfma_f32_32x32x16_bf16 v[72:87],v[36:39],v[204:207],v[72:87]
s_waitcnt lgkmcnt(12)
v_mfma_f32_32x32x16_bf16 v[56:71],v[40:43],a[112:115],v[56:71]
ds_read_b128 v[28:31],v17 offset:32768
v_mfma_f32_32x32x16_bf16 v[72:87],v[40:43],v[208:211],v[72:87]
v_mfma_f32_32x32x16_bf16 v[56:71],v[44:47],a[116:119],v[56:71]
ds_read_b128 v[32:35],v16 offset:34816
v_mfma_f32_32x32x16_bf16 v[72:87],v[44:47],v[212:215],v[72:87]
s_waitcnt lgkmcnt(7)
v_mfma_f32_32x32x16_bf16 v[56:71],v[48:51],a[120:123],v[56:71]
ds_read_b128 v[36:39],v17 offset:34816
v_mfma_f32_32x32x16_bf16 v[72:87],v[48:51],v[216:219],v[72:87]
v_mfma_f32_32x32x16_bf16 v[56:71],v[52:55],a[124:127],v[56:71]
ds_read_b128 v[40:43],v16 offset:36864
v_mfma_f32_32x32x16_bf16 v[72:87],v[52:55],v[220:223],v[72:87]
s_waitcnt lgkmcnt(3)
v_mfma_f32_32x32x16_bf16 v[56:71],v[24:27],a[128:131],v[56:71]
ds_read_b128 v[44:47],v17 offset:36864
s_waitcnt vmcnt(4)
v_cmp_eq_u32 vcc,0,v14
s_cmp_eq_u64 vcc,0
s_cselect_b32 s36,0,2147483648
v_mfma_f32_32x32x16_bf16 v[72:87],v[24:27],v[224:227],v[72:87]
v_cmp_eq_u32 vcc,0,v3
s_cmp_lt_u32 s78,64
s_cselect_b32 s36,s36,2147483648
s_cmp_eq_u64 vcc,0
s_cselect_b32 s60,1,s36
v_mfma_f32_32x32x16_bf16 v[56:71],v[28:31],a[132:135],v[56:71]
ds_read_b128 v[48:51],v16 offset:38912
s_cmp_lt_u32 s79,64
s_cselect_b32 s60,s60,s36
s_sub_u32 s61,s78,s79
s_or_b32 s61,s61,s36
v_mfma_f32_32x32x16_bf16 v[72:87],v[28:31],v[228:231],v[72:87]
s_cmp_lt_u32 s61,16
s_cselect_b32 s36,0,s60
v_mov_b32 v23,s36
s_waitcnt lgkmcnt(3)
v_mfma_f32_32x32x16_bf16 v[56:71],v[32:35],a[136:139],v[56:71]
ds_read_b128 v[52:55],v17 offset:38912
ds_write_b32 v13,v23
v_mfma_f32_32x32x16_bf16 v[72:87],v[32:35],v[232:235],v[72:87]
s_waitcnt lgkmcnt(0)
s_barrier
ds_read_b32 v23,v22
v_mfma_f32_32x32x16_bf16 v[56:71],v[36:39],a[140:143],v[56:71]
ds_read_b128 v[24:27],v18 offset:0
s_cmp_lt_u32 s50,2
s_cselect_b32 s42,1,0
s_cmp_ge_u32 s78,64
s_cselect_b32 s42,1,s42
v_mfma_f32_32x32x16_bf16 v[72:87],v[36:39],v[236:239],v[72:87]
s_or_b32 s42,s42,s37
s_mov_b32 s39,0
s_add_u32 s50,s50,1
s_sub_u32 s57,46080,s57
s_mov_b32 s51,s53
s_mov_b32 s52,s54
v_mfma_f32_32x32x16_bf16 v[56:71],v[40:43],a[144:147],v[56:71]
ds_read_b128 v[28:31],v19 offset:0
v_mfma_f32_32x32x16_bf16 v[72:87],v[40:43],v[240:243],v[72:87]
v_mfma_f32_32x32x16_bf16 v[56:71],v[44:47],a[148:151],v[56:71]
ds_read_b128 v[32:35],v18 offset:2048
s_waitcnt vmcnt(0)
s_mov_b64 exec,1
buffer_store_dword v5,v1,s[8:11],s82 offen sc1
s_mov_b64 exec,-1
s_mov_b32 s82,2147483648
v_mfma_f32_32x32x16_bf16 v[72:87],v[44:47],v[244:247],v[72:87]
s_waitcnt lgkmcnt(3)
v_readfirstlane_b32 s38,v23
s_and_b32 s37,s38,2147483648
s_and_b32 s33,s38,1
s_cselect_b32 s34,s79,s78
s_cmp_lg_u32 s42,0
v_mfma_f32_32x32x16_bf16 v[56:71],v[48:51],a[152:155],v[56:71]
ds_read_b128 v[36:39],v19 offset:2048
v_mfma_f32_32x32x16_bf16 v[72:87],v[48:51],v[248:251],v[72:87]
v_mfma_f32_32x32x16_bf16 v[56:71],v[52:55],a[156:159],v[56:71]
ds_read_b128 v[40:43],v18 offset:4096
v_mfma_f32_32x32x16_bf16 v[72:87],v[52:55],v[252:255],v[72:87]
s_cbranch_scc1 QKVV_S0
QKVV_B1:
s_waitcnt lgkmcnt(3)
v_mfma_f32_32x32x16_bf16 v[88:103],v[24:27],a[0:3],0
ds_read_b128 v[44:47],v19 offset:4096
v_add_u32 v189,s57,v188
v_mfma_f32_32x32x16_bf16 v[104:119],v[24:27],a[160:163],0
v_add_u32 v8,0x800,v189
s_sub_u32 s66,46080,s57
s_lshl_b32 s60,s33,6
s_add_u32 s60,s60,s34
s_mul_i32 s60,s60,46080
s_add_u32 s60,s60,s37
v_mfma_f32_32x32x16_bf16 v[88:103],v[28:31],a[4:7],v[88:103]
ds_read_b128 v[48:51],v18 offset:6144
ds_read2_b64 v[156:159],v189 offset0:0 offset1:32
s_add_u32 s60,s60,206569472
v_mfma_f32_32x32x16_bf16 v[104:119],v[28:31],a[164:167],v[104:119]
ds_read2_b64 v[160:163],v189 offset0:64 offset1:96
s_cmp_eq_u32 s33,0
s_cselect_b32 s67,2147483648,s60
s_mul_i32 s61,s46,10240
s_waitcnt lgkmcnt(5)
v_mfma_f32_32x32x16_bf16 v[88:103],v[32:35],a[8:11],v[88:103]
ds_read_b128 v[52:55],v19 offset:6144
ds_read2_b64 v[164:167],v189 offset0:128 offset1:160
s_add_u32 s60,s60,s61
s_add_u32 s61,s61,s66
v_mfma_f32_32x32x16_bf16 v[104:119],v[32:35],a[168:171],v[104:119]
ds_read2_b64 v[168:171],v189 offset0:192 offset1:224
s_add_u32 m0,s61,0
s_add_u32 s63,s60,0
buffer_load_dwordx4 v1,s[8:11],s63 offen sc1 lds
v_mfma_f32_32x32x16_bf16 v[88:103],v[36:39],a[12:15],v[88:103]
ds_read_b128 v[24:27],v18 offset:8192
ds_read2_b64 v[172:175],v8 offset0:0 offset1:32
s_mul_i32 s74,s73,393216
s_add_u32 s74,s74,s39
v_mfma_f32_32x32x16_bf16 v[104:119],v[36:39],a[172:175],v[104:119]
s_add_u32 s74,s74,s70
v_fma_f32 v56,-v124,v120,v56
v_fma_f32 v57,-v126,v120,v57
v_fma_f32 v58,-v128,v120,v58
v_fma_f32 v59,-v130,v120,v59
s_waitcnt lgkmcnt(8)
v_mfma_f32_32x32x16_bf16 v[88:103],v[40:43],a[16:19],v[88:103]
ds_read_b128 v[28:31],v19 offset:8192
buffer_load_dwordx4 v1,s[8:11],s63 offen offset:1024 sc1 lds
v_fma_f32 v64,-v140,v120,v64
v_fma_f32 v65,-v142,v120,v65
v_mfma_f32_32x32x16_bf16 v[104:119],v[40:43],a[176:179],v[104:119]
v_fma_f32 v66,-v144,v120,v66
v_fma_f32 v67,-v146,v120,v67
v_mul_f32 v56,v56,v125
v_mul_f32 v57,v57,v127
v_mul_f32 v58,v58,v129
v_mfma_f32_32x32x16_bf16 v[88:103],v[44:47],a[20:23],v[88:103]
ds_read_b128 v[32:35],v18 offset:10240
s_mov_b32 s53,s33
s_mov_b32 s54,s34
s_add_u32 s79,s79,s33
s_or_b32 s65,s37,s33
v_mfma_f32_32x32x16_bf16 v[104:119],v[44:47],a[180:183],v[104:119]
buffer_load_dwordx4 v1,s[8:11],s63 offen offset:2048 sc1 lds
s_cmp_eq_u32 s65,0
s_addc_u32 s78,s78,0
s_lshl_b32 s41,s78,9
s_waitcnt lgkmcnt(6)
v_mfma_f32_32x32x16_bf16 v[88:103],v[48:51],a[24:27],v[88:103]
ds_read_b128 v[36:39],v19 offset:10240
s_add_u32 s41,s41,s40
s_lshl_b32 s35,s79,9
s_add_u32 s35,s35,s40
s_add_u32 s35,s35,32768
v_mfma_f32_32x32x16_bf16 v[104:119],v[48:51],a[184:187],v[104:119]
v_mul_f32 v59,v59,v131
v_mul_f32 v64,v64,v141
v_mul_f32 v65,v65,v143
v_mul_f32 v66,v66,v145
v_mul_f32 v67,v67,v147
v_mfma_f32_32x32x16_bf16 v[88:103],v[52:55],a[28:31],v[88:103]
ds_read_b128 v[40:43],v18 offset:12288
buffer_load_dwordx4 v1,s[8:11],s63 offen offset:3072 sc1 lds
s_add_u32 m0,s61,4096
s_add_u32 s63,s60,4096
v_mfma_f32_32x32x16_bf16 v[104:119],v[52:55],a[188:191],v[104:119]
v_cvt_pk_bf16_f32 v56,v56,v57
v_cvt_pk_bf16_f32 v57,v58,v59
v_cvt_pk_bf16_f32 v58,v64,v65
v_cvt_pk_bf16_f32 v59,v66,v67
v_fma_f32 v60,-v132,v120,v60
s_waitcnt lgkmcnt(3)
v_mfma_f32_32x32x16_bf16 v[88:103],v[24:27],a[32:35],v[88:103]
ds_read_b128 v[44:47],v19 offset:12288
v_fma_f32 v61,-v134,v120,v61
v_fma_f32 v62,-v136,v120,v62
v_fma_f32 v63,-v138,v120,v63
v_fma_f32 v68,-v148,v120,v68
v_mfma_f32_32x32x16_bf16 v[104:119],v[24:27],a[192:195],v[104:119]
buffer_load_dwordx4 v1,s[8:11],s63 offen sc1 lds
v_fma_f32 v69,-v150,v120,v69
v_fma_f32 v70,-v152,v120,v70
v_fma_f32 v71,-v154,v120,v71
v_mul_f32 v60,v60,v133
v_mfma_f32_32x32x16_bf16 v[88:103],v[28:31],a[36:39],v[88:103]
ds_read_b128 v[48:51],v18 offset:14336
v_mul_f32 v61,v61,v135
v_mul_f32 v62,v62,v137
v_mul_f32 v63,v63,v139
v_mul_f32 v68,v68,v149
v_mfma_f32_32x32x16_bf16 v[104:119],v[28:31],a[196:199],v[104:119]
v_mul_f32 v69,v69,v151
v_mul_f32 v70,v70,v153
v_mul_f32 v71,v71,v155
v_cvt_pk_bf16_f32 v60,v60,v61
v_cvt_pk_bf16_f32 v61,v62,v63
s_waitcnt lgkmcnt(3)
v_mfma_f32_32x32x16_bf16 v[88:103],v[32:35],a[40:43],v[88:103]
ds_read_b128 v[52:55],v19 offset:14336
buffer_load_dwordx4 v1,s[8:11],s63 offen offset:1024 sc1 lds
v_cvt_pk_bf16_f32 v62,v68,v69
v_cvt_pk_bf16_f32 v63,v70,v71
v_mfma_f32_32x32x16_bf16 v[104:119],v[32:35],a[200:203],v[104:119]
v_fma_f32 v72,-v124,v121,v72
v_fma_f32 v73,-v126,v121,v73
v_fma_f32 v74,-v128,v121,v74
v_fma_f32 v75,-v130,v121,v75
v_fma_f32 v80,-v140,v121,v80
v_mfma_f32_32x32x16_bf16 v[88:103],v[36:39],a[44:47],v[88:103]
ds_read_b128 v[24:27],v18 offset:16384
v_fma_f32 v81,-v142,v121,v81
v_fma_f32 v82,-v144,v121,v82
v_fma_f32 v83,-v146,v121,v83
v_mul_f32 v72,v72,v125
v_mfma_f32_32x32x16_bf16 v[104:119],v[36:39],a[204:207],v[104:119]
buffer_load_dwordx4 v1,s[8:11],s63 offen offset:2048 sc1 lds
v_mul_f32 v73,v73,v127
v_mul_f32 v74,v74,v129
v_mul_f32 v75,v75,v131
s_waitcnt lgkmcnt(3)
v_mfma_f32_32x32x16_bf16 v[88:103],v[40:43],a[48:51],v[88:103]
ds_read_b128 v[28:31],v19 offset:16384
v_mul_f32 v80,v80,v141
v_mul_f32 v81,v81,v143
v_mul_f32 v82,v82,v145
v_mul_f32 v83,v83,v147
v_mfma_f32_32x32x16_bf16 v[104:119],v[40:43],a[208:211],v[104:119]
v_cvt_pk_bf16_f32 v72,v72,v73
v_cvt_pk_bf16_f32 v73,v74,v75
v_cvt_pk_bf16_f32 v74,v80,v81
v_cvt_pk_bf16_f32 v75,v82,v83
v_fma_f32 v76,-v132,v121,v76
v_mfma_f32_32x32x16_bf16 v[88:103],v[44:47],a[52:55],v[88:103]
ds_read_b128 v[32:35],v18 offset:18432
buffer_load_dwordx4 v1,s[8:11],s63 offen offset:3072 sc1 lds
s_add_u32 m0,s61,8192
s_add_u32 s63,s60,8192
v_mfma_f32_32x32x16_bf16 v[104:119],v[44:47],a[212:215],v[104:119]
v_fma_f32 v77,-v134,v121,v77
v_fma_f32 v78,-v136,v121,v78
v_fma_f32 v79,-v138,v121,v79
v_fma_f32 v84,-v148,v121,v84
v_fma_f32 v85,-v150,v121,v85
s_waitcnt lgkmcnt(3)
v_mfma_f32_32x32x16_bf16 v[88:103],v[48:51],a[56:59],v[88:103]
ds_read_b128 v[36:39],v19 offset:18432
v_fma_f32 v86,-v152,v121,v86
v_fma_f32 v87,-v154,v121,v87
v_mul_f32 v76,v76,v133
v_mul_f32 v77,v77,v135
v_mfma_f32_32x32x16_bf16 v[104:119],v[48:51],a[216:219],v[104:119]
buffer_load_dwordx4 v1,s[8:11],s63 offen sc1 lds
v_mul_f32 v78,v78,v137
v_mul_f32 v79,v79,v139
v_mul_f32 v84,v84,v149
v_mul_f32 v85,v85,v151
v_mfma_f32_32x32x16_bf16 v[88:103],v[52:55],a[60:63],v[88:103]
ds_read_b128 v[40:43],v18 offset:20480
s_waitcnt vmcnt(9)
s_mov_b64 exec,1
buffer_store_dword v5,v1,s[8:11],s59 offen sc1
s_mov_b64 exec,-1
s_mov_b32 s59,2147483648
v_mfma_f32_32x32x16_bf16 v[104:119],v[52:55],a[220:223],v[104:119]
v_mul_f32 v86,v86,v153
v_mul_f32 v87,v87,v155
v_cvt_pk_bf16_f32 v76,v76,v77
v_cvt_pk_bf16_f32 v77,v78,v79
v_cvt_pk_bf16_f32 v78,v84,v85
s_waitcnt lgkmcnt(3)
v_mfma_f32_32x32x16_bf16 v[88:103],v[24:27],a[64:67],v[88:103]
ds_read_b128 v[44:47],v19 offset:20480
buffer_load_dwordx4 v1,s[8:11],s63 offen offset:1024 sc1 lds
s_lshl_b32 s62,s46,10
s_add_u32 s62,s62,40960
v_mfma_f32_32x32x16_bf16 v[104:119],v[24:27],a[224:227],v[104:119]
s_add_u32 m0,s66,s62
s_add_u32 s63,s67,s62
v_cvt_pk_bf16_f32 v79,v86,v87
s_lshl_b32 s82,s72,6
s_add_u32 s82,s82,s73
s_lshl_b32 s82,s82,9
v_mfma_f32_32x32x16_bf16 v[88:103],v[28:31],a[68:71],v[88:103]
ds_read_b128 v[48:51],v18 offset:22528
s_add_u32 s82,s82,s71
s_lshl_b32 s75,s69,2
s_add_u32 s82,s82,s75
s_add_u32 s82,s82,s39
v_mfma_f32_32x32x16_bf16 v[104:119],v[28:31],a[228:231],v[104:119]
buffer_load_dwordx4 v1,s[8:11],s63 offen sc1 lds
s_add_u32 m0,s66,45056
s_add_u32 s63,s67,45056
s_waitcnt lgkmcnt(3)
v_mfma_f32_32x32x16_bf16 v[88:103],v[32:35],a[72:75],v[88:103]
ds_read_b128 v[52:55],v19 offset:22528
buffer_load_dword v3,v2,s[8:11],s35 offen sc1
buffer_load_dword v14,v4,s[8:11],s41 offen sc1
v_mfma_f32_32x32x16_bf16 v[104:119],v[32:35],a[232:235],v[104:119]
v_add_f32 v156,v156,v166
v_add_f32 v157,v157,v167
v_add_f32 v158,v158,v168
v_add_f32 v159,v159,v169
v_add_f32 v160,v160,v170
v_mfma_f32_32x32x16_bf16 v[88:103],v[36:39],a[76:79],v[88:103]
ds_read_b128 v[24:27],v18 offset:24576
buffer_load_dwordx4 v1,s[8:11],s63 offen sc1 lds
v_add_f32 v161,v161,v171
v_add_f32 v162,v162,v172
v_mfma_f32_32x32x16_bf16 v[104:119],v[36:39],a[236:239],v[104:119]
v_add_f32 v163,v163,v173
v_add_f32 v164,v164,v174
v_add_f32 v165,v165,v175
v_add_f32 v156,v156,v158
v_add_f32 v157,v157,v159
s_waitcnt lgkmcnt(3)
v_mfma_f32_32x32x16_bf16 v[88:103],v[40:43],a[80:83],v[88:103]
ds_read_b128 v[28:31],v19 offset:24576
buffer_store_dwordx4 v[56:59],v20,s[8:11],s74 offen sc1
v_add_f32 v160,v160,v162
v_add_f32 v161,v161,v163
v_mfma_f32_32x32x16_bf16 v[104:119],v[40:43],a[240:243],v[104:119]
v_add_f32 v156,v156,v160
v_add_f32 v157,v157,v161
v_add_f32 v156,v156,v164
v_add_f32 v157,v157,v165
v_mov_b32 v158,v156
v_mfma_f32_32x32x16_bf16 v[88:103],v[44:47],a[84:87],v[88:103]
ds_read_b128 v[32:35],v18 offset:26624
buffer_store_dwordx4 v[60:63],v21,s[8:11],s74 offen sc1
v_mov_b32 v159,v157
v_permlane32_swap_b32 v156,v158
v_mfma_f32_32x32x16_bf16 v[104:119],v[44:47],a[244:247],v[104:119]
v_permlane32_swap_b32 v157,v159
v_add_f32 v176,v156,v158
v_add_f32 v177,v157,v159
v_mul_f32 v176,0x3acccccd,v176
v_mul_f32 v177,0x3acccccd,v177
s_waitcnt lgkmcnt(3)
v_mfma_f32_32x32x16_bf16 v[88:103],v[48:51],a[88:91],v[88:103]
ds_read_b128 v[36:39],v19 offset:26624
buffer_store_dwordx4 v[72:75],v20,s[8:11],s74 offen offset:2048 sc1
v_fma_f32 v177,-v176,v176,v177
v_max_f32 v177,0,v177
v_mfma_f32_32x32x16_bf16 v[104:119],v[48:51],a[248:251],v[104:119]
v_cvt_pk_bf16_f32 v8,v176,v177
v_lshlrev_b32 v176,16,v8
v_and_b32 v177,0xffff0000,v8
v_add_f32 v177,0x3727c5ac,v177
v_cvt_pk_bf16_f32 v8,v177,v177
v_mfma_f32_32x32x16_bf16 v[88:103],v[52:55],a[92:95],v[88:103]
ds_read_b128 v[40:43],v18 offset:28672
buffer_store_dwordx4 v[76:79],v21,s[8:11],s74 offen offset:2048 sc1
v_lshlrev_b32 v177,16,v8
v_mfma_f32_32x32x16_bf16 v[104:119],v[52:55],a[252:255],v[104:119]
v_sqrt_f32 v177,v177
s_nop 0
v_cvt_pk_bf16_f32 v8,v177,v177
v_lshlrev_b32 v177,16,v8
s_waitcnt lgkmcnt(3)
v_mfma_f32_32x32x16_bf16 v[88:103],v[24:27],a[96:99],v[88:103]
ds_read_b128 v[44:47],v19 offset:28672
v_rcp_f32 v177,v177
s_cmp_eq_u32 s51,0
s_cselect_b64 s[76:77],-1,0
v_mfma_f32_32x32x16_bf16 v[104:119],v[24:27],v[192:195],v[104:119]
v_cndmask_b32 v176,v176,0,s[76:77]
v_cndmask_b32 v177,v177,1.0,s[76:77]
s_mov_b32 s72,s51
s_mov_b32 s73,s52
ds_write_b64 v190,v[176:177]
v_mfma_f32_32x32x16_bf16 v[88:103],v[28:31],a[100:103],v[88:103]
ds_read_b128 v[48:51],v18 offset:30720
ds_read_b128 v[124:127],v191 offset:0
ds_read_b128 v[128:131],v191 offset:16
v_mfma_f32_32x32x16_bf16 v[104:119],v[28:31],v[196:199],v[104:119]
ds_read_b128 v[132:135],v191 offset:64
ds_read_b128 v[136:139],v191 offset:80
s_waitcnt lgkmcnt(8)
v_mfma_f32_32x32x16_bf16 v[88:103],v[32:35],a[104:107],v[88:103]
ds_read_b128 v[52:55],v19 offset:30720
ds_read_b128 v[140:143],v191 offset:128
ds_read_b128 v[144:147],v191 offset:144
v_mfma_f32_32x32x16_bf16 v[104:119],v[32:35],v[200:203],v[104:119]
ds_read_b128 v[148:151],v191 offset:192
ds_read_b128 v[152:155],v191 offset:208
v_mfma_f32_32x32x16_bf16 v[88:103],v[36:39],a[108:111],v[88:103]
ds_read_b128 v[24:27],v18 offset:32768
v_mfma_f32_32x32x16_bf16 v[104:119],v[36:39],v[204:207],v[104:119]
s_waitcnt lgkmcnt(12)
v_mfma_f32_32x32x16_bf16 v[88:103],v[40:43],a[112:115],v[88:103]
ds_read_b128 v[28:31],v19 offset:32768
v_mfma_f32_32x32x16_bf16 v[104:119],v[40:43],v[208:211],v[104:119]
v_mfma_f32_32x32x16_bf16 v[88:103],v[44:47],a[116:119],v[88:103]
ds_read_b128 v[32:35],v18 offset:34816
v_mfma_f32_32x32x16_bf16 v[104:119],v[44:47],v[212:215],v[104:119]
s_waitcnt lgkmcnt(7)
v_mfma_f32_32x32x16_bf16 v[88:103],v[48:51],a[120:123],v[88:103]
ds_read_b128 v[36:39],v19 offset:34816
v_mfma_f32_32x32x16_bf16 v[104:119],v[48:51],v[216:219],v[104:119]
v_mfma_f32_32x32x16_bf16 v[88:103],v[52:55],a[124:127],v[88:103]
ds_read_b128 v[40:43],v18 offset:36864
v_mfma_f32_32x32x16_bf16 v[104:119],v[52:55],v[220:223],v[104:119]
s_waitcnt lgkmcnt(3)
v_mfma_f32_32x32x16_bf16 v[88:103],v[24:27],a[128:131],v[88:103]
ds_read_b128 v[44:47],v19 offset:36864
s_waitcnt vmcnt(4)
v_cmp_eq_u32 vcc,0,v14
s_cmp_eq_u64 vcc,0
s_cselect_b32 s36,0,2147483648
v_mfma_f32_32x32x16_bf16 v[104:119],v[24:27],v[224:227],v[104:119]
v_cmp_eq_u32 vcc,0,v3
s_cmp_lt_u32 s78,64
s_cselect_b32 s36,s36,2147483648
s_cmp_eq_u64 vcc,0
s_cselect_b32 s60,1,s36
v_mfma_f32_32x32x16_bf16 v[88:103],v[28:31],a[132:135],v[88:103]
ds_read_b128 v[48:51],v18 offset:38912
s_cmp_lt_u32 s79,64
s_cselect_b32 s60,s60,s36
s_sub_u32 s61,s78,s79
s_or_b32 s61,s61,s36
v_mfma_f32_32x32x16_bf16 v[104:119],v[28:31],v[228:231],v[104:119]
s_cmp_lt_u32 s61,16
s_cselect_b32 s36,0,s60
v_mov_b32 v23,s36
s_waitcnt lgkmcnt(3)
v_mfma_f32_32x32x16_bf16 v[88:103],v[32:35],a[136:139],v[88:103]
ds_read_b128 v[52:55],v19 offset:38912
ds_write_b32 v13,v23
v_mfma_f32_32x32x16_bf16 v[104:119],v[32:35],v[232:235],v[104:119]
s_waitcnt lgkmcnt(0)
s_barrier
ds_read_b32 v23,v22
v_mfma_f32_32x32x16_bf16 v[88:103],v[36:39],a[140:143],v[88:103]
ds_read_b128 v[24:27],v16 offset:0
s_cmp_lt_u32 s50,2
s_cselect_b32 s42,1,0
s_cmp_ge_u32 s78,64
s_cselect_b32 s42,1,s42
v_mfma_f32_32x32x16_bf16 v[104:119],v[36:39],v[236:239],v[104:119]
s_or_b32 s42,s42,s37
s_mov_b32 s39,0
s_add_u32 s50,s50,1
s_sub_u32 s57,46080,s57
s_mov_b32 s51,s53
s_mov_b32 s52,s54
v_mfma_f32_32x32x16_bf16 v[88:103],v[40:43],a[144:147],v[88:103]
ds_read_b128 v[28:31],v17 offset:0
v_mfma_f32_32x32x16_bf16 v[104:119],v[40:43],v[240:243],v[104:119]
v_mfma_f32_32x32x16_bf16 v[88:103],v[44:47],a[148:151],v[88:103]
ds_read_b128 v[32:35],v16 offset:2048
s_waitcnt vmcnt(0)
s_mov_b64 exec,1
buffer_store_dword v5,v1,s[8:11],s82 offen sc1
s_mov_b64 exec,-1
s_mov_b32 s82,2147483648
v_mfma_f32_32x32x16_bf16 v[104:119],v[44:47],v[244:247],v[104:119]
s_waitcnt lgkmcnt(3)
v_readfirstlane_b32 s38,v23
s_and_b32 s37,s38,2147483648
s_and_b32 s33,s38,1
s_cselect_b32 s34,s79,s78
s_cmp_lg_u32 s42,0
v_mfma_f32_32x32x16_bf16 v[88:103],v[48:51],a[152:155],v[88:103]
ds_read_b128 v[36:39],v17 offset:2048
v_mfma_f32_32x32x16_bf16 v[104:119],v[48:51],v[248:251],v[104:119]
v_mfma_f32_32x32x16_bf16 v[88:103],v[52:55],a[156:159],v[88:103]
ds_read_b128 v[40:43],v16 offset:4096
v_mfma_f32_32x32x16_bf16 v[104:119],v[52:55],v[252:255],v[104:119]
s_cbranch_scc0 QKVV_B0
s_branch QKVV_S1
s_nop 9
QKVV_S0:
s_mov_b32 s55,0
s_cmp_lt_u32 s42,2
s_cbranch_scc1 nt_219
s_mov_b32 s55,2
s_cmp_lg_u32 s37,0
s_cbranch_scc1 nt_219
s_mov_b32 s55,1
s_lshl_b32 s60,s33,6
s_add_u32 s60,s60,s34
s_mul_i32 s60,s60,46080
s_add_u32 s60,s60,206569472
s_cmp_eq_u32 s33,0
s_cselect_b32 s67,2147483648,s60
s_mul_i32 s61,s46,10240
s_add_u32 s60,s60,s61
s_add_u32 s61,s61,s57
s_add_u32 m0,s61,0
s_add_u32 s63,s60,0
buffer_load_dwordx4 v1,s[8:11],s63 offen sc1 lds
buffer_load_dwordx4 v1,s[8:11],s63 offen offset:1024 sc1 lds
buffer_load_dwordx4 v1,s[8:11],s63 offen offset:2048 sc1 lds
buffer_load_dwordx4 v1,s[8:11],s63 offen offset:3072 sc1 lds
s_add_u32 m0,s61,4096
s_add_u32 s63,s60,4096
buffer_load_dwordx4 v1,s[8:11],s63 offen sc1 lds
buffer_load_dwordx4 v1,s[8:11],s63 offen offset:1024 sc1 lds
buffer_load_dwordx4 v1,s[8:11],s63 offen offset:2048 sc1 lds
buffer_load_dwordx4 v1,s[8:11],s63 offen offset:3072 sc1 lds
s_add_u32 m0,s61,8192
s_add_u32 s63,s60,8192
buffer_load_dwordx4 v1,s[8:11],s63 offen sc1 lds
buffer_load_dwordx4 v1,s[8:11],s63 offen offset:1024 sc1 lds
s_lshl_b32 s62,s46,10
s_add_u32 s62,s62,40960
s_add_u32 m0,s57,s62
s_add_u32 s63,s67,s62
buffer_load_dwordx4 v1,s[8:11],s63 offen sc1 lds
s_add_u32 m0,s57,45056
s_add_u32 s63,s67,45056
buffer_load_dwordx4 v1,s[8:11],s63 offen sc1 lds
nt_219:
s_nop 4
s_mul_i32 s74,s73,393216
s_add_u32 s74,s74,s39
s_add_u32 s74,s74,s70
v_fma_f32 v56,-v124,v120,v56
v_fma_f32 v57,-v126,v120,v57
v_fma_f32 v58,-v128,v120,v58
v_fma_f32 v59,-v130,v120,v59
v_fma_f32 v64,-v140,v120,v64
v_fma_f32 v65,-v142,v120,v65
v_fma_f32 v66,-v144,v120,v66
v_fma_f32 v67,-v146,v120,v67
v_mul_f32 v56,v56,v125
v_mul_f32 v57,v57,v127
v_mul_f32 v58,v58,v129
v_mul_f32 v59,v59,v131
v_mul_f32 v64,v64,v141
v_mul_f32 v65,v65,v143
v_mul_f32 v66,v66,v145
v_mul_f32 v67,v67,v147
v_cvt_pk_bf16_f32 v56,v56,v57
v_cvt_pk_bf16_f32 v57,v58,v59
v_cvt_pk_bf16_f32 v58,v64,v65
v_cvt_pk_bf16_f32 v59,v66,v67
buffer_store_dwordx4 v[56:59],v20,s[8:11],s74 offen sc1
v_fma_f32 v60,-v132,v120,v60
v_fma_f32 v61,-v134,v120,v61
v_fma_f32 v62,-v136,v120,v62
v_fma_f32 v63,-v138,v120,v63
v_fma_f32 v68,-v148,v120,v68
v_fma_f32 v69,-v150,v120,v69
v_fma_f32 v70,-v152,v120,v70
v_fma_f32 v71,-v154,v120,v71
v_mul_f32 v60,v60,v133
v_mul_f32 v61,v61,v135
v_mul_f32 v62,v62,v137
v_mul_f32 v63,v63,v139
v_mul_f32 v68,v68,v149
v_mul_f32 v69,v69,v151
v_mul_f32 v70,v70,v153
v_mul_f32 v71,v71,v155
v_cvt_pk_bf16_f32 v60,v60,v61
v_cvt_pk_bf16_f32 v61,v62,v63
v_cvt_pk_bf16_f32 v62,v68,v69
v_cvt_pk_bf16_f32 v63,v70,v71
buffer_store_dwordx4 v[60:63],v21,s[8:11],s74 offen sc1
v_fma_f32 v72,-v124,v121,v72
v_fma_f32 v73,-v126,v121,v73
v_fma_f32 v74,-v128,v121,v74
v_fma_f32 v75,-v130,v121,v75
v_fma_f32 v80,-v140,v121,v80
v_fma_f32 v81,-v142,v121,v81
v_fma_f32 v82,-v144,v121,v82
v_fma_f32 v83,-v146,v121,v83
v_mul_f32 v72,v72,v125
v_mul_f32 v73,v73,v127
v_mul_f32 v74,v74,v129
v_mul_f32 v75,v75,v131
v_mul_f32 v80,v80,v141
v_mul_f32 v81,v81,v143
v_mul_f32 v82,v82,v145
v_mul_f32 v83,v83,v147
v_cvt_pk_bf16_f32 v72,v72,v73
v_cvt_pk_bf16_f32 v73,v74,v75
v_cvt_pk_bf16_f32 v74,v80,v81
v_cvt_pk_bf16_f32 v75,v82,v83
buffer_store_dwordx4 v[72:75],v20,s[8:11],s74 offen offset:2048 sc1
v_fma_f32 v76,-v132,v121,v76
v_fma_f32 v77,-v134,v121,v77
v_fma_f32 v78,-v136,v121,v78
v_fma_f32 v79,-v138,v121,v79
v_fma_f32 v84,-v148,v121,v84
v_fma_f32 v85,-v150,v121,v85
v_fma_f32 v86,-v152,v121,v86
v_fma_f32 v87,-v154,v121,v87
v_mul_f32 v76,v76,v133
v_mul_f32 v77,v77,v135
v_mul_f32 v78,v78,v137
v_mul_f32 v79,v79,v139
v_mul_f32 v84,v84,v149
v_mul_f32 v85,v85,v151
v_mul_f32 v86,v86,v153
v_mul_f32 v87,v87,v155
v_cvt_pk_bf16_f32 v76,v76,v77
v_cvt_pk_bf16_f32 v77,v78,v79
v_cvt_pk_bf16_f32 v78,v84,v85
v_cvt_pk_bf16_f32 v79,v86,v87
buffer_store_dwordx4 v[76:79],v21,s[8:11],s74 offen offset:2048 sc1
s_lshl_b32 s82,s72,6
s_add_u32 s82,s82,s73
s_lshl_b32 s82,s82,9
s_add_u32 s82,s82,s71
s_lshl_b32 s75,s69,2
s_add_u32 s82,s82,s75
s_add_u32 s82,s82,s39
s_mov_b32 s59,s82
s_mov_b32 s82,2147483648
s_mov_b32 s39,2147483648
s_cmp_eq_u32 s55,0
s_cbranch_scc1 QKVV_B1
s_cmp_eq_u32 s55,1
s_cbranch_scc1 QKVV_CD1
s_waitcnt vmcnt(0)
s_mov_b64 exec,1
buffer_store_dword v5,v1,s[8:11],s59 offen sc1
s_mov_b64 exec,-1
s_mov_b32 s59,2147483648
s_cmp_eq_u32 s50,128
s_cbranch_scc1 QKVV_END
s_branch QKVV_COLD1
QKVV_COLD0:
s_cmp_lg_u32 s46,0
s_cbranch_scc1 cp_220
ct_221:
buffer_load_dword v3,v2,s[8:11],s35 offen sc1
buffer_load_dword v14,v4,s[8:11],s41 offen sc1
s_waitcnt vmcnt(0)
v_cmp_eq_u32 vcc,0,v14
s_cmp_eq_u64 vcc,0
s_cselect_b32 s36,0,2147483648
v_cmp_eq_u32 vcc,0,v3
s_cmp_lt_u32 s78,64
s_cselect_b32 s36,s36,2147483648
s_cmp_eq_u64 vcc,0
s_cselect_b32 s60,1,s36
s_cmp_lt_u32 s79,64
s_cselect_b32 s60,s60,s36
s_sub_u32 s61,s78,s79
s_or_b32 s61,s61,s36
s_cmp_lt_u32 s61,16
s_cselect_b32 s36,0,s60
v_mov_b32 v23,s36
s_cmp_lt_u32 s36,2
s_cbranch_scc1 ct_221x
s_sleep 3
s_sub_u32 s47,s47,1
s_cbranch_scc1 ABORT
s_branch ct_221
ct_221x:
ds_write_b32 v22,v23 offset:4
s_waitcnt lgkmcnt(0)
cp_220:
s_barrier
ds_read_b32 v23,v22 offset:4
s_waitcnt lgkmcnt(0)
v_readfirstlane_b32 s38,v23
s_and_b32 s38,s38,1
s_and_b32 s37,s38,2147483648
s_and_b32 s33,s38,1
s_cselect_b32 s34,s79,s78
s_lshl_b32 s60,s33,6
s_add_u32 s60,s60,s34
s_mul_i32 s60,s60,46080
s_add_u32 s60,s60,206569472
s_cmp_eq_u32 s33,0
s_cselect_b32 s67,2147483648,s60
s_mul_i32 s61,s46,10240
s_add_u32 s60,s60,s61
s_add_u32 s61,s61,s57
s_add_u32 m0,s61,0
s_add_u32 s63,s60,0
buffer_load_dwordx4 v1,s[8:11],s63 offen sc1 lds
buffer_load_dwordx4 v1,s[8:11],s63 offen offset:1024 sc1 lds
buffer_load_dwordx4 v1,s[8:11],s63 offen offset:2048 sc1 lds
buffer_load_dwordx4 v1,s[8:11],s63 offen offset:3072 sc1 lds
s_add_u32 m0,s61,4096
s_add_u32 s63,s60,4096
buffer_load_dwordx4 v1,s[8:11],s63 offen sc1 lds
buffer_load_dwordx4 v1,s[8:11],s63 offen offset:1024 sc1 lds
buffer_load_dwordx4 v1,s[8:11],s63 offen offset:2048 sc1 lds
buffer_load_dwordx4 v1,s[8:11],s63 offen offset:3072 sc1 lds
s_add_u32 m0,s61,8192
s_add_u32 s63,s60,8192
buffer_load_dwordx4 v1,s[8:11],s63 offen sc1 lds
buffer_load_dwordx4 v1,s[8:11],s63 offen offset:1024 sc1 lds
s_lshl_b32 s62,s46,10
s_add_u32 s62,s62,40960
s_add_u32 m0,s57,s62
s_add_u32 s63,s67,s62
buffer_load_dwordx4 v1,s[8:11],s63 offen sc1 lds
s_add_u32 m0,s57,45056
s_add_u32 s63,s67,45056
buffer_load_dwordx4 v1,s[8:11],s63 offen sc1 lds
QKVV_CD0:
s_mov_b32 s51,s33
s_mov_b32 s52,s34
s_mov_b32 s53,s33
s_mov_b32 s54,s34
s_add_u32 s79,s79,s33
s_or_b32 s60,s37,s33
s_cmp_eq_u32 s60,0
s_addc_u32 s78,s78,0
s_lshl_b32 s41,s78,9
s_add_u32 s41,s41,s40
s_lshl_b32 s35,s79,9
s_add_u32 s35,s35,s40
s_add_u32 s35,s35,32768
buffer_load_dword v3,v2,s[8:11],s35 offen sc1
buffer_load_dword v14,v4,s[8:11],s41 offen sc1
s_waitcnt vmcnt(0)
s_mov_b64 exec,1
buffer_store_dword v5,v1,s[8:11],s59 offen sc1
s_mov_b64 exec,-1
s_mov_b32 s59,2147483648
v_cmp_eq_u32 vcc,0,v14
s_cmp_eq_u64 vcc,0
s_cselect_b32 s36,0,2147483648
v_cmp_eq_u32 vcc,0,v3
s_cmp_lt_u32 s78,64
s_cselect_b32 s36,s36,2147483648
s_cmp_eq_u64 vcc,0
s_cselect_b32 s60,1,s36
s_cmp_lt_u32 s79,64
s_cselect_b32 s60,s60,s36
s_sub_u32 s61,s78,s79
s_or_b32 s61,s61,s36
s_cmp_lt_u32 s61,16
s_cselect_b32 s36,0,s60
v_mov_b32 v23,s36
ds_write_b32 v13,v23
s_waitcnt lgkmcnt(0)
s_barrier
ds_read_b32 v23,v22
ds_read_b128 v[24:27],v16 offset:0
ds_read_b128 v[28:31],v17 offset:0
ds_read_b128 v[32:35],v16 offset:2048
ds_read_b128 v[36:39],v17 offset:2048
ds_read_b128 v[40:43],v16 offset:4096
s_waitcnt lgkmcnt(5)
v_readfirstlane_b32 s38,v23
s_and_b32 s37,s38,2147483648
s_and_b32 s33,s38,1
s_cselect_b32 s34,s79,s78
s_nop 0
s_branch QKVV_B0
QKVV_S1:
s_mov_b32 s55,0
s_cmp_lt_u32 s42,2
s_cbranch_scc1 nt_222
s_mov_b32 s55,2
s_cmp_lg_u32 s37,0
s_cbranch_scc1 nt_222
s_mov_b32 s55,1
s_lshl_b32 s60,s33,6
s_add_u32 s60,s60,s34
s_mul_i32 s60,s60,46080
s_add_u32 s60,s60,206569472
s_cmp_eq_u32 s33,0
s_cselect_b32 s67,2147483648,s60
s_mul_i32 s61,s46,10240
s_add_u32 s60,s60,s61
s_add_u32 s61,s61,s57
s_add_u32 m0,s61,0
s_add_u32 s63,s60,0
buffer_load_dwordx4 v1,s[8:11],s63 offen sc1 lds
buffer_load_dwordx4 v1,s[8:11],s63 offen offset:1024 sc1 lds
buffer_load_dwordx4 v1,s[8:11],s63 offen offset:2048 sc1 lds
buffer_load_dwordx4 v1,s[8:11],s63 offen offset:3072 sc1 lds
s_add_u32 m0,s61,4096
s_add_u32 s63,s60,4096
buffer_load_dwordx4 v1,s[8:11],s63 offen sc1 lds
buffer_load_dwordx4 v1,s[8:11],s63 offen offset:1024 sc1 lds
buffer_load_dwordx4 v1,s[8:11],s63 offen offset:2048 sc1 lds
buffer_load_dwordx4 v1,s[8:11],s63 offen offset:3072 sc1 lds
s_add_u32 m0,s61,8192
s_add_u32 s63,s60,8192
buffer_load_dwordx4 v1,s[8:11],s63 offen sc1 lds
buffer_load_dwordx4 v1,s[8:11],s63 offen offset:1024 sc1 lds
s_lshl_b32 s62,s46,10
s_add_u32 s62,s62,40960
s_add_u32 m0,s57,s62
s_add_u32 s63,s67,s62
buffer_load_dwordx4 v1,s[8:11],s63 offen sc1 lds
s_add_u32 m0,s57,45056
s_add_u32 s63,s67,45056
buffer_load_dwordx4 v1,s[8:11],s63 offen sc1 lds
nt_222:
s_nop 4
s_mul_i32 s74,s73,393216
s_add_u32 s74,s74,s39
s_add_u32 s74,s74,s70
v_fma_f32 v88,-v124,v120,v88
v_fma_f32 v89,-v126,v120,v89
v_fma_f32 v90,-v128,v120,v90
v_fma_f32 v91,-v130,v120,v91
v_fma_f32 v96,-v140,v120,v96
v_fma_f32 v97,-v142,v120,v97
v_fma_f32 v98,-v144,v120,v98
v_fma_f32 v99,-v146,v120,v99
v_mul_f32 v88,v88,v125
v_mul_f32 v89,v89,v127
v_mul_f32 v90,v90,v129
v_mul_f32 v91,v91,v131
v_mul_f32 v96,v96,v141
v_mul_f32 v97,v97,v143
v_mul_f32 v98,v98,v145
v_mul_f32 v99,v99,v147
v_cvt_pk_bf16_f32 v88,v88,v89
v_cvt_pk_bf16_f32 v89,v90,v91
v_cvt_pk_bf16_f32 v90,v96,v97
v_cvt_pk_bf16_f32 v91,v98,v99
buffer_store_dwordx4 v[88:91],v20,s[8:11],s74 offen sc1
v_fma_f32 v92,-v132,v120,v92
v_fma_f32 v93,-v134,v120,v93
v_fma_f32 v94,-v136,v120,v94
v_fma_f32 v95,-v138,v120,v95
v_fma_f32 v100,-v148,v120,v100
v_fma_f32 v101,-v150,v120,v101
v_fma_f32 v102,-v152,v120,v102
v_fma_f32 v103,-v154,v120,v103
v_mul_f32 v92,v92,v133
v_mul_f32 v93,v93,v135
v_mul_f32 v94,v94,v137
v_mul_f32 v95,v95,v139
v_mul_f32 v100,v100,v149
v_mul_f32 v101,v101,v151
v_mul_f32 v102,v102,v153
v_mul_f32 v103,v103,v155
v_cvt_pk_bf16_f32 v92,v92,v93
v_cvt_pk_bf16_f32 v93,v94,v95
v_cvt_pk_bf16_f32 v94,v100,v101
v_cvt_pk_bf16_f32 v95,v102,v103
buffer_store_dwordx4 v[92:95],v21,s[8:11],s74 offen sc1
v_fma_f32 v104,-v124,v121,v104
v_fma_f32 v105,-v126,v121,v105
v_fma_f32 v106,-v128,v121,v106
v_fma_f32 v107,-v130,v121,v107
v_fma_f32 v112,-v140,v121,v112
v_fma_f32 v113,-v142,v121,v113
v_fma_f32 v114,-v144,v121,v114
v_fma_f32 v115,-v146,v121,v115
v_mul_f32 v104,v104,v125
v_mul_f32 v105,v105,v127
v_mul_f32 v106,v106,v129
v_mul_f32 v107,v107,v131
v_mul_f32 v112,v112,v141
v_mul_f32 v113,v113,v143
v_mul_f32 v114,v114,v145
v_mul_f32 v115,v115,v147
v_cvt_pk_bf16_f32 v104,v104,v105
v_cvt_pk_bf16_f32 v105,v106,v107
v_cvt_pk_bf16_f32 v106,v112,v113
v_cvt_pk_bf16_f32 v107,v114,v115
buffer_store_dwordx4 v[104:107],v20,s[8:11],s74 offen offset:2048 sc1
v_fma_f32 v108,-v132,v121,v108
v_fma_f32 v109,-v134,v121,v109
v_fma_f32 v110,-v136,v121,v110
v_fma_f32 v111,-v138,v121,v111
v_fma_f32 v116,-v148,v121,v116
v_fma_f32 v117,-v150,v121,v117
v_fma_f32 v118,-v152,v121,v118
v_fma_f32 v119,-v154,v121,v119
v_mul_f32 v108,v108,v133
v_mul_f32 v109,v109,v135
v_mul_f32 v110,v110,v137
v_mul_f32 v111,v111,v139
v_mul_f32 v116,v116,v149
v_mul_f32 v117,v117,v151
v_mul_f32 v118,v118,v153
v_mul_f32 v119,v119,v155
v_cvt_pk_bf16_f32 v108,v108,v109
v_cvt_pk_bf16_f32 v109,v110,v111
v_cvt_pk_bf16_f32 v110,v116,v117
v_cvt_pk_bf16_f32 v111,v118,v119
buffer_store_dwordx4 v[108:111],v21,s[8:11],s74 offen offset:2048 sc1
s_lshl_b32 s82,s72,6
s_add_u32 s82,s82,s73
s_lshl_b32 s82,s82,9
s_add_u32 s82,s82,s71
s_lshl_b32 s75,s69,2
s_add_u32 s82,s82,s75
s_add_u32 s82,s82,s39
s_mov_b32 s59,s82
s_mov_b32 s82,2147483648
s_mov_b32 s39,2147483648
s_cmp_eq_u32 s55,0
s_cbranch_scc1 QKVV_B0
s_cmp_eq_u32 s55,1
s_cbranch_scc1 QKVV_CD0
s_waitcnt vmcnt(0)
s_mov_b64 exec,1
buffer_store_dword v5,v1,s[8:11],s59 offen sc1
s_mov_b64 exec,-1
s_mov_b32 s59,2147483648
s_cmp_eq_u32 s50,128
s_cbranch_scc1 QKVV_END
s_branch QKVV_COLD0
QKVV_COLD1:
s_cmp_lg_u32 s46,0
s_cbranch_scc1 cp_223
ct_224:
buffer_load_dword v3,v2,s[8:11],s35 offen sc1
buffer_load_dword v14,v4,s[8:11],s41 offen sc1
s_waitcnt vmcnt(0)
v_cmp_eq_u32 vcc,0,v14
s_cmp_eq_u64 vcc,0
s_cselect_b32 s36,0,2147483648
v_cmp_eq_u32 vcc,0,v3
s_cmp_lt_u32 s78,64
s_cselect_b32 s36,s36,2147483648
s_cmp_eq_u64 vcc,0
s_cselect_b32 s60,1,s36
s_cmp_lt_u32 s79,64
s_cselect_b32 s60,s60,s36
s_sub_u32 s61,s78,s79
s_or_b32 s61,s61,s36
s_cmp_lt_u32 s61,16
s_cselect_b32 s36,0,s60
v_mov_b32 v23,s36
s_cmp_lt_u32 s36,2
s_cbranch_scc1 ct_224x
s_sleep 3
s_sub_u32 s47,s47,1
s_cbranch_scc1 ABORT
s_branch ct_224
ct_224x:
ds_write_b32 v22,v23 offset:4
s_waitcnt lgkmcnt(0)
cp_223:
s_barrier
ds_read_b32 v23,v22 offset:4
s_waitcnt lgkmcnt(0)
v_readfirstlane_b32 s38,v23
s_and_b32 s38,s38,1
s_and_b32 s37,s38,2147483648
s_and_b32 s33,s38,1
s_cselect_b32 s34,s79,s78
s_lshl_b32 s60,s33,6
s_add_u32 s60,s60,s34
s_mul_i32 s60,s60,46080
s_add_u32 s60,s60,206569472
s_cmp_eq_u32 s33,0
s_cselect_b32 s67,2147483648,s60
s_mul_i32 s61,s46,10240
s_add_u32 s60,s60,s61
s_add_u32 s61,s61,s57
s_add_u32 m0,s61,0
s_add_u32 s63,s60,0
buffer_load_dwordx4 v1,s[8:11],s63 offen sc1 lds
buffer_load_dwordx4 v1,s[8:11],s63 offen offset:1024 sc1 lds
buffer_load_dwordx4 v1,s[8:11],s63 offen offset:2048 sc1 lds
buffer_load_dwordx4 v1,s[8:11],s63 offen offset:3072 sc1 lds
s_add_u32 m0,s61,4096
s_add_u32 s63,s60,4096
buffer_load_dwordx4 v1,s[8:11],s63 offen sc1 lds
buffer_load_dwordx4 v1,s[8:11],s63 offen offset:1024 sc1 lds
buffer_load_dwordx4 v1,s[8:11],s63 offen offset:2048 sc1 lds
buffer_load_dwordx4 v1,s[8:11],s63 offen offset:3072 sc1 lds
s_add_u32 m0,s61,8192
s_add_u32 s63,s60,8192
buffer_load_dwordx4 v1,s[8:11],s63 offen sc1 lds
buffer_load_dwordx4 v1,s[8:11],s63 offen offset:1024 sc1 lds
s_lshl_b32 s62,s46,10
s_add_u32 s62,s62,40960
s_add_u32 m0,s57,s62
s_add_u32 s63,s67,s62
buffer_load_dwordx4 v1,s[8:11],s63 offen sc1 lds
s_add_u32 m0,s57,45056
s_add_u32 s63,s67,45056
buffer_load_dwordx4 v1,s[8:11],s63 offen sc1 lds
QKVV_CD1:
s_mov_b32 s51,s33
s_mov_b32 s52,s34
s_mov_b32 s53,s33
s_mov_b32 s54,s34
s_add_u32 s79,s79,s33
s_or_b32 s60,s37,s33
s_cmp_eq_u32 s60,0
s_addc_u32 s78,s78,0
s_lshl_b32 s41,s78,9
s_add_u32 s41,s41,s40
s_lshl_b32 s35,s79,9
s_add_u32 s35,s35,s40
s_add_u32 s35,s35,32768
buffer_load_dword v3,v2,s[8:11],s35 offen sc1
buffer_load_dword v14,v4,s[8:11],s41 offen sc1
s_waitcnt vmcnt(0)
s_mov_b64 exec,1
buffer_store_dword v5,v1,s[8:11],s59 offen sc1
s_mov_b64 exec,-1
s_mov_b32 s59,2147483648
v_cmp_eq_u32 vcc,0,v14
s_cmp_eq_u64 vcc,0
s_cselect_b32 s36,0,2147483648
v_cmp_eq_u32 vcc,0,v3
s_cmp_lt_u32 s78,64
s_cselect_b32 s36,s36,2147483648
s_cmp_eq_u64 vcc,0
s_cselect_b32 s60,1,s36
s_cmp_lt_u32 s79,64
s_cselect_b32 s60,s60,s36
s_sub_u32 s61,s78,s79
s_or_b32 s61,s61,s36
s_cmp_lt_u32 s61,16
s_cselect_b32 s36,0,s60
v_mov_b32 v23,s36
ds_write_b32 v13,v23
s_waitcnt lgkmcnt(0)
s_barrier
ds_read_b32 v23,v22
ds_read_b128 v[24:27],v18 offset:0
ds_read_b128 v[28:31],v19 offset:0
ds_read_b128 v[32:35],v18 offset:2048
ds_read_b128 v[36:39],v19 offset:2048
ds_read_b128 v[40:43],v18 offset:4096
s_waitcnt lgkmcnt(5)
v_readfirstlane_b32 s38,v23
s_and_b32 s37,s38,2147483648
s_and_b32 s33,s38,1
s_cselect_b32 s34,s79,s78
s_nop 0
s_branch QKVV_B1
QKVV_END:
s_endpgm
ROLE_ATT:
v_lshlrev_b32 v1,4,v0
v_mov_b32 v5,1
s_lshl_b32 s56,s48,2
s_add_u32 s56,s56,s46
v_bfe_u32 v6,v0,2,2
v_lshrrev_b32 v7,4,v0
v_add_u32 v7,v6,v7
v_and_b32 v7,3,v7
v_and_b32 v15,3,v0
v_lshlrev_b32 v15,4,v15
v_lshl_add_u32 v15,v7,6,v15
v_lshl_add_u32 v15,v6,8,v15
s_mov_b32 s68,s48
s_and_b32 s51,s46,1
s_lshr_b32 s86,s46,1
s_lshr_b32 s87,s68,3
s_lshl_b32 s87,s87,5
s_and_b32 s60,s68,7
s_add_u32 s87,s87,s60
v_lshlrev_b32 v229,3,v0
v_and_b32 v229,0x300,v1
v_add_u32 v229,v229,v1
v_mov_b32 v230,0xff800000
s_mov_b32 s80,-1
s_mov_b32 s81,0
s_mov_b32 s84,0x3d93cd3a
s_mov_b32 s85,0x3fb8aa3b
v_min_u32 v6,8,v0
v_mul_u32_u24 v7,86,v6
v_lshrrev_b32 v7,8,v7
v_mul_u32_u24 v8,3,v7
v_sub_u32 v6,v6,v8
s_mul_i32 s60,s68,3
v_add_u32 v6,s60,v6
v_lshlrev_b32 v2,2,v6
v_lshl_add_u32 v2,v7,16,v2
v_min_u32 v228,2,v0
v_lshlrev_b32 v228,2,v228
v_lshrrev_b32 v6,4,v0
v_lshlrev_b32 v6,2,v6
v_and_b32 v7,15,v0
v_add_u32 v8,0,v6
v_cmp_le_u32 s[72:73],v8,v7
v_add_u32 v8,1,v6
v_cmp_le_u32 s[74:75],v8,v7
v_add_u32 v8,2,v6
v_cmp_le_u32 s[76:77],v8,v7
v_add_u32 v8,3,v6
v_cmp_le_u32 s[78:79],v8,v7
s_mul_i32 s71,s68,12288
s_mul_i32 s60,s51,13
s_mul_i32 s69,s60,589824
s_mul_i32 s61,s68,18432
s_add_u32 s69,s69,s61
s_mul_i32 s61,s51,9216
s_add_u32 s69,s69,s61
s_add_u32 s69,s69,24120320
s_mul_i32 s70,s60,2048
s_lshl_b32 s61,s68,6
s_add_u32 s70,s70,s61
s_add_u32 s70,s70,688128
s_mul_i32 s69,s51,12582912
s_mul_i32 s61,s68,6144
s_add_u32 s69,s69,s61
s_add_u32 s69,s69,24117248
s_mul_i32 s70,s51,65536
s_lshl_b32 s61,s68,5
s_add_u32 s70,s70,s61
s_add_u32 s70,s70,688128
s_waitcnt vmcnt(0)
s_barrier
s_cmp_lg_u32 s46,0
s_cbranch_scc1 arr_225
v_mov_b32 v6,1
s_lshl_b32 s3,s49,2
v_mov_b32 v7,s3
s_mov_b64 exec,1
buffer_atomic_add v6,v7,s[12:15],0 offen sc1
s_mov_b64 exec,-1
arr_225:
s_mov_b32 s66,s56
s_and_b32 s53,s66,7
s_lshr_b32 s54,s66,3
v_lshrrev_b32 v6,4,v0
v_bfe_u32 v7,v0,2,2
v_and_b32 v8,3,v0
s_and_b32 s61,s53,3
s_lshl_b32 s60,s53,8
v_lshlrev_b32 v132,11,v6
v_lshrrev_b32 v9,1,v6
v_lshlrev_b32 v132,11,v9
v_and_b32 v9,1,v6
v_lshl_add_u32 v132,v9,12,v132
v_add_u32 v9,s61,v7
v_and_b32 v9,3,v9
v_lshl_add_u32 v132,v9,6,v132
v_lshl_add_u32 v132,v8,4,v132
v_add_u32 v132,s60,v132
s_lshl_b32 s60,s53,2
v_add_u32 v9,s60,v8
v_mul_u32_u24 v133,1280,v9
v_lshl_add_u32 v133,v6,5,v133
v_lshl_add_u32 v133,v7,3,v133
s_mov_b32 s4,s16
s_mov_b32 s5,s17
s_mov_b32 s6,2621440
s_mov_b32 s7,0x20000
s_mov_b32 s55,0
s_mul_i32 s62,s54,40960
buffer_load_dwordx2 v[32:33],v133,s[4:7],s62 offen offset:0
buffer_load_dwordx2 v[34:35],v133,s[4:7],s62 offen offset:128
buffer_load_dwordx2 v[36:37],v133,s[4:7],s62 offen offset:256
buffer_load_dwordx2 v[38:39],v133,s[4:7],s62 offen offset:384
buffer_load_dwordx2 v[40:41],v133,s[4:7],s62 offen offset:512
buffer_load_dwordx2 v[42:43],v133,s[4:7],s62 offen offset:640
buffer_load_dwordx2 v[44:45],v133,s[4:7],s62 offen offset:768
buffer_load_dwordx2 v[46:47],v133,s[4:7],s62 offen offset:896
buffer_load_dwordx2 v[48:49],v133,s[4:7],s62 offen offset:1024
buffer_load_dwordx2 v[50:51],v133,s[4:7],s62 offen offset:1152
s_add_u32 s66,s54,16
s_min_u32 s66,s66,63
s_mul_i32 s62,s66,40960
buffer_load_dwordx2 v[52:53],v133,s[4:7],s62 offen offset:0
buffer_load_dwordx2 v[54:55],v133,s[4:7],s62 offen offset:128
buffer_load_dwordx2 v[56:57],v133,s[4:7],s62 offen offset:256
buffer_load_dwordx2 v[58:59],v133,s[4:7],s62 offen offset:384
buffer_load_dwordx2 v[60:61],v133,s[4:7],s62 offen offset:512
buffer_load_dwordx2 v[62:63],v133,s[4:7],s62 offen offset:640
buffer_load_dwordx2 v[64:65],v133,s[4:7],s62 offen offset:768
buffer_load_dwordx2 v[66:67],v133,s[4:7],s62 offen offset:896
buffer_load_dwordx2 v[68:69],v133,s[4:7],s62 offen offset:1024
buffer_load_dwordx2 v[70:71],v133,s[4:7],s62 offen offset:1152
s_mul_i32 s64,s54,40960
s_add_u32 s64,s64,234749952
s_mul_i32 s65,s54,46080
s_add_u32 s65,s65,206569472
s_waitcnt vmcnt(10)
v_lshlrev_b32 v72,16,v32
v_and_b32 v73,0xffff0000,v32
v_lshlrev_b32 v74,16,v33
v_and_b32 v75,0xffff0000,v33
v_lshlrev_b32 v76,16,v34
v_and_b32 v77,0xffff0000,v34
v_lshlrev_b32 v78,16,v35
v_and_b32 v79,0xffff0000,v35
v_lshlrev_b32 v80,16,v36
v_and_b32 v81,0xffff0000,v36
v_lshlrev_b32 v82,16,v37
v_and_b32 v83,0xffff0000,v37
v_lshlrev_b32 v84,16,v38
v_and_b32 v85,0xffff0000,v38
v_lshlrev_b32 v86,16,v39
v_and_b32 v87,0xffff0000,v39
v_lshlrev_b32 v88,16,v40
v_and_b32 v89,0xffff0000,v40
v_lshlrev_b32 v90,16,v41
v_and_b32 v91,0xffff0000,v41
v_lshlrev_b32 v92,16,v42
v_and_b32 v93,0xffff0000,v42
v_lshlrev_b32 v94,16,v43
v_and_b32 v95,0xffff0000,v43
v_lshlrev_b32 v96,16,v44
v_and_b32 v97,0xffff0000,v44
v_lshlrev_b32 v98,16,v45
v_and_b32 v99,0xffff0000,v45
v_lshlrev_b32 v100,16,v46
v_and_b32 v101,0xffff0000,v46
v_lshlrev_b32 v102,16,v47
v_and_b32 v103,0xffff0000,v47
v_lshlrev_b32 v104,16,v48
v_and_b32 v105,0xffff0000,v48
v_lshlrev_b32 v106,16,v49
v_and_b32 v107,0xffff0000,v49
v_lshlrev_b32 v108,16,v50
v_and_b32 v109,0xffff0000,v50
v_lshlrev_b32 v110,16,v51
v_and_b32 v111,0xffff0000,v51
v_pk_add_f32 v[28:29],v[72:73],v[74:75]
v_pk_mul_f32 v[26:27],v[72:73],v[72:73]
v_pk_fma_f32 v[26:27],v[74:75],v[74:75],v[26:27]
v_pk_add_f32 v[28:29],v[28:29],v[76:77]
v_pk_fma_f32 v[26:27],v[76:77],v[76:77],v[26:27]
v_pk_add_f32 v[28:29],v[28:29],v[78:79]
v_pk_fma_f32 v[26:27],v[78:79],v[78:79],v[26:27]
v_pk_add_f32 v[28:29],v[28:29],v[80:81]
v_pk_fma_f32 v[26:27],v[80:81],v[80:81],v[26:27]
v_pk_add_f32 v[28:29],v[28:29],v[82:83]
v_pk_fma_f32 v[26:27],v[82:83],v[82:83],v[26:27]
v_pk_add_f32 v[28:29],v[28:29],v[84:85]
v_pk_fma_f32 v[26:27],v[84:85],v[84:85],v[26:27]
v_pk_add_f32 v[28:29],v[28:29],v[86:87]
v_pk_fma_f32 v[26:27],v[86:87],v[86:87],v[26:27]
v_pk_add_f32 v[28:29],v[28:29],v[88:89]
v_pk_fma_f32 v[26:27],v[88:89],v[88:89],v[26:27]
v_pk_add_f32 v[28:29],v[28:29],v[90:91]
v_pk_fma_f32 v[26:27],v[90:91],v[90:91],v[26:27]
v_pk_add_f32 v[28:29],v[28:29],v[92:93]
v_pk_fma_f32 v[26:27],v[92:93],v[92:93],v[26:27]
v_pk_add_f32 v[28:29],v[28:29],v[94:95]
v_pk_fma_f32 v[26:27],v[94:95],v[94:95],v[26:27]
v_pk_add_f32 v[28:29],v[28:29],v[96:97]
v_pk_fma_f32 v[26:27],v[96:97],v[96:97],v[26:27]
v_pk_add_f32 v[28:29],v[28:29],v[98:99]
v_pk_fma_f32 v[26:27],v[98:99],v[98:99],v[26:27]
v_pk_add_f32 v[28:29],v[28:29],v[100:101]
v_pk_fma_f32 v[26:27],v[100:101],v[100:101],v[26:27]
v_pk_add_f32 v[28:29],v[28:29],v[102:103]
v_pk_fma_f32 v[26:27],v[102:103],v[102:103],v[26:27]
v_pk_add_f32 v[28:29],v[28:29],v[104:105]
v_pk_fma_f32 v[26:27],v[104:105],v[104:105],v[26:27]
v_pk_add_f32 v[28:29],v[28:29],v[106:107]
v_pk_fma_f32 v[26:27],v[106:107],v[106:107],v[26:27]
v_pk_add_f32 v[28:29],v[28:29],v[108:109]
v_pk_fma_f32 v[26:27],v[108:109],v[108:109],v[26:27]
v_pk_add_f32 v[28:29],v[28:29],v[110:111]
v_pk_fma_f32 v[26:27],v[110:111],v[110:111],v[26:27]
v_add_f32 v24,v28,v29
v_add_f32 v25,v26,v27
s_nop 0
v_add_f32_dpp v24,v24,v24 row_ror:4 row_mask:0xf bank_mask:0xf
v_add_f32_dpp v25,v25,v25 row_ror:4 row_mask:0xf bank_mask:0xf
s_nop 0
v_add_f32_dpp v24,v24,v24 row_ror:8 row_mask:0xf bank_mask:0xf
v_add_f32_dpp v25,v25,v25 row_ror:8 row_mask:0xf bank_mask:0xf
v_mov_b32 v26,v24
v_mov_b32 v27,v25
s_nop 0
v_permlane32_swap_b32 v24,v26
v_permlane32_swap_b32 v25,v27
v_add_f32 v24,v24,v26
v_add_f32 v25,v25,v27
v_mov_b32 v26,v24
v_mov_b32 v27,v25
s_nop 0
v_permlane16_swap_b32 v24,v26
v_permlane16_swap_b32 v25,v27
v_add_f32 v24,v24,v26
v_add_f32 v25,v25,v27
v_mul_f32 v24,0x3acccccd,v24
v_mul_f32 v25,0x3acccccd,v25
v_fma_f32 v25,-v24,v24,v25
v_max_f32 v25,0,v25
v_cvt_pk_bf16_f32 v6,v24,v25
v_lshlrev_b32 v24,16,v6
v_and_b32 v25,0xffff0000,v6
v_add_f32 v25,0x3727c5ac,v25
v_cvt_pk_bf16_f32 v6,v25,v25
v_lshlrev_b32 v25,16,v6
v_sqrt_f32 v25,v25
s_nop 0
v_cvt_pk_bf16_f32 v6,v25,v25
v_lshlrev_b32 v25,16,v6
v_rcp_f32 v25,v25
s_nop 0
v_pk_add_f32 v[72:73],v[72:73],v[24:25] op_sel_hi:[1,0] neg_lo:[0,1] neg_hi:[0,1]
v_pk_add_f32 v[74:75],v[74:75],v[24:25] op_sel_hi:[1,0] neg_lo:[0,1] neg_hi:[0,1]
v_pk_add_f32 v[76:77],v[76:77],v[24:25] op_sel_hi:[1,0] neg_lo:[0,1] neg_hi:[0,1]
v_pk_add_f32 v[78:79],v[78:79],v[24:25] op_sel_hi:[1,0] neg_lo:[0,1] neg_hi:[0,1]
v_pk_add_f32 v[80:81],v[80:81],v[24:25] op_sel_hi:[1,0] neg_lo:[0,1] neg_hi:[0,1]
v_pk_add_f32 v[82:83],v[82:83],v[24:25] op_sel_hi:[1,0] neg_lo:[0,1] neg_hi:[0,1]
v_pk_add_f32 v[84:85],v[84:85],v[24:25] op_sel_hi:[1,0] neg_lo:[0,1] neg_hi:[0,1]
v_pk_add_f32 v[86:87],v[86:87],v[24:25] op_sel_hi:[1,0] neg_lo:[0,1] neg_hi:[0,1]
v_pk_add_f32 v[88:89],v[88:89],v[24:25] op_sel_hi:[1,0] neg_lo:[0,1] neg_hi:[0,1]
v_pk_add_f32 v[90:91],v[90:91],v[24:25] op_sel_hi:[1,0] neg_lo:[0,1] neg_hi:[0,1]
v_pk_add_f32 v[92:93],v[92:93],v[24:25] op_sel_hi:[1,0] neg_lo:[0,1] neg_hi:[0,1]
v_pk_add_f32 v[94:95],v[94:95],v[24:25] op_sel_hi:[1,0] neg_lo:[0,1] neg_hi:[0,1]
v_pk_add_f32 v[96:97],v[96:97],v[24:25] op_sel_hi:[1,0] neg_lo:[0,1] neg_hi:[0,1]
v_pk_add_f32 v[98:99],v[98:99],v[24:25] op_sel_hi:[1,0] neg_lo:[0,1] neg_hi:[0,1]
v_pk_add_f32 v[100:101],v[100:101],v[24:25] op_sel_hi:[1,0] neg_lo:[0,1] neg_hi:[0,1]
v_pk_add_f32 v[102:103],v[102:103],v[24:25] op_sel_hi:[1,0] neg_lo:[0,1] neg_hi:[0,1]
v_pk_add_f32 v[104:105],v[104:105],v[24:25] op_sel_hi:[1,0] neg_lo:[0,1] neg_hi:[0,1]
v_pk_add_f32 v[106:107],v[106:107],v[24:25] op_sel_hi:[1,0] neg_lo:[0,1] neg_hi:[0,1]
v_pk_add_f32 v[108:109],v[108:109],v[24:25] op_sel_hi:[1,0] neg_lo:[0,1] neg_hi:[0,1]
v_pk_add_f32 v[110:111],v[110:111],v[24:25] op_sel_hi:[1,0] neg_lo:[0,1] neg_hi:[0,1]
v_cvt_pk_bf16_f32 v6,v72,v73
v_lshlrev_b32 v72,16,v6
v_and_b32 v73,0xffff0000,v6
v_cvt_pk_bf16_f32 v8,v74,v75
v_lshlrev_b32 v74,16,v8
v_and_b32 v75,0xffff0000,v8
v_cvt_pk_bf16_f32 v6,v76,v77
v_lshlrev_b32 v76,16,v6
v_and_b32 v77,0xffff0000,v6
v_cvt_pk_bf16_f32 v8,v78,v79
v_lshlrev_b32 v78,16,v8
v_and_b32 v79,0xffff0000,v8
v_cvt_pk_bf16_f32 v6,v80,v81
v_lshlrev_b32 v80,16,v6
v_and_b32 v81,0xffff0000,v6
v_cvt_pk_bf16_f32 v8,v82,v83
v_lshlrev_b32 v82,16,v8
v_and_b32 v83,0xffff0000,v8
v_cvt_pk_bf16_f32 v6,v84,v85
v_lshlrev_b32 v84,16,v6
v_and_b32 v85,0xffff0000,v6
v_cvt_pk_bf16_f32 v8,v86,v87
v_lshlrev_b32 v86,16,v8
v_and_b32 v87,0xffff0000,v8
v_cvt_pk_bf16_f32 v6,v88,v89
v_lshlrev_b32 v88,16,v6
v_and_b32 v89,0xffff0000,v6
v_cvt_pk_bf16_f32 v8,v90,v91
v_lshlrev_b32 v90,16,v8
v_and_b32 v91,0xffff0000,v8
v_cvt_pk_bf16_f32 v6,v92,v93
v_lshlrev_b32 v92,16,v6
v_and_b32 v93,0xffff0000,v6
v_cvt_pk_bf16_f32 v8,v94,v95
v_lshlrev_b32 v94,16,v8
v_and_b32 v95,0xffff0000,v8
v_cvt_pk_bf16_f32 v6,v96,v97
v_lshlrev_b32 v96,16,v6
v_and_b32 v97,0xffff0000,v6
v_cvt_pk_bf16_f32 v8,v98,v99
v_lshlrev_b32 v98,16,v8
v_and_b32 v99,0xffff0000,v8
v_cvt_pk_bf16_f32 v6,v100,v101
v_lshlrev_b32 v100,16,v6
v_and_b32 v101,0xffff0000,v6
v_cvt_pk_bf16_f32 v8,v102,v103
v_lshlrev_b32 v102,16,v8
v_and_b32 v103,0xffff0000,v8
v_cvt_pk_bf16_f32 v6,v104,v105
v_lshlrev_b32 v104,16,v6
v_and_b32 v105,0xffff0000,v6
v_cvt_pk_bf16_f32 v8,v106,v107
v_lshlrev_b32 v106,16,v8
v_and_b32 v107,0xffff0000,v8
v_cvt_pk_bf16_f32 v6,v108,v109
v_lshlrev_b32 v108,16,v6
v_and_b32 v109,0xffff0000,v6
v_cvt_pk_bf16_f32 v8,v110,v111
v_lshlrev_b32 v110,16,v8
v_and_b32 v111,0xffff0000,v8
v_pk_mul_f32 v[72:73],v[72:73],v[24:25] op_sel:[0,1] op_sel_hi:[1,1]
v_pk_mul_f32 v[74:75],v[74:75],v[24:25] op_sel:[0,1] op_sel_hi:[1,1]
v_pk_mul_f32 v[76:77],v[76:77],v[24:25] op_sel:[0,1] op_sel_hi:[1,1]
v_pk_mul_f32 v[78:79],v[78:79],v[24:25] op_sel:[0,1] op_sel_hi:[1,1]
v_pk_mul_f32 v[80:81],v[80:81],v[24:25] op_sel:[0,1] op_sel_hi:[1,1]
v_pk_mul_f32 v[82:83],v[82:83],v[24:25] op_sel:[0,1] op_sel_hi:[1,1]
v_pk_mul_f32 v[84:85],v[84:85],v[24:25] op_sel:[0,1] op_sel_hi:[1,1]
v_pk_mul_f32 v[86:87],v[86:87],v[24:25] op_sel:[0,1] op_sel_hi:[1,1]
v_pk_mul_f32 v[88:89],v[88:89],v[24:25] op_sel:[0,1] op_sel_hi:[1,1]
v_pk_mul_f32 v[90:91],v[90:91],v[24:25] op_sel:[0,1] op_sel_hi:[1,1]
v_pk_mul_f32 v[92:93],v[92:93],v[24:25] op_sel:[0,1] op_sel_hi:[1,1]
v_pk_mul_f32 v[94:95],v[94:95],v[24:25] op_sel:[0,1] op_sel_hi:[1,1]
v_pk_mul_f32 v[96:97],v[96:97],v[24:25] op_sel:[0,1] op_sel_hi:[1,1]
v_pk_mul_f32 v[98:99],v[98:99],v[24:25] op_sel:[0,1] op_sel_hi:[1,1]
v_pk_mul_f32 v[100:101],v[100:101],v[24:25] op_sel:[0,1] op_sel_hi:[1,1]
v_pk_mul_f32 v[102:103],v[102:103],v[24:25] op_sel:[0,1] op_sel_hi:[1,1]
v_pk_mul_f32 v[104:105],v[104:105],v[24:25] op_sel:[0,1] op_sel_hi:[1,1]
v_pk_mul_f32 v[106:107],v[106:107],v[24:25] op_sel:[0,1] op_sel_hi:[1,1]
v_pk_mul_f32 v[108:109],v[108:109],v[24:25] op_sel:[0,1] op_sel_hi:[1,1]
v_pk_mul_f32 v[110:111],v[110:111],v[24:25] op_sel:[0,1] op_sel_hi:[1,1]
v_cvt_pk_bf16_f32 v112,v72,v73
v_lshlrev_b32 v72,16,v112
v_and_b32 v73,0xffff0000,v112
v_cvt_pk_bf16_f32 v113,v74,v75
v_lshlrev_b32 v74,16,v113
v_and_b32 v75,0xffff0000,v113
v_cvt_pk_bf16_f32 v114,v76,v77
v_lshlrev_b32 v76,16,v114
v_and_b32 v77,0xffff0000,v114
v_cvt_pk_bf16_f32 v115,v78,v79
v_lshlrev_b32 v78,16,v115
v_and_b32 v79,0xffff0000,v115
v_cvt_pk_bf16_f32 v116,v80,v81
v_lshlrev_b32 v80,16,v116
v_and_b32 v81,0xffff0000,v116
v_cvt_pk_bf16_f32 v117,v82,v83
v_lshlrev_b32 v82,16,v117
v_and_b32 v83,0xffff0000,v117
v_cvt_pk_bf16_f32 v118,v84,v85
v_lshlrev_b32 v84,16,v118
v_and_b32 v85,0xffff0000,v118
v_cvt_pk_bf16_f32 v119,v86,v87
v_lshlrev_b32 v86,16,v119
v_and_b32 v87,0xffff0000,v119
v_cvt_pk_bf16_f32 v120,v88,v89
v_lshlrev_b32 v88,16,v120
v_and_b32 v89,0xffff0000,v120
v_cvt_pk_bf16_f32 v121,v90,v91
v_lshlrev_b32 v90,16,v121
v_and_b32 v91,0xffff0000,v121
v_cvt_pk_bf16_f32 v122,v92,v93
v_lshlrev_b32 v92,16,v122
v_and_b32 v93,0xffff0000,v122
v_cvt_pk_bf16_f32 v123,v94,v95
v_lshlrev_b32 v94,16,v123
v_and_b32 v95,0xffff0000,v123
v_cvt_pk_bf16_f32 v124,v96,v97
v_lshlrev_b32 v96,16,v124
v_and_b32 v97,0xffff0000,v124
v_cvt_pk_bf16_f32 v125,v98,v99
v_lshlrev_b32 v98,16,v125
v_and_b32 v99,0xffff0000,v125
v_cvt_pk_bf16_f32 v126,v100,v101
v_lshlrev_b32 v100,16,v126
v_and_b32 v101,0xffff0000,v126
v_cvt_pk_bf16_f32 v127,v102,v103
v_lshlrev_b32 v102,16,v127
v_and_b32 v103,0xffff0000,v127
v_cvt_pk_bf16_f32 v128,v104,v105
v_lshlrev_b32 v104,16,v128
v_and_b32 v105,0xffff0000,v128
v_cvt_pk_bf16_f32 v129,v106,v107
v_lshlrev_b32 v106,16,v129
v_and_b32 v107,0xffff0000,v129
v_cvt_pk_bf16_f32 v130,v108,v109
v_lshlrev_b32 v108,16,v130
v_and_b32 v109,0xffff0000,v130
v_cvt_pk_bf16_f32 v131,v110,v111
v_lshlrev_b32 v110,16,v131
v_and_b32 v111,0xffff0000,v131
s_add_u32 s63,s65,0
v_permlane16_swap_b32 v112,v114
v_permlane16_swap_b32 v113,v115
buffer_store_dwordx4 v[112:115],v132,s[8:11],s63 offen sc1
s_add_u32 s63,s65,8192
v_permlane16_swap_b32 v116,v118
v_permlane16_swap_b32 v117,v119
buffer_store_dwordx4 v[116:119],v132,s[8:11],s63 offen sc1
s_add_u32 s63,s65,16384
v_permlane16_swap_b32 v120,v122
v_permlane16_swap_b32 v121,v123
buffer_store_dwordx4 v[120:123],v132,s[8:11],s63 offen sc1
s_add_u32 s63,s65,24576
v_permlane16_swap_b32 v124,v126
v_permlane16_swap_b32 v125,v127
buffer_store_dwordx4 v[124:127],v132,s[8:11],s63 offen sc1
s_add_u32 s63,s65,32768
v_permlane16_swap_b32 v128,v130
v_permlane16_swap_b32 v129,v131
buffer_store_dwordx4 v[128:131],v132,s[8:11],s63 offen sc1
s_add_u32 s63,s64,0
v_permlane16_swap_b32 v32,v34
v_permlane16_swap_b32 v33,v35
buffer_store_dwordx4 v[32:35],v132,s[8:11],s63 offen sc1
s_add_u32 s63,s64,8192
v_permlane16_swap_b32 v36,v38
v_permlane16_swap_b32 v37,v39
buffer_store_dwordx4 v[36:39],v132,s[8:11],s63 offen sc1
s_add_u32 s63,s64,16384
v_permlane16_swap_b32 v40,v42
v_permlane16_swap_b32 v41,v43
buffer_store_dwordx4 v[40:43],v132,s[8:11],s63 offen sc1
s_add_u32 s63,s64,24576
v_permlane16_swap_b32 v44,v46
v_permlane16_swap_b32 v45,v47
buffer_store_dwordx4 v[44:47],v132,s[8:11],s63 offen sc1
s_add_u32 s63,s64,32768
v_permlane16_swap_b32 v48,v50
v_permlane16_swap_b32 v49,v51
buffer_store_dwordx4 v[48:51],v132,s[8:11],s63 offen sc1
s_lshl_b32 s82,s55,6
s_add_u32 s82,s82,s54
s_lshl_b32 s82,s82,9
s_add_u32 s82,s82,0
s_lshl_b32 s61,s53,2
s_add_u32 s82,s82,s61
s_add_u32 s54,s54,16
s_lshl_b32 s3,s49,2
v_mov_b32 v7,s3
s_nop 1
ibw_226:
buffer_load_dword v6,v7,s[12:15],0 offen sc1
s_waitcnt vmcnt(0)
v_cmp_ne_u32 vcc,256,v6
s_nop 0
s_cbranch_vccz ok_227
s_sleep 8
s_sub_u32 s47,s47,1
s_cbranch_scc1 ABORT
s_branch ibw_226
ok_227:
s_cmp_lg_u32 s49,0
s_cbranch_scc1 ibok_228
v_and_b32 v7,7,v0
v_lshlrev_b32 v7,2,v7
buffer_load_dword v6,v7,s[12:15],0 offen offset:32 sc1
s_waitcnt vmcnt(0)
v_cmp_ne_u32 vcc,32,v6
s_nop 0
s_cbranch_vccz ibok_228
s_barrier
s_mov_b32 s49,1
s_mov_b32 s3,s2
s_load_dwordx16 s[16:31],s[0:1],0
s_load_dwordx8 s[32:39],s[0:1],64
s_waitcnt lgkmcnt(0)
s_branch DISPATCH
ibok_228:
s_mov_b64 exec,1
buffer_store_dword v5,v1,s[8:11],s82 offen sc1
s_mov_b64 exec,-1
s_add_u32 s66,s54,16
s_min_u32 s66,s66,63
s_mul_i32 s62,s66,40960
buffer_load_dwordx2 v[32:33],v133,s[4:7],s62 offen offset:0
buffer_load_dwordx2 v[34:35],v133,s[4:7],s62 offen offset:128
buffer_load_dwordx2 v[36:37],v133,s[4:7],s62 offen offset:256
buffer_load_dwordx2 v[38:39],v133,s[4:7],s62 offen offset:384
buffer_load_dwordx2 v[40:41],v133,s[4:7],s62 offen offset:512
buffer_load_dwordx2 v[42:43],v133,s[4:7],s62 offen offset:640
buffer_load_dwordx2 v[44:45],v133,s[4:7],s62 offen offset:768
buffer_load_dwordx2 v[46:47],v133,s[4:7],s62 offen offset:896
buffer_load_dwordx2 v[48:49],v133,s[4:7],s62 offen offset:1024
buffer_load_dwordx2 v[50:51],v133,s[4:7],s62 offen offset:1152
s_mul_i32 s64,s54,40960
s_add_u32 s64,s64,234749952
s_mul_i32 s65,s54,46080
s_add_u32 s65,s65,206569472
s_waitcnt vmcnt(10)
v_lshlrev_b32 v72,16,v52
v_and_b32 v73,0xffff0000,v52
v_lshlrev_b32 v74,16,v53
v_and_b32 v75,0xffff0000,v53
v_lshlrev_b32 v76,16,v54
v_and_b32 v77,0xffff0000,v54
v_lshlrev_b32 v78,16,v55
v_and_b32 v79,0xffff0000,v55
v_lshlrev_b32 v80,16,v56
v_and_b32 v81,0xffff0000,v56
v_lshlrev_b32 v82,16,v57
v_and_b32 v83,0xffff0000,v57
v_lshlrev_b32 v84,16,v58
v_and_b32 v85,0xffff0000,v58
v_lshlrev_b32 v86,16,v59
v_and_b32 v87,0xffff0000,v59
v_lshlrev_b32 v88,16,v60
v_and_b32 v89,0xffff0000,v60
v_lshlrev_b32 v90,16,v61
v_and_b32 v91,0xffff0000,v61
v_lshlrev_b32 v92,16,v62
v_and_b32 v93,0xffff0000,v62
v_lshlrev_b32 v94,16,v63
v_and_b32 v95,0xffff0000,v63
v_lshlrev_b32 v96,16,v64
v_and_b32 v97,0xffff0000,v64
v_lshlrev_b32 v98,16,v65
v_and_b32 v99,0xffff0000,v65
v_lshlrev_b32 v100,16,v66
v_and_b32 v101,0xffff0000,v66
v_lshlrev_b32 v102,16,v67
v_and_b32 v103,0xffff0000,v67
v_lshlrev_b32 v104,16,v68
v_and_b32 v105,0xffff0000,v68
v_lshlrev_b32 v106,16,v69
v_and_b32 v107,0xffff0000,v69
v_lshlrev_b32 v108,16,v70
v_and_b32 v109,0xffff0000,v70
v_lshlrev_b32 v110,16,v71
v_and_b32 v111,0xffff0000,v71
v_pk_add_f32 v[28:29],v[72:73],v[74:75]
v_pk_mul_f32 v[26:27],v[72:73],v[72:73]
v_pk_fma_f32 v[26:27],v[74:75],v[74:75],v[26:27]
v_pk_add_f32 v[28:29],v[28:29],v[76:77]
v_pk_fma_f32 v[26:27],v[76:77],v[76:77],v[26:27]
v_pk_add_f32 v[28:29],v[28:29],v[78:79]
v_pk_fma_f32 v[26:27],v[78:79],v[78:79],v[26:27]
v_pk_add_f32 v[28:29],v[28:29],v[80:81]
v_pk_fma_f32 v[26:27],v[80:81],v[80:81],v[26:27]
v_pk_add_f32 v[28:29],v[28:29],v[82:83]
v_pk_fma_f32 v[26:27],v[82:83],v[82:83],v[26:27]
v_pk_add_f32 v[28:29],v[28:29],v[84:85]
v_pk_fma_f32 v[26:27],v[84:85],v[84:85],v[26:27]
v_pk_add_f32 v[28:29],v[28:29],v[86:87]
v_pk_fma_f32 v[26:27],v[86:87],v[86:87],v[26:27]
v_pk_add_f32 v[28:29],v[28:29],v[88:89]
v_pk_fma_f32 v[26:27],v[88:89],v[88:89],v[26:27]
v_pk_add_f32 v[28:29],v[28:29],v[90:91]
v_pk_fma_f32 v[26:27],v[90:91],v[90:91],v[26:27]
v_pk_add_f32 v[28:29],v[28:29],v[92:93]
v_pk_fma_f32 v[26:27],v[92:93],v[92:93],v[26:27]
v_pk_add_f32 v[28:29],v[28:29],v[94:95]
v_pk_fma_f32 v[26:27],v[94:95],v[94:95],v[26:27]
v_pk_add_f32 v[28:29],v[28:29],v[96:97]
v_pk_fma_f32 v[26:27],v[96:97],v[96:97],v[26:27]
v_pk_add_f32 v[28:29],v[28:29],v[98:99]
v_pk_fma_f32 v[26:27],v[98:99],v[98:99],v[26:27]
v_pk_add_f32 v[28:29],v[28:29],v[100:101]
v_pk_fma_f32 v[26:27],v[100:101],v[100:101],v[26:27]
v_pk_add_f32 v[28:29],v[28:29],v[102:103]
v_pk_fma_f32 v[26:27],v[102:103],v[102:103],v[26:27]
v_pk_add_f32 v[28:29],v[28:29],v[104:105]
v_pk_fma_f32 v[26:27],v[104:105],v[104:105],v[26:27]
v_pk_add_f32 v[28:29],v[28:29],v[106:107]
v_pk_fma_f32 v[26:27],v[106:107],v[106:107],v[26:27]
v_pk_add_f32 v[28:29],v[28:29],v[108:109]
v_pk_fma_f32 v[26:27],v[108:109],v[108:109],v[26:27]
v_pk_add_f32 v[28:29],v[28:29],v[110:111]
v_pk_fma_f32 v[26:27],v[110:111],v[110:111],v[26:27]
v_add_f32 v24,v28,v29
v_add_f32 v25,v26,v27
s_nop 0
v_add_f32_dpp v24,v24,v24 row_ror:4 row_mask:0xf bank_mask:0xf
v_add_f32_dpp v25,v25,v25 row_ror:4 row_mask:0xf bank_mask:0xf
s_nop 0
v_add_f32_dpp v24,v24,v24 row_ror:8 row_mask:0xf bank_mask:0xf
v_add_f32_dpp v25,v25,v25 row_ror:8 row_mask:0xf bank_mask:0xf
v_mov_b32 v26,v24
v_mov_b32 v27,v25
s_nop 0
v_permlane32_swap_b32 v24,v26
v_permlane32_swap_b32 v25,v27
v_add_f32 v24,v24,v26
v_add_f32 v25,v25,v27
v_mov_b32 v26,v24
v_mov_b32 v27,v25
s_nop 0
v_permlane16_swap_b32 v24,v26
v_permlane16_swap_b32 v25,v27
v_add_f32 v24,v24,v26
v_add_f32 v25,v25,v27
v_mul_f32 v24,0x3acccccd,v24
v_mul_f32 v25,0x3acccccd,v25
v_fma_f32 v25,-v24,v24,v25
v_max_f32 v25,0,v25
v_cvt_pk_bf16_f32 v6,v24,v25
v_lshlrev_b32 v24,16,v6
v_and_b32 v25,0xffff0000,v6
v_add_f32 v25,0x3727c5ac,v25
v_cvt_pk_bf16_f32 v6,v25,v25
v_lshlrev_b32 v25,16,v6
v_sqrt_f32 v25,v25
s_nop 0
v_cvt_pk_bf16_f32 v6,v25,v25
v_lshlrev_b32 v25,16,v6
v_rcp_f32 v25,v25
s_nop 0
v_pk_add_f32 v[72:73],v[72:73],v[24:25] op_sel_hi:[1,0] neg_lo:[0,1] neg_hi:[0,1]
v_pk_add_f32 v[74:75],v[74:75],v[24:25] op_sel_hi:[1,0] neg_lo:[0,1] neg_hi:[0,1]
v_pk_add_f32 v[76:77],v[76:77],v[24:25] op_sel_hi:[1,0] neg_lo:[0,1] neg_hi:[0,1]
v_pk_add_f32 v[78:79],v[78:79],v[24:25] op_sel_hi:[1,0] neg_lo:[0,1] neg_hi:[0,1]
v_pk_add_f32 v[80:81],v[80:81],v[24:25] op_sel_hi:[1,0] neg_lo:[0,1] neg_hi:[0,1]
v_pk_add_f32 v[82:83],v[82:83],v[24:25] op_sel_hi:[1,0] neg_lo:[0,1] neg_hi:[0,1]
v_pk_add_f32 v[84:85],v[84:85],v[24:25] op_sel_hi:[1,0] neg_lo:[0,1] neg_hi:[0,1]
v_pk_add_f32 v[86:87],v[86:87],v[24:25] op_sel_hi:[1,0] neg_lo:[0,1] neg_hi:[0,1]
v_pk_add_f32 v[88:89],v[88:89],v[24:25] op_sel_hi:[1,0] neg_lo:[0,1] neg_hi:[0,1]
v_pk_add_f32 v[90:91],v[90:91],v[24:25] op_sel_hi:[1,0] neg_lo:[0,1] neg_hi:[0,1]
v_pk_add_f32 v[92:93],v[92:93],v[24:25] op_sel_hi:[1,0] neg_lo:[0,1] neg_hi:[0,1]
v_pk_add_f32 v[94:95],v[94:95],v[24:25] op_sel_hi:[1,0] neg_lo:[0,1] neg_hi:[0,1]
v_pk_add_f32 v[96:97],v[96:97],v[24:25] op_sel_hi:[1,0] neg_lo:[0,1] neg_hi:[0,1]
v_pk_add_f32 v[98:99],v[98:99],v[24:25] op_sel_hi:[1,0] neg_lo:[0,1] neg_hi:[0,1]
v_pk_add_f32 v[100:101],v[100:101],v[24:25] op_sel_hi:[1,0] neg_lo:[0,1] neg_hi:[0,1]
v_pk_add_f32 v[102:103],v[102:103],v[24:25] op_sel_hi:[1,0] neg_lo:[0,1] neg_hi:[0,1]
v_pk_add_f32 v[104:105],v[104:105],v[24:25] op_sel_hi:[1,0] neg_lo:[0,1] neg_hi:[0,1]
v_pk_add_f32 v[106:107],v[106:107],v[24:25] op_sel_hi:[1,0] neg_lo:[0,1] neg_hi:[0,1]
v_pk_add_f32 v[108:109],v[108:109],v[24:25] op_sel_hi:[1,0] neg_lo:[0,1] neg_hi:[0,1]
v_pk_add_f32 v[110:111],v[110:111],v[24:25] op_sel_hi:[1,0] neg_lo:[0,1] neg_hi:[0,1]
v_cvt_pk_bf16_f32 v6,v72,v73
v_lshlrev_b32 v72,16,v6
v_and_b32 v73,0xffff0000,v6
v_cvt_pk_bf16_f32 v8,v74,v75
v_lshlrev_b32 v74,16,v8
v_and_b32 v75,0xffff0000,v8
v_cvt_pk_bf16_f32 v6,v76,v77
v_lshlrev_b32 v76,16,v6
v_and_b32 v77,0xffff0000,v6
v_cvt_pk_bf16_f32 v8,v78,v79
v_lshlrev_b32 v78,16,v8
v_and_b32 v79,0xffff0000,v8
v_cvt_pk_bf16_f32 v6,v80,v81
v_lshlrev_b32 v80,16,v6
v_and_b32 v81,0xffff0000,v6
v_cvt_pk_bf16_f32 v8,v82,v83
v_lshlrev_b32 v82,16,v8
v_and_b32 v83,0xffff0000,v8
v_cvt_pk_bf16_f32 v6,v84,v85
v_lshlrev_b32 v84,16,v6
v_and_b32 v85,0xffff0000,v6
v_cvt_pk_bf16_f32 v8,v86,v87
v_lshlrev_b32 v86,16,v8
v_and_b32 v87,0xffff0000,v8
v_cvt_pk_bf16_f32 v6,v88,v89
v_lshlrev_b32 v88,16,v6
v_and_b32 v89,0xffff0000,v6
v_cvt_pk_bf16_f32 v8,v90,v91
v_lshlrev_b32 v90,16,v8
v_and_b32 v91,0xffff0000,v8
v_cvt_pk_bf16_f32 v6,v92,v93
v_lshlrev_b32 v92,16,v6
v_and_b32 v93,0xffff0000,v6
v_cvt_pk_bf16_f32 v8,v94,v95
v_lshlrev_b32 v94,16,v8
v_and_b32 v95,0xffff0000,v8
v_cvt_pk_bf16_f32 v6,v96,v97
v_lshlrev_b32 v96,16,v6
v_and_b32 v97,0xffff0000,v6
v_cvt_pk_bf16_f32 v8,v98,v99
v_lshlrev_b32 v98,16,v8
v_and_b32 v99,0xffff0000,v8
v_cvt_pk_bf16_f32 v6,v100,v101
v_lshlrev_b32 v100,16,v6
v_and_b32 v101,0xffff0000,v6
v_cvt_pk_bf16_f32 v8,v102,v103
v_lshlrev_b32 v102,16,v8
v_and_b32 v103,0xffff0000,v8
v_cvt_pk_bf16_f32 v6,v104,v105
v_lshlrev_b32 v104,16,v6
v_and_b32 v105,0xffff0000,v6
v_cvt_pk_bf16_f32 v8,v106,v107
v_lshlrev_b32 v106,16,v8
v_and_b32 v107,0xffff0000,v8
v_cvt_pk_bf16_f32 v6,v108,v109
v_lshlrev_b32 v108,16,v6
v_and_b32 v109,0xffff0000,v6
v_cvt_pk_bf16_f32 v8,v110,v111
v_lshlrev_b32 v110,16,v8
v_and_b32 v111,0xffff0000,v8
v_pk_mul_f32 v[72:73],v[72:73],v[24:25] op_sel:[0,1] op_sel_hi:[1,1]
v_pk_mul_f32 v[74:75],v[74:75],v[24:25] op_sel:[0,1] op_sel_hi:[1,1]
v_pk_mul_f32 v[76:77],v[76:77],v[24:25] op_sel:[0,1] op_sel_hi:[1,1]
v_pk_mul_f32 v[78:79],v[78:79],v[24:25] op_sel:[0,1] op_sel_hi:[1,1]
v_pk_mul_f32 v[80:81],v[80:81],v[24:25] op_sel:[0,1] op_sel_hi:[1,1]
v_pk_mul_f32 v[82:83],v[82:83],v[24:25] op_sel:[0,1] op_sel_hi:[1,1]
v_pk_mul_f32 v[84:85],v[84:85],v[24:25] op_sel:[0,1] op_sel_hi:[1,1]
v_pk_mul_f32 v[86:87],v[86:87],v[24:25] op_sel:[0,1] op_sel_hi:[1,1]
v_pk_mul_f32 v[88:89],v[88:89],v[24:25] op_sel:[0,1] op_sel_hi:[1,1]
v_pk_mul_f32 v[90:91],v[90:91],v[24:25] op_sel:[0,1] op_sel_hi:[1,1]
v_pk_mul_f32 v[92:93],v[92:93],v[24:25] op_sel:[0,1] op_sel_hi:[1,1]
v_pk_mul_f32 v[94:95],v[94:95],v[24:25] op_sel:[0,1] op_sel_hi:[1,1]
v_pk_mul_f32 v[96:97],v[96:97],v[24:25] op_sel:[0,1] op_sel_hi:[1,1]
v_pk_mul_f32 v[98:99],v[98:99],v[24:25] op_sel:[0,1] op_sel_hi:[1,1]
v_pk_mul_f32 v[100:101],v[100:101],v[24:25] op_sel:[0,1] op_sel_hi:[1,1]
v_pk_mul_f32 v[102:103],v[102:103],v[24:25] op_sel:[0,1] op_sel_hi:[1,1]
v_pk_mul_f32 v[104:105],v[104:105],v[24:25] op_sel:[0,1] op_sel_hi:[1,1]
v_pk_mul_f32 v[106:107],v[106:107],v[24:25] op_sel:[0,1] op_sel_hi:[1,1]
v_pk_mul_f32 v[108:109],v[108:109],v[24:25] op_sel:[0,1] op_sel_hi:[1,1]
v_pk_mul_f32 v[110:111],v[110:111],v[24:25] op_sel:[0,1] op_sel_hi:[1,1]
v_cvt_pk_bf16_f32 v112,v72,v73
v_lshlrev_b32 v72,16,v112
v_and_b32 v73,0xffff0000,v112
v_cvt_pk_bf16_f32 v113,v74,v75
v_lshlrev_b32 v74,16,v113
v_and_b32 v75,0xffff0000,v113
v_cvt_pk_bf16_f32 v114,v76,v77
v_lshlrev_b32 v76,16,v114
v_and_b32 v77,0xffff0000,v114
v_cvt_pk_bf16_f32 v115,v78,v79
v_lshlrev_b32 v78,16,v115
v_and_b32 v79,0xffff0000,v115
v_cvt_pk_bf16_f32 v116,v80,v81
v_lshlrev_b32 v80,16,v116
v_and_b32 v81,0xffff0000,v116
v_cvt_pk_bf16_f32 v117,v82,v83
v_lshlrev_b32 v82,16,v117
v_and_b32 v83,0xffff0000,v117
v_cvt_pk_bf16_f32 v118,v84,v85
v_lshlrev_b32 v84,16,v118
v_and_b32 v85,0xffff0000,v118
v_cvt_pk_bf16_f32 v119,v86,v87
v_lshlrev_b32 v86,16,v119
v_and_b32 v87,0xffff0000,v119
v_cvt_pk_bf16_f32 v120,v88,v89
v_lshlrev_b32 v88,16,v120
v_and_b32 v89,0xffff0000,v120
v_cvt_pk_bf16_f32 v121,v90,v91
v_lshlrev_b32 v90,16,v121
v_and_b32 v91,0xffff0000,v121
v_cvt_pk_bf16_f32 v122,v92,v93
v_lshlrev_b32 v92,16,v122
v_and_b32 v93,0xffff0000,v122
v_cvt_pk_bf16_f32 v123,v94,v95
v_lshlrev_b32 v94,16,v123
v_and_b32 v95,0xffff0000,v123
v_cvt_pk_bf16_f32 v124,v96,v97
v_lshlrev_b32 v96,16,v124
v_and_b32 v97,0xffff0000,v124
v_cvt_pk_bf16_f32 v125,v98,v99
v_lshlrev_b32 v98,16,v125
v_and_b32 v99,0xffff0000,v125
v_cvt_pk_bf16_f32 v126,v100,v101
v_lshlrev_b32 v100,16,v126
v_and_b32 v101,0xffff0000,v126
v_cvt_pk_bf16_f32 v127,v102,v103
v_lshlrev_b32 v102,16,v127
v_and_b32 v103,0xffff0000,v127
v_cvt_pk_bf16_f32 v128,v104,v105
v_lshlrev_b32 v104,16,v128
v_and_b32 v105,0xffff0000,v128
v_cvt_pk_bf16_f32 v129,v106,v107
v_lshlrev_b32 v106,16,v129
v_and_b32 v107,0xffff0000,v129
v_cvt_pk_bf16_f32 v130,v108,v109
v_lshlrev_b32 v108,16,v130
v_and_b32 v109,0xffff0000,v130
v_cvt_pk_bf16_f32 v131,v110,v111
v_lshlrev_b32 v110,16,v131
v_and_b32 v111,0xffff0000,v131
s_add_u32 s63,s65,0
v_permlane16_swap_b32 v112,v114
v_permlane16_swap_b32 v113,v115
buffer_store_dwordx4 v[112:115],v132,s[8:11],s63 offen sc1
s_add_u32 s63,s65,8192
v_permlane16_swap_b32 v116,v118
v_permlane16_swap_b32 v117,v119
buffer_store_dwordx4 v[116:119],v132,s[8:11],s63 offen sc1
s_add_u32 s63,s65,16384
v_permlane16_swap_b32 v120,v122
v_permlane16_swap_b32 v121,v123
buffer_store_dwordx4 v[120:123],v132,s[8:11],s63 offen sc1
s_add_u32 s63,s65,24576
v_permlane16_swap_b32 v124,v126
v_permlane16_swap_b32 v125,v127
buffer_store_dwordx4 v[124:127],v132,s[8:11],s63 offen sc1
s_add_u32 s63,s65,32768
v_permlane16_swap_b32 v128,v130
v_permlane16_swap_b32 v129,v131
buffer_store_dwordx4 v[128:131],v132,s[8:11],s63 offen sc1
s_add_u32 s63,s64,0
v_permlane16_swap_b32 v52,v54
v_permlane16_swap_b32 v53,v55
buffer_store_dwordx4 v[52:55],v132,s[8:11],s63 offen sc1
s_add_u32 s63,s64,8192
v_permlane16_swap_b32 v56,v58
v_permlane16_swap_b32 v57,v59
buffer_store_dwordx4 v[56:59],v132,s[8:11],s63 offen sc1
s_add_u32 s63,s64,16384
v_permlane16_swap_b32 v60,v62
v_permlane16_swap_b32 v61,v63
buffer_store_dwordx4 v[60:63],v132,s[8:11],s63 offen sc1
s_add_u32 s63,s64,24576
v_permlane16_swap_b32 v64,v66
v_permlane16_swap_b32 v65,v67
buffer_store_dwordx4 v[64:67],v132,s[8:11],s63 offen sc1
s_add_u32 s63,s64,32768
v_permlane16_swap_b32 v68,v70
v_permlane16_swap_b32 v69,v71
buffer_store_dwordx4 v[68:71],v132,s[8:11],s63 offen sc1
s_lshl_b32 s82,s55,6
s_add_u32 s82,s82,s54
s_lshl_b32 s82,s82,9
s_add_u32 s82,s82,0
s_lshl_b32 s61,s53,2
s_add_u32 s82,s82,s61
s_add_u32 s54,s54,16
R0_LOOPA:
s_add_u32 s66,s54,16
s_min_u32 s66,s66,63
s_mul_i32 s62,s66,40960
buffer_load_dwordx2 v[52:53],v133,s[4:7],s62 offen offset:0
buffer_load_dwordx2 v[54:55],v133,s[4:7],s62 offen offset:128
buffer_load_dwordx2 v[56:57],v133,s[4:7],s62 offen offset:256
buffer_load_dwordx2 v[58:59],v133,s[4:7],s62 offen offset:384
buffer_load_dwordx2 v[60:61],v133,s[4:7],s62 offen offset:512
buffer_load_dwordx2 v[62:63],v133,s[4:7],s62 offen offset:640
buffer_load_dwordx2 v[64:65],v133,s[4:7],s62 offen offset:768
buffer_load_dwordx2 v[66:67],v133,s[4:7],s62 offen offset:896
buffer_load_dwordx2 v[68:69],v133,s[4:7],s62 offen offset:1024
buffer_load_dwordx2 v[70:71],v133,s[4:7],s62 offen offset:1152
s_mul_i32 s64,s54,40960
s_add_u32 s64,s64,234749952
s_mul_i32 s65,s54,46080
s_add_u32 s65,s65,206569472
s_waitcnt vmcnt(10)
s_mov_b64 exec,1
buffer_store_dword v5,v1,s[8:11],s82 offen sc1
s_mov_b64 exec,-1
v_lshlrev_b32 v72,16,v32
v_and_b32 v73,0xffff0000,v32
v_lshlrev_b32 v74,16,v33
v_and_b32 v75,0xffff0000,v33
v_lshlrev_b32 v76,16,v34
v_and_b32 v77,0xffff0000,v34
v_lshlrev_b32 v78,16,v35
v_and_b32 v79,0xffff0000,v35
v_lshlrev_b32 v80,16,v36
v_and_b32 v81,0xffff0000,v36
v_lshlrev_b32 v82,16,v37
v_and_b32 v83,0xffff0000,v37
v_lshlrev_b32 v84,16,v38
v_and_b32 v85,0xffff0000,v38
v_lshlrev_b32 v86,16,v39
v_and_b32 v87,0xffff0000,v39
v_lshlrev_b32 v88,16,v40
v_and_b32 v89,0xffff0000,v40
v_lshlrev_b32 v90,16,v41
v_and_b32 v91,0xffff0000,v41
v_lshlrev_b32 v92,16,v42
v_and_b32 v93,0xffff0000,v42
v_lshlrev_b32 v94,16,v43
v_and_b32 v95,0xffff0000,v43
v_lshlrev_b32 v96,16,v44
v_and_b32 v97,0xffff0000,v44
v_lshlrev_b32 v98,16,v45
v_and_b32 v99,0xffff0000,v45
v_lshlrev_b32 v100,16,v46
v_and_b32 v101,0xffff0000,v46
v_lshlrev_b32 v102,16,v47
v_and_b32 v103,0xffff0000,v47
v_lshlrev_b32 v104,16,v48
v_and_b32 v105,0xffff0000,v48
v_lshlrev_b32 v106,16,v49
v_and_b32 v107,0xffff0000,v49
v_lshlrev_b32 v108,16,v50
v_and_b32 v109,0xffff0000,v50
v_lshlrev_b32 v110,16,v51
v_and_b32 v111,0xffff0000,v51
v_pk_add_f32 v[28:29],v[72:73],v[74:75]
v_pk_mul_f32 v[26:27],v[72:73],v[72:73]
v_pk_fma_f32 v[26:27],v[74:75],v[74:75],v[26:27]
v_pk_add_f32 v[28:29],v[28:29],v[76:77]
v_pk_fma_f32 v[26:27],v[76:77],v[76:77],v[26:27]
v_pk_add_f32 v[28:29],v[28:29],v[78:79]
v_pk_fma_f32 v[26:27],v[78:79],v[78:79],v[26:27]
v_pk_add_f32 v[28:29],v[28:29],v[80:81]
v_pk_fma_f32 v[26:27],v[80:81],v[80:81],v[26:27]
v_pk_add_f32 v[28:29],v[28:29],v[82:83]
v_pk_fma_f32 v[26:27],v[82:83],v[82:83],v[26:27]
v_pk_add_f32 v[28:29],v[28:29],v[84:85]
v_pk_fma_f32 v[26:27],v[84:85],v[84:85],v[26:27]
v_pk_add_f32 v[28:29],v[28:29],v[86:87]
v_pk_fma_f32 v[26:27],v[86:87],v[86:87],v[26:27]
v_pk_add_f32 v[28:29],v[28:29],v[88:89]
v_pk_fma_f32 v[26:27],v[88:89],v[88:89],v[26:27]
v_pk_add_f32 v[28:29],v[28:29],v[90:91]
v_pk_fma_f32 v[26:27],v[90:91],v[90:91],v[26:27]
v_pk_add_f32 v[28:29],v[28:29],v[92:93]
v_pk_fma_f32 v[26:27],v[92:93],v[92:93],v[26:27]
v_pk_add_f32 v[28:29],v[28:29],v[94:95]
v_pk_fma_f32 v[26:27],v[94:95],v[94:95],v[26:27]
v_pk_add_f32 v[28:29],v[28:29],v[96:97]
v_pk_fma_f32 v[26:27],v[96:97],v[96:97],v[26:27]
v_pk_add_f32 v[28:29],v[28:29],v[98:99]
v_pk_fma_f32 v[26:27],v[98:99],v[98:99],v[26:27]
v_pk_add_f32 v[28:29],v[28:29],v[100:101]
v_pk_fma_f32 v[26:27],v[100:101],v[100:101],v[26:27]
v_pk_add_f32 v[28:29],v[28:29],v[102:103]
v_pk_fma_f32 v[26:27],v[102:103],v[102:103],v[26:27]
v_pk_add_f32 v[28:29],v[28:29],v[104:105]
v_pk_fma_f32 v[26:27],v[104:105],v[104:105],v[26:27]
v_pk_add_f32 v[28:29],v[28:29],v[106:107]
v_pk_fma_f32 v[26:27],v[106:107],v[106:107],v[26:27]
v_pk_add_f32 v[28:29],v[28:29],v[108:109]
v_pk_fma_f32 v[26:27],v[108:109],v[108:109],v[26:27]
v_pk_add_f32 v[28:29],v[28:29],v[110:111]
v_pk_fma_f32 v[26:27],v[110:111],v[110:111],v[26:27]
v_add_f32 v24,v28,v29
v_add_f32 v25,v26,v27
s_nop 0
v_add_f32_dpp v24,v24,v24 row_ror:4 row_mask:0xf bank_mask:0xf
v_add_f32_dpp v25,v25,v25 row_ror:4 row_mask:0xf bank_mask:0xf
s_nop 0
v_add_f32_dpp v24,v24,v24 row_ror:8 row_mask:0xf bank_mask:0xf
v_add_f32_dpp v25,v25,v25 row_ror:8 row_mask:0xf bank_mask:0xf
v_mov_b32 v26,v24
v_mov_b32 v27,v25
s_nop 0
v_permlane32_swap_b32 v24,v26
v_permlane32_swap_b32 v25,v27
v_add_f32 v24,v24,v26
v_add_f32 v25,v25,v27
v_mov_b32 v26,v24
v_mov_b32 v27,v25
s_nop 0
v_permlane16_swap_b32 v24,v26
v_permlane16_swap_b32 v25,v27
v_add_f32 v24,v24,v26
v_add_f32 v25,v25,v27
v_mul_f32 v24,0x3acccccd,v24
v_mul_f32 v25,0x3acccccd,v25
v_fma_f32 v25,-v24,v24,v25
v_max_f32 v25,0,v25
v_cvt_pk_bf16_f32 v6,v24,v25
v_lshlrev_b32 v24,16,v6
v_and_b32 v25,0xffff0000,v6
v_add_f32 v25,0x3727c5ac,v25
v_cvt_pk_bf16_f32 v6,v25,v25
v_lshlrev_b32 v25,16,v6
v_sqrt_f32 v25,v25
s_nop 0
v_cvt_pk_bf16_f32 v6,v25,v25
v_lshlrev_b32 v25,16,v6
v_rcp_f32 v25,v25
s_nop 0
v_pk_add_f32 v[72:73],v[72:73],v[24:25] op_sel_hi:[1,0] neg_lo:[0,1] neg_hi:[0,1]
v_pk_add_f32 v[74:75],v[74:75],v[24:25] op_sel_hi:[1,0] neg_lo:[0,1] neg_hi:[0,1]
v_pk_add_f32 v[76:77],v[76:77],v[24:25] op_sel_hi:[1,0] neg_lo:[0,1] neg_hi:[0,1]
v_pk_add_f32 v[78:79],v[78:79],v[24:25] op_sel_hi:[1,0] neg_lo:[0,1] neg_hi:[0,1]
v_pk_add_f32 v[80:81],v[80:81],v[24:25] op_sel_hi:[1,0] neg_lo:[0,1] neg_hi:[0,1]
v_pk_add_f32 v[82:83],v[82:83],v[24:25] op_sel_hi:[1,0] neg_lo:[0,1] neg_hi:[0,1]
v_pk_add_f32 v[84:85],v[84:85],v[24:25] op_sel_hi:[1,0] neg_lo:[0,1] neg_hi:[0,1]
v_pk_add_f32 v[86:87],v[86:87],v[24:25] op_sel_hi:[1,0] neg_lo:[0,1] neg_hi:[0,1]
v_pk_add_f32 v[88:89],v[88:89],v[24:25] op_sel_hi:[1,0] neg_lo:[0,1] neg_hi:[0,1]
v_pk_add_f32 v[90:91],v[90:91],v[24:25] op_sel_hi:[1,0] neg_lo:[0,1] neg_hi:[0,1]
v_pk_add_f32 v[92:93],v[92:93],v[24:25] op_sel_hi:[1,0] neg_lo:[0,1] neg_hi:[0,1]
v_pk_add_f32 v[94:95],v[94:95],v[24:25] op_sel_hi:[1,0] neg_lo:[0,1] neg_hi:[0,1]
v_pk_add_f32 v[96:97],v[96:97],v[24:25] op_sel_hi:[1,0] neg_lo:[0,1] neg_hi:[0,1]
v_pk_add_f32 v[98:99],v[98:99],v[24:25] op_sel_hi:[1,0] neg_lo:[0,1] neg_hi:[0,1]
v_pk_add_f32 v[100:101],v[100:101],v[24:25] op_sel_hi:[1,0] neg_lo:[0,1] neg_hi:[0,1]
v_pk_add_f32 v[102:103],v[102:103],v[24:25] op_sel_hi:[1,0] neg_lo:[0,1] neg_hi:[0,1]
v_pk_add_f32 v[104:105],v[104:105],v[24:25] op_sel_hi:[1,0] neg_lo:[0,1] neg_hi:[0,1]
v_pk_add_f32 v[106:107],v[106:107],v[24:25] op_sel_hi:[1,0] neg_lo:[0,1] neg_hi:[0,1]
v_pk_add_f32 v[108:109],v[108:109],v[24:25] op_sel_hi:[1,0] neg_lo:[0,1] neg_hi:[0,1]
v_pk_add_f32 v[110:111],v[110:111],v[24:25] op_sel_hi:[1,0] neg_lo:[0,1] neg_hi:[0,1]
v_cvt_pk_bf16_f32 v6,v72,v73
v_lshlrev_b32 v72,16,v6
v_and_b32 v73,0xffff0000,v6
v_cvt_pk_bf16_f32 v8,v74,v75
v_lshlrev_b32 v74,16,v8
v_and_b32 v75,0xffff0000,v8
v_cvt_pk_bf16_f32 v6,v76,v77
v_lshlrev_b32 v76,16,v6
v_and_b32 v77,0xffff0000,v6
v_cvt_pk_bf16_f32 v8,v78,v79
v_lshlrev_b32 v78,16,v8
v_and_b32 v79,0xffff0000,v8
v_cvt_pk_bf16_f32 v6,v80,v81
v_lshlrev_b32 v80,16,v6
v_and_b32 v81,0xffff0000,v6
v_cvt_pk_bf16_f32 v8,v82,v83
v_lshlrev_b32 v82,16,v8
v_and_b32 v83,0xffff0000,v8
v_cvt_pk_bf16_f32 v6,v84,v85
v_lshlrev_b32 v84,16,v6
v_and_b32 v85,0xffff0000,v6
v_cvt_pk_bf16_f32 v8,v86,v87
v_lshlrev_b32 v86,16,v8
v_and_b32 v87,0xffff0000,v8
v_cvt_pk_bf16_f32 v6,v88,v89
v_lshlrev_b32 v88,16,v6
v_and_b32 v89,0xffff0000,v6
v_cvt_pk_bf16_f32 v8,v90,v91
v_lshlrev_b32 v90,16,v8
v_and_b32 v91,0xffff0000,v8
v_cvt_pk_bf16_f32 v6,v92,v93
v_lshlrev_b32 v92,16,v6
v_and_b32 v93,0xffff0000,v6
v_cvt_pk_bf16_f32 v8,v94,v95
v_lshlrev_b32 v94,16,v8
v_and_b32 v95,0xffff0000,v8
v_cvt_pk_bf16_f32 v6,v96,v97
v_lshlrev_b32 v96,16,v6
v_and_b32 v97,0xffff0000,v6
v_cvt_pk_bf16_f32 v8,v98,v99
v_lshlrev_b32 v98,16,v8
v_and_b32 v99,0xffff0000,v8
v_cvt_pk_bf16_f32 v6,v100,v101
v_lshlrev_b32 v100,16,v6
v_and_b32 v101,0xffff0000,v6
v_cvt_pk_bf16_f32 v8,v102,v103
v_lshlrev_b32 v102,16,v8
v_and_b32 v103,0xffff0000,v8
v_cvt_pk_bf16_f32 v6,v104,v105
v_lshlrev_b32 v104,16,v6
v_and_b32 v105,0xffff0000,v6
v_cvt_pk_bf16_f32 v8,v106,v107
v_lshlrev_b32 v106,16,v8
v_and_b32 v107,0xffff0000,v8
v_cvt_pk_bf16_f32 v6,v108,v109
v_lshlrev_b32 v108,16,v6
v_and_b32 v109,0xffff0000,v6
v_cvt_pk_bf16_f32 v8,v110,v111
v_lshlrev_b32 v110,16,v8
v_and_b32 v111,0xffff0000,v8
v_pk_mul_f32 v[72:73],v[72:73],v[24:25] op_sel:[0,1] op_sel_hi:[1,1]
v_pk_mul_f32 v[74:75],v[74:75],v[24:25] op_sel:[0,1] op_sel_hi:[1,1]
v_pk_mul_f32 v[76:77],v[76:77],v[24:25] op_sel:[0,1] op_sel_hi:[1,1]
v_pk_mul_f32 v[78:79],v[78:79],v[24:25] op_sel:[0,1] op_sel_hi:[1,1]
v_pk_mul_f32 v[80:81],v[80:81],v[24:25] op_sel:[0,1] op_sel_hi:[1,1]
v_pk_mul_f32 v[82:83],v[82:83],v[24:25] op_sel:[0,1] op_sel_hi:[1,1]
v_pk_mul_f32 v[84:85],v[84:85],v[24:25] op_sel:[0,1] op_sel_hi:[1,1]
v_pk_mul_f32 v[86:87],v[86:87],v[24:25] op_sel:[0,1] op_sel_hi:[1,1]
v_pk_mul_f32 v[88:89],v[88:89],v[24:25] op_sel:[0,1] op_sel_hi:[1,1]
v_pk_mul_f32 v[90:91],v[90:91],v[24:25] op_sel:[0,1] op_sel_hi:[1,1]
v_pk_mul_f32 v[92:93],v[92:93],v[24:25] op_sel:[0,1] op_sel_hi:[1,1]
v_pk_mul_f32 v[94:95],v[94:95],v[24:25] op_sel:[0,1] op_sel_hi:[1,1]
v_pk_mul_f32 v[96:97],v[96:97],v[24:25] op_sel:[0,1] op_sel_hi:[1,1]
v_pk_mul_f32 v[98:99],v[98:99],v[24:25] op_sel:[0,1] op_sel_hi:[1,1]
v_pk_mul_f32 v[100:101],v[100:101],v[24:25] op_sel:[0,1] op_sel_hi:[1,1]
v_pk_mul_f32 v[102:103],v[102:103],v[24:25] op_sel:[0,1] op_sel_hi:[1,1]
v_pk_mul_f32 v[104:105],v[104:105],v[24:25] op_sel:[0,1] op_sel_hi:[1,1]
v_pk_mul_f32 v[106:107],v[106:107],v[24:25] op_sel:[0,1] op_sel_hi:[1,1]
v_pk_mul_f32 v[108:109],v[108:109],v[24:25] op_sel:[0,1] op_sel_hi:[1,1]
v_pk_mul_f32 v[110:111],v[110:111],v[24:25] op_sel:[0,1] op_sel_hi:[1,1]
v_cvt_pk_bf16_f32 v112,v72,v73
v_lshlrev_b32 v72,16,v112
v_and_b32 v73,0xffff0000,v112
v_cvt_pk_bf16_f32 v113,v74,v75
v_lshlrev_b32 v74,16,v113
v_and_b32 v75,0xffff0000,v113
v_cvt_pk_bf16_f32 v114,v76,v77
v_lshlrev_b32 v76,16,v114
v_and_b32 v77,0xffff0000,v114
v_cvt_pk_bf16_f32 v115,v78,v79
v_lshlrev_b32 v78,16,v115
v_and_b32 v79,0xffff0000,v115
v_cvt_pk_bf16_f32 v116,v80,v81
v_lshlrev_b32 v80,16,v116
v_and_b32 v81,0xffff0000,v116
v_cvt_pk_bf16_f32 v117,v82,v83
v_lshlrev_b32 v82,16,v117
v_and_b32 v83,0xffff0000,v117
v_cvt_pk_bf16_f32 v118,v84,v85
v_lshlrev_b32 v84,16,v118
v_and_b32 v85,0xffff0000,v118
v_cvt_pk_bf16_f32 v119,v86,v87
v_lshlrev_b32 v86,16,v119
v_and_b32 v87,0xffff0000,v119
v_cvt_pk_bf16_f32 v120,v88,v89
v_lshlrev_b32 v88,16,v120
v_and_b32 v89,0xffff0000,v120
v_cvt_pk_bf16_f32 v121,v90,v91
v_lshlrev_b32 v90,16,v121
v_and_b32 v91,0xffff0000,v121
v_cvt_pk_bf16_f32 v122,v92,v93
v_lshlrev_b32 v92,16,v122
v_and_b32 v93,0xffff0000,v122
v_cvt_pk_bf16_f32 v123,v94,v95
v_lshlrev_b32 v94,16,v123
v_and_b32 v95,0xffff0000,v123
v_cvt_pk_bf16_f32 v124,v96,v97
v_lshlrev_b32 v96,16,v124
v_and_b32 v97,0xffff0000,v124
v_cvt_pk_bf16_f32 v125,v98,v99
v_lshlrev_b32 v98,16,v125
v_and_b32 v99,0xffff0000,v125
v_cvt_pk_bf16_f32 v126,v100,v101
v_lshlrev_b32 v100,16,v126
v_and_b32 v101,0xffff0000,v126
v_cvt_pk_bf16_f32 v127,v102,v103
v_lshlrev_b32 v102,16,v127
v_and_b32 v103,0xffff0000,v127
v_cvt_pk_bf16_f32 v128,v104,v105
v_lshlrev_b32 v104,16,v128
v_and_b32 v105,0xffff0000,v128
v_cvt_pk_bf16_f32 v129,v106,v107
v_lshlrev_b32 v106,16,v129
v_and_b32 v107,0xffff0000,v129
v_cvt_pk_bf16_f32 v130,v108,v109
v_lshlrev_b32 v108,16,v130
v_and_b32 v109,0xffff0000,v130
v_cvt_pk_bf16_f32 v131,v110,v111
v_lshlrev_b32 v110,16,v131
v_and_b32 v111,0xffff0000,v131
s_add_u32 s63,s65,0
v_permlane16_swap_b32 v112,v114
v_permlane16_swap_b32 v113,v115
buffer_store_dwordx4 v[112:115],v132,s[8:11],s63 offen sc1
s_add_u32 s63,s65,8192
v_permlane16_swap_b32 v116,v118
v_permlane16_swap_b32 v117,v119
buffer_store_dwordx4 v[116:119],v132,s[8:11],s63 offen sc1
s_add_u32 s63,s65,16384
v_permlane16_swap_b32 v120,v122
v_permlane16_swap_b32 v121,v123
buffer_store_dwordx4 v[120:123],v132,s[8:11],s63 offen sc1
s_add_u32 s63,s65,24576
v_permlane16_swap_b32 v124,v126
v_permlane16_swap_b32 v125,v127
buffer_store_dwordx4 v[124:127],v132,s[8:11],s63 offen sc1
s_add_u32 s63,s65,32768
v_permlane16_swap_b32 v128,v130
v_permlane16_swap_b32 v129,v131
buffer_store_dwordx4 v[128:131],v132,s[8:11],s63 offen sc1
s_add_u32 s63,s64,0
v_permlane16_swap_b32 v32,v34
v_permlane16_swap_b32 v33,v35
buffer_store_dwordx4 v[32:35],v132,s[8:11],s63 offen sc1
s_add_u32 s63,s64,8192
v_permlane16_swap_b32 v36,v38
v_permlane16_swap_b32 v37,v39
buffer_store_dwordx4 v[36:39],v132,s[8:11],s63 offen sc1
s_add_u32 s63,s64,16384
v_permlane16_swap_b32 v40,v42
v_permlane16_swap_b32 v41,v43
buffer_store_dwordx4 v[40:43],v132,s[8:11],s63 offen sc1
s_add_u32 s63,s64,24576
v_permlane16_swap_b32 v44,v46
v_permlane16_swap_b32 v45,v47
buffer_store_dwordx4 v[44:47],v132,s[8:11],s63 offen sc1
s_add_u32 s63,s64,32768
v_permlane16_swap_b32 v48,v50
v_permlane16_swap_b32 v49,v51
buffer_store_dwordx4 v[48:51],v132,s[8:11],s63 offen sc1
s_lshl_b32 s82,s55,6
s_add_u32 s82,s82,s54
s_lshl_b32 s82,s82,9
s_add_u32 s82,s82,0
s_lshl_b32 s61,s53,2
s_add_u32 s82,s82,s61
s_add_u32 s54,s54,16
s_cmp_ge_u32 s54,64
s_cbranch_scc1 R0_ENDA
s_add_u32 s66,s54,16
s_min_u32 s66,s66,63
s_mul_i32 s62,s66,40960
buffer_load_dwordx2 v[32:33],v133,s[4:7],s62 offen offset:0
buffer_load_dwordx2 v[34:35],v133,s[4:7],s62 offen offset:128
buffer_load_dwordx2 v[36:37],v133,s[4:7],s62 offen offset:256
buffer_load_dwordx2 v[38:39],v133,s[4:7],s62 offen offset:384
buffer_load_dwordx2 v[40:41],v133,s[4:7],s62 offen offset:512
buffer_load_dwordx2 v[42:43],v133,s[4:7],s62 offen offset:640
buffer_load_dwordx2 v[44:45],v133,s[4:7],s62 offen offset:768
buffer_load_dwordx2 v[46:47],v133,s[4:7],s62 offen offset:896
buffer_load_dwordx2 v[48:49],v133,s[4:7],s62 offen offset:1024
buffer_load_dwordx2 v[50:51],v133,s[4:7],s62 offen offset:1152
s_mul_i32 s64,s54,40960
s_add_u32 s64,s64,234749952
s_mul_i32 s65,s54,46080
s_add_u32 s65,s65,206569472
s_waitcnt vmcnt(10)
s_mov_b64 exec,1
buffer_store_dword v5,v1,s[8:11],s82 offen sc1
s_mov_b64 exec,-1
v_lshlrev_b32 v72,16,v52
v_and_b32 v73,0xffff0000,v52
v_lshlrev_b32 v74,16,v53
v_and_b32 v75,0xffff0000,v53
v_lshlrev_b32 v76,16,v54
v_and_b32 v77,0xffff0000,v54
v_lshlrev_b32 v78,16,v55
v_and_b32 v79,0xffff0000,v55
v_lshlrev_b32 v80,16,v56
v_and_b32 v81,0xffff0000,v56
v_lshlrev_b32 v82,16,v57
v_and_b32 v83,0xffff0000,v57
v_lshlrev_b32 v84,16,v58
v_and_b32 v85,0xffff0000,v58
v_lshlrev_b32 v86,16,v59
v_and_b32 v87,0xffff0000,v59
v_lshlrev_b32 v88,16,v60
v_and_b32 v89,0xffff0000,v60
v_lshlrev_b32 v90,16,v61
v_and_b32 v91,0xffff0000,v61
v_lshlrev_b32 v92,16,v62
v_and_b32 v93,0xffff0000,v62
v_lshlrev_b32 v94,16,v63
v_and_b32 v95,0xffff0000,v63
v_lshlrev_b32 v96,16,v64
v_and_b32 v97,0xffff0000,v64
v_lshlrev_b32 v98,16,v65
v_and_b32 v99,0xffff0000,v65
v_lshlrev_b32 v100,16,v66
v_and_b32 v101,0xffff0000,v66
v_lshlrev_b32 v102,16,v67
v_and_b32 v103,0xffff0000,v67
v_lshlrev_b32 v104,16,v68
v_and_b32 v105,0xffff0000,v68
v_lshlrev_b32 v106,16,v69
v_and_b32 v107,0xffff0000,v69
v_lshlrev_b32 v108,16,v70
v_and_b32 v109,0xffff0000,v70
v_lshlrev_b32 v110,16,v71
v_and_b32 v111,0xffff0000,v71
v_pk_add_f32 v[28:29],v[72:73],v[74:75]
v_pk_mul_f32 v[26:27],v[72:73],v[72:73]
v_pk_fma_f32 v[26:27],v[74:75],v[74:75],v[26:27]
v_pk_add_f32 v[28:29],v[28:29],v[76:77]
v_pk_fma_f32 v[26:27],v[76:77],v[76:77],v[26:27]
v_pk_add_f32 v[28:29],v[28:29],v[78:79]
v_pk_fma_f32 v[26:27],v[78:79],v[78:79],v[26:27]
v_pk_add_f32 v[28:29],v[28:29],v[80:81]
v_pk_fma_f32 v[26:27],v[80:81],v[80:81],v[26:27]
v_pk_add_f32 v[28:29],v[28:29],v[82:83]
v_pk_fma_f32 v[26:27],v[82:83],v[82:83],v[26:27]
v_pk_add_f32 v[28:29],v[28:29],v[84:85]
v_pk_fma_f32 v[26:27],v[84:85],v[84:85],v[26:27]
v_pk_add_f32 v[28:29],v[28:29],v[86:87]
v_pk_fma_f32 v[26:27],v[86:87],v[86:87],v[26:27]
v_pk_add_f32 v[28:29],v[28:29],v[88:89]
v_pk_fma_f32 v[26:27],v[88:89],v[88:89],v[26:27]
v_pk_add_f32 v[28:29],v[28:29],v[90:91]
v_pk_fma_f32 v[26:27],v[90:91],v[90:91],v[26:27]
v_pk_add_f32 v[28:29],v[28:29],v[92:93]
v_pk_fma_f32 v[26:27],v[92:93],v[92:93],v[26:27]
v_pk_add_f32 v[28:29],v[28:29],v[94:95]
v_pk_fma_f32 v[26:27],v[94:95],v[94:95],v[26:27]
v_pk_add_f32 v[28:29],v[28:29],v[96:97]
v_pk_fma_f32 v[26:27],v[96:97],v[96:97],v[26:27]
v_pk_add_f32 v[28:29],v[28:29],v[98:99]
v_pk_fma_f32 v[26:27],v[98:99],v[98:99],v[26:27]
v_pk_add_f32 v[28:29],v[28:29],v[100:101]
v_pk_fma_f32 v[26:27],v[100:101],v[100:101],v[26:27]
v_pk_add_f32 v[28:29],v[28:29],v[102:103]
v_pk_fma_f32 v[26:27],v[102:103],v[102:103],v[26:27]
v_pk_add_f32 v[28:29],v[28:29],v[104:105]
v_pk_fma_f32 v[26:27],v[104:105],v[104:105],v[26:27]
v_pk_add_f32 v[28:29],v[28:29],v[106:107]
v_pk_fma_f32 v[26:27],v[106:107],v[106:107],v[26:27]
v_pk_add_f32 v[28:29],v[28:29],v[108:109]
v_pk_fma_f32 v[26:27],v[108:109],v[108:109],v[26:27]
v_pk_add_f32 v[28:29],v[28:29],v[110:111]
v_pk_fma_f32 v[26:27],v[110:111],v[110:111],v[26:27]
v_add_f32 v24,v28,v29
v_add_f32 v25,v26,v27
s_nop 0
v_add_f32_dpp v24,v24,v24 row_ror:4 row_mask:0xf bank_mask:0xf
v_add_f32_dpp v25,v25,v25 row_ror:4 row_mask:0xf bank_mask:0xf
s_nop 0
v_add_f32_dpp v24,v24,v24 row_ror:8 row_mask:0xf bank_mask:0xf
v_add_f32_dpp v25,v25,v25 row_ror:8 row_mask:0xf bank_mask:0xf
v_mov_b32 v26,v24
v_mov_b32 v27,v25
s_nop 0
v_permlane32_swap_b32 v24,v26
v_permlane32_swap_b32 v25,v27
v_add_f32 v24,v24,v26
v_add_f32 v25,v25,v27
v_mov_b32 v26,v24
v_mov_b32 v27,v25
s_nop 0
v_permlane16_swap_b32 v24,v26
v_permlane16_swap_b32 v25,v27
v_add_f32 v24,v24,v26
v_add_f32 v25,v25,v27
v_mul_f32 v24,0x3acccccd,v24
v_mul_f32 v25,0x3acccccd,v25
v_fma_f32 v25,-v24,v24,v25
v_max_f32 v25,0,v25
v_cvt_pk_bf16_f32 v6,v24,v25
v_lshlrev_b32 v24,16,v6
v_and_b32 v25,0xffff0000,v6
v_add_f32 v25,0x3727c5ac,v25
v_cvt_pk_bf16_f32 v6,v25,v25
v_lshlrev_b32 v25,16,v6
v_sqrt_f32 v25,v25
s_nop 0
v_cvt_pk_bf16_f32 v6,v25,v25
v_lshlrev_b32 v25,16,v6
v_rcp_f32 v25,v25
s_nop 0
v_pk_add_f32 v[72:73],v[72:73],v[24:25] op_sel_hi:[1,0] neg_lo:[0,1] neg_hi:[0,1]
v_pk_add_f32 v[74:75],v[74:75],v[24:25] op_sel_hi:[1,0] neg_lo:[0,1] neg_hi:[0,1]
v_pk_add_f32 v[76:77],v[76:77],v[24:25] op_sel_hi:[1,0] neg_lo:[0,1] neg_hi:[0,1]
v_pk_add_f32 v[78:79],v[78:79],v[24:25] op_sel_hi:[1,0] neg_lo:[0,1] neg_hi:[0,1]
v_pk_add_f32 v[80:81],v[80:81],v[24:25] op_sel_hi:[1,0] neg_lo:[0,1] neg_hi:[0,1]
v_pk_add_f32 v[82:83],v[82:83],v[24:25] op_sel_hi:[1,0] neg_lo:[0,1] neg_hi:[0,1]
v_pk_add_f32 v[84:85],v[84:85],v[24:25] op_sel_hi:[1,0] neg_lo:[0,1] neg_hi:[0,1]
v_pk_add_f32 v[86:87],v[86:87],v[24:25] op_sel_hi:[1,0] neg_lo:[0,1] neg_hi:[0,1]
v_pk_add_f32 v[88:89],v[88:89],v[24:25] op_sel_hi:[1,0] neg_lo:[0,1] neg_hi:[0,1]
v_pk_add_f32 v[90:91],v[90:91],v[24:25] op_sel_hi:[1,0] neg_lo:[0,1] neg_hi:[0,1]
v_pk_add_f32 v[92:93],v[92:93],v[24:25] op_sel_hi:[1,0] neg_lo:[0,1] neg_hi:[0,1]
v_pk_add_f32 v[94:95],v[94:95],v[24:25] op_sel_hi:[1,0] neg_lo:[0,1] neg_hi:[0,1]
v_pk_add_f32 v[96:97],v[96:97],v[24:25] op_sel_hi:[1,0] neg_lo:[0,1] neg_hi:[0,1]
v_pk_add_f32 v[98:99],v[98:99],v[24:25] op_sel_hi:[1,0] neg_lo:[0,1] neg_hi:[0,1]
v_pk_add_f32 v[100:101],v[100:101],v[24:25] op_sel_hi:[1,0] neg_lo:[0,1] neg_hi:[0,1]
v_pk_add_f32 v[102:103],v[102:103],v[24:25] op_sel_hi:[1,0] neg_lo:[0,1] neg_hi:[0,1]
v_pk_add_f32 v[104:105],v[104:105],v[24:25] op_sel_hi:[1,0] neg_lo:[0,1] neg_hi:[0,1]
v_pk_add_f32 v[106:107],v[106:107],v[24:25] op_sel_hi:[1,0] neg_lo:[0,1] neg_hi:[0,1]
v_pk_add_f32 v[108:109],v[108:109],v[24:25] op_sel_hi:[1,0] neg_lo:[0,1] neg_hi:[0,1]
v_pk_add_f32 v[110:111],v[110:111],v[24:25] op_sel_hi:[1,0] neg_lo:[0,1] neg_hi:[0,1]
v_cvt_pk_bf16_f32 v6,v72,v73
v_lshlrev_b32 v72,16,v6
v_and_b32 v73,0xffff0000,v6
v_cvt_pk_bf16_f32 v8,v74,v75
v_lshlrev_b32 v74,16,v8
v_and_b32 v75,0xffff0000,v8
v_cvt_pk_bf16_f32 v6,v76,v77
v_lshlrev_b32 v76,16,v6
v_and_b32 v77,0xffff0000,v6
v_cvt_pk_bf16_f32 v8,v78,v79
v_lshlrev_b32 v78,16,v8
v_and_b32 v79,0xffff0000,v8
v_cvt_pk_bf16_f32 v6,v80,v81
v_lshlrev_b32 v80,16,v6
v_and_b32 v81,0xffff0000,v6
v_cvt_pk_bf16_f32 v8,v82,v83
v_lshlrev_b32 v82,16,v8
v_and_b32 v83,0xffff0000,v8
v_cvt_pk_bf16_f32 v6,v84,v85
v_lshlrev_b32 v84,16,v6
v_and_b32 v85,0xffff0000,v6
v_cvt_pk_bf16_f32 v8,v86,v87
v_lshlrev_b32 v86,16,v8
v_and_b32 v87,0xffff0000,v8
v_cvt_pk_bf16_f32 v6,v88,v89
v_lshlrev_b32 v88,16,v6
v_and_b32 v89,0xffff0000,v6
v_cvt_pk_bf16_f32 v8,v90,v91
v_lshlrev_b32 v90,16,v8
v_and_b32 v91,0xffff0000,v8
v_cvt_pk_bf16_f32 v6,v92,v93
v_lshlrev_b32 v92,16,v6
v_and_b32 v93,0xffff0000,v6
v_cvt_pk_bf16_f32 v8,v94,v95
v_lshlrev_b32 v94,16,v8
v_and_b32 v95,0xffff0000,v8
v_cvt_pk_bf16_f32 v6,v96,v97
v_lshlrev_b32 v96,16,v6
v_and_b32 v97,0xffff0000,v6
v_cvt_pk_bf16_f32 v8,v98,v99
v_lshlrev_b32 v98,16,v8
v_and_b32 v99,0xffff0000,v8
v_cvt_pk_bf16_f32 v6,v100,v101
v_lshlrev_b32 v100,16,v6
v_and_b32 v101,0xffff0000,v6
v_cvt_pk_bf16_f32 v8,v102,v103
v_lshlrev_b32 v102,16,v8
v_and_b32 v103,0xffff0000,v8
v_cvt_pk_bf16_f32 v6,v104,v105
v_lshlrev_b32 v104,16,v6
v_and_b32 v105,0xffff0000,v6
v_cvt_pk_bf16_f32 v8,v106,v107
v_lshlrev_b32 v106,16,v8
v_and_b32 v107,0xffff0000,v8
v_cvt_pk_bf16_f32 v6,v108,v109
v_lshlrev_b32 v108,16,v6
v_and_b32 v109,0xffff0000,v6
v_cvt_pk_bf16_f32 v8,v110,v111
v_lshlrev_b32 v110,16,v8
v_and_b32 v111,0xffff0000,v8
v_pk_mul_f32 v[72:73],v[72:73],v[24:25] op_sel:[0,1] op_sel_hi:[1,1]
v_pk_mul_f32 v[74:75],v[74:75],v[24:25] op_sel:[0,1] op_sel_hi:[1,1]
v_pk_mul_f32 v[76:77],v[76:77],v[24:25] op_sel:[0,1] op_sel_hi:[1,1]
v_pk_mul_f32 v[78:79],v[78:79],v[24:25] op_sel:[0,1] op_sel_hi:[1,1]
v_pk_mul_f32 v[80:81],v[80:81],v[24:25] op_sel:[0,1] op_sel_hi:[1,1]
v_pk_mul_f32 v[82:83],v[82:83],v[24:25] op_sel:[0,1] op_sel_hi:[1,1]
v_pk_mul_f32 v[84:85],v[84:85],v[24:25] op_sel:[0,1] op_sel_hi:[1,1]
v_pk_mul_f32 v[86:87],v[86:87],v[24:25] op_sel:[0,1] op_sel_hi:[1,1]
v_pk_mul_f32 v[88:89],v[88:89],v[24:25] op_sel:[0,1] op_sel_hi:[1,1]
v_pk_mul_f32 v[90:91],v[90:91],v[24:25] op_sel:[0,1] op_sel_hi:[1,1]
v_pk_mul_f32 v[92:93],v[92:93],v[24:25] op_sel:[0,1] op_sel_hi:[1,1]
v_pk_mul_f32 v[94:95],v[94:95],v[24:25] op_sel:[0,1] op_sel_hi:[1,1]
v_pk_mul_f32 v[96:97],v[96:97],v[24:25] op_sel:[0,1] op_sel_hi:[1,1]
v_pk_mul_f32 v[98:99],v[98:99],v[24:25] op_sel:[0,1] op_sel_hi:[1,1]
v_pk_mul_f32 v[100:101],v[100:101],v[24:25] op_sel:[0,1] op_sel_hi:[1,1]
v_pk_mul_f32 v[102:103],v[102:103],v[24:25] op_sel:[0,1] op_sel_hi:[1,1]
v_pk_mul_f32 v[104:105],v[104:105],v[24:25] op_sel:[0,1] op_sel_hi:[1,1]
v_pk_mul_f32 v[106:107],v[106:107],v[24:25] op_sel:[0,1] op_sel_hi:[1,1]
v_pk_mul_f32 v[108:109],v[108:109],v[24:25] op_sel:[0,1] op_sel_hi:[1,1]
v_pk_mul_f32 v[110:111],v[110:111],v[24:25] op_sel:[0,1] op_sel_hi:[1,1]
v_cvt_pk_bf16_f32 v112,v72,v73
v_lshlrev_b32 v72,16,v112
v_and_b32 v73,0xffff0000,v112
v_cvt_pk_bf16_f32 v113,v74,v75
v_lshlrev_b32 v74,16,v113
v_and_b32 v75,0xffff0000,v113
v_cvt_pk_bf16_f32 v114,v76,v77
v_lshlrev_b32 v76,16,v114
v_and_b32 v77,0xffff0000,v114
v_cvt_pk_bf16_f32 v115,v78,v79
v_lshlrev_b32 v78,16,v115
v_and_b32 v79,0xffff0000,v115
v_cvt_pk_bf16_f32 v116,v80,v81
v_lshlrev_b32 v80,16,v116
v_and_b32 v81,0xffff0000,v116
v_cvt_pk_bf16_f32 v117,v82,v83
v_lshlrev_b32 v82,16,v117
v_and_b32 v83,0xffff0000,v117
v_cvt_pk_bf16_f32 v118,v84,v85
v_lshlrev_b32 v84,16,v118
v_and_b32 v85,0xffff0000,v118
v_cvt_pk_bf16_f32 v119,v86,v87
v_lshlrev_b32 v86,16,v119
v_and_b32 v87,0xffff0000,v119
v_cvt_pk_bf16_f32 v120,v88,v89
v_lshlrev_b32 v88,16,v120
v_and_b32 v89,0xffff0000,v120
v_cvt_pk_bf16_f32 v121,v90,v91
v_lshlrev_b32 v90,16,v121
v_and_b32 v91,0xffff0000,v121
v_cvt_pk_bf16_f32 v122,v92,v93
v_lshlrev_b32 v92,16,v122
v_and_b32 v93,0xffff0000,v122
v_cvt_pk_bf16_f32 v123,v94,v95
v_lshlrev_b32 v94,16,v123
v_and_b32 v95,0xffff0000,v123
v_cvt_pk_bf16_f32 v124,v96,v97
v_lshlrev_b32 v96,16,v124
v_and_b32 v97,0xffff0000,v124
v_cvt_pk_bf16_f32 v125,v98,v99
v_lshlrev_b32 v98,16,v125
v_and_b32 v99,0xffff0000,v125
v_cvt_pk_bf16_f32 v126,v100,v101
v_lshlrev_b32 v100,16,v126
v_and_b32 v101,0xffff0000,v126
v_cvt_pk_bf16_f32 v127,v102,v103
v_lshlrev_b32 v102,16,v127
v_and_b32 v103,0xffff0000,v127
v_cvt_pk_bf16_f32 v128,v104,v105
v_lshlrev_b32 v104,16,v128
v_and_b32 v105,0xffff0000,v128
v_cvt_pk_bf16_f32 v129,v106,v107
v_lshlrev_b32 v106,16,v129
v_and_b32 v107,0xffff0000,v129
v_cvt_pk_bf16_f32 v130,v108,v109
v_lshlrev_b32 v108,16,v130
v_and_b32 v109,0xffff0000,v130
v_cvt_pk_bf16_f32 v131,v110,v111
v_lshlrev_b32 v110,16,v131
v_and_b32 v111,0xffff0000,v131
s_add_u32 s63,s65,0
v_permlane16_swap_b32 v112,v114
v_permlane16_swap_b32 v113,v115
buffer_store_dwordx4 v[112:115],v132,s[8:11],s63 offen sc1
s_add_u32 s63,s65,8192
v_permlane16_swap_b32 v116,v118
v_permlane16_swap_b32 v117,v119
buffer_store_dwordx4 v[116:119],v132,s[8:11],s63 offen sc1
s_add_u32 s63,s65,16384
v_permlane16_swap_b32 v120,v122
v_permlane16_swap_b32 v121,v123
buffer_store_dwordx4 v[120:123],v132,s[8:11],s63 offen sc1
s_add_u32 s63,s65,24576
v_permlane16_swap_b32 v124,v126
v_permlane16_swap_b32 v125,v127
buffer_store_dwordx4 v[124:127],v132,s[8:11],s63 offen sc1
s_add_u32 s63,s65,32768
v_permlane16_swap_b32 v128,v130
v_permlane16_swap_b32 v129,v131
buffer_store_dwordx4 v[128:131],v132,s[8:11],s63 offen sc1
s_add_u32 s63,s64,0
v_permlane16_swap_b32 v52,v54
v_permlane16_swap_b32 v53,v55
buffer_store_dwordx4 v[52:55],v132,s[8:11],s63 offen sc1
s_add_u32 s63,s64,8192
v_permlane16_swap_b32 v56,v58
v_permlane16_swap_b32 v57,v59
buffer_store_dwordx4 v[56:59],v132,s[8:11],s63 offen sc1
s_add_u32 s63,s64,16384
v_permlane16_swap_b32 v60,v62
v_permlane16_swap_b32 v61,v63
buffer_store_dwordx4 v[60:63],v132,s[8:11],s63 offen sc1
s_add_u32 s63,s64,24576
v_permlane16_swap_b32 v64,v66
v_permlane16_swap_b32 v65,v67
buffer_store_dwordx4 v[64:67],v132,s[8:11],s63 offen sc1
s_add_u32 s63,s64,32768
v_permlane16_swap_b32 v68,v70
v_permlane16_swap_b32 v69,v71
buffer_store_dwordx4 v[68:71],v132,s[8:11],s63 offen sc1
s_lshl_b32 s82,s55,6
s_add_u32 s82,s82,s54
s_lshl_b32 s82,s82,9
s_add_u32 s82,s82,0
s_lshl_b32 s61,s53,2
s_add_u32 s82,s82,s61
s_add_u32 s54,s54,16
s_cmp_lt_u32 s54,64
s_cbranch_scc1 R0_LOOPA
R0_ENDA:
s_waitcnt vmcnt(0)
s_mov_b64 exec,1
buffer_store_dword v5,v1,s[8:11],s82 offen sc1
s_mov_b64 exec,-1
s_mov_b32 s52,s86
s_mul_i32 s60,s86,196608
s_add_u32 s69,s69,s60
s_mul_i32 s60,s86,1024
s_add_u32 s70,s70,s60
v_mov_b32 v231,0
s_mov_b32 s83,s100
s_nop 0
ATT_LOOP:
s_lshl_b32 s67,s51,6
s_add_u32 s67,s67,s52
s_lshl_b32 s67,s67,9
s_add_u32 s67,s67,65536
s_mul_i32 s66,s52,393216
s_add_u32 s66,s66,s71
v_cmp_eq_u32 vcc,0,v231
s_nop 0
s_cbranch_vccz ATT_RDY
fb_229:
buffer_load_dword v3,v2,s[8:11],s67 offen sc1
s_waitcnt vmcnt(0)
v_cmp_eq_u32 vcc,0,v3
s_nop 0
s_cbranch_vccz ok_230
s_sleep 20
s_sub_u32 s47,s47,1
s_cbranch_scc1 ABORT
s_branch fb_229
ok_230:
ATT_RDY:
s_add_u32 s63,s66,124780544
buffer_load_dwordx4 v[16:19],v1,s[8:11],s63 offen nt sc1
buffer_load_dwordx4 v[20:23],v1,s[8:11],s63 offen offset:1024 nt sc1
buffer_load_dwordx4 v[24:27],v1,s[8:11],s63 offen offset:2048 nt sc1
buffer_load_dwordx4 v[28:31],v1,s[8:11],s63 offen offset:3072 nt sc1
s_add_u32 s63,s66,124784640
buffer_load_dwordx4 v[32:35],v1,s[8:11],s63 offen nt sc1
buffer_load_dwordx4 v[36:39],v1,s[8:11],s63 offen offset:1024 nt sc1
buffer_load_dwordx4 v[40:43],v1,s[8:11],s63 offen offset:2048 nt sc1
buffer_load_dwordx4 v[44:47],v1,s[8:11],s63 offen offset:3072 nt sc1
s_add_u32 s63,s66,124788736
buffer_load_dwordx4 v[48:51],v1,s[8:11],s63 offen nt sc1
buffer_load_dwordx4 v[52:55],v1,s[8:11],s63 offen offset:1024 nt sc1
buffer_load_dwordx4 v[56:59],v1,s[8:11],s63 offen offset:2048 nt sc1
buffer_load_dwordx4 v[60:63],v1,s[8:11],s63 offen offset:3072 nt sc1
s_add_u32 s63,s66,74448896
buffer_load_dwordx4 v[64:67],v1,s[8:11],s63 offen sc1
buffer_load_dwordx4 v[68:71],v1,s[8:11],s63 offen offset:1024 sc1
buffer_load_dwordx4 v[72:75],v1,s[8:11],s63 offen offset:2048 sc1
buffer_load_dwordx4 v[76:79],v1,s[8:11],s63 offen offset:3072 sc1
s_add_u32 s63,s66,74452992
buffer_load_dwordx4 v[80:83],v1,s[8:11],s63 offen sc1
buffer_load_dwordx4 v[84:87],v1,s[8:11],s63 offen offset:1024 sc1
buffer_load_dwordx4 v[88:91],v1,s[8:11],s63 offen offset:2048 sc1
buffer_load_dwordx4 v[92:95],v1,s[8:11],s63 offen offset:3072 sc1
s_add_u32 s63,s66,74457088
buffer_load_dwordx4 v[96:99],v1,s[8:11],s63 offen sc1
buffer_load_dwordx4 v[100:103],v1,s[8:11],s63 offen offset:1024 sc1
buffer_load_dwordx4 v[104:107],v1,s[8:11],s63 offen offset:2048 sc1
buffer_load_dwordx4 v[108:111],v1,s[8:11],s63 offen offset:3072 sc1
s_add_u32 s63,s66,99614720
buffer_load_dwordx4 v[112:115],v1,s[8:11],s63 offen sc1
buffer_load_dwordx4 v[116:119],v1,s[8:11],s63 offen offset:1024 sc1
buffer_load_dwordx4 v[120:123],v1,s[8:11],s63 offen offset:2048 sc1
buffer_load_dwordx4 v[124:127],v1,s[8:11],s63 offen offset:3072 sc1
s_add_u32 s63,s66,99618816
buffer_load_dwordx4 v[128:131],v1,s[8:11],s63 offen sc1
buffer_load_dwordx4 v[132:135],v1,s[8:11],s63 offen offset:1024 sc1
buffer_load_dwordx4 v[136:139],v1,s[8:11],s63 offen offset:2048 sc1
buffer_load_dwordx4 v[140:143],v1,s[8:11],s63 offen offset:3072 sc1
s_add_u32 s63,s66,99622912
buffer_load_dwordx4 v[144:147],v1,s[8:11],s63 offen sc1
buffer_load_dwordx4 v[148:151],v1,s[8:11],s63 offen offset:1024 sc1
buffer_load_dwordx4 v[152:155],v1,s[8:11],s63 offen offset:2048 sc1
buffer_load_dwordx4 v[156:159],v1,s[8:11],s63 offen offset:3072 sc1
s_and_b32 s66,s52,3
s_lshl2_add_u32 s66,s51,s66
s_mul_i32 s66,s66,393216
s_add_u32 s66,s66,s71
v_lshlrev_b32 v232,7,v0
s_add_u32 s63,s66,149946368
buffer_load_dword v233,v232,s[8:11],s63 offen sc1
s_add_u32 s63,s66,149950464
buffer_load_dword v233,v232,s[8:11],s63 offen sc1
s_waitcnt vmcnt(14)
v_mfma_f32_16x16x32_bf16 v[184:187],v[64:67],v[16:19],0
v_mfma_f32_16x16x32_bf16 v[188:191],v[64:67],v[20:23],0
v_mfma_f32_16x16x32_bf16 v[192:195],v[68:71],v[20:23],0
v_mfma_f32_16x16x32_bf16 v[184:187],v[72:75],v[24:27],v[184:187]
v_mfma_f32_16x16x32_bf16 v[188:191],v[72:75],v[28:31],v[188:191]
v_mfma_f32_16x16x32_bf16 v[192:195],v[76:79],v[28:31],v[192:195]
v_mfma_f32_16x16x32_bf16 v[184:187],v[80:83],v[32:35],v[184:187]
v_mfma_f32_16x16x32_bf16 v[188:191],v[80:83],v[36:39],v[188:191]
v_mfma_f32_16x16x32_bf16 v[192:195],v[84:87],v[36:39],v[192:195]
v_mfma_f32_16x16x32_bf16 v[184:187],v[88:91],v[40:43],v[184:187]
v_mfma_f32_16x16x32_bf16 v[188:191],v[88:91],v[44:47],v[188:191]
v_mfma_f32_16x16x32_bf16 v[192:195],v[92:95],v[44:47],v[192:195]
v_mfma_f32_16x16x32_bf16 v[184:187],v[96:99],v[48:51],v[184:187]
v_mfma_f32_16x16x32_bf16 v[188:191],v[96:99],v[52:55],v[188:191]
v_mfma_f32_16x16x32_bf16 v[192:195],v[100:103],v[52:55],v[192:195]
v_mfma_f32_16x16x32_bf16 v[184:187],v[104:107],v[56:59],v[184:187]
v_mfma_f32_16x16x32_bf16 v[188:191],v[104:107],v[60:63],v[188:191]
v_mfma_f32_16x16x32_bf16 v[192:195],v[108:111],v[60:63],v[192:195]
s_nop 1
v_cvt_pk_bf16_f32 v6,v184,v185
v_lshlrev_b32 v184,16,v6
v_and_b32 v185,0xffff0000,v6
v_cvt_pk_bf16_f32 v6,v186,v187
v_lshlrev_b32 v186,16,v6
v_and_b32 v187,0xffff0000,v6
v_cvt_pk_bf16_f32 v6,v188,v189
v_lshlrev_b32 v188,16,v6
v_and_b32 v189,0xffff0000,v6
v_cvt_pk_bf16_f32 v6,v190,v191
v_lshlrev_b32 v190,16,v6
v_and_b32 v191,0xffff0000,v6
v_cvt_pk_bf16_f32 v6,v192,v193
v_lshlrev_b32 v192,16,v6
v_and_b32 v193,0xffff0000,v6
v_cvt_pk_bf16_f32 v6,v194,v195
v_lshlrev_b32 v194,16,v6
v_and_b32 v195,0xffff0000,v6
v_mul_f32 v184,s84,v184
v_mul_f32 v185,s84,v185
v_mul_f32 v186,s84,v186
v_mul_f32 v187,s84,v187
v_mul_f32 v188,s84,v188
v_mul_f32 v189,s84,v189
v_mul_f32 v190,s84,v190
v_mul_f32 v191,s84,v191
v_mul_f32 v192,s84,v192
v_mul_f32 v193,s84,v193
v_mul_f32 v194,s84,v194
v_mul_f32 v195,s84,v195
v_cvt_pk_bf16_f32 v6,v184,v185
v_lshlrev_b32 v184,16,v6
v_and_b32 v185,0xffff0000,v6
v_cvt_pk_bf16_f32 v6,v186,v187
v_lshlrev_b32 v186,16,v6
v_and_b32 v187,0xffff0000,v6
v_cvt_pk_bf16_f32 v6,v188,v189
v_lshlrev_b32 v188,16,v6
v_and_b32 v189,0xffff0000,v6
v_cvt_pk_bf16_f32 v6,v190,v191
v_lshlrev_b32 v190,16,v6
v_and_b32 v191,0xffff0000,v6
v_cvt_pk_bf16_f32 v6,v192,v193
v_lshlrev_b32 v192,16,v6
v_and_b32 v193,0xffff0000,v6
v_cvt_pk_bf16_f32 v6,v194,v195
v_lshlrev_b32 v194,16,v6
v_and_b32 v195,0xffff0000,v6
v_cndmask_b32 v184,v230,v184,s[72:73]
v_cndmask_b32 v185,v230,v185,s[74:75]
v_cndmask_b32 v186,v230,v186,s[76:77]
v_cndmask_b32 v187,v230,v187,s[78:79]
v_cndmask_b32 v192,v230,v192,s[72:73]
v_cndmask_b32 v193,v230,v193,s[74:75]
v_cndmask_b32 v194,v230,v194,s[76:77]
v_cndmask_b32 v195,v230,v195,s[78:79]
v_max3_f32 v241,v188,v189,v190
v_max3_f32 v240,v184,v185,v186
v_max3_f32 v241,v241,v191,v192
v_max_f32 v240,v240,v187
v_max3_f32 v241,v241,v193,v194
v_mov_b32 v244,v240
v_max_f32 v241,v241,v195
s_nop 0
v_permlane32_swap_b32 v240,v244
v_mov_b32 v248,v241
v_max_f32 v240,v240,v244
s_nop 0
v_permlane32_swap_b32 v241,v248
v_mov_b32 v244,v240
v_max_f32 v241,v241,v248
s_nop 0
v_permlane16_swap_b32 v240,v244
v_mov_b32 v248,v241
v_max_f32 v240,v240,v244
s_nop 0
v_permlane16_swap_b32 v241,v248
v_mul_f32 v244,s85,v240
v_max_f32 v241,v241,v248
v_fma_f32 v184,v184,s85,-v244
v_mul_f32 v248,s85,v241
v_fma_f32 v185,v185,s85,-v244
v_fma_f32 v188,v188,s85,-v248
v_fma_f32 v186,v186,s85,-v244
v_fma_f32 v189,v189,s85,-v248
v_fma_f32 v187,v187,s85,-v244
v_fma_f32 v190,v190,s85,-v248
v_exp_f32 v184,v184
v_fma_f32 v191,v191,s85,-v248
v_exp_f32 v185,v185
v_fma_f32 v192,v192,s85,-v248
v_exp_f32 v186,v186
v_fma_f32 v193,v193,s85,-v248
v_exp_f32 v187,v187
v_fma_f32 v194,v194,s85,-v248
v_add_f32 v242,v184,v185
v_fma_f32 v195,v195,s85,-v248
v_add_f32 v242,v242,v186
v_exp_f32 v188,v188
v_add_f32 v242,v242,v187
v_exp_f32 v189,v189
v_exp_f32 v190,v190
v_exp_f32 v191,v191
v_exp_f32 v192,v192
v_exp_f32 v193,v193
v_exp_f32 v194,v194
v_exp_f32 v195,v195
v_add_f32 v243,v188,v189
v_add_f32 v243,v243,v190
v_add_f32 v243,v243,v191
v_add_f32 v243,v243,v192
v_add_f32 v243,v243,v193
v_add_f32 v243,v243,v194
v_add_f32 v243,v243,v195
v_mov_b32 v215,0
v_mov_b32 v225,0
v_mov_b32 v226,0
s_add_u32 s66,s66,149946368
s_lshl_b32 s82,s51,6
s_add_u32 s82,s82,s52
s_lshl_b32 s82,s82,9
s_add_u32 s82,s82,262144
s_lshl_b32 s61,s87,2
s_add_u32 s82,s82,s61
s_lshl_b32 s65,s51,5
s_add_u32 s65,s65,s68
s_lshl_b32 s65,s65,5
s_add_u32 s65,s65,983040
s_sub_u32 s64,s52,3
v_min_u32 v244,4,v0
v_lshlrev_b32 v244,2,v244
s_nop 1
ob_231:
buffer_load_dword v3,v244,s[8:11],s65 offen sc1
s_waitcnt vmcnt(0)
v_cmp_gt_i32 vcc,s64,v3
s_nop 0
s_cbranch_vccz ok_232
s_sleep 2
s_sub_u32 s47,s47,1
s_cbranch_scc1 ABORT
s_branch ob_231
ok_232:
fb_233:
buffer_load_dword v3,v228,s[8:11],s70 offen sc1
s_waitcnt vmcnt(0)
v_cmp_eq_u32 vcc,0,v3
s_nop 0
s_cbranch_vccz ok_234
s_sleep 4
s_sub_u32 s47,s47,1
s_cbranch_scc1 ABORT
s_branch fb_233
ok_234:
buffer_load_dwordx4 v[160:163],v1,s[8:11],s69 offen sc1
buffer_load_dwordx4 v[164:167],v1,s[8:11],s69 offen offset:1024 sc1
buffer_load_dwordx4 v[168:171],v1,s[8:11],s69 offen offset:2048 sc1
s_add_u32 s63,s69,3072
v_lshlrev_b32 v3,3,v0
buffer_load_dwordx4 v[172:175],v1,s[8:11],s63 offen sc1
buffer_load_dwordx2 v[176:177],v3,s[8:11],s63 offen offset:1024 sc1
buffer_load_dwordx4 v[178:181],v1,s[8:11],s63 offen offset:1536 sc1
buffer_load_dwordx2 v[182:183],v3,s[8:11],s63 offen offset:2560 sc1
buffer_load_dword v231,v2,s[8:11],s67 offen offset:1024 sc1
s_waitcnt vmcnt(5)
v_mfma_f32_16x16x32_bf16 v[196:199],v[160:163],v[16:19],0
v_mfma_f32_16x16x32_bf16 v[200:203],v[160:163],v[24:27],0
v_mfma_f32_16x16x32_bf16 v[204:207],v[160:163],v[20:23],0
v_mfma_f32_16x16x32_bf16 v[208:211],v[160:163],v[28:31],0
v_mfma_f32_16x16x32_bf16 v[196:199],v[164:167],v[32:35],v[196:199]
v_mfma_f32_16x16x32_bf16 v[200:203],v[164:167],v[40:43],v[200:203]
v_mfma_f32_16x16x32_bf16 v[204:207],v[164:167],v[36:39],v[204:207]
v_mfma_f32_16x16x32_bf16 v[208:211],v[164:167],v[44:47],v[208:211]
v_mfma_f32_16x16x32_bf16 v[196:199],v[168:171],v[48:51],v[196:199]
v_mfma_f32_16x16x32_bf16 v[200:203],v[168:171],v[56:59],v[200:203]
v_mfma_f32_16x16x32_bf16 v[204:207],v[168:171],v[52:55],v[204:207]
v_mfma_f32_16x16x32_bf16 v[208:211],v[168:171],v[60:63],v[208:211]
s_nop 7
v_add_f32 v204,v204,v210
v_add_f32 v196,v196,v202
v_add_f32 v205,v205,v211
v_add_f32 v197,v197,v203
v_cvt_pk_bf16_f32 v248,v204,v205
v_cvt_pk_bf16_f32 v244,v196,v197
v_lshlrev_b32 v204,16,v248
v_lshlrev_b32 v196,16,v244
v_and_b32 v205,0xffff0000,v248
v_and_b32 v197,0xffff0000,v244
v_mul_f32 v204,s84,v204
v_mul_f32 v196,s84,v196
v_mul_f32 v205,s84,v205
v_mul_f32 v197,s84,v197
v_cvt_pk_bf16_f32 v248,v204,v205
v_cvt_pk_bf16_f32 v244,v196,v197
v_lshlrev_b32 v204,16,v248
v_lshlrev_b32 v196,16,v244
v_and_b32 v205,0xffff0000,v248
v_and_b32 v197,0xffff0000,v244
v_max3_f32 v248,v204,v205,v241
v_max3_f32 v244,v196,v197,v240
v_mov_b32 v249,v248
v_mov_b32 v245,v244
s_nop 0
v_permlane32_swap_b32 v248,v249
v_permlane32_swap_b32 v244,v245
v_max_f32 v248,v248,v249
v_max_f32 v244,v244,v245
v_mov_b32 v249,v248
v_mov_b32 v245,v244
s_nop 0
v_permlane16_swap_b32 v248,v249
v_permlane16_swap_b32 v244,v245
v_max_f32 v248,v248,v249
v_max_f32 v244,v244,v245
v_mul_f32 v248,s85,v248
v_mul_f32 v244,s85,v244
v_fma_f32 v250,v241,s85,-v248
v_fma_f32 v246,v240,s85,-v244
v_fma_f32 v204,v204,s85,-v248
v_fma_f32 v196,v196,s85,-v244
v_fma_f32 v205,v205,s85,-v248
v_fma_f32 v197,v197,s85,-v244
v_exp_f32 v250,v250
v_exp_f32 v246,v246
v_exp_f32 v204,v204
v_exp_f32 v196,v196
v_exp_f32 v205,v205
v_exp_f32 v197,v197
v_fma_f32 v248,v250,v243,v204
v_fma_f32 v244,v246,v242,v196
v_add_f32 v248,v248,v205
v_add_f32 v244,v244,v197
v_mov_b32 v249,v248
v_mov_b32 v245,v244
s_nop 0
v_permlane32_swap_b32 v248,v249
v_permlane32_swap_b32 v244,v245
v_add_f32 v248,v248,v249
v_add_f32 v244,v244,v245
v_mov_b32 v249,v248
v_mov_b32 v245,v244
s_nop 0
v_permlane16_swap_b32 v248,v249
v_permlane16_swap_b32 v244,v245
v_add_f32 v248,v248,v249
v_add_f32 v244,v244,v245
v_rcp_f32 v248,v248
v_rcp_f32 v244,v244
v_mul_f32 v250,v250,v248
v_mul_f32 v246,v246,v244
v_mul_f32 v188,v188,v250
v_mul_f32 v184,v184,v246
v_mul_f32 v189,v189,v250
v_mul_f32 v185,v185,v246
v_mul_f32 v190,v190,v250
v_mul_f32 v186,v186,v246
v_mul_f32 v191,v191,v250
v_mul_f32 v187,v187,v246
v_mul_f32 v192,v192,v250
v_cvt_pk_bf16_f32 v212,v184,v185
v_mul_f32 v193,v193,v250
v_cvt_pk_bf16_f32 v213,v186,v187
v_mul_f32 v194,v194,v250
v_mul_f32 v196,v196,v244
v_mul_f32 v195,v195,v250
v_mul_f32 v197,v197,v244
v_cvt_pk_bf16_f32 v220,v188,v189
v_cvt_pk_bf16_f32 v214,v196,v197
v_cvt_pk_bf16_f32 v221,v190,v191
v_cvt_pk_bf16_f32 v222,v192,v193
v_cvt_pk_bf16_f32 v223,v194,v195
v_mul_f32 v204,v204,v248
v_mul_f32 v205,v205,v248
v_cvt_pk_bf16_f32 v224,v204,v205
v_cvt_pk_bf16_f32 v227,v204,v205
s_waitcnt vmcnt(1)
s_cmp_lg_u32 s49,0
s_cbranch_scc1 ATT_OS
v_mfma_f32_16x16x32_bf16 v[64:67],v[112:115],v[220:223],0
v_mfma_f32_16x16x32_bf16 v[68:71],v[116:119],v[220:223],0
v_mfma_f32_16x16x16_bf16 v[64:67],v[172:173],v[224:225],v[64:67]
v_mov_b32 v114,v172
v_mov_b32 v118,v173
v_mfma_f32_16x16x16_bf16 v[68:71],v[172:173],v[226:227],v[68:71]
v_mfma_f32_16x16x32_bf16 v[72:75],v[120:123],v[220:223],0
v_mfma_f32_16x16x32_bf16 v[76:79],v[124:127],v[220:223],0
v_cvt_pk_bf16_f32 v232,v64,v65
v_cvt_pk_bf16_f32 v233,v66,v67
v_mfma_f32_16x16x16_bf16 v[72:75],v[174:175],v[224:225],v[72:75]
v_mov_b32 v122,v174
v_mov_b32 v126,v175
v_mfma_f32_16x16x16_bf16 v[76:79],v[174:175],v[226:227],v[76:79]
v_cvt_pk_bf16_f32 v234,v68,v69
v_cvt_pk_bf16_f32 v235,v70,v71
s_add_u32 s63,s66,256
v_mfma_f32_16x16x32_bf16 v[80:83],v[128:131],v[220:223],0
buffer_store_dwordx4 v[232:235],v229,s[8:11],s63 offen offset:0
v_mfma_f32_16x16x32_bf16 v[84:87],v[132:135],v[220:223],0
v_cvt_pk_bf16_f32 v236,v72,v73
v_cvt_pk_bf16_f32 v237,v74,v75
v_mfma_f32_16x16x16_bf16 v[80:83],v[176:177],v[224:225],v[80:83]
v_mov_b32 v130,v176
v_mov_b32 v134,v177
v_mfma_f32_16x16x16_bf16 v[84:87],v[176:177],v[226:227],v[84:87]
v_cvt_pk_bf16_f32 v238,v76,v77
v_cvt_pk_bf16_f32 v239,v78,v79
v_mfma_f32_16x16x32_bf16 v[88:91],v[136:139],v[220:223],0
buffer_store_dwordx4 v[236:239],v229,s[8:11],s63 offen offset:2048
v_mfma_f32_16x16x32_bf16 v[92:95],v[140:143],v[220:223],0
v_cvt_pk_bf16_f32 v232,v80,v81
v_cvt_pk_bf16_f32 v233,v82,v83
v_mfma_f32_16x16x16_bf16 v[88:91],v[178:179],v[224:225],v[88:91]
v_mov_b32 v138,v178
v_mov_b32 v142,v179
v_mfma_f32_16x16x16_bf16 v[92:95],v[178:179],v[226:227],v[92:95]
v_cvt_pk_bf16_f32 v234,v84,v85
v_cvt_pk_bf16_f32 v235,v86,v87
s_add_u32 s63,s66,4352
v_mfma_f32_16x16x32_bf16 v[96:99],v[144:147],v[220:223],0
buffer_store_dwordx4 v[232:235],v229,s[8:11],s63 offen offset:0
v_mfma_f32_16x16x32_bf16 v[100:103],v[148:151],v[220:223],0
v_cvt_pk_bf16_f32 v236,v88,v89
v_cvt_pk_bf16_f32 v237,v90,v91
v_mfma_f32_16x16x16_bf16 v[96:99],v[180:181],v[224:225],v[96:99]
v_mov_b32 v146,v180
v_mov_b32 v150,v181
v_mfma_f32_16x16x16_bf16 v[100:103],v[180:181],v[226:227],v[100:103]
v_cvt_pk_bf16_f32 v238,v92,v93
v_cvt_pk_bf16_f32 v239,v94,v95
v_mfma_f32_16x16x32_bf16 v[104:107],v[152:155],v[220:223],0
buffer_store_dwordx4 v[236:239],v229,s[8:11],s63 offen offset:2048
v_mfma_f32_16x16x32_bf16 v[108:111],v[156:159],v[220:223],0
v_cvt_pk_bf16_f32 v232,v96,v97
v_cvt_pk_bf16_f32 v233,v98,v99
v_mfma_f32_16x16x16_bf16 v[104:107],v[182:183],v[224:225],v[104:107]
v_mov_b32 v154,v182
v_mov_b32 v158,v183
v_mfma_f32_16x16x16_bf16 v[108:111],v[182:183],v[226:227],v[108:111]
v_cvt_pk_bf16_f32 v234,v100,v101
v_cvt_pk_bf16_f32 v235,v102,v103
s_add_u32 s63,s66,8448
v_mfma_f32_16x16x32_bf16 v[16:19],v[112:115],v[212:215],0
buffer_store_dwordx4 v[232:235],v229,s[8:11],s63 offen offset:0
v_mfma_f32_16x16x32_bf16 v[20:23],v[116:119],v[212:215],0
v_cvt_pk_bf16_f32 v236,v104,v105
v_cvt_pk_bf16_f32 v237,v106,v107
v_mfma_f32_16x16x32_bf16 v[24:27],v[120:123],v[212:215],0
v_cvt_pk_bf16_f32 v238,v108,v109
v_cvt_pk_bf16_f32 v239,v110,v111
v_mfma_f32_16x16x32_bf16 v[28:31],v[124:127],v[212:215],0
buffer_store_dwordx4 v[236:239],v229,s[8:11],s63 offen offset:2048
v_cvt_pk_bf16_f32 v232,v16,v17
v_mfma_f32_16x16x32_bf16 v[32:35],v[128:131],v[212:215],0
v_cvt_pk_bf16_f32 v233,v18,v19
v_cvt_pk_bf16_f32 v234,v20,v21
v_mfma_f32_16x16x32_bf16 v[36:39],v[132:135],v[212:215],0
v_cvt_pk_bf16_f32 v235,v22,v23
s_add_u32 s63,s66,0
v_mfma_f32_16x16x32_bf16 v[40:43],v[136:139],v[212:215],0
buffer_store_dwordx4 v[232:235],v229,s[8:11],s63 offen offset:0
v_cvt_pk_bf16_f32 v236,v24,v25
v_mfma_f32_16x16x32_bf16 v[44:47],v[140:143],v[212:215],0
v_cvt_pk_bf16_f32 v237,v26,v27
v_cvt_pk_bf16_f32 v238,v28,v29
v_mfma_f32_16x16x32_bf16 v[48:51],v[144:147],v[212:215],0
v_cvt_pk_bf16_f32 v239,v30,v31
buffer_store_dwordx4 v[236:239],v229,s[8:11],s63 offen offset:2048
v_mfma_f32_16x16x32_bf16 v[52:55],v[148:151],v[212:215],0
v_cvt_pk_bf16_f32 v232,v32,v33
v_cvt_pk_bf16_f32 v233,v34,v35
v_mfma_f32_16x16x32_bf16 v[56:59],v[152:155],v[212:215],0
v_cvt_pk_bf16_f32 v234,v36,v37
v_cvt_pk_bf16_f32 v235,v38,v39
s_add_u32 s63,s66,4096
v_mfma_f32_16x16x32_bf16 v[60:63],v[156:159],v[212:215],0
buffer_store_dwordx4 v[232:235],v229,s[8:11],s63 offen offset:0
v_cvt_pk_bf16_f32 v236,v40,v41
v_cvt_pk_bf16_f32 v237,v42,v43
v_cvt_pk_bf16_f32 v238,v44,v45
v_cvt_pk_bf16_f32 v239,v46,v47
buffer_store_dwordx4 v[236:239],v229,s[8:11],s63 offen offset:2048
v_cvt_pk_bf16_f32 v232,v48,v49
v_cvt_pk_bf16_f32 v233,v50,v51
v_cvt_pk_bf16_f32 v234,v52,v53
v_cvt_pk_bf16_f32 v235,v54,v55
s_add_u32 s63,s66,8192
buffer_store_dwordx4 v[232:235],v229,s[8:11],s63 offen offset:0
v_cvt_pk_bf16_f32 v236,v56,v57
v_cvt_pk_bf16_f32 v237,v58,v59
v_cvt_pk_bf16_f32 v238,v60,v61
v_cvt_pk_bf16_f32 v239,v62,v63
buffer_store_dwordx4 v[236:239],v229,s[8:11],s63 offen offset:2048
s_waitcnt vmcnt(0)
s_mov_b64 exec,1
buffer_store_dword v5,v1,s[8:11],s82 offen
s_mov_b64 exec,-1
s_branch ATT_OJ
ATT_OS:
v_mfma_f32_16x16x32_bf16 v[64:67],v[112:115],v[220:223],0
v_mfma_f32_16x16x32_bf16 v[68:71],v[116:119],v[220:223],0
v_mfma_f32_16x16x16_bf16 v[64:67],v[172:173],v[224:225],v[64:67]
v_mov_b32 v114,v172
v_mov_b32 v118,v173
v_mfma_f32_16x16x16_bf16 v[68:71],v[172:173],v[226:227],v[68:71]
v_mfma_f32_16x16x32_bf16 v[72:75],v[120:123],v[220:223],0
v_mfma_f32_16x16x32_bf16 v[76:79],v[124:127],v[220:223],0
v_cvt_pk_bf16_f32 v232,v64,v65
v_cvt_pk_bf16_f32 v233,v66,v67
v_mfma_f32_16x16x16_bf16 v[72:75],v[174:175],v[224:225],v[72:75]
v_mov_b32 v122,v174
v_mov_b32 v126,v175
v_mfma_f32_16x16x16_bf16 v[76:79],v[174:175],v[226:227],v[76:79]
v_cvt_pk_bf16_f32 v234,v68,v69
v_cvt_pk_bf16_f32 v235,v70,v71
s_add_u32 s63,s66,256
v_mfma_f32_16x16x32_bf16 v[80:83],v[128:131],v[220:223],0
buffer_store_dwordx4 v[232:235],v229,s[8:11],s63 offen sc1
v_mfma_f32_16x16x32_bf16 v[84:87],v[132:135],v[220:223],0
v_cvt_pk_bf16_f32 v236,v72,v73
v_cvt_pk_bf16_f32 v237,v74,v75
v_mfma_f32_16x16x16_bf16 v[80:83],v[176:177],v[224:225],v[80:83]
v_mov_b32 v130,v176
v_mov_b32 v134,v177
v_mfma_f32_16x16x16_bf16 v[84:87],v[176:177],v[226:227],v[84:87]
v_cvt_pk_bf16_f32 v238,v76,v77
v_cvt_pk_bf16_f32 v239,v78,v79
v_mfma_f32_16x16x32_bf16 v[88:91],v[136:139],v[220:223],0
buffer_store_dwordx4 v[236:239],v229,s[8:11],s63 offen offset:2048 sc1
v_mfma_f32_16x16x32_bf16 v[92:95],v[140:143],v[220:223],0
v_cvt_pk_bf16_f32 v232,v80,v81
v_cvt_pk_bf16_f32 v233,v82,v83
v_mfma_f32_16x16x16_bf16 v[88:91],v[178:179],v[224:225],v[88:91]
v_mov_b32 v138,v178
v_mov_b32 v142,v179
v_mfma_f32_16x16x16_bf16 v[92:95],v[178:179],v[226:227],v[92:95]
v_cvt_pk_bf16_f32 v234,v84,v85
v_cvt_pk_bf16_f32 v235,v86,v87
s_add_u32 s63,s66,4352
v_mfma_f32_16x16x32_bf16 v[96:99],v[144:147],v[220:223],0
buffer_store_dwordx4 v[232:235],v229,s[8:11],s63 offen sc1
v_mfma_f32_16x16x32_bf16 v[100:103],v[148:151],v[220:223],0
v_cvt_pk_bf16_f32 v236,v88,v89
v_cvt_pk_bf16_f32 v237,v90,v91
v_mfma_f32_16x16x16_bf16 v[96:99],v[180:181],v[224:225],v[96:99]
v_mov_b32 v146,v180
v_mov_b32 v150,v181
v_mfma_f32_16x16x16_bf16 v[100:103],v[180:181],v[226:227],v[100:103]
v_cvt_pk_bf16_f32 v238,v92,v93
v_cvt_pk_bf16_f32 v239,v94,v95
v_mfma_f32_16x16x32_bf16 v[104:107],v[152:155],v[220:223],0
buffer_store_dwordx4 v[236:239],v229,s[8:11],s63 offen offset:2048 sc1
v_mfma_f32_16x16x32_bf16 v[108:111],v[156:159],v[220:223],0
v_cvt_pk_bf16_f32 v232,v96,v97
v_cvt_pk_bf16_f32 v233,v98,v99
v_mfma_f32_16x16x16_bf16 v[104:107],v[182:183],v[224:225],v[104:107]
v_mov_b32 v154,v182
v_mov_b32 v158,v183
v_mfma_f32_16x16x16_bf16 v[108:111],v[182:183],v[226:227],v[108:111]
v_cvt_pk_bf16_f32 v234,v100,v101
v_cvt_pk_bf16_f32 v235,v102,v103
s_add_u32 s63,s66,8448
v_mfma_f32_16x16x32_bf16 v[16:19],v[112:115],v[212:215],0
buffer_store_dwordx4 v[232:235],v229,s[8:11],s63 offen sc1
v_mfma_f32_16x16x32_bf16 v[20:23],v[116:119],v[212:215],0
v_cvt_pk_bf16_f32 v236,v104,v105
v_cvt_pk_bf16_f32 v237,v106,v107
v_mfma_f32_16x16x32_bf16 v[24:27],v[120:123],v[212:215],0
v_cvt_pk_bf16_f32 v238,v108,v109
v_cvt_pk_bf16_f32 v239,v110,v111
v_mfma_f32_16x16x32_bf16 v[28:31],v[124:127],v[212:215],0
buffer_store_dwordx4 v[236:239],v229,s[8:11],s63 offen offset:2048 sc1
v_cvt_pk_bf16_f32 v232,v16,v17
v_mfma_f32_16x16x32_bf16 v[32:35],v[128:131],v[212:215],0
v_cvt_pk_bf16_f32 v233,v18,v19
v_cvt_pk_bf16_f32 v234,v20,v21
v_mfma_f32_16x16x32_bf16 v[36:39],v[132:135],v[212:215],0
v_cvt_pk_bf16_f32 v235,v22,v23
s_add_u32 s63,s66,0
v_mfma_f32_16x16x32_bf16 v[40:43],v[136:139],v[212:215],0
buffer_store_dwordx4 v[232:235],v229,s[8:11],s63 offen sc1
v_cvt_pk_bf16_f32 v236,v24,v25
v_mfma_f32_16x16x32_bf16 v[44:47],v[140:143],v[212:215],0
v_cvt_pk_bf16_f32 v237,v26,v27
v_cvt_pk_bf16_f32 v238,v28,v29
v_mfma_f32_16x16x32_bf16 v[48:51],v[144:147],v[212:215],0
v_cvt_pk_bf16_f32 v239,v30,v31
buffer_store_dwordx4 v[236:239],v229,s[8:11],s63 offen offset:2048 sc1
v_mfma_f32_16x16x32_bf16 v[52:55],v[148:151],v[212:215],0
v_cvt_pk_bf16_f32 v232,v32,v33
v_cvt_pk_bf16_f32 v233,v34,v35
v_mfma_f32_16x16x32_bf16 v[56:59],v[152:155],v[212:215],0
v_cvt_pk_bf16_f32 v234,v36,v37
v_cvt_pk_bf16_f32 v235,v38,v39
s_add_u32 s63,s66,4096
v_mfma_f32_16x16x32_bf16 v[60:63],v[156:159],v[212:215],0
buffer_store_dwordx4 v[232:235],v229,s[8:11],s63 offen sc1
v_cvt_pk_bf16_f32 v236,v40,v41
v_cvt_pk_bf16_f32 v237,v42,v43
v_cvt_pk_bf16_f32 v238,v44,v45
v_cvt_pk_bf16_f32 v239,v46,v47
buffer_store_dwordx4 v[236:239],v229,s[8:11],s63 offen offset:2048 sc1
v_cvt_pk_bf16_f32 v232,v48,v49
v_cvt_pk_bf16_f32 v233,v50,v51
v_cvt_pk_bf16_f32 v234,v52,v53
v_cvt_pk_bf16_f32 v235,v54,v55
s_add_u32 s63,s66,8192
buffer_store_dwordx4 v[232:235],v229,s[8:11],s63 offen sc1
v_cvt_pk_bf16_f32 v236,v56,v57
v_cvt_pk_bf16_f32 v237,v58,v59
v_cvt_pk_bf16_f32 v238,v60,v61
v_cvt_pk_bf16_f32 v239,v62,v63
buffer_store_dwordx4 v[236:239],v229,s[8:11],s63 offen offset:2048 sc1
s_waitcnt vmcnt(0)
s_mov_b64 exec,1
buffer_store_dword v5,v1,s[8:11],s82 offen sc1
s_mov_b64 exec,-1
ATT_OJ:
s_add_u32 s69,s69,393216
s_add_u32 s70,s70,2048
s_add_u32 s52,s52,2
s_cmp_lt_u32 s52,64
s_cbranch_scc1 ATT_LOOP
s_endpgm
ROLE_WO:
v_lshlrev_b32 v1,4,v0
v_mov_b32 v5,1
s_lshl_b32 s56,s48,2
s_add_u32 s56,s56,s46
v_bfe_u32 v6,v0,2,2
v_lshrrev_b32 v7,4,v0
v_add_u32 v7,v6,v7
v_and_b32 v7,3,v7
v_and_b32 v15,3,v0
v_lshlrev_b32 v15,4,v15
v_lshl_add_u32 v15,v7,6,v15
v_lshl_add_u32 v15,v6,8,v15
v_lshrrev_b32 v6,5,v0
v_bfe_u32 v7,v0,4,1
v_lshlrev_b32 v16,10,v7
v_lshl_add_u32 v16,v6,8,v16
v_and_b32 v6,15,v0
v_lshl_add_u32 v16,v6,4,v16
v_add_u32 v18,49152,v16
v_lshrrev_b32 v6,5,v0
v_bfe_u32 v7,v0,4,1
v_lshlrev_b32 v20,10,v7
v_lshl_add_u32 v20,v6,8,v20
v_and_b32 v6,15,v0
v_lshl_add_u32 v20,v6,4,v20
v_lshrrev_b32 v6,5,v0
v_add_u32 v6,2,v6
v_bfe_u32 v7,v0,4,1
v_lshlrev_b32 v17,10,v7
v_lshl_add_u32 v17,v6,8,v17
v_and_b32 v6,15,v0
v_lshl_add_u32 v17,v6,4,v17
v_add_u32 v19,49152,v17
v_lshrrev_b32 v6,5,v0
v_add_u32 v6,2,v6
v_bfe_u32 v7,v0,4,1
v_lshlrev_b32 v21,10,v7
v_lshl_add_u32 v21,v6,8,v21
v_and_b32 v6,15,v0
v_lshl_add_u32 v21,v6,4,v21
v_add_u32 v16,0,v1
v_add_u32 v17,1024,v1
v_add_u32 v18,49152,v1
v_add_u32 v19,50176,v1
s_mul_i32 s68,s48,52429
s_lshr_b32 s68,s68,18
s_mul_i32 s60,s68,20
s_sub_u32 s60,s56,s60
s_lshl2_add_u32 s61,s68,s46
s_lshl_b32 s74,s61,5
s_and_b32 s62,s60,-4
s_add_u32 s74,s74,s62
s_add_u32 s74,s74,983040
s_lshr_b32 s62,s61,3
s_mul_i32 s62,s62,24
s_add_u32 s61,s61,s62
s_lshl_b32 s61,s61,2
v_mov_b32 v2,s61
v_bfe_u32 v6,v0,2,3
v_mul_u32_u24 v20,5120,v6
v_and_b32 v6,3,v0
v_lshl_add_u32 v20,v6,4,v20
v_lshrrev_b32 v6,5,v0
v_lshl_add_u32 v20,v6,6,v20
s_mul_i32 s58,s68,983040
s_lshl_b32 s61,s60,6
s_add_u32 s58,s58,s61
s_mul_i32 s69,s68,40960
s_lshl_b32 s60,s60,8
s_add_u32 s69,s69,s60
s_add_u32 s69,s69,175112192
s_lshl_b32 s75,s56,2
s_add_u32 s75,s75,819200
s_waitcnt vmcnt(0)
s_barrier
s_cmp_lg_u32 s46,0
s_cbranch_scc1 arr_235
v_mov_b32 v6,1
s_lshl_b32 s3,s49,2
v_mov_b32 v7,s3
s_mov_b64 exec,1
buffer_atomic_add v6,v7,s[12:15],0 offen sc1
s_mov_b64 exec,-1
arr_235:
s_lshl_b32 s3,s49,2
v_mov_b32 v7,s3
s_nop 1
ibw_236:
buffer_load_dword v6,v7,s[12:15],0 offen sc1
s_waitcnt vmcnt(0)
v_cmp_ne_u32 vcc,256,v6
s_nop 0
s_cbranch_vccz ok_237
s_sleep 8
s_sub_u32 s47,s47,1
s_cbranch_scc1 ABORT
s_branch ibw_236
ok_237:
s_cmp_lg_u32 s49,0
s_cbranch_scc1 ibok_238
v_and_b32 v7,7,v0
v_lshlrev_b32 v7,2,v7
buffer_load_dword v6,v7,s[12:15],0 offen offset:32 sc1
s_waitcnt vmcnt(0)
v_cmp_ne_u32 vcc,32,v6
s_nop 0
s_cbranch_vccz ibok_238
s_barrier
s_mov_b32 s49,1
s_mov_b32 s3,s2
s_load_dwordx16 s[16:31],s[0:1],0
s_load_dwordx8 s[32:39],s[0:1],64
s_waitcnt lgkmcnt(0)
s_branch DISPATCH
ibok_238:
s_mul_i32 s63,s46,40960
s_mov_b32 s4,s26
s_mov_b32 s5,s27
s_mov_b32 s6,7864320
s_mov_b32 s7,0x20000
v_lshrrev_b32 v9,2,v0
s_mov_b32 s64,1280
v_mul_lo_u32 v9,v9,s64
v_and_b32 v10,3,v0
v_lshl_add_u32 v6,v10,4,v9
s_add_u32 m0,s63,0
s_add_u32 s65,s58,0
buffer_load_dwordx4 v6,s[4:7],s65 offen lds
s_add_u32 m0,s63,1024
s_add_u32 s65,s58,20480
buffer_load_dwordx4 v6,s[4:7],s65 offen lds
s_add_u32 m0,s63,2048
s_add_u32 s65,s58,40960
buffer_load_dwordx4 v6,s[4:7],s65 offen lds
s_add_u32 m0,s63,3072
s_add_u32 s65,s58,61440
buffer_load_dwordx4 v6,s[4:7],s65 offen lds
s_add_u32 m0,s63,4096
s_add_u32 s65,s58,81920
buffer_load_dwordx4 v6,s[4:7],s65 offen lds
s_add_u32 m0,s63,5120
s_add_u32 s65,s58,102400
buffer_load_dwordx4 v6,s[4:7],s65 offen lds
s_add_u32 m0,s63,6144
s_add_u32 s65,s58,122880
buffer_load_dwordx4 v6,s[4:7],s65 offen lds
s_add_u32 m0,s63,7168
s_add_u32 s65,s58,143360
buffer_load_dwordx4 v6,s[4:7],s65 offen lds
s_add_u32 m0,s63,8192
s_add_u32 s65,s58,163840
buffer_load_dwordx4 v6,s[4:7],s65 offen lds
s_add_u32 m0,s63,9216
s_add_u32 s65,s58,184320
buffer_load_dwordx4 v6,s[4:7],s65 offen lds
s_add_u32 m0,s63,10240
s_add_u32 s65,s58,204800
buffer_load_dwordx4 v6,s[4:7],s65 offen lds
s_add_u32 m0,s63,11264
s_add_u32 s65,s58,225280
buffer_load_dwordx4 v6,s[4:7],s65 offen lds
s_add_u32 m0,s63,12288
s_add_u32 s65,s58,245760
buffer_load_dwordx4 v6,s[4:7],s65 offen lds
s_add_u32 m0,s63,13312
s_add_u32 s65,s58,266240
buffer_load_dwordx4 v6,s[4:7],s65 offen lds
s_add_u32 m0,s63,14336
s_add_u32 s65,s58,286720
buffer_load_dwordx4 v6,s[4:7],s65 offen lds
s_add_u32 m0,s63,15360
s_add_u32 s65,s58,307200
buffer_load_dwordx4 v6,s[4:7],s65 offen lds
s_add_u32 m0,s63,16384
s_add_u32 s65,s58,327680
buffer_load_dwordx4 v6,s[4:7],s65 offen lds
s_add_u32 m0,s63,17408
s_add_u32 s65,s58,348160
buffer_load_dwordx4 v6,s[4:7],s65 offen lds
s_add_u32 m0,s63,18432
s_add_u32 s65,s58,368640
buffer_load_dwordx4 v6,s[4:7],s65 offen lds
s_add_u32 m0,s63,19456
s_add_u32 s65,s58,389120
buffer_load_dwordx4 v6,s[4:7],s65 offen lds
s_add_u32 m0,s63,20480
s_add_u32 s65,s58,409600
buffer_load_dwordx4 v6,s[4:7],s65 offen lds
s_add_u32 m0,s63,21504
s_add_u32 s65,s58,430080
buffer_load_dwordx4 v6,s[4:7],s65 offen lds
s_add_u32 m0,s63,22528
s_add_u32 s65,s58,450560
buffer_load_dwordx4 v6,s[4:7],s65 offen lds
s_add_u32 m0,s63,23552
s_add_u32 s65,s58,471040
buffer_load_dwordx4 v6,s[4:7],s65 offen lds
s_add_u32 m0,s63,24576
s_add_u32 s65,s58,491520
buffer_load_dwordx4 v6,s[4:7],s65 offen lds
s_add_u32 m0,s63,25600
s_add_u32 s65,s58,512000
buffer_load_dwordx4 v6,s[4:7],s65 offen lds
s_add_u32 m0,s63,26624
s_add_u32 s65,s58,532480
buffer_load_dwordx4 v6,s[4:7],s65 offen lds
s_add_u32 m0,s63,27648
s_add_u32 s65,s58,552960
buffer_load_dwordx4 v6,s[4:7],s65 offen lds
s_add_u32 m0,s63,28672
s_add_u32 s65,s58,573440
buffer_load_dwordx4 v6,s[4:7],s65 offen lds
s_add_u32 m0,s63,29696
s_add_u32 s65,s58,593920
buffer_load_dwordx4 v6,s[4:7],s65 offen lds
s_add_u32 m0,s63,30720
s_add_u32 s65,s58,614400
buffer_load_dwordx4 v6,s[4:7],s65 offen lds
s_add_u32 m0,s63,31744
s_add_u32 s65,s58,634880
buffer_load_dwordx4 v6,s[4:7],s65 offen lds
s_add_u32 m0,s63,32768
s_add_u32 s65,s58,655360
buffer_load_dwordx4 v6,s[4:7],s65 offen lds
s_add_u32 m0,s63,33792
s_add_u32 s65,s58,675840
buffer_load_dwordx4 v6,s[4:7],s65 offen lds
s_add_u32 m0,s63,34816
s_add_u32 s65,s58,696320
buffer_load_dwordx4 v6,s[4:7],s65 offen lds
s_add_u32 m0,s63,35840
s_add_u32 s65,s58,716800
buffer_load_dwordx4 v6,s[4:7],s65 offen lds
s_add_u32 m0,s63,36864
s_add_u32 s65,s58,737280
buffer_load_dwordx4 v6,s[4:7],s65 offen lds
s_add_u32 m0,s63,37888
s_add_u32 s65,s58,757760
buffer_load_dwordx4 v6,s[4:7],s65 offen lds
s_add_u32 m0,s63,38912
s_add_u32 s65,s58,778240
buffer_load_dwordx4 v6,s[4:7],s65 offen lds
s_add_u32 m0,s63,39936
s_add_u32 s65,s58,798720
buffer_load_dwordx4 v6,s[4:7],s65 offen lds
s_waitcnt vmcnt(20)
v_bfe_u32 v9,v0,2,2
v_lshrrev_b32 v10,5,v0
v_lshl_add_u32 v9,v10,2,v9
v_mul_u32_u24 v9,64,v9
v_and_b32 v10,1,v0
v_lshl_add_u32 v9,v10,3,v9
v_bfe_u32 v10,v0,1,1
v_lshl_add_u32 v9,v10,5,v9
v_bfe_u32 v10,v0,4,1
v_lshl_add_u32 v9,v10,4,v9
v_add_u32 v7,s63,v9
ds_read_b64_tr_b16 a[0:1],v7 offset:0
ds_read_b64_tr_b16 a[2:3],v7 offset:1024
ds_read_b64_tr_b16 a[4:5],v7 offset:512
ds_read_b64_tr_b16 a[6:7],v7 offset:1536
ds_read_b64_tr_b16 a[8:9],v7 offset:2048
ds_read_b64_tr_b16 a[10:11],v7 offset:3072
ds_read_b64_tr_b16 a[12:13],v7 offset:2560
ds_read_b64_tr_b16 a[14:15],v7 offset:3584
ds_read_b64_tr_b16 a[16:17],v7 offset:4096
ds_read_b64_tr_b16 a[18:19],v7 offset:5120
ds_read_b64_tr_b16 a[20:21],v7 offset:4608
ds_read_b64_tr_b16 a[22:23],v7 offset:5632
s_waitcnt lgkmcnt(4)
ds_read_b64_tr_b16 a[24:25],v7 offset:6144
ds_read_b64_tr_b16 a[26:27],v7 offset:7168
ds_read_b64_tr_b16 a[28:29],v7 offset:6656
ds_read_b64_tr_b16 a[30:31],v7 offset:7680
ds_read_b64_tr_b16 a[32:33],v7 offset:8192
ds_read_b64_tr_b16 a[34:35],v7 offset:9216
ds_read_b64_tr_b16 a[36:37],v7 offset:8704
ds_read_b64_tr_b16 a[38:39],v7 offset:9728
ds_read_b64_tr_b16 a[40:41],v7 offset:10240
ds_read_b64_tr_b16 a[42:43],v7 offset:11264
ds_read_b64_tr_b16 a[44:45],v7 offset:10752
ds_read_b64_tr_b16 a[46:47],v7 offset:11776
s_waitcnt lgkmcnt(4)
ds_read_b64_tr_b16 a[48:49],v7 offset:12288
ds_read_b64_tr_b16 a[50:51],v7 offset:13312
ds_read_b64_tr_b16 a[52:53],v7 offset:12800
ds_read_b64_tr_b16 a[54:55],v7 offset:13824
ds_read_b64_tr_b16 a[56:57],v7 offset:14336
ds_read_b64_tr_b16 a[58:59],v7 offset:15360
ds_read_b64_tr_b16 a[60:61],v7 offset:14848
ds_read_b64_tr_b16 a[62:63],v7 offset:15872
ds_read_b64_tr_b16 a[64:65],v7 offset:16384
ds_read_b64_tr_b16 a[66:67],v7 offset:17408
ds_read_b64_tr_b16 a[68:69],v7 offset:16896
ds_read_b64_tr_b16 a[70:71],v7 offset:17920
s_waitcnt lgkmcnt(4)
ds_read_b64_tr_b16 a[72:73],v7 offset:18432
ds_read_b64_tr_b16 a[74:75],v7 offset:19456
ds_read_b64_tr_b16 a[76:77],v7 offset:18944
ds_read_b64_tr_b16 a[78:79],v7 offset:19968
s_waitcnt lgkmcnt(0)
s_add_u32 m0,s63,0
s_add_u32 s65,s58,819200
buffer_load_dwordx4 v6,s[4:7],s65 offen lds
s_add_u32 m0,s63,1024
s_add_u32 s65,s58,839680
buffer_load_dwordx4 v6,s[4:7],s65 offen lds
s_add_u32 m0,s63,2048
s_add_u32 s65,s58,860160
buffer_load_dwordx4 v6,s[4:7],s65 offen lds
s_add_u32 m0,s63,3072
s_add_u32 s65,s58,880640
buffer_load_dwordx4 v6,s[4:7],s65 offen lds
s_add_u32 m0,s63,4096
s_add_u32 s65,s58,901120
buffer_load_dwordx4 v6,s[4:7],s65 offen lds
s_add_u32 m0,s63,5120
s_add_u32 s65,s58,921600
buffer_load_dwordx4 v6,s[4:7],s65 offen lds
s_add_u32 m0,s63,6144
s_add_u32 s65,s58,942080
buffer_load_dwordx4 v6,s[4:7],s65 offen lds
s_add_u32 m0,s63,7168
s_add_u32 s65,s58,962560
buffer_load_dwordx4 v6,s[4:7],s65 offen lds
s_waitcnt vmcnt(8)
v_bfe_u32 v9,v0,2,2
v_lshrrev_b32 v10,5,v0
v_lshl_add_u32 v9,v10,2,v9
v_mul_u32_u24 v9,64,v9
v_and_b32 v10,1,v0
v_lshl_add_u32 v9,v10,3,v9
v_bfe_u32 v10,v0,1,1
v_lshl_add_u32 v9,v10,5,v9
v_bfe_u32 v10,v0,4,1
v_lshl_add_u32 v9,v10,4,v9
v_add_u32 v7,s63,v9
ds_read_b64_tr_b16 a[80:81],v7 offset:20480
ds_read_b64_tr_b16 a[82:83],v7 offset:21504
ds_read_b64_tr_b16 a[84:85],v7 offset:20992
ds_read_b64_tr_b16 a[86:87],v7 offset:22016
ds_read_b64_tr_b16 a[88:89],v7 offset:22528
ds_read_b64_tr_b16 a[90:91],v7 offset:23552
ds_read_b64_tr_b16 a[92:93],v7 offset:23040
ds_read_b64_tr_b16 a[94:95],v7 offset:24064
ds_read_b64_tr_b16 a[96:97],v7 offset:24576
ds_read_b64_tr_b16 a[98:99],v7 offset:25600
ds_read_b64_tr_b16 a[100:101],v7 offset:25088
ds_read_b64_tr_b16 a[102:103],v7 offset:26112
s_waitcnt lgkmcnt(4)
ds_read_b64_tr_b16 a[104:105],v7 offset:26624
ds_read_b64_tr_b16 a[106:107],v7 offset:27648
ds_read_b64_tr_b16 a[108:109],v7 offset:27136
ds_read_b64_tr_b16 a[110:111],v7 offset:28160
ds_read_b64_tr_b16 a[112:113],v7 offset:28672
ds_read_b64_tr_b16 a[114:115],v7 offset:29696
ds_read_b64_tr_b16 a[116:117],v7 offset:29184
ds_read_b64_tr_b16 a[118:119],v7 offset:30208
ds_read_b64_tr_b16 a[120:121],v7 offset:30720
ds_read_b64_tr_b16 a[122:123],v7 offset:31744
ds_read_b64_tr_b16 a[124:125],v7 offset:31232
ds_read_b64_tr_b16 a[126:127],v7 offset:32256
s_waitcnt lgkmcnt(4)
ds_read_b64_tr_b16 a[128:129],v7 offset:32768
ds_read_b64_tr_b16 a[130:131],v7 offset:33792
ds_read_b64_tr_b16 a[132:133],v7 offset:33280
ds_read_b64_tr_b16 a[134:135],v7 offset:34304
ds_read_b64_tr_b16 a[136:137],v7 offset:34816
ds_read_b64_tr_b16 a[138:139],v7 offset:35840
ds_read_b64_tr_b16 a[140:141],v7 offset:35328
ds_read_b64_tr_b16 a[142:143],v7 offset:36352
ds_read_b64_tr_b16 a[144:145],v7 offset:36864
ds_read_b64_tr_b16 a[146:147],v7 offset:37888
ds_read_b64_tr_b16 a[148:149],v7 offset:37376
ds_read_b64_tr_b16 a[150:151],v7 offset:38400
s_waitcnt lgkmcnt(4)
ds_read_b64_tr_b16 a[152:153],v7 offset:38912
ds_read_b64_tr_b16 a[154:155],v7 offset:39936
ds_read_b64_tr_b16 a[156:157],v7 offset:39424
ds_read_b64_tr_b16 a[158:159],v7 offset:40448
s_waitcnt lgkmcnt(0)
s_waitcnt vmcnt(0)
v_bfe_u32 v9,v0,2,2
v_lshrrev_b32 v10,5,v0
v_lshl_add_u32 v9,v10,2,v9
v_mul_u32_u24 v9,64,v9
v_and_b32 v10,1,v0
v_lshl_add_u32 v9,v10,3,v9
v_bfe_u32 v10,v0,1,1
v_lshl_add_u32 v9,v10,5,v9
v_bfe_u32 v10,v0,4,1
v_lshl_add_u32 v9,v10,4,v9
v_add_u32 v7,s63,v9
ds_read_b64_tr_b16 a[160:161],v7 offset:0
ds_read_b64_tr_b16 a[162:163],v7 offset:1024
ds_read_b64_tr_b16 a[164:165],v7 offset:512
ds_read_b64_tr_b16 a[166:167],v7 offset:1536
ds_read_b64_tr_b16 a[168:169],v7 offset:2048
ds_read_b64_tr_b16 a[170:171],v7 offset:3072
ds_read_b64_tr_b16 a[172:173],v7 offset:2560
ds_read_b64_tr_b16 a[174:175],v7 offset:3584
ds_read_b64_tr_b16 a[176:177],v7 offset:4096
ds_read_b64_tr_b16 a[178:179],v7 offset:5120
ds_read_b64_tr_b16 a[180:181],v7 offset:4608
ds_read_b64_tr_b16 a[182:183],v7 offset:5632
s_waitcnt lgkmcnt(4)
ds_read_b64_tr_b16 a[184:185],v7 offset:6144
ds_read_b64_tr_b16 a[186:187],v7 offset:7168
ds_read_b64_tr_b16 a[188:189],v7 offset:6656
ds_read_b64_tr_b16 a[190:191],v7 offset:7680
s_waitcnt lgkmcnt(0)
s_barrier
s_mov_b32 s50,0
s_mov_b32 s32,0
s_mov_b32 s57,0
s_mov_b32 s59,2147483648
s_mov_b32 s82,2147483648
s_mov_b32 s39,2147483648
v_mov_b32 v22,100352
v_lshl_add_u32 v22,v0,2,v22
v_mov_b32 v23,0
ds_write_b32 v22,v23
s_mov_b32 s39,1600000
v_and_b32 v72,15,v0
v_lshlrev_b32 v72,7,v72
s_mov_b64 s[76:77],-1
s_mov_b64 s[80:81],-1
s_waitcnt lgkmcnt(0)
s_barrier
s_mov_b32 s83,s100
s_min_u32 s62,s32,127
s_sub_u32 s60,s62,14
s_lshr_b32 s34,s60,1
s_and_b32 s33,s60,1
s_cmp_eq_u32 s33,0
s_cselect_b32 s61,14,0
s_add_u32 s34,s34,s61
s_sub_u32 s61,s60,50
s_cmp_ge_u32 s60,100
s_cselect_b32 s34,s61,s34
s_cselect_b32 s33,1,s33
s_cmp_lt_u32 s62,14
s_cselect_b32 s34,s62,s34
s_cselect_b32 s33,0,s33
s_lshl_b32 s35,s33,6
s_add_u32 s35,s35,s34
s_lshl_b32 s35,s35,9
s_add_u32 s35,s35,262144
s_sub_u32 s57,49152,s57
v_swap_b32 v16,v18
v_swap_b32 v17,v19
s_add_u32 s62,s32,1
s_min_u32 s62,s62,127
s_sub_u32 s60,s62,14
s_lshr_b32 s41,s60,1
s_and_b32 s40,s60,1
s_cmp_eq_u32 s40,0
s_cselect_b32 s61,14,0
s_add_u32 s41,s41,s61
s_sub_u32 s61,s60,50
s_cmp_ge_u32 s60,100
s_cselect_b32 s41,s61,s41
s_cselect_b32 s40,1,s40
s_cmp_lt_u32 s62,14
s_cselect_b32 s41,s62,s41
s_cselect_b32 s40,0,s40
s_lshl_b32 s42,s40,6
s_add_u32 s42,s42,s41
s_lshl_b32 s42,s42,9
s_add_u32 s42,s42,262144
WO_COLD:
s_mov_b32 s37,0
fb_239:
buffer_load_dword v3,v2,s[8:11],s35 offen sc1
s_waitcnt vmcnt(0)
v_cmp_eq_u32 vcc,0,v3
s_and_b64 vcc,vcc,s[76:77]
s_cbranch_scc0 ok_240
s_sleep 1
s_sub_u32 s47,s47,1
s_cbranch_scc1 ABORT
s_branch fb_239
ok_240:
WO_COLD2:
s_sub_u32 s66,49152,s57
s_and_b32 s60,s34,3
s_lshl2_add_u32 s60,s33,s60
s_mul_i32 s60,s60,393216
s_add_u32 s60,s60,s37
s_mul_i32 s61,s68,49152
s_add_u32 s60,s60,s61
s_mul_i32 s61,s46,12288
s_add_u32 s60,s60,s61
s_add_u32 s60,s60,149946368
s_add_u32 s61,s61,s66
s_add_u32 m0,s61,0
s_add_u32 s63,s60,0
buffer_load_dwordx4 v1,s[8:11],s63 offen sc1 lds
buffer_load_dwordx4 v1,s[8:11],s63 offen offset:1024 sc1 lds
buffer_load_dwordx4 v1,s[8:11],s63 offen offset:2048 sc1 lds
buffer_load_dwordx4 v1,s[8:11],s63 offen offset:3072 sc1 lds
s_add_u32 m0,s61,4096
s_add_u32 s63,s60,4096
buffer_load_dwordx4 v1,s[8:11],s63 offen sc1 lds
buffer_load_dwordx4 v1,s[8:11],s63 offen offset:1024 sc1 lds
buffer_load_dwordx4 v1,s[8:11],s63 offen offset:2048 sc1 lds
buffer_load_dwordx4 v1,s[8:11],s63 offen offset:3072 sc1 lds
s_waitcnt vmcnt(7)
s_mov_b64 exec,1
buffer_store_dword v5,v1,s[8:11],s59 offen sc1
s_mov_b64 exec,-1
s_mov_b32 s59,2147483648
s_add_u32 m0,s61,8192
s_add_u32 s63,s60,8192
buffer_load_dwordx4 v1,s[8:11],s63 offen sc1 lds
buffer_load_dwordx4 v1,s[8:11],s63 offen offset:1024 sc1 lds
buffer_load_dwordx4 v1,s[8:11],s63 offen offset:2048 sc1 lds
buffer_load_dwordx4 v1,s[8:11],s63 offen offset:3072 sc1 lds
s_mov_b32 s35,s42
buffer_load_dword v3,v2,s[8:11],s35 offen sc1
s_mov_b32 s53,s33
s_mov_b32 s54,s34
s_add_u32 s32,s32,1
s_mov_b32 s33,s40
s_mov_b32 s34,s41
s_mov_b64 s[76:77],s[80:81]
s_sub_u32 s57,49152,s57
v_swap_b32 v16,v18
v_swap_b32 v17,v19
s_mov_b32 s51,s53
s_mov_b32 s52,s54
s_mov_b32 s37,2147483648
s_waitcnt vmcnt(6)
s_branch WO_GO
WO_NEXT:
s_sub_u32 s57,49152,s57
v_swap_b32 v16,v18
v_swap_b32 v17,v19
s_mov_b32 s51,s53
s_mov_b32 s52,s54
s_waitcnt vmcnt(2)
v_cmp_eq_u32 vcc,0,v3
s_and_b64 vcc,vcc,s[76:77]
s_cselect_b32 s37,2147483648,0
s_cmp_lt_u32 s32,128
s_cselect_b32 s37,s37,2147483648
WO_GO:
s_barrier
ds_read_b128 v[24:27],v16 offset:0
ds_read_b128 v[28:31],v17 offset:0
ds_read_b128 v[32:35],v16 offset:12288
ds_read_b128 v[36:39],v17 offset:12288
ds_read_b128 v[40:43],v16 offset:24576
ds_read_b128 v[44:47],v17 offset:24576
ds_read_b128 v[48:51],v16 offset:36864
s_waitcnt lgkmcnt(6)
v_mfma_f32_32x32x16_bf16 v[56:71],a[0:3],v[24:27],0
ds_read_b128 v[52:55],v17 offset:36864
s_sub_u32 s66,49152,s57
s_and_b32 s60,s34,3
s_lshl2_add_u32 s60,s33,s60
s_waitcnt lgkmcnt(6)
v_mfma_f32_32x32x16_bf16 v[56:71],a[4:7],v[28:31],v[56:71]
ds_read_b128 v[24:27],v16 offset:2048
s_mul_i32 s60,s60,393216
s_add_u32 s60,s60,s37
s_mul_i32 s61,s68,49152
s_waitcnt lgkmcnt(5)
v_mfma_f32_32x32x16_bf16 v[56:71],a[48:51],v[32:35],v[56:71]
ds_read_b128 v[28:31],v17 offset:2048
s_add_u32 s60,s60,s61
s_mul_i32 s61,s46,12288
s_add_u32 s60,s60,s61
s_add_u32 s60,s60,149946368
v_mfma_f32_32x32x16_bf16 v[56:71],a[52:55],v[36:39],v[56:71]
ds_read_b128 v[32:35],v16 offset:14336
s_add_u32 s61,s61,s66
s_add_u32 m0,s61,0
s_add_u32 s63,s60,0
s_waitcnt lgkmcnt(5)
v_mfma_f32_32x32x16_bf16 v[56:71],a[96:99],v[40:43],v[56:71]
ds_read_b128 v[36:39],v17 offset:14336
buffer_load_dwordx4 v1,s[8:11],s63 offen sc1 lds
s_mul_i32 s71,s52,491520
s_add_u32 s71,s71,s69
v_mfma_f32_32x32x16_bf16 v[56:71],a[100:103],v[44:47],v[56:71]
ds_read_b128 v[40:43],v16 offset:26624
s_lshl_b32 s70,s51,6
s_add_u32 s70,s70,s52
s_mul_i32 s70,s70,640
s_waitcnt lgkmcnt(5)
v_mfma_f32_32x32x16_bf16 v[56:71],a[144:147],v[48:51],v[56:71]
ds_read_b128 v[44:47],v17 offset:26624
buffer_load_dwordx4 v1,s[8:11],s63 offen offset:1024 sc1 lds
s_add_u32 s82,s70,s75
v_mfma_f32_32x32x16_bf16 v[56:71],a[148:151],v[52:55],v[56:71]
ds_read_b128 v[48:51],v16 offset:38912
s_waitcnt lgkmcnt(5)
v_mfma_f32_32x32x16_bf16 v[56:71],a[8:11],v[24:27],v[56:71]
ds_read_b128 v[52:55],v17 offset:38912
buffer_load_dwordx4 v1,s[8:11],s63 offen offset:2048 sc1 lds
v_mfma_f32_32x32x16_bf16 v[56:71],a[12:15],v[28:31],v[56:71]
ds_read_b128 v[24:27],v16 offset:4096
s_waitcnt lgkmcnt(5)
v_mfma_f32_32x32x16_bf16 v[56:71],a[56:59],v[32:35],v[56:71]
ds_read_b128 v[28:31],v17 offset:4096
buffer_load_dwordx4 v1,s[8:11],s63 offen offset:3072 sc1 lds
s_add_u32 m0,s61,4096
s_add_u32 s63,s60,4096
v_mfma_f32_32x32x16_bf16 v[56:71],a[60:63],v[36:39],v[56:71]
ds_read_b128 v[32:35],v16 offset:16384
s_waitcnt lgkmcnt(5)
v_mfma_f32_32x32x16_bf16 v[56:71],a[104:107],v[40:43],v[56:71]
ds_read_b128 v[36:39],v17 offset:16384
buffer_load_dwordx4 v1,s[8:11],s63 offen sc1 lds
v_mfma_f32_32x32x16_bf16 v[56:71],a[108:111],v[44:47],v[56:71]
ds_read_b128 v[40:43],v16 offset:28672
s_waitcnt lgkmcnt(5)
v_mfma_f32_32x32x16_bf16 v[56:71],a[152:155],v[48:51],v[56:71]
ds_read_b128 v[44:47],v17 offset:28672
buffer_load_dwordx4 v1,s[8:11],s63 offen offset:1024 sc1 lds
v_mfma_f32_32x32x16_bf16 v[56:71],a[156:159],v[52:55],v[56:71]
ds_read_b128 v[48:51],v16 offset:40960
s_waitcnt lgkmcnt(5)
v_mfma_f32_32x32x16_bf16 v[56:71],a[16:19],v[24:27],v[56:71]
ds_read_b128 v[52:55],v17 offset:40960
buffer_load_dwordx4 v1,s[8:11],s63 offen offset:2048 sc1 lds
v_mfma_f32_32x32x16_bf16 v[56:71],a[20:23],v[28:31],v[56:71]
ds_read_b128 v[24:27],v16 offset:6144
s_waitcnt lgkmcnt(5)
v_mfma_f32_32x32x16_bf16 v[56:71],a[64:67],v[32:35],v[56:71]
ds_read_b128 v[28:31],v17 offset:6144
buffer_load_dwordx4 v1,s[8:11],s63 offen offset:3072 sc1 lds
s_add_u32 m0,s61,8192
s_add_u32 s63,s60,8192
v_mfma_f32_32x32x16_bf16 v[56:71],a[68:71],v[36:39],v[56:71]
ds_read_b128 v[32:35],v16 offset:18432
s_waitcnt lgkmcnt(5)
v_mfma_f32_32x32x16_bf16 v[56:71],a[112:115],v[40:43],v[56:71]
ds_read_b128 v[36:39],v17 offset:18432
buffer_load_dwordx4 v1,s[8:11],s63 offen sc1 lds
v_mfma_f32_32x32x16_bf16 v[56:71],a[116:119],v[44:47],v[56:71]
ds_read_b128 v[40:43],v16 offset:30720
s_waitcnt lgkmcnt(5)
v_mfma_f32_32x32x16_bf16 v[56:71],a[160:163],v[48:51],v[56:71]
ds_read_b128 v[44:47],v17 offset:30720
buffer_load_dwordx4 v1,s[8:11],s63 offen offset:1024 sc1 lds
v_mfma_f32_32x32x16_bf16 v[56:71],a[164:167],v[52:55],v[56:71]
ds_read_b128 v[48:51],v16 offset:43008
s_waitcnt lgkmcnt(5)
v_mfma_f32_32x32x16_bf16 v[56:71],a[24:27],v[24:27],v[56:71]
ds_read_b128 v[52:55],v17 offset:43008
s_waitcnt vmcnt(10)
s_mov_b64 exec,1
buffer_store_dword v5,v1,s[8:11],s59 offen sc1
s_mov_b64 exec,-1
s_mov_b32 s59,2147483648
s_barrier
v_mfma_f32_32x32x16_bf16 v[56:71],a[28:31],v[28:31],v[56:71]
ds_read_b128 v[24:27],v16 offset:8192
buffer_load_dwordx4 v1,s[8:11],s63 offen offset:2048 sc1 lds
s_waitcnt lgkmcnt(5)
v_mfma_f32_32x32x16_bf16 v[56:71],a[72:75],v[32:35],v[56:71]
ds_read_b128 v[28:31],v17 offset:8192
v_mfma_f32_32x32x16_bf16 v[56:71],a[76:79],v[36:39],v[56:71]
ds_read_b128 v[32:35],v16 offset:20480
s_lshl_b32 s64,s51,10
s_add_u32 s64,s64,s74
s_add_u32 s65,s52,1
v_mov_b32 v73,s65
s_mov_b64 exec,1
s_cmp_lg_u32 s49,0
s_cbranch_scc0 ls_241
buffer_store_dword v73,v1,s[8:11],s64 offen sc1
s_branch ls_242
ls_241:
buffer_store_dword v73,v1,s[8:11],s64 offen
ls_242:
s_mov_b64 exec,-1
s_waitcnt lgkmcnt(5)
v_mfma_f32_32x32x16_bf16 v[56:71],a[120:123],v[40:43],v[56:71]
ds_read_b128 v[36:39],v17 offset:20480
buffer_load_dwordx4 v1,s[8:11],s63 offen offset:3072 sc1 lds
s_add_u32 s62,s32,1
s_min_u32 s62,s62,127
v_mfma_f32_32x32x16_bf16 v[56:71],a[124:127],v[44:47],v[56:71]
ds_read_b128 v[40:43],v16 offset:32768
s_sub_u32 s60,s62,14
s_lshr_b32 s41,s60,1
s_and_b32 s40,s60,1
s_waitcnt lgkmcnt(5)
v_mfma_f32_32x32x16_bf16 v[56:71],a[168:171],v[48:51],v[56:71]
ds_read_b128 v[44:47],v17 offset:32768
s_cmp_eq_u32 s40,0
s_cselect_b32 s61,14,0
s_add_u32 s41,s41,s61
s_sub_u32 s61,s60,50
v_mfma_f32_32x32x16_bf16 v[56:71],a[172:175],v[52:55],v[56:71]
ds_read_b128 v[48:51],v16 offset:45056
s_cmp_ge_u32 s60,100
s_cselect_b32 s41,s61,s41
s_cselect_b32 s40,1,s40
s_waitcnt lgkmcnt(5)
v_mfma_f32_32x32x16_bf16 v[56:71],a[32:35],v[24:27],v[56:71]
ds_read_b128 v[52:55],v17 offset:45056
s_cmp_lt_u32 s62,14
s_cselect_b32 s41,s62,s41
s_cselect_b32 s40,0,s40
s_lshl_b32 s42,s40,6
v_mfma_f32_32x32x16_bf16 v[56:71],a[36:39],v[28:31],v[56:71]
ds_read_b128 v[24:27],v16 offset:10240
s_add_u32 s42,s42,s41
s_lshl_b32 s42,s42,9
s_add_u32 s42,s42,262144
s_waitcnt lgkmcnt(5)
v_mfma_f32_32x32x16_bf16 v[56:71],a[80:83],v[32:35],v[56:71]
ds_read_b128 v[28:31],v17 offset:10240
v_mfma_f32_32x32x16_bf16 v[56:71],a[84:87],v[36:39],v[56:71]
ds_read_b128 v[32:35],v16 offset:22528
s_waitcnt lgkmcnt(5)
v_mfma_f32_32x32x16_bf16 v[56:71],a[128:131],v[40:43],v[56:71]
ds_read_b128 v[36:39],v17 offset:22528
buffer_load_dword v3,v2,s[8:11],s35 offen sc1
v_mfma_f32_32x32x16_bf16 v[56:71],a[132:135],v[44:47],v[56:71]
ds_read_b128 v[40:43],v16 offset:34816
s_waitcnt lgkmcnt(5)
v_mfma_f32_32x32x16_bf16 v[56:71],a[176:179],v[48:51],v[56:71]
ds_read_b128 v[44:47],v17 offset:34816
v_mfma_f32_32x32x16_bf16 v[56:71],a[180:183],v[52:55],v[56:71]
ds_read_b128 v[48:51],v16 offset:47104
s_waitcnt lgkmcnt(5)
v_mfma_f32_32x32x16_bf16 v[56:71],a[40:43],v[24:27],v[56:71]
ds_read_b128 v[52:55],v17 offset:47104
v_mfma_f32_32x32x16_bf16 v[56:71],a[44:47],v[28:31],v[56:71]
s_waitcnt lgkmcnt(4)
v_mfma_f32_32x32x16_bf16 v[56:71],a[88:91],v[32:35],v[56:71]
v_mfma_f32_32x32x16_bf16 v[56:71],a[92:95],v[36:39],v[56:71]
s_waitcnt lgkmcnt(2)
v_mfma_f32_32x32x16_bf16 v[56:71],a[136:139],v[40:43],v[56:71]
v_mfma_f32_32x32x16_bf16 v[56:71],a[140:143],v[44:47],v[56:71]
s_waitcnt lgkmcnt(0)
v_mfma_f32_32x32x16_bf16 v[56:71],a[184:187],v[48:51],v[56:71]
v_mfma_f32_32x32x16_bf16 v[56:71],a[188:191],v[52:55],v[56:71]
s_cmp_eq_u32 s37,0
s_cbranch_scc0 sec_245
s_mov_b32 s35,s42
buffer_load_dword v3,v2,s[8:11],s35 offen sc1
s_mov_b32 s53,s33
s_mov_b32 s54,s34
s_add_u32 s32,s32,1
s_mov_b32 s33,s40
s_mov_b32 s34,s41
s_mov_b64 s[76:77],s[80:81]
s_nop 2
ep_243:
v_cvt_pk_bf16_f32 v112,v56,v57
v_cvt_pk_bf16_f32 v113,v58,v59
v_cvt_pk_bf16_f32 v114,v60,v61
v_cvt_pk_bf16_f32 v115,v62,v63
v_cvt_pk_bf16_f32 v116,v64,v65
v_cvt_pk_bf16_f32 v117,v66,v67
v_cvt_pk_bf16_f32 v118,v68,v69
v_cvt_pk_bf16_f32 v119,v70,v71
buffer_store_dwordx4 v[112:115],v20,s[8:11],s71 offen sc1
buffer_store_dwordx4 v[116:119],v20,s[8:11],s71 offen offset:128 sc1
s_mov_b32 s59,s82
s_cmp_eq_u32 s37,0
s_cbranch_scc1 WO_NEXT
s_waitcnt vmcnt(2)
v_cmp_eq_u32 vcc,0,v3
s_and_b64 vcc,vcc,s[76:77]
s_cselect_b32 s37,2147483648,0
s_cmp_lt_u32 s32,128
s_cselect_b32 s37,s37,2147483648
s_cmp_eq_u32 s37,0
s_cbranch_scc1 WO_COLD2
s_waitcnt vmcnt(0)
s_mov_b64 exec,1
buffer_store_dword v5,v1,s[8:11],s59 offen sc1
s_mov_b64 exec,-1
s_mov_b32 s59,2147483648
s_cmp_lt_u32 s32,128
s_cbranch_scc1 WO_COLD
s_branch WO_END
sec_245:
s_waitcnt vmcnt(0)
v_cmp_eq_u32 vcc,0,v3
s_and_b64 vcc,vcc,s[76:77]
s_cselect_b32 s37,2147483648,0
s_cmp_lt_u32 s32,128
s_cselect_b32 s37,s37,2147483648
s_cmp_lg_u32 s37,0
s_cbranch_scc1 nr_244
s_sub_u32 s66,49152,s57
s_and_b32 s60,s34,3
s_lshl2_add_u32 s60,s33,s60
s_mul_i32 s60,s60,393216
s_add_u32 s60,s60,s37
s_mul_i32 s61,s68,49152
s_add_u32 s60,s60,s61
s_mul_i32 s61,s46,12288
s_add_u32 s60,s60,s61
s_add_u32 s60,s60,149946368
s_add_u32 s61,s61,s66
s_add_u32 m0,s61,0
s_add_u32 s63,s60,0
buffer_load_dwordx4 v1,s[8:11],s63 offen sc1 lds
v_cvt_pk_bf16_f32 v112,v56,v57
buffer_load_dwordx4 v1,s[8:11],s63 offen offset:1024 sc1 lds
v_cvt_pk_bf16_f32 v113,v58,v59
buffer_load_dwordx4 v1,s[8:11],s63 offen offset:2048 sc1 lds
v_cvt_pk_bf16_f32 v114,v60,v61
buffer_load_dwordx4 v1,s[8:11],s63 offen offset:3072 sc1 lds
v_cvt_pk_bf16_f32 v115,v62,v63
s_add_u32 m0,s61,4096
s_add_u32 s63,s60,4096
buffer_load_dwordx4 v1,s[8:11],s63 offen sc1 lds
v_cvt_pk_bf16_f32 v116,v64,v65
buffer_load_dwordx4 v1,s[8:11],s63 offen offset:1024 sc1 lds
v_cvt_pk_bf16_f32 v117,v66,v67
buffer_load_dwordx4 v1,s[8:11],s63 offen offset:2048 sc1 lds
v_cvt_pk_bf16_f32 v118,v68,v69
buffer_load_dwordx4 v1,s[8:11],s63 offen offset:3072 sc1 lds
v_cvt_pk_bf16_f32 v119,v70,v71
s_add_u32 m0,s61,8192
s_add_u32 s63,s60,8192
buffer_load_dwordx4 v1,s[8:11],s63 offen sc1 lds
buffer_load_dwordx4 v1,s[8:11],s63 offen offset:1024 sc1 lds
buffer_load_dwordx4 v1,s[8:11],s63 offen offset:2048 sc1 lds
buffer_load_dwordx4 v1,s[8:11],s63 offen offset:3072 sc1 lds
s_mov_b32 s35,s42
buffer_load_dword v3,v2,s[8:11],s35 offen sc1
s_mov_b32 s53,s33
s_mov_b32 s54,s34
s_add_u32 s32,s32,1
s_mov_b32 s33,s40
s_mov_b32 s34,s41
s_mov_b64 s[76:77],s[80:81]
buffer_store_dwordx4 v[112:115],v20,s[8:11],s71 offen sc1
buffer_store_dwordx4 v[116:119],v20,s[8:11],s71 offen offset:128 sc1
s_mov_b32 s59,s82
s_branch WO_NEXT
nr_244:
buffer_load_dword v3,v2,s[8:11],s35 offen sc1
s_branch ep_243
WO_END:
s_endpgm
ROLE_R1:
s_lshr_b32 s68,s48,3
s_and_b32 s48,s48,7
v_lshlrev_b32 v1,4,v0
v_mov_b32 v5,1
s_lshl_b32 s56,s48,2
s_add_u32 s56,s56,s46
v_bfe_u32 v6,v0,2,2
v_lshrrev_b32 v7,4,v0
v_add_u32 v7,v6,v7
v_and_b32 v7,3,v7
v_and_b32 v15,3,v0
v_lshlrev_b32 v15,4,v15
v_lshl_add_u32 v15,v7,6,v15
v_lshl_add_u32 v15,v6,8,v15
v_lshrrev_b32 v6,4,v0
v_bfe_u32 v7,v0,2,2
v_and_b32 v8,3,v0
v_add_u32 v9,s48,v7
v_and_b32 v9,3,v9
v_lshlrev_b32 v17,6,v9
v_lshl_add_u32 v17,v8,4,v17
s_lshl_b32 s60,s48,8
s_lshl_b32 s61,s46,13
s_add_u32 s61,s61,s60
v_lshl_add_u32 v16,v6,11,v17
v_add_u32 v16,s61,v16
s_lshl_b32 s61,s46,11
s_add_u32 s61,s61,s60
s_add_u32 s61,s61,32768
v_add_u32 v17,s61,v17
v_lshl_add_u32 v18,v6,2,v17
v_mul_u32_u24 v19,40960,v6
v_and_b32 v9,0xff,v1
v_add_u32 v19,v19,v9
s_mul_i32 s60,s46,768
s_sub_u32 s60,4096,s60
v_add_u32 v19,s60,v19
s_mul_i32 s69,s48,5120
s_lshl_b32 s60,s46,10
s_add_u32 s69,s69,s60
s_add_u32 s69,s69,175112192
s_cmp_eq_u32 s68,0
s_mov_b32 s70,209518592
s_cselect_b32 s70,234749952,s70
s_mov_b32 s71,46080
s_cselect_b32 s71,40960,s71
s_mov_b32 s72,0x3f80
s_mov_b32 s73,0x3f800000
v_lshlrev_b32 v21,5,v8
s_lshl_b32 s60,s46,3
v_add_u32 v20,s60,v21
v_min_u32 v2,39,v0
v_lshlrev_b32 v2,4,v2
s_waitcnt vmcnt(0)
s_barrier
s_cmp_lg_u32 s46,0
s_cbranch_scc1 arr_246
v_mov_b32 v6,1
s_lshl_b32 s3,s49,2
v_mov_b32 v7,s3
s_mov_b64 exec,1
buffer_atomic_add v6,v7,s[12:15],0 offen sc1
s_mov_b64 exec,-1
arr_246:
s_cmp_lg_u32 s49,0
s_cbranch_scc1 vr_247
s_mov_b64 exec,1
s_lshl_b32 s60,s68,5
s_add_u32 s60,s60,s56
s_and_b32 s61,s60,7
s_lshl_b32 s61,s61,14
s_lshl_b32 s60,s60,7
s_add_u32 s60,s60,s61
s_add_u32 s60,s60,11796480
s_add_u32 s61,s60,0x2000
s_mov_b32 s62,-1
s_mov_b32 s63,-1
s_mov_b32 s50,6
vr_247l:
buffer_store_dword v5,v1,s[8:11],s60 offen sc1
buffer_store_dword v5,v1,s[8:11],s61 offen sc1
s_waitcnt vmcnt(0)
s_memtime s[64:65]
s_waitcnt lgkmcnt(0)
buffer_load_dword v3,v1,s[8:11],s60 offen sc1
s_waitcnt vmcnt(0)
s_memtime s[66:67]
s_waitcnt lgkmcnt(0)
s_sub_u32 s66,s66,s64
s_min_u32 s62,s62,s66
s_memtime s[64:65]
s_waitcnt lgkmcnt(0)
buffer_load_dword v3,v1,s[8:11],s61 offen sc1
s_waitcnt vmcnt(0)
s_memtime s[66:67]
s_waitcnt lgkmcnt(0)
s_sub_u32 s66,s66,s64
s_min_u32 s63,s63,s66
s_sub_u32 s50,s50,1
s_cmp_lg_u32 s50,0
s_cbranch_scc1 vr_247l
s_cmp_lt_u32 s63,s62
s_cselect_b32 s60,0x10001,1
v_mov_b32 v3,s60
v_mov_b32 v6,192
buffer_atomic_add v3,v6,s[12:15],0 offen sc1
s_mov_b64 exec,-1
vr_247:
s_lshl_b32 s3,s49,2
v_mov_b32 v7,s3
s_nop 1
ibw_248:
buffer_load_dword v6,v7,s[12:15],0 offen sc1
s_waitcnt vmcnt(0)
v_cmp_ne_u32 vcc,256,v6
s_nop 0
s_cbranch_vccz ok_249
s_sleep 8
s_sub_u32 s47,s47,1
s_cbranch_scc1 ABORT
s_branch ibw_248
ok_249:
s_cmp_lg_u32 s49,0
s_cbranch_scc1 ibok_250
v_and_b32 v7,7,v0
v_lshlrev_b32 v7,2,v7
buffer_load_dword v6,v7,s[12:15],0 offen offset:32 sc1
s_waitcnt vmcnt(0)
v_cmp_ne_u32 vcc,32,v6
s_nop 0
s_cbranch_vccz ibok_250
s_barrier
s_mov_b32 s49,1
s_mov_b32 s3,s2
s_load_dwordx16 s[16:31],s[0:1],0
s_load_dwordx8 s[32:39],s[0:1],64
s_waitcnt lgkmcnt(0)
s_branch DISPATCH
ibok_250:
s_mov_b32 s83,s100
s_mov_b32 s51,s68
s_mov_b32 s52,0
s_mul_i32 s35,s68,40960
s_add_u32 s35,s35,819200
R1_LOOP:
s_mul_i32 s66,s52,491520
s_add_u32 s66,s66,s69
s_mul_i32 s65,s52,s71
s_add_u32 s65,s65,s70
s_lshl_b32 s60,s51,6
s_add_u32 s60,s60,s52
s_mul_i32 s74,s60,40960
s_add_u32 s74,s74,218365952
s_mul_i32 s75,s60,46080
s_add_u32 s75,s75,223608832
s_lshl_b32 s82,s51,6
s_add_u32 s82,s82,s52
s_lshl_b32 s82,s82,9
s_add_u32 s82,s82,393216
s_lshl_b32 s61,s56,2
s_add_u32 s82,s82,s61
s_cmp_lg_u32 s46,0
s_cbranch_scc1 rp_251
rt_252:
buffer_load_dwordx4 v[24:27],v2,s[8:11],s35 offen sc1
s_waitcnt vmcnt(0)
v_min3_u32 v24,v24,v25,v26
v_min_u32 v24,v24,v27
v_cmp_eq_u32 vcc,0,v24
s_nop 0
s_cbranch_vccz ok_253
s_sleep 3
s_sub_u32 s47,s47,1
s_cbranch_scc1 ABORT
s_branch rt_252
ok_253:
rp_251:
s_barrier
s_add_u32 s63,s66,0
buffer_load_dwordx4 v[68:71],v19,s[8:11],s63 offen sc1
s_add_u32 s63,s66,163840
buffer_load_dwordx4 v[72:75],v19,s[8:11],s63 offen sc1
buffer_load_dwordx4 v[76:79],v16,s[8:11],s65 offen sc1
buffer_load_dword v80,v18,s[8:11],s65 offen sc1
s_add_u32 s63,s66,0
buffer_load_dwordx4 v[36:39],v1,s[8:11],s63 offen sc1
s_add_u32 s63,s66,40960
buffer_load_dwordx4 v[40:43],v1,s[8:11],s63 offen sc1
s_add_u32 s63,s66,81920
buffer_load_dwordx4 v[44:47],v1,s[8:11],s63 offen sc1
s_add_u32 s63,s66,122880
buffer_load_dwordx4 v[48:51],v1,s[8:11],s63 offen sc1
s_add_u32 s63,s66,163840
buffer_load_dwordx4 v[52:55],v1,s[8:11],s63 offen sc1
s_add_u32 s63,s66,204800
buffer_load_dwordx4 v[56:59],v1,s[8:11],s63 offen sc1
s_add_u32 s63,s66,245760
buffer_load_dwordx4 v[60:63],v1,s[8:11],s63 offen sc1
s_add_u32 s63,s66,286720
buffer_load_dwordx4 v[64:67],v1,s[8:11],s63 offen sc1
s_waitcnt vmcnt(11)
v_lshlrev_b32 v92,16,v68
v_and_b32 v93,0xffff0000,v68
v_lshlrev_b32 v94,16,v69
v_and_b32 v95,0xffff0000,v69
v_lshlrev_b32 v96,16,v70
v_and_b32 v97,0xffff0000,v70
v_lshlrev_b32 v98,16,v71
v_and_b32 v99,0xffff0000,v71
s_waitcnt vmcnt(10)
v_dot2c_f32_bf16 v92,s72,v72
v_dot2c_f32_bf16 v93,s73,v72
v_dot2c_f32_bf16 v94,s72,v73
v_dot2c_f32_bf16 v95,s73,v73
v_dot2c_f32_bf16 v96,s72,v74
v_dot2c_f32_bf16 v97,s73,v74
v_dot2c_f32_bf16 v98,s72,v75
v_dot2c_f32_bf16 v99,s73,v75
v_permlane32_swap_b32 v92,v96
v_permlane32_swap_b32 v93,v97
v_permlane32_swap_b32 v94,v98
v_permlane32_swap_b32 v95,v99
v_add_f32 v92,v92,v96
v_add_f32 v93,v93,v97
v_add_f32 v94,v94,v98
v_add_f32 v95,v95,v99
s_nop 0
v_permlane16_swap_b32 v92,v94
v_permlane16_swap_b32 v93,v95
v_add_f32 v90,v92,v94
v_add_f32 v91,v93,v95
s_waitcnt vmcnt(8)
v_lshlrev_b32 v100,16,v76
v_and_b32 v101,0xffff0000,v76
v_lshlrev_b32 v102,16,v77
v_and_b32 v103,0xffff0000,v77
v_lshlrev_b32 v104,16,v78
v_and_b32 v105,0xffff0000,v78
v_lshlrev_b32 v106,16,v79
v_and_b32 v107,0xffff0000,v79
v_lshlrev_b32 v108,16,v80
v_and_b32 v109,0xffff0000,v80
s_waitcnt vmcnt(7)
v_lshlrev_b32 v82,16,v36
v_and_b32 v83,0xffff0000,v36
v_lshlrev_b32 v84,16,v37
v_and_b32 v85,0xffff0000,v37
v_lshlrev_b32 v86,16,v38
v_and_b32 v87,0xffff0000,v38
v_lshlrev_b32 v88,16,v39
v_and_b32 v89,0xffff0000,v39
s_waitcnt vmcnt(6)
v_dot2c_f32_bf16 v82,s72,v40
v_dot2c_f32_bf16 v83,s73,v40
v_dot2c_f32_bf16 v84,s72,v41
v_dot2c_f32_bf16 v85,s73,v41
v_dot2c_f32_bf16 v86,s72,v42
v_dot2c_f32_bf16 v87,s73,v42
v_dot2c_f32_bf16 v88,s72,v43
v_dot2c_f32_bf16 v89,s73,v43
s_waitcnt vmcnt(5)
v_dot2c_f32_bf16 v82,s72,v44
v_dot2c_f32_bf16 v83,s73,v44
v_dot2c_f32_bf16 v84,s72,v45
v_dot2c_f32_bf16 v85,s73,v45
v_dot2c_f32_bf16 v86,s72,v46
v_dot2c_f32_bf16 v87,s73,v46
v_dot2c_f32_bf16 v88,s72,v47
v_dot2c_f32_bf16 v89,s73,v47
s_waitcnt vmcnt(4)
v_dot2c_f32_bf16 v82,s72,v48
v_dot2c_f32_bf16 v83,s73,v48
v_dot2c_f32_bf16 v84,s72,v49
v_dot2c_f32_bf16 v85,s73,v49
v_dot2c_f32_bf16 v86,s72,v50
v_dot2c_f32_bf16 v87,s73,v50
v_dot2c_f32_bf16 v88,s72,v51
v_dot2c_f32_bf16 v89,s73,v51
s_waitcnt vmcnt(3)
v_dot2c_f32_bf16 v82,s72,v52
v_dot2c_f32_bf16 v83,s73,v52
v_dot2c_f32_bf16 v84,s72,v53
v_dot2c_f32_bf16 v85,s73,v53
v_dot2c_f32_bf16 v86,s72,v54
v_dot2c_f32_bf16 v87,s73,v54
v_dot2c_f32_bf16 v88,s72,v55
v_dot2c_f32_bf16 v89,s73,v55
s_waitcnt vmcnt(2)
v_dot2c_f32_bf16 v82,s72,v56
v_dot2c_f32_bf16 v83,s73,v56
v_dot2c_f32_bf16 v84,s72,v57
v_dot2c_f32_bf16 v85,s73,v57
v_dot2c_f32_bf16 v86,s72,v58
v_dot2c_f32_bf16 v87,s73,v58
v_dot2c_f32_bf16 v88,s72,v59
v_dot2c_f32_bf16 v89,s73,v59
s_waitcnt vmcnt(1)
v_dot2c_f32_bf16 v82,s72,v60
v_dot2c_f32_bf16 v83,s73,v60
v_dot2c_f32_bf16 v84,s72,v61
v_dot2c_f32_bf16 v85,s73,v61
v_dot2c_f32_bf16 v86,s72,v62
v_dot2c_f32_bf16 v87,s73,v62
v_dot2c_f32_bf16 v88,s72,v63
v_dot2c_f32_bf16 v89,s73,v63
s_waitcnt vmcnt(0)
v_dot2c_f32_bf16 v82,s72,v64
v_dot2c_f32_bf16 v83,s73,v64
v_dot2c_f32_bf16 v84,s72,v65
v_dot2c_f32_bf16 v85,s73,v65
v_dot2c_f32_bf16 v86,s72,v66
v_dot2c_f32_bf16 v87,s73,v66
v_dot2c_f32_bf16 v88,s72,v67
v_dot2c_f32_bf16 v89,s73,v67
v_cvt_pk_bf16_f32 v6,v82,v83
v_lshlrev_b32 v82,16,v6
v_and_b32 v83,0xffff0000,v6
v_cvt_pk_bf16_f32 v8,v84,v85
v_lshlrev_b32 v84,16,v8
v_and_b32 v85,0xffff0000,v8
v_cvt_pk_bf16_f32 v6,v86,v87
v_lshlrev_b32 v86,16,v6
v_and_b32 v87,0xffff0000,v6
v_cvt_pk_bf16_f32 v8,v88,v89
v_lshlrev_b32 v88,16,v8
v_and_b32 v89,0xffff0000,v8
v_cvt_pk_bf16_f32 v6,v90,v91
v_lshlrev_b32 v90,16,v6
v_and_b32 v91,0xffff0000,v6
v_pk_add_f32 v[82:83],v[82:83],v[100:101]
v_pk_add_f32 v[84:85],v[84:85],v[102:103]
v_pk_add_f32 v[86:87],v[86:87],v[104:105]
v_pk_add_f32 v[88:89],v[88:89],v[106:107]
v_pk_add_f32 v[90:91],v[90:91],v[108:109]
v_cvt_pk_bf16_f32 v112,v82,v83
v_lshlrev_b32 v82,16,v112
v_and_b32 v83,0xffff0000,v112
v_cvt_pk_bf16_f32 v113,v84,v85
v_lshlrev_b32 v84,16,v113
v_and_b32 v85,0xffff0000,v113
v_cvt_pk_bf16_f32 v114,v86,v87
v_lshlrev_b32 v86,16,v114
v_and_b32 v87,0xffff0000,v114
v_cvt_pk_bf16_f32 v115,v88,v89
v_lshlrev_b32 v88,16,v115
v_and_b32 v89,0xffff0000,v115
v_cvt_pk_bf16_f32 v116,v90,v91
v_lshlrev_b32 v90,16,v116
v_and_b32 v91,0xffff0000,v116
v_pk_add_f32 v[32:33],v[82:83],v[84:85]
v_pk_mul_f32 v[30:31],v[82:83],v[82:83]
v_pk_fma_f32 v[30:31],v[84:85],v[84:85],v[30:31]
v_pk_add_f32 v[32:33],v[32:33],v[86:87]
v_pk_fma_f32 v[30:31],v[86:87],v[86:87],v[30:31]
v_pk_add_f32 v[32:33],v[32:33],v[88:89]
v_pk_fma_f32 v[30:31],v[88:89],v[88:89],v[30:31]
v_pk_add_f32 v[32:33],v[32:33],v[90:91]
v_pk_fma_f32 v[30:31],v[90:91],v[90:91],v[30:31]
v_add_f32 v28,v32,v33
v_add_f32 v29,v30,v31
s_nop 0
v_add_f32_dpp v28,v28,v28 row_ror:4 row_mask:0xf bank_mask:0xf
v_add_f32_dpp v29,v29,v29 row_ror:4 row_mask:0xf bank_mask:0xf
s_nop 0
v_add_f32_dpp v28,v28,v28 row_ror:8 row_mask:0xf bank_mask:0xf
v_add_f32_dpp v29,v29,v29 row_ror:8 row_mask:0xf bank_mask:0xf
v_mov_b32 v30,v28
v_mov_b32 v31,v29
s_nop 0
v_permlane32_swap_b32 v28,v30
v_permlane32_swap_b32 v29,v31
v_add_f32 v28,v28,v30
v_add_f32 v29,v29,v31
v_mov_b32 v30,v28
v_mov_b32 v31,v29
s_nop 0
v_permlane16_swap_b32 v28,v30
v_permlane16_swap_b32 v29,v31
v_add_f32 v28,v28,v30
v_add_f32 v29,v29,v31
ds_write_b64 v20,v[28:29]
s_waitcnt lgkmcnt(0)
s_barrier
ds_read_b128 v[136:139],v21
ds_read_b128 v[140:143],v21 offset:16
buffer_store_dwordx4 v[112:115],v16,s[8:11],s74 offen sc1
v_mov_b32 v117,v116
s_nop 1
v_permlane16_swap_b32 v116,v117
s_nop 1
v_permlane32_swap_b32 v116,v118
v_permlane32_swap_b32 v117,v119
s_mov_b64 exec,0xffff
buffer_store_dwordx4 v[116:119],v17,s[8:11],s74 offen sc1
s_mov_b64 exec,-1
s_waitcnt lgkmcnt(0)
v_pk_add_f32 v[136:137],v[136:137],v[138:139]
v_pk_add_f32 v[140:141],v[140:141],v[142:143]
v_pk_add_f32 v[28:29],v[136:137],v[140:141]
v_mul_f32 v28,0x3acccccd,v28
v_mul_f32 v29,0x3acccccd,v29
v_fma_f32 v29,-v28,v28,v29
v_max_f32 v29,0,v29
v_mov_b32 v32,v28
v_mov_b32 v33,v29
v_cvt_pk_bf16_f32 v6,v28,v29
v_lshlrev_b32 v28,16,v6
v_and_b32 v29,0xffff0000,v6
v_add_f32 v29,0x3727c5ac,v29
v_cvt_pk_bf16_f32 v6,v29,v29
v_lshlrev_b32 v29,16,v6
v_sqrt_f32 v29,v29
s_nop 0
v_cvt_pk_bf16_f32 v6,v29,v29
v_lshlrev_b32 v29,16,v6
v_rcp_f32 v29,v29
s_nop 0
v_pk_add_f32 v[82:83],v[82:83],v[28:29] op_sel_hi:[1,0] neg_lo:[0,1] neg_hi:[0,1]
v_pk_add_f32 v[84:85],v[84:85],v[28:29] op_sel_hi:[1,0] neg_lo:[0,1] neg_hi:[0,1]
v_pk_add_f32 v[86:87],v[86:87],v[28:29] op_sel_hi:[1,0] neg_lo:[0,1] neg_hi:[0,1]
v_pk_add_f32 v[88:89],v[88:89],v[28:29] op_sel_hi:[1,0] neg_lo:[0,1] neg_hi:[0,1]
v_pk_add_f32 v[90:91],v[90:91],v[28:29] op_sel_hi:[1,0] neg_lo:[0,1] neg_hi:[0,1]
v_cvt_pk_bf16_f32 v6,v82,v83
v_lshlrev_b32 v82,16,v6
v_and_b32 v83,0xffff0000,v6
v_cvt_pk_bf16_f32 v8,v84,v85
v_lshlrev_b32 v84,16,v8
v_and_b32 v85,0xffff0000,v8
v_cvt_pk_bf16_f32 v6,v86,v87
v_lshlrev_b32 v86,16,v6
v_and_b32 v87,0xffff0000,v6
v_cvt_pk_bf16_f32 v8,v88,v89
v_lshlrev_b32 v88,16,v8
v_and_b32 v89,0xffff0000,v8
v_cvt_pk_bf16_f32 v6,v90,v91
v_lshlrev_b32 v90,16,v6
v_and_b32 v91,0xffff0000,v6
v_pk_mul_f32 v[82:83],v[82:83],v[28:29] op_sel:[0,1] op_sel_hi:[1,1]
v_pk_mul_f32 v[84:85],v[84:85],v[28:29] op_sel:[0,1] op_sel_hi:[1,1]
v_pk_mul_f32 v[86:87],v[86:87],v[28:29] op_sel:[0,1] op_sel_hi:[1,1]
v_pk_mul_f32 v[88:89],v[88:89],v[28:29] op_sel:[0,1] op_sel_hi:[1,1]
v_pk_mul_f32 v[90:91],v[90:91],v[28:29] op_sel:[0,1] op_sel_hi:[1,1]
v_cvt_pk_bf16_f32 v124,v82,v83
v_cvt_pk_bf16_f32 v125,v84,v85
v_cvt_pk_bf16_f32 v126,v86,v87
v_cvt_pk_bf16_f32 v127,v88,v89
v_cvt_pk_bf16_f32 v128,v90,v91
buffer_store_dwordx4 v[124:127],v16,s[8:11],s75 offen sc1
v_mov_b32 v129,v128
s_nop 1
v_permlane16_swap_b32 v128,v129
s_nop 1
v_permlane32_swap_b32 v128,v130
v_permlane32_swap_b32 v129,v131
s_mov_b64 exec,0xffff
buffer_store_dwordx4 v[128:131],v17,s[8:11],s75 offen sc1
s_mov_b64 exec,-1
s_cmp_lg_u32 s46,3
s_cbranch_scc1 zs_254
v_sub_f32 v32,v32,v28
v_mul_f32 v33,v33,v29
v_mul_f32 v32,v32,v29
v_mul_f32 v33,v33,v29
v_cvt_pk_bf16_f32 v6,v32,v33
v_lshlrev_b32 v32,16,v6
v_and_b32 v33,0xffff0000,v6
v_add_f32 v33,0x3727c5ac,v33
v_cvt_pk_bf16_f32 v6,v33,v33
v_lshlrev_b32 v33,16,v6
v_sqrt_f32 v33,v33
s_nop 0
v_cvt_pk_bf16_f32 v6,v33,v33
v_lshlrev_b32 v33,16,v6
v_rcp_f32 v33,v33
s_lshl_b32 s60,s48,7
s_add_u32 s63,s75,s60
s_add_u32 s63,s63,40960
v_lshlrev_b32 v6,3,v0
s_mov_b64 exec,65535
buffer_store_dwordx2 v[32:33],v6,s[8:11],s63 offen sc1
s_mov_b64 exec,-1
zs_254:
s_add_u32 s52,s52,1
s_add_u32 s35,s35,640
s_waitcnt vmcnt(0)
s_mov_b64 exec,1
buffer_store_dword v5,v1,s[8:11],s82 offen sc1
s_mov_b64 exec,-1
s_cmp_lt_u32 s52,64
s_cbranch_scc1 R1_LOOP
s_endpgm
ROLE_W1:
v_lshlrev_b32 v1,4,v0
v_mov_b32 v5,1
s_lshl_b32 s56,s48,2
s_add_u32 s56,s56,s46
v_bfe_u32 v6,v0,2,2
v_lshrrev_b32 v7,4,v0
v_add_u32 v7,v6,v7
v_and_b32 v7,3,v7
v_and_b32 v15,3,v0
v_lshlrev_b32 v15,4,v15
v_lshl_add_u32 v15,v7,6,v15
v_lshl_add_u32 v15,v6,8,v15
v_lshrrev_b32 v6,5,v0
v_bfe_u32 v7,v0,4,1
v_lshlrev_b32 v16,10,v7
v_bfe_u32 v7,v0,2,2
v_lshl_add_u32 v16,v7,8,v16
v_add_u32 v6,v6,v7
v_and_b32 v6,3,v6
v_lshl_add_u32 v16,v6,6,v16
v_and_b32 v6,3,v0
v_lshl_add_u32 v16,v6,4,v16
v_add_u32 v18,46080,v16
v_lshrrev_b32 v6,5,v0
v_bfe_u32 v7,v0,4,1
v_lshlrev_b32 v20,10,v7
v_lshl_add_u32 v20,v6,8,v20
v_and_b32 v6,15,v0
v_lshl_add_u32 v20,v6,4,v20
v_lshrrev_b32 v6,5,v0
v_add_u32 v6,2,v6
v_bfe_u32 v7,v0,4,1
v_lshlrev_b32 v17,10,v7
v_bfe_u32 v7,v0,2,2
v_lshl_add_u32 v17,v7,8,v17
v_add_u32 v6,v6,v7
v_and_b32 v6,3,v6
v_lshl_add_u32 v17,v6,6,v17
v_and_b32 v6,3,v0
v_lshl_add_u32 v17,v6,4,v17
v_add_u32 v19,46080,v17
v_lshrrev_b32 v6,5,v0
v_add_u32 v6,2,v6
v_bfe_u32 v7,v0,4,1
v_lshlrev_b32 v21,10,v7
v_lshl_add_u32 v21,v6,8,v21
v_and_b32 v6,15,v0
v_lshl_add_u32 v21,v6,4,v21
v_min_u32 v2,31,v0
v_lshlrev_b32 v2,2,v2
v_mov_b32 v112,0xc0135761
v_mov_b32 v113,0xbdd2d3e8
s_mov_b32 s68,0xbdd2d3e8
v_mov_b32 v116,0
v_mov_b32 v117,0
v_mov_b32 v118,0
v_mov_b32 v119,0
s_lshl_b32 s60,s56,11
s_add_u32 s61,s60,237699072
buffer_store_dwordx4 v[116:119],v1,s[8:11],s61 offen sc1
buffer_store_dwordx4 v[116:119],v1,s[8:11],s61 offen offset:1024 sc1
s_add_u32 s61,s60,238067712
buffer_store_dwordx4 v[116:119],v1,s[8:11],s61 offen sc1
buffer_store_dwordx4 v[116:119],v1,s[8:11],s61 offen offset:1024 sc1
s_waitcnt vmcnt(0)
s_barrier
s_cmp_lg_u32 s46,0
s_cbranch_scc1 arr_255
v_mov_b32 v6,1
s_lshl_b32 s3,s49,2
v_mov_b32 v7,s3
s_mov_b64 exec,1
buffer_atomic_add v6,v7,s[12:15],0 offen sc1
s_mov_b64 exec,-1
arr_255:
s_lshl_b32 s3,s49,2
v_mov_b32 v7,s3
s_nop 1
ibw_256:
buffer_load_dword v6,v7,s[12:15],0 offen sc1
s_waitcnt vmcnt(0)
v_cmp_ne_u32 vcc,256,v6
s_nop 0
s_cbranch_vccz ok_257
s_sleep 8
s_sub_u32 s47,s47,1
s_cbranch_scc1 ABORT
s_branch ibw_256
ok_257:
s_cmp_lg_u32 s49,0
s_cbranch_scc1 ibok_258
v_and_b32 v7,7,v0
v_lshlrev_b32 v7,2,v7
buffer_load_dword v6,v7,s[12:15],0 offen offset:32 sc1
s_waitcnt vmcnt(0)
v_cmp_ne_u32 vcc,32,v6
s_nop 0
s_cbranch_vccz ibok_258
s_barrier
s_mov_b32 s49,1
s_mov_b32 s3,s2
s_load_dwordx16 s[16:31],s[0:1],0
s_load_dwordx8 s[32:39],s[0:1],64
s_waitcnt lgkmcnt(0)
s_branch DISPATCH
ibok_258:
s_lshl_b32 s58,s56,6
s_mul_i32 s63,s46,40960
s_mov_b32 s4,s32
s_mov_b32 s5,s33
s_mov_b32 s6,819200
s_mov_b32 s7,0x20000
v_lshrrev_b32 v9,2,v0
s_mov_b32 s64,1280
v_mul_lo_u32 v9,v9,s64
v_and_b32 v10,3,v0
v_lshl_add_u32 v6,v10,4,v9
s_add_u32 m0,s63,0
s_add_u32 s65,s58,0
buffer_load_dwordx4 v6,s[4:7],s65 offen lds
s_add_u32 m0,s63,1024
s_add_u32 s65,s58,20480
buffer_load_dwordx4 v6,s[4:7],s65 offen lds
s_add_u32 m0,s63,2048
s_add_u32 s65,s58,40960
buffer_load_dwordx4 v6,s[4:7],s65 offen lds
s_add_u32 m0,s63,3072
s_add_u32 s65,s58,61440
buffer_load_dwordx4 v6,s[4:7],s65 offen lds
s_add_u32 m0,s63,4096
s_add_u32 s65,s58,81920
buffer_load_dwordx4 v6,s[4:7],s65 offen lds
s_add_u32 m0,s63,5120
s_add_u32 s65,s58,102400
buffer_load_dwordx4 v6,s[4:7],s65 offen lds
s_add_u32 m0,s63,6144
s_add_u32 s65,s58,122880
buffer_load_dwordx4 v6,s[4:7],s65 offen lds
s_add_u32 m0,s63,7168
s_add_u32 s65,s58,143360
buffer_load_dwordx4 v6,s[4:7],s65 offen lds
s_add_u32 m0,s63,8192
s_add_u32 s65,s58,163840
buffer_load_dwordx4 v6,s[4:7],s65 offen lds
s_add_u32 m0,s63,9216
s_add_u32 s65,s58,184320
buffer_load_dwordx4 v6,s[4:7],s65 offen lds
s_add_u32 m0,s63,10240
s_add_u32 s65,s58,204800
buffer_load_dwordx4 v6,s[4:7],s65 offen lds
s_add_u32 m0,s63,11264
s_add_u32 s65,s58,225280
buffer_load_dwordx4 v6,s[4:7],s65 offen lds
s_add_u32 m0,s63,12288
s_add_u32 s65,s58,245760
buffer_load_dwordx4 v6,s[4:7],s65 offen lds
s_add_u32 m0,s63,13312
s_add_u32 s65,s58,266240
buffer_load_dwordx4 v6,s[4:7],s65 offen lds
s_add_u32 m0,s63,14336
s_add_u32 s65,s58,286720
buffer_load_dwordx4 v6,s[4:7],s65 offen lds
s_add_u32 m0,s63,15360
s_add_u32 s65,s58,307200
buffer_load_dwordx4 v6,s[4:7],s65 offen lds
s_add_u32 m0,s63,16384
s_add_u32 s65,s58,327680
buffer_load_dwordx4 v6,s[4:7],s65 offen lds
s_add_u32 m0,s63,17408
s_add_u32 s65,s58,348160
buffer_load_dwordx4 v6,s[4:7],s65 offen lds
s_add_u32 m0,s63,18432
s_add_u32 s65,s58,368640
buffer_load_dwordx4 v6,s[4:7],s65 offen lds
s_add_u32 m0,s63,19456
s_add_u32 s65,s58,389120
buffer_load_dwordx4 v6,s[4:7],s65 offen lds
s_add_u32 m0,s63,20480
s_add_u32 s65,s58,409600
buffer_load_dwordx4 v6,s[4:7],s65 offen lds
s_add_u32 m0,s63,21504
s_add_u32 s65,s58,430080
buffer_load_dwordx4 v6,s[4:7],s65 offen lds
s_add_u32 m0,s63,22528
s_add_u32 s65,s58,450560
buffer_load_dwordx4 v6,s[4:7],s65 offen lds
s_add_u32 m0,s63,23552
s_add_u32 s65,s58,471040
buffer_load_dwordx4 v6,s[4:7],s65 offen lds
s_add_u32 m0,s63,24576
s_add_u32 s65,s58,491520
buffer_load_dwordx4 v6,s[4:7],s65 offen lds
s_add_u32 m0,s63,25600
s_add_u32 s65,s58,512000
buffer_load_dwordx4 v6,s[4:7],s65 offen lds
s_add_u32 m0,s63,26624
s_add_u32 s65,s58,532480
buffer_load_dwordx4 v6,s[4:7],s65 offen lds
s_add_u32 m0,s63,27648
s_add_u32 s65,s58,552960
buffer_load_dwordx4 v6,s[4:7],s65 offen lds
s_add_u32 m0,s63,28672
s_add_u32 s65,s58,573440
buffer_load_dwordx4 v6,s[4:7],s65 offen lds
s_add_u32 m0,s63,29696
s_add_u32 s65,s58,593920
buffer_load_dwordx4 v6,s[4:7],s65 offen lds
s_add_u32 m0,s63,30720
s_add_u32 s65,s58,614400
buffer_load_dwordx4 v6,s[4:7],s65 offen lds
s_add_u32 m0,s63,31744
s_add_u32 s65,s58,634880
buffer_load_dwordx4 v6,s[4:7],s65 offen lds
s_add_u32 m0,s63,32768
s_add_u32 s65,s58,655360
buffer_load_dwordx4 v6,s[4:7],s65 offen lds
s_add_u32 m0,s63,33792
s_add_u32 s65,s58,675840
buffer_load_dwordx4 v6,s[4:7],s65 offen lds
s_add_u32 m0,s63,34816
s_add_u32 s65,s58,696320
buffer_load_dwordx4 v6,s[4:7],s65 offen lds
s_add_u32 m0,s63,35840
s_add_u32 s65,s58,716800
buffer_load_dwordx4 v6,s[4:7],s65 offen lds
s_add_u32 m0,s63,36864
s_add_u32 s65,s58,737280
buffer_load_dwordx4 v6,s[4:7],s65 offen lds
s_add_u32 m0,s63,37888
s_add_u32 s65,s58,757760
buffer_load_dwordx4 v6,s[4:7],s65 offen lds
s_add_u32 m0,s63,38912
s_add_u32 s65,s58,778240
buffer_load_dwordx4 v6,s[4:7],s65 offen lds
s_add_u32 m0,s63,39936
s_add_u32 s65,s58,798720
buffer_load_dwordx4 v6,s[4:7],s65 offen lds
s_waitcnt vmcnt(20)
v_bfe_u32 v9,v0,2,2
v_lshrrev_b32 v10,5,v0
v_lshl_add_u32 v9,v10,2,v9
v_mul_u32_u24 v9,64,v9
v_and_b32 v10,1,v0
v_lshl_add_u32 v9,v10,3,v9
v_bfe_u32 v10,v0,1,1
v_lshl_add_u32 v9,v10,5,v9
v_bfe_u32 v10,v0,4,1
v_lshl_add_u32 v9,v10,4,v9
v_add_u32 v7,s63,v9
ds_read_b64_tr_b16 a[0:1],v7 offset:0
ds_read_b64_tr_b16 a[2:3],v7 offset:1024
ds_read_b64_tr_b16 a[4:5],v7 offset:512
ds_read_b64_tr_b16 a[6:7],v7 offset:1536
ds_read_b64_tr_b16 a[8:9],v7 offset:2048
ds_read_b64_tr_b16 a[10:11],v7 offset:3072
ds_read_b64_tr_b16 a[12:13],v7 offset:2560
ds_read_b64_tr_b16 a[14:15],v7 offset:3584
ds_read_b64_tr_b16 a[16:17],v7 offset:4096
ds_read_b64_tr_b16 a[18:19],v7 offset:5120
ds_read_b64_tr_b16 a[20:21],v7 offset:4608
ds_read_b64_tr_b16 a[22:23],v7 offset:5632
s_waitcnt lgkmcnt(4)
ds_read_b64_tr_b16 a[24:25],v7 offset:6144
ds_read_b64_tr_b16 a[26:27],v7 offset:7168
ds_read_b64_tr_b16 a[28:29],v7 offset:6656
ds_read_b64_tr_b16 a[30:31],v7 offset:7680
ds_read_b64_tr_b16 a[32:33],v7 offset:8192
ds_read_b64_tr_b16 a[34:35],v7 offset:9216
ds_read_b64_tr_b16 a[36:37],v7 offset:8704
ds_read_b64_tr_b16 a[38:39],v7 offset:9728
ds_read_b64_tr_b16 a[40:41],v7 offset:10240
ds_read_b64_tr_b16 a[42:43],v7 offset:11264
ds_read_b64_tr_b16 a[44:45],v7 offset:10752
ds_read_b64_tr_b16 a[46:47],v7 offset:11776
s_waitcnt lgkmcnt(4)
ds_read_b64_tr_b16 a[48:49],v7 offset:12288
ds_read_b64_tr_b16 a[50:51],v7 offset:13312
ds_read_b64_tr_b16 a[52:53],v7 offset:12800
ds_read_b64_tr_b16 a[54:55],v7 offset:13824
ds_read_b64_tr_b16 a[56:57],v7 offset:14336
ds_read_b64_tr_b16 a[58:59],v7 offset:15360
ds_read_b64_tr_b16 a[60:61],v7 offset:14848
ds_read_b64_tr_b16 a[62:63],v7 offset:15872
ds_read_b64_tr_b16 a[64:65],v7 offset:16384
ds_read_b64_tr_b16 a[66:67],v7 offset:17408
ds_read_b64_tr_b16 a[68:69],v7 offset:16896
ds_read_b64_tr_b16 a[70:71],v7 offset:17920
s_waitcnt lgkmcnt(4)
ds_read_b64_tr_b16 a[72:73],v7 offset:18432
ds_read_b64_tr_b16 a[74:75],v7 offset:19456
ds_read_b64_tr_b16 a[76:77],v7 offset:18944
ds_read_b64_tr_b16 a[78:79],v7 offset:19968
s_waitcnt lgkmcnt(0)
s_waitcnt vmcnt(0)
v_bfe_u32 v9,v0,2,2
v_lshrrev_b32 v10,5,v0
v_lshl_add_u32 v9,v10,2,v9
v_mul_u32_u24 v9,64,v9
v_and_b32 v10,1,v0
v_lshl_add_u32 v9,v10,3,v9
v_bfe_u32 v10,v0,1,1
v_lshl_add_u32 v9,v10,5,v9
v_bfe_u32 v10,v0,4,1
v_lshl_add_u32 v9,v10,4,v9
v_add_u32 v7,s63,v9
ds_read_b64_tr_b16 a[80:81],v7 offset:20480
ds_read_b64_tr_b16 a[82:83],v7 offset:21504
ds_read_b64_tr_b16 a[84:85],v7 offset:20992
ds_read_b64_tr_b16 a[86:87],v7 offset:22016
ds_read_b64_tr_b16 a[88:89],v7 offset:22528
ds_read_b64_tr_b16 a[90:91],v7 offset:23552
ds_read_b64_tr_b16 a[92:93],v7 offset:23040
ds_read_b64_tr_b16 a[94:95],v7 offset:24064
ds_read_b64_tr_b16 a[96:97],v7 offset:24576
ds_read_b64_tr_b16 a[98:99],v7 offset:25600
ds_read_b64_tr_b16 a[100:101],v7 offset:25088
ds_read_b64_tr_b16 a[102:103],v7 offset:26112
s_waitcnt lgkmcnt(4)
ds_read_b64_tr_b16 a[104:105],v7 offset:26624
ds_read_b64_tr_b16 a[106:107],v7 offset:27648
ds_read_b64_tr_b16 a[108:109],v7 offset:27136
ds_read_b64_tr_b16 a[110:111],v7 offset:28160
ds_read_b64_tr_b16 a[112:113],v7 offset:28672
ds_read_b64_tr_b16 a[114:115],v7 offset:29696
ds_read_b64_tr_b16 a[116:117],v7 offset:29184
ds_read_b64_tr_b16 a[118:119],v7 offset:30208
ds_read_b64_tr_b16 a[120:121],v7 offset:30720
ds_read_b64_tr_b16 a[122:123],v7 offset:31744
ds_read_b64_tr_b16 a[124:125],v7 offset:31232
ds_read_b64_tr_b16 a[126:127],v7 offset:32256
s_waitcnt lgkmcnt(4)
ds_read_b64_tr_b16 a[128:129],v7 offset:32768
ds_read_b64_tr_b16 a[130:131],v7 offset:33792
ds_read_b64_tr_b16 a[132:133],v7 offset:33280
ds_read_b64_tr_b16 a[134:135],v7 offset:34304
ds_read_b64_tr_b16 a[136:137],v7 offset:34816
ds_read_b64_tr_b16 a[138:139],v7 offset:35840
ds_read_b64_tr_b16 a[140:141],v7 offset:35328
ds_read_b64_tr_b16 a[142:143],v7 offset:36352
ds_read_b64_tr_b16 a[144:145],v7 offset:36864
ds_read_b64_tr_b16 a[146:147],v7 offset:37888
ds_read_b64_tr_b16 a[148:149],v7 offset:37376
ds_read_b64_tr_b16 a[150:151],v7 offset:38400
s_waitcnt lgkmcnt(4)
ds_read_b64_tr_b16 a[152:153],v7 offset:38912
ds_read_b64_tr_b16 a[154:155],v7 offset:39936
ds_read_b64_tr_b16 a[156:157],v7 offset:39424
ds_read_b64_tr_b16 a[158:159],v7 offset:40448
s_waitcnt lgkmcnt(0)
v_mov_b32 v24,0x3f803f80
v_mov_b32 v25,0x3f803f80
v_mov_b32 v26,0x3f803f80
v_mov_b32 v27,0x3f803f80
s_nop 1
v_mfma_f32_32x32x16_bf16 v[144:159],a[0:3],v[24:27],0
v_mfma_f32_32x32x16_bf16 v[144:159],a[4:7],v[24:27],v[144:159]
v_mfma_f32_32x32x16_bf16 v[144:159],a[8:11],v[24:27],v[144:159]
v_mfma_f32_32x32x16_bf16 v[144:159],a[12:15],v[24:27],v[144:159]
v_mfma_f32_32x32x16_bf16 v[144:159],a[16:19],v[24:27],v[144:159]
v_mfma_f32_32x32x16_bf16 v[144:159],a[20:23],v[24:27],v[144:159]
v_mfma_f32_32x32x16_bf16 v[144:159],a[24:27],v[24:27],v[144:159]
v_mfma_f32_32x32x16_bf16 v[144:159],a[28:31],v[24:27],v[144:159]
v_mfma_f32_32x32x16_bf16 v[144:159],a[32:35],v[24:27],v[144:159]
v_mfma_f32_32x32x16_bf16 v[144:159],a[36:39],v[24:27],v[144:159]
v_mfma_f32_32x32x16_bf16 v[144:159],a[40:43],v[24:27],v[144:159]
v_mfma_f32_32x32x16_bf16 v[144:159],a[44:47],v[24:27],v[144:159]
v_mfma_f32_32x32x16_bf16 v[144:159],a[48:51],v[24:27],v[144:159]
v_mfma_f32_32x32x16_bf16 v[144:159],a[52:55],v[24:27],v[144:159]
v_mfma_f32_32x32x16_bf16 v[144:159],a[56:59],v[24:27],v[144:159]
v_mfma_f32_32x32x16_bf16 v[144:159],a[60:63],v[24:27],v[144:159]
v_mfma_f32_32x32x16_bf16 v[144:159],a[64:67],v[24:27],v[144:159]
v_mfma_f32_32x32x16_bf16 v[144:159],a[68:71],v[24:27],v[144:159]
v_mfma_f32_32x32x16_bf16 v[144:159],a[72:75],v[24:27],v[144:159]
v_mfma_f32_32x32x16_bf16 v[144:159],a[76:79],v[24:27],v[144:159]
v_mfma_f32_32x32x16_bf16 v[144:159],a[80:83],v[24:27],v[144:159]
v_mfma_f32_32x32x16_bf16 v[144:159],a[84:87],v[24:27],v[144:159]
v_mfma_f32_32x32x16_bf16 v[144:159],a[88:91],v[24:27],v[144:159]
v_mfma_f32_32x32x16_bf16 v[144:159],a[92:95],v[24:27],v[144:159]
v_mfma_f32_32x32x16_bf16 v[144:159],a[96:99],v[24:27],v[144:159]
v_mfma_f32_32x32x16_bf16 v[144:159],a[100:103],v[24:27],v[144:159]
v_mfma_f32_32x32x16_bf16 v[144:159],a[104:107],v[24:27],v[144:159]
v_mfma_f32_32x32x16_bf16 v[144:159],a[108:111],v[24:27],v[144:159]
v_mfma_f32_32x32x16_bf16 v[144:159],a[112:115],v[24:27],v[144:159]
v_mfma_f32_32x32x16_bf16 v[144:159],a[116:119],v[24:27],v[144:159]
v_mfma_f32_32x32x16_bf16 v[144:159],a[120:123],v[24:27],v[144:159]
v_mfma_f32_32x32x16_bf16 v[144:159],a[124:127],v[24:27],v[144:159]
v_mfma_f32_32x32x16_bf16 v[144:159],a[128:131],v[24:27],v[144:159]
v_mfma_f32_32x32x16_bf16 v[144:159],a[132:135],v[24:27],v[144:159]
v_mfma_f32_32x32x16_bf16 v[144:159],a[136:139],v[24:27],v[144:159]
v_mfma_f32_32x32x16_bf16 v[144:159],a[140:143],v[24:27],v[144:159]
v_mfma_f32_32x32x16_bf16 v[144:159],a[144:147],v[24:27],v[144:159]
v_mfma_f32_32x32x16_bf16 v[144:159],a[148:151],v[24:27],v[144:159]
v_mfma_f32_32x32x16_bf16 v[144:159],a[152:155],v[24:27],v[144:159]
v_mfma_f32_32x32x16_bf16 v[144:159],a[156:159],v[24:27],v[144:159]
v_and_b32 v182,31,v0
v_lshlrev_b32 v182,3,v182
v_add_u32 v182,0xa000,v182
v_bfe_u32 v6,v0,2,3
v_mul_u32_u24 v6,96,v6
v_add_u32 v182,v182,v6
s_barrier
s_mov_b32 s50,0
s_mov_b32 s32,0
s_mov_b32 s57,0
s_mov_b32 s59,2147483648
s_mov_b32 s82,2147483648
s_mov_b32 s39,2147483648
v_mov_b32 v22,94208
v_lshl_add_u32 v22,v0,2,v22
v_mov_b32 v23,0
ds_write_b32 v22,v23
s_mov_b32 s39,1600000
v_and_b32 v72,15,v0
v_lshlrev_b32 v72,7,v72
v_min_u32 v6,51,v0
v_lshlrev_b32 v6,2,v6
v_add_u32 v2,0,v6
v_add_u32 v7,127360,v6
v_cmp_gt_u32 s[78:79],32,v0
s_nop 1
v_cndmask_b32 v2,v7,v2,s[78:79]
s_mov_b32 s51,0
s_mov_b32 s52,0
s_mul_i32 s62,s51,9
s_and_b32 s63,s52,7
s_add_u32 s62,s62,s63
s_mul_i32 s62,s62,40960
s_add_u32 s62,s62,237371392
s_lshl_b32 s63,s56,11
s_add_u32 s62,s62,s63
buffer_load_dword v73,v72,s[8:11],s62 offen sc1
s_mov_b32 s51,0
s_mov_b32 s52,1
s_mul_i32 s62,s51,9
s_and_b32 s63,s52,7
s_add_u32 s62,s62,s63
s_mul_i32 s62,s62,40960
s_add_u32 s62,s62,237371392
s_lshl_b32 s63,s56,11
s_add_u32 s62,s62,s63
buffer_load_dword v73,v72,s[8:11],s62 offen sc1
s_mov_b32 s51,0
s_mov_b32 s52,2
s_mul_i32 s62,s51,9
s_and_b32 s63,s52,7
s_add_u32 s62,s62,s63
s_mul_i32 s62,s62,40960
s_add_u32 s62,s62,237371392
s_lshl_b32 s63,s56,11
s_add_u32 s62,s62,s63
buffer_load_dword v73,v72,s[8:11],s62 offen sc1
s_mov_b32 s51,0
s_mov_b32 s52,3
s_mul_i32 s62,s51,9
s_and_b32 s63,s52,7
s_add_u32 s62,s62,s63
s_mul_i32 s62,s62,40960
s_add_u32 s62,s62,237371392
s_lshl_b32 s63,s56,11
s_add_u32 s62,s62,s63
buffer_load_dword v73,v72,s[8:11],s62 offen sc1
s_mov_b32 s51,0
s_mov_b32 s52,4
s_mul_i32 s62,s51,9
s_and_b32 s63,s52,7
s_add_u32 s62,s62,s63
s_mul_i32 s62,s62,40960
s_add_u32 s62,s62,237371392
s_lshl_b32 s63,s56,11
s_add_u32 s62,s62,s63
buffer_load_dword v73,v72,s[8:11],s62 offen sc1
s_mov_b32 s51,0
s_mov_b32 s52,5
s_mul_i32 s62,s51,9
s_and_b32 s63,s52,7
s_add_u32 s62,s62,s63
s_mul_i32 s62,s62,40960
s_add_u32 s62,s62,237371392
s_lshl_b32 s63,s56,11
s_add_u32 s62,s62,s63
buffer_load_dword v73,v72,s[8:11],s62 offen sc1
s_mov_b32 s51,0
s_mov_b32 s52,6
s_mul_i32 s62,s51,9
s_and_b32 s63,s52,7
s_add_u32 s62,s62,s63
s_mul_i32 s62,s62,40960
s_add_u32 s62,s62,237371392
s_lshl_b32 s63,s56,11
s_add_u32 s62,s62,s63
buffer_load_dword v73,v72,s[8:11],s62 offen sc1
s_mov_b32 s51,0
s_mov_b32 s52,7
s_mul_i32 s62,s51,9
s_and_b32 s63,s52,7
s_add_u32 s62,s62,s63
s_mul_i32 s62,s62,40960
s_add_u32 s62,s62,237371392
s_lshl_b32 s63,s56,11
s_add_u32 s62,s62,s63
buffer_load_dword v73,v72,s[8:11],s62 offen sc1
s_mov_b32 s51,1
s_mov_b32 s52,0
s_mul_i32 s62,s51,9
s_and_b32 s63,s52,7
s_add_u32 s62,s62,s63
s_mul_i32 s62,s62,40960
s_add_u32 s62,s62,237371392
s_lshl_b32 s63,s56,11
s_add_u32 s62,s62,s63
buffer_load_dword v73,v72,s[8:11],s62 offen sc1
s_mov_b32 s51,1
s_mov_b32 s52,1
s_mul_i32 s62,s51,9
s_and_b32 s63,s52,7
s_add_u32 s62,s62,s63
s_mul_i32 s62,s62,40960
s_add_u32 s62,s62,237371392
s_lshl_b32 s63,s56,11
s_add_u32 s62,s62,s63
buffer_load_dword v73,v72,s[8:11],s62 offen sc1
s_mov_b32 s51,1
s_mov_b32 s52,2
s_mul_i32 s62,s51,9
s_and_b32 s63,s52,7
s_add_u32 s62,s62,s63
s_mul_i32 s62,s62,40960
s_add_u32 s62,s62,237371392
s_lshl_b32 s63,s56,11
s_add_u32 s62,s62,s63
buffer_load_dword v73,v72,s[8:11],s62 offen sc1
s_mov_b32 s51,1
s_mov_b32 s52,3
s_mul_i32 s62,s51,9
s_and_b32 s63,s52,7
s_add_u32 s62,s62,s63
s_mul_i32 s62,s62,40960
s_add_u32 s62,s62,237371392
s_lshl_b32 s63,s56,11
s_add_u32 s62,s62,s63
buffer_load_dword v73,v72,s[8:11],s62 offen sc1
s_mov_b32 s51,1
s_mov_b32 s52,4
s_mul_i32 s62,s51,9
s_and_b32 s63,s52,7
s_add_u32 s62,s62,s63
s_mul_i32 s62,s62,40960
s_add_u32 s62,s62,237371392
s_lshl_b32 s63,s56,11
s_add_u32 s62,s62,s63
buffer_load_dword v73,v72,s[8:11],s62 offen sc1
s_mov_b32 s51,1
s_mov_b32 s52,5
s_mul_i32 s62,s51,9
s_and_b32 s63,s52,7
s_add_u32 s62,s62,s63
s_mul_i32 s62,s62,40960
s_add_u32 s62,s62,237371392
s_lshl_b32 s63,s56,11
s_add_u32 s62,s62,s63
buffer_load_dword v73,v72,s[8:11],s62 offen sc1
s_mov_b32 s51,1
s_mov_b32 s52,6
s_mul_i32 s62,s51,9
s_and_b32 s63,s52,7
s_add_u32 s62,s62,s63
s_mul_i32 s62,s62,40960
s_add_u32 s62,s62,237371392
s_lshl_b32 s63,s56,11
s_add_u32 s62,s62,s63
buffer_load_dword v73,v72,s[8:11],s62 offen sc1
s_mov_b32 s51,1
s_mov_b32 s52,7
s_mul_i32 s62,s51,9
s_and_b32 s63,s52,7
s_add_u32 s62,s62,s63
s_mul_i32 s62,s62,40960
s_add_u32 s62,s62,237371392
s_lshl_b32 s63,s56,11
s_add_u32 s62,s62,s63
buffer_load_dword v73,v72,s[8:11],s62 offen sc1
s_waitcnt vmcnt(0)
s_waitcnt lgkmcnt(0)
s_barrier
s_mov_b32 s83,s100
s_min_u32 s62,s32,127
s_sub_u32 s60,s62,15
s_lshr_b32 s34,s60,1
s_and_b32 s33,s60,1
s_cmp_eq_u32 s33,0
s_cselect_b32 s61,15,0
s_add_u32 s34,s34,s61
s_sub_u32 s61,s60,49
s_cmp_ge_u32 s60,98
s_cselect_b32 s34,s61,s34
s_cselect_b32 s33,1,s33
s_cmp_lt_u32 s62,15
s_cselect_b32 s34,s62,s34
s_cselect_b32 s33,0,s33
s_lshl_b32 s35,s33,6
s_add_u32 s35,s35,s34
s_lshl_b32 s35,s35,9
s_add_u32 s35,s35,393216
s_cmp_lt_u32 s34,7
s_cselect_b64 s[76:77],s[78:79],-1
s_sub_u32 s57,46080,s57
v_swap_b32 v16,v18
v_swap_b32 v17,v19
s_add_u32 s62,s32,1
s_min_u32 s62,s62,127
s_sub_u32 s60,s62,15
s_lshr_b32 s41,s60,1
s_and_b32 s40,s60,1
s_cmp_eq_u32 s40,0
s_cselect_b32 s61,15,0
s_add_u32 s41,s41,s61
s_sub_u32 s61,s60,49
s_cmp_ge_u32 s60,98
s_cselect_b32 s41,s61,s41
s_cselect_b32 s40,1,s40
s_cmp_lt_u32 s62,15
s_cselect_b32 s41,s62,s41
s_cselect_b32 s40,0,s40
s_lshl_b32 s42,s40,6
s_add_u32 s42,s42,s41
s_lshl_b32 s42,s42,9
s_add_u32 s42,s42,393216
s_cmp_lt_u32 s41,7
s_cselect_b64 s[80:81],s[78:79],-1
W1_COLD:
s_mov_b32 s37,0
s_cmp_lg_u32 s46,0
s_cbranch_scc1 wo_259
fb_261:
buffer_load_dword v3,v2,s[8:11],s35 offen sc1
s_waitcnt vmcnt(0)
v_cmp_eq_u32 vcc,0,v3
s_and_b64 vcc,vcc,s[76:77]
s_cbranch_scc0 ok_262
s_sleep 3
s_sub_u32 s47,s47,1
s_cbranch_scc1 ABORT
s_branch fb_261
ok_262:
W1_COLD2:
s_add_u32 s65,s32,1
s_or_b32 s65,s65,s37
v_mov_b32 v23,s65
ds_max_i32 v22,v23
s_branch wd_260
wo_259:
ds_read_b32 v23,v22
s_waitcnt lgkmcnt(0)
v_cmp_ge_u32 vcc,s32,v23
s_nop 0
s_cbranch_vccz wd_260
s_sleep 1
s_sub_u32 s39,s39,1
s_cbranch_scc1 ABORT
s_branch wo_259
wd_260:
s_sub_u32 s66,46080,s57
s_lshl_b32 s60,s33,6
s_add_u32 s60,s60,s34
s_mul_i32 s60,s60,46080
s_add_u32 s60,s60,s37
s_add_u32 s60,s60,223608832
s_mov_b32 s67,s60
s_mul_i32 s61,s46,10240
s_add_u32 s60,s60,s61
s_add_u32 s61,s61,s66
s_add_u32 m0,s61,0
s_add_u32 s63,s60,0
buffer_load_dwordx4 v1,s[8:11],s63 offen sc1 lds
buffer_load_dwordx4 v1,s[8:11],s63 offen offset:1024 sc1 lds
buffer_load_dwordx4 v1,s[8:11],s63 offen offset:2048 sc1 lds
buffer_load_dwordx4 v1,s[8:11],s63 offen offset:3072 sc1 lds
s_add_u32 m0,s61,4096
s_add_u32 s63,s60,4096
buffer_load_dwordx4 v1,s[8:11],s63 offen sc1 lds
buffer_load_dwordx4 v1,s[8:11],s63 offen offset:1024 sc1 lds
s_waitcnt vmcnt(6)
s_mov_b64 exec,1
s_cmp_lg_u32 s49,0
s_cbranch_scc0 ls_263
buffer_store_dword v5,v1,s[8:11],s59 offen sc1
s_branch ls_264
ls_263:
buffer_store_dword v5,v1,s[8:11],s59 offen
ls_264:
s_mov_b64 exec,-1
s_mov_b32 s59,2147483648
buffer_load_dwordx4 v1,s[8:11],s63 offen offset:2048 sc1 lds
buffer_load_dwordx4 v1,s[8:11],s63 offen offset:3072 sc1 lds
s_add_u32 m0,s61,8192
s_add_u32 s63,s60,8192
buffer_load_dwordx4 v1,s[8:11],s63 offen sc1 lds
buffer_load_dwordx4 v1,s[8:11],s63 offen offset:1024 sc1 lds
s_add_u32 m0,s66,40960
s_add_u32 s63,s67,40960
buffer_load_dwordx4 v1,s[8:11],s63 offen sc1 lds
s_mov_b32 s35,s42
buffer_load_dword v3,v2,s[8:11],s35 offen sc1
s_mov_b32 s53,s33
s_mov_b32 s54,s34
s_add_u32 s32,s32,1
s_mov_b32 s33,s40
s_mov_b32 s34,s41
s_mov_b64 s[76:77],s[80:81]
s_sub_u32 s57,46080,s57
v_swap_b32 v16,v18
v_swap_b32 v17,v19
s_mov_b32 s51,s53
s_mov_b32 s52,s54
s_mov_b32 s37,2147483648
s_waitcnt vmcnt(7)
s_branch W1_GO
W1_NEXT:
s_sub_u32 s57,46080,s57
v_swap_b32 v16,v18
v_swap_b32 v17,v19
s_mov_b32 s51,s53
s_mov_b32 s52,s54
s_waitcnt vmcnt(2)
v_cmp_eq_u32 vcc,0,v3
s_and_b64 vcc,vcc,s[76:77]
s_cselect_b32 s37,2147483648,0
s_cmp_lt_u32 s32,128
s_cselect_b32 s37,s37,2147483648
W1_GO:
s_barrier
ds_read_b128 v[24:27],v16 offset:0
ds_read_b128 v[28:31],v17 offset:0
ds_read_b128 v[32:35],v16 offset:10240
ds_read_b128 v[36:39],v17 offset:10240
ds_read_b128 v[40:43],v16 offset:20480
ds_read_b128 v[44:47],v17 offset:20480
ds_read_b128 v[48:51],v16 offset:30720
s_waitcnt lgkmcnt(6)
v_mfma_f32_32x32x16_bf16 v[56:71],a[0:3],v[24:27],0
ds_read_b128 v[52:55],v17 offset:30720
s_lshl_b32 s60,s51,6
s_add_u32 s60,s60,s52
s_mul_i32 s60,s60,40960
s_waitcnt lgkmcnt(6)
v_mfma_f32_32x32x16_bf16 v[56:71],a[4:7],v[28:31],v[56:71]
ds_read_b128 v[24:27],v16 offset:2048
s_lshl_b32 s61,s56,11
s_add_u32 s60,s60,s61
s_add_u32 s60,s60,218365952
s_waitcnt lgkmcnt(5)
v_mfma_f32_32x32x16_bf16 v[56:71],a[40:43],v[32:35],v[56:71]
ds_read_b128 v[28:31],v17 offset:2048
buffer_load_dword v73,v72,s[8:11],s60 offen sc1
s_add_u32 s65,s32,1
s_or_b32 s65,s65,s37
v_mfma_f32_32x32x16_bf16 v[56:71],a[44:47],v[36:39],v[56:71]
ds_read_b128 v[32:35],v16 offset:12288
v_mov_b32 v23,s65
ds_max_i32 v22,v23
s_waitcnt lgkmcnt(6)
v_mfma_f32_32x32x16_bf16 v[56:71],a[80:83],v[40:43],v[56:71]
ds_read_b128 v[36:39],v17 offset:12288
s_sub_u32 s66,46080,s57
s_lshl_b32 s60,s33,6
s_add_u32 s60,s60,s34
s_mul_i32 s60,s60,46080
v_mfma_f32_32x32x16_bf16 v[56:71],a[84:87],v[44:47],v[56:71]
ds_read_b128 v[40:43],v16 offset:22528
s_add_u32 s60,s60,s37
s_add_u32 s60,s60,223608832
s_mov_b32 s67,s60
s_waitcnt lgkmcnt(6)
v_mfma_f32_32x32x16_bf16 v[56:71],a[120:123],v[48:51],v[56:71]
ds_read_b128 v[44:47],v17 offset:22528
s_mul_i32 s61,s46,10240
s_add_u32 s60,s60,s61
s_add_u32 s61,s61,s66
s_add_u32 m0,s61,0
v_mfma_f32_32x32x16_bf16 v[56:71],a[124:127],v[52:55],v[56:71]
ds_read_b128 v[48:51],v16 offset:32768
s_add_u32 s63,s60,0
buffer_load_dwordx4 v1,s[8:11],s63 offen sc1 lds
s_waitcnt lgkmcnt(6)
v_mfma_f32_32x32x16_bf16 v[56:71],a[8:11],v[24:27],v[56:71]
ds_read_b128 v[52:55],v17 offset:32768
s_mul_i32 s71,s51,9
s_and_b32 s72,s52,7
s_add_u32 s71,s71,s72
s_mul_i32 s71,s71,40960
v_mfma_f32_32x32x16_bf16 v[56:71],a[12:15],v[28:31],v[56:71]
ds_read_b128 v[24:27],v16 offset:4096
s_add_u32 s71,s71,237371392
s_lshl_b32 s72,s56,11
s_add_u32 s71,s71,s72
s_waitcnt lgkmcnt(5)
v_mfma_f32_32x32x16_bf16 v[56:71],a[48:51],v[32:35],v[56:71]
ds_read_b128 v[28:31],v17 offset:4096
buffer_load_dword v3,v2,s[8:11],s35 offen sc1
s_lshl_b32 s82,s51,6
v_mfma_f32_32x32x16_bf16 v[56:71],a[52:55],v[36:39],v[56:71]
ds_read_b128 v[32:35],v16 offset:14336
buffer_load_dwordx4 v1,s[8:11],s63 offen offset:1024 sc1 lds
s_add_u32 s82,s82,s52
s_waitcnt lgkmcnt(5)
v_mfma_f32_32x32x16_bf16 v[56:71],a[88:91],v[40:43],v[56:71]
ds_read_b128 v[36:39],v17 offset:14336
s_waitcnt vmcnt(4)
s_mov_b64 exec,1
s_cmp_lg_u32 s49,0
s_cbranch_scc0 ls_265
buffer_store_dword v5,v1,s[8:11],s59 offen sc1
s_branch ls_266
ls_265:
buffer_store_dword v5,v1,s[8:11],s59 offen
ls_266:
s_mov_b64 exec,-1
s_mov_b32 s59,2147483648
v_mfma_f32_32x32x16_bf16 v[56:71],a[92:95],v[44:47],v[56:71]
ds_read_b128 v[40:43],v16 offset:24576
s_lshl_b32 s82,s82,9
s_add_u32 s82,s82,458752
s_lshl_b32 s70,s56,2
s_waitcnt lgkmcnt(5)
v_mfma_f32_32x32x16_bf16 v[56:71],a[128:131],v[48:51],v[56:71]
ds_read_b128 v[44:47],v17 offset:24576
buffer_load_dwordx4 v1,s[8:11],s63 offen offset:2048 sc1 lds
s_add_u32 s82,s82,s70
v_mfma_f32_32x32x16_bf16 v[56:71],a[132:135],v[52:55],v[56:71]
ds_read_b128 v[48:51],v16 offset:34816
s_waitcnt lgkmcnt(5)
v_mfma_f32_32x32x16_bf16 v[56:71],a[16:19],v[24:27],v[56:71]
ds_read_b128 v[52:55],v17 offset:34816
s_barrier
v_mfma_f32_32x32x16_bf16 v[56:71],a[20:23],v[28:31],v[56:71]
ds_read_b128 v[24:27],v16 offset:6144
v_add_u32 v183,s57,v182
buffer_load_dwordx4 v1,s[8:11],s63 offen offset:3072 sc1 lds
s_waitcnt lgkmcnt(5)
v_mfma_f32_32x32x16_bf16 v[56:71],a[56:59],v[32:35],v[56:71]
ds_read_b128 v[28:31],v17 offset:6144
ds_read_b64 v[180:181],v183
s_add_u32 m0,s61,4096
s_add_u32 s63,s60,4096
v_mfma_f32_32x32x16_bf16 v[56:71],a[60:63],v[36:39],v[56:71]
ds_read_b128 v[32:35],v16 offset:16384
s_waitcnt lgkmcnt(6)
v_mfma_f32_32x32x16_bf16 v[56:71],a[96:99],v[40:43],v[56:71]
ds_read_b128 v[36:39],v17 offset:16384
buffer_load_dwordx4 v1,s[8:11],s63 offen sc1 lds
v_mfma_f32_32x32x16_bf16 v[56:71],a[100:103],v[44:47],v[56:71]
ds_read_b128 v[40:43],v16 offset:26624
s_waitcnt lgkmcnt(6)
v_mfma_f32_32x32x16_bf16 v[56:71],a[136:139],v[48:51],v[56:71]
ds_read_b128 v[44:47],v17 offset:26624
v_mfma_f32_32x32x16_bf16 v[56:71],a[140:143],v[52:55],v[56:71]
ds_read_b128 v[48:51],v16 offset:36864
buffer_load_dwordx4 v1,s[8:11],s63 offen offset:1024 sc1 lds
s_waitcnt lgkmcnt(6)
v_mfma_f32_32x32x16_bf16 v[56:71],a[24:27],v[24:27],v[56:71]
ds_read_b128 v[52:55],v17 offset:36864
v_mfma_f32_32x32x16_bf16 v[56:71],a[28:31],v[28:31],v[56:71]
ds_read_b128 v[24:27],v16 offset:8192
s_waitcnt lgkmcnt(5)
v_mfma_f32_32x32x16_bf16 v[56:71],a[64:67],v[32:35],v[56:71]
ds_read_b128 v[28:31],v17 offset:8192
buffer_load_dwordx4 v1,s[8:11],s63 offen offset:2048 sc1 lds
v_mfma_f32_32x32x16_bf16 v[56:71],a[68:71],v[36:39],v[56:71]
ds_read_b128 v[32:35],v16 offset:18432
s_waitcnt lgkmcnt(5)
v_mfma_f32_32x32x16_bf16 v[56:71],a[104:107],v[40:43],v[56:71]
ds_read_b128 v[36:39],v17 offset:18432
v_mfma_f32_32x32x16_bf16 v[56:71],a[108:111],v[44:47],v[56:71]
ds_read_b128 v[40:43],v16 offset:28672
buffer_load_dwordx4 v1,s[8:11],s63 offen offset:3072 sc1 lds
s_add_u32 m0,s61,8192
s_waitcnt lgkmcnt(5)
v_mfma_f32_32x32x16_bf16 v[56:71],a[144:147],v[48:51],v[56:71]
ds_read_b128 v[44:47],v17 offset:28672
s_add_u32 s63,s60,8192
v_mfma_f32_32x32x16_bf16 v[56:71],a[148:151],v[52:55],v[56:71]
ds_read_b128 v[48:51],v16 offset:38912
s_waitcnt lgkmcnt(5)
v_mfma_f32_32x32x16_bf16 v[56:71],a[32:35],v[24:27],v[56:71]
ds_read_b128 v[52:55],v17 offset:38912
buffer_load_dwordx4 v1,s[8:11],s63 offen sc1 lds
v_mfma_f32_32x32x16_bf16 v[56:71],a[36:39],v[28:31],v[56:71]
s_waitcnt lgkmcnt(4)
v_mfma_f32_32x32x16_bf16 v[56:71],a[72:75],v[32:35],v[56:71]
v_mfma_f32_32x32x16_bf16 v[56:71],a[76:79],v[36:39],v[56:71]
buffer_load_dwordx4 v1,s[8:11],s63 offen offset:1024 sc1 lds
s_add_u32 m0,s66,40960
s_add_u32 s63,s67,40960
s_waitcnt lgkmcnt(2)
v_mfma_f32_32x32x16_bf16 v[56:71],a[112:115],v[40:43],v[56:71]
v_mfma_f32_32x32x16_bf16 v[56:71],a[116:119],v[44:47],v[56:71]
s_waitcnt lgkmcnt(0)
v_mfma_f32_32x32x16_bf16 v[56:71],a[152:155],v[48:51],v[56:71]
buffer_load_dwordx4 v1,s[8:11],s63 offen sc1 lds
s_add_u32 s62,s32,1
s_min_u32 s62,s62,127
s_sub_u32 s60,s62,15
s_lshr_b32 s41,s60,1
v_mfma_f32_32x32x16_bf16 v[56:71],a[156:159],v[52:55],v[56:71]
s_and_b32 s40,s60,1
s_cmp_eq_u32 s40,0
s_cselect_b32 s61,15,0
s_add_u32 s41,s41,s61
s_sub_u32 s61,s60,49
s_cmp_ge_u32 s60,98
s_cselect_b32 s41,s61,s41
s_cselect_b32 s40,1,s40
s_cmp_lt_u32 s62,15
s_cselect_b32 s41,s62,s41
s_cselect_b32 s40,0,s40
s_lshl_b32 s42,s40,6
s_add_u32 s42,s42,s41
s_lshl_b32 s42,s42,9
s_add_u32 s42,s42,393216
s_cmp_lt_u32 s41,7
s_cselect_b64 s[80:81],s[78:79],-1
s_cmp_eq_u32 s37,0
s_cbranch_scc0 sec_269
s_mov_b32 s35,s42
buffer_load_dword v3,v2,s[8:11],s35 offen sc1
s_mov_b32 s53,s33
s_mov_b32 s54,s34
s_add_u32 s32,s32,1
s_mov_b32 s33,s40
s_mov_b32 s34,s41
s_mov_b64 s[76:77],s[80:81]
s_nop 2
ep_267:
v_pk_fma_f32 v[56:57],v[144:145],v[180:181],v[56:57] op_sel_hi:[1,0,1] neg_lo:[0,1,0] neg_hi:[0,1,0]
v_pk_fma_f32 v[58:59],v[146:147],v[180:181],v[58:59] op_sel_hi:[1,0,1] neg_lo:[0,1,0] neg_hi:[0,1,0]
v_pk_fma_f32 v[60:61],v[148:149],v[180:181],v[60:61] op_sel_hi:[1,0,1] neg_lo:[0,1,0] neg_hi:[0,1,0]
v_pk_fma_f32 v[62:63],v[150:151],v[180:181],v[62:63] op_sel_hi:[1,0,1] neg_lo:[0,1,0] neg_hi:[0,1,0]
v_pk_fma_f32 v[64:65],v[152:153],v[180:181],v[64:65] op_sel_hi:[1,0,1] neg_lo:[0,1,0] neg_hi:[0,1,0]
v_pk_fma_f32 v[66:67],v[154:155],v[180:181],v[66:67] op_sel_hi:[1,0,1] neg_lo:[0,1,0] neg_hi:[0,1,0]
v_pk_fma_f32 v[68:69],v[156:157],v[180:181],v[68:69] op_sel_hi:[1,0,1] neg_lo:[0,1,0] neg_hi:[0,1,0]
v_pk_fma_f32 v[70:71],v[158:159],v[180:181],v[70:71] op_sel_hi:[1,0,1] neg_lo:[0,1,0] neg_hi:[0,1,0]
v_pk_mul_f32 v[56:57],v[56:57],v[180:181] op_sel:[0,1] op_sel_hi:[1,1]
v_pk_mul_f32 v[58:59],v[58:59],v[180:181] op_sel:[0,1] op_sel_hi:[1,1]
v_pk_mul_f32 v[60:61],v[60:61],v[180:181] op_sel:[0,1] op_sel_hi:[1,1]
v_pk_mul_f32 v[62:63],v[62:63],v[180:181] op_sel:[0,1] op_sel_hi:[1,1]
v_pk_mul_f32 v[64:65],v[64:65],v[180:181] op_sel:[0,1] op_sel_hi:[1,1]
v_pk_mul_f32 v[66:67],v[66:67],v[180:181] op_sel:[0,1] op_sel_hi:[1,1]
v_pk_mul_f32 v[68:69],v[68:69],v[180:181] op_sel:[0,1] op_sel_hi:[1,1]
v_pk_mul_f32 v[70:71],v[70:71],v[180:181] op_sel:[0,1] op_sel_hi:[1,1]
v_pk_mul_f32 v[124:125],v[56:57],v[56:57]
v_pk_mul_f32 v[126:127],v[58:59],v[58:59]
v_pk_mul_f32 v[128:129],v[60:61],v[60:61]
v_pk_mul_f32 v[130:131],v[62:63],v[62:63]
v_pk_mul_f32 v[132:133],v[64:65],v[64:65]
v_pk_mul_f32 v[134:135],v[66:67],v[66:67]
v_pk_mul_f32 v[136:137],v[68:69],v[68:69]
v_pk_mul_f32 v[138:139],v[70:71],v[70:71]
v_pk_fma_f32 v[124:125],v[124:125],v[112:113],v[112:113] op_sel:[0,1,0] op_sel_hi:[1,1,0]
v_pk_fma_f32 v[126:127],v[126:127],v[112:113],v[112:113] op_sel:[0,1,0] op_sel_hi:[1,1,0]
v_pk_fma_f32 v[128:129],v[128:129],v[112:113],v[112:113] op_sel:[0,1,0] op_sel_hi:[1,1,0]
v_pk_fma_f32 v[130:131],v[130:131],v[112:113],v[112:113] op_sel:[0,1,0] op_sel_hi:[1,1,0]
v_pk_fma_f32 v[132:133],v[132:133],v[112:113],v[112:113] op_sel:[0,1,0] op_sel_hi:[1,1,0]
v_pk_fma_f32 v[134:135],v[134:135],v[112:113],v[112:113] op_sel:[0,1,0] op_sel_hi:[1,1,0]
v_pk_fma_f32 v[136:137],v[136:137],v[112:113],v[112:113] op_sel:[0,1,0] op_sel_hi:[1,1,0]
v_pk_fma_f32 v[138:139],v[138:139],v[112:113],v[112:113] op_sel:[0,1,0] op_sel_hi:[1,1,0]
v_pk_mul_f32 v[124:125],v[124:125],v[56:57]
v_pk_mul_f32 v[126:127],v[126:127],v[58:59]
v_pk_mul_f32 v[128:129],v[128:129],v[60:61]
v_pk_mul_f32 v[130:131],v[130:131],v[62:63]
v_pk_mul_f32 v[132:133],v[132:133],v[64:65]
v_pk_mul_f32 v[134:135],v[134:135],v[66:67]
v_pk_mul_f32 v[136:137],v[136:137],v[68:69]
v_pk_mul_f32 v[138:139],v[138:139],v[70:71]
v_exp_f32 v124,v124
v_exp_f32 v125,v125
v_exp_f32 v126,v126
v_exp_f32 v127,v127
v_exp_f32 v128,v128
v_exp_f32 v129,v129
v_exp_f32 v130,v130
v_exp_f32 v131,v131
v_exp_f32 v132,v132
v_exp_f32 v133,v133
v_exp_f32 v134,v134
v_exp_f32 v135,v135
v_exp_f32 v136,v136
v_exp_f32 v137,v137
v_exp_f32 v138,v138
v_exp_f32 v139,v139
v_pk_add_f32 v[124:125],v[124:125],1.0 op_sel_hi:[1,0]
v_pk_add_f32 v[126:127],v[126:127],1.0 op_sel_hi:[1,0]
v_pk_add_f32 v[128:129],v[128:129],1.0 op_sel_hi:[1,0]
v_pk_add_f32 v[130:131],v[130:131],1.0 op_sel_hi:[1,0]
v_pk_add_f32 v[132:133],v[132:133],1.0 op_sel_hi:[1,0]
v_pk_add_f32 v[134:135],v[134:135],1.0 op_sel_hi:[1,0]
v_pk_add_f32 v[136:137],v[136:137],1.0 op_sel_hi:[1,0]
v_pk_add_f32 v[138:139],v[138:139],1.0 op_sel_hi:[1,0]
v_rcp_f32 v124,v124
v_rcp_f32 v125,v125
v_rcp_f32 v126,v126
v_rcp_f32 v127,v127
v_rcp_f32 v128,v128
v_rcp_f32 v129,v129
v_rcp_f32 v130,v130
v_rcp_f32 v131,v131
v_rcp_f32 v132,v132
v_rcp_f32 v133,v133
v_rcp_f32 v134,v134
v_rcp_f32 v135,v135
v_rcp_f32 v136,v136
v_rcp_f32 v137,v137
v_rcp_f32 v138,v138
v_rcp_f32 v139,v139
v_pk_mul_f32 v[56:57],v[56:57],v[124:125]
v_pk_mul_f32 v[58:59],v[58:59],v[126:127]
v_pk_mul_f32 v[60:61],v[60:61],v[128:129]
v_pk_mul_f32 v[62:63],v[62:63],v[130:131]
v_pk_mul_f32 v[64:65],v[64:65],v[132:133]
v_pk_mul_f32 v[66:67],v[66:67],v[134:135]
v_pk_mul_f32 v[68:69],v[68:69],v[136:137]
v_pk_mul_f32 v[70:71],v[70:71],v[138:139]
v_cvt_pk_bf16_f32 v116,v56,v57
v_cvt_pk_bf16_f32 v117,v58,v59
v_cvt_pk_bf16_f32 v118,v60,v61
v_cvt_pk_bf16_f32 v119,v62,v63
v_cvt_pk_bf16_f32 v120,v64,v65
v_cvt_pk_bf16_f32 v121,v66,v67
v_cvt_pk_bf16_f32 v122,v68,v69
v_cvt_pk_bf16_f32 v123,v70,v71
s_cmp_lg_u32 s49,0
s_cbranch_scc0 ls_270
buffer_store_dwordx4 v[116:119],v20,s[8:11],s71 offen sc1
buffer_store_dwordx4 v[120:123],v21,s[8:11],s71 offen sc1
s_branch ls_271
ls_270:
buffer_store_dwordx4 v[116:119],v20,s[8:11],s71 offen
buffer_store_dwordx4 v[120:123],v21,s[8:11],s71 offen
ls_271:
s_mov_b32 s59,s82
s_cmp_eq_u32 s37,0
s_cbranch_scc1 W1_NEXT
s_waitcnt vmcnt(2)
v_cmp_eq_u32 vcc,0,v3
s_and_b64 vcc,vcc,s[76:77]
s_cselect_b32 s37,2147483648,0
s_cmp_lt_u32 s32,128
s_cselect_b32 s37,s37,2147483648
s_cmp_eq_u32 s37,0
s_cbranch_scc1 W1_COLD2
s_waitcnt vmcnt(0)
s_mov_b64 exec,1
s_cmp_lg_u32 s49,0
s_cbranch_scc0 ls_272
buffer_store_dword v5,v1,s[8:11],s59 offen sc1
s_branch ls_273
ls_272:
buffer_store_dword v5,v1,s[8:11],s59 offen
ls_273:
s_mov_b64 exec,-1
s_mov_b32 s59,2147483648
s_cmp_lt_u32 s32,128
s_cbranch_scc1 W1_COLD
s_branch W1_END
sec_269:
s_waitcnt vmcnt(11)
v_cmp_eq_u32 vcc,0,v3
s_and_b64 vcc,vcc,s[76:77]
s_cselect_b32 s37,2147483648,0
s_cmp_lt_u32 s32,128
s_cselect_b32 s37,s37,2147483648
s_cmp_lg_u32 s37,0
s_cbranch_scc1 nr_268
s_add_u32 s65,s32,1
s_or_b32 s65,s65,s37
v_mov_b32 v23,s65
ds_max_i32 v22,v23
s_sub_u32 s66,46080,s57
s_lshl_b32 s60,s33,6
s_add_u32 s60,s60,s34
s_mul_i32 s60,s60,46080
s_add_u32 s60,s60,s37
s_add_u32 s60,s60,223608832
s_mov_b32 s67,s60
s_mul_i32 s61,s46,10240
s_add_u32 s60,s60,s61
s_add_u32 s61,s61,s66
s_add_u32 m0,s61,0
s_add_u32 s63,s60,0
buffer_load_dwordx4 v1,s[8:11],s63 offen sc1 lds
v_pk_fma_f32 v[56:57],v[144:145],v[180:181],v[56:57] op_sel_hi:[1,0,1] neg_lo:[0,1,0] neg_hi:[0,1,0]
v_pk_fma_f32 v[58:59],v[146:147],v[180:181],v[58:59] op_sel_hi:[1,0,1] neg_lo:[0,1,0] neg_hi:[0,1,0]
v_pk_fma_f32 v[60:61],v[148:149],v[180:181],v[60:61] op_sel_hi:[1,0,1] neg_lo:[0,1,0] neg_hi:[0,1,0]
v_pk_fma_f32 v[62:63],v[150:151],v[180:181],v[62:63] op_sel_hi:[1,0,1] neg_lo:[0,1,0] neg_hi:[0,1,0]
v_pk_fma_f32 v[64:65],v[152:153],v[180:181],v[64:65] op_sel_hi:[1,0,1] neg_lo:[0,1,0] neg_hi:[0,1,0]
v_pk_fma_f32 v[66:67],v[154:155],v[180:181],v[66:67] op_sel_hi:[1,0,1] neg_lo:[0,1,0] neg_hi:[0,1,0]
v_pk_fma_f32 v[68:69],v[156:157],v[180:181],v[68:69] op_sel_hi:[1,0,1] neg_lo:[0,1,0] neg_hi:[0,1,0]
buffer_load_dwordx4 v1,s[8:11],s63 offen offset:1024 sc1 lds
v_pk_fma_f32 v[70:71],v[158:159],v[180:181],v[70:71] op_sel_hi:[1,0,1] neg_lo:[0,1,0] neg_hi:[0,1,0]
v_pk_mul_f32 v[56:57],v[56:57],v[180:181] op_sel:[0,1] op_sel_hi:[1,1]
v_pk_mul_f32 v[58:59],v[58:59],v[180:181] op_sel:[0,1] op_sel_hi:[1,1]
v_pk_mul_f32 v[60:61],v[60:61],v[180:181] op_sel:[0,1] op_sel_hi:[1,1]
v_pk_mul_f32 v[62:63],v[62:63],v[180:181] op_sel:[0,1] op_sel_hi:[1,1]
v_pk_mul_f32 v[64:65],v[64:65],v[180:181] op_sel:[0,1] op_sel_hi:[1,1]
v_pk_mul_f32 v[66:67],v[66:67],v[180:181] op_sel:[0,1] op_sel_hi:[1,1]
buffer_load_dwordx4 v1,s[8:11],s63 offen offset:2048 sc1 lds
v_pk_mul_f32 v[68:69],v[68:69],v[180:181] op_sel:[0,1] op_sel_hi:[1,1]
v_pk_mul_f32 v[70:71],v[70:71],v[180:181] op_sel:[0,1] op_sel_hi:[1,1]
v_pk_mul_f32 v[124:125],v[56:57],v[56:57]
v_pk_mul_f32 v[126:127],v[58:59],v[58:59]
v_pk_mul_f32 v[128:129],v[60:61],v[60:61]
v_pk_mul_f32 v[130:131],v[62:63],v[62:63]
v_pk_mul_f32 v[132:133],v[64:65],v[64:65]
buffer_load_dwordx4 v1,s[8:11],s63 offen offset:3072 sc1 lds
v_pk_mul_f32 v[134:135],v[66:67],v[66:67]
v_pk_mul_f32 v[136:137],v[68:69],v[68:69]
v_pk_mul_f32 v[138:139],v[70:71],v[70:71]
v_pk_fma_f32 v[124:125],v[124:125],v[112:113],v[112:113] op_sel:[0,1,0] op_sel_hi:[1,1,0]
v_pk_fma_f32 v[126:127],v[126:127],v[112:113],v[112:113] op_sel:[0,1,0] op_sel_hi:[1,1,0]
v_pk_fma_f32 v[128:129],v[128:129],v[112:113],v[112:113] op_sel:[0,1,0] op_sel_hi:[1,1,0]
v_pk_fma_f32 v[130:131],v[130:131],v[112:113],v[112:113] op_sel:[0,1,0] op_sel_hi:[1,1,0]
s_add_u32 m0,s61,4096
s_add_u32 s63,s60,4096
buffer_load_dwordx4 v1,s[8:11],s63 offen sc1 lds
v_pk_fma_f32 v[132:133],v[132:133],v[112:113],v[112:113] op_sel:[0,1,0] op_sel_hi:[1,1,0]
v_pk_fma_f32 v[134:135],v[134:135],v[112:113],v[112:113] op_sel:[0,1,0] op_sel_hi:[1,1,0]
v_pk_fma_f32 v[136:137],v[136:137],v[112:113],v[112:113] op_sel:[0,1,0] op_sel_hi:[1,1,0]
v_pk_fma_f32 v[138:139],v[138:139],v[112:113],v[112:113] op_sel:[0,1,0] op_sel_hi:[1,1,0]
v_pk_mul_f32 v[124:125],v[124:125],v[56:57]
v_pk_mul_f32 v[126:127],v[126:127],v[58:59]
v_pk_mul_f32 v[128:129],v[128:129],v[60:61]
buffer_load_dwordx4 v1,s[8:11],s63 offen offset:1024 sc1 lds
v_pk_mul_f32 v[130:131],v[130:131],v[62:63]
v_pk_mul_f32 v[132:133],v[132:133],v[64:65]
v_pk_mul_f32 v[134:135],v[134:135],v[66:67]
v_pk_mul_f32 v[136:137],v[136:137],v[68:69]
v_pk_mul_f32 v[138:139],v[138:139],v[70:71]
v_exp_f32 v124,v124
v_exp_f32 v125,v125
buffer_load_dwordx4 v1,s[8:11],s63 offen offset:2048 sc1 lds
v_exp_f32 v126,v126
v_exp_f32 v127,v127
v_exp_f32 v128,v128
v_exp_f32 v129,v129
v_exp_f32 v130,v130
v_exp_f32 v131,v131
v_exp_f32 v132,v132
buffer_load_dwordx4 v1,s[8:11],s63 offen offset:3072 sc1 lds
v_exp_f32 v133,v133
v_exp_f32 v134,v134
v_exp_f32 v135,v135
v_exp_f32 v136,v136
v_exp_f32 v137,v137
v_exp_f32 v138,v138
v_exp_f32 v139,v139
s_add_u32 m0,s61,8192
s_add_u32 s63,s60,8192
buffer_load_dwordx4 v1,s[8:11],s63 offen sc1 lds
v_pk_add_f32 v[124:125],v[124:125],1.0 op_sel_hi:[1,0]
v_pk_add_f32 v[126:127],v[126:127],1.0 op_sel_hi:[1,0]
v_pk_add_f32 v[128:129],v[128:129],1.0 op_sel_hi:[1,0]
v_pk_add_f32 v[130:131],v[130:131],1.0 op_sel_hi:[1,0]
v_pk_add_f32 v[132:133],v[132:133],1.0 op_sel_hi:[1,0]
v_pk_add_f32 v[134:135],v[134:135],1.0 op_sel_hi:[1,0]
v_pk_add_f32 v[136:137],v[136:137],1.0 op_sel_hi:[1,0]
buffer_load_dwordx4 v1,s[8:11],s63 offen offset:1024 sc1 lds
v_pk_add_f32 v[138:139],v[138:139],1.0 op_sel_hi:[1,0]
v_rcp_f32 v124,v124
v_rcp_f32 v125,v125
v_rcp_f32 v126,v126
v_rcp_f32 v127,v127
v_rcp_f32 v128,v128
v_rcp_f32 v129,v129
s_add_u32 m0,s66,40960
s_add_u32 s63,s67,40960
buffer_load_dwordx4 v1,s[8:11],s63 offen sc1 lds
v_rcp_f32 v130,v130
v_rcp_f32 v131,v131
v_rcp_f32 v132,v132
v_rcp_f32 v133,v133
v_rcp_f32 v134,v134
v_rcp_f32 v135,v135
v_rcp_f32 v136,v136
s_mov_b32 s35,s42
buffer_load_dword v3,v2,s[8:11],s35 offen sc1
s_mov_b32 s53,s33
s_mov_b32 s54,s34
s_add_u32 s32,s32,1
s_mov_b32 s33,s40
s_mov_b32 s34,s41
s_mov_b64 s[76:77],s[80:81]
v_rcp_f32 v137,v137
v_rcp_f32 v138,v138
v_rcp_f32 v139,v139
v_pk_mul_f32 v[56:57],v[56:57],v[124:125]
v_pk_mul_f32 v[58:59],v[58:59],v[126:127]
v_pk_mul_f32 v[60:61],v[60:61],v[128:129]
v_pk_mul_f32 v[62:63],v[62:63],v[130:131]
v_pk_mul_f32 v[64:65],v[64:65],v[132:133]
v_pk_mul_f32 v[66:67],v[66:67],v[134:135]
v_pk_mul_f32 v[68:69],v[68:69],v[136:137]
v_pk_mul_f32 v[70:71],v[70:71],v[138:139]
v_cvt_pk_bf16_f32 v116,v56,v57
v_cvt_pk_bf16_f32 v117,v58,v59
v_cvt_pk_bf16_f32 v118,v60,v61
v_cvt_pk_bf16_f32 v119,v62,v63
v_cvt_pk_bf16_f32 v120,v64,v65
v_cvt_pk_bf16_f32 v121,v66,v67
v_cvt_pk_bf16_f32 v122,v68,v69
v_cvt_pk_bf16_f32 v123,v70,v71
s_cmp_lg_u32 s49,0
s_cbranch_scc0 ls_274
buffer_store_dwordx4 v[116:119],v20,s[8:11],s71 offen sc1
buffer_store_dwordx4 v[120:123],v21,s[8:11],s71 offen sc1
s_branch ls_275
ls_274:
buffer_store_dwordx4 v[116:119],v20,s[8:11],s71 offen
buffer_store_dwordx4 v[120:123],v21,s[8:11],s71 offen
ls_275:
s_mov_b32 s59,s82
s_branch W1_NEXT
nr_268:
buffer_load_dword v3,v2,s[8:11],s35 offen sc1
s_branch ep_267
W1_END:
s_endpgm
ROLE_W2:
v_lshlrev_b32 v1,4,v0
v_mov_b32 v5,1
s_lshl_b32 s56,s48,2
s_add_u32 s56,s56,s46
v_bfe_u32 v6,v0,2,2
v_lshrrev_b32 v7,4,v0
v_add_u32 v7,v6,v7
v_and_b32 v7,3,v7
v_and_b32 v15,3,v0
v_lshlrev_b32 v15,4,v15
v_lshl_add_u32 v15,v7,6,v15
v_lshl_add_u32 v15,v6,8,v15
v_lshrrev_b32 v6,5,v0
v_bfe_u32 v7,v0,4,1
v_lshlrev_b32 v16,10,v7
v_lshl_add_u32 v16,v6,8,v16
v_and_b32 v6,15,v0
v_lshl_add_u32 v16,v6,4,v16
v_add_u32 v18,40960,v16
v_lshrrev_b32 v6,5,v0
v_bfe_u32 v7,v0,4,1
v_lshlrev_b32 v20,10,v7
v_lshl_add_u32 v20,v6,8,v20
v_and_b32 v6,15,v0
v_lshl_add_u32 v20,v6,4,v20
v_lshrrev_b32 v6,5,v0
v_add_u32 v6,2,v6
v_bfe_u32 v7,v0,4,1
v_lshlrev_b32 v17,10,v7
v_lshl_add_u32 v17,v6,8,v17
v_and_b32 v6,15,v0
v_lshl_add_u32 v17,v6,4,v17
v_add_u32 v19,40960,v17
v_lshrrev_b32 v6,5,v0
v_add_u32 v6,2,v6
v_bfe_u32 v7,v0,4,1
v_lshlrev_b32 v21,10,v7
v_lshl_add_u32 v21,v6,8,v21
v_and_b32 v6,15,v0
v_lshl_add_u32 v21,v6,4,v21
v_min_u32 v2,19,v0
v_lshlrev_b32 v2,2,v2
s_lshr_b32 s60,s46,1
s_add_u32 s60,s60,1
s_sub_u32 s61,32,s60
s_add_u32 s60,s60,32
s_bitcmp1_b32 s46,0
s_cselect_b32 s60,s60,s61
v_and_b32 v6,15,v0
v_add_u32 v6,s60,v6
v_lshrrev_b32 v7,5,v6
v_mul_u32_u24 v112,40960,v7
v_bfe_u32 v7,v6,4,1
v_lshl_add_u32 v112,v7,10,v112
v_and_b32 v7,15,v6
v_lshl_add_u32 v112,v7,4,v112
v_lshrrev_b32 v7,4,v0
v_lshl_add_u32 v112,v7,8,v112
v_and_b32 v6,15,v0
v_add_u32 v6,s60,v6
v_add_u32 v6,16,v6
v_lshrrev_b32 v7,5,v6
v_mul_u32_u24 v113,40960,v7
v_bfe_u32 v7,v6,4,1
v_lshl_add_u32 v113,v7,10,v113
v_and_b32 v7,15,v6
v_lshl_add_u32 v113,v7,4,v113
v_lshrrev_b32 v7,4,v0
v_lshl_add_u32 v113,v7,8,v113
v_lshrrev_b32 v6,5,v0
v_and_b32 v7,15,v0
v_lshlrev_b32 v114,3,v7
v_lshl_add_u32 v114,v6,7,v114
v_and_b32 v114,31,v0
v_lshlrev_b32 v114,3,v114
v_lshrrev_b32 v6,5,v0
v_bfe_u32 v7,v0,4,1
v_lshlrev_b32 v116,10,v7
v_bfe_u32 v7,v0,2,2
v_lshl_add_u32 v116,v7,8,v116
v_add_u32 v6,v6,v7
v_and_b32 v6,3,v6
v_lshl_add_u32 v116,v6,6,v116
v_and_b32 v6,3,v0
v_lshl_add_u32 v116,v6,4,v116
v_lshrrev_b32 v6,5,v0
v_add_u32 v6,2,v6
v_bfe_u32 v7,v0,4,1
v_lshlrev_b32 v117,10,v7
v_bfe_u32 v7,v0,2,2
v_lshl_add_u32 v117,v7,8,v117
v_add_u32 v6,v6,v7
v_and_b32 v6,3,v6
v_lshl_add_u32 v117,v6,6,v117
v_and_b32 v6,3,v0
v_lshl_add_u32 v117,v6,4,v117
v_subrev_u32 v6,40960,v112
v_cmp_gt_u32 vcc,40960,v6
s_nop 1
v_cndmask_b32 v78,0,1,vcc
v_xor_b32 v76,1,v78
v_and_b32 v74,2047,v112
v_subrev_u32 v6,40960,v113
v_cmp_gt_u32 vcc,40960,v6
s_nop 1
v_cndmask_b32 v79,0,1,vcc
v_xor_b32 v77,1,v79
v_and_b32 v75,2047,v113
s_and_b32 s68,s46,1
s_lshl_b32 s68,s68,1
s_sub_u32 s68,s68,1
s_waitcnt vmcnt(0)
s_barrier
s_cmp_lg_u32 s46,0
s_cbranch_scc1 arr_276
v_mov_b32 v6,1
s_lshl_b32 s3,s49,2
v_mov_b32 v7,s3
s_mov_b64 exec,1
buffer_atomic_add v6,v7,s[12:15],0 offen sc1
s_mov_b64 exec,-1
arr_276:
s_lshl_b32 s3,s49,2
v_mov_b32 v7,s3
s_nop 1
ibw_277:
buffer_load_dword v6,v7,s[12:15],0 offen sc1
s_waitcnt vmcnt(0)
v_cmp_ne_u32 vcc,256,v6
s_nop 0
s_cbranch_vccz ok_278
s_sleep 8
s_sub_u32 s47,s47,1
s_cbranch_scc1 ABORT
s_branch ibw_277
ok_278:
s_cmp_lg_u32 s49,0
s_cbranch_scc1 ibok_279
v_and_b32 v7,7,v0
v_lshlrev_b32 v7,2,v7
buffer_load_dword v6,v7,s[12:15],0 offen offset:32 sc1
s_waitcnt vmcnt(0)
v_cmp_ne_u32 vcc,32,v6
s_nop 0
s_cbranch_vccz ibok_279
s_barrier
s_mov_b32 s49,1
s_mov_b32 s3,s2
s_load_dwordx16 s[16:31],s[0:1],0
s_load_dwordx8 s[32:39],s[0:1],64
s_waitcnt lgkmcnt(0)
s_branch DISPATCH
ibok_279:
s_lshl_b32 s58,s56,6
s_mul_i32 s63,s46,40960
s_mov_b32 s4,s34
s_mov_b32 s5,s35
s_mov_b32 s6,819200
s_mov_b32 s7,0x20000
v_lshrrev_b32 v9,2,v0
s_mov_b32 s64,1280
v_mul_lo_u32 v9,v9,s64
v_and_b32 v10,3,v0
v_lshl_add_u32 v6,v10,4,v9
s_add_u32 m0,s63,0
s_add_u32 s65,s58,0
buffer_load_dwordx4 v6,s[4:7],s65 offen lds
s_add_u32 m0,s63,1024
s_add_u32 s65,s58,20480
buffer_load_dwordx4 v6,s[4:7],s65 offen lds
s_add_u32 m0,s63,2048
s_add_u32 s65,s58,40960
buffer_load_dwordx4 v6,s[4:7],s65 offen lds
s_add_u32 m0,s63,3072
s_add_u32 s65,s58,61440
buffer_load_dwordx4 v6,s[4:7],s65 offen lds
s_add_u32 m0,s63,4096
s_add_u32 s65,s58,81920
buffer_load_dwordx4 v6,s[4:7],s65 offen lds
s_add_u32 m0,s63,5120
s_add_u32 s65,s58,102400
buffer_load_dwordx4 v6,s[4:7],s65 offen lds
s_add_u32 m0,s63,6144
s_add_u32 s65,s58,122880
buffer_load_dwordx4 v6,s[4:7],s65 offen lds
s_add_u32 m0,s63,7168
s_add_u32 s65,s58,143360
buffer_load_dwordx4 v6,s[4:7],s65 offen lds
s_add_u32 m0,s63,8192
s_add_u32 s65,s58,163840
buffer_load_dwordx4 v6,s[4:7],s65 offen lds
s_add_u32 m0,s63,9216
s_add_u32 s65,s58,184320
buffer_load_dwordx4 v6,s[4:7],s65 offen lds
s_add_u32 m0,s63,10240
s_add_u32 s65,s58,204800
buffer_load_dwordx4 v6,s[4:7],s65 offen lds
s_add_u32 m0,s63,11264
s_add_u32 s65,s58,225280
buffer_load_dwordx4 v6,s[4:7],s65 offen lds
s_add_u32 m0,s63,12288
s_add_u32 s65,s58,245760
buffer_load_dwordx4 v6,s[4:7],s65 offen lds
s_add_u32 m0,s63,13312
s_add_u32 s65,s58,266240
buffer_load_dwordx4 v6,s[4:7],s65 offen lds
s_add_u32 m0,s63,14336
s_add_u32 s65,s58,286720
buffer_load_dwordx4 v6,s[4:7],s65 offen lds
s_add_u32 m0,s63,15360
s_add_u32 s65,s58,307200
buffer_load_dwordx4 v6,s[4:7],s65 offen lds
s_add_u32 m0,s63,16384
s_add_u32 s65,s58,327680
buffer_load_dwordx4 v6,s[4:7],s65 offen lds
s_add_u32 m0,s63,17408
s_add_u32 s65,s58,348160
buffer_load_dwordx4 v6,s[4:7],s65 offen lds
s_add_u32 m0,s63,18432
s_add_u32 s65,s58,368640
buffer_load_dwordx4 v6,s[4:7],s65 offen lds
s_add_u32 m0,s63,19456
s_add_u32 s65,s58,389120
buffer_load_dwordx4 v6,s[4:7],s65 offen lds
s_add_u32 m0,s63,20480
s_add_u32 s65,s58,409600
buffer_load_dwordx4 v6,s[4:7],s65 offen lds
s_add_u32 m0,s63,21504
s_add_u32 s65,s58,430080
buffer_load_dwordx4 v6,s[4:7],s65 offen lds
s_add_u32 m0,s63,22528
s_add_u32 s65,s58,450560
buffer_load_dwordx4 v6,s[4:7],s65 offen lds
s_add_u32 m0,s63,23552
s_add_u32 s65,s58,471040
buffer_load_dwordx4 v6,s[4:7],s65 offen lds
s_add_u32 m0,s63,24576
s_add_u32 s65,s58,491520
buffer_load_dwordx4 v6,s[4:7],s65 offen lds
s_add_u32 m0,s63,25600
s_add_u32 s65,s58,512000
buffer_load_dwordx4 v6,s[4:7],s65 offen lds
s_add_u32 m0,s63,26624
s_add_u32 s65,s58,532480
buffer_load_dwordx4 v6,s[4:7],s65 offen lds
s_add_u32 m0,s63,27648
s_add_u32 s65,s58,552960
buffer_load_dwordx4 v6,s[4:7],s65 offen lds
s_add_u32 m0,s63,28672
s_add_u32 s65,s58,573440
buffer_load_dwordx4 v6,s[4:7],s65 offen lds
s_add_u32 m0,s63,29696
s_add_u32 s65,s58,593920
buffer_load_dwordx4 v6,s[4:7],s65 offen lds
s_add_u32 m0,s63,30720
s_add_u32 s65,s58,614400
buffer_load_dwordx4 v6,s[4:7],s65 offen lds
s_add_u32 m0,s63,31744
s_add_u32 s65,s58,634880
buffer_load_dwordx4 v6,s[4:7],s65 offen lds
s_add_u32 m0,s63,32768
s_add_u32 s65,s58,655360
buffer_load_dwordx4 v6,s[4:7],s65 offen lds
s_add_u32 m0,s63,33792
s_add_u32 s65,s58,675840
buffer_load_dwordx4 v6,s[4:7],s65 offen lds
s_add_u32 m0,s63,34816
s_add_u32 s65,s58,696320
buffer_load_dwordx4 v6,s[4:7],s65 offen lds
s_add_u32 m0,s63,35840
s_add_u32 s65,s58,716800
buffer_load_dwordx4 v6,s[4:7],s65 offen lds
s_add_u32 m0,s63,36864
s_add_u32 s65,s58,737280
buffer_load_dwordx4 v6,s[4:7],s65 offen lds
s_add_u32 m0,s63,37888
s_add_u32 s65,s58,757760
buffer_load_dwordx4 v6,s[4:7],s65 offen lds
s_add_u32 m0,s63,38912
s_add_u32 s65,s58,778240
buffer_load_dwordx4 v6,s[4:7],s65 offen lds
s_add_u32 m0,s63,39936
s_add_u32 s65,s58,798720
buffer_load_dwordx4 v6,s[4:7],s65 offen lds
s_waitcnt vmcnt(20)
v_bfe_u32 v9,v0,2,2
v_lshrrev_b32 v10,5,v0
v_lshl_add_u32 v9,v10,2,v9
v_mul_u32_u24 v9,64,v9
v_and_b32 v10,1,v0
v_lshl_add_u32 v9,v10,3,v9
v_bfe_u32 v10,v0,1,1
v_lshl_add_u32 v9,v10,5,v9
v_bfe_u32 v10,v0,4,1
v_lshl_add_u32 v9,v10,4,v9
v_add_u32 v7,s63,v9
ds_read_b64_tr_b16 a[0:1],v7 offset:0
ds_read_b64_tr_b16 a[2:3],v7 offset:1024
ds_read_b64_tr_b16 a[4:5],v7 offset:512
ds_read_b64_tr_b16 a[6:7],v7 offset:1536
ds_read_b64_tr_b16 a[8:9],v7 offset:2048
ds_read_b64_tr_b16 a[10:11],v7 offset:3072
ds_read_b64_tr_b16 a[12:13],v7 offset:2560
ds_read_b64_tr_b16 a[14:15],v7 offset:3584
ds_read_b64_tr_b16 a[16:17],v7 offset:4096
ds_read_b64_tr_b16 a[18:19],v7 offset:5120
ds_read_b64_tr_b16 a[20:21],v7 offset:4608
ds_read_b64_tr_b16 a[22:23],v7 offset:5632
s_waitcnt lgkmcnt(4)
ds_read_b64_tr_b16 a[24:25],v7 offset:6144
ds_read_b64_tr_b16 a[26:27],v7 offset:7168
ds_read_b64_tr_b16 a[28:29],v7 offset:6656
ds_read_b64_tr_b16 a[30:31],v7 offset:7680
ds_read_b64_tr_b16 a[32:33],v7 offset:8192
ds_read_b64_tr_b16 a[34:35],v7 offset:9216
ds_read_b64_tr_b16 a[36:37],v7 offset:8704
ds_read_b64_tr_b16 a[38:39],v7 offset:9728
ds_read_b64_tr_b16 a[40:41],v7 offset:10240
ds_read_b64_tr_b16 a[42:43],v7 offset:11264
ds_read_b64_tr_b16 a[44:45],v7 offset:10752
ds_read_b64_tr_b16 a[46:47],v7 offset:11776
s_waitcnt lgkmcnt(4)
ds_read_b64_tr_b16 a[48:49],v7 offset:12288
ds_read_b64_tr_b16 a[50:51],v7 offset:13312
ds_read_b64_tr_b16 a[52:53],v7 offset:12800
ds_read_b64_tr_b16 a[54:55],v7 offset:13824
ds_read_b64_tr_b16 a[56:57],v7 offset:14336
ds_read_b64_tr_b16 a[58:59],v7 offset:15360
ds_read_b64_tr_b16 a[60:61],v7 offset:14848
ds_read_b64_tr_b16 a[62:63],v7 offset:15872
ds_read_b64_tr_b16 a[64:65],v7 offset:16384
ds_read_b64_tr_b16 a[66:67],v7 offset:17408
ds_read_b64_tr_b16 a[68:69],v7 offset:16896
ds_read_b64_tr_b16 a[70:71],v7 offset:17920
s_waitcnt lgkmcnt(4)
ds_read_b64_tr_b16 a[72:73],v7 offset:18432
ds_read_b64_tr_b16 a[74:75],v7 offset:19456
ds_read_b64_tr_b16 a[76:77],v7 offset:18944
ds_read_b64_tr_b16 a[78:79],v7 offset:19968
s_waitcnt lgkmcnt(0)
s_waitcnt vmcnt(0)
v_bfe_u32 v9,v0,2,2
v_lshrrev_b32 v10,5,v0
v_lshl_add_u32 v9,v10,2,v9
v_mul_u32_u24 v9,64,v9
v_and_b32 v10,1,v0
v_lshl_add_u32 v9,v10,3,v9
v_bfe_u32 v10,v0,1,1
v_lshl_add_u32 v9,v10,5,v9
v_bfe_u32 v10,v0,4,1
v_lshl_add_u32 v9,v10,4,v9
v_add_u32 v7,s63,v9
ds_read_b64_tr_b16 a[80:81],v7 offset:20480
ds_read_b64_tr_b16 a[82:83],v7 offset:21504
ds_read_b64_tr_b16 a[84:85],v7 offset:20992
ds_read_b64_tr_b16 a[86:87],v7 offset:22016
ds_read_b64_tr_b16 a[88:89],v7 offset:22528
ds_read_b64_tr_b16 a[90:91],v7 offset:23552
ds_read_b64_tr_b16 a[92:93],v7 offset:23040
ds_read_b64_tr_b16 a[94:95],v7 offset:24064
ds_read_b64_tr_b16 a[96:97],v7 offset:24576
ds_read_b64_tr_b16 a[98:99],v7 offset:25600
ds_read_b64_tr_b16 a[100:101],v7 offset:25088
ds_read_b64_tr_b16 a[102:103],v7 offset:26112
s_waitcnt lgkmcnt(4)
ds_read_b64_tr_b16 a[104:105],v7 offset:26624
ds_read_b64_tr_b16 a[106:107],v7 offset:27648
ds_read_b64_tr_b16 a[108:109],v7 offset:27136
ds_read_b64_tr_b16 a[110:111],v7 offset:28160
ds_read_b64_tr_b16 a[112:113],v7 offset:28672
ds_read_b64_tr_b16 a[114:115],v7 offset:29696
ds_read_b64_tr_b16 a[116:117],v7 offset:29184
ds_read_b64_tr_b16 a[118:119],v7 offset:30208
ds_read_b64_tr_b16 a[120:121],v7 offset:30720
ds_read_b64_tr_b16 a[122:123],v7 offset:31744
ds_read_b64_tr_b16 a[124:125],v7 offset:31232
ds_read_b64_tr_b16 a[126:127],v7 offset:32256
s_waitcnt lgkmcnt(4)
ds_read_b64_tr_b16 a[128:129],v7 offset:32768
ds_read_b64_tr_b16 a[130:131],v7 offset:33792
ds_read_b64_tr_b16 a[132:133],v7 offset:33280
ds_read_b64_tr_b16 a[134:135],v7 offset:34304
ds_read_b64_tr_b16 a[136:137],v7 offset:34816
ds_read_b64_tr_b16 a[138:139],v7 offset:35840
ds_read_b64_tr_b16 a[140:141],v7 offset:35328
ds_read_b64_tr_b16 a[142:143],v7 offset:36352
ds_read_b64_tr_b16 a[144:145],v7 offset:36864
ds_read_b64_tr_b16 a[146:147],v7 offset:37888
ds_read_b64_tr_b16 a[148:149],v7 offset:37376
ds_read_b64_tr_b16 a[150:151],v7 offset:38400
s_waitcnt lgkmcnt(4)
ds_read_b64_tr_b16 a[152:153],v7 offset:38912
ds_read_b64_tr_b16 a[154:155],v7 offset:39936
ds_read_b64_tr_b16 a[156:157],v7 offset:39424
ds_read_b64_tr_b16 a[158:159],v7 offset:40448
s_waitcnt lgkmcnt(0)
s_barrier
s_mov_b32 s50,0
s_mov_b32 s32,0
s_mov_b32 s57,0
s_mov_b32 s59,2147483648
s_mov_b32 s82,2147483648
s_mov_b32 s39,2147483648
v_mov_b32 v22,83968
v_lshl_add_u32 v22,v0,2,v22
v_mov_b32 v23,0
ds_write_b32 v22,v23
s_mov_b32 s39,1600000
v_and_b32 v72,15,v0
v_lshlrev_b32 v72,7,v72
s_mul_i32 s60,s56,-1792
s_add_u32 s60,s60,40960
v_and_b32 v6,128,v72
v_add_u32 v6,s60,v6
v_cmp_lt_u32 vcc,15,v0
s_nop 1
v_cndmask_b32 v72,v72,v6,vcc
v_min_u32 v6,59,v0
v_lshlrev_b32 v6,2,v6
v_add_u32 v2,135168,v6
v_add_u32 v7,-80,v6
v_cmp_gt_u32 s[78:79],20,v0
s_nop 1
v_cndmask_b32 v2,v7,v2,s[78:79]
s_mov_b32 s51,0
s_mov_b32 s52,0
s_mul_i32 s62,s51,8
s_and_b32 s63,s52,7
s_add_u32 s62,s62,s63
s_mul_i32 s62,s62,46080
s_add_u32 s62,s62,212467712
s_lshl_b32 s63,s56,11
s_add_u32 s62,s62,s63
buffer_load_dword v73,v72,s[8:11],s62 offen sc1
s_mov_b32 s51,0
s_mov_b32 s52,1
s_mul_i32 s62,s51,8
s_and_b32 s63,s52,7
s_add_u32 s62,s62,s63
s_mul_i32 s62,s62,46080
s_add_u32 s62,s62,212467712
s_lshl_b32 s63,s56,11
s_add_u32 s62,s62,s63
buffer_load_dword v73,v72,s[8:11],s62 offen sc1
s_mov_b32 s51,0
s_mov_b32 s52,2
s_mul_i32 s62,s51,8
s_and_b32 s63,s52,7
s_add_u32 s62,s62,s63
s_mul_i32 s62,s62,46080
s_add_u32 s62,s62,212467712
s_lshl_b32 s63,s56,11
s_add_u32 s62,s62,s63
buffer_load_dword v73,v72,s[8:11],s62 offen sc1
s_mov_b32 s51,0
s_mov_b32 s52,3
s_mul_i32 s62,s51,8
s_and_b32 s63,s52,7
s_add_u32 s62,s62,s63
s_mul_i32 s62,s62,46080
s_add_u32 s62,s62,212467712
s_lshl_b32 s63,s56,11
s_add_u32 s62,s62,s63
buffer_load_dword v73,v72,s[8:11],s62 offen sc1
s_mov_b32 s51,0
s_mov_b32 s52,4
s_mul_i32 s62,s51,8
s_and_b32 s63,s52,7
s_add_u32 s62,s62,s63
s_mul_i32 s62,s62,46080
s_add_u32 s62,s62,212467712
s_lshl_b32 s63,s56,11
s_add_u32 s62,s62,s63
buffer_load_dword v73,v72,s[8:11],s62 offen sc1
s_mov_b32 s51,0
s_mov_b32 s52,5
s_mul_i32 s62,s51,8
s_and_b32 s63,s52,7
s_add_u32 s62,s62,s63
s_mul_i32 s62,s62,46080
s_add_u32 s62,s62,212467712
s_lshl_b32 s63,s56,11
s_add_u32 s62,s62,s63
buffer_load_dword v73,v72,s[8:11],s62 offen sc1
s_mov_b32 s51,0
s_mov_b32 s52,6
s_mul_i32 s62,s51,8
s_and_b32 s63,s52,7
s_add_u32 s62,s62,s63
s_mul_i32 s62,s62,46080
s_add_u32 s62,s62,212467712
s_lshl_b32 s63,s56,11
s_add_u32 s62,s62,s63
buffer_load_dword v73,v72,s[8:11],s62 offen sc1
s_mov_b32 s51,0
s_mov_b32 s52,7
s_mul_i32 s62,s51,8
s_and_b32 s63,s52,7
s_add_u32 s62,s62,s63
s_mul_i32 s62,s62,46080
s_add_u32 s62,s62,212467712
s_lshl_b32 s63,s56,11
s_add_u32 s62,s62,s63
buffer_load_dword v73,v72,s[8:11],s62 offen sc1
s_mov_b32 s51,1
s_mov_b32 s52,0
s_mul_i32 s62,s51,8
s_and_b32 s63,s52,7
s_add_u32 s62,s62,s63
s_mul_i32 s62,s62,46080
s_add_u32 s62,s62,212467712
s_lshl_b32 s63,s56,11
s_add_u32 s62,s62,s63
buffer_load_dword v73,v72,s[8:11],s62 offen sc1
s_mov_b32 s51,1
s_mov_b32 s52,1
s_mul_i32 s62,s51,8
s_and_b32 s63,s52,7
s_add_u32 s62,s62,s63
s_mul_i32 s62,s62,46080
s_add_u32 s62,s62,212467712
s_lshl_b32 s63,s56,11
s_add_u32 s62,s62,s63
buffer_load_dword v73,v72,s[8:11],s62 offen sc1
s_mov_b32 s51,1
s_mov_b32 s52,2
s_mul_i32 s62,s51,8
s_and_b32 s63,s52,7
s_add_u32 s62,s62,s63
s_mul_i32 s62,s62,46080
s_add_u32 s62,s62,212467712
s_lshl_b32 s63,s56,11
s_add_u32 s62,s62,s63
buffer_load_dword v73,v72,s[8:11],s62 offen sc1
s_mov_b32 s51,1
s_mov_b32 s52,3
s_mul_i32 s62,s51,8
s_and_b32 s63,s52,7
s_add_u32 s62,s62,s63
s_mul_i32 s62,s62,46080
s_add_u32 s62,s62,212467712
s_lshl_b32 s63,s56,11
s_add_u32 s62,s62,s63
buffer_load_dword v73,v72,s[8:11],s62 offen sc1
s_mov_b32 s51,1
s_mov_b32 s52,4
s_mul_i32 s62,s51,8
s_and_b32 s63,s52,7
s_add_u32 s62,s62,s63
s_mul_i32 s62,s62,46080
s_add_u32 s62,s62,212467712
s_lshl_b32 s63,s56,11
s_add_u32 s62,s62,s63
buffer_load_dword v73,v72,s[8:11],s62 offen sc1
s_mov_b32 s51,1
s_mov_b32 s52,5
s_mul_i32 s62,s51,8
s_and_b32 s63,s52,7
s_add_u32 s62,s62,s63
s_mul_i32 s62,s62,46080
s_add_u32 s62,s62,212467712
s_lshl_b32 s63,s56,11
s_add_u32 s62,s62,s63
buffer_load_dword v73,v72,s[8:11],s62 offen sc1
s_mov_b32 s51,1
s_mov_b32 s52,6
s_mul_i32 s62,s51,8
s_and_b32 s63,s52,7
s_add_u32 s62,s62,s63
s_mul_i32 s62,s62,46080
s_add_u32 s62,s62,212467712
s_lshl_b32 s63,s56,11
s_add_u32 s62,s62,s63
buffer_load_dword v73,v72,s[8:11],s62 offen sc1
s_mov_b32 s51,1
s_mov_b32 s52,7
s_mul_i32 s62,s51,8
s_and_b32 s63,s52,7
s_add_u32 s62,s62,s63
s_mul_i32 s62,s62,46080
s_add_u32 s62,s62,212467712
s_lshl_b32 s63,s56,11
s_add_u32 s62,s62,s63
buffer_load_dword v73,v72,s[8:11],s62 offen sc1
s_waitcnt vmcnt(0)
s_waitcnt lgkmcnt(0)
s_barrier
s_mov_b32 s83,s100
s_min_u32 s62,s32,127
s_sub_u32 s60,s62,16
s_lshr_b32 s34,s60,1
s_and_b32 s33,s60,1
s_cmp_eq_u32 s33,0
s_cselect_b32 s61,16,0
s_add_u32 s34,s34,s61
s_sub_u32 s61,s60,48
s_cmp_ge_u32 s60,96
s_cselect_b32 s34,s61,s34
s_cselect_b32 s33,1,s33
s_cmp_lt_u32 s62,16
s_cselect_b32 s34,s62,s34
s_cselect_b32 s33,0,s33
s_add_u32 s60,s34,1
s_min_u32 s60,s60,63
s_lshl_b32 s35,s33,6
s_add_u32 s35,s35,s60
s_lshl_b32 s35,s35,9
s_add_u32 s35,s35,323584
s_cmp_lt_u32 s60,8
s_cselect_b64 s[76:77],s[78:79],-1
s_sub_u32 s57,40960,s57
v_swap_b32 v16,v18
v_swap_b32 v17,v19
s_add_u32 s62,s32,1
s_min_u32 s62,s62,127
s_sub_u32 s60,s62,16
s_lshr_b32 s41,s60,1
s_and_b32 s40,s60,1
s_cmp_eq_u32 s40,0
s_cselect_b32 s61,16,0
s_add_u32 s41,s41,s61
s_sub_u32 s61,s60,48
s_cmp_ge_u32 s60,96
s_cselect_b32 s41,s61,s41
s_cselect_b32 s40,1,s40
s_cmp_lt_u32 s62,16
s_cselect_b32 s41,s62,s41
s_cselect_b32 s40,0,s40
s_add_u32 s60,s41,1
s_min_u32 s60,s60,63
s_lshl_b32 s42,s40,6
s_add_u32 s42,s42,s60
s_lshl_b32 s42,s42,9
s_add_u32 s42,s42,323584
s_cmp_lt_u32 s60,8
s_cselect_b64 s[80:81],s[78:79],-1
W2_COLD:
s_mov_b32 s37,0
fb_280:
buffer_load_dword v3,v2,s[8:11],s35 offen sc1
s_waitcnt vmcnt(0)
v_cmp_eq_u32 vcc,0,v3
s_and_b64 vcc,vcc,s[76:77]
s_cbranch_scc0 ok_281
s_sleep 1
s_sub_u32 s47,s47,1
s_cbranch_scc1 ABORT
s_branch fb_280
ok_281:
W2_COLD2:
s_sub_u32 s66,40960,s57
s_add_u32 s61,s34,s68
s_and_b32 s62,s61,7
s_cmp_lt_u32 s61,64
s_cselect_b32 s62,s62,8
s_mul_i32 s62,s62,40960
s_and_b32 s61,s34,7
s_mul_i32 s61,s61,40960
v_mad_u32_u24 v112,v76,s62,v74
v_mad_u32_u24 v112,v78,s61,v112
v_mad_u32_u24 v113,v77,s62,v75
v_mad_u32_u24 v113,v79,s61,v113
s_mov_b32 s60,s33
s_mul_i32 s60,s60,368640
s_add_u32 s60,s60,s37
s_mul_i32 s61,s46,10240
s_add_u32 s60,s60,s61
s_add_u32 s60,s60,237371392
s_add_u32 s61,s61,s66
s_add_u32 m0,s61,0
s_add_u32 s63,s60,0
buffer_load_dwordx4 v112,s[8:11],s63 offen sc1 lds
s_add_u32 m0,s61,1024
s_nop 0
buffer_load_dwordx4 v113,s[8:11],s63 offen sc1 lds
s_add_u32 m0,s61,2048
s_add_u32 s63,s60,2048
buffer_load_dwordx4 v112,s[8:11],s63 offen sc1 lds
s_add_u32 m0,s61,3072
s_nop 0
buffer_load_dwordx4 v113,s[8:11],s63 offen sc1 lds
s_add_u32 m0,s61,4096
s_add_u32 s63,s60,4096
buffer_load_dwordx4 v112,s[8:11],s63 offen sc1 lds
s_add_u32 m0,s61,5120
s_nop 0
buffer_load_dwordx4 v113,s[8:11],s63 offen sc1 lds
s_waitcnt vmcnt(5)
s_mov_b64 exec,1
s_cmp_lg_u32 s49,0
s_cbranch_scc0 ls_282
buffer_store_dword v5,v1,s[8:11],s59 offen sc1
s_branch ls_283
ls_282:
buffer_store_dword v5,v1,s[8:11],s59 offen
ls_283:
s_mov_b64 exec,-1
s_mov_b32 s59,2147483648
s_add_u32 m0,s61,6144
s_add_u32 s63,s60,6144
buffer_load_dwordx4 v112,s[8:11],s63 offen sc1 lds
s_add_u32 m0,s61,7168
s_nop 0
buffer_load_dwordx4 v113,s[8:11],s63 offen sc1 lds
s_add_u32 m0,s61,8192
s_add_u32 s63,s60,8192
buffer_load_dwordx4 v112,s[8:11],s63 offen sc1 lds
s_add_u32 m0,s61,9216
s_nop 0
buffer_load_dwordx4 v113,s[8:11],s63 offen sc1 lds
s_mov_b32 s35,s42
s_mov_b32 s53,s33
s_mov_b32 s54,s34
s_add_u32 s32,s32,1
s_mov_b32 s33,s40
s_mov_b32 s34,s41
s_mov_b64 s[76:77],s[80:81]
s_sub_u32 s57,40960,s57
v_swap_b32 v16,v18
v_swap_b32 v17,v19
s_mov_b32 s51,s53
s_mov_b32 s52,s54
s_waitcnt vmcnt(5)
s_branch W2_GO
W2_NEXT:
s_sub_u32 s57,40960,s57
v_swap_b32 v16,v18
v_swap_b32 v17,v19
s_mov_b32 s51,s53
s_mov_b32 s52,s54
s_waitcnt vmcnt(3)
W2_GO:
s_barrier
ds_read_b128 v[24:27],v16 offset:0
ds_read_b128 v[28:31],v17 offset:0
ds_read_b128 v[32:35],v16 offset:10240
ds_read_b128 v[36:39],v17 offset:10240
ds_read_b128 v[40:43],v16 offset:20480
ds_read_b128 v[44:47],v17 offset:20480
ds_read_b128 v[48:51],v16 offset:30720
buffer_load_dword v3,v2,s[8:11],s35 offen sc1
s_waitcnt lgkmcnt(6)
v_mfma_f32_32x32x16_bf16 v[56:71],a[0:3],v[24:27],0
ds_read_b128 v[52:55],v17 offset:30720
s_lshl_b32 s60,s51,6
s_add_u32 s60,s60,s52
s_mul_i32 s60,s60,46080
s_waitcnt lgkmcnt(6)
v_mfma_f32_32x32x16_bf16 v[56:71],a[4:7],v[28:31],v[56:71]
ds_read_b128 v[24:27],v16 offset:2048
s_lshl_b32 s61,s56,11
s_add_u32 s60,s60,s61
s_add_u32 s60,s60,223608832
s_waitcnt lgkmcnt(5)
v_mfma_f32_32x32x16_bf16 v[56:71],a[40:43],v[32:35],v[56:71]
ds_read_b128 v[28:31],v17 offset:2048
buffer_load_dwordx4 v[120:123],v116,s[8:11],s60 offen sc1
buffer_load_dwordx4 v[124:127],v117,s[8:11],s60 offen sc1
v_mfma_f32_32x32x16_bf16 v[56:71],a[44:47],v[36:39],v[56:71]
ds_read_b128 v[32:35],v16 offset:12288
s_add_u32 s62,s32,1
s_min_u32 s62,s62,127
s_sub_u32 s60,s62,16
s_waitcnt lgkmcnt(5)
v_mfma_f32_32x32x16_bf16 v[56:71],a[80:83],v[40:43],v[56:71]
ds_read_b128 v[36:39],v17 offset:12288
s_lshr_b32 s41,s60,1
s_and_b32 s40,s60,1
s_cmp_eq_u32 s40,0
s_cselect_b32 s61,16,0
v_mfma_f32_32x32x16_bf16 v[56:71],a[84:87],v[44:47],v[56:71]
ds_read_b128 v[40:43],v16 offset:22528
s_add_u32 s41,s41,s61
s_sub_u32 s61,s60,48
s_mul_i32 s71,s51,8
s_waitcnt lgkmcnt(5)
v_mfma_f32_32x32x16_bf16 v[56:71],a[120:123],v[48:51],v[56:71]
ds_read_b128 v[44:47],v17 offset:22528
s_cmp_ge_u32 s60,96
s_cselect_b32 s41,s61,s41
s_cselect_b32 s40,1,s40
s_and_b32 s72,s52,7
v_mfma_f32_32x32x16_bf16 v[56:71],a[124:127],v[52:55],v[56:71]
ds_read_b128 v[48:51],v16 offset:32768
s_cmp_lt_u32 s62,16
s_cselect_b32 s41,s62,s41
s_cselect_b32 s40,0,s40
s_waitcnt lgkmcnt(5)
v_mfma_f32_32x32x16_bf16 v[56:71],a[8:11],v[24:27],v[56:71]
ds_read_b128 v[52:55],v17 offset:32768
s_add_u32 s60,s41,1
s_min_u32 s60,s60,63
s_lshl_b32 s42,s40,6
s_add_u32 s42,s42,s60
v_mfma_f32_32x32x16_bf16 v[56:71],a[12:15],v[28:31],v[56:71]
ds_read_b128 v[24:27],v16 offset:4096
s_lshl_b32 s42,s42,9
s_add_u32 s42,s42,323584
s_add_u32 s71,s71,s72
s_waitcnt lgkmcnt(5)
v_mfma_f32_32x32x16_bf16 v[56:71],a[48:51],v[32:35],v[56:71]
ds_read_b128 v[28:31],v17 offset:4096
s_cmp_lt_u32 s60,8
s_cselect_b64 s[80:81],s[78:79],-1
s_mul_i32 s71,s71,46080
s_add_u32 s71,s71,212467712
v_mfma_f32_32x32x16_bf16 v[56:71],a[52:55],v[36:39],v[56:71]
ds_read_b128 v[32:35],v16 offset:14336
s_lshl_b32 s72,s56,8
s_add_u32 s72,s72,s71
s_add_u32 s72,s72,40960
s_waitcnt lgkmcnt(5)
v_mfma_f32_32x32x16_bf16 v[56:71],a[88:91],v[40:43],v[56:71]
ds_read_b128 v[36:39],v17 offset:14336
s_waitcnt vmcnt(2)
s_mov_b64 exec,1
s_cmp_lg_u32 s49,0
s_cbranch_scc0 ls_284
buffer_store_dword v5,v1,s[8:11],s59 offen sc1
s_branch ls_285
ls_284:
buffer_store_dword v5,v1,s[8:11],s59 offen
ls_285:
s_mov_b64 exec,-1
s_mov_b32 s59,2147483648
v_mfma_f32_32x32x16_bf16 v[56:71],a[92:95],v[44:47],v[56:71]
ds_read_b128 v[40:43],v16 offset:24576
v_cmp_eq_u32 vcc,0,v3
s_and_b64 vcc,vcc,s[76:77]
s_cselect_b32 s37,2147483648,0
s_waitcnt lgkmcnt(5)
v_mfma_f32_32x32x16_bf16 v[56:71],a[128:131],v[48:51],v[56:71]
ds_read_b128 v[44:47],v17 offset:24576
s_cmp_lt_u32 s32,128
s_cselect_b32 s37,s37,2147483648
s_sub_u32 s66,40960,s57
s_add_u32 s61,s34,s68
v_mfma_f32_32x32x16_bf16 v[56:71],a[132:135],v[52:55],v[56:71]
ds_read_b128 v[48:51],v16 offset:34816
s_and_b32 s62,s61,7
s_cmp_lt_u32 s61,64
s_cselect_b32 s62,s62,8
s_waitcnt lgkmcnt(5)
v_mfma_f32_32x32x16_bf16 v[56:71],a[16:19],v[24:27],v[56:71]
ds_read_b128 v[52:55],v17 offset:34816
s_mul_i32 s62,s62,40960
s_and_b32 s61,s34,7
s_mul_i32 s61,s61,40960
v_mad_u32_u24 v112,v76,s62,v74
s_barrier
v_mfma_f32_32x32x16_bf16 v[56:71],a[20:23],v[28:31],v[56:71]
ds_read_b128 v[24:27],v16 offset:6144
v_mad_u32_u24 v112,v78,s61,v112
v_mad_u32_u24 v113,v77,s62,v75
v_mad_u32_u24 v113,v79,s61,v113
s_waitcnt lgkmcnt(5)
v_mfma_f32_32x32x16_bf16 v[56:71],a[56:59],v[32:35],v[56:71]
ds_read_b128 v[28:31],v17 offset:6144
s_mov_b32 s60,s33
s_mul_i32 s60,s60,368640
s_add_u32 s60,s60,s37
s_mul_i32 s61,s46,10240
v_mfma_f32_32x32x16_bf16 v[56:71],a[60:63],v[36:39],v[56:71]
ds_read_b128 v[32:35],v16 offset:16384
s_add_u32 s60,s60,s61
s_add_u32 s60,s60,237371392
s_add_u32 s61,s61,s66
s_waitcnt lgkmcnt(5)
v_mfma_f32_32x32x16_bf16 v[56:71],a[96:99],v[40:43],v[56:71]
ds_read_b128 v[36:39],v17 offset:16384
s_add_u32 m0,s61,0
s_add_u32 s63,s60,0
buffer_load_dwordx4 v112,s[8:11],s63 offen sc1 lds
v_mfma_f32_32x32x16_bf16 v[56:71],a[100:103],v[44:47],v[56:71]
ds_read_b128 v[40:43],v16 offset:26624
s_add_u32 m0,s61,1024
s_lshl_b32 s73,s56,11
s_add_u32 s71,s71,s73
s_waitcnt lgkmcnt(5)
v_mfma_f32_32x32x16_bf16 v[56:71],a[136:139],v[48:51],v[56:71]
ds_read_b128 v[44:47],v17 offset:26624
buffer_load_dwordx4 v113,s[8:11],s63 offen sc1 lds
s_add_u32 m0,s61,2048
s_add_u32 s63,s60,2048
v_mfma_f32_32x32x16_bf16 v[56:71],a[140:143],v[52:55],v[56:71]
ds_read_b128 v[48:51],v16 offset:36864
s_lshl_b32 s82,s51,6
s_add_u32 s82,s82,s52
s_lshl_b32 s82,s82,9
s_waitcnt lgkmcnt(5)
v_mfma_f32_32x32x16_bf16 v[56:71],a[24:27],v[24:27],v[56:71]
ds_read_b128 v[52:55],v17 offset:36864
buffer_load_dwordx4 v112,s[8:11],s63 offen sc1 lds
s_add_u32 m0,s61,3072
s_add_u32 s82,s82,524288
v_mfma_f32_32x32x16_bf16 v[56:71],a[28:31],v[28:31],v[56:71]
ds_read_b128 v[24:27],v16 offset:8192
s_lshl_b32 s70,s56,2
s_add_u32 s82,s82,s70
s_waitcnt lgkmcnt(5)
v_mfma_f32_32x32x16_bf16 v[56:71],a[64:67],v[32:35],v[56:71]
ds_read_b128 v[28:31],v17 offset:8192
buffer_load_dwordx4 v113,s[8:11],s63 offen sc1 lds
s_add_u32 m0,s61,4096
s_add_u32 s63,s60,4096
v_mfma_f32_32x32x16_bf16 v[56:71],a[68:71],v[36:39],v[56:71]
ds_read_b128 v[32:35],v16 offset:18432
s_waitcnt lgkmcnt(5)
v_mfma_f32_32x32x16_bf16 v[56:71],a[104:107],v[40:43],v[56:71]
ds_read_b128 v[36:39],v17 offset:18432
buffer_load_dwordx4 v112,s[8:11],s63 offen sc1 lds
s_add_u32 m0,s61,5120
v_mfma_f32_32x32x16_bf16 v[56:71],a[108:111],v[44:47],v[56:71]
ds_read_b128 v[40:43],v16 offset:28672
s_waitcnt lgkmcnt(5)
v_mfma_f32_32x32x16_bf16 v[56:71],a[144:147],v[48:51],v[56:71]
ds_read_b128 v[44:47],v17 offset:28672
buffer_load_dword v3,v2,s[8:11],s35 offen sc1
v_mfma_f32_32x32x16_bf16 v[56:71],a[148:151],v[52:55],v[56:71]
ds_read_b128 v[48:51],v16 offset:38912
buffer_load_dwordx4 v113,s[8:11],s63 offen sc1 lds
s_add_u32 m0,s61,6144
s_waitcnt lgkmcnt(5)
v_mfma_f32_32x32x16_bf16 v[56:71],a[32:35],v[24:27],v[56:71]
ds_read_b128 v[52:55],v17 offset:38912
s_add_u32 s63,s60,6144
v_mfma_f32_32x32x16_bf16 v[56:71],a[36:39],v[28:31],v[56:71]
buffer_load_dwordx4 v112,s[8:11],s63 offen sc1 lds
s_add_u32 m0,s61,7168
s_waitcnt lgkmcnt(4)
v_mfma_f32_32x32x16_bf16 v[56:71],a[72:75],v[32:35],v[56:71]
v_mfma_f32_32x32x16_bf16 v[56:71],a[76:79],v[36:39],v[56:71]
buffer_load_dwordx4 v113,s[8:11],s63 offen sc1 lds
s_add_u32 m0,s61,8192
s_add_u32 s63,s60,8192
s_waitcnt lgkmcnt(2)
v_mfma_f32_32x32x16_bf16 v[56:71],a[112:115],v[40:43],v[56:71]
v_mfma_f32_32x32x16_bf16 v[56:71],a[116:119],v[44:47],v[56:71]
buffer_load_dwordx4 v112,s[8:11],s63 offen sc1 lds
s_add_u32 m0,s61,9216
s_waitcnt lgkmcnt(0)
v_mfma_f32_32x32x16_bf16 v[56:71],a[152:155],v[48:51],v[56:71]
v_mfma_f32_32x32x16_bf16 v[56:71],a[156:159],v[52:55],v[56:71]
buffer_load_dwordx4 v113,s[8:11],s63 offen sc1 lds
s_waitcnt vmcnt(12)
v_lshlrev_b32 v128,16,v120
v_and_b32 v129,0xffff0000,v120
v_lshlrev_b32 v130,16,v121
v_and_b32 v131,0xffff0000,v121
v_lshlrev_b32 v132,16,v122
v_and_b32 v133,0xffff0000,v122
v_lshlrev_b32 v134,16,v123
v_and_b32 v135,0xffff0000,v123
v_lshlrev_b32 v136,16,v124
v_and_b32 v137,0xffff0000,v124
v_lshlrev_b32 v138,16,v125
v_and_b32 v139,0xffff0000,v125
v_lshlrev_b32 v140,16,v126
v_and_b32 v141,0xffff0000,v126
v_lshlrev_b32 v142,16,v127
v_and_b32 v143,0xffff0000,v127
s_cmp_eq_u32 s37,0
s_cbranch_scc0 sec_288
s_mov_b32 s35,s42
s_mov_b32 s53,s33
s_mov_b32 s54,s34
s_add_u32 s32,s32,1
s_mov_b32 s33,s40
s_mov_b32 s34,s41
s_mov_b64 s[76:77],s[80:81]
s_nop 2
ep_286:
v_cvt_pk_bf16_f32 v6,v56,v57
v_lshlrev_b32 v56,16,v6
v_and_b32 v57,0xffff0000,v6
v_cvt_pk_bf16_f32 v6,v58,v59
v_lshlrev_b32 v58,16,v6
v_and_b32 v59,0xffff0000,v6
v_cvt_pk_bf16_f32 v6,v60,v61
v_lshlrev_b32 v60,16,v6
v_and_b32 v61,0xffff0000,v6
v_cvt_pk_bf16_f32 v6,v62,v63
v_lshlrev_b32 v62,16,v6
v_and_b32 v63,0xffff0000,v6
v_cvt_pk_bf16_f32 v6,v64,v65
v_lshlrev_b32 v64,16,v6
v_and_b32 v65,0xffff0000,v6
v_cvt_pk_bf16_f32 v6,v66,v67
v_lshlrev_b32 v66,16,v6
v_and_b32 v67,0xffff0000,v6
v_cvt_pk_bf16_f32 v6,v68,v69
v_lshlrev_b32 v68,16,v6
v_and_b32 v69,0xffff0000,v6
v_cvt_pk_bf16_f32 v6,v70,v71
v_lshlrev_b32 v70,16,v6
v_and_b32 v71,0xffff0000,v6
v_pk_add_f32 v[56:57],v[56:57],v[128:129]
v_pk_add_f32 v[58:59],v[58:59],v[130:131]
v_pk_add_f32 v[60:61],v[60:61],v[132:133]
v_pk_add_f32 v[62:63],v[62:63],v[134:135]
v_pk_add_f32 v[64:65],v[64:65],v[136:137]
v_pk_add_f32 v[66:67],v[66:67],v[138:139]
v_pk_add_f32 v[68:69],v[68:69],v[140:141]
v_pk_add_f32 v[70:71],v[70:71],v[142:143]
v_cvt_pk_bf16_f32 v144,v56,v57
v_lshlrev_b32 v56,16,v144
v_and_b32 v57,0xffff0000,v144
v_cvt_pk_bf16_f32 v145,v58,v59
v_lshlrev_b32 v58,16,v145
v_and_b32 v59,0xffff0000,v145
v_cvt_pk_bf16_f32 v146,v60,v61
v_lshlrev_b32 v60,16,v146
v_and_b32 v61,0xffff0000,v146
v_cvt_pk_bf16_f32 v147,v62,v63
v_lshlrev_b32 v62,16,v147
v_and_b32 v63,0xffff0000,v147
v_cvt_pk_bf16_f32 v148,v64,v65
v_lshlrev_b32 v64,16,v148
v_and_b32 v65,0xffff0000,v148
v_cvt_pk_bf16_f32 v149,v66,v67
v_lshlrev_b32 v66,16,v149
v_and_b32 v67,0xffff0000,v149
v_cvt_pk_bf16_f32 v150,v68,v69
v_lshlrev_b32 v68,16,v150
v_and_b32 v69,0xffff0000,v150
v_cvt_pk_bf16_f32 v151,v70,v71
v_lshlrev_b32 v70,16,v151
v_and_b32 v71,0xffff0000,v151
s_cmp_lg_u32 s49,0
s_cbranch_scc0 ls_289
buffer_store_dwordx4 v[144:147],v20,s[8:11],s71 offen sc1
buffer_store_dwordx4 v[148:151],v21,s[8:11],s71 offen sc1
s_branch ls_290
ls_289:
buffer_store_dwordx4 v[144:147],v20,s[8:11],s71 offen
buffer_store_dwordx4 v[148:151],v21,s[8:11],s71 offen
ls_290:
v_pk_add_f32 v[6:7],v[56:57],v[58:59]
v_pk_mul_f32 v[8:9],v[56:57],v[56:57]
v_pk_fma_f32 v[8:9],v[58:59],v[58:59],v[8:9]
v_pk_add_f32 v[6:7],v[6:7],v[60:61]
v_pk_fma_f32 v[8:9],v[60:61],v[60:61],v[8:9]
v_pk_add_f32 v[6:7],v[6:7],v[62:63]
v_pk_fma_f32 v[8:9],v[62:63],v[62:63],v[8:9]
v_pk_add_f32 v[6:7],v[6:7],v[64:65]
v_pk_fma_f32 v[8:9],v[64:65],v[64:65],v[8:9]
v_pk_add_f32 v[6:7],v[6:7],v[66:67]
v_pk_fma_f32 v[8:9],v[66:67],v[66:67],v[8:9]
v_pk_add_f32 v[6:7],v[6:7],v[68:69]
v_pk_fma_f32 v[8:9],v[68:69],v[68:69],v[8:9]
v_pk_add_f32 v[6:7],v[6:7],v[70:71]
v_pk_fma_f32 v[8:9],v[70:71],v[70:71],v[8:9]
v_add_f32 v6,v6,v7
v_add_f32 v7,v8,v9
v_mov_b32 v8,v6
v_mov_b32 v9,v7
s_nop 0
v_permlane32_swap_b32 v6,v8
v_permlane32_swap_b32 v7,v9
v_pk_add_f32 v[6:7],v[6:7],v[8:9]
s_mov_b32 exec_hi,0
s_cmp_lg_u32 s49,0
s_cbranch_scc0 ls_291
buffer_store_dwordx2 v[6:7],v114,s[8:11],s72 offen sc1
s_branch ls_292
ls_291:
buffer_store_dwordx2 v[6:7],v114,s[8:11],s72 offen
ls_292:
s_mov_b32 exec_hi,-1
s_mov_b32 s59,s82
s_cmp_eq_u32 s37,0
s_cbranch_scc1 W2_NEXT
s_waitcnt vmcnt(3)
v_cmp_eq_u32 vcc,0,v3
s_and_b64 vcc,vcc,s[76:77]
s_cselect_b32 s37,2147483648,0
s_cmp_lt_u32 s32,128
s_cselect_b32 s37,s37,2147483648
s_cmp_eq_u32 s37,0
s_cbranch_scc1 W2_COLD2
s_waitcnt vmcnt(0)
s_mov_b64 exec,1
s_cmp_lg_u32 s49,0
s_cbranch_scc0 ls_293
buffer_store_dword v5,v1,s[8:11],s59 offen sc1
s_branch ls_294
ls_293:
buffer_store_dword v5,v1,s[8:11],s59 offen
ls_294:
s_mov_b64 exec,-1
s_mov_b32 s59,2147483648
s_cmp_lt_u32 s32,128
s_cbranch_scc1 W2_COLD
s_branch W2_END
sec_288:
s_waitcnt vmcnt(5)
v_cmp_eq_u32 vcc,0,v3
s_and_b64 vcc,vcc,s[76:77]
s_cselect_b32 s37,2147483648,0
s_cmp_lt_u32 s32,128
s_cselect_b32 s37,s37,2147483648
s_cmp_lg_u32 s37,0
s_cbranch_scc1 nr_287
s_sub_u32 s66,40960,s57
s_add_u32 s61,s34,s68
s_and_b32 s62,s61,7
s_cmp_lt_u32 s61,64
s_cselect_b32 s62,s62,8
s_mul_i32 s62,s62,40960
s_and_b32 s61,s34,7
s_mul_i32 s61,s61,40960
v_mad_u32_u24 v112,v76,s62,v74
v_mad_u32_u24 v112,v78,s61,v112
v_mad_u32_u24 v113,v77,s62,v75
v_mad_u32_u24 v113,v79,s61,v113
s_mov_b32 s60,s33
s_mul_i32 s60,s60,368640
s_add_u32 s60,s60,s37
s_mul_i32 s61,s46,10240
s_add_u32 s60,s60,s61
s_add_u32 s60,s60,237371392
s_add_u32 s61,s61,s66
s_add_u32 m0,s61,0
s_add_u32 s63,s60,0
buffer_load_dwordx4 v112,s[8:11],s63 offen sc1 lds
v_cvt_pk_bf16_f32 v6,v56,v57
v_lshlrev_b32 v56,16,v6
v_and_b32 v57,0xffff0000,v6
v_cvt_pk_bf16_f32 v6,v58,v59
s_add_u32 m0,s61,1024
s_nop 0
buffer_load_dwordx4 v113,s[8:11],s63 offen sc1 lds
v_lshlrev_b32 v58,16,v6
v_and_b32 v59,0xffff0000,v6
v_cvt_pk_bf16_f32 v6,v60,v61
v_lshlrev_b32 v60,16,v6
s_add_u32 m0,s61,2048
s_add_u32 s63,s60,2048
buffer_load_dwordx4 v112,s[8:11],s63 offen sc1 lds
v_and_b32 v61,0xffff0000,v6
v_cvt_pk_bf16_f32 v6,v62,v63
v_lshlrev_b32 v62,16,v6
v_and_b32 v63,0xffff0000,v6
s_add_u32 m0,s61,3072
s_nop 0
buffer_load_dwordx4 v113,s[8:11],s63 offen sc1 lds
v_cvt_pk_bf16_f32 v6,v64,v65
v_lshlrev_b32 v64,16,v6
v_and_b32 v65,0xffff0000,v6
v_cvt_pk_bf16_f32 v6,v66,v67
s_add_u32 m0,s61,4096
s_add_u32 s63,s60,4096
buffer_load_dwordx4 v112,s[8:11],s63 offen sc1 lds
v_lshlrev_b32 v66,16,v6
v_and_b32 v67,0xffff0000,v6
v_cvt_pk_bf16_f32 v6,v68,v69
v_lshlrev_b32 v68,16,v6
s_add_u32 m0,s61,5120
s_nop 0
buffer_load_dwordx4 v113,s[8:11],s63 offen sc1 lds
v_and_b32 v69,0xffff0000,v6
v_cvt_pk_bf16_f32 v6,v70,v71
v_lshlrev_b32 v70,16,v6
v_and_b32 v71,0xffff0000,v6
s_add_u32 m0,s61,6144
s_add_u32 s63,s60,6144
buffer_load_dwordx4 v112,s[8:11],s63 offen sc1 lds
v_pk_add_f32 v[56:57],v[56:57],v[128:129]
v_pk_add_f32 v[58:59],v[58:59],v[130:131]
v_pk_add_f32 v[60:61],v[60:61],v[132:133]
v_pk_add_f32 v[62:63],v[62:63],v[134:135]
s_add_u32 m0,s61,7168
s_nop 0
buffer_load_dwordx4 v113,s[8:11],s63 offen sc1 lds
v_pk_add_f32 v[64:65],v[64:65],v[136:137]
v_pk_add_f32 v[66:67],v[66:67],v[138:139]
v_pk_add_f32 v[68:69],v[68:69],v[140:141]
v_pk_add_f32 v[70:71],v[70:71],v[142:143]
s_add_u32 m0,s61,8192
s_add_u32 s63,s60,8192
buffer_load_dwordx4 v112,s[8:11],s63 offen sc1 lds
v_cvt_pk_bf16_f32 v144,v56,v57
v_lshlrev_b32 v56,16,v144
v_and_b32 v57,0xffff0000,v144
v_cvt_pk_bf16_f32 v145,v58,v59
s_add_u32 m0,s61,9216
s_nop 0
buffer_load_dwordx4 v113,s[8:11],s63 offen sc1 lds
v_lshlrev_b32 v58,16,v145
v_and_b32 v59,0xffff0000,v145
v_cvt_pk_bf16_f32 v146,v60,v61
v_lshlrev_b32 v60,16,v146
s_mov_b32 s35,s42
s_mov_b32 s53,s33
s_mov_b32 s54,s34
s_add_u32 s32,s32,1
s_mov_b32 s33,s40
s_mov_b32 s34,s41
s_mov_b64 s[76:77],s[80:81]
v_and_b32 v61,0xffff0000,v146
v_cvt_pk_bf16_f32 v147,v62,v63
v_lshlrev_b32 v62,16,v147
v_and_b32 v63,0xffff0000,v147
v_cvt_pk_bf16_f32 v148,v64,v65
v_lshlrev_b32 v64,16,v148
v_and_b32 v65,0xffff0000,v148
v_cvt_pk_bf16_f32 v149,v66,v67
v_lshlrev_b32 v66,16,v149
v_and_b32 v67,0xffff0000,v149
v_cvt_pk_bf16_f32 v150,v68,v69
v_lshlrev_b32 v68,16,v150
v_and_b32 v69,0xffff0000,v150
v_cvt_pk_bf16_f32 v151,v70,v71
v_lshlrev_b32 v70,16,v151
v_and_b32 v71,0xffff0000,v151
s_cmp_lg_u32 s49,0
s_cbranch_scc0 ls_295
buffer_store_dwordx4 v[144:147],v20,s[8:11],s71 offen sc1
buffer_store_dwordx4 v[148:151],v21,s[8:11],s71 offen sc1
s_branch ls_296
ls_295:
buffer_store_dwordx4 v[144:147],v20,s[8:11],s71 offen
buffer_store_dwordx4 v[148:151],v21,s[8:11],s71 offen
ls_296:
v_pk_add_f32 v[6:7],v[56:57],v[58:59]
v_pk_mul_f32 v[8:9],v[56:57],v[56:57]
v_pk_fma_f32 v[8:9],v[58:59],v[58:59],v[8:9]
v_pk_add_f32 v[6:7],v[6:7],v[60:61]
v_pk_fma_f32 v[8:9],v[60:61],v[60:61],v[8:9]
v_pk_add_f32 v[6:7],v[6:7],v[62:63]
v_pk_fma_f32 v[8:9],v[62:63],v[62:63],v[8:9]
v_pk_add_f32 v[6:7],v[6:7],v[64:65]
v_pk_fma_f32 v[8:9],v[64:65],v[64:65],v[8:9]
v_pk_add_f32 v[6:7],v[6:7],v[66:67]
v_pk_fma_f32 v[8:9],v[66:67],v[66:67],v[8:9]
v_pk_add_f32 v[6:7],v[6:7],v[68:69]
v_pk_fma_f32 v[8:9],v[68:69],v[68:69],v[8:9]
v_pk_add_f32 v[6:7],v[6:7],v[70:71]
v_pk_fma_f32 v[8:9],v[70:71],v[70:71],v[8:9]
v_add_f32 v6,v6,v7
v_add_f32 v7,v8,v9
v_mov_b32 v8,v6
v_mov_b32 v9,v7
s_nop 0
v_permlane32_swap_b32 v6,v8
v_permlane32_swap_b32 v7,v9
v_pk_add_f32 v[6:7],v[6:7],v[8:9]
s_mov_b32 exec_hi,0
s_cmp_lg_u32 s49,0
s_cbranch_scc0 ls_297
buffer_store_dwordx2 v[6:7],v114,s[8:11],s72 offen sc1
s_branch ls_298
ls_297:
buffer_store_dwordx2 v[6:7],v114,s[8:11],s72 offen
ls_298:
s_mov_b32 exec_hi,-1
s_mov_b32 s59,s82
s_branch W2_NEXT
nr_287:
buffer_load_dword v3,v2,s[8:11],s35 offen sc1
s_branch ep_286
W2_END:
s_endpgm
ROLE_W3:
v_lshlrev_b32 v1,4,v0
v_mov_b32 v5,1
s_lshl_b32 s56,s48,2
s_add_u32 s56,s56,s46
v_bfe_u32 v6,v0,2,2
v_lshrrev_b32 v7,4,v0
v_add_u32 v7,v6,v7
v_and_b32 v7,3,v7
v_and_b32 v15,3,v0
v_lshlrev_b32 v15,4,v15
v_lshl_add_u32 v15,v7,6,v15
v_lshl_add_u32 v15,v6,8,v15
v_lshrrev_b32 v6,5,v0
v_bfe_u32 v7,v0,4,1
v_lshlrev_b32 v16,10,v7
v_lshl_add_u32 v16,v6,8,v16
v_and_b32 v6,15,v0
v_lshl_add_u32 v16,v6,4,v16
v_add_u32 v18,46080,v16
v_lshrrev_b32 v6,5,v0
v_bfe_u32 v7,v0,4,1
v_lshlrev_b32 v20,10,v7
v_lshl_add_u32 v20,v6,8,v20
v_and_b32 v6,15,v0
v_lshl_add_u32 v20,v6,4,v20
v_lshrrev_b32 v6,5,v0
v_add_u32 v6,2,v6
v_bfe_u32 v7,v0,4,1
v_lshlrev_b32 v17,10,v7
v_lshl_add_u32 v17,v6,8,v17
v_and_b32 v6,15,v0
v_lshl_add_u32 v17,v6,4,v17
v_add_u32 v19,46080,v17
v_lshrrev_b32 v6,5,v0
v_add_u32 v6,2,v6
v_bfe_u32 v7,v0,4,1
v_lshlrev_b32 v21,10,v7
v_lshl_add_u32 v21,v6,8,v21
v_and_b32 v6,15,v0
v_lshl_add_u32 v21,v6,4,v21
v_min_u32 v2,19,v0
v_lshlrev_b32 v2,2,v2
v_mov_b32 v112,0xc0135761
v_mov_b32 v113,0xbdd2d3e8
s_mov_b32 s68,0xbdd2d3e8
v_lshrrev_b32 v6,5,v0
v_mul_u32_u24 v182,2560,v6
v_and_b32 v6,31,v0
v_lshl_add_u32 v182,v6,3,v182
v_add_u32 v182,0xa000,v182
v_mov_b32 v20,v1
v_add_u32 v21,1024,v1
s_waitcnt vmcnt(0)
s_barrier
s_cmp_lg_u32 s46,0
s_cbranch_scc1 arr_299
v_mov_b32 v6,1
s_lshl_b32 s3,s49,2
v_mov_b32 v7,s3
s_mov_b64 exec,1
buffer_atomic_add v6,v7,s[12:15],0 offen sc1
s_mov_b64 exec,-1
arr_299:
s_lshl_b32 s3,s49,2
v_mov_b32 v7,s3
s_nop 1
ibw_300:
buffer_load_dword v6,v7,s[12:15],0 offen sc1
s_waitcnt vmcnt(0)
v_cmp_ne_u32 vcc,256,v6
s_nop 0
s_cbranch_vccz ok_301
s_sleep 8
s_sub_u32 s47,s47,1
s_cbranch_scc1 ABORT
s_branch ibw_300
ok_301:
s_cmp_lg_u32 s49,0
s_cbranch_scc1 ibok_302
v_and_b32 v7,7,v0
v_lshlrev_b32 v7,2,v7
buffer_load_dword v6,v7,s[12:15],0 offen offset:32 sc1
s_waitcnt vmcnt(0)
v_cmp_ne_u32 vcc,32,v6
s_nop 0
s_cbranch_vccz ibok_302
s_barrier
s_mov_b32 s49,1
s_mov_b32 s3,s2
s_load_dwordx16 s[16:31],s[0:1],0
s_load_dwordx8 s[32:39],s[0:1],64
s_waitcnt lgkmcnt(0)
s_branch DISPATCH
ibok_302:
s_lshl_b32 s58,s56,6
s_mul_i32 s63,s46,40960
s_mov_b32 s4,s36
s_mov_b32 s5,s37
s_mov_b32 s6,1966080
s_mov_b32 s7,0x20000
v_lshrrev_b32 v9,2,v0
s_mov_b32 s64,3072
v_mul_lo_u32 v9,v9,s64
v_and_b32 v10,3,v0
v_lshl_add_u32 v6,v10,4,v9
s_add_u32 m0,s63,0
s_add_u32 s65,s58,0
buffer_load_dwordx4 v6,s[4:7],s65 offen lds
s_add_u32 m0,s63,1024
s_add_u32 s65,s58,49152
buffer_load_dwordx4 v6,s[4:7],s65 offen lds
s_add_u32 m0,s63,2048
s_add_u32 s65,s58,98304
buffer_load_dwordx4 v6,s[4:7],s65 offen lds
s_add_u32 m0,s63,3072
s_add_u32 s65,s58,147456
buffer_load_dwordx4 v6,s[4:7],s65 offen lds
s_add_u32 m0,s63,4096
s_add_u32 s65,s58,196608
buffer_load_dwordx4 v6,s[4:7],s65 offen lds
s_add_u32 m0,s63,5120
s_add_u32 s65,s58,245760
buffer_load_dwordx4 v6,s[4:7],s65 offen lds
s_add_u32 m0,s63,6144
s_add_u32 s65,s58,294912
buffer_load_dwordx4 v6,s[4:7],s65 offen lds
s_add_u32 m0,s63,7168
s_add_u32 s65,s58,344064
buffer_load_dwordx4 v6,s[4:7],s65 offen lds
s_add_u32 m0,s63,8192
s_add_u32 s65,s58,393216
buffer_load_dwordx4 v6,s[4:7],s65 offen lds
s_add_u32 m0,s63,9216
s_add_u32 s65,s58,442368
buffer_load_dwordx4 v6,s[4:7],s65 offen lds
s_add_u32 m0,s63,10240
s_add_u32 s65,s58,491520
buffer_load_dwordx4 v6,s[4:7],s65 offen lds
s_add_u32 m0,s63,11264
s_add_u32 s65,s58,540672
buffer_load_dwordx4 v6,s[4:7],s65 offen lds
s_add_u32 m0,s63,12288
s_add_u32 s65,s58,589824
buffer_load_dwordx4 v6,s[4:7],s65 offen lds
s_add_u32 m0,s63,13312
s_add_u32 s65,s58,638976
buffer_load_dwordx4 v6,s[4:7],s65 offen lds
s_add_u32 m0,s63,14336
s_add_u32 s65,s58,688128
buffer_load_dwordx4 v6,s[4:7],s65 offen lds
s_add_u32 m0,s63,15360
s_add_u32 s65,s58,737280
buffer_load_dwordx4 v6,s[4:7],s65 offen lds
s_add_u32 m0,s63,16384
s_add_u32 s65,s58,786432
buffer_load_dwordx4 v6,s[4:7],s65 offen lds
s_add_u32 m0,s63,17408
s_add_u32 s65,s58,835584
buffer_load_dwordx4 v6,s[4:7],s65 offen lds
s_add_u32 m0,s63,18432
s_add_u32 s65,s58,884736
buffer_load_dwordx4 v6,s[4:7],s65 offen lds
s_add_u32 m0,s63,19456
s_add_u32 s65,s58,933888
buffer_load_dwordx4 v6,s[4:7],s65 offen lds
s_add_u32 m0,s63,20480
s_add_u32 s65,s58,983040
buffer_load_dwordx4 v6,s[4:7],s65 offen lds
s_add_u32 m0,s63,21504
s_add_u32 s65,s58,1032192
buffer_load_dwordx4 v6,s[4:7],s65 offen lds
s_add_u32 m0,s63,22528
s_add_u32 s65,s58,1081344
buffer_load_dwordx4 v6,s[4:7],s65 offen lds
s_add_u32 m0,s63,23552
s_add_u32 s65,s58,1130496
buffer_load_dwordx4 v6,s[4:7],s65 offen lds
s_add_u32 m0,s63,24576
s_add_u32 s65,s58,1179648
buffer_load_dwordx4 v6,s[4:7],s65 offen lds
s_add_u32 m0,s63,25600
s_add_u32 s65,s58,1228800
buffer_load_dwordx4 v6,s[4:7],s65 offen lds
s_add_u32 m0,s63,26624
s_add_u32 s65,s58,1277952
buffer_load_dwordx4 v6,s[4:7],s65 offen lds
s_add_u32 m0,s63,27648
s_add_u32 s65,s58,1327104
buffer_load_dwordx4 v6,s[4:7],s65 offen lds
s_add_u32 m0,s63,28672
s_add_u32 s65,s58,1376256
buffer_load_dwordx4 v6,s[4:7],s65 offen lds
s_add_u32 m0,s63,29696
s_add_u32 s65,s58,1425408
buffer_load_dwordx4 v6,s[4:7],s65 offen lds
s_add_u32 m0,s63,30720
s_add_u32 s65,s58,1474560
buffer_load_dwordx4 v6,s[4:7],s65 offen lds
s_add_u32 m0,s63,31744
s_add_u32 s65,s58,1523712
buffer_load_dwordx4 v6,s[4:7],s65 offen lds
s_add_u32 m0,s63,32768
s_add_u32 s65,s58,1572864
buffer_load_dwordx4 v6,s[4:7],s65 offen lds
s_add_u32 m0,s63,33792
s_add_u32 s65,s58,1622016
buffer_load_dwordx4 v6,s[4:7],s65 offen lds
s_add_u32 m0,s63,34816
s_add_u32 s65,s58,1671168
buffer_load_dwordx4 v6,s[4:7],s65 offen lds
s_add_u32 m0,s63,35840
s_add_u32 s65,s58,1720320
buffer_load_dwordx4 v6,s[4:7],s65 offen lds
s_add_u32 m0,s63,36864
s_add_u32 s65,s58,1769472
buffer_load_dwordx4 v6,s[4:7],s65 offen lds
s_add_u32 m0,s63,37888
s_add_u32 s65,s58,1818624
buffer_load_dwordx4 v6,s[4:7],s65 offen lds
s_add_u32 m0,s63,38912
s_add_u32 s65,s58,1867776
buffer_load_dwordx4 v6,s[4:7],s65 offen lds
s_add_u32 m0,s63,39936
s_add_u32 s65,s58,1916928
buffer_load_dwordx4 v6,s[4:7],s65 offen lds
s_waitcnt vmcnt(20)
v_bfe_u32 v9,v0,2,2
v_lshrrev_b32 v10,5,v0
v_lshl_add_u32 v9,v10,2,v9
v_mul_u32_u24 v9,64,v9
v_and_b32 v10,1,v0
v_lshl_add_u32 v9,v10,3,v9
v_bfe_u32 v10,v0,1,1
v_lshl_add_u32 v9,v10,5,v9
v_bfe_u32 v10,v0,4,1
v_lshl_add_u32 v9,v10,4,v9
v_add_u32 v7,s63,v9
ds_read_b64_tr_b16 a[0:1],v7 offset:0
ds_read_b64_tr_b16 a[2:3],v7 offset:1024
ds_read_b64_tr_b16 a[4:5],v7 offset:512
ds_read_b64_tr_b16 a[6:7],v7 offset:1536
ds_read_b64_tr_b16 a[8:9],v7 offset:2048
ds_read_b64_tr_b16 a[10:11],v7 offset:3072
ds_read_b64_tr_b16 a[12:13],v7 offset:2560
ds_read_b64_tr_b16 a[14:15],v7 offset:3584
ds_read_b64_tr_b16 a[16:17],v7 offset:4096
ds_read_b64_tr_b16 a[18:19],v7 offset:5120
ds_read_b64_tr_b16 a[20:21],v7 offset:4608
ds_read_b64_tr_b16 a[22:23],v7 offset:5632
s_waitcnt lgkmcnt(4)
ds_read_b64_tr_b16 a[24:25],v7 offset:6144
ds_read_b64_tr_b16 a[26:27],v7 offset:7168
ds_read_b64_tr_b16 a[28:29],v7 offset:6656
ds_read_b64_tr_b16 a[30:31],v7 offset:7680
ds_read_b64_tr_b16 a[32:33],v7 offset:8192
ds_read_b64_tr_b16 a[34:35],v7 offset:9216
ds_read_b64_tr_b16 a[36:37],v7 offset:8704
ds_read_b64_tr_b16 a[38:39],v7 offset:9728
ds_read_b64_tr_b16 a[40:41],v7 offset:10240
ds_read_b64_tr_b16 a[42:43],v7 offset:11264
ds_read_b64_tr_b16 a[44:45],v7 offset:10752
ds_read_b64_tr_b16 a[46:47],v7 offset:11776
s_waitcnt lgkmcnt(4)
ds_read_b64_tr_b16 a[48:49],v7 offset:12288
ds_read_b64_tr_b16 a[50:51],v7 offset:13312
ds_read_b64_tr_b16 a[52:53],v7 offset:12800
ds_read_b64_tr_b16 a[54:55],v7 offset:13824
ds_read_b64_tr_b16 a[56:57],v7 offset:14336
ds_read_b64_tr_b16 a[58:59],v7 offset:15360
ds_read_b64_tr_b16 a[60:61],v7 offset:14848
ds_read_b64_tr_b16 a[62:63],v7 offset:15872
ds_read_b64_tr_b16 a[64:65],v7 offset:16384
ds_read_b64_tr_b16 a[66:67],v7 offset:17408
ds_read_b64_tr_b16 a[68:69],v7 offset:16896
ds_read_b64_tr_b16 a[70:71],v7 offset:17920
s_waitcnt lgkmcnt(4)
ds_read_b64_tr_b16 a[72:73],v7 offset:18432
ds_read_b64_tr_b16 a[74:75],v7 offset:19456
ds_read_b64_tr_b16 a[76:77],v7 offset:18944
ds_read_b64_tr_b16 a[78:79],v7 offset:19968
s_waitcnt lgkmcnt(0)
s_waitcnt vmcnt(0)
v_bfe_u32 v9,v0,2,2
v_lshrrev_b32 v10,5,v0
v_lshl_add_u32 v9,v10,2,v9
v_mul_u32_u24 v9,64,v9
v_and_b32 v10,1,v0
v_lshl_add_u32 v9,v10,3,v9
v_bfe_u32 v10,v0,1,1
v_lshl_add_u32 v9,v10,5,v9
v_bfe_u32 v10,v0,4,1
v_lshl_add_u32 v9,v10,4,v9
v_add_u32 v7,s63,v9
ds_read_b64_tr_b16 a[80:81],v7 offset:20480
ds_read_b64_tr_b16 a[82:83],v7 offset:21504
ds_read_b64_tr_b16 a[84:85],v7 offset:20992
ds_read_b64_tr_b16 a[86:87],v7 offset:22016
ds_read_b64_tr_b16 a[88:89],v7 offset:22528
ds_read_b64_tr_b16 a[90:91],v7 offset:23552
ds_read_b64_tr_b16 a[92:93],v7 offset:23040
ds_read_b64_tr_b16 a[94:95],v7 offset:24064
ds_read_b64_tr_b16 a[96:97],v7 offset:24576
ds_read_b64_tr_b16 a[98:99],v7 offset:25600
ds_read_b64_tr_b16 a[100:101],v7 offset:25088
ds_read_b64_tr_b16 a[102:103],v7 offset:26112
s_waitcnt lgkmcnt(4)
ds_read_b64_tr_b16 a[104:105],v7 offset:26624
ds_read_b64_tr_b16 a[106:107],v7 offset:27648
ds_read_b64_tr_b16 a[108:109],v7 offset:27136
ds_read_b64_tr_b16 a[110:111],v7 offset:28160
ds_read_b64_tr_b16 a[112:113],v7 offset:28672
ds_read_b64_tr_b16 a[114:115],v7 offset:29696
ds_read_b64_tr_b16 a[116:117],v7 offset:29184
ds_read_b64_tr_b16 a[118:119],v7 offset:30208
ds_read_b64_tr_b16 a[120:121],v7 offset:30720
ds_read_b64_tr_b16 a[122:123],v7 offset:31744
ds_read_b64_tr_b16 a[124:125],v7 offset:31232
ds_read_b64_tr_b16 a[126:127],v7 offset:32256
s_waitcnt lgkmcnt(4)
ds_read_b64_tr_b16 a[128:129],v7 offset:32768
ds_read_b64_tr_b16 a[130:131],v7 offset:33792
ds_read_b64_tr_b16 a[132:133],v7 offset:33280
ds_read_b64_tr_b16 a[134:135],v7 offset:34304
ds_read_b64_tr_b16 a[136:137],v7 offset:34816
ds_read_b64_tr_b16 a[138:139],v7 offset:35840
ds_read_b64_tr_b16 a[140:141],v7 offset:35328
ds_read_b64_tr_b16 a[142:143],v7 offset:36352
ds_read_b64_tr_b16 a[144:145],v7 offset:36864
ds_read_b64_tr_b16 a[146:147],v7 offset:37888
ds_read_b64_tr_b16 a[148:149],v7 offset:37376
ds_read_b64_tr_b16 a[150:151],v7 offset:38400
s_waitcnt lgkmcnt(4)
ds_read_b64_tr_b16 a[152:153],v7 offset:38912
ds_read_b64_tr_b16 a[154:155],v7 offset:39936
ds_read_b64_tr_b16 a[156:157],v7 offset:39424
ds_read_b64_tr_b16 a[158:159],v7 offset:40448
s_waitcnt lgkmcnt(0)
v_mov_b32 v24,0x3f803f80
v_mov_b32 v25,0x3f803f80
v_mov_b32 v26,0x3f803f80
v_mov_b32 v27,0x3f803f80
s_nop 1
v_mfma_f32_32x32x16_bf16 v[144:159],a[0:3],v[24:27],0
v_mfma_f32_32x32x16_bf16 v[144:159],a[4:7],v[24:27],v[144:159]
v_mfma_f32_32x32x16_bf16 v[144:159],a[8:11],v[24:27],v[144:159]
v_mfma_f32_32x32x16_bf16 v[144:159],a[12:15],v[24:27],v[144:159]
v_mfma_f32_32x32x16_bf16 v[144:159],a[16:19],v[24:27],v[144:159]
v_mfma_f32_32x32x16_bf16 v[144:159],a[20:23],v[24:27],v[144:159]
v_mfma_f32_32x32x16_bf16 v[144:159],a[24:27],v[24:27],v[144:159]
v_mfma_f32_32x32x16_bf16 v[144:159],a[28:31],v[24:27],v[144:159]
v_mfma_f32_32x32x16_bf16 v[144:159],a[32:35],v[24:27],v[144:159]
v_mfma_f32_32x32x16_bf16 v[144:159],a[36:39],v[24:27],v[144:159]
v_mfma_f32_32x32x16_bf16 v[144:159],a[40:43],v[24:27],v[144:159]
v_mfma_f32_32x32x16_bf16 v[144:159],a[44:47],v[24:27],v[144:159]
v_mfma_f32_32x32x16_bf16 v[144:159],a[48:51],v[24:27],v[144:159]
v_mfma_f32_32x32x16_bf16 v[144:159],a[52:55],v[24:27],v[144:159]
v_mfma_f32_32x32x16_bf16 v[144:159],a[56:59],v[24:27],v[144:159]
v_mfma_f32_32x32x16_bf16 v[144:159],a[60:63],v[24:27],v[144:159]
v_mfma_f32_32x32x16_bf16 v[144:159],a[64:67],v[24:27],v[144:159]
v_mfma_f32_32x32x16_bf16 v[144:159],a[68:71],v[24:27],v[144:159]
v_mfma_f32_32x32x16_bf16 v[144:159],a[72:75],v[24:27],v[144:159]
v_mfma_f32_32x32x16_bf16 v[144:159],a[76:79],v[24:27],v[144:159]
v_mfma_f32_32x32x16_bf16 v[144:159],a[80:83],v[24:27],v[144:159]
v_mfma_f32_32x32x16_bf16 v[144:159],a[84:87],v[24:27],v[144:159]
v_mfma_f32_32x32x16_bf16 v[144:159],a[88:91],v[24:27],v[144:159]
v_mfma_f32_32x32x16_bf16 v[144:159],a[92:95],v[24:27],v[144:159]
v_mfma_f32_32x32x16_bf16 v[144:159],a[96:99],v[24:27],v[144:159]
v_mfma_f32_32x32x16_bf16 v[144:159],a[100:103],v[24:27],v[144:159]
v_mfma_f32_32x32x16_bf16 v[144:159],a[104:107],v[24:27],v[144:159]
v_mfma_f32_32x32x16_bf16 v[144:159],a[108:111],v[24:27],v[144:159]
v_mfma_f32_32x32x16_bf16 v[144:159],a[112:115],v[24:27],v[144:159]
v_mfma_f32_32x32x16_bf16 v[144:159],a[116:119],v[24:27],v[144:159]
v_mfma_f32_32x32x16_bf16 v[144:159],a[120:123],v[24:27],v[144:159]
v_mfma_f32_32x32x16_bf16 v[144:159],a[124:127],v[24:27],v[144:159]
v_mfma_f32_32x32x16_bf16 v[144:159],a[128:131],v[24:27],v[144:159]
v_mfma_f32_32x32x16_bf16 v[144:159],a[132:135],v[24:27],v[144:159]
v_mfma_f32_32x32x16_bf16 v[144:159],a[136:139],v[24:27],v[144:159]
v_mfma_f32_32x32x16_bf16 v[144:159],a[140:143],v[24:27],v[144:159]
v_mfma_f32_32x32x16_bf16 v[144:159],a[144:147],v[24:27],v[144:159]
v_mfma_f32_32x32x16_bf16 v[144:159],a[148:151],v[24:27],v[144:159]
v_mfma_f32_32x32x16_bf16 v[144:159],a[152:155],v[24:27],v[144:159]
v_mfma_f32_32x32x16_bf16 v[144:159],a[156:159],v[24:27],v[144:159]
s_barrier
s_mov_b32 s50,0
s_mov_b32 s32,0
s_mov_b32 s57,0
s_mov_b32 s59,2147483648
s_mov_b32 s82,2147483648
s_mov_b32 s39,2147483648
v_mov_b32 v22,94208
v_lshl_add_u32 v22,v0,2,v22
v_mov_b32 v23,0
ds_write_b32 v22,v23
s_mov_b32 s39,1600000
v_and_b32 v72,15,v0
v_lshlrev_b32 v72,7,v72
v_min_u32 v6,59,v0
v_lshlrev_b32 v6,2,v6
v_add_u32 v2,198656,v6
v_add_u32 v7,-80,v6
v_cmp_gt_u32 s[78:79],20,v0
s_nop 1
v_cndmask_b32 v2,v7,v2,s[78:79]
s_mov_b32 s51,0
s_mov_b32 s52,0
s_mul_i32 s62,s51,4
s_and_b32 s63,s52,3
s_add_u32 s62,s62,s63
s_mul_i32 s62,s62,98304
s_add_u32 s62,s62,242778112
s_lshl_b32 s63,s56,11
s_add_u32 s62,s62,s63
buffer_load_dword v73,v72,s[8:11],s62 offen sc1
s_mov_b32 s51,0
s_mov_b32 s52,1
s_mul_i32 s62,s51,4
s_and_b32 s63,s52,3
s_add_u32 s62,s62,s63
s_mul_i32 s62,s62,98304
s_add_u32 s62,s62,242778112
s_lshl_b32 s63,s56,11
s_add_u32 s62,s62,s63
buffer_load_dword v73,v72,s[8:11],s62 offen sc1
s_mov_b32 s51,0
s_mov_b32 s52,2
s_mul_i32 s62,s51,4
s_and_b32 s63,s52,3
s_add_u32 s62,s62,s63
s_mul_i32 s62,s62,98304
s_add_u32 s62,s62,242778112
s_lshl_b32 s63,s56,11
s_add_u32 s62,s62,s63
buffer_load_dword v73,v72,s[8:11],s62 offen sc1
s_mov_b32 s51,0
s_mov_b32 s52,3
s_mul_i32 s62,s51,4
s_and_b32 s63,s52,3
s_add_u32 s62,s62,s63
s_mul_i32 s62,s62,98304
s_add_u32 s62,s62,242778112
s_lshl_b32 s63,s56,11
s_add_u32 s62,s62,s63
buffer_load_dword v73,v72,s[8:11],s62 offen sc1
s_mov_b32 s51,1
s_mov_b32 s52,0
s_mul_i32 s62,s51,4
s_and_b32 s63,s52,3
s_add_u32 s62,s62,s63
s_mul_i32 s62,s62,98304
s_add_u32 s62,s62,242778112
s_lshl_b32 s63,s56,11
s_add_u32 s62,s62,s63
buffer_load_dword v73,v72,s[8:11],s62 offen sc1
s_mov_b32 s51,1
s_mov_b32 s52,1
s_mul_i32 s62,s51,4
s_and_b32 s63,s52,3
s_add_u32 s62,s62,s63
s_mul_i32 s62,s62,98304
s_add_u32 s62,s62,242778112
s_lshl_b32 s63,s56,11
s_add_u32 s62,s62,s63
buffer_load_dword v73,v72,s[8:11],s62 offen sc1
s_mov_b32 s51,1
s_mov_b32 s52,2
s_mul_i32 s62,s51,4
s_and_b32 s63,s52,3
s_add_u32 s62,s62,s63
s_mul_i32 s62,s62,98304
s_add_u32 s62,s62,242778112
s_lshl_b32 s63,s56,11
s_add_u32 s62,s62,s63
buffer_load_dword v73,v72,s[8:11],s62 offen sc1
s_mov_b32 s51,1
s_mov_b32 s52,3
s_mul_i32 s62,s51,4
s_and_b32 s63,s52,3
s_add_u32 s62,s62,s63
s_mul_i32 s62,s62,98304
s_add_u32 s62,s62,242778112
s_lshl_b32 s63,s56,11
s_add_u32 s62,s62,s63
buffer_load_dword v73,v72,s[8:11],s62 offen sc1
s_waitcnt vmcnt(0)
s_waitcnt lgkmcnt(0)
s_barrier
s_mov_b32 s83,s100
s_min_u32 s62,s32,127
s_sub_u32 s60,s62,17
s_lshr_b32 s34,s60,1
s_and_b32 s33,s60,1
s_cmp_eq_u32 s33,0
s_cselect_b32 s61,17,0
s_add_u32 s34,s34,s61
s_sub_u32 s61,s60,47
s_cmp_ge_u32 s60,94
s_cselect_b32 s34,s61,s34
s_cselect_b32 s33,1,s33
s_cmp_lt_u32 s62,17
s_cselect_b32 s34,s62,s34
s_cselect_b32 s33,0,s33
s_lshl_b32 s35,s33,6
s_add_u32 s35,s35,s34
s_lshl_b32 s35,s35,9
s_add_u32 s35,s35,325632
s_cmp_lt_u32 s34,4
s_cselect_b64 s[76:77],s[78:79],-1
s_sub_u32 s57,46080,s57
v_swap_b32 v16,v18
v_swap_b32 v17,v19
s_add_u32 s62,s32,1
s_min_u32 s62,s62,127
s_sub_u32 s60,s62,17
s_lshr_b32 s41,s60,1
s_and_b32 s40,s60,1
s_cmp_eq_u32 s40,0
s_cselect_b32 s61,17,0
s_add_u32 s41,s41,s61
s_sub_u32 s61,s60,47
s_cmp_ge_u32 s60,94
s_cselect_b32 s41,s61,s41
s_cselect_b32 s40,1,s40
s_cmp_lt_u32 s62,17
s_cselect_b32 s41,s62,s41
s_cselect_b32 s40,0,s40
s_lshl_b32 s42,s40,6
s_add_u32 s42,s42,s41
s_lshl_b32 s42,s42,9
s_add_u32 s42,s42,325632
s_cmp_lt_u32 s41,4
s_cselect_b64 s[80:81],s[78:79],-1
W3_COLD:
s_mov_b32 s37,0
fb_303:
buffer_load_dword v3,v2,s[8:11],s35 offen sc1
s_waitcnt vmcnt(0)
v_cmp_eq_u32 vcc,0,v3
s_and_b64 vcc,vcc,s[76:77]
s_cbranch_scc0 ok_304
s_sleep 1
s_sub_u32 s47,s47,1
s_cbranch_scc1 ABORT
s_branch fb_303
ok_304:
W3_COLD2:
s_sub_u32 s66,46080,s57
s_mul_i32 s60,s33,8
s_and_b32 s61,s34,7
s_add_u32 s60,s60,s61
s_mul_i32 s60,s60,46080
s_add_u32 s60,s60,s37
s_add_u32 s60,s60,212467712
s_mov_b32 s67,s60
s_mul_i32 s61,s46,10240
s_add_u32 s60,s60,s61
s_add_u32 s61,s61,s66
s_add_u32 m0,s61,0
s_add_u32 s63,s60,0
buffer_load_dwordx4 v1,s[8:11],s63 offen sc1 lds
buffer_load_dwordx4 v1,s[8:11],s63 offen offset:1024 sc1 lds
buffer_load_dwordx4 v1,s[8:11],s63 offen offset:2048 sc1 lds
buffer_load_dwordx4 v1,s[8:11],s63 offen offset:3072 sc1 lds
s_add_u32 m0,s61,4096
s_add_u32 s63,s60,4096
buffer_load_dwordx4 v1,s[8:11],s63 offen sc1 lds
buffer_load_dwordx4 v1,s[8:11],s63 offen offset:1024 sc1 lds
s_waitcnt vmcnt(5)
s_mov_b64 exec,1
s_cmp_lg_u32 s49,0
s_cbranch_scc0 ls_305
buffer_store_dword v5,v1,s[8:11],s59 offen sc1
s_branch ls_306
ls_305:
buffer_store_dword v5,v1,s[8:11],s59 offen
ls_306:
s_mov_b64 exec,-1
s_mov_b32 s59,2147483648
buffer_load_dwordx4 v1,s[8:11],s63 offen offset:2048 sc1 lds
buffer_load_dwordx4 v1,s[8:11],s63 offen offset:3072 sc1 lds
s_add_u32 m0,s61,8192
s_add_u32 s63,s60,8192
buffer_load_dwordx4 v1,s[8:11],s63 offen sc1 lds
buffer_load_dwordx4 v1,s[8:11],s63 offen offset:1024 sc1 lds
s_lshl_b32 s62,s46,10
s_add_u32 s62,s62,40960
s_add_u32 m0,s66,s62
s_add_u32 s63,s67,s62
buffer_load_dwordx4 v1,s[8:11],s63 offen sc1 lds
s_add_u32 m0,s66,45056
s_add_u32 s63,s67,45056
buffer_load_dwordx4 v1,s[8:11],s63 offen sc1 lds
s_mov_b32 s35,s42
s_mov_b32 s53,s33
s_mov_b32 s54,s34
s_add_u32 s32,s32,1
s_mov_b32 s33,s40
s_mov_b32 s34,s41
s_mov_b64 s[76:77],s[80:81]
s_sub_u32 s57,46080,s57
v_swap_b32 v16,v18
v_swap_b32 v17,v19
s_mov_b32 s51,s53
s_mov_b32 s52,s54
s_waitcnt vmcnt(7)
s_branch W3_GO
W3_NEXT:
s_sub_u32 s57,46080,s57
v_swap_b32 v16,v18
v_swap_b32 v17,v19
s_mov_b32 s51,s53
s_mov_b32 s52,s54
s_waitcnt vmcnt(2)
W3_GO:
s_barrier
ds_read_b128 v[24:27],v16 offset:0
ds_read_b128 v[28:31],v17 offset:0
ds_read_b128 v[32:35],v16 offset:10240
ds_read_b128 v[36:39],v17 offset:10240
ds_read_b128 v[40:43],v16 offset:20480
ds_read_b128 v[44:47],v17 offset:20480
ds_read_b128 v[48:51],v16 offset:30720
buffer_load_dword v3,v2,s[8:11],s35 offen sc1
s_waitcnt lgkmcnt(6)
v_mfma_f32_32x32x16_bf16 v[56:71],a[0:3],v[24:27],0
ds_read_b128 v[52:55],v17 offset:30720
s_add_u32 s62,s32,1
s_min_u32 s62,s62,127
s_sub_u32 s60,s62,17
s_waitcnt lgkmcnt(6)
v_mfma_f32_32x32x16_bf16 v[56:71],a[4:7],v[28:31],v[56:71]
ds_read_b128 v[24:27],v16 offset:2048
s_lshr_b32 s41,s60,1
s_and_b32 s40,s60,1
s_mul_i32 s71,s51,4
s_waitcnt lgkmcnt(5)
v_mfma_f32_32x32x16_bf16 v[56:71],a[40:43],v[32:35],v[56:71]
ds_read_b128 v[28:31],v17 offset:2048
s_cmp_eq_u32 s40,0
s_cselect_b32 s61,17,0
s_add_u32 s41,s41,s61
s_sub_u32 s61,s60,47
v_mfma_f32_32x32x16_bf16 v[56:71],a[44:47],v[36:39],v[56:71]
ds_read_b128 v[32:35],v16 offset:12288
s_cmp_ge_u32 s60,94
s_cselect_b32 s41,s61,s41
s_cselect_b32 s40,1,s40
s_waitcnt lgkmcnt(5)
v_mfma_f32_32x32x16_bf16 v[56:71],a[80:83],v[40:43],v[56:71]
ds_read_b128 v[36:39],v17 offset:12288
s_cmp_lt_u32 s62,17
s_cselect_b32 s41,s62,s41
s_cselect_b32 s40,0,s40
s_lshl_b32 s42,s40,6
v_mfma_f32_32x32x16_bf16 v[56:71],a[84:87],v[44:47],v[56:71]
ds_read_b128 v[40:43],v16 offset:22528
s_add_u32 s42,s42,s41
s_lshl_b32 s42,s42,9
s_add_u32 s42,s42,325632
s_waitcnt lgkmcnt(5)
v_mfma_f32_32x32x16_bf16 v[56:71],a[120:123],v[48:51],v[56:71]
ds_read_b128 v[44:47],v17 offset:22528
s_cmp_lt_u32 s41,4
s_cselect_b64 s[80:81],s[78:79],-1
s_and_b32 s72,s52,3
s_add_u32 s71,s71,s72
v_mfma_f32_32x32x16_bf16 v[56:71],a[124:127],v[52:55],v[56:71]
ds_read_b128 v[48:51],v16 offset:32768
s_mul_i32 s71,s71,98304
s_add_u32 s71,s71,242778112
s_lshl_b32 s72,s56,11
s_waitcnt lgkmcnt(5)
v_mfma_f32_32x32x16_bf16 v[56:71],a[8:11],v[24:27],v[56:71]
ds_read_b128 v[52:55],v17 offset:32768
s_add_u32 s71,s71,s72
s_lshl_b32 s82,s51,6
s_add_u32 s82,s82,s52
s_lshl_b32 s82,s82,9
v_mfma_f32_32x32x16_bf16 v[56:71],a[12:15],v[28:31],v[56:71]
ds_read_b128 v[24:27],v16 offset:4096
s_add_u32 s82,s82,589824
s_lshl_b32 s70,s56,2
s_add_u32 s82,s82,s70
s_waitcnt lgkmcnt(5)
v_mfma_f32_32x32x16_bf16 v[56:71],a[48:51],v[32:35],v[56:71]
ds_read_b128 v[28:31],v17 offset:4096
v_mfma_f32_32x32x16_bf16 v[56:71],a[52:55],v[36:39],v[56:71]
ds_read_b128 v[32:35],v16 offset:14336
s_waitcnt lgkmcnt(5)
v_mfma_f32_32x32x16_bf16 v[56:71],a[88:91],v[40:43],v[56:71]
ds_read_b128 v[36:39],v17 offset:14336
s_waitcnt vmcnt(0)
s_mov_b64 exec,1
s_cmp_lg_u32 s49,0
s_cbranch_scc0 ls_307
buffer_store_dword v5,v1,s[8:11],s59 offen sc1
s_branch ls_308
ls_307:
buffer_store_dword v5,v1,s[8:11],s59 offen
ls_308:
s_mov_b64 exec,-1
s_mov_b32 s59,2147483648
v_mfma_f32_32x32x16_bf16 v[56:71],a[92:95],v[44:47],v[56:71]
ds_read_b128 v[40:43],v16 offset:24576
v_cmp_eq_u32 vcc,0,v3
s_and_b64 vcc,vcc,s[76:77]
s_cselect_b32 s37,2147483648,0
s_waitcnt lgkmcnt(5)
v_mfma_f32_32x32x16_bf16 v[56:71],a[128:131],v[48:51],v[56:71]
ds_read_b128 v[44:47],v17 offset:24576
s_cmp_lt_u32 s32,128
s_cselect_b32 s37,s37,2147483648
s_sub_u32 s66,46080,s57
s_mul_i32 s60,s33,8
v_mfma_f32_32x32x16_bf16 v[56:71],a[132:135],v[52:55],v[56:71]
ds_read_b128 v[48:51],v16 offset:34816
s_and_b32 s61,s34,7
s_add_u32 s60,s60,s61
s_mul_i32 s60,s60,46080
s_waitcnt lgkmcnt(5)
v_mfma_f32_32x32x16_bf16 v[56:71],a[16:19],v[24:27],v[56:71]
ds_read_b128 v[52:55],v17 offset:34816
s_add_u32 s60,s60,s37
s_add_u32 s60,s60,212467712
s_mov_b32 s67,s60
s_mul_i32 s61,s46,10240
s_barrier
v_mfma_f32_32x32x16_bf16 v[56:71],a[20:23],v[28:31],v[56:71]
ds_read_b128 v[24:27],v16 offset:6144
v_add_u32 v183,s57,v182
s_add_u32 s60,s60,s61
s_add_u32 s61,s61,s66
s_waitcnt lgkmcnt(5)
v_mfma_f32_32x32x16_bf16 v[56:71],a[56:59],v[32:35],v[56:71]
ds_read_b128 v[28:31],v17 offset:6144
v_add_u32 v8,0x800,v183
s_add_u32 m0,s61,0
s_add_u32 s63,s60,0
v_mfma_f32_32x32x16_bf16 v[56:71],a[60:63],v[36:39],v[56:71]
ds_read_b128 v[32:35],v16 offset:16384
ds_read2_b64 v[160:163],v183 offset0:0 offset1:32
s_waitcnt lgkmcnt(6)
v_mfma_f32_32x32x16_bf16 v[56:71],a[96:99],v[40:43],v[56:71]
ds_read_b128 v[36:39],v17 offset:16384
ds_read2_b64 v[164:167],v183 offset0:64 offset1:96
buffer_load_dwordx4 v1,s[8:11],s63 offen sc1 lds
v_mfma_f32_32x32x16_bf16 v[56:71],a[100:103],v[44:47],v[56:71]
ds_read_b128 v[40:43],v16 offset:26624
ds_read2_b64 v[168:171],v183 offset0:128 offset1:160
s_waitcnt lgkmcnt(8)
v_mfma_f32_32x32x16_bf16 v[56:71],a[136:139],v[48:51],v[56:71]
ds_read_b128 v[44:47],v17 offset:26624
ds_read2_b64 v[172:175],v183 offset0:192 offset1:224
buffer_load_dwordx4 v1,s[8:11],s63 offen offset:1024 sc1 lds
v_mfma_f32_32x32x16_bf16 v[56:71],a[140:143],v[52:55],v[56:71]
ds_read_b128 v[48:51],v16 offset:36864
ds_read2_b64 v[176:179],v8 offset0:0 offset1:32
s_waitcnt lgkmcnt(10)
v_mfma_f32_32x32x16_bf16 v[56:71],a[24:27],v[24:27],v[56:71]
ds_read_b128 v[52:55],v17 offset:36864
buffer_load_dwordx4 v1,s[8:11],s63 offen offset:2048 sc1 lds
v_mfma_f32_32x32x16_bf16 v[56:71],a[28:31],v[28:31],v[56:71]
ds_read_b128 v[24:27],v16 offset:8192
s_waitcnt lgkmcnt(9)
v_mfma_f32_32x32x16_bf16 v[56:71],a[64:67],v[32:35],v[56:71]
ds_read_b128 v[28:31],v17 offset:8192
buffer_load_dwordx4 v1,s[8:11],s63 offen offset:3072 sc1 lds
s_add_u32 m0,s61,4096
s_add_u32 s63,s60,4096
v_mfma_f32_32x32x16_bf16 v[56:71],a[68:71],v[36:39],v[56:71]
ds_read_b128 v[32:35],v16 offset:18432
s_waitcnt lgkmcnt(4)
v_add_f32 v160,v160,v170
v_add_f32 v161,v161,v171
v_mfma_f32_32x32x16_bf16 v[56:71],a[104:107],v[40:43],v[56:71]
ds_read_b128 v[36:39],v17 offset:18432
buffer_load_dwordx4 v1,s[8:11],s63 offen sc1 lds
v_add_f32 v162,v162,v172
v_add_f32 v163,v163,v173
v_mfma_f32_32x32x16_bf16 v[56:71],a[108:111],v[44:47],v[56:71]
ds_read_b128 v[40:43],v16 offset:28672
v_add_f32 v164,v164,v174
v_add_f32 v165,v165,v175
v_add_f32 v166,v166,v176
s_waitcnt lgkmcnt(5)
v_mfma_f32_32x32x16_bf16 v[56:71],a[144:147],v[48:51],v[56:71]
ds_read_b128 v[44:47],v17 offset:28672
buffer_load_dword v3,v2,s[8:11],s35 offen sc1
v_add_f32 v167,v167,v177
v_mfma_f32_32x32x16_bf16 v[56:71],a[148:151],v[52:55],v[56:71]
ds_read_b128 v[48:51],v16 offset:38912
buffer_load_dwordx4 v1,s[8:11],s63 offen offset:1024 sc1 lds
v_add_f32 v168,v168,v178
s_waitcnt lgkmcnt(5)
v_mfma_f32_32x32x16_bf16 v[56:71],a[32:35],v[24:27],v[56:71]
ds_read_b128 v[52:55],v17 offset:38912
v_add_f32 v169,v169,v179
v_add_f32 v160,v160,v162
v_add_f32 v161,v161,v163
v_add_f32 v164,v164,v166
v_mfma_f32_32x32x16_bf16 v[56:71],a[36:39],v[28:31],v[56:71]
buffer_load_dwordx4 v1,s[8:11],s63 offen offset:2048 sc1 lds
v_add_f32 v165,v165,v167
v_add_f32 v160,v160,v164
v_add_f32 v161,v161,v165
s_waitcnt lgkmcnt(4)
v_mfma_f32_32x32x16_bf16 v[56:71],a[72:75],v[32:35],v[56:71]
v_add_f32 v160,v160,v168
v_add_f32 v161,v161,v169
v_mov_b32 v162,v160
v_mov_b32 v163,v161
s_nop 0
v_permlane32_swap_b32 v160,v162
v_mfma_f32_32x32x16_bf16 v[56:71],a[76:79],v[36:39],v[56:71]
buffer_load_dwordx4 v1,s[8:11],s63 offen offset:3072 sc1 lds
s_add_u32 m0,s61,8192
s_add_u32 s63,s60,8192
v_permlane32_swap_b32 v161,v163
s_waitcnt lgkmcnt(2)
v_mfma_f32_32x32x16_bf16 v[56:71],a[112:115],v[40:43],v[56:71]
v_add_f32 v180,v160,v162
v_add_f32 v181,v161,v163
v_mul_f32 v180,0x3acccccd,v180
v_mul_f32 v181,0x3acccccd,v181
v_fma_f32 v181,-v180,v180,v181
v_mfma_f32_32x32x16_bf16 v[56:71],a[116:119],v[44:47],v[56:71]
buffer_load_dwordx4 v1,s[8:11],s63 offen sc1 lds
v_max_f32 v181,0,v181
v_cvt_pk_bf16_f32 v8,v180,v181
v_lshlrev_b32 v180,16,v8
s_waitcnt lgkmcnt(0)
v_mfma_f32_32x32x16_bf16 v[56:71],a[152:155],v[48:51],v[56:71]
v_and_b32 v181,0xffff0000,v8
v_add_f32 v181,0x3727c5ac,v181
v_cvt_pk_bf16_f32 v8,v181,v181
v_lshlrev_b32 v181,16,v8
v_sqrt_f32 v181,v181
v_mfma_f32_32x32x16_bf16 v[56:71],a[156:159],v[52:55],v[56:71]
buffer_load_dwordx4 v1,s[8:11],s63 offen offset:1024 sc1 lds
s_lshl_b32 s62,s46,10
s_add_u32 s62,s62,40960
s_add_u32 m0,s66,s62
s_add_u32 s63,s67,s62
buffer_load_dwordx4 v1,s[8:11],s63 offen sc1 lds
s_add_u32 m0,s66,45056
s_add_u32 s63,s67,45056
buffer_load_dwordx4 v1,s[8:11],s63 offen sc1 lds
v_cvt_pk_bf16_f32 v8,v181,v181
v_lshlrev_b32 v181,16,v8
v_rcp_f32 v181,v181
s_cmp_eq_u32 s37,0
s_cbranch_scc0 sec_311
s_mov_b32 s35,s42
s_mov_b32 s53,s33
s_mov_b32 s54,s34
s_add_u32 s32,s32,1
s_mov_b32 s33,s40
s_mov_b32 s34,s41
s_mov_b64 s[76:77],s[80:81]
s_nop 2
ep_309:
v_pk_fma_f32 v[56:57],v[144:145],v[180:181],v[56:57] op_sel_hi:[1,0,1] neg_lo:[0,1,0] neg_hi:[0,1,0]
v_pk_fma_f32 v[58:59],v[146:147],v[180:181],v[58:59] op_sel_hi:[1,0,1] neg_lo:[0,1,0] neg_hi:[0,1,0]
v_pk_fma_f32 v[60:61],v[148:149],v[180:181],v[60:61] op_sel_hi:[1,0,1] neg_lo:[0,1,0] neg_hi:[0,1,0]
v_pk_fma_f32 v[62:63],v[150:151],v[180:181],v[62:63] op_sel_hi:[1,0,1] neg_lo:[0,1,0] neg_hi:[0,1,0]
v_pk_fma_f32 v[64:65],v[152:153],v[180:181],v[64:65] op_sel_hi:[1,0,1] neg_lo:[0,1,0] neg_hi:[0,1,0]
v_pk_fma_f32 v[66:67],v[154:155],v[180:181],v[66:67] op_sel_hi:[1,0,1] neg_lo:[0,1,0] neg_hi:[0,1,0]
v_pk_fma_f32 v[68:69],v[156:157],v[180:181],v[68:69] op_sel_hi:[1,0,1] neg_lo:[0,1,0] neg_hi:[0,1,0]
v_pk_fma_f32 v[70:71],v[158:159],v[180:181],v[70:71] op_sel_hi:[1,0,1] neg_lo:[0,1,0] neg_hi:[0,1,0]
v_pk_mul_f32 v[56:57],v[56:57],v[180:181] op_sel:[0,1] op_sel_hi:[1,1]
v_pk_mul_f32 v[58:59],v[58:59],v[180:181] op_sel:[0,1] op_sel_hi:[1,1]
v_pk_mul_f32 v[60:61],v[60:61],v[180:181] op_sel:[0,1] op_sel_hi:[1,1]
v_pk_mul_f32 v[62:63],v[62:63],v[180:181] op_sel:[0,1] op_sel_hi:[1,1]
v_pk_mul_f32 v[64:65],v[64:65],v[180:181] op_sel:[0,1] op_sel_hi:[1,1]
v_pk_mul_f32 v[66:67],v[66:67],v[180:181] op_sel:[0,1] op_sel_hi:[1,1]
v_pk_mul_f32 v[68:69],v[68:69],v[180:181] op_sel:[0,1] op_sel_hi:[1,1]
v_pk_mul_f32 v[70:71],v[70:71],v[180:181] op_sel:[0,1] op_sel_hi:[1,1]
v_pk_mul_f32 v[124:125],v[56:57],v[56:57]
v_pk_mul_f32 v[126:127],v[58:59],v[58:59]
v_pk_mul_f32 v[128:129],v[60:61],v[60:61]
v_pk_mul_f32 v[130:131],v[62:63],v[62:63]
v_pk_mul_f32 v[132:133],v[64:65],v[64:65]
v_pk_mul_f32 v[134:135],v[66:67],v[66:67]
v_pk_mul_f32 v[136:137],v[68:69],v[68:69]
v_pk_mul_f32 v[138:139],v[70:71],v[70:71]
v_pk_fma_f32 v[124:125],v[124:125],v[112:113],v[112:113] op_sel:[0,1,0] op_sel_hi:[1,1,0]
v_pk_fma_f32 v[126:127],v[126:127],v[112:113],v[112:113] op_sel:[0,1,0] op_sel_hi:[1,1,0]
v_pk_fma_f32 v[128:129],v[128:129],v[112:113],v[112:113] op_sel:[0,1,0] op_sel_hi:[1,1,0]
v_pk_fma_f32 v[130:131],v[130:131],v[112:113],v[112:113] op_sel:[0,1,0] op_sel_hi:[1,1,0]
v_pk_fma_f32 v[132:133],v[132:133],v[112:113],v[112:113] op_sel:[0,1,0] op_sel_hi:[1,1,0]
v_pk_fma_f32 v[134:135],v[134:135],v[112:113],v[112:113] op_sel:[0,1,0] op_sel_hi:[1,1,0]
v_pk_fma_f32 v[136:137],v[136:137],v[112:113],v[112:113] op_sel:[0,1,0] op_sel_hi:[1,1,0]
v_pk_fma_f32 v[138:139],v[138:139],v[112:113],v[112:113] op_sel:[0,1,0] op_sel_hi:[1,1,0]
v_pk_mul_f32 v[124:125],v[124:125],v[56:57]
v_pk_mul_f32 v[126:127],v[126:127],v[58:59]
v_pk_mul_f32 v[128:129],v[128:129],v[60:61]
v_pk_mul_f32 v[130:131],v[130:131],v[62:63]
v_pk_mul_f32 v[132:133],v[132:133],v[64:65]
v_pk_mul_f32 v[134:135],v[134:135],v[66:67]
v_pk_mul_f32 v[136:137],v[136:137],v[68:69]
v_pk_mul_f32 v[138:139],v[138:139],v[70:71]
v_exp_f32 v124,v124
v_exp_f32 v125,v125
v_exp_f32 v126,v126
v_exp_f32 v127,v127
v_exp_f32 v128,v128
v_exp_f32 v129,v129
v_exp_f32 v130,v130
v_exp_f32 v131,v131
v_exp_f32 v132,v132
v_exp_f32 v133,v133
v_exp_f32 v134,v134
v_exp_f32 v135,v135
v_exp_f32 v136,v136
v_exp_f32 v137,v137
v_exp_f32 v138,v138
v_exp_f32 v139,v139
v_pk_add_f32 v[124:125],v[124:125],1.0 op_sel_hi:[1,0]
v_pk_add_f32 v[126:127],v[126:127],1.0 op_sel_hi:[1,0]
v_pk_add_f32 v[128:129],v[128:129],1.0 op_sel_hi:[1,0]
v_pk_add_f32 v[130:131],v[130:131],1.0 op_sel_hi:[1,0]
v_pk_add_f32 v[132:133],v[132:133],1.0 op_sel_hi:[1,0]
v_pk_add_f32 v[134:135],v[134:135],1.0 op_sel_hi:[1,0]
v_pk_add_f32 v[136:137],v[136:137],1.0 op_sel_hi:[1,0]
v_pk_add_f32 v[138:139],v[138:139],1.0 op_sel_hi:[1,0]
v_rcp_f32 v124,v124
v_rcp_f32 v125,v125
v_rcp_f32 v126,v126
v_rcp_f32 v127,v127
v_rcp_f32 v128,v128
v_rcp_f32 v129,v129
v_rcp_f32 v130,v130
v_rcp_f32 v131,v131
v_rcp_f32 v132,v132
v_rcp_f32 v133,v133
v_rcp_f32 v134,v134
v_rcp_f32 v135,v135
v_rcp_f32 v136,v136
v_rcp_f32 v137,v137
v_rcp_f32 v138,v138
v_rcp_f32 v139,v139
v_pk_mul_f32 v[56:57],v[56:57],v[124:125]
v_pk_mul_f32 v[58:59],v[58:59],v[126:127]
v_pk_mul_f32 v[60:61],v[60:61],v[128:129]
v_pk_mul_f32 v[62:63],v[62:63],v[130:131]
v_pk_mul_f32 v[64:65],v[64:65],v[132:133]
v_pk_mul_f32 v[66:67],v[66:67],v[134:135]
v_pk_mul_f32 v[68:69],v[68:69],v[136:137]
v_pk_mul_f32 v[70:71],v[70:71],v[138:139]
v_cvt_pk_bf16_f32 v116,v56,v57
v_cvt_pk_bf16_f32 v117,v58,v59
v_cvt_pk_bf16_f32 v118,v60,v61
v_cvt_pk_bf16_f32 v119,v62,v63
v_cvt_pk_bf16_f32 v120,v64,v65
v_cvt_pk_bf16_f32 v121,v66,v67
v_cvt_pk_bf16_f32 v122,v68,v69
v_cvt_pk_bf16_f32 v123,v70,v71
s_cmp_lg_u32 s49,0
s_cbranch_scc0 ls_312
buffer_store_dwordx4 v[116:119],v20,s[8:11],s71 offen sc1
buffer_store_dwordx4 v[120:123],v21,s[8:11],s71 offen sc1
s_branch ls_313
ls_312:
buffer_store_dwordx4 v[116:119],v20,s[8:11],s71 offen
buffer_store_dwordx4 v[120:123],v21,s[8:11],s71 offen
ls_313:
s_mov_b32 s59,s82
s_cmp_eq_u32 s37,0
s_cbranch_scc1 W3_NEXT
s_waitcnt vmcnt(2)
v_cmp_eq_u32 vcc,0,v3
s_and_b64 vcc,vcc,s[76:77]
s_cselect_b32 s37,2147483648,0
s_cmp_lt_u32 s32,128
s_cselect_b32 s37,s37,2147483648
s_cmp_eq_u32 s37,0
s_cbranch_scc1 W3_COLD2
s_waitcnt vmcnt(0)
s_mov_b64 exec,1
s_cmp_lg_u32 s49,0
s_cbranch_scc0 ls_314
buffer_store_dword v5,v1,s[8:11],s59 offen sc1
s_branch ls_315
ls_314:
buffer_store_dword v5,v1,s[8:11],s59 offen
ls_315:
s_mov_b64 exec,-1
s_mov_b32 s59,2147483648
s_cmp_lt_u32 s32,128
s_cbranch_scc1 W3_COLD
s_branch W3_END
sec_311:
s_waitcnt vmcnt(7)
v_cmp_eq_u32 vcc,0,v3
s_and_b64 vcc,vcc,s[76:77]
s_cselect_b32 s37,2147483648,0
s_cmp_lt_u32 s32,128
s_cselect_b32 s37,s37,2147483648
s_cmp_lg_u32 s37,0
s_cbranch_scc1 nr_310
s_sub_u32 s66,46080,s57
s_mul_i32 s60,s33,8
s_and_b32 s61,s34,7
s_add_u32 s60,s60,s61
s_mul_i32 s60,s60,46080
s_add_u32 s60,s60,s37
s_add_u32 s60,s60,212467712
s_mov_b32 s67,s60
s_mul_i32 s61,s46,10240
s_add_u32 s60,s60,s61
s_add_u32 s61,s61,s66
s_add_u32 m0,s61,0
s_add_u32 s63,s60,0
buffer_load_dwordx4 v1,s[8:11],s63 offen sc1 lds
v_pk_fma_f32 v[56:57],v[144:145],v[180:181],v[56:57] op_sel_hi:[1,0,1] neg_lo:[0,1,0] neg_hi:[0,1,0]
v_pk_fma_f32 v[58:59],v[146:147],v[180:181],v[58:59] op_sel_hi:[1,0,1] neg_lo:[0,1,0] neg_hi:[0,1,0]
v_pk_fma_f32 v[60:61],v[148:149],v[180:181],v[60:61] op_sel_hi:[1,0,1] neg_lo:[0,1,0] neg_hi:[0,1,0]
v_pk_fma_f32 v[62:63],v[150:151],v[180:181],v[62:63] op_sel_hi:[1,0,1] neg_lo:[0,1,0] neg_hi:[0,1,0]
v_pk_fma_f32 v[64:65],v[152:153],v[180:181],v[64:65] op_sel_hi:[1,0,1] neg_lo:[0,1,0] neg_hi:[0,1,0]
v_pk_fma_f32 v[66:67],v[154:155],v[180:181],v[66:67] op_sel_hi:[1,0,1] neg_lo:[0,1,0] neg_hi:[0,1,0]
v_pk_fma_f32 v[68:69],v[156:157],v[180:181],v[68:69] op_sel_hi:[1,0,1] neg_lo:[0,1,0] neg_hi:[0,1,0]
buffer_load_dwordx4 v1,s[8:11],s63 offen offset:1024 sc1 lds
v_pk_fma_f32 v[70:71],v[158:159],v[180:181],v[70:71] op_sel_hi:[1,0,1] neg_lo:[0,1,0] neg_hi:[0,1,0]
v_pk_mul_f32 v[56:57],v[56:57],v[180:181] op_sel:[0,1] op_sel_hi:[1,1]
v_pk_mul_f32 v[58:59],v[58:59],v[180:181] op_sel:[0,1] op_sel_hi:[1,1]
v_pk_mul_f32 v[60:61],v[60:61],v[180:181] op_sel:[0,1] op_sel_hi:[1,1]
v_pk_mul_f32 v[62:63],v[62:63],v[180:181] op_sel:[0,1] op_sel_hi:[1,1]
v_pk_mul_f32 v[64:65],v[64:65],v[180:181] op_sel:[0,1] op_sel_hi:[1,1]
v_pk_mul_f32 v[66:67],v[66:67],v[180:181] op_sel:[0,1] op_sel_hi:[1,1]
buffer_load_dwordx4 v1,s[8:11],s63 offen offset:2048 sc1 lds
v_pk_mul_f32 v[68:69],v[68:69],v[180:181] op_sel:[0,1] op_sel_hi:[1,1]
v_pk_mul_f32 v[70:71],v[70:71],v[180:181] op_sel:[0,1] op_sel_hi:[1,1]
v_pk_mul_f32 v[124:125],v[56:57],v[56:57]
v_pk_mul_f32 v[126:127],v[58:59],v[58:59]
v_pk_mul_f32 v[128:129],v[60:61],v[60:61]
v_pk_mul_f32 v[130:131],v[62:63],v[62:63]
v_pk_mul_f32 v[132:133],v[64:65],v[64:65]
buffer_load_dwordx4 v1,s[8:11],s63 offen offset:3072 sc1 lds
v_pk_mul_f32 v[134:135],v[66:67],v[66:67]
v_pk_mul_f32 v[136:137],v[68:69],v[68:69]
v_pk_mul_f32 v[138:139],v[70:71],v[70:71]
v_pk_fma_f32 v[124:125],v[124:125],v[112:113],v[112:113] op_sel:[0,1,0] op_sel_hi:[1,1,0]
v_pk_fma_f32 v[126:127],v[126:127],v[112:113],v[112:113] op_sel:[0,1,0] op_sel_hi:[1,1,0]
v_pk_fma_f32 v[128:129],v[128:129],v[112:113],v[112:113] op_sel:[0,1,0] op_sel_hi:[1,1,0]
v_pk_fma_f32 v[130:131],v[130:131],v[112:113],v[112:113] op_sel:[0,1,0] op_sel_hi:[1,1,0]
s_add_u32 m0,s61,4096
s_add_u32 s63,s60,4096
buffer_load_dwordx4 v1,s[8:11],s63 offen sc1 lds
v_pk_fma_f32 v[132:133],v[132:133],v[112:113],v[112:113] op_sel:[0,1,0] op_sel_hi:[1,1,0]
v_pk_fma_f32 v[134:135],v[134:135],v[112:113],v[112:113] op_sel:[0,1,0] op_sel_hi:[1,1,0]
v_pk_fma_f32 v[136:137],v[136:137],v[112:113],v[112:113] op_sel:[0,1,0] op_sel_hi:[1,1,0]
v_pk_fma_f32 v[138:139],v[138:139],v[112:113],v[112:113] op_sel:[0,1,0] op_sel_hi:[1,1,0]
v_pk_mul_f32 v[124:125],v[124:125],v[56:57]
v_pk_mul_f32 v[126:127],v[126:127],v[58:59]
v_pk_mul_f32 v[128:129],v[128:129],v[60:61]
buffer_load_dwordx4 v1,s[8:11],s63 offen offset:1024 sc1 lds
v_pk_mul_f32 v[130:131],v[130:131],v[62:63]
v_pk_mul_f32 v[132:133],v[132:133],v[64:65]
v_pk_mul_f32 v[134:135],v[134:135],v[66:67]
v_pk_mul_f32 v[136:137],v[136:137],v[68:69]
v_pk_mul_f32 v[138:139],v[138:139],v[70:71]
v_exp_f32 v124,v124
v_exp_f32 v125,v125
buffer_load_dwordx4 v1,s[8:11],s63 offen offset:2048 sc1 lds
v_exp_f32 v126,v126
v_exp_f32 v127,v127
v_exp_f32 v128,v128
v_exp_f32 v129,v129
v_exp_f32 v130,v130
v_exp_f32 v131,v131
v_exp_f32 v132,v132
buffer_load_dwordx4 v1,s[8:11],s63 offen offset:3072 sc1 lds
v_exp_f32 v133,v133
v_exp_f32 v134,v134
v_exp_f32 v135,v135
v_exp_f32 v136,v136
v_exp_f32 v137,v137
v_exp_f32 v138,v138
v_exp_f32 v139,v139
s_add_u32 m0,s61,8192
s_add_u32 s63,s60,8192
buffer_load_dwordx4 v1,s[8:11],s63 offen sc1 lds
v_pk_add_f32 v[124:125],v[124:125],1.0 op_sel_hi:[1,0]
v_pk_add_f32 v[126:127],v[126:127],1.0 op_sel_hi:[1,0]
v_pk_add_f32 v[128:129],v[128:129],1.0 op_sel_hi:[1,0]
v_pk_add_f32 v[130:131],v[130:131],1.0 op_sel_hi:[1,0]
v_pk_add_f32 v[132:133],v[132:133],1.0 op_sel_hi:[1,0]
v_pk_add_f32 v[134:135],v[134:135],1.0 op_sel_hi:[1,0]
v_pk_add_f32 v[136:137],v[136:137],1.0 op_sel_hi:[1,0]
buffer_load_dwordx4 v1,s[8:11],s63 offen offset:1024 sc1 lds
v_pk_add_f32 v[138:139],v[138:139],1.0 op_sel_hi:[1,0]
v_rcp_f32 v124,v124
v_rcp_f32 v125,v125
v_rcp_f32 v126,v126
v_rcp_f32 v127,v127
v_rcp_f32 v128,v128
v_rcp_f32 v129,v129
s_lshl_b32 s62,s46,10
s_add_u32 s62,s62,40960
s_add_u32 m0,s66,s62
s_add_u32 s63,s67,s62
buffer_load_dwordx4 v1,s[8:11],s63 offen sc1 lds
v_rcp_f32 v130,v130
v_rcp_f32 v131,v131
v_rcp_f32 v132,v132
v_rcp_f32 v133,v133
v_rcp_f32 v134,v134
v_rcp_f32 v135,v135
v_rcp_f32 v136,v136
s_add_u32 m0,s66,45056
s_add_u32 s63,s67,45056
buffer_load_dwordx4 v1,s[8:11],s63 offen sc1 lds
v_rcp_f32 v137,v137
v_rcp_f32 v138,v138
v_rcp_f32 v139,v139
v_pk_mul_f32 v[56:57],v[56:57],v[124:125]
v_pk_mul_f32 v[58:59],v[58:59],v[126:127]
v_pk_mul_f32 v[60:61],v[60:61],v[128:129]
v_pk_mul_f32 v[62:63],v[62:63],v[130:131]
s_mov_b32 s35,s42
s_mov_b32 s53,s33
s_mov_b32 s54,s34
s_add_u32 s32,s32,1
s_mov_b32 s33,s40
s_mov_b32 s34,s41
s_mov_b64 s[76:77],s[80:81]
v_pk_mul_f32 v[64:65],v[64:65],v[132:133]
v_pk_mul_f32 v[66:67],v[66:67],v[134:135]
v_pk_mul_f32 v[68:69],v[68:69],v[136:137]
v_pk_mul_f32 v[70:71],v[70:71],v[138:139]
v_cvt_pk_bf16_f32 v116,v56,v57
v_cvt_pk_bf16_f32 v117,v58,v59
v_cvt_pk_bf16_f32 v118,v60,v61
v_cvt_pk_bf16_f32 v119,v62,v63
v_cvt_pk_bf16_f32 v120,v64,v65
v_cvt_pk_bf16_f32 v121,v66,v67
v_cvt_pk_bf16_f32 v122,v68,v69
v_cvt_pk_bf16_f32 v123,v70,v71
s_cmp_lg_u32 s49,0
s_cbranch_scc0 ls_316
buffer_store_dwordx4 v[116:119],v20,s[8:11],s71 offen sc1
buffer_store_dwordx4 v[120:123],v21,s[8:11],s71 offen sc1
s_branch ls_317
ls_316:
buffer_store_dwordx4 v[116:119],v20,s[8:11],s71 offen
buffer_store_dwordx4 v[120:123],v21,s[8:11],s71 offen
ls_317:
s_mov_b32 s59,s82
s_branch W3_NEXT
nr_310:
buffer_load_dword v3,v2,s[8:11],s35 offen sc1
s_branch ep_309
W3_END:
s_endpgm
ROLE_W4:
v_lshlrev_b32 v1,4,v0
v_mov_b32 v5,1
s_lshl_b32 s56,s48,2
s_add_u32 s56,s56,s46
v_bfe_u32 v6,v0,2,2
v_lshrrev_b32 v7,4,v0
v_add_u32 v7,v6,v7
v_and_b32 v7,3,v7
v_and_b32 v15,3,v0
v_lshlrev_b32 v15,4,v15
v_lshl_add_u32 v15,v7,6,v15
v_lshl_add_u32 v15,v6,8,v15
v_lshrrev_b32 v6,5,v0
v_bfe_u32 v7,v0,4,1
v_lshlrev_b32 v208,10,v7
v_lshl_add_u32 v208,v6,8,v208
v_and_b32 v6,15,v0
v_lshl_add_u32 v208,v6,4,v208
v_lshrrev_b32 v6,5,v0
v_add_u32 v6,2,v6
v_bfe_u32 v7,v0,4,1
v_lshlrev_b32 v209,10,v7
v_lshl_add_u32 v209,v6,8,v209
v_and_b32 v6,15,v0
v_lshl_add_u32 v209,v6,4,v209
v_min_u32 v2,11,v0
s_mul_i32 s60,s46,12
v_add_u32 v2,s60,v2
v_lshlrev_b32 v2,2,v2
s_and_b32 s60,s46,1
s_lshl_b32 s68,s48,1
s_add_u32 s68,s68,s60
s_lshr_b32 s69,s46,1
s_mul_i32 s71,s46,24576
s_mul_i32 s58,s46,491520
s_lshl_b32 s61,s48,7
s_add_u32 s58,s58,s61
s_add_u32 s71,s71,242778112
v_and_b32 v6,15,v0
v_lshlrev_b32 v204,3,v6
s_lshl_b32 s60,s69,4
v_add_u32 v6,s60,v6
v_mul_u32_u24 v205,1280,v6
v_bfe_u32 v6,v0,4,1
v_lshl_add_u32 v205,v6,5,v205
v_lshrrev_b32 v6,5,v0
v_lshl_add_u32 v205,v6,4,v205
s_lshl_b32 s60,s68,6
v_add_u32 v205,s60,v205
s_mov_b32 s76,s40
s_mov_b32 s77,s41
s_mov_b32 s78,2621440
s_mov_b32 s79,0x20000
s_lshl_b32 s70,s68,1
s_add_u32 s70,s70,s69
s_lshl_b32 s70,s70,10
v_bfe_u32 v6,v0,4,1
v_lshlrev_b32 v206,14,v6
v_lshrrev_b32 v6,5,v0
v_lshl_add_u32 v206,v6,8,v206
v_and_b32 v6,15,v0
v_lshl_add_u32 v206,v6,4,v206
s_lshl_b32 s60,s46,11
v_add_u32 v206,s60,v206
s_lshl_b32 s60,s46,13
v_add_u32 v207,s60,v1
s_waitcnt vmcnt(0)
s_barrier
s_cmp_lg_u32 s46,0
s_cbranch_scc1 arr_318
v_mov_b32 v6,1
s_lshl_b32 s3,s49,2
v_mov_b32 v7,s3
s_mov_b64 exec,1
buffer_atomic_add v6,v7,s[12:15],0 offen sc1
s_mov_b64 exec,-1
arr_318:
s_lshl_b32 s3,s49,2
v_mov_b32 v7,s3
s_nop 1
ibw_319:
buffer_load_dword v6,v7,s[12:15],0 offen sc1
s_waitcnt vmcnt(0)
v_cmp_ne_u32 vcc,256,v6
s_nop 0
s_cbranch_vccz ok_320
s_sleep 8
s_sub_u32 s47,s47,1
s_cbranch_scc1 ABORT
s_branch ibw_319
ok_320:
s_cmp_lg_u32 s49,0
s_cbranch_scc1 ibok_321
v_and_b32 v7,7,v0
v_lshlrev_b32 v7,2,v7
buffer_load_dword v6,v7,s[12:15],0 offen offset:32 sc1
s_waitcnt vmcnt(0)
v_cmp_ne_u32 vcc,32,v6
s_nop 0
s_cbranch_vccz ibok_321
s_barrier
s_mov_b32 s49,1
s_mov_b32 s3,s2
s_load_dwordx16 s[16:31],s[0:1],0
s_load_dwordx8 s[32:39],s[0:1],64
s_waitcnt lgkmcnt(0)
s_branch DISPATCH
ibok_321:
s_mul_i32 s63,s46,40960
s_mov_b32 s4,s38
s_mov_b32 s5,s39
s_mov_b32 s6,1966080
s_mov_b32 s7,0x20000
v_lshrrev_b32 v9,3,v0
s_mov_b32 s64,1280
v_mul_lo_u32 v9,v9,s64
v_and_b32 v10,7,v0
v_lshl_add_u32 v6,v10,4,v9
s_add_u32 m0,s63,0
s_add_u32 s65,s58,0
buffer_load_dwordx4 v6,s[4:7],s65 offen lds
s_add_u32 m0,s63,1024
s_add_u32 s65,s58,10240
buffer_load_dwordx4 v6,s[4:7],s65 offen lds
s_add_u32 m0,s63,2048
s_add_u32 s65,s58,20480
buffer_load_dwordx4 v6,s[4:7],s65 offen lds
s_add_u32 m0,s63,3072
s_add_u32 s65,s58,30720
buffer_load_dwordx4 v6,s[4:7],s65 offen lds
s_add_u32 m0,s63,4096
s_add_u32 s65,s58,40960
buffer_load_dwordx4 v6,s[4:7],s65 offen lds
s_add_u32 m0,s63,5120
s_add_u32 s65,s58,51200
buffer_load_dwordx4 v6,s[4:7],s65 offen lds
s_add_u32 m0,s63,6144
s_add_u32 s65,s58,61440
buffer_load_dwordx4 v6,s[4:7],s65 offen lds
s_add_u32 m0,s63,7168
s_add_u32 s65,s58,71680
buffer_load_dwordx4 v6,s[4:7],s65 offen lds
s_add_u32 m0,s63,8192
s_add_u32 s65,s58,81920
buffer_load_dwordx4 v6,s[4:7],s65 offen lds
s_add_u32 m0,s63,9216
s_add_u32 s65,s58,92160
buffer_load_dwordx4 v6,s[4:7],s65 offen lds
s_add_u32 m0,s63,10240
s_add_u32 s65,s58,102400
buffer_load_dwordx4 v6,s[4:7],s65 offen lds
s_add_u32 m0,s63,11264
s_add_u32 s65,s58,112640
buffer_load_dwordx4 v6,s[4:7],s65 offen lds
s_add_u32 m0,s63,12288
s_add_u32 s65,s58,122880
buffer_load_dwordx4 v6,s[4:7],s65 offen lds
s_add_u32 m0,s63,13312
s_add_u32 s65,s58,133120
buffer_load_dwordx4 v6,s[4:7],s65 offen lds
s_add_u32 m0,s63,14336
s_add_u32 s65,s58,143360
buffer_load_dwordx4 v6,s[4:7],s65 offen lds
s_add_u32 m0,s63,15360
s_add_u32 s65,s58,153600
buffer_load_dwordx4 v6,s[4:7],s65 offen lds
s_add_u32 m0,s63,16384
s_add_u32 s65,s58,163840
buffer_load_dwordx4 v6,s[4:7],s65 offen lds
s_add_u32 m0,s63,17408
s_add_u32 s65,s58,174080
buffer_load_dwordx4 v6,s[4:7],s65 offen lds
s_add_u32 m0,s63,18432
s_add_u32 s65,s58,184320
buffer_load_dwordx4 v6,s[4:7],s65 offen lds
s_add_u32 m0,s63,19456
s_add_u32 s65,s58,194560
buffer_load_dwordx4 v6,s[4:7],s65 offen lds
s_add_u32 m0,s63,20480
s_add_u32 s65,s58,204800
buffer_load_dwordx4 v6,s[4:7],s65 offen lds
s_add_u32 m0,s63,21504
s_add_u32 s65,s58,215040
buffer_load_dwordx4 v6,s[4:7],s65 offen lds
s_add_u32 m0,s63,22528
s_add_u32 s65,s58,225280
buffer_load_dwordx4 v6,s[4:7],s65 offen lds
s_add_u32 m0,s63,23552
s_add_u32 s65,s58,235520
buffer_load_dwordx4 v6,s[4:7],s65 offen lds
s_add_u32 m0,s63,24576
s_add_u32 s65,s58,245760
buffer_load_dwordx4 v6,s[4:7],s65 offen lds
s_add_u32 m0,s63,25600
s_add_u32 s65,s58,256000
buffer_load_dwordx4 v6,s[4:7],s65 offen lds
s_add_u32 m0,s63,26624
s_add_u32 s65,s58,266240
buffer_load_dwordx4 v6,s[4:7],s65 offen lds
s_add_u32 m0,s63,27648
s_add_u32 s65,s58,276480
buffer_load_dwordx4 v6,s[4:7],s65 offen lds
s_add_u32 m0,s63,28672
s_add_u32 s65,s58,286720
buffer_load_dwordx4 v6,s[4:7],s65 offen lds
s_add_u32 m0,s63,29696
s_add_u32 s65,s58,296960
buffer_load_dwordx4 v6,s[4:7],s65 offen lds
s_add_u32 m0,s63,30720
s_add_u32 s65,s58,307200
buffer_load_dwordx4 v6,s[4:7],s65 offen lds
s_add_u32 m0,s63,31744
s_add_u32 s65,s58,317440
buffer_load_dwordx4 v6,s[4:7],s65 offen lds
s_add_u32 m0,s63,32768
s_add_u32 s65,s58,327680
buffer_load_dwordx4 v6,s[4:7],s65 offen lds
s_add_u32 m0,s63,33792
s_add_u32 s65,s58,337920
buffer_load_dwordx4 v6,s[4:7],s65 offen lds
s_add_u32 m0,s63,34816
s_add_u32 s65,s58,348160
buffer_load_dwordx4 v6,s[4:7],s65 offen lds
s_add_u32 m0,s63,35840
s_add_u32 s65,s58,358400
buffer_load_dwordx4 v6,s[4:7],s65 offen lds
s_add_u32 m0,s63,36864
s_add_u32 s65,s58,368640
buffer_load_dwordx4 v6,s[4:7],s65 offen lds
s_add_u32 m0,s63,37888
s_add_u32 s65,s58,378880
buffer_load_dwordx4 v6,s[4:7],s65 offen lds
s_add_u32 m0,s63,38912
s_add_u32 s65,s58,389120
buffer_load_dwordx4 v6,s[4:7],s65 offen lds
s_add_u32 m0,s63,39936
s_add_u32 s65,s58,399360
buffer_load_dwordx4 v6,s[4:7],s65 offen lds
s_waitcnt vmcnt(20)
v_bfe_u32 v9,v0,2,2
v_lshrrev_b32 v10,5,v0
v_lshl_add_u32 v9,v10,2,v9
v_mul_u32_u24 v9,128,v9
v_and_b32 v10,1,v0
v_lshl_add_u32 v9,v10,3,v9
v_bfe_u32 v10,v0,1,1
v_lshl_add_u32 v9,v10,5,v9
v_bfe_u32 v10,v0,4,1
v_lshl_add_u32 v9,v10,4,v9
v_add_u32 v7,s63,v9
ds_read_b64_tr_b16 a[0:1],v7 offset:0
ds_read_b64_tr_b16 a[2:3],v7 offset:2048
ds_read_b64_tr_b16 a[4:5],v7 offset:1024
ds_read_b64_tr_b16 a[6:7],v7 offset:3072
ds_read_b64_tr_b16 a[96:97],v7 offset:64
ds_read_b64_tr_b16 a[98:99],v7 offset:2112
ds_read_b64_tr_b16 a[100:101],v7 offset:1088
ds_read_b64_tr_b16 a[102:103],v7 offset:3136
ds_read_b64_tr_b16 a[8:9],v7 offset:4096
ds_read_b64_tr_b16 a[10:11],v7 offset:6144
ds_read_b64_tr_b16 a[12:13],v7 offset:5120
ds_read_b64_tr_b16 a[14:15],v7 offset:7168
s_waitcnt lgkmcnt(4)
ds_read_b64_tr_b16 a[104:105],v7 offset:4160
ds_read_b64_tr_b16 a[106:107],v7 offset:6208
ds_read_b64_tr_b16 a[108:109],v7 offset:5184
ds_read_b64_tr_b16 a[110:111],v7 offset:7232
ds_read_b64_tr_b16 a[16:17],v7 offset:8192
ds_read_b64_tr_b16 a[18:19],v7 offset:10240
ds_read_b64_tr_b16 a[20:21],v7 offset:9216
ds_read_b64_tr_b16 a[22:23],v7 offset:11264
ds_read_b64_tr_b16 a[112:113],v7 offset:8256
ds_read_b64_tr_b16 a[114:115],v7 offset:10304
ds_read_b64_tr_b16 a[116:117],v7 offset:9280
ds_read_b64_tr_b16 a[118:119],v7 offset:11328
s_waitcnt lgkmcnt(4)
ds_read_b64_tr_b16 a[24:25],v7 offset:12288
ds_read_b64_tr_b16 a[26:27],v7 offset:14336
ds_read_b64_tr_b16 a[28:29],v7 offset:13312
ds_read_b64_tr_b16 a[30:31],v7 offset:15360
ds_read_b64_tr_b16 a[120:121],v7 offset:12352
ds_read_b64_tr_b16 a[122:123],v7 offset:14400
ds_read_b64_tr_b16 a[124:125],v7 offset:13376
ds_read_b64_tr_b16 a[126:127],v7 offset:15424
ds_read_b64_tr_b16 a[32:33],v7 offset:16384
ds_read_b64_tr_b16 a[34:35],v7 offset:18432
ds_read_b64_tr_b16 a[36:37],v7 offset:17408
ds_read_b64_tr_b16 a[38:39],v7 offset:19456
s_waitcnt lgkmcnt(4)
ds_read_b64_tr_b16 a[128:129],v7 offset:16448
ds_read_b64_tr_b16 a[130:131],v7 offset:18496
ds_read_b64_tr_b16 a[132:133],v7 offset:17472
ds_read_b64_tr_b16 a[134:135],v7 offset:19520
s_waitcnt lgkmcnt(0)
s_add_u32 m0,s63,0
s_add_u32 s65,s58,409600
buffer_load_dwordx4 v6,s[4:7],s65 offen lds
s_add_u32 m0,s63,1024
s_add_u32 s65,s58,419840
buffer_load_dwordx4 v6,s[4:7],s65 offen lds
s_add_u32 m0,s63,2048
s_add_u32 s65,s58,430080
buffer_load_dwordx4 v6,s[4:7],s65 offen lds
s_add_u32 m0,s63,3072
s_add_u32 s65,s58,440320
buffer_load_dwordx4 v6,s[4:7],s65 offen lds
s_add_u32 m0,s63,4096
s_add_u32 s65,s58,450560
buffer_load_dwordx4 v6,s[4:7],s65 offen lds
s_add_u32 m0,s63,5120
s_add_u32 s65,s58,460800
buffer_load_dwordx4 v6,s[4:7],s65 offen lds
s_add_u32 m0,s63,6144
s_add_u32 s65,s58,471040
buffer_load_dwordx4 v6,s[4:7],s65 offen lds
s_add_u32 m0,s63,7168
s_add_u32 s65,s58,481280
buffer_load_dwordx4 v6,s[4:7],s65 offen lds
s_waitcnt vmcnt(8)
v_bfe_u32 v9,v0,2,2
v_lshrrev_b32 v10,5,v0
v_lshl_add_u32 v9,v10,2,v9
v_mul_u32_u24 v9,128,v9
v_and_b32 v10,1,v0
v_lshl_add_u32 v9,v10,3,v9
v_bfe_u32 v10,v0,1,1
v_lshl_add_u32 v9,v10,5,v9
v_bfe_u32 v10,v0,4,1
v_lshl_add_u32 v9,v10,4,v9
v_add_u32 v7,s63,v9
ds_read_b64_tr_b16 a[40:41],v7 offset:20480
ds_read_b64_tr_b16 a[42:43],v7 offset:22528
ds_read_b64_tr_b16 a[44:45],v7 offset:21504
ds_read_b64_tr_b16 a[46:47],v7 offset:23552
ds_read_b64_tr_b16 a[136:137],v7 offset:20544
ds_read_b64_tr_b16 a[138:139],v7 offset:22592
ds_read_b64_tr_b16 a[140:141],v7 offset:21568
ds_read_b64_tr_b16 a[142:143],v7 offset:23616
ds_read_b64_tr_b16 a[48:49],v7 offset:24576
ds_read_b64_tr_b16 a[50:51],v7 offset:26624
ds_read_b64_tr_b16 a[52:53],v7 offset:25600
ds_read_b64_tr_b16 a[54:55],v7 offset:27648
s_waitcnt lgkmcnt(4)
ds_read_b64_tr_b16 a[144:145],v7 offset:24640
ds_read_b64_tr_b16 a[146:147],v7 offset:26688
ds_read_b64_tr_b16 a[148:149],v7 offset:25664
ds_read_b64_tr_b16 a[150:151],v7 offset:27712
ds_read_b64_tr_b16 a[56:57],v7 offset:28672
ds_read_b64_tr_b16 a[58:59],v7 offset:30720
ds_read_b64_tr_b16 a[60:61],v7 offset:29696
ds_read_b64_tr_b16 a[62:63],v7 offset:31744
ds_read_b64_tr_b16 a[152:153],v7 offset:28736
ds_read_b64_tr_b16 a[154:155],v7 offset:30784
ds_read_b64_tr_b16 a[156:157],v7 offset:29760
ds_read_b64_tr_b16 a[158:159],v7 offset:31808
s_waitcnt lgkmcnt(4)
ds_read_b64_tr_b16 a[64:65],v7 offset:32768
ds_read_b64_tr_b16 a[66:67],v7 offset:34816
ds_read_b64_tr_b16 a[68:69],v7 offset:33792
ds_read_b64_tr_b16 a[70:71],v7 offset:35840
ds_read_b64_tr_b16 a[160:161],v7 offset:32832
ds_read_b64_tr_b16 a[162:163],v7 offset:34880
ds_read_b64_tr_b16 a[164:165],v7 offset:33856
ds_read_b64_tr_b16 a[166:167],v7 offset:35904
ds_read_b64_tr_b16 a[72:73],v7 offset:36864
ds_read_b64_tr_b16 a[74:75],v7 offset:38912
ds_read_b64_tr_b16 a[76:77],v7 offset:37888
ds_read_b64_tr_b16 a[78:79],v7 offset:39936
s_waitcnt lgkmcnt(4)
ds_read_b64_tr_b16 a[168:169],v7 offset:36928
ds_read_b64_tr_b16 a[170:171],v7 offset:38976
ds_read_b64_tr_b16 a[172:173],v7 offset:37952
ds_read_b64_tr_b16 a[174:175],v7 offset:40000
s_waitcnt lgkmcnt(0)
s_waitcnt vmcnt(0)
v_bfe_u32 v9,v0,2,2
v_lshrrev_b32 v10,5,v0
v_lshl_add_u32 v9,v10,2,v9
v_mul_u32_u24 v9,128,v9
v_and_b32 v10,1,v0
v_lshl_add_u32 v9,v10,3,v9
v_bfe_u32 v10,v0,1,1
v_lshl_add_u32 v9,v10,5,v9
v_bfe_u32 v10,v0,4,1
v_lshl_add_u32 v9,v10,4,v9
v_add_u32 v7,s63,v9
ds_read_b64_tr_b16 a[80:81],v7 offset:0
ds_read_b64_tr_b16 a[82:83],v7 offset:2048
ds_read_b64_tr_b16 a[84:85],v7 offset:1024
ds_read_b64_tr_b16 a[86:87],v7 offset:3072
ds_read_b64_tr_b16 a[176:177],v7 offset:64
ds_read_b64_tr_b16 a[178:179],v7 offset:2112
ds_read_b64_tr_b16 a[180:181],v7 offset:1088
ds_read_b64_tr_b16 a[182:183],v7 offset:3136
ds_read_b64_tr_b16 a[88:89],v7 offset:4096
ds_read_b64_tr_b16 a[90:91],v7 offset:6144
ds_read_b64_tr_b16 a[92:93],v7 offset:5120
ds_read_b64_tr_b16 a[94:95],v7 offset:7168
s_waitcnt lgkmcnt(4)
ds_read_b64_tr_b16 a[184:185],v7 offset:4160
ds_read_b64_tr_b16 a[186:187],v7 offset:6208
ds_read_b64_tr_b16 a[188:189],v7 offset:5184
ds_read_b64_tr_b16 a[190:191],v7 offset:7232
s_waitcnt lgkmcnt(0)
s_barrier
s_mov_b32 s83,s100
s_mov_b32 s32,0
s_mov_b32 s59,2147483648
s_min_u32 s62,s32,127
s_sub_u32 s60,s62,18
s_lshr_b32 s34,s60,1
s_and_b32 s33,s60,1
s_cmp_eq_u32 s33,0
s_cselect_b32 s61,18,0
s_add_u32 s34,s34,s61
s_sub_u32 s61,s60,46
s_cmp_ge_u32 s60,92
s_cselect_b32 s34,s61,s34
s_cselect_b32 s33,1,s33
s_cmp_lt_u32 s62,18
s_cselect_b32 s34,s62,s34
s_cselect_b32 s33,0,s33
s_lshl_b32 s35,s33,6
s_add_u32 s35,s35,s34
s_lshl_b32 s35,s35,9
s_add_u32 s35,s35,589824
s_and_b32 s60,s34,3
s_lshl2_add_u32 s60,s33,s60
s_mul_i32 s73,s60,98304
s_add_u32 s73,s73,s71
s_add_u32 s62,s32,1
s_min_u32 s62,s62,127
s_sub_u32 s60,s62,18
s_lshr_b32 s29,s60,1
s_and_b32 s28,s60,1
s_cmp_eq_u32 s28,0
s_cselect_b32 s61,18,0
s_add_u32 s29,s29,s61
s_sub_u32 s61,s60,46
s_cmp_ge_u32 s60,92
s_cselect_b32 s29,s61,s29
s_cselect_b32 s28,1,s28
s_cmp_lt_u32 s62,18
s_cselect_b32 s29,s62,s29
s_cselect_b32 s28,0,s28
s_lshl_b32 s30,s28,6
s_add_u32 s30,s30,s29
s_lshl_b32 s30,s30,9
s_add_u32 s30,s30,589824
s_and_b32 s60,s29,3
s_lshl2_add_u32 s60,s28,s60
s_mul_i32 s31,s60,98304
s_add_u32 s31,s31,s71
W4_COLD:
buffer_load_dword v3,v2,s[8:11],s35 offen sc1
s_waitcnt vmcnt(1)
s_mov_b64 exec,1
buffer_store_dword v5,v1,s[8:11],s59 offen sc1
s_mov_b64 exec,-1
s_mov_b32 s59,2147483648
s_cmp_ge_u32 s32,128
s_cbranch_scc1 W4_END
s_waitcnt vmcnt(1)
v_cmp_eq_u32 vcc,0,v3
s_nop 0
s_cbranch_vccz W4_RDY
fb_322:
buffer_load_dword v3,v2,s[8:11],s35 offen sc1
s_waitcnt vmcnt(0)
v_cmp_eq_u32 vcc,0,v3
s_nop 0
s_cbranch_vccz ok_323
s_sleep 1
s_sub_u32 s47,s47,1
s_cbranch_scc1 ABORT
s_branch fb_322
ok_323:
W4_RDY:
s_add_u32 s63,s73,0
buffer_load_dwordx4 v[16:19],v1,s[8:11],s63 offen sc1
s_nop 7
buffer_load_dwordx4 v[20:23],v1,s[8:11],s63 offen offset:1024 sc1
s_nop 7
buffer_load_dwordx4 v[24:27],v1,s[8:11],s63 offen offset:2048 sc1
s_nop 7
buffer_load_dwordx4 v[28:31],v1,s[8:11],s63 offen offset:3072 sc1
s_nop 7
s_add_u32 s63,s73,4096
buffer_load_dwordx4 v[32:35],v1,s[8:11],s63 offen sc1
s_nop 7
buffer_load_dwordx4 v[36:39],v1,s[8:11],s63 offen offset:1024 sc1
s_nop 7
buffer_load_dwordx4 v[40:43],v1,s[8:11],s63 offen offset:2048 sc1
s_nop 7
buffer_load_dwordx4 v[44:47],v1,s[8:11],s63 offen offset:3072 sc1
W4_C:
s_mov_b32 s51,s33
s_mov_b32 s52,s34
s_mov_b32 s72,s73
s_add_u32 s32,s32,1
s_mov_b32 s33,s28
s_mov_b32 s34,s29
s_mov_b32 s35,s30
s_mov_b32 s73,s31
s_waitcnt vmcnt(7)
v_mfma_f32_32x32x16_bf16 v[112:127],a[0:3],v[16:19],0
s_add_u32 s63,s72,8192
buffer_load_dwordx4 v[48:51],v1,s[8:11],s63 offen sc1
v_xor_b32 v206,0x8000,v206
v_xor_b32 v207,0x8000,v207
s_lshl_b32 s64,s51,6
v_mfma_f32_32x32x16_bf16 v[128:143],a[96:99],v[16:19],0
s_add_u32 s64,s64,s52
s_and_b32 s65,s52,7
s_lshl3_add_u32 s65,s51,s65
s_mul_i32 s65,s65,46080
s_add_u32 s65,s65,s70
s_add_u32 s65,s65,212467712
s_waitcnt vmcnt(7)
v_mfma_f32_32x32x16_bf16 v[112:127],a[4:7],v[20:23],v[112:127]
buffer_load_dwordx4 v[52:55],v1,s[8:11],s63 offen offset:1024 sc1
buffer_load_dwordx4 v[176:179],v1,s[8:11],s65 offen sc1
s_mul_i32 s65,s64,40960
s_add_u32 s65,s65,s70
v_mfma_f32_32x32x16_bf16 v[128:143],a[100:103],v[20:23],v[128:143]
s_add_u32 s65,s65,218365952
s_mov_b32 s43,s65
s_lshl_b32 s82,s64,9
s_lshl2_add_u32 s82,s56,s82
s_add_u32 s42,s82,32768
s_add_u32 s82,s82,327680
s_waitcnt vmcnt(8)
v_mfma_f32_32x32x16_bf16 v[112:127],a[8:11],v[24:27],v[112:127]
buffer_load_dwordx4 v[56:59],v1,s[8:11],s63 offen offset:2048 sc1
s_mul_i32 s41,s52,46080
s_add_u32 s41,s41,209518592
s_add_u32 s40,s41,s70
s_lshr_b32 s64,s70,3
v_mfma_f32_32x32x16_bf16 v[128:143],a[104:107],v[24:27],v[128:143]
s_add_u32 s41,s41,s64
s_add_u32 s41,s41,40960
s_mul_i32 s64,s52,40960
s_cmp_lg_u32 s51,0
s_cselect_b32 s40,s64,s40
s_cselect_b32 s42,2147483648,s42
s_waitcnt vmcnt(8)
v_mfma_f32_32x32x16_bf16 v[112:127],a[12:15],v[28:31],v[112:127]
buffer_load_dwordx4 v[60:63],v1,s[8:11],s63 offen offset:3072 sc1
s_add_u32 s63,s72,12288
s_add_u32 s62,s32,1
s_min_u32 s62,s62,127
s_sub_u32 s60,s62,18
v_mfma_f32_32x32x16_bf16 v[128:143],a[108:111],v[28:31],v[128:143]
s_lshr_b32 s29,s60,1
s_and_b32 s28,s60,1
s_cmp_eq_u32 s28,0
s_cselect_b32 s61,18,0
s_add_u32 s29,s29,s61
s_sub_u32 s61,s60,46
s_waitcnt vmcnt(8)
v_mfma_f32_32x32x16_bf16 v[112:127],a[16:19],v[32:35],v[112:127]
buffer_load_dwordx4 v[64:67],v1,s[8:11],s63 offen sc1
s_cmp_ge_u32 s60,92
s_cselect_b32 s29,s61,s29
s_cselect_b32 s28,1,s28
v_mfma_f32_32x32x16_bf16 v[128:143],a[112:115],v[32:35],v[128:143]
s_cmp_lt_u32 s62,18
s_cselect_b32 s29,s62,s29
s_cselect_b32 s28,0,s28
s_lshl_b32 s30,s28,6
s_add_u32 s30,s30,s29
s_lshl_b32 s30,s30,9
s_waitcnt vmcnt(8)
v_mfma_f32_32x32x16_bf16 v[112:127],a[20:23],v[36:39],v[112:127]
buffer_load_dwordx4 v[68:71],v1,s[8:11],s63 offen offset:1024 sc1
s_add_u32 s30,s30,589824
s_and_b32 s60,s29,3
s_lshl2_add_u32 s60,s28,s60
s_mul_i32 s31,s60,98304
v_mfma_f32_32x32x16_bf16 v[128:143],a[116:119],v[36:39],v[128:143]
s_add_u32 s31,s31,s71
s_waitcnt vmcnt(8)
v_mfma_f32_32x32x16_bf16 v[112:127],a[24:27],v[40:43],v[112:127]
buffer_load_dwordx4 v[72:75],v1,s[8:11],s63 offen offset:2048 sc1
v_mfma_f32_32x32x16_bf16 v[128:143],a[120:123],v[40:43],v[128:143]
s_waitcnt vmcnt(8)
v_mfma_f32_32x32x16_bf16 v[112:127],a[28:31],v[44:47],v[112:127]
buffer_load_dwordx4 v[76:79],v1,s[8:11],s63 offen offset:3072 sc1
s_add_u32 s63,s72,16384
v_mfma_f32_32x32x16_bf16 v[128:143],a[124:127],v[44:47],v[128:143]
s_waitcnt vmcnt(8)
v_mfma_f32_32x32x16_bf16 v[112:127],a[32:35],v[48:51],v[112:127]
buffer_load_dwordx4 v[80:83],v1,s[8:11],s63 offen sc1
s_mov_b64 exec,1
buffer_store_dword v5,v1,s[8:11],s59 offen sc1
s_mov_b64 exec,-1
s_mov_b32 s59,2147483648
v_mfma_f32_32x32x16_bf16 v[128:143],a[128:131],v[48:51],v[128:143]
buffer_load_dword v3,v2,s[8:11],s35 offen sc1
s_waitcnt vmcnt(10)
v_mfma_f32_32x32x16_bf16 v[112:127],a[36:39],v[52:55],v[112:127]
buffer_load_dwordx4 v[84:87],v1,s[8:11],s63 offen offset:1024 sc1
v_mfma_f32_32x32x16_bf16 v[128:143],a[132:135],v[52:55],v[128:143]
s_waitcnt vmcnt(9)
v_mfma_f32_32x32x16_bf16 v[112:127],a[40:43],v[56:59],v[112:127]
buffer_load_dwordx4 v[88:91],v1,s[8:11],s63 offen offset:2048 sc1
v_mfma_f32_32x32x16_bf16 v[128:143],a[136:139],v[56:59],v[128:143]
s_waitcnt vmcnt(9)
v_mfma_f32_32x32x16_bf16 v[112:127],a[44:47],v[60:63],v[112:127]
buffer_load_dwordx4 v[92:95],v1,s[8:11],s63 offen offset:3072 sc1
s_add_u32 s63,s72,20480
v_mfma_f32_32x32x16_bf16 v[128:143],a[140:143],v[60:63],v[128:143]
s_waitcnt vmcnt(9)
v_mfma_f32_32x32x16_bf16 v[112:127],a[48:51],v[64:67],v[112:127]
buffer_load_dwordx4 v[96:99],v1,s[8:11],s63 offen sc1
v_mfma_f32_32x32x16_bf16 v[128:143],a[144:147],v[64:67],v[128:143]
s_waitcnt vmcnt(9)
v_mfma_f32_32x32x16_bf16 v[112:127],a[52:55],v[68:71],v[112:127]
buffer_load_dwordx4 v[100:103],v1,s[8:11],s63 offen offset:1024 sc1
v_mfma_f32_32x32x16_bf16 v[128:143],a[148:151],v[68:71],v[128:143]
s_waitcnt vmcnt(9)
v_mfma_f32_32x32x16_bf16 v[112:127],a[56:59],v[72:75],v[112:127]
buffer_load_dwordx4 v[104:107],v1,s[8:11],s63 offen offset:2048 sc1
v_mfma_f32_32x32x16_bf16 v[128:143],a[152:155],v[72:75],v[128:143]
s_waitcnt vmcnt(6)
v_cmp_eq_u32 vcc,0,v3
s_cmp_eq_u64 vcc,0
s_cselect_b32 s37,0,2147483648
s_cmp_lt_u32 s32,128
s_cselect_b32 s37,s37,2147483648
v_mfma_f32_32x32x16_bf16 v[112:127],a[60:63],v[76:79],v[112:127]
buffer_load_dwordx4 v[108:111],v1,s[8:11],s63 offen offset:3072 sc1
buffer_load_dwordx4 v[180:183],v15,s[8:11],s43 offen sc1
s_cmp_eq_u32 s37,0
v_mfma_f32_32x32x16_bf16 v[128:143],a[156:159],v[76:79],v[128:143]
s_cbranch_scc0 no_324
v_mfma_f32_32x32x16_bf16 v[112:127],a[64:67],v[80:83],v[112:127]
s_add_u32 s63,s73,0
buffer_load_dwordx4 v[16:19],v1,s[8:11],s63 offen sc1
v_mfma_f32_32x32x16_bf16 v[128:143],a[160:163],v[80:83],v[128:143]
s_waitcnt vmcnt(8)
v_mfma_f32_32x32x16_bf16 v[112:127],a[68:71],v[84:87],v[112:127]
buffer_load_dwordx4 v[20:23],v1,s[8:11],s63 offen offset:1024 sc1
v_mfma_f32_32x32x16_bf16 v[128:143],a[164:167],v[84:87],v[128:143]
s_waitcnt vmcnt(8)
v_mfma_f32_32x32x16_bf16 v[112:127],a[72:75],v[88:91],v[112:127]
buffer_load_dwordx4 v[24:27],v1,s[8:11],s63 offen offset:2048 sc1
v_mfma_f32_32x32x16_bf16 v[128:143],a[168:171],v[88:91],v[128:143]
v_lshlrev_b32 v184,16,v176
v_and_b32 v185,0xffff0000,v176
v_lshlrev_b32 v186,16,v177
v_and_b32 v187,0xffff0000,v177
v_lshlrev_b32 v188,16,v178
s_waitcnt vmcnt(8)
v_mfma_f32_32x32x16_bf16 v[112:127],a[76:79],v[92:95],v[112:127]
buffer_load_dwordx4 v[28:31],v1,s[8:11],s63 offen offset:3072 sc1
s_add_u32 s63,s73,4096
v_and_b32 v189,0xffff0000,v178
v_lshlrev_b32 v190,16,v179
v_and_b32 v191,0xffff0000,v179
v_mfma_f32_32x32x16_bf16 v[128:143],a[172:175],v[92:95],v[128:143]
s_waitcnt vmcnt(8)
v_mfma_f32_32x32x16_bf16 v[112:127],a[80:83],v[96:99],v[112:127]
buffer_load_dwordx4 v[32:35],v1,s[8:11],s63 offen sc1
s_waitcnt vmcnt(8)
v_mfma_f32_32x32x16_bf16 v[112:127],a[84:87],v[100:103],v[112:127]
s_waitcnt vmcnt(7)
v_mfma_f32_32x32x16_bf16 v[112:127],a[88:91],v[104:107],v[112:127]
buffer_load_dwordx4 v[36:39],v1,s[8:11],s63 offen offset:1024 sc1
s_waitcnt vmcnt(7)
v_mfma_f32_32x32x16_bf16 v[112:127],a[92:95],v[108:111],v[112:127]
v_mfma_f32_32x32x16_bf16 v[128:143],a[176:179],v[96:99],v[128:143]
buffer_load_dwordx4 v[40:43],v1,s[8:11],s63 offen offset:2048 sc1
s_mov_b64 exec,1
s_cmp_lg_u32 s49,0
s_cbranch_scc0 ls_325
buffer_store_dword v5,v1,s[8:11],s82 offen sc1
s_branch ls_326
ls_325:
buffer_store_dword v5,v1,s[8:11],s82 offen
ls_326:
s_mov_b64 exec,-1
v_mfma_f32_32x32x16_bf16 v[128:143],a[180:183],v[100:103],v[128:143]
ds_write_b128 v206,v[112:115] offset:0
ds_write_b128 v206,v[116:119] offset:1024
ds_write_b128 v206,v[120:123] offset:512
v_mfma_f32_32x32x16_bf16 v[128:143],a[184:187],v[104:107],v[128:143]
buffer_load_dwordx4 v[44:47],v1,s[8:11],s63 offen offset:3072 sc1
ds_write_b128 v206,v[124:127] offset:1536
v_mfma_f32_32x32x16_bf16 v[128:143],a[188:191],v[108:111],v[128:143]
buffer_load_dword v3,v2,s[8:11],s30 offen sc1
s_nop 5
s_branch W4_E1
no_324:
v_mfma_f32_32x32x16_bf16 v[112:127],a[64:67],v[80:83],v[112:127]
v_mfma_f32_32x32x16_bf16 v[128:143],a[160:163],v[80:83],v[128:143]
s_waitcnt vmcnt(7)
v_mfma_f32_32x32x16_bf16 v[112:127],a[68:71],v[84:87],v[112:127]
v_mfma_f32_32x32x16_bf16 v[128:143],a[164:167],v[84:87],v[128:143]
s_waitcnt vmcnt(6)
v_mfma_f32_32x32x16_bf16 v[112:127],a[72:75],v[88:91],v[112:127]
v_mfma_f32_32x32x16_bf16 v[128:143],a[168:171],v[88:91],v[128:143]
v_lshlrev_b32 v184,16,v176
v_and_b32 v185,0xffff0000,v176
v_lshlrev_b32 v186,16,v177
v_and_b32 v187,0xffff0000,v177
v_lshlrev_b32 v188,16,v178
s_waitcnt vmcnt(5)
v_mfma_f32_32x32x16_bf16 v[112:127],a[76:79],v[92:95],v[112:127]
buffer_load_dword v3,v2,s[8:11],s35 offen sc1
v_and_b32 v189,0xffff0000,v178
v_lshlrev_b32 v190,16,v179
v_and_b32 v191,0xffff0000,v179
v_mfma_f32_32x32x16_bf16 v[128:143],a[172:175],v[92:95],v[128:143]
s_waitcnt vmcnt(5)
v_mfma_f32_32x32x16_bf16 v[112:127],a[80:83],v[96:99],v[112:127]
s_waitcnt vmcnt(4)
v_mfma_f32_32x32x16_bf16 v[112:127],a[84:87],v[100:103],v[112:127]
s_waitcnt vmcnt(3)
v_mfma_f32_32x32x16_bf16 v[112:127],a[88:91],v[104:107],v[112:127]
s_waitcnt vmcnt(2)
v_mfma_f32_32x32x16_bf16 v[112:127],a[92:95],v[108:111],v[112:127]
v_mfma_f32_32x32x16_bf16 v[128:143],a[176:179],v[96:99],v[128:143]
s_mov_b64 exec,1
s_cmp_lg_u32 s49,0
s_cbranch_scc0 ls_327
buffer_store_dword v5,v1,s[8:11],s82 offen sc1
s_branch ls_328
ls_327:
buffer_store_dword v5,v1,s[8:11],s82 offen
ls_328:
s_mov_b64 exec,-1
v_mfma_f32_32x32x16_bf16 v[128:143],a[180:183],v[100:103],v[128:143]
ds_write_b128 v206,v[112:115] offset:0
ds_write_b128 v206,v[116:119] offset:1024
ds_write_b128 v206,v[120:123] offset:512
v_mfma_f32_32x32x16_bf16 v[128:143],a[184:187],v[104:107],v[128:143]
ds_write_b128 v206,v[124:127] offset:1536
v_mfma_f32_32x32x16_bf16 v[128:143],a[188:191],v[108:111],v[128:143]
s_waitcnt vmcnt(1)
v_cmp_eq_u32 vcc,0,v3
s_cmp_eq_u64 vcc,0
s_cselect_b32 s37,0,2147483648
s_cmp_lt_u32 s32,128
s_cselect_b32 s37,s37,2147483648
s_cmp_eq_u32 s37,0
s_cbranch_scc1 W4_E2
s_branch W4_E0
W4_E2:
s_add_u32 s63,s73,0
buffer_load_dwordx4 v[16:19],v1,s[8:11],s63 offen sc1
s_nop 2
ds_write_b128 v206,v[128:131] offset:8192
ds_write_b128 v206,v[132:135] offset:9216
buffer_load_dwordx4 v[20:23],v1,s[8:11],s63 offen offset:1024 sc1
ds_write_b128 v206,v[136:139] offset:8704
ds_write_b128 v206,v[140:143] offset:9728
buffer_load_dwordx4 v[24:27],v1,s[8:11],s63 offen offset:2048 sc1
s_waitcnt lgkmcnt(0)
s_barrier
ds_read_b128 v[144:147],v207 offset:0
ds_read_b128 v[148:151],v207 offset:1024
ds_read_b128 v[152:155],v207 offset:2048
ds_read_b128 v[156:159],v207 offset:3072
ds_read_b128 v[160:163],v207 offset:4096
ds_read_b128 v[164:167],v207 offset:5120
ds_read_b128 v[168:171],v207 offset:6144
ds_read_b128 v[172:175],v207 offset:7168
s_waitcnt vmcnt(43)
v_lshlrev_b32 v192,16,v180
v_and_b32 v193,0xffff0000,v180
v_lshlrev_b32 v194,16,v181
v_and_b32 v195,0xffff0000,v181
v_lshlrev_b32 v196,16,v182
v_and_b32 v197,0xffff0000,v182
v_lshlrev_b32 v198,16,v183
v_and_b32 v199,0xffff0000,v183
buffer_load_dwordx4 v[28:31],v1,s[8:11],s63 offen offset:3072 sc1
s_add_u32 s63,s73,4096
buffer_load_dwordx4 v[32:35],v1,s[8:11],s63 offen sc1
buffer_load_dwordx4 v[36:39],v1,s[8:11],s63 offen offset:1024 sc1
s_waitcnt lgkmcnt(4)
v_pk_add_f32 v[144:145],v[144:145],v[152:153]
v_pk_add_f32 v[146:147],v[146:147],v[154:155]
v_pk_add_f32 v[148:149],v[148:149],v[156:157]
v_pk_add_f32 v[150:151],v[150:151],v[158:159]
s_waitcnt lgkmcnt(0)
v_pk_add_f32 v[160:161],v[160:161],v[168:169]
v_pk_add_f32 v[162:163],v[162:163],v[170:171]
v_pk_add_f32 v[164:165],v[164:165],v[172:173]
v_pk_add_f32 v[166:167],v[166:167],v[174:175]
buffer_load_dwordx4 v[40:43],v1,s[8:11],s63 offen offset:2048 sc1
v_pk_add_f32 v[144:145],v[144:145],v[160:161]
v_pk_add_f32 v[146:147],v[146:147],v[162:163]
v_pk_add_f32 v[148:149],v[148:149],v[164:165]
v_pk_add_f32 v[150:151],v[150:151],v[166:167]
v_cvt_pk_bf16_f32 v6,v144,v145
v_lshlrev_b32 v144,16,v6
v_and_b32 v145,0xffff0000,v6
v_cvt_pk_bf16_f32 v6,v146,v147
v_lshlrev_b32 v146,16,v6
v_and_b32 v147,0xffff0000,v6
v_cvt_pk_bf16_f32 v6,v148,v149
v_lshlrev_b32 v148,16,v6
v_and_b32 v149,0xffff0000,v6
v_cvt_pk_bf16_f32 v6,v150,v151
v_lshlrev_b32 v150,16,v6
v_and_b32 v151,0xffff0000,v6
buffer_load_dwordx4 v[44:47],v1,s[8:11],s63 offen offset:3072 sc1
v_pk_add_f32 v[144:145],v[144:145],v[184:185]
v_pk_add_f32 v[146:147],v[146:147],v[186:187]
v_pk_add_f32 v[148:149],v[148:149],v[188:189]
v_pk_add_f32 v[150:151],v[150:151],v[190:191]
v_cvt_pk_bf16_f32 v6,v144,v145
v_lshlrev_b32 v144,16,v6
v_and_b32 v145,0xffff0000,v6
v_cvt_pk_bf16_f32 v6,v146,v147
v_lshlrev_b32 v146,16,v6
v_and_b32 v147,0xffff0000,v6
v_cvt_pk_bf16_f32 v6,v148,v149
v_lshlrev_b32 v148,16,v6
v_and_b32 v149,0xffff0000,v6
v_cvt_pk_bf16_f32 v6,v150,v151
v_lshlrev_b32 v150,16,v6
v_and_b32 v151,0xffff0000,v6
v_pk_add_f32 v[144:145],v[144:145],v[192:193]
v_pk_add_f32 v[146:147],v[146:147],v[194:195]
v_pk_add_f32 v[148:149],v[148:149],v[196:197]
v_pk_add_f32 v[150:151],v[150:151],v[198:199]
v_cvt_pk_bf16_f32 v200,v144,v145
v_cvt_pk_bf16_f32 v201,v146,v147
v_cvt_pk_bf16_f32 v202,v148,v149
v_cvt_pk_bf16_f32 v203,v150,v151
s_cmp_lg_u32 s51,0
s_cbranch_scc1 w4o_329
buffer_store_dwordx4 v[200:203],v15,s[8:11],s40 offen sc1
v_lshlrev_b32 v144,16,v200
v_and_b32 v145,0xffff0000,v200
v_lshlrev_b32 v146,16,v201
v_and_b32 v147,0xffff0000,v201
v_lshlrev_b32 v148,16,v202
v_and_b32 v149,0xffff0000,v202
v_lshlrev_b32 v150,16,v203
v_and_b32 v151,0xffff0000,v203
v_pk_add_f32 v[6:7],v[144:145],v[146:147]
v_pk_mul_f32 v[8:9],v[144:145],v[144:145]
v_pk_fma_f32 v[8:9],v[146:147],v[146:147],v[8:9]
v_pk_add_f32 v[6:7],v[6:7],v[148:149]
v_pk_fma_f32 v[8:9],v[148:149],v[148:149],v[8:9]
v_pk_add_f32 v[6:7],v[6:7],v[150:151]
v_pk_fma_f32 v[8:9],v[150:151],v[150:151],v[8:9]
v_add_f32 v6,v6,v7
v_add_f32 v7,v8,v9
s_nop 1
v_permlane32_swap_b32 v6,v7
v_add_f32 v6,v6,v7
v_mov_b32 v7,v6
s_nop 1
v_permlane16_swap_b32 v6,v7
v_add_f32 v6,v6,v7
v_mov_b32 v7,v6
s_nop 1
v_permlane32_swap_b32 v6,v7
s_mov_b64 exec,0xffff
buffer_store_dwordx2 v[6:7],v204,s[8:11],s41 offen sc1
s_mov_b64 exec,-1
s_branch w4n_330
w4o_329:
v_permlane16_swap_b32 v200,v202
v_permlane16_swap_b32 v201,v203
buffer_store_dwordx4 v[200:203],v205,s[76:79],s40 offen
s_mov_b64 exec,1
buffer_store_dword v5,v1,s[8:11],s42 offen
s_mov_b64 exec,-1
w4n_330:
s_mov_b32 s59,s42
s_branch W4_C
W4_E1:
s_add_u32 s63,s73,8192
buffer_load_dwordx4 v[48:51],v1,s[8:11],s63 offen sc1
s_nop 2
ds_write_b128 v206,v[128:131] offset:8192
ds_write_b128 v206,v[132:135] offset:9216
buffer_load_dwordx4 v[52:55],v1,s[8:11],s63 offen offset:1024 sc1
ds_write_b128 v206,v[136:139] offset:8704
ds_write_b128 v206,v[140:143] offset:9728
buffer_load_dwordx4 v[56:59],v1,s[8:11],s63 offen offset:2048 sc1
s_waitcnt lgkmcnt(0)
s_barrier
ds_read_b128 v[144:147],v207 offset:0
ds_read_b128 v[148:151],v207 offset:1024
ds_read_b128 v[152:155],v207 offset:2048
ds_read_b128 v[156:159],v207 offset:3072
ds_read_b128 v[160:163],v207 offset:4096
ds_read_b128 v[164:167],v207 offset:5120
ds_read_b128 v[168:171],v207 offset:6144
ds_read_b128 v[172:175],v207 offset:7168
s_waitcnt vmcnt(13)
v_lshlrev_b32 v192,16,v180
v_and_b32 v193,0xffff0000,v180
v_lshlrev_b32 v194,16,v181
v_and_b32 v195,0xffff0000,v181
v_lshlrev_b32 v196,16,v182
v_and_b32 v197,0xffff0000,v182
v_lshlrev_b32 v198,16,v183
v_and_b32 v199,0xffff0000,v183
buffer_load_dwordx4 v[60:63],v1,s[8:11],s63 offen offset:3072 sc1
s_add_u32 s63,s73,12288
buffer_load_dwordx4 v[64:67],v1,s[8:11],s63 offen sc1
buffer_load_dwordx4 v[68:71],v1,s[8:11],s63 offen offset:1024 sc1
s_waitcnt lgkmcnt(4)
v_pk_add_f32 v[144:145],v[144:145],v[152:153]
v_pk_add_f32 v[146:147],v[146:147],v[154:155]
v_pk_add_f32 v[148:149],v[148:149],v[156:157]
v_pk_add_f32 v[150:151],v[150:151],v[158:159]
s_waitcnt lgkmcnt(0)
v_pk_add_f32 v[160:161],v[160:161],v[168:169]
v_pk_add_f32 v[162:163],v[162:163],v[170:171]
v_pk_add_f32 v[164:165],v[164:165],v[172:173]
v_pk_add_f32 v[166:167],v[166:167],v[174:175]
v_pk_add_f32 v[144:145],v[144:145],v[160:161]
v_pk_add_f32 v[146:147],v[146:147],v[162:163]
v_pk_add_f32 v[148:149],v[148:149],v[164:165]
v_pk_add_f32 v[150:151],v[150:151],v[166:167]
v_cvt_pk_bf16_f32 v6,v144,v145
v_lshlrev_b32 v144,16,v6
v_and_b32 v145,0xffff0000,v6
v_cvt_pk_bf16_f32 v6,v146,v147
v_lshlrev_b32 v146,16,v6
v_and_b32 v147,0xffff0000,v6
v_cvt_pk_bf16_f32 v6,v148,v149
v_lshlrev_b32 v148,16,v6
v_and_b32 v149,0xffff0000,v6
v_cvt_pk_bf16_f32 v6,v150,v151
v_lshlrev_b32 v150,16,v6
v_and_b32 v151,0xffff0000,v6
v_pk_add_f32 v[144:145],v[144:145],v[184:185]
v_pk_add_f32 v[146:147],v[146:147],v[186:187]
v_pk_add_f32 v[148:149],v[148:149],v[188:189]
v_pk_add_f32 v[150:151],v[150:151],v[190:191]
v_cvt_pk_bf16_f32 v6,v144,v145
v_lshlrev_b32 v144,16,v6
v_and_b32 v145,0xffff0000,v6
v_cvt_pk_bf16_f32 v6,v146,v147
v_lshlrev_b32 v146,16,v6
v_and_b32 v147,0xffff0000,v6
v_cvt_pk_bf16_f32 v6,v148,v149
v_lshlrev_b32 v148,16,v6
v_and_b32 v149,0xffff0000,v6
v_cvt_pk_bf16_f32 v6,v150,v151
v_lshlrev_b32 v150,16,v6
v_and_b32 v151,0xffff0000,v6
v_pk_add_f32 v[144:145],v[144:145],v[192:193]
v_pk_add_f32 v[146:147],v[146:147],v[194:195]
v_pk_add_f32 v[148:149],v[148:149],v[196:197]
v_pk_add_f32 v[150:151],v[150:151],v[198:199]
v_cvt_pk_bf16_f32 v200,v144,v145
v_cvt_pk_bf16_f32 v201,v146,v147
v_cvt_pk_bf16_f32 v202,v148,v149
v_cvt_pk_bf16_f32 v203,v150,v151
s_cmp_lg_u32 s51,0
s_cbranch_scc1 w4o_331
buffer_store_dwordx4 v[200:203],v15,s[8:11],s40 offen sc1
v_lshlrev_b32 v144,16,v200
v_and_b32 v145,0xffff0000,v200
v_lshlrev_b32 v146,16,v201
v_and_b32 v147,0xffff0000,v201
v_lshlrev_b32 v148,16,v202
v_and_b32 v149,0xffff0000,v202
v_lshlrev_b32 v150,16,v203
v_and_b32 v151,0xffff0000,v203
v_pk_add_f32 v[6:7],v[144:145],v[146:147]
v_pk_mul_f32 v[8:9],v[144:145],v[144:145]
v_pk_fma_f32 v[8:9],v[146:147],v[146:147],v[8:9]
v_pk_add_f32 v[6:7],v[6:7],v[148:149]
v_pk_fma_f32 v[8:9],v[148:149],v[148:149],v[8:9]
v_pk_add_f32 v[6:7],v[6:7],v[150:151]
v_pk_fma_f32 v[8:9],v[150:151],v[150:151],v[8:9]
v_add_f32 v6,v6,v7
v_add_f32 v7,v8,v9
s_nop 1
v_permlane32_swap_b32 v6,v7
v_add_f32 v6,v6,v7
v_mov_b32 v7,v6
s_nop 1
v_permlane16_swap_b32 v6,v7
v_add_f32 v6,v6,v7
v_mov_b32 v7,v6
s_nop 1
v_permlane32_swap_b32 v6,v7
s_mov_b64 exec,0xffff
buffer_store_dwordx2 v[6:7],v204,s[8:11],s41 offen sc1
s_mov_b64 exec,-1
s_branch w4n_332
w4o_331:
v_permlane16_swap_b32 v200,v202
v_permlane16_swap_b32 v201,v203
buffer_store_dwordx4 v[200:203],v205,s[76:79],s40 offen
s_mov_b64 exec,1
buffer_store_dword v5,v1,s[8:11],s42 offen
s_mov_b64 exec,-1
w4n_332:
s_mov_b32 s59,s42
s_waitcnt vmcnt(8)
s_branch W4_W
W4_E0:
s_nop 4
ds_write_b128 v206,v[128:131] offset:8192
ds_write_b128 v206,v[132:135] offset:9216
ds_write_b128 v206,v[136:139] offset:8704
ds_write_b128 v206,v[140:143] offset:9728
s_waitcnt lgkmcnt(0)
s_barrier
ds_read_b128 v[144:147],v207 offset:0
ds_read_b128 v[148:151],v207 offset:1024
ds_read_b128 v[152:155],v207 offset:2048
ds_read_b128 v[156:159],v207 offset:3072
ds_read_b128 v[160:163],v207 offset:4096
ds_read_b128 v[164:167],v207 offset:5120
ds_read_b128 v[168:171],v207 offset:6144
ds_read_b128 v[172:175],v207 offset:7168
s_waitcnt vmcnt(16)
v_lshlrev_b32 v192,16,v180
v_and_b32 v193,0xffff0000,v180
v_lshlrev_b32 v194,16,v181
v_and_b32 v195,0xffff0000,v181
v_lshlrev_b32 v196,16,v182
v_and_b32 v197,0xffff0000,v182
v_lshlrev_b32 v198,16,v183
v_and_b32 v199,0xffff0000,v183
s_waitcnt lgkmcnt(4)
v_pk_add_f32 v[144:145],v[144:145],v[152:153]
v_pk_add_f32 v[146:147],v[146:147],v[154:155]
v_pk_add_f32 v[148:149],v[148:149],v[156:157]
v_pk_add_f32 v[150:151],v[150:151],v[158:159]
s_waitcnt lgkmcnt(0)
v_pk_add_f32 v[160:161],v[160:161],v[168:169]
v_pk_add_f32 v[162:163],v[162:163],v[170:171]
v_pk_add_f32 v[164:165],v[164:165],v[172:173]
v_pk_add_f32 v[166:167],v[166:167],v[174:175]
v_pk_add_f32 v[144:145],v[144:145],v[160:161]
v_pk_add_f32 v[146:147],v[146:147],v[162:163]
v_pk_add_f32 v[148:149],v[148:149],v[164:165]
v_pk_add_f32 v[150:151],v[150:151],v[166:167]
v_cvt_pk_bf16_f32 v6,v144,v145
v_lshlrev_b32 v144,16,v6
v_and_b32 v145,0xffff0000,v6
v_cvt_pk_bf16_f32 v6,v146,v147
v_lshlrev_b32 v146,16,v6
v_and_b32 v147,0xffff0000,v6
v_cvt_pk_bf16_f32 v6,v148,v149
v_lshlrev_b32 v148,16,v6
v_and_b32 v149,0xffff0000,v6
v_cvt_pk_bf16_f32 v6,v150,v151
v_lshlrev_b32 v150,16,v6
v_and_b32 v151,0xffff0000,v6
v_pk_add_f32 v[144:145],v[144:145],v[184:185]
v_pk_add_f32 v[146:147],v[146:147],v[186:187]
v_pk_add_f32 v[148:149],v[148:149],v[188:189]
v_pk_add_f32 v[150:151],v[150:151],v[190:191]
v_cvt_pk_bf16_f32 v6,v144,v145
v_lshlrev_b32 v144,16,v6
v_and_b32 v145,0xffff0000,v6
v_cvt_pk_bf16_f32 v6,v146,v147
v_lshlrev_b32 v146,16,v6
v_and_b32 v147,0xffff0000,v6
v_cvt_pk_bf16_f32 v6,v148,v149
v_lshlrev_b32 v148,16,v6
v_and_b32 v149,0xffff0000,v6
v_cvt_pk_bf16_f32 v6,v150,v151
v_lshlrev_b32 v150,16,v6
v_and_b32 v151,0xffff0000,v6
v_pk_add_f32 v[144:145],v[144:145],v[192:193]
v_pk_add_f32 v[146:147],v[146:147],v[194:195]
v_pk_add_f32 v[148:149],v[148:149],v[196:197]
v_pk_add_f32 v[150:151],v[150:151],v[198:199]
v_cvt_pk_bf16_f32 v200,v144,v145
v_cvt_pk_bf16_f32 v201,v146,v147
v_cvt_pk_bf16_f32 v202,v148,v149
v_cvt_pk_bf16_f32 v203,v150,v151
s_cmp_lg_u32 s51,0
s_cbranch_scc1 w4o_333
buffer_store_dwordx4 v[200:203],v15,s[8:11],s40 offen sc1
v_lshlrev_b32 v144,16,v200
v_and_b32 v145,0xffff0000,v200
v_lshlrev_b32 v146,16,v201
v_and_b32 v147,0xffff0000,v201
v_lshlrev_b32 v148,16,v202
v_and_b32 v149,0xffff0000,v202
v_lshlrev_b32 v150,16,v203
v_and_b32 v151,0xffff0000,v203
v_pk_add_f32 v[6:7],v[144:145],v[146:147]
v_pk_mul_f32 v[8:9],v[144:145],v[144:145]
v_pk_fma_f32 v[8:9],v[146:147],v[146:147],v[8:9]
v_pk_add_f32 v[6:7],v[6:7],v[148:149]
v_pk_fma_f32 v[8:9],v[148:149],v[148:149],v[8:9]
v_pk_add_f32 v[6:7],v[6:7],v[150:151]
v_pk_fma_f32 v[8:9],v[150:151],v[150:151],v[8:9]
v_add_f32 v6,v6,v7
v_add_f32 v7,v8,v9
s_nop 1
v_permlane32_swap_b32 v6,v7
v_add_f32 v6,v6,v7
v_mov_b32 v7,v6
s_nop 1
v_permlane16_swap_b32 v6,v7
v_add_f32 v6,v6,v7
v_mov_b32 v7,v6
s_nop 1
v_permlane32_swap_b32 v6,v7
s_mov_b64 exec,0xffff
buffer_store_dwordx2 v[6:7],v204,s[8:11],s41 offen sc1
s_mov_b64 exec,-1
s_branch w4n_334
w4o_333:
v_permlane16_swap_b32 v200,v202
v_permlane16_swap_b32 v201,v203
buffer_store_dwordx4 v[200:203],v205,s[76:79],s40 offen
s_mov_b64 exec,1
buffer_store_dword v5,v1,s[8:11],s42 offen
s_mov_b64 exec,-1
w4n_334:
s_mov_b32 s59,s42
s_cmp_lg_u32 s37,0
s_cbranch_scc1 W4_COLD
s_waitcnt vmcnt(2)
W4_W:
s_mov_b32 s51,s33
s_mov_b32 s52,s34
s_mov_b32 s72,s73
s_add_u32 s32,s32,1
s_mov_b32 s33,s28
s_mov_b32 s34,s29
s_mov_b32 s35,s30
s_mov_b32 s73,s31
v_cmp_eq_u32 vcc,0,v3
s_cmp_eq_u64 vcc,0
s_cselect_b32 s37,0,2147483648
s_cmp_lt_u32 s32,128
s_cselect_b32 s37,s37,2147483648
s_cmp_lg_u32 s37,0
s_cbranch_scc1 W4_W0
s_waitcnt vmcnt(15)
v_mfma_f32_32x32x16_bf16 v[112:127],a[0:3],v[16:19],0
s_add_u32 s63,s72,12288
buffer_load_dwordx4 v[72:75],v1,s[8:11],s63 offen offset:2048 sc1
v_xor_b32 v206,0x8000,v206
v_xor_b32 v207,0x8000,v207
s_lshl_b32 s64,s51,6
v_mfma_f32_32x32x16_bf16 v[128:143],a[96:99],v[16:19],0
s_add_u32 s64,s64,s52
s_and_b32 s65,s52,7
s_lshl3_add_u32 s65,s51,s65
s_mul_i32 s65,s65,46080
s_add_u32 s65,s65,s70
s_add_u32 s65,s65,212467712
s_waitcnt vmcnt(15)
v_mfma_f32_32x32x16_bf16 v[112:127],a[4:7],v[20:23],v[112:127]
buffer_load_dwordx4 v[76:79],v1,s[8:11],s63 offen offset:3072 sc1
s_add_u32 s63,s72,16384
buffer_load_dwordx4 v[176:179],v1,s[8:11],s65 offen sc1
s_mul_i32 s65,s64,40960
v_mfma_f32_32x32x16_bf16 v[128:143],a[100:103],v[20:23],v[128:143]
s_add_u32 s65,s65,s70
s_add_u32 s65,s65,218365952
s_mov_b32 s43,s65
s_lshl_b32 s82,s64,9
s_lshl2_add_u32 s82,s56,s82
s_add_u32 s42,s82,32768
s_waitcnt vmcnt(16)
v_mfma_f32_32x32x16_bf16 v[112:127],a[8:11],v[24:27],v[112:127]
buffer_load_dwordx4 v[80:83],v1,s[8:11],s63 offen sc1
s_add_u32 s82,s82,327680
s_mul_i32 s41,s52,46080
s_add_u32 s41,s41,209518592
s_add_u32 s40,s41,s70
v_mfma_f32_32x32x16_bf16 v[128:143],a[104:107],v[24:27],v[128:143]
s_lshr_b32 s64,s70,3
s_add_u32 s41,s41,s64
s_add_u32 s41,s41,40960
s_mul_i32 s64,s52,40960
s_add_u32 s62,s32,1
s_min_u32 s62,s62,127
s_waitcnt vmcnt(16)
v_mfma_f32_32x32x16_bf16 v[112:127],a[12:15],v[28:31],v[112:127]
buffer_load_dwordx4 v[84:87],v1,s[8:11],s63 offen offset:1024 sc1
s_cmp_lg_u32 s51,0
s_cselect_b32 s40,s64,s40
s_cselect_b32 s42,2147483648,s42
s_sub_u32 s60,s62,18
v_mfma_f32_32x32x16_bf16 v[128:143],a[108:111],v[28:31],v[128:143]
s_lshr_b32 s29,s60,1
s_and_b32 s28,s60,1
s_cmp_eq_u32 s28,0
s_cselect_b32 s61,18,0
s_add_u32 s29,s29,s61
s_sub_u32 s61,s60,46
s_waitcnt vmcnt(16)
v_mfma_f32_32x32x16_bf16 v[112:127],a[16:19],v[32:35],v[112:127]
buffer_load_dwordx4 v[88:91],v1,s[8:11],s63 offen offset:2048 sc1
s_cmp_ge_u32 s60,92
s_cselect_b32 s29,s61,s29
s_cselect_b32 s28,1,s28
v_mfma_f32_32x32x16_bf16 v[128:143],a[112:115],v[32:35],v[128:143]
s_cmp_lt_u32 s62,18
s_cselect_b32 s29,s62,s29
s_cselect_b32 s28,0,s28
s_lshl_b32 s30,s28,6
s_add_u32 s30,s30,s29
s_lshl_b32 s30,s30,9
s_waitcnt vmcnt(16)
v_mfma_f32_32x32x16_bf16 v[112:127],a[20:23],v[36:39],v[112:127]
buffer_load_dwordx4 v[92:95],v1,s[8:11],s63 offen offset:3072 sc1
s_add_u32 s63,s72,20480
s_add_u32 s30,s30,589824
s_and_b32 s60,s29,3
s_lshl2_add_u32 s60,s28,s60
v_mfma_f32_32x32x16_bf16 v[128:143],a[116:119],v[36:39],v[128:143]
s_mul_i32 s31,s60,98304
s_add_u32 s31,s31,s71
s_waitcnt vmcnt(16)
v_mfma_f32_32x32x16_bf16 v[112:127],a[24:27],v[40:43],v[112:127]
buffer_load_dwordx4 v[96:99],v1,s[8:11],s63 offen sc1
v_mfma_f32_32x32x16_bf16 v[128:143],a[120:123],v[40:43],v[128:143]
s_waitcnt vmcnt(16)
v_mfma_f32_32x32x16_bf16 v[112:127],a[28:31],v[44:47],v[112:127]
buffer_load_dwordx4 v[100:103],v1,s[8:11],s63 offen offset:1024 sc1
v_mfma_f32_32x32x16_bf16 v[128:143],a[124:127],v[44:47],v[128:143]
s_waitcnt vmcnt(16)
v_mfma_f32_32x32x16_bf16 v[112:127],a[32:35],v[48:51],v[112:127]
buffer_load_dwordx4 v[104:107],v1,s[8:11],s63 offen offset:2048 sc1
v_mfma_f32_32x32x16_bf16 v[128:143],a[128:131],v[48:51],v[128:143]
s_waitcnt vmcnt(16)
v_mfma_f32_32x32x16_bf16 v[112:127],a[36:39],v[52:55],v[112:127]
buffer_load_dwordx4 v[108:111],v1,s[8:11],s63 offen offset:3072 sc1
buffer_load_dwordx4 v[180:183],v15,s[8:11],s43 offen sc1
s_add_u32 s63,s73,0
v_mfma_f32_32x32x16_bf16 v[128:143],a[132:135],v[52:55],v[128:143]
buffer_load_dwordx4 v[16:19],v1,s[8:11],s63 offen sc1
s_waitcnt vmcnt(18)
v_mfma_f32_32x32x16_bf16 v[112:127],a[40:43],v[56:59],v[112:127]
v_mfma_f32_32x32x16_bf16 v[128:143],a[136:139],v[56:59],v[128:143]
buffer_load_dwordx4 v[20:23],v1,s[8:11],s63 offen offset:1024 sc1
s_waitcnt vmcnt(18)
v_mfma_f32_32x32x16_bf16 v[112:127],a[44:47],v[60:63],v[112:127]
v_mfma_f32_32x32x16_bf16 v[128:143],a[140:143],v[60:63],v[128:143]
buffer_load_dwordx4 v[24:27],v1,s[8:11],s63 offen offset:2048 sc1
s_waitcnt vmcnt(18)
v_mfma_f32_32x32x16_bf16 v[112:127],a[48:51],v[64:67],v[112:127]
v_mfma_f32_32x32x16_bf16 v[128:143],a[144:147],v[64:67],v[128:143]
buffer_load_dwordx4 v[28:31],v1,s[8:11],s63 offen offset:3072 sc1
s_add_u32 s63,s73,4096
s_waitcnt vmcnt(18)
v_mfma_f32_32x32x16_bf16 v[112:127],a[52:55],v[68:71],v[112:127]
s_waitcnt vmcnt(16)
s_mov_b64 exec,1
buffer_store_dword v5,v1,s[8:11],s59 offen sc1
s_mov_b64 exec,-1
s_mov_b32 s59,2147483648
v_mfma_f32_32x32x16_bf16 v[128:143],a[148:151],v[68:71],v[128:143]
buffer_load_dwordx4 v[32:35],v1,s[8:11],s63 offen sc1
s_waitcnt vmcnt(17)
v_mfma_f32_32x32x16_bf16 v[112:127],a[56:59],v[72:75],v[112:127]
v_mfma_f32_32x32x16_bf16 v[128:143],a[152:155],v[72:75],v[128:143]
buffer_load_dwordx4 v[36:39],v1,s[8:11],s63 offen offset:1024 sc1
s_waitcnt vmcnt(17)
v_mfma_f32_32x32x16_bf16 v[112:127],a[60:63],v[76:79],v[112:127]
v_mfma_f32_32x32x16_bf16 v[128:143],a[156:159],v[76:79],v[128:143]
buffer_load_dwordx4 v[40:43],v1,s[8:11],s63 offen offset:2048 sc1
s_waitcnt vmcnt(16)
v_mfma_f32_32x32x16_bf16 v[112:127],a[64:67],v[80:83],v[112:127]
v_mfma_f32_32x32x16_bf16 v[128:143],a[160:163],v[80:83],v[128:143]
buffer_load_dwordx4 v[44:47],v1,s[8:11],s63 offen offset:3072 sc1
s_add_u32 s63,s73,8192
s_waitcnt vmcnt(16)
v_mfma_f32_32x32x16_bf16 v[112:127],a[68:71],v[84:87],v[112:127]
v_mfma_f32_32x32x16_bf16 v[128:143],a[164:167],v[84:87],v[128:143]
buffer_load_dwordx4 v[48:51],v1,s[8:11],s63 offen sc1
s_waitcnt vmcnt(16)
v_mfma_f32_32x32x16_bf16 v[112:127],a[72:75],v[88:91],v[112:127]
v_mfma_f32_32x32x16_bf16 v[128:143],a[168:171],v[88:91],v[128:143]
buffer_load_dwordx4 v[52:55],v1,s[8:11],s63 offen offset:1024 sc1
v_lshlrev_b32 v184,16,v176
v_and_b32 v185,0xffff0000,v176
v_lshlrev_b32 v186,16,v177
s_waitcnt vmcnt(16)
v_mfma_f32_32x32x16_bf16 v[112:127],a[76:79],v[92:95],v[112:127]
v_and_b32 v187,0xffff0000,v177
v_lshlrev_b32 v188,16,v178
v_and_b32 v189,0xffff0000,v178
v_lshlrev_b32 v190,16,v179
v_and_b32 v191,0xffff0000,v179
v_mfma_f32_32x32x16_bf16 v[128:143],a[172:175],v[92:95],v[128:143]
buffer_load_dwordx4 v[56:59],v1,s[8:11],s63 offen offset:2048 sc1
s_waitcnt vmcnt(16)
v_mfma_f32_32x32x16_bf16 v[112:127],a[80:83],v[96:99],v[112:127]
s_waitcnt vmcnt(15)
v_mfma_f32_32x32x16_bf16 v[112:127],a[84:87],v[100:103],v[112:127]
buffer_load_dwordx4 v[60:63],v1,s[8:11],s63 offen offset:3072 sc1
s_add_u32 s63,s73,12288
s_waitcnt vmcnt(15)
v_mfma_f32_32x32x16_bf16 v[112:127],a[88:91],v[104:107],v[112:127]
s_waitcnt vmcnt(14)
v_mfma_f32_32x32x16_bf16 v[112:127],a[92:95],v[108:111],v[112:127]
buffer_load_dwordx4 v[64:67],v1,s[8:11],s63 offen sc1
v_mfma_f32_32x32x16_bf16 v[128:143],a[176:179],v[96:99],v[128:143]
s_mov_b64 exec,1
s_cmp_lg_u32 s49,0
s_cbranch_scc0 ls_335
buffer_store_dword v5,v1,s[8:11],s82 offen sc1
s_branch ls_336
ls_335:
buffer_store_dword v5,v1,s[8:11],s82 offen
ls_336:
s_mov_b64 exec,-1
v_mfma_f32_32x32x16_bf16 v[128:143],a[180:183],v[100:103],v[128:143]
buffer_load_dwordx4 v[68:71],v1,s[8:11],s63 offen offset:1024 sc1
ds_write_b128 v206,v[112:115] offset:0
ds_write_b128 v206,v[116:119] offset:1024
v_mfma_f32_32x32x16_bf16 v[128:143],a[184:187],v[104:107],v[128:143]
ds_write_b128 v206,v[120:123] offset:512
ds_write_b128 v206,v[124:127] offset:1536
v_mfma_f32_32x32x16_bf16 v[128:143],a[188:191],v[108:111],v[128:143]
buffer_load_dword v3,v2,s[8:11],s30 offen sc1
s_nop 5
s_branch W4_E0
s_nop 3
W4_W0:
s_waitcnt vmcnt(15)
v_mfma_f32_32x32x16_bf16 v[112:127],a[0:3],v[16:19],0
s_add_u32 s63,s72,12288
buffer_load_dwordx4 v[72:75],v1,s[8:11],s63 offen offset:2048 sc1
v_xor_b32 v206,0x8000,v206
v_xor_b32 v207,0x8000,v207
s_lshl_b32 s64,s51,6
v_mfma_f32_32x32x16_bf16 v[128:143],a[96:99],v[16:19],0
s_add_u32 s64,s64,s52
s_and_b32 s65,s52,7
s_lshl3_add_u32 s65,s51,s65
s_mul_i32 s65,s65,46080
s_add_u32 s65,s65,s70
s_add_u32 s65,s65,212467712
s_waitcnt vmcnt(15)
v_mfma_f32_32x32x16_bf16 v[112:127],a[4:7],v[20:23],v[112:127]
buffer_load_dwordx4 v[76:79],v1,s[8:11],s63 offen offset:3072 sc1
s_add_u32 s63,s72,16384
buffer_load_dwordx4 v[176:179],v1,s[8:11],s65 offen sc1
s_mul_i32 s65,s64,40960
v_mfma_f32_32x32x16_bf16 v[128:143],a[100:103],v[20:23],v[128:143]
s_add_u32 s65,s65,s70
s_add_u32 s65,s65,218365952
s_mov_b32 s43,s65
s_lshl_b32 s82,s64,9
s_lshl2_add_u32 s82,s56,s82
s_add_u32 s42,s82,32768
s_waitcnt vmcnt(16)
v_mfma_f32_32x32x16_bf16 v[112:127],a[8:11],v[24:27],v[112:127]
buffer_load_dwordx4 v[80:83],v1,s[8:11],s63 offen sc1
s_add_u32 s82,s82,327680
s_mul_i32 s41,s52,46080
s_add_u32 s41,s41,209518592
s_add_u32 s40,s41,s70
v_mfma_f32_32x32x16_bf16 v[128:143],a[104:107],v[24:27],v[128:143]
s_lshr_b32 s64,s70,3
s_add_u32 s41,s41,s64
s_add_u32 s41,s41,40960
s_mul_i32 s64,s52,40960
s_add_u32 s62,s32,1
s_min_u32 s62,s62,127
s_waitcnt vmcnt(16)
v_mfma_f32_32x32x16_bf16 v[112:127],a[12:15],v[28:31],v[112:127]
buffer_load_dwordx4 v[84:87],v1,s[8:11],s63 offen offset:1024 sc1
s_cmp_lg_u32 s51,0
s_cselect_b32 s40,s64,s40
s_cselect_b32 s42,2147483648,s42
s_sub_u32 s60,s62,18
v_mfma_f32_32x32x16_bf16 v[128:143],a[108:111],v[28:31],v[128:143]
s_lshr_b32 s29,s60,1
s_and_b32 s28,s60,1
s_cmp_eq_u32 s28,0
s_cselect_b32 s61,18,0
s_add_u32 s29,s29,s61
s_sub_u32 s61,s60,46
s_waitcnt vmcnt(16)
v_mfma_f32_32x32x16_bf16 v[112:127],a[16:19],v[32:35],v[112:127]
buffer_load_dwordx4 v[88:91],v1,s[8:11],s63 offen offset:2048 sc1
s_cmp_ge_u32 s60,92
s_cselect_b32 s29,s61,s29
s_cselect_b32 s28,1,s28
v_mfma_f32_32x32x16_bf16 v[128:143],a[112:115],v[32:35],v[128:143]
s_cmp_lt_u32 s62,18
s_cselect_b32 s29,s62,s29
s_cselect_b32 s28,0,s28
s_lshl_b32 s30,s28,6
s_add_u32 s30,s30,s29
s_lshl_b32 s30,s30,9
s_waitcnt vmcnt(16)
v_mfma_f32_32x32x16_bf16 v[112:127],a[20:23],v[36:39],v[112:127]
buffer_load_dwordx4 v[92:95],v1,s[8:11],s63 offen offset:3072 sc1
s_add_u32 s63,s72,20480
s_add_u32 s30,s30,589824
s_and_b32 s60,s29,3
s_lshl2_add_u32 s60,s28,s60
v_mfma_f32_32x32x16_bf16 v[128:143],a[116:119],v[36:39],v[128:143]
s_mul_i32 s31,s60,98304
s_add_u32 s31,s31,s71
s_waitcnt vmcnt(16)
v_mfma_f32_32x32x16_bf16 v[112:127],a[24:27],v[40:43],v[112:127]
buffer_load_dwordx4 v[96:99],v1,s[8:11],s63 offen sc1
v_mfma_f32_32x32x16_bf16 v[128:143],a[120:123],v[40:43],v[128:143]
s_waitcnt vmcnt(16)
v_mfma_f32_32x32x16_bf16 v[112:127],a[28:31],v[44:47],v[112:127]
buffer_load_dwordx4 v[100:103],v1,s[8:11],s63 offen offset:1024 sc1
v_mfma_f32_32x32x16_bf16 v[128:143],a[124:127],v[44:47],v[128:143]
s_waitcnt vmcnt(16)
v_mfma_f32_32x32x16_bf16 v[112:127],a[32:35],v[48:51],v[112:127]
buffer_load_dwordx4 v[104:107],v1,s[8:11],s63 offen offset:2048 sc1
v_mfma_f32_32x32x16_bf16 v[128:143],a[128:131],v[48:51],v[128:143]
s_waitcnt vmcnt(16)
v_mfma_f32_32x32x16_bf16 v[112:127],a[36:39],v[52:55],v[112:127]
buffer_load_dwordx4 v[108:111],v1,s[8:11],s63 offen offset:3072 sc1
buffer_load_dwordx4 v[180:183],v15,s[8:11],s43 offen sc1
v_mfma_f32_32x32x16_bf16 v[128:143],a[132:135],v[52:55],v[128:143]
s_waitcnt vmcnt(17)
v_mfma_f32_32x32x16_bf16 v[112:127],a[40:43],v[56:59],v[112:127]
v_mfma_f32_32x32x16_bf16 v[128:143],a[136:139],v[56:59],v[128:143]
s_waitcnt vmcnt(16)
v_mfma_f32_32x32x16_bf16 v[112:127],a[44:47],v[60:63],v[112:127]
v_mfma_f32_32x32x16_bf16 v[128:143],a[140:143],v[60:63],v[128:143]
s_waitcnt vmcnt(15)
v_mfma_f32_32x32x16_bf16 v[112:127],a[48:51],v[64:67],v[112:127]
v_mfma_f32_32x32x16_bf16 v[128:143],a[144:147],v[64:67],v[128:143]
s_waitcnt vmcnt(14)
v_mfma_f32_32x32x16_bf16 v[112:127],a[52:55],v[68:71],v[112:127]
s_waitcnt vmcnt(12)
s_mov_b64 exec,1
buffer_store_dword v5,v1,s[8:11],s59 offen sc1
s_mov_b64 exec,-1
s_mov_b32 s59,2147483648
v_mfma_f32_32x32x16_bf16 v[128:143],a[148:151],v[68:71],v[128:143]
s_waitcnt vmcnt(12)
v_mfma_f32_32x32x16_bf16 v[112:127],a[56:59],v[72:75],v[112:127]
v_mfma_f32_32x32x16_bf16 v[128:143],a[152:155],v[72:75],v[128:143]
s_waitcnt vmcnt(11)
v_mfma_f32_32x32x16_bf16 v[112:127],a[60:63],v[76:79],v[112:127]
v_mfma_f32_32x32x16_bf16 v[128:143],a[156:159],v[76:79],v[128:143]
s_waitcnt vmcnt(9)
v_mfma_f32_32x32x16_bf16 v[112:127],a[64:67],v[80:83],v[112:127]
v_mfma_f32_32x32x16_bf16 v[128:143],a[160:163],v[80:83],v[128:143]
s_waitcnt vmcnt(8)
v_mfma_f32_32x32x16_bf16 v[112:127],a[68:71],v[84:87],v[112:127]
v_mfma_f32_32x32x16_bf16 v[128:143],a[164:167],v[84:87],v[128:143]
s_waitcnt vmcnt(7)
v_mfma_f32_32x32x16_bf16 v[112:127],a[72:75],v[88:91],v[112:127]
v_mfma_f32_32x32x16_bf16 v[128:143],a[168:171],v[88:91],v[128:143]
v_lshlrev_b32 v184,16,v176
v_and_b32 v185,0xffff0000,v176
v_lshlrev_b32 v186,16,v177
v_and_b32 v187,0xffff0000,v177
v_lshlrev_b32 v188,16,v178
s_waitcnt vmcnt(6)
v_mfma_f32_32x32x16_bf16 v[112:127],a[76:79],v[92:95],v[112:127]
buffer_load_dword v3,v2,s[8:11],s35 offen sc1
v_and_b32 v189,0xffff0000,v178
v_lshlrev_b32 v190,16,v179
v_and_b32 v191,0xffff0000,v179
v_mfma_f32_32x32x16_bf16 v[128:143],a[172:175],v[92:95],v[128:143]
s_waitcnt vmcnt(6)
v_mfma_f32_32x32x16_bf16 v[112:127],a[80:83],v[96:99],v[112:127]
s_waitcnt vmcnt(5)
v_mfma_f32_32x32x16_bf16 v[112:127],a[84:87],v[100:103],v[112:127]
s_waitcnt vmcnt(4)
v_mfma_f32_32x32x16_bf16 v[112:127],a[88:91],v[104:107],v[112:127]
s_waitcnt vmcnt(3)
v_mfma_f32_32x32x16_bf16 v[112:127],a[92:95],v[108:111],v[112:127]
v_mfma_f32_32x32x16_bf16 v[128:143],a[176:179],v[96:99],v[128:143]
s_mov_b64 exec,1
s_cmp_lg_u32 s49,0
s_cbranch_scc0 ls_337
buffer_store_dword v5,v1,s[8:11],s82 offen sc1
s_branch ls_338
ls_337:
buffer_store_dword v5,v1,s[8:11],s82 offen
ls_338:
s_mov_b64 exec,-1
v_mfma_f32_32x32x16_bf16 v[128:143],a[180:183],v[100:103],v[128:143]
ds_write_b128 v206,v[112:115] offset:0
ds_write_b128 v206,v[116:119] offset:1024
ds_write_b128 v206,v[120:123] offset:512
v_mfma_f32_32x32x16_bf16 v[128:143],a[184:187],v[104:107],v[128:143]
ds_write_b128 v206,v[124:127] offset:1536
v_mfma_f32_32x32x16_bf16 v[128:143],a[188:191],v[108:111],v[128:143]
s_waitcnt vmcnt(1)
v_cmp_eq_u32 vcc,0,v3
s_cmp_eq_u64 vcc,0
s_cselect_b32 s37,0,2147483648
s_cmp_lt_u32 s32,128
s_cselect_b32 s37,s37,2147483648
s_cmp_eq_u32 s37,0
s_cbranch_scc1 W4_E2
s_branch W4_E0
s_nop 2
W4_END:
s_endpgm
.section .rodata,"a"
.p2align 6
.amdhsa_kernel interleave_layers__memory_aug_recurrent_mem_tr__mixer_s_mlp__prompt_kernel
  .amdhsa_next_free_vgpr 512
  .amdhsa_next_free_sgpr 102
  .amdhsa_accum_offset 256
  .amdhsa_group_segment_fixed_size 0
  .amdhsa_kernarg_size 120
  .amdhsa_user_sgpr_count 2
  .amdhsa_user_sgpr_kernarg_segment_ptr 1
  .amdhsa_system_sgpr_workgroup_id_x 1
.end_amdhsa_kernel
```

```asm
; @launch grid=(256,1,1) block=(256,1,1) lds=163840
.amdgcn_target "amdgcn-amd-amdhsa--gfx950"
.text
.globl interleave_layers__memory_aug_recurrent_mem_tr__mixer_s_mlp__prompt_kernel
.p2align 8
.type interleave_layers__memory_aug_recurrent_mem_tr__mixer_s_mlp__prompt_kernel,@function
interleave_layers__memory_aug_recurrent_mem_tr__mixer_s_mlp__prompt_kernel:
s_cmp_ge_u32 s2,256
s_cbranch_scc1 EXIT
s_load_dwordx16 s[16:31],s[0:1],0
s_load_dwordx8 s[32:39],s[0:1],64
s_load_dwordx4 s[40:43],s[0:1],96
s_load_dwordx2 s[44:45],s[0:1],112
v_lshrrev_b32 v1,6,v0
v_and_b32 v0,63,v0
v_readfirstlane_b32 s46,v1
s_mov_b32 s47,200000
s_mov_b32 s49,0
s_getreg_b32 s4,hwreg(HW_REG_XCC_ID)
s_and_b32 s4,s4,7
s_waitcnt lgkmcnt(0)
s_mov_b32 s8,s44
s_mov_b32 s9,s45
s_mov_b32 s10,268435456
s_mov_b32 s11,0x20000
s_mov_b32 s12,s42
s_mov_b32 s13,s43
s_mov_b32 s14,256
s_mov_b32 s15,0x20000
v_lshlrev_b32 v1,4,v0
v_mov_b32 v4,0
v_mov_b32 v5,0
v_mov_b32 v6,0
v_mov_b32 v7,0
s_lshl_b32 s5,s2,2
s_add_u32 s5,s5,s46
s_lshl_b32 s5,s5,10
buffer_store_dwordx4 v[4:7],v1,s[8:11],s5 offen sc1
v_mov_b32 v2,0
s_cmp_lg_u32 s46,0
s_cbranch_scc1 TK_DONE
s_mov_b64 exec,1
v_mov_b32 v1,1
s_lshl_b32 s5,s4,2
v_mov_b32 v3,s5
buffer_atomic_add v1,v3,s[12:15],0 offen offset:32 sc0 sc1
s_waitcnt vmcnt(0)
v_readfirstlane_b32 s5,v1
s_lshl_b32 s6,s4,5
s_add_u32 s6,s6,s5
s_cmp_lt_u32 s5,32
s_cselect_b32 s6,s6,999
v_mov_b32 v1,s6
ds_write_b32 v2,v1
s_mov_b64 exec,-1
s_waitcnt lgkmcnt(0)
TK_DONE:
s_barrier
ds_read_b32 v1,v2
s_waitcnt lgkmcnt(0)
v_readfirstlane_b32 s3,v1
s_barrier
s_nop 2
s_branch DISPATCH
ROLE_CS:
s_lshr_b32 s28,s48,4
s_and_b32 s29,s48,15
s_mul_i32 s82,s28,2097152
s_add_u32 s82,s82,2097152
v_lshlrev_b32 v1,4,v0
v_and_b32 v12,1,v0
v_mul_u32_u24 v2,0xaaaa,v12
v_or_b32 v2,0x4444,v2
s_add_u32 s60,s46,1
s_and_b32 s60,s60,3
s_lshl_b32 s60,s60,11
s_add_u32 s60,s60,131072
v_add_u32 v3,s60,v1
s_add_u32 s60,s46,2
s_and_b32 s60,s60,3
s_lshl_b32 s60,s60,11
s_add_u32 s60,s60,131072
v_add_u32 v4,s60,v1
s_add_u32 s60,s46,3
s_and_b32 s60,s60,3
s_lshl_b32 s60,s60,11
s_add_u32 s60,s60,131072
v_add_u32 v5,s60,v1
v_add_u32 v59,139264,v1
s_lshl_b32 s60,s46,11
s_add_u32 s60,s60,131072
v_add_u32 v22,s60,v1
s_lshr_b32 s60,s46,1
s_lshl_b32 s60,s60,10
s_and_b32 s61,s46,1
s_lshl_b32 s61,s61,3
s_add_u32 s60,s60,s61
v_add_u32 v23,s60,v59
s_mul_i32 s60,s46,20480
v_add_u32 v21,s60,v1
v_and_b32 v11,7,v0
v_lshlrev_b32 v11,2,v11
v_bfe_u32 v12,v0,3,2
v_lshl_add_u32 v11,v12,7,v11
s_xor_b32 s60,s28,1
s_lshl_b32 s60,s60,19
s_lshl_b32 s61,s46,11
s_add_u32 s83,s60,s61
s_add_u32 s83,s83,10485760
s_mov_b32 s36,0
s_mov_b32 s88,0xcccccccc
s_mov_b32 s89,0xcccccccc
s_mov_b32 s90,0x33333333
s_mov_b32 s91,0x33333333
s_mov_b32 s87,0x3dd53b95
v_lshrrev_b32 v14,4,v0
v_and_b32 v15,15,v0
v_lshrrev_b32 v12,2,v15
v_add_u32 v12,v12,v14
v_and_b32 v12,3,v12
v_lshlrev_b32 v6,3,v12
v_lshl_add_u32 v6,v15,5,v6
s_mul_i32 s60,s46,1536
s_add_u32 s60,s60,141312
v_add_u32 v6,s60,v6
v_add_u32 v12,v0,v14
v_and_b32 v12,3,v12
v_lshlrev_b32 v7,3,v12
v_lshrrev_b32 v12,2,v0
v_lshl_add_u32 v7,v12,5,v7
v_add_u32 v7,141312,v7
s_min_u32 s62,s46,2
v_lshrrev_b32 v12,2,v15
v_and_b32 v13,1,v15
v_lshl_add_u32 v12,v12,1,v13
v_bfe_u32 v13,v15,1,1
v_lshlrev_b32 v8,8,v14
v_lshl_add_u32 v8,v12,5,v8
v_xor_b32 v16,1,v13
v_lshl_add_u32 v8,v16,4,v8
v_lshlrev_b32 v20,8,v14
v_lshl_add_u32 v20,v13,7,v20
v_and_b32 v16,3,v12
v_lshl_add_u32 v20,v16,5,v20
v_lshrrev_b32 v16,2,v12
v_lshl_add_u32 v20,v16,4,v20
v_min_u32 v12,5,v0
s_mul_i32 s60,s48,3
v_add_u32 v9,s60,v12
v_lshlrev_b32 v9,2,v9
v_add_u32 v13,65524,v9
v_cmp_lt_u32 vcc,2,v12
s_nop 1
v_cndmask_b32 v9,v9,v13,vcc
s_mul_i32 s84,s48,12288
s_add_u32 s84,s84,74448896
s_mul_i32 s60,s29,3072
s_lshl_b32 s61,s62,10
s_add_u32 s60,s60,s61
s_add_u32 s60,s60,s82
s_add_u32 s33,s60,163840
s_add_u32 s34,s60,557056
s_mul_i32 s85,s48,6144
s_add_u32 s85,s85,24117248
s_lshl_b32 s86,s48,5
s_lshl_b32 s61,s62,2
s_add_u32 s86,s86,688128
s_lshr_b32 s60,s29,2
s_lshl_b32 s60,s60,7
s_and_b32 s63,s29,3
s_mul_i32 s63,s63,12
s_add_u32 s60,s60,s63
s_add_u32 s60,s60,s61
s_add_u32 s60,s60,s82
s_add_u32 s35,s60,951296
s_cmp_eq_u32 s46,3
s_cbranch_scc1 si_1
v_mov_b32 v12,-1
v_mov_b32 v13,0
s_cmp_lg_u32 s49,0
s_cbranch_scc1 ls_2
s_add_u32 s60,s33,0
buffer_store_dword v12,v1,s[8:11],s60 offen
s_add_u32 s60,s33,49152
buffer_store_dword v12,v1,s[8:11],s60 offen
s_add_u32 s60,s33,98304
buffer_store_dword v12,v1,s[8:11],s60 offen
s_add_u32 s60,s33,147456
buffer_store_dword v12,v1,s[8:11],s60 offen
s_add_u32 s60,s33,196608
buffer_store_dword v12,v1,s[8:11],s60 offen
s_add_u32 s60,s33,245760
buffer_store_dword v12,v1,s[8:11],s60 offen
s_add_u32 s60,s33,294912
buffer_store_dword v12,v1,s[8:11],s60 offen
s_add_u32 s60,s33,344064
buffer_store_dword v12,v1,s[8:11],s60 offen
s_mov_b64 exec,1
buffer_store_dword v13,v1,s[8:11],s35 offen
buffer_store_dword v13,v1,s[8:11],s35 offen offset:512
s_mov_b64 exec,-1
s_branch ls_3
ls_2:
s_add_u32 s60,s33,0
buffer_store_dword v12,v1,s[8:11],s60 offen sc1
s_add_u32 s60,s33,49152
buffer_store_dword v12,v1,s[8:11],s60 offen sc1
s_add_u32 s60,s33,98304
buffer_store_dword v12,v1,s[8:11],s60 offen sc1
s_add_u32 s60,s33,147456
buffer_store_dword v12,v1,s[8:11],s60 offen sc1
s_add_u32 s60,s33,196608
buffer_store_dword v12,v1,s[8:11],s60 offen sc1
s_add_u32 s60,s33,245760
buffer_store_dword v12,v1,s[8:11],s60 offen sc1
s_add_u32 s60,s33,294912
buffer_store_dword v12,v1,s[8:11],s60 offen sc1
s_add_u32 s60,s33,344064
buffer_store_dword v12,v1,s[8:11],s60 offen sc1
s_mov_b64 exec,1
buffer_store_dword v13,v1,s[8:11],s35 offen sc1
buffer_store_dword v13,v1,s[8:11],s35 offen offset:512 sc1
s_mov_b64 exec,-1
ls_3:
si_1:
s_mul_i32 s73,s48,384
s_mov_b32 s74,s73
v_add_u32 v12,0,v0
v_mul_u32_u24 v13,2731,v12
v_lshrrev_b32 v13,16,v13
v_mul_u32_u24 v16,24,v13
v_sub_u32 v12,v12,v16
v_mul_u32_u24 v104,12288,v13
v_lshl_add_u32 v104,v12,4,v104
v_add_u32 v12,64,v0
v_mul_u32_u24 v13,2731,v12
v_lshrrev_b32 v13,16,v13
v_mul_u32_u24 v16,24,v13
v_sub_u32 v12,v12,v16
v_mul_u32_u24 v105,12288,v13
v_lshl_add_u32 v105,v12,4,v105
v_add_u32 v12,128,v0
v_mul_u32_u24 v13,2731,v12
v_lshrrev_b32 v13,16,v13
v_mul_u32_u24 v16,24,v13
v_sub_u32 v12,v12,v16
v_mul_u32_u24 v106,12288,v13
v_lshl_add_u32 v106,v12,4,v106
s_mov_b32 s4,s20
s_mov_b32 s5,s21
s_mov_b32 s6,7864320
s_mov_b32 s7,0x20000
s_mov_b32 s52,s22
s_mov_b32 s53,s23
s_mov_b32 s54,7864320
s_mov_b32 s55,0x20000
s_branch SV_LOAD
ROLE_CV:
s_lshr_b32 s28,s48,3
s_and_b32 s29,s48,7
s_mul_i32 s82,s28,2097152
s_add_u32 s82,s82,2097152
v_lshlrev_b32 v1,4,v0
v_and_b32 v12,1,v0
v_mul_u32_u24 v2,0xaaaa,v12
v_or_b32 v2,0x4444,v2
s_add_u32 s60,s46,1
s_and_b32 s60,s60,3
s_lshl_b32 s60,s60,11
s_add_u32 s60,s60,131072
v_add_u32 v3,s60,v1
s_add_u32 s60,s46,2
s_and_b32 s60,s60,3
s_lshl_b32 s60,s60,11
s_add_u32 s60,s60,131072
v_add_u32 v4,s60,v1
s_add_u32 s60,s46,3
s_and_b32 s60,s60,3
s_lshl_b32 s60,s60,11
s_add_u32 s60,s60,131072
v_add_u32 v5,s60,v1
v_add_u32 v59,139264,v1
s_lshl_b32 s60,s46,11
s_add_u32 s60,s60,131072
v_add_u32 v22,s60,v1
s_lshr_b32 s60,s46,1
s_lshl_b32 s60,s60,10
s_and_b32 s61,s46,1
s_lshl_b32 s61,s61,3
s_add_u32 s60,s60,s61
v_add_u32 v23,s60,v59
s_mul_i32 s60,s46,20480
v_add_u32 v21,s60,v1
v_and_b32 v11,7,v0
v_lshlrev_b32 v11,2,v11
v_bfe_u32 v12,v0,3,2
v_lshl_add_u32 v11,v12,7,v11
s_xor_b32 s60,s28,1
s_lshl_b32 s60,s60,19
s_lshl_b32 s61,s46,11
s_add_u32 s83,s60,s61
s_add_u32 s83,s83,10485760
s_mov_b32 s36,1
v_lshlrev_b32 v8,3,v0
v_lshlrev_b32 v9,3,v0
v_lshlrev_b32 v20,3,v0
s_and_b32 s62,s46,1
s_lshl_b32 s60,s62,11
v_add_u32 v6,s60,v1
s_lshl_b32 s60,s62,3
s_add_u32 s60,s60,1024
v_add_u32 v7,s60,v1
s_lshr_b32 s61,s46,1
s_lshl_b32 s60,s29,1
s_add_u32 s60,s60,s61
s_mul_i32 s60,s60,3072
s_add_u32 s60,s60,s82
s_add_u32 s34,s60,557056
s_lshl_b32 s60,s48,1
s_add_u32 s60,s60,s61
s_mul_i32 s85,s60,6144
s_add_u32 s85,s85,24120320
s_lshl_b32 s86,s60,5
s_lshl_b32 s61,s62,2
s_add_u32 s86,s86,s61
s_add_u32 s86,s86,688132
v_mov_b32 v12,-1
v_mov_b32 v13,-1
v_mov_b32 v14,-1
v_mov_b32 v15,-1
s_cmp_lg_u32 s49,0
s_cbranch_scc1 ls_4
s_add_u32 s60,s34,0
buffer_store_dwordx4 v[12:15],v6,s[8:11],s60 offen
buffer_store_dwordx2 v[12:13],v7,s[8:11],s60 offen
s_add_u32 s60,s34,49152
buffer_store_dwordx4 v[12:15],v6,s[8:11],s60 offen
buffer_store_dwordx2 v[12:13],v7,s[8:11],s60 offen
s_add_u32 s60,s34,98304
buffer_store_dwordx4 v[12:15],v6,s[8:11],s60 offen
buffer_store_dwordx2 v[12:13],v7,s[8:11],s60 offen
s_add_u32 s60,s34,147456
buffer_store_dwordx4 v[12:15],v6,s[8:11],s60 offen
buffer_store_dwordx2 v[12:13],v7,s[8:11],s60 offen
s_add_u32 s60,s34,196608
buffer_store_dwordx4 v[12:15],v6,s[8:11],s60 offen
buffer_store_dwordx2 v[12:13],v7,s[8:11],s60 offen
s_add_u32 s60,s34,245760
buffer_store_dwordx4 v[12:15],v6,s[8:11],s60 offen
buffer_store_dwordx2 v[12:13],v7,s[8:11],s60 offen
s_add_u32 s60,s34,294912
buffer_store_dwordx4 v[12:15],v6,s[8:11],s60 offen
buffer_store_dwordx2 v[12:13],v7,s[8:11],s60 offen
s_add_u32 s60,s34,344064
buffer_store_dwordx4 v[12:15],v6,s[8:11],s60 offen
buffer_store_dwordx2 v[12:13],v7,s[8:11],s60 offen
s_branch ls_5
ls_4:
s_add_u32 s60,s34,0
buffer_store_dwordx4 v[12:15],v6,s[8:11],s60 offen sc1
buffer_store_dwordx2 v[12:13],v7,s[8:11],s60 offen sc1
s_add_u32 s60,s34,49152
buffer_store_dwordx4 v[12:15],v6,s[8:11],s60 offen sc1
buffer_store_dwordx2 v[12:13],v7,s[8:11],s60 offen sc1
s_add_u32 s60,s34,98304
buffer_store_dwordx4 v[12:15],v6,s[8:11],s60 offen sc1
buffer_store_dwordx2 v[12:13],v7,s[8:11],s60 offen sc1
s_add_u32 s60,s34,147456
buffer_store_dwordx4 v[12:15],v6,s[8:11],s60 offen sc1
buffer_store_dwordx2 v[12:13],v7,s[8:11],s60 offen sc1
s_add_u32 s60,s34,196608
buffer_store_dwordx4 v[12:15],v6,s[8:11],s60 offen sc1
buffer_store_dwordx2 v[12:13],v7,s[8:11],s60 offen sc1
s_add_u32 s60,s34,245760
buffer_store_dwordx4 v[12:15],v6,s[8:11],s60 offen sc1
buffer_store_dwordx2 v[12:13],v7,s[8:11],s60 offen sc1
s_add_u32 s60,s34,294912
buffer_store_dwordx4 v[12:15],v6,s[8:11],s60 offen sc1
buffer_store_dwordx2 v[12:13],v7,s[8:11],s60 offen sc1
s_add_u32 s60,s34,344064
buffer_store_dwordx4 v[12:15],v6,s[8:11],s60 offen sc1
buffer_store_dwordx2 v[12:13],v7,s[8:11],s60 offen sc1
s_nop 0
ls_5:
s_mul_i32 s73,s48,768
s_add_u32 s74,s73,96
v_add_u32 v12,0,v0
v_mul_u32_u24 v13,2731,v12
v_lshrrev_b32 v13,16,v13
v_mul_u32_u24 v16,24,v13
v_sub_u32 v12,v12,v16
v_mul_u32_u24 v104,12288,v13
v_lshl_add_u32 v104,v12,4,v104
v_mul_u32_u24 v13,43,v12
v_lshrrev_b32 v13,8,v13
v_mul_u32_u24 v13,96,v13
v_add_u32 v104,v104,v13
v_add_u32 v12,64,v0
v_mul_u32_u24 v13,2731,v12
v_lshrrev_b32 v13,16,v13
v_mul_u32_u24 v16,24,v13
v_sub_u32 v12,v12,v16
v_mul_u32_u24 v105,12288,v13
v_lshl_add_u32 v105,v12,4,v105
v_mul_u32_u24 v13,43,v12
v_lshrrev_b32 v13,8,v13
v_mul_u32_u24 v13,96,v13
v_add_u32 v105,v105,v13
v_add_u32 v12,128,v0
v_mul_u32_u24 v13,2731,v12
v_lshrrev_b32 v13,16,v13
v_mul_u32_u24 v16,24,v13
v_sub_u32 v12,v12,v16
v_mul_u32_u24 v106,12288,v13
v_lshl_add_u32 v106,v12,4,v106
v_mul_u32_u24 v13,43,v12
v_lshrrev_b32 v13,8,v13
v_mul_u32_u24 v13,96,v13
v_add_u32 v106,v106,v13
s_mov_b32 s4,s24
s_mov_b32 s5,s25
s_mov_b32 s6,7864320
s_mov_b32 s7,0x20000
s_mov_b32 s52,s24
s_mov_b32 s53,s25
s_mov_b32 s54,7864320
s_mov_b32 s55,0x20000
SV_LOAD:
s_waitcnt vmcnt(0)
s_barrier
s_cmp_lg_u32 s46,0
s_cbranch_scc1 arr_6
v_mov_b32 v12,1
s_lshl_b32 s3,s49,2
v_mov_b32 v13,s3
s_mov_b64 exec,1
buffer_atomic_add v12,v13,s[12:15],0 offen sc1
s_mov_b64 exec,-1
arr_6:
s_and_b32 s60,s46,1
s_mul_i32 s60,s60,196608
s_lshr_b32 s61,s46,1
s_mul_i32 s75,s61,393216
s_add_u32 s75,s75,s60
s_mul_i32 s76,s61,393216
s_add_u32 s76,s76,s60
s_mul_i32 s77,s46,6144
v_lshrrev_b32 v14,4,v0
v_and_b32 v15,15,v0
v_and_b32 v12,1,v14
v_lshlrev_b32 v12,2,v12
v_lshrrev_b32 v13,1,v14
v_lshl_add_u32 v12,v13,4,v12
v_bfe_u32 v13,v0,2,1
v_add_u32 v12,v12,v13
v_bfe_u32 v13,v0,3,1
v_lshl_add_u32 v12,v13,3,v12
v_mul_u32_u24 v107,384,v12
v_and_b32 v13,3,v0
v_lshl_add_u32 v107,v13,3,v107
s_mul_i32 s60,s46,96
v_add_u32 v107,s60,v107
s_add_u32 s60,s75,s73
s_add_u32 m0,s77,0
s_add_u32 s61,s60,0
buffer_load_dwordx4 v104,s[4:7],s61 offen lds
s_add_u32 m0,s77,1024
s_add_u32 s61,s60,0
buffer_load_dwordx4 v105,s[4:7],s61 offen lds
s_add_u32 m0,s77,2048
s_add_u32 s61,s60,0
buffer_load_dwordx4 v106,s[4:7],s61 offen lds
s_add_u32 m0,s77,3072
s_add_u32 s61,s60,98304
buffer_load_dwordx4 v104,s[4:7],s61 offen lds
s_add_u32 m0,s77,4096
s_add_u32 s61,s60,98304
buffer_load_dwordx4 v105,s[4:7],s61 offen lds
s_add_u32 m0,s77,5120
s_add_u32 s61,s60,98304
buffer_load_dwordx4 v106,s[4:7],s61 offen lds
s_add_u32 s60,s75,s74
s_add_u32 m0,s77,24576
s_add_u32 s61,s60,0
buffer_load_dwordx4 v104,s[52:55],s61 offen lds
s_add_u32 m0,s77,25600
s_add_u32 s61,s60,0
buffer_load_dwordx4 v105,s[52:55],s61 offen lds
s_add_u32 m0,s77,26624
s_add_u32 s61,s60,0
buffer_load_dwordx4 v106,s[52:55],s61 offen lds
s_add_u32 m0,s77,27648
s_add_u32 s61,s60,98304
buffer_load_dwordx4 v104,s[52:55],s61 offen lds
s_add_u32 m0,s77,28672
s_add_u32 s61,s60,98304
buffer_load_dwordx4 v105,s[52:55],s61 offen lds
s_add_u32 m0,s77,29696
s_add_u32 s61,s60,98304
buffer_load_dwordx4 v106,s[52:55],s61 offen lds
s_add_u32 s60,s75,s73
s_add_u32 m0,s77,49152
s_add_u32 s61,s60,786432
buffer_load_dwordx4 v104,s[4:7],s61 offen lds
s_add_u32 m0,s77,50176
s_add_u32 s61,s60,786432
buffer_load_dwordx4 v105,s[4:7],s61 offen lds
s_add_u32 m0,s77,51200
s_add_u32 s61,s60,786432
buffer_load_dwordx4 v106,s[4:7],s61 offen lds
s_add_u32 m0,s77,52224
s_add_u32 s61,s60,884736
buffer_load_dwordx4 v104,s[4:7],s61 offen lds
s_add_u32 m0,s77,53248
s_add_u32 s61,s60,884736
buffer_load_dwordx4 v105,s[4:7],s61 offen lds
s_add_u32 m0,s77,54272
s_add_u32 s61,s60,884736
buffer_load_dwordx4 v106,s[4:7],s61 offen lds
s_add_u32 s60,s75,s74
s_add_u32 m0,s77,73728
s_add_u32 s61,s60,786432
buffer_load_dwordx4 v104,s[52:55],s61 offen lds
s_add_u32 m0,s77,74752
s_add_u32 s61,s60,786432
buffer_load_dwordx4 v105,s[52:55],s61 offen lds
s_add_u32 m0,s77,75776
s_add_u32 s61,s60,786432
buffer_load_dwordx4 v106,s[52:55],s61 offen lds
s_add_u32 m0,s77,76800
s_add_u32 s61,s60,884736
buffer_load_dwordx4 v104,s[52:55],s61 offen lds
s_add_u32 m0,s77,77824
s_add_u32 s61,s60,884736
buffer_load_dwordx4 v105,s[52:55],s61 offen lds
s_add_u32 m0,s77,78848
s_add_u32 s61,s60,884736
buffer_load_dwordx4 v106,s[52:55],s61 offen lds
s_add_u32 s60,s75,s73
s_add_u32 m0,s77,98304
s_add_u32 s61,s60,1572864
buffer_load_dwordx4 v104,s[4:7],s61 offen lds
s_add_u32 m0,s77,99328
s_add_u32 s61,s60,1572864
buffer_load_dwordx4 v105,s[4:7],s61 offen lds
s_add_u32 m0,s77,100352
s_add_u32 s61,s60,1572864
buffer_load_dwordx4 v106,s[4:7],s61 offen lds
s_add_u32 m0,s77,101376
s_add_u32 s61,s60,1671168
buffer_load_dwordx4 v104,s[4:7],s61 offen lds
s_add_u32 m0,s77,102400
s_add_u32 s61,s60,1671168
buffer_load_dwordx4 v105,s[4:7],s61 offen lds
s_add_u32 m0,s77,103424
s_add_u32 s61,s60,1671168
buffer_load_dwordx4 v106,s[4:7],s61 offen lds
s_waitcnt vmcnt(24)
s_barrier
s_add_u32 s60,s75,s74
s_add_u32 m0,s77,122880
s_add_u32 s61,s60,1572864
buffer_load_dwordx4 v104,s[52:55],s61 offen lds
s_add_u32 m0,s77,123904
s_add_u32 s61,s60,1572864
buffer_load_dwordx4 v105,s[52:55],s61 offen lds
s_add_u32 m0,s77,124928
s_add_u32 s61,s60,1572864
buffer_load_dwordx4 v106,s[52:55],s61 offen lds
s_add_u32 m0,s77,125952
s_add_u32 s61,s60,1671168
buffer_load_dwordx4 v104,s[52:55],s61 offen lds
s_add_u32 m0,s77,126976
s_add_u32 s61,s60,1671168
buffer_load_dwordx4 v105,s[52:55],s61 offen lds
s_add_u32 m0,s77,128000
s_add_u32 s61,s60,1671168
buffer_load_dwordx4 v106,s[52:55],s61 offen lds
v_add_u32 v12,0,v107
s_cmp_eq_u32 s46,1
s_cbranch_scc1 lw_9
s_cmp_eq_u32 s46,2
s_cbranch_scc1 lw_10
s_cmp_eq_u32 s46,3
s_cbranch_scc1 lw_11
lw_8:
ds_read_b64_tr_b16 a[0:1],v12 offset:0
ds_read_b64_tr_b16 a[2:3],v12 offset:768
ds_read_b64_tr_b16 a[4:5],v12 offset:12288
ds_read_b64_tr_b16 a[6:7],v12 offset:13056
ds_read_b64_tr_b16 a[8:9],v12 offset:32
ds_read_b64_tr_b16 a[10:11],v12 offset:800
ds_read_b64_tr_b16 a[12:13],v12 offset:12320
ds_read_b64_tr_b16 a[14:15],v12 offset:13088
ds_read_b64_tr_b16 a[16:17],v12 offset:64
ds_read_b64_tr_b16 a[18:19],v12 offset:832
ds_read_b64_tr_b16 a[20:21],v12 offset:12352
ds_read_b64_tr_b16 a[22:23],v12 offset:13120
s_branch ld_7
lw_9:
ds_read_b64_tr_b16 a[240:241],v12 offset:0
ds_read_b64_tr_b16 a[242:243],v12 offset:768
ds_read_b64_tr_b16 a[244:245],v12 offset:12288
ds_read_b64_tr_b16 a[246:247],v12 offset:13056
ds_read_b64_tr_b16 a[248:249],v12 offset:32
ds_read_b64_tr_b16 a[250:251],v12 offset:800
ds_read_b64_tr_b16 a[252:253],v12 offset:12320
ds_read_b64_tr_b16 a[254:255],v12 offset:13088
ds_read_b64_tr_b16 v[112:113],v12 offset:64
ds_read_b64_tr_b16 v[114:115],v12 offset:832
ds_read_b64_tr_b16 v[116:117],v12 offset:12352
ds_read_b64_tr_b16 v[118:119],v12 offset:13120
s_branch ld_7
lw_10:
ds_read_b64_tr_b16 a[160:161],v12 offset:0
ds_read_b64_tr_b16 a[162:163],v12 offset:768
ds_read_b64_tr_b16 a[164:165],v12 offset:12288
ds_read_b64_tr_b16 a[166:167],v12 offset:13056
ds_read_b64_tr_b16 a[168:169],v12 offset:32
ds_read_b64_tr_b16 a[170:171],v12 offset:800
ds_read_b64_tr_b16 a[172:173],v12 offset:12320
ds_read_b64_tr_b16 a[174:175],v12 offset:13088
ds_read_b64_tr_b16 a[176:177],v12 offset:64
ds_read_b64_tr_b16 a[178:179],v12 offset:832
ds_read_b64_tr_b16 a[180:181],v12 offset:12352
ds_read_b64_tr_b16 a[182:183],v12 offset:13120
s_branch ld_7
lw_11:
ds_read_b64_tr_b16 a[80:81],v12 offset:0
ds_read_b64_tr_b16 a[82:83],v12 offset:768
ds_read_b64_tr_b16 a[84:85],v12 offset:12288
ds_read_b64_tr_b16 a[86:87],v12 offset:13056
ds_read_b64_tr_b16 a[88:89],v12 offset:32
ds_read_b64_tr_b16 a[90:91],v12 offset:800
ds_read_b64_tr_b16 a[92:93],v12 offset:12320
ds_read_b64_tr_b16 a[94:95],v12 offset:13088
ds_read_b64_tr_b16 a[96:97],v12 offset:64
ds_read_b64_tr_b16 a[98:99],v12 offset:832
ds_read_b64_tr_b16 a[100:101],v12 offset:12352
ds_read_b64_tr_b16 a[102:103],v12 offset:13120
ld_7:
s_waitcnt lgkmcnt(0)
s_waitcnt vmcnt(24)
s_barrier
s_add_u32 s60,s75,s73
s_add_u32 m0,s77,0
s_add_u32 s61,s60,2359296
buffer_load_dwordx4 v104,s[4:7],s61 offen lds
s_add_u32 m0,s77,1024
s_add_u32 s61,s60,2359296
buffer_load_dwordx4 v105,s[4:7],s61 offen lds
s_add_u32 m0,s77,2048
s_add_u32 s61,s60,2359296
buffer_load_dwordx4 v106,s[4:7],s61 offen lds
s_add_u32 m0,s77,3072
s_add_u32 s61,s60,2457600
buffer_load_dwordx4 v104,s[4:7],s61 offen lds
s_add_u32 m0,s77,4096
s_add_u32 s61,s60,2457600
buffer_load_dwordx4 v105,s[4:7],s61 offen lds
s_add_u32 m0,s77,5120
s_add_u32 s61,s60,2457600
buffer_load_dwordx4 v106,s[4:7],s61 offen lds
v_add_u32 v12,24576,v107
s_cmp_eq_u32 s46,1
s_cbranch_scc1 lw_14
s_cmp_eq_u32 s46,2
s_cbranch_scc1 lw_15
s_cmp_eq_u32 s46,3
s_cbranch_scc1 lw_16
lw_13:
ds_read_b64_tr_b16 a[24:25],v12 offset:0
ds_read_b64_tr_b16 a[26:27],v12 offset:768
ds_read_b64_tr_b16 a[28:29],v12 offset:12288
ds_read_b64_tr_b16 a[30:31],v12 offset:13056
ds_read_b64_tr_b16 a[32:33],v12 offset:32
ds_read_b64_tr_b16 a[34:35],v12 offset:800
ds_read_b64_tr_b16 a[36:37],v12 offset:12320
ds_read_b64_tr_b16 a[38:39],v12 offset:13088
ds_read_b64_tr_b16 v[24:25],v12 offset:64
ds_read_b64_tr_b16 v[26:27],v12 offset:832
ds_read_b64_tr_b16 v[28:29],v12 offset:12352
ds_read_b64_tr_b16 v[30:31],v12 offset:13120
s_branch ld_12
lw_14:
ds_read_b64_tr_b16 v[120:121],v12 offset:0
ds_read_b64_tr_b16 v[122:123],v12 offset:768
ds_read_b64_tr_b16 v[124:125],v12 offset:12288
ds_read_b64_tr_b16 v[126:127],v12 offset:13056
ds_read_b64_tr_b16 v[128:129],v12 offset:32
ds_read_b64_tr_b16 v[130:131],v12 offset:800
ds_read_b64_tr_b16 v[132:133],v12 offset:12320
ds_read_b64_tr_b16 v[134:135],v12 offset:13088
ds_read_b64_tr_b16 v[72:73],v12 offset:64
ds_read_b64_tr_b16 v[74:75],v12 offset:832
ds_read_b64_tr_b16 v[76:77],v12 offset:12352
ds_read_b64_tr_b16 v[78:79],v12 offset:13120
s_branch ld_12
lw_15:
ds_read_b64_tr_b16 a[184:185],v12 offset:0
ds_read_b64_tr_b16 a[186:187],v12 offset:768
ds_read_b64_tr_b16 a[188:189],v12 offset:12288
ds_read_b64_tr_b16 a[190:191],v12 offset:13056
ds_read_b64_tr_b16 a[192:193],v12 offset:32
ds_read_b64_tr_b16 a[194:195],v12 offset:800
ds_read_b64_tr_b16 a[196:197],v12 offset:12320
ds_read_b64_tr_b16 a[198:199],v12 offset:13088
ds_read_b64_tr_b16 v[56:57],v12 offset:64
ds_read_b64_tr_b16 v[58:59],v12 offset:832
ds_read_b64_tr_b16 v[60:61],v12 offset:12352
ds_read_b64_tr_b16 v[62:63],v12 offset:13120
s_branch ld_12
lw_16:
ds_read_b64_tr_b16 a[104:105],v12 offset:0
ds_read_b64_tr_b16 a[106:107],v12 offset:768
ds_read_b64_tr_b16 a[108:109],v12 offset:12288
ds_read_b64_tr_b16 a[110:111],v12 offset:13056
ds_read_b64_tr_b16 a[112:113],v12 offset:32
ds_read_b64_tr_b16 a[114:115],v12 offset:800
ds_read_b64_tr_b16 a[116:117],v12 offset:12320
ds_read_b64_tr_b16 a[118:119],v12 offset:13088
ds_read_b64_tr_b16 v[40:41],v12 offset:64
ds_read_b64_tr_b16 v[42:43],v12 offset:832
ds_read_b64_tr_b16 v[44:45],v12 offset:12352
ds_read_b64_tr_b16 v[46:47],v12 offset:13120
ld_12:
s_waitcnt lgkmcnt(0)
s_waitcnt vmcnt(24)
s_barrier
s_add_u32 s60,s75,s74
s_add_u32 m0,s77,24576
s_add_u32 s61,s60,2359296
buffer_load_dwordx4 v104,s[52:55],s61 offen lds
s_add_u32 m0,s77,25600
s_add_u32 s61,s60,2359296
buffer_load_dwordx4 v105,s[52:55],s61 offen lds
s_add_u32 m0,s77,26624
s_add_u32 s61,s60,2359296
buffer_load_dwordx4 v106,s[52:55],s61 offen lds
s_add_u32 m0,s77,27648
s_add_u32 s61,s60,2457600
buffer_load_dwordx4 v104,s[52:55],s61 offen lds
s_add_u32 m0,s77,28672
s_add_u32 s61,s60,2457600
buffer_load_dwordx4 v105,s[52:55],s61 offen lds
s_add_u32 m0,s77,29696
s_add_u32 s61,s60,2457600
buffer_load_dwordx4 v106,s[52:55],s61 offen lds
v_add_u32 v12,49152,v107
s_cmp_eq_u32 s46,1
s_cbranch_scc1 lw_19
s_cmp_eq_u32 s46,2
s_cbranch_scc1 lw_20
s_cmp_eq_u32 s46,3
s_cbranch_scc1 lw_21
lw_18:
ds_read_b64_tr_b16 a[40:41],v12 offset:0
ds_read_b64_tr_b16 a[42:43],v12 offset:768
ds_read_b64_tr_b16 a[44:45],v12 offset:12288
ds_read_b64_tr_b16 a[46:47],v12 offset:13056
ds_read_b64_tr_b16 a[48:49],v12 offset:32
ds_read_b64_tr_b16 a[50:51],v12 offset:800
ds_read_b64_tr_b16 a[52:53],v12 offset:12320
ds_read_b64_tr_b16 a[54:55],v12 offset:13088
ds_read_b64_tr_b16 a[56:57],v12 offset:64
ds_read_b64_tr_b16 a[58:59],v12 offset:832
ds_read_b64_tr_b16 a[60:61],v12 offset:12352
ds_read_b64_tr_b16 a[62:63],v12 offset:13120
s_branch ld_17
lw_19:
ds_read_b64_tr_b16 v[136:137],v12 offset:0
ds_read_b64_tr_b16 v[138:139],v12 offset:768
ds_read_b64_tr_b16 v[140:141],v12 offset:12288
ds_read_b64_tr_b16 v[142:143],v12 offset:13056
ds_read_b64_tr_b16 v[144:145],v12 offset:32
ds_read_b64_tr_b16 v[146:147],v12 offset:800
ds_read_b64_tr_b16 v[148:149],v12 offset:12320
ds_read_b64_tr_b16 v[150:151],v12 offset:13088
ds_read_b64_tr_b16 v[152:153],v12 offset:64
ds_read_b64_tr_b16 v[154:155],v12 offset:832
ds_read_b64_tr_b16 v[156:157],v12 offset:12352
ds_read_b64_tr_b16 v[158:159],v12 offset:13120
s_branch ld_17
lw_20:
ds_read_b64_tr_b16 a[200:201],v12 offset:0
ds_read_b64_tr_b16 a[202:203],v12 offset:768
ds_read_b64_tr_b16 a[204:205],v12 offset:12288
ds_read_b64_tr_b16 a[206:207],v12 offset:13056
ds_read_b64_tr_b16 a[208:209],v12 offset:32
ds_read_b64_tr_b16 a[210:211],v12 offset:800
ds_read_b64_tr_b16 a[212:213],v12 offset:12320
ds_read_b64_tr_b16 a[214:215],v12 offset:13088
ds_read_b64_tr_b16 a[216:217],v12 offset:64
ds_read_b64_tr_b16 a[218:219],v12 offset:832
ds_read_b64_tr_b16 a[220:221],v12 offset:12352
ds_read_b64_tr_b16 a[222:223],v12 offset:13120
s_branch ld_17
lw_21:
ds_read_b64_tr_b16 a[120:121],v12 offset:0
ds_read_b64_tr_b16 a[122:123],v12 offset:768
ds_read_b64_tr_b16 a[124:125],v12 offset:12288
ds_read_b64_tr_b16 a[126:127],v12 offset:13056
ds_read_b64_tr_b16 a[128:129],v12 offset:32
ds_read_b64_tr_b16 a[130:131],v12 offset:800
ds_read_b64_tr_b16 a[132:133],v12 offset:12320
ds_read_b64_tr_b16 a[134:135],v12 offset:13088
ds_read_b64_tr_b16 a[136:137],v12 offset:64
ds_read_b64_tr_b16 a[138:139],v12 offset:832
ds_read_b64_tr_b16 a[140:141],v12 offset:12352
ds_read_b64_tr_b16 a[142:143],v12 offset:13120
ld_17:
s_waitcnt lgkmcnt(0)
s_waitcnt vmcnt(24)
s_barrier
s_add_u32 s60,s75,s73
s_add_u32 m0,s77,49152
s_add_u32 s61,s60,3145728
buffer_load_dwordx4 v104,s[4:7],s61 offen lds
s_add_u32 m0,s77,50176
s_add_u32 s61,s60,3145728
buffer_load_dwordx4 v105,s[4:7],s61 offen lds
s_add_u32 m0,s77,51200
s_add_u32 s61,s60,3145728
buffer_load_dwordx4 v106,s[4:7],s61 offen lds
s_add_u32 m0,s77,52224
s_add_u32 s61,s60,3244032
buffer_load_dwordx4 v104,s[4:7],s61 offen lds
s_add_u32 m0,s77,53248
s_add_u32 s61,s60,3244032
buffer_load_dwordx4 v105,s[4:7],s61 offen lds
s_add_u32 m0,s77,54272
s_add_u32 s61,s60,3244032
buffer_load_dwordx4 v106,s[4:7],s61 offen lds
v_add_u32 v12,73728,v107
s_cmp_eq_u32 s46,1
s_cbranch_scc1 lw_24
s_cmp_eq_u32 s46,2
s_cbranch_scc1 lw_25
s_cmp_eq_u32 s46,3
s_cbranch_scc1 lw_26
lw_23:
ds_read_b64_tr_b16 a[64:65],v12 offset:0
ds_read_b64_tr_b16 a[66:67],v12 offset:768
ds_read_b64_tr_b16 a[68:69],v12 offset:12288
ds_read_b64_tr_b16 a[70:71],v12 offset:13056
ds_read_b64_tr_b16 a[72:73],v12 offset:32
ds_read_b64_tr_b16 a[74:75],v12 offset:800
ds_read_b64_tr_b16 a[76:77],v12 offset:12320
ds_read_b64_tr_b16 a[78:79],v12 offset:13088
ds_read_b64_tr_b16 v[32:33],v12 offset:64
ds_read_b64_tr_b16 v[34:35],v12 offset:832
ds_read_b64_tr_b16 v[36:37],v12 offset:12352
ds_read_b64_tr_b16 v[38:39],v12 offset:13120
s_branch ld_22
lw_24:
ds_read_b64_tr_b16 v[160:161],v12 offset:0
ds_read_b64_tr_b16 v[162:163],v12 offset:768
ds_read_b64_tr_b16 v[164:165],v12 offset:12288
ds_read_b64_tr_b16 v[166:167],v12 offset:13056
ds_read_b64_tr_b16 v[168:169],v12 offset:32
ds_read_b64_tr_b16 v[170:171],v12 offset:800
ds_read_b64_tr_b16 v[172:173],v12 offset:12320
ds_read_b64_tr_b16 v[174:175],v12 offset:13088
ds_read_b64_tr_b16 v[80:81],v12 offset:64
ds_read_b64_tr_b16 v[82:83],v12 offset:832
ds_read_b64_tr_b16 v[84:85],v12 offset:12352
ds_read_b64_tr_b16 v[86:87],v12 offset:13120
s_branch ld_22
lw_25:
ds_read_b64_tr_b16 a[224:225],v12 offset:0
ds_read_b64_tr_b16 a[226:227],v12 offset:768
ds_read_b64_tr_b16 a[228:229],v12 offset:12288
ds_read_b64_tr_b16 a[230:231],v12 offset:13056
ds_read_b64_tr_b16 a[232:233],v12 offset:32
ds_read_b64_tr_b16 a[234:235],v12 offset:800
ds_read_b64_tr_b16 a[236:237],v12 offset:12320
ds_read_b64_tr_b16 a[238:239],v12 offset:13088
ds_read_b64_tr_b16 v[64:65],v12 offset:64
ds_read_b64_tr_b16 v[66:67],v12 offset:832
ds_read_b64_tr_b16 v[68:69],v12 offset:12352
ds_read_b64_tr_b16 v[70:71],v12 offset:13120
s_branch ld_22
lw_26:
ds_read_b64_tr_b16 a[144:145],v12 offset:0
ds_read_b64_tr_b16 a[146:147],v12 offset:768
ds_read_b64_tr_b16 a[148:149],v12 offset:12288
ds_read_b64_tr_b16 a[150:151],v12 offset:13056
ds_read_b64_tr_b16 a[152:153],v12 offset:32
ds_read_b64_tr_b16 a[154:155],v12 offset:800
ds_read_b64_tr_b16 a[156:157],v12 offset:12320
ds_read_b64_tr_b16 a[158:159],v12 offset:13088
ds_read_b64_tr_b16 v[48:49],v12 offset:64
ds_read_b64_tr_b16 v[50:51],v12 offset:832
ds_read_b64_tr_b16 v[52:53],v12 offset:12352
ds_read_b64_tr_b16 v[54:55],v12 offset:13120
ld_22:
s_waitcnt lgkmcnt(0)
s_waitcnt vmcnt(24)
s_barrier
s_add_u32 s60,s75,s74
s_add_u32 m0,s77,73728
s_add_u32 s61,s60,3145728
buffer_load_dwordx4 v104,s[52:55],s61 offen lds
s_add_u32 m0,s77,74752
s_add_u32 s61,s60,3145728
buffer_load_dwordx4 v105,s[52:55],s61 offen lds
s_add_u32 m0,s77,75776
s_add_u32 s61,s60,3145728
buffer_load_dwordx4 v106,s[52:55],s61 offen lds
s_add_u32 m0,s77,76800
s_add_u32 s61,s60,3244032
buffer_load_dwordx4 v104,s[52:55],s61 offen lds
s_add_u32 m0,s77,77824
s_add_u32 s61,s60,3244032
buffer_load_dwordx4 v105,s[52:55],s61 offen lds
s_add_u32 m0,s77,78848
s_add_u32 s61,s60,3244032
buffer_load_dwordx4 v106,s[52:55],s61 offen lds
v_add_u32 v12,98304,v107
s_cmp_eq_u32 s46,1
s_cbranch_scc1 lw_29
s_cmp_eq_u32 s46,2
s_cbranch_scc1 lw_30
s_cmp_eq_u32 s46,3
s_cbranch_scc1 lw_31
lw_28:
ds_read_b64_tr_b16 a[80:81],v12 offset:0
ds_read_b64_tr_b16 a[82:83],v12 offset:768
ds_read_b64_tr_b16 a[84:85],v12 offset:12288
ds_read_b64_tr_b16 a[86:87],v12 offset:13056
ds_read_b64_tr_b16 a[88:89],v12 offset:32
ds_read_b64_tr_b16 a[90:91],v12 offset:800
ds_read_b64_tr_b16 a[92:93],v12 offset:12320
ds_read_b64_tr_b16 a[94:95],v12 offset:13088
ds_read_b64_tr_b16 a[96:97],v12 offset:64
ds_read_b64_tr_b16 a[98:99],v12 offset:832
ds_read_b64_tr_b16 a[100:101],v12 offset:12352
ds_read_b64_tr_b16 a[102:103],v12 offset:13120
s_branch ld_27
lw_29:
ds_read_b64_tr_b16 a[0:1],v12 offset:0
ds_read_b64_tr_b16 a[2:3],v12 offset:768
ds_read_b64_tr_b16 a[4:5],v12 offset:12288
ds_read_b64_tr_b16 a[6:7],v12 offset:13056
ds_read_b64_tr_b16 a[8:9],v12 offset:32
ds_read_b64_tr_b16 a[10:11],v12 offset:800
ds_read_b64_tr_b16 a[12:13],v12 offset:12320
ds_read_b64_tr_b16 a[14:15],v12 offset:13088
ds_read_b64_tr_b16 a[16:17],v12 offset:64
ds_read_b64_tr_b16 a[18:19],v12 offset:832
ds_read_b64_tr_b16 a[20:21],v12 offset:12352
ds_read_b64_tr_b16 a[22:23],v12 offset:13120
s_branch ld_27
lw_30:
ds_read_b64_tr_b16 a[240:241],v12 offset:0
ds_read_b64_tr_b16 a[242:243],v12 offset:768
ds_read_b64_tr_b16 a[244:245],v12 offset:12288
ds_read_b64_tr_b16 a[246:247],v12 offset:13056
ds_read_b64_tr_b16 a[248:249],v12 offset:32
ds_read_b64_tr_b16 a[250:251],v12 offset:800
ds_read_b64_tr_b16 a[252:253],v12 offset:12320
ds_read_b64_tr_b16 a[254:255],v12 offset:13088
ds_read_b64_tr_b16 v[112:113],v12 offset:64
ds_read_b64_tr_b16 v[114:115],v12 offset:832
ds_read_b64_tr_b16 v[116:117],v12 offset:12352
ds_read_b64_tr_b16 v[118:119],v12 offset:13120
s_branch ld_27
lw_31:
ds_read_b64_tr_b16 a[160:161],v12 offset:0
ds_read_b64_tr_b16 a[162:163],v12 offset:768
ds_read_b64_tr_b16 a[164:165],v12 offset:12288
ds_read_b64_tr_b16 a[166:167],v12 offset:13056
ds_read_b64_tr_b16 a[168:169],v12 offset:32
ds_read_b64_tr_b16 a[170:171],v12 offset:800
ds_read_b64_tr_b16 a[172:173],v12 offset:12320
ds_read_b64_tr_b16 a[174:175],v12 offset:13088
ds_read_b64_tr_b16 a[176:177],v12 offset:64
ds_read_b64_tr_b16 a[178:179],v12 offset:832
ds_read_b64_tr_b16 a[180:181],v12 offset:12352
ds_read_b64_tr_b16 a[182:183],v12 offset:13120
ld_27:
s_waitcnt lgkmcnt(0)
s_waitcnt vmcnt(24)
s_barrier
s_add_u32 s60,s75,s73
s_add_u32 m0,s77,98304
s_add_u32 s61,s60,3932160
buffer_load_dwordx4 v104,s[4:7],s61 offen lds
s_add_u32 m0,s77,99328
s_add_u32 s61,s60,3932160
buffer_load_dwordx4 v105,s[4:7],s61 offen lds
s_add_u32 m0,s77,100352
s_add_u32 s61,s60,3932160
buffer_load_dwordx4 v106,s[4:7],s61 offen lds
s_add_u32 m0,s77,101376
s_add_u32 s61,s60,4030464
buffer_load_dwordx4 v104,s[4:7],s61 offen lds
s_add_u32 m0,s77,102400
s_add_u32 s61,s60,4030464
buffer_load_dwordx4 v105,s[4:7],s61 offen lds
s_add_u32 m0,s77,103424
s_add_u32 s61,s60,4030464
buffer_load_dwordx4 v106,s[4:7],s61 offen lds
v_add_u32 v12,122880,v107
s_cmp_eq_u32 s46,1
s_cbranch_scc1 lw_34
s_cmp_eq_u32 s46,2
s_cbranch_scc1 lw_35
s_cmp_eq_u32 s46,3
s_cbranch_scc1 lw_36
lw_33:
ds_read_b64_tr_b16 a[104:105],v12 offset:0
ds_read_b64_tr_b16 a[106:107],v12 offset:768
ds_read_b64_tr_b16 a[108:109],v12 offset:12288
ds_read_b64_tr_b16 a[110:111],v12 offset:13056
ds_read_b64_tr_b16 a[112:113],v12 offset:32
ds_read_b64_tr_b16 a[114:115],v12 offset:800
ds_read_b64_tr_b16 a[116:117],v12 offset:12320
ds_read_b64_tr_b16 a[118:119],v12 offset:13088
ds_read_b64_tr_b16 v[40:41],v12 offset:64
ds_read_b64_tr_b16 v[42:43],v12 offset:832
ds_read_b64_tr_b16 v[44:45],v12 offset:12352
ds_read_b64_tr_b16 v[46:47],v12 offset:13120
s_branch ld_32
lw_34:
ds_read_b64_tr_b16 a[24:25],v12 offset:0
ds_read_b64_tr_b16 a[26:27],v12 offset:768
ds_read_b64_tr_b16 a[28:29],v12 offset:12288
ds_read_b64_tr_b16 a[30:31],v12 offset:13056
ds_read_b64_tr_b16 a[32:33],v12 offset:32
ds_read_b64_tr_b16 a[34:35],v12 offset:800
ds_read_b64_tr_b16 a[36:37],v12 offset:12320
ds_read_b64_tr_b16 a[38:39],v12 offset:13088
ds_read_b64_tr_b16 v[24:25],v12 offset:64
ds_read_b64_tr_b16 v[26:27],v12 offset:832
ds_read_b64_tr_b16 v[28:29],v12 offset:12352
ds_read_b64_tr_b16 v[30:31],v12 offset:13120
s_branch ld_32
lw_35:
ds_read_b64_tr_b16 v[120:121],v12 offset:0
ds_read_b64_tr_b16 v[122:123],v12 offset:768
ds_read_b64_tr_b16 v[124:125],v12 offset:12288
ds_read_b64_tr_b16 v[126:127],v12 offset:13056
ds_read_b64_tr_b16 v[128:129],v12 offset:32
ds_read_b64_tr_b16 v[130:131],v12 offset:800
ds_read_b64_tr_b16 v[132:133],v12 offset:12320
ds_read_b64_tr_b16 v[134:135],v12 offset:13088
ds_read_b64_tr_b16 v[72:73],v12 offset:64
ds_read_b64_tr_b16 v[74:75],v12 offset:832
ds_read_b64_tr_b16 v[76:77],v12 offset:12352
ds_read_b64_tr_b16 v[78:79],v12 offset:13120
s_branch ld_32
lw_36:
ds_read_b64_tr_b16 a[184:185],v12 offset:0
ds_read_b64_tr_b16 a[186:187],v12 offset:768
ds_read_b64_tr_b16 a[188:189],v12 offset:12288
ds_read_b64_tr_b16 a[190:191],v12 offset:13056
ds_read_b64_tr_b16 a[192:193],v12 offset:32
ds_read_b64_tr_b16 a[194:195],v12 offset:800
ds_read_b64_tr_b16 a[196:197],v12 offset:12320
ds_read_b64_tr_b16 a[198:199],v12 offset:13088
ds_read_b64_tr_b16 v[56:57],v12 offset:64
ds_read_b64_tr_b16 v[58:59],v12 offset:832
ds_read_b64_tr_b16 v[60:61],v12 offset:12352
ds_read_b64_tr_b16 v[62:63],v12 offset:13120
ld_32:
s_waitcnt lgkmcnt(0)
s_waitcnt vmcnt(24)
s_barrier
s_add_u32 s60,s75,s74
s_add_u32 m0,s77,122880
s_add_u32 s61,s60,3932160
buffer_load_dwordx4 v104,s[52:55],s61 offen lds
s_add_u32 m0,s77,123904
s_add_u32 s61,s60,3932160
buffer_load_dwordx4 v105,s[52:55],s61 offen lds
s_add_u32 m0,s77,124928
s_add_u32 s61,s60,3932160
buffer_load_dwordx4 v106,s[52:55],s61 offen lds
s_add_u32 m0,s77,125952
s_add_u32 s61,s60,4030464
buffer_load_dwordx4 v104,s[52:55],s61 offen lds
s_add_u32 m0,s77,126976
s_add_u32 s61,s60,4030464
buffer_load_dwordx4 v105,s[52:55],s61 offen lds
s_add_u32 m0,s77,128000
s_add_u32 s61,s60,4030464
buffer_load_dwordx4 v106,s[52:55],s61 offen lds
v_add_u32 v12,0,v107
s_cmp_eq_u32 s46,1
s_cbranch_scc1 lw_39
s_cmp_eq_u32 s46,2
s_cbranch_scc1 lw_40
s_cmp_eq_u32 s46,3
s_cbranch_scc1 lw_41
lw_38:
ds_read_b64_tr_b16 a[120:121],v12 offset:0
ds_read_b64_tr_b16 a[122:123],v12 offset:768
ds_read_b64_tr_b16 a[124:125],v12 offset:12288
ds_read_b64_tr_b16 a[126:127],v12 offset:13056
ds_read_b64_tr_b16 a[128:129],v12 offset:32
ds_read_b64_tr_b16 a[130:131],v12 offset:800
ds_read_b64_tr_b16 a[132:133],v12 offset:12320
ds_read_b64_tr_b16 a[134:135],v12 offset:13088
ds_read_b64_tr_b16 a[136:137],v12 offset:64
ds_read_b64_tr_b16 a[138:139],v12 offset:832
ds_read_b64_tr_b16 a[140:141],v12 offset:12352
ds_read_b64_tr_b16 a[142:143],v12 offset:13120
s_branch ld_37
lw_39:
ds_read_b64_tr_b16 a[40:41],v12 offset:0
ds_read_b64_tr_b16 a[42:43],v12 offset:768
ds_read_b64_tr_b16 a[44:45],v12 offset:12288
ds_read_b64_tr_b16 a[46:47],v12 offset:13056
ds_read_b64_tr_b16 a[48:49],v12 offset:32
ds_read_b64_tr_b16 a[50:51],v12 offset:800
ds_read_b64_tr_b16 a[52:53],v12 offset:12320
ds_read_b64_tr_b16 a[54:55],v12 offset:13088
ds_read_b64_tr_b16 a[56:57],v12 offset:64
ds_read_b64_tr_b16 a[58:59],v12 offset:832
ds_read_b64_tr_b16 a[60:61],v12 offset:12352
ds_read_b64_tr_b16 a[62:63],v12 offset:13120
s_branch ld_37
lw_40:
ds_read_b64_tr_b16 v[136:137],v12 offset:0
ds_read_b64_tr_b16 v[138:139],v12 offset:768
ds_read_b64_tr_b16 v[140:141],v12 offset:12288
ds_read_b64_tr_b16 v[142:143],v12 offset:13056
ds_read_b64_tr_b16 v[144:145],v12 offset:32
ds_read_b64_tr_b16 v[146:147],v12 offset:800
ds_read_b64_tr_b16 v[148:149],v12 offset:12320
ds_read_b64_tr_b16 v[150:151],v12 offset:13088
ds_read_b64_tr_b16 v[152:153],v12 offset:64
ds_read_b64_tr_b16 v[154:155],v12 offset:832
ds_read_b64_tr_b16 v[156:157],v12 offset:12352
ds_read_b64_tr_b16 v[158:159],v12 offset:13120
s_branch ld_37
lw_41:
ds_read_b64_tr_b16 a[200:201],v12 offset:0
ds_read_b64_tr_b16 a[202:203],v12 offset:768
ds_read_b64_tr_b16 a[204:205],v12 offset:12288
ds_read_b64_tr_b16 a[206:207],v12 offset:13056
ds_read_b64_tr_b16 a[208:209],v12 offset:32
ds_read_b64_tr_b16 a[210:211],v12 offset:800
ds_read_b64_tr_b16 a[212:213],v12 offset:12320
ds_read_b64_tr_b16 a[214:215],v12 offset:13088
ds_read_b64_tr_b16 a[216:217],v12 offset:64
ds_read_b64_tr_b16 a[218:219],v12 offset:832
ds_read_b64_tr_b16 a[220:221],v12 offset:12352
ds_read_b64_tr_b16 a[222:223],v12 offset:13120
ld_37:
s_waitcnt lgkmcnt(0)
s_waitcnt vmcnt(24)
s_barrier
s_add_u32 s60,s75,s73
s_add_u32 m0,s77,0
s_add_u32 s61,s60,4718592
buffer_load_dwordx4 v104,s[4:7],s61 offen lds
s_add_u32 m0,s77,1024
s_add_u32 s61,s60,4718592
buffer_load_dwordx4 v105,s[4:7],s61 offen lds
s_add_u32 m0,s77,2048
s_add_u32 s61,s60,4718592
buffer_load_dwordx4 v106,s[4:7],s61 offen lds
s_add_u32 m0,s77,3072
s_add_u32 s61,s60,4816896
buffer_load_dwordx4 v104,s[4:7],s61 offen lds
s_add_u32 m0,s77,4096
s_add_u32 s61,s60,4816896
buffer_load_dwordx4 v105,s[4:7],s61 offen lds
s_add_u32 m0,s77,5120
s_add_u32 s61,s60,4816896
buffer_load_dwordx4 v106,s[4:7],s61 offen lds
v_add_u32 v12,24576,v107
s_cmp_eq_u32 s46,1
s_cbranch_scc1 lw_44
s_cmp_eq_u32 s46,2
s_cbranch_scc1 lw_45
s_cmp_eq_u32 s46,3
s_cbranch_scc1 lw_46
lw_43:
ds_read_b64_tr_b16 a[144:145],v12 offset:0
ds_read_b64_tr_b16 a[146:147],v12 offset:768
ds_read_b64_tr_b16 a[148:149],v12 offset:12288
ds_read_b64_tr_b16 a[150:151],v12 offset:13056
ds_read_b64_tr_b16 a[152:153],v12 offset:32
ds_read_b64_tr_b16 a[154:155],v12 offset:800
ds_read_b64_tr_b16 a[156:157],v12 offset:12320
ds_read_b64_tr_b16 a[158:159],v12 offset:13088
ds_read_b64_tr_b16 v[48:49],v12 offset:64
ds_read_b64_tr_b16 v[50:51],v12 offset:832
ds_read_b64_tr_b16 v[52:53],v12 offset:12352
ds_read_b64_tr_b16 v[54:55],v12 offset:13120
s_branch ld_42
lw_44:
ds_read_b64_tr_b16 a[64:65],v12 offset:0
ds_read_b64_tr_b16 a[66:67],v12 offset:768
ds_read_b64_tr_b16 a[68:69],v12 offset:12288
ds_read_b64_tr_b16 a[70:71],v12 offset:13056
ds_read_b64_tr_b16 a[72:73],v12 offset:32
ds_read_b64_tr_b16 a[74:75],v12 offset:800
ds_read_b64_tr_b16 a[76:77],v12 offset:12320
ds_read_b64_tr_b16 a[78:79],v12 offset:13088
ds_read_b64_tr_b16 v[32:33],v12 offset:64
ds_read_b64_tr_b16 v[34:35],v12 offset:832
ds_read_b64_tr_b16 v[36:37],v12 offset:12352
ds_read_b64_tr_b16 v[38:39],v12 offset:13120
s_branch ld_42
lw_45:
ds_read_b64_tr_b16 v[160:161],v12 offset:0
ds_read_b64_tr_b16 v[162:163],v12 offset:768
ds_read_b64_tr_b16 v[164:165],v12 offset:12288
ds_read_b64_tr_b16 v[166:167],v12 offset:13056
ds_read_b64_tr_b16 v[168:169],v12 offset:32
ds_read_b64_tr_b16 v[170:171],v12 offset:800
ds_read_b64_tr_b16 v[172:173],v12 offset:12320
ds_read_b64_tr_b16 v[174:175],v12 offset:13088
ds_read_b64_tr_b16 v[80:81],v12 offset:64
ds_read_b64_tr_b16 v[82:83],v12 offset:832
ds_read_b64_tr_b16 v[84:85],v12 offset:12352
ds_read_b64_tr_b16 v[86:87],v12 offset:13120
s_branch ld_42
lw_46:
ds_read_b64_tr_b16 a[224:225],v12 offset:0
ds_read_b64_tr_b16 a[226:227],v12 offset:768
ds_read_b64_tr_b16 a[228:229],v12 offset:12288
ds_read_b64_tr_b16 a[230:231],v12 offset:13056
ds_read_b64_tr_b16 a[232:233],v12 offset:32
ds_read_b64_tr_b16 a[234:235],v12 offset:800
ds_read_b64_tr_b16 a[236:237],v12 offset:12320
ds_read_b64_tr_b16 a[238:239],v12 offset:13088
ds_read_b64_tr_b16 v[64:65],v12 offset:64
ds_read_b64_tr_b16 v[66:67],v12 offset:832
ds_read_b64_tr_b16 v[68:69],v12 offset:12352
ds_read_b64_tr_b16 v[70:71],v12 offset:13120
ld_42:
s_waitcnt lgkmcnt(0)
s_waitcnt vmcnt(24)
s_barrier
s_add_u32 s60,s75,s74
s_add_u32 m0,s77,24576
s_add_u32 s61,s60,4718592
buffer_load_dwordx4 v104,s[52:55],s61 offen lds
s_add_u32 m0,s77,25600
s_add_u32 s61,s60,4718592
buffer_load_dwordx4 v105,s[52:55],s61 offen lds
s_add_u32 m0,s77,26624
s_add_u32 s61,s60,4718592
buffer_load_dwordx4 v106,s[52:55],s61 offen lds
s_add_u32 m0,s77,27648
s_add_u32 s61,s60,4816896
buffer_load_dwordx4 v104,s[52:55],s61 offen lds
s_add_u32 m0,s77,28672
s_add_u32 s61,s60,4816896
buffer_load_dwordx4 v105,s[52:55],s61 offen lds
s_add_u32 m0,s77,29696
s_add_u32 s61,s60,4816896
buffer_load_dwordx4 v106,s[52:55],s61 offen lds
v_add_u32 v12,49152,v107
s_cmp_eq_u32 s46,1
s_cbranch_scc1 lw_49
s_cmp_eq_u32 s46,2
s_cbranch_scc1 lw_50
s_cmp_eq_u32 s46,3
s_cbranch_scc1 lw_51
lw_48:
ds_read_b64_tr_b16 a[160:161],v12 offset:0
ds_read_b64_tr_b16 a[162:163],v12 offset:768
ds_read_b64_tr_b16 a[164:165],v12 offset:12288
ds_read_b64_tr_b16 a[166:167],v12 offset:13056
ds_read_b64_tr_b16 a[168:169],v12 offset:32
ds_read_b64_tr_b16 a[170:171],v12 offset:800
ds_read_b64_tr_b16 a[172:173],v12 offset:12320
ds_read_b64_tr_b16 a[174:175],v12 offset:13088
ds_read_b64_tr_b16 a[176:177],v12 offset:64
ds_read_b64_tr_b16 a[178:179],v12 offset:832
ds_read_b64_tr_b16 a[180:181],v12 offset:12352
ds_read_b64_tr_b16 a[182:183],v12 offset:13120
s_branch ld_47
lw_49:
ds_read_b64_tr_b16 a[80:81],v12 offset:0
ds_read_b64_tr_b16 a[82:83],v12 offset:768
ds_read_b64_tr_b16 a[84:85],v12 offset:12288
ds_read_b64_tr_b16 a[86:87],v12 offset:13056
ds_read_b64_tr_b16 a[88:89],v12 offset:32
ds_read_b64_tr_b16 a[90:91],v12 offset:800
ds_read_b64_tr_b16 a[92:93],v12 offset:12320
ds_read_b64_tr_b16 a[94:95],v12 offset:13088
ds_read_b64_tr_b16 a[96:97],v12 offset:64
ds_read_b64_tr_b16 a[98:99],v12 offset:832
ds_read_b64_tr_b16 a[100:101],v12 offset:12352
ds_read_b64_tr_b16 a[102:103],v12 offset:13120
s_branch ld_47
lw_50:
ds_read_b64_tr_b16 a[0:1],v12 offset:0
ds_read_b64_tr_b16 a[2:3],v12 offset:768
ds_read_b64_tr_b16 a[4:5],v12 offset:12288
ds_read_b64_tr_b16 a[6:7],v12 offset:13056
ds_read_b64_tr_b16 a[8:9],v12 offset:32
ds_read_b64_tr_b16 a[10:11],v12 offset:800
ds_read_b64_tr_b16 a[12:13],v12 offset:12320
ds_read_b64_tr_b16 a[14:15],v12 offset:13088
ds_read_b64_tr_b16 a[16:17],v12 offset:64
ds_read_b64_tr_b16 a[18:19],v12 offset:832
ds_read_b64_tr_b16 a[20:21],v12 offset:12352
ds_read_b64_tr_b16 a[22:23],v12 offset:13120
s_branch ld_47
lw_51:
ds_read_b64_tr_b16 a[240:241],v12 offset:0
ds_read_b64_tr_b16 a[242:243],v12 offset:768
ds_read_b64_tr_b16 a[244:245],v12 offset:12288
ds_read_b64_tr_b16 a[246:247],v12 offset:13056
ds_read_b64_tr_b16 a[248:249],v12 offset:32
ds_read_b64_tr_b16 a[250:251],v12 offset:800
ds_read_b64_tr_b16 a[252:253],v12 offset:12320
ds_read_b64_tr_b16 a[254:255],v12 offset:13088
ds_read_b64_tr_b16 v[112:113],v12 offset:64
ds_read_b64_tr_b16 v[114:115],v12 offset:832
ds_read_b64_tr_b16 v[116:117],v12 offset:12352
ds_read_b64_tr_b16 v[118:119],v12 offset:13120
ld_47:
s_waitcnt lgkmcnt(0)
s_waitcnt vmcnt(24)
s_barrier
s_add_u32 s60,s75,s73
s_add_u32 m0,s77,49152
s_add_u32 s61,s60,5505024
buffer_load_dwordx4 v104,s[4:7],s61 offen lds
s_add_u32 m0,s77,50176
s_add_u32 s61,s60,5505024
buffer_load_dwordx4 v105,s[4:7],s61 offen lds
s_add_u32 m0,s77,51200
s_add_u32 s61,s60,5505024
buffer_load_dwordx4 v106,s[4:7],s61 offen lds
s_add_u32 m0,s77,52224
s_add_u32 s61,s60,5603328
buffer_load_dwordx4 v104,s[4:7],s61 offen lds
s_add_u32 m0,s77,53248
s_add_u32 s61,s60,5603328
buffer_load_dwordx4 v105,s[4:7],s61 offen lds
s_add_u32 m0,s77,54272
s_add_u32 s61,s60,5603328
buffer_load_dwordx4 v106,s[4:7],s61 offen lds
v_add_u32 v12,73728,v107
s_cmp_eq_u32 s46,1
s_cbranch_scc1 lw_54
s_cmp_eq_u32 s46,2
s_cbranch_scc1 lw_55
s_cmp_eq_u32 s46,3
s_cbranch_scc1 lw_56
lw_53:
ds_read_b64_tr_b16 a[184:185],v12 offset:0
ds_read_b64_tr_b16 a[186:187],v12 offset:768
ds_read_b64_tr_b16 a[188:189],v12 offset:12288
ds_read_b64_tr_b16 a[190:191],v12 offset:13056
ds_read_b64_tr_b16 a[192:193],v12 offset:32
ds_read_b64_tr_b16 a[194:195],v12 offset:800
ds_read_b64_tr_b16 a[196:197],v12 offset:12320
ds_read_b64_tr_b16 a[198:199],v12 offset:13088
ds_read_b64_tr_b16 v[56:57],v12 offset:64
ds_read_b64_tr_b16 v[58:59],v12 offset:832
ds_read_b64_tr_b16 v[60:61],v12 offset:12352
ds_read_b64_tr_b16 v[62:63],v12 offset:13120
s_branch ld_52
lw_54:
ds_read_b64_tr_b16 a[104:105],v12 offset:0
ds_read_b64_tr_b16 a[106:107],v12 offset:768
ds_read_b64_tr_b16 a[108:109],v12 offset:12288
ds_read_b64_tr_b16 a[110:111],v12 offset:13056
ds_read_b64_tr_b16 a[112:113],v12 offset:32
ds_read_b64_tr_b16 a[114:115],v12 offset:800
ds_read_b64_tr_b16 a[116:117],v12 offset:12320
ds_read_b64_tr_b16 a[118:119],v12 offset:13088
ds_read_b64_tr_b16 v[40:41],v12 offset:64
ds_read_b64_tr_b16 v[42:43],v12 offset:832
ds_read_b64_tr_b16 v[44:45],v12 offset:12352
ds_read_b64_tr_b16 v[46:47],v12 offset:13120
s_branch ld_52
lw_55:
ds_read_b64_tr_b16 a[24:25],v12 offset:0
ds_read_b64_tr_b16 a[26:27],v12 offset:768
ds_read_b64_tr_b16 a[28:29],v12 offset:12288
ds_read_b64_tr_b16 a[30:31],v12 offset:13056
ds_read_b64_tr_b16 a[32:33],v12 offset:32
ds_read_b64_tr_b16 a[34:35],v12 offset:800
ds_read_b64_tr_b16 a[36:37],v12 offset:12320
ds_read_b64_tr_b16 a[38:39],v12 offset:13088
ds_read_b64_tr_b16 v[24:25],v12 offset:64
ds_read_b64_tr_b16 v[26:27],v12 offset:832
ds_read_b64_tr_b16 v[28:29],v12 offset:12352
ds_read_b64_tr_b16 v[30:31],v12 offset:13120
s_branch ld_52
lw_56:
ds_read_b64_tr_b16 v[120:121],v12 offset:0
ds_read_b64_tr_b16 v[122:123],v12 offset:768
ds_read_b64_tr_b16 v[124:125],v12 offset:12288
ds_read_b64_tr_b16 v[126:127],v12 offset:13056
ds_read_b64_tr_b16 v[128:129],v12 offset:32
ds_read_b64_tr_b16 v[130:131],v12 offset:800
ds_read_b64_tr_b16 v[132:133],v12 offset:12320
ds_read_b64_tr_b16 v[134:135],v12 offset:13088
ds_read_b64_tr_b16 v[72:73],v12 offset:64
ds_read_b64_tr_b16 v[74:75],v12 offset:832
ds_read_b64_tr_b16 v[76:77],v12 offset:12352
ds_read_b64_tr_b16 v[78:79],v12 offset:13120
ld_52:
s_waitcnt lgkmcnt(0)
s_waitcnt vmcnt(24)
s_barrier
s_add_u32 s60,s75,s74
s_add_u32 m0,s77,73728
s_add_u32 s61,s60,5505024
buffer_load_dwordx4 v104,s[52:55],s61 offen lds
s_add_u32 m0,s77,74752
s_add_u32 s61,s60,5505024
buffer_load_dwordx4 v105,s[52:55],s61 offen lds
s_add_u32 m0,s77,75776
s_add_u32 s61,s60,5505024
buffer_load_dwordx4 v106,s[52:55],s61 offen lds
s_add_u32 m0,s77,76800
s_add_u32 s61,s60,5603328
buffer_load_dwordx4 v104,s[52:55],s61 offen lds
s_add_u32 m0,s77,77824
s_add_u32 s61,s60,5603328
buffer_load_dwordx4 v105,s[52:55],s61 offen lds
s_add_u32 m0,s77,78848
s_add_u32 s61,s60,5603328
buffer_load_dwordx4 v106,s[52:55],s61 offen lds
v_add_u32 v12,98304,v107
s_cmp_eq_u32 s46,1
s_cbranch_scc1 lw_59
s_cmp_eq_u32 s46,2
s_cbranch_scc1 lw_60
s_cmp_eq_u32 s46,3
s_cbranch_scc1 lw_61
lw_58:
ds_read_b64_tr_b16 a[200:201],v12 offset:0
ds_read_b64_tr_b16 a[202:203],v12 offset:768
ds_read_b64_tr_b16 a[204:205],v12 offset:12288
ds_read_b64_tr_b16 a[206:207],v12 offset:13056
ds_read_b64_tr_b16 a[208:209],v12 offset:32
ds_read_b64_tr_b16 a[210:211],v12 offset:800
ds_read_b64_tr_b16 a[212:213],v12 offset:12320
ds_read_b64_tr_b16 a[214:215],v12 offset:13088
ds_read_b64_tr_b16 a[216:217],v12 offset:64
ds_read_b64_tr_b16 a[218:219],v12 offset:832
ds_read_b64_tr_b16 a[220:221],v12 offset:12352
ds_read_b64_tr_b16 a[222:223],v12 offset:13120
s_branch ld_57
lw_59:
ds_read_b64_tr_b16 a[120:121],v12 offset:0
ds_read_b64_tr_b16 a[122:123],v12 offset:768
ds_read_b64_tr_b16 a[124:125],v12 offset:12288
ds_read_b64_tr_b16 a[126:127],v12 offset:13056
ds_read_b64_tr_b16 a[128:129],v12 offset:32
ds_read_b64_tr_b16 a[130:131],v12 offset:800
ds_read_b64_tr_b16 a[132:133],v12 offset:12320
ds_read_b64_tr_b16 a[134:135],v12 offset:13088
ds_read_b64_tr_b16 a[136:137],v12 offset:64
ds_read_b64_tr_b16 a[138:139],v12 offset:832
ds_read_b64_tr_b16 a[140:141],v12 offset:12352
ds_read_b64_tr_b16 a[142:143],v12 offset:13120
s_branch ld_57
lw_60:
ds_read_b64_tr_b16 a[40:41],v12 offset:0
ds_read_b64_tr_b16 a[42:43],v12 offset:768
ds_read_b64_tr_b16 a[44:45],v12 offset:12288
ds_read_b64_tr_b16 a[46:47],v12 offset:13056
ds_read_b64_tr_b16 a[48:49],v12 offset:32
ds_read_b64_tr_b16 a[50:51],v12 offset:800
ds_read_b64_tr_b16 a[52:53],v12 offset:12320
ds_read_b64_tr_b16 a[54:55],v12 offset:13088
ds_read_b64_tr_b16 a[56:57],v12 offset:64
ds_read_b64_tr_b16 a[58:59],v12 offset:832
ds_read_b64_tr_b16 a[60:61],v12 offset:12352
ds_read_b64_tr_b16 a[62:63],v12 offset:13120
s_branch ld_57
lw_61:
ds_read_b64_tr_b16 v[136:137],v12 offset:0
ds_read_b64_tr_b16 v[138:139],v12 offset:768
ds_read_b64_tr_b16 v[140:141],v12 offset:12288
ds_read_b64_tr_b16 v[142:143],v12 offset:13056
ds_read_b64_tr_b16 v[144:145],v12 offset:32
ds_read_b64_tr_b16 v[146:147],v12 offset:800
ds_read_b64_tr_b16 v[148:149],v12 offset:12320
ds_read_b64_tr_b16 v[150:151],v12 offset:13088
ds_read_b64_tr_b16 v[152:153],v12 offset:64
ds_read_b64_tr_b16 v[154:155],v12 offset:832
ds_read_b64_tr_b16 v[156:157],v12 offset:12352
ds_read_b64_tr_b16 v[158:159],v12 offset:13120
ld_57:
s_waitcnt lgkmcnt(0)
s_waitcnt vmcnt(24)
s_barrier
s_add_u32 s60,s76,s73
s_add_u32 m0,s77,98304
s_add_u32 s61,s60,6291456
buffer_load_dwordx4 v104,s[4:7],s61 offen lds
s_add_u32 m0,s77,99328
s_add_u32 s61,s60,6291456
buffer_load_dwordx4 v105,s[4:7],s61 offen lds
s_add_u32 m0,s77,100352
s_add_u32 s61,s60,6291456
buffer_load_dwordx4 v106,s[4:7],s61 offen lds
s_add_u32 m0,s77,101376
s_add_u32 s61,s60,6389760
buffer_load_dwordx4 v104,s[4:7],s61 offen lds
s_add_u32 m0,s77,102400
s_add_u32 s61,s60,6389760
buffer_load_dwordx4 v105,s[4:7],s61 offen lds
s_add_u32 m0,s77,103424
s_add_u32 s61,s60,6389760
buffer_load_dwordx4 v106,s[4:7],s61 offen lds
v_add_u32 v12,122880,v107
s_cmp_eq_u32 s46,1
s_cbranch_scc1 lw_64
s_cmp_eq_u32 s46,2
s_cbranch_scc1 lw_65
s_cmp_eq_u32 s46,3
s_cbranch_scc1 lw_66
lw_63:
ds_read_b64_tr_b16 a[224:225],v12 offset:0
ds_read_b64_tr_b16 a[226:227],v12 offset:768
ds_read_b64_tr_b16 a[228:229],v12 offset:12288
ds_read_b64_tr_b16 a[230:231],v12 offset:13056
ds_read_b64_tr_b16 a[232:233],v12 offset:32
ds_read_b64_tr_b16 a[234:235],v12 offset:800
ds_read_b64_tr_b16 a[236:237],v12 offset:12320
ds_read_b64_tr_b16 a[238:239],v12 offset:13088
ds_read_b64_tr_b16 v[64:65],v12 offset:64
ds_read_b64_tr_b16 v[66:67],v12 offset:832
ds_read_b64_tr_b16 v[68:69],v12 offset:12352
ds_read_b64_tr_b16 v[70:71],v12 offset:13120
s_branch ld_62
lw_64:
ds_read_b64_tr_b16 a[144:145],v12 offset:0
ds_read_b64_tr_b16 a[146:147],v12 offset:768
ds_read_b64_tr_b16 a[148:149],v12 offset:12288
ds_read_b64_tr_b16 a[150:151],v12 offset:13056
ds_read_b64_tr_b16 a[152:153],v12 offset:32
ds_read_b64_tr_b16 a[154:155],v12 offset:800
ds_read_b64_tr_b16 a[156:157],v12 offset:12320
ds_read_b64_tr_b16 a[158:159],v12 offset:13088
ds_read_b64_tr_b16 v[48:49],v12 offset:64
ds_read_b64_tr_b16 v[50:51],v12 offset:832
ds_read_b64_tr_b16 v[52:53],v12 offset:12352
ds_read_b64_tr_b16 v[54:55],v12 offset:13120
s_branch ld_62
lw_65:
ds_read_b64_tr_b16 a[64:65],v12 offset:0
ds_read_b64_tr_b16 a[66:67],v12 offset:768
ds_read_b64_tr_b16 a[68:69],v12 offset:12288
ds_read_b64_tr_b16 a[70:71],v12 offset:13056
ds_read_b64_tr_b16 a[72:73],v12 offset:32
ds_read_b64_tr_b16 a[74:75],v12 offset:800
ds_read_b64_tr_b16 a[76:77],v12 offset:12320
ds_read_b64_tr_b16 a[78:79],v12 offset:13088
ds_read_b64_tr_b16 v[32:33],v12 offset:64
ds_read_b64_tr_b16 v[34:35],v12 offset:832
ds_read_b64_tr_b16 v[36:37],v12 offset:12352
ds_read_b64_tr_b16 v[38:39],v12 offset:13120
s_branch ld_62
lw_66:
ds_read_b64_tr_b16 v[160:161],v12 offset:0
ds_read_b64_tr_b16 v[162:163],v12 offset:768
ds_read_b64_tr_b16 v[164:165],v12 offset:12288
ds_read_b64_tr_b16 v[166:167],v12 offset:13056
ds_read_b64_tr_b16 v[168:169],v12 offset:32
ds_read_b64_tr_b16 v[170:171],v12 offset:800
ds_read_b64_tr_b16 v[172:173],v12 offset:12320
ds_read_b64_tr_b16 v[174:175],v12 offset:13088
ds_read_b64_tr_b16 v[80:81],v12 offset:64
ds_read_b64_tr_b16 v[82:83],v12 offset:832
ds_read_b64_tr_b16 v[84:85],v12 offset:12352
ds_read_b64_tr_b16 v[86:87],v12 offset:13120
ld_62:
s_waitcnt lgkmcnt(0)
s_waitcnt vmcnt(24)
s_barrier
s_add_u32 s60,s76,s74
s_add_u32 m0,s77,122880
s_add_u32 s61,s60,6291456
buffer_load_dwordx4 v104,s[52:55],s61 offen lds
s_add_u32 m0,s77,123904
s_add_u32 s61,s60,6291456
buffer_load_dwordx4 v105,s[52:55],s61 offen lds
s_add_u32 m0,s77,124928
s_add_u32 s61,s60,6291456
buffer_load_dwordx4 v106,s[52:55],s61 offen lds
s_add_u32 m0,s77,125952
s_add_u32 s61,s60,6389760
buffer_load_dwordx4 v104,s[52:55],s61 offen lds
s_add_u32 m0,s77,126976
s_add_u32 s61,s60,6389760
buffer_load_dwordx4 v105,s[52:55],s61 offen lds
s_add_u32 m0,s77,128000
s_add_u32 s61,s60,6389760
buffer_load_dwordx4 v106,s[52:55],s61 offen lds
v_add_u32 v12,0,v107
s_cmp_eq_u32 s46,1
s_cbranch_scc1 lw_69
s_cmp_eq_u32 s46,2
s_cbranch_scc1 lw_70
s_cmp_eq_u32 s46,3
s_cbranch_scc1 lw_71
lw_68:
ds_read_b64_tr_b16 a[240:241],v12 offset:0
ds_read_b64_tr_b16 a[242:243],v12 offset:768
ds_read_b64_tr_b16 a[244:245],v12 offset:12288
ds_read_b64_tr_b16 a[246:247],v12 offset:13056
ds_read_b64_tr_b16 a[248:249],v12 offset:32
ds_read_b64_tr_b16 a[250:251],v12 offset:800
ds_read_b64_tr_b16 a[252:253],v12 offset:12320
ds_read_b64_tr_b16 a[254:255],v12 offset:13088
ds_read_b64_tr_b16 v[112:113],v12 offset:64
ds_read_b64_tr_b16 v[114:115],v12 offset:832
ds_read_b64_tr_b16 v[116:117],v12 offset:12352
ds_read_b64_tr_b16 v[118:119],v12 offset:13120
s_branch ld_67
lw_69:
ds_read_b64_tr_b16 a[160:161],v12 offset:0
ds_read_b64_tr_b16 a[162:163],v12 offset:768
ds_read_b64_tr_b16 a[164:165],v12 offset:12288
ds_read_b64_tr_b16 a[166:167],v12 offset:13056
ds_read_b64_tr_b16 a[168:169],v12 offset:32
ds_read_b64_tr_b16 a[170:171],v12 offset:800
ds_read_b64_tr_b16 a[172:173],v12 offset:12320
ds_read_b64_tr_b16 a[174:175],v12 offset:13088
ds_read_b64_tr_b16 a[176:177],v12 offset:64
ds_read_b64_tr_b16 a[178:179],v12 offset:832
ds_read_b64_tr_b16 a[180:181],v12 offset:12352
ds_read_b64_tr_b16 a[182:183],v12 offset:13120
s_branch ld_67
lw_70:
ds_read_b64_tr_b16 a[80:81],v12 offset:0
ds_read_b64_tr_b16 a[82:83],v12 offset:768
ds_read_b64_tr_b16 a[84:85],v12 offset:12288
ds_read_b64_tr_b16 a[86:87],v12 offset:13056
ds_read_b64_tr_b16 a[88:89],v12 offset:32
ds_read_b64_tr_b16 a[90:91],v12 offset:800
ds_read_b64_tr_b16 a[92:93],v12 offset:12320
ds_read_b64_tr_b16 a[94:95],v12 offset:13088
ds_read_b64_tr_b16 a[96:97],v12 offset:64
ds_read_b64_tr_b16 a[98:99],v12 offset:832
ds_read_b64_tr_b16 a[100:101],v12 offset:12352
ds_read_b64_tr_b16 a[102:103],v12 offset:13120
s_branch ld_67
lw_71:
ds_read_b64_tr_b16 a[0:1],v12 offset:0
ds_read_b64_tr_b16 a[2:3],v12 offset:768
ds_read_b64_tr_b16 a[4:5],v12 offset:12288
ds_read_b64_tr_b16 a[6:7],v12 offset:13056
ds_read_b64_tr_b16 a[8:9],v12 offset:32
ds_read_b64_tr_b16 a[10:11],v12 offset:800
ds_read_b64_tr_b16 a[12:13],v12 offset:12320
ds_read_b64_tr_b16 a[14:15],v12 offset:13088
ds_read_b64_tr_b16 a[16:17],v12 offset:64
ds_read_b64_tr_b16 a[18:19],v12 offset:832
ds_read_b64_tr_b16 a[20:21],v12 offset:12352
ds_read_b64_tr_b16 a[22:23],v12 offset:13120
ld_67:
s_waitcnt lgkmcnt(0)
s_waitcnt vmcnt(24)
s_barrier
s_add_u32 s60,s76,s73
s_add_u32 m0,s77,0
s_add_u32 s61,s60,7077888
buffer_load_dwordx4 v104,s[4:7],s61 offen lds
s_add_u32 m0,s77,1024
s_add_u32 s61,s60,7077888
buffer_load_dwordx4 v105,s[4:7],s61 offen lds
s_add_u32 m0,s77,2048
s_add_u32 s61,s60,7077888
buffer_load_dwordx4 v106,s[4:7],s61 offen lds
s_add_u32 m0,s77,3072
s_add_u32 s61,s60,7176192
buffer_load_dwordx4 v104,s[4:7],s61 offen lds
s_add_u32 m0,s77,4096
s_add_u32 s61,s60,7176192
buffer_load_dwordx4 v105,s[4:7],s61 offen lds
s_add_u32 m0,s77,5120
s_add_u32 s61,s60,7176192
buffer_load_dwordx4 v106,s[4:7],s61 offen lds
v_add_u32 v12,24576,v107
s_cmp_eq_u32 s46,1
s_cbranch_scc1 lw_74
s_cmp_eq_u32 s46,2
s_cbranch_scc1 lw_75
s_cmp_eq_u32 s46,3
s_cbranch_scc1 lw_76
lw_73:
ds_read_b64_tr_b16 v[120:121],v12 offset:0
ds_read_b64_tr_b16 v[122:123],v12 offset:768
ds_read_b64_tr_b16 v[124:125],v12 offset:12288
ds_read_b64_tr_b16 v[126:127],v12 offset:13056
ds_read_b64_tr_b16 v[128:129],v12 offset:32
ds_read_b64_tr_b16 v[130:131],v12 offset:800
ds_read_b64_tr_b16 v[132:133],v12 offset:12320
ds_read_b64_tr_b16 v[134:135],v12 offset:13088
ds_read_b64_tr_b16 v[72:73],v12 offset:64
ds_read_b64_tr_b16 v[74:75],v12 offset:832
ds_read_b64_tr_b16 v[76:77],v12 offset:12352
ds_read_b64_tr_b16 v[78:79],v12 offset:13120
s_branch ld_72
lw_74:
ds_read_b64_tr_b16 a[184:185],v12 offset:0
ds_read_b64_tr_b16 a[186:187],v12 offset:768
ds_read_b64_tr_b16 a[188:189],v12 offset:12288
ds_read_b64_tr_b16 a[190:191],v12 offset:13056
ds_read_b64_tr_b16 a[192:193],v12 offset:32
ds_read_b64_tr_b16 a[194:195],v12 offset:800
ds_read_b64_tr_b16 a[196:197],v12 offset:12320
ds_read_b64_tr_b16 a[198:199],v12 offset:13088
ds_read_b64_tr_b16 v[56:57],v12 offset:64
ds_read_b64_tr_b16 v[58:59],v12 offset:832
ds_read_b64_tr_b16 v[60:61],v12 offset:12352
ds_read_b64_tr_b16 v[62:63],v12 offset:13120
s_branch ld_72
lw_75:
ds_read_b64_tr_b16 a[104:105],v12 offset:0
ds_read_b64_tr_b16 a[106:107],v12 offset:768
ds_read_b64_tr_b16 a[108:109],v12 offset:12288
ds_read_b64_tr_b16 a[110:111],v12 offset:13056
ds_read_b64_tr_b16 a[112:113],v12 offset:32
ds_read_b64_tr_b16 a[114:115],v12 offset:800
ds_read_b64_tr_b16 a[116:117],v12 offset:12320
ds_read_b64_tr_b16 a[118:119],v12 offset:13088
ds_read_b64_tr_b16 v[40:41],v12 offset:64
ds_read_b64_tr_b16 v[42:43],v12 offset:832
ds_read_b64_tr_b16 v[44:45],v12 offset:12352
ds_read_b64_tr_b16 v[46:47],v12 offset:13120
s_branch ld_72
lw_76:
ds_read_b64_tr_b16 a[24:25],v12 offset:0
ds_read_b64_tr_b16 a[26:27],v12 offset:768
ds_read_b64_tr_b16 a[28:29],v12 offset:12288
ds_read_b64_tr_b16 a[30:31],v12 offset:13056
ds_read_b64_tr_b16 a[32:33],v12 offset:32
ds_read_b64_tr_b16 a[34:35],v12 offset:800
ds_read_b64_tr_b16 a[36:37],v12 offset:12320
ds_read_b64_tr_b16 a[38:39],v12 offset:13088
ds_read_b64_tr_b16 v[24:25],v12 offset:64
ds_read_b64_tr_b16 v[26:27],v12 offset:832
ds_read_b64_tr_b16 v[28:29],v12 offset:12352
ds_read_b64_tr_b16 v[30:31],v12 offset:13120
ld_72:
s_waitcnt lgkmcnt(0)
s_waitcnt vmcnt(24)
s_barrier
s_add_u32 s60,s76,s74
s_add_u32 m0,s77,24576
s_add_u32 s61,s60,7077888
buffer_load_dwordx4 v104,s[52:55],s61 offen lds
s_add_u32 m0,s77,25600
s_add_u32 s61,s60,7077888
buffer_load_dwordx4 v105,s[52:55],s61 offen lds
s_add_u32 m0,s77,26624
s_add_u32 s61,s60,7077888
buffer_load_dwordx4 v106,s[52:55],s61 offen lds
s_add_u32 m0,s77,27648
s_add_u32 s61,s60,7176192
buffer_load_dwordx4 v104,s[52:55],s61 offen lds
s_add_u32 m0,s77,28672
s_add_u32 s61,s60,7176192
buffer_load_dwordx4 v105,s[52:55],s61 offen lds
s_add_u32 m0,s77,29696
s_add_u32 s61,s60,7176192
buffer_load_dwordx4 v106,s[52:55],s61 offen lds
v_add_u32 v12,49152,v107
s_cmp_eq_u32 s46,1
s_cbranch_scc1 lw_79
s_cmp_eq_u32 s46,2
s_cbranch_scc1 lw_80
s_cmp_eq_u32 s46,3
s_cbranch_scc1 lw_81
lw_78:
ds_read_b64_tr_b16 v[136:137],v12 offset:0
ds_read_b64_tr_b16 v[138:139],v12 offset:768
ds_read_b64_tr_b16 v[140:141],v12 offset:12288
ds_read_b64_tr_b16 v[142:143],v12 offset:13056
ds_read_b64_tr_b16 v[144:145],v12 offset:32
ds_read_b64_tr_b16 v[146:147],v12 offset:800
ds_read_b64_tr_b16 v[148:149],v12 offset:12320
ds_read_b64_tr_b16 v[150:151],v12 offset:13088
ds_read_b64_tr_b16 v[152:153],v12 offset:64
ds_read_b64_tr_b16 v[154:155],v12 offset:832
ds_read_b64_tr_b16 v[156:157],v12 offset:12352
ds_read_b64_tr_b16 v[158:159],v12 offset:13120
s_branch ld_77
lw_79:
ds_read_b64_tr_b16 a[200:201],v12 offset:0
ds_read_b64_tr_b16 a[202:203],v12 offset:768
ds_read_b64_tr_b16 a[204:205],v12 offset:12288
ds_read_b64_tr_b16 a[206:207],v12 offset:13056
ds_read_b64_tr_b16 a[208:209],v12 offset:32
ds_read_b64_tr_b16 a[210:211],v12 offset:800
ds_read_b64_tr_b16 a[212:213],v12 offset:12320
ds_read_b64_tr_b16 a[214:215],v12 offset:13088
ds_read_b64_tr_b16 a[216:217],v12 offset:64
ds_read_b64_tr_b16 a[218:219],v12 offset:832
ds_read_b64_tr_b16 a[220:221],v12 offset:12352
ds_read_b64_tr_b16 a[222:223],v12 offset:13120
s_branch ld_77
lw_80:
ds_read_b64_tr_b16 a[120:121],v12 offset:0
ds_read_b64_tr_b16 a[122:123],v12 offset:768
ds_read_b64_tr_b16 a[124:125],v12 offset:12288
ds_read_b64_tr_b16 a[126:127],v12 offset:13056
ds_read_b64_tr_b16 a[128:129],v12 offset:32
ds_read_b64_tr_b16 a[130:131],v12 offset:800
ds_read_b64_tr_b16 a[132:133],v12 offset:12320
ds_read_b64_tr_b16 a[134:135],v12 offset:13088
ds_read_b64_tr_b16 a[136:137],v12 offset:64
ds_read_b64_tr_b16 a[138:139],v12 offset:832
ds_read_b64_tr_b16 a[140:141],v12 offset:12352
ds_read_b64_tr_b16 a[142:143],v12 offset:13120
s_branch ld_77
lw_81:
ds_read_b64_tr_b16 a[40:41],v12 offset:0
ds_read_b64_tr_b16 a[42:43],v12 offset:768
ds_read_b64_tr_b16 a[44:45],v12 offset:12288
ds_read_b64_tr_b16 a[46:47],v12 offset:13056
ds_read_b64_tr_b16 a[48:49],v12 offset:32
ds_read_b64_tr_b16 a[50:51],v12 offset:800
ds_read_b64_tr_b16 a[52:53],v12 offset:12320
ds_read_b64_tr_b16 a[54:55],v12 offset:13088
ds_read_b64_tr_b16 a[56:57],v12 offset:64
ds_read_b64_tr_b16 a[58:59],v12 offset:832
ds_read_b64_tr_b16 a[60:61],v12 offset:12352
ds_read_b64_tr_b16 a[62:63],v12 offset:13120
ld_77:
s_waitcnt lgkmcnt(0)
s_waitcnt vmcnt(24)
s_barrier
v_add_u32 v12,73728,v107
s_cmp_eq_u32 s46,1
s_cbranch_scc1 lw_84
s_cmp_eq_u32 s46,2
s_cbranch_scc1 lw_85
s_cmp_eq_u32 s46,3
s_cbranch_scc1 lw_86
lw_83:
ds_read_b64_tr_b16 v[160:161],v12 offset:0
ds_read_b64_tr_b16 v[162:163],v12 offset:768
ds_read_b64_tr_b16 v[164:165],v12 offset:12288
ds_read_b64_tr_b16 v[166:167],v12 offset:13056
ds_read_b64_tr_b16 v[168:169],v12 offset:32
ds_read_b64_tr_b16 v[170:171],v12 offset:800
ds_read_b64_tr_b16 v[172:173],v12 offset:12320
ds_read_b64_tr_b16 v[174:175],v12 offset:13088
ds_read_b64_tr_b16 v[80:81],v12 offset:64
ds_read_b64_tr_b16 v[82:83],v12 offset:832
ds_read_b64_tr_b16 v[84:85],v12 offset:12352
ds_read_b64_tr_b16 v[86:87],v12 offset:13120
s_branch ld_82
lw_84:
ds_read_b64_tr_b16 a[224:225],v12 offset:0
ds_read_b64_tr_b16 a[226:227],v12 offset:768
ds_read_b64_tr_b16 a[228:229],v12 offset:12288
ds_read_b64_tr_b16 a[230:231],v12 offset:13056
ds_read_b64_tr_b16 a[232:233],v12 offset:32
ds_read_b64_tr_b16 a[234:235],v12 offset:800
ds_read_b64_tr_b16 a[236:237],v12 offset:12320
ds_read_b64_tr_b16 a[238:239],v12 offset:13088
ds_read_b64_tr_b16 v[64:65],v12 offset:64
ds_read_b64_tr_b16 v[66:67],v12 offset:832
ds_read_b64_tr_b16 v[68:69],v12 offset:12352
ds_read_b64_tr_b16 v[70:71],v12 offset:13120
s_branch ld_82
lw_85:
ds_read_b64_tr_b16 a[144:145],v12 offset:0
ds_read_b64_tr_b16 a[146:147],v12 offset:768
ds_read_b64_tr_b16 a[148:149],v12 offset:12288
ds_read_b64_tr_b16 a[150:151],v12 offset:13056
ds_read_b64_tr_b16 a[152:153],v12 offset:32
ds_read_b64_tr_b16 a[154:155],v12 offset:800
ds_read_b64_tr_b16 a[156:157],v12 offset:12320
ds_read_b64_tr_b16 a[158:159],v12 offset:13088
ds_read_b64_tr_b16 v[48:49],v12 offset:64
ds_read_b64_tr_b16 v[50:51],v12 offset:832
ds_read_b64_tr_b16 v[52:53],v12 offset:12352
ds_read_b64_tr_b16 v[54:55],v12 offset:13120
s_branch ld_82
lw_86:
ds_read_b64_tr_b16 a[64:65],v12 offset:0
ds_read_b64_tr_b16 a[66:67],v12 offset:768
ds_read_b64_tr_b16 a[68:69],v12 offset:12288
ds_read_b64_tr_b16 a[70:71],v12 offset:13056
ds_read_b64_tr_b16 a[72:73],v12 offset:32
ds_read_b64_tr_b16 a[74:75],v12 offset:800
ds_read_b64_tr_b16 a[76:77],v12 offset:12320
ds_read_b64_tr_b16 a[78:79],v12 offset:13088
ds_read_b64_tr_b16 v[32:33],v12 offset:64
ds_read_b64_tr_b16 v[34:35],v12 offset:832
ds_read_b64_tr_b16 v[36:37],v12 offset:12352
ds_read_b64_tr_b16 v[38:39],v12 offset:13120
ld_82:
s_waitcnt lgkmcnt(0)
s_waitcnt vmcnt(18)
s_barrier
v_add_u32 v12,98304,v107
ds_read_b64_tr_b16 v[176:177],v12 offset:0
ds_read_b64_tr_b16 v[178:179],v12 offset:768
ds_read_b64_tr_b16 v[180:181],v12 offset:12288
ds_read_b64_tr_b16 v[182:183],v12 offset:13056
ds_read_b64_tr_b16 v[184:185],v12 offset:32
ds_read_b64_tr_b16 v[186:187],v12 offset:800
ds_read_b64_tr_b16 v[188:189],v12 offset:12320
ds_read_b64_tr_b16 v[190:191],v12 offset:13088
ds_read_b64_tr_b16 v[192:193],v12 offset:64
ds_read_b64_tr_b16 v[194:195],v12 offset:832
ds_read_b64_tr_b16 v[196:197],v12 offset:12352
ds_read_b64_tr_b16 v[198:199],v12 offset:13120
s_waitcnt lgkmcnt(0)
s_waitcnt vmcnt(12)
s_barrier
v_add_u32 v12,122880,v107
ds_read_b64_tr_b16 v[200:201],v12 offset:0
ds_read_b64_tr_b16 v[202:203],v12 offset:768
ds_read_b64_tr_b16 v[204:205],v12 offset:12288
ds_read_b64_tr_b16 v[206:207],v12 offset:13056
ds_read_b64_tr_b16 v[208:209],v12 offset:32
ds_read_b64_tr_b16 v[210:211],v12 offset:800
ds_read_b64_tr_b16 v[212:213],v12 offset:12320
ds_read_b64_tr_b16 v[214:215],v12 offset:13088
ds_read_b64_tr_b16 v[88:89],v12 offset:64
ds_read_b64_tr_b16 v[90:91],v12 offset:832
ds_read_b64_tr_b16 v[92:93],v12 offset:12352
ds_read_b64_tr_b16 v[94:95],v12 offset:13120
s_waitcnt lgkmcnt(0)
s_waitcnt vmcnt(6)
s_barrier
v_add_u32 v12,0,v107
ds_read_b64_tr_b16 v[216:217],v12 offset:0
ds_read_b64_tr_b16 v[218:219],v12 offset:768
ds_read_b64_tr_b16 v[220:221],v12 offset:12288
ds_read_b64_tr_b16 v[222:223],v12 offset:13056
ds_read_b64_tr_b16 v[224:225],v12 offset:32
ds_read_b64_tr_b16 v[226:227],v12 offset:800
ds_read_b64_tr_b16 v[228:229],v12 offset:12320
ds_read_b64_tr_b16 v[230:231],v12 offset:13088
ds_read_b64_tr_b16 v[232:233],v12 offset:64
ds_read_b64_tr_b16 v[234:235],v12 offset:832
ds_read_b64_tr_b16 v[236:237],v12 offset:12352
ds_read_b64_tr_b16 v[238:239],v12 offset:13120
s_waitcnt lgkmcnt(0)
s_waitcnt vmcnt(0)
s_barrier
v_add_u32 v12,24576,v107
ds_read_b64_tr_b16 v[240:241],v12 offset:0
ds_read_b64_tr_b16 v[242:243],v12 offset:768
ds_read_b64_tr_b16 v[244:245],v12 offset:12288
ds_read_b64_tr_b16 v[246:247],v12 offset:13056
ds_read_b64_tr_b16 v[248:249],v12 offset:32
ds_read_b64_tr_b16 v[250:251],v12 offset:800
ds_read_b64_tr_b16 v[252:253],v12 offset:12320
ds_read_b64_tr_b16 v[254:255],v12 offset:13088
ds_read_b64_tr_b16 v[96:97],v12 offset:64
ds_read_b64_tr_b16 v[98:99],v12 offset:832
ds_read_b64_tr_b16 v[100:101],v12 offset:12352
ds_read_b64_tr_b16 v[102:103],v12 offset:13120
s_waitcnt lgkmcnt(0)
s_barrier
ds_write_b128 v21,v[24:27] offset:0
ds_write_b128 v21,v[28:31] offset:1024
ds_write_b128 v21,v[32:35] offset:2048
ds_write_b128 v21,v[36:39] offset:3072
ds_write_b128 v21,v[40:43] offset:4096
ds_write_b128 v21,v[44:47] offset:5120
ds_write_b128 v21,v[48:51] offset:6144
ds_write_b128 v21,v[52:55] offset:7168
ds_write_b128 v21,v[56:59] offset:8192
ds_write_b128 v21,v[60:63] offset:9216
ds_write_b128 v21,v[64:67] offset:10240
ds_write_b128 v21,v[68:71] offset:11264
ds_write_b128 v21,v[72:75] offset:12288
ds_write_b128 v21,v[76:79] offset:13312
ds_write_b128 v21,v[80:83] offset:14336
ds_write_b128 v21,v[84:87] offset:15360
ds_write_b128 v21,v[88:91] offset:16384
ds_write_b128 v21,v[92:95] offset:17408
ds_write_b128 v21,v[96:99] offset:18432
ds_write_b128 v21,v[100:103] offset:19456
s_waitcnt lgkmcnt(0)
v_add_u32 v59,139264,v1
s_barrier
s_lshl_b32 s3,s49,2
v_mov_b32 v13,s3
s_nop 1
ibw_87:
buffer_load_dword v12,v13,s[12:15],0 offen sc1
s_waitcnt vmcnt(0)
v_cmp_ne_u32 vcc,256,v12
s_nop 0
s_cbranch_vccz ok_88
s_sleep 8
s_sub_u32 s47,s47,1
s_cbranch_scc1 ABORT
s_branch ibw_87
ok_88:
s_cmp_lg_u32 s49,0
s_cbranch_scc1 ibok_89
v_and_b32 v13,7,v0
v_lshlrev_b32 v13,2,v13
buffer_load_dword v12,v13,s[12:15],0 offen offset:32 sc1
s_waitcnt vmcnt(0)
v_cmp_ne_u32 vcc,32,v12
s_nop 0
s_cbranch_vccz ibok_89
s_barrier
s_mov_b32 s49,1
s_mov_b32 s3,s2
s_load_dwordx16 s[16:31],s[0:1],0
s_load_dwordx8 s[32:39],s[0:1],64
s_waitcnt lgkmcnt(0)
s_branch DISPATCH
ibok_89:
v_mov_b32 v13,192
s_cmp_lg_u32 s49,0
s_cbranch_scc1 vx_91
vw_90:
buffer_load_dword v12,v13,s[12:15],0 offen sc1
s_waitcnt vmcnt(0)
v_and_b32 v14,0xffff,v12
v_cmp_ne_u32 vcc,32,v14
s_nop 0
s_cbranch_vccz ok_92
s_sleep 4
s_sub_u32 s47,s47,1
s_cbranch_scc1 ABORT
s_branch vw_90
ok_92:
v_readfirstlane_b32 s60,v12
s_cmp_gt_u32 s60,1114112
s_cselect_b32 s60,0x2000,0
s_add_u32 s83,s83,s60
s_nop 1
vx_91:
s_mul_i32 s6,s46,2048
v_sub_u32 v18,v23,v22
v_add_u32 v18,v18,v1
v_add_u32 v18,8192,v18
s_mov_b32 s37,0x3f80
s_mov_b32 s81,0x3f800000
s_add_u32 s6,s6,s82
s_mov_b32 s7,0
s_add_u32 s7,s7,s82
s_add_u32 s7,s7,950272
s_mov_b32 s50,0
s_mov_b32 s4,0
s_mov_b32 s5,0
s_mov_b32 s78,2147483648
s_mov_b32 s79,2147483648
s_mov_b32 s30,2147483648
s_sub_u32 s60,s4,s5
s_cmp_gt_i32 s60,13
s_cselect_b32 s51,1,0
s_cmp_eq_u32 s4,64
s_cselect_b32 s51,1,s51
s_cmp_eq_u32 s51,0
s_cselect_b32 s52,s4,s5
s_addc_u32 s4,s4,0
s_add_u32 s5,s5,s51
s_and_b32 s60,s52,1
s_lshl2_add_u32 s60,s51,s60
s_lshl_b32 s68,s60,16
s_add_u32 s68,s68,s83
s_mul_i32 s59,s60,20480
s_add_u32 s59,s59,s6
s_lshl_b32 s69,s51,9
s_add_u32 s69,s69,s7
s_bfe_u32 s57,s52,65537
s_add_u32 s58,s52,1
s_cmp_lg_u32 s36,0
s_cbranch_scc1 CV_START
s_cmp_eq_u32 s46,3
s_cbranch_scc1 CH_START
s_lshl_b32 s60,s46,2
s_add_u32 s60,s60,147456
v_mov_b32 v20,s60
v_mov_b32 v12,0
ds_write_b32 v20,v12
v_add_u32 v58,106496,v1
v_mov_b32 v9,147468
s_lshl_b32 s85,s46,12
s_add_u32 s84,s84,s85
s_add_u32 s84,s84,25165824
s_add_u32 s74,s85,94208
s_add_u32 s75,s74,s74
s_add_u32 s75,s75,24576
s_mul_i32 s60,s29,3
s_add_u32 s60,s60,s46
v_lshlrev_b32 v13,7,v0
s_add_u32 s61,s60,0
s_min_u32 s61,s61,115
s_lshl_b32 s61,s61,13
s_add_u32 s61,s61,s82
buffer_load_dword v14,v13,s[8:11],s61 offen sc1
s_add_u32 s61,s60,48
s_min_u32 s61,s61,115
s_lshl_b32 s61,s61,13
s_add_u32 s61,s61,s82
buffer_load_dword v14,v13,s[8:11],s61 offen sc1
s_add_u32 s61,s60,96
s_min_u32 s61,s61,115
s_lshl_b32 s61,s61,13
s_add_u32 s61,s61,s82
buffer_load_dword v14,v13,s[8:11],s61 offen sc1
s_waitcnt vmcnt(0)
s_mov_b64 vcc,-1
s_waitcnt lgkmcnt(0)
v_mov_b32 v10,0
v_mov_b32 v11,0
v_mov_b32 v24,0
v_mov_b32 v25,0
v_mov_b32 v26,0
v_mov_b32 v27,0
v_mov_b32 v28,0
v_mov_b32 v29,0
v_mov_b32 v30,0
v_mov_b32 v31,0
v_mov_b32 v32,0
v_mov_b32 v33,0
v_mov_b32 v34,0
v_mov_b32 v35,0
v_mov_b32 v36,0
v_mov_b32 v37,0
v_mov_b32 v38,0
v_mov_b32 v39,0
v_mov_b32 v40,0
v_mov_b32 v41,0
v_mov_b32 v42,0
v_mov_b32 v43,0
v_mov_b32 v44,0
v_mov_b32 v45,0
v_mov_b32 v46,0
v_mov_b32 v47,0
s_cmp_lg_u32 s49,0
s_cbranch_scc1 CS_LOOP_S
CS_LOOP_F:
s_barrier
buffer_load_dwordx2 v[80:81],v18,s[8:11],s59 offen sc1
buffer_load_dwordx4 v[72:75],v1,s[8:11],s59 offen sc1
buffer_load_dwordx4 v[76:79],v1,s[8:11],s59 offen offset:1024 sc1
s_cbranch_vccz fj_95f
fj_95w:
s_waitcnt vmcnt(2)
fj_95f:
buffer_load_dwordx2 v[90:91],v18,s[8:11],s68 offen sc1
buffer_load_dwordx4 v[82:85],v1,s[8:11],s68 offen sc1
buffer_load_dwordx4 v[86:89],v1,s[8:11],s68 offen offset:1024 sc1
fj_95z:
v_mfma_f32_32x32x8_bf16 v[24:39],v[10:11],v[10:11],0
v_mfma_f32_16x16x16_bf16 v[40:43],v[10:11],v[10:11],0
v_mfma_f32_16x16x16_bf16 v[44:47],v[10:11],v[10:11],0
fj_95:
fa_93:
s_waitcnt vmcnt(5)
v_lshlrev_b32 v108,16,v80
v_and_b32 v109,0xffff0000,v80
v_lshlrev_b32 v110,16,v81
v_and_b32 v111,0xffff0000,v81
s_waitcnt vmcnt(4)
v_lshlrev_b32 v92,16,v72
v_and_b32 v93,0xffff0000,v72
v_lshlrev_b32 v94,16,v73
v_and_b32 v95,0xffff0000,v73
v_lshlrev_b32 v96,16,v74
v_and_b32 v97,0xffff0000,v74
v_lshlrev_b32 v98,16,v75
v_and_b32 v99,0xffff0000,v75
s_waitcnt vmcnt(3)
v_lshlrev_b32 v100,16,v76
v_and_b32 v101,0xffff0000,v76
v_lshlrev_b32 v102,16,v77
v_and_b32 v103,0xffff0000,v77
v_lshlrev_b32 v104,16,v78
v_and_b32 v105,0xffff0000,v78
v_lshlrev_b32 v106,16,v79
v_and_b32 v107,0xffff0000,v79
v_bitop3_b32 v16,v72,v76,s57 bitop3:0x7e
v_bitop3_b32 v16,v16,v80,s57 bitop3:0xf6
ec_96:
s_waitcnt vmcnt(2)
v_dot2c_f32_bf16 v108,s37,v90
v_dot2c_f32_bf16 v109,s81,v90
v_dot2c_f32_bf16 v110,s37,v91
v_dot2c_f32_bf16 v111,s81,v91
s_waitcnt vmcnt(1)
v_bitop3_b32 v17,v82,v90,s57 bitop3:0x7e
s_waitcnt vmcnt(0)
v_bitop3_b32 v17,v17,v86,s57 bitop3:0xf6
v_bitop3_b32 v17,v16,v17,1 bitop3:0xa8
v_cmp_ne_u32 vcc,0,v17
v_cvt_pk_bf16_f32 v56,v108,v109
v_cvt_pk_bf16_f32 v57,v110,v111
ds_write_b64 v23,v[56:57]
s_cbranch_vccnz ec_96r
v_dot2c_f32_bf16 v92,s37,v82
v_dot2c_f32_bf16 v93,s81,v82
v_dot2c_f32_bf16 v94,s37,v83
v_dot2c_f32_bf16 v95,s81,v83
v_dot2c_f32_bf16 v96,s37,v84
v_dot2c_f32_bf16 v97,s81,v84
v_dot2c_f32_bf16 v98,s37,v85
v_dot2c_f32_bf16 v99,s81,v85
v_cvt_pk_bf16_f32 v48,v92,v93
v_cvt_pk_bf16_f32 v49,v94,v95
v_cvt_pk_bf16_f32 v50,v96,v97
v_cvt_pk_bf16_f32 v51,v98,v99
ds_write_b128 v22,v[48:51] offset:0
v_dot2c_f32_bf16 v100,s37,v86
v_dot2c_f32_bf16 v101,s81,v86
v_dot2c_f32_bf16 v102,s37,v87
v_dot2c_f32_bf16 v103,s81,v87
v_dot2c_f32_bf16 v104,s37,v88
v_dot2c_f32_bf16 v105,s81,v88
v_dot2c_f32_bf16 v106,s37,v89
v_dot2c_f32_bf16 v107,s81,v89
v_cvt_pk_bf16_f32 v52,v100,v101
v_cvt_pk_bf16_f32 v53,v102,v103
v_cvt_pk_bf16_f32 v54,v104,v105
v_cvt_pk_bf16_f32 v55,v106,v107
ds_write_b128 v22,v[52:55] offset:1024
fj_95g:
v_smfmac_f32_16x16x64_bf16 v[24:27],v[48:51],a[0:7],v2
ds_read_b128 v[72:75],v21 offset:0
v_xor_b32 v58,57344,v58
v_smfmac_f32_16x16x64_bf16 v[28:31],v[48:51],a[8:15],v2
ds_read_b128 v[76:79],v21 offset:1024
s_sub_u32 s60,s4,s5
v_smfmac_f32_16x16x64_bf16 v[32:35],v[48:51],a[16:23],v2
ds_read_b128 v[80:83],v21 offset:2048
s_cmp_gt_i32 s60,13
v_smfmac_f32_16x16x64_bf16 v[36:39],v[48:51],a[24:31],v2
ds_read_b128 v[84:87],v21 offset:3072
s_cselect_b32 s53,1,0
s_waitcnt lgkmcnt(4)
s_barrier
v_smfmac_f32_16x16x64_bf16 v[40:43],v[48:51],a[32:39],v2
ds_read_b128 v[60:63],v3 offset:0
s_cmp_eq_u32 s4,64
v_smfmac_f32_16x16x64_bf16 v[24:27],v[52:55],a[40:47],v2
ds_read_b128 v[64:67],v3 offset:1024
s_cselect_b32 s53,1,s53
v_smfmac_f32_16x16x64_bf16 v[28:31],v[52:55],a[48:55],v2
ds_read_b128 v[68:71],v4 offset:0
s_cmp_eq_u32 s53,0
v_smfmac_f32_16x16x64_bf16 v[32:35],v[52:55],a[56:63],v2
s_cselect_b32 s54,s4,s5
s_addc_u32 s4,s4,0
s_add_u32 s5,s5,s53
v_smfmac_f32_16x16x64_bf16 v[36:39],v[52:55],a[64:71],v2
s_mul_i32 s73,s54,393216
s_add_u32 s73,s73,s84
s_sub_u32 s74,s75,s74
v_smfmac_f32_16x16x64_bf16 v[40:43],v[52:55],a[72:79],v2
s_mov_b32 m0,s74
s_and_b32 s60,s52,1
s_waitcnt lgkmcnt(5)
v_smfmac_f32_16x16x64_bf16 v[44:47],v[48:51],v[72:79],v2
ds_read_b128 v[72:75],v21 offset:4096
s_waitcnt lgkmcnt(4)
v_smfmac_f32_16x16x64_bf16 v[44:47],v[52:55],v[80:87],v2
ds_read_b128 v[76:79],v21 offset:5120
s_waitcnt lgkmcnt(4)
v_smfmac_f32_16x16x64_bf16 v[24:27],v[60:63],a[80:87],v2
ds_read_b128 v[80:83],v21 offset:6144
s_lshl2_add_u32 s60,s51,s60
v_smfmac_f32_16x16x64_bf16 v[28:31],v[60:63],a[88:95],v2
ds_read_b128 v[84:87],v21 offset:7168
s_mul_i32 s60,s60,49152
v_smfmac_f32_16x16x64_bf16 v[32:35],v[60:63],a[96:103],v2
s_add_u32 s71,s60,s34
s_add_u32 s70,s60,s33
s_lshl_b32 s60,s51,9
v_smfmac_f32_16x16x64_bf16 v[36:39],v[60:63],a[104:111],v2
s_add_u32 s72,s60,s35
buffer_load_dwordx4 v1,s[8:11],s73 offen sc1 lds
v_smfmac_f32_16x16x64_bf16 v[40:43],v[60:63],a[112:119],v2
buffer_load_dwordx4 v1,s[8:11],s73 offen offset:1024 sc1 lds
s_waitcnt lgkmcnt(2)
v_smfmac_f32_16x16x64_bf16 v[44:47],v[60:63],v[72:79],v2
ds_read_b128 v[60:63],v4 offset:1024
v_smfmac_f32_16x16x64_bf16 v[24:27],v[64:67],a[120:127],v2
ds_read_b128 v[72:75],v21 offset:8192
v_smfmac_f32_16x16x64_bf16 v[28:31],v[64:67],a[128:135],v2
ds_read_b128 v[76:79],v21 offset:9216
v_smfmac_f32_16x16x64_bf16 v[32:35],v[64:67],a[136:143],v2
buffer_load_dwordx4 v1,s[8:11],s73 offen offset:2048 sc1 lds
v_smfmac_f32_16x16x64_bf16 v[36:39],v[64:67],a[144:151],v2
buffer_load_dwordx4 v1,s[8:11],s73 offen offset:3072 sc1 lds
v_add_u32 v17,s85,v58
v_smfmac_f32_16x16x64_bf16 v[40:43],v[64:67],a[152:159],v2
v_mov_b32 v16,s58
s_and_b32 s60,s54,1
s_waitcnt lgkmcnt(3)
v_smfmac_f32_16x16x64_bf16 v[44:47],v[64:67],v[80:87],v2
ds_read_b128 v[64:67],v5 offset:0
s_lshl2_add_u32 s60,s53,s60
v_smfmac_f32_16x16x64_bf16 v[24:27],v[68:71],a[160:167],v2
ds_read_b128 v[80:83],v21 offset:10240
s_lshl_b32 s68,s60,16
v_smfmac_f32_16x16x64_bf16 v[28:31],v[68:71],a[168:175],v2
ds_read_b128 v[84:87],v21 offset:11264
s_add_u32 s68,s68,s83
v_smfmac_f32_16x16x64_bf16 v[32:35],v[68:71],a[176:183],v2
s_mul_i32 s59,s60,20480
s_add_u32 s59,s59,s6
s_lshl_b32 s69,s53,9
v_smfmac_f32_16x16x64_bf16 v[36:39],v[68:71],a[184:191],v2
s_add_u32 s69,s69,s7
s_bfe_u32 s31,s54,65537
s_add_u32 s32,s54,1
v_smfmac_f32_16x16x64_bf16 v[40:43],v[68:71],a[192:199],v2
s_add_u32 s50,s50,1
s_mov_b32 s51,s53
s_waitcnt lgkmcnt(3)
v_smfmac_f32_16x16x64_bf16 v[44:47],v[68:71],v[72:79],v2
ds_read_b128 v[68:71],v5 offset:1024
s_mov_b32 s52,s54
v_smfmac_f32_16x16x64_bf16 v[24:27],v[60:63],a[200:207],v2
ds_read_b128 v[72:75],v21 offset:12288
s_mov_b32 s58,s32
v_smfmac_f32_16x16x64_bf16 v[28:31],v[60:63],a[208:215],v2
ds_read_b128 v[76:79],v21 offset:13312
s_mov_b64 vcc,s[88:89]
v_smfmac_f32_16x16x64_bf16 v[32:35],v[60:63],a[216:223],v2
ds_read_b128 v[48:51],v58 offset:0
s_and_b32 s76,s50,128
v_smfmac_f32_16x16x64_bf16 v[36:39],v[60:63],a[224:231],v2
v_smfmac_f32_16x16x64_bf16 v[40:43],v[60:63],a[232:239],v2
ds_read_b128 v[52:55],v58 offset:1024
s_waitcnt lgkmcnt(5)
v_smfmac_f32_16x16x64_bf16 v[44:47],v[60:63],v[80:87],v2
ds_read_b128 v[60:63],v59 offset:0
v_smfmac_f32_16x16x64_bf16 v[24:27],v[64:67],a[240:247],v2
ds_read_b128 v[80:83],v21 offset:14336
v_smfmac_f32_16x16x64_bf16 v[28:31],v[64:67],a[248:255],v2
ds_read_b128 v[84:87],v21 offset:15360
v_smfmac_f32_16x16x64_bf16 v[32:35],v[64:67],v[112:119],v2
ds_read_b128 v[88:91],v58 offset:2048
v_smfmac_f32_16x16x64_bf16 v[36:39],v[64:67],v[120:127],v2
v_smfmac_f32_16x16x64_bf16 v[40:43],v[64:67],v[128:135],v2
ds_read_b128 v[92:95],v58 offset:3072
s_waitcnt lgkmcnt(7)
v_smfmac_f32_16x16x64_bf16 v[44:47],v[64:67],v[72:79],v2
ds_read_b128 v[64:67],v59 offset:1024
v_smfmac_f32_16x16x64_bf16 v[24:27],v[68:71],v[136:143],v2
ds_read_b128 v[72:75],v21 offset:16384
v_smfmac_f32_16x16x64_bf16 v[28:31],v[68:71],v[144:151],v2
ds_read_b128 v[76:79],v21 offset:17408
v_smfmac_f32_16x16x64_bf16 v[32:35],v[68:71],v[152:159],v2
ds_read_b128 v[96:99],v58 offset:4096
v_smfmac_f32_16x16x64_bf16 v[36:39],v[68:71],v[160:167],v2
v_smfmac_f32_16x16x64_bf16 v[40:43],v[68:71],v[168:175],v2
ds_read_b128 v[100:103],v58 offset:5120
s_waitcnt lgkmcnt(7)
v_smfmac_f32_16x16x64_bf16 v[44:47],v[68:71],v[80:87],v2
ds_read_b128 v[80:83],v21 offset:18432
v_smfmac_f32_16x16x64_bf16 v[24:27],v[60:63],v[176:183],v2
ds_read_b128 v[84:87],v21 offset:19456
v_smfmac_f32_16x16x64_bf16 v[36:39],v[60:63],v[200:207],v2
ds_read_b128 v[104:107],v58 offset:6144
s_waitcnt lgkmcnt(7)
v_smfmac_f32_16x16x64_bf16 v[24:27],v[64:67],v[216:223],v2
v_smfmac_f32_16x16x64_bf16 v[36:39],v[64:67],v[240:247],v2
ds_read_b128 v[108:111],v58 offset:7168
v_smfmac_f32_16x16x64_bf16 v[28:31],v[60:63],v[184:191],v2
v_smfmac_f32_16x16x64_bf16 v[40:43],v[60:63],v[208:215],v2
v_add_f32 v24,v24,v25
v_smfmac_f32_16x16x64_bf16 v[28:31],v[64:67],v[224:231],v2
v_add_f32 v26,v26,v27
v_smfmac_f32_16x16x64_bf16 v[40:43],v[64:67],v[248:255],v2
v_add_f32 v36,v36,v37
v_smfmac_f32_16x16x64_bf16 v[32:35],v[60:63],v[192:199],v2
v_add_f32 v38,v38,v39
s_waitcnt lgkmcnt(6)
v_smfmac_f32_16x16x64_bf16 v[44:47],v[60:63],v[72:79],v2
v_cvt_pk_bf16_f32 v37,v24,v26
v_smfmac_f32_16x16x64_bf16 v[32:35],v[64:67],v[232:239],v2
v_cvt_pk_bf16_f32 v36,v36,v38
s_waitcnt lgkmcnt(2)
v_smfmac_f32_16x16x64_bf16 v[44:47],v[64:67],v[80:87],v2
ds_write_b64 v6,v[36:37] offset:0
v_add_f32 v28,v28,v29
v_add_f32 v30,v30,v31
v_add_f32 v40,v40,v41
v_add_f32 v42,v42,v43
v_cvt_pk_bf16_f32 v41,v28,v30
v_cvt_pk_bf16_f32 v40,v40,v42
ds_write_b64 v6,v[40:41] offset:512
v_add_f32 v32,v32,v33
v_add_f32 v34,v34,v35
v_add_f32 v44,v44,v45
v_add_f32 v46,v46,v47
v_cvt_pk_bf16_f32 v45,v32,v34
v_cvt_pk_bf16_f32 v44,v44,v46
ds_write_b64 v6,v[44:45] offset:1024
ds_read_b128 v[72:75],v58 offset:8192
ds_read_b128 v[76:79],v58 offset:9216
s_waitcnt lgkmcnt(2)
s_barrier
ds_read_b64_tr_b16 v[24:25],v7 offset:0
ds_read_b64_tr_b16 v[26:27],v7 offset:512
ds_read_b64_tr_b16 v[28:29],v7 offset:1024
ds_read_b64_tr_b16 v[30:31],v7 offset:1536
ds_read_b64_tr_b16 v[32:33],v7 offset:2048
ds_read_b64_tr_b16 v[34:35],v7 offset:2560
ds_read_b64_tr_b16 v[36:37],v7 offset:3072
ds_read_b64_tr_b16 v[38:39],v7 offset:3584
s_waitcnt lgkmcnt(6)
v_mfma_f32_16x16x32_bf16 v[60:63],v[48:51],v[24:27],0
ds_read_b64_tr_b16 v[40:41],v7 offset:4096
v_mfma_f32_16x16x32_bf16 v[64:67],v[52:55],v[24:27],0
ds_read_b64_tr_b16 v[42:43],v7 offset:4608
v_mfma_f32_16x16x32_bf16 v[68:71],v[24:27],v[24:27],0
ds_read_b128 v[80:83],v58 offset:10240
s_waitcnt lgkmcnt(7)
v_mfma_f32_16x16x32_bf16 v[60:63],v[88:91],v[28:31],v[60:63]
ds_read_b128 v[84:87],v58 offset:11264
v_mfma_f32_16x16x32_bf16 v[64:67],v[92:95],v[28:31],v[64:67]
ds_read_b64_tr_b16 v[44:45],v7 offset:5120
v_mfma_f32_16x16x32_bf16 v[68:71],v[28:31],v[28:31],v[68:71]
ds_read_b64_tr_b16 v[46:47],v7 offset:5632
s_waitcnt lgkmcnt(8)
v_mfma_f32_16x16x32_bf16 v[60:63],v[96:99],v[32:35],v[60:63]
ds_read_b128 v[24:27],v17 offset:12288
v_mfma_f32_16x16x32_bf16 v[64:67],v[100:103],v[32:35],v[64:67]
ds_read_b128 v[28:31],v17 offset:13312
v_mfma_f32_16x16x32_bf16 v[68:71],v[32:35],v[32:35],v[68:71]
s_waitcnt lgkmcnt(8)
v_mfma_f32_16x16x32_bf16 v[60:63],v[104:107],v[36:39],v[60:63]
ds_read_b128 v[32:35],v17 offset:14336
v_mfma_f32_16x16x32_bf16 v[64:67],v[108:111],v[36:39],v[64:67]
v_mfma_f32_16x16x32_bf16 v[68:71],v[36:39],v[36:39],v[68:71]
s_waitcnt lgkmcnt(7)
v_mfma_f32_16x16x32_bf16 v[60:63],v[72:75],v[40:43],v[60:63]
ds_read_b128 v[36:39],v17 offset:15360
v_mfma_f32_16x16x32_bf16 v[64:67],v[76:79],v[40:43],v[64:67]
v_mfma_f32_16x16x32_bf16 v[68:71],v[40:43],v[40:43],v[68:71]
s_waitcnt lgkmcnt(4)
v_mfma_f32_16x16x32_bf16 v[60:63],v[80:83],v[44:47],v[60:63]
v_mfma_f32_16x16x32_bf16 v[64:67],v[84:87],v[44:47],v[64:67]
buffer_load_dwordx4 v[48:51],v1,s[8:11],s71 offen sc1
v_mfma_f32_16x16x32_bf16 v[68:71],v[44:47],v[44:47],v[68:71]
s_nop 4
v_cndmask_b32_dpp v60,v64,v60,vcc quad_perm:[2,3,2,3] row_mask:0xf bank_mask:0xf
v_cndmask_b32_dpp v61,v65,v61,vcc quad_perm:[2,3,2,3] row_mask:0xf bank_mask:0xf
v_cndmask_b32_dpp v62,v66,v62,vcc quad_perm:[2,3,2,3] row_mask:0xf bank_mask:0xf
v_cndmask_b32_dpp v63,v67,v63,vcc quad_perm:[2,3,2,3] row_mask:0xf bank_mask:0xf
v_max3_f32 v12,v60,v61,v62
v_cndmask_b32_dpp v68,v69,v68,vcc quad_perm:[2,3,2,3] row_mask:0xf bank_mask:0xf
v_max3_f32 v12,v12,v63,v68
s_nop 1
v_max_f32_dpp v13,v12,v12 quad_perm:[2,3,0,1] row_mask:0xf bank_mask:0xf
v_max_f32_dpp v12,v12,v12 quad_perm:[2,3,0,1] row_mask:0xf bank_mask:0xf
s_nop 1
v_permlane32_swap_b32 v12,v13
v_max_f32 v15,v12,v13
v_max_f32 v12,v12,v13
s_mov_b64 exec,1
buffer_store_dword v16,v1,s[8:11],s72 offen
s_mov_b64 exec,-1
v_permlane16_swap_b32 v12,v15
v_max_f32 v12,v12,v15
v_mul_f32 v12,s87,v12
v_fma_f32 v60,v60,s87,-v12
v_fma_f32 v61,v61,s87,-v12
v_fma_f32 v62,v62,s87,-v12
v_fma_f32 v63,v63,s87,-v12
v_fma_f32 v68,v68,s87,-v12
v_exp_f32 v60,v60
v_exp_f32 v61,v61
v_exp_f32 v62,v62
v_exp_f32 v63,v63
v_exp_f32 v68,v68
v_cvt_pk_bf16_f32 v70,v60,v61
v_cvt_pk_bf16_f32 v71,v62,v63
v_cndmask_b32 v46,v70,v10,vcc
v_cndmask_b32 v47,v71,v10,vcc
v_cndmask_b32_dpp v44,v70,v10,vcc quad_perm:[2,3,0,1] row_mask:0xf bank_mask:0xf
v_cndmask_b32_dpp v45,v71,v10,vcc quad_perm:[2,3,0,1] row_mask:0xf bank_mask:0xf
s_mov_b64 vcc,s[90:91]
s_waitcnt lgkmcnt(0)
v_cndmask_b32 v40,v70,v10,vcc
v_mfma_f32_16x16x32_bf16 v[64:67],v[28:31],v[44:47],0
v_cndmask_b32 v41,v71,v10,vcc
v_cndmask_b32_dpp v42,v70,v10,vcc quad_perm:[2,3,0,1] row_mask:0xf bank_mask:0xf
v_mfma_f32_16x16x32_bf16 v[52:55],v[36:39],v[44:47],0
v_cndmask_b32_dpp v43,v71,v10,vcc quad_perm:[2,3,0,1] row_mask:0xf bank_mask:0xf
v_mov_b32_dpp v14,v68 quad_perm:[2,3,0,1] row_mask:0xf bank_mask:0xf
v_add_f32 v12,v60,v61
v_mfma_f32_16x16x32_bf16 v[64:67],v[24:27],v[40:43],v[64:67]
v_cvt_pk_bf16_f32 v56,v68,v14
v_cvt_pk_bf16_f32 v57,v14,v68
v_mov_b32 v16,s50
v_mfma_f32_16x16x32_bf16 v[52:55],v[32:35],v[40:43],v[52:55]
v_cndmask_b32 v56,v56,v10,vcc
v_cndmask_b32 v57,v10,v57,vcc
v_add_f32 v13,v62,v63
v_add_f32 v12,v12,v68
s_waitcnt vmcnt(1)
v_mfma_f32_16x16x16_bf16 v[64:67],v[48:49],v[56:57],v[64:67]
v_add_f32 v12,v12,v13
v_bitop3_b32 v17,v48,v50,s57 bitop3:0x7e
v_mfma_f32_16x16x16_bf16 v[52:55],v[50:51],v[56:57],v[52:55]
v_add_f32_dpp v13,v12,v12 quad_perm:[2,3,0,1] row_mask:0xf bank_mask:0xf
v_add_f32_dpp v12,v12,v12 quad_perm:[2,3,0,1] row_mask:0xf bank_mask:0xf
v_and_b32 v17,1,v17
v_cmp_ne_u32 vcc,0,v17
v_permlane32_swap_b32 v12,v13
v_add_f32 v15,v12,v13
v_add_f32 v12,v12,v13
s_cmp_lg_u64 vcc,0
s_cselect_b32 s60,1,0
v_permlane16_swap_b32 v12,v15
v_add_f32 v12,v12,v15
v_rcp_f32 v12,v12
s_xor_b32 s61,s57,s60
v_pk_mul_f32 v[64:65],v[64:65],v[12:13] op_sel_hi:[1,0]
v_pk_mul_f32 v[66:67],v[66:67],v[12:13] op_sel_hi:[1,0]
v_pk_mul_f32 v[52:53],v[52:53],v[12:13] op_sel_hi:[1,0]
v_pk_mul_f32 v[54:55],v[54:55],v[12:13] op_sel_hi:[1,0]
v_cvt_pk_bf16_f32 v48,v64,v65
v_cvt_pk_bf16_f32 v49,v66,v67
v_cvt_pk_bf16_f32 v50,v52,v53
v_cvt_pk_bf16_f32 v51,v54,v55
v_and_or_b32 v48,v48,-2,s61
buffer_store_dwordx4 v[48:51],v8,s[8:11],s70 offen
ds_read_b32 v0,v9
ds_write_b32 v20,v16
s_or_b32 s61,s60,s76
s_cbranch_scc1 od_97
ct_98:
s_barrier
buffer_load_dwordx2 v[80:81],v18,s[8:11],s59 offen sc1
buffer_load_dwordx4 v[72:75],v1,s[8:11],s59 offen sc1
buffer_load_dwordx4 v[76:79],v1,s[8:11],s59 offen offset:1024 sc1
s_waitcnt lgkmcnt(0)
v_cmp_ne_u32 vcc,s50,v0
s_mov_b32 s57,s31
s_cbranch_vccnz fj_95w
buffer_load_dwordx2 v[90:91],v18,s[8:11],s68 offen sc1
buffer_load_dwordx4 v[82:85],v1,s[8:11],s68 offen sc1
buffer_load_dwordx4 v[86:89],v1,s[8:11],s68 offen offset:1024 sc1
s_branch fj_95z
fr_94:
v_bitop3_b32 v12,v72,v76,s57 bitop3:0x7e
v_bitop3_b32 v13,v80,v80,s57 bitop3:0x7e
v_xor_b32 v14,s57,v80
v_or3_b32 v12,v12,v13,v14
v_and_b32 v12,1,v12
v_cmp_ne_u32 vcc,0,v12
s_cbranch_vccz sk_100
buffer_load_dwordx2 v[80:81],v18,s[8:11],s59 offen sc1
buffer_load_dwordx4 v[72:75],v1,s[8:11],s59 offen sc1
buffer_load_dwordx4 v[76:79],v1,s[8:11],s59 offen offset:1024 sc1
sk_100:
buffer_load_dwordx2 v[90:91],v18,s[8:11],s68 offen sc1
buffer_load_dwordx4 v[82:85],v1,s[8:11],s68 offen sc1
buffer_load_dwordx4 v[86:89],v1,s[8:11],s68 offen offset:1024 sc1
s_sub_u32 s47,s47,1
s_cbranch_scc1 ABORT
s_waitcnt lgkmcnt(0)
s_branch fa_93
ec_96r:
buffer_load_dwordx2 v[90:91],v18,s[8:11],s68 offen sc1
buffer_load_dwordx4 v[82:85],v1,s[8:11],s68 offen sc1
buffer_load_dwordx4 v[86:89],v1,s[8:11],s68 offen offset:1024 sc1
v_and_b32 v17,1,v16
v_cmp_ne_u32 vcc,0,v17
s_nop 0
s_cbranch_vccnz fr_94
v_lshlrev_b32 v92,16,v72
v_and_b32 v93,0xffff0000,v72
v_lshlrev_b32 v94,16,v73
v_and_b32 v95,0xffff0000,v73
v_lshlrev_b32 v96,16,v74
v_and_b32 v97,0xffff0000,v74
v_lshlrev_b32 v98,16,v75
v_and_b32 v99,0xffff0000,v75
v_lshlrev_b32 v108,16,v80
v_and_b32 v109,0xffff0000,v80
v_lshlrev_b32 v110,16,v81
v_and_b32 v111,0xffff0000,v81
s_sub_u32 s47,s47,1
s_cbranch_scc1 ABORT
s_branch ec_96
od_97:
s_cmp_eq_u32 s60,0
s_cbranch_scc1 CS_DONE
vb_101:
s_sub_u32 s47,s47,1
s_cbranch_scc1 ABORT
buffer_load_dwordx4 v[48:51],v1,s[8:11],s71 offen sc1
s_waitcnt vmcnt(0)
v_bitop3_b32 v17,v48,v50,s57 bitop3:0x7e
v_and_b32 v17,1,v17
v_cmp_ne_u32 vcc,0,v17
s_nop 0
s_cbranch_vccnz vb_101
v_mfma_f32_16x16x32_bf16 v[64:67],v[28:31],v[44:47],0
v_mfma_f32_16x16x32_bf16 v[52:55],v[36:39],v[44:47],0
v_mfma_f32_16x16x32_bf16 v[64:67],v[24:27],v[40:43],v[64:67]
v_mfma_f32_16x16x32_bf16 v[52:55],v[32:35],v[40:43],v[52:55]
v_mfma_f32_16x16x16_bf16 v[64:67],v[48:49],v[56:57],v[64:67]
v_mfma_f32_16x16x16_bf16 v[52:55],v[50:51],v[56:57],v[52:55]
s_nop 4
v_pk_mul_f32 v[64:65],v[64:65],v[12:13] op_sel_hi:[1,0]
v_pk_mul_f32 v[66:67],v[66:67],v[12:13] op_sel_hi:[1,0]
s_nop 0
v_pk_mul_f32 v[52:53],v[52:53],v[12:13] op_sel_hi:[1,0]
v_pk_mul_f32 v[54:55],v[54:55],v[12:13] op_sel_hi:[1,0]
v_cvt_pk_bf16_f32 v48,v64,v65
v_cvt_pk_bf16_f32 v49,v66,v67
v_cvt_pk_bf16_f32 v50,v52,v53
v_cvt_pk_bf16_f32 v51,v54,v55
v_and_or_b32 v48,v48,-2,s57
buffer_store_dwordx4 v[48:51],v8,s[8:11],s70 offen
s_cmp_lg_u32 s76,0
s_cbranch_scc1 CS_DONE
s_branch ct_98
CS_LOOP_S:
s_barrier
buffer_load_dwordx2 v[80:81],v18,s[8:11],s59 offen sc1
buffer_load_dwordx4 v[72:75],v1,s[8:11],s59 offen sc1
buffer_load_dwordx4 v[76:79],v1,s[8:11],s59 offen offset:1024 sc1
s_cbranch_vccz fj_104f
fj_104w:
s_waitcnt vmcnt(2)
fj_104f:
buffer_load_dwordx2 v[90:91],v18,s[8:11],s68 offen sc1
buffer_load_dwordx4 v[82:85],v1,s[8:11],s68 offen sc1
buffer_load_dwordx4 v[86:89],v1,s[8:11],s68 offen offset:1024 sc1
fj_104z:
v_mfma_f32_32x32x8_bf16 v[24:39],v[10:11],v[10:11],0
v_mfma_f32_16x16x16_bf16 v[40:43],v[10:11],v[10:11],0
v_mfma_f32_16x16x16_bf16 v[44:47],v[10:11],v[10:11],0
fj_104:
fa_102:
s_waitcnt vmcnt(5)
v_lshlrev_b32 v108,16,v80
v_and_b32 v109,0xffff0000,v80
v_lshlrev_b32 v110,16,v81
v_and_b32 v111,0xffff0000,v81
s_waitcnt vmcnt(4)
v_lshlrev_b32 v92,16,v72
v_and_b32 v93,0xffff0000,v72
v_lshlrev_b32 v94,16,v73
v_and_b32 v95,0xffff0000,v73
v_lshlrev_b32 v96,16,v74
v_and_b32 v97,0xffff0000,v74
v_lshlrev_b32 v98,16,v75
v_and_b32 v99,0xffff0000,v75
s_waitcnt vmcnt(3)
v_lshlrev_b32 v100,16,v76
v_and_b32 v101,0xffff0000,v76
v_lshlrev_b32 v102,16,v77
v_and_b32 v103,0xffff0000,v77
v_lshlrev_b32 v104,16,v78
v_and_b32 v105,0xffff0000,v78
v_lshlrev_b32 v106,16,v79
v_and_b32 v107,0xffff0000,v79
v_bitop3_b32 v16,v72,v76,s57 bitop3:0x7e
v_bitop3_b32 v16,v16,v80,s57 bitop3:0xf6
ec_105:
s_waitcnt vmcnt(2)
v_dot2c_f32_bf16 v108,s37,v90
v_dot2c_f32_bf16 v109,s81,v90
v_dot2c_f32_bf16 v110,s37,v91
v_dot2c_f32_bf16 v111,s81,v91
s_waitcnt vmcnt(1)
v_bitop3_b32 v17,v82,v90,s57 bitop3:0x7e
s_waitcnt vmcnt(0)
v_bitop3_b32 v17,v17,v86,s57 bitop3:0xf6
v_bitop3_b32 v17,v16,v17,1 bitop3:0xa8
v_cmp_ne_u32 vcc,0,v17
v_cvt_pk_bf16_f32 v56,v108,v109
v_cvt_pk_bf16_f32 v57,v110,v111
ds_write_b64 v23,v[56:57]
s_cbranch_vccnz ec_105r
v_dot2c_f32_bf16 v92,s37,v82
v_dot2c_f32_bf16 v93,s81,v82
v_dot2c_f32_bf16 v94,s37,v83
v_dot2c_f32_bf16 v95,s81,v83
v_dot2c_f32_bf16 v96,s37,v84
v_dot2c_f32_bf16 v97,s81,v84
v_dot2c_f32_bf16 v98,s37,v85
v_dot2c_f32_bf16 v99,s81,v85
v_cvt_pk_bf16_f32 v48,v92,v93
v_cvt_pk_bf16_f32 v49,v94,v95
v_cvt_pk_bf16_f32 v50,v96,v97
v_cvt_pk_bf16_f32 v51,v98,v99
ds_write_b128 v22,v[48:51] offset:0
v_dot2c_f32_bf16 v100,s37,v86
v_dot2c_f32_bf16 v101,s81,v86
v_dot2c_f32_bf16 v102,s37,v87
v_dot2c_f32_bf16 v103,s81,v87
v_dot2c_f32_bf16 v104,s37,v88
v_dot2c_f32_bf16 v105,s81,v88
v_dot2c_f32_bf16 v106,s37,v89
v_dot2c_f32_bf16 v107,s81,v89
v_cvt_pk_bf16_f32 v52,v100,v101
v_cvt_pk_bf16_f32 v53,v102,v103
v_cvt_pk_bf16_f32 v54,v104,v105
v_cvt_pk_bf16_f32 v55,v106,v107
ds_write_b128 v22,v[52:55] offset:1024
fj_104g:
v_smfmac_f32_16x16x64_bf16 v[24:27],v[48:51],a[0:7],v2
ds_read_b128 v[72:75],v21 offset:0
v_xor_b32 v58,57344,v58
v_smfmac_f32_16x16x64_bf16 v[28:31],v[48:51],a[8:15],v2
ds_read_b128 v[76:79],v21 offset:1024
s_sub_u32 s60,s4,s5
v_smfmac_f32_16x16x64_bf16 v[32:35],v[48:51],a[16:23],v2
ds_read_b128 v[80:83],v21 offset:2048
s_cmp_gt_i32 s60,13
v_smfmac_f32_16x16x64_bf16 v[36:39],v[48:51],a[24:31],v2
ds_read_b128 v[84:87],v21 offset:3072
s_cselect_b32 s53,1,0
s_waitcnt lgkmcnt(4)
s_barrier
v_smfmac_f32_16x16x64_bf16 v[40:43],v[48:51],a[32:39],v2
ds_read_b128 v[60:63],v3 offset:0
s_cmp_eq_u32 s4,64
v_smfmac_f32_16x16x64_bf16 v[24:27],v[52:55],a[40:47],v2
ds_read_b128 v[64:67],v3 offset:1024
s_cselect_b32 s53,1,s53
v_smfmac_f32_16x16x64_bf16 v[28:31],v[52:55],a[48:55],v2
ds_read_b128 v[68:71],v4 offset:0
s_cmp_eq_u32 s53,0
v_smfmac_f32_16x16x64_bf16 v[32:35],v[52:55],a[56:63],v2
s_cselect_b32 s54,s4,s5
s_addc_u32 s4,s4,0
s_add_u32 s5,s5,s53
v_smfmac_f32_16x16x64_bf16 v[36:39],v[52:55],a[64:71],v2
s_mul_i32 s73,s54,393216
s_add_u32 s73,s73,s84
s_sub_u32 s74,s75,s74
v_smfmac_f32_16x16x64_bf16 v[40:43],v[52:55],a[72:79],v2
s_mov_b32 m0,s74
s_and_b32 s60,s52,1
s_waitcnt lgkmcnt(5)
v_smfmac_f32_16x16x64_bf16 v[44:47],v[48:51],v[72:79],v2
ds_read_b128 v[72:75],v21 offset:4096
s_waitcnt lgkmcnt(4)
v_smfmac_f32_16x16x64_bf16 v[44:47],v[52:55],v[80:87],v2
ds_read_b128 v[76:79],v21 offset:5120
s_waitcnt lgkmcnt(4)
v_smfmac_f32_16x16x64_bf16 v[24:27],v[60:63],a[80:87],v2
ds_read_b128 v[80:83],v21 offset:6144
s_lshl2_add_u32 s60,s51,s60
v_smfmac_f32_16x16x64_bf16 v[28:31],v[60:63],a[88:95],v2
ds_read_b128 v[84:87],v21 offset:7168
s_mul_i32 s60,s60,49152
v_smfmac_f32_16x16x64_bf16 v[32:35],v[60:63],a[96:103],v2
s_add_u32 s71,s60,s34
s_add_u32 s70,s60,s33
s_lshl_b32 s60,s51,9
v_smfmac_f32_16x16x64_bf16 v[36:39],v[60:63],a[104:111],v2
s_add_u32 s72,s60,s35
buffer_load_dwordx4 v1,s[8:11],s73 offen sc1 lds
v_smfmac_f32_16x16x64_bf16 v[40:43],v[60:63],a[112:119],v2
buffer_load_dwordx4 v1,s[8:11],s73 offen offset:1024 sc1 lds
s_waitcnt lgkmcnt(2)
v_smfmac_f32_16x16x64_bf16 v[44:47],v[60:63],v[72:79],v2
ds_read_b128 v[60:63],v4 offset:1024
v_smfmac_f32_16x16x64_bf16 v[24:27],v[64:67],a[120:127],v2
ds_read_b128 v[72:75],v21 offset:8192
v_smfmac_f32_16x16x64_bf16 v[28:31],v[64:67],a[128:135],v2
ds_read_b128 v[76:79],v21 offset:9216
v_smfmac_f32_16x16x64_bf16 v[32:35],v[64:67],a[136:143],v2
buffer_load_dwordx4 v1,s[8:11],s73 offen offset:2048 sc1 lds
v_smfmac_f32_16x16x64_bf16 v[36:39],v[64:67],a[144:151],v2
buffer_load_dwordx4 v1,s[8:11],s73 offen offset:3072 sc1 lds
v_add_u32 v17,s85,v58
v_smfmac_f32_16x16x64_bf16 v[40:43],v[64:67],a[152:159],v2
v_mov_b32 v16,s58
s_and_b32 s60,s54,1
s_waitcnt lgkmcnt(3)
v_smfmac_f32_16x16x64_bf16 v[44:47],v[64:67],v[80:87],v2
ds_read_b128 v[64:67],v5 offset:0
s_lshl2_add_u32 s60,s53,s60
v_smfmac_f32_16x16x64_bf16 v[24:27],v[68:71],a[160:167],v2
ds_read_b128 v[80:83],v21 offset:10240
s_lshl_b32 s68,s60,16
v_smfmac_f32_16x16x64_bf16 v[28:31],v[68:71],a[168:175],v2
ds_read_b128 v[84:87],v21 offset:11264
s_add_u32 s68,s68,s83
v_smfmac_f32_16x16x64_bf16 v[32:35],v[68:71],a[176:183],v2
s_mul_i32 s59,s60,20480
s_add_u32 s59,s59,s6
s_lshl_b32 s69,s53,9
v_smfmac_f32_16x16x64_bf16 v[36:39],v[68:71],a[184:191],v2
s_add_u32 s69,s69,s7
s_bfe_u32 s31,s54,65537
s_add_u32 s32,s54,1
v_smfmac_f32_16x16x64_bf16 v[40:43],v[68:71],a[192:199],v2
s_add_u32 s50,s50,1
s_mov_b32 s51,s53
s_waitcnt lgkmcnt(3)
v_smfmac_f32_16x16x64_bf16 v[44:47],v[68:71],v[72:79],v2
ds_read_b128 v[68:71],v5 offset:1024
s_mov_b32 s52,s54
v_smfmac_f32_16x16x64_bf16 v[24:27],v[60:63],a[200:207],v2
ds_read_b128 v[72:75],v21 offset:12288
s_mov_b32 s58,s32
v_smfmac_f32_16x16x64_bf16 v[28:31],v[60:63],a[208:215],v2
ds_read_b128 v[76:79],v21 offset:13312
s_mov_b64 vcc,s[88:89]
v_smfmac_f32_16x16x64_bf16 v[32:35],v[60:63],a[216:223],v2
ds_read_b128 v[48:51],v58 offset:0
s_and_b32 s76,s50,128
v_smfmac_f32_16x16x64_bf16 v[36:39],v[60:63],a[224:231],v2
v_smfmac_f32_16x16x64_bf16 v[40:43],v[60:63],a[232:239],v2
ds_read_b128 v[52:55],v58 offset:1024
s_waitcnt lgkmcnt(5)
v_smfmac_f32_16x16x64_bf16 v[44:47],v[60:63],v[80:87],v2
ds_read_b128 v[60:63],v59 offset:0
v_smfmac_f32_16x16x64_bf16 v[24:27],v[64:67],a[240:247],v2
ds_read_b128 v[80:83],v21 offset:14336
v_smfmac_f32_16x16x64_bf16 v[28:31],v[64:67],a[248:255],v2
ds_read_b128 v[84:87],v21 offset:15360
v_smfmac_f32_16x16x64_bf16 v[32:35],v[64:67],v[112:119],v2
ds_read_b128 v[88:91],v58 offset:2048
v_smfmac_f32_16x16x64_bf16 v[36:39],v[64:67],v[120:127],v2
v_smfmac_f32_16x16x64_bf16 v[40:43],v[64:67],v[128:135],v2
ds_read_b128 v[92:95],v58 offset:3072
s_waitcnt lgkmcnt(7)
v_smfmac_f32_16x16x64_bf16 v[44:47],v[64:67],v[72:79],v2
ds_read_b128 v[64:67],v59 offset:1024
v_smfmac_f32_16x16x64_bf16 v[24:27],v[68:71],v[136:143],v2
ds_read_b128 v[72:75],v21 offset:16384
v_smfmac_f32_16x16x64_bf16 v[28:31],v[68:71],v[144:151],v2
ds_read_b128 v[76:79],v21 offset:17408
v_smfmac_f32_16x16x64_bf16 v[32:35],v[68:71],v[152:159],v2
ds_read_b128 v[96:99],v58 offset:4096
v_smfmac_f32_16x16x64_bf16 v[36:39],v[68:71],v[160:167],v2
v_smfmac_f32_16x16x64_bf16 v[40:43],v[68:71],v[168:175],v2
ds_read_b128 v[100:103],v58 offset:5120
s_waitcnt lgkmcnt(7)
v_smfmac_f32_16x16x64_bf16 v[44:47],v[68:71],v[80:87],v2
ds_read_b128 v[80:83],v21 offset:18432
v_smfmac_f32_16x16x64_bf16 v[24:27],v[60:63],v[176:183],v2
ds_read_b128 v[84:87],v21 offset:19456
v_smfmac_f32_16x16x64_bf16 v[36:39],v[60:63],v[200:207],v2
ds_read_b128 v[104:107],v58 offset:6144
s_waitcnt lgkmcnt(7)
v_smfmac_f32_16x16x64_bf16 v[24:27],v[64:67],v[216:223],v2
v_smfmac_f32_16x16x64_bf16 v[36:39],v[64:67],v[240:247],v2
ds_read_b128 v[108:111],v58 offset:7168
v_smfmac_f32_16x16x64_bf16 v[28:31],v[60:63],v[184:191],v2
v_smfmac_f32_16x16x64_bf16 v[40:43],v[60:63],v[208:215],v2
v_add_f32 v24,v24,v25
v_smfmac_f32_16x16x64_bf16 v[28:31],v[64:67],v[224:231],v2
v_add_f32 v26,v26,v27
v_smfmac_f32_16x16x64_bf16 v[40:43],v[64:67],v[248:255],v2
v_add_f32 v36,v36,v37
v_smfmac_f32_16x16x64_bf16 v[32:35],v[60:63],v[192:199],v2
v_add_f32 v38,v38,v39
s_waitcnt lgkmcnt(6)
v_smfmac_f32_16x16x64_bf16 v[44:47],v[60:63],v[72:79],v2
v_cvt_pk_bf16_f32 v37,v24,v26
v_smfmac_f32_16x16x64_bf16 v[32:35],v[64:67],v[232:239],v2
v_cvt_pk_bf16_f32 v36,v36,v38
s_waitcnt lgkmcnt(2)
v_smfmac_f32_16x16x64_bf16 v[44:47],v[64:67],v[80:87],v2
ds_write_b64 v6,v[36:37] offset:0
v_add_f32 v28,v28,v29
v_add_f32 v30,v30,v31
v_add_f32 v40,v40,v41
v_add_f32 v42,v42,v43
v_cvt_pk_bf16_f32 v41,v28,v30
v_cvt_pk_bf16_f32 v40,v40,v42
ds_write_b64 v6,v[40:41] offset:512
v_add_f32 v32,v32,v33
v_add_f32 v34,v34,v35
v_add_f32 v44,v44,v45
v_add_f32 v46,v46,v47
v_cvt_pk_bf16_f32 v45,v32,v34
v_cvt_pk_bf16_f32 v44,v44,v46
ds_write_b64 v6,v[44:45] offset:1024
ds_read_b128 v[72:75],v58 offset:8192
ds_read_b128 v[76:79],v58 offset:9216
s_waitcnt lgkmcnt(2)
s_barrier
ds_read_b64_tr_b16 v[24:25],v7 offset:0
ds_read_b64_tr_b16 v[26:27],v7 offset:512
ds_read_b64_tr_b16 v[28:29],v7 offset:1024
ds_read_b64_tr_b16 v[30:31],v7 offset:1536
ds_read_b64_tr_b16 v[32:33],v7 offset:2048
ds_read_b64_tr_b16 v[34:35],v7 offset:2560
ds_read_b64_tr_b16 v[36:37],v7 offset:3072
ds_read_b64_tr_b16 v[38:39],v7 offset:3584
s_waitcnt lgkmcnt(6)
v_mfma_f32_16x16x32_bf16 v[60:63],v[48:51],v[24:27],0
ds_read_b64_tr_b16 v[40:41],v7 offset:4096
v_mfma_f32_16x16x32_bf16 v[64:67],v[52:55],v[24:27],0
ds_read_b64_tr_b16 v[42:43],v7 offset:4608
v_mfma_f32_16x16x32_bf16 v[68:71],v[24:27],v[24:27],0
ds_read_b128 v[80:83],v58 offset:10240
s_waitcnt lgkmcnt(7)
v_mfma_f32_16x16x32_bf16 v[60:63],v[88:91],v[28:31],v[60:63]
ds_read_b128 v[84:87],v58 offset:11264
v_mfma_f32_16x16x32_bf16 v[64:67],v[92:95],v[28:31],v[64:67]
ds_read_b64_tr_b16 v[44:45],v7 offset:5120
v_mfma_f32_16x16x32_bf16 v[68:71],v[28:31],v[28:31],v[68:71]
ds_read_b64_tr_b16 v[46:47],v7 offset:5632
s_waitcnt lgkmcnt(8)
v_mfma_f32_16x16x32_bf16 v[60:63],v[96:99],v[32:35],v[60:63]
ds_read_b128 v[24:27],v17 offset:12288
v_mfma_f32_16x16x32_bf16 v[64:67],v[100:103],v[32:35],v[64:67]
ds_read_b128 v[28:31],v17 offset:13312
v_mfma_f32_16x16x32_bf16 v[68:71],v[32:35],v[32:35],v[68:71]
s_waitcnt lgkmcnt(8)
v_mfma_f32_16x16x32_bf16 v[60:63],v[104:107],v[36:39],v[60:63]
ds_read_b128 v[32:35],v17 offset:14336
v_mfma_f32_16x16x32_bf16 v[64:67],v[108:111],v[36:39],v[64:67]
v_mfma_f32_16x16x32_bf16 v[68:71],v[36:39],v[36:39],v[68:71]
s_waitcnt lgkmcnt(7)
v_mfma_f32_16x16x32_bf16 v[60:63],v[72:75],v[40:43],v[60:63]
ds_read_b128 v[36:39],v17 offset:15360
v_mfma_f32_16x16x32_bf16 v[64:67],v[76:79],v[40:43],v[64:67]
v_mfma_f32_16x16x32_bf16 v[68:71],v[40:43],v[40:43],v[68:71]
s_waitcnt lgkmcnt(4)
v_mfma_f32_16x16x32_bf16 v[60:63],v[80:83],v[44:47],v[60:63]
v_mfma_f32_16x16x32_bf16 v[64:67],v[84:87],v[44:47],v[64:67]
buffer_load_dwordx4 v[48:51],v1,s[8:11],s71 offen sc1
v_mfma_f32_16x16x32_bf16 v[68:71],v[44:47],v[44:47],v[68:71]
s_nop 4
v_cndmask_b32_dpp v60,v64,v60,vcc quad_perm:[2,3,2,3] row_mask:0xf bank_mask:0xf
v_cndmask_b32_dpp v61,v65,v61,vcc quad_perm:[2,3,2,3] row_mask:0xf bank_mask:0xf
v_cndmask_b32_dpp v62,v66,v62,vcc quad_perm:[2,3,2,3] row_mask:0xf bank_mask:0xf
v_cndmask_b32_dpp v63,v67,v63,vcc quad_perm:[2,3,2,3] row_mask:0xf bank_mask:0xf
v_max3_f32 v12,v60,v61,v62
v_cndmask_b32_dpp v68,v69,v68,vcc quad_perm:[2,3,2,3] row_mask:0xf bank_mask:0xf
v_max3_f32 v12,v12,v63,v68
s_nop 1
v_max_f32_dpp v13,v12,v12 quad_perm:[2,3,0,1] row_mask:0xf bank_mask:0xf
v_max_f32_dpp v12,v12,v12 quad_perm:[2,3,0,1] row_mask:0xf bank_mask:0xf
s_nop 1
v_permlane32_swap_b32 v12,v13
v_max_f32 v15,v12,v13
v_max_f32 v12,v12,v13
s_mov_b64 exec,1
buffer_store_dword v16,v1,s[8:11],s72 offen sc1
s_mov_b64 exec,-1
v_permlane16_swap_b32 v12,v15
v_max_f32 v12,v12,v15
v_mul_f32 v12,s87,v12
v_fma_f32 v60,v60,s87,-v12
v_fma_f32 v61,v61,s87,-v12
v_fma_f32 v62,v62,s87,-v12
v_fma_f32 v63,v63,s87,-v12
v_fma_f32 v68,v68,s87,-v12
v_exp_f32 v60,v60
v_exp_f32 v61,v61
v_exp_f32 v62,v62
v_exp_f32 v63,v63
v_exp_f32 v68,v68
v_cvt_pk_bf16_f32 v70,v60,v61
v_cvt_pk_bf16_f32 v71,v62,v63
v_cndmask_b32 v46,v70,v10,vcc
v_cndmask_b32 v47,v71,v10,vcc
v_cndmask_b32_dpp v44,v70,v10,vcc quad_perm:[2,3,0,1] row_mask:0xf bank_mask:0xf
v_cndmask_b32_dpp v45,v71,v10,vcc quad_perm:[2,3,0,1] row_mask:0xf bank_mask:0xf
s_mov_b64 vcc,s[90:91]
s_waitcnt lgkmcnt(0)
v_cndmask_b32 v40,v70,v10,vcc
v_mfma_f32_16x16x32_bf16 v[64:67],v[28:31],v[44:47],0
v_cndmask_b32 v41,v71,v10,vcc
v_cndmask_b32_dpp v42,v70,v10,vcc quad_perm:[2,3,0,1] row_mask:0xf bank_mask:0xf
v_mfma_f32_16x16x32_bf16 v[52:55],v[36:39],v[44:47],0
v_cndmask_b32_dpp v43,v71,v10,vcc quad_perm:[2,3,0,1] row_mask:0xf bank_mask:0xf
v_mov_b32_dpp v14,v68 quad_perm:[2,3,0,1] row_mask:0xf bank_mask:0xf
v_add_f32 v12,v60,v61
v_mfma_f32_16x16x32_bf16 v[64:67],v[24:27],v[40:43],v[64:67]
v_cvt_pk_bf16_f32 v56,v68,v14
v_cvt_pk_bf16_f32 v57,v14,v68
v_mov_b32 v16,s50
v_mfma_f32_16x16x32_bf16 v[52:55],v[32:35],v[40:43],v[52:55]
v_cndmask_b32 v56,v56,v10,vcc
v_cndmask_b32 v57,v10,v57,vcc
v_add_f32 v13,v62,v63
v_add_f32 v12,v12,v68
s_waitcnt vmcnt(1)
v_mfma_f32_16x16x16_bf16 v[64:67],v[48:49],v[56:57],v[64:67]
v_add_f32 v12,v12,v13
v_bitop3_b32 v17,v48,v50,s57 bitop3:0x7e
v_mfma_f32_16x16x16_bf16 v[52:55],v[50:51],v[56:57],v[52:55]
v_add_f32_dpp v13,v12,v12 quad_perm:[2,3,0,1] row_mask:0xf bank_mask:0xf
v_add_f32_dpp v12,v12,v12 quad_perm:[2,3,0,1] row_mask:0xf bank_mask:0xf
v_and_b32 v17,1,v17
v_cmp_ne_u32 vcc,0,v17
v_permlane32_swap_b32 v12,v13
v_add_f32 v15,v12,v13
v_add_f32 v12,v12,v13
s_cmp_lg_u64 vcc,0
s_cselect_b32 s60,1,0
v_permlane16_swap_b32 v12,v15
v_add_f32 v12,v12,v15
v_rcp_f32 v12,v12
s_xor_b32 s61,s57,s60
v_pk_mul_f32 v[64:65],v[64:65],v[12:13] op_sel_hi:[1,0]
v_pk_mul_f32 v[66:67],v[66:67],v[12:13] op_sel_hi:[1,0]
v_pk_mul_f32 v[52:53],v[52:53],v[12:13] op_sel_hi:[1,0]
v_pk_mul_f32 v[54:55],v[54:55],v[12:13] op_sel_hi:[1,0]
v_cvt_pk_bf16_f32 v48,v64,v65
v_cvt_pk_bf16_f32 v49,v66,v67
v_cvt_pk_bf16_f32 v50,v52,v53
v_cvt_pk_bf16_f32 v51,v54,v55
v_and_or_b32 v48,v48,-2,s61
buffer_store_dwordx4 v[48:51],v8,s[8:11],s70 offen sc1
ds_read_b32 v0,v9
ds_write_b32 v20,v16
s_or_b32 s61,s60,s76
s_cbranch_scc1 od_106
ct_107:
s_barrier
buffer_load_dwordx2 v[80:81],v18,s[8:11],s59 offen sc1
buffer_load_dwordx4 v[72:75],v1,s[8:11],s59 offen sc1
buffer_load_dwordx4 v[76:79],v1,s[8:11],s59 offen offset:1024 sc1
s_waitcnt lgkmcnt(0)
v_cmp_ne_u32 vcc,s50,v0
s_mov_b32 s57,s31
s_cbranch_vccnz fj_104w
buffer_load_dwordx2 v[90:91],v18,s[8:11],s68 offen sc1
buffer_load_dwordx4 v[82:85],v1,s[8:11],s68 offen sc1
buffer_load_dwordx4 v[86:89],v1,s[8:11],s68 offen offset:1024 sc1
s_branch fj_104z
fr_103:
v_bitop3_b32 v12,v72,v76,s57 bitop3:0x7e
v_bitop3_b32 v13,v80,v80,s57 bitop3:0x7e
v_xor_b32 v14,s57,v80
v_or3_b32 v12,v12,v13,v14
v_and_b32 v12,1,v12
v_cmp_ne_u32 vcc,0,v12
s_cbranch_vccz sk_109
buffer_load_dwordx2 v[80:81],v18,s[8:11],s59 offen sc1
buffer_load_dwordx4 v[72:75],v1,s[8:11],s59 offen sc1
buffer_load_dwordx4 v[76:79],v1,s[8:11],s59 offen offset:1024 sc1
sk_109:
buffer_load_dwordx2 v[90:91],v18,s[8:11],s68 offen sc1
buffer_load_dwordx4 v[82:85],v1,s[8:11],s68 offen sc1
buffer_load_dwordx4 v[86:89],v1,s[8:11],s68 offen offset:1024 sc1
s_sub_u32 s47,s47,1
s_cbranch_scc1 ABORT
s_waitcnt lgkmcnt(0)
s_branch fa_102
ec_105r:
buffer_load_dwordx2 v[90:91],v18,s[8:11],s68 offen sc1
buffer_load_dwordx4 v[82:85],v1,s[8:11],s68 offen sc1
buffer_load_dwordx4 v[86:89],v1,s[8:11],s68 offen offset:1024 sc1
v_and_b32 v17,1,v16
v_cmp_ne_u32 vcc,0,v17
s_nop 0
s_cbranch_vccnz fr_103
v_lshlrev_b32 v92,16,v72
v_and_b32 v93,0xffff0000,v72
v_lshlrev_b32 v94,16,v73
v_and_b32 v95,0xffff0000,v73
v_lshlrev_b32 v96,16,v74
v_and_b32 v97,0xffff0000,v74
v_lshlrev_b32 v98,16,v75
v_and_b32 v99,0xffff0000,v75
v_lshlrev_b32 v108,16,v80
v_and_b32 v109,0xffff0000,v80
v_lshlrev_b32 v110,16,v81
v_and_b32 v111,0xffff0000,v81
s_sub_u32 s47,s47,1
s_cbranch_scc1 ABORT
s_branch ec_105
od_106:
s_cmp_eq_u32 s60,0
s_cbranch_scc1 CS_DONE
vb_110:
s_sub_u32 s47,s47,1
s_cbranch_scc1 ABORT
buffer_load_dwordx4 v[48:51],v1,s[8:11],s71 offen sc1
s_waitcnt vmcnt(0)
v_bitop3_b32 v17,v48,v50,s57 bitop3:0x7e
v_and_b32 v17,1,v17
v_cmp_ne_u32 vcc,0,v17
s_nop 0
s_cbranch_vccnz vb_110
v_mfma_f32_16x16x32_bf16 v[64:67],v[28:31],v[44:47],0
v_mfma_f32_16x16x32_bf16 v[52:55],v[36:39],v[44:47],0
v_mfma_f32_16x16x32_bf16 v[64:67],v[24:27],v[40:43],v[64:67]
v_mfma_f32_16x16x32_bf16 v[52:55],v[32:35],v[40:43],v[52:55]
v_mfma_f32_16x16x16_bf16 v[64:67],v[48:49],v[56:57],v[64:67]
v_mfma_f32_16x16x16_bf16 v[52:55],v[50:51],v[56:57],v[52:55]
s_nop 4
v_pk_mul_f32 v[64:65],v[64:65],v[12:13] op_sel_hi:[1,0]
v_pk_mul_f32 v[66:67],v[66:67],v[12:13] op_sel_hi:[1,0]
s_nop 0
v_pk_mul_f32 v[52:53],v[52:53],v[12:13] op_sel_hi:[1,0]
v_pk_mul_f32 v[54:55],v[54:55],v[12:13] op_sel_hi:[1,0]
v_cvt_pk_bf16_f32 v48,v64,v65
v_cvt_pk_bf16_f32 v49,v66,v67
v_cvt_pk_bf16_f32 v50,v52,v53
v_cvt_pk_bf16_f32 v51,v54,v55
v_and_or_b32 v48,v48,-2,s57
buffer_store_dwordx4 v[48:51],v8,s[8:11],s70 offen sc1
s_cmp_lg_u32 s76,0
s_cbranch_scc1 CS_DONE
s_branch ct_107
CH_START:
s_sub_u32 s60,s4,s5
s_cmp_gt_i32 s60,13
s_cselect_b32 s53,1,0
s_cmp_eq_u32 s4,64
s_cselect_b32 s53,1,s53
s_cmp_eq_u32 s53,0
s_cselect_b32 s54,s4,s5
s_addc_u32 s4,s4,0
s_add_u32 s5,s5,s53
s_sub_u32 s60,s4,s5
s_cmp_gt_i32 s60,13
s_cselect_b32 s55,1,0
s_cmp_eq_u32 s4,64
s_cselect_b32 s55,1,s55
s_cmp_eq_u32 s55,0
s_cselect_b32 s56,s4,s5
s_addc_u32 s4,s4,0
s_add_u32 s5,s5,s55
s_mov_b32 s74,81920
s_mul_i32 s73,s52,393216
s_add_u32 s73,s73,s84
s_lshl_b32 s75,s51,6
s_add_u32 s75,s75,s52
s_lshl_b32 s75,s75,9
s_add_u32 s75,s75,131072
fl_111:
buffer_load_dword v12,v9,s[8:11],s75 offen sc1
s_waitcnt vmcnt(0)
v_cmp_eq_u32 vcc,0,v12
s_nop 0
s_cbranch_vccz ok_112
s_sleep 1
s_sub_u32 s47,s47,1
s_cbranch_scc1 ABORT
s_branch fl_111
ok_112:
s_add_u32 m0,s74,0
s_add_u32 s67,s73,0
buffer_load_dwordx4 v1,s[8:11],s67 offen sc1 lds
buffer_load_dwordx4 v1,s[8:11],s67 offen offset:1024 sc1 lds
buffer_load_dwordx4 v1,s[8:11],s67 offen offset:2048 sc1 lds
buffer_load_dwordx4 v1,s[8:11],s67 offen offset:3072 sc1 lds
s_add_u32 m0,s74,4096
s_add_u32 s67,s73,4096
buffer_load_dwordx4 v1,s[8:11],s67 offen sc1 lds
buffer_load_dwordx4 v1,s[8:11],s67 offen offset:1024 sc1 lds
buffer_load_dwordx4 v1,s[8:11],s67 offen offset:2048 sc1 lds
buffer_load_dwordx4 v1,s[8:11],s67 offen offset:3072 sc1 lds
s_add_u32 m0,s74,8192
s_add_u32 s67,s73,8192
buffer_load_dwordx4 v1,s[8:11],s67 offen sc1 lds
buffer_load_dwordx4 v1,s[8:11],s67 offen offset:1024 sc1 lds
buffer_load_dwordx4 v1,s[8:11],s67 offen offset:2048 sc1 lds
buffer_load_dwordx4 v1,s[8:11],s67 offen offset:3072 sc1 lds
s_add_u32 m0,s74,12288
s_add_u32 s67,s73,25165824
buffer_load_dwordx4 v1,s[8:11],s67 offen sc1 lds
buffer_load_dwordx4 v1,s[8:11],s67 offen offset:1024 sc1 lds
buffer_load_dwordx4 v1,s[8:11],s67 offen offset:2048 sc1 lds
buffer_load_dwordx4 v1,s[8:11],s67 offen offset:3072 sc1 lds
s_add_u32 m0,s74,16384
s_add_u32 s67,s73,25169920
buffer_load_dwordx4 v1,s[8:11],s67 offen sc1 lds
buffer_load_dwordx4 v1,s[8:11],s67 offen offset:1024 sc1 lds
buffer_load_dwordx4 v1,s[8:11],s67 offen offset:2048 sc1 lds
buffer_load_dwordx4 v1,s[8:11],s67 offen offset:3072 sc1 lds
s_add_u32 m0,s74,20480
s_add_u32 s67,s73,25174016
buffer_load_dwordx4 v1,s[8:11],s67 offen sc1 lds
buffer_load_dwordx4 v1,s[8:11],s67 offen offset:1024 sc1 lds
buffer_load_dwordx4 v1,s[8:11],s67 offen offset:2048 sc1 lds
buffer_load_dwordx4 v1,s[8:11],s67 offen offset:3072 sc1 lds
s_mov_b32 s74,106496
s_mul_i32 s73,s54,393216
s_add_u32 s73,s73,s84
s_lshl_b32 s75,s53,6
s_add_u32 s75,s75,s54
s_lshl_b32 s75,s75,9
s_add_u32 s75,s75,131072
s_lshl_b32 s76,s55,6
s_add_u32 s76,s76,s56
s_lshl_b32 s76,s76,9
s_add_u32 s76,s76,131072
s_mov_b32 s77,1
v_min_u32 v8,2,v0
v_lshlrev_b32 v8,2,v8
v_add_u32 v8,147456,v8
v_mov_b32 v58,147468
s_mov_b32 s80,0
s_mov_b32 s70,2147483648
s_mov_b32 s71,0
s_mov_b32 s72,2147483648
v_mov_b32 v24,0
v_mov_b32 v25,0
v_mov_b32 v26,0
v_mov_b32 v27,0
v_mov_b32 v28,0
v_mov_b32 v29,0
v_mov_b32 v30,0
v_mov_b32 v31,0
v_mov_b32 v32,0
v_mov_b32 v33,0
v_mov_b32 v34,0
v_mov_b32 v35,0
v_mov_b32 v36,0
v_mov_b32 v37,0
v_mov_b32 v38,0
v_mov_b32 v39,0
v_mov_b32 v40,0
v_mov_b32 v41,0
v_mov_b32 v42,0
v_mov_b32 v43,0
v_mov_b32 v44,0
v_mov_b32 v45,0
v_mov_b32 v46,0
v_mov_b32 v47,0
s_nop 1
CH_LOOP:
v_mov_b32 v14,s50
s_nop 1
db_116:
buffer_load_dword v12,v11,s[8:11],s69 offen sc1
s_waitcnt vmcnt(0)
v_cmp_gt_u32 vcc,s58,v12
s_cbranch_vccz dbok_117
s_sub_u32 s47,s47,1
s_cbranch_scc1 ABORT
s_branch db_116
dbok_117:
ds_write_b32 v58,v14
buffer_load_dwordx2 v[68:69],v18,s[8:11],s59 offen sc1
buffer_load_dwordx4 v[60:63],v1,s[8:11],s59 offen sc1
buffer_load_dwordx4 v[64:67],v1,s[8:11],s59 offen offset:1024 sc1
s_barrier
fj_115w:
s_waitcnt vmcnt(2)
fj_115f:
buffer_load_dwordx2 v[78:79],v18,s[8:11],s68 offen sc1
buffer_load_dwordx4 v[70:73],v1,s[8:11],s68 offen sc1
buffer_load_dwordx4 v[74:77],v1,s[8:11],s68 offen offset:1024 sc1
fj_115z:
s_mov_b64 vcc,s[90:91]
ds_read_b64_tr_b16 v[100:101],v7 offset:0
ds_read_b64_tr_b16 v[102:103],v7 offset:512
ds_read_b64_tr_b16 v[48:49],v7 offset:1024
ds_read_b64_tr_b16 v[50:51],v7 offset:1536
ds_read_b64_tr_b16 v[104:105],v7 offset:2048
ds_read_b64_tr_b16 v[106:107],v7 offset:2560
ds_read_b64_tr_b16 v[52:53],v7 offset:3072
ds_read_b64_tr_b16 v[54:55],v7 offset:3584
ds_read_b64_tr_b16 v[108:109],v7 offset:4096
ds_read_b64_tr_b16 v[110:111],v7 offset:4608
ds_read_b64_tr_b16 v[12:13],v7 offset:5120
ds_read_b64_tr_b16 v[14:15],v7 offset:5632
s_waitcnt lgkmcnt(8)
v_cndmask_b32_dpp v100,v48,v100,vcc quad_perm:[0,1,0,1] row_mask:0xf bank_mask:0xf
v_cndmask_b32_dpp v101,v49,v101,vcc quad_perm:[0,1,0,1] row_mask:0xf bank_mask:0xf
v_cndmask_b32_dpp v102,v50,v102,vcc quad_perm:[0,1,0,1] row_mask:0xf bank_mask:0xf
v_cndmask_b32_dpp v103,v51,v103,vcc quad_perm:[0,1,0,1] row_mask:0xf bank_mask:0xf
v_and_or_b32 v100,v100,-2,s28
s_waitcnt lgkmcnt(4)
v_cndmask_b32_dpp v104,v52,v104,vcc quad_perm:[0,1,0,1] row_mask:0xf bank_mask:0xf
v_cndmask_b32_dpp v105,v53,v105,vcc quad_perm:[0,1,0,1] row_mask:0xf bank_mask:0xf
v_cndmask_b32_dpp v106,v54,v106,vcc quad_perm:[0,1,0,1] row_mask:0xf bank_mask:0xf
v_cndmask_b32_dpp v107,v55,v107,vcc quad_perm:[0,1,0,1] row_mask:0xf bank_mask:0xf
v_and_or_b32 v104,v104,-2,s28
s_waitcnt lgkmcnt(0)
v_cndmask_b32_dpp v108,v12,v108,vcc quad_perm:[0,1,0,1] row_mask:0xf bank_mask:0xf
v_cndmask_b32_dpp v109,v13,v109,vcc quad_perm:[0,1,0,1] row_mask:0xf bank_mask:0xf
v_cndmask_b32_dpp v110,v14,v110,vcc quad_perm:[0,1,0,1] row_mask:0xf bank_mask:0xf
v_cndmask_b32_dpp v111,v15,v111,vcc quad_perm:[0,1,0,1] row_mask:0xf bank_mask:0xf
v_and_or_b32 v108,v108,-2,s28
fj_115:
fa_113:
s_waitcnt vmcnt(5)
v_lshlrev_b32 v96,16,v68
v_and_b32 v97,0xffff0000,v68
v_lshlrev_b32 v98,16,v69
v_and_b32 v99,0xffff0000,v69
s_waitcnt vmcnt(4)
v_lshlrev_b32 v80,16,v60
v_and_b32 v81,0xffff0000,v60
v_lshlrev_b32 v82,16,v61
v_and_b32 v83,0xffff0000,v61
v_lshlrev_b32 v84,16,v62
v_and_b32 v85,0xffff0000,v62
v_lshlrev_b32 v86,16,v63
v_and_b32 v87,0xffff0000,v63
s_waitcnt vmcnt(3)
v_lshlrev_b32 v88,16,v64
v_and_b32 v89,0xffff0000,v64
v_lshlrev_b32 v90,16,v65
v_and_b32 v91,0xffff0000,v65
v_lshlrev_b32 v92,16,v66
v_and_b32 v93,0xffff0000,v66
v_lshlrev_b32 v94,16,v67
v_and_b32 v95,0xffff0000,v67
v_bitop3_b32 v16,v60,v64,s57 bitop3:0x7e
v_bitop3_b32 v16,v16,v68,s57 bitop3:0xf6
ec_118:
s_waitcnt vmcnt(2)
v_dot2c_f32_bf16 v96,s37,v78
v_dot2c_f32_bf16 v97,s81,v78
v_dot2c_f32_bf16 v98,s37,v79
v_dot2c_f32_bf16 v99,s81,v79
s_waitcnt vmcnt(1)
v_bitop3_b32 v17,v70,v78,s57 bitop3:0x7e
s_waitcnt vmcnt(0)
v_bitop3_b32 v17,v17,v74,s57 bitop3:0xf6
v_bitop3_b32 v17,v16,v17,1 bitop3:0xa8
v_cmp_ne_u32 vcc,0,v17
v_cvt_pk_bf16_f32 v56,v96,v97
v_cvt_pk_bf16_f32 v57,v98,v99
ds_write_b64 v23,v[56:57]
s_cbranch_vccnz ec_118r
v_dot2c_f32_bf16 v80,s37,v70
v_dot2c_f32_bf16 v81,s81,v70
v_dot2c_f32_bf16 v82,s37,v71
v_dot2c_f32_bf16 v83,s81,v71
v_dot2c_f32_bf16 v84,s37,v72
v_dot2c_f32_bf16 v85,s81,v72
v_dot2c_f32_bf16 v86,s37,v73
v_dot2c_f32_bf16 v87,s81,v73
v_cvt_pk_bf16_f32 v48,v80,v81
v_cvt_pk_bf16_f32 v49,v82,v83
v_cvt_pk_bf16_f32 v50,v84,v85
v_cvt_pk_bf16_f32 v51,v86,v87
ds_write_b128 v22,v[48:51] offset:0
v_dot2c_f32_bf16 v88,s37,v74
v_dot2c_f32_bf16 v89,s81,v74
v_dot2c_f32_bf16 v90,s37,v75
v_dot2c_f32_bf16 v91,s81,v75
v_dot2c_f32_bf16 v92,s37,v76
v_dot2c_f32_bf16 v93,s81,v76
v_dot2c_f32_bf16 v94,s37,v77
v_dot2c_f32_bf16 v95,s81,v77
v_cvt_pk_bf16_f32 v52,v88,v89
v_cvt_pk_bf16_f32 v53,v90,v91
v_cvt_pk_bf16_f32 v54,v92,v93
v_cvt_pk_bf16_f32 v55,v94,v95
ds_write_b128 v22,v[52:55] offset:1024
fj_115g:
s_cmp_lt_u32 s70,2147483648
s_cbranch_scc1 CH_XV
CH_XVB:
v_smfmac_f32_16x16x64_bf16 v[24:27],v[48:51],a[0:7],v2
ds_read_b128 v[72:75],v21 offset:0
s_and_b32 s60,s54,1
v_smfmac_f32_16x16x64_bf16 v[28:31],v[48:51],a[8:15],v2
ds_read_b128 v[76:79],v21 offset:1024
s_lshl2_add_u32 s60,s53,s60
v_smfmac_f32_16x16x64_bf16 v[32:35],v[48:51],a[16:23],v2
ds_read_b128 v[80:83],v21 offset:2048
s_lshl_b32 s68,s60,16
v_smfmac_f32_16x16x64_bf16 v[36:39],v[48:51],a[24:31],v2
ds_read_b128 v[84:87],v21 offset:3072
s_add_u32 s68,s68,s83
s_waitcnt lgkmcnt(4)
s_barrier
v_smfmac_f32_16x16x64_bf16 v[40:43],v[48:51],a[32:39],v2
ds_read_b128 v[60:63],v3 offset:0
s_mul_i32 s59,s60,20480
v_smfmac_f32_16x16x64_bf16 v[24:27],v[52:55],a[40:47],v2
ds_read_b128 v[64:67],v3 offset:1024
s_add_u32 s59,s59,s6
v_smfmac_f32_16x16x64_bf16 v[28:31],v[52:55],a[48:55],v2
ds_read_b128 v[68:71],v4 offset:0
s_lshl_b32 s69,s53,9
v_smfmac_f32_16x16x64_bf16 v[32:35],v[52:55],a[56:63],v2
s_add_u32 m0,s74,0
s_add_u32 s67,s73,0
s_add_u32 s69,s69,s7
v_smfmac_f32_16x16x64_bf16 v[36:39],v[52:55],a[64:71],v2
buffer_load_dwordx4 v1,s[8:11],s67 offen sc1 lds
s_bfe_u32 s31,s54,65537
v_smfmac_f32_16x16x64_bf16 v[40:43],v[52:55],a[72:79],v2
buffer_load_dwordx4 v1,s[8:11],s67 offen offset:1024 sc1 lds
s_waitcnt lgkmcnt(5)
v_smfmac_f32_16x16x64_bf16 v[44:47],v[48:51],v[72:79],v2
ds_read_b128 v[72:75],v21 offset:4096
s_waitcnt lgkmcnt(4)
v_smfmac_f32_16x16x64_bf16 v[44:47],v[52:55],v[80:87],v2
ds_read_b128 v[76:79],v21 offset:5120
s_waitcnt lgkmcnt(4)
v_smfmac_f32_16x16x64_bf16 v[24:27],v[60:63],a[80:87],v2
ds_read_b128 v[80:83],v21 offset:6144
s_add_u32 s32,s54,1
v_smfmac_f32_16x16x64_bf16 v[28:31],v[60:63],a[88:95],v2
ds_read_b128 v[84:87],v21 offset:7168
v_smfmac_f32_16x16x64_bf16 v[32:35],v[60:63],a[96:103],v2
buffer_load_dwordx4 v1,s[8:11],s67 offen offset:2048 sc1 lds
v_smfmac_f32_16x16x64_bf16 v[36:39],v[60:63],a[104:111],v2
buffer_load_dwordx4 v1,s[8:11],s67 offen offset:3072 sc1 lds
v_smfmac_f32_16x16x64_bf16 v[40:43],v[60:63],a[112:119],v2
s_add_u32 m0,s74,4096
s_add_u32 s67,s73,4096
s_waitcnt lgkmcnt(2)
v_smfmac_f32_16x16x64_bf16 v[44:47],v[60:63],v[72:79],v2
ds_read_b128 v[60:63],v4 offset:1024
v_smfmac_f32_16x16x64_bf16 v[24:27],v[64:67],a[120:127],v2
ds_read_b128 v[72:75],v21 offset:8192
v_smfmac_f32_16x16x64_bf16 v[28:31],v[64:67],a[128:135],v2
ds_read_b128 v[76:79],v21 offset:9216
v_smfmac_f32_16x16x64_bf16 v[32:35],v[64:67],a[136:143],v2
buffer_store_dwordx4 v[100:103],v1,s[8:11],s78 offen sc1
v_smfmac_f32_16x16x64_bf16 v[36:39],v[64:67],a[144:151],v2
buffer_store_dwordx4 v[104:107],v1,s[8:11],s78 offen offset:1024 sc1
v_smfmac_f32_16x16x64_bf16 v[40:43],v[64:67],a[152:159],v2
buffer_store_dwordx4 v[108:111],v1,s[8:11],s78 offen offset:2048 sc1
s_waitcnt lgkmcnt(3)
v_smfmac_f32_16x16x64_bf16 v[44:47],v[64:67],v[80:87],v2
ds_read_b128 v[64:67],v5 offset:0
s_mov_b32 s78,2147483648
v_smfmac_f32_16x16x64_bf16 v[24:27],v[68:71],a[160:167],v2
ds_read_b128 v[80:83],v21 offset:10240
v_smfmac_f32_16x16x64_bf16 v[28:31],v[68:71],a[168:175],v2
ds_read_b128 v[84:87],v21 offset:11264
v_smfmac_f32_16x16x64_bf16 v[32:35],v[68:71],a[176:183],v2
buffer_load_dword v10,v9,s[8:11],s76 offen sc1
v_smfmac_f32_16x16x64_bf16 v[36:39],v[68:71],a[184:191],v2
buffer_load_dwordx4 v1,s[8:11],s67 offen sc1 lds
v_smfmac_f32_16x16x64_bf16 v[40:43],v[68:71],a[192:199],v2
buffer_load_dwordx4 v1,s[8:11],s67 offen offset:1024 sc1 lds
s_waitcnt lgkmcnt(3)
v_smfmac_f32_16x16x64_bf16 v[44:47],v[68:71],v[72:79],v2
ds_read_b128 v[68:71],v5 offset:1024
v_smfmac_f32_16x16x64_bf16 v[24:27],v[60:63],a[200:207],v2
ds_read_b128 v[72:75],v21 offset:12288
v_smfmac_f32_16x16x64_bf16 v[28:31],v[60:63],a[208:215],v2
ds_read_b128 v[76:79],v21 offset:13312
v_smfmac_f32_16x16x64_bf16 v[32:35],v[60:63],a[216:223],v2
buffer_load_dwordx4 v1,s[8:11],s67 offen offset:2048 sc1 lds
v_smfmac_f32_16x16x64_bf16 v[36:39],v[60:63],a[224:231],v2
buffer_load_dwordx4 v1,s[8:11],s67 offen offset:3072 sc1 lds
v_smfmac_f32_16x16x64_bf16 v[40:43],v[60:63],a[232:239],v2
s_add_u32 m0,s74,8192
s_add_u32 s67,s73,8192
s_waitcnt lgkmcnt(3)
v_smfmac_f32_16x16x64_bf16 v[44:47],v[60:63],v[80:87],v2
ds_read_b128 v[60:63],v59 offset:0
v_smfmac_f32_16x16x64_bf16 v[24:27],v[64:67],a[240:247],v2
ds_read_b128 v[80:83],v21 offset:14336
v_smfmac_f32_16x16x64_bf16 v[28:31],v[64:67],a[248:255],v2
ds_read_b128 v[84:87],v21 offset:15360
v_smfmac_f32_16x16x64_bf16 v[32:35],v[64:67],v[112:119],v2
buffer_load_dwordx4 v1,s[8:11],s67 offen sc1 lds
v_smfmac_f32_16x16x64_bf16 v[36:39],v[64:67],v[120:127],v2
buffer_load_dwordx4 v1,s[8:11],s67 offen offset:1024 sc1 lds
v_smfmac_f32_16x16x64_bf16 v[40:43],v[64:67],v[128:135],v2
buffer_load_dwordx4 v1,s[8:11],s67 offen offset:2048 sc1 lds
s_waitcnt lgkmcnt(3)
v_smfmac_f32_16x16x64_bf16 v[44:47],v[64:67],v[72:79],v2
ds_read_b128 v[64:67],v59 offset:1024
v_smfmac_f32_16x16x64_bf16 v[24:27],v[68:71],v[136:143],v2
ds_read_b128 v[72:75],v21 offset:16384
v_smfmac_f32_16x16x64_bf16 v[28:31],v[68:71],v[144:151],v2
ds_read_b128 v[76:79],v21 offset:17408
v_smfmac_f32_16x16x64_bf16 v[32:35],v[68:71],v[152:159],v2
buffer_load_dwordx4 v1,s[8:11],s67 offen offset:3072 sc1 lds
v_smfmac_f32_16x16x64_bf16 v[36:39],v[68:71],v[160:167],v2
buffer_load_dword v0,v9,s[8:11],s72 offen sc1
v_smfmac_f32_16x16x64_bf16 v[40:43],v[68:71],v[168:175],v2
s_waitcnt lgkmcnt(3)
v_smfmac_f32_16x16x64_bf16 v[44:47],v[68:71],v[80:87],v2
ds_read_b128 v[80:83],v21 offset:18432
v_smfmac_f32_16x16x64_bf16 v[24:27],v[60:63],v[176:183],v2
ds_read_b128 v[84:87],v21 offset:19456
v_smfmac_f32_16x16x64_bf16 v[36:39],v[60:63],v[200:207],v2
s_waitcnt lgkmcnt(4)
v_smfmac_f32_16x16x64_bf16 v[24:27],v[64:67],v[216:223],v2
v_smfmac_f32_16x16x64_bf16 v[36:39],v[64:67],v[240:247],v2
v_smfmac_f32_16x16x64_bf16 v[28:31],v[60:63],v[184:191],v2
v_smfmac_f32_16x16x64_bf16 v[40:43],v[60:63],v[208:215],v2
v_add_f32 v24,v24,v25
v_smfmac_f32_16x16x64_bf16 v[28:31],v[64:67],v[224:231],v2
v_add_f32 v26,v26,v27
v_smfmac_f32_16x16x64_bf16 v[40:43],v[64:67],v[248:255],v2
v_add_f32 v36,v36,v37
v_smfmac_f32_16x16x64_bf16 v[32:35],v[60:63],v[192:199],v2
v_add_f32 v38,v38,v39
s_waitcnt lgkmcnt(2)
v_smfmac_f32_16x16x64_bf16 v[44:47],v[60:63],v[72:79],v2
v_cvt_pk_bf16_f32 v37,v24,v26
v_smfmac_f32_16x16x64_bf16 v[32:35],v[64:67],v[232:239],v2
v_cvt_pk_bf16_f32 v36,v36,v38
s_waitcnt lgkmcnt(0)
v_smfmac_f32_16x16x64_bf16 v[44:47],v[64:67],v[80:87],v2
ds_write_b64 v6,v[36:37] offset:0
v_add_f32 v28,v28,v29
v_add_f32 v30,v30,v31
v_add_f32 v40,v40,v41
v_add_f32 v42,v42,v43
v_cvt_pk_bf16_f32 v41,v28,v30
v_cvt_pk_bf16_f32 v40,v40,v42
ds_write_b64 v6,v[40:41] offset:512
v_add_f32 v32,v32,v33
v_add_f32 v34,v34,v35
v_add_f32 v44,v44,v45
v_add_f32 v46,v46,v47
v_cvt_pk_bf16_f32 v45,v32,v34
v_cvt_pk_bf16_f32 v44,v44,v46
ds_write_b64 v6,v[44:45] offset:1024
s_waitcnt vmcnt(17)
s_waitcnt lgkmcnt(0)
s_barrier
buffer_load_dword v16,v11,s[8:11],s69 offen sc1
s_and_b32 s60,s52,15
s_lshl4_add_u32 s60,s51,s60
s_mul_i32 s78,s60,196608
s_add_u32 s78,s78,s85
s_bfe_u32 s28,s52,0x10004
s_cmp_ge_u32 s54,63
s_cselect_b32 s77,0,s77
s_cmp_eq_u32 s53,s51
s_cselect_b32 s60,1,s77
s_cmp_eq_u32 s60,0
s_cbranch_scc0 h1_119
h2_120:
s_add_u32 s50,s50,1
s_mov_b32 s51,s53
s_mov_b32 s52,s54
s_mov_b32 s57,s31
s_mov_b32 s58,s32
s_mov_b32 s53,s55
s_mov_b32 s54,s56
s_mov_b32 s75,s76
s_sub_u32 s60,s4,s5
s_cmp_gt_i32 s60,13
s_cselect_b32 s55,1,0
s_cmp_eq_u32 s4,64
s_cselect_b32 s55,1,s55
s_cmp_eq_u32 s55,0
s_cselect_b32 s56,s4,s5
s_addc_u32 s4,s4,0
s_add_u32 s5,s5,s55
s_lshl_b32 s76,s55,6
s_add_u32 s76,s76,s56
s_lshl_b32 s76,s76,9
s_add_u32 s76,s76,131072
s_mul_i32 s73,s54,393216
s_add_u32 s73,s73,s84
s_xor_b32 s74,s74,57344
v_mov_b32 v24,0
v_mov_b32 v25,0
v_mov_b32 v26,0
v_mov_b32 v27,0
v_mov_b32 v28,0
v_mov_b32 v29,0
v_mov_b32 v30,0
v_mov_b32 v31,0
v_mov_b32 v32,0
v_mov_b32 v33,0
v_mov_b32 v34,0
v_mov_b32 v35,0
v_mov_b32 v36,0
v_mov_b32 v37,0
v_mov_b32 v38,0
v_mov_b32 v39,0
v_mov_b32 v40,0
v_mov_b32 v41,0
v_mov_b32 v42,0
v_mov_b32 v43,0
v_mov_b32 v44,0
v_mov_b32 v45,0
v_mov_b32 v46,0
v_mov_b32 v47,0
s_waitcnt vmcnt(0)
v_cmp_eq_u32 vcc,0,v10
s_cmp_lg_u64 vcc,0
s_cselect_b32 s77,1,0
s_cselect_b32 s72,s75,2147483648
v_cmp_gt_u32 vcc,s58,v16
s_nop 0
s_cbranch_vccz CH_RUNG
s_cmp_lt_u32 s50,128
s_cbranch_scc1 CH_LOOP
s_branch CS_DONE
h1_119:
s_cmp_eq_u32 s53,s51
s_cbranch_scc1 c1_121
s_waitcnt vmcnt(0)
v_cmp_eq_u32 vcc,0,v0
s_nop 0
s_cbranch_vccz c2_122
fl_123:
buffer_load_dword v12,v9,s[8:11],s75 offen sc1
s_waitcnt vmcnt(0)
v_cmp_eq_u32 vcc,0,v12
s_nop 0
s_cbranch_vccz ok_124
s_sleep 1
s_sub_u32 s47,s47,1
s_cbranch_scc1 ABORT
s_branch fl_123
ok_124:
c2_122:
s_add_u32 m0,s74,0
s_add_u32 s67,s73,0
buffer_load_dwordx4 v1,s[8:11],s67 offen sc1 lds
buffer_load_dwordx4 v1,s[8:11],s67 offen offset:1024 sc1 lds
buffer_load_dwordx4 v1,s[8:11],s67 offen offset:2048 sc1 lds
buffer_load_dwordx4 v1,s[8:11],s67 offen offset:3072 sc1 lds
s_add_u32 m0,s74,4096
s_add_u32 s67,s73,4096
buffer_load_dwordx4 v1,s[8:11],s67 offen sc1 lds
buffer_load_dwordx4 v1,s[8:11],s67 offen offset:1024 sc1 lds
buffer_load_dwordx4 v1,s[8:11],s67 offen offset:2048 sc1 lds
buffer_load_dwordx4 v1,s[8:11],s67 offen offset:3072 sc1 lds
s_add_u32 m0,s74,8192
s_add_u32 s67,s73,8192
buffer_load_dwordx4 v1,s[8:11],s67 offen sc1 lds
buffer_load_dwordx4 v1,s[8:11],s67 offen offset:1024 sc1 lds
buffer_load_dwordx4 v1,s[8:11],s67 offen offset:2048 sc1 lds
buffer_load_dwordx4 v1,s[8:11],s67 offen offset:3072 sc1 lds
buffer_load_dword v16,v11,s[8:11],s69 offen sc1
s_mov_b32 s70,s73
s_mov_b32 s71,s74
s_branch h2_120
c1_121:
s_mov_b64 vcc,s[90:91]
ds_read_b64_tr_b16 v[100:101],v7 offset:0
ds_read_b64_tr_b16 v[102:103],v7 offset:512
ds_read_b64_tr_b16 v[48:49],v7 offset:1024
ds_read_b64_tr_b16 v[50:51],v7 offset:1536
ds_read_b64_tr_b16 v[104:105],v7 offset:2048
ds_read_b64_tr_b16 v[106:107],v7 offset:2560
ds_read_b64_tr_b16 v[52:53],v7 offset:3072
ds_read_b64_tr_b16 v[54:55],v7 offset:3584
ds_read_b64_tr_b16 v[108:109],v7 offset:4096
ds_read_b64_tr_b16 v[110:111],v7 offset:4608
ds_read_b64_tr_b16 v[12:13],v7 offset:5120
ds_read_b64_tr_b16 v[14:15],v7 offset:5632
s_waitcnt lgkmcnt(8)
v_cndmask_b32_dpp v100,v48,v100,vcc quad_perm:[0,1,0,1] row_mask:0xf bank_mask:0xf
v_cndmask_b32_dpp v101,v49,v101,vcc quad_perm:[0,1,0,1] row_mask:0xf bank_mask:0xf
v_cndmask_b32_dpp v102,v50,v102,vcc quad_perm:[0,1,0,1] row_mask:0xf bank_mask:0xf
v_cndmask_b32_dpp v103,v51,v103,vcc quad_perm:[0,1,0,1] row_mask:0xf bank_mask:0xf
v_and_or_b32 v100,v100,-2,s28
s_waitcnt lgkmcnt(4)
v_cndmask_b32_dpp v104,v52,v104,vcc quad_perm:[0,1,0,1] row_mask:0xf bank_mask:0xf
v_cndmask_b32_dpp v105,v53,v105,vcc quad_perm:[0,1,0,1] row_mask:0xf bank_mask:0xf
v_cndmask_b32_dpp v106,v54,v106,vcc quad_perm:[0,1,0,1] row_mask:0xf bank_mask:0xf
v_cndmask_b32_dpp v107,v55,v107,vcc quad_perm:[0,1,0,1] row_mask:0xf bank_mask:0xf
v_and_or_b32 v104,v104,-2,s28
s_waitcnt lgkmcnt(0)
v_cndmask_b32_dpp v108,v12,v108,vcc quad_perm:[0,1,0,1] row_mask:0xf bank_mask:0xf
v_cndmask_b32_dpp v109,v13,v109,vcc quad_perm:[0,1,0,1] row_mask:0xf bank_mask:0xf
v_cndmask_b32_dpp v110,v14,v110,vcc quad_perm:[0,1,0,1] row_mask:0xf bank_mask:0xf
v_cndmask_b32_dpp v111,v15,v111,vcc quad_perm:[0,1,0,1] row_mask:0xf bank_mask:0xf
v_and_or_b32 v108,v108,-2,s28
s_cmp_eq_u32 s50,127
s_cbranch_scc1 sp_125x
sp_125:
ds_read_b32 v12,v8
s_waitcnt lgkmcnt(0)
v_cmp_ge_u32 vcc,s50,v12
s_nop 0
s_cbranch_vccz ok_126
s_sleep 1
s_sub_u32 s47,s47,1
s_cbranch_scc1 ABORT
s_branch sp_125
ok_126:
sp_125x:
s_waitcnt vmcnt(0)
s_cmp_ge_u32 s79,2147483648
s_cbranch_scc1 pf_127
v_mov_b32 v17,1
s_mov_b64 exec,1
buffer_store_dword v17,v1,s[8:11],s79 offen sc1
s_mov_b64 exec,-1
s_mov_b32 s79,2147483648
pf_127:
s_cmp_eq_u32 s78,2147483648
s_cbranch_scc1 pk_128
buffer_store_dwordx4 v[100:103],v1,s[8:11],s78 offen sc1
buffer_store_dwordx4 v[104:107],v1,s[8:11],s78 offen offset:1024 sc1
buffer_store_dwordx4 v[108:111],v1,s[8:11],s78 offen offset:2048 sc1
s_mov_b32 s79,s30
s_mov_b32 s78,2147483648
pk_128:
s_waitcnt vmcnt(0)
s_cmp_ge_u32 s79,2147483648
s_cbranch_scc1 pf_129
v_mov_b32 v17,1
s_mov_b64 exec,1
buffer_store_dword v17,v1,s[8:11],s79 offen sc1
s_mov_b64 exec,-1
s_mov_b32 s79,2147483648
pf_129:
s_cmp_eq_u32 s77,0
s_cbranch_scc1 h2_120
fl_130:
buffer_load_dword v12,v9,s[8:11],s75 offen sc1
s_waitcnt vmcnt(0)
v_cmp_eq_u32 vcc,0,v12
s_nop 0
s_cbranch_vccz ok_131
s_sleep 1
s_sub_u32 s47,s47,1
s_cbranch_scc1 ABORT
s_branch fl_130
ok_131:
s_add_u32 m0,s74,0
s_add_u32 s67,s73,0
buffer_load_dwordx4 v1,s[8:11],s67 offen sc1 lds
buffer_load_dwordx4 v1,s[8:11],s67 offen offset:1024 sc1 lds
buffer_load_dwordx4 v1,s[8:11],s67 offen offset:2048 sc1 lds
buffer_load_dwordx4 v1,s[8:11],s67 offen offset:3072 sc1 lds
s_add_u32 m0,s74,4096
s_add_u32 s67,s73,4096
buffer_load_dwordx4 v1,s[8:11],s67 offen sc1 lds
buffer_load_dwordx4 v1,s[8:11],s67 offen offset:1024 sc1 lds
buffer_load_dwordx4 v1,s[8:11],s67 offen offset:2048 sc1 lds
buffer_load_dwordx4 v1,s[8:11],s67 offen offset:3072 sc1 lds
s_add_u32 m0,s74,8192
s_add_u32 s67,s73,8192
buffer_load_dwordx4 v1,s[8:11],s67 offen sc1 lds
buffer_load_dwordx4 v1,s[8:11],s67 offen offset:1024 sc1 lds
buffer_load_dwordx4 v1,s[8:11],s67 offen offset:2048 sc1 lds
buffer_load_dwordx4 v1,s[8:11],s67 offen offset:3072 sc1 lds
s_add_u32 m0,s74,12288
s_add_u32 s67,s73,25165824
buffer_load_dwordx4 v1,s[8:11],s67 offen sc1 lds
buffer_load_dwordx4 v1,s[8:11],s67 offen offset:1024 sc1 lds
buffer_load_dwordx4 v1,s[8:11],s67 offen offset:2048 sc1 lds
buffer_load_dwordx4 v1,s[8:11],s67 offen offset:3072 sc1 lds
s_add_u32 m0,s74,16384
s_add_u32 s67,s73,25169920
buffer_load_dwordx4 v1,s[8:11],s67 offen sc1 lds
buffer_load_dwordx4 v1,s[8:11],s67 offen offset:1024 sc1 lds
buffer_load_dwordx4 v1,s[8:11],s67 offen offset:2048 sc1 lds
buffer_load_dwordx4 v1,s[8:11],s67 offen offset:3072 sc1 lds
s_add_u32 m0,s74,20480
s_add_u32 s67,s73,25174016
buffer_load_dwordx4 v1,s[8:11],s67 offen sc1 lds
buffer_load_dwordx4 v1,s[8:11],s67 offen offset:1024 sc1 lds
buffer_load_dwordx4 v1,s[8:11],s67 offen offset:2048 sc1 lds
buffer_load_dwordx4 v1,s[8:11],s67 offen offset:3072 sc1 lds
s_branch h2_120
fr_114:
v_bitop3_b32 v12,v60,v64,s57 bitop3:0x7e
v_bitop3_b32 v13,v68,v68,s57 bitop3:0x7e
v_xor_b32 v14,s57,v68
v_or3_b32 v12,v12,v13,v14
v_and_b32 v12,1,v12
v_cmp_ne_u32 vcc,0,v12
s_cbranch_vccz sk_132
buffer_load_dwordx2 v[68:69],v18,s[8:11],s59 offen sc1
buffer_load_dwordx4 v[60:63],v1,s[8:11],s59 offen sc1
buffer_load_dwordx4 v[64:67],v1,s[8:11],s59 offen offset:1024 sc1
sk_132:
buffer_load_dwordx2 v[78:79],v18,s[8:11],s68 offen sc1
buffer_load_dwordx4 v[70:73],v1,s[8:11],s68 offen sc1
buffer_load_dwordx4 v[74:77],v1,s[8:11],s68 offen offset:1024 sc1
s_sub_u32 s47,s47,1
s_cbranch_scc1 ABORT
s_waitcnt lgkmcnt(0)
s_branch fa_113
CH_RUNG:
v_mov_b32 v14,s50
ds_write_b32 v58,v14
buffer_load_dwordx2 v[68:69],v18,s[8:11],s59 offen sc1
buffer_load_dwordx4 v[60:63],v1,s[8:11],s59 offen sc1
buffer_load_dwordx4 v[64:67],v1,s[8:11],s59 offen offset:1024 sc1
fj_115e:
buffer_load_dwordx2 v[78:79],v18,s[8:11],s68 offen sc1
buffer_load_dwordx4 v[70:73],v1,s[8:11],s68 offen sc1
buffer_load_dwordx4 v[74:77],v1,s[8:11],s68 offen offset:1024 sc1
s_mov_b64 vcc,s[90:91]
ds_read_b64_tr_b16 v[100:101],v7 offset:0
ds_read_b64_tr_b16 v[102:103],v7 offset:512
ds_read_b64_tr_b16 v[48:49],v7 offset:1024
ds_read_b64_tr_b16 v[50:51],v7 offset:1536
ds_read_b64_tr_b16 v[104:105],v7 offset:2048
ds_read_b64_tr_b16 v[106:107],v7 offset:2560
ds_read_b64_tr_b16 v[52:53],v7 offset:3072
ds_read_b64_tr_b16 v[54:55],v7 offset:3584
ds_read_b64_tr_b16 v[108:109],v7 offset:4096
ds_read_b64_tr_b16 v[110:111],v7 offset:4608
ds_read_b64_tr_b16 v[12:13],v7 offset:5120
ds_read_b64_tr_b16 v[14:15],v7 offset:5632
s_waitcnt lgkmcnt(8)
v_cndmask_b32_dpp v100,v48,v100,vcc quad_perm:[0,1,0,1] row_mask:0xf bank_mask:0xf
v_cndmask_b32_dpp v101,v49,v101,vcc quad_perm:[0,1,0,1] row_mask:0xf bank_mask:0xf
v_cndmask_b32_dpp v102,v50,v102,vcc quad_perm:[0,1,0,1] row_mask:0xf bank_mask:0xf
v_cndmask_b32_dpp v103,v51,v103,vcc quad_perm:[0,1,0,1] row_mask:0xf bank_mask:0xf
v_and_or_b32 v100,v100,-2,s28
s_waitcnt lgkmcnt(4)
v_cndmask_b32_dpp v104,v52,v104,vcc quad_perm:[0,1,0,1] row_mask:0xf bank_mask:0xf
v_cndmask_b32_dpp v105,v53,v105,vcc quad_perm:[0,1,0,1] row_mask:0xf bank_mask:0xf
v_cndmask_b32_dpp v106,v54,v106,vcc quad_perm:[0,1,0,1] row_mask:0xf bank_mask:0xf
v_cndmask_b32_dpp v107,v55,v107,vcc quad_perm:[0,1,0,1] row_mask:0xf bank_mask:0xf
v_and_or_b32 v104,v104,-2,s28
s_waitcnt lgkmcnt(0)
v_cndmask_b32_dpp v108,v12,v108,vcc quad_perm:[0,1,0,1] row_mask:0xf bank_mask:0xf
v_cndmask_b32_dpp v109,v13,v109,vcc quad_perm:[0,1,0,1] row_mask:0xf bank_mask:0xf
v_cndmask_b32_dpp v110,v14,v110,vcc quad_perm:[0,1,0,1] row_mask:0xf bank_mask:0xf
v_cndmask_b32_dpp v111,v15,v111,vcc quad_perm:[0,1,0,1] row_mask:0xf bank_mask:0xf
v_and_or_b32 v108,v108,-2,s28
s_barrier
s_branch fj_115
ec_118r:
buffer_load_dwordx2 v[78:79],v18,s[8:11],s68 offen sc1
buffer_load_dwordx4 v[70:73],v1,s[8:11],s68 offen sc1
buffer_load_dwordx4 v[74:77],v1,s[8:11],s68 offen offset:1024 sc1
v_and_b32 v17,1,v16
v_cmp_ne_u32 vcc,0,v17
s_nop 0
s_cbranch_vccnz fr_114
v_lshlrev_b32 v80,16,v60
v_and_b32 v81,0xffff0000,v60
v_lshlrev_b32 v82,16,v61
v_and_b32 v83,0xffff0000,v61
v_lshlrev_b32 v84,16,v62
v_and_b32 v85,0xffff0000,v62
v_lshlrev_b32 v86,16,v63
v_and_b32 v87,0xffff0000,v63
v_lshlrev_b32 v96,16,v68
v_and_b32 v97,0xffff0000,v68
v_lshlrev_b32 v98,16,v69
v_and_b32 v99,0xffff0000,v69
s_sub_u32 s47,s47,1
s_cbranch_scc1 ABORT
s_branch ec_118
CH_XV:
s_add_u32 m0,s71,12288
s_add_u32 s67,s70,25165824
buffer_load_dwordx4 v1,s[8:11],s67 offen sc1 lds
buffer_load_dwordx4 v1,s[8:11],s67 offen offset:1024 sc1 lds
buffer_load_dwordx4 v1,s[8:11],s67 offen offset:2048 sc1 lds
buffer_load_dwordx4 v1,s[8:11],s67 offen offset:3072 sc1 lds
s_add_u32 m0,s71,16384
s_add_u32 s67,s70,25169920
buffer_load_dwordx4 v1,s[8:11],s67 offen sc1 lds
buffer_load_dwordx4 v1,s[8:11],s67 offen offset:1024 sc1 lds
buffer_load_dwordx4 v1,s[8:11],s67 offen offset:2048 sc1 lds
buffer_load_dwordx4 v1,s[8:11],s67 offen offset:3072 sc1 lds
s_add_u32 m0,s71,20480
s_add_u32 s67,s70,25174016
buffer_load_dwordx4 v1,s[8:11],s67 offen sc1 lds
buffer_load_dwordx4 v1,s[8:11],s67 offen offset:1024 sc1 lds
buffer_load_dwordx4 v1,s[8:11],s67 offen offset:2048 sc1 lds
buffer_load_dwordx4 v1,s[8:11],s67 offen offset:3072 sc1 lds
s_mov_b32 s70,2147483648
s_branch CH_XVB
CS_DONE:
v_lshrrev_b32 v0,4,v1
s_add_u32 s61,s48,0
s_endpgm
CV_START:
s_and_b32 s60,s46,1
s_lshl1_add_u32 s60,s49,s60
s_cmp_eq_u32 s60,1
s_cbranch_scc1 CV_LOOP_F1
s_cmp_eq_u32 s60,2
s_cbranch_scc1 CV_LOOP_S0
s_cmp_eq_u32 s60,3
s_cbranch_scc1 CV_LOOP_S1
CV_LOOP_F0:
v_mov_b32 v24,0
v_mov_b32 v25,0
v_mov_b32 v26,0
v_mov_b32 v27,0
v_mov_b32 v28,0
v_mov_b32 v29,0
v_mov_b32 v30,0
v_mov_b32 v31,0
v_mov_b32 v32,0
v_mov_b32 v33,0
v_mov_b32 v34,0
v_mov_b32 v35,0
v_mov_b32 v36,0
v_mov_b32 v37,0
v_mov_b32 v38,0
v_mov_b32 v39,0
v_mov_b32 v40,0
v_mov_b32 v41,0
v_mov_b32 v42,0
v_mov_b32 v43,0
v_mov_b32 v44,0
v_mov_b32 v45,0
v_mov_b32 v46,0
v_mov_b32 v47,0
s_cmp_lg_u32 s46,0
s_cbranch_scc1 np_136
db_137:
buffer_load_dword v12,v11,s[8:11],s69 offen sc1
s_waitcnt vmcnt(0)
v_cmp_gt_u32 vcc,s58,v12
s_cbranch_vccz dbok_138
s_sub_u32 s47,s47,1
s_cbranch_scc1 ABORT
s_branch db_137
dbok_138:
np_136:
s_barrier
buffer_load_dwordx2 v[68:69],v18,s[8:11],s59 offen sc1
buffer_load_dwordx4 v[60:63],v1,s[8:11],s59 offen sc1
buffer_load_dwordx4 v[64:67],v1,s[8:11],s59 offen offset:1024 sc1
fj_135w:
s_waitcnt vmcnt(2)
fj_135f:
buffer_load_dwordx2 v[78:79],v18,s[8:11],s68 offen sc1
buffer_load_dwordx4 v[70:73],v1,s[8:11],s68 offen sc1
buffer_load_dwordx4 v[74:77],v1,s[8:11],s68 offen offset:1024 sc1
fj_135z:
fj_135:
fa_133:
s_waitcnt vmcnt(5)
v_lshlrev_b32 v96,16,v68
v_and_b32 v97,0xffff0000,v68
v_lshlrev_b32 v98,16,v69
v_and_b32 v99,0xffff0000,v69
s_waitcnt vmcnt(4)
v_lshlrev_b32 v80,16,v60
v_and_b32 v81,0xffff0000,v60
v_lshlrev_b32 v82,16,v61
v_and_b32 v83,0xffff0000,v61
v_lshlrev_b32 v84,16,v62
v_and_b32 v85,0xffff0000,v62
v_lshlrev_b32 v86,16,v63
v_and_b32 v87,0xffff0000,v63
s_waitcnt vmcnt(3)
v_lshlrev_b32 v88,16,v64
v_and_b32 v89,0xffff0000,v64
v_lshlrev_b32 v90,16,v65
v_and_b32 v91,0xffff0000,v65
v_lshlrev_b32 v92,16,v66
v_and_b32 v93,0xffff0000,v66
v_lshlrev_b32 v94,16,v67
v_and_b32 v95,0xffff0000,v67
v_bitop3_b32 v16,v60,v64,s57 bitop3:0x7e
v_bitop3_b32 v16,v16,v68,s57 bitop3:0xf6
ec_139:
s_waitcnt vmcnt(2)
v_dot2c_f32_bf16 v96,s37,v78
v_dot2c_f32_bf16 v97,s81,v78
v_dot2c_f32_bf16 v98,s37,v79
v_dot2c_f32_bf16 v99,s81,v79
s_waitcnt vmcnt(1)
v_bitop3_b32 v17,v70,v78,s57 bitop3:0x7e
s_waitcnt vmcnt(0)
v_bitop3_b32 v17,v17,v74,s57 bitop3:0xf6
v_bitop3_b32 v17,v16,v17,1 bitop3:0xa8
v_cmp_ne_u32 vcc,0,v17
v_cvt_pk_bf16_f32 v56,v96,v97
v_cvt_pk_bf16_f32 v57,v98,v99
ds_write_b64 v23,v[56:57]
s_cbranch_vccnz ec_139r
v_dot2c_f32_bf16 v80,s37,v70
v_dot2c_f32_bf16 v81,s81,v70
v_dot2c_f32_bf16 v82,s37,v71
v_dot2c_f32_bf16 v83,s81,v71
v_dot2c_f32_bf16 v84,s37,v72
v_dot2c_f32_bf16 v85,s81,v72
v_dot2c_f32_bf16 v86,s37,v73
v_dot2c_f32_bf16 v87,s81,v73
v_cvt_pk_bf16_f32 v48,v80,v81
v_cvt_pk_bf16_f32 v49,v82,v83
v_cvt_pk_bf16_f32 v50,v84,v85
v_cvt_pk_bf16_f32 v51,v86,v87
ds_write_b128 v22,v[48:51] offset:0
v_dot2c_f32_bf16 v88,s37,v74
v_dot2c_f32_bf16 v89,s81,v74
v_dot2c_f32_bf16 v90,s37,v75
v_dot2c_f32_bf16 v91,s81,v75
v_dot2c_f32_bf16 v92,s37,v76
v_dot2c_f32_bf16 v93,s81,v76
v_dot2c_f32_bf16 v94,s37,v77
v_dot2c_f32_bf16 v95,s81,v77
v_cvt_pk_bf16_f32 v52,v88,v89
v_cvt_pk_bf16_f32 v53,v90,v91
v_cvt_pk_bf16_f32 v54,v92,v93
v_cvt_pk_bf16_f32 v55,v94,v95
ds_write_b128 v22,v[52:55] offset:1024
fj_135g:
v_smfmac_f32_16x16x64_bf16 v[24:27],v[48:51],a[0:7],v2
ds_read_b128 v[72:75],v21 offset:0
s_and_b32 s60,s52,1
v_smfmac_f32_16x16x64_bf16 v[28:31],v[48:51],a[8:15],v2
ds_read_b128 v[76:79],v21 offset:1024
s_lshl2_add_u32 s60,s51,s60
v_smfmac_f32_16x16x64_bf16 v[32:35],v[48:51],a[16:23],v2
ds_read_b128 v[80:83],v21 offset:2048
s_mul_i32 s60,s60,49152
v_smfmac_f32_16x16x64_bf16 v[36:39],v[48:51],a[24:31],v2
ds_read_b128 v[84:87],v21 offset:3072
s_add_u32 s71,s60,s34
s_waitcnt lgkmcnt(4)
s_barrier
v_smfmac_f32_16x16x64_bf16 v[40:43],v[48:51],a[32:39],v2
ds_read_b128 v[60:63],v3 offset:0
v_smfmac_f32_16x16x64_bf16 v[24:27],v[52:55],a[40:47],v2
ds_read_b128 v[64:67],v3 offset:1024
v_smfmac_f32_16x16x64_bf16 v[28:31],v[52:55],a[48:55],v2
ds_read_b128 v[68:71],v4 offset:0
v_smfmac_f32_16x16x64_bf16 v[32:35],v[52:55],a[56:63],v2
buffer_store_dwordx4 v[100:103],v1,s[8:11],s78 offen sc1
v_smfmac_f32_16x16x64_bf16 v[36:39],v[52:55],a[64:71],v2
buffer_store_dwordx2 v[104:105],v8,s[8:11],s78 offen offset:1024 sc1
s_mov_b32 s78,2147483648
v_smfmac_f32_16x16x64_bf16 v[40:43],v[52:55],a[72:79],v2
s_waitcnt lgkmcnt(5)
v_smfmac_f32_16x16x64_bf16 v[44:47],v[48:51],v[72:79],v2
ds_read_b128 v[72:75],v21 offset:4096
s_waitcnt lgkmcnt(4)
v_smfmac_f32_16x16x64_bf16 v[44:47],v[52:55],v[80:87],v2
ds_read_b128 v[76:79],v21 offset:5120
s_waitcnt lgkmcnt(4)
v_smfmac_f32_16x16x64_bf16 v[24:27],v[60:63],a[80:87],v2
ds_read_b128 v[80:83],v21 offset:6144
v_smfmac_f32_16x16x64_bf16 v[28:31],v[60:63],a[88:95],v2
ds_read_b128 v[84:87],v21 offset:7168
v_smfmac_f32_16x16x64_bf16 v[32:35],v[60:63],a[96:103],v2
v_smfmac_f32_16x16x64_bf16 v[36:39],v[60:63],a[104:111],v2
v_smfmac_f32_16x16x64_bf16 v[40:43],v[60:63],a[112:119],v2
s_waitcnt lgkmcnt(2)
v_smfmac_f32_16x16x64_bf16 v[44:47],v[60:63],v[72:79],v2
ds_read_b128 v[60:63],v4 offset:1024
v_smfmac_f32_16x16x64_bf16 v[24:27],v[64:67],a[120:127],v2
ds_read_b128 v[72:75],v21 offset:8192
v_smfmac_f32_16x16x64_bf16 v[28:31],v[64:67],a[128:135],v2
ds_read_b128 v[76:79],v21 offset:9216
v_smfmac_f32_16x16x64_bf16 v[32:35],v[64:67],a[136:143],v2
v_smfmac_f32_16x16x64_bf16 v[36:39],v[64:67],a[144:151],v2
v_smfmac_f32_16x16x64_bf16 v[40:43],v[64:67],a[152:159],v2
s_waitcnt lgkmcnt(3)
v_smfmac_f32_16x16x64_bf16 v[44:47],v[64:67],v[80:87],v2
ds_read_b128 v[64:67],v5 offset:0
v_smfmac_f32_16x16x64_bf16 v[24:27],v[68:71],a[160:167],v2
ds_read_b128 v[80:83],v21 offset:10240
v_smfmac_f32_16x16x64_bf16 v[28:31],v[68:71],a[168:175],v2
ds_read_b128 v[84:87],v21 offset:11264
v_smfmac_f32_16x16x64_bf16 v[32:35],v[68:71],a[176:183],v2
v_smfmac_f32_16x16x64_bf16 v[36:39],v[68:71],a[184:191],v2
v_smfmac_f32_16x16x64_bf16 v[40:43],v[68:71],a[192:199],v2
s_waitcnt lgkmcnt(3)
v_smfmac_f32_16x16x64_bf16 v[44:47],v[68:71],v[72:79],v2
ds_read_b128 v[68:71],v5 offset:1024
v_smfmac_f32_16x16x64_bf16 v[24:27],v[60:63],a[200:207],v2
ds_read_b128 v[72:75],v21 offset:12288
v_smfmac_f32_16x16x64_bf16 v[28:31],v[60:63],a[208:215],v2
ds_read_b128 v[76:79],v21 offset:13312
v_smfmac_f32_16x16x64_bf16 v[32:35],v[60:63],a[216:223],v2
v_smfmac_f32_16x16x64_bf16 v[36:39],v[60:63],a[224:231],v2
v_smfmac_f32_16x16x64_bf16 v[40:43],v[60:63],a[232:239],v2
s_waitcnt lgkmcnt(3)
v_smfmac_f32_16x16x64_bf16 v[44:47],v[60:63],v[80:87],v2
ds_read_b128 v[60:63],v59 offset:0
v_smfmac_f32_16x16x64_bf16 v[24:27],v[64:67],a[240:247],v2
ds_read_b128 v[80:83],v21 offset:14336
v_smfmac_f32_16x16x64_bf16 v[28:31],v[64:67],a[248:255],v2
ds_read_b128 v[84:87],v21 offset:15360
v_smfmac_f32_16x16x64_bf16 v[32:35],v[64:67],v[112:119],v2
v_smfmac_f32_16x16x64_bf16 v[36:39],v[64:67],v[120:127],v2
v_smfmac_f32_16x16x64_bf16 v[40:43],v[64:67],v[128:135],v2
s_waitcnt lgkmcnt(3)
v_smfmac_f32_16x16x64_bf16 v[44:47],v[64:67],v[72:79],v2
ds_read_b128 v[64:67],v59 offset:1024
v_smfmac_f32_16x16x64_bf16 v[24:27],v[68:71],v[136:143],v2
ds_read_b128 v[72:75],v21 offset:16384
v_smfmac_f32_16x16x64_bf16 v[28:31],v[68:71],v[144:151],v2
ds_read_b128 v[76:79],v21 offset:17408
v_smfmac_f32_16x16x64_bf16 v[32:35],v[68:71],v[152:159],v2
v_smfmac_f32_16x16x64_bf16 v[36:39],v[68:71],v[160:167],v2
v_smfmac_f32_16x16x64_bf16 v[40:43],v[68:71],v[168:175],v2
s_waitcnt lgkmcnt(3)
v_smfmac_f32_16x16x64_bf16 v[44:47],v[68:71],v[80:87],v2
ds_read_b128 v[80:83],v21 offset:18432
v_smfmac_f32_16x16x64_bf16 v[24:27],v[60:63],v[176:183],v2
ds_read_b128 v[84:87],v21 offset:19456
v_smfmac_f32_16x16x64_bf16 v[28:31],v[60:63],v[184:191],v2
s_waitcnt lgkmcnt(4)
v_smfmac_f32_16x16x64_bf16 v[24:27],v[64:67],v[216:223],v2
v_smfmac_f32_16x16x64_bf16 v[28:31],v[64:67],v[224:231],v2
v_smfmac_f32_16x16x64_bf16 v[32:35],v[60:63],v[192:199],v2
v_smfmac_f32_16x16x64_bf16 v[36:39],v[60:63],v[200:207],v2
v_add_f32 v24,v24,v25
v_smfmac_f32_16x16x64_bf16 v[32:35],v[64:67],v[232:239],v2
v_add_f32 v26,v26,v27
v_smfmac_f32_16x16x64_bf16 v[36:39],v[64:67],v[240:247],v2
v_add_f32 v28,v28,v29
v_smfmac_f32_16x16x64_bf16 v[40:43],v[60:63],v[208:215],v2
v_add_f32 v30,v30,v31
s_waitcnt lgkmcnt(2)
v_smfmac_f32_16x16x64_bf16 v[44:47],v[60:63],v[72:79],v2
v_cvt_pk_bf16_f32 v100,v24,v26
v_smfmac_f32_16x16x64_bf16 v[40:43],v[64:67],v[248:255],v2
v_cvt_pk_bf16_f32 v101,v28,v30
s_waitcnt lgkmcnt(0)
v_smfmac_f32_16x16x64_bf16 v[44:47],v[64:67],v[80:87],v2
v_and_or_b32 v100,v100,-2,s57
v_add_f32 v32,v32,v33
v_add_f32 v34,v34,v35
v_add_f32 v36,v36,v37
v_add_f32 v38,v38,v39
v_cvt_pk_bf16_f32 v102,v32,v34
v_cvt_pk_bf16_f32 v103,v36,v38
v_and_or_b32 v102,v102,-2,s57
buffer_store_dwordx4 v[100:103],v6,s[8:11],s71 offen
v_add_f32 v40,v40,v41
v_add_f32 v42,v42,v43
v_add_f32 v44,v44,v45
v_add_f32 v46,v46,v47
v_cvt_pk_bf16_f32 v104,v40,v42
v_cvt_pk_bf16_f32 v105,v44,v46
v_and_or_b32 v104,v104,-2,s57
buffer_store_dwordx2 v[104:105],v7,s[8:11],s71 offen
s_and_b32 s60,s52,15
s_lshl4_add_u32 s60,s51,s60
s_mul_i32 s78,s60,196608
s_add_u32 s78,s78,s85
s_bfe_u32 s28,s52,0x10004
v_and_or_b32 v100,v100,-2,s28
v_and_or_b32 v104,v104,-2,s28
s_sub_u32 s60,s4,s5
s_cmp_gt_i32 s60,13
s_cselect_b32 s53,1,0
s_cmp_eq_u32 s4,64
s_cselect_b32 s53,1,s53
s_cmp_eq_u32 s53,0
s_cselect_b32 s54,s4,s5
s_addc_u32 s4,s4,0
s_add_u32 s5,s5,s53
s_and_b32 s60,s54,1
s_lshl2_add_u32 s60,s53,s60
s_lshl_b32 s68,s60,16
s_add_u32 s68,s68,s83
s_mul_i32 s59,s60,20480
s_add_u32 s59,s59,s6
s_lshl_b32 s69,s53,9
s_add_u32 s69,s69,s7
s_bfe_u32 s31,s54,65537
s_add_u32 s32,s54,1
s_cmp_lg_u32 s53,s51
s_cbranch_scc1 nx_140
s_waitcnt vmcnt(0)
s_cmp_ge_u32 s79,2147483648
s_cbranch_scc1 pf_141
v_mov_b32 v17,1
s_mov_b64 exec,1
buffer_store_dword v17,v1,s[8:11],s79 offen sc1
s_mov_b64 exec,-1
s_mov_b32 s79,2147483648
pf_141:
s_cmp_eq_u32 s78,2147483648
s_cbranch_scc1 pk_142
buffer_store_dwordx4 v[100:103],v1,s[8:11],s78 offen sc1
buffer_store_dwordx2 v[104:105],v8,s[8:11],s78 offen offset:1024 sc1
s_mov_b32 s79,s30
s_mov_b32 s78,2147483648
pk_142:
s_waitcnt vmcnt(0)
s_cmp_ge_u32 s79,2147483648
s_cbranch_scc1 pf_143
v_mov_b32 v17,1
s_mov_b64 exec,1
buffer_store_dword v17,v1,s[8:11],s79 offen sc1
s_mov_b64 exec,-1
s_mov_b32 s79,2147483648
pf_143:
nx_140:
s_add_u32 s50,s50,1
s_mov_b32 s51,s53
s_mov_b32 s52,s54
s_mov_b32 s57,s31
s_mov_b32 s58,s32
s_cmp_lt_u32 s50,128
s_cbranch_scc1 CV_LOOP_F0
s_branch CV_DONE
fr_134:
v_bitop3_b32 v12,v60,v64,s57 bitop3:0x7e
v_bitop3_b32 v13,v68,v68,s57 bitop3:0x7e
v_xor_b32 v14,s57,v68
v_or3_b32 v12,v12,v13,v14
v_and_b32 v12,1,v12
v_cmp_ne_u32 vcc,0,v12
s_cbranch_vccz sk_144
buffer_load_dwordx2 v[68:69],v18,s[8:11],s59 offen sc1
buffer_load_dwordx4 v[60:63],v1,s[8:11],s59 offen sc1
buffer_load_dwordx4 v[64:67],v1,s[8:11],s59 offen offset:1024 sc1
sk_144:
buffer_load_dwordx2 v[78:79],v18,s[8:11],s68 offen sc1
buffer_load_dwordx4 v[70:73],v1,s[8:11],s68 offen sc1
buffer_load_dwordx4 v[74:77],v1,s[8:11],s68 offen offset:1024 sc1
s_sub_u32 s47,s47,1
s_cbranch_scc1 ABORT
s_waitcnt lgkmcnt(0)
s_branch fa_133
ec_139r:
buffer_load_dwordx2 v[78:79],v18,s[8:11],s68 offen sc1
buffer_load_dwordx4 v[70:73],v1,s[8:11],s68 offen sc1
buffer_load_dwordx4 v[74:77],v1,s[8:11],s68 offen offset:1024 sc1
v_and_b32 v17,1,v16
v_cmp_ne_u32 vcc,0,v17
s_nop 0
s_cbranch_vccnz fr_134
v_lshlrev_b32 v80,16,v60
v_and_b32 v81,0xffff0000,v60
v_lshlrev_b32 v82,16,v61
v_and_b32 v83,0xffff0000,v61
v_lshlrev_b32 v84,16,v62
v_and_b32 v85,0xffff0000,v62
v_lshlrev_b32 v86,16,v63
v_and_b32 v87,0xffff0000,v63
v_lshlrev_b32 v96,16,v68
v_and_b32 v97,0xffff0000,v68
v_lshlrev_b32 v98,16,v69
v_and_b32 v99,0xffff0000,v69
s_sub_u32 s47,s47,1
s_cbranch_scc1 ABORT
s_branch ec_139
CV_LOOP_F1:
v_mov_b32 v24,0
v_mov_b32 v25,0
v_mov_b32 v26,0
v_mov_b32 v27,0
v_mov_b32 v28,0
v_mov_b32 v29,0
v_mov_b32 v30,0
v_mov_b32 v31,0
v_mov_b32 v32,0
v_mov_b32 v33,0
v_mov_b32 v34,0
v_mov_b32 v35,0
v_mov_b32 v36,0
v_mov_b32 v37,0
v_mov_b32 v38,0
v_mov_b32 v39,0
v_mov_b32 v40,0
v_mov_b32 v41,0
v_mov_b32 v42,0
v_mov_b32 v43,0
v_mov_b32 v44,0
v_mov_b32 v45,0
v_mov_b32 v46,0
v_mov_b32 v47,0
s_barrier
buffer_load_dwordx2 v[68:69],v18,s[8:11],s59 offen sc1
buffer_load_dwordx4 v[60:63],v1,s[8:11],s59 offen sc1
buffer_load_dwordx4 v[64:67],v1,s[8:11],s59 offen offset:1024 sc1
fj_147w:
s_waitcnt vmcnt(2)
fj_147f:
buffer_load_dwordx2 v[78:79],v18,s[8:11],s68 offen sc1
buffer_load_dwordx4 v[70:73],v1,s[8:11],s68 offen sc1
buffer_load_dwordx4 v[74:77],v1,s[8:11],s68 offen offset:1024 sc1
fj_147z:
fj_147:
fa_145:
s_waitcnt vmcnt(5)
v_lshlrev_b32 v96,16,v68
v_and_b32 v97,0xffff0000,v68
v_lshlrev_b32 v98,16,v69
v_and_b32 v99,0xffff0000,v69
s_waitcnt vmcnt(4)
v_lshlrev_b32 v80,16,v60
v_and_b32 v81,0xffff0000,v60
v_lshlrev_b32 v82,16,v61
v_and_b32 v83,0xffff0000,v61
v_lshlrev_b32 v84,16,v62
v_and_b32 v85,0xffff0000,v62
v_lshlrev_b32 v86,16,v63
v_and_b32 v87,0xffff0000,v63
s_waitcnt vmcnt(3)
v_lshlrev_b32 v88,16,v64
v_and_b32 v89,0xffff0000,v64
v_lshlrev_b32 v90,16,v65
v_and_b32 v91,0xffff0000,v65
v_lshlrev_b32 v92,16,v66
v_and_b32 v93,0xffff0000,v66
v_lshlrev_b32 v94,16,v67
v_and_b32 v95,0xffff0000,v67
v_bitop3_b32 v16,v60,v64,s57 bitop3:0x7e
v_bitop3_b32 v16,v16,v68,s57 bitop3:0xf6
ec_148:
s_waitcnt vmcnt(2)
v_dot2c_f32_bf16 v96,s37,v78
v_dot2c_f32_bf16 v97,s81,v78
v_dot2c_f32_bf16 v98,s37,v79
v_dot2c_f32_bf16 v99,s81,v79
s_waitcnt vmcnt(1)
v_bitop3_b32 v17,v70,v78,s57 bitop3:0x7e
s_waitcnt vmcnt(0)
v_bitop3_b32 v17,v17,v74,s57 bitop3:0xf6
v_bitop3_b32 v17,v16,v17,1 bitop3:0xa8
v_cmp_ne_u32 vcc,0,v17
v_cvt_pk_bf16_f32 v56,v96,v97
v_cvt_pk_bf16_f32 v57,v98,v99
ds_write_b64 v23,v[56:57]
s_cbranch_vccnz ec_148r
v_dot2c_f32_bf16 v80,s37,v70
v_dot2c_f32_bf16 v81,s81,v70
v_dot2c_f32_bf16 v82,s37,v71
v_dot2c_f32_bf16 v83,s81,v71
v_dot2c_f32_bf16 v84,s37,v72
v_dot2c_f32_bf16 v85,s81,v72
v_dot2c_f32_bf16 v86,s37,v73
v_dot2c_f32_bf16 v87,s81,v73
v_cvt_pk_bf16_f32 v48,v80,v81
v_cvt_pk_bf16_f32 v49,v82,v83
v_cvt_pk_bf16_f32 v50,v84,v85
v_cvt_pk_bf16_f32 v51,v86,v87
ds_write_b128 v22,v[48:51] offset:0
v_dot2c_f32_bf16 v88,s37,v74
v_dot2c_f32_bf16 v89,s81,v74
v_dot2c_f32_bf16 v90,s37,v75
v_dot2c_f32_bf16 v91,s81,v75
v_dot2c_f32_bf16 v92,s37,v76
v_dot2c_f32_bf16 v93,s81,v76
v_dot2c_f32_bf16 v94,s37,v77
v_dot2c_f32_bf16 v95,s81,v77
v_cvt_pk_bf16_f32 v52,v88,v89
v_cvt_pk_bf16_f32 v53,v90,v91
v_cvt_pk_bf16_f32 v54,v92,v93
v_cvt_pk_bf16_f32 v55,v94,v95
ds_write_b128 v22,v[52:55] offset:1024
fj_147g:
v_smfmac_f32_16x16x64_bf16 v[24:27],v[48:51],a[0:7],v2
ds_read_b128 v[72:75],v21 offset:0
s_and_b32 s60,s52,1
v_smfmac_f32_16x16x64_bf16 v[28:31],v[48:51],a[8:15],v2
ds_read_b128 v[76:79],v21 offset:1024
s_lshl2_add_u32 s60,s51,s60
v_smfmac_f32_16x16x64_bf16 v[32:35],v[48:51],a[16:23],v2
ds_read_b128 v[80:83],v21 offset:2048
s_mul_i32 s60,s60,49152
v_smfmac_f32_16x16x64_bf16 v[36:39],v[48:51],a[24:31],v2
ds_read_b128 v[84:87],v21 offset:3072
s_add_u32 s71,s60,s34
s_waitcnt lgkmcnt(4)
s_barrier
v_smfmac_f32_16x16x64_bf16 v[40:43],v[48:51],a[32:39],v2
ds_read_b128 v[60:63],v3 offset:0
v_smfmac_f32_16x16x64_bf16 v[24:27],v[52:55],a[40:47],v2
ds_read_b128 v[64:67],v3 offset:1024
v_smfmac_f32_16x16x64_bf16 v[28:31],v[52:55],a[48:55],v2
ds_read_b128 v[68:71],v4 offset:0
v_smfmac_f32_16x16x64_bf16 v[32:35],v[52:55],a[56:63],v2
buffer_store_dwordx4 v[100:103],v1,s[8:11],s78 offen offset:1536 sc1
v_smfmac_f32_16x16x64_bf16 v[36:39],v[52:55],a[64:71],v2
buffer_store_dwordx2 v[104:105],v8,s[8:11],s78 offen offset:2560 sc1
s_mov_b32 s78,2147483648
v_smfmac_f32_16x16x64_bf16 v[40:43],v[52:55],a[72:79],v2
s_waitcnt lgkmcnt(5)
v_smfmac_f32_16x16x64_bf16 v[44:47],v[48:51],v[72:79],v2
ds_read_b128 v[72:75],v21 offset:4096
s_waitcnt lgkmcnt(4)
v_smfmac_f32_16x16x64_bf16 v[44:47],v[52:55],v[80:87],v2
ds_read_b128 v[76:79],v21 offset:5120
s_waitcnt lgkmcnt(4)
v_smfmac_f32_16x16x64_bf16 v[24:27],v[60:63],a[80:87],v2
ds_read_b128 v[80:83],v21 offset:6144
v_smfmac_f32_16x16x64_bf16 v[28:31],v[60:63],a[88:95],v2
ds_read_b128 v[84:87],v21 offset:7168
v_smfmac_f32_16x16x64_bf16 v[32:35],v[60:63],a[96:103],v2
v_smfmac_f32_16x16x64_bf16 v[36:39],v[60:63],a[104:111],v2
v_smfmac_f32_16x16x64_bf16 v[40:43],v[60:63],a[112:119],v2
s_waitcnt lgkmcnt(2)
v_smfmac_f32_16x16x64_bf16 v[44:47],v[60:63],v[72:79],v2
ds_read_b128 v[60:63],v4 offset:1024
v_smfmac_f32_16x16x64_bf16 v[24:27],v[64:67],a[120:127],v2
ds_read_b128 v[72:75],v21 offset:8192
v_smfmac_f32_16x16x64_bf16 v[28:31],v[64:67],a[128:135],v2
ds_read_b128 v[76:79],v21 offset:9216
v_smfmac_f32_16x16x64_bf16 v[32:35],v[64:67],a[136:143],v2
v_smfmac_f32_16x16x64_bf16 v[36:39],v[64:67],a[144:151],v2
v_smfmac_f32_16x16x64_bf16 v[40:43],v[64:67],a[152:159],v2
s_waitcnt lgkmcnt(3)
v_smfmac_f32_16x16x64_bf16 v[44:47],v[64:67],v[80:87],v2
ds_read_b128 v[64:67],v5 offset:0
v_smfmac_f32_16x16x64_bf16 v[24:27],v[68:71],a[160:167],v2
ds_read_b128 v[80:83],v21 offset:10240
v_smfmac_f32_16x16x64_bf16 v[28:31],v[68:71],a[168:175],v2
ds_read_b128 v[84:87],v21 offset:11264
v_smfmac_f32_16x16x64_bf16 v[32:35],v[68:71],a[176:183],v2
v_smfmac_f32_16x16x64_bf16 v[36:39],v[68:71],a[184:191],v2
v_smfmac_f32_16x16x64_bf16 v[40:43],v[68:71],a[192:199],v2
s_waitcnt lgkmcnt(3)
v_smfmac_f32_16x16x64_bf16 v[44:47],v[68:71],v[72:79],v2
ds_read_b128 v[68:71],v5 offset:1024
v_smfmac_f32_16x16x64_bf16 v[24:27],v[60:63],a[200:207],v2
ds_read_b128 v[72:75],v21 offset:12288
v_smfmac_f32_16x16x64_bf16 v[28:31],v[60:63],a[208:215],v2
ds_read_b128 v[76:79],v21 offset:13312
v_smfmac_f32_16x16x64_bf16 v[32:35],v[60:63],a[216:223],v2
v_smfmac_f32_16x16x64_bf16 v[36:39],v[60:63],a[224:231],v2
v_smfmac_f32_16x16x64_bf16 v[40:43],v[60:63],a[232:239],v2
s_waitcnt lgkmcnt(3)
v_smfmac_f32_16x16x64_bf16 v[44:47],v[60:63],v[80:87],v2
ds_read_b128 v[60:63],v59 offset:0
v_smfmac_f32_16x16x64_bf16 v[24:27],v[64:67],a[240:247],v2
ds_read_b128 v[80:83],v21 offset:14336
v_smfmac_f32_16x16x64_bf16 v[28:31],v[64:67],a[248:255],v2
ds_read_b128 v[84:87],v21 offset:15360
v_smfmac_f32_16x16x64_bf16 v[32:35],v[64:67],v[112:119],v2
v_smfmac_f32_16x16x64_bf16 v[36:39],v[64:67],v[120:127],v2
v_smfmac_f32_16x16x64_bf16 v[40:43],v[64:67],v[128:135],v2
s_waitcnt lgkmcnt(3)
v_smfmac_f32_16x16x64_bf16 v[44:47],v[64:67],v[72:79],v2
ds_read_b128 v[64:67],v59 offset:1024
v_smfmac_f32_16x16x64_bf16 v[24:27],v[68:71],v[136:143],v2
ds_read_b128 v[72:75],v21 offset:16384
v_smfmac_f32_16x16x64_bf16 v[28:31],v[68:71],v[144:151],v2
ds_read_b128 v[76:79],v21 offset:17408
v_smfmac_f32_16x16x64_bf16 v[32:35],v[68:71],v[152:159],v2
v_smfmac_f32_16x16x64_bf16 v[36:39],v[68:71],v[160:167],v2
v_smfmac_f32_16x16x64_bf16 v[40:43],v[68:71],v[168:175],v2
s_waitcnt lgkmcnt(3)
v_smfmac_f32_16x16x64_bf16 v[44:47],v[68:71],v[80:87],v2
ds_read_b128 v[80:83],v21 offset:18432
v_smfmac_f32_16x16x64_bf16 v[24:27],v[60:63],v[176:183],v2
ds_read_b128 v[84:87],v21 offset:19456
v_smfmac_f32_16x16x64_bf16 v[28:31],v[60:63],v[184:191],v2
s_waitcnt lgkmcnt(4)
v_smfmac_f32_16x16x64_bf16 v[24:27],v[64:67],v[216:223],v2
v_smfmac_f32_16x16x64_bf16 v[28:31],v[64:67],v[224:231],v2
v_smfmac_f32_16x16x64_bf16 v[32:35],v[60:63],v[192:199],v2
v_smfmac_f32_16x16x64_bf16 v[36:39],v[60:63],v[200:207],v2
v_add_f32 v24,v24,v25
v_smfmac_f32_16x16x64_bf16 v[32:35],v[64:67],v[232:239],v2
v_add_f32 v26,v26,v27
v_smfmac_f32_16x16x64_bf16 v[36:39],v[64:67],v[240:247],v2
v_add_f32 v28,v28,v29
v_smfmac_f32_16x16x64_bf16 v[40:43],v[60:63],v[208:215],v2
v_add_f32 v30,v30,v31
s_waitcnt lgkmcnt(2)
v_smfmac_f32_16x16x64_bf16 v[44:47],v[60:63],v[72:79],v2
v_cvt_pk_bf16_f32 v100,v24,v26
v_smfmac_f32_16x16x64_bf16 v[40:43],v[64:67],v[248:255],v2
v_cvt_pk_bf16_f32 v101,v28,v30
s_waitcnt lgkmcnt(0)
v_smfmac_f32_16x16x64_bf16 v[44:47],v[64:67],v[80:87],v2
v_and_or_b32 v100,v100,-2,s57
buffer_store_dwordx2 v[100:101],v7,s[8:11],s71 offen
v_add_f32 v32,v32,v33
v_add_f32 v34,v34,v35
v_add_f32 v36,v36,v37
v_add_f32 v38,v38,v39
v_cvt_pk_bf16_f32 v102,v32,v34
v_cvt_pk_bf16_f32 v103,v36,v38
v_and_or_b32 v102,v102,-2,s57
v_add_f32 v40,v40,v41
v_add_f32 v42,v42,v43
v_add_f32 v44,v44,v45
v_add_f32 v46,v46,v47
v_cvt_pk_bf16_f32 v104,v40,v42
v_cvt_pk_bf16_f32 v105,v44,v46
v_and_or_b32 v104,v104,-2,s57
buffer_store_dwordx4 v[102:105],v6,s[8:11],s71 offen
s_and_b32 s60,s52,15
s_lshl4_add_u32 s60,s51,s60
s_mul_i32 s78,s60,196608
s_add_u32 s78,s78,s85
s_bfe_u32 s28,s52,0x10004
v_and_or_b32 v100,v100,-2,s28
v_and_or_b32 v104,v104,-2,s28
s_sub_u32 s60,s4,s5
s_cmp_gt_i32 s60,13
s_cselect_b32 s53,1,0
s_cmp_eq_u32 s4,64
s_cselect_b32 s53,1,s53
s_cmp_eq_u32 s53,0
s_cselect_b32 s54,s4,s5
s_addc_u32 s4,s4,0
s_add_u32 s5,s5,s53
s_and_b32 s60,s54,1
s_lshl2_add_u32 s60,s53,s60
s_lshl_b32 s68,s60,16
s_add_u32 s68,s68,s83
s_mul_i32 s59,s60,20480
s_add_u32 s59,s59,s6
s_lshl_b32 s69,s53,9
s_add_u32 s69,s69,s7
s_bfe_u32 s31,s54,65537
s_add_u32 s32,s54,1
s_cmp_lg_u32 s53,s51
s_cbranch_scc1 nx_149
s_waitcnt vmcnt(0)
s_cmp_ge_u32 s79,2147483648
s_cbranch_scc1 pf_150
v_mov_b32 v17,1
s_mov_b64 exec,1
buffer_store_dword v17,v1,s[8:11],s79 offen sc1
s_mov_b64 exec,-1
s_mov_b32 s79,2147483648
pf_150:
s_cmp_eq_u32 s78,2147483648
s_cbranch_scc1 pk_151
buffer_store_dwordx4 v[100:103],v1,s[8:11],s78 offen offset:1536 sc1
buffer_store_dwordx2 v[104:105],v8,s[8:11],s78 offen offset:2560 sc1
s_mov_b32 s79,s30
s_mov_b32 s78,2147483648
pk_151:
s_waitcnt vmcnt(0)
s_cmp_ge_u32 s79,2147483648
s_cbranch_scc1 pf_152
v_mov_b32 v17,1
s_mov_b64 exec,1
buffer_store_dword v17,v1,s[8:11],s79 offen sc1
s_mov_b64 exec,-1
s_mov_b32 s79,2147483648
pf_152:
nx_149:
s_add_u32 s50,s50,1
s_mov_b32 s51,s53
s_mov_b32 s52,s54
s_mov_b32 s57,s31
s_mov_b32 s58,s32
s_cmp_lt_u32 s50,128
s_cbranch_scc1 CV_LOOP_F1
s_branch CV_DONE
fr_146:
v_bitop3_b32 v12,v60,v64,s57 bitop3:0x7e
v_bitop3_b32 v13,v68,v68,s57 bitop3:0x7e
v_xor_b32 v14,s57,v68
v_or3_b32 v12,v12,v13,v14
v_and_b32 v12,1,v12
v_cmp_ne_u32 vcc,0,v12
s_cbranch_vccz sk_153
buffer_load_dwordx2 v[68:69],v18,s[8:11],s59 offen sc1
buffer_load_dwordx4 v[60:63],v1,s[8:11],s59 offen sc1
buffer_load_dwordx4 v[64:67],v1,s[8:11],s59 offen offset:1024 sc1
sk_153:
buffer_load_dwordx2 v[78:79],v18,s[8:11],s68 offen sc1
buffer_load_dwordx4 v[70:73],v1,s[8:11],s68 offen sc1
buffer_load_dwordx4 v[74:77],v1,s[8:11],s68 offen offset:1024 sc1
s_sub_u32 s47,s47,1
s_cbranch_scc1 ABORT
s_waitcnt lgkmcnt(0)
s_branch fa_145
ec_148r:
buffer_load_dwordx2 v[78:79],v18,s[8:11],s68 offen sc1
buffer_load_dwordx4 v[70:73],v1,s[8:11],s68 offen sc1
buffer_load_dwordx4 v[74:77],v1,s[8:11],s68 offen offset:1024 sc1
v_and_b32 v17,1,v16
v_cmp_ne_u32 vcc,0,v17
s_nop 0
s_cbranch_vccnz fr_146
v_lshlrev_b32 v80,16,v60
v_and_b32 v81,0xffff0000,v60
v_lshlrev_b32 v82,16,v61
v_and_b32 v83,0xffff0000,v61
v_lshlrev_b32 v84,16,v62
v_and_b32 v85,0xffff0000,v62
v_lshlrev_b32 v86,16,v63
v_and_b32 v87,0xffff0000,v63
v_lshlrev_b32 v96,16,v68
v_and_b32 v97,0xffff0000,v68
v_lshlrev_b32 v98,16,v69
v_and_b32 v99,0xffff0000,v69
s_sub_u32 s47,s47,1
s_cbranch_scc1 ABORT
s_branch ec_148
CV_LOOP_S0:
v_mov_b32 v24,0
v_mov_b32 v25,0
v_mov_b32 v26,0
v_mov_b32 v27,0
v_mov_b32 v28,0
v_mov_b32 v29,0
v_mov_b32 v30,0
v_mov_b32 v31,0
v_mov_b32 v32,0
v_mov_b32 v33,0
v_mov_b32 v34,0
v_mov_b32 v35,0
v_mov_b32 v36,0
v_mov_b32 v37,0
v_mov_b32 v38,0
v_mov_b32 v39,0
v_mov_b32 v40,0
v_mov_b32 v41,0
v_mov_b32 v42,0
v_mov_b32 v43,0
v_mov_b32 v44,0
v_mov_b32 v45,0
v_mov_b32 v46,0
v_mov_b32 v47,0
s_cmp_lg_u32 s46,0
s_cbranch_scc1 np_157
db_158:
buffer_load_dword v12,v11,s[8:11],s69 offen sc1
s_waitcnt vmcnt(0)
v_cmp_gt_u32 vcc,s58,v12
s_cbranch_vccz dbok_159
s_sub_u32 s47,s47,1
s_cbranch_scc1 ABORT
s_branch db_158
dbok_159:
np_157:
s_barrier
buffer_load_dwordx2 v[68:69],v18,s[8:11],s59 offen sc1
buffer_load_dwordx4 v[60:63],v1,s[8:11],s59 offen sc1
buffer_load_dwordx4 v[64:67],v1,s[8:11],s59 offen offset:1024 sc1
fj_156w:
s_waitcnt vmcnt(2)
fj_156f:
buffer_load_dwordx2 v[78:79],v18,s[8:11],s68 offen sc1
buffer_load_dwordx4 v[70:73],v1,s[8:11],s68 offen sc1
buffer_load_dwordx4 v[74:77],v1,s[8:11],s68 offen offset:1024 sc1
fj_156z:
fj_156:
fa_154:
s_waitcnt vmcnt(5)
v_lshlrev_b32 v96,16,v68
v_and_b32 v97,0xffff0000,v68
v_lshlrev_b32 v98,16,v69
v_and_b32 v99,0xffff0000,v69
s_waitcnt vmcnt(4)
v_lshlrev_b32 v80,16,v60
v_and_b32 v81,0xffff0000,v60
v_lshlrev_b32 v82,16,v61
v_and_b32 v83,0xffff0000,v61
v_lshlrev_b32 v84,16,v62
v_and_b32 v85,0xffff0000,v62
v_lshlrev_b32 v86,16,v63
v_and_b32 v87,0xffff0000,v63
s_waitcnt vmcnt(3)
v_lshlrev_b32 v88,16,v64
v_and_b32 v89,0xffff0000,v64
v_lshlrev_b32 v90,16,v65
v_and_b32 v91,0xffff0000,v65
v_lshlrev_b32 v92,16,v66
v_and_b32 v93,0xffff0000,v66
v_lshlrev_b32 v94,16,v67
v_and_b32 v95,0xffff0000,v67
v_bitop3_b32 v16,v60,v64,s57 bitop3:0x7e
v_bitop3_b32 v16,v16,v68,s57 bitop3:0xf6
ec_160:
s_waitcnt vmcnt(2)
v_dot2c_f32_bf16 v96,s37,v78
v_dot2c_f32_bf16 v97,s81,v78
v_dot2c_f32_bf16 v98,s37,v79
v_dot2c_f32_bf16 v99,s81,v79
s_waitcnt vmcnt(1)
v_bitop3_b32 v17,v70,v78,s57 bitop3:0x7e
s_waitcnt vmcnt(0)
v_bitop3_b32 v17,v17,v74,s57 bitop3:0xf6
v_bitop3_b32 v17,v16,v17,1 bitop3:0xa8
v_cmp_ne_u32 vcc,0,v17
v_cvt_pk_bf16_f32 v56,v96,v97
v_cvt_pk_bf16_f32 v57,v98,v99
ds_write_b64 v23,v[56:57]
s_cbranch_vccnz ec_160r
v_dot2c_f32_bf16 v80,s37,v70
v_dot2c_f32_bf16 v81,s81,v70
v_dot2c_f32_bf16 v82,s37,v71
v_dot2c_f32_bf16 v83,s81,v71
v_dot2c_f32_bf16 v84,s37,v72
v_dot2c_f32_bf16 v85,s81,v72
v_dot2c_f32_bf16 v86,s37,v73
v_dot2c_f32_bf16 v87,s81,v73
v_cvt_pk_bf16_f32 v48,v80,v81
v_cvt_pk_bf16_f32 v49,v82,v83
v_cvt_pk_bf16_f32 v50,v84,v85
v_cvt_pk_bf16_f32 v51,v86,v87
ds_write_b128 v22,v[48:51] offset:0
v_dot2c_f32_bf16 v88,s37,v74
v_dot2c_f32_bf16 v89,s81,v74
v_dot2c_f32_bf16 v90,s37,v75
v_dot2c_f32_bf16 v91,s81,v75
v_dot2c_f32_bf16 v92,s37,v76
v_dot2c_f32_bf16 v93,s81,v76
v_dot2c_f32_bf16 v94,s37,v77
v_dot2c_f32_bf16 v95,s81,v77
v_cvt_pk_bf16_f32 v52,v88,v89
v_cvt_pk_bf16_f32 v53,v90,v91
v_cvt_pk_bf16_f32 v54,v92,v93
v_cvt_pk_bf16_f32 v55,v94,v95
ds_write_b128 v22,v[52:55] offset:1024
fj_156g:
v_smfmac_f32_16x16x64_bf16 v[24:27],v[48:51],a[0:7],v2
ds_read_b128 v[72:75],v21 offset:0
s_and_b32 s60,s52,1
v_smfmac_f32_16x16x64_bf16 v[28:31],v[48:51],a[8:15],v2
ds_read_b128 v[76:79],v21 offset:1024
s_lshl2_add_u32 s60,s51,s60
v_smfmac_f32_16x16x64_bf16 v[32:35],v[48:51],a[16:23],v2
ds_read_b128 v[80:83],v21 offset:2048
s_mul_i32 s60,s60,49152
v_smfmac_f32_16x16x64_bf16 v[36:39],v[48:51],a[24:31],v2
ds_read_b128 v[84:87],v21 offset:3072
s_add_u32 s71,s60,s34
s_waitcnt lgkmcnt(4)
s_barrier
v_smfmac_f32_16x16x64_bf16 v[40:43],v[48:51],a[32:39],v2
ds_read_b128 v[60:63],v3 offset:0
v_smfmac_f32_16x16x64_bf16 v[24:27],v[52:55],a[40:47],v2
ds_read_b128 v[64:67],v3 offset:1024
v_smfmac_f32_16x16x64_bf16 v[28:31],v[52:55],a[48:55],v2
ds_read_b128 v[68:71],v4 offset:0
v_smfmac_f32_16x16x64_bf16 v[32:35],v[52:55],a[56:63],v2
buffer_store_dwordx4 v[100:103],v1,s[8:11],s78 offen sc1
v_smfmac_f32_16x16x64_bf16 v[36:39],v[52:55],a[64:71],v2
buffer_store_dwordx2 v[104:105],v8,s[8:11],s78 offen offset:1024 sc1
s_mov_b32 s78,2147483648
v_smfmac_f32_16x16x64_bf16 v[40:43],v[52:55],a[72:79],v2
s_waitcnt lgkmcnt(5)
v_smfmac_f32_16x16x64_bf16 v[44:47],v[48:51],v[72:79],v2
ds_read_b128 v[72:75],v21 offset:4096
s_waitcnt lgkmcnt(4)
v_smfmac_f32_16x16x64_bf16 v[44:47],v[52:55],v[80:87],v2
ds_read_b128 v[76:79],v21 offset:5120
s_waitcnt lgkmcnt(4)
v_smfmac_f32_16x16x64_bf16 v[24:27],v[60:63],a[80:87],v2
ds_read_b128 v[80:83],v21 offset:6144
v_smfmac_f32_16x16x64_bf16 v[28:31],v[60:63],a[88:95],v2
ds_read_b128 v[84:87],v21 offset:7168
v_smfmac_f32_16x16x64_bf16 v[32:35],v[60:63],a[96:103],v2
v_smfmac_f32_16x16x64_bf16 v[36:39],v[60:63],a[104:111],v2
v_smfmac_f32_16x16x64_bf16 v[40:43],v[60:63],a[112:119],v2
s_waitcnt lgkmcnt(2)
v_smfmac_f32_16x16x64_bf16 v[44:47],v[60:63],v[72:79],v2
ds_read_b128 v[60:63],v4 offset:1024
v_smfmac_f32_16x16x64_bf16 v[24:27],v[64:67],a[120:127],v2
ds_read_b128 v[72:75],v21 offset:8192
v_smfmac_f32_16x16x64_bf16 v[28:31],v[64:67],a[128:135],v2
ds_read_b128 v[76:79],v21 offset:9216
v_smfmac_f32_16x16x64_bf16 v[32:35],v[64:67],a[136:143],v2
v_smfmac_f32_16x16x64_bf16 v[36:39],v[64:67],a[144:151],v2
v_smfmac_f32_16x16x64_bf16 v[40:43],v[64:67],a[152:159],v2
s_waitcnt lgkmcnt(3)
v_smfmac_f32_16x16x64_bf16 v[44:47],v[64:67],v[80:87],v2
ds_read_b128 v[64:67],v5 offset:0
v_smfmac_f32_16x16x64_bf16 v[24:27],v[68:71],a[160:167],v2
ds_read_b128 v[80:83],v21 offset:10240
v_smfmac_f32_16x16x64_bf16 v[28:31],v[68:71],a[168:175],v2
ds_read_b128 v[84:87],v21 offset:11264
v_smfmac_f32_16x16x64_bf16 v[32:35],v[68:71],a[176:183],v2
v_smfmac_f32_16x16x64_bf16 v[36:39],v[68:71],a[184:191],v2
v_smfmac_f32_16x16x64_bf16 v[40:43],v[68:71],a[192:199],v2
s_waitcnt lgkmcnt(3)
v_smfmac_f32_16x16x64_bf16 v[44:47],v[68:71],v[72:79],v2
ds_read_b128 v[68:71],v5 offset:1024
v_smfmac_f32_16x16x64_bf16 v[24:27],v[60:63],a[200:207],v2
ds_read_b128 v[72:75],v21 offset:12288
v_smfmac_f32_16x16x64_bf16 v[28:31],v[60:63],a[208:215],v2
ds_read_b128 v[76:79],v21 offset:13312
v_smfmac_f32_16x16x64_bf16 v[32:35],v[60:63],a[216:223],v2
v_smfmac_f32_16x16x64_bf16 v[36:39],v[60:63],a[224:231],v2
v_smfmac_f32_16x16x64_bf16 v[40:43],v[60:63],a[232:239],v2
s_waitcnt lgkmcnt(3)
v_smfmac_f32_16x16x64_bf16 v[44:47],v[60:63],v[80:87],v2
ds_read_b128 v[60:63],v59 offset:0
v_smfmac_f32_16x16x64_bf16 v[24:27],v[64:67],a[240:247],v2
ds_read_b128 v[80:83],v21 offset:14336
v_smfmac_f32_16x16x64_bf16 v[28:31],v[64:67],a[248:255],v2
ds_read_b128 v[84:87],v21 offset:15360
v_smfmac_f32_16x16x64_bf16 v[32:35],v[64:67],v[112:119],v2
v_smfmac_f32_16x16x64_bf16 v[36:39],v[64:67],v[120:127],v2
v_smfmac_f32_16x16x64_bf16 v[40:43],v[64:67],v[128:135],v2
s_waitcnt lgkmcnt(3)
v_smfmac_f32_16x16x64_bf16 v[44:47],v[64:67],v[72:79],v2
ds_read_b128 v[64:67],v59 offset:1024
v_smfmac_f32_16x16x64_bf16 v[24:27],v[68:71],v[136:143],v2
ds_read_b128 v[72:75],v21 offset:16384
v_smfmac_f32_16x16x64_bf16 v[28:31],v[68:71],v[144:151],v2
ds_read_b128 v[76:79],v21 offset:17408
v_smfmac_f32_16x16x64_bf16 v[32:35],v[68:71],v[152:159],v2
v_smfmac_f32_16x16x64_bf16 v[36:39],v[68:71],v[160:167],v2
v_smfmac_f32_16x16x64_bf16 v[40:43],v[68:71],v[168:175],v2
s_waitcnt lgkmcnt(3)
v_smfmac_f32_16x16x64_bf16 v[44:47],v[68:71],v[80:87],v2
ds_read_b128 v[80:83],v21 offset:18432
v_smfmac_f32_16x16x64_bf16 v[24:27],v[60:63],v[176:183],v2
ds_read_b128 v[84:87],v21 offset:19456
v_smfmac_f32_16x16x64_bf16 v[28:31],v[60:63],v[184:191],v2
s_waitcnt lgkmcnt(4)
v_smfmac_f32_16x16x64_bf16 v[24:27],v[64:67],v[216:223],v2
v_smfmac_f32_16x16x64_bf16 v[28:31],v[64:67],v[224:231],v2
v_smfmac_f32_16x16x64_bf16 v[32:35],v[60:63],v[192:199],v2
v_smfmac_f32_16x16x64_bf16 v[36:39],v[60:63],v[200:207],v2
v_add_f32 v24,v24,v25
v_smfmac_f32_16x16x64_bf16 v[32:35],v[64:67],v[232:239],v2
v_add_f32 v26,v26,v27
v_smfmac_f32_16x16x64_bf16 v[36:39],v[64:67],v[240:247],v2
v_add_f32 v28,v28,v29
v_smfmac_f32_16x16x64_bf16 v[40:43],v[60:63],v[208:215],v2
v_add_f32 v30,v30,v31
s_waitcnt lgkmcnt(2)
v_smfmac_f32_16x16x64_bf16 v[44:47],v[60:63],v[72:79],v2
v_cvt_pk_bf16_f32 v100,v24,v26
v_smfmac_f32_16x16x64_bf16 v[40:43],v[64:67],v[248:255],v2
v_cvt_pk_bf16_f32 v101,v28,v30
s_waitcnt lgkmcnt(0)
v_smfmac_f32_16x16x64_bf16 v[44:47],v[64:67],v[80:87],v2
v_and_or_b32 v100,v100,-2,s57
v_add_f32 v32,v32,v33
v_add_f32 v34,v34,v35
v_add_f32 v36,v36,v37
v_add_f32 v38,v38,v39
v_cvt_pk_bf16_f32 v102,v32,v34
v_cvt_pk_bf16_f32 v103,v36,v38
v_and_or_b32 v102,v102,-2,s57
buffer_store_dwordx4 v[100:103],v6,s[8:11],s71 offen sc1
v_add_f32 v40,v40,v41
v_add_f32 v42,v42,v43
v_add_f32 v44,v44,v45
v_add_f32 v46,v46,v47
v_cvt_pk_bf16_f32 v104,v40,v42
v_cvt_pk_bf16_f32 v105,v44,v46
v_and_or_b32 v104,v104,-2,s57
buffer_store_dwordx2 v[104:105],v7,s[8:11],s71 offen sc1
s_and_b32 s60,s52,15
s_lshl4_add_u32 s60,s51,s60
s_mul_i32 s78,s60,196608
s_add_u32 s78,s78,s85
s_bfe_u32 s28,s52,0x10004
v_and_or_b32 v100,v100,-2,s28
v_and_or_b32 v104,v104,-2,s28
s_sub_u32 s60,s4,s5
s_cmp_gt_i32 s60,13
s_cselect_b32 s53,1,0
s_cmp_eq_u32 s4,64
s_cselect_b32 s53,1,s53
s_cmp_eq_u32 s53,0
s_cselect_b32 s54,s4,s5
s_addc_u32 s4,s4,0
s_add_u32 s5,s5,s53
s_and_b32 s60,s54,1
s_lshl2_add_u32 s60,s53,s60
s_lshl_b32 s68,s60,16
s_add_u32 s68,s68,s83
s_mul_i32 s59,s60,20480
s_add_u32 s59,s59,s6
s_lshl_b32 s69,s53,9
s_add_u32 s69,s69,s7
s_bfe_u32 s31,s54,65537
s_add_u32 s32,s54,1
s_cmp_lg_u32 s53,s51
s_cbranch_scc1 nx_161
s_waitcnt vmcnt(0)
s_cmp_ge_u32 s79,2147483648
s_cbranch_scc1 pf_162
v_mov_b32 v17,1
s_mov_b64 exec,1
buffer_store_dword v17,v1,s[8:11],s79 offen sc1
s_mov_b64 exec,-1
s_mov_b32 s79,2147483648
pf_162:
s_cmp_eq_u32 s78,2147483648
s_cbranch_scc1 pk_163
buffer_store_dwordx4 v[100:103],v1,s[8:11],s78 offen sc1
buffer_store_dwordx2 v[104:105],v8,s[8:11],s78 offen offset:1024 sc1
s_mov_b32 s79,s30
s_mov_b32 s78,2147483648
pk_163:
s_waitcnt vmcnt(0)
s_cmp_ge_u32 s79,2147483648
s_cbranch_scc1 pf_164
v_mov_b32 v17,1
s_mov_b64 exec,1
buffer_store_dword v17,v1,s[8:11],s79 offen sc1
s_mov_b64 exec,-1
s_mov_b32 s79,2147483648
pf_164:
nx_161:
s_add_u32 s50,s50,1
s_mov_b32 s51,s53
s_mov_b32 s52,s54
s_mov_b32 s57,s31
s_mov_b32 s58,s32
s_cmp_lt_u32 s50,128
s_cbranch_scc1 CV_LOOP_S0
s_branch CV_DONE
fr_155:
v_bitop3_b32 v12,v60,v64,s57 bitop3:0x7e
v_bitop3_b32 v13,v68,v68,s57 bitop3:0x7e
v_xor_b32 v14,s57,v68
v_or3_b32 v12,v12,v13,v14
v_and_b32 v12,1,v12
v_cmp_ne_u32 vcc,0,v12
s_cbranch_vccz sk_165
buffer_load_dwordx2 v[68:69],v18,s[8:11],s59 offen sc1
buffer_load_dwordx4 v[60:63],v1,s[8:11],s59 offen sc1
buffer_load_dwordx4 v[64:67],v1,s[8:11],s59 offen offset:1024 sc1
sk_165:
buffer_load_dwordx2 v[78:79],v18,s[8:11],s68 offen sc1
buffer_load_dwordx4 v[70:73],v1,s[8:11],s68 offen sc1
buffer_load_dwordx4 v[74:77],v1,s[8:11],s68 offen offset:1024 sc1
s_sub_u32 s47,s47,1
s_cbranch_scc1 ABORT
s_waitcnt lgkmcnt(0)
s_branch fa_154
ec_160r:
buffer_load_dwordx2 v[78:79],v18,s[8:11],s68 offen sc1
buffer_load_dwordx4 v[70:73],v1,s[8:11],s68 offen sc1
buffer_load_dwordx4 v[74:77],v1,s[8:11],s68 offen offset:1024 sc1
v_and_b32 v17,1,v16
v_cmp_ne_u32 vcc,0,v17
s_nop 0
s_cbranch_vccnz fr_155
v_lshlrev_b32 v80,16,v60
v_and_b32 v81,0xffff0000,v60
v_lshlrev_b32 v82,16,v61
v_and_b32 v83,0xffff0000,v61
v_lshlrev_b32 v84,16,v62
v_and_b32 v85,0xffff0000,v62
v_lshlrev_b32 v86,16,v63
v_and_b32 v87,0xffff0000,v63
v_lshlrev_b32 v96,16,v68
v_and_b32 v97,0xffff0000,v68
v_lshlrev_b32 v98,16,v69
v_and_b32 v99,0xffff0000,v69
s_sub_u32 s47,s47,1
s_cbranch_scc1 ABORT
s_branch ec_160
CV_LOOP_S1:
v_mov_b32 v24,0
v_mov_b32 v25,0
v_mov_b32 v26,0
v_mov_b32 v27,0
v_mov_b32 v28,0
v_mov_b32 v29,0
v_mov_b32 v30,0
v_mov_b32 v31,0
v_mov_b32 v32,0
v_mov_b32 v33,0
v_mov_b32 v34,0
v_mov_b32 v35,0
v_mov_b32 v36,0
v_mov_b32 v37,0
v_mov_b32 v38,0
v_mov_b32 v39,0
v_mov_b32 v40,0
v_mov_b32 v41,0
v_mov_b32 v42,0
v_mov_b32 v43,0
v_mov_b32 v44,0
v_mov_b32 v45,0
v_mov_b32 v46,0
v_mov_b32 v47,0
s_barrier
buffer_load_dwordx2 v[68:69],v18,s[8:11],s59 offen sc1
buffer_load_dwordx4 v[60:63],v1,s[8:11],s59 offen sc1
buffer_load_dwordx4 v[64:67],v1,s[8:11],s59 offen offset:1024 sc1
fj_168w:
s_waitcnt vmcnt(2)
fj_168f:
buffer_load_dwordx2 v[78:79],v18,s[8:11],s68 offen sc1
buffer_load_dwordx4 v[70:73],v1,s[8:11],s68 offen sc1
buffer_load_dwordx4 v[74:77],v1,s[8:11],s68 offen offset:1024 sc1
fj_168z:
fj_168:
fa_166:
s_waitcnt vmcnt(5)
v_lshlrev_b32 v96,16,v68
v_and_b32 v97,0xffff0000,v68
v_lshlrev_b32 v98,16,v69
v_and_b32 v99,0xffff0000,v69
s_waitcnt vmcnt(4)
v_lshlrev_b32 v80,16,v60
v_and_b32 v81,0xffff0000,v60
v_lshlrev_b32 v82,16,v61
v_and_b32 v83,0xffff0000,v61
v_lshlrev_b32 v84,16,v62
v_and_b32 v85,0xffff0000,v62
v_lshlrev_b32 v86,16,v63
v_and_b32 v87,0xffff0000,v63
s_waitcnt vmcnt(3)
v_lshlrev_b32 v88,16,v64
v_and_b32 v89,0xffff0000,v64
v_lshlrev_b32 v90,16,v65
v_and_b32 v91,0xffff0000,v65
v_lshlrev_b32 v92,16,v66
v_and_b32 v93,0xffff0000,v66
v_lshlrev_b32 v94,16,v67
v_and_b32 v95,0xffff0000,v67
v_bitop3_b32 v16,v60,v64,s57 bitop3:0x7e
v_bitop3_b32 v16,v16,v68,s57 bitop3:0xf6
ec_169:
s_waitcnt vmcnt(2)
v_dot2c_f32_bf16 v96,s37,v78
v_dot2c_f32_bf16 v97,s81,v78
v_dot2c_f32_bf16 v98,s37,v79
v_dot2c_f32_bf16 v99,s81,v79
s_waitcnt vmcnt(1)
v_bitop3_b32 v17,v70,v78,s57 bitop3:0x7e
s_waitcnt vmcnt(0)
v_bitop3_b32 v17,v17,v74,s57 bitop3:0xf6
v_bitop3_b32 v17,v16,v17,1 bitop3:0xa8
v_cmp_ne_u32 vcc,0,v17
v_cvt_pk_bf16_f32 v56,v96,v97
v_cvt_pk_bf16_f32 v57,v98,v99
ds_write_b64 v23,v[56:57]
s_cbranch_vccnz ec_169r
v_dot2c_f32_bf16 v80,s37,v70
v_dot2c_f32_bf16 v81,s81,v70
v_dot2c_f32_bf16 v82,s37,v71
v_dot2c_f32_bf16 v83,s81,v71
v_dot2c_f32_bf16 v84,s37,v72
v_dot2c_f32_bf16 v85,s81,v72
v_dot2c_f32_bf16 v86,s37,v73
v_dot2c_f32_bf16 v87,s81,v73
v_cvt_pk_bf16_f32 v48,v80,v81
v_cvt_pk_bf16_f32 v49,v82,v83
v_cvt_pk_bf16_f32 v50,v84,v85
v_cvt_pk_bf16_f32 v51,v86,v87
ds_write_b128 v22,v[48:51] offset:0
v_dot2c_f32_bf16 v88,s37,v74
v_dot2c_f32_bf16 v89,s81,v74
v_dot2c_f32_bf16 v90,s37,v75
v_dot2c_f32_bf16 v91,s81,v75
v_dot2c_f32_bf16 v92,s37,v76
v_dot2c_f32_bf16 v93,s81,v76
v_dot2c_f32_bf16 v94,s37,v77
v_dot2c_f32_bf16 v95,s81,v77
v_cvt_pk_bf16_f32 v52,v88,v89
v_cvt_pk_bf16_f32 v53,v90,v91
v_cvt_pk_bf16_f32 v54,v92,v93
v_cvt_pk_bf16_f32 v55,v94,v95
ds_write_b128 v22,v[52:55] offset:1024
fj_168g:
v_smfmac_f32_16x16x64_bf16 v[24:27],v[48:51],a[0:7],v2
ds_read_b128 v[72:75],v21 offset:0
s_and_b32 s60,s52,1
v_smfmac_f32_16x16x64_bf16 v[28:31],v[48:51],a[8:15],v2
ds_read_b128 v[76:79],v21 offset:1024
s_lshl2_add_u32 s60,s51,s60
v_smfmac_f32_16x16x64_bf16 v[32:35],v[48:51],a[16:23],v2
ds_read_b128 v[80:83],v21 offset:2048
s_mul_i32 s60,s60,49152
v_smfmac_f32_16x16x64_bf16 v[36:39],v[48:51],a[24:31],v2
ds_read_b128 v[84:87],v21 offset:3072
s_add_u32 s71,s60,s34
s_waitcnt lgkmcnt(4)
s_barrier
v_smfmac_f32_16x16x64_bf16 v[40:43],v[48:51],a[32:39],v2
ds_read_b128 v[60:63],v3 offset:0
v_smfmac_f32_16x16x64_bf16 v[24:27],v[52:55],a[40:47],v2
ds_read_b128 v[64:67],v3 offset:1024
v_smfmac_f32_16x16x64_bf16 v[28:31],v[52:55],a[48:55],v2
ds_read_b128 v[68:71],v4 offset:0
v_smfmac_f32_16x16x64_bf16 v[32:35],v[52:55],a[56:63],v2
buffer_store_dwordx4 v[100:103],v1,s[8:11],s78 offen offset:1536 sc1
v_smfmac_f32_16x16x64_bf16 v[36:39],v[52:55],a[64:71],v2
buffer_store_dwordx2 v[104:105],v8,s[8:11],s78 offen offset:2560 sc1
s_mov_b32 s78,2147483648
v_smfmac_f32_16x16x64_bf16 v[40:43],v[52:55],a[72:79],v2
s_waitcnt lgkmcnt(5)
v_smfmac_f32_16x16x64_bf16 v[44:47],v[48:51],v[72:79],v2
ds_read_b128 v[72:75],v21 offset:4096
s_waitcnt lgkmcnt(4)
v_smfmac_f32_16x16x64_bf16 v[44:47],v[52:55],v[80:87],v2
ds_read_b128 v[76:79],v21 offset:5120
s_waitcnt lgkmcnt(4)
v_smfmac_f32_16x16x64_bf16 v[24:27],v[60:63],a[80:87],v2
ds_read_b128 v[80:83],v21 offset:6144
v_smfmac_f32_16x16x64_bf16 v[28:31],v[60:63],a[88:95],v2
ds_read_b128 v[84:87],v21 offset:7168
v_smfmac_f32_16x16x64_bf16 v[32:35],v[60:63],a[96:103],v2
v_smfmac_f32_16x16x64_bf16 v[36:39],v[60:63],a[104:111],v2
v_smfmac_f32_16x16x64_bf16 v[40:43],v[60:63],a[112:119],v2
s_waitcnt lgkmcnt(2)
v_smfmac_f32_16x16x64_bf16 v[44:47],v[60:63],v[72:79],v2
ds_read_b128 v[60:63],v4 offset:1024
v_smfmac_f32_16x16x64_bf16 v[24:27],v[64:67],a[120:127],v2
ds_read_b128 v[72:75],v21 offset:8192
v_smfmac_f32_16x16x64_bf16 v[28:31],v[64:67],a[128:135],v2
ds_read_b128 v[76:79],v21 offset:9216
v_smfmac_f32_16x16x64_bf16 v[32:35],v[64:67],a[136:143],v2
v_smfmac_f32_16x16x64_bf16 v[36:39],v[64:67],a[144:151],v2
v_smfmac_f32_16x16x64_bf16 v[40:43],v[64:67],a[152:159],v2
s_waitcnt lgkmcnt(3)
v_smfmac_f32_16x16x64_bf16 v[44:47],v[64:67],v[80:87],v2
ds_read_b128 v[64:67],v5 offset:0
v_smfmac_f32_16x16x64_bf16 v[24:27],v[68:71],a[160:167],v2
ds_read_b128 v[80:83],v21 offset:10240
v_smfmac_f32_16x16x64_bf16 v[28:31],v[68:71],a[168:175],v2
ds_read_b128 v[84:87],v21 offset:11264
v_smfmac_f32_16x16x64_bf16 v[32:35],v[68:71],a[176:183],v2
v_smfmac_f32_16x16x64_bf16 v[36:39],v[68:71],a[184:191],v2
v_smfmac_f32_16x16x64_bf16 v[40:43],v[68:71],a[192:199],v2
s_waitcnt lgkmcnt(3)
v_smfmac_f32_16x16x64_bf16 v[44:47],v[68:71],v[72:79],v2
ds_read_b128 v[68:71],v5 offset:1024
v_smfmac_f32_16x16x64_bf16 v[24:27],v[60:63],a[200:207],v2
ds_read_b128 v[72:75],v21 offset:12288
v_smfmac_f32_16x16x64_bf16 v[28:31],v[60:63],a[208:215],v2
ds_read_b128 v[76:79],v21 offset:13312
v_smfmac_f32_16x16x64_bf16 v[32:35],v[60:63],a[216:223],v2
v_smfmac_f32_16x16x64_bf16 v[36:39],v[60:63],a[224:231],v2
v_smfmac_f32_16x16x64_bf16 v[40:43],v[60:63],a[232:239],v2
s_waitcnt lgkmcnt(3)
v_smfmac_f32_16x16x64_bf16 v[44:47],v[60:63],v[80:87],v2
ds_read_b128 v[60:63],v59 offset:0
v_smfmac_f32_16x16x64_bf16 v[24:27],v[64:67],a[240:247],v2
ds_read_b128 v[80:83],v21 offset:14336
v_smfmac_f32_16x16x64_bf16 v[28:31],v[64:67],a[248:255],v2
ds_read_b128 v[84:87],v21 offset:15360
v_smfmac_f32_16x16x64_bf16 v[32:35],v[64:67],v[112:119],v2
v_smfmac_f32_16x16x64_bf16 v[36:39],v[64:67],v[120:127],v2
v_smfmac_f32_16x16x64_bf16 v[40:43],v[64:67],v[128:135],v2
s_waitcnt lgkmcnt(3)
v_smfmac_f32_16x16x64_bf16 v[44:47],v[64:67],v[72:79],v2
ds_read_b128 v[64:67],v59 offset:1024
v_smfmac_f32_16x16x64_bf16 v[24:27],v[68:71],v[136:143],v2
ds_read_b128 v[72:75],v21 offset:16384
v_smfmac_f32_16x16x64_bf16 v[28:31],v[68:71],v[144:151],v2
ds_read_b128 v[76:79],v21 offset:17408
v_smfmac_f32_16x16x64_bf16 v[32:35],v[68:71],v[152:159],v2
v_smfmac_f32_16x16x64_bf16 v[36:39],v[68:71],v[160:167],v2
v_smfmac_f32_16x16x64_bf16 v[40:43],v[68:71],v[168:175],v2
s_waitcnt lgkmcnt(3)
v_smfmac_f32_16x16x64_bf16 v[44:47],v[68:71],v[80:87],v2
ds_read_b128 v[80:83],v21 offset:18432
v_smfmac_f32_16x16x64_bf16 v[24:27],v[60:63],v[176:183],v2
ds_read_b128 v[84:87],v21 offset:19456
v_smfmac_f32_16x16x64_bf16 v[28:31],v[60:63],v[184:191],v2
s_waitcnt lgkmcnt(4)
v_smfmac_f32_16x16x64_bf16 v[24:27],v[64:67],v[216:223],v2
v_smfmac_f32_16x16x64_bf16 v[28:31],v[64:67],v[224:231],v2
v_smfmac_f32_16x16x64_bf16 v[32:35],v[60:63],v[192:199],v2
v_smfmac_f32_16x16x64_bf16 v[36:39],v[60:63],v[200:207],v2
v_add_f32 v24,v24,v25
v_smfmac_f32_16x16x64_bf16 v[32:35],v[64:67],v[232:239],v2
v_add_f32 v26,v26,v27
v_smfmac_f32_16x16x64_bf16 v[36:39],v[64:67],v[240:247],v2
v_add_f32 v28,v28,v29
v_smfmac_f32_16x16x64_bf16 v[40:43],v[60:63],v[208:215],v2
v_add_f32 v30,v30,v31
s_waitcnt lgkmcnt(2)
v_smfmac_f32_16x16x64_bf16 v[44:47],v[60:63],v[72:79],v2
v_cvt_pk_bf16_f32 v100,v24,v26
v_smfmac_f32_16x16x64_bf16 v[40:43],v[64:67],v[248:255],v2
v_cvt_pk_bf16_f32 v101,v28,v30
s_waitcnt lgkmcnt(0)
v_smfmac_f32_16x16x64_bf16 v[44:47],v[64:67],v[80:87],v2
v_and_or_b32 v100,v100,-2,s57
buffer_store_dwordx2 v[100:101],v7,s[8:11],s71 offen sc1
v_add_f32 v32,v32,v33
v_add_f32 v34,v34,v35
v_add_f32 v36,v36,v37
v_add_f32 v38,v38,v39
v_cvt_pk_bf16_f32 v102,v32,v34
v_cvt_pk_bf16_f32 v103,v36,v38
v_and_or_b32 v102,v102,-2,s57
v_add_f32 v40,v40,v41
v_add_f32 v42,v42,v43
v_add_f32 v44,v44,v45
v_add_f32 v46,v46,v47
v_cvt_pk_bf16_f32 v104,v40,v42
v_cvt_pk_bf16_f32 v105,v44,v46
v_and_or_b32 v104,v104,-2,s57
buffer_store_dwordx4 v[102:105],v6,s[8:11],s71 offen sc1
s_and_b32 s60,s52,15
s_lshl4_add_u32 s60,s51,s60
s_mul_i32 s78,s60,196608
s_add_u32 s78,s78,s85
s_bfe_u32 s28,s52,0x10004
v_and_or_b32 v100,v100,-2,s28
v_and_or_b32 v104,v104,-2,s28
s_sub_u32 s60,s4,s5
s_cmp_gt_i32 s60,13
s_cselect_b32 s53,1,0
s_cmp_eq_u32 s4,64
s_cselect_b32 s53,1,s53
s_cmp_eq_u32 s53,0
s_cselect_b32 s54,s4,s5
s_addc_u32 s4,s4,0
s_add_u32 s5,s5,s53
s_and_b32 s60,s54,1
s_lshl2_add_u32 s60,s53,s60
s_lshl_b32 s68,s60,16
s_add_u32 s68,s68,s83
s_mul_i32 s59,s60,20480
s_add_u32 s59,s59,s6
s_lshl_b32 s69,s53,9
s_add_u32 s69,s69,s7
s_bfe_u32 s31,s54,65537
s_add_u32 s32,s54,1
s_cmp_lg_u32 s53,s51
s_cbranch_scc1 nx_170
s_waitcnt vmcnt(0)
s_cmp_ge_u32 s79,2147483648
s_cbranch_scc1 pf_171
v_mov_b32 v17,1
s_mov_b64 exec,1
buffer_store_dword v17,v1,s[8:11],s79 offen sc1
s_mov_b64 exec,-1
s_mov_b32 s79,2147483648
pf_171:
s_cmp_eq_u32 s78,2147483648
s_cbranch_scc1 pk_172
buffer_store_dwordx4 v[100:103],v1,s[8:11],s78 offen offset:1536 sc1
buffer_store_dwordx2 v[104:105],v8,s[8:11],s78 offen offset:2560 sc1
s_mov_b32 s79,s30
s_mov_b32 s78,2147483648
pk_172:
s_waitcnt vmcnt(0)
s_cmp_ge_u32 s79,2147483648
s_cbranch_scc1 pf_173
v_mov_b32 v17,1
s_mov_b64 exec,1
buffer_store_dword v17,v1,s[8:11],s79 offen sc1
s_mov_b64 exec,-1
s_mov_b32 s79,2147483648
pf_173:
nx_170:
s_add_u32 s50,s50,1
s_mov_b32 s51,s53
s_mov_b32 s52,s54
s_mov_b32 s57,s31
s_mov_b32 s58,s32
s_cmp_lt_u32 s50,128
s_cbranch_scc1 CV_LOOP_S1
s_branch CV_DONE
fr_167:
v_bitop3_b32 v12,v60,v64,s57 bitop3:0x7e
v_bitop3_b32 v13,v68,v68,s57 bitop3:0x7e
v_xor_b32 v14,s57,v68
v_or3_b32 v12,v12,v13,v14
v_and_b32 v12,1,v12
v_cmp_ne_u32 vcc,0,v12
s_cbranch_vccz sk_174
buffer_load_dwordx2 v[68:69],v18,s[8:11],s59 offen sc1
buffer_load_dwordx4 v[60:63],v1,s[8:11],s59 offen sc1
buffer_load_dwordx4 v[64:67],v1,s[8:11],s59 offen offset:1024 sc1
sk_174:
buffer_load_dwordx2 v[78:79],v18,s[8:11],s68 offen sc1
buffer_load_dwordx4 v[70:73],v1,s[8:11],s68 offen sc1
buffer_load_dwordx4 v[74:77],v1,s[8:11],s68 offen offset:1024 sc1
s_sub_u32 s47,s47,1
s_cbranch_scc1 ABORT
s_waitcnt lgkmcnt(0)
s_branch fa_166
ec_169r:
buffer_load_dwordx2 v[78:79],v18,s[8:11],s68 offen sc1
buffer_load_dwordx4 v[70:73],v1,s[8:11],s68 offen sc1
buffer_load_dwordx4 v[74:77],v1,s[8:11],s68 offen offset:1024 sc1
v_and_b32 v17,1,v16
v_cmp_ne_u32 vcc,0,v17
s_nop 0
s_cbranch_vccnz fr_167
v_lshlrev_b32 v80,16,v60
v_and_b32 v81,0xffff0000,v60
v_lshlrev_b32 v82,16,v61
v_and_b32 v83,0xffff0000,v61
v_lshlrev_b32 v84,16,v62
v_and_b32 v85,0xffff0000,v62
v_lshlrev_b32 v86,16,v63
v_and_b32 v87,0xffff0000,v63
v_lshlrev_b32 v96,16,v68
v_and_b32 v97,0xffff0000,v68
v_lshlrev_b32 v98,16,v69
v_and_b32 v99,0xffff0000,v69
s_sub_u32 s47,s47,1
s_cbranch_scc1 ABORT
s_branch ec_169
CV_DONE:
s_add_u32 s61,s48,32
s_endpgm
ROLE_CW:
s_lshr_b32 s28,s48,3
s_and_b32 s29,s48,7
s_mul_i32 s82,s28,2097152
s_add_u32 s82,s82,2097152
v_lshlrev_b32 v1,4,v0
v_and_b32 v12,1,v0
v_mul_u32_u24 v2,0xaaaa,v12
v_or_b32 v2,0x4444,v2
v_lshrrev_b32 v14,4,v0
v_and_b32 v15,15,v0
v_min_u32 v3,11,v15
v_lshlrev_b32 v3,2,v3
v_lshl_add_u32 v3,v14,7,v3
s_mul_i32 s60,s46,24576
v_add_u32 v4,s60,v1
v_mul_u32_u24 v5,704,v14
v_and_b32 v12,3,v15
v_lshl_add_u32 v5,v12,2,v5
v_bfe_u32 v12,v15,2,1
v_lshl_add_u32 v5,v12,5,v5
v_bfe_u32 v12,v15,3,1
v_lshl_add_u32 v5,v12,4,v5
s_mul_i32 s60,s46,2816
s_add_u32 s60,s60,98304
v_add_u32 v5,s60,v5
s_mul_i32 s60,s46,24
s_min_u32 s60,s60,64
s_cmp_lt_u32 s46,2
s_cselect_b32 s61,23,15
s_mov_b32 s88,0xffff
s_cselect_b32 s88,0xffffff,s88
s_mov_b32 s89,0
v_and_b32 v12,31,v0
v_min_u32 v12,s61,v12
v_add_u32 v12,s60,v12
v_lshrrev_b32 v13,5,v0
v_lshl_add_u32 v12,v12,1,v13
v_bfe_u32 v13,v12,2,3
v_mul_u32_u24 v6,352,v13
v_mul_u32_u24 v17,1280,v13
v_lshrrev_b32 v13,5,v12
v_lshl_add_u32 v6,v13,6,v6
v_lshl_add_u32 v17,v13,5,v17
v_and_b32 v13,3,v12
v_lshl_add_u32 v17,v13,3,v17
v_and_b32 v13,1,v12
v_lshl_add_u32 v6,v13,5,v6
v_bfe_u32 v13,v12,1,1
v_lshl_add_u32 v6,v13,4,v6
v_add_u32 v6,98304,v6
s_mul_i32 s60,s29,1280
v_lshlrev_b32 v9,3,v12
v_add_u32 v9,s60,v9
v_lshrrev_b32 v13,13,v9
v_lshl_add_u32 v9,v13,13,v9
v_xor_b32 v10,1,v12
v_or_b32 v10,v10,v13
v_and_b32 v10,1,v10
s_mov_b32 s4,s18
s_mov_b32 s5,s19
s_mov_b32 s6,10240
s_mov_b32 s7,0x20000
s_mul_i32 s60,s29,160
buffer_load_dwordx2 v[32:33],v17,s[4:7],s60 offen
s_mul_i32 s84,s29,0
s_add_u32 s84,s84,s82
s_lshl_b32 s83,s28,19
s_lshr_b32 s60,s29,1
s_and_b32 s61,s29,1
s_mul_i32 s62,s61,0
s_add_u32 s83,s83,s62
s_add_u32 s83,s83,10485760
s_lshl_b32 s85,s60,7
s_lshl_b32 s61,s61,2
s_add_u32 s61,s61,s46
s_lshl_b32 s61,s61,2
s_add_u32 s85,s85,s61
s_add_u32 s85,s85,s82
s_add_u32 s85,s85,950272
s_mul_i32 s33,s46,12288
s_add_u32 s33,s33,s82
s_add_u32 s33,s33,163840
s_mov_b32 s35,0
s_add_u32 s35,s35,s82
s_add_u32 s35,s35,951296
s_cmp_eq_u32 s28,0
s_cselect_b32 s63,0xffff0000,0
s_waitcnt vmcnt(0)
s_cselect_b64 vcc,-1,0
v_bfi_b32 v36,v10,0,v32
v_lshlrev_b32 v34,16,v32
v_lshlrev_b32 v35,16,v36
v_sub_f32 v34,v34,v35
v_lshrrev_b32 v34,16,v34
v_and_b32 v34,-2,v34
v_cndmask_b32 v36,v34,v36,vcc
v_cndmask_b32 v37,0,v33,vcc
s_nop 0
v_permlane32_swap_b32 v36,v38
v_permlane32_swap_b32 v37,v39
v_mov_b32 v40,-1
v_mov_b32 v41,-1
v_mov_b32 v42,-1
v_mov_b32 v43,-1
v_mov_b32 v44,1
s_mov_b64 exec,s[88:89]
s_add_u32 s60,s83,0
buffer_store_dwordx4 v[36:39],v9,s[8:11],s60 offen sc1
s_add_u32 s60,s83,8192
buffer_store_dwordx4 v[36:39],v9,s[8:11],s60 offen sc1
s_add_u32 s60,s83,65536
buffer_store_dwordx4 v[40:43],v9,s[8:11],s60 offen sc1
s_add_u32 s60,s83,73728
buffer_store_dwordx4 v[40:43],v9,s[8:11],s60 offen sc1
s_add_u32 s60,s83,131072
buffer_store_dwordx4 v[40:43],v9,s[8:11],s60 offen sc1
s_add_u32 s60,s83,139264
buffer_store_dwordx4 v[40:43],v9,s[8:11],s60 offen sc1
s_add_u32 s60,s83,196608
buffer_store_dwordx4 v[40:43],v9,s[8:11],s60 offen sc1
s_add_u32 s60,s83,204800
buffer_store_dwordx4 v[40:43],v9,s[8:11],s60 offen sc1
s_add_u32 s60,s83,262144
buffer_store_dwordx4 v[36:39],v9,s[8:11],s60 offen sc1
s_add_u32 s60,s83,270336
buffer_store_dwordx4 v[36:39],v9,s[8:11],s60 offen sc1
s_add_u32 s60,s83,327680
buffer_store_dwordx4 v[40:43],v9,s[8:11],s60 offen sc1
s_add_u32 s60,s83,335872
buffer_store_dwordx4 v[40:43],v9,s[8:11],s60 offen sc1
s_add_u32 s60,s83,393216
buffer_store_dwordx4 v[40:43],v9,s[8:11],s60 offen sc1
s_add_u32 s60,s83,401408
buffer_store_dwordx4 v[40:43],v9,s[8:11],s60 offen sc1
s_add_u32 s60,s83,458752
buffer_store_dwordx4 v[40:43],v9,s[8:11],s60 offen sc1
s_add_u32 s60,s83,466944
buffer_store_dwordx4 v[40:43],v9,s[8:11],s60 offen sc1
s_cmp_lg_u32 s49,0
s_cbranch_scc1 ls_175
s_add_u32 s60,s84,0
buffer_store_dwordx4 v[36:39],v9,s[8:11],s60 offen
s_add_u32 s60,s84,20480
buffer_store_dwordx4 v[40:43],v9,s[8:11],s60 offen
s_add_u32 s60,s84,40960
buffer_store_dwordx4 v[40:43],v9,s[8:11],s60 offen
s_add_u32 s60,s84,61440
buffer_store_dwordx4 v[40:43],v9,s[8:11],s60 offen
s_add_u32 s60,s84,81920
buffer_store_dwordx4 v[36:39],v9,s[8:11],s60 offen
s_add_u32 s60,s84,102400
buffer_store_dwordx4 v[40:43],v9,s[8:11],s60 offen
s_add_u32 s60,s84,122880
buffer_store_dwordx4 v[40:43],v9,s[8:11],s60 offen
s_add_u32 s60,s84,143360
buffer_store_dwordx4 v[40:43],v9,s[8:11],s60 offen
s_mov_b64 exec,1
buffer_store_dword v44,v1,s[8:11],s85 offen
buffer_store_dword v44,v1,s[8:11],s85 offen offset:512
s_branch ls_176
ls_175:
s_add_u32 s60,s84,0
buffer_store_dwordx4 v[36:39],v9,s[8:11],s60 offen sc1
s_add_u32 s60,s84,20480
buffer_store_dwordx4 v[40:43],v9,s[8:11],s60 offen sc1
s_add_u32 s60,s84,40960
buffer_store_dwordx4 v[40:43],v9,s[8:11],s60 offen sc1
s_add_u32 s60,s84,61440
buffer_store_dwordx4 v[40:43],v9,s[8:11],s60 offen sc1
s_add_u32 s60,s84,81920
buffer_store_dwordx4 v[36:39],v9,s[8:11],s60 offen sc1
s_add_u32 s60,s84,102400
buffer_store_dwordx4 v[40:43],v9,s[8:11],s60 offen sc1
s_add_u32 s60,s84,122880
buffer_store_dwordx4 v[40:43],v9,s[8:11],s60 offen sc1
s_add_u32 s60,s84,143360
buffer_store_dwordx4 v[40:43],v9,s[8:11],s60 offen sc1
s_mov_b64 exec,1
buffer_store_dword v44,v1,s[8:11],s85 offen sc1
buffer_store_dword v44,v1,s[8:11],s85 offen offset:512 sc1
ls_176:
s_mov_b64 exec,-1
s_waitcnt vmcnt(0)
s_barrier
s_cmp_lg_u32 s46,0
s_cbranch_scc1 arr_177
v_mov_b32 v12,1
s_lshl_b32 s3,s49,2
v_mov_b32 v13,s3
s_mov_b64 exec,1
buffer_atomic_add v12,v13,s[12:15],0 offen sc1
s_mov_b64 exec,-1
arr_177:
s_mov_b32 s4,s26
s_mov_b32 s5,s27
s_mov_b32 s6,7864320
s_mov_b32 s7,0x20000
s_lshl_b32 s60,s28,2
s_add_u32 s60,s60,s46
s_mul_i32 s73,s60,983040
s_mul_i32 s60,s29,160
s_add_u32 s73,s73,s60
s_mul_i32 s74,s46,40960
v_add_u32 v12,0,v0
v_mul_u32_u24 v13,6554,v12
v_lshrrev_b32 v13,16,v13
v_mul_u32_u24 v16,10,v13
v_sub_u32 v12,v12,v16
v_mul_u32_u24 v20,1280,v13
v_lshl_add_u32 v20,v12,4,v20
v_add_u32 v12,64,v0
v_mul_u32_u24 v13,6554,v12
v_lshrrev_b32 v13,16,v13
v_mul_u32_u24 v16,10,v13
v_sub_u32 v12,v12,v16
v_mul_u32_u24 v21,1280,v13
v_lshl_add_u32 v21,v12,4,v21
v_add_u32 v12,128,v0
v_mul_u32_u24 v13,6554,v12
v_lshrrev_b32 v13,16,v13
v_mul_u32_u24 v16,10,v13
v_sub_u32 v12,v12,v16
v_mul_u32_u24 v22,1280,v13
v_lshl_add_u32 v22,v12,4,v22
v_add_u32 v12,192,v0
v_mul_u32_u24 v13,6554,v12
v_lshrrev_b32 v13,16,v13
v_mul_u32_u24 v16,10,v13
v_sub_u32 v12,v12,v16
v_mul_u32_u24 v23,1280,v13
v_lshl_add_u32 v23,v12,4,v23
v_add_u32 v12,256,v0
v_mul_u32_u24 v13,6554,v12
v_lshrrev_b32 v13,16,v13
v_mul_u32_u24 v16,10,v13
v_sub_u32 v12,v12,v16
v_mul_u32_u24 v24,1280,v13
v_lshl_add_u32 v24,v12,4,v24
v_add_u32 v12,320,v0
v_mul_u32_u24 v13,6554,v12
v_lshrrev_b32 v13,16,v13
v_mul_u32_u24 v16,10,v13
v_sub_u32 v12,v12,v16
v_mul_u32_u24 v25,1280,v13
v_lshl_add_u32 v25,v12,4,v25
v_add_u32 v12,384,v0
v_mul_u32_u24 v13,6554,v12
v_lshrrev_b32 v13,16,v13
v_mul_u32_u24 v16,10,v13
v_sub_u32 v12,v12,v16
v_mul_u32_u24 v26,1280,v13
v_lshl_add_u32 v26,v12,4,v26
v_add_u32 v12,448,v0
v_mul_u32_u24 v13,6554,v12
v_lshrrev_b32 v13,16,v13
v_mul_u32_u24 v16,10,v13
v_sub_u32 v12,v12,v16
v_mul_u32_u24 v27,1280,v13
v_lshl_add_u32 v27,v12,4,v27
v_add_u32 v12,512,v0
v_mul_u32_u24 v13,6554,v12
v_lshrrev_b32 v13,16,v13
v_mul_u32_u24 v16,10,v13
v_sub_u32 v12,v12,v16
v_mul_u32_u24 v28,1280,v13
v_lshl_add_u32 v28,v12,4,v28
v_add_u32 v12,576,v0
v_mul_u32_u24 v13,6554,v12
v_lshrrev_b32 v13,16,v13
v_mul_u32_u24 v16,10,v13
v_sub_u32 v12,v12,v16
v_mul_u32_u24 v29,1280,v13
v_lshl_add_u32 v29,v12,4,v29
v_lshrrev_b32 v14,4,v0
v_and_b32 v12,1,v14
v_lshlrev_b32 v12,5,v12
v_lshrrev_b32 v13,1,v14
v_lshl_add_u32 v12,v13,2,v12
v_bfe_u32 v13,v0,2,1
v_add_u32 v12,v12,v13
v_bfe_u32 v13,v0,3,1
v_lshl_add_u32 v12,v13,4,v12
v_mul_u32_u24 v30,160,v12
v_and_b32 v13,3,v0
v_lshl_add_u32 v30,v13,3,v30
v_add_u32 v30,s74,v30
s_add_u32 s61,s73,0
s_add_u32 m0,s74,0
s_nop 0
buffer_load_dwordx4 v20,s[4:7],s61 offen lds
s_add_u32 m0,s74,1024
s_nop 0
buffer_load_dwordx4 v21,s[4:7],s61 offen lds
s_add_u32 m0,s74,2048
s_nop 0
buffer_load_dwordx4 v22,s[4:7],s61 offen lds
s_add_u32 m0,s74,3072
s_nop 0
buffer_load_dwordx4 v23,s[4:7],s61 offen lds
s_add_u32 m0,s74,4096
s_nop 0
buffer_load_dwordx4 v24,s[4:7],s61 offen lds
s_add_u32 m0,s74,5120
s_nop 0
buffer_load_dwordx4 v25,s[4:7],s61 offen lds
s_add_u32 m0,s74,6144
s_nop 0
buffer_load_dwordx4 v26,s[4:7],s61 offen lds
s_add_u32 m0,s74,7168
s_nop 0
buffer_load_dwordx4 v27,s[4:7],s61 offen lds
s_add_u32 m0,s74,8192
s_nop 0
buffer_load_dwordx4 v28,s[4:7],s61 offen lds
s_add_u32 m0,s74,9216
s_nop 0
buffer_load_dwordx4 v29,s[4:7],s61 offen lds
s_add_u32 s61,s73,81920
s_add_u32 m0,s74,10240
s_nop 0
buffer_load_dwordx4 v20,s[4:7],s61 offen lds
s_add_u32 m0,s74,11264
s_nop 0
buffer_load_dwordx4 v21,s[4:7],s61 offen lds
s_add_u32 m0,s74,12288
s_nop 0
buffer_load_dwordx4 v22,s[4:7],s61 offen lds
s_add_u32 m0,s74,13312
s_nop 0
buffer_load_dwordx4 v23,s[4:7],s61 offen lds
s_add_u32 m0,s74,14336
s_nop 0
buffer_load_dwordx4 v24,s[4:7],s61 offen lds
s_add_u32 m0,s74,15360
s_nop 0
buffer_load_dwordx4 v25,s[4:7],s61 offen lds
s_add_u32 m0,s74,16384
s_nop 0
buffer_load_dwordx4 v26,s[4:7],s61 offen lds
s_add_u32 m0,s74,17408
s_nop 0
buffer_load_dwordx4 v27,s[4:7],s61 offen lds
s_add_u32 m0,s74,18432
s_nop 0
buffer_load_dwordx4 v28,s[4:7],s61 offen lds
s_add_u32 m0,s74,19456
s_nop 0
buffer_load_dwordx4 v29,s[4:7],s61 offen lds
s_add_u32 s61,s73,163840
s_add_u32 m0,s74,20480
s_nop 0
buffer_load_dwordx4 v20,s[4:7],s61 offen lds
s_add_u32 m0,s74,21504
s_nop 0
buffer_load_dwordx4 v21,s[4:7],s61 offen lds
s_add_u32 m0,s74,22528
s_nop 0
buffer_load_dwordx4 v22,s[4:7],s61 offen lds
s_add_u32 m0,s74,23552
s_nop 0
buffer_load_dwordx4 v23,s[4:7],s61 offen lds
s_add_u32 m0,s74,24576
s_nop 0
buffer_load_dwordx4 v24,s[4:7],s61 offen lds
s_add_u32 m0,s74,25600
s_nop 0
buffer_load_dwordx4 v25,s[4:7],s61 offen lds
s_add_u32 m0,s74,26624
s_nop 0
buffer_load_dwordx4 v26,s[4:7],s61 offen lds
s_add_u32 m0,s74,27648
s_nop 0
buffer_load_dwordx4 v27,s[4:7],s61 offen lds
s_add_u32 m0,s74,28672
s_nop 0
buffer_load_dwordx4 v28,s[4:7],s61 offen lds
s_add_u32 m0,s74,29696
s_nop 0
buffer_load_dwordx4 v29,s[4:7],s61 offen lds
s_add_u32 s61,s73,245760
s_add_u32 m0,s74,30720
s_nop 0
buffer_load_dwordx4 v20,s[4:7],s61 offen lds
s_add_u32 m0,s74,31744
s_nop 0
buffer_load_dwordx4 v21,s[4:7],s61 offen lds
s_add_u32 m0,s74,32768
s_nop 0
buffer_load_dwordx4 v22,s[4:7],s61 offen lds
s_add_u32 m0,s74,33792
s_nop 0
buffer_load_dwordx4 v23,s[4:7],s61 offen lds
s_add_u32 m0,s74,34816
s_nop 0
buffer_load_dwordx4 v24,s[4:7],s61 offen lds
s_add_u32 m0,s74,35840
s_nop 0
buffer_load_dwordx4 v25,s[4:7],s61 offen lds
s_add_u32 m0,s74,36864
s_nop 0
buffer_load_dwordx4 v26,s[4:7],s61 offen lds
s_add_u32 m0,s74,37888
s_nop 0
buffer_load_dwordx4 v27,s[4:7],s61 offen lds
s_add_u32 m0,s74,38912
s_nop 0
buffer_load_dwordx4 v28,s[4:7],s61 offen lds
s_add_u32 m0,s74,39936
s_nop 0
buffer_load_dwordx4 v29,s[4:7],s61 offen lds
s_waitcnt vmcnt(30)
ds_read_b64_tr_b16 a[0:1],v30 offset:0
ds_read_b64_tr_b16 a[2:3],v30 offset:320
ds_read_b64_tr_b16 a[4:5],v30 offset:1280
ds_read_b64_tr_b16 a[6:7],v30 offset:1600
ds_read_b64_tr_b16 a[8:9],v30 offset:32
ds_read_b64_tr_b16 a[10:11],v30 offset:352
ds_read_b64_tr_b16 a[12:13],v30 offset:1312
ds_read_b64_tr_b16 a[14:15],v30 offset:1632
ds_read_b64_tr_b16 a[16:17],v30 offset:64
ds_read_b64_tr_b16 a[18:19],v30 offset:384
ds_read_b64_tr_b16 a[20:21],v30 offset:1344
ds_read_b64_tr_b16 a[22:23],v30 offset:1664
s_waitcnt lgkmcnt(4)
ds_read_b64_tr_b16 a[24:25],v30 offset:96
ds_read_b64_tr_b16 a[26:27],v30 offset:416
ds_read_b64_tr_b16 a[28:29],v30 offset:1376
ds_read_b64_tr_b16 a[30:31],v30 offset:1696
ds_read_b64_tr_b16 v[32:33],v30 offset:128
ds_read_b64_tr_b16 v[34:35],v30 offset:448
ds_read_b64_tr_b16 v[36:37],v30 offset:1408
ds_read_b64_tr_b16 v[38:39],v30 offset:1728
s_waitcnt lgkmcnt(0)
s_add_u32 s61,s73,327680
s_add_u32 m0,s74,0
s_nop 0
buffer_load_dwordx4 v20,s[4:7],s61 offen lds
s_add_u32 m0,s74,1024
s_nop 0
buffer_load_dwordx4 v21,s[4:7],s61 offen lds
s_add_u32 m0,s74,2048
s_nop 0
buffer_load_dwordx4 v22,s[4:7],s61 offen lds
s_add_u32 m0,s74,3072
s_nop 0
buffer_load_dwordx4 v23,s[4:7],s61 offen lds
s_add_u32 m0,s74,4096
s_nop 0
buffer_load_dwordx4 v24,s[4:7],s61 offen lds
s_add_u32 m0,s74,5120
s_nop 0
buffer_load_dwordx4 v25,s[4:7],s61 offen lds
s_add_u32 m0,s74,6144
s_nop 0
buffer_load_dwordx4 v26,s[4:7],s61 offen lds
s_add_u32 m0,s74,7168
s_nop 0
buffer_load_dwordx4 v27,s[4:7],s61 offen lds
s_add_u32 m0,s74,8192
s_nop 0
buffer_load_dwordx4 v28,s[4:7],s61 offen lds
s_add_u32 m0,s74,9216
s_nop 0
buffer_load_dwordx4 v29,s[4:7],s61 offen lds
s_waitcnt vmcnt(30)
ds_read_b64_tr_b16 a[32:33],v30 offset:10240
ds_read_b64_tr_b16 a[34:35],v30 offset:10560
ds_read_b64_tr_b16 a[36:37],v30 offset:11520
ds_read_b64_tr_b16 a[38:39],v30 offset:11840
ds_read_b64_tr_b16 a[40:41],v30 offset:10272
ds_read_b64_tr_b16 a[42:43],v30 offset:10592
ds_read_b64_tr_b16 a[44:45],v30 offset:11552
ds_read_b64_tr_b16 a[46:47],v30 offset:11872
ds_read_b64_tr_b16 a[48:49],v30 offset:10304
ds_read_b64_tr_b16 a[50:51],v30 offset:10624
ds_read_b64_tr_b16 a[52:53],v30 offset:11584
ds_read_b64_tr_b16 a[54:55],v30 offset:11904
s_waitcnt lgkmcnt(4)
ds_read_b64_tr_b16 a[56:57],v30 offset:10336
ds_read_b64_tr_b16 a[58:59],v30 offset:10656
ds_read_b64_tr_b16 a[60:61],v30 offset:11616
ds_read_b64_tr_b16 a[62:63],v30 offset:11936
ds_read_b64_tr_b16 v[40:41],v30 offset:10368
ds_read_b64_tr_b16 v[42:43],v30 offset:10688
ds_read_b64_tr_b16 v[44:45],v30 offset:11648
ds_read_b64_tr_b16 v[46:47],v30 offset:11968
s_waitcnt lgkmcnt(0)
s_add_u32 s61,s73,409600
s_add_u32 m0,s74,10240
s_nop 0
buffer_load_dwordx4 v20,s[4:7],s61 offen lds
s_add_u32 m0,s74,11264
s_nop 0
buffer_load_dwordx4 v21,s[4:7],s61 offen lds
s_add_u32 m0,s74,12288
s_nop 0
buffer_load_dwordx4 v22,s[4:7],s61 offen lds
s_add_u32 m0,s74,13312
s_nop 0
buffer_load_dwordx4 v23,s[4:7],s61 offen lds
s_add_u32 m0,s74,14336
s_nop 0
buffer_load_dwordx4 v24,s[4:7],s61 offen lds
s_add_u32 m0,s74,15360
s_nop 0
buffer_load_dwordx4 v25,s[4:7],s61 offen lds
s_add_u32 m0,s74,16384
s_nop 0
buffer_load_dwordx4 v26,s[4:7],s61 offen lds
s_add_u32 m0,s74,17408
s_nop 0
buffer_load_dwordx4 v27,s[4:7],s61 offen lds
s_add_u32 m0,s74,18432
s_nop 0
buffer_load_dwordx4 v28,s[4:7],s61 offen lds
s_add_u32 m0,s74,19456
s_nop 0
buffer_load_dwordx4 v29,s[4:7],s61 offen lds
s_waitcnt vmcnt(30)
ds_read_b64_tr_b16 a[64:65],v30 offset:20480
ds_read_b64_tr_b16 a[66:67],v30 offset:20800
ds_read_b64_tr_b16 a[68:69],v30 offset:21760
ds_read_b64_tr_b16 a[70:71],v30 offset:22080
ds_read_b64_tr_b16 a[72:73],v30 offset:20512
ds_read_b64_tr_b16 a[74:75],v30 offset:20832
ds_read_b64_tr_b16 a[76:77],v30 offset:21792
ds_read_b64_tr_b16 a[78:79],v30 offset:22112
ds_read_b64_tr_b16 a[80:81],v30 offset:20544
ds_read_b64_tr_b16 a[82:83],v30 offset:20864
ds_read_b64_tr_b16 a[84:85],v30 offset:21824
ds_read_b64_tr_b16 a[86:87],v30 offset:22144
s_waitcnt lgkmcnt(4)
ds_read_b64_tr_b16 a[88:89],v30 offset:20576
ds_read_b64_tr_b16 a[90:91],v30 offset:20896
ds_read_b64_tr_b16 a[92:93],v30 offset:21856
ds_read_b64_tr_b16 a[94:95],v30 offset:22176
ds_read_b64_tr_b16 v[48:49],v30 offset:20608
ds_read_b64_tr_b16 v[50:51],v30 offset:20928
ds_read_b64_tr_b16 v[52:53],v30 offset:21888
ds_read_b64_tr_b16 v[54:55],v30 offset:22208
s_waitcnt lgkmcnt(0)
s_add_u32 s61,s73,491520
s_add_u32 m0,s74,20480
s_nop 0
buffer_load_dwordx4 v20,s[4:7],s61 offen lds
s_add_u32 m0,s74,21504
s_nop 0
buffer_load_dwordx4 v21,s[4:7],s61 offen lds
s_add_u32 m0,s74,22528
s_nop 0
buffer_load_dwordx4 v22,s[4:7],s61 offen lds
s_add_u32 m0,s74,23552
s_nop 0
buffer_load_dwordx4 v23,s[4:7],s61 offen lds
s_add_u32 m0,s74,24576
s_nop 0
buffer_load_dwordx4 v24,s[4:7],s61 offen lds
s_add_u32 m0,s74,25600
s_nop 0
buffer_load_dwordx4 v25,s[4:7],s61 offen lds
s_add_u32 m0,s74,26624
s_nop 0
buffer_load_dwordx4 v26,s[4:7],s61 offen lds
s_add_u32 m0,s74,27648
s_nop 0
buffer_load_dwordx4 v27,s[4:7],s61 offen lds
s_add_u32 m0,s74,28672
s_nop 0
buffer_load_dwordx4 v28,s[4:7],s61 offen lds
s_add_u32 m0,s74,29696
s_nop 0
buffer_load_dwordx4 v29,s[4:7],s61 offen lds
s_waitcnt vmcnt(30)
ds_read_b64_tr_b16 a[96:97],v30 offset:30720
ds_read_b64_tr_b16 a[98:99],v30 offset:31040
ds_read_b64_tr_b16 a[100:101],v30 offset:32000
ds_read_b64_tr_b16 a[102:103],v30 offset:32320
ds_read_b64_tr_b16 a[104:105],v30 offset:30752
ds_read_b64_tr_b16 a[106:107],v30 offset:31072
ds_read_b64_tr_b16 a[108:109],v30 offset:32032
ds_read_b64_tr_b16 a[110:111],v30 offset:32352
ds_read_b64_tr_b16 a[112:113],v30 offset:30784
ds_read_b64_tr_b16 a[114:115],v30 offset:31104
ds_read_b64_tr_b16 a[116:117],v30 offset:32064
ds_read_b64_tr_b16 a[118:119],v30 offset:32384
s_waitcnt lgkmcnt(4)
ds_read_b64_tr_b16 a[120:121],v30 offset:30816
ds_read_b64_tr_b16 a[122:123],v30 offset:31136
ds_read_b64_tr_b16 a[124:125],v30 offset:32096
ds_read_b64_tr_b16 a[126:127],v30 offset:32416
ds_read_b64_tr_b16 v[56:57],v30 offset:30848
ds_read_b64_tr_b16 v[58:59],v30 offset:31168
ds_read_b64_tr_b16 v[60:61],v30 offset:32128
ds_read_b64_tr_b16 v[62:63],v30 offset:32448
s_waitcnt lgkmcnt(0)
s_add_u32 s61,s73,573440
s_add_u32 m0,s74,30720
s_nop 0
buffer_load_dwordx4 v20,s[4:7],s61 offen lds
s_add_u32 m0,s74,31744
s_nop 0
buffer_load_dwordx4 v21,s[4:7],s61 offen lds
s_add_u32 m0,s74,32768
s_nop 0
buffer_load_dwordx4 v22,s[4:7],s61 offen lds
s_add_u32 m0,s74,33792
s_nop 0
buffer_load_dwordx4 v23,s[4:7],s61 offen lds
s_add_u32 m0,s74,34816
s_nop 0
buffer_load_dwordx4 v24,s[4:7],s61 offen lds
s_add_u32 m0,s74,35840
s_nop 0
buffer_load_dwordx4 v25,s[4:7],s61 offen lds
s_add_u32 m0,s74,36864
s_nop 0
buffer_load_dwordx4 v26,s[4:7],s61 offen lds
s_add_u32 m0,s74,37888
s_nop 0
buffer_load_dwordx4 v27,s[4:7],s61 offen lds
s_add_u32 m0,s74,38912
s_nop 0
buffer_load_dwordx4 v28,s[4:7],s61 offen lds
s_add_u32 m0,s74,39936
s_nop 0
buffer_load_dwordx4 v29,s[4:7],s61 offen lds
s_waitcnt vmcnt(30)
ds_read_b64_tr_b16 a[128:129],v30 offset:0
ds_read_b64_tr_b16 a[130:131],v30 offset:320
ds_read_b64_tr_b16 a[132:133],v30 offset:1280
ds_read_b64_tr_b16 a[134:135],v30 offset:1600
ds_read_b64_tr_b16 a[136:137],v30 offset:32
ds_read_b64_tr_b16 a[138:139],v30 offset:352
ds_read_b64_tr_b16 a[140:141],v30 offset:1312
ds_read_b64_tr_b16 a[142:143],v30 offset:1632
ds_read_b64_tr_b16 a[144:145],v30 offset:64
ds_read_b64_tr_b16 a[146:147],v30 offset:384
ds_read_b64_tr_b16 a[148:149],v30 offset:1344
ds_read_b64_tr_b16 a[150:151],v30 offset:1664
s_waitcnt lgkmcnt(4)
ds_read_b64_tr_b16 a[152:153],v30 offset:96
ds_read_b64_tr_b16 a[154:155],v30 offset:416
ds_read_b64_tr_b16 a[156:157],v30 offset:1376
ds_read_b64_tr_b16 a[158:159],v30 offset:1696
ds_read_b64_tr_b16 v[64:65],v30 offset:128
ds_read_b64_tr_b16 v[66:67],v30 offset:448
ds_read_b64_tr_b16 v[68:69],v30 offset:1408
ds_read_b64_tr_b16 v[70:71],v30 offset:1728
s_waitcnt lgkmcnt(0)
s_add_u32 s61,s73,655360
s_add_u32 m0,s74,0
s_nop 0
buffer_load_dwordx4 v20,s[4:7],s61 offen lds
s_add_u32 m0,s74,1024
s_nop 0
buffer_load_dwordx4 v21,s[4:7],s61 offen lds
s_add_u32 m0,s74,2048
s_nop 0
buffer_load_dwordx4 v22,s[4:7],s61 offen lds
s_add_u32 m0,s74,3072
s_nop 0
buffer_load_dwordx4 v23,s[4:7],s61 offen lds
s_add_u32 m0,s74,4096
s_nop 0
buffer_load_dwordx4 v24,s[4:7],s61 offen lds
s_add_u32 m0,s74,5120
s_nop 0
buffer_load_dwordx4 v25,s[4:7],s61 offen lds
s_add_u32 m0,s74,6144
s_nop 0
buffer_load_dwordx4 v26,s[4:7],s61 offen lds
s_add_u32 m0,s74,7168
s_nop 0
buffer_load_dwordx4 v27,s[4:7],s61 offen lds
s_add_u32 m0,s74,8192
s_nop 0
buffer_load_dwordx4 v28,s[4:7],s61 offen lds
s_add_u32 m0,s74,9216
s_nop 0
buffer_load_dwordx4 v29,s[4:7],s61 offen lds
s_waitcnt vmcnt(30)
ds_read_b64_tr_b16 a[160:161],v30 offset:10240
ds_read_b64_tr_b16 a[162:163],v30 offset:10560
ds_read_b64_tr_b16 a[164:165],v30 offset:11520
ds_read_b64_tr_b16 a[166:167],v30 offset:11840
ds_read_b64_tr_b16 a[168:169],v30 offset:10272
ds_read_b64_tr_b16 a[170:171],v30 offset:10592
ds_read_b64_tr_b16 a[172:173],v30 offset:11552
ds_read_b64_tr_b16 a[174:175],v30 offset:11872
ds_read_b64_tr_b16 a[176:177],v30 offset:10304
ds_read_b64_tr_b16 a[178:179],v30 offset:10624
ds_read_b64_tr_b16 a[180:181],v30 offset:11584
ds_read_b64_tr_b16 a[182:183],v30 offset:11904
s_waitcnt lgkmcnt(4)
ds_read_b64_tr_b16 a[184:185],v30 offset:10336
ds_read_b64_tr_b16 a[186:187],v30 offset:10656
ds_read_b64_tr_b16 a[188:189],v30 offset:11616
ds_read_b64_tr_b16 a[190:191],v30 offset:11936
ds_read_b64_tr_b16 v[72:73],v30 offset:10368
ds_read_b64_tr_b16 v[74:75],v30 offset:10688
ds_read_b64_tr_b16 v[76:77],v30 offset:11648
ds_read_b64_tr_b16 v[78:79],v30 offset:11968
s_waitcnt lgkmcnt(0)
s_add_u32 s61,s73,737280
s_add_u32 m0,s74,10240
s_nop 0
buffer_load_dwordx4 v20,s[4:7],s61 offen lds
s_add_u32 m0,s74,11264
s_nop 0
buffer_load_dwordx4 v21,s[4:7],s61 offen lds
s_add_u32 m0,s74,12288
s_nop 0
buffer_load_dwordx4 v22,s[4:7],s61 offen lds
s_add_u32 m0,s74,13312
s_nop 0
buffer_load_dwordx4 v23,s[4:7],s61 offen lds
s_add_u32 m0,s74,14336
s_nop 0
buffer_load_dwordx4 v24,s[4:7],s61 offen lds
s_add_u32 m0,s74,15360
s_nop 0
buffer_load_dwordx4 v25,s[4:7],s61 offen lds
s_add_u32 m0,s74,16384
s_nop 0
buffer_load_dwordx4 v26,s[4:7],s61 offen lds
s_add_u32 m0,s74,17408
s_nop 0
buffer_load_dwordx4 v27,s[4:7],s61 offen lds
s_add_u32 m0,s74,18432
s_nop 0
buffer_load_dwordx4 v28,s[4:7],s61 offen lds
s_add_u32 m0,s74,19456
s_nop 0
buffer_load_dwordx4 v29,s[4:7],s61 offen lds
s_waitcnt vmcnt(30)
ds_read_b64_tr_b16 a[192:193],v30 offset:20480
ds_read_b64_tr_b16 a[194:195],v30 offset:20800
ds_read_b64_tr_b16 a[196:197],v30 offset:21760
ds_read_b64_tr_b16 a[198:199],v30 offset:22080
ds_read_b64_tr_b16 a[200:201],v30 offset:20512
ds_read_b64_tr_b16 a[202:203],v30 offset:20832
ds_read_b64_tr_b16 a[204:205],v30 offset:21792
ds_read_b64_tr_b16 a[206:207],v30 offset:22112
ds_read_b64_tr_b16 a[208:209],v30 offset:20544
ds_read_b64_tr_b16 a[210:211],v30 offset:20864
ds_read_b64_tr_b16 a[212:213],v30 offset:21824
ds_read_b64_tr_b16 a[214:215],v30 offset:22144
s_waitcnt lgkmcnt(4)
ds_read_b64_tr_b16 a[216:217],v30 offset:20576
ds_read_b64_tr_b16 a[218:219],v30 offset:20896
ds_read_b64_tr_b16 a[220:221],v30 offset:21856
ds_read_b64_tr_b16 a[222:223],v30 offset:22176
ds_read_b64_tr_b16 v[80:81],v30 offset:20608
ds_read_b64_tr_b16 v[82:83],v30 offset:20928
ds_read_b64_tr_b16 v[84:85],v30 offset:21888
ds_read_b64_tr_b16 v[86:87],v30 offset:22208
s_waitcnt lgkmcnt(0)
s_add_u32 s61,s73,819200
s_add_u32 m0,s74,20480
s_nop 0
buffer_load_dwordx4 v20,s[4:7],s61 offen lds
s_add_u32 m0,s74,21504
s_nop 0
buffer_load_dwordx4 v21,s[4:7],s61 offen lds
s_add_u32 m0,s74,22528
s_nop 0
buffer_load_dwordx4 v22,s[4:7],s61 offen lds
s_add_u32 m0,s74,23552
s_nop 0
buffer_load_dwordx4 v23,s[4:7],s61 offen lds
s_add_u32 m0,s74,24576
s_nop 0
buffer_load_dwordx4 v24,s[4:7],s61 offen lds
s_add_u32 m0,s74,25600
s_nop 0
buffer_load_dwordx4 v25,s[4:7],s61 offen lds
s_add_u32 m0,s74,26624
s_nop 0
buffer_load_dwordx4 v26,s[4:7],s61 offen lds
s_add_u32 m0,s74,27648
s_nop 0
buffer_load_dwordx4 v27,s[4:7],s61 offen lds
s_add_u32 m0,s74,28672
s_nop 0
buffer_load_dwordx4 v28,s[4:7],s61 offen lds
s_add_u32 m0,s74,29696
s_nop 0
buffer_load_dwordx4 v29,s[4:7],s61 offen lds
s_waitcnt vmcnt(30)
ds_read_b64_tr_b16 a[224:225],v30 offset:30720
ds_read_b64_tr_b16 a[226:227],v30 offset:31040
ds_read_b64_tr_b16 a[228:229],v30 offset:32000
ds_read_b64_tr_b16 a[230:231],v30 offset:32320
ds_read_b64_tr_b16 a[232:233],v30 offset:30752
ds_read_b64_tr_b16 a[234:235],v30 offset:31072
ds_read_b64_tr_b16 a[236:237],v30 offset:32032
ds_read_b64_tr_b16 a[238:239],v30 offset:32352
ds_read_b64_tr_b16 a[240:241],v30 offset:30784
ds_read_b64_tr_b16 a[242:243],v30 offset:31104
ds_read_b64_tr_b16 a[244:245],v30 offset:32064
ds_read_b64_tr_b16 a[246:247],v30 offset:32384
s_waitcnt lgkmcnt(4)
ds_read_b64_tr_b16 a[248:249],v30 offset:30816
ds_read_b64_tr_b16 a[250:251],v30 offset:31136
ds_read_b64_tr_b16 a[252:253],v30 offset:32096
ds_read_b64_tr_b16 a[254:255],v30 offset:32416
ds_read_b64_tr_b16 v[88:89],v30 offset:30848
ds_read_b64_tr_b16 v[90:91],v30 offset:31168
ds_read_b64_tr_b16 v[92:93],v30 offset:32128
ds_read_b64_tr_b16 v[94:95],v30 offset:32448
s_waitcnt lgkmcnt(0)
s_add_u32 s61,s73,901120
s_add_u32 m0,s74,30720
s_nop 0
buffer_load_dwordx4 v20,s[4:7],s61 offen lds
s_add_u32 m0,s74,31744
s_nop 0
buffer_load_dwordx4 v21,s[4:7],s61 offen lds
s_add_u32 m0,s74,32768
s_nop 0
buffer_load_dwordx4 v22,s[4:7],s61 offen lds
s_add_u32 m0,s74,33792
s_nop 0
buffer_load_dwordx4 v23,s[4:7],s61 offen lds
s_add_u32 m0,s74,34816
s_nop 0
buffer_load_dwordx4 v24,s[4:7],s61 offen lds
s_add_u32 m0,s74,35840
s_nop 0
buffer_load_dwordx4 v25,s[4:7],s61 offen lds
s_add_u32 m0,s74,36864
s_nop 0
buffer_load_dwordx4 v26,s[4:7],s61 offen lds
s_add_u32 m0,s74,37888
s_nop 0
buffer_load_dwordx4 v27,s[4:7],s61 offen lds
s_add_u32 m0,s74,38912
s_nop 0
buffer_load_dwordx4 v28,s[4:7],s61 offen lds
s_add_u32 m0,s74,39936
s_nop 0
buffer_load_dwordx4 v29,s[4:7],s61 offen lds
s_waitcnt vmcnt(30)
ds_read_b64_tr_b16 v[128:129],v30 offset:0
ds_read_b64_tr_b16 v[130:131],v30 offset:320
ds_read_b64_tr_b16 v[132:133],v30 offset:1280
ds_read_b64_tr_b16 v[134:135],v30 offset:1600
ds_read_b64_tr_b16 v[136:137],v30 offset:32
ds_read_b64_tr_b16 v[138:139],v30 offset:352
ds_read_b64_tr_b16 v[140:141],v30 offset:1312
ds_read_b64_tr_b16 v[142:143],v30 offset:1632
ds_read_b64_tr_b16 v[144:145],v30 offset:64
ds_read_b64_tr_b16 v[146:147],v30 offset:384
ds_read_b64_tr_b16 v[148:149],v30 offset:1344
ds_read_b64_tr_b16 v[150:151],v30 offset:1664
s_waitcnt lgkmcnt(4)
ds_read_b64_tr_b16 v[152:153],v30 offset:96
ds_read_b64_tr_b16 v[154:155],v30 offset:416
ds_read_b64_tr_b16 v[156:157],v30 offset:1376
ds_read_b64_tr_b16 v[158:159],v30 offset:1696
ds_read_b64_tr_b16 v[96:97],v30 offset:128
ds_read_b64_tr_b16 v[98:99],v30 offset:448
ds_read_b64_tr_b16 v[100:101],v30 offset:1408
ds_read_b64_tr_b16 v[102:103],v30 offset:1728
s_waitcnt lgkmcnt(0)
s_waitcnt vmcnt(20)
ds_read_b64_tr_b16 v[160:161],v30 offset:10240
ds_read_b64_tr_b16 v[162:163],v30 offset:10560
ds_read_b64_tr_b16 v[164:165],v30 offset:11520
ds_read_b64_tr_b16 v[166:167],v30 offset:11840
ds_read_b64_tr_b16 v[168:169],v30 offset:10272
ds_read_b64_tr_b16 v[170:171],v30 offset:10592
ds_read_b64_tr_b16 v[172:173],v30 offset:11552
ds_read_b64_tr_b16 v[174:175],v30 offset:11872
ds_read_b64_tr_b16 v[176:177],v30 offset:10304
ds_read_b64_tr_b16 v[178:179],v30 offset:10624
ds_read_b64_tr_b16 v[180:181],v30 offset:11584
ds_read_b64_tr_b16 v[182:183],v30 offset:11904
s_waitcnt lgkmcnt(4)
ds_read_b64_tr_b16 v[184:185],v30 offset:10336
ds_read_b64_tr_b16 v[186:187],v30 offset:10656
ds_read_b64_tr_b16 v[188:189],v30 offset:11616
ds_read_b64_tr_b16 v[190:191],v30 offset:11936
ds_read_b64_tr_b16 v[104:105],v30 offset:10368
ds_read_b64_tr_b16 v[106:107],v30 offset:10688
ds_read_b64_tr_b16 v[108:109],v30 offset:11648
ds_read_b64_tr_b16 v[110:111],v30 offset:11968
s_waitcnt lgkmcnt(0)
s_waitcnt vmcnt(10)
ds_read_b64_tr_b16 v[192:193],v30 offset:20480
ds_read_b64_tr_b16 v[194:195],v30 offset:20800
ds_read_b64_tr_b16 v[196:197],v30 offset:21760
ds_read_b64_tr_b16 v[198:199],v30 offset:22080
ds_read_b64_tr_b16 v[200:201],v30 offset:20512
ds_read_b64_tr_b16 v[202:203],v30 offset:20832
ds_read_b64_tr_b16 v[204:205],v30 offset:21792
ds_read_b64_tr_b16 v[206:207],v30 offset:22112
ds_read_b64_tr_b16 v[208:209],v30 offset:20544
ds_read_b64_tr_b16 v[210:211],v30 offset:20864
ds_read_b64_tr_b16 v[212:213],v30 offset:21824
ds_read_b64_tr_b16 v[214:215],v30 offset:22144
s_waitcnt lgkmcnt(4)
ds_read_b64_tr_b16 v[216:217],v30 offset:20576
ds_read_b64_tr_b16 v[218:219],v30 offset:20896
ds_read_b64_tr_b16 v[220:221],v30 offset:21856
ds_read_b64_tr_b16 v[222:223],v30 offset:22176
ds_read_b64_tr_b16 v[112:113],v30 offset:20608
ds_read_b64_tr_b16 v[114:115],v30 offset:20928
ds_read_b64_tr_b16 v[116:117],v30 offset:21888
ds_read_b64_tr_b16 v[118:119],v30 offset:22208
s_waitcnt lgkmcnt(0)
s_waitcnt vmcnt(0)
ds_read_b64_tr_b16 v[224:225],v30 offset:30720
ds_read_b64_tr_b16 v[226:227],v30 offset:31040
ds_read_b64_tr_b16 v[228:229],v30 offset:32000
ds_read_b64_tr_b16 v[230:231],v30 offset:32320
ds_read_b64_tr_b16 v[232:233],v30 offset:30752
ds_read_b64_tr_b16 v[234:235],v30 offset:31072
ds_read_b64_tr_b16 v[236:237],v30 offset:32032
ds_read_b64_tr_b16 v[238:239],v30 offset:32352
ds_read_b64_tr_b16 v[240:241],v30 offset:30784
ds_read_b64_tr_b16 v[242:243],v30 offset:31104
ds_read_b64_tr_b16 v[244:245],v30 offset:32064
ds_read_b64_tr_b16 v[246:247],v30 offset:32384
s_waitcnt lgkmcnt(4)
ds_read_b64_tr_b16 v[248:249],v30 offset:30816
ds_read_b64_tr_b16 v[250:251],v30 offset:31136
ds_read_b64_tr_b16 v[252:253],v30 offset:32096
ds_read_b64_tr_b16 v[254:255],v30 offset:32416
ds_read_b64_tr_b16 v[120:121],v30 offset:30848
ds_read_b64_tr_b16 v[122:123],v30 offset:31168
ds_read_b64_tr_b16 v[124:125],v30 offset:32128
ds_read_b64_tr_b16 v[126:127],v30 offset:32448
s_waitcnt lgkmcnt(0)
s_barrier
ds_write_b128 v4,v[32:35] offset:0
ds_write_b128 v4,v[36:39] offset:1024
ds_write_b128 v4,v[40:43] offset:2048
ds_write_b128 v4,v[44:47] offset:3072
ds_write_b128 v4,v[48:51] offset:4096
ds_write_b128 v4,v[52:55] offset:5120
ds_write_b128 v4,v[56:59] offset:6144
ds_write_b128 v4,v[60:63] offset:7168
s_waitcnt lgkmcnt(0)
ds_write_b128 v4,v[64:67] offset:8192
ds_write_b128 v4,v[68:71] offset:9216
ds_write_b128 v4,v[72:75] offset:10240
ds_write_b128 v4,v[76:79] offset:11264
ds_write_b128 v4,v[80:83] offset:12288
ds_write_b128 v4,v[84:87] offset:13312
ds_write_b128 v4,v[88:91] offset:14336
ds_write_b128 v4,v[92:95] offset:15360
s_waitcnt lgkmcnt(0)
ds_write_b128 v4,v[96:99] offset:16384
ds_write_b128 v4,v[100:103] offset:17408
ds_write_b128 v4,v[104:107] offset:18432
ds_write_b128 v4,v[108:111] offset:19456
ds_write_b128 v4,v[112:115] offset:20480
ds_write_b128 v4,v[116:119] offset:21504
ds_write_b128 v4,v[120:123] offset:22528
ds_write_b128 v4,v[124:127] offset:23552
s_waitcnt lgkmcnt(0)
s_barrier
s_lshl_b32 s3,s49,2
v_mov_b32 v13,s3
s_nop 1
ibw_178:
buffer_load_dword v12,v13,s[12:15],0 offen sc1
s_waitcnt vmcnt(0)
v_cmp_ne_u32 vcc,256,v12
s_nop 0
s_cbranch_vccz ok_179
s_sleep 8
s_sub_u32 s47,s47,1
s_cbranch_scc1 ABORT
s_branch ibw_178
ok_179:
s_cmp_lg_u32 s49,0
s_cbranch_scc1 ibok_180
v_and_b32 v13,7,v0
v_lshlrev_b32 v13,2,v13
buffer_load_dword v12,v13,s[12:15],0 offen offset:32 sc1
s_waitcnt vmcnt(0)
v_cmp_ne_u32 vcc,32,v12
s_nop 0
s_cbranch_vccz ibok_180
s_barrier
s_mov_b32 s49,1
s_mov_b32 s3,s2
s_load_dwordx16 s[16:31],s[0:1],0
s_load_dwordx8 s[32:39],s[0:1],64
s_waitcnt lgkmcnt(0)
s_branch DISPATCH
ibok_180:
v_mov_b32 v13,192
s_cmp_lg_u32 s49,0
s_cbranch_scc1 vx_182
vw_181:
buffer_load_dword v12,v13,s[12:15],0 offen sc1
s_waitcnt vmcnt(0)
v_and_b32 v14,0xffff,v12
v_cmp_ne_u32 vcc,32,v14
s_nop 0
s_cbranch_vccz ok_183
s_sleep 4
s_sub_u32 s47,s47,1
s_cbranch_scc1 ABORT
s_branch vw_181
ok_183:
v_readfirstlane_b32 s60,v12
s_cmp_gt_u32 s60,1114112
s_cselect_b32 s60,0x2000,0
s_add_u32 s83,s83,s60
s_nop 1
vx_182:
s_mov_b32 s50,0
s_mov_b32 s77,0
ds_read_b128 v[20:23],v4 offset:12288
ds_read_b128 v[24:27],v4 offset:13312
ds_read_b128 v[116:119],v4 offset:22528
ds_read_b128 v[120:123],v4 offset:23552
s_waitcnt lgkmcnt(0)
s_cmp_lg_u32 s49,0
s_cbranch_scc1 CW_LOOP_S
CW_LOOP_F:
s_sub_u32 s60,s50,13
s_lshr_b32 s52,s60,1
s_and_b32 s51,s60,1
s_cmp_eq_u32 s51,0
s_cselect_b32 s61,13,0
s_add_u32 s52,s52,s61
s_sub_u32 s61,s60,51
s_cmp_ge_u32 s60,102
s_cselect_b32 s52,s61,s52
s_cselect_b32 s51,1,s51
s_cmp_lt_u32 s50,13
s_cselect_b32 s52,s50,s52
s_cselect_b32 s51,0,s51
s_cmp_eq_u32 s52,63
s_cbranch_scc1 CW_NEXT_F
s_add_u32 s58,s52,1
s_lshl_b32 s61,s51,9
s_add_u32 s72,s61,s35
s_add_u32 s69,s61,s85
s_lshl_b32 s61,s51,2
s_and_b32 s60,s52,1
s_add_u32 s60,s60,s61
s_mul_i32 s70,s60,49152
s_add_u32 s70,s70,s33
s_add_u32 s71,s70,4096
s_add_u32 s80,s70,8192
s_bfe_u32 s57,s52,65537
s_bfe_u32 s31,s58,65537
s_and_b32 s60,s58,1
s_add_u32 s60,s60,s61
s_mul_i32 s59,s60,20480
s_add_u32 s59,s59,s84
s_lshl_b32 s68,s60,16
s_add_u32 s68,s68,s83
s_xor_b32 s77,s77,11264
v_add_u32 v7,s77,v5
v_add_u32 v8,s77,v6
s_add_u32 s60,s52,2
v_mov_b32 v16,s60
ds_read_b128 v[100:103],v4 offset:0
ds_read_b128 v[104:107],v4 offset:1024
ds_read_b128 v[108:111],v4 offset:6144
ds_read_b128 v[112:115],v4 offset:7168
s_cmp_lg_u32 s46,0
s_cbranch_scc1 np_184
db_186:
buffer_load_dword v12,v3,s[8:11],s72 offen sc1
s_waitcnt vmcnt(0)
v_cmp_gt_u32 vcc,s58,v12
s_cbranch_vccz dbok_187
s_sub_u32 s47,s47,1
s_cbranch_scc1 ABORT
s_branch db_186
dbok_187:
np_184:
s_barrier
rd_185:
buffer_load_dwordx4 v[32:35],v1,s[8:11],s70 offen sc1
v_mov_b32 v80,0
v_mov_b32 v81,0
v_mov_b32 v82,0
v_mov_b32 v83,0
v_mov_b32 v84,0
buffer_load_dwordx4 v[36:39],v1,s[8:11],s70 offen offset:3072 sc1
v_mov_b32 v85,0
v_mov_b32 v86,0
v_mov_b32 v87,0
v_mov_b32 v88,0
v_mov_b32 v89,0
buffer_load_dwordx4 v[40:43],v1,s[8:11],s71 offen offset:2048 sc1
v_mov_b32 v90,0
v_mov_b32 v91,0
v_mov_b32 v92,0
v_mov_b32 v93,0
v_mov_b32 v94,0
buffer_load_dwordx4 v[44:47],v1,s[8:11],s80 offen offset:1024 sc1
v_mov_b32 v95,0
v_mov_b32 v96,0
v_mov_b32 v97,0
v_mov_b32 v98,0
v_mov_b32 v99,0
buffer_load_dwordx4 v[48:51],v1,s[8:11],s70 offen offset:1024 sc1
s_waitcnt vmcnt(4)
v_and_b32 v12,1,v32
v_cmp_ne_u32 vcc,s57,v12
s_cbranch_vccnz ws_188
wg_192:
v_smfmac_f32_16x16x64_bf16 v[80:83],v[32:35],a[0:7],v2
buffer_load_dwordx4 v[52:55],v1,s[8:11],s71 offen sc1
v_smfmac_f32_16x16x64_bf16 v[84:87],v[32:35],a[8:15],v2
s_waitcnt vmcnt(4)
v_and_b32 v12,1,v36
v_smfmac_f32_16x16x64_bf16 v[88:91],v[32:35],a[16:23],v2
v_cmp_ne_u32 vcc,s57,v12
v_smfmac_f32_16x16x64_bf16 v[92:95],v[32:35],a[24:31],v2
s_waitcnt lgkmcnt(2)
v_smfmac_f32_16x16x64_bf16 v[96:99],v[32:35],v[100:107],v2
s_cbranch_vccnz ws_189
wg_193:
v_smfmac_f32_16x16x64_bf16 v[80:83],v[36:39],a[96:103],v2
buffer_load_dwordx4 v[56:59],v1,s[8:11],s71 offen offset:3072 sc1
v_smfmac_f32_16x16x64_bf16 v[84:87],v[36:39],a[104:111],v2
s_waitcnt vmcnt(4)
v_and_b32 v12,1,v40
v_smfmac_f32_16x16x64_bf16 v[88:91],v[36:39],a[112:119],v2
v_cmp_ne_u32 vcc,s57,v12
v_smfmac_f32_16x16x64_bf16 v[92:95],v[36:39],a[120:127],v2
s_waitcnt lgkmcnt(0)
v_smfmac_f32_16x16x64_bf16 v[96:99],v[36:39],v[108:115],v2
s_cbranch_vccnz ws_190
wg_194:
v_smfmac_f32_16x16x64_bf16 v[80:83],v[40:43],a[192:199],v2
buffer_load_dwordx4 v[60:63],v1,s[8:11],s80 offen offset:2048 sc1
v_smfmac_f32_16x16x64_bf16 v[84:87],v[40:43],a[200:207],v2
s_waitcnt vmcnt(4)
v_and_b32 v12,1,v44
v_smfmac_f32_16x16x64_bf16 v[88:91],v[40:43],a[208:215],v2
v_cmp_ne_u32 vcc,s57,v12
ds_read_b128 v[100:103],v4 offset:18432
v_smfmac_f32_16x16x64_bf16 v[92:95],v[40:43],a[216:223],v2
ds_read_b128 v[104:107],v4 offset:19456
v_smfmac_f32_16x16x64_bf16 v[96:99],v[40:43],v[20:27],v2
s_cbranch_vccnz ws_191
wg_195:
v_smfmac_f32_16x16x64_bf16 v[80:83],v[44:47],v[160:167],v2
buffer_load_dwordx4 v[64:67],v1,s[8:11],s70 offen offset:2048 sc1
v_smfmac_f32_16x16x64_bf16 v[84:87],v[44:47],v[168:175],v2
ds_read_b128 v[108:111],v4 offset:2048
v_smfmac_f32_16x16x64_bf16 v[88:91],v[44:47],v[176:183],v2
ds_read_b128 v[112:115],v4 offset:3072
v_smfmac_f32_16x16x64_bf16 v[92:95],v[44:47],v[184:191],v2
s_waitcnt lgkmcnt(2)
v_smfmac_f32_16x16x64_bf16 v[96:99],v[44:47],v[100:107],v2
buffer_load_dwordx4 v[68:71],v1,s[8:11],s71 offen offset:1024 sc1
s_waitcnt vmcnt(5)
v_smfmac_f32_16x16x64_bf16 v[80:83],v[48:51],a[32:39],v2
ds_read_b128 v[100:103],v4 offset:8192
v_smfmac_f32_16x16x64_bf16 v[84:87],v[48:51],a[40:47],v2
ds_read_b128 v[104:107],v4 offset:9216
v_smfmac_f32_16x16x64_bf16 v[88:91],v[48:51],a[48:55],v2
v_smfmac_f32_16x16x64_bf16 v[92:95],v[48:51],a[56:63],v2
buffer_load_dwordx4 v[72:75],v1,s[8:11],s80 offen sc1
s_waitcnt lgkmcnt(2)
v_smfmac_f32_16x16x64_bf16 v[96:99],v[48:51],v[108:115],v2
s_waitcnt vmcnt(5)
v_smfmac_f32_16x16x64_bf16 v[80:83],v[52:55],a[128:135],v2
ds_read_b128 v[108:111],v4 offset:14336
v_bitop3_b32 v13,v48,v52,s57 bitop3:0x7e
v_smfmac_f32_16x16x64_bf16 v[84:87],v[52:55],a[136:143],v2
ds_read_b128 v[112:115],v4 offset:15360
v_smfmac_f32_16x16x64_bf16 v[88:91],v[52:55],a[144:151],v2
buffer_load_dwordx4 v[76:79],v1,s[8:11],s80 offen offset:3072 sc1
v_smfmac_f32_16x16x64_bf16 v[92:95],v[52:55],a[152:159],v2
s_waitcnt lgkmcnt(2)
v_smfmac_f32_16x16x64_bf16 v[96:99],v[52:55],v[100:107],v2
s_waitcnt vmcnt(5)
v_smfmac_f32_16x16x64_bf16 v[80:83],v[56:59],a[224:231],v2
ds_read_b128 v[100:103],v4 offset:20480
v_smfmac_f32_16x16x64_bf16 v[84:87],v[56:59],a[232:239],v2
ds_read_b128 v[104:107],v4 offset:21504
v_smfmac_f32_16x16x64_bf16 v[88:91],v[56:59],a[240:247],v2
v_smfmac_f32_16x16x64_bf16 v[92:95],v[56:59],a[248:255],v2
s_waitcnt lgkmcnt(2)
v_smfmac_f32_16x16x64_bf16 v[96:99],v[56:59],v[108:115],v2
s_waitcnt vmcnt(4)
v_smfmac_f32_16x16x64_bf16 v[80:83],v[60:63],v[192:199],v2
ds_read_b128 v[108:111],v4 offset:4096
v_bitop3_b32 v14,v56,v60,s57 bitop3:0x7e
v_smfmac_f32_16x16x64_bf16 v[84:87],v[60:63],v[200:207],v2
ds_read_b128 v[112:115],v4 offset:5120
v_or_b32 v13,v13,v14
v_smfmac_f32_16x16x64_bf16 v[88:91],v[60:63],v[208:215],v2
v_smfmac_f32_16x16x64_bf16 v[92:95],v[60:63],v[216:223],v2
s_waitcnt lgkmcnt(2)
v_smfmac_f32_16x16x64_bf16 v[96:99],v[60:63],v[100:107],v2
s_waitcnt vmcnt(3)
v_smfmac_f32_16x16x64_bf16 v[80:83],v[64:67],a[64:71],v2
ds_read_b128 v[100:103],v4 offset:10240
v_smfmac_f32_16x16x64_bf16 v[84:87],v[64:67],a[72:79],v2
ds_read_b128 v[104:107],v4 offset:11264
v_smfmac_f32_16x16x64_bf16 v[88:91],v[64:67],a[80:87],v2
v_smfmac_f32_16x16x64_bf16 v[92:95],v[64:67],a[88:95],v2
s_waitcnt lgkmcnt(2)
v_smfmac_f32_16x16x64_bf16 v[96:99],v[64:67],v[108:115],v2
s_waitcnt vmcnt(0)
v_smfmac_f32_16x16x64_bf16 v[80:83],v[68:71],a[160:167],v2
ds_read_b128 v[108:111],v4 offset:16384
v_bitop3_b32 v14,v64,v68,s57 bitop3:0x7e
v_smfmac_f32_16x16x64_bf16 v[80:83],v[72:75],v[128:135],v2
ds_read_b128 v[112:115],v4 offset:17408
v_or_b32 v13,v13,v14
v_smfmac_f32_16x16x64_bf16 v[80:83],v[76:79],v[224:231],v2
v_bitop3_b32 v14,v72,v76,s57 bitop3:0x7e
v_smfmac_f32_16x16x64_bf16 v[84:87],v[68:71],a[168:175],v2
v_or_b32 v13,v13,v14
v_smfmac_f32_16x16x64_bf16 v[84:87],v[72:75],v[136:143],v2
v_and_b32 v13,1,v13
v_smfmac_f32_16x16x64_bf16 v[84:87],v[76:79],v[232:239],v2
v_cmp_ne_u32 vcc,0,v13
v_smfmac_f32_16x16x64_bf16 v[88:91],v[68:71],a[176:183],v2
s_cbranch_vccnz rd_185x
v_smfmac_f32_16x16x64_bf16 v[88:91],v[72:75],v[144:151],v2
v_add_f32 v80,v80,v81
v_smfmac_f32_16x16x64_bf16 v[88:91],v[76:79],v[240:247],v2
v_add_f32 v82,v82,v83
ds_write2_b32 v7,v80,v82 offset0:0 offset1:88
v_smfmac_f32_16x16x64_bf16 v[92:95],v[68:71],a[184:191],v2
v_add_f32 v84,v84,v85
v_smfmac_f32_16x16x64_bf16 v[92:95],v[72:75],v[152:159],v2
v_add_f32 v86,v86,v87
ds_write2_b32 v7,v84,v86 offset0:16 offset1:104
v_smfmac_f32_16x16x64_bf16 v[92:95],v[76:79],v[248:255],v2
v_add_f32 v88,v88,v89
s_waitcnt lgkmcnt(4)
v_smfmac_f32_16x16x64_bf16 v[96:99],v[68:71],v[100:107],v2
v_add_f32 v90,v90,v91
s_waitcnt lgkmcnt(2)
v_smfmac_f32_16x16x64_bf16 v[96:99],v[72:75],v[108:115],v2
ds_write2_b32 v7,v88,v90 offset0:32 offset1:120
v_smfmac_f32_16x16x64_bf16 v[96:99],v[76:79],v[116:123],v2
v_add_f32 v92,v92,v93
v_add_f32 v94,v94,v95
ds_write2_b32 v7,v92,v94 offset0:48 offset1:136
s_nop 4
v_add_f32 v96,v96,v97
v_add_f32 v98,v98,v99
ds_write2_b32 v7,v96,v98 offset0:64 offset1:152
s_waitcnt lgkmcnt(0)
s_barrier
ds_read_b128 v[32:35],v8 offset:0
ds_read_b128 v[36:39],v8 offset:2816
ds_read_b128 v[40:43],v8 offset:5632
ds_read_b128 v[44:47],v8 offset:8448
s_mov_b64 exec,1
buffer_store_dword v16,v1,s[8:11],s69 offen
s_mov_b64 exec,-1
s_waitcnt lgkmcnt(2)
v_pk_add_f32 v[32:33],v[32:33],v[36:37]
v_pk_add_f32 v[34:35],v[34:35],v[38:39]
s_waitcnt lgkmcnt(0)
v_pk_add_f32 v[40:41],v[40:41],v[44:45]
v_pk_add_f32 v[42:43],v[42:43],v[46:47]
v_pk_add_f32 v[32:33],v[32:33],v[40:41]
v_pk_add_f32 v[34:35],v[34:35],v[42:43]
v_cvt_pk_bf16_f32 v32,v32,v33
v_cvt_pk_bf16_f32 v33,v34,v35
v_bfi_b32 v32,v10,s31,v32
s_nop 0
v_permlane32_swap_b32 v33,v35
v_permlane32_swap_b32 v32,v34
s_mov_b64 exec,s[88:89]
buffer_store_dwordx4 v[32:35],v9,s[8:11],s59 offen
s_barrier
buffer_store_dwordx4 v[32:35],v9,s[8:11],s68 offen sc1
s_mov_b64 exec,-1
s_nop 0
CW_NEXT_F:
s_add_u32 s50,s50,1
s_cmp_lt_u32 s50,128
s_cbranch_scc1 CW_LOOP_F
s_branch CW_DONE
ws_188:
buffer_load_dwordx4 v[32:35],v1,s[8:11],s70 offen sc1
buffer_load_dwordx4 v[36:39],v1,s[8:11],s70 offen offset:3072 sc1
buffer_load_dwordx4 v[40:43],v1,s[8:11],s71 offen offset:2048 sc1
buffer_load_dwordx4 v[44:47],v1,s[8:11],s80 offen offset:1024 sc1
buffer_load_dwordx4 v[48:51],v1,s[8:11],s70 offen offset:1024 sc1
s_sub_u32 s47,s47,1
s_cbranch_scc1 ABORT
s_waitcnt vmcnt(4)
v_and_b32 v12,1,v32
v_cmp_ne_u32 vcc,s57,v12
s_nop 0
s_cbranch_vccnz ws_188
s_branch wg_192
ws_189:
buffer_load_dwordx4 v[36:39],v1,s[8:11],s70 offen offset:3072 sc1
buffer_load_dwordx4 v[40:43],v1,s[8:11],s71 offen offset:2048 sc1
buffer_load_dwordx4 v[44:47],v1,s[8:11],s80 offen offset:1024 sc1
buffer_load_dwordx4 v[48:51],v1,s[8:11],s70 offen offset:1024 sc1
buffer_load_dwordx4 v[52:55],v1,s[8:11],s71 offen sc1
s_sub_u32 s47,s47,1
s_cbranch_scc1 ABORT
s_waitcnt vmcnt(4)
v_and_b32 v12,1,v36
v_cmp_ne_u32 vcc,s57,v12
s_nop 0
s_cbranch_vccnz ws_189
s_branch wg_193
ws_190:
buffer_load_dwordx4 v[40:43],v1,s[8:11],s71 offen offset:2048 sc1
buffer_load_dwordx4 v[44:47],v1,s[8:11],s80 offen offset:1024 sc1
buffer_load_dwordx4 v[48:51],v1,s[8:11],s70 offen offset:1024 sc1
buffer_load_dwordx4 v[52:55],v1,s[8:11],s71 offen sc1
buffer_load_dwordx4 v[56:59],v1,s[8:11],s71 offen offset:3072 sc1
s_sub_u32 s47,s47,1
s_cbranch_scc1 ABORT
s_waitcnt vmcnt(4)
v_and_b32 v12,1,v40
v_cmp_ne_u32 vcc,s57,v12
s_nop 0
s_cbranch_vccnz ws_190
s_branch wg_194
ws_191:
buffer_load_dwordx4 v[44:47],v1,s[8:11],s80 offen offset:1024 sc1
buffer_load_dwordx4 v[48:51],v1,s[8:11],s70 offen offset:1024 sc1
buffer_load_dwordx4 v[52:55],v1,s[8:11],s71 offen sc1
buffer_load_dwordx4 v[56:59],v1,s[8:11],s71 offen offset:3072 sc1
buffer_load_dwordx4 v[60:63],v1,s[8:11],s80 offen offset:2048 sc1
s_sub_u32 s47,s47,1
s_cbranch_scc1 ABORT
s_waitcnt vmcnt(4)
v_and_b32 v12,1,v44
v_cmp_ne_u32 vcc,s57,v12
s_nop 0
s_cbranch_vccnz ws_191
s_branch wg_195
rd_185x:
s_sub_u32 s47,s47,1
s_cbranch_scc1 ABORT
s_waitcnt lgkmcnt(0)
s_nop 7
ds_read_b128 v[100:103],v4 offset:0
ds_read_b128 v[104:107],v4 offset:1024
ds_read_b128 v[108:111],v4 offset:6144
ds_read_b128 v[112:115],v4 offset:7168
s_branch rd_185
CW_LOOP_S:
s_sub_u32 s60,s50,13
s_lshr_b32 s52,s60,1
s_and_b32 s51,s60,1
s_cmp_eq_u32 s51,0
s_cselect_b32 s61,13,0
s_add_u32 s52,s52,s61
s_sub_u32 s61,s60,51
s_cmp_ge_u32 s60,102
s_cselect_b32 s52,s61,s52
s_cselect_b32 s51,1,s51
s_cmp_lt_u32 s50,13
s_cselect_b32 s52,s50,s52
s_cselect_b32 s51,0,s51
s_cmp_eq_u32 s52,63
s_cbranch_scc1 CW_NEXT_S
s_add_u32 s58,s52,1
s_lshl_b32 s61,s51,9
s_add_u32 s72,s61,s35
s_add_u32 s69,s61,s85
s_lshl_b32 s61,s51,2
s_and_b32 s60,s52,1
s_add_u32 s60,s60,s61
s_mul_i32 s70,s60,49152
s_add_u32 s70,s70,s33
s_add_u32 s71,s70,4096
s_add_u32 s80,s70,8192
s_bfe_u32 s57,s52,65537
s_bfe_u32 s31,s58,65537
s_and_b32 s60,s58,1
s_add_u32 s60,s60,s61
s_mul_i32 s59,s60,20480
s_add_u32 s59,s59,s84
s_lshl_b32 s68,s60,16
s_add_u32 s68,s68,s83
s_xor_b32 s77,s77,11264
v_add_u32 v7,s77,v5
v_add_u32 v8,s77,v6
s_add_u32 s60,s52,2
v_mov_b32 v16,s60
ds_read_b128 v[100:103],v4 offset:0
ds_read_b128 v[104:107],v4 offset:1024
ds_read_b128 v[108:111],v4 offset:6144
ds_read_b128 v[112:115],v4 offset:7168
s_cmp_lg_u32 s46,0
s_cbranch_scc1 np_196
db_198:
buffer_load_dword v12,v3,s[8:11],s72 offen sc1
s_waitcnt vmcnt(0)
v_cmp_gt_u32 vcc,s58,v12
s_cbranch_vccz dbok_199
s_sub_u32 s47,s47,1
s_cbranch_scc1 ABORT
s_branch db_198
dbok_199:
np_196:
s_barrier
rd_197:
buffer_load_dwordx4 v[32:35],v1,s[8:11],s70 offen sc1
v_mov_b32 v80,0
v_mov_b32 v81,0
v_mov_b32 v82,0
v_mov_b32 v83,0
v_mov_b32 v84,0
buffer_load_dwordx4 v[36:39],v1,s[8:11],s70 offen offset:3072 sc1
v_mov_b32 v85,0
v_mov_b32 v86,0
v_mov_b32 v87,0
v_mov_b32 v88,0
v_mov_b32 v89,0
buffer_load_dwordx4 v[40:43],v1,s[8:11],s71 offen offset:2048 sc1
v_mov_b32 v90,0
v_mov_b32 v91,0
v_mov_b32 v92,0
v_mov_b32 v93,0
v_mov_b32 v94,0
buffer_load_dwordx4 v[44:47],v1,s[8:11],s80 offen offset:1024 sc1
v_mov_b32 v95,0
v_mov_b32 v96,0
v_mov_b32 v97,0
v_mov_b32 v98,0
v_mov_b32 v99,0
buffer_load_dwordx4 v[48:51],v1,s[8:11],s70 offen offset:1024 sc1
s_waitcnt vmcnt(4)
v_and_b32 v12,1,v32
v_cmp_ne_u32 vcc,s57,v12
s_cbranch_vccnz ws_200
wg_204:
v_smfmac_f32_16x16x64_bf16 v[80:83],v[32:35],a[0:7],v2
buffer_load_dwordx4 v[52:55],v1,s[8:11],s71 offen sc1
v_smfmac_f32_16x16x64_bf16 v[84:87],v[32:35],a[8:15],v2
s_waitcnt vmcnt(4)
v_and_b32 v12,1,v36
v_smfmac_f32_16x16x64_bf16 v[88:91],v[32:35],a[16:23],v2
v_cmp_ne_u32 vcc,s57,v12
v_smfmac_f32_16x16x64_bf16 v[92:95],v[32:35],a[24:31],v2
s_waitcnt lgkmcnt(2)
v_smfmac_f32_16x16x64_bf16 v[96:99],v[32:35],v[100:107],v2
s_cbranch_vccnz ws_201
wg_205:
v_smfmac_f32_16x16x64_bf16 v[80:83],v[36:39],a[96:103],v2
buffer_load_dwordx4 v[56:59],v1,s[8:11],s71 offen offset:3072 sc1
v_smfmac_f32_16x16x64_bf16 v[84:87],v[36:39],a[104:111],v2
s_waitcnt vmcnt(4)
v_and_b32 v12,1,v40
v_smfmac_f32_16x16x64_bf16 v[88:91],v[36:39],a[112:119],v2
v_cmp_ne_u32 vcc,s57,v12
v_smfmac_f32_16x16x64_bf16 v[92:95],v[36:39],a[120:127],v2
s_waitcnt lgkmcnt(0)
v_smfmac_f32_16x16x64_bf16 v[96:99],v[36:39],v[108:115],v2
s_cbranch_vccnz ws_202
wg_206:
v_smfmac_f32_16x16x64_bf16 v[80:83],v[40:43],a[192:199],v2
buffer_load_dwordx4 v[60:63],v1,s[8:11],s80 offen offset:2048 sc1
v_smfmac_f32_16x16x64_bf16 v[84:87],v[40:43],a[200:207],v2
s_waitcnt vmcnt(4)
v_and_b32 v12,1,v44
v_smfmac_f32_16x16x64_bf16 v[88:91],v[40:43],a[208:215],v2
v_cmp_ne_u32 vcc,s57,v12
ds_read_b128 v[100:103],v4 offset:18432
v_smfmac_f32_16x16x64_bf16 v[92:95],v[40:43],a[216:223],v2
ds_read_b128 v[104:107],v4 offset:19456
v_smfmac_f32_16x16x64_bf16 v[96:99],v[40:43],v[20:27],v2
s_cbranch_vccnz ws_203
wg_207:
v_smfmac_f32_16x16x64_bf16 v[80:83],v[44:47],v[160:167],v2
buffer_load_dwordx4 v[64:67],v1,s[8:11],s70 offen offset:2048 sc1
v_smfmac_f32_16x16x64_bf16 v[84:87],v[44:47],v[168:175],v2
ds_read_b128 v[108:111],v4 offset:2048
v_smfmac_f32_16x16x64_bf16 v[88:91],v[44:47],v[176:183],v2
ds_read_b128 v[112:115],v4 offset:3072
v_smfmac_f32_16x16x64_bf16 v[92:95],v[44:47],v[184:191],v2
s_waitcnt lgkmcnt(2)
v_smfmac_f32_16x16x64_bf16 v[96:99],v[44:47],v[100:107],v2
buffer_load_dwordx4 v[68:71],v1,s[8:11],s71 offen offset:1024 sc1
s_waitcnt vmcnt(5)
v_smfmac_f32_16x16x64_bf16 v[80:83],v[48:51],a[32:39],v2
ds_read_b128 v[100:103],v4 offset:8192
v_smfmac_f32_16x16x64_bf16 v[84:87],v[48:51],a[40:47],v2
ds_read_b128 v[104:107],v4 offset:9216
v_smfmac_f32_16x16x64_bf16 v[88:91],v[48:51],a[48:55],v2
v_smfmac_f32_16x16x64_bf16 v[92:95],v[48:51],a[56:63],v2
buffer_load_dwordx4 v[72:75],v1,s[8:11],s80 offen sc1
s_waitcnt lgkmcnt(2)
v_smfmac_f32_16x16x64_bf16 v[96:99],v[48:51],v[108:115],v2
s_waitcnt vmcnt(5)
v_smfmac_f32_16x16x64_bf16 v[80:83],v[52:55],a[128:135],v2
ds_read_b128 v[108:111],v4 offset:14336
v_bitop3_b32 v13,v48,v52,s57 bitop3:0x7e
v_smfmac_f32_16x16x64_bf16 v[84:87],v[52:55],a[136:143],v2
ds_read_b128 v[112:115],v4 offset:15360
v_smfmac_f32_16x16x64_bf16 v[88:91],v[52:55],a[144:151],v2
buffer_load_dwordx4 v[76:79],v1,s[8:11],s80 offen offset:3072 sc1
v_smfmac_f32_16x16x64_bf16 v[92:95],v[52:55],a[152:159],v2
s_waitcnt lgkmcnt(2)
v_smfmac_f32_16x16x64_bf16 v[96:99],v[52:55],v[100:107],v2
s_waitcnt vmcnt(5)
v_smfmac_f32_16x16x64_bf16 v[80:83],v[56:59],a[224:231],v2
ds_read_b128 v[100:103],v4 offset:20480
v_smfmac_f32_16x16x64_bf16 v[84:87],v[56:59],a[232:239],v2
ds_read_b128 v[104:107],v4 offset:21504
v_smfmac_f32_16x16x64_bf16 v[88:91],v[56:59],a[240:247],v2
v_smfmac_f32_16x16x64_bf16 v[92:95],v[56:59],a[248:255],v2
s_waitcnt lgkmcnt(2)
v_smfmac_f32_16x16x64_bf16 v[96:99],v[56:59],v[108:115],v2
s_waitcnt vmcnt(4)
v_smfmac_f32_16x16x64_bf16 v[80:83],v[60:63],v[192:199],v2
ds_read_b128 v[108:111],v4 offset:4096
v_bitop3_b32 v14,v56,v60,s57 bitop3:0x7e
v_smfmac_f32_16x16x64_bf16 v[84:87],v[60:63],v[200:207],v2
ds_read_b128 v[112:115],v4 offset:5120
v_or_b32 v13,v13,v14
v_smfmac_f32_16x16x64_bf16 v[88:91],v[60:63],v[208:215],v2
v_smfmac_f32_16x16x64_bf16 v[92:95],v[60:63],v[216:223],v2
s_waitcnt lgkmcnt(2)
v_smfmac_f32_16x16x64_bf16 v[96:99],v[60:63],v[100:107],v2
s_waitcnt vmcnt(3)
v_smfmac_f32_16x16x64_bf16 v[80:83],v[64:67],a[64:71],v2
ds_read_b128 v[100:103],v4 offset:10240
v_smfmac_f32_16x16x64_bf16 v[84:87],v[64:67],a[72:79],v2
ds_read_b128 v[104:107],v4 offset:11264
v_smfmac_f32_16x16x64_bf16 v[88:91],v[64:67],a[80:87],v2
v_smfmac_f32_16x16x64_bf16 v[92:95],v[64:67],a[88:95],v2
s_waitcnt lgkmcnt(2)
v_smfmac_f32_16x16x64_bf16 v[96:99],v[64:67],v[108:115],v2
s_waitcnt vmcnt(0)
v_smfmac_f32_16x16x64_bf16 v[80:83],v[68:71],a[160:167],v2
ds_read_b128 v[108:111],v4 offset:16384
v_bitop3_b32 v14,v64,v68,s57 bitop3:0x7e
v_smfmac_f32_16x16x64_bf16 v[80:83],v[72:75],v[128:135],v2
ds_read_b128 v[112:115],v4 offset:17408
v_or_b32 v13,v13,v14
v_smfmac_f32_16x16x64_bf16 v[80:83],v[76:79],v[224:231],v2
v_bitop3_b32 v14,v72,v76,s57 bitop3:0x7e
v_smfmac_f32_16x16x64_bf16 v[84:87],v[68:71],a[168:175],v2
v_or_b32 v13,v13,v14
v_smfmac_f32_16x16x64_bf16 v[84:87],v[72:75],v[136:143],v2
v_and_b32 v13,1,v13
v_smfmac_f32_16x16x64_bf16 v[84:87],v[76:79],v[232:239],v2
v_cmp_ne_u32 vcc,0,v13
v_smfmac_f32_16x16x64_bf16 v[88:91],v[68:71],a[176:183],v2
s_cbranch_vccnz rd_197x
v_smfmac_f32_16x16x64_bf16 v[88:91],v[72:75],v[144:151],v2
v_add_f32 v80,v80,v81
v_smfmac_f32_16x16x64_bf16 v[88:91],v[76:79],v[240:247],v2
v_add_f32 v82,v82,v83
ds_write2_b32 v7,v80,v82 offset0:0 offset1:88
v_smfmac_f32_16x16x64_bf16 v[92:95],v[68:71],a[184:191],v2
v_add_f32 v84,v84,v85
v_smfmac_f32_16x16x64_bf16 v[92:95],v[72:75],v[152:159],v2
v_add_f32 v86,v86,v87
ds_write2_b32 v7,v84,v86 offset0:16 offset1:104
v_smfmac_f32_16x16x64_bf16 v[92:95],v[76:79],v[248:255],v2
v_add_f32 v88,v88,v89
s_waitcnt lgkmcnt(4)
v_smfmac_f32_16x16x64_bf16 v[96:99],v[68:71],v[100:107],v2
v_add_f32 v90,v90,v91
s_waitcnt lgkmcnt(2)
v_smfmac_f32_16x16x64_bf16 v[96:99],v[72:75],v[108:115],v2
ds_write2_b32 v7,v88,v90 offset0:32 offset1:120
v_smfmac_f32_16x16x64_bf16 v[96:99],v[76:79],v[116:123],v2
v_add_f32 v92,v92,v93
v_add_f32 v94,v94,v95
ds_write2_b32 v7,v92,v94 offset0:48 offset1:136
s_nop 4
v_add_f32 v96,v96,v97
v_add_f32 v98,v98,v99
ds_write2_b32 v7,v96,v98 offset0:64 offset1:152
s_waitcnt lgkmcnt(0)
s_barrier
ds_read_b128 v[32:35],v8 offset:0
ds_read_b128 v[36:39],v8 offset:2816
ds_read_b128 v[40:43],v8 offset:5632
ds_read_b128 v[44:47],v8 offset:8448
s_mov_b64 exec,1
buffer_store_dword v16,v1,s[8:11],s69 offen sc1
s_mov_b64 exec,-1
s_waitcnt lgkmcnt(2)
v_pk_add_f32 v[32:33],v[32:33],v[36:37]
v_pk_add_f32 v[34:35],v[34:35],v[38:39]
s_waitcnt lgkmcnt(0)
v_pk_add_f32 v[40:41],v[40:41],v[44:45]
v_pk_add_f32 v[42:43],v[42:43],v[46:47]
v_pk_add_f32 v[32:33],v[32:33],v[40:41]
v_pk_add_f32 v[34:35],v[34:35],v[42:43]
v_cvt_pk_bf16_f32 v32,v32,v33
v_cvt_pk_bf16_f32 v33,v34,v35
v_bfi_b32 v32,v10,s31,v32
s_nop 0
v_permlane32_swap_b32 v33,v35
v_permlane32_swap_b32 v32,v34
s_mov_b64 exec,s[88:89]
buffer_store_dwordx4 v[32:35],v9,s[8:11],s59 offen sc1
s_barrier
buffer_store_dwordx4 v[32:35],v9,s[8:11],s68 offen sc1
s_mov_b64 exec,-1
s_nop 0
CW_NEXT_S:
s_add_u32 s50,s50,1
s_cmp_lt_u32 s50,128
s_cbranch_scc1 CW_LOOP_S
s_branch CW_DONE
ws_200:
buffer_load_dwordx4 v[32:35],v1,s[8:11],s70 offen sc1
buffer_load_dwordx4 v[36:39],v1,s[8:11],s70 offen offset:3072 sc1
buffer_load_dwordx4 v[40:43],v1,s[8:11],s71 offen offset:2048 sc1
buffer_load_dwordx4 v[44:47],v1,s[8:11],s80 offen offset:1024 sc1
buffer_load_dwordx4 v[48:51],v1,s[8:11],s70 offen offset:1024 sc1
s_sub_u32 s47,s47,1
s_cbranch_scc1 ABORT
s_waitcnt vmcnt(4)
v_and_b32 v12,1,v32
v_cmp_ne_u32 vcc,s57,v12
s_nop 0
s_cbranch_vccnz ws_200
s_branch wg_204
ws_201:
buffer_load_dwordx4 v[36:39],v1,s[8:11],s70 offen offset:3072 sc1
buffer_load_dwordx4 v[40:43],v1,s[8:11],s71 offen offset:2048 sc1
buffer_load_dwordx4 v[44:47],v1,s[8:11],s80 offen offset:1024 sc1
buffer_load_dwordx4 v[48:51],v1,s[8:11],s70 offen offset:1024 sc1
buffer_load_dwordx4 v[52:55],v1,s[8:11],s71 offen sc1
s_sub_u32 s47,s47,1
s_cbranch_scc1 ABORT
s_waitcnt vmcnt(4)
v_and_b32 v12,1,v36
v_cmp_ne_u32 vcc,s57,v12
s_nop 0
s_cbranch_vccnz ws_201
s_branch wg_205
ws_202:
buffer_load_dwordx4 v[40:43],v1,s[8:11],s71 offen offset:2048 sc1
buffer_load_dwordx4 v[44:47],v1,s[8:11],s80 offen offset:1024 sc1
buffer_load_dwordx4 v[48:51],v1,s[8:11],s70 offen offset:1024 sc1
buffer_load_dwordx4 v[52:55],v1,s[8:11],s71 offen sc1
buffer_load_dwordx4 v[56:59],v1,s[8:11],s71 offen offset:3072 sc1
s_sub_u32 s47,s47,1
s_cbranch_scc1 ABORT
s_waitcnt vmcnt(4)
v_and_b32 v12,1,v40
v_cmp_ne_u32 vcc,s57,v12
s_nop 0
s_cbranch_vccnz ws_202
s_branch wg_206
ws_203:
buffer_load_dwordx4 v[44:47],v1,s[8:11],s80 offen offset:1024 sc1
buffer_load_dwordx4 v[48:51],v1,s[8:11],s70 offen offset:1024 sc1
buffer_load_dwordx4 v[52:55],v1,s[8:11],s71 offen sc1
buffer_load_dwordx4 v[56:59],v1,s[8:11],s71 offen offset:3072 sc1
buffer_load_dwordx4 v[60:63],v1,s[8:11],s80 offen offset:2048 sc1
s_sub_u32 s47,s47,1
s_cbranch_scc1 ABORT
s_waitcnt vmcnt(4)
v_and_b32 v12,1,v44
v_cmp_ne_u32 vcc,s57,v12
s_nop 0
s_cbranch_vccnz ws_203
s_branch wg_207
rd_197x:
s_sub_u32 s47,s47,1
s_cbranch_scc1 ABORT
s_waitcnt lgkmcnt(0)
s_nop 7
ds_read_b128 v[100:103],v4 offset:0
ds_read_b128 v[104:107],v4 offset:1024
ds_read_b128 v[108:111],v4 offset:6144
ds_read_b128 v[112:115],v4 offset:7168
s_branch rd_197
CW_DONE:
s_add_u32 s61,s48,48
s_endpgm
DISPATCH:
s_sub_u32 s48,s3,0
s_cmp_lt_u32 s3,8
s_cbranch_scc1 ROLE_CW
s_sub_u32 s48,s3,8
s_cmp_lt_u32 s3,16
s_cbranch_scc1 ROLE_CV
s_sub_u32 s48,s3,16
s_cmp_lt_u32 s3,32
s_cbranch_scc1 ROLE_CS
s_sub_u32 s48,s3,24
s_cmp_lt_u32 s3,40
s_cbranch_scc1 ROLE_CW
s_sub_u32 s48,s3,32
s_cmp_lt_u32 s3,48
s_cbranch_scc1 ROLE_CV
s_sub_u32 s48,s3,32
s_cmp_lt_u32 s3,64
s_cbranch_scc1 ROLE_CS
s_sub_u32 s48,s3,64
s_cmp_lt_u32 s3,69
s_cbranch_scc1 ROLE_W1
s_sub_u32 s48,s3,69
s_cmp_lt_u32 s3,74
s_cbranch_scc1 ROLE_W2
s_sub_u32 s48,s3,74
s_cmp_lt_u32 s3,86
s_cbranch_scc1 ROLE_W3
s_sub_u32 s48,s3,86
s_cmp_lt_u32 s3,96
s_cbranch_scc1 ROLE_W4
s_sub_u32 s48,s3,96
s_cmp_lt_u32 s3,108
s_cbranch_scc1 ROLE_QKVQ
s_sub_u32 s48,s3,108
s_cmp_lt_u32 s3,116
s_cbranch_scc1 ROLE_QKVV
s_sub_u32 s48,s3,116
s_cmp_lt_u32 s3,128
s_cbranch_scc1 ROLE_R1
s_sub_u32 s48,s3,120
s_cmp_lt_u32 s3,132
s_cbranch_scc1 ROLE_QKVV
s_sub_u32 s48,s3,120
s_cmp_lt_u32 s3,141
s_cbranch_scc1 ROLE_QKVQ
s_sub_u32 s48,s3,141
s_cmp_lt_u32 s3,149
s_cbranch_scc1 ROLE_ATT
s_sub_u32 s48,s3,149
s_cmp_lt_u32 s3,159
s_cbranch_scc1 ROLE_WO
s_sub_u32 s48,s3,147
s_cmp_lt_u32 s3,160
s_cbranch_scc1 ROLE_R1
s_sub_u32 s48,s3,148
s_cmp_lt_u32 s3,164
s_cbranch_scc1 ROLE_QKVV
s_sub_u32 s48,s3,143
s_cmp_lt_u32 s3,173
s_cbranch_scc1 ROLE_QKVQ
s_sub_u32 s48,s3,165
s_cmp_lt_u32 s3,181
s_cbranch_scc1 ROLE_ATT
s_sub_u32 s48,s3,171
s_cmp_lt_u32 s3,191
s_cbranch_scc1 ROLE_WO
s_sub_u32 s48,s3,178
s_cmp_lt_u32 s3,192
s_cbranch_scc1 ROLE_R1
s_sub_u32 s48,s3,176
s_cmp_lt_u32 s3,196
s_cbranch_scc1 ROLE_QKVV
s_sub_u32 s48,s3,166
s_cmp_lt_u32 s3,205
s_cbranch_scc1 ROLE_QKVQ
s_sub_u32 s48,s3,189
s_cmp_lt_u32 s3,213
s_cbranch_scc1 ROLE_ATT
s_sub_u32 s48,s3,193
s_cmp_lt_u32 s3,223
s_cbranch_scc1 ROLE_WO
s_sub_u32 s48,s3,209
s_cmp_lt_u32 s3,224
s_cbranch_scc1 ROLE_R1
s_sub_u32 s48,s3,204
s_cmp_lt_u32 s3,228
s_cbranch_scc1 ROLE_QKVV
s_sub_u32 s48,s3,189
s_cmp_lt_u32 s3,237
s_cbranch_scc1 ROLE_QKVQ
s_sub_u32 s48,s3,213
s_cmp_lt_u32 s3,245
s_cbranch_scc1 ROLE_ATT
s_sub_u32 s48,s3,215
s_cmp_lt_u32 s3,255
s_cbranch_scc1 ROLE_WO
s_sub_u32 s48,s3,240
s_cmp_lt_u32 s3,256
s_cbranch_scc1 ROLE_R1
s_branch ROLE_SPARE
EXIT:
s_endpgm
ABORT:
s_mov_b64 exec,1
v_mov_b32 v1,s2
v_add_u32 v1,0x10000,v1
v_mov_b32 v2,8
buffer_store_dword v1,v2,s[12:15],0 offen
s_endpgm
ROLE_SPARE:
s_waitcnt vmcnt(0)
s_barrier
s_cmp_lg_u32 s46,0
s_cbranch_scc1 arr_208
v_mov_b32 v12,1
s_lshl_b32 s3,s49,2
v_mov_b32 v13,s3
s_mov_b64 exec,1
buffer_atomic_add v12,v13,s[12:15],0 offen sc1
s_mov_b64 exec,-1
arr_208:
s_lshl_b32 s3,s49,2
v_mov_b32 v13,s3
s_nop 1
ibw_209:
buffer_load_dword v12,v13,s[12:15],0 offen sc1
s_waitcnt vmcnt(0)
v_cmp_ne_u32 vcc,256,v12
s_nop 0
s_cbranch_vccz ok_210
s_sleep 8
s_sub_u32 s47,s47,1
s_cbranch_scc1 ABORT
s_branch ibw_209
ok_210:
s_cmp_lg_u32 s49,0
s_cbranch_scc1 ibok_211
v_and_b32 v13,7,v0
v_lshlrev_b32 v13,2,v13
buffer_load_dword v12,v13,s[12:15],0 offen offset:32 sc1
s_waitcnt vmcnt(0)
v_cmp_ne_u32 vcc,32,v12
s_nop 0
s_cbranch_vccz ibok_211
s_barrier
s_mov_b32 s49,1
s_mov_b32 s3,s2
s_load_dwordx16 s[16:31],s[0:1],0
s_load_dwordx8 s[32:39],s[0:1],64
s_waitcnt lgkmcnt(0)
s_branch DISPATCH
ibok_211:
s_endpgm
ROLE_QKVQ:
v_lshlrev_b32 v1,4,v0
v_mov_b32 v5,1
s_lshl_b32 s56,s48,2
s_add_u32 s56,s56,s46
v_bfe_u32 v6,v0,2,2
v_lshrrev_b32 v7,4,v0
v_add_u32 v7,v6,v7
v_and_b32 v7,3,v7
v_and_b32 v15,3,v0
v_lshlrev_b32 v15,4,v15
v_lshl_add_u32 v15,v7,6,v15
v_lshl_add_u32 v15,v6,8,v15
v_lshrrev_b32 v6,5,v0
v_bfe_u32 v7,v0,4,1
v_lshlrev_b32 v16,10,v7
v_bfe_u32 v7,v0,2,2
v_lshl_add_u32 v16,v7,8,v16
v_add_u32 v6,v6,v7
v_and_b32 v6,3,v6
v_lshl_add_u32 v16,v6,6,v16
v_and_b32 v6,3,v0
v_lshl_add_u32 v16,v6,4,v16
v_add_u32 v18,46080,v16
v_lshrrev_b32 v6,5,v0
v_bfe_u32 v7,v0,4,1
v_lshlrev_b32 v20,10,v7
v_lshl_add_u32 v20,v6,8,v20
v_and_b32 v6,15,v0
v_lshl_add_u32 v20,v6,4,v20
v_lshrrev_b32 v6,5,v0
v_add_u32 v6,2,v6
v_bfe_u32 v7,v0,4,1
v_lshlrev_b32 v17,10,v7
v_bfe_u32 v7,v0,2,2
v_lshl_add_u32 v17,v7,8,v17
v_add_u32 v6,v6,v7
v_and_b32 v6,3,v6
v_lshl_add_u32 v17,v6,6,v17
v_and_b32 v6,3,v0
v_lshl_add_u32 v17,v6,4,v17
v_add_u32 v19,46080,v17
v_lshrrev_b32 v6,5,v0
v_add_u32 v6,2,v6
v_bfe_u32 v7,v0,4,1
v_lshlrev_b32 v21,10,v7
v_lshl_add_u32 v21,v6,8,v21
v_and_b32 v6,15,v0
v_lshl_add_u32 v21,v6,4,v21
s_cmp_ge_u32 s48,24
s_cselect_b32 s68,1,0
s_mul_i32 s60,s68,96
s_sub_u32 s69,s56,s60
s_mul_i32 s70,s68,50331648
s_add_u32 s70,s70,74448896
s_mul_i32 s60,s68,65536
s_sub_u32 s71,131072,s60
s_lshl_b32 s60,s69,12
s_add_u32 s70,s70,s60
v_lshrrev_b32 v6,5,v0
v_mul_u32_u24 v188,2560,v6
v_and_b32 v6,31,v0
v_lshl_add_u32 v188,v6,3,v188
v_add_u32 v188,0xa000,v188
v_min_u32 v4,7,v0
v_lshlrev_b32 v4,2,v4
v_min_u32 v2,39,v0
v_lshlrev_b32 v2,2,v2
v_mov_b32 v12,93184
s_waitcnt vmcnt(0)
s_barrier
s_cmp_lg_u32 s46,0
s_cbranch_scc1 arr_212
v_mov_b32 v6,1
s_lshl_b32 s3,s49,2
v_mov_b32 v7,s3
s_mov_b64 exec,1
buffer_atomic_add v6,v7,s[12:15],0 offen sc1
s_mov_b64 exec,-1
arr_212:
s_lshl_b32 s58,s69,7
v_mov_b32 v24,0x3f803f80
v_mov_b32 v25,0x3f803f80
v_mov_b32 v26,0x3f803f80
v_mov_b32 v27,0x3f803f80
s_mul_i32 s63,s46,40960
s_cmp_eq_u32 s68,0
s_cselect_b32 s4,s22,s20
s_cselect_b32 s5,s23,s21
s_mov_b32 s6,7864320
s_mov_b32 s7,0x20000
v_lshrrev_b32 v9,3,v0
s_mov_b32 s64,12288
v_mul_lo_u32 v9,v9,s64
v_and_b32 v10,7,v0
v_lshl_add_u32 v6,v10,4,v9
s_add_u32 m0,s63,0
s_add_u32 s65,s58,0
buffer_load_dwordx4 v6,s[4:7],s65 offen lds
s_add_u32 m0,s63,1024
s_add_u32 s65,s58,98304
buffer_load_dwordx4 v6,s[4:7],s65 offen lds
s_add_u32 m0,s63,2048
s_add_u32 s65,s58,196608
buffer_load_dwordx4 v6,s[4:7],s65 offen lds
s_add_u32 m0,s63,3072
s_add_u32 s65,s58,294912
buffer_load_dwordx4 v6,s[4:7],s65 offen lds
s_add_u32 m0,s63,4096
s_add_u32 s65,s58,393216
buffer_load_dwordx4 v6,s[4:7],s65 offen lds
s_add_u32 m0,s63,5120
s_add_u32 s65,s58,491520
buffer_load_dwordx4 v6,s[4:7],s65 offen lds
s_add_u32 m0,s63,6144
s_add_u32 s65,s58,589824
buffer_load_dwordx4 v6,s[4:7],s65 offen lds
s_add_u32 m0,s63,7168
s_add_u32 s65,s58,688128
buffer_load_dwordx4 v6,s[4:7],s65 offen lds
s_add_u32 m0,s63,8192
s_add_u32 s65,s58,786432
buffer_load_dwordx4 v6,s[4:7],s65 offen lds
s_add_u32 m0,s63,9216
s_add_u32 s65,s58,884736
buffer_load_dwordx4 v6,s[4:7],s65 offen lds
s_add_u32 m0,s63,10240
s_add_u32 s65,s58,983040
buffer_load_dwordx4 v6,s[4:7],s65 offen lds
s_add_u32 m0,s63,11264
s_add_u32 s65,s58,1081344
buffer_load_dwordx4 v6,s[4:7],s65 offen lds
s_add_u32 m0,s63,12288
s_add_u32 s65,s58,1179648
buffer_load_dwordx4 v6,s[4:7],s65 offen lds
s_add_u32 m0,s63,13312
s_add_u32 s65,s58,1277952
buffer_load_dwordx4 v6,s[4:7],s65 offen lds
s_add_u32 m0,s63,14336
s_add_u32 s65,s58,1376256
buffer_load_dwordx4 v6,s[4:7],s65 offen lds
s_add_u32 m0,s63,15360
s_add_u32 s65,s58,1474560
buffer_load_dwordx4 v6,s[4:7],s65 offen lds
s_add_u32 m0,s63,16384
s_add_u32 s65,s58,1572864
buffer_load_dwordx4 v6,s[4:7],s65 offen lds
s_add_u32 m0,s63,17408
s_add_u32 s65,s58,1671168
buffer_load_dwordx4 v6,s[4:7],s65 offen lds
s_add_u32 m0,s63,18432
s_add_u32 s65,s58,1769472
buffer_load_dwordx4 v6,s[4:7],s65 offen lds
s_add_u32 m0,s63,19456
s_add_u32 s65,s58,1867776
buffer_load_dwordx4 v6,s[4:7],s65 offen lds
s_add_u32 m0,s63,20480
s_add_u32 s65,s58,1966080
buffer_load_dwordx4 v6,s[4:7],s65 offen lds
s_add_u32 m0,s63,21504
s_add_u32 s65,s58,2064384
buffer_load_dwordx4 v6,s[4:7],s65 offen lds
s_add_u32 m0,s63,22528
s_add_u32 s65,s58,2162688
buffer_load_dwordx4 v6,s[4:7],s65 offen lds
s_add_u32 m0,s63,23552
s_add_u32 s65,s58,2260992
buffer_load_dwordx4 v6,s[4:7],s65 offen lds
s_add_u32 m0,s63,24576
s_add_u32 s65,s58,2359296
buffer_load_dwordx4 v6,s[4:7],s65 offen lds
s_add_u32 m0,s63,25600
s_add_u32 s65,s58,2457600
buffer_load_dwordx4 v6,s[4:7],s65 offen lds
s_add_u32 m0,s63,26624
s_add_u32 s65,s58,2555904
buffer_load_dwordx4 v6,s[4:7],s65 offen lds
s_add_u32 m0,s63,27648
s_add_u32 s65,s58,2654208
buffer_load_dwordx4 v6,s[4:7],s65 offen lds
s_add_u32 m0,s63,28672
s_add_u32 s65,s58,2752512
buffer_load_dwordx4 v6,s[4:7],s65 offen lds
s_add_u32 m0,s63,29696
s_add_u32 s65,s58,2850816
buffer_load_dwordx4 v6,s[4:7],s65 offen lds
s_add_u32 m0,s63,30720
s_add_u32 s65,s58,2949120
buffer_load_dwordx4 v6,s[4:7],s65 offen lds
s_add_u32 m0,s63,31744
s_add_u32 s65,s58,3047424
buffer_load_dwordx4 v6,s[4:7],s65 offen lds
s_add_u32 m0,s63,32768
s_add_u32 s65,s58,3145728
buffer_load_dwordx4 v6,s[4:7],s65 offen lds
s_add_u32 m0,s63,33792
s_add_u32 s65,s58,3244032
buffer_load_dwordx4 v6,s[4:7],s65 offen lds
s_add_u32 m0,s63,34816
s_add_u32 s65,s58,3342336
buffer_load_dwordx4 v6,s[4:7],s65 offen lds
s_add_u32 m0,s63,35840
s_add_u32 s65,s58,3440640
buffer_load_dwordx4 v6,s[4:7],s65 offen lds
s_add_u32 m0,s63,36864
s_add_u32 s65,s58,3538944
buffer_load_dwordx4 v6,s[4:7],s65 offen lds
s_add_u32 m0,s63,37888
s_add_u32 s65,s58,3637248
buffer_load_dwordx4 v6,s[4:7],s65 offen lds
s_add_u32 m0,s63,38912
s_add_u32 s65,s58,3735552
buffer_load_dwordx4 v6,s[4:7],s65 offen lds
s_add_u32 m0,s63,39936
s_add_u32 s65,s58,3833856
buffer_load_dwordx4 v6,s[4:7],s65 offen lds
s_waitcnt vmcnt(20)
v_bfe_u32 v9,v0,2,2
v_lshrrev_b32 v10,5,v0
v_lshl_add_u32 v9,v10,2,v9
v_mul_u32_u24 v9,128,v9
v_and_b32 v10,1,v0
v_lshl_add_u32 v9,v10,3,v9
v_bfe_u32 v10,v0,1,1
v_lshl_add_u32 v9,v10,5,v9
v_bfe_u32 v10,v0,4,1
v_lshl_add_u32 v9,v10,4,v9
v_add_u32 v7,s63,v9
ds_read_b64_tr_b16 a[0:1],v7 offset:0
ds_read_b64_tr_b16 a[2:3],v7 offset:2048
ds_read_b64_tr_b16 a[4:5],v7 offset:1024
ds_read_b64_tr_b16 a[6:7],v7 offset:3072
ds_read_b64_tr_b16 a[160:161],v7 offset:64
ds_read_b64_tr_b16 a[162:163],v7 offset:2112
ds_read_b64_tr_b16 a[164:165],v7 offset:1088
ds_read_b64_tr_b16 a[166:167],v7 offset:3136
ds_read_b64_tr_b16 a[8:9],v7 offset:4096
ds_read_b64_tr_b16 a[10:11],v7 offset:6144
ds_read_b64_tr_b16 a[12:13],v7 offset:5120
ds_read_b64_tr_b16 a[14:15],v7 offset:7168
s_waitcnt lgkmcnt(4)
ds_read_b64_tr_b16 a[168:169],v7 offset:4160
ds_read_b64_tr_b16 a[170:171],v7 offset:6208
ds_read_b64_tr_b16 a[172:173],v7 offset:5184
ds_read_b64_tr_b16 a[174:175],v7 offset:7232
ds_read_b64_tr_b16 a[16:17],v7 offset:8192
ds_read_b64_tr_b16 a[18:19],v7 offset:10240
ds_read_b64_tr_b16 a[20:21],v7 offset:9216
ds_read_b64_tr_b16 a[22:23],v7 offset:11264
ds_read_b64_tr_b16 a[176:177],v7 offset:8256
ds_read_b64_tr_b16 a[178:179],v7 offset:10304
ds_read_b64_tr_b16 a[180:181],v7 offset:9280
ds_read_b64_tr_b16 a[182:183],v7 offset:11328
s_waitcnt lgkmcnt(4)
ds_read_b64_tr_b16 a[24:25],v7 offset:12288
ds_read_b64_tr_b16 a[26:27],v7 offset:14336
ds_read_b64_tr_b16 a[28:29],v7 offset:13312
ds_read_b64_tr_b16 a[30:31],v7 offset:15360
ds_read_b64_tr_b16 a[184:185],v7 offset:12352
ds_read_b64_tr_b16 a[186:187],v7 offset:14400
ds_read_b64_tr_b16 a[188:189],v7 offset:13376
ds_read_b64_tr_b16 a[190:191],v7 offset:15424
ds_read_b64_tr_b16 a[32:33],v7 offset:16384
ds_read_b64_tr_b16 a[34:35],v7 offset:18432
ds_read_b64_tr_b16 a[36:37],v7 offset:17408
ds_read_b64_tr_b16 a[38:39],v7 offset:19456
s_waitcnt lgkmcnt(4)
ds_read_b64_tr_b16 a[192:193],v7 offset:16448
ds_read_b64_tr_b16 a[194:195],v7 offset:18496
ds_read_b64_tr_b16 a[196:197],v7 offset:17472
ds_read_b64_tr_b16 a[198:199],v7 offset:19520
s_waitcnt lgkmcnt(0)
s_add_u32 m0,s63,0
s_add_u32 s65,s58,3932160
buffer_load_dwordx4 v6,s[4:7],s65 offen lds
s_add_u32 m0,s63,1024
s_add_u32 s65,s58,4030464
buffer_load_dwordx4 v6,s[4:7],s65 offen lds
s_add_u32 m0,s63,2048
s_add_u32 s65,s58,4128768
buffer_load_dwordx4 v6,s[4:7],s65 offen lds
s_add_u32 m0,s63,3072
s_add_u32 s65,s58,4227072
buffer_load_dwordx4 v6,s[4:7],s65 offen lds
s_add_u32 m0,s63,4096
s_add_u32 s65,s58,4325376
buffer_load_dwordx4 v6,s[4:7],s65 offen lds
s_add_u32 m0,s63,5120
s_add_u32 s65,s58,4423680
buffer_load_dwordx4 v6,s[4:7],s65 offen lds
s_add_u32 m0,s63,6144
s_add_u32 s65,s58,4521984
buffer_load_dwordx4 v6,s[4:7],s65 offen lds
s_add_u32 m0,s63,7168
s_add_u32 s65,s58,4620288
buffer_load_dwordx4 v6,s[4:7],s65 offen lds
s_add_u32 m0,s63,8192
s_add_u32 s65,s58,4718592
buffer_load_dwordx4 v6,s[4:7],s65 offen lds
s_add_u32 m0,s63,9216
s_add_u32 s65,s58,4816896
buffer_load_dwordx4 v6,s[4:7],s65 offen lds
s_add_u32 m0,s63,10240
s_add_u32 s65,s58,4915200
buffer_load_dwordx4 v6,s[4:7],s65 offen lds
s_add_u32 m0,s63,11264
s_add_u32 s65,s58,5013504
buffer_load_dwordx4 v6,s[4:7],s65 offen lds
s_add_u32 m0,s63,12288
s_add_u32 s65,s58,5111808
buffer_load_dwordx4 v6,s[4:7],s65 offen lds
s_add_u32 m0,s63,13312
s_add_u32 s65,s58,5210112
buffer_load_dwordx4 v6,s[4:7],s65 offen lds
s_add_u32 m0,s63,14336
s_add_u32 s65,s58,5308416
buffer_load_dwordx4 v6,s[4:7],s65 offen lds
s_add_u32 m0,s63,15360
s_add_u32 s65,s58,5406720
buffer_load_dwordx4 v6,s[4:7],s65 offen lds
s_add_u32 m0,s63,16384
s_add_u32 s65,s58,5505024
buffer_load_dwordx4 v6,s[4:7],s65 offen lds
s_add_u32 m0,s63,17408
s_add_u32 s65,s58,5603328
buffer_load_dwordx4 v6,s[4:7],s65 offen lds
s_add_u32 m0,s63,18432
s_add_u32 s65,s58,5701632
buffer_load_dwordx4 v6,s[4:7],s65 offen lds
s_add_u32 m0,s63,19456
s_add_u32 s65,s58,5799936
buffer_load_dwordx4 v6,s[4:7],s65 offen lds
v_mfma_f32_32x32x16_bf16 v[120:135],a[0:3],v[24:27],0
v_mfma_f32_32x32x16_bf16 v[136:151],a[160:163],v[24:27],0
v_mfma_f32_32x32x16_bf16 v[120:135],a[4:7],v[24:27],v[120:135]
v_mfma_f32_32x32x16_bf16 v[136:151],a[164:167],v[24:27],v[136:151]
v_mfma_f32_32x32x16_bf16 v[120:135],a[8:11],v[24:27],v[120:135]
v_mfma_f32_32x32x16_bf16 v[136:151],a[168:171],v[24:27],v[136:151]
v_mfma_f32_32x32x16_bf16 v[120:135],a[12:15],v[24:27],v[120:135]
v_mfma_f32_32x32x16_bf16 v[136:151],a[172:175],v[24:27],v[136:151]
v_mfma_f32_32x32x16_bf16 v[120:135],a[16:19],v[24:27],v[120:135]
v_mfma_f32_32x32x16_bf16 v[136:151],a[176:179],v[24:27],v[136:151]
v_mfma_f32_32x32x16_bf16 v[120:135],a[20:23],v[24:27],v[120:135]
v_mfma_f32_32x32x16_bf16 v[136:151],a[180:183],v[24:27],v[136:151]
v_mfma_f32_32x32x16_bf16 v[120:135],a[24:27],v[24:27],v[120:135]
v_mfma_f32_32x32x16_bf16 v[136:151],a[184:187],v[24:27],v[136:151]
v_mfma_f32_32x32x16_bf16 v[120:135],a[28:31],v[24:27],v[120:135]
v_mfma_f32_32x32x16_bf16 v[136:151],a[188:191],v[24:27],v[136:151]
v_mfma_f32_32x32x16_bf16 v[120:135],a[32:35],v[24:27],v[120:135]
v_mfma_f32_32x32x16_bf16 v[136:151],a[192:195],v[24:27],v[136:151]
v_mfma_f32_32x32x16_bf16 v[120:135],a[36:39],v[24:27],v[120:135]
v_mfma_f32_32x32x16_bf16 v[136:151],a[196:199],v[24:27],v[136:151]
s_waitcnt vmcnt(20)
v_bfe_u32 v9,v0,2,2
v_lshrrev_b32 v10,5,v0
v_lshl_add_u32 v9,v10,2,v9
v_mul_u32_u24 v9,128,v9
v_and_b32 v10,1,v0
v_lshl_add_u32 v9,v10,3,v9
v_bfe_u32 v10,v0,1,1
v_lshl_add_u32 v9,v10,5,v9
v_bfe_u32 v10,v0,4,1
v_lshl_add_u32 v9,v10,4,v9
v_add_u32 v7,s63,v9
ds_read_b64_tr_b16 a[40:41],v7 offset:20480
ds_read_b64_tr_b16 a[42:43],v7 offset:22528
ds_read_b64_tr_b16 a[44:45],v7 offset:21504
ds_read_b64_tr_b16 a[46:47],v7 offset:23552
ds_read_b64_tr_b16 a[200:201],v7 offset:20544
ds_read_b64_tr_b16 a[202:203],v7 offset:22592
ds_read_b64_tr_b16 a[204:205],v7 offset:21568
ds_read_b64_tr_b16 a[206:207],v7 offset:23616
ds_read_b64_tr_b16 a[48:49],v7 offset:24576
ds_read_b64_tr_b16 a[50:51],v7 offset:26624
ds_read_b64_tr_b16 a[52:53],v7 offset:25600
ds_read_b64_tr_b16 a[54:55],v7 offset:27648
s_waitcnt lgkmcnt(4)
ds_read_b64_tr_b16 a[208:209],v7 offset:24640
ds_read_b64_tr_b16 a[210:211],v7 offset:26688
ds_read_b64_tr_b16 a[212:213],v7 offset:25664
ds_read_b64_tr_b16 a[214:215],v7 offset:27712
ds_read_b64_tr_b16 a[56:57],v7 offset:28672
ds_read_b64_tr_b16 a[58:59],v7 offset:30720
ds_read_b64_tr_b16 a[60:61],v7 offset:29696
ds_read_b64_tr_b16 a[62:63],v7 offset:31744
ds_read_b64_tr_b16 a[216:217],v7 offset:28736
ds_read_b64_tr_b16 a[218:219],v7 offset:30784
ds_read_b64_tr_b16 a[220:221],v7 offset:29760
ds_read_b64_tr_b16 a[222:223],v7 offset:31808
s_waitcnt lgkmcnt(4)
ds_read_b64_tr_b16 a[64:65],v7 offset:32768
ds_read_b64_tr_b16 a[66:67],v7 offset:34816
ds_read_b64_tr_b16 a[68:69],v7 offset:33792
ds_read_b64_tr_b16 a[70:71],v7 offset:35840
ds_read_b64_tr_b16 a[224:225],v7 offset:32832
ds_read_b64_tr_b16 a[226:227],v7 offset:34880
ds_read_b64_tr_b16 a[228:229],v7 offset:33856
ds_read_b64_tr_b16 a[230:231],v7 offset:35904
ds_read_b64_tr_b16 a[72:73],v7 offset:36864
ds_read_b64_tr_b16 a[74:75],v7 offset:38912
ds_read_b64_tr_b16 a[76:77],v7 offset:37888
ds_read_b64_tr_b16 a[78:79],v7 offset:39936
s_waitcnt lgkmcnt(4)
ds_read_b64_tr_b16 a[232:233],v7 offset:36928
ds_read_b64_tr_b16 a[234:235],v7 offset:38976
ds_read_b64_tr_b16 a[236:237],v7 offset:37952
ds_read_b64_tr_b16 a[238:239],v7 offset:40000
s_waitcnt lgkmcnt(0)
s_add_u32 m0,s63,20480
s_add_u32 s65,s58,5898240
buffer_load_dwordx4 v6,s[4:7],s65 offen lds
s_add_u32 m0,s63,21504
s_add_u32 s65,s58,5996544
buffer_load_dwordx4 v6,s[4:7],s65 offen lds
s_add_u32 m0,s63,22528
s_add_u32 s65,s58,6094848
buffer_load_dwordx4 v6,s[4:7],s65 offen lds
s_add_u32 m0,s63,23552
s_add_u32 s65,s58,6193152
buffer_load_dwordx4 v6,s[4:7],s65 offen lds
s_add_u32 m0,s63,24576
s_add_u32 s65,s58,6291456
buffer_load_dwordx4 v6,s[4:7],s65 offen lds
s_add_u32 m0,s63,25600
s_add_u32 s65,s58,6389760
buffer_load_dwordx4 v6,s[4:7],s65 offen lds
s_add_u32 m0,s63,26624
s_add_u32 s65,s58,6488064
buffer_load_dwordx4 v6,s[4:7],s65 offen lds
s_add_u32 m0,s63,27648
s_add_u32 s65,s58,6586368
buffer_load_dwordx4 v6,s[4:7],s65 offen lds
s_add_u32 m0,s63,28672
s_add_u32 s65,s58,6684672
buffer_load_dwordx4 v6,s[4:7],s65 offen lds
s_add_u32 m0,s63,29696
s_add_u32 s65,s58,6782976
buffer_load_dwordx4 v6,s[4:7],s65 offen lds
s_add_u32 m0,s63,30720
s_add_u32 s65,s58,6881280
buffer_load_dwordx4 v6,s[4:7],s65 offen lds
s_add_u32 m0,s63,31744
s_add_u32 s65,s58,6979584
buffer_load_dwordx4 v6,s[4:7],s65 offen lds
s_add_u32 m0,s63,32768
s_add_u32 s65,s58,7077888
buffer_load_dwordx4 v6,s[4:7],s65 offen lds
s_add_u32 m0,s63,33792
s_add_u32 s65,s58,7176192
buffer_load_dwordx4 v6,s[4:7],s65 offen lds
s_add_u32 m0,s63,34816
s_add_u32 s65,s58,7274496
buffer_load_dwordx4 v6,s[4:7],s65 offen lds
s_add_u32 m0,s63,35840
s_add_u32 s65,s58,7372800
buffer_load_dwordx4 v6,s[4:7],s65 offen lds
s_add_u32 m0,s63,36864
s_add_u32 s65,s58,7471104
buffer_load_dwordx4 v6,s[4:7],s65 offen lds
s_add_u32 m0,s63,37888
s_add_u32 s65,s58,7569408
buffer_load_dwordx4 v6,s[4:7],s65 offen lds
s_add_u32 m0,s63,38912
s_add_u32 s65,s58,7667712
buffer_load_dwordx4 v6,s[4:7],s65 offen lds
s_add_u32 m0,s63,39936
s_add_u32 s65,s58,7766016
buffer_load_dwordx4 v6,s[4:7],s65 offen lds
v_mfma_f32_32x32x16_bf16 v[120:135],a[40:43],v[24:27],v[120:135]
v_mfma_f32_32x32x16_bf16 v[136:151],a[200:203],v[24:27],v[136:151]
v_mfma_f32_32x32x16_bf16 v[120:135],a[44:47],v[24:27],v[120:135]
v_mfma_f32_32x32x16_bf16 v[136:151],a[204:207],v[24:27],v[136:151]
v_mfma_f32_32x32x16_bf16 v[120:135],a[48:51],v[24:27],v[120:135]
v_mfma_f32_32x32x16_bf16 v[136:151],a[208:211],v[24:27],v[136:151]
v_mfma_f32_32x32x16_bf16 v[120:135],a[52:55],v[24:27],v[120:135]
v_mfma_f32_32x32x16_bf16 v[136:151],a[212:215],v[24:27],v[136:151]
v_mfma_f32_32x32x16_bf16 v[120:135],a[56:59],v[24:27],v[120:135]
v_mfma_f32_32x32x16_bf16 v[136:151],a[216:219],v[24:27],v[136:151]
v_mfma_f32_32x32x16_bf16 v[120:135],a[60:63],v[24:27],v[120:135]
v_mfma_f32_32x32x16_bf16 v[136:151],a[220:223],v[24:27],v[136:151]
v_mfma_f32_32x32x16_bf16 v[120:135],a[64:67],v[24:27],v[120:135]
v_mfma_f32_32x32x16_bf16 v[136:151],a[224:227],v[24:27],v[136:151]
v_mfma_f32_32x32x16_bf16 v[120:135],a[68:71],v[24:27],v[120:135]
v_mfma_f32_32x32x16_bf16 v[136:151],a[228:231],v[24:27],v[136:151]
v_mfma_f32_32x32x16_bf16 v[120:135],a[72:75],v[24:27],v[120:135]
v_mfma_f32_32x32x16_bf16 v[136:151],a[232:235],v[24:27],v[136:151]
v_mfma_f32_32x32x16_bf16 v[120:135],a[76:79],v[24:27],v[120:135]
v_mfma_f32_32x32x16_bf16 v[136:151],a[236:239],v[24:27],v[136:151]
s_waitcnt vmcnt(20)
v_bfe_u32 v9,v0,2,2
v_lshrrev_b32 v10,5,v0
v_lshl_add_u32 v9,v10,2,v9
v_mul_u32_u24 v9,128,v9
v_and_b32 v10,1,v0
v_lshl_add_u32 v9,v10,3,v9
v_bfe_u32 v10,v0,1,1
v_lshl_add_u32 v9,v10,5,v9
v_bfe_u32 v10,v0,4,1
v_lshl_add_u32 v9,v10,4,v9
v_add_u32 v7,s63,v9
ds_read_b64_tr_b16 a[80:81],v7 offset:0
ds_read_b64_tr_b16 a[82:83],v7 offset:2048
ds_read_b64_tr_b16 a[84:85],v7 offset:1024
ds_read_b64_tr_b16 a[86:87],v7 offset:3072
ds_read_b64_tr_b16 a[240:241],v7 offset:64
ds_read_b64_tr_b16 a[242:243],v7 offset:2112
ds_read_b64_tr_b16 a[244:245],v7 offset:1088
ds_read_b64_tr_b16 a[246:247],v7 offset:3136
ds_read_b64_tr_b16 a[88:89],v7 offset:4096
ds_read_b64_tr_b16 a[90:91],v7 offset:6144
ds_read_b64_tr_b16 a[92:93],v7 offset:5120
ds_read_b64_tr_b16 a[94:95],v7 offset:7168
s_waitcnt lgkmcnt(4)
ds_read_b64_tr_b16 a[248:249],v7 offset:4160
ds_read_b64_tr_b16 a[250:251],v7 offset:6208
ds_read_b64_tr_b16 a[252:253],v7 offset:5184
ds_read_b64_tr_b16 a[254:255],v7 offset:7232
ds_read_b64_tr_b16 a[96:97],v7 offset:8192
ds_read_b64_tr_b16 a[98:99],v7 offset:10240
ds_read_b64_tr_b16 a[100:101],v7 offset:9216
ds_read_b64_tr_b16 a[102:103],v7 offset:11264
ds_read_b64_tr_b16 v[192:193],v7 offset:8256
ds_read_b64_tr_b16 v[194:195],v7 offset:10304
ds_read_b64_tr_b16 v[196:197],v7 offset:9280
ds_read_b64_tr_b16 v[198:199],v7 offset:11328
s_waitcnt lgkmcnt(4)
ds_read_b64_tr_b16 a[104:105],v7 offset:12288
ds_read_b64_tr_b16 a[106:107],v7 offset:14336
ds_read_b64_tr_b16 a[108:109],v7 offset:13312
ds_read_b64_tr_b16 a[110:111],v7 offset:15360
ds_read_b64_tr_b16 v[200:201],v7 offset:12352
ds_read_b64_tr_b16 v[202:203],v7 offset:14400
ds_read_b64_tr_b16 v[204:205],v7 offset:13376
ds_read_b64_tr_b16 v[206:207],v7 offset:15424
ds_read_b64_tr_b16 a[112:113],v7 offset:16384
ds_read_b64_tr_b16 a[114:115],v7 offset:18432
ds_read_b64_tr_b16 a[116:117],v7 offset:17408
ds_read_b64_tr_b16 a[118:119],v7 offset:19456
s_waitcnt lgkmcnt(4)
ds_read_b64_tr_b16 v[208:209],v7 offset:16448
ds_read_b64_tr_b16 v[210:211],v7 offset:18496
ds_read_b64_tr_b16 v[212:213],v7 offset:17472
ds_read_b64_tr_b16 v[214:215],v7 offset:19520
s_waitcnt lgkmcnt(0)
v_mfma_f32_32x32x16_bf16 v[120:135],a[80:83],v[24:27],v[120:135]
v_mfma_f32_32x32x16_bf16 v[136:151],a[240:243],v[24:27],v[136:151]
v_mfma_f32_32x32x16_bf16 v[120:135],a[84:87],v[24:27],v[120:135]
v_mfma_f32_32x32x16_bf16 v[136:151],a[244:247],v[24:27],v[136:151]
v_mfma_f32_32x32x16_bf16 v[120:135],a[88:91],v[24:27],v[120:135]
v_mfma_f32_32x32x16_bf16 v[136:151],a[248:251],v[24:27],v[136:151]
v_mfma_f32_32x32x16_bf16 v[120:135],a[92:95],v[24:27],v[120:135]
v_mfma_f32_32x32x16_bf16 v[136:151],a[252:255],v[24:27],v[136:151]
v_mfma_f32_32x32x16_bf16 v[120:135],a[96:99],v[24:27],v[120:135]
v_mfma_f32_32x32x16_bf16 v[136:151],v[192:195],v[24:27],v[136:151]
v_mfma_f32_32x32x16_bf16 v[120:135],a[100:103],v[24:27],v[120:135]
v_mfma_f32_32x32x16_bf16 v[136:151],v[196:199],v[24:27],v[136:151]
v_mfma_f32_32x32x16_bf16 v[120:135],a[104:107],v[24:27],v[120:135]
v_mfma_f32_32x32x16_bf16 v[136:151],v[200:203],v[24:27],v[136:151]
v_mfma_f32_32x32x16_bf16 v[120:135],a[108:111],v[24:27],v[120:135]
v_mfma_f32_32x32x16_bf16 v[136:151],v[204:207],v[24:27],v[136:151]
v_mfma_f32_32x32x16_bf16 v[120:135],a[112:115],v[24:27],v[120:135]
v_mfma_f32_32x32x16_bf16 v[136:151],v[208:211],v[24:27],v[136:151]
v_mfma_f32_32x32x16_bf16 v[120:135],a[116:119],v[24:27],v[120:135]
v_mfma_f32_32x32x16_bf16 v[136:151],v[212:215],v[24:27],v[136:151]
s_waitcnt vmcnt(0)
v_bfe_u32 v9,v0,2,2
v_lshrrev_b32 v10,5,v0
v_lshl_add_u32 v9,v10,2,v9
v_mul_u32_u24 v9,128,v9
v_and_b32 v10,1,v0
v_lshl_add_u32 v9,v10,3,v9
v_bfe_u32 v10,v0,1,1
v_lshl_add_u32 v9,v10,5,v9
v_bfe_u32 v10,v0,4,1
v_lshl_add_u32 v9,v10,4,v9
v_add_u32 v7,s63,v9
ds_read_b64_tr_b16 a[120:121],v7 offset:20480
ds_read_b64_tr_b16 a[122:123],v7 offset:22528
ds_read_b64_tr_b16 a[124:125],v7 offset:21504
ds_read_b64_tr_b16 a[126:127],v7 offset:23552
ds_read_b64_tr_b16 v[216:217],v7 offset:20544
ds_read_b64_tr_b16 v[218:219],v7 offset:22592
ds_read_b64_tr_b16 v[220:221],v7 offset:21568
ds_read_b64_tr_b16 v[222:223],v7 offset:23616
ds_read_b64_tr_b16 a[128:129],v7 offset:24576
ds_read_b64_tr_b16 a[130:131],v7 offset:26624
ds_read_b64_tr_b16 a[132:133],v7 offset:25600
ds_read_b64_tr_b16 a[134:135],v7 offset:27648
s_waitcnt lgkmcnt(4)
ds_read_b64_tr_b16 v[224:225],v7 offset:24640
ds_read_b64_tr_b16 v[226:227],v7 offset:26688
ds_read_b64_tr_b16 v[228:229],v7 offset:25664
ds_read_b64_tr_b16 v[230:231],v7 offset:27712
ds_read_b64_tr_b16 a[136:137],v7 offset:28672
ds_read_b64_tr_b16 a[138:139],v7 offset:30720
ds_read_b64_tr_b16 a[140:141],v7 offset:29696
ds_read_b64_tr_b16 a[142:143],v7 offset:31744
ds_read_b64_tr_b16 v[232:233],v7 offset:28736
ds_read_b64_tr_b16 v[234:235],v7 offset:30784
ds_read_b64_tr_b16 v[236:237],v7 offset:29760
ds_read_b64_tr_b16 v[238:239],v7 offset:31808
s_waitcnt lgkmcnt(4)
ds_read_b64_tr_b16 a[144:145],v7 offset:32768
ds_read_b64_tr_b16 a[146:147],v7 offset:34816
ds_read_b64_tr_b16 a[148:149],v7 offset:33792
ds_read_b64_tr_b16 a[150:151],v7 offset:35840
ds_read_b64_tr_b16 v[240:241],v7 offset:32832
ds_read_b64_tr_b16 v[242:243],v7 offset:34880
ds_read_b64_tr_b16 v[244:245],v7 offset:33856
ds_read_b64_tr_b16 v[246:247],v7 offset:35904
ds_read_b64_tr_b16 a[152:153],v7 offset:36864
ds_read_b64_tr_b16 a[154:155],v7 offset:38912
ds_read_b64_tr_b16 a[156:157],v7 offset:37888
ds_read_b64_tr_b16 a[158:159],v7 offset:39936
s_waitcnt lgkmcnt(4)
ds_read_b64_tr_b16 v[248:249],v7 offset:36928
ds_read_b64_tr_b16 v[250:251],v7 offset:38976
ds_read_b64_tr_b16 v[252:253],v7 offset:37952
ds_read_b64_tr_b16 v[254:255],v7 offset:40000
s_waitcnt lgkmcnt(0)
v_mfma_f32_32x32x16_bf16 v[120:135],a[120:123],v[24:27],v[120:135]
v_mfma_f32_32x32x16_bf16 v[136:151],v[216:219],v[24:27],v[136:151]
v_mfma_f32_32x32x16_bf16 v[120:135],a[124:127],v[24:27],v[120:135]
v_mfma_f32_32x32x16_bf16 v[136:151],v[220:223],v[24:27],v[136:151]
v_mfma_f32_32x32x16_bf16 v[120:135],a[128:131],v[24:27],v[120:135]
v_mfma_f32_32x32x16_bf16 v[136:151],v[224:227],v[24:27],v[136:151]
v_mfma_f32_32x32x16_bf16 v[120:135],a[132:135],v[24:27],v[120:135]
v_mfma_f32_32x32x16_bf16 v[136:151],v[228:231],v[24:27],v[136:151]
v_mfma_f32_32x32x16_bf16 v[120:135],a[136:139],v[24:27],v[120:135]
v_mfma_f32_32x32x16_bf16 v[136:151],v[232:235],v[24:27],v[136:151]
v_mfma_f32_32x32x16_bf16 v[120:135],a[140:143],v[24:27],v[120:135]
v_mfma_f32_32x32x16_bf16 v[136:151],v[236:239],v[24:27],v[136:151]
v_mfma_f32_32x32x16_bf16 v[120:135],a[144:147],v[24:27],v[120:135]
v_mfma_f32_32x32x16_bf16 v[136:151],v[240:243],v[24:27],v[136:151]
v_mfma_f32_32x32x16_bf16 v[120:135],a[148:151],v[24:27],v[120:135]
v_mfma_f32_32x32x16_bf16 v[136:151],v[244:247],v[24:27],v[136:151]
v_mfma_f32_32x32x16_bf16 v[120:135],a[152:155],v[24:27],v[120:135]
v_mfma_f32_32x32x16_bf16 v[136:151],v[248:251],v[24:27],v[136:151]
v_mfma_f32_32x32x16_bf16 v[120:135],a[156:159],v[24:27],v[120:135]
v_mfma_f32_32x32x16_bf16 v[136:151],v[252:255],v[24:27],v[136:151]
s_barrier
s_lshl_b32 s3,s49,2
v_mov_b32 v7,s3
s_nop 8
ibw_213:
buffer_load_dword v6,v7,s[12:15],0 offen sc1
s_waitcnt vmcnt(0)
v_cmp_ne_u32 vcc,256,v6
s_nop 0
s_cbranch_vccz ok_214
s_sleep 8
s_sub_u32 s47,s47,1
s_cbranch_scc1 ABORT
s_branch ibw_213
ok_214:
s_cmp_lg_u32 s49,0
s_cbranch_scc1 ibok_215
v_and_b32 v7,7,v0
v_lshlrev_b32 v7,2,v7
buffer_load_dword v6,v7,s[12:15],0 offen offset:32 sc1
s_waitcnt vmcnt(0)
v_cmp_ne_u32 vcc,32,v6
s_nop 0
s_cbranch_vccz ibok_215
s_barrier
s_mov_b32 s49,1
s_mov_b32 s3,s2
s_load_dwordx16 s[16:31],s[0:1],0
s_load_dwordx8 s[32:39],s[0:1],64
s_waitcnt lgkmcnt(0)
s_branch DISPATCH
ibok_215:
s_mov_b32 s50,0
s_mov_b32 s32,0
s_mov_b32 s57,0
s_mov_b32 s59,2147483648
s_mov_b32 s82,2147483648
s_mov_b32 s39,2147483648
v_mov_b32 v22,94208
s_mov_b32 s72,0
s_mov_b32 s73,0
s_mov_b32 s78,0
s_mov_b32 s79,0
s_cmp_eq_u32 s46,0
s_cselect_b32 s40,0,2147483648
s_lshl_b32 s60,s46,3
v_add_u32 v13,s60,v22
s_mov_b32 s83,s100
s_lshl_b32 s41,s78,9
s_add_u32 s41,s41,s40
s_lshl_b32 s35,s79,9
s_add_u32 s35,s35,s40
s_add_u32 s35,s35,32768
s_branch QKVQ_COLD0
QKVQ_B0:
s_waitcnt lgkmcnt(3)
v_mfma_f32_32x32x16_bf16 v[56:71],a[0:3],v[24:27],0
ds_read_b128 v[44:47],v17 offset:4096
v_add_u32 v189,s57,v188
v_mfma_f32_32x32x16_bf16 v[72:87],a[160:163],v[24:27],0
v_add_u32 v8,0x800,v189
s_sub_u32 s66,46080,s57
s_lshl_b32 s60,s33,6
s_add_u32 s60,s60,s34
s_mul_i32 s60,s60,46080
s_add_u32 s60,s60,s37
v_mfma_f32_32x32x16_bf16 v[56:71],a[4:7],v[28:31],v[56:71]
ds_read_b128 v[48:51],v16 offset:6144
ds_read2_b64 v[156:159],v189 offset0:0 offset1:32
s_add_u32 s60,s60,206569472
v_mfma_f32_32x32x16_bf16 v[72:87],a[164:167],v[28:31],v[72:87]
ds_read2_b64 v[160:163],v189 offset0:64 offset1:96
s_cmp_eq_u32 s33,0
s_cselect_b32 s67,2147483648,s60
s_mul_i32 s61,s46,10240
s_waitcnt lgkmcnt(5)
v_mfma_f32_32x32x16_bf16 v[56:71],a[8:11],v[32:35],v[56:71]
ds_read_b128 v[52:55],v17 offset:6144
ds_read2_b64 v[164:167],v189 offset0:128 offset1:160
s_add_u32 s60,s60,s61
s_add_u32 s61,s61,s66
v_mfma_f32_32x32x16_bf16 v[72:87],a[168:171],v[32:35],v[72:87]
ds_read2_b64 v[168:171],v189 offset0:192 offset1:224
s_add_u32 m0,s61,0
s_add_u32 s63,s60,0
buffer_load_dwordx4 v1,s[8:11],s63 offen sc1 lds
v_mfma_f32_32x32x16_bf16 v[56:71],a[12:15],v[36:39],v[56:71]
ds_read_b128 v[24:27],v16 offset:8192
ds_read2_b64 v[172:175],v8 offset0:0 offset1:32
s_mul_i32 s74,s73,393216
s_add_u32 s74,s74,s39
v_mfma_f32_32x32x16_bf16 v[72:87],a[172:175],v[36:39],v[72:87]
s_add_u32 s74,s74,s70
v_fma_f32 v88,-v176,v120,v88
v_fma_f32 v89,-v176,v121,v89
v_fma_f32 v90,-v176,v122,v90
v_fma_f32 v91,-v176,v123,v91
s_waitcnt lgkmcnt(8)
v_mfma_f32_32x32x16_bf16 v[56:71],a[16:19],v[40:43],v[56:71]
ds_read_b128 v[28:31],v17 offset:8192
buffer_load_dwordx4 v1,s[8:11],s63 offen offset:1024 sc1 lds
v_fma_f32 v92,-v176,v124,v92
v_fma_f32 v93,-v176,v125,v93
v_mfma_f32_32x32x16_bf16 v[72:87],a[176:179],v[40:43],v[72:87]
v_fma_f32 v94,-v176,v126,v94
v_fma_f32 v95,-v176,v127,v95
v_mul_f32 v88,v88,v177
v_mul_f32 v89,v89,v177
v_mul_f32 v90,v90,v177
v_mfma_f32_32x32x16_bf16 v[56:71],a[20:23],v[44:47],v[56:71]
ds_read_b128 v[32:35],v16 offset:10240
s_mov_b32 s53,s33
s_mov_b32 s54,s34
s_add_u32 s79,s79,s33
s_or_b32 s65,s37,s33
v_mfma_f32_32x32x16_bf16 v[72:87],a[180:183],v[44:47],v[72:87]
buffer_load_dwordx4 v1,s[8:11],s63 offen offset:2048 sc1 lds
s_cmp_eq_u32 s65,0
s_addc_u32 s78,s78,0
s_lshl_b32 s41,s78,9
s_waitcnt lgkmcnt(6)
v_mfma_f32_32x32x16_bf16 v[56:71],a[24:27],v[48:51],v[56:71]
ds_read_b128 v[36:39],v17 offset:10240
s_add_u32 s41,s41,s40
s_lshl_b32 s35,s79,9
s_add_u32 s35,s35,s40
s_add_u32 s35,s35,32768
v_mfma_f32_32x32x16_bf16 v[72:87],a[184:187],v[48:51],v[72:87]
v_mul_f32 v91,v91,v177
v_mul_f32 v92,v92,v177
v_mul_f32 v93,v93,v177
v_mul_f32 v94,v94,v177
v_mul_f32 v95,v95,v177
v_mfma_f32_32x32x16_bf16 v[56:71],a[28:31],v[52:55],v[56:71]
ds_read_b128 v[40:43],v16 offset:12288
buffer_load_dwordx4 v1,s[8:11],s63 offen offset:3072 sc1 lds
s_add_u32 m0,s61,4096
s_add_u32 s63,s60,4096
v_mfma_f32_32x32x16_bf16 v[72:87],a[188:191],v[52:55],v[72:87]
v_cvt_pk_bf16_f32 v88,v88,v89
v_cvt_pk_bf16_f32 v89,v90,v91
v_cvt_pk_bf16_f32 v90,v92,v93
v_cvt_pk_bf16_f32 v91,v94,v95
v_fma_f32 v96,-v176,v128,v96
s_waitcnt lgkmcnt(3)
v_mfma_f32_32x32x16_bf16 v[56:71],a[32:35],v[24:27],v[56:71]
ds_read_b128 v[44:47],v17 offset:12288
v_fma_f32 v97,-v176,v129,v97
v_fma_f32 v98,-v176,v130,v98
v_fma_f32 v99,-v176,v131,v99
v_fma_f32 v100,-v176,v132,v100
v_mfma_f32_32x32x16_bf16 v[72:87],a[192:195],v[24:27],v[72:87]
buffer_load_dwordx4 v1,s[8:11],s63 offen sc1 lds
v_fma_f32 v101,-v176,v133,v101
v_fma_f32 v102,-v176,v134,v102
v_fma_f32 v103,-v176,v135,v103
v_mul_f32 v96,v96,v177
v_mfma_f32_32x32x16_bf16 v[56:71],a[36:39],v[28:31],v[56:71]
ds_read_b128 v[48:51],v16 offset:14336
v_mul_f32 v97,v97,v177
v_mul_f32 v98,v98,v177
v_mul_f32 v99,v99,v177
v_mul_f32 v100,v100,v177
v_mfma_f32_32x32x16_bf16 v[72:87],a[196:199],v[28:31],v[72:87]
v_mul_f32 v101,v101,v177
v_mul_f32 v102,v102,v177
v_mul_f32 v103,v103,v177
v_cvt_pk_bf16_f32 v96,v96,v97
v_cvt_pk_bf16_f32 v97,v98,v99
s_waitcnt lgkmcnt(3)
v_mfma_f32_32x32x16_bf16 v[56:71],a[40:43],v[32:35],v[56:71]
ds_read_b128 v[52:55],v17 offset:14336
buffer_load_dwordx4 v1,s[8:11],s63 offen offset:1024 sc1 lds
v_cvt_pk_bf16_f32 v98,v100,v101
v_cvt_pk_bf16_f32 v99,v102,v103
v_mfma_f32_32x32x16_bf16 v[72:87],a[200:203],v[32:35],v[72:87]
v_fma_f32 v104,-v176,v136,v104
v_fma_f32 v105,-v176,v137,v105
v_fma_f32 v106,-v176,v138,v106
v_fma_f32 v107,-v176,v139,v107
v_fma_f32 v108,-v176,v140,v108
v_mfma_f32_32x32x16_bf16 v[56:71],a[44:47],v[36:39],v[56:71]
ds_read_b128 v[24:27],v16 offset:16384
v_fma_f32 v109,-v176,v141,v109
v_fma_f32 v110,-v176,v142,v110
v_fma_f32 v111,-v176,v143,v111
v_mul_f32 v104,v104,v177
v_mfma_f32_32x32x16_bf16 v[72:87],a[204:207],v[36:39],v[72:87]
buffer_load_dwordx4 v1,s[8:11],s63 offen offset:2048 sc1 lds
v_mul_f32 v105,v105,v177
v_mul_f32 v106,v106,v177
v_mul_f32 v107,v107,v177
s_waitcnt lgkmcnt(3)
v_mfma_f32_32x32x16_bf16 v[56:71],a[48:51],v[40:43],v[56:71]
ds_read_b128 v[28:31],v17 offset:16384
v_mul_f32 v108,v108,v177
v_mul_f32 v109,v109,v177
v_mul_f32 v110,v110,v177
v_mul_f32 v111,v111,v177
v_mfma_f32_32x32x16_bf16 v[72:87],a[208:211],v[40:43],v[72:87]
v_cvt_pk_bf16_f32 v104,v104,v105
v_cvt_pk_bf16_f32 v105,v106,v107
v_cvt_pk_bf16_f32 v106,v108,v109
v_cvt_pk_bf16_f32 v107,v110,v111
v_fma_f32 v112,-v176,v144,v112
v_mfma_f32_32x32x16_bf16 v[56:71],a[52:55],v[44:47],v[56:71]
ds_read_b128 v[32:35],v16 offset:18432
buffer_load_dwordx4 v1,s[8:11],s63 offen offset:3072 sc1 lds
s_add_u32 m0,s61,8192
s_add_u32 s63,s60,8192
v_mfma_f32_32x32x16_bf16 v[72:87],a[212:215],v[44:47],v[72:87]
v_fma_f32 v113,-v176,v145,v113
v_fma_f32 v114,-v176,v146,v114
v_fma_f32 v115,-v176,v147,v115
v_fma_f32 v116,-v176,v148,v116
v_fma_f32 v117,-v176,v149,v117
s_waitcnt lgkmcnt(3)
v_mfma_f32_32x32x16_bf16 v[56:71],a[56:59],v[48:51],v[56:71]
ds_read_b128 v[36:39],v17 offset:18432
v_fma_f32 v118,-v176,v150,v118
v_fma_f32 v119,-v176,v151,v119
v_mul_f32 v112,v112,v177
v_mul_f32 v113,v113,v177
v_mfma_f32_32x32x16_bf16 v[72:87],a[216:219],v[48:51],v[72:87]
buffer_load_dwordx4 v1,s[8:11],s63 offen sc1 lds
v_mul_f32 v114,v114,v177
v_mul_f32 v115,v115,v177
v_mul_f32 v116,v116,v177
v_mul_f32 v117,v117,v177
v_mfma_f32_32x32x16_bf16 v[56:71],a[60:63],v[52:55],v[56:71]
ds_read_b128 v[40:43],v16 offset:20480
s_waitcnt vmcnt(9)
s_mov_b64 exec,1
buffer_store_dword v5,v1,s[8:11],s59 offen sc1
s_mov_b64 exec,-1
s_mov_b32 s59,2147483648
v_mfma_f32_32x32x16_bf16 v[72:87],a[220:223],v[52:55],v[72:87]
v_mul_f32 v118,v118,v177
v_mul_f32 v119,v119,v177
v_cvt_pk_bf16_f32 v112,v112,v113
v_cvt_pk_bf16_f32 v113,v114,v115
v_cvt_pk_bf16_f32 v114,v116,v117
s_waitcnt lgkmcnt(3)
v_mfma_f32_32x32x16_bf16 v[56:71],a[64:67],v[24:27],v[56:71]
ds_read_b128 v[44:47],v17 offset:20480
buffer_load_dwordx4 v1,s[8:11],s63 offen offset:1024 sc1 lds
s_lshl_b32 s62,s46,10
s_add_u32 s62,s62,40960
v_mfma_f32_32x32x16_bf16 v[72:87],a[224:227],v[24:27],v[72:87]
s_add_u32 m0,s66,s62
s_add_u32 s63,s67,s62
v_cvt_pk_bf16_f32 v115,v118,v119
s_lshl_b32 s82,s72,6
s_add_u32 s82,s82,s73
s_lshl_b32 s82,s82,9
v_mfma_f32_32x32x16_bf16 v[56:71],a[68:71],v[28:31],v[56:71]
ds_read_b128 v[48:51],v16 offset:22528
s_add_u32 s82,s82,s71
s_lshl_b32 s75,s69,2
s_add_u32 s82,s82,s75
s_add_u32 s82,s82,s39
v_mfma_f32_32x32x16_bf16 v[72:87],a[228:231],v[28:31],v[72:87]
buffer_load_dwordx4 v1,s[8:11],s63 offen sc1 lds
s_add_u32 m0,s66,45056
s_add_u32 s63,s67,45056
s_waitcnt lgkmcnt(3)
v_mfma_f32_32x32x16_bf16 v[56:71],a[72:75],v[32:35],v[56:71]
ds_read_b128 v[52:55],v17 offset:22528
buffer_load_dword v3,v2,s[8:11],s35 offen sc1
buffer_load_dword v14,v4,s[8:11],s41 offen sc1
v_mfma_f32_32x32x16_bf16 v[72:87],a[232:235],v[32:35],v[72:87]
v_add_f32 v156,v156,v166
v_add_f32 v157,v157,v167
v_add_f32 v158,v158,v168
v_add_f32 v159,v159,v169
v_add_f32 v160,v160,v170
v_mfma_f32_32x32x16_bf16 v[56:71],a[76:79],v[36:39],v[56:71]
ds_read_b128 v[24:27],v16 offset:24576
buffer_load_dwordx4 v1,s[8:11],s63 offen sc1 lds
v_add_f32 v161,v161,v171
v_add_f32 v162,v162,v172
v_mfma_f32_32x32x16_bf16 v[72:87],a[236:239],v[36:39],v[72:87]
v_add_f32 v163,v163,v173
v_add_f32 v164,v164,v174
v_add_f32 v165,v165,v175
v_add_f32 v156,v156,v158
v_add_f32 v157,v157,v159
s_waitcnt lgkmcnt(3)
v_mfma_f32_32x32x16_bf16 v[56:71],a[80:83],v[40:43],v[56:71]
ds_read_b128 v[28:31],v17 offset:24576
buffer_store_dwordx4 v[88:91],v20,s[8:11],s74 offen sc1
v_add_f32 v160,v160,v162
v_add_f32 v161,v161,v163
v_mfma_f32_32x32x16_bf16 v[72:87],a[240:243],v[40:43],v[72:87]
v_add_f32 v156,v156,v160
v_add_f32 v157,v157,v161
v_add_f32 v156,v156,v164
v_add_f32 v157,v157,v165
v_mov_b32 v158,v156
v_mfma_f32_32x32x16_bf16 v[56:71],a[84:87],v[44:47],v[56:71]
ds_read_b128 v[32:35],v16 offset:26624
buffer_store_dwordx4 v[96:99],v21,s[8:11],s74 offen sc1
v_mov_b32 v159,v157
v_permlane32_swap_b32 v156,v158
v_mfma_f32_32x32x16_bf16 v[72:87],a[244:247],v[44:47],v[72:87]
v_permlane32_swap_b32 v157,v159
v_add_f32 v176,v156,v158
v_add_f32 v177,v157,v159
v_mul_f32 v176,0x3acccccd,v176
v_mul_f32 v177,0x3acccccd,v177
s_waitcnt lgkmcnt(3)
v_mfma_f32_32x32x16_bf16 v[56:71],a[88:91],v[48:51],v[56:71]
ds_read_b128 v[36:39],v17 offset:26624
buffer_store_dwordx4 v[104:107],v20,s[8:11],s74 offen offset:2048 sc1
v_fma_f32 v177,-v176,v176,v177
v_max_f32 v177,0,v177
v_mfma_f32_32x32x16_bf16 v[72:87],a[248:251],v[48:51],v[72:87]
v_cvt_pk_bf16_f32 v8,v176,v177
v_lshlrev_b32 v176,16,v8
v_and_b32 v177,0xffff0000,v8
v_add_f32 v177,0x3727c5ac,v177
v_cvt_pk_bf16_f32 v8,v177,v177
v_mfma_f32_32x32x16_bf16 v[56:71],a[92:95],v[52:55],v[56:71]
ds_read_b128 v[40:43],v16 offset:28672
buffer_store_dwordx4 v[112:115],v21,s[8:11],s74 offen offset:2048 sc1
v_lshlrev_b32 v177,16,v8
v_mfma_f32_32x32x16_bf16 v[72:87],a[252:255],v[52:55],v[72:87]
v_sqrt_f32 v177,v177
s_nop 0
v_cvt_pk_bf16_f32 v8,v177,v177
v_lshlrev_b32 v177,16,v8
s_waitcnt lgkmcnt(3)
v_mfma_f32_32x32x16_bf16 v[56:71],a[96:99],v[24:27],v[56:71]
ds_read_b128 v[44:47],v17 offset:28672
v_rcp_f32 v177,v177
s_cmp_eq_u32 s51,0
s_cselect_b64 s[76:77],-1,0
v_mfma_f32_32x32x16_bf16 v[72:87],v[192:195],v[24:27],v[72:87]
v_cndmask_b32 v176,v176,0,s[76:77]
v_cndmask_b32 v177,v177,1.0,s[76:77]
s_mov_b32 s72,s51
s_mov_b32 s73,s52
v_mfma_f32_32x32x16_bf16 v[56:71],a[100:103],v[28:31],v[56:71]
ds_read_b128 v[48:51],v16 offset:30720
v_mfma_f32_32x32x16_bf16 v[72:87],v[196:199],v[28:31],v[72:87]
s_waitcnt lgkmcnt(3)
v_mfma_f32_32x32x16_bf16 v[56:71],a[104:107],v[32:35],v[56:71]
ds_read_b128 v[52:55],v17 offset:30720
v_mfma_f32_32x32x16_bf16 v[72:87],v[200:203],v[32:35],v[72:87]
v_mfma_f32_32x32x16_bf16 v[56:71],a[108:111],v[36:39],v[56:71]
ds_read_b128 v[24:27],v16 offset:32768
v_mfma_f32_32x32x16_bf16 v[72:87],v[204:207],v[36:39],v[72:87]
s_waitcnt lgkmcnt(3)
v_mfma_f32_32x32x16_bf16 v[56:71],a[112:115],v[40:43],v[56:71]
ds_read_b128 v[28:31],v17 offset:32768
v_mfma_f32_32x32x16_bf16 v[72:87],v[208:211],v[40:43],v[72:87]
v_mfma_f32_32x32x16_bf16 v[56:71],a[116:119],v[44:47],v[56:71]
ds_read_b128 v[32:35],v16 offset:34816
v_mfma_f32_32x32x16_bf16 v[72:87],v[212:215],v[44:47],v[72:87]
s_waitcnt lgkmcnt(3)
v_mfma_f32_32x32x16_bf16 v[56:71],a[120:123],v[48:51],v[56:71]
ds_read_b128 v[36:39],v17 offset:34816
v_mfma_f32_32x32x16_bf16 v[72:87],v[216:219],v[48:51],v[72:87]
v_mfma_f32_32x32x16_bf16 v[56:71],a[124:127],v[52:55],v[56:71]
ds_read_b128 v[40:43],v16 offset:36864
v_mfma_f32_32x32x16_bf16 v[72:87],v[220:223],v[52:55],v[72:87]
s_waitcnt lgkmcnt(3)
v_mfma_f32_32x32x16_bf16 v[56:71],a[128:131],v[24:27],v[56:71]
ds_read_b128 v[44:47],v17 offset:36864
s_waitcnt vmcnt(4)
v_cmp_eq_u32 vcc,0,v14
s_cmp_eq_u64 vcc,0
s_cselect_b32 s36,0,2147483648
v_mfma_f32_32x32x16_bf16 v[72:87],v[224:227],v[24:27],v[72:87]
v_cmp_eq_u32 vcc,0,v3
s_cmp_lt_u32 s78,64
s_cselect_b32 s36,s36,2147483648
s_cmp_eq_u64 vcc,0
s_cselect_b32 s60,1,s36
v_mfma_f32_32x32x16_bf16 v[56:71],a[132:135],v[28:31],v[56:71]
ds_read_b128 v[48:51],v16 offset:38912
s_cmp_lt_u32 s79,64
s_cselect_b32 s60,s60,s36
s_sub_u32 s61,s78,s79
s_or_b32 s61,s61,s36
v_mfma_f32_32x32x16_bf16 v[72:87],v[228:231],v[28:31],v[72:87]
s_cmp_lt_u32 s61,16
s_cselect_b32 s36,0,s60
v_mov_b32 v23,s36
s_waitcnt lgkmcnt(3)
v_mfma_f32_32x32x16_bf16 v[56:71],a[136:139],v[32:35],v[56:71]
ds_read_b128 v[52:55],v17 offset:38912
ds_write_b32 v13,v23
v_mfma_f32_32x32x16_bf16 v[72:87],v[232:235],v[32:35],v[72:87]
s_waitcnt lgkmcnt(0)
s_barrier
ds_read_b32 v23,v22
v_mfma_f32_32x32x16_bf16 v[56:71],a[140:143],v[36:39],v[56:71]
ds_read_b128 v[24:27],v18 offset:0
s_cmp_lt_u32 s50,2
s_cselect_b32 s42,1,0
s_cmp_ge_u32 s78,64
s_cselect_b32 s42,1,s42
v_mfma_f32_32x32x16_bf16 v[72:87],v[236:239],v[36:39],v[72:87]
s_or_b32 s42,s42,s37
s_mov_b32 s39,0
s_add_u32 s50,s50,1
s_sub_u32 s57,46080,s57
s_mov_b32 s51,s53
s_mov_b32 s52,s54
v_mfma_f32_32x32x16_bf16 v[56:71],a[144:147],v[40:43],v[56:71]
ds_read_b128 v[28:31],v19 offset:0
v_mfma_f32_32x32x16_bf16 v[72:87],v[240:243],v[40:43],v[72:87]
v_mfma_f32_32x32x16_bf16 v[56:71],a[148:151],v[44:47],v[56:71]
ds_read_b128 v[32:35],v18 offset:2048
s_waitcnt vmcnt(0)
s_mov_b64 exec,1
buffer_store_dword v5,v1,s[8:11],s82 offen sc1
s_mov_b64 exec,-1
s_mov_b32 s82,2147483648
v_mfma_f32_32x32x16_bf16 v[72:87],v[244:247],v[44:47],v[72:87]
s_waitcnt lgkmcnt(3)
v_readfirstlane_b32 s38,v23
s_and_b32 s37,s38,2147483648
s_and_b32 s33,s38,1
s_cselect_b32 s34,s79,s78
s_cmp_lg_u32 s42,0
v_mfma_f32_32x32x16_bf16 v[56:71],a[152:155],v[48:51],v[56:71]
ds_read_b128 v[36:39],v19 offset:2048
v_mfma_f32_32x32x16_bf16 v[72:87],v[248:251],v[48:51],v[72:87]
v_mfma_f32_32x32x16_bf16 v[56:71],a[156:159],v[52:55],v[56:71]
ds_read_b128 v[40:43],v18 offset:4096
v_mfma_f32_32x32x16_bf16 v[72:87],v[252:255],v[52:55],v[72:87]
s_cbranch_scc1 QKVQ_S0
QKVQ_B1:
s_waitcnt lgkmcnt(3)
v_mfma_f32_32x32x16_bf16 v[88:103],a[0:3],v[24:27],0
ds_read_b128 v[44:47],v19 offset:4096
v_add_u32 v189,s57,v188
v_mfma_f32_32x32x16_bf16 v[104:119],a[160:163],v[24:27],0
v_add_u32 v8,0x800,v189
s_sub_u32 s66,46080,s57
s_lshl_b32 s60,s33,6
s_add_u32 s60,s60,s34
s_mul_i32 s60,s60,46080
s_add_u32 s60,s60,s37
v_mfma_f32_32x32x16_bf16 v[88:103],a[4:7],v[28:31],v[88:103]
ds_read_b128 v[48:51],v18 offset:6144
ds_read2_b64 v[156:159],v189 offset0:0 offset1:32
s_add_u32 s60,s60,206569472
v_mfma_f32_32x32x16_bf16 v[104:119],a[164:167],v[28:31],v[104:119]
ds_read2_b64 v[160:163],v189 offset0:64 offset1:96
s_cmp_eq_u32 s33,0
s_cselect_b32 s67,2147483648,s60
s_mul_i32 s61,s46,10240
s_waitcnt lgkmcnt(5)
v_mfma_f32_32x32x16_bf16 v[88:103],a[8:11],v[32:35],v[88:103]
ds_read_b128 v[52:55],v19 offset:6144
ds_read2_b64 v[164:167],v189 offset0:128 offset1:160
s_add_u32 s60,s60,s61
s_add_u32 s61,s61,s66
v_mfma_f32_32x32x16_bf16 v[104:119],a[168:171],v[32:35],v[104:119]
ds_read2_b64 v[168:171],v189 offset0:192 offset1:224
s_add_u32 m0,s61,0
s_add_u32 s63,s60,0
buffer_load_dwordx4 v1,s[8:11],s63 offen sc1 lds
v_mfma_f32_32x32x16_bf16 v[88:103],a[12:15],v[36:39],v[88:103]
ds_read_b128 v[24:27],v18 offset:8192
ds_read2_b64 v[172:175],v8 offset0:0 offset1:32
s_mul_i32 s74,s73,393216
s_add_u32 s74,s74,s39
v_mfma_f32_32x32x16_bf16 v[104:119],a[172:175],v[36:39],v[104:119]
s_add_u32 s74,s74,s70
v_fma_f32 v56,-v176,v120,v56
v_fma_f32 v57,-v176,v121,v57
v_fma_f32 v58,-v176,v122,v58
v_fma_f32 v59,-v176,v123,v59
s_waitcnt lgkmcnt(8)
v_mfma_f32_32x32x16_bf16 v[88:103],a[16:19],v[40:43],v[88:103]
ds_read_b128 v[28:31],v19 offset:8192
buffer_load_dwordx4 v1,s[8:11],s63 offen offset:1024 sc1 lds
v_fma_f32 v60,-v176,v124,v60
v_fma_f32 v61,-v176,v125,v61
v_mfma_f32_32x32x16_bf16 v[104:119],a[176:179],v[40:43],v[104:119]
v_fma_f32 v62,-v176,v126,v62
v_fma_f32 v63,-v176,v127,v63
v_mul_f32 v56,v56,v177
v_mul_f32 v57,v57,v177
v_mul_f32 v58,v58,v177
v_mfma_f32_32x32x16_bf16 v[88:103],a[20:23],v[44:47],v[88:103]
ds_read_b128 v[32:35],v18 offset:10240
s_mov_b32 s53,s33
s_mov_b32 s54,s34
s_add_u32 s79,s79,s33
s_or_b32 s65,s37,s33
v_mfma_f32_32x32x16_bf16 v[104:119],a[180:183],v[44:47],v[104:119]
buffer_load_dwordx4 v1,s[8:11],s63 offen offset:2048 sc1 lds
s_cmp_eq_u32 s65,0
s_addc_u32 s78,s78,0
s_lshl_b32 s41,s78,9
s_waitcnt lgkmcnt(6)
v_mfma_f32_32x32x16_bf16 v[88:103],a[24:27],v[48:51],v[88:103]
ds_read_b128 v[36:39],v19 offset:10240
s_add_u32 s41,s41,s40
s_lshl_b32 s35,s79,9
s_add_u32 s35,s35,s40
s_add_u32 s35,s35,32768
v_mfma_f32_32x32x16_bf16 v[104:119],a[184:187],v[48:51],v[104:119]
v_mul_f32 v59,v59,v177
v_mul_f32 v60,v60,v177
v_mul_f32 v61,v61,v177
v_mul_f32 v62,v62,v177
v_mul_f32 v63,v63,v177
v_mfma_f32_32x32x16_bf16 v[88:103],a[28:31],v[52:55],v[88:103]
ds_read_b128 v[40:43],v18 offset:12288
buffer_load_dwordx4 v1,s[8:11],s63 offen offset:3072 sc1 lds
s_add_u32 m0,s61,4096
s_add_u32 s63,s60,4096
v_mfma_f32_32x32x16_bf16 v[104:119],a[188:191],v[52:55],v[104:119]
v_cvt_pk_bf16_f32 v56,v56,v57
v_cvt_pk_bf16_f32 v57,v58,v59
v_cvt_pk_bf16_f32 v58,v60,v61
v_cvt_pk_bf16_f32 v59,v62,v63
v_fma_f32 v64,-v176,v128,v64
s_waitcnt lgkmcnt(3)
v_mfma_f32_32x32x16_bf16 v[88:103],a[32:35],v[24:27],v[88:103]
ds_read_b128 v[44:47],v19 offset:12288
v_fma_f32 v65,-v176,v129,v65
v_fma_f32 v66,-v176,v130,v66
v_fma_f32 v67,-v176,v131,v67
v_fma_f32 v68,-v176,v132,v68
v_mfma_f32_32x32x16_bf16 v[104:119],a[192:195],v[24:27],v[104:119]
buffer_load_dwordx4 v1,s[8:11],s63 offen sc1 lds
v_fma_f32 v69,-v176,v133,v69
v_fma_f32 v70,-v176,v134,v70
v_fma_f32 v71,-v176,v135,v71
v_mul_f32 v64,v64,v177
v_mfma_f32_32x32x16_bf16 v[88:103],a[36:39],v[28:31],v[88:103]
ds_read_b128 v[48:51],v18 offset:14336
v_mul_f32 v65,v65,v177
v_mul_f32 v66,v66,v177
v_mul_f32 v67,v67,v177
v_mul_f32 v68,v68,v177
v_mfma_f32_32x32x16_bf16 v[104:119],a[196:199],v[28:31],v[104:119]
v_mul_f32 v69,v69,v177
v_mul_f32 v70,v70,v177
v_mul_f32 v71,v71,v177
v_cvt_pk_bf16_f32 v64,v64,v65
v_cvt_pk_bf16_f32 v65,v66,v67
s_waitcnt lgkmcnt(3)
v_mfma_f32_32x32x16_bf16 v[88:103],a[40:43],v[32:35],v[88:103]
ds_read_b128 v[52:55],v19 offset:14336
buffer_load_dwordx4 v1,s[8:11],s63 offen offset:1024 sc1 lds
v_cvt_pk_bf16_f32 v66,v68,v69
v_cvt_pk_bf16_f32 v67,v70,v71
v_mfma_f32_32x32x16_bf16 v[104:119],a[200:203],v[32:35],v[104:119]
v_fma_f32 v72,-v176,v136,v72
v_fma_f32 v73,-v176,v137,v73
v_fma_f32 v74,-v176,v138,v74
v_fma_f32 v75,-v176,v139,v75
v_fma_f32 v76,-v176,v140,v76
v_mfma_f32_32x32x16_bf16 v[88:103],a[44:47],v[36:39],v[88:103]
ds_read_b128 v[24:27],v18 offset:16384
v_fma_f32 v77,-v176,v141,v77
v_fma_f32 v78,-v176,v142,v78
v_fma_f32 v79,-v176,v143,v79
v_mul_f32 v72,v72,v177
v_mfma_f32_32x32x16_bf16 v[104:119],a[204:207],v[36:39],v[104:119]
buffer_load_dwordx4 v1,s[8:11],s63 offen offset:2048 sc1 lds
v_mul_f32 v73,v73,v177
v_mul_f32 v74,v74,v177
v_mul_f32 v75,v75,v177
s_waitcnt lgkmcnt(3)
v_mfma_f32_32x32x16_bf16 v[88:103],a[48:51],v[40:43],v[88:103]
ds_read_b128 v[28:31],v19 offset:16384
v_mul_f32 v76,v76,v177
v_mul_f32 v77,v77,v177
v_mul_f32 v78,v78,v177
v_mul_f32 v79,v79,v177
v_mfma_f32_32x32x16_bf16 v[104:119],a[208:211],v[40:43],v[104:119]
v_cvt_pk_bf16_f32 v72,v72,v73
v_cvt_pk_bf16_f32 v73,v74,v75
v_cvt_pk_bf16_f32 v74,v76,v77
v_cvt_pk_bf16_f32 v75,v78,v79
v_fma_f32 v80,-v176,v144,v80
v_mfma_f32_32x32x16_bf16 v[88:103],a[52:55],v[44:47],v[88:103]
ds_read_b128 v[32:35],v18 offset:18432
buffer_load_dwordx4 v1,s[8:11],s63 offen offset:3072 sc1 lds
s_add_u32 m0,s61,8192
s_add_u32 s63,s60,8192
v_mfma_f32_32x32x16_bf16 v[104:119],a[212:215],v[44:47],v[104:119]
v_fma_f32 v81,-v176,v145,v81
v_fma_f32 v82,-v176,v146,v82
v_fma_f32 v83,-v176,v147,v83
v_fma_f32 v84,-v176,v148,v84
v_fma_f32 v85,-v176,v149,v85
s_waitcnt lgkmcnt(3)
v_mfma_f32_32x32x16_bf16 v[88:103],a[56:59],v[48:51],v[88:103]
ds_read_b128 v[36:39],v19 offset:18432
v_fma_f32 v86,-v176,v150,v86
v_fma_f32 v87,-v176,v151,v87
v_mul_f32 v80,v80,v177
v_mul_f32 v81,v81,v177
v_mfma_f32_32x32x16_bf16 v[104:119],a[216:219],v[48:51],v[104:119]
buffer_load_dwordx4 v1,s[8:11],s63 offen sc1 lds
v_mul_f32 v82,v82,v177
v_mul_f32 v83,v83,v177
v_mul_f32 v84,v84,v177
v_mul_f32 v85,v85,v177
v_mfma_f32_32x32x16_bf16 v[88:103],a[60:63],v[52:55],v[88:103]
ds_read_b128 v[40:43],v18 offset:20480
s_waitcnt vmcnt(9)
s_mov_b64 exec,1
buffer_store_dword v5,v1,s[8:11],s59 offen sc1
s_mov_b64 exec,-1
s_mov_b32 s59,2147483648
v_mfma_f32_32x32x16_bf16 v[104:119],a[220:223],v[52:55],v[104:119]
v_mul_f32 v86,v86,v177
v_mul_f32 v87,v87,v177
v_cvt_pk_bf16_f32 v80,v80,v81
v_cvt_pk_bf16_f32 v81,v82,v83
v_cvt_pk_bf16_f32 v82,v84,v85
s_waitcnt lgkmcnt(3)
v_mfma_f32_32x32x16_bf16 v[88:103],a[64:67],v[24:27],v[88:103]
ds_read_b128 v[44:47],v19 offset:20480
buffer_load_dwordx4 v1,s[8:11],s63 offen offset:1024 sc1 lds
s_lshl_b32 s62,s46,10
s_add_u32 s62,s62,40960
v_mfma_f32_32x32x16_bf16 v[104:119],a[224:227],v[24:27],v[104:119]
s_add_u32 m0,s66,s62
s_add_u32 s63,s67,s62
v_cvt_pk_bf16_f32 v83,v86,v87
s_lshl_b32 s82,s72,6
s_add_u32 s82,s82,s73
s_lshl_b32 s82,s82,9
v_mfma_f32_32x32x16_bf16 v[88:103],a[68:71],v[28:31],v[88:103]
ds_read_b128 v[48:51],v18 offset:22528
s_add_u32 s82,s82,s71
s_lshl_b32 s75,s69,2
s_add_u32 s82,s82,s75
s_add_u32 s82,s82,s39
v_mfma_f32_32x32x16_bf16 v[104:119],a[228:231],v[28:31],v[104:119]
buffer_load_dwordx4 v1,s[8:11],s63 offen sc1 lds
s_add_u32 m0,s66,45056
s_add_u32 s63,s67,45056
s_waitcnt lgkmcnt(3)
v_mfma_f32_32x32x16_bf16 v[88:103],a[72:75],v[32:35],v[88:103]
ds_read_b128 v[52:55],v19 offset:22528
buffer_load_dword v3,v2,s[8:11],s35 offen sc1
buffer_load_dword v14,v4,s[8:11],s41 offen sc1
v_mfma_f32_32x32x16_bf16 v[104:119],a[232:235],v[32:35],v[104:119]
v_add_f32 v156,v156,v166
v_add_f32 v157,v157,v167
v_add_f32 v158,v158,v168
v_add_f32 v159,v159,v169
v_add_f32 v160,v160,v170
v_mfma_f32_32x32x16_bf16 v[88:103],a[76:79],v[36:39],v[88:103]
ds_read_b128 v[24:27],v18 offset:24576
buffer_load_dwordx4 v1,s[8:11],s63 offen sc1 lds
v_add_f32 v161,v161,v171
v_add_f32 v162,v162,v172
v_mfma_f32_32x32x16_bf16 v[104:119],a[236:239],v[36:39],v[104:119]
v_add_f32 v163,v163,v173
v_add_f32 v164,v164,v174
v_add_f32 v165,v165,v175
v_add_f32 v156,v156,v158
v_add_f32 v157,v157,v159
s_waitcnt lgkmcnt(3)
v_mfma_f32_32x32x16_bf16 v[88:103],a[80:83],v[40:43],v[88:103]
ds_read_b128 v[28:31],v19 offset:24576
buffer_store_dwordx4 v[56:59],v20,s[8:11],s74 offen sc1
v_add_f32 v160,v160,v162
v_add_f32 v161,v161,v163
v_mfma_f32_32x32x16_bf16 v[104:119],a[240:243],v[40:43],v[104:119]
v_add_f32 v156,v156,v160
v_add_f32 v157,v157,v161
v_add_f32 v156,v156,v164
v_add_f32 v157,v157,v165
v_mov_b32 v158,v156
v_mfma_f32_32x32x16_bf16 v[88:103],a[84:87],v[44:47],v[88:103]
ds_read_b128 v[32:35],v18 offset:26624
buffer_store_dwordx4 v[64:67],v21,s[8:11],s74 offen sc1
v_mov_b32 v159,v157
v_permlane32_swap_b32 v156,v158
v_mfma_f32_32x32x16_bf16 v[104:119],a[244:247],v[44:47],v[104:119]
v_permlane32_swap_b32 v157,v159
v_add_f32 v176,v156,v158
v_add_f32 v177,v157,v159
v_mul_f32 v176,0x3acccccd,v176
v_mul_f32 v177,0x3acccccd,v177
s_waitcnt lgkmcnt(3)
v_mfma_f32_32x32x16_bf16 v[88:103],a[88:91],v[48:51],v[88:103]
ds_read_b128 v[36:39],v19 offset:26624
buffer_store_dwordx4 v[72:75],v20,s[8:11],s74 offen offset:2048 sc1
v_fma_f32 v177,-v176,v176,v177
v_max_f32 v177,0,v177
v_mfma_f32_32x32x16_bf16 v[104:119],a[248:251],v[48:51],v[104:119]
v_cvt_pk_bf16_f32 v8,v176,v177
v_lshlrev_b32 v176,16,v8
v_and_b32 v177,0xffff0000,v8
v_add_f32 v177,0x3727c5ac,v177
v_cvt_pk_bf16_f32 v8,v177,v177
v_mfma_f32_32x32x16_bf16 v[88:103],a[92:95],v[52:55],v[88:103]
ds_read_b128 v[40:43],v18 offset:28672
buffer_store_dwordx4 v[80:83],v21,s[8:11],s74 offen offset:2048 sc1
v_lshlrev_b32 v177,16,v8
v_mfma_f32_32x32x16_bf16 v[104:119],a[252:255],v[52:55],v[104:119]
v_sqrt_f32 v177,v177
s_nop 0
v_cvt_pk_bf16_f32 v8,v177,v177
v_lshlrev_b32 v177,16,v8
s_waitcnt lgkmcnt(3)
v_mfma_f32_32x32x16_bf16 v[88:103],a[96:99],v[24:27],v[88:103]
ds_read_b128 v[44:47],v19 offset:28672
v_rcp_f32 v177,v177
s_cmp_eq_u32 s51,0
s_cselect_b64 s[76:77],-1,0
v_mfma_f32_32x32x16_bf16 v[104:119],v[192:195],v[24:27],v[104:119]
v_cndmask_b32 v176,v176,0,s[76:77]
v_cndmask_b32 v177,v177,1.0,s[76:77]
s_mov_b32 s72,s51
s_mov_b32 s73,s52
v_mfma_f32_32x32x16_bf16 v[88:103],a[100:103],v[28:31],v[88:103]
ds_read_b128 v[48:51],v18 offset:30720
v_mfma_f32_32x32x16_bf16 v[104:119],v[196:199],v[28:31],v[104:119]
s_waitcnt lgkmcnt(3)
v_mfma_f32_32x32x16_bf16 v[88:103],a[104:107],v[32:35],v[88:103]
ds_read_b128 v[52:55],v19 offset:30720
v_mfma_f32_32x32x16_bf16 v[104:119],v[200:203],v[32:35],v[104:119]
v_mfma_f32_32x32x16_bf16 v[88:103],a[108:111],v[36:39],v[88:103]
ds_read_b128 v[24:27],v18 offset:32768
v_mfma_f32_32x32x16_bf16 v[104:119],v[204:207],v[36:39],v[104:119]
s_waitcnt lgkmcnt(3)
v_mfma_f32_32x32x16_bf16 v[88:103],a[112:115],v[40:43],v[88:103]
ds_read_b128 v[28:31],v19 offset:32768
v_mfma_f32_32x32x16_bf16 v[104:119],v[208:211],v[40:43],v[104:119]
v_mfma_f32_32x32x16_bf16 v[88:103],a[116:119],v[44:47],v[88:103]
ds_read_b128 v[32:35],v18 offset:34816
v_mfma_f32_32x32x16_bf16 v[104:119],v[212:215],v[44:47],v[104:119]
s_waitcnt lgkmcnt(3)
v_mfma_f32_32x32x16_bf16 v[88:103],a[120:123],v[48:51],v[88:103]
ds_read_b128 v[36:39],v19 offset:34816
v_mfma_f32_32x32x16_bf16 v[104:119],v[216:219],v[48:51],v[104:119]
v_mfma_f32_32x32x16_bf16 v[88:103],a[124:127],v[52:55],v[88:103]
ds_read_b128 v[40:43],v18 offset:36864
v_mfma_f32_32x32x16_bf16 v[104:119],v[220:223],v[52:55],v[104:119]
s_waitcnt lgkmcnt(3)
v_mfma_f32_32x32x16_bf16 v[88:103],a[128:131],v[24:27],v[88:103]
ds_read_b128 v[44:47],v19 offset:36864
s_waitcnt vmcnt(4)
v_cmp_eq_u32 vcc,0,v14
s_cmp_eq_u64 vcc,0
s_cselect_b32 s36,0,2147483648
v_mfma_f32_32x32x16_bf16 v[104:119],v[224:227],v[24:27],v[104:119]
v_cmp_eq_u32 vcc,0,v3
s_cmp_lt_u32 s78,64
s_cselect_b32 s36,s36,2147483648
s_cmp_eq_u64 vcc,0
s_cselect_b32 s60,1,s36
v_mfma_f32_32x32x16_bf16 v[88:103],a[132:135],v[28:31],v[88:103]
ds_read_b128 v[48:51],v18 offset:38912
s_cmp_lt_u32 s79,64
s_cselect_b32 s60,s60,s36
s_sub_u32 s61,s78,s79
s_or_b32 s61,s61,s36
v_mfma_f32_32x32x16_bf16 v[104:119],v[228:231],v[28:31],v[104:119]
s_cmp_lt_u32 s61,16
s_cselect_b32 s36,0,s60
v_mov_b32 v23,s36
s_waitcnt lgkmcnt(3)
v_mfma_f32_32x32x16_bf16 v[88:103],a[136:139],v[32:35],v[88:103]
ds_read_b128 v[52:55],v19 offset:38912
ds_write_b32 v13,v23
v_mfma_f32_32x32x16_bf16 v[104:119],v[232:235],v[32:35],v[104:119]
s_waitcnt lgkmcnt(0)
s_barrier
ds_read_b32 v23,v22
v_mfma_f32_32x32x16_bf16 v[88:103],a[140:143],v[36:39],v[88:103]
ds_read_b128 v[24:27],v16 offset:0
s_cmp_lt_u32 s50,2
s_cselect_b32 s42,1,0
s_cmp_ge_u32 s78,64
s_cselect_b32 s42,1,s42
v_mfma_f32_32x32x16_bf16 v[104:119],v[236:239],v[36:39],v[104:119]
s_or_b32 s42,s42,s37
s_mov_b32 s39,0
s_add_u32 s50,s50,1
s_sub_u32 s57,46080,s57
s_mov_b32 s51,s53
s_mov_b32 s52,s54
v_mfma_f32_32x32x16_bf16 v[88:103],a[144:147],v[40:43],v[88:103]
ds_read_b128 v[28:31],v17 offset:0
v_mfma_f32_32x32x16_bf16 v[104:119],v[240:243],v[40:43],v[104:119]
v_mfma_f32_32x32x16_bf16 v[88:103],a[148:151],v[44:47],v[88:103]
ds_read_b128 v[32:35],v16 offset:2048
s_waitcnt vmcnt(0)
s_mov_b64 exec,1
buffer_store_dword v5,v1,s[8:11],s82 offen sc1
s_mov_b64 exec,-1
s_mov_b32 s82,2147483648
v_mfma_f32_32x32x16_bf16 v[104:119],v[244:247],v[44:47],v[104:119]
s_waitcnt lgkmcnt(3)
v_readfirstlane_b32 s38,v23
s_and_b32 s37,s38,2147483648
s_and_b32 s33,s38,1
s_cselect_b32 s34,s79,s78
s_cmp_lg_u32 s42,0
v_mfma_f32_32x32x16_bf16 v[88:103],a[152:155],v[48:51],v[88:103]
ds_read_b128 v[36:39],v17 offset:2048
v_mfma_f32_32x32x16_bf16 v[104:119],v[248:251],v[48:51],v[104:119]
v_mfma_f32_32x32x16_bf16 v[88:103],a[156:159],v[52:55],v[88:103]
ds_read_b128 v[40:43],v16 offset:4096
v_mfma_f32_32x32x16_bf16 v[104:119],v[252:255],v[52:55],v[104:119]
s_cbranch_scc0 QKVQ_B0
s_branch QKVQ_S1
s_nop 9
QKVQ_S0:
s_mov_b32 s55,0
s_cmp_lt_u32 s42,2
s_cbranch_scc1 nt_216
s_mov_b32 s55,2
s_cmp_lg_u32 s37,0
s_cbranch_scc1 nt_216
s_mov_b32 s55,1
s_lshl_b32 s60,s33,6
s_add_u32 s60,s60,s34
s_mul_i32 s60,s60,46080
s_add_u32 s60,s60,206569472
s_cmp_eq_u32 s33,0
s_cselect_b32 s67,2147483648,s60
s_mul_i32 s61,s46,10240
s_add_u32 s60,s60,s61
s_add_u32 s61,s61,s57
s_add_u32 m0,s61,0
s_add_u32 s63,s60,0
buffer_load_dwordx4 v1,s[8:11],s63 offen sc1 lds
buffer_load_dwordx4 v1,s[8:11],s63 offen offset:1024 sc1 lds
buffer_load_dwordx4 v1,s[8:11],s63 offen offset:2048 sc1 lds
buffer_load_dwordx4 v1,s[8:11],s63 offen offset:3072 sc1 lds
s_add_u32 m0,s61,4096
s_add_u32 s63,s60,4096
buffer_load_dwordx4 v1,s[8:11],s63 offen sc1 lds
buffer_load_dwordx4 v1,s[8:11],s63 offen offset:1024 sc1 lds
buffer_load_dwordx4 v1,s[8:11],s63 offen offset:2048 sc1 lds
buffer_load_dwordx4 v1,s[8:11],s63 offen offset:3072 sc1 lds
s_add_u32 m0,s61,8192
s_add_u32 s63,s60,8192
buffer_load_dwordx4 v1,s[8:11],s63 offen sc1 lds
buffer_load_dwordx4 v1,s[8:11],s63 offen offset:1024 sc1 lds
s_lshl_b32 s62,s46,10
s_add_u32 s62,s62,40960
s_add_u32 m0,s57,s62
s_add_u32 s63,s67,s62
buffer_load_dwordx4 v1,s[8:11],s63 offen sc1 lds
s_add_u32 m0,s57,45056
s_add_u32 s63,s67,45056
buffer_load_dwordx4 v1,s[8:11],s63 offen sc1 lds
nt_216:
s_nop 4
s_mul_i32 s74,s73,393216
s_add_u32 s74,s74,s39
s_add_u32 s74,s74,s70
v_fma_f32 v56,-v176,v120,v56
v_fma_f32 v57,-v176,v121,v57
v_fma_f32 v58,-v176,v122,v58
v_fma_f32 v59,-v176,v123,v59
v_fma_f32 v60,-v176,v124,v60
v_fma_f32 v61,-v176,v125,v61
v_fma_f32 v62,-v176,v126,v62
v_fma_f32 v63,-v176,v127,v63
v_mul_f32 v56,v56,v177
v_mul_f32 v57,v57,v177
v_mul_f32 v58,v58,v177
v_mul_f32 v59,v59,v177
v_mul_f32 v60,v60,v177
v_mul_f32 v61,v61,v177
v_mul_f32 v62,v62,v177
v_mul_f32 v63,v63,v177
v_cvt_pk_bf16_f32 v56,v56,v57
v_cvt_pk_bf16_f32 v57,v58,v59
v_cvt_pk_bf16_f32 v58,v60,v61
v_cvt_pk_bf16_f32 v59,v62,v63
buffer_store_dwordx4 v[56:59],v20,s[8:11],s74 offen sc1
v_fma_f32 v64,-v176,v128,v64
v_fma_f32 v65,-v176,v129,v65
v_fma_f32 v66,-v176,v130,v66
v_fma_f32 v67,-v176,v131,v67
v_fma_f32 v68,-v176,v132,v68
v_fma_f32 v69,-v176,v133,v69
v_fma_f32 v70,-v176,v134,v70
v_fma_f32 v71,-v176,v135,v71
v_mul_f32 v64,v64,v177
v_mul_f32 v65,v65,v177
v_mul_f32 v66,v66,v177
v_mul_f32 v67,v67,v177
v_mul_f32 v68,v68,v177
v_mul_f32 v69,v69,v177
v_mul_f32 v70,v70,v177
v_mul_f32 v71,v71,v177
v_cvt_pk_bf16_f32 v64,v64,v65
v_cvt_pk_bf16_f32 v65,v66,v67
v_cvt_pk_bf16_f32 v66,v68,v69
v_cvt_pk_bf16_f32 v67,v70,v71
buffer_store_dwordx4 v[64:67],v21,s[8:11],s74 offen sc1
v_fma_f32 v72,-v176,v136,v72
v_fma_f32 v73,-v176,v137,v73
v_fma_f32 v74,-v176,v138,v74
v_fma_f32 v75,-v176,v139,v75
v_fma_f32 v76,-v176,v140,v76
v_fma_f32 v77,-v176,v141,v77
v_fma_f32 v78,-v176,v142,v78
v_fma_f32 v79,-v176,v143,v79
v_mul_f32 v72,v72,v177
v_mul_f32 v73,v73,v177
v_mul_f32 v74,v74,v177
v_mul_f32 v75,v75,v177
v_mul_f32 v76,v76,v177
v_mul_f32 v77,v77,v177
v_mul_f32 v78,v78,v177
v_mul_f32 v79,v79,v177
v_cvt_pk_bf16_f32 v72,v72,v73
v_cvt_pk_bf16_f32 v73,v74,v75
v_cvt_pk_bf16_f32 v74,v76,v77
v_cvt_pk_bf16_f32 v75,v78,v79
buffer_store_dwordx4 v[72:75],v20,s[8:11],s74 offen offset:2048 sc1
v_fma_f32 v80,-v176,v144,v80
v_fma_f32 v81,-v176,v145,v81
v_fma_f32 v82,-v176,v146,v82
v_fma_f32 v83,-v176,v147,v83
v_fma_f32 v84,-v176,v148,v84
v_fma_f32 v85,-v176,v149,v85
v_fma_f32 v86,-v176,v150,v86
v_fma_f32 v87,-v176,v151,v87
v_mul_f32 v80,v80,v177
v_mul_f32 v81,v81,v177
v_mul_f32 v82,v82,v177
v_mul_f32 v83,v83,v177
v_mul_f32 v84,v84,v177
v_mul_f32 v85,v85,v177
v_mul_f32 v86,v86,v177
v_mul_f32 v87,v87,v177
v_cvt_pk_bf16_f32 v80,v80,v81
v_cvt_pk_bf16_f32 v81,v82,v83
v_cvt_pk_bf16_f32 v82,v84,v85
v_cvt_pk_bf16_f32 v83,v86,v87
buffer_store_dwordx4 v[80:83],v21,s[8:11],s74 offen offset:2048 sc1
s_lshl_b32 s82,s72,6
s_add_u32 s82,s82,s73
s_lshl_b32 s82,s82,9
s_add_u32 s82,s82,s71
s_lshl_b32 s75,s69,2
s_add_u32 s82,s82,s75
s_add_u32 s82,s82,s39
s_mov_b32 s59,s82
s_mov_b32 s82,2147483648
s_mov_b32 s39,2147483648
s_cmp_eq_u32 s55,0
s_cbranch_scc1 QKVQ_B1
s_cmp_eq_u32 s55,1
s_cbranch_scc1 QKVQ_CD1
s_waitcnt vmcnt(0)
s_mov_b64 exec,1
buffer_store_dword v5,v1,s[8:11],s59 offen sc1
s_mov_b64 exec,-1
s_mov_b32 s59,2147483648
s_cmp_eq_u32 s50,128
s_cbranch_scc1 QKVQ_END
s_branch QKVQ_COLD1
QKVQ_COLD0:
s_cmp_lg_u32 s46,0
s_cbranch_scc1 cp_217
ct_218:
buffer_load_dword v3,v2,s[8:11],s35 offen sc1
buffer_load_dword v14,v4,s[8:11],s41 offen sc1
s_waitcnt vmcnt(0)
v_cmp_eq_u32 vcc,0,v14
s_cmp_eq_u64 vcc,0
s_cselect_b32 s36,0,2147483648
v_cmp_eq_u32 vcc,0,v3
s_cmp_lt_u32 s78,64
s_cselect_b32 s36,s36,2147483648
s_cmp_eq_u64 vcc,0
s_cselect_b32 s60,1,s36
s_cmp_lt_u32 s79,64
s_cselect_b32 s60,s60,s36
s_sub_u32 s61,s78,s79
s_or_b32 s61,s61,s36
s_cmp_lt_u32 s61,16
s_cselect_b32 s36,0,s60
v_mov_b32 v23,s36
s_cmp_lt_u32 s36,2
s_cbranch_scc1 ct_218x
s_sleep 3
s_sub_u32 s47,s47,1
s_cbranch_scc1 ABORT
s_branch ct_218
ct_218x:
ds_write_b32 v22,v23 offset:4
s_waitcnt lgkmcnt(0)
cp_217:
s_barrier
ds_read_b32 v23,v22 offset:4
s_waitcnt lgkmcnt(0)
v_readfirstlane_b32 s38,v23
s_and_b32 s38,s38,1
s_and_b32 s37,s38,2147483648
s_and_b32 s33,s38,1
s_cselect_b32 s34,s79,s78
s_lshl_b32 s60,s33,6
s_add_u32 s60,s60,s34
s_mul_i32 s60,s60,46080
s_add_u32 s60,s60,206569472
s_cmp_eq_u32 s33,0
s_cselect_b32 s67,2147483648,s60
s_mul_i32 s61,s46,10240
s_add_u32 s60,s60,s61
s_add_u32 s61,s61,s57
s_add_u32 m0,s61,0
s_add_u32 s63,s60,0
buffer_load_dwordx4 v1,s[8:11],s63 offen sc1 lds
buffer_load_dwordx4 v1,s[8:11],s63 offen offset:1024 sc1 lds
buffer_load_dwordx4 v1,s[8:11],s63 offen offset:2048 sc1 lds
buffer_load_dwordx4 v1,s[8:11],s63 offen offset:3072 sc1 lds
s_add_u32 m0,s61,4096
s_add_u32 s63,s60,4096
buffer_load_dwordx4 v1,s[8:11],s63 offen sc1 lds
buffer_load_dwordx4 v1,s[8:11],s63 offen offset:1024 sc1 lds
buffer_load_dwordx4 v1,s[8:11],s63 offen offset:2048 sc1 lds
buffer_load_dwordx4 v1,s[8:11],s63 offen offset:3072 sc1 lds
s_add_u32 m0,s61,8192
s_add_u32 s63,s60,8192
buffer_load_dwordx4 v1,s[8:11],s63 offen sc1 lds
buffer_load_dwordx4 v1,s[8:11],s63 offen offset:1024 sc1 lds
s_lshl_b32 s62,s46,10
s_add_u32 s62,s62,40960
s_add_u32 m0,s57,s62
s_add_u32 s63,s67,s62
buffer_load_dwordx4 v1,s[8:11],s63 offen sc1 lds
s_add_u32 m0,s57,45056
s_add_u32 s63,s67,45056
buffer_load_dwordx4 v1,s[8:11],s63 offen sc1 lds
QKVQ_CD0:
s_mov_b32 s51,s33
s_mov_b32 s52,s34
s_mov_b32 s53,s33
s_mov_b32 s54,s34
s_add_u32 s79,s79,s33
s_or_b32 s60,s37,s33
s_cmp_eq_u32 s60,0
s_addc_u32 s78,s78,0
s_lshl_b32 s41,s78,9
s_add_u32 s41,s41,s40
s_lshl_b32 s35,s79,9
s_add_u32 s35,s35,s40
s_add_u32 s35,s35,32768
buffer_load_dword v3,v2,s[8:11],s35 offen sc1
buffer_load_dword v14,v4,s[8:11],s41 offen sc1
s_waitcnt vmcnt(0)
s_mov_b64 exec,1
buffer_store_dword v5,v1,s[8:11],s59 offen sc1
s_mov_b64 exec,-1
s_mov_b32 s59,2147483648
v_cmp_eq_u32 vcc,0,v14
s_cmp_eq_u64 vcc,0
s_cselect_b32 s36,0,2147483648
v_cmp_eq_u32 vcc,0,v3
s_cmp_lt_u32 s78,64
s_cselect_b32 s36,s36,2147483648
s_cmp_eq_u64 vcc,0
s_cselect_b32 s60,1,s36
s_cmp_lt_u32 s79,64
s_cselect_b32 s60,s60,s36
s_sub_u32 s61,s78,s79
s_or_b32 s61,s61,s36
s_cmp_lt_u32 s61,16
s_cselect_b32 s36,0,s60
v_mov_b32 v23,s36
ds_write_b32 v13,v23
s_waitcnt lgkmcnt(0)
s_barrier
ds_read_b32 v23,v22
ds_read_b128 v[24:27],v16 offset:0
ds_read_b128 v[28:31],v17 offset:0
ds_read_b128 v[32:35],v16 offset:2048
ds_read_b128 v[36:39],v17 offset:2048
ds_read_b128 v[40:43],v16 offset:4096
s_waitcnt lgkmcnt(5)
v_readfirstlane_b32 s38,v23
s_and_b32 s37,s38,2147483648
s_and_b32 s33,s38,1
s_cselect_b32 s34,s79,s78
s_nop 0
s_branch QKVQ_B0
QKVQ_S1:
s_mov_b32 s55,0
s_cmp_lt_u32 s42,2
s_cbranch_scc1 nt_219
s_mov_b32 s55,2
s_cmp_lg_u32 s37,0
s_cbranch_scc1 nt_219
s_mov_b32 s55,1
s_lshl_b32 s60,s33,6
s_add_u32 s60,s60,s34
s_mul_i32 s60,s60,46080
s_add_u32 s60,s60,206569472
s_cmp_eq_u32 s33,0
s_cselect_b32 s67,2147483648,s60
s_mul_i32 s61,s46,10240
s_add_u32 s60,s60,s61
s_add_u32 s61,s61,s57
s_add_u32 m0,s61,0
s_add_u32 s63,s60,0
buffer_load_dwordx4 v1,s[8:11],s63 offen sc1 lds
buffer_load_dwordx4 v1,s[8:11],s63 offen offset:1024 sc1 lds
buffer_load_dwordx4 v1,s[8:11],s63 offen offset:2048 sc1 lds
buffer_load_dwordx4 v1,s[8:11],s63 offen offset:3072 sc1 lds
s_add_u32 m0,s61,4096
s_add_u32 s63,s60,4096
buffer_load_dwordx4 v1,s[8:11],s63 offen sc1 lds
buffer_load_dwordx4 v1,s[8:11],s63 offen offset:1024 sc1 lds
buffer_load_dwordx4 v1,s[8:11],s63 offen offset:2048 sc1 lds
buffer_load_dwordx4 v1,s[8:11],s63 offen offset:3072 sc1 lds
s_add_u32 m0,s61,8192
s_add_u32 s63,s60,8192
buffer_load_dwordx4 v1,s[8:11],s63 offen sc1 lds
buffer_load_dwordx4 v1,s[8:11],s63 offen offset:1024 sc1 lds
s_lshl_b32 s62,s46,10
s_add_u32 s62,s62,40960
s_add_u32 m0,s57,s62
s_add_u32 s63,s67,s62
buffer_load_dwordx4 v1,s[8:11],s63 offen sc1 lds
s_add_u32 m0,s57,45056
s_add_u32 s63,s67,45056
buffer_load_dwordx4 v1,s[8:11],s63 offen sc1 lds
nt_219:
s_nop 4
s_mul_i32 s74,s73,393216
s_add_u32 s74,s74,s39
s_add_u32 s74,s74,s70
v_fma_f32 v88,-v176,v120,v88
v_fma_f32 v89,-v176,v121,v89
v_fma_f32 v90,-v176,v122,v90
v_fma_f32 v91,-v176,v123,v91
v_fma_f32 v92,-v176,v124,v92
v_fma_f32 v93,-v176,v125,v93
v_fma_f32 v94,-v176,v126,v94
v_fma_f32 v95,-v176,v127,v95
v_mul_f32 v88,v88,v177
v_mul_f32 v89,v89,v177
v_mul_f32 v90,v90,v177
v_mul_f32 v91,v91,v177
v_mul_f32 v92,v92,v177
v_mul_f32 v93,v93,v177
v_mul_f32 v94,v94,v177
v_mul_f32 v95,v95,v177
v_cvt_pk_bf16_f32 v88,v88,v89
v_cvt_pk_bf16_f32 v89,v90,v91
v_cvt_pk_bf16_f32 v90,v92,v93
v_cvt_pk_bf16_f32 v91,v94,v95
buffer_store_dwordx4 v[88:91],v20,s[8:11],s74 offen sc1
v_fma_f32 v96,-v176,v128,v96
v_fma_f32 v97,-v176,v129,v97
v_fma_f32 v98,-v176,v130,v98
v_fma_f32 v99,-v176,v131,v99
v_fma_f32 v100,-v176,v132,v100
v_fma_f32 v101,-v176,v133,v101
v_fma_f32 v102,-v176,v134,v102
v_fma_f32 v103,-v176,v135,v103
v_mul_f32 v96,v96,v177
v_mul_f32 v97,v97,v177
v_mul_f32 v98,v98,v177
v_mul_f32 v99,v99,v177
v_mul_f32 v100,v100,v177
v_mul_f32 v101,v101,v177
v_mul_f32 v102,v102,v177
v_mul_f32 v103,v103,v177
v_cvt_pk_bf16_f32 v96,v96,v97
v_cvt_pk_bf16_f32 v97,v98,v99
v_cvt_pk_bf16_f32 v98,v100,v101
v_cvt_pk_bf16_f32 v99,v102,v103
buffer_store_dwordx4 v[96:99],v21,s[8:11],s74 offen sc1
v_fma_f32 v104,-v176,v136,v104
v_fma_f32 v105,-v176,v137,v105
v_fma_f32 v106,-v176,v138,v106
v_fma_f32 v107,-v176,v139,v107
v_fma_f32 v108,-v176,v140,v108
v_fma_f32 v109,-v176,v141,v109
v_fma_f32 v110,-v176,v142,v110
v_fma_f32 v111,-v176,v143,v111
v_mul_f32 v104,v104,v177
v_mul_f32 v105,v105,v177
v_mul_f32 v106,v106,v177
v_mul_f32 v107,v107,v177
v_mul_f32 v108,v108,v177
v_mul_f32 v109,v109,v177
v_mul_f32 v110,v110,v177
v_mul_f32 v111,v111,v177
v_cvt_pk_bf16_f32 v104,v104,v105
v_cvt_pk_bf16_f32 v105,v106,v107
v_cvt_pk_bf16_f32 v106,v108,v109
v_cvt_pk_bf16_f32 v107,v110,v111
buffer_store_dwordx4 v[104:107],v20,s[8:11],s74 offen offset:2048 sc1
v_fma_f32 v112,-v176,v144,v112
v_fma_f32 v113,-v176,v145,v113
v_fma_f32 v114,-v176,v146,v114
v_fma_f32 v115,-v176,v147,v115
v_fma_f32 v116,-v176,v148,v116
v_fma_f32 v117,-v176,v149,v117
v_fma_f32 v118,-v176,v150,v118
v_fma_f32 v119,-v176,v151,v119
v_mul_f32 v112,v112,v177
v_mul_f32 v113,v113,v177
v_mul_f32 v114,v114,v177
v_mul_f32 v115,v115,v177
v_mul_f32 v116,v116,v177
v_mul_f32 v117,v117,v177
v_mul_f32 v118,v118,v177
v_mul_f32 v119,v119,v177
v_cvt_pk_bf16_f32 v112,v112,v113
v_cvt_pk_bf16_f32 v113,v114,v115
v_cvt_pk_bf16_f32 v114,v116,v117
v_cvt_pk_bf16_f32 v115,v118,v119
buffer_store_dwordx4 v[112:115],v21,s[8:11],s74 offen offset:2048 sc1
s_lshl_b32 s82,s72,6
s_add_u32 s82,s82,s73
s_lshl_b32 s82,s82,9
s_add_u32 s82,s82,s71
s_lshl_b32 s75,s69,2
s_add_u32 s82,s82,s75
s_add_u32 s82,s82,s39
s_mov_b32 s59,s82
s_mov_b32 s82,2147483648
s_mov_b32 s39,2147483648
s_cmp_eq_u32 s55,0
s_cbranch_scc1 QKVQ_B0
s_cmp_eq_u32 s55,1
s_cbranch_scc1 QKVQ_CD0
s_waitcnt vmcnt(0)
s_mov_b64 exec,1
buffer_store_dword v5,v1,s[8:11],s59 offen sc1
s_mov_b64 exec,-1
s_mov_b32 s59,2147483648
s_cmp_eq_u32 s50,128
s_cbranch_scc1 QKVQ_END
s_branch QKVQ_COLD0
QKVQ_COLD1:
s_cmp_lg_u32 s46,0
s_cbranch_scc1 cp_220
ct_221:
buffer_load_dword v3,v2,s[8:11],s35 offen sc1
buffer_load_dword v14,v4,s[8:11],s41 offen sc1
s_waitcnt vmcnt(0)
v_cmp_eq_u32 vcc,0,v14
s_cmp_eq_u64 vcc,0
s_cselect_b32 s36,0,2147483648
v_cmp_eq_u32 vcc,0,v3
s_cmp_lt_u32 s78,64
s_cselect_b32 s36,s36,2147483648
s_cmp_eq_u64 vcc,0
s_cselect_b32 s60,1,s36
s_cmp_lt_u32 s79,64
s_cselect_b32 s60,s60,s36
s_sub_u32 s61,s78,s79
s_or_b32 s61,s61,s36
s_cmp_lt_u32 s61,16
s_cselect_b32 s36,0,s60
v_mov_b32 v23,s36
s_cmp_lt_u32 s36,2
s_cbranch_scc1 ct_221x
s_sleep 3
s_sub_u32 s47,s47,1
s_cbranch_scc1 ABORT
s_branch ct_221
ct_221x:
ds_write_b32 v22,v23 offset:4
s_waitcnt lgkmcnt(0)
cp_220:
s_barrier
ds_read_b32 v23,v22 offset:4
s_waitcnt lgkmcnt(0)
v_readfirstlane_b32 s38,v23
s_and_b32 s38,s38,1
s_and_b32 s37,s38,2147483648
s_and_b32 s33,s38,1
s_cselect_b32 s34,s79,s78
s_lshl_b32 s60,s33,6
s_add_u32 s60,s60,s34
s_mul_i32 s60,s60,46080
s_add_u32 s60,s60,206569472
s_cmp_eq_u32 s33,0
s_cselect_b32 s67,2147483648,s60
s_mul_i32 s61,s46,10240
s_add_u32 s60,s60,s61
s_add_u32 s61,s61,s57
s_add_u32 m0,s61,0
s_add_u32 s63,s60,0
buffer_load_dwordx4 v1,s[8:11],s63 offen sc1 lds
buffer_load_dwordx4 v1,s[8:11],s63 offen offset:1024 sc1 lds
buffer_load_dwordx4 v1,s[8:11],s63 offen offset:2048 sc1 lds
buffer_load_dwordx4 v1,s[8:11],s63 offen offset:3072 sc1 lds
s_add_u32 m0,s61,4096
s_add_u32 s63,s60,4096
buffer_load_dwordx4 v1,s[8:11],s63 offen sc1 lds
buffer_load_dwordx4 v1,s[8:11],s63 offen offset:1024 sc1 lds
buffer_load_dwordx4 v1,s[8:11],s63 offen offset:2048 sc1 lds
buffer_load_dwordx4 v1,s[8:11],s63 offen offset:3072 sc1 lds
s_add_u32 m0,s61,8192
s_add_u32 s63,s60,8192
buffer_load_dwordx4 v1,s[8:11],s63 offen sc1 lds
buffer_load_dwordx4 v1,s[8:11],s63 offen offset:1024 sc1 lds
s_lshl_b32 s62,s46,10
s_add_u32 s62,s62,40960
s_add_u32 m0,s57,s62
s_add_u32 s63,s67,s62
buffer_load_dwordx4 v1,s[8:11],s63 offen sc1 lds
s_add_u32 m0,s57,45056
s_add_u32 s63,s67,45056
buffer_load_dwordx4 v1,s[8:11],s63 offen sc1 lds
QKVQ_CD1:
s_mov_b32 s51,s33
s_mov_b32 s52,s34
s_mov_b32 s53,s33
s_mov_b32 s54,s34
s_add_u32 s79,s79,s33
s_or_b32 s60,s37,s33
s_cmp_eq_u32 s60,0
s_addc_u32 s78,s78,0
s_lshl_b32 s41,s78,9
s_add_u32 s41,s41,s40
s_lshl_b32 s35,s79,9
s_add_u32 s35,s35,s40
s_add_u32 s35,s35,32768
buffer_load_dword v3,v2,s[8:11],s35 offen sc1
buffer_load_dword v14,v4,s[8:11],s41 offen sc1
s_waitcnt vmcnt(0)
s_mov_b64 exec,1
buffer_store_dword v5,v1,s[8:11],s59 offen sc1
s_mov_b64 exec,-1
s_mov_b32 s59,2147483648
v_cmp_eq_u32 vcc,0,v14
s_cmp_eq_u64 vcc,0
s_cselect_b32 s36,0,2147483648
v_cmp_eq_u32 vcc,0,v3
s_cmp_lt_u32 s78,64
s_cselect_b32 s36,s36,2147483648
s_cmp_eq_u64 vcc,0
s_cselect_b32 s60,1,s36
s_cmp_lt_u32 s79,64
s_cselect_b32 s60,s60,s36
s_sub_u32 s61,s78,s79
s_or_b32 s61,s61,s36
s_cmp_lt_u32 s61,16
s_cselect_b32 s36,0,s60
v_mov_b32 v23,s36
ds_write_b32 v13,v23
s_waitcnt lgkmcnt(0)
s_barrier
ds_read_b32 v23,v22
ds_read_b128 v[24:27],v18 offset:0
ds_read_b128 v[28:31],v19 offset:0
ds_read_b128 v[32:35],v18 offset:2048
ds_read_b128 v[36:39],v19 offset:2048
ds_read_b128 v[40:43],v18 offset:4096
s_waitcnt lgkmcnt(5)
v_readfirstlane_b32 s38,v23
s_and_b32 s37,s38,2147483648
s_and_b32 s33,s38,1
s_cselect_b32 s34,s79,s78
s_nop 0
s_branch QKVQ_B1
QKVQ_END:
s_endpgm
ROLE_QKVV:
v_lshlrev_b32 v1,4,v0
v_mov_b32 v5,1
s_lshl_b32 s56,s48,2
s_add_u32 s56,s56,s46
v_bfe_u32 v6,v0,2,2
v_lshrrev_b32 v7,4,v0
v_add_u32 v7,v6,v7
v_and_b32 v7,3,v7
v_and_b32 v15,3,v0
v_lshlrev_b32 v15,4,v15
v_lshl_add_u32 v15,v7,6,v15
v_lshl_add_u32 v15,v6,8,v15
v_lshrrev_b32 v6,5,v0
v_bfe_u32 v7,v0,4,1
v_lshlrev_b32 v16,10,v7
v_bfe_u32 v7,v0,2,2
v_lshl_add_u32 v16,v7,8,v16
v_add_u32 v6,v6,v7
v_and_b32 v6,3,v6
v_lshl_add_u32 v16,v6,6,v16
v_and_b32 v6,3,v0
v_lshl_add_u32 v16,v6,4,v16
v_add_u32 v18,46080,v16
v_lshrrev_b32 v6,5,v0
v_bfe_u32 v7,v0,4,1
v_lshlrev_b32 v20,10,v7
v_lshl_add_u32 v20,v6,8,v20
v_and_b32 v6,15,v0
v_lshl_add_u32 v20,v6,4,v20
v_lshrrev_b32 v6,5,v0
v_add_u32 v6,2,v6
v_bfe_u32 v7,v0,4,1
v_lshlrev_b32 v17,10,v7
v_bfe_u32 v7,v0,2,2
v_lshl_add_u32 v17,v7,8,v17
v_add_u32 v6,v6,v7
v_and_b32 v6,3,v6
v_lshl_add_u32 v17,v6,6,v17
v_and_b32 v6,3,v0
v_lshl_add_u32 v17,v6,4,v17
v_add_u32 v19,46080,v17
v_lshrrev_b32 v6,5,v0
v_add_u32 v6,2,v6
v_bfe_u32 v7,v0,4,1
v_lshlrev_b32 v21,10,v7
v_lshl_add_u32 v21,v6,8,v21
v_and_b32 v6,15,v0
v_lshl_add_u32 v21,v6,4,v21
s_mov_b32 s69,s56
s_mov_b32 s70,99614720
s_mov_b32 s71,196608
s_lshl_b32 s60,s69,12
s_add_u32 s70,s70,s60
v_lshrrev_b32 v6,5,v0
v_mul_u32_u24 v188,2560,v6
v_and_b32 v6,31,v0
v_lshl_add_u32 v188,v6,3,v188
v_add_u32 v188,0xa000,v188
v_min_u32 v4,7,v0
v_lshlrev_b32 v4,2,v4
v_min_u32 v2,39,v0
v_lshlrev_b32 v2,2,v2
v_mov_b32 v12,93184
s_lshl_b32 s60,s46,8
s_add_u32 s60,s60,92160
v_and_b32 v6,31,v0
v_lshlrev_b32 v190,3,v6
v_add_u32 v190,s60,v190
v_lshrrev_b32 v6,5,v0
v_lshlrev_b32 v191,5,v6
v_add_u32 v191,s60,v191
s_waitcnt vmcnt(0)
s_barrier
s_cmp_lg_u32 s46,0
s_cbranch_scc1 arr_222
v_mov_b32 v6,1
s_lshl_b32 s3,s49,2
v_mov_b32 v7,s3
s_mov_b64 exec,1
buffer_atomic_add v6,v7,s[12:15],0 offen sc1
s_mov_b64 exec,-1
arr_222:
s_lshl_b32 s58,s69,7
v_mov_b32 v24,0x3f803f80
v_mov_b32 v25,0x3f803f80
v_mov_b32 v26,0x3f803f80
v_mov_b32 v27,0x3f803f80
s_mul_i32 s63,s46,40960
s_mov_b32 s4,s24
s_mov_b32 s5,s25
s_mov_b32 s6,7864320
s_mov_b32 s7,0x20000
v_lshrrev_b32 v9,3,v0
s_mov_b32 s64,12288
v_mul_lo_u32 v9,v9,s64
v_and_b32 v10,7,v0
v_lshl_add_u32 v6,v10,4,v9
s_add_u32 m0,s63,0
s_add_u32 s65,s58,0
buffer_load_dwordx4 v6,s[4:7],s65 offen lds
s_add_u32 m0,s63,1024
s_add_u32 s65,s58,98304
buffer_load_dwordx4 v6,s[4:7],s65 offen lds
s_add_u32 m0,s63,2048
s_add_u32 s65,s58,196608
buffer_load_dwordx4 v6,s[4:7],s65 offen lds
s_add_u32 m0,s63,3072
s_add_u32 s65,s58,294912
buffer_load_dwordx4 v6,s[4:7],s65 offen lds
s_add_u32 m0,s63,4096
s_add_u32 s65,s58,393216
buffer_load_dwordx4 v6,s[4:7],s65 offen lds
s_add_u32 m0,s63,5120
s_add_u32 s65,s58,491520
buffer_load_dwordx4 v6,s[4:7],s65 offen lds
s_add_u32 m0,s63,6144
s_add_u32 s65,s58,589824
buffer_load_dwordx4 v6,s[4:7],s65 offen lds
s_add_u32 m0,s63,7168
s_add_u32 s65,s58,688128
buffer_load_dwordx4 v6,s[4:7],s65 offen lds
s_add_u32 m0,s63,8192
s_add_u32 s65,s58,786432
buffer_load_dwordx4 v6,s[4:7],s65 offen lds
s_add_u32 m0,s63,9216
s_add_u32 s65,s58,884736
buffer_load_dwordx4 v6,s[4:7],s65 offen lds
s_add_u32 m0,s63,10240
s_add_u32 s65,s58,983040
buffer_load_dwordx4 v6,s[4:7],s65 offen lds
s_add_u32 m0,s63,11264
s_add_u32 s65,s58,1081344
buffer_load_dwordx4 v6,s[4:7],s65 offen lds
s_add_u32 m0,s63,12288
s_add_u32 s65,s58,1179648
buffer_load_dwordx4 v6,s[4:7],s65 offen lds
s_add_u32 m0,s63,13312
s_add_u32 s65,s58,1277952
buffer_load_dwordx4 v6,s[4:7],s65 offen lds
s_add_u32 m0,s63,14336
s_add_u32 s65,s58,1376256
buffer_load_dwordx4 v6,s[4:7],s65 offen lds
s_add_u32 m0,s63,15360
s_add_u32 s65,s58,1474560
buffer_load_dwordx4 v6,s[4:7],s65 offen lds
s_add_u32 m0,s63,16384
s_add_u32 s65,s58,1572864
buffer_load_dwordx4 v6,s[4:7],s65 offen lds
s_add_u32 m0,s63,17408
s_add_u32 s65,s58,1671168
buffer_load_dwordx4 v6,s[4:7],s65 offen lds
s_add_u32 m0,s63,18432
s_add_u32 s65,s58,1769472
buffer_load_dwordx4 v6,s[4:7],s65 offen lds
s_add_u32 m0,s63,19456
s_add_u32 s65,s58,1867776
buffer_load_dwordx4 v6,s[4:7],s65 offen lds
s_add_u32 m0,s63,20480
s_add_u32 s65,s58,1966080
buffer_load_dwordx4 v6,s[4:7],s65 offen lds
s_add_u32 m0,s63,21504
s_add_u32 s65,s58,2064384
buffer_load_dwordx4 v6,s[4:7],s65 offen lds
s_add_u32 m0,s63,22528
s_add_u32 s65,s58,2162688
buffer_load_dwordx4 v6,s[4:7],s65 offen lds
s_add_u32 m0,s63,23552
s_add_u32 s65,s58,2260992
buffer_load_dwordx4 v6,s[4:7],s65 offen lds
s_add_u32 m0,s63,24576
s_add_u32 s65,s58,2359296
buffer_load_dwordx4 v6,s[4:7],s65 offen lds
s_add_u32 m0,s63,25600
s_add_u32 s65,s58,2457600
buffer_load_dwordx4 v6,s[4:7],s65 offen lds
s_add_u32 m0,s63,26624
s_add_u32 s65,s58,2555904
buffer_load_dwordx4 v6,s[4:7],s65 offen lds
s_add_u32 m0,s63,27648
s_add_u32 s65,s58,2654208
buffer_load_dwordx4 v6,s[4:7],s65 offen lds
s_add_u32 m0,s63,28672
s_add_u32 s65,s58,2752512
buffer_load_dwordx4 v6,s[4:7],s65 offen lds
s_add_u32 m0,s63,29696
s_add_u32 s65,s58,2850816
buffer_load_dwordx4 v6,s[4:7],s65 offen lds
s_add_u32 m0,s63,30720
s_add_u32 s65,s58,2949120
buffer_load_dwordx4 v6,s[4:7],s65 offen lds
s_add_u32 m0,s63,31744
s_add_u32 s65,s58,3047424
buffer_load_dwordx4 v6,s[4:7],s65 offen lds
s_add_u32 m0,s63,32768
s_add_u32 s65,s58,3145728
buffer_load_dwordx4 v6,s[4:7],s65 offen lds
s_add_u32 m0,s63,33792
s_add_u32 s65,s58,3244032
buffer_load_dwordx4 v6,s[4:7],s65 offen lds
s_add_u32 m0,s63,34816
s_add_u32 s65,s58,3342336
buffer_load_dwordx4 v6,s[4:7],s65 offen lds
s_add_u32 m0,s63,35840
s_add_u32 s65,s58,3440640
buffer_load_dwordx4 v6,s[4:7],s65 offen lds
s_add_u32 m0,s63,36864
s_add_u32 s65,s58,3538944
buffer_load_dwordx4 v6,s[4:7],s65 offen lds
s_add_u32 m0,s63,37888
s_add_u32 s65,s58,3637248
buffer_load_dwordx4 v6,s[4:7],s65 offen lds
s_add_u32 m0,s63,38912
s_add_u32 s65,s58,3735552
buffer_load_dwordx4 v6,s[4:7],s65 offen lds
s_add_u32 m0,s63,39936
s_add_u32 s65,s58,3833856
buffer_load_dwordx4 v6,s[4:7],s65 offen lds
s_waitcnt vmcnt(20)
v_bfe_u32 v9,v0,2,2
v_lshrrev_b32 v10,5,v0
v_lshl_add_u32 v9,v10,2,v9
v_mul_u32_u24 v9,128,v9
v_and_b32 v10,1,v0
v_lshl_add_u32 v9,v10,3,v9
v_bfe_u32 v10,v0,1,1
v_lshl_add_u32 v9,v10,4,v9
v_bfe_u32 v10,v0,4,1
v_lshl_add_u32 v9,v10,5,v9
v_add_u32 v7,s63,v9
ds_read_b64_tr_b16 a[0:1],v7 offset:0
ds_read_b64_tr_b16 a[2:3],v7 offset:2048
ds_read_b64_tr_b16 a[4:5],v7 offset:1024
ds_read_b64_tr_b16 a[6:7],v7 offset:3072
ds_read_b64_tr_b16 a[160:161],v7 offset:64
ds_read_b64_tr_b16 a[162:163],v7 offset:2112
ds_read_b64_tr_b16 a[164:165],v7 offset:1088
ds_read_b64_tr_b16 a[166:167],v7 offset:3136
ds_read_b64_tr_b16 a[8:9],v7 offset:4096
ds_read_b64_tr_b16 a[10:11],v7 offset:6144
ds_read_b64_tr_b16 a[12:13],v7 offset:5120
ds_read_b64_tr_b16 a[14:15],v7 offset:7168
s_waitcnt lgkmcnt(4)
ds_read_b64_tr_b16 a[168:169],v7 offset:4160
ds_read_b64_tr_b16 a[170:171],v7 offset:6208
ds_read_b64_tr_b16 a[172:173],v7 offset:5184
ds_read_b64_tr_b16 a[174:175],v7 offset:7232
ds_read_b64_tr_b16 a[16:17],v7 offset:8192
ds_read_b64_tr_b16 a[18:19],v7 offset:10240
ds_read_b64_tr_b16 a[20:21],v7 offset:9216
ds_read_b64_tr_b16 a[22:23],v7 offset:11264
ds_read_b64_tr_b16 a[176:177],v7 offset:8256
ds_read_b64_tr_b16 a[178:179],v7 offset:10304
ds_read_b64_tr_b16 a[180:181],v7 offset:9280
ds_read_b64_tr_b16 a[182:183],v7 offset:11328
s_waitcnt lgkmcnt(4)
ds_read_b64_tr_b16 a[24:25],v7 offset:12288
ds_read_b64_tr_b16 a[26:27],v7 offset:14336
ds_read_b64_tr_b16 a[28:29],v7 offset:13312
ds_read_b64_tr_b16 a[30:31],v7 offset:15360
ds_read_b64_tr_b16 a[184:185],v7 offset:12352
ds_read_b64_tr_b16 a[186:187],v7 offset:14400
ds_read_b64_tr_b16 a[188:189],v7 offset:13376
ds_read_b64_tr_b16 a[190:191],v7 offset:15424
ds_read_b64_tr_b16 a[32:33],v7 offset:16384
ds_read_b64_tr_b16 a[34:35],v7 offset:18432
ds_read_b64_tr_b16 a[36:37],v7 offset:17408
ds_read_b64_tr_b16 a[38:39],v7 offset:19456
s_waitcnt lgkmcnt(4)
ds_read_b64_tr_b16 a[192:193],v7 offset:16448
ds_read_b64_tr_b16 a[194:195],v7 offset:18496
ds_read_b64_tr_b16 a[196:197],v7 offset:17472
ds_read_b64_tr_b16 a[198:199],v7 offset:19520
s_waitcnt lgkmcnt(0)
s_add_u32 m0,s63,0
s_add_u32 s65,s58,3932160
buffer_load_dwordx4 v6,s[4:7],s65 offen lds
s_add_u32 m0,s63,1024
s_add_u32 s65,s58,4030464
buffer_load_dwordx4 v6,s[4:7],s65 offen lds
s_add_u32 m0,s63,2048
s_add_u32 s65,s58,4128768
buffer_load_dwordx4 v6,s[4:7],s65 offen lds
s_add_u32 m0,s63,3072
s_add_u32 s65,s58,4227072
buffer_load_dwordx4 v6,s[4:7],s65 offen lds
s_add_u32 m0,s63,4096
s_add_u32 s65,s58,4325376
buffer_load_dwordx4 v6,s[4:7],s65 offen lds
s_add_u32 m0,s63,5120
s_add_u32 s65,s58,4423680
buffer_load_dwordx4 v6,s[4:7],s65 offen lds
s_add_u32 m0,s63,6144
s_add_u32 s65,s58,4521984
buffer_load_dwordx4 v6,s[4:7],s65 offen lds
s_add_u32 m0,s63,7168
s_add_u32 s65,s58,4620288
buffer_load_dwordx4 v6,s[4:7],s65 offen lds
s_add_u32 m0,s63,8192
s_add_u32 s65,s58,4718592
buffer_load_dwordx4 v6,s[4:7],s65 offen lds
s_add_u32 m0,s63,9216
s_add_u32 s65,s58,4816896
buffer_load_dwordx4 v6,s[4:7],s65 offen lds
s_add_u32 m0,s63,10240
s_add_u32 s65,s58,4915200
buffer_load_dwordx4 v6,s[4:7],s65 offen lds
s_add_u32 m0,s63,11264
s_add_u32 s65,s58,5013504
buffer_load_dwordx4 v6,s[4:7],s65 offen lds
s_add_u32 m0,s63,12288
s_add_u32 s65,s58,5111808
buffer_load_dwordx4 v6,s[4:7],s65 offen lds
s_add_u32 m0,s63,13312
s_add_u32 s65,s58,5210112
buffer_load_dwordx4 v6,s[4:7],s65 offen lds
s_add_u32 m0,s63,14336
s_add_u32 s65,s58,5308416
buffer_load_dwordx4 v6,s[4:7],s65 offen lds
s_add_u32 m0,s63,15360
s_add_u32 s65,s58,5406720
buffer_load_dwordx4 v6,s[4:7],s65 offen lds
s_add_u32 m0,s63,16384
s_add_u32 s65,s58,5505024
buffer_load_dwordx4 v6,s[4:7],s65 offen lds
s_add_u32 m0,s63,17408
s_add_u32 s65,s58,5603328
buffer_load_dwordx4 v6,s[4:7],s65 offen lds
s_add_u32 m0,s63,18432
s_add_u32 s65,s58,5701632
buffer_load_dwordx4 v6,s[4:7],s65 offen lds
s_add_u32 m0,s63,19456
s_add_u32 s65,s58,5799936
buffer_load_dwordx4 v6,s[4:7],s65 offen lds
v_mfma_f32_32x32x16_bf16 v[56:71],v[24:27],a[0:3],0
v_mfma_f32_32x32x16_bf16 v[72:87],v[24:27],a[160:163],0
v_mfma_f32_32x32x16_bf16 v[56:71],v[24:27],a[4:7],v[56:71]
v_mfma_f32_32x32x16_bf16 v[72:87],v[24:27],a[164:167],v[72:87]
v_mfma_f32_32x32x16_bf16 v[56:71],v[24:27],a[8:11],v[56:71]
v_mfma_f32_32x32x16_bf16 v[72:87],v[24:27],a[168:171],v[72:87]
v_mfma_f32_32x32x16_bf16 v[56:71],v[24:27],a[12:15],v[56:71]
v_mfma_f32_32x32x16_bf16 v[72:87],v[24:27],a[172:175],v[72:87]
v_mfma_f32_32x32x16_bf16 v[56:71],v[24:27],a[16:19],v[56:71]
v_mfma_f32_32x32x16_bf16 v[72:87],v[24:27],a[176:179],v[72:87]
v_mfma_f32_32x32x16_bf16 v[56:71],v[24:27],a[20:23],v[56:71]
v_mfma_f32_32x32x16_bf16 v[72:87],v[24:27],a[180:183],v[72:87]
v_mfma_f32_32x32x16_bf16 v[56:71],v[24:27],a[24:27],v[56:71]
v_mfma_f32_32x32x16_bf16 v[72:87],v[24:27],a[184:187],v[72:87]
v_mfma_f32_32x32x16_bf16 v[56:71],v[24:27],a[28:31],v[56:71]
v_mfma_f32_32x32x16_bf16 v[72:87],v[24:27],a[188:191],v[72:87]
v_mfma_f32_32x32x16_bf16 v[56:71],v[24:27],a[32:35],v[56:71]
v_mfma_f32_32x32x16_bf16 v[72:87],v[24:27],a[192:195],v[72:87]
v_mfma_f32_32x32x16_bf16 v[56:71],v[24:27],a[36:39],v[56:71]
v_mfma_f32_32x32x16_bf16 v[72:87],v[24:27],a[196:199],v[72:87]
s_waitcnt vmcnt(20)
v_bfe_u32 v9,v0,2,2
v_lshrrev_b32 v10,5,v0
v_lshl_add_u32 v9,v10,2,v9
v_mul_u32_u24 v9,128,v9
v_and_b32 v10,1,v0
v_lshl_add_u32 v9,v10,3,v9
v_bfe_u32 v10,v0,1,1
v_lshl_add_u32 v9,v10,4,v9
v_bfe_u32 v10,v0,4,1
v_lshl_add_u32 v9,v10,5,v9
v_add_u32 v7,s63,v9
ds_read_b64_tr_b16 a[40:41],v7 offset:20480
ds_read_b64_tr_b16 a[42:43],v7 offset:22528
ds_read_b64_tr_b16 a[44:45],v7 offset:21504
ds_read_b64_tr_b16 a[46:47],v7 offset:23552
ds_read_b64_tr_b16 a[200:201],v7 offset:20544
ds_read_b64_tr_b16 a[202:203],v7 offset:22592
ds_read_b64_tr_b16 a[204:205],v7 offset:21568
ds_read_b64_tr_b16 a[206:207],v7 offset:23616
ds_read_b64_tr_b16 a[48:49],v7 offset:24576
ds_read_b64_tr_b16 a[50:51],v7 offset:26624
ds_read_b64_tr_b16 a[52:53],v7 offset:25600
ds_read_b64_tr_b16 a[54:55],v7 offset:27648
s_waitcnt lgkmcnt(4)
ds_read_b64_tr_b16 a[208:209],v7 offset:24640
ds_read_b64_tr_b16 a[210:211],v7 offset:26688
ds_read_b64_tr_b16 a[212:213],v7 offset:25664
ds_read_b64_tr_b16 a[214:215],v7 offset:27712
ds_read_b64_tr_b16 a[56:57],v7 offset:28672
ds_read_b64_tr_b16 a[58:59],v7 offset:30720
ds_read_b64_tr_b16 a[60:61],v7 offset:29696
ds_read_b64_tr_b16 a[62:63],v7 offset:31744
ds_read_b64_tr_b16 a[216:217],v7 offset:28736
ds_read_b64_tr_b16 a[218:219],v7 offset:30784
ds_read_b64_tr_b16 a[220:221],v7 offset:29760
ds_read_b64_tr_b16 a[222:223],v7 offset:31808
s_waitcnt lgkmcnt(4)
ds_read_b64_tr_b16 a[64:65],v7 offset:32768
ds_read_b64_tr_b16 a[66:67],v7 offset:34816
ds_read_b64_tr_b16 a[68:69],v7 offset:33792
ds_read_b64_tr_b16 a[70:71],v7 offset:35840
ds_read_b64_tr_b16 a[224:225],v7 offset:32832
ds_read_b64_tr_b16 a[226:227],v7 offset:34880
ds_read_b64_tr_b16 a[228:229],v7 offset:33856
ds_read_b64_tr_b16 a[230:231],v7 offset:35904
ds_read_b64_tr_b16 a[72:73],v7 offset:36864
ds_read_b64_tr_b16 a[74:75],v7 offset:38912
ds_read_b64_tr_b16 a[76:77],v7 offset:37888
ds_read_b64_tr_b16 a[78:79],v7 offset:39936
s_waitcnt lgkmcnt(4)
ds_read_b64_tr_b16 a[232:233],v7 offset:36928
ds_read_b64_tr_b16 a[234:235],v7 offset:38976
ds_read_b64_tr_b16 a[236:237],v7 offset:37952
ds_read_b64_tr_b16 a[238:239],v7 offset:40000
s_waitcnt lgkmcnt(0)
s_add_u32 m0,s63,20480
s_add_u32 s65,s58,5898240
buffer_load_dwordx4 v6,s[4:7],s65 offen lds
s_add_u32 m0,s63,21504
s_add_u32 s65,s58,5996544
buffer_load_dwordx4 v6,s[4:7],s65 offen lds
s_add_u32 m0,s63,22528
s_add_u32 s65,s58,6094848
buffer_load_dwordx4 v6,s[4:7],s65 offen lds
s_add_u32 m0,s63,23552
s_add_u32 s65,s58,6193152
buffer_load_dwordx4 v6,s[4:7],s65 offen lds
s_add_u32 m0,s63,24576
s_add_u32 s65,s58,6291456
buffer_load_dwordx4 v6,s[4:7],s65 offen lds
s_add_u32 m0,s63,25600
s_add_u32 s65,s58,6389760
buffer_load_dwordx4 v6,s[4:7],s65 offen lds
s_add_u32 m0,s63,26624
s_add_u32 s65,s58,6488064
buffer_load_dwordx4 v6,s[4:7],s65 offen lds
s_add_u32 m0,s63,27648
s_add_u32 s65,s58,6586368
buffer_load_dwordx4 v6,s[4:7],s65 offen lds
s_add_u32 m0,s63,28672
s_add_u32 s65,s58,6684672
buffer_load_dwordx4 v6,s[4:7],s65 offen lds
s_add_u32 m0,s63,29696
s_add_u32 s65,s58,6782976
buffer_load_dwordx4 v6,s[4:7],s65 offen lds
s_add_u32 m0,s63,30720
s_add_u32 s65,s58,6881280
buffer_load_dwordx4 v6,s[4:7],s65 offen lds
s_add_u32 m0,s63,31744
s_add_u32 s65,s58,6979584
buffer_load_dwordx4 v6,s[4:7],s65 offen lds
s_add_u32 m0,s63,32768
s_add_u32 s65,s58,7077888
buffer_load_dwordx4 v6,s[4:7],s65 offen lds
s_add_u32 m0,s63,33792
s_add_u32 s65,s58,7176192
buffer_load_dwordx4 v6,s[4:7],s65 offen lds
s_add_u32 m0,s63,34816
s_add_u32 s65,s58,7274496
buffer_load_dwordx4 v6,s[4:7],s65 offen lds
s_add_u32 m0,s63,35840
s_add_u32 s65,s58,7372800
buffer_load_dwordx4 v6,s[4:7],s65 offen lds
s_add_u32 m0,s63,36864
s_add_u32 s65,s58,7471104
buffer_load_dwordx4 v6,s[4:7],s65 offen lds
s_add_u32 m0,s63,37888
s_add_u32 s65,s58,7569408
buffer_load_dwordx4 v6,s[4:7],s65 offen lds
s_add_u32 m0,s63,38912
s_add_u32 s65,s58,7667712
buffer_load_dwordx4 v6,s[4:7],s65 offen lds
s_add_u32 m0,s63,39936
s_add_u32 s65,s58,7766016
buffer_load_dwordx4 v6,s[4:7],s65 offen lds
v_mfma_f32_32x32x16_bf16 v[56:71],v[24:27],a[40:43],v[56:71]
v_mfma_f32_32x32x16_bf16 v[72:87],v[24:27],a[200:203],v[72:87]
v_mfma_f32_32x32x16_bf16 v[56:71],v[24:27],a[44:47],v[56:71]
v_mfma_f32_32x32x16_bf16 v[72:87],v[24:27],a[204:207],v[72:87]
v_mfma_f32_32x32x16_bf16 v[56:71],v[24:27],a[48:51],v[56:71]
v_mfma_f32_32x32x16_bf16 v[72:87],v[24:27],a[208:211],v[72:87]
v_mfma_f32_32x32x16_bf16 v[56:71],v[24:27],a[52:55],v[56:71]
v_mfma_f32_32x32x16_bf16 v[72:87],v[24:27],a[212:215],v[72:87]
v_mfma_f32_32x32x16_bf16 v[56:71],v[24:27],a[56:59],v[56:71]
v_mfma_f32_32x32x16_bf16 v[72:87],v[24:27],a[216:219],v[72:87]
v_mfma_f32_32x32x16_bf16 v[56:71],v[24:27],a[60:63],v[56:71]
v_mfma_f32_32x32x16_bf16 v[72:87],v[24:27],a[220:223],v[72:87]
v_mfma_f32_32x32x16_bf16 v[56:71],v[24:27],a[64:67],v[56:71]
v_mfma_f32_32x32x16_bf16 v[72:87],v[24:27],a[224:227],v[72:87]
v_mfma_f32_32x32x16_bf16 v[56:71],v[24:27],a[68:71],v[56:71]
v_mfma_f32_32x32x16_bf16 v[72:87],v[24:27],a[228:231],v[72:87]
v_mfma_f32_32x32x16_bf16 v[56:71],v[24:27],a[72:75],v[56:71]
v_mfma_f32_32x32x16_bf16 v[72:87],v[24:27],a[232:235],v[72:87]
v_mfma_f32_32x32x16_bf16 v[56:71],v[24:27],a[76:79],v[56:71]
v_mfma_f32_32x32x16_bf16 v[72:87],v[24:27],a[236:239],v[72:87]
s_waitcnt vmcnt(20)
v_bfe_u32 v9,v0,2,2
v_lshrrev_b32 v10,5,v0
v_lshl_add_u32 v9,v10,2,v9
v_mul_u32_u24 v9,128,v9
v_and_b32 v10,1,v0
v_lshl_add_u32 v9,v10,3,v9
v_bfe_u32 v10,v0,1,1
v_lshl_add_u32 v9,v10,4,v9
v_bfe_u32 v10,v0,4,1
v_lshl_add_u32 v9,v10,5,v9
v_add_u32 v7,s63,v9
ds_read_b64_tr_b16 a[80:81],v7 offset:0
ds_read_b64_tr_b16 a[82:83],v7 offset:2048
ds_read_b64_tr_b16 a[84:85],v7 offset:1024
ds_read_b64_tr_b16 a[86:87],v7 offset:3072
ds_read_b64_tr_b16 a[240:241],v7 offset:64
ds_read_b64_tr_b16 a[242:243],v7 offset:2112
ds_read_b64_tr_b16 a[244:245],v7 offset:1088
ds_read_b64_tr_b16 a[246:247],v7 offset:3136
ds_read_b64_tr_b16 a[88:89],v7 offset:4096
ds_read_b64_tr_b16 a[90:91],v7 offset:6144
ds_read_b64_tr_b16 a[92:93],v7 offset:5120
ds_read_b64_tr_b16 a[94:95],v7 offset:7168
s_waitcnt lgkmcnt(4)
ds_read_b64_tr_b16 a[248:249],v7 offset:4160
ds_read_b64_tr_b16 a[250:251],v7 offset:6208
ds_read_b64_tr_b16 a[252:253],v7 offset:5184
ds_read_b64_tr_b16 a[254:255],v7 offset:7232
ds_read_b64_tr_b16 a[96:97],v7 offset:8192
ds_read_b64_tr_b16 a[98:99],v7 offset:10240
ds_read_b64_tr_b16 a[100:101],v7 offset:9216
ds_read_b64_tr_b16 a[102:103],v7 offset:11264
ds_read_b64_tr_b16 v[192:193],v7 offset:8256
ds_read_b64_tr_b16 v[194:195],v7 offset:10304
ds_read_b64_tr_b16 v[196:197],v7 offset:9280
ds_read_b64_tr_b16 v[198:199],v7 offset:11328
s_waitcnt lgkmcnt(4)
ds_read_b64_tr_b16 a[104:105],v7 offset:12288
ds_read_b64_tr_b16 a[106:107],v7 offset:14336
ds_read_b64_tr_b16 a[108:109],v7 offset:13312
ds_read_b64_tr_b16 a[110:111],v7 offset:15360
ds_read_b64_tr_b16 v[200:201],v7 offset:12352
ds_read_b64_tr_b16 v[202:203],v7 offset:14400
ds_read_b64_tr_b16 v[204:205],v7 offset:13376
ds_read_b64_tr_b16 v[206:207],v7 offset:15424
ds_read_b64_tr_b16 a[112:113],v7 offset:16384
ds_read_b64_tr_b16 a[114:115],v7 offset:18432
ds_read_b64_tr_b16 a[116:117],v7 offset:17408
ds_read_b64_tr_b16 a[118:119],v7 offset:19456
s_waitcnt lgkmcnt(4)
ds_read_b64_tr_b16 v[208:209],v7 offset:16448
ds_read_b64_tr_b16 v[210:211],v7 offset:18496
ds_read_b64_tr_b16 v[212:213],v7 offset:17472
ds_read_b64_tr_b16 v[214:215],v7 offset:19520
s_waitcnt lgkmcnt(0)
v_mfma_f32_32x32x16_bf16 v[56:71],v[24:27],a[80:83],v[56:71]
v_mfma_f32_32x32x16_bf16 v[72:87],v[24:27],a[240:243],v[72:87]
v_mfma_f32_32x32x16_bf16 v[56:71],v[24:27],a[84:87],v[56:71]
v_mfma_f32_32x32x16_bf16 v[72:87],v[24:27],a[244:247],v[72:87]
v_mfma_f32_32x32x16_bf16 v[56:71],v[24:27],a[88:91],v[56:71]
v_mfma_f32_32x32x16_bf16 v[72:87],v[24:27],a[248:251],v[72:87]
v_mfma_f32_32x32x16_bf16 v[56:71],v[24:27],a[92:95],v[56:71]
v_mfma_f32_32x32x16_bf16 v[72:87],v[24:27],a[252:255],v[72:87]
v_mfma_f32_32x32x16_bf16 v[56:71],v[24:27],a[96:99],v[56:71]
v_mfma_f32_32x32x16_bf16 v[72:87],v[24:27],v[192:195],v[72:87]
v_mfma_f32_32x32x16_bf16 v[56:71],v[24:27],a[100:103],v[56:71]
v_mfma_f32_32x32x16_bf16 v[72:87],v[24:27],v[196:199],v[72:87]
v_mfma_f32_32x32x16_bf16 v[56:71],v[24:27],a[104:107],v[56:71]
v_mfma_f32_32x32x16_bf16 v[72:87],v[24:27],v[200:203],v[72:87]
v_mfma_f32_32x32x16_bf16 v[56:71],v[24:27],a[108:111],v[56:71]
v_mfma_f32_32x32x16_bf16 v[72:87],v[24:27],v[204:207],v[72:87]
v_mfma_f32_32x32x16_bf16 v[56:71],v[24:27],a[112:115],v[56:71]
v_mfma_f32_32x32x16_bf16 v[72:87],v[24:27],v[208:211],v[72:87]
v_mfma_f32_32x32x16_bf16 v[56:71],v[24:27],a[116:119],v[56:71]
v_mfma_f32_32x32x16_bf16 v[72:87],v[24:27],v[212:215],v[72:87]
s_waitcnt vmcnt(0)
v_bfe_u32 v9,v0,2,2
v_lshrrev_b32 v10,5,v0
v_lshl_add_u32 v9,v10,2,v9
v_mul_u32_u24 v9,128,v9
v_and_b32 v10,1,v0
v_lshl_add_u32 v9,v10,3,v9
v_bfe_u32 v10,v0,1,1
v_lshl_add_u32 v9,v10,4,v9
v_bfe_u32 v10,v0,4,1
v_lshl_add_u32 v9,v10,5,v9
v_add_u32 v7,s63,v9
ds_read_b64_tr_b16 a[120:121],v7 offset:20480
ds_read_b64_tr_b16 a[122:123],v7 offset:22528
ds_read_b64_tr_b16 a[124:125],v7 offset:21504
ds_read_b64_tr_b16 a[126:127],v7 offset:23552
ds_read_b64_tr_b16 v[216:217],v7 offset:20544
ds_read_b64_tr_b16 v[218:219],v7 offset:22592
ds_read_b64_tr_b16 v[220:221],v7 offset:21568
ds_read_b64_tr_b16 v[222:223],v7 offset:23616
ds_read_b64_tr_b16 a[128:129],v7 offset:24576
ds_read_b64_tr_b16 a[130:131],v7 offset:26624
ds_read_b64_tr_b16 a[132:133],v7 offset:25600
ds_read_b64_tr_b16 a[134:135],v7 offset:27648
s_waitcnt lgkmcnt(4)
ds_read_b64_tr_b16 v[224:225],v7 offset:24640
ds_read_b64_tr_b16 v[226:227],v7 offset:26688
ds_read_b64_tr_b16 v[228:229],v7 offset:25664
ds_read_b64_tr_b16 v[230:231],v7 offset:27712
ds_read_b64_tr_b16 a[136:137],v7 offset:28672
ds_read_b64_tr_b16 a[138:139],v7 offset:30720
ds_read_b64_tr_b16 a[140:141],v7 offset:29696
ds_read_b64_tr_b16 a[142:143],v7 offset:31744
ds_read_b64_tr_b16 v[232:233],v7 offset:28736
ds_read_b64_tr_b16 v[234:235],v7 offset:30784
ds_read_b64_tr_b16 v[236:237],v7 offset:29760
ds_read_b64_tr_b16 v[238:239],v7 offset:31808
s_waitcnt lgkmcnt(4)
ds_read_b64_tr_b16 a[144:145],v7 offset:32768
ds_read_b64_tr_b16 a[146:147],v7 offset:34816
ds_read_b64_tr_b16 a[148:149],v7 offset:33792
ds_read_b64_tr_b16 a[150:151],v7 offset:35840
ds_read_b64_tr_b16 v[240:241],v7 offset:32832
ds_read_b64_tr_b16 v[242:243],v7 offset:34880
ds_read_b64_tr_b16 v[244:245],v7 offset:33856
ds_read_b64_tr_b16 v[246:247],v7 offset:35904
ds_read_b64_tr_b16 a[152:153],v7 offset:36864
ds_read_b64_tr_b16 a[154:155],v7 offset:38912
ds_read_b64_tr_b16 a[156:157],v7 offset:37888
ds_read_b64_tr_b16 a[158:159],v7 offset:39936
s_waitcnt lgkmcnt(4)
ds_read_b64_tr_b16 v[248:249],v7 offset:36928
ds_read_b64_tr_b16 v[250:251],v7 offset:38976
ds_read_b64_tr_b16 v[252:253],v7 offset:37952
ds_read_b64_tr_b16 v[254:255],v7 offset:40000
s_waitcnt lgkmcnt(0)
v_mfma_f32_32x32x16_bf16 v[56:71],v[24:27],a[120:123],v[56:71]
v_mfma_f32_32x32x16_bf16 v[72:87],v[24:27],v[216:219],v[72:87]
v_mfma_f32_32x32x16_bf16 v[56:71],v[24:27],a[124:127],v[56:71]
v_mfma_f32_32x32x16_bf16 v[72:87],v[24:27],v[220:223],v[72:87]
v_mfma_f32_32x32x16_bf16 v[56:71],v[24:27],a[128:131],v[56:71]
v_mfma_f32_32x32x16_bf16 v[72:87],v[24:27],v[224:227],v[72:87]
v_mfma_f32_32x32x16_bf16 v[56:71],v[24:27],a[132:135],v[56:71]
v_mfma_f32_32x32x16_bf16 v[72:87],v[24:27],v[228:231],v[72:87]
v_mfma_f32_32x32x16_bf16 v[56:71],v[24:27],a[136:139],v[56:71]
v_mfma_f32_32x32x16_bf16 v[72:87],v[24:27],v[232:235],v[72:87]
v_mfma_f32_32x32x16_bf16 v[56:71],v[24:27],a[140:143],v[56:71]
v_mfma_f32_32x32x16_bf16 v[72:87],v[24:27],v[236:239],v[72:87]
v_mfma_f32_32x32x16_bf16 v[56:71],v[24:27],a[144:147],v[56:71]
v_mfma_f32_32x32x16_bf16 v[72:87],v[24:27],v[240:243],v[72:87]
v_mfma_f32_32x32x16_bf16 v[56:71],v[24:27],a[148:151],v[56:71]
v_mfma_f32_32x32x16_bf16 v[72:87],v[24:27],v[244:247],v[72:87]
v_mfma_f32_32x32x16_bf16 v[56:71],v[24:27],a[152:155],v[56:71]
v_mfma_f32_32x32x16_bf16 v[72:87],v[24:27],v[248:251],v[72:87]
v_mfma_f32_32x32x16_bf16 v[56:71],v[24:27],a[156:159],v[56:71]
v_mfma_f32_32x32x16_bf16 v[72:87],v[24:27],v[252:255],v[72:87]
s_nop 4
v_mov_b32 v120,v56
s_nop 5
v_mov_b32 v121,v72
s_barrier
s_lshl_b32 s3,s49,2
v_mov_b32 v7,s3
s_nop 1
ibw_223:
buffer_load_dword v6,v7,s[12:15],0 offen sc1
s_waitcnt vmcnt(0)
v_cmp_ne_u32 vcc,256,v6
s_nop 0
s_cbranch_vccz ok_224
s_sleep 8
s_sub_u32 s47,s47,1
s_cbranch_scc1 ABORT
s_branch ibw_223
ok_224:
s_cmp_lg_u32 s49,0
s_cbranch_scc1 ibok_225
v_and_b32 v7,7,v0
v_lshlrev_b32 v7,2,v7
buffer_load_dword v6,v7,s[12:15],0 offen offset:32 sc1
s_waitcnt vmcnt(0)
v_cmp_ne_u32 vcc,32,v6
s_nop 0
s_cbranch_vccz ibok_225
s_barrier
s_mov_b32 s49,1
s_mov_b32 s3,s2
s_load_dwordx16 s[16:31],s[0:1],0
s_load_dwordx8 s[32:39],s[0:1],64
s_waitcnt lgkmcnt(0)
s_branch DISPATCH
ibok_225:
s_mov_b32 s50,0
s_mov_b32 s32,0
s_mov_b32 s57,0
s_mov_b32 s59,2147483648
s_mov_b32 s82,2147483648
s_mov_b32 s39,2147483648
v_mov_b32 v22,94208
s_mov_b32 s72,0
s_mov_b32 s73,0
s_mov_b32 s78,0
s_mov_b32 s79,0
s_cmp_eq_u32 s46,0
s_cselect_b32 s40,0,2147483648
s_lshl_b32 s60,s46,3
v_add_u32 v13,s60,v22
s_mov_b32 s83,s100
s_lshl_b32 s41,s78,9
s_add_u32 s41,s41,s40
s_lshl_b32 s35,s79,9
s_add_u32 s35,s35,s40
s_add_u32 s35,s35,32768
s_branch QKVV_COLD0
QKVV_B0:
s_waitcnt lgkmcnt(3)
v_mfma_f32_32x32x16_bf16 v[56:71],v[24:27],a[0:3],0
ds_read_b128 v[44:47],v17 offset:4096
v_add_u32 v189,s57,v188
v_mfma_f32_32x32x16_bf16 v[72:87],v[24:27],a[160:163],0
v_add_u32 v8,0x800,v189
s_sub_u32 s66,46080,s57
s_lshl_b32 s60,s33,6
s_add_u32 s60,s60,s34
s_mul_i32 s60,s60,46080
s_add_u32 s60,s60,s37
v_mfma_f32_32x32x16_bf16 v[56:71],v[28:31],a[4:7],v[56:71]
ds_read_b128 v[48:51],v16 offset:6144
ds_read2_b64 v[156:159],v189 offset0:0 offset1:32
s_add_u32 s60,s60,206569472
v_mfma_f32_32x32x16_bf16 v[72:87],v[28:31],a[164:167],v[72:87]
ds_read2_b64 v[160:163],v189 offset0:64 offset1:96
s_cmp_eq_u32 s33,0
s_cselect_b32 s67,2147483648,s60
s_mul_i32 s61,s46,10240
s_waitcnt lgkmcnt(5)
v_mfma_f32_32x32x16_bf16 v[56:71],v[32:35],a[8:11],v[56:71]
ds_read_b128 v[52:55],v17 offset:6144
ds_read2_b64 v[164:167],v189 offset0:128 offset1:160
s_add_u32 s60,s60,s61
s_add_u32 s61,s61,s66
v_mfma_f32_32x32x16_bf16 v[72:87],v[32:35],a[168:171],v[72:87]
ds_read2_b64 v[168:171],v189 offset0:192 offset1:224
s_add_u32 m0,s61,0
s_add_u32 s63,s60,0
buffer_load_dwordx4 v1,s[8:11],s63 offen sc1 lds
v_mfma_f32_32x32x16_bf16 v[56:71],v[36:39],a[12:15],v[56:71]
ds_read_b128 v[24:27],v16 offset:8192
ds_read2_b64 v[172:175],v8 offset0:0 offset1:32
s_mul_i32 s74,s73,393216
s_add_u32 s74,s74,s39
v_mfma_f32_32x32x16_bf16 v[72:87],v[36:39],a[172:175],v[72:87]
s_add_u32 s74,s74,s70
v_fma_f32 v88,-v124,v120,v88
v_fma_f32 v89,-v126,v120,v89
v_fma_f32 v90,-v128,v120,v90
v_fma_f32 v91,-v130,v120,v91
s_waitcnt lgkmcnt(8)
v_mfma_f32_32x32x16_bf16 v[56:71],v[40:43],a[16:19],v[56:71]
ds_read_b128 v[28:31],v17 offset:8192
buffer_load_dwordx4 v1,s[8:11],s63 offen offset:1024 sc1 lds
v_fma_f32 v96,-v140,v120,v96
v_fma_f32 v97,-v142,v120,v97
v_mfma_f32_32x32x16_bf16 v[72:87],v[40:43],a[176:179],v[72:87]
v_fma_f32 v98,-v144,v120,v98
v_fma_f32 v99,-v146,v120,v99
v_mul_f32 v88,v88,v125
v_mul_f32 v89,v89,v127
v_mul_f32 v90,v90,v129
v_mfma_f32_32x32x16_bf16 v[56:71],v[44:47],a[20:23],v[56:71]
ds_read_b128 v[32:35],v16 offset:10240
s_mov_b32 s53,s33
s_mov_b32 s54,s34
s_add_u32 s79,s79,s33
s_or_b32 s65,s37,s33
v_mfma_f32_32x32x16_bf16 v[72:87],v[44:47],a[180:183],v[72:87]
buffer_load_dwordx4 v1,s[8:11],s63 offen offset:2048 sc1 lds
s_cmp_eq_u32 s65,0
s_addc_u32 s78,s78,0
s_lshl_b32 s41,s78,9
s_waitcnt lgkmcnt(6)
v_mfma_f32_32x32x16_bf16 v[56:71],v[48:51],a[24:27],v[56:71]
ds_read_b128 v[36:39],v17 offset:10240
s_add_u32 s41,s41,s40
s_lshl_b32 s35,s79,9
s_add_u32 s35,s35,s40
s_add_u32 s35,s35,32768
v_mfma_f32_32x32x16_bf16 v[72:87],v[48:51],a[184:187],v[72:87]
v_mul_f32 v91,v91,v131
v_mul_f32 v96,v96,v141
v_mul_f32 v97,v97,v143
v_mul_f32 v98,v98,v145
v_mul_f32 v99,v99,v147
v_mfma_f32_32x32x16_bf16 v[56:71],v[52:55],a[28:31],v[56:71]
ds_read_b128 v[40:43],v16 offset:12288
buffer_load_dwordx4 v1,s[8:11],s63 offen offset:3072 sc1 lds
s_add_u32 m0,s61,4096
s_add_u32 s63,s60,4096
v_mfma_f32_32x32x16_bf16 v[72:87],v[52:55],a[188:191],v[72:87]
v_cvt_pk_bf16_f32 v88,v88,v89
v_cvt_pk_bf16_f32 v89,v90,v91
v_cvt_pk_bf16_f32 v90,v96,v97
v_cvt_pk_bf16_f32 v91,v98,v99
v_fma_f32 v92,-v132,v120,v92
s_waitcnt lgkmcnt(3)
v_mfma_f32_32x32x16_bf16 v[56:71],v[24:27],a[32:35],v[56:71]
ds_read_b128 v[44:47],v17 offset:12288
v_fma_f32 v93,-v134,v120,v93
v_fma_f32 v94,-v136,v120,v94
v_fma_f32 v95,-v138,v120,v95
v_fma_f32 v100,-v148,v120,v100
v_mfma_f32_32x32x16_bf16 v[72:87],v[24:27],a[192:195],v[72:87]
buffer_load_dwordx4 v1,s[8:11],s63 offen sc1 lds
v_fma_f32 v101,-v150,v120,v101
v_fma_f32 v102,-v152,v120,v102
v_fma_f32 v103,-v154,v120,v103
v_mul_f32 v92,v92,v133
v_mfma_f32_32x32x16_bf16 v[56:71],v[28:31],a[36:39],v[56:71]
ds_read_b128 v[48:51],v16 offset:14336
v_mul_f32 v93,v93,v135
v_mul_f32 v94,v94,v137
v_mul_f32 v95,v95,v139
v_mul_f32 v100,v100,v149
v_mfma_f32_32x32x16_bf16 v[72:87],v[28:31],a[196:199],v[72:87]
v_mul_f32 v101,v101,v151
v_mul_f32 v102,v102,v153
v_mul_f32 v103,v103,v155
v_cvt_pk_bf16_f32 v92,v92,v93
v_cvt_pk_bf16_f32 v93,v94,v95
s_waitcnt lgkmcnt(3)
v_mfma_f32_32x32x16_bf16 v[56:71],v[32:35],a[40:43],v[56:71]
ds_read_b128 v[52:55],v17 offset:14336
buffer_load_dwordx4 v1,s[8:11],s63 offen offset:1024 sc1 lds
v_cvt_pk_bf16_f32 v94,v100,v101
v_cvt_pk_bf16_f32 v95,v102,v103
v_mfma_f32_32x32x16_bf16 v[72:87],v[32:35],a[200:203],v[72:87]
v_fma_f32 v104,-v124,v121,v104
v_fma_f32 v105,-v126,v121,v105
v_fma_f32 v106,-v128,v121,v106
v_fma_f32 v107,-v130,v121,v107
v_fma_f32 v112,-v140,v121,v112
v_mfma_f32_32x32x16_bf16 v[56:71],v[36:39],a[44:47],v[56:71]
ds_read_b128 v[24:27],v16 offset:16384
v_fma_f32 v113,-v142,v121,v113
v_fma_f32 v114,-v144,v121,v114
v_fma_f32 v115,-v146,v121,v115
v_mul_f32 v104,v104,v125
v_mfma_f32_32x32x16_bf16 v[72:87],v[36:39],a[204:207],v[72:87]
buffer_load_dwordx4 v1,s[8:11],s63 offen offset:2048 sc1 lds
v_mul_f32 v105,v105,v127
v_mul_f32 v106,v106,v129
v_mul_f32 v107,v107,v131
s_waitcnt lgkmcnt(3)
v_mfma_f32_32x32x16_bf16 v[56:71],v[40:43],a[48:51],v[56:71]
ds_read_b128 v[28:31],v17 offset:16384
v_mul_f32 v112,v112,v141
v_mul_f32 v113,v113,v143
v_mul_f32 v114,v114,v145
v_mul_f32 v115,v115,v147
v_mfma_f32_32x32x16_bf16 v[72:87],v[40:43],a[208:211],v[72:87]
v_cvt_pk_bf16_f32 v104,v104,v105
v_cvt_pk_bf16_f32 v105,v106,v107
v_cvt_pk_bf16_f32 v106,v112,v113
v_cvt_pk_bf16_f32 v107,v114,v115
v_fma_f32 v108,-v132,v121,v108
v_mfma_f32_32x32x16_bf16 v[56:71],v[44:47],a[52:55],v[56:71]
ds_read_b128 v[32:35],v16 offset:18432
buffer_load_dwordx4 v1,s[8:11],s63 offen offset:3072 sc1 lds
s_add_u32 m0,s61,8192
s_add_u32 s63,s60,8192
v_mfma_f32_32x32x16_bf16 v[72:87],v[44:47],a[212:215],v[72:87]
v_fma_f32 v109,-v134,v121,v109
v_fma_f32 v110,-v136,v121,v110
v_fma_f32 v111,-v138,v121,v111
v_fma_f32 v116,-v148,v121,v116
v_fma_f32 v117,-v150,v121,v117
s_waitcnt lgkmcnt(3)
v_mfma_f32_32x32x16_bf16 v[56:71],v[48:51],a[56:59],v[56:71]
ds_read_b128 v[36:39],v17 offset:18432
v_fma_f32 v118,-v152,v121,v118
v_fma_f32 v119,-v154,v121,v119
v_mul_f32 v108,v108,v133
v_mul_f32 v109,v109,v135
v_mfma_f32_32x32x16_bf16 v[72:87],v[48:51],a[216:219],v[72:87]
buffer_load_dwordx4 v1,s[8:11],s63 offen sc1 lds
v_mul_f32 v110,v110,v137
v_mul_f32 v111,v111,v139
v_mul_f32 v116,v116,v149
v_mul_f32 v117,v117,v151
v_mfma_f32_32x32x16_bf16 v[56:71],v[52:55],a[60:63],v[56:71]
ds_read_b128 v[40:43],v16 offset:20480
s_waitcnt vmcnt(9)
s_mov_b64 exec,1
buffer_store_dword v5,v1,s[8:11],s59 offen sc1
s_mov_b64 exec,-1
s_mov_b32 s59,2147483648
v_mfma_f32_32x32x16_bf16 v[72:87],v[52:55],a[220:223],v[72:87]
v_mul_f32 v118,v118,v153
v_mul_f32 v119,v119,v155
v_cvt_pk_bf16_f32 v108,v108,v109
v_cvt_pk_bf16_f32 v109,v110,v111
v_cvt_pk_bf16_f32 v110,v116,v117
s_waitcnt lgkmcnt(3)
v_mfma_f32_32x32x16_bf16 v[56:71],v[24:27],a[64:67],v[56:71]
ds_read_b128 v[44:47],v17 offset:20480
buffer_load_dwordx4 v1,s[8:11],s63 offen offset:1024 sc1 lds
s_lshl_b32 s62,s46,10
s_add_u32 s62,s62,40960
v_mfma_f32_32x32x16_bf16 v[72:87],v[24:27],a[224:227],v[72:87]
s_add_u32 m0,s66,s62
s_add_u32 s63,s67,s62
v_cvt_pk_bf16_f32 v111,v118,v119
s_lshl_b32 s82,s72,6
s_add_u32 s82,s82,s73
s_lshl_b32 s82,s82,9
v_mfma_f32_32x32x16_bf16 v[56:71],v[28:31],a[68:71],v[56:71]
ds_read_b128 v[48:51],v16 offset:22528
s_add_u32 s82,s82,s71
s_lshl_b32 s75,s69,2
s_add_u32 s82,s82,s75
s_add_u32 s82,s82,s39
v_mfma_f32_32x32x16_bf16 v[72:87],v[28:31],a[228:231],v[72:87]
buffer_load_dwordx4 v1,s[8:11],s63 offen sc1 lds
s_add_u32 m0,s66,45056
s_add_u32 s63,s67,45056
s_waitcnt lgkmcnt(3)
v_mfma_f32_32x32x16_bf16 v[56:71],v[32:35],a[72:75],v[56:71]
ds_read_b128 v[52:55],v17 offset:22528
buffer_load_dword v3,v2,s[8:11],s35 offen sc1
buffer_load_dword v14,v4,s[8:11],s41 offen sc1
v_mfma_f32_32x32x16_bf16 v[72:87],v[32:35],a[232:235],v[72:87]
v_add_f32 v156,v156,v166
v_add_f32 v157,v157,v167
v_add_f32 v158,v158,v168
v_add_f32 v159,v159,v169
v_add_f32 v160,v160,v170
v_mfma_f32_32x32x16_bf16 v[56:71],v[36:39],a[76:79],v[56:71]
ds_read_b128 v[24:27],v16 offset:24576
buffer_load_dwordx4 v1,s[8:11],s63 offen sc1 lds
v_add_f32 v161,v161,v171
v_add_f32 v162,v162,v172
v_mfma_f32_32x32x16_bf16 v[72:87],v[36:39],a[236:239],v[72:87]
v_add_f32 v163,v163,v173
v_add_f32 v164,v164,v174
v_add_f32 v165,v165,v175
v_add_f32 v156,v156,v158
v_add_f32 v157,v157,v159
s_waitcnt lgkmcnt(3)
v_mfma_f32_32x32x16_bf16 v[56:71],v[40:43],a[80:83],v[56:71]
ds_read_b128 v[28:31],v17 offset:24576
buffer_store_dwordx4 v[88:91],v20,s[8:11],s74 offen sc1
v_add_f32 v160,v160,v162
v_add_f32 v161,v161,v163
v_mfma_f32_32x32x16_bf16 v[72:87],v[40:43],a[240:243],v[72:87]
v_add_f32 v156,v156,v160
v_add_f32 v157,v157,v161
v_add_f32 v156,v156,v164
v_add_f32 v157,v157,v165
v_mov_b32 v158,v156
v_mfma_f32_32x32x16_bf16 v[56:71],v[44:47],a[84:87],v[56:71]
ds_read_b128 v[32:35],v16 offset:26624
buffer_store_dwordx4 v[92:95],v21,s[8:11],s74 offen sc1
v_mov_b32 v159,v157
v_permlane32_swap_b32 v156,v158
v_mfma_f32_32x32x16_bf16 v[72:87],v[44:47],a[244:247],v[72:87]
v_permlane32_swap_b32 v157,v159
v_add_f32 v176,v156,v158
v_add_f32 v177,v157,v159
v_mul_f32 v176,0x3acccccd,v176
v_mul_f32 v177,0x3acccccd,v177
s_waitcnt lgkmcnt(3)
v_mfma_f32_32x32x16_bf16 v[56:71],v[48:51],a[88:91],v[56:71]
ds_read_b128 v[36:39],v17 offset:26624
buffer_store_dwordx4 v[104:107],v20,s[8:11],s74 offen offset:2048 sc1
v_fma_f32 v177,-v176,v176,v177
v_max_f32 v177,0,v177
v_mfma_f32_32x32x16_bf16 v[72:87],v[48:51],a[248:251],v[72:87]
v_cvt_pk_bf16_f32 v8,v176,v177
v_lshlrev_b32 v176,16,v8
v_and_b32 v177,0xffff0000,v8
v_add_f32 v177,0x3727c5ac,v177
v_cvt_pk_bf16_f32 v8,v177,v177
v_mfma_f32_32x32x16_bf16 v[56:71],v[52:55],a[92:95],v[56:71]
ds_read_b128 v[40:43],v16 offset:28672
buffer_store_dwordx4 v[108:111],v21,s[8:11],s74 offen offset:2048 sc1
v_lshlrev_b32 v177,16,v8
v_mfma_f32_32x32x16_bf16 v[72:87],v[52:55],a[252:255],v[72:87]
v_sqrt_f32 v177,v177
s_nop 0
v_cvt_pk_bf16_f32 v8,v177,v177
v_lshlrev_b32 v177,16,v8
s_waitcnt lgkmcnt(3)
v_mfma_f32_32x32x16_bf16 v[56:71],v[24:27],a[96:99],v[56:71]
ds_read_b128 v[44:47],v17 offset:28672
v_rcp_f32 v177,v177
s_cmp_eq_u32 s51,0
s_cselect_b64 s[76:77],-1,0
v_mfma_f32_32x32x16_bf16 v[72:87],v[24:27],v[192:195],v[72:87]
v_cndmask_b32 v176,v176,0,s[76:77]
v_cndmask_b32 v177,v177,1.0,s[76:77]
s_mov_b32 s72,s51
s_mov_b32 s73,s52
ds_write_b64 v190,v[176:177]
v_mfma_f32_32x32x16_bf16 v[56:71],v[28:31],a[100:103],v[56:71]
ds_read_b128 v[48:51],v16 offset:30720
ds_read_b128 v[124:127],v191 offset:0
ds_read_b128 v[128:131],v191 offset:16
v_mfma_f32_32x32x16_bf16 v[72:87],v[28:31],v[196:199],v[72:87]
ds_read_b128 v[132:135],v191 offset:64
ds_read_b128 v[136:139],v191 offset:80
s_waitcnt lgkmcnt(8)
v_mfma_f32_32x32x16_bf16 v[56:71],v[32:35],a[104:107],v[56:71]
ds_read_b128 v[52:55],v17 offset:30720
ds_read_b128 v[140:143],v191 offset:128
ds_read_b128 v[144:147],v191 offset:144
v_mfma_f32_32x32x16_bf16 v[72:87],v[32:35],v[200:203],v[72:87]
ds_read_b128 v[148:151],v191 offset:192
ds_read_b128 v[152:155],v191 offset:208
v_mfma_f32_32x32x16_bf16 v[56:71],v[36:39],a[108:111],v[56:71]
ds_read_b128 v[24:27],v16 offset:32768
v_mfma_f32_32x32x16_bf16 v[72:87],v[36:39],v[204:207],v[72:87]
s_waitcnt lgkmcnt(12)
v_mfma_f32_32x32x16_bf16 v[56:71],v[40:43],a[112:115],v[56:71]
ds_read_b128 v[28:31],v17 offset:32768
v_mfma_f32_32x32x16_bf16 v[72:87],v[40:43],v[208:211],v[72:87]
v_mfma_f32_32x32x16_bf16 v[56:71],v[44:47],a[116:119],v[56:71]
ds_read_b128 v[32:35],v16 offset:34816
v_mfma_f32_32x32x16_bf16 v[72:87],v[44:47],v[212:215],v[72:87]
s_waitcnt lgkmcnt(7)
v_mfma_f32_32x32x16_bf16 v[56:71],v[48:51],a[120:123],v[56:71]
ds_read_b128 v[36:39],v17 offset:34816
v_mfma_f32_32x32x16_bf16 v[72:87],v[48:51],v[216:219],v[72:87]
v_mfma_f32_32x32x16_bf16 v[56:71],v[52:55],a[124:127],v[56:71]
ds_read_b128 v[40:43],v16 offset:36864
v_mfma_f32_32x32x16_bf16 v[72:87],v[52:55],v[220:223],v[72:87]
s_waitcnt lgkmcnt(3)
v_mfma_f32_32x32x16_bf16 v[56:71],v[24:27],a[128:131],v[56:71]
ds_read_b128 v[44:47],v17 offset:36864
s_waitcnt vmcnt(4)
v_cmp_eq_u32 vcc,0,v14
s_cmp_eq_u64 vcc,0
s_cselect_b32 s36,0,2147483648
v_mfma_f32_32x32x16_bf16 v[72:87],v[24:27],v[224:227],v[72:87]
v_cmp_eq_u32 vcc,0,v3
s_cmp_lt_u32 s78,64
s_cselect_b32 s36,s36,2147483648
s_cmp_eq_u64 vcc,0
s_cselect_b32 s60,1,s36
v_mfma_f32_32x32x16_bf16 v[56:71],v[28:31],a[132:135],v[56:71]
ds_read_b128 v[48:51],v16 offset:38912
s_cmp_lt_u32 s79,64
s_cselect_b32 s60,s60,s36
s_sub_u32 s61,s78,s79
s_or_b32 s61,s61,s36
v_mfma_f32_32x32x16_bf16 v[72:87],v[28:31],v[228:231],v[72:87]
s_cmp_lt_u32 s61,16
s_cselect_b32 s36,0,s60
v_mov_b32 v23,s36
s_waitcnt lgkmcnt(3)
v_mfma_f32_32x32x16_bf16 v[56:71],v[32:35],a[136:139],v[56:71]
ds_read_b128 v[52:55],v17 offset:38912
ds_write_b32 v13,v23
v_mfma_f32_32x32x16_bf16 v[72:87],v[32:35],v[232:235],v[72:87]
s_waitcnt lgkmcnt(0)
s_barrier
ds_read_b32 v23,v22
v_mfma_f32_32x32x16_bf16 v[56:71],v[36:39],a[140:143],v[56:71]
ds_read_b128 v[24:27],v18 offset:0
s_cmp_lt_u32 s50,2
s_cselect_b32 s42,1,0
s_cmp_ge_u32 s78,64
s_cselect_b32 s42,1,s42
v_mfma_f32_32x32x16_bf16 v[72:87],v[36:39],v[236:239],v[72:87]
s_or_b32 s42,s42,s37
s_mov_b32 s39,0
s_add_u32 s50,s50,1
s_sub_u32 s57,46080,s57
s_mov_b32 s51,s53
s_mov_b32 s52,s54
v_mfma_f32_32x32x16_bf16 v[56:71],v[40:43],a[144:147],v[56:71]
ds_read_b128 v[28:31],v19 offset:0
v_mfma_f32_32x32x16_bf16 v[72:87],v[40:43],v[240:243],v[72:87]
v_mfma_f32_32x32x16_bf16 v[56:71],v[44:47],a[148:151],v[56:71]
ds_read_b128 v[32:35],v18 offset:2048
s_waitcnt vmcnt(0)
s_mov_b64 exec,1
buffer_store_dword v5,v1,s[8:11],s82 offen sc1
s_mov_b64 exec,-1
s_mov_b32 s82,2147483648
v_mfma_f32_32x32x16_bf16 v[72:87],v[44:47],v[244:247],v[72:87]
s_waitcnt lgkmcnt(3)
v_readfirstlane_b32 s38,v23
s_and_b32 s37,s38,2147483648
s_and_b32 s33,s38,1
s_cselect_b32 s34,s79,s78
s_cmp_lg_u32 s42,0
v_mfma_f32_32x32x16_bf16 v[56:71],v[48:51],a[152:155],v[56:71]
ds_read_b128 v[36:39],v19 offset:2048
v_mfma_f32_32x32x16_bf16 v[72:87],v[48:51],v[248:251],v[72:87]
v_mfma_f32_32x32x16_bf16 v[56:71],v[52:55],a[156:159],v[56:71]
ds_read_b128 v[40:43],v18 offset:4096
v_mfma_f32_32x32x16_bf16 v[72:87],v[52:55],v[252:255],v[72:87]
s_cbranch_scc1 QKVV_S0
QKVV_B1:
s_waitcnt lgkmcnt(3)
v_mfma_f32_32x32x16_bf16 v[88:103],v[24:27],a[0:3],0
ds_read_b128 v[44:47],v19 offset:4096
v_add_u32 v189,s57,v188
v_mfma_f32_32x32x16_bf16 v[104:119],v[24:27],a[160:163],0
v_add_u32 v8,0x800,v189
s_sub_u32 s66,46080,s57
s_lshl_b32 s60,s33,6
s_add_u32 s60,s60,s34
s_mul_i32 s60,s60,46080
s_add_u32 s60,s60,s37
v_mfma_f32_32x32x16_bf16 v[88:103],v[28:31],a[4:7],v[88:103]
ds_read_b128 v[48:51],v18 offset:6144
ds_read2_b64 v[156:159],v189 offset0:0 offset1:32
s_add_u32 s60,s60,206569472
v_mfma_f32_32x32x16_bf16 v[104:119],v[28:31],a[164:167],v[104:119]
ds_read2_b64 v[160:163],v189 offset0:64 offset1:96
s_cmp_eq_u32 s33,0
s_cselect_b32 s67,2147483648,s60
s_mul_i32 s61,s46,10240
s_waitcnt lgkmcnt(5)
v_mfma_f32_32x32x16_bf16 v[88:103],v[32:35],a[8:11],v[88:103]
ds_read_b128 v[52:55],v19 offset:6144
ds_read2_b64 v[164:167],v189 offset0:128 offset1:160
s_add_u32 s60,s60,s61
s_add_u32 s61,s61,s66
v_mfma_f32_32x32x16_bf16 v[104:119],v[32:35],a[168:171],v[104:119]
ds_read2_b64 v[168:171],v189 offset0:192 offset1:224
s_add_u32 m0,s61,0
s_add_u32 s63,s60,0
buffer_load_dwordx4 v1,s[8:11],s63 offen sc1 lds
v_mfma_f32_32x32x16_bf16 v[88:103],v[36:39],a[12:15],v[88:103]
ds_read_b128 v[24:27],v18 offset:8192
ds_read2_b64 v[172:175],v8 offset0:0 offset1:32
s_mul_i32 s74,s73,393216
s_add_u32 s74,s74,s39
v_mfma_f32_32x32x16_bf16 v[104:119],v[36:39],a[172:175],v[104:119]
s_add_u32 s74,s74,s70
v_fma_f32 v56,-v124,v120,v56
v_fma_f32 v57,-v126,v120,v57
v_fma_f32 v58,-v128,v120,v58
v_fma_f32 v59,-v130,v120,v59
s_waitcnt lgkmcnt(8)
v_mfma_f32_32x32x16_bf16 v[88:103],v[40:43],a[16:19],v[88:103]
ds_read_b128 v[28:31],v19 offset:8192
buffer_load_dwordx4 v1,s[8:11],s63 offen offset:1024 sc1 lds
v_fma_f32 v64,-v140,v120,v64
v_fma_f32 v65,-v142,v120,v65
v_mfma_f32_32x32x16_bf16 v[104:119],v[40:43],a[176:179],v[104:119]
v_fma_f32 v66,-v144,v120,v66
v_fma_f32 v67,-v146,v120,v67
v_mul_f32 v56,v56,v125
v_mul_f32 v57,v57,v127
v_mul_f32 v58,v58,v129
v_mfma_f32_32x32x16_bf16 v[88:103],v[44:47],a[20:23],v[88:103]
ds_read_b128 v[32:35],v18 offset:10240
s_mov_b32 s53,s33
s_mov_b32 s54,s34
s_add_u32 s79,s79,s33
s_or_b32 s65,s37,s33
v_mfma_f32_32x32x16_bf16 v[104:119],v[44:47],a[180:183],v[104:119]
buffer_load_dwordx4 v1,s[8:11],s63 offen offset:2048 sc1 lds
s_cmp_eq_u32 s65,0
s_addc_u32 s78,s78,0
s_lshl_b32 s41,s78,9
s_waitcnt lgkmcnt(6)
v_mfma_f32_32x32x16_bf16 v[88:103],v[48:51],a[24:27],v[88:103]
ds_read_b128 v[36:39],v19 offset:10240
s_add_u32 s41,s41,s40
s_lshl_b32 s35,s79,9
s_add_u32 s35,s35,s40
s_add_u32 s35,s35,32768
v_mfma_f32_32x32x16_bf16 v[104:119],v[48:51],a[184:187],v[104:119]
v_mul_f32 v59,v59,v131
v_mul_f32 v64,v64,v141
v_mul_f32 v65,v65,v143
v_mul_f32 v66,v66,v145
v_mul_f32 v67,v67,v147
v_mfma_f32_32x32x16_bf16 v[88:103],v[52:55],a[28:31],v[88:103]
ds_read_b128 v[40:43],v18 offset:12288
buffer_load_dwordx4 v1,s[8:11],s63 offen offset:3072 sc1 lds
s_add_u32 m0,s61,4096
s_add_u32 s63,s60,4096
v_mfma_f32_32x32x16_bf16 v[104:119],v[52:55],a[188:191],v[104:119]
v_cvt_pk_bf16_f32 v56,v56,v57
v_cvt_pk_bf16_f32 v57,v58,v59
v_cvt_pk_bf16_f32 v58,v64,v65
v_cvt_pk_bf16_f32 v59,v66,v67
v_fma_f32 v60,-v132,v120,v60
s_waitcnt lgkmcnt(3)
v_mfma_f32_32x32x16_bf16 v[88:103],v[24:27],a[32:35],v[88:103]
ds_read_b128 v[44:47],v19 offset:12288
v_fma_f32 v61,-v134,v120,v61
v_fma_f32 v62,-v136,v120,v62
v_fma_f32 v63,-v138,v120,v63
v_fma_f32 v68,-v148,v120,v68
v_mfma_f32_32x32x16_bf16 v[104:119],v[24:27],a[192:195],v[104:119]
buffer_load_dwordx4 v1,s[8:11],s63 offen sc1 lds
v_fma_f32 v69,-v150,v120,v69
v_fma_f32 v70,-v152,v120,v70
v_fma_f32 v71,-v154,v120,v71
v_mul_f32 v60,v60,v133
v_mfma_f32_32x32x16_bf16 v[88:103],v[28:31],a[36:39],v[88:103]
ds_read_b128 v[48:51],v18 offset:14336
v_mul_f32 v61,v61,v135
v_mul_f32 v62,v62,v137
v_mul_f32 v63,v63,v139
v_mul_f32 v68,v68,v149
v_mfma_f32_32x32x16_bf16 v[104:119],v[28:31],a[196:199],v[104:119]
v_mul_f32 v69,v69,v151
v_mul_f32 v70,v70,v153
v_mul_f32 v71,v71,v155
v_cvt_pk_bf16_f32 v60,v60,v61
v_cvt_pk_bf16_f32 v61,v62,v63
s_waitcnt lgkmcnt(3)
v_mfma_f32_32x32x16_bf16 v[88:103],v[32:35],a[40:43],v[88:103]
ds_read_b128 v[52:55],v19 offset:14336
buffer_load_dwordx4 v1,s[8:11],s63 offen offset:1024 sc1 lds
v_cvt_pk_bf16_f32 v62,v68,v69
v_cvt_pk_bf16_f32 v63,v70,v71
v_mfma_f32_32x32x16_bf16 v[104:119],v[32:35],a[200:203],v[104:119]
v_fma_f32 v72,-v124,v121,v72
v_fma_f32 v73,-v126,v121,v73
v_fma_f32 v74,-v128,v121,v74
v_fma_f32 v75,-v130,v121,v75
v_fma_f32 v80,-v140,v121,v80
v_mfma_f32_32x32x16_bf16 v[88:103],v[36:39],a[44:47],v[88:103]
ds_read_b128 v[24:27],v18 offset:16384
v_fma_f32 v81,-v142,v121,v81
v_fma_f32 v82,-v144,v121,v82
v_fma_f32 v83,-v146,v121,v83
v_mul_f32 v72,v72,v125
v_mfma_f32_32x32x16_bf16 v[104:119],v[36:39],a[204:207],v[104:119]
buffer_load_dwordx4 v1,s[8:11],s63 offen offset:2048 sc1 lds
v_mul_f32 v73,v73,v127
v_mul_f32 v74,v74,v129
v_mul_f32 v75,v75,v131
s_waitcnt lgkmcnt(3)
v_mfma_f32_32x32x16_bf16 v[88:103],v[40:43],a[48:51],v[88:103]
ds_read_b128 v[28:31],v19 offset:16384
v_mul_f32 v80,v80,v141
v_mul_f32 v81,v81,v143
v_mul_f32 v82,v82,v145
v_mul_f32 v83,v83,v147
v_mfma_f32_32x32x16_bf16 v[104:119],v[40:43],a[208:211],v[104:119]
v_cvt_pk_bf16_f32 v72,v72,v73
v_cvt_pk_bf16_f32 v73,v74,v75
v_cvt_pk_bf16_f32 v74,v80,v81
v_cvt_pk_bf16_f32 v75,v82,v83
v_fma_f32 v76,-v132,v121,v76
v_mfma_f32_32x32x16_bf16 v[88:103],v[44:47],a[52:55],v[88:103]
ds_read_b128 v[32:35],v18 offset:18432
buffer_load_dwordx4 v1,s[8:11],s63 offen offset:3072 sc1 lds
s_add_u32 m0,s61,8192
s_add_u32 s63,s60,8192
v_mfma_f32_32x32x16_bf16 v[104:119],v[44:47],a[212:215],v[104:119]
v_fma_f32 v77,-v134,v121,v77
v_fma_f32 v78,-v136,v121,v78
v_fma_f32 v79,-v138,v121,v79
v_fma_f32 v84,-v148,v121,v84
v_fma_f32 v85,-v150,v121,v85
s_waitcnt lgkmcnt(3)
v_mfma_f32_32x32x16_bf16 v[88:103],v[48:51],a[56:59],v[88:103]
ds_read_b128 v[36:39],v19 offset:18432
v_fma_f32 v86,-v152,v121,v86
v_fma_f32 v87,-v154,v121,v87
v_mul_f32 v76,v76,v133
v_mul_f32 v77,v77,v135
v_mfma_f32_32x32x16_bf16 v[104:119],v[48:51],a[216:219],v[104:119]
buffer_load_dwordx4 v1,s[8:11],s63 offen sc1 lds
v_mul_f32 v78,v78,v137
v_mul_f32 v79,v79,v139
v_mul_f32 v84,v84,v149
v_mul_f32 v85,v85,v151
v_mfma_f32_32x32x16_bf16 v[88:103],v[52:55],a[60:63],v[88:103]
ds_read_b128 v[40:43],v18 offset:20480
s_waitcnt vmcnt(9)
s_mov_b64 exec,1
buffer_store_dword v5,v1,s[8:11],s59 offen sc1
s_mov_b64 exec,-1
s_mov_b32 s59,2147483648
v_mfma_f32_32x32x16_bf16 v[104:119],v[52:55],a[220:223],v[104:119]
v_mul_f32 v86,v86,v153
v_mul_f32 v87,v87,v155
v_cvt_pk_bf16_f32 v76,v76,v77
v_cvt_pk_bf16_f32 v77,v78,v79
v_cvt_pk_bf16_f32 v78,v84,v85
s_waitcnt lgkmcnt(3)
v_mfma_f32_32x32x16_bf16 v[88:103],v[24:27],a[64:67],v[88:103]
ds_read_b128 v[44:47],v19 offset:20480
buffer_load_dwordx4 v1,s[8:11],s63 offen offset:1024 sc1 lds
s_lshl_b32 s62,s46,10
s_add_u32 s62,s62,40960
v_mfma_f32_32x32x16_bf16 v[104:119],v[24:27],a[224:227],v[104:119]
s_add_u32 m0,s66,s62
s_add_u32 s63,s67,s62
v_cvt_pk_bf16_f32 v79,v86,v87
s_lshl_b32 s82,s72,6
s_add_u32 s82,s82,s73
s_lshl_b32 s82,s82,9
v_mfma_f32_32x32x16_bf16 v[88:103],v[28:31],a[68:71],v[88:103]
ds_read_b128 v[48:51],v18 offset:22528
s_add_u32 s82,s82,s71
s_lshl_b32 s75,s69,2
s_add_u32 s82,s82,s75
s_add_u32 s82,s82,s39
v_mfma_f32_32x32x16_bf16 v[104:119],v[28:31],a[228:231],v[104:119]
buffer_load_dwordx4 v1,s[8:11],s63 offen sc1 lds
s_add_u32 m0,s66,45056
s_add_u32 s63,s67,45056
s_waitcnt lgkmcnt(3)
v_mfma_f32_32x32x16_bf16 v[88:103],v[32:35],a[72:75],v[88:103]
ds_read_b128 v[52:55],v19 offset:22528
buffer_load_dword v3,v2,s[8:11],s35 offen sc1
buffer_load_dword v14,v4,s[8:11],s41 offen sc1
v_mfma_f32_32x32x16_bf16 v[104:119],v[32:35],a[232:235],v[104:119]
v_add_f32 v156,v156,v166
v_add_f32 v157,v157,v167
v_add_f32 v158,v158,v168
v_add_f32 v159,v159,v169
v_add_f32 v160,v160,v170
v_mfma_f32_32x32x16_bf16 v[88:103],v[36:39],a[76:79],v[88:103]
ds_read_b128 v[24:27],v18 offset:24576
buffer_load_dwordx4 v1,s[8:11],s63 offen sc1 lds
v_add_f32 v161,v161,v171
v_add_f32 v162,v162,v172
v_mfma_f32_32x32x16_bf16 v[104:119],v[36:39],a[236:239],v[104:119]
v_add_f32 v163,v163,v173
v_add_f32 v164,v164,v174
v_add_f32 v165,v165,v175
v_add_f32 v156,v156,v158
v_add_f32 v157,v157,v159
s_waitcnt lgkmcnt(3)
v_mfma_f32_32x32x16_bf16 v[88:103],v[40:43],a[80:83],v[88:103]
ds_read_b128 v[28:31],v19 offset:24576
buffer_store_dwordx4 v[56:59],v20,s[8:11],s74 offen sc1
v_add_f32 v160,v160,v162
v_add_f32 v161,v161,v163
v_mfma_f32_32x32x16_bf16 v[104:119],v[40:43],a[240:243],v[104:119]
v_add_f32 v156,v156,v160
v_add_f32 v157,v157,v161
v_add_f32 v156,v156,v164
v_add_f32 v157,v157,v165
v_mov_b32 v158,v156
v_mfma_f32_32x32x16_bf16 v[88:103],v[44:47],a[84:87],v[88:103]
ds_read_b128 v[32:35],v18 offset:26624
buffer_store_dwordx4 v[60:63],v21,s[8:11],s74 offen sc1
v_mov_b32 v159,v157
v_permlane32_swap_b32 v156,v158
v_mfma_f32_32x32x16_bf16 v[104:119],v[44:47],a[244:247],v[104:119]
v_permlane32_swap_b32 v157,v159
v_add_f32 v176,v156,v158
v_add_f32 v177,v157,v159
v_mul_f32 v176,0x3acccccd,v176
v_mul_f32 v177,0x3acccccd,v177
s_waitcnt lgkmcnt(3)
v_mfma_f32_32x32x16_bf16 v[88:103],v[48:51],a[88:91],v[88:103]
ds_read_b128 v[36:39],v19 offset:26624
buffer_store_dwordx4 v[72:75],v20,s[8:11],s74 offen offset:2048 sc1
v_fma_f32 v177,-v176,v176,v177
v_max_f32 v177,0,v177
v_mfma_f32_32x32x16_bf16 v[104:119],v[48:51],a[248:251],v[104:119]
v_cvt_pk_bf16_f32 v8,v176,v177
v_lshlrev_b32 v176,16,v8
v_and_b32 v177,0xffff0000,v8
v_add_f32 v177,0x3727c5ac,v177
v_cvt_pk_bf16_f32 v8,v177,v177
v_mfma_f32_32x32x16_bf16 v[88:103],v[52:55],a[92:95],v[88:103]
ds_read_b128 v[40:43],v18 offset:28672
buffer_store_dwordx4 v[76:79],v21,s[8:11],s74 offen offset:2048 sc1
v_lshlrev_b32 v177,16,v8
v_mfma_f32_32x32x16_bf16 v[104:119],v[52:55],a[252:255],v[104:119]
v_sqrt_f32 v177,v177
s_nop 0
v_cvt_pk_bf16_f32 v8,v177,v177
v_lshlrev_b32 v177,16,v8
s_waitcnt lgkmcnt(3)
v_mfma_f32_32x32x16_bf16 v[88:103],v[24:27],a[96:99],v[88:103]
ds_read_b128 v[44:47],v19 offset:28672
v_rcp_f32 v177,v177
s_cmp_eq_u32 s51,0
s_cselect_b64 s[76:77],-1,0
v_mfma_f32_32x32x16_bf16 v[104:119],v[24:27],v[192:195],v[104:119]
v_cndmask_b32 v176,v176,0,s[76:77]
v_cndmask_b32 v177,v177,1.0,s[76:77]
s_mov_b32 s72,s51
s_mov_b32 s73,s52
ds_write_b64 v190,v[176:177]
v_mfma_f32_32x32x16_bf16 v[88:103],v[28:31],a[100:103],v[88:103]
ds_read_b128 v[48:51],v18 offset:30720
ds_read_b128 v[124:127],v191 offset:0
ds_read_b128 v[128:131],v191 offset:16
v_mfma_f32_32x32x16_bf16 v[104:119],v[28:31],v[196:199],v[104:119]
ds_read_b128 v[132:135],v191 offset:64
ds_read_b128 v[136:139],v191 offset:80
s_waitcnt lgkmcnt(8)
v_mfma_f32_32x32x16_bf16 v[88:103],v[32:35],a[104:107],v[88:103]
ds_read_b128 v[52:55],v19 offset:30720
ds_read_b128 v[140:143],v191 offset:128
ds_read_b128 v[144:147],v191 offset:144
v_mfma_f32_32x32x16_bf16 v[104:119],v[32:35],v[200:203],v[104:119]
ds_read_b128 v[148:151],v191 offset:192
ds_read_b128 v[152:155],v191 offset:208
v_mfma_f32_32x32x16_bf16 v[88:103],v[36:39],a[108:111],v[88:103]
ds_read_b128 v[24:27],v18 offset:32768
v_mfma_f32_32x32x16_bf16 v[104:119],v[36:39],v[204:207],v[104:119]
s_waitcnt lgkmcnt(12)
v_mfma_f32_32x32x16_bf16 v[88:103],v[40:43],a[112:115],v[88:103]
ds_read_b128 v[28:31],v19 offset:32768
v_mfma_f32_32x32x16_bf16 v[104:119],v[40:43],v[208:211],v[104:119]
v_mfma_f32_32x32x16_bf16 v[88:103],v[44:47],a[116:119],v[88:103]
ds_read_b128 v[32:35],v18 offset:34816
v_mfma_f32_32x32x16_bf16 v[104:119],v[44:47],v[212:215],v[104:119]
s_waitcnt lgkmcnt(7)
v_mfma_f32_32x32x16_bf16 v[88:103],v[48:51],a[120:123],v[88:103]
ds_read_b128 v[36:39],v19 offset:34816
v_mfma_f32_32x32x16_bf16 v[104:119],v[48:51],v[216:219],v[104:119]
v_mfma_f32_32x32x16_bf16 v[88:103],v[52:55],a[124:127],v[88:103]
ds_read_b128 v[40:43],v18 offset:36864
v_mfma_f32_32x32x16_bf16 v[104:119],v[52:55],v[220:223],v[104:119]
s_waitcnt lgkmcnt(3)
v_mfma_f32_32x32x16_bf16 v[88:103],v[24:27],a[128:131],v[88:103]
ds_read_b128 v[44:47],v19 offset:36864
s_waitcnt vmcnt(4)
v_cmp_eq_u32 vcc,0,v14
s_cmp_eq_u64 vcc,0
s_cselect_b32 s36,0,2147483648
v_mfma_f32_32x32x16_bf16 v[104:119],v[24:27],v[224:227],v[104:119]
v_cmp_eq_u32 vcc,0,v3
s_cmp_lt_u32 s78,64
s_cselect_b32 s36,s36,2147483648
s_cmp_eq_u64 vcc,0
s_cselect_b32 s60,1,s36
v_mfma_f32_32x32x16_bf16 v[88:103],v[28:31],a[132:135],v[88:103]
ds_read_b128 v[48:51],v18 offset:38912
s_cmp_lt_u32 s79,64
s_cselect_b32 s60,s60,s36
s_sub_u32 s61,s78,s79
s_or_b32 s61,s61,s36
v_mfma_f32_32x32x16_bf16 v[104:119],v[28:31],v[228:231],v[104:119]
s_cmp_lt_u32 s61,16
s_cselect_b32 s36,0,s60
v_mov_b32 v23,s36
s_waitcnt lgkmcnt(3)
v_mfma_f32_32x32x16_bf16 v[88:103],v[32:35],a[136:139],v[88:103]
ds_read_b128 v[52:55],v19 offset:38912
ds_write_b32 v13,v23
v_mfma_f32_32x32x16_bf16 v[104:119],v[32:35],v[232:235],v[104:119]
s_waitcnt lgkmcnt(0)
s_barrier
ds_read_b32 v23,v22
v_mfma_f32_32x32x16_bf16 v[88:103],v[36:39],a[140:143],v[88:103]
ds_read_b128 v[24:27],v16 offset:0
s_cmp_lt_u32 s50,2
s_cselect_b32 s42,1,0
s_cmp_ge_u32 s78,64
s_cselect_b32 s42,1,s42
v_mfma_f32_32x32x16_bf16 v[104:119],v[36:39],v[236:239],v[104:119]
s_or_b32 s42,s42,s37
s_mov_b32 s39,0
s_add_u32 s50,s50,1
s_sub_u32 s57,46080,s57
s_mov_b32 s51,s53
s_mov_b32 s52,s54
v_mfma_f32_32x32x16_bf16 v[88:103],v[40:43],a[144:147],v[88:103]
ds_read_b128 v[28:31],v17 offset:0
v_mfma_f32_32x32x16_bf16 v[104:119],v[40:43],v[240:243],v[104:119]
v_mfma_f32_32x32x16_bf16 v[88:103],v[44:47],a[148:151],v[88:103]
ds_read_b128 v[32:35],v16 offset:2048
s_waitcnt vmcnt(0)
s_mov_b64 exec,1
buffer_store_dword v5,v1,s[8:11],s82 offen sc1
s_mov_b64 exec,-1
s_mov_b32 s82,2147483648
v_mfma_f32_32x32x16_bf16 v[104:119],v[44:47],v[244:247],v[104:119]
s_waitcnt lgkmcnt(3)
v_readfirstlane_b32 s38,v23
s_and_b32 s37,s38,2147483648
s_and_b32 s33,s38,1
s_cselect_b32 s34,s79,s78
s_cmp_lg_u32 s42,0
v_mfma_f32_32x32x16_bf16 v[88:103],v[48:51],a[152:155],v[88:103]
ds_read_b128 v[36:39],v17 offset:2048
v_mfma_f32_32x32x16_bf16 v[104:119],v[48:51],v[248:251],v[104:119]
v_mfma_f32_32x32x16_bf16 v[88:103],v[52:55],a[156:159],v[88:103]
ds_read_b128 v[40:43],v16 offset:4096
v_mfma_f32_32x32x16_bf16 v[104:119],v[52:55],v[252:255],v[104:119]
s_cbranch_scc0 QKVV_B0
s_branch QKVV_S1
s_nop 9
QKVV_S0:
s_mov_b32 s55,0
s_cmp_lt_u32 s42,2
s_cbranch_scc1 nt_226
s_mov_b32 s55,2
s_cmp_lg_u32 s37,0
s_cbranch_scc1 nt_226
s_mov_b32 s55,1
s_lshl_b32 s60,s33,6
s_add_u32 s60,s60,s34
s_mul_i32 s60,s60,46080
s_add_u32 s60,s60,206569472
s_cmp_eq_u32 s33,0
s_cselect_b32 s67,2147483648,s60
s_mul_i32 s61,s46,10240
s_add_u32 s60,s60,s61
s_add_u32 s61,s61,s57
s_add_u32 m0,s61,0
s_add_u32 s63,s60,0
buffer_load_dwordx4 v1,s[8:11],s63 offen sc1 lds
buffer_load_dwordx4 v1,s[8:11],s63 offen offset:1024 sc1 lds
buffer_load_dwordx4 v1,s[8:11],s63 offen offset:2048 sc1 lds
buffer_load_dwordx4 v1,s[8:11],s63 offen offset:3072 sc1 lds
s_add_u32 m0,s61,4096
s_add_u32 s63,s60,4096
buffer_load_dwordx4 v1,s[8:11],s63 offen sc1 lds
buffer_load_dwordx4 v1,s[8:11],s63 offen offset:1024 sc1 lds
buffer_load_dwordx4 v1,s[8:11],s63 offen offset:2048 sc1 lds
buffer_load_dwordx4 v1,s[8:11],s63 offen offset:3072 sc1 lds
s_add_u32 m0,s61,8192
s_add_u32 s63,s60,8192
buffer_load_dwordx4 v1,s[8:11],s63 offen sc1 lds
buffer_load_dwordx4 v1,s[8:11],s63 offen offset:1024 sc1 lds
s_lshl_b32 s62,s46,10
s_add_u32 s62,s62,40960
s_add_u32 m0,s57,s62
s_add_u32 s63,s67,s62
buffer_load_dwordx4 v1,s[8:11],s63 offen sc1 lds
s_add_u32 m0,s57,45056
s_add_u32 s63,s67,45056
buffer_load_dwordx4 v1,s[8:11],s63 offen sc1 lds
nt_226:
s_nop 4
s_mul_i32 s74,s73,393216
s_add_u32 s74,s74,s39
s_add_u32 s74,s74,s70
v_fma_f32 v56,-v124,v120,v56
v_fma_f32 v57,-v126,v120,v57
v_fma_f32 v58,-v128,v120,v58
v_fma_f32 v59,-v130,v120,v59
v_fma_f32 v64,-v140,v120,v64
v_fma_f32 v65,-v142,v120,v65
v_fma_f32 v66,-v144,v120,v66
v_fma_f32 v67,-v146,v120,v67
v_mul_f32 v56,v56,v125
v_mul_f32 v57,v57,v127
v_mul_f32 v58,v58,v129
v_mul_f32 v59,v59,v131
v_mul_f32 v64,v64,v141
v_mul_f32 v65,v65,v143
v_mul_f32 v66,v66,v145
v_mul_f32 v67,v67,v147
v_cvt_pk_bf16_f32 v56,v56,v57
v_cvt_pk_bf16_f32 v57,v58,v59
v_cvt_pk_bf16_f32 v58,v64,v65
v_cvt_pk_bf16_f32 v59,v66,v67
buffer_store_dwordx4 v[56:59],v20,s[8:11],s74 offen sc1
v_fma_f32 v60,-v132,v120,v60
v_fma_f32 v61,-v134,v120,v61
v_fma_f32 v62,-v136,v120,v62
v_fma_f32 v63,-v138,v120,v63
v_fma_f32 v68,-v148,v120,v68
v_fma_f32 v69,-v150,v120,v69
v_fma_f32 v70,-v152,v120,v70
v_fma_f32 v71,-v154,v120,v71
v_mul_f32 v60,v60,v133
v_mul_f32 v61,v61,v135
v_mul_f32 v62,v62,v137
v_mul_f32 v63,v63,v139
v_mul_f32 v68,v68,v149
v_mul_f32 v69,v69,v151
v_mul_f32 v70,v70,v153
v_mul_f32 v71,v71,v155
v_cvt_pk_bf16_f32 v60,v60,v61
v_cvt_pk_bf16_f32 v61,v62,v63
v_cvt_pk_bf16_f32 v62,v68,v69
v_cvt_pk_bf16_f32 v63,v70,v71
buffer_store_dwordx4 v[60:63],v21,s[8:11],s74 offen sc1
v_fma_f32 v72,-v124,v121,v72
v_fma_f32 v73,-v126,v121,v73
v_fma_f32 v74,-v128,v121,v74
v_fma_f32 v75,-v130,v121,v75
v_fma_f32 v80,-v140,v121,v80
v_fma_f32 v81,-v142,v121,v81
v_fma_f32 v82,-v144,v121,v82
v_fma_f32 v83,-v146,v121,v83
v_mul_f32 v72,v72,v125
v_mul_f32 v73,v73,v127
v_mul_f32 v74,v74,v129
v_mul_f32 v75,v75,v131
v_mul_f32 v80,v80,v141
v_mul_f32 v81,v81,v143
v_mul_f32 v82,v82,v145
v_mul_f32 v83,v83,v147
v_cvt_pk_bf16_f32 v72,v72,v73
v_cvt_pk_bf16_f32 v73,v74,v75
v_cvt_pk_bf16_f32 v74,v80,v81
v_cvt_pk_bf16_f32 v75,v82,v83
buffer_store_dwordx4 v[72:75],v20,s[8:11],s74 offen offset:2048 sc1
v_fma_f32 v76,-v132,v121,v76
v_fma_f32 v77,-v134,v121,v77
v_fma_f32 v78,-v136,v121,v78
v_fma_f32 v79,-v138,v121,v79
v_fma_f32 v84,-v148,v121,v84
v_fma_f32 v85,-v150,v121,v85
v_fma_f32 v86,-v152,v121,v86
v_fma_f32 v87,-v154,v121,v87
v_mul_f32 v76,v76,v133
v_mul_f32 v77,v77,v135
v_mul_f32 v78,v78,v137
v_mul_f32 v79,v79,v139
v_mul_f32 v84,v84,v149
v_mul_f32 v85,v85,v151
v_mul_f32 v86,v86,v153
v_mul_f32 v87,v87,v155
v_cvt_pk_bf16_f32 v76,v76,v77
v_cvt_pk_bf16_f32 v77,v78,v79
v_cvt_pk_bf16_f32 v78,v84,v85
v_cvt_pk_bf16_f32 v79,v86,v87
buffer_store_dwordx4 v[76:79],v21,s[8:11],s74 offen offset:2048 sc1
s_lshl_b32 s82,s72,6
s_add_u32 s82,s82,s73
s_lshl_b32 s82,s82,9
s_add_u32 s82,s82,s71
s_lshl_b32 s75,s69,2
s_add_u32 s82,s82,s75
s_add_u32 s82,s82,s39
s_mov_b32 s59,s82
s_mov_b32 s82,2147483648
s_mov_b32 s39,2147483648
s_cmp_eq_u32 s55,0
s_cbranch_scc1 QKVV_B1
s_cmp_eq_u32 s55,1
s_cbranch_scc1 QKVV_CD1
s_waitcnt vmcnt(0)
s_mov_b64 exec,1
buffer_store_dword v5,v1,s[8:11],s59 offen sc1
s_mov_b64 exec,-1
s_mov_b32 s59,2147483648
s_cmp_eq_u32 s50,128
s_cbranch_scc1 QKVV_END
s_branch QKVV_COLD1
QKVV_COLD0:
s_cmp_lg_u32 s46,0
s_cbranch_scc1 cp_227
ct_228:
buffer_load_dword v3,v2,s[8:11],s35 offen sc1
buffer_load_dword v14,v4,s[8:11],s41 offen sc1
s_waitcnt vmcnt(0)
v_cmp_eq_u32 vcc,0,v14
s_cmp_eq_u64 vcc,0
s_cselect_b32 s36,0,2147483648
v_cmp_eq_u32 vcc,0,v3
s_cmp_lt_u32 s78,64
s_cselect_b32 s36,s36,2147483648
s_cmp_eq_u64 vcc,0
s_cselect_b32 s60,1,s36
s_cmp_lt_u32 s79,64
s_cselect_b32 s60,s60,s36
s_sub_u32 s61,s78,s79
s_or_b32 s61,s61,s36
s_cmp_lt_u32 s61,16
s_cselect_b32 s36,0,s60
v_mov_b32 v23,s36
s_cmp_lt_u32 s36,2
s_cbranch_scc1 ct_228x
s_sleep 3
s_sub_u32 s47,s47,1
s_cbranch_scc1 ABORT
s_branch ct_228
ct_228x:
ds_write_b32 v22,v23 offset:4
s_waitcnt lgkmcnt(0)
cp_227:
s_barrier
ds_read_b32 v23,v22 offset:4
s_waitcnt lgkmcnt(0)
v_readfirstlane_b32 s38,v23
s_and_b32 s38,s38,1
s_and_b32 s37,s38,2147483648
s_and_b32 s33,s38,1
s_cselect_b32 s34,s79,s78
s_lshl_b32 s60,s33,6
s_add_u32 s60,s60,s34
s_mul_i32 s60,s60,46080
s_add_u32 s60,s60,206569472
s_cmp_eq_u32 s33,0
s_cselect_b32 s67,2147483648,s60
s_mul_i32 s61,s46,10240
s_add_u32 s60,s60,s61
s_add_u32 s61,s61,s57
s_add_u32 m0,s61,0
s_add_u32 s63,s60,0
buffer_load_dwordx4 v1,s[8:11],s63 offen sc1 lds
buffer_load_dwordx4 v1,s[8:11],s63 offen offset:1024 sc1 lds
buffer_load_dwordx4 v1,s[8:11],s63 offen offset:2048 sc1 lds
buffer_load_dwordx4 v1,s[8:11],s63 offen offset:3072 sc1 lds
s_add_u32 m0,s61,4096
s_add_u32 s63,s60,4096
buffer_load_dwordx4 v1,s[8:11],s63 offen sc1 lds
buffer_load_dwordx4 v1,s[8:11],s63 offen offset:1024 sc1 lds
buffer_load_dwordx4 v1,s[8:11],s63 offen offset:2048 sc1 lds
buffer_load_dwordx4 v1,s[8:11],s63 offen offset:3072 sc1 lds
s_add_u32 m0,s61,8192
s_add_u32 s63,s60,8192
buffer_load_dwordx4 v1,s[8:11],s63 offen sc1 lds
buffer_load_dwordx4 v1,s[8:11],s63 offen offset:1024 sc1 lds
s_lshl_b32 s62,s46,10
s_add_u32 s62,s62,40960
s_add_u32 m0,s57,s62
s_add_u32 s63,s67,s62
buffer_load_dwordx4 v1,s[8:11],s63 offen sc1 lds
s_add_u32 m0,s57,45056
s_add_u32 s63,s67,45056
buffer_load_dwordx4 v1,s[8:11],s63 offen sc1 lds
QKVV_CD0:
s_mov_b32 s51,s33
s_mov_b32 s52,s34
s_mov_b32 s53,s33
s_mov_b32 s54,s34
s_add_u32 s79,s79,s33
s_or_b32 s60,s37,s33
s_cmp_eq_u32 s60,0
s_addc_u32 s78,s78,0
s_lshl_b32 s41,s78,9
s_add_u32 s41,s41,s40
s_lshl_b32 s35,s79,9
s_add_u32 s35,s35,s40
s_add_u32 s35,s35,32768
buffer_load_dword v3,v2,s[8:11],s35 offen sc1
buffer_load_dword v14,v4,s[8:11],s41 offen sc1
s_waitcnt vmcnt(0)
s_mov_b64 exec,1
buffer_store_dword v5,v1,s[8:11],s59 offen sc1
s_mov_b64 exec,-1
s_mov_b32 s59,2147483648
v_cmp_eq_u32 vcc,0,v14
s_cmp_eq_u64 vcc,0
s_cselect_b32 s36,0,2147483648
v_cmp_eq_u32 vcc,0,v3
s_cmp_lt_u32 s78,64
s_cselect_b32 s36,s36,2147483648
s_cmp_eq_u64 vcc,0
s_cselect_b32 s60,1,s36
s_cmp_lt_u32 s79,64
s_cselect_b32 s60,s60,s36
s_sub_u32 s61,s78,s79
s_or_b32 s61,s61,s36
s_cmp_lt_u32 s61,16
s_cselect_b32 s36,0,s60
v_mov_b32 v23,s36
ds_write_b32 v13,v23
s_waitcnt lgkmcnt(0)
s_barrier
ds_read_b32 v23,v22
ds_read_b128 v[24:27],v16 offset:0
ds_read_b128 v[28:31],v17 offset:0
ds_read_b128 v[32:35],v16 offset:2048
ds_read_b128 v[36:39],v17 offset:2048
ds_read_b128 v[40:43],v16 offset:4096
s_waitcnt lgkmcnt(5)
v_readfirstlane_b32 s38,v23
s_and_b32 s37,s38,2147483648
s_and_b32 s33,s38,1
s_cselect_b32 s34,s79,s78
s_nop 0
s_branch QKVV_B0
QKVV_S1:
s_mov_b32 s55,0
s_cmp_lt_u32 s42,2
s_cbranch_scc1 nt_229
s_mov_b32 s55,2
s_cmp_lg_u32 s37,0
s_cbranch_scc1 nt_229
s_mov_b32 s55,1
s_lshl_b32 s60,s33,6
s_add_u32 s60,s60,s34
s_mul_i32 s60,s60,46080
s_add_u32 s60,s60,206569472
s_cmp_eq_u32 s33,0
s_cselect_b32 s67,2147483648,s60
s_mul_i32 s61,s46,10240
s_add_u32 s60,s60,s61
s_add_u32 s61,s61,s57
s_add_u32 m0,s61,0
s_add_u32 s63,s60,0
buffer_load_dwordx4 v1,s[8:11],s63 offen sc1 lds
buffer_load_dwordx4 v1,s[8:11],s63 offen offset:1024 sc1 lds
buffer_load_dwordx4 v1,s[8:11],s63 offen offset:2048 sc1 lds
buffer_load_dwordx4 v1,s[8:11],s63 offen offset:3072 sc1 lds
s_add_u32 m0,s61,4096
s_add_u32 s63,s60,4096
buffer_load_dwordx4 v1,s[8:11],s63 offen sc1 lds
buffer_load_dwordx4 v1,s[8:11],s63 offen offset:1024 sc1 lds
buffer_load_dwordx4 v1,s[8:11],s63 offen offset:2048 sc1 lds
buffer_load_dwordx4 v1,s[8:11],s63 offen offset:3072 sc1 lds
s_add_u32 m0,s61,8192
s_add_u32 s63,s60,8192
buffer_load_dwordx4 v1,s[8:11],s63 offen sc1 lds
buffer_load_dwordx4 v1,s[8:11],s63 offen offset:1024 sc1 lds
s_lshl_b32 s62,s46,10
s_add_u32 s62,s62,40960
s_add_u32 m0,s57,s62
s_add_u32 s63,s67,s62
buffer_load_dwordx4 v1,s[8:11],s63 offen sc1 lds
s_add_u32 m0,s57,45056
s_add_u32 s63,s67,45056
buffer_load_dwordx4 v1,s[8:11],s63 offen sc1 lds
nt_229:
s_nop 4
s_mul_i32 s74,s73,393216
s_add_u32 s74,s74,s39
s_add_u32 s74,s74,s70
v_fma_f32 v88,-v124,v120,v88
v_fma_f32 v89,-v126,v120,v89
v_fma_f32 v90,-v128,v120,v90
v_fma_f32 v91,-v130,v120,v91
v_fma_f32 v96,-v140,v120,v96
v_fma_f32 v97,-v142,v120,v97
v_fma_f32 v98,-v144,v120,v98
v_fma_f32 v99,-v146,v120,v99
v_mul_f32 v88,v88,v125
v_mul_f32 v89,v89,v127
v_mul_f32 v90,v90,v129
v_mul_f32 v91,v91,v131
v_mul_f32 v96,v96,v141
v_mul_f32 v97,v97,v143
v_mul_f32 v98,v98,v145
v_mul_f32 v99,v99,v147
v_cvt_pk_bf16_f32 v88,v88,v89
v_cvt_pk_bf16_f32 v89,v90,v91
v_cvt_pk_bf16_f32 v90,v96,v97
v_cvt_pk_bf16_f32 v91,v98,v99
buffer_store_dwordx4 v[88:91],v20,s[8:11],s74 offen sc1
v_fma_f32 v92,-v132,v120,v92
v_fma_f32 v93,-v134,v120,v93
v_fma_f32 v94,-v136,v120,v94
v_fma_f32 v95,-v138,v120,v95
v_fma_f32 v100,-v148,v120,v100
v_fma_f32 v101,-v150,v120,v101
v_fma_f32 v102,-v152,v120,v102
v_fma_f32 v103,-v154,v120,v103
v_mul_f32 v92,v92,v133
v_mul_f32 v93,v93,v135
v_mul_f32 v94,v94,v137
v_mul_f32 v95,v95,v139
v_mul_f32 v100,v100,v149
v_mul_f32 v101,v101,v151
v_mul_f32 v102,v102,v153
v_mul_f32 v103,v103,v155
v_cvt_pk_bf16_f32 v92,v92,v93
v_cvt_pk_bf16_f32 v93,v94,v95
v_cvt_pk_bf16_f32 v94,v100,v101
v_cvt_pk_bf16_f32 v95,v102,v103
buffer_store_dwordx4 v[92:95],v21,s[8:11],s74 offen sc1
v_fma_f32 v104,-v124,v121,v104
v_fma_f32 v105,-v126,v121,v105
v_fma_f32 v106,-v128,v121,v106
v_fma_f32 v107,-v130,v121,v107
v_fma_f32 v112,-v140,v121,v112
v_fma_f32 v113,-v142,v121,v113
v_fma_f32 v114,-v144,v121,v114
v_fma_f32 v115,-v146,v121,v115
v_mul_f32 v104,v104,v125
v_mul_f32 v105,v105,v127
v_mul_f32 v106,v106,v129
v_mul_f32 v107,v107,v131
v_mul_f32 v112,v112,v141
v_mul_f32 v113,v113,v143
v_mul_f32 v114,v114,v145
v_mul_f32 v115,v115,v147
v_cvt_pk_bf16_f32 v104,v104,v105
v_cvt_pk_bf16_f32 v105,v106,v107
v_cvt_pk_bf16_f32 v106,v112,v113
v_cvt_pk_bf16_f32 v107,v114,v115
buffer_store_dwordx4 v[104:107],v20,s[8:11],s74 offen offset:2048 sc1
v_fma_f32 v108,-v132,v121,v108
v_fma_f32 v109,-v134,v121,v109
v_fma_f32 v110,-v136,v121,v110
v_fma_f32 v111,-v138,v121,v111
v_fma_f32 v116,-v148,v121,v116
v_fma_f32 v117,-v150,v121,v117
v_fma_f32 v118,-v152,v121,v118
v_fma_f32 v119,-v154,v121,v119
v_mul_f32 v108,v108,v133
v_mul_f32 v109,v109,v135
v_mul_f32 v110,v110,v137
v_mul_f32 v111,v111,v139
v_mul_f32 v116,v116,v149
v_mul_f32 v117,v117,v151
v_mul_f32 v118,v118,v153
v_mul_f32 v119,v119,v155
v_cvt_pk_bf16_f32 v108,v108,v109
v_cvt_pk_bf16_f32 v109,v110,v111
v_cvt_pk_bf16_f32 v110,v116,v117
v_cvt_pk_bf16_f32 v111,v118,v119
buffer_store_dwordx4 v[108:111],v21,s[8:11],s74 offen offset:2048 sc1
s_lshl_b32 s82,s72,6
s_add_u32 s82,s82,s73
s_lshl_b32 s82,s82,9
s_add_u32 s82,s82,s71
s_lshl_b32 s75,s69,2
s_add_u32 s82,s82,s75
s_add_u32 s82,s82,s39
s_mov_b32 s59,s82
s_mov_b32 s82,2147483648
s_mov_b32 s39,2147483648
s_cmp_eq_u32 s55,0
s_cbranch_scc1 QKVV_B0
s_cmp_eq_u32 s55,1
s_cbranch_scc1 QKVV_CD0
s_waitcnt vmcnt(0)
s_mov_b64 exec,1
buffer_store_dword v5,v1,s[8:11],s59 offen sc1
s_mov_b64 exec,-1
s_mov_b32 s59,2147483648
s_cmp_eq_u32 s50,128
s_cbranch_scc1 QKVV_END
s_branch QKVV_COLD0
QKVV_COLD1:
s_cmp_lg_u32 s46,0
s_cbranch_scc1 cp_230
ct_231:
buffer_load_dword v3,v2,s[8:11],s35 offen sc1
buffer_load_dword v14,v4,s[8:11],s41 offen sc1
s_waitcnt vmcnt(0)
v_cmp_eq_u32 vcc,0,v14
s_cmp_eq_u64 vcc,0
s_cselect_b32 s36,0,2147483648
v_cmp_eq_u32 vcc,0,v3
s_cmp_lt_u32 s78,64
s_cselect_b32 s36,s36,2147483648
s_cmp_eq_u64 vcc,0
s_cselect_b32 s60,1,s36
s_cmp_lt_u32 s79,64
s_cselect_b32 s60,s60,s36
s_sub_u32 s61,s78,s79
s_or_b32 s61,s61,s36
s_cmp_lt_u32 s61,16
s_cselect_b32 s36,0,s60
v_mov_b32 v23,s36
s_cmp_lt_u32 s36,2
s_cbranch_scc1 ct_231x
s_sleep 3
s_sub_u32 s47,s47,1
s_cbranch_scc1 ABORT
s_branch ct_231
ct_231x:
ds_write_b32 v22,v23 offset:4
s_waitcnt lgkmcnt(0)
cp_230:
s_barrier
ds_read_b32 v23,v22 offset:4
s_waitcnt lgkmcnt(0)
v_readfirstlane_b32 s38,v23
s_and_b32 s38,s38,1
s_and_b32 s37,s38,2147483648
s_and_b32 s33,s38,1
s_cselect_b32 s34,s79,s78
s_lshl_b32 s60,s33,6
s_add_u32 s60,s60,s34
s_mul_i32 s60,s60,46080
s_add_u32 s60,s60,206569472
s_cmp_eq_u32 s33,0
s_cselect_b32 s67,2147483648,s60
s_mul_i32 s61,s46,10240
s_add_u32 s60,s60,s61
s_add_u32 s61,s61,s57
s_add_u32 m0,s61,0
s_add_u32 s63,s60,0
buffer_load_dwordx4 v1,s[8:11],s63 offen sc1 lds
buffer_load_dwordx4 v1,s[8:11],s63 offen offset:1024 sc1 lds
buffer_load_dwordx4 v1,s[8:11],s63 offen offset:2048 sc1 lds
buffer_load_dwordx4 v1,s[8:11],s63 offen offset:3072 sc1 lds
s_add_u32 m0,s61,4096
s_add_u32 s63,s60,4096
buffer_load_dwordx4 v1,s[8:11],s63 offen sc1 lds
buffer_load_dwordx4 v1,s[8:11],s63 offen offset:1024 sc1 lds
buffer_load_dwordx4 v1,s[8:11],s63 offen offset:2048 sc1 lds
buffer_load_dwordx4 v1,s[8:11],s63 offen offset:3072 sc1 lds
s_add_u32 m0,s61,8192
s_add_u32 s63,s60,8192
buffer_load_dwordx4 v1,s[8:11],s63 offen sc1 lds
buffer_load_dwordx4 v1,s[8:11],s63 offen offset:1024 sc1 lds
s_lshl_b32 s62,s46,10
s_add_u32 s62,s62,40960
s_add_u32 m0,s57,s62
s_add_u32 s63,s67,s62
buffer_load_dwordx4 v1,s[8:11],s63 offen sc1 lds
s_add_u32 m0,s57,45056
s_add_u32 s63,s67,45056
buffer_load_dwordx4 v1,s[8:11],s63 offen sc1 lds
QKVV_CD1:
s_mov_b32 s51,s33
s_mov_b32 s52,s34
s_mov_b32 s53,s33
s_mov_b32 s54,s34
s_add_u32 s79,s79,s33
s_or_b32 s60,s37,s33
s_cmp_eq_u32 s60,0
s_addc_u32 s78,s78,0
s_lshl_b32 s41,s78,9
s_add_u32 s41,s41,s40
s_lshl_b32 s35,s79,9
s_add_u32 s35,s35,s40
s_add_u32 s35,s35,32768
buffer_load_dword v3,v2,s[8:11],s35 offen sc1
buffer_load_dword v14,v4,s[8:11],s41 offen sc1
s_waitcnt vmcnt(0)
s_mov_b64 exec,1
buffer_store_dword v5,v1,s[8:11],s59 offen sc1
s_mov_b64 exec,-1
s_mov_b32 s59,2147483648
v_cmp_eq_u32 vcc,0,v14
s_cmp_eq_u64 vcc,0
s_cselect_b32 s36,0,2147483648
v_cmp_eq_u32 vcc,0,v3
s_cmp_lt_u32 s78,64
s_cselect_b32 s36,s36,2147483648
s_cmp_eq_u64 vcc,0
s_cselect_b32 s60,1,s36
s_cmp_lt_u32 s79,64
s_cselect_b32 s60,s60,s36
s_sub_u32 s61,s78,s79
s_or_b32 s61,s61,s36
s_cmp_lt_u32 s61,16
s_cselect_b32 s36,0,s60
v_mov_b32 v23,s36
ds_write_b32 v13,v23
s_waitcnt lgkmcnt(0)
s_barrier
ds_read_b32 v23,v22
ds_read_b128 v[24:27],v18 offset:0
ds_read_b128 v[28:31],v19 offset:0
ds_read_b128 v[32:35],v18 offset:2048
ds_read_b128 v[36:39],v19 offset:2048
ds_read_b128 v[40:43],v18 offset:4096
s_waitcnt lgkmcnt(5)
v_readfirstlane_b32 s38,v23
s_and_b32 s37,s38,2147483648
s_and_b32 s33,s38,1
s_cselect_b32 s34,s79,s78
s_nop 0
s_branch QKVV_B1
QKVV_END:
s_endpgm
ROLE_ATT:
v_lshlrev_b32 v1,4,v0
v_mov_b32 v5,1
s_lshl_b32 s56,s48,2
s_add_u32 s56,s56,s46
v_bfe_u32 v6,v0,2,2
v_lshrrev_b32 v7,4,v0
v_add_u32 v7,v6,v7
v_and_b32 v7,3,v7
v_and_b32 v15,3,v0
v_lshlrev_b32 v15,4,v15
v_lshl_add_u32 v15,v7,6,v15
v_lshl_add_u32 v15,v6,8,v15
s_mov_b32 s68,s48
s_and_b32 s51,s46,1
s_lshr_b32 s86,s46,1
s_lshr_b32 s87,s68,3
s_lshl_b32 s87,s87,5
s_and_b32 s60,s68,7
s_add_u32 s87,s87,s60
v_lshlrev_b32 v229,3,v0
v_and_b32 v229,0x300,v1
v_add_u32 v229,v229,v1
v_mov_b32 v230,0xff800000
s_mov_b32 s80,-1
s_mov_b32 s81,0
s_mov_b32 s84,0x3d93cd3a
s_mov_b32 s85,0x3fb8aa3b
v_min_u32 v6,8,v0
v_mul_u32_u24 v7,86,v6
v_lshrrev_b32 v7,8,v7
v_mul_u32_u24 v8,3,v7
v_sub_u32 v6,v6,v8
s_mul_i32 s60,s68,3
v_add_u32 v6,s60,v6
v_lshlrev_b32 v2,2,v6
v_lshl_add_u32 v2,v7,16,v2
v_min_u32 v228,2,v0
v_lshlrev_b32 v228,2,v228
v_lshrrev_b32 v6,4,v0
v_lshlrev_b32 v6,2,v6
v_and_b32 v7,15,v0
v_add_u32 v8,0,v6
v_cmp_le_u32 s[72:73],v8,v7
v_add_u32 v8,1,v6
v_cmp_le_u32 s[74:75],v8,v7
v_add_u32 v8,2,v6
v_cmp_le_u32 s[76:77],v8,v7
v_add_u32 v8,3,v6
v_cmp_le_u32 s[78:79],v8,v7
s_mul_i32 s71,s68,12288
s_mul_i32 s60,s51,13
s_mul_i32 s69,s60,589824
s_mul_i32 s61,s68,18432
s_add_u32 s69,s69,s61
s_mul_i32 s61,s51,9216
s_add_u32 s69,s69,s61
s_add_u32 s69,s69,24120320
s_mul_i32 s70,s60,2048
s_lshl_b32 s61,s68,6
s_add_u32 s70,s70,s61
s_add_u32 s70,s70,688128
s_mul_i32 s69,s51,3145728
s_mul_i32 s61,s68,6144
s_add_u32 s69,s69,s61
s_add_u32 s69,s69,24117248
s_mul_i32 s70,s51,65536
s_lshl_b32 s61,s68,5
s_add_u32 s70,s70,s61
s_add_u32 s70,s70,688128
s_waitcnt vmcnt(0)
s_barrier
s_cmp_lg_u32 s46,0
s_cbranch_scc1 arr_232
v_mov_b32 v6,1
s_lshl_b32 s3,s49,2
v_mov_b32 v7,s3
s_mov_b64 exec,1
buffer_atomic_add v6,v7,s[12:15],0 offen sc1
s_mov_b64 exec,-1
arr_232:
s_mov_b32 s66,s56
s_and_b32 s53,s66,7
s_lshr_b32 s54,s66,3
v_lshrrev_b32 v6,4,v0
v_bfe_u32 v7,v0,2,2
v_and_b32 v8,3,v0
s_and_b32 s61,s53,3
s_lshl_b32 s60,s53,8
v_lshlrev_b32 v132,11,v6
v_lshrrev_b32 v9,1,v6
v_lshlrev_b32 v132,11,v9
v_and_b32 v9,1,v6
v_lshl_add_u32 v132,v9,12,v132
v_add_u32 v9,s61,v7
v_and_b32 v9,3,v9
v_lshl_add_u32 v132,v9,6,v132
v_lshl_add_u32 v132,v8,4,v132
v_add_u32 v132,s60,v132
s_lshl_b32 s60,s53,2
v_add_u32 v9,s60,v8
v_mul_u32_u24 v133,1280,v9
v_lshl_add_u32 v133,v6,5,v133
v_lshl_add_u32 v133,v7,3,v133
s_mov_b32 s4,s16
s_mov_b32 s5,s17
s_mov_b32 s6,2621440
s_mov_b32 s7,0x20000
s_mov_b32 s55,0
s_mul_i32 s62,s54,40960
buffer_load_dwordx2 v[32:33],v133,s[4:7],s62 offen offset:0
buffer_load_dwordx2 v[34:35],v133,s[4:7],s62 offen offset:128
buffer_load_dwordx2 v[36:37],v133,s[4:7],s62 offen offset:256
buffer_load_dwordx2 v[38:39],v133,s[4:7],s62 offen offset:384
buffer_load_dwordx2 v[40:41],v133,s[4:7],s62 offen offset:512
buffer_load_dwordx2 v[42:43],v133,s[4:7],s62 offen offset:640
buffer_load_dwordx2 v[44:45],v133,s[4:7],s62 offen offset:768
buffer_load_dwordx2 v[46:47],v133,s[4:7],s62 offen offset:896
buffer_load_dwordx2 v[48:49],v133,s[4:7],s62 offen offset:1024
buffer_load_dwordx2 v[50:51],v133,s[4:7],s62 offen offset:1152
s_add_u32 s66,s54,16
s_min_u32 s66,s66,63
s_mul_i32 s62,s66,40960
buffer_load_dwordx2 v[52:53],v133,s[4:7],s62 offen offset:0
buffer_load_dwordx2 v[54:55],v133,s[4:7],s62 offen offset:128
buffer_load_dwordx2 v[56:57],v133,s[4:7],s62 offen offset:256
buffer_load_dwordx2 v[58:59],v133,s[4:7],s62 offen offset:384
buffer_load_dwordx2 v[60:61],v133,s[4:7],s62 offen offset:512
buffer_load_dwordx2 v[62:63],v133,s[4:7],s62 offen offset:640
buffer_load_dwordx2 v[64:65],v133,s[4:7],s62 offen offset:768
buffer_load_dwordx2 v[66:67],v133,s[4:7],s62 offen offset:896
buffer_load_dwordx2 v[68:69],v133,s[4:7],s62 offen offset:1024
buffer_load_dwordx2 v[70:71],v133,s[4:7],s62 offen offset:1152
s_mul_i32 s64,s54,40960
s_add_u32 s64,s64,234749952
s_mul_i32 s65,s54,46080
s_add_u32 s65,s65,206569472
s_waitcnt vmcnt(10)
v_lshlrev_b32 v72,16,v32
v_and_b32 v73,0xffff0000,v32
v_lshlrev_b32 v74,16,v33
v_and_b32 v75,0xffff0000,v33
v_lshlrev_b32 v76,16,v34
v_and_b32 v77,0xffff0000,v34
v_lshlrev_b32 v78,16,v35
v_and_b32 v79,0xffff0000,v35
v_lshlrev_b32 v80,16,v36
v_and_b32 v81,0xffff0000,v36
v_lshlrev_b32 v82,16,v37
v_and_b32 v83,0xffff0000,v37
v_lshlrev_b32 v84,16,v38
v_and_b32 v85,0xffff0000,v38
v_lshlrev_b32 v86,16,v39
v_and_b32 v87,0xffff0000,v39
v_lshlrev_b32 v88,16,v40
v_and_b32 v89,0xffff0000,v40
v_lshlrev_b32 v90,16,v41
v_and_b32 v91,0xffff0000,v41
v_lshlrev_b32 v92,16,v42
v_and_b32 v93,0xffff0000,v42
v_lshlrev_b32 v94,16,v43
v_and_b32 v95,0xffff0000,v43
v_lshlrev_b32 v96,16,v44
v_and_b32 v97,0xffff0000,v44
v_lshlrev_b32 v98,16,v45
v_and_b32 v99,0xffff0000,v45
v_lshlrev_b32 v100,16,v46
v_and_b32 v101,0xffff0000,v46
v_lshlrev_b32 v102,16,v47
v_and_b32 v103,0xffff0000,v47
v_lshlrev_b32 v104,16,v48
v_and_b32 v105,0xffff0000,v48
v_lshlrev_b32 v106,16,v49
v_and_b32 v107,0xffff0000,v49
v_lshlrev_b32 v108,16,v50
v_and_b32 v109,0xffff0000,v50
v_lshlrev_b32 v110,16,v51
v_and_b32 v111,0xffff0000,v51
v_pk_add_f32 v[28:29],v[72:73],v[74:75]
v_pk_mul_f32 v[26:27],v[72:73],v[72:73]
v_pk_fma_f32 v[26:27],v[74:75],v[74:75],v[26:27]
v_pk_add_f32 v[28:29],v[28:29],v[76:77]
v_pk_fma_f32 v[26:27],v[76:77],v[76:77],v[26:27]
v_pk_add_f32 v[28:29],v[28:29],v[78:79]
v_pk_fma_f32 v[26:27],v[78:79],v[78:79],v[26:27]
v_pk_add_f32 v[28:29],v[28:29],v[80:81]
v_pk_fma_f32 v[26:27],v[80:81],v[80:81],v[26:27]
v_pk_add_f32 v[28:29],v[28:29],v[82:83]
v_pk_fma_f32 v[26:27],v[82:83],v[82:83],v[26:27]
v_pk_add_f32 v[28:29],v[28:29],v[84:85]
v_pk_fma_f32 v[26:27],v[84:85],v[84:85],v[26:27]
v_pk_add_f32 v[28:29],v[28:29],v[86:87]
v_pk_fma_f32 v[26:27],v[86:87],v[86:87],v[26:27]
v_pk_add_f32 v[28:29],v[28:29],v[88:89]
v_pk_fma_f32 v[26:27],v[88:89],v[88:89],v[26:27]
v_pk_add_f32 v[28:29],v[28:29],v[90:91]
v_pk_fma_f32 v[26:27],v[90:91],v[90:91],v[26:27]
v_pk_add_f32 v[28:29],v[28:29],v[92:93]
v_pk_fma_f32 v[26:27],v[92:93],v[92:93],v[26:27]
v_pk_add_f32 v[28:29],v[28:29],v[94:95]
v_pk_fma_f32 v[26:27],v[94:95],v[94:95],v[26:27]
v_pk_add_f32 v[28:29],v[28:29],v[96:97]
v_pk_fma_f32 v[26:27],v[96:97],v[96:97],v[26:27]
v_pk_add_f32 v[28:29],v[28:29],v[98:99]
v_pk_fma_f32 v[26:27],v[98:99],v[98:99],v[26:27]
v_pk_add_f32 v[28:29],v[28:29],v[100:101]
v_pk_fma_f32 v[26:27],v[100:101],v[100:101],v[26:27]
v_pk_add_f32 v[28:29],v[28:29],v[102:103]
v_pk_fma_f32 v[26:27],v[102:103],v[102:103],v[26:27]
v_pk_add_f32 v[28:29],v[28:29],v[104:105]
v_pk_fma_f32 v[26:27],v[104:105],v[104:105],v[26:27]
v_pk_add_f32 v[28:29],v[28:29],v[106:107]
v_pk_fma_f32 v[26:27],v[106:107],v[106:107],v[26:27]
v_pk_add_f32 v[28:29],v[28:29],v[108:109]
v_pk_fma_f32 v[26:27],v[108:109],v[108:109],v[26:27]
v_pk_add_f32 v[28:29],v[28:29],v[110:111]
v_pk_fma_f32 v[26:27],v[110:111],v[110:111],v[26:27]
v_add_f32 v24,v28,v29
v_add_f32 v25,v26,v27
s_nop 0
v_add_f32_dpp v24,v24,v24 row_ror:4 row_mask:0xf bank_mask:0xf
v_add_f32_dpp v25,v25,v25 row_ror:4 row_mask:0xf bank_mask:0xf
s_nop 0
v_add_f32_dpp v24,v24,v24 row_ror:8 row_mask:0xf bank_mask:0xf
v_add_f32_dpp v25,v25,v25 row_ror:8 row_mask:0xf bank_mask:0xf
v_mov_b32 v26,v24
v_mov_b32 v27,v25
s_nop 0
v_permlane32_swap_b32 v24,v26
v_permlane32_swap_b32 v25,v27
v_add_f32 v24,v24,v26
v_add_f32 v25,v25,v27
v_mov_b32 v26,v24
v_mov_b32 v27,v25
s_nop 0
v_permlane16_swap_b32 v24,v26
v_permlane16_swap_b32 v25,v27
v_add_f32 v24,v24,v26
v_add_f32 v25,v25,v27
v_mul_f32 v24,0x3acccccd,v24
v_mul_f32 v25,0x3acccccd,v25
v_fma_f32 v25,-v24,v24,v25
v_max_f32 v25,0,v25
v_cvt_pk_bf16_f32 v6,v24,v25
v_lshlrev_b32 v24,16,v6
v_and_b32 v25,0xffff0000,v6
v_add_f32 v25,0x3727c5ac,v25
v_cvt_pk_bf16_f32 v6,v25,v25
v_lshlrev_b32 v25,16,v6
v_sqrt_f32 v25,v25
s_nop 0
v_cvt_pk_bf16_f32 v6,v25,v25
v_lshlrev_b32 v25,16,v6
v_rcp_f32 v25,v25
s_nop 0
v_pk_add_f32 v[72:73],v[72:73],v[24:25] op_sel_hi:[1,0] neg_lo:[0,1] neg_hi:[0,1]
v_pk_add_f32 v[74:75],v[74:75],v[24:25] op_sel_hi:[1,0] neg_lo:[0,1] neg_hi:[0,1]
v_pk_add_f32 v[76:77],v[76:77],v[24:25] op_sel_hi:[1,0] neg_lo:[0,1] neg_hi:[0,1]
v_pk_add_f32 v[78:79],v[78:79],v[24:25] op_sel_hi:[1,0] neg_lo:[0,1] neg_hi:[0,1]
v_pk_add_f32 v[80:81],v[80:81],v[24:25] op_sel_hi:[1,0] neg_lo:[0,1] neg_hi:[0,1]
v_pk_add_f32 v[82:83],v[82:83],v[24:25] op_sel_hi:[1,0] neg_lo:[0,1] neg_hi:[0,1]
v_pk_add_f32 v[84:85],v[84:85],v[24:25] op_sel_hi:[1,0] neg_lo:[0,1] neg_hi:[0,1]
v_pk_add_f32 v[86:87],v[86:87],v[24:25] op_sel_hi:[1,0] neg_lo:[0,1] neg_hi:[0,1]
v_pk_add_f32 v[88:89],v[88:89],v[24:25] op_sel_hi:[1,0] neg_lo:[0,1] neg_hi:[0,1]
v_pk_add_f32 v[90:91],v[90:91],v[24:25] op_sel_hi:[1,0] neg_lo:[0,1] neg_hi:[0,1]
v_pk_add_f32 v[92:93],v[92:93],v[24:25] op_sel_hi:[1,0] neg_lo:[0,1] neg_hi:[0,1]
v_pk_add_f32 v[94:95],v[94:95],v[24:25] op_sel_hi:[1,0] neg_lo:[0,1] neg_hi:[0,1]
v_pk_add_f32 v[96:97],v[96:97],v[24:25] op_sel_hi:[1,0] neg_lo:[0,1] neg_hi:[0,1]
v_pk_add_f32 v[98:99],v[98:99],v[24:25] op_sel_hi:[1,0] neg_lo:[0,1] neg_hi:[0,1]
v_pk_add_f32 v[100:101],v[100:101],v[24:25] op_sel_hi:[1,0] neg_lo:[0,1] neg_hi:[0,1]
v_pk_add_f32 v[102:103],v[102:103],v[24:25] op_sel_hi:[1,0] neg_lo:[0,1] neg_hi:[0,1]
v_pk_add_f32 v[104:105],v[104:105],v[24:25] op_sel_hi:[1,0] neg_lo:[0,1] neg_hi:[0,1]
v_pk_add_f32 v[106:107],v[106:107],v[24:25] op_sel_hi:[1,0] neg_lo:[0,1] neg_hi:[0,1]
v_pk_add_f32 v[108:109],v[108:109],v[24:25] op_sel_hi:[1,0] neg_lo:[0,1] neg_hi:[0,1]
v_pk_add_f32 v[110:111],v[110:111],v[24:25] op_sel_hi:[1,0] neg_lo:[0,1] neg_hi:[0,1]
v_cvt_pk_bf16_f32 v6,v72,v73
v_lshlrev_b32 v72,16,v6
v_and_b32 v73,0xffff0000,v6
v_cvt_pk_bf16_f32 v8,v74,v75
v_lshlrev_b32 v74,16,v8
v_and_b32 v75,0xffff0000,v8
v_cvt_pk_bf16_f32 v6,v76,v77
v_lshlrev_b32 v76,16,v6
v_and_b32 v77,0xffff0000,v6
v_cvt_pk_bf16_f32 v8,v78,v79
v_lshlrev_b32 v78,16,v8
v_and_b32 v79,0xffff0000,v8
v_cvt_pk_bf16_f32 v6,v80,v81
v_lshlrev_b32 v80,16,v6
v_and_b32 v81,0xffff0000,v6
v_cvt_pk_bf16_f32 v8,v82,v83
v_lshlrev_b32 v82,16,v8
v_and_b32 v83,0xffff0000,v8
v_cvt_pk_bf16_f32 v6,v84,v85
v_lshlrev_b32 v84,16,v6
v_and_b32 v85,0xffff0000,v6
v_cvt_pk_bf16_f32 v8,v86,v87
v_lshlrev_b32 v86,16,v8
v_and_b32 v87,0xffff0000,v8
v_cvt_pk_bf16_f32 v6,v88,v89
v_lshlrev_b32 v88,16,v6
v_and_b32 v89,0xffff0000,v6
v_cvt_pk_bf16_f32 v8,v90,v91
v_lshlrev_b32 v90,16,v8
v_and_b32 v91,0xffff0000,v8
v_cvt_pk_bf16_f32 v6,v92,v93
v_lshlrev_b32 v92,16,v6
v_and_b32 v93,0xffff0000,v6
v_cvt_pk_bf16_f32 v8,v94,v95
v_lshlrev_b32 v94,16,v8
v_and_b32 v95,0xffff0000,v8
v_cvt_pk_bf16_f32 v6,v96,v97
v_lshlrev_b32 v96,16,v6
v_and_b32 v97,0xffff0000,v6
v_cvt_pk_bf16_f32 v8,v98,v99
v_lshlrev_b32 v98,16,v8
v_and_b32 v99,0xffff0000,v8
v_cvt_pk_bf16_f32 v6,v100,v101
v_lshlrev_b32 v100,16,v6
v_and_b32 v101,0xffff0000,v6
v_cvt_pk_bf16_f32 v8,v102,v103
v_lshlrev_b32 v102,16,v8
v_and_b32 v103,0xffff0000,v8
v_cvt_pk_bf16_f32 v6,v104,v105
v_lshlrev_b32 v104,16,v6
v_and_b32 v105,0xffff0000,v6
v_cvt_pk_bf16_f32 v8,v106,v107
v_lshlrev_b32 v106,16,v8
v_and_b32 v107,0xffff0000,v8
v_cvt_pk_bf16_f32 v6,v108,v109
v_lshlrev_b32 v108,16,v6
v_and_b32 v109,0xffff0000,v6
v_cvt_pk_bf16_f32 v8,v110,v111
v_lshlrev_b32 v110,16,v8
v_and_b32 v111,0xffff0000,v8
v_pk_mul_f32 v[72:73],v[72:73],v[24:25] op_sel:[0,1] op_sel_hi:[1,1]
v_pk_mul_f32 v[74:75],v[74:75],v[24:25] op_sel:[0,1] op_sel_hi:[1,1]
v_pk_mul_f32 v[76:77],v[76:77],v[24:25] op_sel:[0,1] op_sel_hi:[1,1]
v_pk_mul_f32 v[78:79],v[78:79],v[24:25] op_sel:[0,1] op_sel_hi:[1,1]
v_pk_mul_f32 v[80:81],v[80:81],v[24:25] op_sel:[0,1] op_sel_hi:[1,1]
v_pk_mul_f32 v[82:83],v[82:83],v[24:25] op_sel:[0,1] op_sel_hi:[1,1]
v_pk_mul_f32 v[84:85],v[84:85],v[24:25] op_sel:[0,1] op_sel_hi:[1,1]
v_pk_mul_f32 v[86:87],v[86:87],v[24:25] op_sel:[0,1] op_sel_hi:[1,1]
v_pk_mul_f32 v[88:89],v[88:89],v[24:25] op_sel:[0,1] op_sel_hi:[1,1]
v_pk_mul_f32 v[90:91],v[90:91],v[24:25] op_sel:[0,1] op_sel_hi:[1,1]
v_pk_mul_f32 v[92:93],v[92:93],v[24:25] op_sel:[0,1] op_sel_hi:[1,1]
v_pk_mul_f32 v[94:95],v[94:95],v[24:25] op_sel:[0,1] op_sel_hi:[1,1]
v_pk_mul_f32 v[96:97],v[96:97],v[24:25] op_sel:[0,1] op_sel_hi:[1,1]
v_pk_mul_f32 v[98:99],v[98:99],v[24:25] op_sel:[0,1] op_sel_hi:[1,1]
v_pk_mul_f32 v[100:101],v[100:101],v[24:25] op_sel:[0,1] op_sel_hi:[1,1]
v_pk_mul_f32 v[102:103],v[102:103],v[24:25] op_sel:[0,1] op_sel_hi:[1,1]
v_pk_mul_f32 v[104:105],v[104:105],v[24:25] op_sel:[0,1] op_sel_hi:[1,1]
v_pk_mul_f32 v[106:107],v[106:107],v[24:25] op_sel:[0,1] op_sel_hi:[1,1]
v_pk_mul_f32 v[108:109],v[108:109],v[24:25] op_sel:[0,1] op_sel_hi:[1,1]
v_pk_mul_f32 v[110:111],v[110:111],v[24:25] op_sel:[0,1] op_sel_hi:[1,1]
v_cvt_pk_bf16_f32 v112,v72,v73
v_lshlrev_b32 v72,16,v112
v_and_b32 v73,0xffff0000,v112
v_cvt_pk_bf16_f32 v113,v74,v75
v_lshlrev_b32 v74,16,v113
v_and_b32 v75,0xffff0000,v113
v_cvt_pk_bf16_f32 v114,v76,v77
v_lshlrev_b32 v76,16,v114
v_and_b32 v77,0xffff0000,v114
v_cvt_pk_bf16_f32 v115,v78,v79
v_lshlrev_b32 v78,16,v115
v_and_b32 v79,0xffff0000,v115
v_cvt_pk_bf16_f32 v116,v80,v81
v_lshlrev_b32 v80,16,v116
v_and_b32 v81,0xffff0000,v116
v_cvt_pk_bf16_f32 v117,v82,v83
v_lshlrev_b32 v82,16,v117
v_and_b32 v83,0xffff0000,v117
v_cvt_pk_bf16_f32 v118,v84,v85
v_lshlrev_b32 v84,16,v118
v_and_b32 v85,0xffff0000,v118
v_cvt_pk_bf16_f32 v119,v86,v87
v_lshlrev_b32 v86,16,v119
v_and_b32 v87,0xffff0000,v119
v_cvt_pk_bf16_f32 v120,v88,v89
v_lshlrev_b32 v88,16,v120
v_and_b32 v89,0xffff0000,v120
v_cvt_pk_bf16_f32 v121,v90,v91
v_lshlrev_b32 v90,16,v121
v_and_b32 v91,0xffff0000,v121
v_cvt_pk_bf16_f32 v122,v92,v93
v_lshlrev_b32 v92,16,v122
v_and_b32 v93,0xffff0000,v122
v_cvt_pk_bf16_f32 v123,v94,v95
v_lshlrev_b32 v94,16,v123
v_and_b32 v95,0xffff0000,v123
v_cvt_pk_bf16_f32 v124,v96,v97
v_lshlrev_b32 v96,16,v124
v_and_b32 v97,0xffff0000,v124
v_cvt_pk_bf16_f32 v125,v98,v99
v_lshlrev_b32 v98,16,v125
v_and_b32 v99,0xffff0000,v125
v_cvt_pk_bf16_f32 v126,v100,v101
v_lshlrev_b32 v100,16,v126
v_and_b32 v101,0xffff0000,v126
v_cvt_pk_bf16_f32 v127,v102,v103
v_lshlrev_b32 v102,16,v127
v_and_b32 v103,0xffff0000,v127
v_cvt_pk_bf16_f32 v128,v104,v105
v_lshlrev_b32 v104,16,v128
v_and_b32 v105,0xffff0000,v128
v_cvt_pk_bf16_f32 v129,v106,v107
v_lshlrev_b32 v106,16,v129
v_and_b32 v107,0xffff0000,v129
v_cvt_pk_bf16_f32 v130,v108,v109
v_lshlrev_b32 v108,16,v130
v_and_b32 v109,0xffff0000,v130
v_cvt_pk_bf16_f32 v131,v110,v111
v_lshlrev_b32 v110,16,v131
v_and_b32 v111,0xffff0000,v131
s_add_u32 s63,s65,0
v_permlane16_swap_b32 v112,v114
v_permlane16_swap_b32 v113,v115
buffer_store_dwordx4 v[112:115],v132,s[8:11],s63 offen sc1
s_add_u32 s63,s65,8192
v_permlane16_swap_b32 v116,v118
v_permlane16_swap_b32 v117,v119
buffer_store_dwordx4 v[116:119],v132,s[8:11],s63 offen sc1
s_add_u32 s63,s65,16384
v_permlane16_swap_b32 v120,v122
v_permlane16_swap_b32 v121,v123
buffer_store_dwordx4 v[120:123],v132,s[8:11],s63 offen sc1
s_add_u32 s63,s65,24576
v_permlane16_swap_b32 v124,v126
v_permlane16_swap_b32 v125,v127
buffer_store_dwordx4 v[124:127],v132,s[8:11],s63 offen sc1
s_add_u32 s63,s65,32768
v_permlane16_swap_b32 v128,v130
v_permlane16_swap_b32 v129,v131
buffer_store_dwordx4 v[128:131],v132,s[8:11],s63 offen sc1
s_add_u32 s63,s64,0
v_permlane16_swap_b32 v32,v34
v_permlane16_swap_b32 v33,v35
buffer_store_dwordx4 v[32:35],v132,s[8:11],s63 offen sc1
s_add_u32 s63,s64,8192
v_permlane16_swap_b32 v36,v38
v_permlane16_swap_b32 v37,v39
buffer_store_dwordx4 v[36:39],v132,s[8:11],s63 offen sc1
s_add_u32 s63,s64,16384
v_permlane16_swap_b32 v40,v42
v_permlane16_swap_b32 v41,v43
buffer_store_dwordx4 v[40:43],v132,s[8:11],s63 offen sc1
s_add_u32 s63,s64,24576
v_permlane16_swap_b32 v44,v46
v_permlane16_swap_b32 v45,v47
buffer_store_dwordx4 v[44:47],v132,s[8:11],s63 offen sc1
s_add_u32 s63,s64,32768
v_permlane16_swap_b32 v48,v50
v_permlane16_swap_b32 v49,v51
buffer_store_dwordx4 v[48:51],v132,s[8:11],s63 offen sc1
s_lshl_b32 s82,s55,6
s_add_u32 s82,s82,s54
s_lshl_b32 s82,s82,9
s_add_u32 s82,s82,0
s_lshl_b32 s61,s53,2
s_add_u32 s82,s82,s61
s_add_u32 s54,s54,16
s_lshl_b32 s3,s49,2
v_mov_b32 v7,s3
s_nop 1
ibw_233:
buffer_load_dword v6,v7,s[12:15],0 offen sc1
s_waitcnt vmcnt(0)
v_cmp_ne_u32 vcc,256,v6
s_nop 0
s_cbranch_vccz ok_234
s_sleep 8
s_sub_u32 s47,s47,1
s_cbranch_scc1 ABORT
s_branch ibw_233
ok_234:
s_cmp_lg_u32 s49,0
s_cbranch_scc1 ibok_235
v_and_b32 v7,7,v0
v_lshlrev_b32 v7,2,v7
buffer_load_dword v6,v7,s[12:15],0 offen offset:32 sc1
s_waitcnt vmcnt(0)
v_cmp_ne_u32 vcc,32,v6
s_nop 0
s_cbranch_vccz ibok_235
s_barrier
s_mov_b32 s49,1
s_mov_b32 s3,s2
s_load_dwordx16 s[16:31],s[0:1],0
s_load_dwordx8 s[32:39],s[0:1],64
s_waitcnt lgkmcnt(0)
s_branch DISPATCH
ibok_235:
s_mov_b64 exec,1
buffer_store_dword v5,v1,s[8:11],s82 offen sc1
s_mov_b64 exec,-1
s_add_u32 s66,s54,16
s_min_u32 s66,s66,63
s_mul_i32 s62,s66,40960
buffer_load_dwordx2 v[32:33],v133,s[4:7],s62 offen offset:0
buffer_load_dwordx2 v[34:35],v133,s[4:7],s62 offen offset:128
buffer_load_dwordx2 v[36:37],v133,s[4:7],s62 offen offset:256
buffer_load_dwordx2 v[38:39],v133,s[4:7],s62 offen offset:384
buffer_load_dwordx2 v[40:41],v133,s[4:7],s62 offen offset:512
buffer_load_dwordx2 v[42:43],v133,s[4:7],s62 offen offset:640
buffer_load_dwordx2 v[44:45],v133,s[4:7],s62 offen offset:768
buffer_load_dwordx2 v[46:47],v133,s[4:7],s62 offen offset:896
buffer_load_dwordx2 v[48:49],v133,s[4:7],s62 offen offset:1024
buffer_load_dwordx2 v[50:51],v133,s[4:7],s62 offen offset:1152
s_mul_i32 s64,s54,40960
s_add_u32 s64,s64,234749952
s_mul_i32 s65,s54,46080
s_add_u32 s65,s65,206569472
s_waitcnt vmcnt(10)
v_lshlrev_b32 v72,16,v52
v_and_b32 v73,0xffff0000,v52
v_lshlrev_b32 v74,16,v53
v_and_b32 v75,0xffff0000,v53
v_lshlrev_b32 v76,16,v54
v_and_b32 v77,0xffff0000,v54
v_lshlrev_b32 v78,16,v55
v_and_b32 v79,0xffff0000,v55
v_lshlrev_b32 v80,16,v56
v_and_b32 v81,0xffff0000,v56
v_lshlrev_b32 v82,16,v57
v_and_b32 v83,0xffff0000,v57
v_lshlrev_b32 v84,16,v58
v_and_b32 v85,0xffff0000,v58
v_lshlrev_b32 v86,16,v59
v_and_b32 v87,0xffff0000,v59
v_lshlrev_b32 v88,16,v60
v_and_b32 v89,0xffff0000,v60
v_lshlrev_b32 v90,16,v61
v_and_b32 v91,0xffff0000,v61
v_lshlrev_b32 v92,16,v62
v_and_b32 v93,0xffff0000,v62
v_lshlrev_b32 v94,16,v63
v_and_b32 v95,0xffff0000,v63
v_lshlrev_b32 v96,16,v64
v_and_b32 v97,0xffff0000,v64
v_lshlrev_b32 v98,16,v65
v_and_b32 v99,0xffff0000,v65
v_lshlrev_b32 v100,16,v66
v_and_b32 v101,0xffff0000,v66
v_lshlrev_b32 v102,16,v67
v_and_b32 v103,0xffff0000,v67
v_lshlrev_b32 v104,16,v68
v_and_b32 v105,0xffff0000,v68
v_lshlrev_b32 v106,16,v69
v_and_b32 v107,0xffff0000,v69
v_lshlrev_b32 v108,16,v70
v_and_b32 v109,0xffff0000,v70
v_lshlrev_b32 v110,16,v71
v_and_b32 v111,0xffff0000,v71
v_pk_add_f32 v[28:29],v[72:73],v[74:75]
v_pk_mul_f32 v[26:27],v[72:73],v[72:73]
v_pk_fma_f32 v[26:27],v[74:75],v[74:75],v[26:27]
v_pk_add_f32 v[28:29],v[28:29],v[76:77]
v_pk_fma_f32 v[26:27],v[76:77],v[76:77],v[26:27]
v_pk_add_f32 v[28:29],v[28:29],v[78:79]
v_pk_fma_f32 v[26:27],v[78:79],v[78:79],v[26:27]
v_pk_add_f32 v[28:29],v[28:29],v[80:81]
v_pk_fma_f32 v[26:27],v[80:81],v[80:81],v[26:27]
v_pk_add_f32 v[28:29],v[28:29],v[82:83]
v_pk_fma_f32 v[26:27],v[82:83],v[82:83],v[26:27]
v_pk_add_f32 v[28:29],v[28:29],v[84:85]
v_pk_fma_f32 v[26:27],v[84:85],v[84:85],v[26:27]
v_pk_add_f32 v[28:29],v[28:29],v[86:87]
v_pk_fma_f32 v[26:27],v[86:87],v[86:87],v[26:27]
v_pk_add_f32 v[28:29],v[28:29],v[88:89]
v_pk_fma_f32 v[26:27],v[88:89],v[88:89],v[26:27]
v_pk_add_f32 v[28:29],v[28:29],v[90:91]
v_pk_fma_f32 v[26:27],v[90:91],v[90:91],v[26:27]
v_pk_add_f32 v[28:29],v[28:29],v[92:93]
v_pk_fma_f32 v[26:27],v[92:93],v[92:93],v[26:27]
v_pk_add_f32 v[28:29],v[28:29],v[94:95]
v_pk_fma_f32 v[26:27],v[94:95],v[94:95],v[26:27]
v_pk_add_f32 v[28:29],v[28:29],v[96:97]
v_pk_fma_f32 v[26:27],v[96:97],v[96:97],v[26:27]
v_pk_add_f32 v[28:29],v[28:29],v[98:99]
v_pk_fma_f32 v[26:27],v[98:99],v[98:99],v[26:27]
v_pk_add_f32 v[28:29],v[28:29],v[100:101]
v_pk_fma_f32 v[26:27],v[100:101],v[100:101],v[26:27]
v_pk_add_f32 v[28:29],v[28:29],v[102:103]
v_pk_fma_f32 v[26:27],v[102:103],v[102:103],v[26:27]
v_pk_add_f32 v[28:29],v[28:29],v[104:105]
v_pk_fma_f32 v[26:27],v[104:105],v[104:105],v[26:27]
v_pk_add_f32 v[28:29],v[28:29],v[106:107]
v_pk_fma_f32 v[26:27],v[106:107],v[106:107],v[26:27]
v_pk_add_f32 v[28:29],v[28:29],v[108:109]
v_pk_fma_f32 v[26:27],v[108:109],v[108:109],v[26:27]
v_pk_add_f32 v[28:29],v[28:29],v[110:111]
v_pk_fma_f32 v[26:27],v[110:111],v[110:111],v[26:27]
v_add_f32 v24,v28,v29
v_add_f32 v25,v26,v27
s_nop 0
v_add_f32_dpp v24,v24,v24 row_ror:4 row_mask:0xf bank_mask:0xf
v_add_f32_dpp v25,v25,v25 row_ror:4 row_mask:0xf bank_mask:0xf
s_nop 0
v_add_f32_dpp v24,v24,v24 row_ror:8 row_mask:0xf bank_mask:0xf
v_add_f32_dpp v25,v25,v25 row_ror:8 row_mask:0xf bank_mask:0xf
v_mov_b32 v26,v24
v_mov_b32 v27,v25
s_nop 0
v_permlane32_swap_b32 v24,v26
v_permlane32_swap_b32 v25,v27
v_add_f32 v24,v24,v26
v_add_f32 v25,v25,v27
v_mov_b32 v26,v24
v_mov_b32 v27,v25
s_nop 0
v_permlane16_swap_b32 v24,v26
v_permlane16_swap_b32 v25,v27
v_add_f32 v24,v24,v26
v_add_f32 v25,v25,v27
v_mul_f32 v24,0x3acccccd,v24
v_mul_f32 v25,0x3acccccd,v25
v_fma_f32 v25,-v24,v24,v25
v_max_f32 v25,0,v25
v_cvt_pk_bf16_f32 v6,v24,v25
v_lshlrev_b32 v24,16,v6
v_and_b32 v25,0xffff0000,v6
v_add_f32 v25,0x3727c5ac,v25
v_cvt_pk_bf16_f32 v6,v25,v25
v_lshlrev_b32 v25,16,v6
v_sqrt_f32 v25,v25
s_nop 0
v_cvt_pk_bf16_f32 v6,v25,v25
v_lshlrev_b32 v25,16,v6
v_rcp_f32 v25,v25
s_nop 0
v_pk_add_f32 v[72:73],v[72:73],v[24:25] op_sel_hi:[1,0] neg_lo:[0,1] neg_hi:[0,1]
v_pk_add_f32 v[74:75],v[74:75],v[24:25] op_sel_hi:[1,0] neg_lo:[0,1] neg_hi:[0,1]
v_pk_add_f32 v[76:77],v[76:77],v[24:25] op_sel_hi:[1,0] neg_lo:[0,1] neg_hi:[0,1]
v_pk_add_f32 v[78:79],v[78:79],v[24:25] op_sel_hi:[1,0] neg_lo:[0,1] neg_hi:[0,1]
v_pk_add_f32 v[80:81],v[80:81],v[24:25] op_sel_hi:[1,0] neg_lo:[0,1] neg_hi:[0,1]
v_pk_add_f32 v[82:83],v[82:83],v[24:25] op_sel_hi:[1,0] neg_lo:[0,1] neg_hi:[0,1]
v_pk_add_f32 v[84:85],v[84:85],v[24:25] op_sel_hi:[1,0] neg_lo:[0,1] neg_hi:[0,1]
v_pk_add_f32 v[86:87],v[86:87],v[24:25] op_sel_hi:[1,0] neg_lo:[0,1] neg_hi:[0,1]
v_pk_add_f32 v[88:89],v[88:89],v[24:25] op_sel_hi:[1,0] neg_lo:[0,1] neg_hi:[0,1]
v_pk_add_f32 v[90:91],v[90:91],v[24:25] op_sel_hi:[1,0] neg_lo:[0,1] neg_hi:[0,1]
v_pk_add_f32 v[92:93],v[92:93],v[24:25] op_sel_hi:[1,0] neg_lo:[0,1] neg_hi:[0,1]
v_pk_add_f32 v[94:95],v[94:95],v[24:25] op_sel_hi:[1,0] neg_lo:[0,1] neg_hi:[0,1]
v_pk_add_f32 v[96:97],v[96:97],v[24:25] op_sel_hi:[1,0] neg_lo:[0,1] neg_hi:[0,1]
v_pk_add_f32 v[98:99],v[98:99],v[24:25] op_sel_hi:[1,0] neg_lo:[0,1] neg_hi:[0,1]
v_pk_add_f32 v[100:101],v[100:101],v[24:25] op_sel_hi:[1,0] neg_lo:[0,1] neg_hi:[0,1]
v_pk_add_f32 v[102:103],v[102:103],v[24:25] op_sel_hi:[1,0] neg_lo:[0,1] neg_hi:[0,1]
v_pk_add_f32 v[104:105],v[104:105],v[24:25] op_sel_hi:[1,0] neg_lo:[0,1] neg_hi:[0,1]
v_pk_add_f32 v[106:107],v[106:107],v[24:25] op_sel_hi:[1,0] neg_lo:[0,1] neg_hi:[0,1]
v_pk_add_f32 v[108:109],v[108:109],v[24:25] op_sel_hi:[1,0] neg_lo:[0,1] neg_hi:[0,1]
v_pk_add_f32 v[110:111],v[110:111],v[24:25] op_sel_hi:[1,0] neg_lo:[0,1] neg_hi:[0,1]
v_cvt_pk_bf16_f32 v6,v72,v73
v_lshlrev_b32 v72,16,v6
v_and_b32 v73,0xffff0000,v6
v_cvt_pk_bf16_f32 v8,v74,v75
v_lshlrev_b32 v74,16,v8
v_and_b32 v75,0xffff0000,v8
v_cvt_pk_bf16_f32 v6,v76,v77
v_lshlrev_b32 v76,16,v6
v_and_b32 v77,0xffff0000,v6
v_cvt_pk_bf16_f32 v8,v78,v79
v_lshlrev_b32 v78,16,v8
v_and_b32 v79,0xffff0000,v8
v_cvt_pk_bf16_f32 v6,v80,v81
v_lshlrev_b32 v80,16,v6
v_and_b32 v81,0xffff0000,v6
v_cvt_pk_bf16_f32 v8,v82,v83
v_lshlrev_b32 v82,16,v8
v_and_b32 v83,0xffff0000,v8
v_cvt_pk_bf16_f32 v6,v84,v85
v_lshlrev_b32 v84,16,v6
v_and_b32 v85,0xffff0000,v6
v_cvt_pk_bf16_f32 v8,v86,v87
v_lshlrev_b32 v86,16,v8
v_and_b32 v87,0xffff0000,v8
v_cvt_pk_bf16_f32 v6,v88,v89
v_lshlrev_b32 v88,16,v6
v_and_b32 v89,0xffff0000,v6
v_cvt_pk_bf16_f32 v8,v90,v91
v_lshlrev_b32 v90,16,v8
v_and_b32 v91,0xffff0000,v8
v_cvt_pk_bf16_f32 v6,v92,v93
v_lshlrev_b32 v92,16,v6
v_and_b32 v93,0xffff0000,v6
v_cvt_pk_bf16_f32 v8,v94,v95
v_lshlrev_b32 v94,16,v8
v_and_b32 v95,0xffff0000,v8
v_cvt_pk_bf16_f32 v6,v96,v97
v_lshlrev_b32 v96,16,v6
v_and_b32 v97,0xffff0000,v6
v_cvt_pk_bf16_f32 v8,v98,v99
v_lshlrev_b32 v98,16,v8
v_and_b32 v99,0xffff0000,v8
v_cvt_pk_bf16_f32 v6,v100,v101
v_lshlrev_b32 v100,16,v6
v_and_b32 v101,0xffff0000,v6
v_cvt_pk_bf16_f32 v8,v102,v103
v_lshlrev_b32 v102,16,v8
v_and_b32 v103,0xffff0000,v8
v_cvt_pk_bf16_f32 v6,v104,v105
v_lshlrev_b32 v104,16,v6
v_and_b32 v105,0xffff0000,v6
v_cvt_pk_bf16_f32 v8,v106,v107
v_lshlrev_b32 v106,16,v8
v_and_b32 v107,0xffff0000,v8
v_cvt_pk_bf16_f32 v6,v108,v109
v_lshlrev_b32 v108,16,v6
v_and_b32 v109,0xffff0000,v6
v_cvt_pk_bf16_f32 v8,v110,v111
v_lshlrev_b32 v110,16,v8
v_and_b32 v111,0xffff0000,v8
v_pk_mul_f32 v[72:73],v[72:73],v[24:25] op_sel:[0,1] op_sel_hi:[1,1]
v_pk_mul_f32 v[74:75],v[74:75],v[24:25] op_sel:[0,1] op_sel_hi:[1,1]
v_pk_mul_f32 v[76:77],v[76:77],v[24:25] op_sel:[0,1] op_sel_hi:[1,1]
v_pk_mul_f32 v[78:79],v[78:79],v[24:25] op_sel:[0,1] op_sel_hi:[1,1]
v_pk_mul_f32 v[80:81],v[80:81],v[24:25] op_sel:[0,1] op_sel_hi:[1,1]
v_pk_mul_f32 v[82:83],v[82:83],v[24:25] op_sel:[0,1] op_sel_hi:[1,1]
v_pk_mul_f32 v[84:85],v[84:85],v[24:25] op_sel:[0,1] op_sel_hi:[1,1]
v_pk_mul_f32 v[86:87],v[86:87],v[24:25] op_sel:[0,1] op_sel_hi:[1,1]
v_pk_mul_f32 v[88:89],v[88:89],v[24:25] op_sel:[0,1] op_sel_hi:[1,1]
v_pk_mul_f32 v[90:91],v[90:91],v[24:25] op_sel:[0,1] op_sel_hi:[1,1]
v_pk_mul_f32 v[92:93],v[92:93],v[24:25] op_sel:[0,1] op_sel_hi:[1,1]
v_pk_mul_f32 v[94:95],v[94:95],v[24:25] op_sel:[0,1] op_sel_hi:[1,1]
v_pk_mul_f32 v[96:97],v[96:97],v[24:25] op_sel:[0,1] op_sel_hi:[1,1]
v_pk_mul_f32 v[98:99],v[98:99],v[24:25] op_sel:[0,1] op_sel_hi:[1,1]
v_pk_mul_f32 v[100:101],v[100:101],v[24:25] op_sel:[0,1] op_sel_hi:[1,1]
v_pk_mul_f32 v[102:103],v[102:103],v[24:25] op_sel:[0,1] op_sel_hi:[1,1]
v_pk_mul_f32 v[104:105],v[104:105],v[24:25] op_sel:[0,1] op_sel_hi:[1,1]
v_pk_mul_f32 v[106:107],v[106:107],v[24:25] op_sel:[0,1] op_sel_hi:[1,1]
v_pk_mul_f32 v[108:109],v[108:109],v[24:25] op_sel:[0,1] op_sel_hi:[1,1]
v_pk_mul_f32 v[110:111],v[110:111],v[24:25] op_sel:[0,1] op_sel_hi:[1,1]
v_cvt_pk_bf16_f32 v112,v72,v73
v_lshlrev_b32 v72,16,v112
v_and_b32 v73,0xffff0000,v112
v_cvt_pk_bf16_f32 v113,v74,v75
v_lshlrev_b32 v74,16,v113
v_and_b32 v75,0xffff0000,v113
v_cvt_pk_bf16_f32 v114,v76,v77
v_lshlrev_b32 v76,16,v114
v_and_b32 v77,0xffff0000,v114
v_cvt_pk_bf16_f32 v115,v78,v79
v_lshlrev_b32 v78,16,v115
v_and_b32 v79,0xffff0000,v115
v_cvt_pk_bf16_f32 v116,v80,v81
v_lshlrev_b32 v80,16,v116
v_and_b32 v81,0xffff0000,v116
v_cvt_pk_bf16_f32 v117,v82,v83
v_lshlrev_b32 v82,16,v117
v_and_b32 v83,0xffff0000,v117
v_cvt_pk_bf16_f32 v118,v84,v85
v_lshlrev_b32 v84,16,v118
v_and_b32 v85,0xffff0000,v118
v_cvt_pk_bf16_f32 v119,v86,v87
v_lshlrev_b32 v86,16,v119
v_and_b32 v87,0xffff0000,v119
v_cvt_pk_bf16_f32 v120,v88,v89
v_lshlrev_b32 v88,16,v120
v_and_b32 v89,0xffff0000,v120
v_cvt_pk_bf16_f32 v121,v90,v91
v_lshlrev_b32 v90,16,v121
v_and_b32 v91,0xffff0000,v121
v_cvt_pk_bf16_f32 v122,v92,v93
v_lshlrev_b32 v92,16,v122
v_and_b32 v93,0xffff0000,v122
v_cvt_pk_bf16_f32 v123,v94,v95
v_lshlrev_b32 v94,16,v123
v_and_b32 v95,0xffff0000,v123
v_cvt_pk_bf16_f32 v124,v96,v97
v_lshlrev_b32 v96,16,v124
v_and_b32 v97,0xffff0000,v124
v_cvt_pk_bf16_f32 v125,v98,v99
v_lshlrev_b32 v98,16,v125
v_and_b32 v99,0xffff0000,v125
v_cvt_pk_bf16_f32 v126,v100,v101
v_lshlrev_b32 v100,16,v126
v_and_b32 v101,0xffff0000,v126
v_cvt_pk_bf16_f32 v127,v102,v103
v_lshlrev_b32 v102,16,v127
v_and_b32 v103,0xffff0000,v127
v_cvt_pk_bf16_f32 v128,v104,v105
v_lshlrev_b32 v104,16,v128
v_and_b32 v105,0xffff0000,v128
v_cvt_pk_bf16_f32 v129,v106,v107
v_lshlrev_b32 v106,16,v129
v_and_b32 v107,0xffff0000,v129
v_cvt_pk_bf16_f32 v130,v108,v109
v_lshlrev_b32 v108,16,v130
v_and_b32 v109,0xffff0000,v130
v_cvt_pk_bf16_f32 v131,v110,v111
v_lshlrev_b32 v110,16,v131
v_and_b32 v111,0xffff0000,v131
s_add_u32 s63,s65,0
v_permlane16_swap_b32 v112,v114
v_permlane16_swap_b32 v113,v115
buffer_store_dwordx4 v[112:115],v132,s[8:11],s63 offen sc1
s_add_u32 s63,s65,8192
v_permlane16_swap_b32 v116,v118
v_permlane16_swap_b32 v117,v119
buffer_store_dwordx4 v[116:119],v132,s[8:11],s63 offen sc1
s_add_u32 s63,s65,16384
v_permlane16_swap_b32 v120,v122
v_permlane16_swap_b32 v121,v123
buffer_store_dwordx4 v[120:123],v132,s[8:11],s63 offen sc1
s_add_u32 s63,s65,24576
v_permlane16_swap_b32 v124,v126
v_permlane16_swap_b32 v125,v127
buffer_store_dwordx4 v[124:127],v132,s[8:11],s63 offen sc1
s_add_u32 s63,s65,32768
v_permlane16_swap_b32 v128,v130
v_permlane16_swap_b32 v129,v131
buffer_store_dwordx4 v[128:131],v132,s[8:11],s63 offen sc1
s_add_u32 s63,s64,0
v_permlane16_swap_b32 v52,v54
v_permlane16_swap_b32 v53,v55
buffer_store_dwordx4 v[52:55],v132,s[8:11],s63 offen sc1
s_add_u32 s63,s64,8192
v_permlane16_swap_b32 v56,v58
v_permlane16_swap_b32 v57,v59
buffer_store_dwordx4 v[56:59],v132,s[8:11],s63 offen sc1
s_add_u32 s63,s64,16384
v_permlane16_swap_b32 v60,v62
v_permlane16_swap_b32 v61,v63
buffer_store_dwordx4 v[60:63],v132,s[8:11],s63 offen sc1
s_add_u32 s63,s64,24576
v_permlane16_swap_b32 v64,v66
v_permlane16_swap_b32 v65,v67
buffer_store_dwordx4 v[64:67],v132,s[8:11],s63 offen sc1
s_add_u32 s63,s64,32768
v_permlane16_swap_b32 v68,v70
v_permlane16_swap_b32 v69,v71
buffer_store_dwordx4 v[68:71],v132,s[8:11],s63 offen sc1
s_lshl_b32 s82,s55,6
s_add_u32 s82,s82,s54
s_lshl_b32 s82,s82,9
s_add_u32 s82,s82,0
s_lshl_b32 s61,s53,2
s_add_u32 s82,s82,s61
s_add_u32 s54,s54,16
R0_LOOPA:
s_add_u32 s66,s54,16
s_min_u32 s66,s66,63
s_mul_i32 s62,s66,40960
buffer_load_dwordx2 v[52:53],v133,s[4:7],s62 offen offset:0
buffer_load_dwordx2 v[54:55],v133,s[4:7],s62 offen offset:128
buffer_load_dwordx2 v[56:57],v133,s[4:7],s62 offen offset:256
buffer_load_dwordx2 v[58:59],v133,s[4:7],s62 offen offset:384
buffer_load_dwordx2 v[60:61],v133,s[4:7],s62 offen offset:512
buffer_load_dwordx2 v[62:63],v133,s[4:7],s62 offen offset:640
buffer_load_dwordx2 v[64:65],v133,s[4:7],s62 offen offset:768
buffer_load_dwordx2 v[66:67],v133,s[4:7],s62 offen offset:896
buffer_load_dwordx2 v[68:69],v133,s[4:7],s62 offen offset:1024
buffer_load_dwordx2 v[70:71],v133,s[4:7],s62 offen offset:1152
s_mul_i32 s64,s54,40960
s_add_u32 s64,s64,234749952
s_mul_i32 s65,s54,46080
s_add_u32 s65,s65,206569472
s_waitcnt vmcnt(10)
s_mov_b64 exec,1
buffer_store_dword v5,v1,s[8:11],s82 offen sc1
s_mov_b64 exec,-1
v_lshlrev_b32 v72,16,v32
v_and_b32 v73,0xffff0000,v32
v_lshlrev_b32 v74,16,v33
v_and_b32 v75,0xffff0000,v33
v_lshlrev_b32 v76,16,v34
v_and_b32 v77,0xffff0000,v34
v_lshlrev_b32 v78,16,v35
v_and_b32 v79,0xffff0000,v35
v_lshlrev_b32 v80,16,v36
v_and_b32 v81,0xffff0000,v36
v_lshlrev_b32 v82,16,v37
v_and_b32 v83,0xffff0000,v37
v_lshlrev_b32 v84,16,v38
v_and_b32 v85,0xffff0000,v38
v_lshlrev_b32 v86,16,v39
v_and_b32 v87,0xffff0000,v39
v_lshlrev_b32 v88,16,v40
v_and_b32 v89,0xffff0000,v40
v_lshlrev_b32 v90,16,v41
v_and_b32 v91,0xffff0000,v41
v_lshlrev_b32 v92,16,v42
v_and_b32 v93,0xffff0000,v42
v_lshlrev_b32 v94,16,v43
v_and_b32 v95,0xffff0000,v43
v_lshlrev_b32 v96,16,v44
v_and_b32 v97,0xffff0000,v44
v_lshlrev_b32 v98,16,v45
v_and_b32 v99,0xffff0000,v45
v_lshlrev_b32 v100,16,v46
v_and_b32 v101,0xffff0000,v46
v_lshlrev_b32 v102,16,v47
v_and_b32 v103,0xffff0000,v47
v_lshlrev_b32 v104,16,v48
v_and_b32 v105,0xffff0000,v48
v_lshlrev_b32 v106,16,v49
v_and_b32 v107,0xffff0000,v49
v_lshlrev_b32 v108,16,v50
v_and_b32 v109,0xffff0000,v50
v_lshlrev_b32 v110,16,v51
v_and_b32 v111,0xffff0000,v51
v_pk_add_f32 v[28:29],v[72:73],v[74:75]
v_pk_mul_f32 v[26:27],v[72:73],v[72:73]
v_pk_fma_f32 v[26:27],v[74:75],v[74:75],v[26:27]
v_pk_add_f32 v[28:29],v[28:29],v[76:77]
v_pk_fma_f32 v[26:27],v[76:77],v[76:77],v[26:27]
v_pk_add_f32 v[28:29],v[28:29],v[78:79]
v_pk_fma_f32 v[26:27],v[78:79],v[78:79],v[26:27]
v_pk_add_f32 v[28:29],v[28:29],v[80:81]
v_pk_fma_f32 v[26:27],v[80:81],v[80:81],v[26:27]
v_pk_add_f32 v[28:29],v[28:29],v[82:83]
v_pk_fma_f32 v[26:27],v[82:83],v[82:83],v[26:27]
v_pk_add_f32 v[28:29],v[28:29],v[84:85]
v_pk_fma_f32 v[26:27],v[84:85],v[84:85],v[26:27]
v_pk_add_f32 v[28:29],v[28:29],v[86:87]
v_pk_fma_f32 v[26:27],v[86:87],v[86:87],v[26:27]
v_pk_add_f32 v[28:29],v[28:29],v[88:89]
v_pk_fma_f32 v[26:27],v[88:89],v[88:89],v[26:27]
v_pk_add_f32 v[28:29],v[28:29],v[90:91]
v_pk_fma_f32 v[26:27],v[90:91],v[90:91],v[26:27]
v_pk_add_f32 v[28:29],v[28:29],v[92:93]
v_pk_fma_f32 v[26:27],v[92:93],v[92:93],v[26:27]
v_pk_add_f32 v[28:29],v[28:29],v[94:95]
v_pk_fma_f32 v[26:27],v[94:95],v[94:95],v[26:27]
v_pk_add_f32 v[28:29],v[28:29],v[96:97]
v_pk_fma_f32 v[26:27],v[96:97],v[96:97],v[26:27]
v_pk_add_f32 v[28:29],v[28:29],v[98:99]
v_pk_fma_f32 v[26:27],v[98:99],v[98:99],v[26:27]
v_pk_add_f32 v[28:29],v[28:29],v[100:101]
v_pk_fma_f32 v[26:27],v[100:101],v[100:101],v[26:27]
v_pk_add_f32 v[28:29],v[28:29],v[102:103]
v_pk_fma_f32 v[26:27],v[102:103],v[102:103],v[26:27]
v_pk_add_f32 v[28:29],v[28:29],v[104:105]
v_pk_fma_f32 v[26:27],v[104:105],v[104:105],v[26:27]
v_pk_add_f32 v[28:29],v[28:29],v[106:107]
v_pk_fma_f32 v[26:27],v[106:107],v[106:107],v[26:27]
v_pk_add_f32 v[28:29],v[28:29],v[108:109]
v_pk_fma_f32 v[26:27],v[108:109],v[108:109],v[26:27]
v_pk_add_f32 v[28:29],v[28:29],v[110:111]
v_pk_fma_f32 v[26:27],v[110:111],v[110:111],v[26:27]
v_add_f32 v24,v28,v29
v_add_f32 v25,v26,v27
s_nop 0
v_add_f32_dpp v24,v24,v24 row_ror:4 row_mask:0xf bank_mask:0xf
v_add_f32_dpp v25,v25,v25 row_ror:4 row_mask:0xf bank_mask:0xf
s_nop 0
v_add_f32_dpp v24,v24,v24 row_ror:8 row_mask:0xf bank_mask:0xf
v_add_f32_dpp v25,v25,v25 row_ror:8 row_mask:0xf bank_mask:0xf
v_mov_b32 v26,v24
v_mov_b32 v27,v25
s_nop 0
v_permlane32_swap_b32 v24,v26
v_permlane32_swap_b32 v25,v27
v_add_f32 v24,v24,v26
v_add_f32 v25,v25,v27
v_mov_b32 v26,v24
v_mov_b32 v27,v25
s_nop 0
v_permlane16_swap_b32 v24,v26
v_permlane16_swap_b32 v25,v27
v_add_f32 v24,v24,v26
v_add_f32 v25,v25,v27
v_mul_f32 v24,0x3acccccd,v24
v_mul_f32 v25,0x3acccccd,v25
v_fma_f32 v25,-v24,v24,v25
v_max_f32 v25,0,v25
v_cvt_pk_bf16_f32 v6,v24,v25
v_lshlrev_b32 v24,16,v6
v_and_b32 v25,0xffff0000,v6
v_add_f32 v25,0x3727c5ac,v25
v_cvt_pk_bf16_f32 v6,v25,v25
v_lshlrev_b32 v25,16,v6
v_sqrt_f32 v25,v25
s_nop 0
v_cvt_pk_bf16_f32 v6,v25,v25
v_lshlrev_b32 v25,16,v6
v_rcp_f32 v25,v25
s_nop 0
v_pk_add_f32 v[72:73],v[72:73],v[24:25] op_sel_hi:[1,0] neg_lo:[0,1] neg_hi:[0,1]
v_pk_add_f32 v[74:75],v[74:75],v[24:25] op_sel_hi:[1,0] neg_lo:[0,1] neg_hi:[0,1]
v_pk_add_f32 v[76:77],v[76:77],v[24:25] op_sel_hi:[1,0] neg_lo:[0,1] neg_hi:[0,1]
v_pk_add_f32 v[78:79],v[78:79],v[24:25] op_sel_hi:[1,0] neg_lo:[0,1] neg_hi:[0,1]
v_pk_add_f32 v[80:81],v[80:81],v[24:25] op_sel_hi:[1,0] neg_lo:[0,1] neg_hi:[0,1]
v_pk_add_f32 v[82:83],v[82:83],v[24:25] op_sel_hi:[1,0] neg_lo:[0,1] neg_hi:[0,1]
v_pk_add_f32 v[84:85],v[84:85],v[24:25] op_sel_hi:[1,0] neg_lo:[0,1] neg_hi:[0,1]
v_pk_add_f32 v[86:87],v[86:87],v[24:25] op_sel_hi:[1,0] neg_lo:[0,1] neg_hi:[0,1]
v_pk_add_f32 v[88:89],v[88:89],v[24:25] op_sel_hi:[1,0] neg_lo:[0,1] neg_hi:[0,1]
v_pk_add_f32 v[90:91],v[90:91],v[24:25] op_sel_hi:[1,0] neg_lo:[0,1] neg_hi:[0,1]
v_pk_add_f32 v[92:93],v[92:93],v[24:25] op_sel_hi:[1,0] neg_lo:[0,1] neg_hi:[0,1]
v_pk_add_f32 v[94:95],v[94:95],v[24:25] op_sel_hi:[1,0] neg_lo:[0,1] neg_hi:[0,1]
v_pk_add_f32 v[96:97],v[96:97],v[24:25] op_sel_hi:[1,0] neg_lo:[0,1] neg_hi:[0,1]
v_pk_add_f32 v[98:99],v[98:99],v[24:25] op_sel_hi:[1,0] neg_lo:[0,1] neg_hi:[0,1]
v_pk_add_f32 v[100:101],v[100:101],v[24:25] op_sel_hi:[1,0] neg_lo:[0,1] neg_hi:[0,1]
v_pk_add_f32 v[102:103],v[102:103],v[24:25] op_sel_hi:[1,0] neg_lo:[0,1] neg_hi:[0,1]
v_pk_add_f32 v[104:105],v[104:105],v[24:25] op_sel_hi:[1,0] neg_lo:[0,1] neg_hi:[0,1]
v_pk_add_f32 v[106:107],v[106:107],v[24:25] op_sel_hi:[1,0] neg_lo:[0,1] neg_hi:[0,1]
v_pk_add_f32 v[108:109],v[108:109],v[24:25] op_sel_hi:[1,0] neg_lo:[0,1] neg_hi:[0,1]
v_pk_add_f32 v[110:111],v[110:111],v[24:25] op_sel_hi:[1,0] neg_lo:[0,1] neg_hi:[0,1]
v_cvt_pk_bf16_f32 v6,v72,v73
v_lshlrev_b32 v72,16,v6
v_and_b32 v73,0xffff0000,v6
v_cvt_pk_bf16_f32 v8,v74,v75
v_lshlrev_b32 v74,16,v8
v_and_b32 v75,0xffff0000,v8
v_cvt_pk_bf16_f32 v6,v76,v77
v_lshlrev_b32 v76,16,v6
v_and_b32 v77,0xffff0000,v6
v_cvt_pk_bf16_f32 v8,v78,v79
v_lshlrev_b32 v78,16,v8
v_and_b32 v79,0xffff0000,v8
v_cvt_pk_bf16_f32 v6,v80,v81
v_lshlrev_b32 v80,16,v6
v_and_b32 v81,0xffff0000,v6
v_cvt_pk_bf16_f32 v8,v82,v83
v_lshlrev_b32 v82,16,v8
v_and_b32 v83,0xffff0000,v8
v_cvt_pk_bf16_f32 v6,v84,v85
v_lshlrev_b32 v84,16,v6
v_and_b32 v85,0xffff0000,v6
v_cvt_pk_bf16_f32 v8,v86,v87
v_lshlrev_b32 v86,16,v8
v_and_b32 v87,0xffff0000,v8
v_cvt_pk_bf16_f32 v6,v88,v89
v_lshlrev_b32 v88,16,v6
v_and_b32 v89,0xffff0000,v6
v_cvt_pk_bf16_f32 v8,v90,v91
v_lshlrev_b32 v90,16,v8
v_and_b32 v91,0xffff0000,v8
v_cvt_pk_bf16_f32 v6,v92,v93
v_lshlrev_b32 v92,16,v6
v_and_b32 v93,0xffff0000,v6
v_cvt_pk_bf16_f32 v8,v94,v95
v_lshlrev_b32 v94,16,v8
v_and_b32 v95,0xffff0000,v8
v_cvt_pk_bf16_f32 v6,v96,v97
v_lshlrev_b32 v96,16,v6
v_and_b32 v97,0xffff0000,v6
v_cvt_pk_bf16_f32 v8,v98,v99
v_lshlrev_b32 v98,16,v8
v_and_b32 v99,0xffff0000,v8
v_cvt_pk_bf16_f32 v6,v100,v101
v_lshlrev_b32 v100,16,v6
v_and_b32 v101,0xffff0000,v6
v_cvt_pk_bf16_f32 v8,v102,v103
v_lshlrev_b32 v102,16,v8
v_and_b32 v103,0xffff0000,v8
v_cvt_pk_bf16_f32 v6,v104,v105
v_lshlrev_b32 v104,16,v6
v_and_b32 v105,0xffff0000,v6
v_cvt_pk_bf16_f32 v8,v106,v107
v_lshlrev_b32 v106,16,v8
v_and_b32 v107,0xffff0000,v8
v_cvt_pk_bf16_f32 v6,v108,v109
v_lshlrev_b32 v108,16,v6
v_and_b32 v109,0xffff0000,v6
v_cvt_pk_bf16_f32 v8,v110,v111
v_lshlrev_b32 v110,16,v8
v_and_b32 v111,0xffff0000,v8
v_pk_mul_f32 v[72:73],v[72:73],v[24:25] op_sel:[0,1] op_sel_hi:[1,1]
v_pk_mul_f32 v[74:75],v[74:75],v[24:25] op_sel:[0,1] op_sel_hi:[1,1]
v_pk_mul_f32 v[76:77],v[76:77],v[24:25] op_sel:[0,1] op_sel_hi:[1,1]
v_pk_mul_f32 v[78:79],v[78:79],v[24:25] op_sel:[0,1] op_sel_hi:[1,1]
v_pk_mul_f32 v[80:81],v[80:81],v[24:25] op_sel:[0,1] op_sel_hi:[1,1]
v_pk_mul_f32 v[82:83],v[82:83],v[24:25] op_sel:[0,1] op_sel_hi:[1,1]
v_pk_mul_f32 v[84:85],v[84:85],v[24:25] op_sel:[0,1] op_sel_hi:[1,1]
v_pk_mul_f32 v[86:87],v[86:87],v[24:25] op_sel:[0,1] op_sel_hi:[1,1]
v_pk_mul_f32 v[88:89],v[88:89],v[24:25] op_sel:[0,1] op_sel_hi:[1,1]
v_pk_mul_f32 v[90:91],v[90:91],v[24:25] op_sel:[0,1] op_sel_hi:[1,1]
v_pk_mul_f32 v[92:93],v[92:93],v[24:25] op_sel:[0,1] op_sel_hi:[1,1]
v_pk_mul_f32 v[94:95],v[94:95],v[24:25] op_sel:[0,1] op_sel_hi:[1,1]
v_pk_mul_f32 v[96:97],v[96:97],v[24:25] op_sel:[0,1] op_sel_hi:[1,1]
v_pk_mul_f32 v[98:99],v[98:99],v[24:25] op_sel:[0,1] op_sel_hi:[1,1]
v_pk_mul_f32 v[100:101],v[100:101],v[24:25] op_sel:[0,1] op_sel_hi:[1,1]
v_pk_mul_f32 v[102:103],v[102:103],v[24:25] op_sel:[0,1] op_sel_hi:[1,1]
v_pk_mul_f32 v[104:105],v[104:105],v[24:25] op_sel:[0,1] op_sel_hi:[1,1]
v_pk_mul_f32 v[106:107],v[106:107],v[24:25] op_sel:[0,1] op_sel_hi:[1,1]
v_pk_mul_f32 v[108:109],v[108:109],v[24:25] op_sel:[0,1] op_sel_hi:[1,1]
v_pk_mul_f32 v[110:111],v[110:111],v[24:25] op_sel:[0,1] op_sel_hi:[1,1]
v_cvt_pk_bf16_f32 v112,v72,v73
v_lshlrev_b32 v72,16,v112
v_and_b32 v73,0xffff0000,v112
v_cvt_pk_bf16_f32 v113,v74,v75
v_lshlrev_b32 v74,16,v113
v_and_b32 v75,0xffff0000,v113
v_cvt_pk_bf16_f32 v114,v76,v77
v_lshlrev_b32 v76,16,v114
v_and_b32 v77,0xffff0000,v114
v_cvt_pk_bf16_f32 v115,v78,v79
v_lshlrev_b32 v78,16,v115
v_and_b32 v79,0xffff0000,v115
v_cvt_pk_bf16_f32 v116,v80,v81
v_lshlrev_b32 v80,16,v116
v_and_b32 v81,0xffff0000,v116
v_cvt_pk_bf16_f32 v117,v82,v83
v_lshlrev_b32 v82,16,v117
v_and_b32 v83,0xffff0000,v117
v_cvt_pk_bf16_f32 v118,v84,v85
v_lshlrev_b32 v84,16,v118
v_and_b32 v85,0xffff0000,v118
v_cvt_pk_bf16_f32 v119,v86,v87
v_lshlrev_b32 v86,16,v119
v_and_b32 v87,0xffff0000,v119
v_cvt_pk_bf16_f32 v120,v88,v89
v_lshlrev_b32 v88,16,v120
v_and_b32 v89,0xffff0000,v120
v_cvt_pk_bf16_f32 v121,v90,v91
v_lshlrev_b32 v90,16,v121
v_and_b32 v91,0xffff0000,v121
v_cvt_pk_bf16_f32 v122,v92,v93
v_lshlrev_b32 v92,16,v122
v_and_b32 v93,0xffff0000,v122
v_cvt_pk_bf16_f32 v123,v94,v95
v_lshlrev_b32 v94,16,v123
v_and_b32 v95,0xffff0000,v123
v_cvt_pk_bf16_f32 v124,v96,v97
v_lshlrev_b32 v96,16,v124
v_and_b32 v97,0xffff0000,v124
v_cvt_pk_bf16_f32 v125,v98,v99
v_lshlrev_b32 v98,16,v125
v_and_b32 v99,0xffff0000,v125
v_cvt_pk_bf16_f32 v126,v100,v101
v_lshlrev_b32 v100,16,v126
v_and_b32 v101,0xffff0000,v126
v_cvt_pk_bf16_f32 v127,v102,v103
v_lshlrev_b32 v102,16,v127
v_and_b32 v103,0xffff0000,v127
v_cvt_pk_bf16_f32 v128,v104,v105
v_lshlrev_b32 v104,16,v128
v_and_b32 v105,0xffff0000,v128
v_cvt_pk_bf16_f32 v129,v106,v107
v_lshlrev_b32 v106,16,v129
v_and_b32 v107,0xffff0000,v129
v_cvt_pk_bf16_f32 v130,v108,v109
v_lshlrev_b32 v108,16,v130
v_and_b32 v109,0xffff0000,v130
v_cvt_pk_bf16_f32 v131,v110,v111
v_lshlrev_b32 v110,16,v131
v_and_b32 v111,0xffff0000,v131
s_add_u32 s63,s65,0
v_permlane16_swap_b32 v112,v114
v_permlane16_swap_b32 v113,v115
buffer_store_dwordx4 v[112:115],v132,s[8:11],s63 offen sc1
s_add_u32 s63,s65,8192
v_permlane16_swap_b32 v116,v118
v_permlane16_swap_b32 v117,v119
buffer_store_dwordx4 v[116:119],v132,s[8:11],s63 offen sc1
s_add_u32 s63,s65,16384
v_permlane16_swap_b32 v120,v122
v_permlane16_swap_b32 v121,v123
buffer_store_dwordx4 v[120:123],v132,s[8:11],s63 offen sc1
s_add_u32 s63,s65,24576
v_permlane16_swap_b32 v124,v126
v_permlane16_swap_b32 v125,v127
buffer_store_dwordx4 v[124:127],v132,s[8:11],s63 offen sc1
s_add_u32 s63,s65,32768
v_permlane16_swap_b32 v128,v130
v_permlane16_swap_b32 v129,v131
buffer_store_dwordx4 v[128:131],v132,s[8:11],s63 offen sc1
s_add_u32 s63,s64,0
v_permlane16_swap_b32 v32,v34
v_permlane16_swap_b32 v33,v35
buffer_store_dwordx4 v[32:35],v132,s[8:11],s63 offen sc1
s_add_u32 s63,s64,8192
v_permlane16_swap_b32 v36,v38
v_permlane16_swap_b32 v37,v39
buffer_store_dwordx4 v[36:39],v132,s[8:11],s63 offen sc1
s_add_u32 s63,s64,16384
v_permlane16_swap_b32 v40,v42
v_permlane16_swap_b32 v41,v43
buffer_store_dwordx4 v[40:43],v132,s[8:11],s63 offen sc1
s_add_u32 s63,s64,24576
v_permlane16_swap_b32 v44,v46
v_permlane16_swap_b32 v45,v47
buffer_store_dwordx4 v[44:47],v132,s[8:11],s63 offen sc1
s_add_u32 s63,s64,32768
v_permlane16_swap_b32 v48,v50
v_permlane16_swap_b32 v49,v51
buffer_store_dwordx4 v[48:51],v132,s[8:11],s63 offen sc1
s_lshl_b32 s82,s55,6
s_add_u32 s82,s82,s54
s_lshl_b32 s82,s82,9
s_add_u32 s82,s82,0
s_lshl_b32 s61,s53,2
s_add_u32 s82,s82,s61
s_add_u32 s54,s54,16
s_cmp_ge_u32 s54,64
s_cbranch_scc1 R0_ENDA
s_add_u32 s66,s54,16
s_min_u32 s66,s66,63
s_mul_i32 s62,s66,40960
buffer_load_dwordx2 v[32:33],v133,s[4:7],s62 offen offset:0
buffer_load_dwordx2 v[34:35],v133,s[4:7],s62 offen offset:128
buffer_load_dwordx2 v[36:37],v133,s[4:7],s62 offen offset:256
buffer_load_dwordx2 v[38:39],v133,s[4:7],s62 offen offset:384
buffer_load_dwordx2 v[40:41],v133,s[4:7],s62 offen offset:512
buffer_load_dwordx2 v[42:43],v133,s[4:7],s62 offen offset:640
buffer_load_dwordx2 v[44:45],v133,s[4:7],s62 offen offset:768
buffer_load_dwordx2 v[46:47],v133,s[4:7],s62 offen offset:896
buffer_load_dwordx2 v[48:49],v133,s[4:7],s62 offen offset:1024
buffer_load_dwordx2 v[50:51],v133,s[4:7],s62 offen offset:1152
s_mul_i32 s64,s54,40960
s_add_u32 s64,s64,234749952
s_mul_i32 s65,s54,46080
s_add_u32 s65,s65,206569472
s_waitcnt vmcnt(10)
s_mov_b64 exec,1
buffer_store_dword v5,v1,s[8:11],s82 offen sc1
s_mov_b64 exec,-1
v_lshlrev_b32 v72,16,v52
v_and_b32 v73,0xffff0000,v52
v_lshlrev_b32 v74,16,v53
v_and_b32 v75,0xffff0000,v53
v_lshlrev_b32 v76,16,v54
v_and_b32 v77,0xffff0000,v54
v_lshlrev_b32 v78,16,v55
v_and_b32 v79,0xffff0000,v55
v_lshlrev_b32 v80,16,v56
v_and_b32 v81,0xffff0000,v56
v_lshlrev_b32 v82,16,v57
v_and_b32 v83,0xffff0000,v57
v_lshlrev_b32 v84,16,v58
v_and_b32 v85,0xffff0000,v58
v_lshlrev_b32 v86,16,v59
v_and_b32 v87,0xffff0000,v59
v_lshlrev_b32 v88,16,v60
v_and_b32 v89,0xffff0000,v60
v_lshlrev_b32 v90,16,v61
v_and_b32 v91,0xffff0000,v61
v_lshlrev_b32 v92,16,v62
v_and_b32 v93,0xffff0000,v62
v_lshlrev_b32 v94,16,v63
v_and_b32 v95,0xffff0000,v63
v_lshlrev_b32 v96,16,v64
v_and_b32 v97,0xffff0000,v64
v_lshlrev_b32 v98,16,v65
v_and_b32 v99,0xffff0000,v65
v_lshlrev_b32 v100,16,v66
v_and_b32 v101,0xffff0000,v66
v_lshlrev_b32 v102,16,v67
v_and_b32 v103,0xffff0000,v67
v_lshlrev_b32 v104,16,v68
v_and_b32 v105,0xffff0000,v68
v_lshlrev_b32 v106,16,v69
v_and_b32 v107,0xffff0000,v69
v_lshlrev_b32 v108,16,v70
v_and_b32 v109,0xffff0000,v70
v_lshlrev_b32 v110,16,v71
v_and_b32 v111,0xffff0000,v71
v_pk_add_f32 v[28:29],v[72:73],v[74:75]
v_pk_mul_f32 v[26:27],v[72:73],v[72:73]
v_pk_fma_f32 v[26:27],v[74:75],v[74:75],v[26:27]
v_pk_add_f32 v[28:29],v[28:29],v[76:77]
v_pk_fma_f32 v[26:27],v[76:77],v[76:77],v[26:27]
v_pk_add_f32 v[28:29],v[28:29],v[78:79]
v_pk_fma_f32 v[26:27],v[78:79],v[78:79],v[26:27]
v_pk_add_f32 v[28:29],v[28:29],v[80:81]
v_pk_fma_f32 v[26:27],v[80:81],v[80:81],v[26:27]
v_pk_add_f32 v[28:29],v[28:29],v[82:83]
v_pk_fma_f32 v[26:27],v[82:83],v[82:83],v[26:27]
v_pk_add_f32 v[28:29],v[28:29],v[84:85]
v_pk_fma_f32 v[26:27],v[84:85],v[84:85],v[26:27]
v_pk_add_f32 v[28:29],v[28:29],v[86:87]
v_pk_fma_f32 v[26:27],v[86:87],v[86:87],v[26:27]
v_pk_add_f32 v[28:29],v[28:29],v[88:89]
v_pk_fma_f32 v[26:27],v[88:89],v[88:89],v[26:27]
v_pk_add_f32 v[28:29],v[28:29],v[90:91]
v_pk_fma_f32 v[26:27],v[90:91],v[90:91],v[26:27]
v_pk_add_f32 v[28:29],v[28:29],v[92:93]
v_pk_fma_f32 v[26:27],v[92:93],v[92:93],v[26:27]
v_pk_add_f32 v[28:29],v[28:29],v[94:95]
v_pk_fma_f32 v[26:27],v[94:95],v[94:95],v[26:27]
v_pk_add_f32 v[28:29],v[28:29],v[96:97]
v_pk_fma_f32 v[26:27],v[96:97],v[96:97],v[26:27]
v_pk_add_f32 v[28:29],v[28:29],v[98:99]
v_pk_fma_f32 v[26:27],v[98:99],v[98:99],v[26:27]
v_pk_add_f32 v[28:29],v[28:29],v[100:101]
v_pk_fma_f32 v[26:27],v[100:101],v[100:101],v[26:27]
v_pk_add_f32 v[28:29],v[28:29],v[102:103]
v_pk_fma_f32 v[26:27],v[102:103],v[102:103],v[26:27]
v_pk_add_f32 v[28:29],v[28:29],v[104:105]
v_pk_fma_f32 v[26:27],v[104:105],v[104:105],v[26:27]
v_pk_add_f32 v[28:29],v[28:29],v[106:107]
v_pk_fma_f32 v[26:27],v[106:107],v[106:107],v[26:27]
v_pk_add_f32 v[28:29],v[28:29],v[108:109]
v_pk_fma_f32 v[26:27],v[108:109],v[108:109],v[26:27]
v_pk_add_f32 v[28:29],v[28:29],v[110:111]
v_pk_fma_f32 v[26:27],v[110:111],v[110:111],v[26:27]
v_add_f32 v24,v28,v29
v_add_f32 v25,v26,v27
s_nop 0
v_add_f32_dpp v24,v24,v24 row_ror:4 row_mask:0xf bank_mask:0xf
v_add_f32_dpp v25,v25,v25 row_ror:4 row_mask:0xf bank_mask:0xf
s_nop 0
v_add_f32_dpp v24,v24,v24 row_ror:8 row_mask:0xf bank_mask:0xf
v_add_f32_dpp v25,v25,v25 row_ror:8 row_mask:0xf bank_mask:0xf
v_mov_b32 v26,v24
v_mov_b32 v27,v25
s_nop 0
v_permlane32_swap_b32 v24,v26
v_permlane32_swap_b32 v25,v27
v_add_f32 v24,v24,v26
v_add_f32 v25,v25,v27
v_mov_b32 v26,v24
v_mov_b32 v27,v25
s_nop 0
v_permlane16_swap_b32 v24,v26
v_permlane16_swap_b32 v25,v27
v_add_f32 v24,v24,v26
v_add_f32 v25,v25,v27
v_mul_f32 v24,0x3acccccd,v24
v_mul_f32 v25,0x3acccccd,v25
v_fma_f32 v25,-v24,v24,v25
v_max_f32 v25,0,v25
v_cvt_pk_bf16_f32 v6,v24,v25
v_lshlrev_b32 v24,16,v6
v_and_b32 v25,0xffff0000,v6
v_add_f32 v25,0x3727c5ac,v25
v_cvt_pk_bf16_f32 v6,v25,v25
v_lshlrev_b32 v25,16,v6
v_sqrt_f32 v25,v25
s_nop 0
v_cvt_pk_bf16_f32 v6,v25,v25
v_lshlrev_b32 v25,16,v6
v_rcp_f32 v25,v25
s_nop 0
v_pk_add_f32 v[72:73],v[72:73],v[24:25] op_sel_hi:[1,0] neg_lo:[0,1] neg_hi:[0,1]
v_pk_add_f32 v[74:75],v[74:75],v[24:25] op_sel_hi:[1,0] neg_lo:[0,1] neg_hi:[0,1]
v_pk_add_f32 v[76:77],v[76:77],v[24:25] op_sel_hi:[1,0] neg_lo:[0,1] neg_hi:[0,1]
v_pk_add_f32 v[78:79],v[78:79],v[24:25] op_sel_hi:[1,0] neg_lo:[0,1] neg_hi:[0,1]
v_pk_add_f32 v[80:81],v[80:81],v[24:25] op_sel_hi:[1,0] neg_lo:[0,1] neg_hi:[0,1]
v_pk_add_f32 v[82:83],v[82:83],v[24:25] op_sel_hi:[1,0] neg_lo:[0,1] neg_hi:[0,1]
v_pk_add_f32 v[84:85],v[84:85],v[24:25] op_sel_hi:[1,0] neg_lo:[0,1] neg_hi:[0,1]
v_pk_add_f32 v[86:87],v[86:87],v[24:25] op_sel_hi:[1,0] neg_lo:[0,1] neg_hi:[0,1]
v_pk_add_f32 v[88:89],v[88:89],v[24:25] op_sel_hi:[1,0] neg_lo:[0,1] neg_hi:[0,1]
v_pk_add_f32 v[90:91],v[90:91],v[24:25] op_sel_hi:[1,0] neg_lo:[0,1] neg_hi:[0,1]
v_pk_add_f32 v[92:93],v[92:93],v[24:25] op_sel_hi:[1,0] neg_lo:[0,1] neg_hi:[0,1]
v_pk_add_f32 v[94:95],v[94:95],v[24:25] op_sel_hi:[1,0] neg_lo:[0,1] neg_hi:[0,1]
v_pk_add_f32 v[96:97],v[96:97],v[24:25] op_sel_hi:[1,0] neg_lo:[0,1] neg_hi:[0,1]
v_pk_add_f32 v[98:99],v[98:99],v[24:25] op_sel_hi:[1,0] neg_lo:[0,1] neg_hi:[0,1]
v_pk_add_f32 v[100:101],v[100:101],v[24:25] op_sel_hi:[1,0] neg_lo:[0,1] neg_hi:[0,1]
v_pk_add_f32 v[102:103],v[102:103],v[24:25] op_sel_hi:[1,0] neg_lo:[0,1] neg_hi:[0,1]
v_pk_add_f32 v[104:105],v[104:105],v[24:25] op_sel_hi:[1,0] neg_lo:[0,1] neg_hi:[0,1]
v_pk_add_f32 v[106:107],v[106:107],v[24:25] op_sel_hi:[1,0] neg_lo:[0,1] neg_hi:[0,1]
v_pk_add_f32 v[108:109],v[108:109],v[24:25] op_sel_hi:[1,0] neg_lo:[0,1] neg_hi:[0,1]
v_pk_add_f32 v[110:111],v[110:111],v[24:25] op_sel_hi:[1,0] neg_lo:[0,1] neg_hi:[0,1]
v_cvt_pk_bf16_f32 v6,v72,v73
v_lshlrev_b32 v72,16,v6
v_and_b32 v73,0xffff0000,v6
v_cvt_pk_bf16_f32 v8,v74,v75
v_lshlrev_b32 v74,16,v8
v_and_b32 v75,0xffff0000,v8
v_cvt_pk_bf16_f32 v6,v76,v77
v_lshlrev_b32 v76,16,v6
v_and_b32 v77,0xffff0000,v6
v_cvt_pk_bf16_f32 v8,v78,v79
v_lshlrev_b32 v78,16,v8
v_and_b32 v79,0xffff0000,v8
v_cvt_pk_bf16_f32 v6,v80,v81
v_lshlrev_b32 v80,16,v6
v_and_b32 v81,0xffff0000,v6
v_cvt_pk_bf16_f32 v8,v82,v83
v_lshlrev_b32 v82,16,v8
v_and_b32 v83,0xffff0000,v8
v_cvt_pk_bf16_f32 v6,v84,v85
v_lshlrev_b32 v84,16,v6
v_and_b32 v85,0xffff0000,v6
v_cvt_pk_bf16_f32 v8,v86,v87
v_lshlrev_b32 v86,16,v8
v_and_b32 v87,0xffff0000,v8
v_cvt_pk_bf16_f32 v6,v88,v89
v_lshlrev_b32 v88,16,v6
v_and_b32 v89,0xffff0000,v6
v_cvt_pk_bf16_f32 v8,v90,v91
v_lshlrev_b32 v90,16,v8
v_and_b32 v91,0xffff0000,v8
v_cvt_pk_bf16_f32 v6,v92,v93
v_lshlrev_b32 v92,16,v6
v_and_b32 v93,0xffff0000,v6
v_cvt_pk_bf16_f32 v8,v94,v95
v_lshlrev_b32 v94,16,v8
v_and_b32 v95,0xffff0000,v8
v_cvt_pk_bf16_f32 v6,v96,v97
v_lshlrev_b32 v96,16,v6
v_and_b32 v97,0xffff0000,v6
v_cvt_pk_bf16_f32 v8,v98,v99
v_lshlrev_b32 v98,16,v8
v_and_b32 v99,0xffff0000,v8
v_cvt_pk_bf16_f32 v6,v100,v101
v_lshlrev_b32 v100,16,v6
v_and_b32 v101,0xffff0000,v6
v_cvt_pk_bf16_f32 v8,v102,v103
v_lshlrev_b32 v102,16,v8
v_and_b32 v103,0xffff0000,v8
v_cvt_pk_bf16_f32 v6,v104,v105
v_lshlrev_b32 v104,16,v6
v_and_b32 v105,0xffff0000,v6
v_cvt_pk_bf16_f32 v8,v106,v107
v_lshlrev_b32 v106,16,v8
v_and_b32 v107,0xffff0000,v8
v_cvt_pk_bf16_f32 v6,v108,v109
v_lshlrev_b32 v108,16,v6
v_and_b32 v109,0xffff0000,v6
v_cvt_pk_bf16_f32 v8,v110,v111
v_lshlrev_b32 v110,16,v8
v_and_b32 v111,0xffff0000,v8
v_pk_mul_f32 v[72:73],v[72:73],v[24:25] op_sel:[0,1] op_sel_hi:[1,1]
v_pk_mul_f32 v[74:75],v[74:75],v[24:25] op_sel:[0,1] op_sel_hi:[1,1]
v_pk_mul_f32 v[76:77],v[76:77],v[24:25] op_sel:[0,1] op_sel_hi:[1,1]
v_pk_mul_f32 v[78:79],v[78:79],v[24:25] op_sel:[0,1] op_sel_hi:[1,1]
v_pk_mul_f32 v[80:81],v[80:81],v[24:25] op_sel:[0,1] op_sel_hi:[1,1]
v_pk_mul_f32 v[82:83],v[82:83],v[24:25] op_sel:[0,1] op_sel_hi:[1,1]
v_pk_mul_f32 v[84:85],v[84:85],v[24:25] op_sel:[0,1] op_sel_hi:[1,1]
v_pk_mul_f32 v[86:87],v[86:87],v[24:25] op_sel:[0,1] op_sel_hi:[1,1]
v_pk_mul_f32 v[88:89],v[88:89],v[24:25] op_sel:[0,1] op_sel_hi:[1,1]
v_pk_mul_f32 v[90:91],v[90:91],v[24:25] op_sel:[0,1] op_sel_hi:[1,1]
v_pk_mul_f32 v[92:93],v[92:93],v[24:25] op_sel:[0,1] op_sel_hi:[1,1]
v_pk_mul_f32 v[94:95],v[94:95],v[24:25] op_sel:[0,1] op_sel_hi:[1,1]
v_pk_mul_f32 v[96:97],v[96:97],v[24:25] op_sel:[0,1] op_sel_hi:[1,1]
v_pk_mul_f32 v[98:99],v[98:99],v[24:25] op_sel:[0,1] op_sel_hi:[1,1]
v_pk_mul_f32 v[100:101],v[100:101],v[24:25] op_sel:[0,1] op_sel_hi:[1,1]
v_pk_mul_f32 v[102:103],v[102:103],v[24:25] op_sel:[0,1] op_sel_hi:[1,1]
v_pk_mul_f32 v[104:105],v[104:105],v[24:25] op_sel:[0,1] op_sel_hi:[1,1]
v_pk_mul_f32 v[106:107],v[106:107],v[24:25] op_sel:[0,1] op_sel_hi:[1,1]
v_pk_mul_f32 v[108:109],v[108:109],v[24:25] op_sel:[0,1] op_sel_hi:[1,1]
v_pk_mul_f32 v[110:111],v[110:111],v[24:25] op_sel:[0,1] op_sel_hi:[1,1]
v_cvt_pk_bf16_f32 v112,v72,v73
v_lshlrev_b32 v72,16,v112
v_and_b32 v73,0xffff0000,v112
v_cvt_pk_bf16_f32 v113,v74,v75
v_lshlrev_b32 v74,16,v113
v_and_b32 v75,0xffff0000,v113
v_cvt_pk_bf16_f32 v114,v76,v77
v_lshlrev_b32 v76,16,v114
v_and_b32 v77,0xffff0000,v114
v_cvt_pk_bf16_f32 v115,v78,v79
v_lshlrev_b32 v78,16,v115
v_and_b32 v79,0xffff0000,v115
v_cvt_pk_bf16_f32 v116,v80,v81
v_lshlrev_b32 v80,16,v116
v_and_b32 v81,0xffff0000,v116
v_cvt_pk_bf16_f32 v117,v82,v83
v_lshlrev_b32 v82,16,v117
v_and_b32 v83,0xffff0000,v117
v_cvt_pk_bf16_f32 v118,v84,v85
v_lshlrev_b32 v84,16,v118
v_and_b32 v85,0xffff0000,v118
v_cvt_pk_bf16_f32 v119,v86,v87
v_lshlrev_b32 v86,16,v119
v_and_b32 v87,0xffff0000,v119
v_cvt_pk_bf16_f32 v120,v88,v89
v_lshlrev_b32 v88,16,v120
v_and_b32 v89,0xffff0000,v120
v_cvt_pk_bf16_f32 v121,v90,v91
v_lshlrev_b32 v90,16,v121
v_and_b32 v91,0xffff0000,v121
v_cvt_pk_bf16_f32 v122,v92,v93
v_lshlrev_b32 v92,16,v122
v_and_b32 v93,0xffff0000,v122
v_cvt_pk_bf16_f32 v123,v94,v95
v_lshlrev_b32 v94,16,v123
v_and_b32 v95,0xffff0000,v123
v_cvt_pk_bf16_f32 v124,v96,v97
v_lshlrev_b32 v96,16,v124
v_and_b32 v97,0xffff0000,v124
v_cvt_pk_bf16_f32 v125,v98,v99
v_lshlrev_b32 v98,16,v125
v_and_b32 v99,0xffff0000,v125
v_cvt_pk_bf16_f32 v126,v100,v101
v_lshlrev_b32 v100,16,v126
v_and_b32 v101,0xffff0000,v126
v_cvt_pk_bf16_f32 v127,v102,v103
v_lshlrev_b32 v102,16,v127
v_and_b32 v103,0xffff0000,v127
v_cvt_pk_bf16_f32 v128,v104,v105
v_lshlrev_b32 v104,16,v128
v_and_b32 v105,0xffff0000,v128
v_cvt_pk_bf16_f32 v129,v106,v107
v_lshlrev_b32 v106,16,v129
v_and_b32 v107,0xffff0000,v129
v_cvt_pk_bf16_f32 v130,v108,v109
v_lshlrev_b32 v108,16,v130
v_and_b32 v109,0xffff0000,v130
v_cvt_pk_bf16_f32 v131,v110,v111
v_lshlrev_b32 v110,16,v131
v_and_b32 v111,0xffff0000,v131
s_add_u32 s63,s65,0
v_permlane16_swap_b32 v112,v114
v_permlane16_swap_b32 v113,v115
buffer_store_dwordx4 v[112:115],v132,s[8:11],s63 offen sc1
s_add_u32 s63,s65,8192
v_permlane16_swap_b32 v116,v118
v_permlane16_swap_b32 v117,v119
buffer_store_dwordx4 v[116:119],v132,s[8:11],s63 offen sc1
s_add_u32 s63,s65,16384
v_permlane16_swap_b32 v120,v122
v_permlane16_swap_b32 v121,v123
buffer_store_dwordx4 v[120:123],v132,s[8:11],s63 offen sc1
s_add_u32 s63,s65,24576
v_permlane16_swap_b32 v124,v126
v_permlane16_swap_b32 v125,v127
buffer_store_dwordx4 v[124:127],v132,s[8:11],s63 offen sc1
s_add_u32 s63,s65,32768
v_permlane16_swap_b32 v128,v130
v_permlane16_swap_b32 v129,v131
buffer_store_dwordx4 v[128:131],v132,s[8:11],s63 offen sc1
s_add_u32 s63,s64,0
v_permlane16_swap_b32 v52,v54
v_permlane16_swap_b32 v53,v55
buffer_store_dwordx4 v[52:55],v132,s[8:11],s63 offen sc1
s_add_u32 s63,s64,8192
v_permlane16_swap_b32 v56,v58
v_permlane16_swap_b32 v57,v59
buffer_store_dwordx4 v[56:59],v132,s[8:11],s63 offen sc1
s_add_u32 s63,s64,16384
v_permlane16_swap_b32 v60,v62
v_permlane16_swap_b32 v61,v63
buffer_store_dwordx4 v[60:63],v132,s[8:11],s63 offen sc1
s_add_u32 s63,s64,24576
v_permlane16_swap_b32 v64,v66
v_permlane16_swap_b32 v65,v67
buffer_store_dwordx4 v[64:67],v132,s[8:11],s63 offen sc1
s_add_u32 s63,s64,32768
v_permlane16_swap_b32 v68,v70
v_permlane16_swap_b32 v69,v71
buffer_store_dwordx4 v[68:71],v132,s[8:11],s63 offen sc1
s_lshl_b32 s82,s55,6
s_add_u32 s82,s82,s54
s_lshl_b32 s82,s82,9
s_add_u32 s82,s82,0
s_lshl_b32 s61,s53,2
s_add_u32 s82,s82,s61
s_add_u32 s54,s54,16
s_cmp_lt_u32 s54,64
s_cbranch_scc1 R0_LOOPA
R0_ENDA:
s_waitcnt vmcnt(0)
s_mov_b64 exec,1
buffer_store_dword v5,v1,s[8:11],s82 offen sc1
s_mov_b64 exec,-1
s_mov_b32 s52,s86
s_mul_i32 s60,s86,196608
s_add_u32 s69,s69,s60
s_mul_i32 s60,s86,1024
s_add_u32 s70,s70,s60
s_mov_b32 s70,s69
v_mov_b32 v231,0
s_mov_b32 s83,s100
s_nop 0
ATT_LOOP:
s_lshl_b32 s67,s51,6
s_add_u32 s67,s67,s52
s_lshl_b32 s67,s67,9
s_add_u32 s67,s67,65536
s_mul_i32 s66,s52,393216
s_add_u32 s66,s66,s71
v_cmp_eq_u32 vcc,0,v231
s_nop 0
s_cbranch_vccz ATT_RDY
fb_236:
buffer_load_dword v3,v2,s[8:11],s67 offen sc1
s_waitcnt vmcnt(0)
v_cmp_eq_u32 vcc,0,v3
s_nop 0
s_cbranch_vccz ok_237
s_sleep 20
s_sub_u32 s47,s47,1
s_cbranch_scc1 ABORT
s_branch fb_236
ok_237:
ATT_RDY:
s_add_u32 s63,s66,124780544
buffer_load_dwordx4 v[16:19],v1,s[8:11],s63 offen nt sc1
buffer_load_dwordx4 v[20:23],v1,s[8:11],s63 offen offset:1024 nt sc1
buffer_load_dwordx4 v[24:27],v1,s[8:11],s63 offen offset:2048 nt sc1
buffer_load_dwordx4 v[28:31],v1,s[8:11],s63 offen offset:3072 nt sc1
s_add_u32 s63,s66,124784640
buffer_load_dwordx4 v[32:35],v1,s[8:11],s63 offen nt sc1
buffer_load_dwordx4 v[36:39],v1,s[8:11],s63 offen offset:1024 nt sc1
buffer_load_dwordx4 v[40:43],v1,s[8:11],s63 offen offset:2048 nt sc1
buffer_load_dwordx4 v[44:47],v1,s[8:11],s63 offen offset:3072 nt sc1
s_add_u32 s63,s66,124788736
buffer_load_dwordx4 v[48:51],v1,s[8:11],s63 offen nt sc1
buffer_load_dwordx4 v[52:55],v1,s[8:11],s63 offen offset:1024 nt sc1
buffer_load_dwordx4 v[56:59],v1,s[8:11],s63 offen offset:2048 nt sc1
buffer_load_dwordx4 v[60:63],v1,s[8:11],s63 offen offset:3072 nt sc1
s_add_u32 s63,s66,74448896
buffer_load_dwordx4 v[64:67],v1,s[8:11],s63 offen sc1
buffer_load_dwordx4 v[68:71],v1,s[8:11],s63 offen offset:1024 sc1
buffer_load_dwordx4 v[72:75],v1,s[8:11],s63 offen offset:2048 sc1
buffer_load_dwordx4 v[76:79],v1,s[8:11],s63 offen offset:3072 sc1
s_add_u32 s63,s66,74452992
buffer_load_dwordx4 v[80:83],v1,s[8:11],s63 offen sc1
buffer_load_dwordx4 v[84:87],v1,s[8:11],s63 offen offset:1024 sc1
buffer_load_dwordx4 v[88:91],v1,s[8:11],s63 offen offset:2048 sc1
buffer_load_dwordx4 v[92:95],v1,s[8:11],s63 offen offset:3072 sc1
s_add_u32 s63,s66,74457088
buffer_load_dwordx4 v[96:99],v1,s[8:11],s63 offen sc1
buffer_load_dwordx4 v[100:103],v1,s[8:11],s63 offen offset:1024 sc1
buffer_load_dwordx4 v[104:107],v1,s[8:11],s63 offen offset:2048 sc1
buffer_load_dwordx4 v[108:111],v1,s[8:11],s63 offen offset:3072 sc1
s_add_u32 s63,s66,99614720
buffer_load_dwordx4 v[112:115],v1,s[8:11],s63 offen sc1
buffer_load_dwordx4 v[116:119],v1,s[8:11],s63 offen offset:1024 sc1
buffer_load_dwordx4 v[120:123],v1,s[8:11],s63 offen offset:2048 sc1
buffer_load_dwordx4 v[124:127],v1,s[8:11],s63 offen offset:3072 sc1
s_add_u32 s63,s66,99618816
buffer_load_dwordx4 v[128:131],v1,s[8:11],s63 offen sc1
buffer_load_dwordx4 v[132:135],v1,s[8:11],s63 offen offset:1024 sc1
buffer_load_dwordx4 v[136:139],v1,s[8:11],s63 offen offset:2048 sc1
buffer_load_dwordx4 v[140:143],v1,s[8:11],s63 offen offset:3072 sc1
s_add_u32 s63,s66,99622912
buffer_load_dwordx4 v[144:147],v1,s[8:11],s63 offen sc1
buffer_load_dwordx4 v[148:151],v1,s[8:11],s63 offen offset:1024 sc1
buffer_load_dwordx4 v[152:155],v1,s[8:11],s63 offen offset:2048 sc1
buffer_load_dwordx4 v[156:159],v1,s[8:11],s63 offen offset:3072 sc1
s_and_b32 s66,s52,3
s_lshl2_add_u32 s66,s51,s66
s_mul_i32 s66,s66,393216
s_add_u32 s66,s66,s71
v_lshlrev_b32 v232,7,v0
s_add_u32 s63,s66,149946368
buffer_load_dword v233,v232,s[8:11],s63 offen sc1
s_add_u32 s63,s66,149950464
buffer_load_dword v233,v232,s[8:11],s63 offen sc1
s_waitcnt vmcnt(14)
v_mfma_f32_16x16x32_bf16 v[184:187],v[64:67],v[16:19],0
v_mfma_f32_16x16x32_bf16 v[188:191],v[64:67],v[20:23],0
v_mfma_f32_16x16x32_bf16 v[192:195],v[68:71],v[20:23],0
v_mfma_f32_16x16x32_bf16 v[184:187],v[72:75],v[24:27],v[184:187]
v_mfma_f32_16x16x32_bf16 v[188:191],v[72:75],v[28:31],v[188:191]
v_mfma_f32_16x16x32_bf16 v[192:195],v[76:79],v[28:31],v[192:195]
v_mfma_f32_16x16x32_bf16 v[184:187],v[80:83],v[32:35],v[184:187]
v_mfma_f32_16x16x32_bf16 v[188:191],v[80:83],v[36:39],v[188:191]
v_mfma_f32_16x16x32_bf16 v[192:195],v[84:87],v[36:39],v[192:195]
v_mfma_f32_16x16x32_bf16 v[184:187],v[88:91],v[40:43],v[184:187]
v_mfma_f32_16x16x32_bf16 v[188:191],v[88:91],v[44:47],v[188:191]
v_mfma_f32_16x16x32_bf16 v[192:195],v[92:95],v[44:47],v[192:195]
v_mfma_f32_16x16x32_bf16 v[184:187],v[96:99],v[48:51],v[184:187]
v_mfma_f32_16x16x32_bf16 v[188:191],v[96:99],v[52:55],v[188:191]
v_mfma_f32_16x16x32_bf16 v[192:195],v[100:103],v[52:55],v[192:195]
v_mfma_f32_16x16x32_bf16 v[184:187],v[104:107],v[56:59],v[184:187]
v_mfma_f32_16x16x32_bf16 v[188:191],v[104:107],v[60:63],v[188:191]
v_mfma_f32_16x16x32_bf16 v[192:195],v[108:111],v[60:63],v[192:195]
s_nop 1
v_cvt_pk_bf16_f32 v6,v184,v185
v_lshlrev_b32 v184,16,v6
v_and_b32 v185,0xffff0000,v6
v_cvt_pk_bf16_f32 v6,v186,v187
v_lshlrev_b32 v186,16,v6
v_and_b32 v187,0xffff0000,v6
v_cvt_pk_bf16_f32 v6,v188,v189
v_lshlrev_b32 v188,16,v6
v_and_b32 v189,0xffff0000,v6
v_cvt_pk_bf16_f32 v6,v190,v191
v_lshlrev_b32 v190,16,v6
v_and_b32 v191,0xffff0000,v6
v_cvt_pk_bf16_f32 v6,v192,v193
v_lshlrev_b32 v192,16,v6
v_and_b32 v193,0xffff0000,v6
v_cvt_pk_bf16_f32 v6,v194,v195
v_lshlrev_b32 v194,16,v6
v_and_b32 v195,0xffff0000,v6
v_mul_f32 v184,s84,v184
v_mul_f32 v185,s84,v185
v_mul_f32 v186,s84,v186
v_mul_f32 v187,s84,v187
v_mul_f32 v188,s84,v188
v_mul_f32 v189,s84,v189
v_mul_f32 v190,s84,v190
v_mul_f32 v191,s84,v191
v_mul_f32 v192,s84,v192
v_mul_f32 v193,s84,v193
v_mul_f32 v194,s84,v194
v_mul_f32 v195,s84,v195
v_cvt_pk_bf16_f32 v6,v184,v185
v_lshlrev_b32 v184,16,v6
v_and_b32 v185,0xffff0000,v6
v_cvt_pk_bf16_f32 v6,v186,v187
v_lshlrev_b32 v186,16,v6
v_and_b32 v187,0xffff0000,v6
v_cvt_pk_bf16_f32 v6,v188,v189
v_lshlrev_b32 v188,16,v6
v_and_b32 v189,0xffff0000,v6
v_cvt_pk_bf16_f32 v6,v190,v191
v_lshlrev_b32 v190,16,v6
v_and_b32 v191,0xffff0000,v6
v_cvt_pk_bf16_f32 v6,v192,v193
v_lshlrev_b32 v192,16,v6
v_and_b32 v193,0xffff0000,v6
v_cvt_pk_bf16_f32 v6,v194,v195
v_lshlrev_b32 v194,16,v6
v_and_b32 v195,0xffff0000,v6
v_cndmask_b32 v184,v230,v184,s[72:73]
v_cndmask_b32 v185,v230,v185,s[74:75]
v_cndmask_b32 v186,v230,v186,s[76:77]
v_cndmask_b32 v187,v230,v187,s[78:79]
v_cndmask_b32 v192,v230,v192,s[72:73]
v_cndmask_b32 v193,v230,v193,s[74:75]
v_cndmask_b32 v194,v230,v194,s[76:77]
v_cndmask_b32 v195,v230,v195,s[78:79]
v_max3_f32 v241,v188,v189,v190
v_max3_f32 v240,v184,v185,v186
v_max3_f32 v241,v241,v191,v192
v_max_f32 v240,v240,v187
v_max3_f32 v241,v241,v193,v194
v_mov_b32 v244,v240
v_max_f32 v241,v241,v195
s_nop 0
v_permlane32_swap_b32 v240,v244
v_mov_b32 v248,v241
v_max_f32 v240,v240,v244
s_nop 0
v_permlane32_swap_b32 v241,v248
v_mov_b32 v244,v240
v_max_f32 v241,v241,v248
s_nop 0
v_permlane16_swap_b32 v240,v244
v_mov_b32 v248,v241
v_max_f32 v240,v240,v244
s_nop 0
v_permlane16_swap_b32 v241,v248
v_mul_f32 v244,s85,v240
v_max_f32 v241,v241,v248
v_fma_f32 v184,v184,s85,-v244
v_mul_f32 v248,s85,v241
v_fma_f32 v185,v185,s85,-v244
v_fma_f32 v188,v188,s85,-v248
v_fma_f32 v186,v186,s85,-v244
v_fma_f32 v189,v189,s85,-v248
v_fma_f32 v187,v187,s85,-v244
v_fma_f32 v190,v190,s85,-v248
v_exp_f32 v184,v184
v_fma_f32 v191,v191,s85,-v248
v_exp_f32 v185,v185
v_fma_f32 v192,v192,s85,-v248
v_exp_f32 v186,v186
v_fma_f32 v193,v193,s85,-v248
v_exp_f32 v187,v187
v_fma_f32 v194,v194,s85,-v248
v_add_f32 v242,v184,v185
v_fma_f32 v195,v195,s85,-v248
v_add_f32 v242,v242,v186
v_exp_f32 v188,v188
v_add_f32 v242,v242,v187
v_exp_f32 v189,v189
v_exp_f32 v190,v190
v_exp_f32 v191,v191
v_exp_f32 v192,v192
v_exp_f32 v193,v193
v_exp_f32 v194,v194
v_exp_f32 v195,v195
v_add_f32 v243,v188,v189
v_add_f32 v243,v243,v190
v_add_f32 v243,v243,v191
v_add_f32 v243,v243,v192
v_add_f32 v243,v243,v193
v_add_f32 v243,v243,v194
v_add_f32 v243,v243,v195
v_mov_b32 v215,0
v_mov_b32 v225,0
v_mov_b32 v226,0
s_add_u32 s66,s66,149946368
s_lshl_b32 s82,s51,6
s_add_u32 s82,s82,s52
s_lshl_b32 s82,s82,9
s_add_u32 s82,s82,262144
s_lshl_b32 s61,s87,2
s_add_u32 s82,s82,s61
s_lshl_b32 s65,s51,5
s_add_u32 s65,s65,s68
s_lshl_b32 s65,s65,5
s_add_u32 s65,s65,983040
s_sub_u32 s64,s52,3
v_min_u32 v244,4,v0
v_lshlrev_b32 v244,2,v244
s_nop 1
ob_238:
buffer_load_dword v3,v244,s[8:11],s65 offen sc1
s_waitcnt vmcnt(0)
v_cmp_gt_i32 vcc,s64,v3
s_nop 0
s_cbranch_vccz ok_239
s_sleep 2
s_sub_u32 s47,s47,1
s_cbranch_scc1 ABORT
s_branch ob_238
ok_239:
s_and_b32 s69,s52,14
s_mul_i32 s69,s69,196608
s_add_u32 s69,s69,s70
s_bfe_u32 s65,s52,0x10004
xk_240:
buffer_load_dwordx4 v[160:163],v1,s[8:11],s69 offen sc1
buffer_load_dwordx4 v[164:167],v1,s[8:11],s69 offen offset:1024 sc1
buffer_load_dwordx4 v[168:171],v1,s[8:11],s69 offen offset:2048 sc1
s_waitcnt vmcnt(0)
v_bitop3_b32 v3,v160,v164,s65 bitop3:0x7e
v_xor_b32 v244,s65,v168
v_bitop3_b32 v3,v3,v244,1 bitop3:0xa8
v_cmp_ne_u32 vcc,0,v3
s_nop 0
s_cbranch_vccz ok_241
s_sleep 4
s_sub_u32 s47,s47,1
s_cbranch_scc1 ABORT
s_branch xk_240
ok_241:
s_add_u32 s63,s69,3072
v_lshlrev_b32 v3,3,v0
buffer_load_dwordx4 v[172:175],v1,s[8:11],s63 offen sc1
buffer_load_dwordx2 v[176:177],v3,s[8:11],s63 offen offset:1024 sc1
buffer_load_dwordx4 v[178:181],v1,s[8:11],s63 offen offset:1536 sc1
buffer_load_dwordx2 v[182:183],v3,s[8:11],s63 offen offset:2560 sc1
buffer_load_dword v231,v2,s[8:11],s67 offen offset:1024 sc1
s_waitcnt vmcnt(5)
v_mfma_f32_16x16x32_bf16 v[196:199],v[160:163],v[16:19],0
v_mfma_f32_16x16x32_bf16 v[200:203],v[160:163],v[24:27],0
v_mfma_f32_16x16x32_bf16 v[204:207],v[160:163],v[20:23],0
v_mfma_f32_16x16x32_bf16 v[208:211],v[160:163],v[28:31],0
v_mfma_f32_16x16x32_bf16 v[196:199],v[164:167],v[32:35],v[196:199]
v_mfma_f32_16x16x32_bf16 v[200:203],v[164:167],v[40:43],v[200:203]
v_mfma_f32_16x16x32_bf16 v[204:207],v[164:167],v[36:39],v[204:207]
v_mfma_f32_16x16x32_bf16 v[208:211],v[164:167],v[44:47],v[208:211]
v_mfma_f32_16x16x32_bf16 v[196:199],v[168:171],v[48:51],v[196:199]
v_mfma_f32_16x16x32_bf16 v[200:203],v[168:171],v[56:59],v[200:203]
v_mfma_f32_16x16x32_bf16 v[204:207],v[168:171],v[52:55],v[204:207]
v_mfma_f32_16x16x32_bf16 v[208:211],v[168:171],v[60:63],v[208:211]
s_nop 7
v_add_f32 v204,v204,v210
v_add_f32 v196,v196,v202
v_add_f32 v205,v205,v211
v_add_f32 v197,v197,v203
v_cvt_pk_bf16_f32 v248,v204,v205
v_cvt_pk_bf16_f32 v244,v196,v197
v_lshlrev_b32 v204,16,v248
v_lshlrev_b32 v196,16,v244
v_and_b32 v205,0xffff0000,v248
v_and_b32 v197,0xffff0000,v244
v_mul_f32 v204,s84,v204
v_mul_f32 v196,s84,v196
v_mul_f32 v205,s84,v205
v_mul_f32 v197,s84,v197
v_cvt_pk_bf16_f32 v248,v204,v205
v_cvt_pk_bf16_f32 v244,v196,v197
v_lshlrev_b32 v204,16,v248
v_lshlrev_b32 v196,16,v244
v_and_b32 v205,0xffff0000,v248
v_and_b32 v197,0xffff0000,v244
v_max3_f32 v248,v204,v205,v241
v_max3_f32 v244,v196,v197,v240
v_mov_b32 v249,v248
v_mov_b32 v245,v244
s_nop 0
v_permlane32_swap_b32 v248,v249
v_permlane32_swap_b32 v244,v245
v_max_f32 v248,v248,v249
v_max_f32 v244,v244,v245
v_mov_b32 v249,v248
v_mov_b32 v245,v244
s_nop 0
v_permlane16_swap_b32 v248,v249
v_permlane16_swap_b32 v244,v245
v_max_f32 v248,v248,v249
v_max_f32 v244,v244,v245
v_mul_f32 v248,s85,v248
v_mul_f32 v244,s85,v244
v_fma_f32 v250,v241,s85,-v248
v_fma_f32 v246,v240,s85,-v244
v_fma_f32 v204,v204,s85,-v248
v_fma_f32 v196,v196,s85,-v244
v_fma_f32 v205,v205,s85,-v248
v_fma_f32 v197,v197,s85,-v244
v_exp_f32 v250,v250
v_exp_f32 v246,v246
v_exp_f32 v204,v204
v_exp_f32 v196,v196
v_exp_f32 v205,v205
v_exp_f32 v197,v197
v_fma_f32 v248,v250,v243,v204
v_fma_f32 v244,v246,v242,v196
v_add_f32 v248,v248,v205
v_add_f32 v244,v244,v197
v_mov_b32 v249,v248
v_mov_b32 v245,v244
s_nop 0
v_permlane32_swap_b32 v248,v249
v_permlane32_swap_b32 v244,v245
v_add_f32 v248,v248,v249
v_add_f32 v244,v244,v245
v_mov_b32 v249,v248
v_mov_b32 v245,v244
s_nop 0
v_permlane16_swap_b32 v248,v249
v_permlane16_swap_b32 v244,v245
v_add_f32 v248,v248,v249
v_add_f32 v244,v244,v245
v_rcp_f32 v248,v248
v_rcp_f32 v244,v244
v_mul_f32 v250,v250,v248
v_mul_f32 v246,v246,v244
v_mul_f32 v188,v188,v250
v_mul_f32 v184,v184,v246
v_mul_f32 v189,v189,v250
v_mul_f32 v185,v185,v246
v_mul_f32 v190,v190,v250
v_mul_f32 v186,v186,v246
v_mul_f32 v191,v191,v250
v_mul_f32 v187,v187,v246
v_mul_f32 v192,v192,v250
v_cvt_pk_bf16_f32 v212,v184,v185
v_mul_f32 v193,v193,v250
v_cvt_pk_bf16_f32 v213,v186,v187
v_mul_f32 v194,v194,v250
v_mul_f32 v196,v196,v244
v_mul_f32 v195,v195,v250
v_mul_f32 v197,v197,v244
v_cvt_pk_bf16_f32 v220,v188,v189
v_cvt_pk_bf16_f32 v214,v196,v197
v_cvt_pk_bf16_f32 v221,v190,v191
v_cvt_pk_bf16_f32 v222,v192,v193
v_cvt_pk_bf16_f32 v223,v194,v195
v_mul_f32 v204,v204,v248
v_mul_f32 v205,v205,v248
v_cvt_pk_bf16_f32 v224,v204,v205
v_cvt_pk_bf16_f32 v227,v204,v205
s_waitcnt vmcnt(1)
s_nop 0
xv_242:
v_bitop3_b32 v244,v172,v176,s65 bitop3:0x7e
v_bitop3_b32 v245,v178,v182,s65 bitop3:0x7e
v_bitop3_b32 v244,v244,v245,1 bitop3:0xa8
v_cmp_ne_u32 vcc,0,v244
s_nop 0
s_cbranch_vccz xo_243
s_sub_u32 s47,s47,1
s_cbranch_scc1 ABORT
buffer_load_dwordx4 v[172:175],v1,s[8:11],s63 offen sc1
buffer_load_dwordx2 v[176:177],v3,s[8:11],s63 offen offset:1024 sc1
buffer_load_dwordx4 v[178:181],v1,s[8:11],s63 offen offset:1536 sc1
buffer_load_dwordx2 v[182:183],v3,s[8:11],s63 offen offset:2560 sc1
s_waitcnt vmcnt(0)
s_branch xv_242
xo_243:
s_cmp_lg_u32 s49,0
s_cbranch_scc1 ATT_OS
v_mfma_f32_16x16x32_bf16 v[64:67],v[112:115],v[220:223],0
v_mfma_f32_16x16x32_bf16 v[68:71],v[116:119],v[220:223],0
v_mfma_f32_16x16x16_bf16 v[64:67],v[172:173],v[224:225],v[64:67]
v_mov_b32 v114,v172
v_mov_b32 v118,v173
v_mfma_f32_16x16x16_bf16 v[68:71],v[172:173],v[226:227],v[68:71]
v_mfma_f32_16x16x32_bf16 v[72:75],v[120:123],v[220:223],0
v_mfma_f32_16x16x32_bf16 v[76:79],v[124:127],v[220:223],0
v_cvt_pk_bf16_f32 v232,v64,v65
v_cvt_pk_bf16_f32 v233,v66,v67
v_mfma_f32_16x16x16_bf16 v[72:75],v[174:175],v[224:225],v[72:75]
v_mov_b32 v122,v174
v_mov_b32 v126,v175
v_mfma_f32_16x16x16_bf16 v[76:79],v[174:175],v[226:227],v[76:79]
v_cvt_pk_bf16_f32 v234,v68,v69
v_cvt_pk_bf16_f32 v235,v70,v71
s_add_u32 s63,s66,256
v_mfma_f32_16x16x32_bf16 v[80:83],v[128:131],v[220:223],0
buffer_store_dwordx4 v[232:235],v229,s[8:11],s63 offen offset:0
v_mfma_f32_16x16x32_bf16 v[84:87],v[132:135],v[220:223],0
v_cvt_pk_bf16_f32 v236,v72,v73
v_cvt_pk_bf16_f32 v237,v74,v75
v_mfma_f32_16x16x16_bf16 v[80:83],v[176:177],v[224:225],v[80:83]
v_mov_b32 v130,v176
v_mov_b32 v134,v177
v_mfma_f32_16x16x16_bf16 v[84:87],v[176:177],v[226:227],v[84:87]
v_cvt_pk_bf16_f32 v238,v76,v77
v_cvt_pk_bf16_f32 v239,v78,v79
v_mfma_f32_16x16x32_bf16 v[88:91],v[136:139],v[220:223],0
buffer_store_dwordx4 v[236:239],v229,s[8:11],s63 offen offset:2048
v_mfma_f32_16x16x32_bf16 v[92:95],v[140:143],v[220:223],0
v_cvt_pk_bf16_f32 v232,v80,v81
v_cvt_pk_bf16_f32 v233,v82,v83
v_mfma_f32_16x16x16_bf16 v[88:91],v[178:179],v[224:225],v[88:91]
v_mov_b32 v138,v178
v_mov_b32 v142,v179
v_mfma_f32_16x16x16_bf16 v[92:95],v[178:179],v[226:227],v[92:95]
v_cvt_pk_bf16_f32 v234,v84,v85
v_cvt_pk_bf16_f32 v235,v86,v87
s_add_u32 s63,s66,4352
v_mfma_f32_16x16x32_bf16 v[96:99],v[144:147],v[220:223],0
buffer_store_dwordx4 v[232:235],v229,s[8:11],s63 offen offset:0
v_mfma_f32_16x16x32_bf16 v[100:103],v[148:151],v[220:223],0
v_cvt_pk_bf16_f32 v236,v88,v89
v_cvt_pk_bf16_f32 v237,v90,v91
v_mfma_f32_16x16x16_bf16 v[96:99],v[180:181],v[224:225],v[96:99]
v_mov_b32 v146,v180
v_mov_b32 v150,v181
v_mfma_f32_16x16x16_bf16 v[100:103],v[180:181],v[226:227],v[100:103]
v_cvt_pk_bf16_f32 v238,v92,v93
v_cvt_pk_bf16_f32 v239,v94,v95
v_mfma_f32_16x16x32_bf16 v[104:107],v[152:155],v[220:223],0
buffer_store_dwordx4 v[236:239],v229,s[8:11],s63 offen offset:2048
v_mfma_f32_16x16x32_bf16 v[108:111],v[156:159],v[220:223],0
v_cvt_pk_bf16_f32 v232,v96,v97
v_cvt_pk_bf16_f32 v233,v98,v99
v_mfma_f32_16x16x16_bf16 v[104:107],v[182:183],v[224:225],v[104:107]
v_mov_b32 v154,v182
v_mov_b32 v158,v183
v_mfma_f32_16x16x16_bf16 v[108:111],v[182:183],v[226:227],v[108:111]
v_cvt_pk_bf16_f32 v234,v100,v101
v_cvt_pk_bf16_f32 v235,v102,v103
s_add_u32 s63,s66,8448
v_mfma_f32_16x16x32_bf16 v[16:19],v[112:115],v[212:215],0
buffer_store_dwordx4 v[232:235],v229,s[8:11],s63 offen offset:0
v_mfma_f32_16x16x32_bf16 v[20:23],v[116:119],v[212:215],0
v_cvt_pk_bf16_f32 v236,v104,v105
v_cvt_pk_bf16_f32 v237,v106,v107
v_mfma_f32_16x16x32_bf16 v[24:27],v[120:123],v[212:215],0
v_cvt_pk_bf16_f32 v238,v108,v109
v_cvt_pk_bf16_f32 v239,v110,v111
v_mfma_f32_16x16x32_bf16 v[28:31],v[124:127],v[212:215],0
buffer_store_dwordx4 v[236:239],v229,s[8:11],s63 offen offset:2048
v_cvt_pk_bf16_f32 v232,v16,v17
v_mfma_f32_16x16x32_bf16 v[32:35],v[128:131],v[212:215],0
v_cvt_pk_bf16_f32 v233,v18,v19
v_cvt_pk_bf16_f32 v234,v20,v21
v_mfma_f32_16x16x32_bf16 v[36:39],v[132:135],v[212:215],0
v_cvt_pk_bf16_f32 v235,v22,v23
s_add_u32 s63,s66,0
v_mfma_f32_16x16x32_bf16 v[40:43],v[136:139],v[212:215],0
buffer_store_dwordx4 v[232:235],v229,s[8:11],s63 offen offset:0
v_cvt_pk_bf16_f32 v236,v24,v25
v_mfma_f32_16x16x32_bf16 v[44:47],v[140:143],v[212:215],0
v_cvt_pk_bf16_f32 v237,v26,v27
v_cvt_pk_bf16_f32 v238,v28,v29
v_mfma_f32_16x16x32_bf16 v[48:51],v[144:147],v[212:215],0
v_cvt_pk_bf16_f32 v239,v30,v31
buffer_store_dwordx4 v[236:239],v229,s[8:11],s63 offen offset:2048
v_mfma_f32_16x16x32_bf16 v[52:55],v[148:151],v[212:215],0
v_cvt_pk_bf16_f32 v232,v32,v33
v_cvt_pk_bf16_f32 v233,v34,v35
v_mfma_f32_16x16x32_bf16 v[56:59],v[152:155],v[212:215],0
v_cvt_pk_bf16_f32 v234,v36,v37
v_cvt_pk_bf16_f32 v235,v38,v39
s_add_u32 s63,s66,4096
v_mfma_f32_16x16x32_bf16 v[60:63],v[156:159],v[212:215],0
buffer_store_dwordx4 v[232:235],v229,s[8:11],s63 offen offset:0
v_cvt_pk_bf16_f32 v236,v40,v41
v_cvt_pk_bf16_f32 v237,v42,v43
v_cvt_pk_bf16_f32 v238,v44,v45
v_cvt_pk_bf16_f32 v239,v46,v47
buffer_store_dwordx4 v[236:239],v229,s[8:11],s63 offen offset:2048
v_cvt_pk_bf16_f32 v232,v48,v49
v_cvt_pk_bf16_f32 v233,v50,v51
v_cvt_pk_bf16_f32 v234,v52,v53
v_cvt_pk_bf16_f32 v235,v54,v55
s_add_u32 s63,s66,8192
buffer_store_dwordx4 v[232:235],v229,s[8:11],s63 offen offset:0
v_cvt_pk_bf16_f32 v236,v56,v57
v_cvt_pk_bf16_f32 v237,v58,v59
v_cvt_pk_bf16_f32 v238,v60,v61
v_cvt_pk_bf16_f32 v239,v62,v63
buffer_store_dwordx4 v[236:239],v229,s[8:11],s63 offen offset:2048
s_waitcnt vmcnt(0)
s_mov_b64 exec,1
buffer_store_dword v5,v1,s[8:11],s82 offen
s_mov_b64 exec,-1
s_branch ATT_OJ
ATT_OS:
v_mfma_f32_16x16x32_bf16 v[64:67],v[112:115],v[220:223],0
v_mfma_f32_16x16x32_bf16 v[68:71],v[116:119],v[220:223],0
v_mfma_f32_16x16x16_bf16 v[64:67],v[172:173],v[224:225],v[64:67]
v_mov_b32 v114,v172
v_mov_b32 v118,v173
v_mfma_f32_16x16x16_bf16 v[68:71],v[172:173],v[226:227],v[68:71]
v_mfma_f32_16x16x32_bf16 v[72:75],v[120:123],v[220:223],0
v_mfma_f32_16x16x32_bf16 v[76:79],v[124:127],v[220:223],0
v_cvt_pk_bf16_f32 v232,v64,v65
v_cvt_pk_bf16_f32 v233,v66,v67
v_mfma_f32_16x16x16_bf16 v[72:75],v[174:175],v[224:225],v[72:75]
v_mov_b32 v122,v174
v_mov_b32 v126,v175
v_mfma_f32_16x16x16_bf16 v[76:79],v[174:175],v[226:227],v[76:79]
v_cvt_pk_bf16_f32 v234,v68,v69
v_cvt_pk_bf16_f32 v235,v70,v71
s_add_u32 s63,s66,256
v_mfma_f32_16x16x32_bf16 v[80:83],v[128:131],v[220:223],0
buffer_store_dwordx4 v[232:235],v229,s[8:11],s63 offen sc1
v_mfma_f32_16x16x32_bf16 v[84:87],v[132:135],v[220:223],0
v_cvt_pk_bf16_f32 v236,v72,v73
v_cvt_pk_bf16_f32 v237,v74,v75
v_mfma_f32_16x16x16_bf16 v[80:83],v[176:177],v[224:225],v[80:83]
v_mov_b32 v130,v176
v_mov_b32 v134,v177
v_mfma_f32_16x16x16_bf16 v[84:87],v[176:177],v[226:227],v[84:87]
v_cvt_pk_bf16_f32 v238,v76,v77
v_cvt_pk_bf16_f32 v239,v78,v79
v_mfma_f32_16x16x32_bf16 v[88:91],v[136:139],v[220:223],0
buffer_store_dwordx4 v[236:239],v229,s[8:11],s63 offen offset:2048 sc1
v_mfma_f32_16x16x32_bf16 v[92:95],v[140:143],v[220:223],0
v_cvt_pk_bf16_f32 v232,v80,v81
v_cvt_pk_bf16_f32 v233,v82,v83
v_mfma_f32_16x16x16_bf16 v[88:91],v[178:179],v[224:225],v[88:91]
v_mov_b32 v138,v178
v_mov_b32 v142,v179
v_mfma_f32_16x16x16_bf16 v[92:95],v[178:179],v[226:227],v[92:95]
v_cvt_pk_bf16_f32 v234,v84,v85
v_cvt_pk_bf16_f32 v235,v86,v87
s_add_u32 s63,s66,4352
v_mfma_f32_16x16x32_bf16 v[96:99],v[144:147],v[220:223],0
buffer_store_dwordx4 v[232:235],v229,s[8:11],s63 offen sc1
v_mfma_f32_16x16x32_bf16 v[100:103],v[148:151],v[220:223],0
v_cvt_pk_bf16_f32 v236,v88,v89
v_cvt_pk_bf16_f32 v237,v90,v91
v_mfma_f32_16x16x16_bf16 v[96:99],v[180:181],v[224:225],v[96:99]
v_mov_b32 v146,v180
v_mov_b32 v150,v181
v_mfma_f32_16x16x16_bf16 v[100:103],v[180:181],v[226:227],v[100:103]
v_cvt_pk_bf16_f32 v238,v92,v93
v_cvt_pk_bf16_f32 v239,v94,v95
v_mfma_f32_16x16x32_bf16 v[104:107],v[152:155],v[220:223],0
buffer_store_dwordx4 v[236:239],v229,s[8:11],s63 offen offset:2048 sc1
v_mfma_f32_16x16x32_bf16 v[108:111],v[156:159],v[220:223],0
v_cvt_pk_bf16_f32 v232,v96,v97
v_cvt_pk_bf16_f32 v233,v98,v99
v_mfma_f32_16x16x16_bf16 v[104:107],v[182:183],v[224:225],v[104:107]
v_mov_b32 v154,v182
v_mov_b32 v158,v183
v_mfma_f32_16x16x16_bf16 v[108:111],v[182:183],v[226:227],v[108:111]
v_cvt_pk_bf16_f32 v234,v100,v101
v_cvt_pk_bf16_f32 v235,v102,v103
s_add_u32 s63,s66,8448
v_mfma_f32_16x16x32_bf16 v[16:19],v[112:115],v[212:215],0
buffer_store_dwordx4 v[232:235],v229,s[8:11],s63 offen sc1
v_mfma_f32_16x16x32_bf16 v[20:23],v[116:119],v[212:215],0
v_cvt_pk_bf16_f32 v236,v104,v105
v_cvt_pk_bf16_f32 v237,v106,v107
v_mfma_f32_16x16x32_bf16 v[24:27],v[120:123],v[212:215],0
v_cvt_pk_bf16_f32 v238,v108,v109
v_cvt_pk_bf16_f32 v239,v110,v111
v_mfma_f32_16x16x32_bf16 v[28:31],v[124:127],v[212:215],0
buffer_store_dwordx4 v[236:239],v229,s[8:11],s63 offen offset:2048 sc1
v_cvt_pk_bf16_f32 v232,v16,v17
v_mfma_f32_16x16x32_bf16 v[32:35],v[128:131],v[212:215],0
v_cvt_pk_bf16_f32 v233,v18,v19
v_cvt_pk_bf16_f32 v234,v20,v21
v_mfma_f32_16x16x32_bf16 v[36:39],v[132:135],v[212:215],0
v_cvt_pk_bf16_f32 v235,v22,v23
s_add_u32 s63,s66,0
v_mfma_f32_16x16x32_bf16 v[40:43],v[136:139],v[212:215],0
buffer_store_dwordx4 v[232:235],v229,s[8:11],s63 offen sc1
v_cvt_pk_bf16_f32 v236,v24,v25
v_mfma_f32_16x16x32_bf16 v[44:47],v[140:143],v[212:215],0
v_cvt_pk_bf16_f32 v237,v26,v27
v_cvt_pk_bf16_f32 v238,v28,v29
v_mfma_f32_16x16x32_bf16 v[48:51],v[144:147],v[212:215],0
v_cvt_pk_bf16_f32 v239,v30,v31
buffer_store_dwordx4 v[236:239],v229,s[8:11],s63 offen offset:2048 sc1
v_mfma_f32_16x16x32_bf16 v[52:55],v[148:151],v[212:215],0
v_cvt_pk_bf16_f32 v232,v32,v33
v_cvt_pk_bf16_f32 v233,v34,v35
v_mfma_f32_16x16x32_bf16 v[56:59],v[152:155],v[212:215],0
v_cvt_pk_bf16_f32 v234,v36,v37
v_cvt_pk_bf16_f32 v235,v38,v39
s_add_u32 s63,s66,4096
v_mfma_f32_16x16x32_bf16 v[60:63],v[156:159],v[212:215],0
buffer_store_dwordx4 v[232:235],v229,s[8:11],s63 offen sc1
v_cvt_pk_bf16_f32 v236,v40,v41
v_cvt_pk_bf16_f32 v237,v42,v43
v_cvt_pk_bf16_f32 v238,v44,v45
v_cvt_pk_bf16_f32 v239,v46,v47
buffer_store_dwordx4 v[236:239],v229,s[8:11],s63 offen offset:2048 sc1
v_cvt_pk_bf16_f32 v232,v48,v49
v_cvt_pk_bf16_f32 v233,v50,v51
v_cvt_pk_bf16_f32 v234,v52,v53
v_cvt_pk_bf16_f32 v235,v54,v55
s_add_u32 s63,s66,8192
buffer_store_dwordx4 v[232:235],v229,s[8:11],s63 offen sc1
v_cvt_pk_bf16_f32 v236,v56,v57
v_cvt_pk_bf16_f32 v237,v58,v59
v_cvt_pk_bf16_f32 v238,v60,v61
v_cvt_pk_bf16_f32 v239,v62,v63
buffer_store_dwordx4 v[236:239],v229,s[8:11],s63 offen offset:2048 sc1
s_waitcnt vmcnt(0)
s_mov_b64 exec,1
buffer_store_dword v5,v1,s[8:11],s82 offen sc1
s_mov_b64 exec,-1
ATT_OJ:
s_add_u32 s52,s52,2
s_cmp_lt_u32 s52,64
s_cbranch_scc1 ATT_LOOP
s_endpgm
ROLE_WO:
v_lshlrev_b32 v1,4,v0
v_mov_b32 v5,1
s_lshl_b32 s56,s48,2
s_add_u32 s56,s56,s46
v_bfe_u32 v6,v0,2,2
v_lshrrev_b32 v7,4,v0
v_add_u32 v7,v6,v7
v_and_b32 v7,3,v7
v_and_b32 v15,3,v0
v_lshlrev_b32 v15,4,v15
v_lshl_add_u32 v15,v7,6,v15
v_lshl_add_u32 v15,v6,8,v15
v_lshrrev_b32 v6,5,v0
v_bfe_u32 v7,v0,4,1
v_lshlrev_b32 v16,10,v7
v_lshl_add_u32 v16,v6,8,v16
v_and_b32 v6,15,v0
v_lshl_add_u32 v16,v6,4,v16
v_add_u32 v18,49152,v16
v_lshrrev_b32 v6,5,v0
v_bfe_u32 v7,v0,4,1
v_lshlrev_b32 v20,10,v7
v_lshl_add_u32 v20,v6,8,v20
v_and_b32 v6,15,v0
v_lshl_add_u32 v20,v6,4,v20
v_lshrrev_b32 v6,5,v0
v_add_u32 v6,2,v6
v_bfe_u32 v7,v0,4,1
v_lshlrev_b32 v17,10,v7
v_lshl_add_u32 v17,v6,8,v17
v_and_b32 v6,15,v0
v_lshl_add_u32 v17,v6,4,v17
v_add_u32 v19,49152,v17
v_lshrrev_b32 v6,5,v0
v_add_u32 v6,2,v6
v_bfe_u32 v7,v0,4,1
v_lshlrev_b32 v21,10,v7
v_lshl_add_u32 v21,v6,8,v21
v_and_b32 v6,15,v0
v_lshl_add_u32 v21,v6,4,v21
v_add_u32 v16,0,v1
v_add_u32 v17,1024,v1
v_add_u32 v18,49152,v1
v_add_u32 v19,50176,v1
s_mul_i32 s68,s48,52429
s_lshr_b32 s68,s68,18
s_mul_i32 s60,s68,20
s_sub_u32 s60,s56,s60
s_lshl2_add_u32 s61,s68,s46
s_lshl_b32 s74,s61,5
s_and_b32 s62,s60,-4
s_add_u32 s74,s74,s62
s_add_u32 s74,s74,983040
s_lshr_b32 s62,s61,3
s_mul_i32 s62,s62,24
s_add_u32 s61,s61,s62
s_lshl_b32 s61,s61,2
v_mov_b32 v2,s61
v_bfe_u32 v6,v0,2,3
v_mul_u32_u24 v20,5120,v6
v_and_b32 v6,3,v0
v_lshl_add_u32 v20,v6,4,v20
v_lshrrev_b32 v6,5,v0
v_lshl_add_u32 v20,v6,6,v20
s_mul_i32 s58,s68,983040
s_lshl_b32 s61,s60,6
s_add_u32 s58,s58,s61
s_mul_i32 s69,s68,40960
s_lshl_b32 s60,s60,8
s_add_u32 s69,s69,s60
s_add_u32 s69,s69,175112192
s_lshl_b32 s75,s56,2
s_add_u32 s75,s75,819200
v_mov_b32 v24,-1
v_mov_b32 v25,-1
v_mov_b32 v26,-1
v_mov_b32 v27,-1
s_add_u32 s60,s48,32
s_lshl2_add_u32 s60,s60,s46
s_mul_i32 s60,s60,22528
s_add_u32 s61,s60,24117248
buffer_store_dwordx4 v[24:27],v1,s[8:11],s61 offen sc1
buffer_store_dwordx4 v[24:27],v1,s[8:11],s61 offen offset:1024 sc1
buffer_store_dwordx4 v[24:27],v1,s[8:11],s61 offen offset:2048 sc1
buffer_store_dwordx4 v[24:27],v1,s[8:11],s61 offen offset:3072 sc1
s_add_u32 s61,s60,24121344
buffer_store_dwordx4 v[24:27],v1,s[8:11],s61 offen sc1
buffer_store_dwordx4 v[24:27],v1,s[8:11],s61 offen offset:1024 sc1
buffer_store_dwordx4 v[24:27],v1,s[8:11],s61 offen offset:2048 sc1
buffer_store_dwordx4 v[24:27],v1,s[8:11],s61 offen offset:3072 sc1
s_add_u32 s61,s60,24125440
buffer_store_dwordx4 v[24:27],v1,s[8:11],s61 offen sc1
buffer_store_dwordx4 v[24:27],v1,s[8:11],s61 offen offset:1024 sc1
buffer_store_dwordx4 v[24:27],v1,s[8:11],s61 offen offset:2048 sc1
buffer_store_dwordx4 v[24:27],v1,s[8:11],s61 offen offset:3072 sc1
s_add_u32 s61,s60,24129536
buffer_store_dwordx4 v[24:27],v1,s[8:11],s61 offen sc1
buffer_store_dwordx4 v[24:27],v1,s[8:11],s61 offen offset:1024 sc1
buffer_store_dwordx4 v[24:27],v1,s[8:11],s61 offen offset:2048 sc1
buffer_store_dwordx4 v[24:27],v1,s[8:11],s61 offen offset:3072 sc1
s_add_u32 s61,s60,24133632
buffer_store_dwordx4 v[24:27],v1,s[8:11],s61 offen sc1
buffer_store_dwordx4 v[24:27],v1,s[8:11],s61 offen offset:1024 sc1
buffer_store_dwordx4 v[24:27],v1,s[8:11],s61 offen offset:2048 sc1
buffer_store_dwordx4 v[24:27],v1,s[8:11],s61 offen offset:3072 sc1
s_add_u32 s61,s60,24137728
buffer_store_dwordx4 v[24:27],v1,s[8:11],s61 offen sc1
buffer_store_dwordx4 v[24:27],v1,s[8:11],s61 offen offset:1024 sc1
s_waitcnt vmcnt(0)
s_barrier
s_cmp_lg_u32 s46,0
s_cbranch_scc1 arr_244
v_mov_b32 v6,1
s_lshl_b32 s3,s49,2
v_mov_b32 v7,s3
s_mov_b64 exec,1
buffer_atomic_add v6,v7,s[12:15],0 offen sc1
s_mov_b64 exec,-1
arr_244:
s_lshl_b32 s3,s49,2
v_mov_b32 v7,s3
s_nop 1
ibw_245:
buffer_load_dword v6,v7,s[12:15],0 offen sc1
s_waitcnt vmcnt(0)
v_cmp_ne_u32 vcc,256,v6
s_nop 0
s_cbranch_vccz ok_246
s_sleep 8
s_sub_u32 s47,s47,1
s_cbranch_scc1 ABORT
s_branch ibw_245
ok_246:
s_cmp_lg_u32 s49,0
s_cbranch_scc1 ibok_247
v_and_b32 v7,7,v0
v_lshlrev_b32 v7,2,v7
buffer_load_dword v6,v7,s[12:15],0 offen offset:32 sc1
s_waitcnt vmcnt(0)
v_cmp_ne_u32 vcc,32,v6
s_nop 0
s_cbranch_vccz ibok_247
s_barrier
s_mov_b32 s49,1
s_mov_b32 s3,s2
s_load_dwordx16 s[16:31],s[0:1],0
s_load_dwordx8 s[32:39],s[0:1],64
s_waitcnt lgkmcnt(0)
s_branch DISPATCH
ibok_247:
s_mul_i32 s63,s46,40960
s_mov_b32 s4,s26
s_mov_b32 s5,s27
s_mov_b32 s6,7864320
s_mov_b32 s7,0x20000
v_lshrrev_b32 v9,2,v0
s_mov_b32 s64,1280
v_mul_lo_u32 v9,v9,s64
v_and_b32 v10,3,v0
v_lshl_add_u32 v6,v10,4,v9
s_add_u32 m0,s63,0
s_add_u32 s65,s58,0
buffer_load_dwordx4 v6,s[4:7],s65 offen lds
s_add_u32 m0,s63,1024
s_add_u32 s65,s58,20480
buffer_load_dwordx4 v6,s[4:7],s65 offen lds
s_add_u32 m0,s63,2048
s_add_u32 s65,s58,40960
buffer_load_dwordx4 v6,s[4:7],s65 offen lds
s_add_u32 m0,s63,3072
s_add_u32 s65,s58,61440
buffer_load_dwordx4 v6,s[4:7],s65 offen lds
s_add_u32 m0,s63,4096
s_add_u32 s65,s58,81920
buffer_load_dwordx4 v6,s[4:7],s65 offen lds
s_add_u32 m0,s63,5120
s_add_u32 s65,s58,102400
buffer_load_dwordx4 v6,s[4:7],s65 offen lds
s_add_u32 m0,s63,6144
s_add_u32 s65,s58,122880
buffer_load_dwordx4 v6,s[4:7],s65 offen lds
s_add_u32 m0,s63,7168
s_add_u32 s65,s58,143360
buffer_load_dwordx4 v6,s[4:7],s65 offen lds
s_add_u32 m0,s63,8192
s_add_u32 s65,s58,163840
buffer_load_dwordx4 v6,s[4:7],s65 offen lds
s_add_u32 m0,s63,9216
s_add_u32 s65,s58,184320
buffer_load_dwordx4 v6,s[4:7],s65 offen lds
s_add_u32 m0,s63,10240
s_add_u32 s65,s58,204800
buffer_load_dwordx4 v6,s[4:7],s65 offen lds
s_add_u32 m0,s63,11264
s_add_u32 s65,s58,225280
buffer_load_dwordx4 v6,s[4:7],s65 offen lds
s_add_u32 m0,s63,12288
s_add_u32 s65,s58,245760
buffer_load_dwordx4 v6,s[4:7],s65 offen lds
s_add_u32 m0,s63,13312
s_add_u32 s65,s58,266240
buffer_load_dwordx4 v6,s[4:7],s65 offen lds
s_add_u32 m0,s63,14336
s_add_u32 s65,s58,286720
buffer_load_dwordx4 v6,s[4:7],s65 offen lds
s_add_u32 m0,s63,15360
s_add_u32 s65,s58,307200
buffer_load_dwordx4 v6,s[4:7],s65 offen lds
s_add_u32 m0,s63,16384
s_add_u32 s65,s58,327680
buffer_load_dwordx4 v6,s[4:7],s65 offen lds
s_add_u32 m0,s63,17408
s_add_u32 s65,s58,348160
buffer_load_dwordx4 v6,s[4:7],s65 offen lds
s_add_u32 m0,s63,18432
s_add_u32 s65,s58,368640
buffer_load_dwordx4 v6,s[4:7],s65 offen lds
s_add_u32 m0,s63,19456
s_add_u32 s65,s58,389120
buffer_load_dwordx4 v6,s[4:7],s65 offen lds
s_add_u32 m0,s63,20480
s_add_u32 s65,s58,409600
buffer_load_dwordx4 v6,s[4:7],s65 offen lds
s_add_u32 m0,s63,21504
s_add_u32 s65,s58,430080
buffer_load_dwordx4 v6,s[4:7],s65 offen lds
s_add_u32 m0,s63,22528
s_add_u32 s65,s58,450560
buffer_load_dwordx4 v6,s[4:7],s65 offen lds
s_add_u32 m0,s63,23552
s_add_u32 s65,s58,471040
buffer_load_dwordx4 v6,s[4:7],s65 offen lds
s_add_u32 m0,s63,24576
s_add_u32 s65,s58,491520
buffer_load_dwordx4 v6,s[4:7],s65 offen lds
s_add_u32 m0,s63,25600
s_add_u32 s65,s58,512000
buffer_load_dwordx4 v6,s[4:7],s65 offen lds
s_add_u32 m0,s63,26624
s_add_u32 s65,s58,532480
buffer_load_dwordx4 v6,s[4:7],s65 offen lds
s_add_u32 m0,s63,27648
s_add_u32 s65,s58,552960
buffer_load_dwordx4 v6,s[4:7],s65 offen lds
s_add_u32 m0,s63,28672
s_add_u32 s65,s58,573440
buffer_load_dwordx4 v6,s[4:7],s65 offen lds
s_add_u32 m0,s63,29696
s_add_u32 s65,s58,593920
buffer_load_dwordx4 v6,s[4:7],s65 offen lds
s_add_u32 m0,s63,30720
s_add_u32 s65,s58,614400
buffer_load_dwordx4 v6,s[4:7],s65 offen lds
s_add_u32 m0,s63,31744
s_add_u32 s65,s58,634880
buffer_load_dwordx4 v6,s[4:7],s65 offen lds
s_add_u32 m0,s63,32768
s_add_u32 s65,s58,655360
buffer_load_dwordx4 v6,s[4:7],s65 offen lds
s_add_u32 m0,s63,33792
s_add_u32 s65,s58,675840
buffer_load_dwordx4 v6,s[4:7],s65 offen lds
s_add_u32 m0,s63,34816
s_add_u32 s65,s58,696320
buffer_load_dwordx4 v6,s[4:7],s65 offen lds
s_add_u32 m0,s63,35840
s_add_u32 s65,s58,716800
buffer_load_dwordx4 v6,s[4:7],s65 offen lds
s_add_u32 m0,s63,36864
s_add_u32 s65,s58,737280
buffer_load_dwordx4 v6,s[4:7],s65 offen lds
s_add_u32 m0,s63,37888
s_add_u32 s65,s58,757760
buffer_load_dwordx4 v6,s[4:7],s65 offen lds
s_add_u32 m0,s63,38912
s_add_u32 s65,s58,778240
buffer_load_dwordx4 v6,s[4:7],s65 offen lds
s_add_u32 m0,s63,39936
s_add_u32 s65,s58,798720
buffer_load_dwordx4 v6,s[4:7],s65 offen lds
s_waitcnt vmcnt(20)
v_bfe_u32 v9,v0,2,2
v_lshrrev_b32 v10,5,v0
v_lshl_add_u32 v9,v10,2,v9
v_mul_u32_u24 v9,64,v9
v_and_b32 v10,1,v0
v_lshl_add_u32 v9,v10,3,v9
v_bfe_u32 v10,v0,1,1
v_lshl_add_u32 v9,v10,5,v9
v_bfe_u32 v10,v0,4,1
v_lshl_add_u32 v9,v10,4,v9
v_add_u32 v7,s63,v9
ds_read_b64_tr_b16 a[0:1],v7 offset:0
ds_read_b64_tr_b16 a[2:3],v7 offset:1024
ds_read_b64_tr_b16 a[4:5],v7 offset:512
ds_read_b64_tr_b16 a[6:7],v7 offset:1536
ds_read_b64_tr_b16 a[8:9],v7 offset:2048
ds_read_b64_tr_b16 a[10:11],v7 offset:3072
ds_read_b64_tr_b16 a[12:13],v7 offset:2560
ds_read_b64_tr_b16 a[14:15],v7 offset:3584
ds_read_b64_tr_b16 a[16:17],v7 offset:4096
ds_read_b64_tr_b16 a[18:19],v7 offset:5120
ds_read_b64_tr_b16 a[20:21],v7 offset:4608
ds_read_b64_tr_b16 a[22:23],v7 offset:5632
s_waitcnt lgkmcnt(4)
ds_read_b64_tr_b16 a[24:25],v7 offset:6144
ds_read_b64_tr_b16 a[26:27],v7 offset:7168
ds_read_b64_tr_b16 a[28:29],v7 offset:6656
ds_read_b64_tr_b16 a[30:31],v7 offset:7680
ds_read_b64_tr_b16 a[32:33],v7 offset:8192
ds_read_b64_tr_b16 a[34:35],v7 offset:9216
ds_read_b64_tr_b16 a[36:37],v7 offset:8704
ds_read_b64_tr_b16 a[38:39],v7 offset:9728
ds_read_b64_tr_b16 a[40:41],v7 offset:10240
ds_read_b64_tr_b16 a[42:43],v7 offset:11264
ds_read_b64_tr_b16 a[44:45],v7 offset:10752
ds_read_b64_tr_b16 a[46:47],v7 offset:11776
s_waitcnt lgkmcnt(4)
ds_read_b64_tr_b16 a[48:49],v7 offset:12288
ds_read_b64_tr_b16 a[50:51],v7 offset:13312
ds_read_b64_tr_b16 a[52:53],v7 offset:12800
ds_read_b64_tr_b16 a[54:55],v7 offset:13824
ds_read_b64_tr_b16 a[56:57],v7 offset:14336
ds_read_b64_tr_b16 a[58:59],v7 offset:15360
ds_read_b64_tr_b16 a[60:61],v7 offset:14848
ds_read_b64_tr_b16 a[62:63],v7 offset:15872
ds_read_b64_tr_b16 a[64:65],v7 offset:16384
ds_read_b64_tr_b16 a[66:67],v7 offset:17408
ds_read_b64_tr_b16 a[68:69],v7 offset:16896
ds_read_b64_tr_b16 a[70:71],v7 offset:17920
s_waitcnt lgkmcnt(4)
ds_read_b64_tr_b16 a[72:73],v7 offset:18432
ds_read_b64_tr_b16 a[74:75],v7 offset:19456
ds_read_b64_tr_b16 a[76:77],v7 offset:18944
ds_read_b64_tr_b16 a[78:79],v7 offset:19968
s_waitcnt lgkmcnt(0)
s_add_u32 m0,s63,0
s_add_u32 s65,s58,819200
buffer_load_dwordx4 v6,s[4:7],s65 offen lds
s_add_u32 m0,s63,1024
s_add_u32 s65,s58,839680
buffer_load_dwordx4 v6,s[4:7],s65 offen lds
s_add_u32 m0,s63,2048
s_add_u32 s65,s58,860160
buffer_load_dwordx4 v6,s[4:7],s65 offen lds
s_add_u32 m0,s63,3072
s_add_u32 s65,s58,880640
buffer_load_dwordx4 v6,s[4:7],s65 offen lds
s_add_u32 m0,s63,4096
s_add_u32 s65,s58,901120
buffer_load_dwordx4 v6,s[4:7],s65 offen lds
s_add_u32 m0,s63,5120
s_add_u32 s65,s58,921600
buffer_load_dwordx4 v6,s[4:7],s65 offen lds
s_add_u32 m0,s63,6144
s_add_u32 s65,s58,942080
buffer_load_dwordx4 v6,s[4:7],s65 offen lds
s_add_u32 m0,s63,7168
s_add_u32 s65,s58,962560
buffer_load_dwordx4 v6,s[4:7],s65 offen lds
s_waitcnt vmcnt(8)
v_bfe_u32 v9,v0,2,2
v_lshrrev_b32 v10,5,v0
v_lshl_add_u32 v9,v10,2,v9
v_mul_u32_u24 v9,64,v9
v_and_b32 v10,1,v0
v_lshl_add_u32 v9,v10,3,v9
v_bfe_u32 v10,v0,1,1
v_lshl_add_u32 v9,v10,5,v9
v_bfe_u32 v10,v0,4,1
v_lshl_add_u32 v9,v10,4,v9
v_add_u32 v7,s63,v9
ds_read_b64_tr_b16 a[80:81],v7 offset:20480
ds_read_b64_tr_b16 a[82:83],v7 offset:21504
ds_read_b64_tr_b16 a[84:85],v7 offset:20992
ds_read_b64_tr_b16 a[86:87],v7 offset:22016
ds_read_b64_tr_b16 a[88:89],v7 offset:22528
ds_read_b64_tr_b16 a[90:91],v7 offset:23552
ds_read_b64_tr_b16 a[92:93],v7 offset:23040
ds_read_b64_tr_b16 a[94:95],v7 offset:24064
ds_read_b64_tr_b16 a[96:97],v7 offset:24576
ds_read_b64_tr_b16 a[98:99],v7 offset:25600
ds_read_b64_tr_b16 a[100:101],v7 offset:25088
ds_read_b64_tr_b16 a[102:103],v7 offset:26112
s_waitcnt lgkmcnt(4)
ds_read_b64_tr_b16 a[104:105],v7 offset:26624
ds_read_b64_tr_b16 a[106:107],v7 offset:27648
ds_read_b64_tr_b16 a[108:109],v7 offset:27136
ds_read_b64_tr_b16 a[110:111],v7 offset:28160
ds_read_b64_tr_b16 a[112:113],v7 offset:28672
ds_read_b64_tr_b16 a[114:115],v7 offset:29696
ds_read_b64_tr_b16 a[116:117],v7 offset:29184
ds_read_b64_tr_b16 a[118:119],v7 offset:30208
ds_read_b64_tr_b16 a[120:121],v7 offset:30720
ds_read_b64_tr_b16 a[122:123],v7 offset:31744
ds_read_b64_tr_b16 a[124:125],v7 offset:31232
ds_read_b64_tr_b16 a[126:127],v7 offset:32256
s_waitcnt lgkmcnt(4)
ds_read_b64_tr_b16 a[128:129],v7 offset:32768
ds_read_b64_tr_b16 a[130:131],v7 offset:33792
ds_read_b64_tr_b16 a[132:133],v7 offset:33280
ds_read_b64_tr_b16 a[134:135],v7 offset:34304
ds_read_b64_tr_b16 a[136:137],v7 offset:34816
ds_read_b64_tr_b16 a[138:139],v7 offset:35840
ds_read_b64_tr_b16 a[140:141],v7 offset:35328
ds_read_b64_tr_b16 a[142:143],v7 offset:36352
ds_read_b64_tr_b16 a[144:145],v7 offset:36864
ds_read_b64_tr_b16 a[146:147],v7 offset:37888
ds_read_b64_tr_b16 a[148:149],v7 offset:37376
ds_read_b64_tr_b16 a[150:151],v7 offset:38400
s_waitcnt lgkmcnt(4)
ds_read_b64_tr_b16 a[152:153],v7 offset:38912
ds_read_b64_tr_b16 a[154:155],v7 offset:39936
ds_read_b64_tr_b16 a[156:157],v7 offset:39424
ds_read_b64_tr_b16 a[158:159],v7 offset:40448
s_waitcnt lgkmcnt(0)
s_waitcnt vmcnt(0)
v_bfe_u32 v9,v0,2,2
v_lshrrev_b32 v10,5,v0
v_lshl_add_u32 v9,v10,2,v9
v_mul_u32_u24 v9,64,v9
v_and_b32 v10,1,v0
v_lshl_add_u32 v9,v10,3,v9
v_bfe_u32 v10,v0,1,1
v_lshl_add_u32 v9,v10,5,v9
v_bfe_u32 v10,v0,4,1
v_lshl_add_u32 v9,v10,4,v9
v_add_u32 v7,s63,v9
ds_read_b64_tr_b16 a[160:161],v7 offset:0
ds_read_b64_tr_b16 a[162:163],v7 offset:1024
ds_read_b64_tr_b16 a[164:165],v7 offset:512
ds_read_b64_tr_b16 a[166:167],v7 offset:1536
ds_read_b64_tr_b16 a[168:169],v7 offset:2048
ds_read_b64_tr_b16 a[170:171],v7 offset:3072
ds_read_b64_tr_b16 a[172:173],v7 offset:2560
ds_read_b64_tr_b16 a[174:175],v7 offset:3584
ds_read_b64_tr_b16 a[176:177],v7 offset:4096
ds_read_b64_tr_b16 a[178:179],v7 offset:5120
ds_read_b64_tr_b16 a[180:181],v7 offset:4608
ds_read_b64_tr_b16 a[182:183],v7 offset:5632
s_waitcnt lgkmcnt(4)
ds_read_b64_tr_b16 a[184:185],v7 offset:6144
ds_read_b64_tr_b16 a[186:187],v7 offset:7168
ds_read_b64_tr_b16 a[188:189],v7 offset:6656
ds_read_b64_tr_b16 a[190:191],v7 offset:7680
s_waitcnt lgkmcnt(0)
s_barrier
s_mov_b32 s50,0
s_mov_b32 s32,0
s_mov_b32 s57,0
s_mov_b32 s59,2147483648
s_mov_b32 s82,2147483648
s_mov_b32 s39,2147483648
v_mov_b32 v22,100352
v_lshl_add_u32 v22,v0,2,v22
v_mov_b32 v23,0
ds_write_b32 v22,v23
s_mov_b32 s39,1600000
v_and_b32 v72,15,v0
v_lshlrev_b32 v72,7,v72
s_mov_b64 s[76:77],-1
s_mov_b64 s[80:81],-1
s_waitcnt lgkmcnt(0)
s_barrier
s_mov_b32 s83,s100
s_min_u32 s62,s32,127
s_sub_u32 s60,s62,14
s_lshr_b32 s34,s60,1
s_and_b32 s33,s60,1
s_cmp_eq_u32 s33,0
s_cselect_b32 s61,14,0
s_add_u32 s34,s34,s61
s_sub_u32 s61,s60,50
s_cmp_ge_u32 s60,100
s_cselect_b32 s34,s61,s34
s_cselect_b32 s33,1,s33
s_cmp_lt_u32 s62,14
s_cselect_b32 s34,s62,s34
s_cselect_b32 s33,0,s33
s_lshl_b32 s35,s33,6
s_add_u32 s35,s35,s34
s_lshl_b32 s35,s35,9
s_add_u32 s35,s35,262144
s_sub_u32 s57,49152,s57
v_swap_b32 v16,v18
v_swap_b32 v17,v19
s_add_u32 s62,s32,1
s_min_u32 s62,s62,127
s_sub_u32 s60,s62,14
s_lshr_b32 s41,s60,1
s_and_b32 s40,s60,1
s_cmp_eq_u32 s40,0
s_cselect_b32 s61,14,0
s_add_u32 s41,s41,s61
s_sub_u32 s61,s60,50
s_cmp_ge_u32 s60,100
s_cselect_b32 s41,s61,s41
s_cselect_b32 s40,1,s40
s_cmp_lt_u32 s62,14
s_cselect_b32 s41,s62,s41
s_cselect_b32 s40,0,s40
s_lshl_b32 s42,s40,6
s_add_u32 s42,s42,s41
s_lshl_b32 s42,s42,9
s_add_u32 s42,s42,262144
WO_COLD:
s_mov_b32 s37,0
fb_248:
buffer_load_dword v3,v2,s[8:11],s35 offen sc1
s_waitcnt vmcnt(0)
v_cmp_eq_u32 vcc,0,v3
s_and_b64 vcc,vcc,s[76:77]
s_cbranch_scc0 ok_249
s_sleep 1
s_sub_u32 s47,s47,1
s_cbranch_scc1 ABORT
s_branch fb_248
ok_249:
WO_COLD2:
buffer_load_dword v3,v2,s[8:11],s42 offen sc1
s_sub_u32 s66,49152,s57
s_and_b32 s60,s34,3
s_lshl2_add_u32 s60,s33,s60
s_mul_i32 s60,s60,393216
s_add_u32 s60,s60,s37
s_mul_i32 s61,s68,49152
s_add_u32 s60,s60,s61
s_mul_i32 s61,s46,12288
s_add_u32 s60,s60,s61
s_add_u32 s60,s60,149946368
s_add_u32 s61,s61,s66
s_add_u32 m0,s61,0
s_add_u32 s63,s60,0
buffer_load_dwordx4 v1,s[8:11],s63 offen sc1 lds
buffer_load_dwordx4 v1,s[8:11],s63 offen offset:1024 sc1 lds
buffer_load_dwordx4 v1,s[8:11],s63 offen offset:2048 sc1 lds
buffer_load_dwordx4 v1,s[8:11],s63 offen offset:3072 sc1 lds
s_add_u32 m0,s61,4096
s_add_u32 s63,s60,4096
buffer_load_dwordx4 v1,s[8:11],s63 offen sc1 lds
buffer_load_dwordx4 v1,s[8:11],s63 offen offset:1024 sc1 lds
buffer_load_dwordx4 v1,s[8:11],s63 offen offset:2048 sc1 lds
buffer_load_dwordx4 v1,s[8:11],s63 offen offset:3072 sc1 lds
s_waitcnt vmcnt(7)
s_mov_b64 exec,1
buffer_store_dword v5,v1,s[8:11],s59 offen sc1
s_mov_b64 exec,-1
s_mov_b32 s59,2147483648
s_add_u32 m0,s61,8192
s_add_u32 s63,s60,8192
buffer_load_dwordx4 v1,s[8:11],s63 offen sc1 lds
buffer_load_dwordx4 v1,s[8:11],s63 offen offset:1024 sc1 lds
buffer_load_dwordx4 v1,s[8:11],s63 offen offset:2048 sc1 lds
buffer_load_dwordx4 v1,s[8:11],s63 offen offset:3072 sc1 lds
s_mov_b32 s35,s42
s_mov_b32 s53,s33
s_mov_b32 s54,s34
s_add_u32 s32,s32,1
s_mov_b32 s33,s40
s_mov_b32 s34,s41
s_mov_b64 s[76:77],s[80:81]
s_sub_u32 s57,49152,s57
v_swap_b32 v16,v18
v_swap_b32 v17,v19
s_mov_b32 s51,s53
s_mov_b32 s52,s54
s_waitcnt vmcnt(5)
v_cmp_eq_u32 vcc,0,v3
s_and_b64 vcc,vcc,s[76:77]
s_cselect_b32 s37,2147483648,0
s_cmp_lt_u32 s32,128
s_cselect_b32 s37,s37,2147483648
s_branch WO_GO
WO_NEXT:
s_sub_u32 s57,49152,s57
v_swap_b32 v16,v18
v_swap_b32 v17,v19
s_mov_b32 s51,s53
s_mov_b32 s52,s54
s_waitcnt vmcnt(2)
v_cmp_eq_u32 vcc,0,v3
s_and_b64 vcc,vcc,s[76:77]
s_cselect_b32 s37,2147483648,0
s_cmp_lt_u32 s32,128
s_cselect_b32 s37,s37,2147483648
WO_GO:
s_barrier
ds_read_b128 v[24:27],v16 offset:0
ds_read_b128 v[28:31],v17 offset:0
ds_read_b128 v[32:35],v16 offset:12288
ds_read_b128 v[36:39],v17 offset:12288
ds_read_b128 v[40:43],v16 offset:24576
ds_read_b128 v[44:47],v17 offset:24576
ds_read_b128 v[48:51],v16 offset:36864
s_waitcnt lgkmcnt(6)
v_mfma_f32_32x32x16_bf16 v[56:71],a[0:3],v[24:27],0
ds_read_b128 v[52:55],v17 offset:36864
s_sub_u32 s66,49152,s57
s_and_b32 s60,s34,3
s_lshl2_add_u32 s60,s33,s60
s_waitcnt lgkmcnt(6)
v_mfma_f32_32x32x16_bf16 v[56:71],a[4:7],v[28:31],v[56:71]
ds_read_b128 v[24:27],v16 offset:2048
s_mul_i32 s60,s60,393216
s_add_u32 s60,s60,s37
s_mul_i32 s61,s68,49152
s_waitcnt lgkmcnt(5)
v_mfma_f32_32x32x16_bf16 v[56:71],a[48:51],v[32:35],v[56:71]
ds_read_b128 v[28:31],v17 offset:2048
s_add_u32 s60,s60,s61
s_mul_i32 s61,s46,12288
s_add_u32 s60,s60,s61
s_add_u32 s60,s60,149946368
v_mfma_f32_32x32x16_bf16 v[56:71],a[52:55],v[36:39],v[56:71]
ds_read_b128 v[32:35],v16 offset:14336
s_add_u32 s61,s61,s66
s_add_u32 m0,s61,0
s_add_u32 s63,s60,0
s_waitcnt lgkmcnt(5)
v_mfma_f32_32x32x16_bf16 v[56:71],a[96:99],v[40:43],v[56:71]
ds_read_b128 v[36:39],v17 offset:14336
buffer_load_dwordx4 v1,s[8:11],s63 offen sc1 lds
s_mul_i32 s71,s52,491520
s_add_u32 s71,s71,s69
v_mfma_f32_32x32x16_bf16 v[56:71],a[100:103],v[44:47],v[56:71]
ds_read_b128 v[40:43],v16 offset:26624
s_lshl_b32 s70,s51,6
s_add_u32 s70,s70,s52
s_mul_i32 s70,s70,640
s_waitcnt lgkmcnt(5)
v_mfma_f32_32x32x16_bf16 v[56:71],a[144:147],v[48:51],v[56:71]
ds_read_b128 v[44:47],v17 offset:26624
buffer_load_dwordx4 v1,s[8:11],s63 offen offset:1024 sc1 lds
s_add_u32 s82,s70,s75
v_mfma_f32_32x32x16_bf16 v[56:71],a[148:151],v[52:55],v[56:71]
ds_read_b128 v[48:51],v16 offset:38912
s_waitcnt lgkmcnt(5)
v_mfma_f32_32x32x16_bf16 v[56:71],a[8:11],v[24:27],v[56:71]
ds_read_b128 v[52:55],v17 offset:38912
buffer_load_dwordx4 v1,s[8:11],s63 offen offset:2048 sc1 lds
v_mfma_f32_32x32x16_bf16 v[56:71],a[12:15],v[28:31],v[56:71]
ds_read_b128 v[24:27],v16 offset:4096
s_waitcnt lgkmcnt(5)
v_mfma_f32_32x32x16_bf16 v[56:71],a[56:59],v[32:35],v[56:71]
ds_read_b128 v[28:31],v17 offset:4096
buffer_load_dwordx4 v1,s[8:11],s63 offen offset:3072 sc1 lds
s_add_u32 m0,s61,4096
s_add_u32 s63,s60,4096
v_mfma_f32_32x32x16_bf16 v[56:71],a[60:63],v[36:39],v[56:71]
ds_read_b128 v[32:35],v16 offset:16384
s_waitcnt lgkmcnt(5)
v_mfma_f32_32x32x16_bf16 v[56:71],a[104:107],v[40:43],v[56:71]
ds_read_b128 v[36:39],v17 offset:16384
buffer_load_dwordx4 v1,s[8:11],s63 offen sc1 lds
v_mfma_f32_32x32x16_bf16 v[56:71],a[108:111],v[44:47],v[56:71]
ds_read_b128 v[40:43],v16 offset:28672
s_waitcnt lgkmcnt(5)
v_mfma_f32_32x32x16_bf16 v[56:71],a[152:155],v[48:51],v[56:71]
ds_read_b128 v[44:47],v17 offset:28672
buffer_load_dwordx4 v1,s[8:11],s63 offen offset:1024 sc1 lds
v_mfma_f32_32x32x16_bf16 v[56:71],a[156:159],v[52:55],v[56:71]
ds_read_b128 v[48:51],v16 offset:40960
s_waitcnt lgkmcnt(5)
v_mfma_f32_32x32x16_bf16 v[56:71],a[16:19],v[24:27],v[56:71]
ds_read_b128 v[52:55],v17 offset:40960
buffer_load_dwordx4 v1,s[8:11],s63 offen offset:2048 sc1 lds
v_mfma_f32_32x32x16_bf16 v[56:71],a[20:23],v[28:31],v[56:71]
ds_read_b128 v[24:27],v16 offset:6144
s_waitcnt lgkmcnt(5)
v_mfma_f32_32x32x16_bf16 v[56:71],a[64:67],v[32:35],v[56:71]
ds_read_b128 v[28:31],v17 offset:6144
buffer_load_dwordx4 v1,s[8:11],s63 offen offset:3072 sc1 lds
s_add_u32 m0,s61,8192
s_add_u32 s63,s60,8192
v_mfma_f32_32x32x16_bf16 v[56:71],a[68:71],v[36:39],v[56:71]
ds_read_b128 v[32:35],v16 offset:18432
s_waitcnt lgkmcnt(5)
v_mfma_f32_32x32x16_bf16 v[56:71],a[112:115],v[40:43],v[56:71]
ds_read_b128 v[36:39],v17 offset:18432
buffer_load_dwordx4 v1,s[8:11],s63 offen sc1 lds
v_mfma_f32_32x32x16_bf16 v[56:71],a[116:119],v[44:47],v[56:71]
ds_read_b128 v[40:43],v16 offset:30720
s_waitcnt lgkmcnt(5)
v_mfma_f32_32x32x16_bf16 v[56:71],a[160:163],v[48:51],v[56:71]
ds_read_b128 v[44:47],v17 offset:30720
buffer_load_dwordx4 v1,s[8:11],s63 offen offset:1024 sc1 lds
v_mfma_f32_32x32x16_bf16 v[56:71],a[164:167],v[52:55],v[56:71]
ds_read_b128 v[48:51],v16 offset:43008
s_waitcnt lgkmcnt(5)
v_mfma_f32_32x32x16_bf16 v[56:71],a[24:27],v[24:27],v[56:71]
ds_read_b128 v[52:55],v17 offset:43008
s_waitcnt vmcnt(10)
s_mov_b64 exec,1
buffer_store_dword v5,v1,s[8:11],s59 offen sc1
s_mov_b64 exec,-1
s_mov_b32 s59,2147483648
s_barrier
v_mfma_f32_32x32x16_bf16 v[56:71],a[28:31],v[28:31],v[56:71]
ds_read_b128 v[24:27],v16 offset:8192
buffer_load_dwordx4 v1,s[8:11],s63 offen offset:2048 sc1 lds
s_waitcnt lgkmcnt(5)
v_mfma_f32_32x32x16_bf16 v[56:71],a[72:75],v[32:35],v[56:71]
ds_read_b128 v[28:31],v17 offset:8192
v_mfma_f32_32x32x16_bf16 v[56:71],a[76:79],v[36:39],v[56:71]
ds_read_b128 v[32:35],v16 offset:20480
s_lshl_b32 s64,s51,10
s_add_u32 s64,s64,s74
s_add_u32 s65,s52,1
v_mov_b32 v73,s65
s_mov_b64 exec,1
s_cmp_lg_u32 s49,0
s_cbranch_scc0 ls_250
buffer_store_dword v73,v1,s[8:11],s64 offen sc1
s_branch ls_251
ls_250:
buffer_store_dword v73,v1,s[8:11],s64 offen
ls_251:
s_mov_b64 exec,-1
s_waitcnt lgkmcnt(5)
v_mfma_f32_32x32x16_bf16 v[56:71],a[120:123],v[40:43],v[56:71]
ds_read_b128 v[36:39],v17 offset:20480
buffer_load_dwordx4 v1,s[8:11],s63 offen offset:3072 sc1 lds
s_add_u32 s62,s32,1
s_min_u32 s62,s62,127
v_mfma_f32_32x32x16_bf16 v[56:71],a[124:127],v[44:47],v[56:71]
ds_read_b128 v[40:43],v16 offset:32768
s_sub_u32 s60,s62,14
s_lshr_b32 s41,s60,1
s_and_b32 s40,s60,1
s_waitcnt lgkmcnt(5)
v_mfma_f32_32x32x16_bf16 v[56:71],a[168:171],v[48:51],v[56:71]
ds_read_b128 v[44:47],v17 offset:32768
s_cmp_eq_u32 s40,0
s_cselect_b32 s61,14,0
s_add_u32 s41,s41,s61
s_sub_u32 s61,s60,50
v_mfma_f32_32x32x16_bf16 v[56:71],a[172:175],v[52:55],v[56:71]
ds_read_b128 v[48:51],v16 offset:45056
s_cmp_ge_u32 s60,100
s_cselect_b32 s41,s61,s41
s_cselect_b32 s40,1,s40
s_waitcnt lgkmcnt(5)
v_mfma_f32_32x32x16_bf16 v[56:71],a[32:35],v[24:27],v[56:71]
ds_read_b128 v[52:55],v17 offset:45056
s_cmp_lt_u32 s62,14
s_cselect_b32 s41,s62,s41
s_cselect_b32 s40,0,s40
s_lshl_b32 s42,s40,6
v_mfma_f32_32x32x16_bf16 v[56:71],a[36:39],v[28:31],v[56:71]
ds_read_b128 v[24:27],v16 offset:10240
s_add_u32 s42,s42,s41
s_lshl_b32 s42,s42,9
s_add_u32 s42,s42,262144
s_waitcnt lgkmcnt(5)
v_mfma_f32_32x32x16_bf16 v[56:71],a[80:83],v[32:35],v[56:71]
ds_read_b128 v[28:31],v17 offset:10240
v_mfma_f32_32x32x16_bf16 v[56:71],a[84:87],v[36:39],v[56:71]
ds_read_b128 v[32:35],v16 offset:22528
s_waitcnt lgkmcnt(5)
v_mfma_f32_32x32x16_bf16 v[56:71],a[128:131],v[40:43],v[56:71]
ds_read_b128 v[36:39],v17 offset:22528
buffer_load_dword v3,v2,s[8:11],s35 offen sc1
v_mfma_f32_32x32x16_bf16 v[56:71],a[132:135],v[44:47],v[56:71]
ds_read_b128 v[40:43],v16 offset:34816
s_waitcnt lgkmcnt(5)
v_mfma_f32_32x32x16_bf16 v[56:71],a[176:179],v[48:51],v[56:71]
ds_read_b128 v[44:47],v17 offset:34816
v_mfma_f32_32x32x16_bf16 v[56:71],a[180:183],v[52:55],v[56:71]
ds_read_b128 v[48:51],v16 offset:47104
s_waitcnt lgkmcnt(5)
v_mfma_f32_32x32x16_bf16 v[56:71],a[40:43],v[24:27],v[56:71]
ds_read_b128 v[52:55],v17 offset:47104
v_mfma_f32_32x32x16_bf16 v[56:71],a[44:47],v[28:31],v[56:71]
s_waitcnt lgkmcnt(4)
v_mfma_f32_32x32x16_bf16 v[56:71],a[88:91],v[32:35],v[56:71]
v_mfma_f32_32x32x16_bf16 v[56:71],a[92:95],v[36:39],v[56:71]
s_waitcnt lgkmcnt(2)
v_mfma_f32_32x32x16_bf16 v[56:71],a[136:139],v[40:43],v[56:71]
v_mfma_f32_32x32x16_bf16 v[56:71],a[140:143],v[44:47],v[56:71]
s_waitcnt lgkmcnt(0)
v_mfma_f32_32x32x16_bf16 v[56:71],a[184:187],v[48:51],v[56:71]
v_mfma_f32_32x32x16_bf16 v[56:71],a[188:191],v[52:55],v[56:71]
s_cmp_eq_u32 s37,0
s_cbranch_scc0 sec_254
s_mov_b32 s35,s42
buffer_load_dword v3,v2,s[8:11],s35 offen sc1
s_mov_b32 s53,s33
s_mov_b32 s54,s34
s_add_u32 s32,s32,1
s_mov_b32 s33,s40
s_mov_b32 s34,s41
s_mov_b64 s[76:77],s[80:81]
s_nop 2
ep_252:
v_cvt_pk_bf16_f32 v112,v56,v57
v_cvt_pk_bf16_f32 v113,v58,v59
v_cvt_pk_bf16_f32 v114,v60,v61
v_cvt_pk_bf16_f32 v115,v62,v63
v_cvt_pk_bf16_f32 v116,v64,v65
v_cvt_pk_bf16_f32 v117,v66,v67
v_cvt_pk_bf16_f32 v118,v68,v69
v_cvt_pk_bf16_f32 v119,v70,v71
buffer_store_dwordx4 v[112:115],v20,s[8:11],s71 offen sc1
buffer_store_dwordx4 v[116:119],v20,s[8:11],s71 offen offset:128 sc1
s_mov_b32 s59,s82
s_cmp_eq_u32 s37,0
s_cbranch_scc1 WO_NEXT
s_waitcnt vmcnt(2)
v_cmp_eq_u32 vcc,0,v3
s_and_b64 vcc,vcc,s[76:77]
s_cselect_b32 s37,2147483648,0
s_cmp_lt_u32 s32,128
s_cselect_b32 s37,s37,2147483648
s_cmp_eq_u32 s37,0
s_cbranch_scc1 WO_COLD2
s_waitcnt vmcnt(0)
s_mov_b64 exec,1
buffer_store_dword v5,v1,s[8:11],s59 offen sc1
s_mov_b64 exec,-1
s_mov_b32 s59,2147483648
s_cmp_lt_u32 s32,128
s_cbranch_scc1 WO_COLD
s_branch WO_END
sec_254:
s_waitcnt vmcnt(0)
v_cmp_eq_u32 vcc,0,v3
s_and_b64 vcc,vcc,s[76:77]
s_cselect_b32 s37,2147483648,0
s_cmp_lt_u32 s32,128
s_cselect_b32 s37,s37,2147483648
s_cmp_lg_u32 s37,0
s_cbranch_scc1 nr_253
s_sub_u32 s66,49152,s57
s_and_b32 s60,s34,3
s_lshl2_add_u32 s60,s33,s60
s_mul_i32 s60,s60,393216
s_add_u32 s60,s60,s37
s_mul_i32 s61,s68,49152
s_add_u32 s60,s60,s61
s_mul_i32 s61,s46,12288
s_add_u32 s60,s60,s61
s_add_u32 s60,s60,149946368
s_add_u32 s61,s61,s66
s_add_u32 m0,s61,0
s_add_u32 s63,s60,0
buffer_load_dwordx4 v1,s[8:11],s63 offen sc1 lds
v_cvt_pk_bf16_f32 v112,v56,v57
buffer_load_dwordx4 v1,s[8:11],s63 offen offset:1024 sc1 lds
v_cvt_pk_bf16_f32 v113,v58,v59
buffer_load_dwordx4 v1,s[8:11],s63 offen offset:2048 sc1 lds
v_cvt_pk_bf16_f32 v114,v60,v61
buffer_load_dwordx4 v1,s[8:11],s63 offen offset:3072 sc1 lds
v_cvt_pk_bf16_f32 v115,v62,v63
s_add_u32 m0,s61,4096
s_add_u32 s63,s60,4096
buffer_load_dwordx4 v1,s[8:11],s63 offen sc1 lds
v_cvt_pk_bf16_f32 v116,v64,v65
buffer_load_dwordx4 v1,s[8:11],s63 offen offset:1024 sc1 lds
v_cvt_pk_bf16_f32 v117,v66,v67
buffer_load_dwordx4 v1,s[8:11],s63 offen offset:2048 sc1 lds
v_cvt_pk_bf16_f32 v118,v68,v69
buffer_load_dwordx4 v1,s[8:11],s63 offen offset:3072 sc1 lds
v_cvt_pk_bf16_f32 v119,v70,v71
s_add_u32 m0,s61,8192
s_add_u32 s63,s60,8192
buffer_load_dwordx4 v1,s[8:11],s63 offen sc1 lds
buffer_load_dwordx4 v1,s[8:11],s63 offen offset:1024 sc1 lds
buffer_load_dwordx4 v1,s[8:11],s63 offen offset:2048 sc1 lds
buffer_load_dwordx4 v1,s[8:11],s63 offen offset:3072 sc1 lds
s_mov_b32 s35,s42
buffer_load_dword v3,v2,s[8:11],s35 offen sc1
s_mov_b32 s53,s33
s_mov_b32 s54,s34
s_add_u32 s32,s32,1
s_mov_b32 s33,s40
s_mov_b32 s34,s41
s_mov_b64 s[76:77],s[80:81]
buffer_store_dwordx4 v[112:115],v20,s[8:11],s71 offen sc1
buffer_store_dwordx4 v[116:119],v20,s[8:11],s71 offen offset:128 sc1
s_mov_b32 s59,s82
s_branch WO_NEXT
nr_253:
buffer_load_dword v3,v2,s[8:11],s35 offen sc1
s_branch ep_252
WO_END:
s_endpgm
ROLE_R1:
s_lshr_b32 s68,s48,3
s_and_b32 s48,s48,7
v_lshlrev_b32 v1,4,v0
v_mov_b32 v5,1
s_lshl_b32 s56,s48,2
s_add_u32 s56,s56,s46
v_bfe_u32 v6,v0,2,2
v_lshrrev_b32 v7,4,v0
v_add_u32 v7,v6,v7
v_and_b32 v7,3,v7
v_and_b32 v15,3,v0
v_lshlrev_b32 v15,4,v15
v_lshl_add_u32 v15,v7,6,v15
v_lshl_add_u32 v15,v6,8,v15
v_lshrrev_b32 v6,4,v0
v_bfe_u32 v7,v0,2,2
v_and_b32 v8,3,v0
v_add_u32 v9,s48,v7
v_and_b32 v9,3,v9
v_lshlrev_b32 v17,6,v9
v_lshl_add_u32 v17,v8,4,v17
s_lshl_b32 s60,s48,8
s_lshl_b32 s61,s46,13
s_add_u32 s61,s61,s60
v_lshl_add_u32 v16,v6,11,v17
v_add_u32 v16,s61,v16
s_lshl_b32 s61,s46,11
s_add_u32 s61,s61,s60
s_add_u32 s61,s61,32768
v_add_u32 v17,s61,v17
v_lshl_add_u32 v18,v6,2,v17
v_mul_u32_u24 v19,40960,v6
v_and_b32 v9,0xff,v1
v_add_u32 v19,v19,v9
s_mul_i32 s60,s46,768
s_sub_u32 s60,4096,s60
v_add_u32 v19,s60,v19
s_mul_i32 s69,s48,5120
s_lshl_b32 s60,s46,10
s_add_u32 s69,s69,s60
s_add_u32 s69,s69,175112192
s_cmp_eq_u32 s68,0
s_mov_b32 s70,209518592
s_cselect_b32 s70,234749952,s70
s_mov_b32 s71,46080
s_cselect_b32 s71,40960,s71
s_mov_b32 s72,0x3f80
s_mov_b32 s73,0x3f800000
v_lshlrev_b32 v21,5,v8
s_lshl_b32 s60,s46,3
v_add_u32 v20,s60,v21
v_min_u32 v2,39,v0
v_lshlrev_b32 v2,4,v2
s_waitcnt vmcnt(0)
s_barrier
s_cmp_lg_u32 s46,0
s_cbranch_scc1 arr_255
v_mov_b32 v6,1
s_lshl_b32 s3,s49,2
v_mov_b32 v7,s3
s_mov_b64 exec,1
buffer_atomic_add v6,v7,s[12:15],0 offen sc1
s_mov_b64 exec,-1
arr_255:
s_cmp_lg_u32 s49,0
s_cbranch_scc1 vr_256
s_lshl_b32 s60,s68,5
s_add_u32 s60,s60,s56
s_cmp_ge_u32 s60,32
s_cbranch_scc1 vr_256
s_mov_b64 exec,1
s_and_b32 s61,s60,7
s_lshl_b32 s61,s61,14
s_lshl_b32 s60,s60,7
s_add_u32 s60,s60,s61
s_add_u32 s60,s60,11796480
s_add_u32 s61,s60,0x2000
s_mov_b32 s62,-1
s_mov_b32 s63,-1
s_mov_b32 s50,6
vr_256l:
buffer_store_dword v5,v1,s[8:11],s60 offen sc1
buffer_store_dword v5,v1,s[8:11],s61 offen sc1
s_waitcnt vmcnt(0)
s_memtime s[64:65]
s_waitcnt lgkmcnt(0)
buffer_load_dword v3,v1,s[8:11],s60 offen sc1
s_waitcnt vmcnt(0)
s_memtime s[66:67]
s_waitcnt lgkmcnt(0)
s_sub_u32 s66,s66,s64
s_min_u32 s62,s62,s66
s_memtime s[64:65]
s_waitcnt lgkmcnt(0)
buffer_load_dword v3,v1,s[8:11],s61 offen sc1
s_waitcnt vmcnt(0)
s_memtime s[66:67]
s_waitcnt lgkmcnt(0)
s_sub_u32 s66,s66,s64
s_min_u32 s63,s63,s66
s_sub_u32 s50,s50,1
s_cmp_lg_u32 s50,0
s_cbranch_scc1 vr_256l
s_cmp_lt_u32 s63,s62
s_cselect_b32 s60,0x10001,1
v_mov_b32 v3,s60
v_mov_b32 v6,192
buffer_atomic_add v3,v6,s[12:15],0 offen sc1
s_mov_b64 exec,-1
vr_256:
s_lshl_b32 s3,s49,2
v_mov_b32 v7,s3
s_nop 1
ibw_257:
buffer_load_dword v6,v7,s[12:15],0 offen sc1
s_waitcnt vmcnt(0)
v_cmp_ne_u32 vcc,256,v6
s_nop 0
s_cbranch_vccz ok_258
s_sleep 8
s_sub_u32 s47,s47,1
s_cbranch_scc1 ABORT
s_branch ibw_257
ok_258:
s_cmp_lg_u32 s49,0
s_cbranch_scc1 ibok_259
v_and_b32 v7,7,v0
v_lshlrev_b32 v7,2,v7
buffer_load_dword v6,v7,s[12:15],0 offen offset:32 sc1
s_waitcnt vmcnt(0)
v_cmp_ne_u32 vcc,32,v6
s_nop 0
s_cbranch_vccz ibok_259
s_barrier
s_mov_b32 s49,1
s_mov_b32 s3,s2
s_load_dwordx16 s[16:31],s[0:1],0
s_load_dwordx8 s[32:39],s[0:1],64
s_waitcnt lgkmcnt(0)
s_branch DISPATCH
ibok_259:
s_mov_b32 s83,s100
s_mov_b32 s51,s68
s_mov_b32 s52,0
s_mul_i32 s35,s68,40960
s_add_u32 s35,s35,819200
R1_LOOP:
s_mul_i32 s66,s52,491520
s_add_u32 s66,s66,s69
s_mul_i32 s65,s52,s71
s_add_u32 s65,s65,s70
s_lshl_b32 s60,s51,6
s_add_u32 s60,s60,s52
s_mul_i32 s74,s60,40960
s_add_u32 s74,s74,218365952
s_mul_i32 s75,s60,46080
s_add_u32 s75,s75,223608832
s_lshl_b32 s82,s51,6
s_add_u32 s82,s82,s52
s_lshl_b32 s82,s82,9
s_add_u32 s82,s82,393216
s_lshl_b32 s61,s56,2
s_add_u32 s82,s82,s61
s_cmp_lg_u32 s46,0
s_cbranch_scc1 rp_260
rt_261:
buffer_load_dwordx4 v[24:27],v2,s[8:11],s35 offen sc1
s_waitcnt vmcnt(0)
v_min3_u32 v24,v24,v25,v26
v_min_u32 v24,v24,v27
v_cmp_eq_u32 vcc,0,v24
s_nop 0
s_cbranch_vccz ok_262
s_sleep 3
s_sub_u32 s47,s47,1
s_cbranch_scc1 ABORT
s_branch rt_261
ok_262:
rp_260:
s_barrier
s_add_u32 s63,s66,0
buffer_load_dwordx4 v[68:71],v19,s[8:11],s63 offen sc1
s_add_u32 s63,s66,163840
buffer_load_dwordx4 v[72:75],v19,s[8:11],s63 offen sc1
buffer_load_dwordx4 v[76:79],v16,s[8:11],s65 offen sc1
buffer_load_dword v80,v18,s[8:11],s65 offen sc1
s_add_u32 s63,s66,0
buffer_load_dwordx4 v[36:39],v1,s[8:11],s63 offen sc1
s_add_u32 s63,s66,40960
buffer_load_dwordx4 v[40:43],v1,s[8:11],s63 offen sc1
s_add_u32 s63,s66,81920
buffer_load_dwordx4 v[44:47],v1,s[8:11],s63 offen sc1
s_add_u32 s63,s66,122880
buffer_load_dwordx4 v[48:51],v1,s[8:11],s63 offen sc1
s_add_u32 s63,s66,163840
buffer_load_dwordx4 v[52:55],v1,s[8:11],s63 offen sc1
s_add_u32 s63,s66,204800
buffer_load_dwordx4 v[56:59],v1,s[8:11],s63 offen sc1
s_add_u32 s63,s66,245760
buffer_load_dwordx4 v[60:63],v1,s[8:11],s63 offen sc1
s_add_u32 s63,s66,286720
buffer_load_dwordx4 v[64:67],v1,s[8:11],s63 offen sc1
s_waitcnt vmcnt(11)
v_lshlrev_b32 v92,16,v68
v_and_b32 v93,0xffff0000,v68
v_lshlrev_b32 v94,16,v69
v_and_b32 v95,0xffff0000,v69
v_lshlrev_b32 v96,16,v70
v_and_b32 v97,0xffff0000,v70
v_lshlrev_b32 v98,16,v71
v_and_b32 v99,0xffff0000,v71
s_waitcnt vmcnt(10)
v_dot2c_f32_bf16 v92,s72,v72
v_dot2c_f32_bf16 v93,s73,v72
v_dot2c_f32_bf16 v94,s72,v73
v_dot2c_f32_bf16 v95,s73,v73
v_dot2c_f32_bf16 v96,s72,v74
v_dot2c_f32_bf16 v97,s73,v74
v_dot2c_f32_bf16 v98,s72,v75
v_dot2c_f32_bf16 v99,s73,v75
v_permlane32_swap_b32 v92,v96
v_permlane32_swap_b32 v93,v97
v_permlane32_swap_b32 v94,v98
v_permlane32_swap_b32 v95,v99
v_add_f32 v92,v92,v96
v_add_f32 v93,v93,v97
v_add_f32 v94,v94,v98
v_add_f32 v95,v95,v99
s_nop 0
v_permlane16_swap_b32 v92,v94
v_permlane16_swap_b32 v93,v95
v_add_f32 v90,v92,v94
v_add_f32 v91,v93,v95
s_waitcnt vmcnt(8)
v_lshlrev_b32 v100,16,v76
v_and_b32 v101,0xffff0000,v76
v_lshlrev_b32 v102,16,v77
v_and_b32 v103,0xffff0000,v77
v_lshlrev_b32 v104,16,v78
v_and_b32 v105,0xffff0000,v78
v_lshlrev_b32 v106,16,v79
v_and_b32 v107,0xffff0000,v79
v_lshlrev_b32 v108,16,v80
v_and_b32 v109,0xffff0000,v80
s_waitcnt vmcnt(7)
v_lshlrev_b32 v82,16,v36
v_and_b32 v83,0xffff0000,v36
v_lshlrev_b32 v84,16,v37
v_and_b32 v85,0xffff0000,v37
v_lshlrev_b32 v86,16,v38
v_and_b32 v87,0xffff0000,v38
v_lshlrev_b32 v88,16,v39
v_and_b32 v89,0xffff0000,v39
s_waitcnt vmcnt(6)
v_dot2c_f32_bf16 v82,s72,v40
v_dot2c_f32_bf16 v83,s73,v40
v_dot2c_f32_bf16 v84,s72,v41
v_dot2c_f32_bf16 v85,s73,v41
v_dot2c_f32_bf16 v86,s72,v42
v_dot2c_f32_bf16 v87,s73,v42
v_dot2c_f32_bf16 v88,s72,v43
v_dot2c_f32_bf16 v89,s73,v43
s_waitcnt vmcnt(5)
v_dot2c_f32_bf16 v82,s72,v44
v_dot2c_f32_bf16 v83,s73,v44
v_dot2c_f32_bf16 v84,s72,v45
v_dot2c_f32_bf16 v85,s73,v45
v_dot2c_f32_bf16 v86,s72,v46
v_dot2c_f32_bf16 v87,s73,v46
v_dot2c_f32_bf16 v88,s72,v47
v_dot2c_f32_bf16 v89,s73,v47
s_waitcnt vmcnt(4)
v_dot2c_f32_bf16 v82,s72,v48
v_dot2c_f32_bf16 v83,s73,v48
v_dot2c_f32_bf16 v84,s72,v49
v_dot2c_f32_bf16 v85,s73,v49
v_dot2c_f32_bf16 v86,s72,v50
v_dot2c_f32_bf16 v87,s73,v50
v_dot2c_f32_bf16 v88,s72,v51
v_dot2c_f32_bf16 v89,s73,v51
s_waitcnt vmcnt(3)
v_dot2c_f32_bf16 v82,s72,v52
v_dot2c_f32_bf16 v83,s73,v52
v_dot2c_f32_bf16 v84,s72,v53
v_dot2c_f32_bf16 v85,s73,v53
v_dot2c_f32_bf16 v86,s72,v54
v_dot2c_f32_bf16 v87,s73,v54
v_dot2c_f32_bf16 v88,s72,v55
v_dot2c_f32_bf16 v89,s73,v55
s_waitcnt vmcnt(2)
v_dot2c_f32_bf16 v82,s72,v56
v_dot2c_f32_bf16 v83,s73,v56
v_dot2c_f32_bf16 v84,s72,v57
v_dot2c_f32_bf16 v85,s73,v57
v_dot2c_f32_bf16 v86,s72,v58
v_dot2c_f32_bf16 v87,s73,v58
v_dot2c_f32_bf16 v88,s72,v59
v_dot2c_f32_bf16 v89,s73,v59
s_waitcnt vmcnt(1)
v_dot2c_f32_bf16 v82,s72,v60
v_dot2c_f32_bf16 v83,s73,v60
v_dot2c_f32_bf16 v84,s72,v61
v_dot2c_f32_bf16 v85,s73,v61
v_dot2c_f32_bf16 v86,s72,v62
v_dot2c_f32_bf16 v87,s73,v62
v_dot2c_f32_bf16 v88,s72,v63
v_dot2c_f32_bf16 v89,s73,v63
s_waitcnt vmcnt(0)
v_dot2c_f32_bf16 v82,s72,v64
v_dot2c_f32_bf16 v83,s73,v64
v_dot2c_f32_bf16 v84,s72,v65
v_dot2c_f32_bf16 v85,s73,v65
v_dot2c_f32_bf16 v86,s72,v66
v_dot2c_f32_bf16 v87,s73,v66
v_dot2c_f32_bf16 v88,s72,v67
v_dot2c_f32_bf16 v89,s73,v67
v_cvt_pk_bf16_f32 v6,v82,v83
v_lshlrev_b32 v82,16,v6
v_and_b32 v83,0xffff0000,v6
v_cvt_pk_bf16_f32 v8,v84,v85
v_lshlrev_b32 v84,16,v8
v_and_b32 v85,0xffff0000,v8
v_cvt_pk_bf16_f32 v6,v86,v87
v_lshlrev_b32 v86,16,v6
v_and_b32 v87,0xffff0000,v6
v_cvt_pk_bf16_f32 v8,v88,v89
v_lshlrev_b32 v88,16,v8
v_and_b32 v89,0xffff0000,v8
v_cvt_pk_bf16_f32 v6,v90,v91
v_lshlrev_b32 v90,16,v6
v_and_b32 v91,0xffff0000,v6
v_pk_add_f32 v[82:83],v[82:83],v[100:101]
v_pk_add_f32 v[84:85],v[84:85],v[102:103]
v_pk_add_f32 v[86:87],v[86:87],v[104:105]
v_pk_add_f32 v[88:89],v[88:89],v[106:107]
v_pk_add_f32 v[90:91],v[90:91],v[108:109]
v_cvt_pk_bf16_f32 v112,v82,v83
v_lshlrev_b32 v82,16,v112
v_and_b32 v83,0xffff0000,v112
v_cvt_pk_bf16_f32 v113,v84,v85
v_lshlrev_b32 v84,16,v113
v_and_b32 v85,0xffff0000,v113
v_cvt_pk_bf16_f32 v114,v86,v87
v_lshlrev_b32 v86,16,v114
v_and_b32 v87,0xffff0000,v114
v_cvt_pk_bf16_f32 v115,v88,v89
v_lshlrev_b32 v88,16,v115
v_and_b32 v89,0xffff0000,v115
v_cvt_pk_bf16_f32 v116,v90,v91
v_lshlrev_b32 v90,16,v116
v_and_b32 v91,0xffff0000,v116
v_pk_add_f32 v[32:33],v[82:83],v[84:85]
v_pk_mul_f32 v[30:31],v[82:83],v[82:83]
v_pk_fma_f32 v[30:31],v[84:85],v[84:85],v[30:31]
v_pk_add_f32 v[32:33],v[32:33],v[86:87]
v_pk_fma_f32 v[30:31],v[86:87],v[86:87],v[30:31]
v_pk_add_f32 v[32:33],v[32:33],v[88:89]
v_pk_fma_f32 v[30:31],v[88:89],v[88:89],v[30:31]
v_pk_add_f32 v[32:33],v[32:33],v[90:91]
v_pk_fma_f32 v[30:31],v[90:91],v[90:91],v[30:31]
v_add_f32 v28,v32,v33
v_add_f32 v29,v30,v31
s_nop 0
v_add_f32_dpp v28,v28,v28 row_ror:4 row_mask:0xf bank_mask:0xf
v_add_f32_dpp v29,v29,v29 row_ror:4 row_mask:0xf bank_mask:0xf
s_nop 0
v_add_f32_dpp v28,v28,v28 row_ror:8 row_mask:0xf bank_mask:0xf
v_add_f32_dpp v29,v29,v29 row_ror:8 row_mask:0xf bank_mask:0xf
v_mov_b32 v30,v28
v_mov_b32 v31,v29
s_nop 0
v_permlane32_swap_b32 v28,v30
v_permlane32_swap_b32 v29,v31
v_add_f32 v28,v28,v30
v_add_f32 v29,v29,v31
v_mov_b32 v30,v28
v_mov_b32 v31,v29
s_nop 0
v_permlane16_swap_b32 v28,v30
v_permlane16_swap_b32 v29,v31
v_add_f32 v28,v28,v30
v_add_f32 v29,v29,v31
ds_write_b64 v20,v[28:29]
s_waitcnt lgkmcnt(0)
s_barrier
ds_read_b128 v[136:139],v21
ds_read_b128 v[140:143],v21 offset:16
buffer_store_dwordx4 v[112:115],v16,s[8:11],s74 offen sc1
v_mov_b32 v117,v116
s_nop 1
v_permlane16_swap_b32 v116,v117
s_nop 1
v_permlane32_swap_b32 v116,v118
v_permlane32_swap_b32 v117,v119
s_mov_b64 exec,0xffff
buffer_store_dwordx4 v[116:119],v17,s[8:11],s74 offen sc1
s_mov_b64 exec,-1
s_waitcnt lgkmcnt(0)
v_pk_add_f32 v[136:137],v[136:137],v[138:139]
v_pk_add_f32 v[140:141],v[140:141],v[142:143]
v_pk_add_f32 v[28:29],v[136:137],v[140:141]
v_mul_f32 v28,0x3acccccd,v28
v_mul_f32 v29,0x3acccccd,v29
v_fma_f32 v29,-v28,v28,v29
v_max_f32 v29,0,v29
v_mov_b32 v32,v28
v_mov_b32 v33,v29
v_cvt_pk_bf16_f32 v6,v28,v29
v_lshlrev_b32 v28,16,v6
v_and_b32 v29,0xffff0000,v6
v_add_f32 v29,0x3727c5ac,v29
v_cvt_pk_bf16_f32 v6,v29,v29
v_lshlrev_b32 v29,16,v6
v_sqrt_f32 v29,v29
s_nop 0
v_cvt_pk_bf16_f32 v6,v29,v29
v_lshlrev_b32 v29,16,v6
v_rcp_f32 v29,v29
s_nop 0
v_pk_add_f32 v[82:83],v[82:83],v[28:29] op_sel_hi:[1,0] neg_lo:[0,1] neg_hi:[0,1]
v_pk_add_f32 v[84:85],v[84:85],v[28:29] op_sel_hi:[1,0] neg_lo:[0,1] neg_hi:[0,1]
v_pk_add_f32 v[86:87],v[86:87],v[28:29] op_sel_hi:[1,0] neg_lo:[0,1] neg_hi:[0,1]
v_pk_add_f32 v[88:89],v[88:89],v[28:29] op_sel_hi:[1,0] neg_lo:[0,1] neg_hi:[0,1]
v_pk_add_f32 v[90:91],v[90:91],v[28:29] op_sel_hi:[1,0] neg_lo:[0,1] neg_hi:[0,1]
v_cvt_pk_bf16_f32 v6,v82,v83
v_lshlrev_b32 v82,16,v6
v_and_b32 v83,0xffff0000,v6
v_cvt_pk_bf16_f32 v8,v84,v85
v_lshlrev_b32 v84,16,v8
v_and_b32 v85,0xffff0000,v8
v_cvt_pk_bf16_f32 v6,v86,v87
v_lshlrev_b32 v86,16,v6
v_and_b32 v87,0xffff0000,v6
v_cvt_pk_bf16_f32 v8,v88,v89
v_lshlrev_b32 v88,16,v8
v_and_b32 v89,0xffff0000,v8
v_cvt_pk_bf16_f32 v6,v90,v91
v_lshlrev_b32 v90,16,v6
v_and_b32 v91,0xffff0000,v6
v_pk_mul_f32 v[82:83],v[82:83],v[28:29] op_sel:[0,1] op_sel_hi:[1,1]
v_pk_mul_f32 v[84:85],v[84:85],v[28:29] op_sel:[0,1] op_sel_hi:[1,1]
v_pk_mul_f32 v[86:87],v[86:87],v[28:29] op_sel:[0,1] op_sel_hi:[1,1]
v_pk_mul_f32 v[88:89],v[88:89],v[28:29] op_sel:[0,1] op_sel_hi:[1,1]
v_pk_mul_f32 v[90:91],v[90:91],v[28:29] op_sel:[0,1] op_sel_hi:[1,1]
v_cvt_pk_bf16_f32 v124,v82,v83
v_cvt_pk_bf16_f32 v125,v84,v85
v_cvt_pk_bf16_f32 v126,v86,v87
v_cvt_pk_bf16_f32 v127,v88,v89
v_cvt_pk_bf16_f32 v128,v90,v91
buffer_store_dwordx4 v[124:127],v16,s[8:11],s75 offen sc1
v_mov_b32 v129,v128
s_nop 1
v_permlane16_swap_b32 v128,v129
s_nop 1
v_permlane32_swap_b32 v128,v130
v_permlane32_swap_b32 v129,v131
s_mov_b64 exec,0xffff
buffer_store_dwordx4 v[128:131],v17,s[8:11],s75 offen sc1
s_mov_b64 exec,-1
s_cmp_lg_u32 s46,3
s_cbranch_scc1 zs_263
v_sub_f32 v32,v32,v28
v_mul_f32 v33,v33,v29
v_mul_f32 v32,v32,v29
v_mul_f32 v33,v33,v29
v_cvt_pk_bf16_f32 v6,v32,v33
v_lshlrev_b32 v32,16,v6
v_and_b32 v33,0xffff0000,v6
v_add_f32 v33,0x3727c5ac,v33
v_cvt_pk_bf16_f32 v6,v33,v33
v_lshlrev_b32 v33,16,v6
v_sqrt_f32 v33,v33
s_nop 0
v_cvt_pk_bf16_f32 v6,v33,v33
v_lshlrev_b32 v33,16,v6
v_rcp_f32 v33,v33
s_lshl_b32 s60,s48,7
s_add_u32 s63,s75,s60
s_add_u32 s63,s63,40960
v_lshlrev_b32 v6,3,v0
s_mov_b64 exec,65535
buffer_store_dwordx2 v[32:33],v6,s[8:11],s63 offen sc1
s_mov_b64 exec,-1
zs_263:
s_add_u32 s52,s52,1
s_add_u32 s35,s35,640
s_waitcnt vmcnt(0)
s_mov_b64 exec,1
buffer_store_dword v5,v1,s[8:11],s82 offen sc1
s_mov_b64 exec,-1
s_cmp_lt_u32 s52,64
s_cbranch_scc1 R1_LOOP
s_endpgm
ROLE_W1:
v_lshlrev_b32 v1,4,v0
v_mov_b32 v5,1
s_lshl_b32 s56,s48,2
s_add_u32 s56,s56,s46
v_bfe_u32 v6,v0,2,2
v_lshrrev_b32 v7,4,v0
v_add_u32 v7,v6,v7
v_and_b32 v7,3,v7
v_and_b32 v15,3,v0
v_lshlrev_b32 v15,4,v15
v_lshl_add_u32 v15,v7,6,v15
v_lshl_add_u32 v15,v6,8,v15
v_lshrrev_b32 v6,5,v0
v_bfe_u32 v7,v0,4,1
v_lshlrev_b32 v16,10,v7
v_bfe_u32 v7,v0,2,2
v_lshl_add_u32 v16,v7,8,v16
v_add_u32 v6,v6,v7
v_and_b32 v6,3,v6
v_lshl_add_u32 v16,v6,6,v16
v_and_b32 v6,3,v0
v_lshl_add_u32 v16,v6,4,v16
v_add_u32 v18,46080,v16
v_lshrrev_b32 v6,5,v0
v_bfe_u32 v7,v0,4,1
v_lshlrev_b32 v20,10,v7
v_lshl_add_u32 v20,v6,8,v20
v_and_b32 v6,15,v0
v_lshl_add_u32 v20,v6,4,v20
v_lshrrev_b32 v6,5,v0
v_add_u32 v6,2,v6
v_bfe_u32 v7,v0,4,1
v_lshlrev_b32 v17,10,v7
v_bfe_u32 v7,v0,2,2
v_lshl_add_u32 v17,v7,8,v17
v_add_u32 v6,v6,v7
v_and_b32 v6,3,v6
v_lshl_add_u32 v17,v6,6,v17
v_and_b32 v6,3,v0
v_lshl_add_u32 v17,v6,4,v17
v_add_u32 v19,46080,v17
v_lshrrev_b32 v6,5,v0
v_add_u32 v6,2,v6
v_bfe_u32 v7,v0,4,1
v_lshlrev_b32 v21,10,v7
v_lshl_add_u32 v21,v6,8,v21
v_and_b32 v6,15,v0
v_lshl_add_u32 v21,v6,4,v21
v_min_u32 v2,31,v0
v_lshlrev_b32 v2,2,v2
v_mov_b32 v112,0xc0135761
v_mov_b32 v113,0xbdd2d3e8
s_mov_b32 s68,0xbdd2d3e8
v_mov_b32 v116,0
v_mov_b32 v117,0
v_mov_b32 v118,0
v_mov_b32 v119,0
s_lshl_b32 s60,s56,11
s_add_u32 s61,s60,237699072
buffer_store_dwordx4 v[116:119],v1,s[8:11],s61 offen sc1
buffer_store_dwordx4 v[116:119],v1,s[8:11],s61 offen offset:1024 sc1
s_add_u32 s61,s60,238067712
buffer_store_dwordx4 v[116:119],v1,s[8:11],s61 offen sc1
buffer_store_dwordx4 v[116:119],v1,s[8:11],s61 offen offset:1024 sc1
v_mov_b32 v24,-1
v_mov_b32 v25,-1
v_mov_b32 v26,-1
v_mov_b32 v27,-1
s_add_u32 s60,s48,0
s_lshl2_add_u32 s60,s60,s46
s_mul_i32 s60,s60,22528
s_add_u32 s61,s60,24117248
buffer_store_dwordx4 v[24:27],v1,s[8:11],s61 offen sc1
buffer_store_dwordx4 v[24:27],v1,s[8:11],s61 offen offset:1024 sc1
buffer_store_dwordx4 v[24:27],v1,s[8:11],s61 offen offset:2048 sc1
buffer_store_dwordx4 v[24:27],v1,s[8:11],s61 offen offset:3072 sc1
s_add_u32 s61,s60,24121344
buffer_store_dwordx4 v[24:27],v1,s[8:11],s61 offen sc1
buffer_store_dwordx4 v[24:27],v1,s[8:11],s61 offen offset:1024 sc1
buffer_store_dwordx4 v[24:27],v1,s[8:11],s61 offen offset:2048 sc1
buffer_store_dwordx4 v[24:27],v1,s[8:11],s61 offen offset:3072 sc1
s_add_u32 s61,s60,24125440
buffer_store_dwordx4 v[24:27],v1,s[8:11],s61 offen sc1
buffer_store_dwordx4 v[24:27],v1,s[8:11],s61 offen offset:1024 sc1
buffer_store_dwordx4 v[24:27],v1,s[8:11],s61 offen offset:2048 sc1
buffer_store_dwordx4 v[24:27],v1,s[8:11],s61 offen offset:3072 sc1
s_add_u32 s61,s60,24129536
buffer_store_dwordx4 v[24:27],v1,s[8:11],s61 offen sc1
buffer_store_dwordx4 v[24:27],v1,s[8:11],s61 offen offset:1024 sc1
buffer_store_dwordx4 v[24:27],v1,s[8:11],s61 offen offset:2048 sc1
buffer_store_dwordx4 v[24:27],v1,s[8:11],s61 offen offset:3072 sc1
s_add_u32 s61,s60,24133632
buffer_store_dwordx4 v[24:27],v1,s[8:11],s61 offen sc1
buffer_store_dwordx4 v[24:27],v1,s[8:11],s61 offen offset:1024 sc1
buffer_store_dwordx4 v[24:27],v1,s[8:11],s61 offen offset:2048 sc1
buffer_store_dwordx4 v[24:27],v1,s[8:11],s61 offen offset:3072 sc1
s_add_u32 s61,s60,24137728
buffer_store_dwordx4 v[24:27],v1,s[8:11],s61 offen sc1
buffer_store_dwordx4 v[24:27],v1,s[8:11],s61 offen offset:1024 sc1
s_waitcnt vmcnt(0)
s_barrier
s_cmp_lg_u32 s46,0
s_cbranch_scc1 arr_264
v_mov_b32 v6,1
s_lshl_b32 s3,s49,2
v_mov_b32 v7,s3
s_mov_b64 exec,1
buffer_atomic_add v6,v7,s[12:15],0 offen sc1
s_mov_b64 exec,-1
arr_264:
s_lshl_b32 s3,s49,2
v_mov_b32 v7,s3
s_nop 1
ibw_265:
buffer_load_dword v6,v7,s[12:15],0 offen sc1
s_waitcnt vmcnt(0)
v_cmp_ne_u32 vcc,256,v6
s_nop 0
s_cbranch_vccz ok_266
s_sleep 8
s_sub_u32 s47,s47,1
s_cbranch_scc1 ABORT
s_branch ibw_265
ok_266:
s_cmp_lg_u32 s49,0
s_cbranch_scc1 ibok_267
v_and_b32 v7,7,v0
v_lshlrev_b32 v7,2,v7
buffer_load_dword v6,v7,s[12:15],0 offen offset:32 sc1
s_waitcnt vmcnt(0)
v_cmp_ne_u32 vcc,32,v6
s_nop 0
s_cbranch_vccz ibok_267
s_barrier
s_mov_b32 s49,1
s_mov_b32 s3,s2
s_load_dwordx16 s[16:31],s[0:1],0
s_load_dwordx8 s[32:39],s[0:1],64
s_waitcnt lgkmcnt(0)
s_branch DISPATCH
ibok_267:
s_lshl_b32 s58,s56,6
s_mul_i32 s63,s46,40960
s_mov_b32 s4,s32
s_mov_b32 s5,s33
s_mov_b32 s6,819200
s_mov_b32 s7,0x20000
v_lshrrev_b32 v9,2,v0
s_mov_b32 s64,1280
v_mul_lo_u32 v9,v9,s64
v_and_b32 v10,3,v0
v_lshl_add_u32 v6,v10,4,v9
s_add_u32 m0,s63,0
s_add_u32 s65,s58,0
buffer_load_dwordx4 v6,s[4:7],s65 offen lds
s_add_u32 m0,s63,1024
s_add_u32 s65,s58,20480
buffer_load_dwordx4 v6,s[4:7],s65 offen lds
s_add_u32 m0,s63,2048
s_add_u32 s65,s58,40960
buffer_load_dwordx4 v6,s[4:7],s65 offen lds
s_add_u32 m0,s63,3072
s_add_u32 s65,s58,61440
buffer_load_dwordx4 v6,s[4:7],s65 offen lds
s_add_u32 m0,s63,4096
s_add_u32 s65,s58,81920
buffer_load_dwordx4 v6,s[4:7],s65 offen lds
s_add_u32 m0,s63,5120
s_add_u32 s65,s58,102400
buffer_load_dwordx4 v6,s[4:7],s65 offen lds
s_add_u32 m0,s63,6144
s_add_u32 s65,s58,122880
buffer_load_dwordx4 v6,s[4:7],s65 offen lds
s_add_u32 m0,s63,7168
s_add_u32 s65,s58,143360
buffer_load_dwordx4 v6,s[4:7],s65 offen lds
s_add_u32 m0,s63,8192
s_add_u32 s65,s58,163840
buffer_load_dwordx4 v6,s[4:7],s65 offen lds
s_add_u32 m0,s63,9216
s_add_u32 s65,s58,184320
buffer_load_dwordx4 v6,s[4:7],s65 offen lds
s_add_u32 m0,s63,10240
s_add_u32 s65,s58,204800
buffer_load_dwordx4 v6,s[4:7],s65 offen lds
s_add_u32 m0,s63,11264
s_add_u32 s65,s58,225280
buffer_load_dwordx4 v6,s[4:7],s65 offen lds
s_add_u32 m0,s63,12288
s_add_u32 s65,s58,245760
buffer_load_dwordx4 v6,s[4:7],s65 offen lds
s_add_u32 m0,s63,13312
s_add_u32 s65,s58,266240
buffer_load_dwordx4 v6,s[4:7],s65 offen lds
s_add_u32 m0,s63,14336
s_add_u32 s65,s58,286720
buffer_load_dwordx4 v6,s[4:7],s65 offen lds
s_add_u32 m0,s63,15360
s_add_u32 s65,s58,307200
buffer_load_dwordx4 v6,s[4:7],s65 offen lds
s_add_u32 m0,s63,16384
s_add_u32 s65,s58,327680
buffer_load_dwordx4 v6,s[4:7],s65 offen lds
s_add_u32 m0,s63,17408
s_add_u32 s65,s58,348160
buffer_load_dwordx4 v6,s[4:7],s65 offen lds
s_add_u32 m0,s63,18432
s_add_u32 s65,s58,368640
buffer_load_dwordx4 v6,s[4:7],s65 offen lds
s_add_u32 m0,s63,19456
s_add_u32 s65,s58,389120
buffer_load_dwordx4 v6,s[4:7],s65 offen lds
s_add_u32 m0,s63,20480
s_add_u32 s65,s58,409600
buffer_load_dwordx4 v6,s[4:7],s65 offen lds
s_add_u32 m0,s63,21504
s_add_u32 s65,s58,430080
buffer_load_dwordx4 v6,s[4:7],s65 offen lds
s_add_u32 m0,s63,22528
s_add_u32 s65,s58,450560
buffer_load_dwordx4 v6,s[4:7],s65 offen lds
s_add_u32 m0,s63,23552
s_add_u32 s65,s58,471040
buffer_load_dwordx4 v6,s[4:7],s65 offen lds
s_add_u32 m0,s63,24576
s_add_u32 s65,s58,491520
buffer_load_dwordx4 v6,s[4:7],s65 offen lds
s_add_u32 m0,s63,25600
s_add_u32 s65,s58,512000
buffer_load_dwordx4 v6,s[4:7],s65 offen lds
s_add_u32 m0,s63,26624
s_add_u32 s65,s58,532480
buffer_load_dwordx4 v6,s[4:7],s65 offen lds
s_add_u32 m0,s63,27648
s_add_u32 s65,s58,552960
buffer_load_dwordx4 v6,s[4:7],s65 offen lds
s_add_u32 m0,s63,28672
s_add_u32 s65,s58,573440
buffer_load_dwordx4 v6,s[4:7],s65 offen lds
s_add_u32 m0,s63,29696
s_add_u32 s65,s58,593920
buffer_load_dwordx4 v6,s[4:7],s65 offen lds
s_add_u32 m0,s63,30720
s_add_u32 s65,s58,614400
buffer_load_dwordx4 v6,s[4:7],s65 offen lds
s_add_u32 m0,s63,31744
s_add_u32 s65,s58,634880
buffer_load_dwordx4 v6,s[4:7],s65 offen lds
s_add_u32 m0,s63,32768
s_add_u32 s65,s58,655360
buffer_load_dwordx4 v6,s[4:7],s65 offen lds
s_add_u32 m0,s63,33792
s_add_u32 s65,s58,675840
buffer_load_dwordx4 v6,s[4:7],s65 offen lds
s_add_u32 m0,s63,34816
s_add_u32 s65,s58,696320
buffer_load_dwordx4 v6,s[4:7],s65 offen lds
s_add_u32 m0,s63,35840
s_add_u32 s65,s58,716800
buffer_load_dwordx4 v6,s[4:7],s65 offen lds
s_add_u32 m0,s63,36864
s_add_u32 s65,s58,737280
buffer_load_dwordx4 v6,s[4:7],s65 offen lds
s_add_u32 m0,s63,37888
s_add_u32 s65,s58,757760
buffer_load_dwordx4 v6,s[4:7],s65 offen lds
s_add_u32 m0,s63,38912
s_add_u32 s65,s58,778240
buffer_load_dwordx4 v6,s[4:7],s65 offen lds
s_add_u32 m0,s63,39936
s_add_u32 s65,s58,798720
buffer_load_dwordx4 v6,s[4:7],s65 offen lds
s_waitcnt vmcnt(20)
v_bfe_u32 v9,v0,2,2
v_lshrrev_b32 v10,5,v0
v_lshl_add_u32 v9,v10,2,v9
v_mul_u32_u24 v9,64,v9
v_and_b32 v10,1,v0
v_lshl_add_u32 v9,v10,3,v9
v_bfe_u32 v10,v0,1,1
v_lshl_add_u32 v9,v10,5,v9
v_bfe_u32 v10,v0,4,1
v_lshl_add_u32 v9,v10,4,v9
v_add_u32 v7,s63,v9
ds_read_b64_tr_b16 a[0:1],v7 offset:0
ds_read_b64_tr_b16 a[2:3],v7 offset:1024
ds_read_b64_tr_b16 a[4:5],v7 offset:512
ds_read_b64_tr_b16 a[6:7],v7 offset:1536
ds_read_b64_tr_b16 a[8:9],v7 offset:2048
ds_read_b64_tr_b16 a[10:11],v7 offset:3072
ds_read_b64_tr_b16 a[12:13],v7 offset:2560
ds_read_b64_tr_b16 a[14:15],v7 offset:3584
ds_read_b64_tr_b16 a[16:17],v7 offset:4096
ds_read_b64_tr_b16 a[18:19],v7 offset:5120
ds_read_b64_tr_b16 a[20:21],v7 offset:4608
ds_read_b64_tr_b16 a[22:23],v7 offset:5632
s_waitcnt lgkmcnt(4)
ds_read_b64_tr_b16 a[24:25],v7 offset:6144
ds_read_b64_tr_b16 a[26:27],v7 offset:7168
ds_read_b64_tr_b16 a[28:29],v7 offset:6656
ds_read_b64_tr_b16 a[30:31],v7 offset:7680
ds_read_b64_tr_b16 a[32:33],v7 offset:8192
ds_read_b64_tr_b16 a[34:35],v7 offset:9216
ds_read_b64_tr_b16 a[36:37],v7 offset:8704
ds_read_b64_tr_b16 a[38:39],v7 offset:9728
ds_read_b64_tr_b16 a[40:41],v7 offset:10240
ds_read_b64_tr_b16 a[42:43],v7 offset:11264
ds_read_b64_tr_b16 a[44:45],v7 offset:10752
ds_read_b64_tr_b16 a[46:47],v7 offset:11776
s_waitcnt lgkmcnt(4)
ds_read_b64_tr_b16 a[48:49],v7 offset:12288
ds_read_b64_tr_b16 a[50:51],v7 offset:13312
ds_read_b64_tr_b16 a[52:53],v7 offset:12800
ds_read_b64_tr_b16 a[54:55],v7 offset:13824
ds_read_b64_tr_b16 a[56:57],v7 offset:14336
ds_read_b64_tr_b16 a[58:59],v7 offset:15360
ds_read_b64_tr_b16 a[60:61],v7 offset:14848
ds_read_b64_tr_b16 a[62:63],v7 offset:15872
ds_read_b64_tr_b16 a[64:65],v7 offset:16384
ds_read_b64_tr_b16 a[66:67],v7 offset:17408
ds_read_b64_tr_b16 a[68:69],v7 offset:16896
ds_read_b64_tr_b16 a[70:71],v7 offset:17920
s_waitcnt lgkmcnt(4)
ds_read_b64_tr_b16 a[72:73],v7 offset:18432
ds_read_b64_tr_b16 a[74:75],v7 offset:19456
ds_read_b64_tr_b16 a[76:77],v7 offset:18944
ds_read_b64_tr_b16 a[78:79],v7 offset:19968
s_waitcnt lgkmcnt(0)
s_waitcnt vmcnt(0)
v_bfe_u32 v9,v0,2,2
v_lshrrev_b32 v10,5,v0
v_lshl_add_u32 v9,v10,2,v9
v_mul_u32_u24 v9,64,v9
v_and_b32 v10,1,v0
v_lshl_add_u32 v9,v10,3,v9
v_bfe_u32 v10,v0,1,1
v_lshl_add_u32 v9,v10,5,v9
v_bfe_u32 v10,v0,4,1
v_lshl_add_u32 v9,v10,4,v9
v_add_u32 v7,s63,v9
ds_read_b64_tr_b16 a[80:81],v7 offset:20480
ds_read_b64_tr_b16 a[82:83],v7 offset:21504
ds_read_b64_tr_b16 a[84:85],v7 offset:20992
ds_read_b64_tr_b16 a[86:87],v7 offset:22016
ds_read_b64_tr_b16 a[88:89],v7 offset:22528
ds_read_b64_tr_b16 a[90:91],v7 offset:23552
ds_read_b64_tr_b16 a[92:93],v7 offset:23040
ds_read_b64_tr_b16 a[94:95],v7 offset:24064
ds_read_b64_tr_b16 a[96:97],v7 offset:24576
ds_read_b64_tr_b16 a[98:99],v7 offset:25600
ds_read_b64_tr_b16 a[100:101],v7 offset:25088
ds_read_b64_tr_b16 a[102:103],v7 offset:26112
s_waitcnt lgkmcnt(4)
ds_read_b64_tr_b16 a[104:105],v7 offset:26624
ds_read_b64_tr_b16 a[106:107],v7 offset:27648
ds_read_b64_tr_b16 a[108:109],v7 offset:27136
ds_read_b64_tr_b16 a[110:111],v7 offset:28160
ds_read_b64_tr_b16 a[112:113],v7 offset:28672
ds_read_b64_tr_b16 a[114:115],v7 offset:29696
ds_read_b64_tr_b16 a[116:117],v7 offset:29184
ds_read_b64_tr_b16 a[118:119],v7 offset:30208
ds_read_b64_tr_b16 a[120:121],v7 offset:30720
ds_read_b64_tr_b16 a[122:123],v7 offset:31744
ds_read_b64_tr_b16 a[124:125],v7 offset:31232
ds_read_b64_tr_b16 a[126:127],v7 offset:32256
s_waitcnt lgkmcnt(4)
ds_read_b64_tr_b16 a[128:129],v7 offset:32768
ds_read_b64_tr_b16 a[130:131],v7 offset:33792
ds_read_b64_tr_b16 a[132:133],v7 offset:33280
ds_read_b64_tr_b16 a[134:135],v7 offset:34304
ds_read_b64_tr_b16 a[136:137],v7 offset:34816
ds_read_b64_tr_b16 a[138:139],v7 offset:35840
ds_read_b64_tr_b16 a[140:141],v7 offset:35328
ds_read_b64_tr_b16 a[142:143],v7 offset:36352
ds_read_b64_tr_b16 a[144:145],v7 offset:36864
ds_read_b64_tr_b16 a[146:147],v7 offset:37888
ds_read_b64_tr_b16 a[148:149],v7 offset:37376
ds_read_b64_tr_b16 a[150:151],v7 offset:38400
s_waitcnt lgkmcnt(4)
ds_read_b64_tr_b16 a[152:153],v7 offset:38912
ds_read_b64_tr_b16 a[154:155],v7 offset:39936
ds_read_b64_tr_b16 a[156:157],v7 offset:39424
ds_read_b64_tr_b16 a[158:159],v7 offset:40448
s_waitcnt lgkmcnt(0)
v_mov_b32 v24,0x3f803f80
v_mov_b32 v25,0x3f803f80
v_mov_b32 v26,0x3f803f80
v_mov_b32 v27,0x3f803f80
s_nop 1
v_mfma_f32_32x32x16_bf16 v[144:159],a[0:3],v[24:27],0
v_mfma_f32_32x32x16_bf16 v[144:159],a[4:7],v[24:27],v[144:159]
v_mfma_f32_32x32x16_bf16 v[144:159],a[8:11],v[24:27],v[144:159]
v_mfma_f32_32x32x16_bf16 v[144:159],a[12:15],v[24:27],v[144:159]
v_mfma_f32_32x32x16_bf16 v[144:159],a[16:19],v[24:27],v[144:159]
v_mfma_f32_32x32x16_bf16 v[144:159],a[20:23],v[24:27],v[144:159]
v_mfma_f32_32x32x16_bf16 v[144:159],a[24:27],v[24:27],v[144:159]
v_mfma_f32_32x32x16_bf16 v[144:159],a[28:31],v[24:27],v[144:159]
v_mfma_f32_32x32x16_bf16 v[144:159],a[32:35],v[24:27],v[144:159]
v_mfma_f32_32x32x16_bf16 v[144:159],a[36:39],v[24:27],v[144:159]
v_mfma_f32_32x32x16_bf16 v[144:159],a[40:43],v[24:27],v[144:159]
v_mfma_f32_32x32x16_bf16 v[144:159],a[44:47],v[24:27],v[144:159]
v_mfma_f32_32x32x16_bf16 v[144:159],a[48:51],v[24:27],v[144:159]
v_mfma_f32_32x32x16_bf16 v[144:159],a[52:55],v[24:27],v[144:159]
v_mfma_f32_32x32x16_bf16 v[144:159],a[56:59],v[24:27],v[144:159]
v_mfma_f32_32x32x16_bf16 v[144:159],a[60:63],v[24:27],v[144:159]
v_mfma_f32_32x32x16_bf16 v[144:159],a[64:67],v[24:27],v[144:159]
v_mfma_f32_32x32x16_bf16 v[144:159],a[68:71],v[24:27],v[144:159]
v_mfma_f32_32x32x16_bf16 v[144:159],a[72:75],v[24:27],v[144:159]
v_mfma_f32_32x32x16_bf16 v[144:159],a[76:79],v[24:27],v[144:159]
v_mfma_f32_32x32x16_bf16 v[144:159],a[80:83],v[24:27],v[144:159]
v_mfma_f32_32x32x16_bf16 v[144:159],a[84:87],v[24:27],v[144:159]
v_mfma_f32_32x32x16_bf16 v[144:159],a[88:91],v[24:27],v[144:159]
v_mfma_f32_32x32x16_bf16 v[144:159],a[92:95],v[24:27],v[144:159]
v_mfma_f32_32x32x16_bf16 v[144:159],a[96:99],v[24:27],v[144:159]
v_mfma_f32_32x32x16_bf16 v[144:159],a[100:103],v[24:27],v[144:159]
v_mfma_f32_32x32x16_bf16 v[144:159],a[104:107],v[24:27],v[144:159]
v_mfma_f32_32x32x16_bf16 v[144:159],a[108:111],v[24:27],v[144:159]
v_mfma_f32_32x32x16_bf16 v[144:159],a[112:115],v[24:27],v[144:159]
v_mfma_f32_32x32x16_bf16 v[144:159],a[116:119],v[24:27],v[144:159]
v_mfma_f32_32x32x16_bf16 v[144:159],a[120:123],v[24:27],v[144:159]
v_mfma_f32_32x32x16_bf16 v[144:159],a[124:127],v[24:27],v[144:159]
v_mfma_f32_32x32x16_bf16 v[144:159],a[128:131],v[24:27],v[144:159]
v_mfma_f32_32x32x16_bf16 v[144:159],a[132:135],v[24:27],v[144:159]
v_mfma_f32_32x32x16_bf16 v[144:159],a[136:139],v[24:27],v[144:159]
v_mfma_f32_32x32x16_bf16 v[144:159],a[140:143],v[24:27],v[144:159]
v_mfma_f32_32x32x16_bf16 v[144:159],a[144:147],v[24:27],v[144:159]
v_mfma_f32_32x32x16_bf16 v[144:159],a[148:151],v[24:27],v[144:159]
v_mfma_f32_32x32x16_bf16 v[144:159],a[152:155],v[24:27],v[144:159]
v_mfma_f32_32x32x16_bf16 v[144:159],a[156:159],v[24:27],v[144:159]
v_and_b32 v182,31,v0
v_lshlrev_b32 v182,3,v182
v_add_u32 v182,0xa000,v182
v_bfe_u32 v6,v0,2,3
v_mul_u32_u24 v6,96,v6
v_add_u32 v182,v182,v6
s_barrier
s_mov_b32 s50,0
s_mov_b32 s32,0
s_mov_b32 s57,0
s_mov_b32 s59,2147483648
s_mov_b32 s82,2147483648
s_mov_b32 s39,2147483648
v_mov_b32 v22,94208
v_lshl_add_u32 v22,v0,2,v22
v_mov_b32 v23,0
ds_write_b32 v22,v23
s_mov_b32 s39,1600000
v_and_b32 v72,15,v0
v_lshlrev_b32 v72,7,v72
v_min_u32 v6,51,v0
v_lshlrev_b32 v6,2,v6
v_add_u32 v2,0,v6
v_add_u32 v7,127360,v6
v_cmp_gt_u32 s[78:79],32,v0
s_nop 1
v_cndmask_b32 v2,v7,v2,s[78:79]
s_mov_b32 s51,0
s_mov_b32 s52,0
s_mul_i32 s62,s51,9
s_and_b32 s63,s52,7
s_add_u32 s62,s62,s63
s_mul_i32 s62,s62,40960
s_add_u32 s62,s62,237371392
s_lshl_b32 s63,s56,11
s_add_u32 s62,s62,s63
buffer_load_dword v73,v72,s[8:11],s62 offen sc1
s_mov_b32 s51,0
s_mov_b32 s52,1
s_mul_i32 s62,s51,9
s_and_b32 s63,s52,7
s_add_u32 s62,s62,s63
s_mul_i32 s62,s62,40960
s_add_u32 s62,s62,237371392
s_lshl_b32 s63,s56,11
s_add_u32 s62,s62,s63
buffer_load_dword v73,v72,s[8:11],s62 offen sc1
s_mov_b32 s51,0
s_mov_b32 s52,2
s_mul_i32 s62,s51,9
s_and_b32 s63,s52,7
s_add_u32 s62,s62,s63
s_mul_i32 s62,s62,40960
s_add_u32 s62,s62,237371392
s_lshl_b32 s63,s56,11
s_add_u32 s62,s62,s63
buffer_load_dword v73,v72,s[8:11],s62 offen sc1
s_mov_b32 s51,0
s_mov_b32 s52,3
s_mul_i32 s62,s51,9
s_and_b32 s63,s52,7
s_add_u32 s62,s62,s63
s_mul_i32 s62,s62,40960
s_add_u32 s62,s62,237371392
s_lshl_b32 s63,s56,11
s_add_u32 s62,s62,s63
buffer_load_dword v73,v72,s[8:11],s62 offen sc1
s_mov_b32 s51,0
s_mov_b32 s52,4
s_mul_i32 s62,s51,9
s_and_b32 s63,s52,7
s_add_u32 s62,s62,s63
s_mul_i32 s62,s62,40960
s_add_u32 s62,s62,237371392
s_lshl_b32 s63,s56,11
s_add_u32 s62,s62,s63
buffer_load_dword v73,v72,s[8:11],s62 offen sc1
s_mov_b32 s51,0
s_mov_b32 s52,5
s_mul_i32 s62,s51,9
s_and_b32 s63,s52,7
s_add_u32 s62,s62,s63
s_mul_i32 s62,s62,40960
s_add_u32 s62,s62,237371392
s_lshl_b32 s63,s56,11
s_add_u32 s62,s62,s63
buffer_load_dword v73,v72,s[8:11],s62 offen sc1
s_mov_b32 s51,0
s_mov_b32 s52,6
s_mul_i32 s62,s51,9
s_and_b32 s63,s52,7
s_add_u32 s62,s62,s63
s_mul_i32 s62,s62,40960
s_add_u32 s62,s62,237371392
s_lshl_b32 s63,s56,11
s_add_u32 s62,s62,s63
buffer_load_dword v73,v72,s[8:11],s62 offen sc1
s_mov_b32 s51,0
s_mov_b32 s52,7
s_mul_i32 s62,s51,9
s_and_b32 s63,s52,7
s_add_u32 s62,s62,s63
s_mul_i32 s62,s62,40960
s_add_u32 s62,s62,237371392
s_lshl_b32 s63,s56,11
s_add_u32 s62,s62,s63
buffer_load_dword v73,v72,s[8:11],s62 offen sc1
s_mov_b32 s51,1
s_mov_b32 s52,0
s_mul_i32 s62,s51,9
s_and_b32 s63,s52,7
s_add_u32 s62,s62,s63
s_mul_i32 s62,s62,40960
s_add_u32 s62,s62,237371392
s_lshl_b32 s63,s56,11
s_add_u32 s62,s62,s63
buffer_load_dword v73,v72,s[8:11],s62 offen sc1
s_mov_b32 s51,1
s_mov_b32 s52,1
s_mul_i32 s62,s51,9
s_and_b32 s63,s52,7
s_add_u32 s62,s62,s63
s_mul_i32 s62,s62,40960
s_add_u32 s62,s62,237371392
s_lshl_b32 s63,s56,11
s_add_u32 s62,s62,s63
buffer_load_dword v73,v72,s[8:11],s62 offen sc1
s_mov_b32 s51,1
s_mov_b32 s52,2
s_mul_i32 s62,s51,9
s_and_b32 s63,s52,7
s_add_u32 s62,s62,s63
s_mul_i32 s62,s62,40960
s_add_u32 s62,s62,237371392
s_lshl_b32 s63,s56,11
s_add_u32 s62,s62,s63
buffer_load_dword v73,v72,s[8:11],s62 offen sc1
s_mov_b32 s51,1
s_mov_b32 s52,3
s_mul_i32 s62,s51,9
s_and_b32 s63,s52,7
s_add_u32 s62,s62,s63
s_mul_i32 s62,s62,40960
s_add_u32 s62,s62,237371392
s_lshl_b32 s63,s56,11
s_add_u32 s62,s62,s63
buffer_load_dword v73,v72,s[8:11],s62 offen sc1
s_mov_b32 s51,1
s_mov_b32 s52,4
s_mul_i32 s62,s51,9
s_and_b32 s63,s52,7
s_add_u32 s62,s62,s63
s_mul_i32 s62,s62,40960
s_add_u32 s62,s62,237371392
s_lshl_b32 s63,s56,11
s_add_u32 s62,s62,s63
buffer_load_dword v73,v72,s[8:11],s62 offen sc1
s_mov_b32 s51,1
s_mov_b32 s52,5
s_mul_i32 s62,s51,9
s_and_b32 s63,s52,7
s_add_u32 s62,s62,s63
s_mul_i32 s62,s62,40960
s_add_u32 s62,s62,237371392
s_lshl_b32 s63,s56,11
s_add_u32 s62,s62,s63
buffer_load_dword v73,v72,s[8:11],s62 offen sc1
s_mov_b32 s51,1
s_mov_b32 s52,6
s_mul_i32 s62,s51,9
s_and_b32 s63,s52,7
s_add_u32 s62,s62,s63
s_mul_i32 s62,s62,40960
s_add_u32 s62,s62,237371392
s_lshl_b32 s63,s56,11
s_add_u32 s62,s62,s63
buffer_load_dword v73,v72,s[8:11],s62 offen sc1
s_mov_b32 s51,1
s_mov_b32 s52,7
s_mul_i32 s62,s51,9
s_and_b32 s63,s52,7
s_add_u32 s62,s62,s63
s_mul_i32 s62,s62,40960
s_add_u32 s62,s62,237371392
s_lshl_b32 s63,s56,11
s_add_u32 s62,s62,s63
buffer_load_dword v73,v72,s[8:11],s62 offen sc1
s_waitcnt vmcnt(0)
s_waitcnt lgkmcnt(0)
s_barrier
s_mov_b32 s83,s100
s_min_u32 s62,s32,127
s_sub_u32 s60,s62,15
s_lshr_b32 s34,s60,1
s_and_b32 s33,s60,1
s_cmp_eq_u32 s33,0
s_cselect_b32 s61,15,0
s_add_u32 s34,s34,s61
s_sub_u32 s61,s60,49
s_cmp_ge_u32 s60,98
s_cselect_b32 s34,s61,s34
s_cselect_b32 s33,1,s33
s_cmp_lt_u32 s62,15
s_cselect_b32 s34,s62,s34
s_cselect_b32 s33,0,s33
s_lshl_b32 s35,s33,6
s_add_u32 s35,s35,s34
s_lshl_b32 s35,s35,9
s_add_u32 s35,s35,393216
s_cmp_lt_u32 s34,7
s_cselect_b64 s[76:77],s[78:79],-1
s_sub_u32 s57,46080,s57
v_swap_b32 v16,v18
v_swap_b32 v17,v19
s_add_u32 s62,s32,1
s_min_u32 s62,s62,127
s_sub_u32 s60,s62,15
s_lshr_b32 s41,s60,1
s_and_b32 s40,s60,1
s_cmp_eq_u32 s40,0
s_cselect_b32 s61,15,0
s_add_u32 s41,s41,s61
s_sub_u32 s61,s60,49
s_cmp_ge_u32 s60,98
s_cselect_b32 s41,s61,s41
s_cselect_b32 s40,1,s40
s_cmp_lt_u32 s62,15
s_cselect_b32 s41,s62,s41
s_cselect_b32 s40,0,s40
s_lshl_b32 s42,s40,6
s_add_u32 s42,s42,s41
s_lshl_b32 s42,s42,9
s_add_u32 s42,s42,393216
s_cmp_lt_u32 s41,7
s_cselect_b64 s[80:81],s[78:79],-1
W1_COLD:
s_mov_b32 s37,0
s_cmp_lg_u32 s46,0
s_cbranch_scc1 wo_268
fb_270:
buffer_load_dword v3,v2,s[8:11],s35 offen sc1
s_waitcnt vmcnt(0)
v_cmp_eq_u32 vcc,0,v3
s_and_b64 vcc,vcc,s[76:77]
s_cbranch_scc0 ok_271
s_sleep 3
s_sub_u32 s47,s47,1
s_cbranch_scc1 ABORT
s_branch fb_270
ok_271:
W1_COLD2:
s_add_u32 s65,s32,1
s_or_b32 s65,s65,s37
v_mov_b32 v23,s65
ds_max_i32 v22,v23
s_branch wd_269
wo_268:
ds_read_b32 v23,v22
s_waitcnt lgkmcnt(0)
v_cmp_ge_u32 vcc,s32,v23
s_nop 0
s_cbranch_vccz wd_269
s_sleep 1
s_sub_u32 s39,s39,1
s_cbranch_scc1 ABORT
s_branch wo_268
wd_269:
buffer_load_dword v3,v2,s[8:11],s42 offen sc1
s_sub_u32 s66,46080,s57
s_lshl_b32 s60,s33,6
s_add_u32 s60,s60,s34
s_mul_i32 s60,s60,46080
s_add_u32 s60,s60,s37
s_add_u32 s60,s60,223608832
s_mov_b32 s67,s60
s_mul_i32 s61,s46,10240
s_add_u32 s60,s60,s61
s_add_u32 s61,s61,s66
s_add_u32 m0,s61,0
s_add_u32 s63,s60,0
buffer_load_dwordx4 v1,s[8:11],s63 offen sc1 lds
buffer_load_dwordx4 v1,s[8:11],s63 offen offset:1024 sc1 lds
buffer_load_dwordx4 v1,s[8:11],s63 offen offset:2048 sc1 lds
buffer_load_dwordx4 v1,s[8:11],s63 offen offset:3072 sc1 lds
s_add_u32 m0,s61,4096
s_add_u32 s63,s60,4096
buffer_load_dwordx4 v1,s[8:11],s63 offen sc1 lds
buffer_load_dwordx4 v1,s[8:11],s63 offen offset:1024 sc1 lds
s_waitcnt vmcnt(7)
s_mov_b64 exec,1
s_cmp_lg_u32 s49,0
s_cbranch_scc0 ls_272
buffer_store_dword v5,v1,s[8:11],s59 offen sc1
s_branch ls_273
ls_272:
buffer_store_dword v5,v1,s[8:11],s59 offen
ls_273:
s_mov_b64 exec,-1
s_mov_b32 s59,2147483648
buffer_load_dwordx4 v1,s[8:11],s63 offen offset:2048 sc1 lds
buffer_load_dwordx4 v1,s[8:11],s63 offen offset:3072 sc1 lds
s_add_u32 m0,s61,8192
s_add_u32 s63,s60,8192
buffer_load_dwordx4 v1,s[8:11],s63 offen sc1 lds
buffer_load_dwordx4 v1,s[8:11],s63 offen offset:1024 sc1 lds
s_add_u32 m0,s66,40960
s_add_u32 s63,s67,40960
buffer_load_dwordx4 v1,s[8:11],s63 offen sc1 lds
s_mov_b32 s35,s42
s_mov_b32 s53,s33
s_mov_b32 s54,s34
s_add_u32 s32,s32,1
s_mov_b32 s33,s40
s_mov_b32 s34,s41
s_mov_b64 s[76:77],s[80:81]
s_sub_u32 s57,46080,s57
v_swap_b32 v16,v18
v_swap_b32 v17,v19
s_mov_b32 s51,s53
s_mov_b32 s52,s54
s_waitcnt vmcnt(6)
v_cmp_eq_u32 vcc,0,v3
s_and_b64 vcc,vcc,s[76:77]
s_cselect_b32 s37,2147483648,0
s_cmp_lt_u32 s32,128
s_cselect_b32 s37,s37,2147483648
s_branch W1_GO
W1_NEXT:
s_sub_u32 s57,46080,s57
v_swap_b32 v16,v18
v_swap_b32 v17,v19
s_mov_b32 s51,s53
s_mov_b32 s52,s54
s_waitcnt vmcnt(2)
v_cmp_eq_u32 vcc,0,v3
s_and_b64 vcc,vcc,s[76:77]
s_cselect_b32 s37,2147483648,0
s_cmp_lt_u32 s32,128
s_cselect_b32 s37,s37,2147483648
W1_GO:
s_barrier
ds_read_b128 v[24:27],v16 offset:0
ds_read_b128 v[28:31],v17 offset:0
ds_read_b128 v[32:35],v16 offset:10240
ds_read_b128 v[36:39],v17 offset:10240
ds_read_b128 v[40:43],v16 offset:20480
ds_read_b128 v[44:47],v17 offset:20480
ds_read_b128 v[48:51],v16 offset:30720
s_waitcnt lgkmcnt(6)
v_mfma_f32_32x32x16_bf16 v[56:71],a[0:3],v[24:27],0
ds_read_b128 v[52:55],v17 offset:30720
s_lshl_b32 s60,s51,6
s_add_u32 s60,s60,s52
s_mul_i32 s60,s60,40960
s_waitcnt lgkmcnt(6)
v_mfma_f32_32x32x16_bf16 v[56:71],a[4:7],v[28:31],v[56:71]
ds_read_b128 v[24:27],v16 offset:2048
s_lshl_b32 s61,s56,11
s_add_u32 s60,s60,s61
s_add_u32 s60,s60,218365952
s_waitcnt lgkmcnt(5)
v_mfma_f32_32x32x16_bf16 v[56:71],a[40:43],v[32:35],v[56:71]
ds_read_b128 v[28:31],v17 offset:2048
buffer_load_dword v73,v72,s[8:11],s60 offen sc1
s_add_u32 s65,s32,1
s_or_b32 s65,s65,s37
v_mfma_f32_32x32x16_bf16 v[56:71],a[44:47],v[36:39],v[56:71]
ds_read_b128 v[32:35],v16 offset:12288
v_mov_b32 v23,s65
ds_max_i32 v22,v23
s_waitcnt lgkmcnt(6)
v_mfma_f32_32x32x16_bf16 v[56:71],a[80:83],v[40:43],v[56:71]
ds_read_b128 v[36:39],v17 offset:12288
s_sub_u32 s66,46080,s57
s_lshl_b32 s60,s33,6
s_add_u32 s60,s60,s34
s_mul_i32 s60,s60,46080
v_mfma_f32_32x32x16_bf16 v[56:71],a[84:87],v[44:47],v[56:71]
ds_read_b128 v[40:43],v16 offset:22528
s_add_u32 s60,s60,s37
s_add_u32 s60,s60,223608832
s_mov_b32 s67,s60
s_waitcnt lgkmcnt(6)
v_mfma_f32_32x32x16_bf16 v[56:71],a[120:123],v[48:51],v[56:71]
ds_read_b128 v[44:47],v17 offset:22528
s_mul_i32 s61,s46,10240
s_add_u32 s60,s60,s61
s_add_u32 s61,s61,s66
s_add_u32 m0,s61,0
v_mfma_f32_32x32x16_bf16 v[56:71],a[124:127],v[52:55],v[56:71]
ds_read_b128 v[48:51],v16 offset:32768
s_add_u32 s63,s60,0
buffer_load_dwordx4 v1,s[8:11],s63 offen sc1 lds
s_waitcnt lgkmcnt(6)
v_mfma_f32_32x32x16_bf16 v[56:71],a[8:11],v[24:27],v[56:71]
ds_read_b128 v[52:55],v17 offset:32768
s_mul_i32 s71,s51,9
s_and_b32 s72,s52,7
s_add_u32 s71,s71,s72
s_mul_i32 s71,s71,40960
v_mfma_f32_32x32x16_bf16 v[56:71],a[12:15],v[28:31],v[56:71]
ds_read_b128 v[24:27],v16 offset:4096
s_add_u32 s71,s71,237371392
s_lshl_b32 s72,s56,11
s_add_u32 s71,s71,s72
s_waitcnt lgkmcnt(5)
v_mfma_f32_32x32x16_bf16 v[56:71],a[48:51],v[32:35],v[56:71]
ds_read_b128 v[28:31],v17 offset:4096
buffer_load_dword v3,v2,s[8:11],s35 offen sc1
s_lshl_b32 s82,s51,6
v_mfma_f32_32x32x16_bf16 v[56:71],a[52:55],v[36:39],v[56:71]
ds_read_b128 v[32:35],v16 offset:14336
buffer_load_dwordx4 v1,s[8:11],s63 offen offset:1024 sc1 lds
s_add_u32 s82,s82,s52
s_waitcnt lgkmcnt(5)
v_mfma_f32_32x32x16_bf16 v[56:71],a[88:91],v[40:43],v[56:71]
ds_read_b128 v[36:39],v17 offset:14336
s_waitcnt vmcnt(4)
s_mov_b64 exec,1
s_cmp_lg_u32 s49,0
s_cbranch_scc0 ls_274
buffer_store_dword v5,v1,s[8:11],s59 offen sc1
s_branch ls_275
ls_274:
buffer_store_dword v5,v1,s[8:11],s59 offen
ls_275:
s_mov_b64 exec,-1
s_mov_b32 s59,2147483648
v_mfma_f32_32x32x16_bf16 v[56:71],a[92:95],v[44:47],v[56:71]
ds_read_b128 v[40:43],v16 offset:24576
s_lshl_b32 s82,s82,9
s_add_u32 s82,s82,458752
s_lshl_b32 s70,s56,2
s_waitcnt lgkmcnt(5)
v_mfma_f32_32x32x16_bf16 v[56:71],a[128:131],v[48:51],v[56:71]
ds_read_b128 v[44:47],v17 offset:24576
buffer_load_dwordx4 v1,s[8:11],s63 offen offset:2048 sc1 lds
s_add_u32 s82,s82,s70
v_mfma_f32_32x32x16_bf16 v[56:71],a[132:135],v[52:55],v[56:71]
ds_read_b128 v[48:51],v16 offset:34816
s_waitcnt lgkmcnt(5)
v_mfma_f32_32x32x16_bf16 v[56:71],a[16:19],v[24:27],v[56:71]
ds_read_b128 v[52:55],v17 offset:34816
s_barrier
v_mfma_f32_32x32x16_bf16 v[56:71],a[20:23],v[28:31],v[56:71]
ds_read_b128 v[24:27],v16 offset:6144
v_add_u32 v183,s57,v182
buffer_load_dwordx4 v1,s[8:11],s63 offen offset:3072 sc1 lds
s_waitcnt lgkmcnt(5)
v_mfma_f32_32x32x16_bf16 v[56:71],a[56:59],v[32:35],v[56:71]
ds_read_b128 v[28:31],v17 offset:6144
ds_read_b64 v[180:181],v183
s_add_u32 m0,s61,4096
s_add_u32 s63,s60,4096
v_mfma_f32_32x32x16_bf16 v[56:71],a[60:63],v[36:39],v[56:71]
ds_read_b128 v[32:35],v16 offset:16384
s_waitcnt lgkmcnt(6)
v_mfma_f32_32x32x16_bf16 v[56:71],a[96:99],v[40:43],v[56:71]
ds_read_b128 v[36:39],v17 offset:16384
buffer_load_dwordx4 v1,s[8:11],s63 offen sc1 lds
v_mfma_f32_32x32x16_bf16 v[56:71],a[100:103],v[44:47],v[56:71]
ds_read_b128 v[40:43],v16 offset:26624
s_waitcnt lgkmcnt(6)
v_mfma_f32_32x32x16_bf16 v[56:71],a[136:139],v[48:51],v[56:71]
ds_read_b128 v[44:47],v17 offset:26624
v_mfma_f32_32x32x16_bf16 v[56:71],a[140:143],v[52:55],v[56:71]
ds_read_b128 v[48:51],v16 offset:36864
buffer_load_dwordx4 v1,s[8:11],s63 offen offset:1024 sc1 lds
s_waitcnt lgkmcnt(6)
v_mfma_f32_32x32x16_bf16 v[56:71],a[24:27],v[24:27],v[56:71]
ds_read_b128 v[52:55],v17 offset:36864
v_mfma_f32_32x32x16_bf16 v[56:71],a[28:31],v[28:31],v[56:71]
ds_read_b128 v[24:27],v16 offset:8192
s_waitcnt lgkmcnt(5)
v_mfma_f32_32x32x16_bf16 v[56:71],a[64:67],v[32:35],v[56:71]
ds_read_b128 v[28:31],v17 offset:8192
buffer_load_dwordx4 v1,s[8:11],s63 offen offset:2048 sc1 lds
v_mfma_f32_32x32x16_bf16 v[56:71],a[68:71],v[36:39],v[56:71]
ds_read_b128 v[32:35],v16 offset:18432
s_waitcnt lgkmcnt(5)
v_mfma_f32_32x32x16_bf16 v[56:71],a[104:107],v[40:43],v[56:71]
ds_read_b128 v[36:39],v17 offset:18432
v_mfma_f32_32x32x16_bf16 v[56:71],a[108:111],v[44:47],v[56:71]
ds_read_b128 v[40:43],v16 offset:28672
buffer_load_dwordx4 v1,s[8:11],s63 offen offset:3072 sc1 lds
s_add_u32 m0,s61,8192
s_waitcnt lgkmcnt(5)
v_mfma_f32_32x32x16_bf16 v[56:71],a[144:147],v[48:51],v[56:71]
ds_read_b128 v[44:47],v17 offset:28672
s_add_u32 s63,s60,8192
v_mfma_f32_32x32x16_bf16 v[56:71],a[148:151],v[52:55],v[56:71]
ds_read_b128 v[48:51],v16 offset:38912
s_waitcnt lgkmcnt(5)
v_mfma_f32_32x32x16_bf16 v[56:71],a[32:35],v[24:27],v[56:71]
ds_read_b128 v[52:55],v17 offset:38912
buffer_load_dwordx4 v1,s[8:11],s63 offen sc1 lds
v_mfma_f32_32x32x16_bf16 v[56:71],a[36:39],v[28:31],v[56:71]
s_waitcnt lgkmcnt(4)
v_mfma_f32_32x32x16_bf16 v[56:71],a[72:75],v[32:35],v[56:71]
v_mfma_f32_32x32x16_bf16 v[56:71],a[76:79],v[36:39],v[56:71]
buffer_load_dwordx4 v1,s[8:11],s63 offen offset:1024 sc1 lds
s_add_u32 m0,s66,40960
s_add_u32 s63,s67,40960
s_waitcnt lgkmcnt(2)
v_mfma_f32_32x32x16_bf16 v[56:71],a[112:115],v[40:43],v[56:71]
v_mfma_f32_32x32x16_bf16 v[56:71],a[116:119],v[44:47],v[56:71]
s_waitcnt lgkmcnt(0)
v_mfma_f32_32x32x16_bf16 v[56:71],a[152:155],v[48:51],v[56:71]
buffer_load_dwordx4 v1,s[8:11],s63 offen sc1 lds
s_add_u32 s62,s32,1
s_min_u32 s62,s62,127
s_sub_u32 s60,s62,15
s_lshr_b32 s41,s60,1
v_mfma_f32_32x32x16_bf16 v[56:71],a[156:159],v[52:55],v[56:71]
s_and_b32 s40,s60,1
s_cmp_eq_u32 s40,0
s_cselect_b32 s61,15,0
s_add_u32 s41,s41,s61
s_sub_u32 s61,s60,49
s_cmp_ge_u32 s60,98
s_cselect_b32 s41,s61,s41
s_cselect_b32 s40,1,s40
s_cmp_lt_u32 s62,15
s_cselect_b32 s41,s62,s41
s_cselect_b32 s40,0,s40
s_lshl_b32 s42,s40,6
s_add_u32 s42,s42,s41
s_lshl_b32 s42,s42,9
s_add_u32 s42,s42,393216
s_cmp_lt_u32 s41,7
s_cselect_b64 s[80:81],s[78:79],-1
s_cmp_eq_u32 s37,0
s_cbranch_scc0 sec_278
s_mov_b32 s35,s42
buffer_load_dword v3,v2,s[8:11],s35 offen sc1
s_mov_b32 s53,s33
s_mov_b32 s54,s34
s_add_u32 s32,s32,1
s_mov_b32 s33,s40
s_mov_b32 s34,s41
s_mov_b64 s[76:77],s[80:81]
s_nop 2
ep_276:
v_pk_fma_f32 v[56:57],v[144:145],v[180:181],v[56:57] op_sel_hi:[1,0,1] neg_lo:[0,1,0] neg_hi:[0,1,0]
v_pk_fma_f32 v[58:59],v[146:147],v[180:181],v[58:59] op_sel_hi:[1,0,1] neg_lo:[0,1,0] neg_hi:[0,1,0]
v_pk_fma_f32 v[60:61],v[148:149],v[180:181],v[60:61] op_sel_hi:[1,0,1] neg_lo:[0,1,0] neg_hi:[0,1,0]
v_pk_fma_f32 v[62:63],v[150:151],v[180:181],v[62:63] op_sel_hi:[1,0,1] neg_lo:[0,1,0] neg_hi:[0,1,0]
v_pk_fma_f32 v[64:65],v[152:153],v[180:181],v[64:65] op_sel_hi:[1,0,1] neg_lo:[0,1,0] neg_hi:[0,1,0]
v_pk_fma_f32 v[66:67],v[154:155],v[180:181],v[66:67] op_sel_hi:[1,0,1] neg_lo:[0,1,0] neg_hi:[0,1,0]
v_pk_fma_f32 v[68:69],v[156:157],v[180:181],v[68:69] op_sel_hi:[1,0,1] neg_lo:[0,1,0] neg_hi:[0,1,0]
v_pk_fma_f32 v[70:71],v[158:159],v[180:181],v[70:71] op_sel_hi:[1,0,1] neg_lo:[0,1,0] neg_hi:[0,1,0]
v_pk_mul_f32 v[56:57],v[56:57],v[180:181] op_sel:[0,1] op_sel_hi:[1,1]
v_pk_mul_f32 v[58:59],v[58:59],v[180:181] op_sel:[0,1] op_sel_hi:[1,1]
v_pk_mul_f32 v[60:61],v[60:61],v[180:181] op_sel:[0,1] op_sel_hi:[1,1]
v_pk_mul_f32 v[62:63],v[62:63],v[180:181] op_sel:[0,1] op_sel_hi:[1,1]
v_pk_mul_f32 v[64:65],v[64:65],v[180:181] op_sel:[0,1] op_sel_hi:[1,1]
v_pk_mul_f32 v[66:67],v[66:67],v[180:181] op_sel:[0,1] op_sel_hi:[1,1]
v_pk_mul_f32 v[68:69],v[68:69],v[180:181] op_sel:[0,1] op_sel_hi:[1,1]
v_pk_mul_f32 v[70:71],v[70:71],v[180:181] op_sel:[0,1] op_sel_hi:[1,1]
v_pk_mul_f32 v[124:125],v[56:57],v[56:57]
v_pk_mul_f32 v[126:127],v[58:59],v[58:59]
v_pk_mul_f32 v[128:129],v[60:61],v[60:61]
v_pk_mul_f32 v[130:131],v[62:63],v[62:63]
v_pk_mul_f32 v[132:133],v[64:65],v[64:65]
v_pk_mul_f32 v[134:135],v[66:67],v[66:67]
v_pk_mul_f32 v[136:137],v[68:69],v[68:69]
v_pk_mul_f32 v[138:139],v[70:71],v[70:71]
v_pk_fma_f32 v[124:125],v[124:125],v[112:113],v[112:113] op_sel:[0,1,0] op_sel_hi:[1,1,0]
v_pk_fma_f32 v[126:127],v[126:127],v[112:113],v[112:113] op_sel:[0,1,0] op_sel_hi:[1,1,0]
v_pk_fma_f32 v[128:129],v[128:129],v[112:113],v[112:113] op_sel:[0,1,0] op_sel_hi:[1,1,0]
v_pk_fma_f32 v[130:131],v[130:131],v[112:113],v[112:113] op_sel:[0,1,0] op_sel_hi:[1,1,0]
v_pk_fma_f32 v[132:133],v[132:133],v[112:113],v[112:113] op_sel:[0,1,0] op_sel_hi:[1,1,0]
v_pk_fma_f32 v[134:135],v[134:135],v[112:113],v[112:113] op_sel:[0,1,0] op_sel_hi:[1,1,0]
v_pk_fma_f32 v[136:137],v[136:137],v[112:113],v[112:113] op_sel:[0,1,0] op_sel_hi:[1,1,0]
v_pk_fma_f32 v[138:139],v[138:139],v[112:113],v[112:113] op_sel:[0,1,0] op_sel_hi:[1,1,0]
v_pk_mul_f32 v[124:125],v[124:125],v[56:57]
v_pk_mul_f32 v[126:127],v[126:127],v[58:59]
v_pk_mul_f32 v[128:129],v[128:129],v[60:61]
v_pk_mul_f32 v[130:131],v[130:131],v[62:63]
v_pk_mul_f32 v[132:133],v[132:133],v[64:65]
v_pk_mul_f32 v[134:135],v[134:135],v[66:67]
v_pk_mul_f32 v[136:137],v[136:137],v[68:69]
v_pk_mul_f32 v[138:139],v[138:139],v[70:71]
v_exp_f32 v124,v124
v_exp_f32 v125,v125
v_exp_f32 v126,v126
v_exp_f32 v127,v127
v_exp_f32 v128,v128
v_exp_f32 v129,v129
v_exp_f32 v130,v130
v_exp_f32 v131,v131
v_exp_f32 v132,v132
v_exp_f32 v133,v133
v_exp_f32 v134,v134
v_exp_f32 v135,v135
v_exp_f32 v136,v136
v_exp_f32 v137,v137
v_exp_f32 v138,v138
v_exp_f32 v139,v139
v_pk_add_f32 v[124:125],v[124:125],1.0 op_sel_hi:[1,0]
v_pk_add_f32 v[126:127],v[126:127],1.0 op_sel_hi:[1,0]
v_pk_add_f32 v[128:129],v[128:129],1.0 op_sel_hi:[1,0]
v_pk_add_f32 v[130:131],v[130:131],1.0 op_sel_hi:[1,0]
v_pk_add_f32 v[132:133],v[132:133],1.0 op_sel_hi:[1,0]
v_pk_add_f32 v[134:135],v[134:135],1.0 op_sel_hi:[1,0]
v_pk_add_f32 v[136:137],v[136:137],1.0 op_sel_hi:[1,0]
v_pk_add_f32 v[138:139],v[138:139],1.0 op_sel_hi:[1,0]
v_rcp_f32 v124,v124
v_rcp_f32 v125,v125
v_rcp_f32 v126,v126
v_rcp_f32 v127,v127
v_rcp_f32 v128,v128
v_rcp_f32 v129,v129
v_rcp_f32 v130,v130
v_rcp_f32 v131,v131
v_rcp_f32 v132,v132
v_rcp_f32 v133,v133
v_rcp_f32 v134,v134
v_rcp_f32 v135,v135
v_rcp_f32 v136,v136
v_rcp_f32 v137,v137
v_rcp_f32 v138,v138
v_rcp_f32 v139,v139
v_pk_mul_f32 v[56:57],v[56:57],v[124:125]
v_pk_mul_f32 v[58:59],v[58:59],v[126:127]
v_pk_mul_f32 v[60:61],v[60:61],v[128:129]
v_pk_mul_f32 v[62:63],v[62:63],v[130:131]
v_pk_mul_f32 v[64:65],v[64:65],v[132:133]
v_pk_mul_f32 v[66:67],v[66:67],v[134:135]
v_pk_mul_f32 v[68:69],v[68:69],v[136:137]
v_pk_mul_f32 v[70:71],v[70:71],v[138:139]
v_cvt_pk_bf16_f32 v116,v56,v57
v_cvt_pk_bf16_f32 v117,v58,v59
v_cvt_pk_bf16_f32 v118,v60,v61
v_cvt_pk_bf16_f32 v119,v62,v63
v_cvt_pk_bf16_f32 v120,v64,v65
v_cvt_pk_bf16_f32 v121,v66,v67
v_cvt_pk_bf16_f32 v122,v68,v69
v_cvt_pk_bf16_f32 v123,v70,v71
s_cmp_lg_u32 s49,0
s_cbranch_scc0 ls_279
buffer_store_dwordx4 v[116:119],v20,s[8:11],s71 offen sc1
buffer_store_dwordx4 v[120:123],v21,s[8:11],s71 offen sc1
s_branch ls_280
ls_279:
buffer_store_dwordx4 v[116:119],v20,s[8:11],s71 offen
buffer_store_dwordx4 v[120:123],v21,s[8:11],s71 offen
ls_280:
s_mov_b32 s59,s82
s_cmp_eq_u32 s37,0
s_cbranch_scc1 W1_NEXT
s_waitcnt vmcnt(2)
v_cmp_eq_u32 vcc,0,v3
s_and_b64 vcc,vcc,s[76:77]
s_cselect_b32 s37,2147483648,0
s_cmp_lt_u32 s32,128
s_cselect_b32 s37,s37,2147483648
s_cmp_eq_u32 s37,0
s_cbranch_scc1 W1_COLD2
s_waitcnt vmcnt(0)
s_mov_b64 exec,1
s_cmp_lg_u32 s49,0
s_cbranch_scc0 ls_281
buffer_store_dword v5,v1,s[8:11],s59 offen sc1
s_branch ls_282
ls_281:
buffer_store_dword v5,v1,s[8:11],s59 offen
ls_282:
s_mov_b64 exec,-1
s_mov_b32 s59,2147483648
s_cmp_lt_u32 s32,128
s_cbranch_scc1 W1_COLD
s_branch W1_END
sec_278:
s_waitcnt vmcnt(11)
v_cmp_eq_u32 vcc,0,v3
s_and_b64 vcc,vcc,s[76:77]
s_cselect_b32 s37,2147483648,0
s_cmp_lt_u32 s32,128
s_cselect_b32 s37,s37,2147483648
s_cmp_lg_u32 s37,0
s_cbranch_scc1 nr_277
s_add_u32 s65,s32,1
s_or_b32 s65,s65,s37
v_mov_b32 v23,s65
ds_max_i32 v22,v23
s_sub_u32 s66,46080,s57
s_lshl_b32 s60,s33,6
s_add_u32 s60,s60,s34
s_mul_i32 s60,s60,46080
s_add_u32 s60,s60,s37
s_add_u32 s60,s60,223608832
s_mov_b32 s67,s60
s_mul_i32 s61,s46,10240
s_add_u32 s60,s60,s61
s_add_u32 s61,s61,s66
s_add_u32 m0,s61,0
s_add_u32 s63,s60,0
buffer_load_dwordx4 v1,s[8:11],s63 offen sc1 lds
v_pk_fma_f32 v[56:57],v[144:145],v[180:181],v[56:57] op_sel_hi:[1,0,1] neg_lo:[0,1,0] neg_hi:[0,1,0]
v_pk_fma_f32 v[58:59],v[146:147],v[180:181],v[58:59] op_sel_hi:[1,0,1] neg_lo:[0,1,0] neg_hi:[0,1,0]
v_pk_fma_f32 v[60:61],v[148:149],v[180:181],v[60:61] op_sel_hi:[1,0,1] neg_lo:[0,1,0] neg_hi:[0,1,0]
v_pk_fma_f32 v[62:63],v[150:151],v[180:181],v[62:63] op_sel_hi:[1,0,1] neg_lo:[0,1,0] neg_hi:[0,1,0]
v_pk_fma_f32 v[64:65],v[152:153],v[180:181],v[64:65] op_sel_hi:[1,0,1] neg_lo:[0,1,0] neg_hi:[0,1,0]
v_pk_fma_f32 v[66:67],v[154:155],v[180:181],v[66:67] op_sel_hi:[1,0,1] neg_lo:[0,1,0] neg_hi:[0,1,0]
v_pk_fma_f32 v[68:69],v[156:157],v[180:181],v[68:69] op_sel_hi:[1,0,1] neg_lo:[0,1,0] neg_hi:[0,1,0]
buffer_load_dwordx4 v1,s[8:11],s63 offen offset:1024 sc1 lds
v_pk_fma_f32 v[70:71],v[158:159],v[180:181],v[70:71] op_sel_hi:[1,0,1] neg_lo:[0,1,0] neg_hi:[0,1,0]
v_pk_mul_f32 v[56:57],v[56:57],v[180:181] op_sel:[0,1] op_sel_hi:[1,1]
v_pk_mul_f32 v[58:59],v[58:59],v[180:181] op_sel:[0,1] op_sel_hi:[1,1]
v_pk_mul_f32 v[60:61],v[60:61],v[180:181] op_sel:[0,1] op_sel_hi:[1,1]
v_pk_mul_f32 v[62:63],v[62:63],v[180:181] op_sel:[0,1] op_sel_hi:[1,1]
v_pk_mul_f32 v[64:65],v[64:65],v[180:181] op_sel:[0,1] op_sel_hi:[1,1]
v_pk_mul_f32 v[66:67],v[66:67],v[180:181] op_sel:[0,1] op_sel_hi:[1,1]
buffer_load_dwordx4 v1,s[8:11],s63 offen offset:2048 sc1 lds
v_pk_mul_f32 v[68:69],v[68:69],v[180:181] op_sel:[0,1] op_sel_hi:[1,1]
v_pk_mul_f32 v[70:71],v[70:71],v[180:181] op_sel:[0,1] op_sel_hi:[1,1]
v_pk_mul_f32 v[124:125],v[56:57],v[56:57]
v_pk_mul_f32 v[126:127],v[58:59],v[58:59]
v_pk_mul_f32 v[128:129],v[60:61],v[60:61]
v_pk_mul_f32 v[130:131],v[62:63],v[62:63]
v_pk_mul_f32 v[132:133],v[64:65],v[64:65]
buffer_load_dwordx4 v1,s[8:11],s63 offen offset:3072 sc1 lds
v_pk_mul_f32 v[134:135],v[66:67],v[66:67]
v_pk_mul_f32 v[136:137],v[68:69],v[68:69]
v_pk_mul_f32 v[138:139],v[70:71],v[70:71]
v_pk_fma_f32 v[124:125],v[124:125],v[112:113],v[112:113] op_sel:[0,1,0] op_sel_hi:[1,1,0]
v_pk_fma_f32 v[126:127],v[126:127],v[112:113],v[112:113] op_sel:[0,1,0] op_sel_hi:[1,1,0]
v_pk_fma_f32 v[128:129],v[128:129],v[112:113],v[112:113] op_sel:[0,1,0] op_sel_hi:[1,1,0]
v_pk_fma_f32 v[130:131],v[130:131],v[112:113],v[112:113] op_sel:[0,1,0] op_sel_hi:[1,1,0]
s_add_u32 m0,s61,4096
s_add_u32 s63,s60,4096
buffer_load_dwordx4 v1,s[8:11],s63 offen sc1 lds
v_pk_fma_f32 v[132:133],v[132:133],v[112:113],v[112:113] op_sel:[0,1,0] op_sel_hi:[1,1,0]
v_pk_fma_f32 v[134:135],v[134:135],v[112:113],v[112:113] op_sel:[0,1,0] op_sel_hi:[1,1,0]
v_pk_fma_f32 v[136:137],v[136:137],v[112:113],v[112:113] op_sel:[0,1,0] op_sel_hi:[1,1,0]
v_pk_fma_f32 v[138:139],v[138:139],v[112:113],v[112:113] op_sel:[0,1,0] op_sel_hi:[1,1,0]
v_pk_mul_f32 v[124:125],v[124:125],v[56:57]
v_pk_mul_f32 v[126:127],v[126:127],v[58:59]
v_pk_mul_f32 v[128:129],v[128:129],v[60:61]
buffer_load_dwordx4 v1,s[8:11],s63 offen offset:1024 sc1 lds
v_pk_mul_f32 v[130:131],v[130:131],v[62:63]
v_pk_mul_f32 v[132:133],v[132:133],v[64:65]
v_pk_mul_f32 v[134:135],v[134:135],v[66:67]
v_pk_mul_f32 v[136:137],v[136:137],v[68:69]
v_pk_mul_f32 v[138:139],v[138:139],v[70:71]
v_exp_f32 v124,v124
v_exp_f32 v125,v125
buffer_load_dwordx4 v1,s[8:11],s63 offen offset:2048 sc1 lds
v_exp_f32 v126,v126
v_exp_f32 v127,v127
v_exp_f32 v128,v128
v_exp_f32 v129,v129
v_exp_f32 v130,v130
v_exp_f32 v131,v131
v_exp_f32 v132,v132
buffer_load_dwordx4 v1,s[8:11],s63 offen offset:3072 sc1 lds
v_exp_f32 v133,v133
v_exp_f32 v134,v134
v_exp_f32 v135,v135
v_exp_f32 v136,v136
v_exp_f32 v137,v137
v_exp_f32 v138,v138
v_exp_f32 v139,v139
s_add_u32 m0,s61,8192
s_add_u32 s63,s60,8192
buffer_load_dwordx4 v1,s[8:11],s63 offen sc1 lds
v_pk_add_f32 v[124:125],v[124:125],1.0 op_sel_hi:[1,0]
v_pk_add_f32 v[126:127],v[126:127],1.0 op_sel_hi:[1,0]
v_pk_add_f32 v[128:129],v[128:129],1.0 op_sel_hi:[1,0]
v_pk_add_f32 v[130:131],v[130:131],1.0 op_sel_hi:[1,0]
v_pk_add_f32 v[132:133],v[132:133],1.0 op_sel_hi:[1,0]
v_pk_add_f32 v[134:135],v[134:135],1.0 op_sel_hi:[1,0]
v_pk_add_f32 v[136:137],v[136:137],1.0 op_sel_hi:[1,0]
buffer_load_dwordx4 v1,s[8:11],s63 offen offset:1024 sc1 lds
v_pk_add_f32 v[138:139],v[138:139],1.0 op_sel_hi:[1,0]
v_rcp_f32 v124,v124
v_rcp_f32 v125,v125
v_rcp_f32 v126,v126
v_rcp_f32 v127,v127
v_rcp_f32 v128,v128
v_rcp_f32 v129,v129
s_add_u32 m0,s66,40960
s_add_u32 s63,s67,40960
buffer_load_dwordx4 v1,s[8:11],s63 offen sc1 lds
v_rcp_f32 v130,v130
v_rcp_f32 v131,v131
v_rcp_f32 v132,v132
v_rcp_f32 v133,v133
v_rcp_f32 v134,v134
v_rcp_f32 v135,v135
v_rcp_f32 v136,v136
s_mov_b32 s35,s42
buffer_load_dword v3,v2,s[8:11],s35 offen sc1
s_mov_b32 s53,s33
s_mov_b32 s54,s34
s_add_u32 s32,s32,1
s_mov_b32 s33,s40
s_mov_b32 s34,s41
s_mov_b64 s[76:77],s[80:81]
v_rcp_f32 v137,v137
v_rcp_f32 v138,v138
v_rcp_f32 v139,v139
v_pk_mul_f32 v[56:57],v[56:57],v[124:125]
v_pk_mul_f32 v[58:59],v[58:59],v[126:127]
v_pk_mul_f32 v[60:61],v[60:61],v[128:129]
v_pk_mul_f32 v[62:63],v[62:63],v[130:131]
v_pk_mul_f32 v[64:65],v[64:65],v[132:133]
v_pk_mul_f32 v[66:67],v[66:67],v[134:135]
v_pk_mul_f32 v[68:69],v[68:69],v[136:137]
v_pk_mul_f32 v[70:71],v[70:71],v[138:139]
v_cvt_pk_bf16_f32 v116,v56,v57
v_cvt_pk_bf16_f32 v117,v58,v59
v_cvt_pk_bf16_f32 v118,v60,v61
v_cvt_pk_bf16_f32 v119,v62,v63
v_cvt_pk_bf16_f32 v120,v64,v65
v_cvt_pk_bf16_f32 v121,v66,v67
v_cvt_pk_bf16_f32 v122,v68,v69
v_cvt_pk_bf16_f32 v123,v70,v71
s_cmp_lg_u32 s49,0
s_cbranch_scc0 ls_283
buffer_store_dwordx4 v[116:119],v20,s[8:11],s71 offen sc1
buffer_store_dwordx4 v[120:123],v21,s[8:11],s71 offen sc1
s_branch ls_284
ls_283:
buffer_store_dwordx4 v[116:119],v20,s[8:11],s71 offen
buffer_store_dwordx4 v[120:123],v21,s[8:11],s71 offen
ls_284:
s_mov_b32 s59,s82
s_branch W1_NEXT
nr_277:
buffer_load_dword v3,v2,s[8:11],s35 offen sc1
s_branch ep_276
W1_END:
s_endpgm
ROLE_W2:
v_lshlrev_b32 v1,4,v0
v_mov_b32 v5,1
s_lshl_b32 s56,s48,2
s_add_u32 s56,s56,s46
v_bfe_u32 v6,v0,2,2
v_lshrrev_b32 v7,4,v0
v_add_u32 v7,v6,v7
v_and_b32 v7,3,v7
v_and_b32 v15,3,v0
v_lshlrev_b32 v15,4,v15
v_lshl_add_u32 v15,v7,6,v15
v_lshl_add_u32 v15,v6,8,v15
v_lshrrev_b32 v6,5,v0
v_bfe_u32 v7,v0,4,1
v_lshlrev_b32 v16,10,v7
v_lshl_add_u32 v16,v6,8,v16
v_and_b32 v6,15,v0
v_lshl_add_u32 v16,v6,4,v16
v_add_u32 v18,40960,v16
v_lshrrev_b32 v6,5,v0
v_bfe_u32 v7,v0,4,1
v_lshlrev_b32 v20,10,v7
v_lshl_add_u32 v20,v6,8,v20
v_and_b32 v6,15,v0
v_lshl_add_u32 v20,v6,4,v20
v_lshrrev_b32 v6,5,v0
v_add_u32 v6,2,v6
v_bfe_u32 v7,v0,4,1
v_lshlrev_b32 v17,10,v7
v_lshl_add_u32 v17,v6,8,v17
v_and_b32 v6,15,v0
v_lshl_add_u32 v17,v6,4,v17
v_add_u32 v19,40960,v17
v_lshrrev_b32 v6,5,v0
v_add_u32 v6,2,v6
v_bfe_u32 v7,v0,4,1
v_lshlrev_b32 v21,10,v7
v_lshl_add_u32 v21,v6,8,v21
v_and_b32 v6,15,v0
v_lshl_add_u32 v21,v6,4,v21
v_min_u32 v2,19,v0
v_lshlrev_b32 v2,2,v2
s_lshr_b32 s60,s46,1
s_add_u32 s60,s60,1
s_sub_u32 s61,32,s60
s_add_u32 s60,s60,32
s_bitcmp1_b32 s46,0
s_cselect_b32 s60,s60,s61
v_and_b32 v6,15,v0
v_add_u32 v6,s60,v6
v_lshrrev_b32 v7,5,v6
v_mul_u32_u24 v112,40960,v7
v_bfe_u32 v7,v6,4,1
v_lshl_add_u32 v112,v7,10,v112
v_and_b32 v7,15,v6
v_lshl_add_u32 v112,v7,4,v112
v_lshrrev_b32 v7,4,v0
v_lshl_add_u32 v112,v7,8,v112
v_and_b32 v6,15,v0
v_add_u32 v6,s60,v6
v_add_u32 v6,16,v6
v_lshrrev_b32 v7,5,v6
v_mul_u32_u24 v113,40960,v7
v_bfe_u32 v7,v6,4,1
v_lshl_add_u32 v113,v7,10,v113
v_and_b32 v7,15,v6
v_lshl_add_u32 v113,v7,4,v113
v_lshrrev_b32 v7,4,v0
v_lshl_add_u32 v113,v7,8,v113
v_lshrrev_b32 v6,5,v0
v_and_b32 v7,15,v0
v_lshlrev_b32 v114,3,v7
v_lshl_add_u32 v114,v6,7,v114
v_and_b32 v114,31,v0
v_lshlrev_b32 v114,3,v114
v_lshrrev_b32 v6,5,v0
v_bfe_u32 v7,v0,4,1
v_lshlrev_b32 v116,10,v7
v_bfe_u32 v7,v0,2,2
v_lshl_add_u32 v116,v7,8,v116
v_add_u32 v6,v6,v7
v_and_b32 v6,3,v6
v_lshl_add_u32 v116,v6,6,v116
v_and_b32 v6,3,v0
v_lshl_add_u32 v116,v6,4,v116
v_lshrrev_b32 v6,5,v0
v_add_u32 v6,2,v6
v_bfe_u32 v7,v0,4,1
v_lshlrev_b32 v117,10,v7
v_bfe_u32 v7,v0,2,2
v_lshl_add_u32 v117,v7,8,v117
v_add_u32 v6,v6,v7
v_and_b32 v6,3,v6
v_lshl_add_u32 v117,v6,6,v117
v_and_b32 v6,3,v0
v_lshl_add_u32 v117,v6,4,v117
v_subrev_u32 v6,40960,v112
v_cmp_gt_u32 vcc,40960,v6
s_nop 1
v_cndmask_b32 v78,0,1,vcc
v_xor_b32 v76,1,v78
v_and_b32 v74,2047,v112
v_subrev_u32 v6,40960,v113
v_cmp_gt_u32 vcc,40960,v6
s_nop 1
v_cndmask_b32 v79,0,1,vcc
v_xor_b32 v77,1,v79
v_and_b32 v75,2047,v113
s_and_b32 s68,s46,1
s_lshl_b32 s68,s68,1
s_sub_u32 s68,s68,1
v_mov_b32 v24,-1
v_mov_b32 v25,-1
v_mov_b32 v26,-1
v_mov_b32 v27,-1
s_add_u32 s60,s48,5
s_lshl2_add_u32 s60,s60,s46
s_mul_i32 s60,s60,22528
s_add_u32 s61,s60,24117248
buffer_store_dwordx4 v[24:27],v1,s[8:11],s61 offen sc1
buffer_store_dwordx4 v[24:27],v1,s[8:11],s61 offen offset:1024 sc1
buffer_store_dwordx4 v[24:27],v1,s[8:11],s61 offen offset:2048 sc1
buffer_store_dwordx4 v[24:27],v1,s[8:11],s61 offen offset:3072 sc1
s_add_u32 s61,s60,24121344
buffer_store_dwordx4 v[24:27],v1,s[8:11],s61 offen sc1
buffer_store_dwordx4 v[24:27],v1,s[8:11],s61 offen offset:1024 sc1
buffer_store_dwordx4 v[24:27],v1,s[8:11],s61 offen offset:2048 sc1
buffer_store_dwordx4 v[24:27],v1,s[8:11],s61 offen offset:3072 sc1
s_add_u32 s61,s60,24125440
buffer_store_dwordx4 v[24:27],v1,s[8:11],s61 offen sc1
buffer_store_dwordx4 v[24:27],v1,s[8:11],s61 offen offset:1024 sc1
buffer_store_dwordx4 v[24:27],v1,s[8:11],s61 offen offset:2048 sc1
buffer_store_dwordx4 v[24:27],v1,s[8:11],s61 offen offset:3072 sc1
s_add_u32 s61,s60,24129536
buffer_store_dwordx4 v[24:27],v1,s[8:11],s61 offen sc1
buffer_store_dwordx4 v[24:27],v1,s[8:11],s61 offen offset:1024 sc1
buffer_store_dwordx4 v[24:27],v1,s[8:11],s61 offen offset:2048 sc1
buffer_store_dwordx4 v[24:27],v1,s[8:11],s61 offen offset:3072 sc1
s_add_u32 s61,s60,24133632
buffer_store_dwordx4 v[24:27],v1,s[8:11],s61 offen sc1
buffer_store_dwordx4 v[24:27],v1,s[8:11],s61 offen offset:1024 sc1
buffer_store_dwordx4 v[24:27],v1,s[8:11],s61 offen offset:2048 sc1
buffer_store_dwordx4 v[24:27],v1,s[8:11],s61 offen offset:3072 sc1
s_add_u32 s61,s60,24137728
buffer_store_dwordx4 v[24:27],v1,s[8:11],s61 offen sc1
buffer_store_dwordx4 v[24:27],v1,s[8:11],s61 offen offset:1024 sc1
s_waitcnt vmcnt(0)
s_barrier
s_cmp_lg_u32 s46,0
s_cbranch_scc1 arr_285
v_mov_b32 v6,1
s_lshl_b32 s3,s49,2
v_mov_b32 v7,s3
s_mov_b64 exec,1
buffer_atomic_add v6,v7,s[12:15],0 offen sc1
s_mov_b64 exec,-1
arr_285:
s_lshl_b32 s3,s49,2
v_mov_b32 v7,s3
s_nop 1
ibw_286:
buffer_load_dword v6,v7,s[12:15],0 offen sc1
s_waitcnt vmcnt(0)
v_cmp_ne_u32 vcc,256,v6
s_nop 0
s_cbranch_vccz ok_287
s_sleep 8
s_sub_u32 s47,s47,1
s_cbranch_scc1 ABORT
s_branch ibw_286
ok_287:
s_cmp_lg_u32 s49,0
s_cbranch_scc1 ibok_288
v_and_b32 v7,7,v0
v_lshlrev_b32 v7,2,v7
buffer_load_dword v6,v7,s[12:15],0 offen offset:32 sc1
s_waitcnt vmcnt(0)
v_cmp_ne_u32 vcc,32,v6
s_nop 0
s_cbranch_vccz ibok_288
s_barrier
s_mov_b32 s49,1
s_mov_b32 s3,s2
s_load_dwordx16 s[16:31],s[0:1],0
s_load_dwordx8 s[32:39],s[0:1],64
s_waitcnt lgkmcnt(0)
s_branch DISPATCH
ibok_288:
s_lshl_b32 s58,s56,6
s_mul_i32 s63,s46,40960
s_mov_b32 s4,s34
s_mov_b32 s5,s35
s_mov_b32 s6,819200
s_mov_b32 s7,0x20000
v_lshrrev_b32 v9,2,v0
s_mov_b32 s64,1280
v_mul_lo_u32 v9,v9,s64
v_and_b32 v10,3,v0
v_lshl_add_u32 v6,v10,4,v9
s_add_u32 m0,s63,0
s_add_u32 s65,s58,0
buffer_load_dwordx4 v6,s[4:7],s65 offen lds
s_add_u32 m0,s63,1024
s_add_u32 s65,s58,20480
buffer_load_dwordx4 v6,s[4:7],s65 offen lds
s_add_u32 m0,s63,2048
s_add_u32 s65,s58,40960
buffer_load_dwordx4 v6,s[4:7],s65 offen lds
s_add_u32 m0,s63,3072
s_add_u32 s65,s58,61440
buffer_load_dwordx4 v6,s[4:7],s65 offen lds
s_add_u32 m0,s63,4096
s_add_u32 s65,s58,81920
buffer_load_dwordx4 v6,s[4:7],s65 offen lds
s_add_u32 m0,s63,5120
s_add_u32 s65,s58,102400
buffer_load_dwordx4 v6,s[4:7],s65 offen lds
s_add_u32 m0,s63,6144
s_add_u32 s65,s58,122880
buffer_load_dwordx4 v6,s[4:7],s65 offen lds
s_add_u32 m0,s63,7168
s_add_u32 s65,s58,143360
buffer_load_dwordx4 v6,s[4:7],s65 offen lds
s_add_u32 m0,s63,8192
s_add_u32 s65,s58,163840
buffer_load_dwordx4 v6,s[4:7],s65 offen lds
s_add_u32 m0,s63,9216
s_add_u32 s65,s58,184320
buffer_load_dwordx4 v6,s[4:7],s65 offen lds
s_add_u32 m0,s63,10240
s_add_u32 s65,s58,204800
buffer_load_dwordx4 v6,s[4:7],s65 offen lds
s_add_u32 m0,s63,11264
s_add_u32 s65,s58,225280
buffer_load_dwordx4 v6,s[4:7],s65 offen lds
s_add_u32 m0,s63,12288
s_add_u32 s65,s58,245760
buffer_load_dwordx4 v6,s[4:7],s65 offen lds
s_add_u32 m0,s63,13312
s_add_u32 s65,s58,266240
buffer_load_dwordx4 v6,s[4:7],s65 offen lds
s_add_u32 m0,s63,14336
s_add_u32 s65,s58,286720
buffer_load_dwordx4 v6,s[4:7],s65 offen lds
s_add_u32 m0,s63,15360
s_add_u32 s65,s58,307200
buffer_load_dwordx4 v6,s[4:7],s65 offen lds
s_add_u32 m0,s63,16384
s_add_u32 s65,s58,327680
buffer_load_dwordx4 v6,s[4:7],s65 offen lds
s_add_u32 m0,s63,17408
s_add_u32 s65,s58,348160
buffer_load_dwordx4 v6,s[4:7],s65 offen lds
s_add_u32 m0,s63,18432
s_add_u32 s65,s58,368640
buffer_load_dwordx4 v6,s[4:7],s65 offen lds
s_add_u32 m0,s63,19456
s_add_u32 s65,s58,389120
buffer_load_dwordx4 v6,s[4:7],s65 offen lds
s_add_u32 m0,s63,20480
s_add_u32 s65,s58,409600
buffer_load_dwordx4 v6,s[4:7],s65 offen lds
s_add_u32 m0,s63,21504
s_add_u32 s65,s58,430080
buffer_load_dwordx4 v6,s[4:7],s65 offen lds
s_add_u32 m0,s63,22528
s_add_u32 s65,s58,450560
buffer_load_dwordx4 v6,s[4:7],s65 offen lds
s_add_u32 m0,s63,23552
s_add_u32 s65,s58,471040
buffer_load_dwordx4 v6,s[4:7],s65 offen lds
s_add_u32 m0,s63,24576
s_add_u32 s65,s58,491520
buffer_load_dwordx4 v6,s[4:7],s65 offen lds
s_add_u32 m0,s63,25600
s_add_u32 s65,s58,512000
buffer_load_dwordx4 v6,s[4:7],s65 offen lds
s_add_u32 m0,s63,26624
s_add_u32 s65,s58,532480
buffer_load_dwordx4 v6,s[4:7],s65 offen lds
s_add_u32 m0,s63,27648
s_add_u32 s65,s58,552960
buffer_load_dwordx4 v6,s[4:7],s65 offen lds
s_add_u32 m0,s63,28672
s_add_u32 s65,s58,573440
buffer_load_dwordx4 v6,s[4:7],s65 offen lds
s_add_u32 m0,s63,29696
s_add_u32 s65,s58,593920
buffer_load_dwordx4 v6,s[4:7],s65 offen lds
s_add_u32 m0,s63,30720
s_add_u32 s65,s58,614400
buffer_load_dwordx4 v6,s[4:7],s65 offen lds
s_add_u32 m0,s63,31744
s_add_u32 s65,s58,634880
buffer_load_dwordx4 v6,s[4:7],s65 offen lds
s_add_u32 m0,s63,32768
s_add_u32 s65,s58,655360
buffer_load_dwordx4 v6,s[4:7],s65 offen lds
s_add_u32 m0,s63,33792
s_add_u32 s65,s58,675840
buffer_load_dwordx4 v6,s[4:7],s65 offen lds
s_add_u32 m0,s63,34816
s_add_u32 s65,s58,696320
buffer_load_dwordx4 v6,s[4:7],s65 offen lds
s_add_u32 m0,s63,35840
s_add_u32 s65,s58,716800
buffer_load_dwordx4 v6,s[4:7],s65 offen lds
s_add_u32 m0,s63,36864
s_add_u32 s65,s58,737280
buffer_load_dwordx4 v6,s[4:7],s65 offen lds
s_add_u32 m0,s63,37888
s_add_u32 s65,s58,757760
buffer_load_dwordx4 v6,s[4:7],s65 offen lds
s_add_u32 m0,s63,38912
s_add_u32 s65,s58,778240
buffer_load_dwordx4 v6,s[4:7],s65 offen lds
s_add_u32 m0,s63,39936
s_add_u32 s65,s58,798720
buffer_load_dwordx4 v6,s[4:7],s65 offen lds
s_waitcnt vmcnt(20)
v_bfe_u32 v9,v0,2,2
v_lshrrev_b32 v10,5,v0
v_lshl_add_u32 v9,v10,2,v9
v_mul_u32_u24 v9,64,v9
v_and_b32 v10,1,v0
v_lshl_add_u32 v9,v10,3,v9
v_bfe_u32 v10,v0,1,1
v_lshl_add_u32 v9,v10,5,v9
v_bfe_u32 v10,v0,4,1
v_lshl_add_u32 v9,v10,4,v9
v_add_u32 v7,s63,v9
ds_read_b64_tr_b16 a[0:1],v7 offset:0
ds_read_b64_tr_b16 a[2:3],v7 offset:1024
ds_read_b64_tr_b16 a[4:5],v7 offset:512
ds_read_b64_tr_b16 a[6:7],v7 offset:1536
ds_read_b64_tr_b16 a[8:9],v7 offset:2048
ds_read_b64_tr_b16 a[10:11],v7 offset:3072
ds_read_b64_tr_b16 a[12:13],v7 offset:2560
ds_read_b64_tr_b16 a[14:15],v7 offset:3584
ds_read_b64_tr_b16 a[16:17],v7 offset:4096
ds_read_b64_tr_b16 a[18:19],v7 offset:5120
ds_read_b64_tr_b16 a[20:21],v7 offset:4608
ds_read_b64_tr_b16 a[22:23],v7 offset:5632
s_waitcnt lgkmcnt(4)
ds_read_b64_tr_b16 a[24:25],v7 offset:6144
ds_read_b64_tr_b16 a[26:27],v7 offset:7168
ds_read_b64_tr_b16 a[28:29],v7 offset:6656
ds_read_b64_tr_b16 a[30:31],v7 offset:7680
ds_read_b64_tr_b16 a[32:33],v7 offset:8192
ds_read_b64_tr_b16 a[34:35],v7 offset:9216
ds_read_b64_tr_b16 a[36:37],v7 offset:8704
ds_read_b64_tr_b16 a[38:39],v7 offset:9728
ds_read_b64_tr_b16 a[40:41],v7 offset:10240
ds_read_b64_tr_b16 a[42:43],v7 offset:11264
ds_read_b64_tr_b16 a[44:45],v7 offset:10752
ds_read_b64_tr_b16 a[46:47],v7 offset:11776
s_waitcnt lgkmcnt(4)
ds_read_b64_tr_b16 a[48:49],v7 offset:12288
ds_read_b64_tr_b16 a[50:51],v7 offset:13312
ds_read_b64_tr_b16 a[52:53],v7 offset:12800
ds_read_b64_tr_b16 a[54:55],v7 offset:13824
ds_read_b64_tr_b16 a[56:57],v7 offset:14336
ds_read_b64_tr_b16 a[58:59],v7 offset:15360
ds_read_b64_tr_b16 a[60:61],v7 offset:14848
ds_read_b64_tr_b16 a[62:63],v7 offset:15872
ds_read_b64_tr_b16 a[64:65],v7 offset:16384
ds_read_b64_tr_b16 a[66:67],v7 offset:17408
ds_read_b64_tr_b16 a[68:69],v7 offset:16896
ds_read_b64_tr_b16 a[70:71],v7 offset:17920
s_waitcnt lgkmcnt(4)
ds_read_b64_tr_b16 a[72:73],v7 offset:18432
ds_read_b64_tr_b16 a[74:75],v7 offset:19456
ds_read_b64_tr_b16 a[76:77],v7 offset:18944
ds_read_b64_tr_b16 a[78:79],v7 offset:19968
s_waitcnt lgkmcnt(0)
s_waitcnt vmcnt(0)
v_bfe_u32 v9,v0,2,2
v_lshrrev_b32 v10,5,v0
v_lshl_add_u32 v9,v10,2,v9
v_mul_u32_u24 v9,64,v9
v_and_b32 v10,1,v0
v_lshl_add_u32 v9,v10,3,v9
v_bfe_u32 v10,v0,1,1
v_lshl_add_u32 v9,v10,5,v9
v_bfe_u32 v10,v0,4,1
v_lshl_add_u32 v9,v10,4,v9
v_add_u32 v7,s63,v9
ds_read_b64_tr_b16 a[80:81],v7 offset:20480
ds_read_b64_tr_b16 a[82:83],v7 offset:21504
ds_read_b64_tr_b16 a[84:85],v7 offset:20992
ds_read_b64_tr_b16 a[86:87],v7 offset:22016
ds_read_b64_tr_b16 a[88:89],v7 offset:22528
ds_read_b64_tr_b16 a[90:91],v7 offset:23552
ds_read_b64_tr_b16 a[92:93],v7 offset:23040
ds_read_b64_tr_b16 a[94:95],v7 offset:24064
ds_read_b64_tr_b16 a[96:97],v7 offset:24576
ds_read_b64_tr_b16 a[98:99],v7 offset:25600
ds_read_b64_tr_b16 a[100:101],v7 offset:25088
ds_read_b64_tr_b16 a[102:103],v7 offset:26112
s_waitcnt lgkmcnt(4)
ds_read_b64_tr_b16 a[104:105],v7 offset:26624
ds_read_b64_tr_b16 a[106:107],v7 offset:27648
ds_read_b64_tr_b16 a[108:109],v7 offset:27136
ds_read_b64_tr_b16 a[110:111],v7 offset:28160
ds_read_b64_tr_b16 a[112:113],v7 offset:28672
ds_read_b64_tr_b16 a[114:115],v7 offset:29696
ds_read_b64_tr_b16 a[116:117],v7 offset:29184
ds_read_b64_tr_b16 a[118:119],v7 offset:30208
ds_read_b64_tr_b16 a[120:121],v7 offset:30720
ds_read_b64_tr_b16 a[122:123],v7 offset:31744
ds_read_b64_tr_b16 a[124:125],v7 offset:31232
ds_read_b64_tr_b16 a[126:127],v7 offset:32256
s_waitcnt lgkmcnt(4)
ds_read_b64_tr_b16 a[128:129],v7 offset:32768
ds_read_b64_tr_b16 a[130:131],v7 offset:33792
ds_read_b64_tr_b16 a[132:133],v7 offset:33280
ds_read_b64_tr_b16 a[134:135],v7 offset:34304
ds_read_b64_tr_b16 a[136:137],v7 offset:34816
ds_read_b64_tr_b16 a[138:139],v7 offset:35840
ds_read_b64_tr_b16 a[140:141],v7 offset:35328
ds_read_b64_tr_b16 a[142:143],v7 offset:36352
ds_read_b64_tr_b16 a[144:145],v7 offset:36864
ds_read_b64_tr_b16 a[146:147],v7 offset:37888
ds_read_b64_tr_b16 a[148:149],v7 offset:37376
ds_read_b64_tr_b16 a[150:151],v7 offset:38400
s_waitcnt lgkmcnt(4)
ds_read_b64_tr_b16 a[152:153],v7 offset:38912
ds_read_b64_tr_b16 a[154:155],v7 offset:39936
ds_read_b64_tr_b16 a[156:157],v7 offset:39424
ds_read_b64_tr_b16 a[158:159],v7 offset:40448
s_waitcnt lgkmcnt(0)
s_barrier
s_mov_b32 s50,0
s_mov_b32 s32,0
s_mov_b32 s57,0
s_mov_b32 s59,2147483648
s_mov_b32 s82,2147483648
s_mov_b32 s39,2147483648
v_mov_b32 v22,83968
v_lshl_add_u32 v22,v0,2,v22
v_mov_b32 v23,0
ds_write_b32 v22,v23
s_mov_b32 s39,1600000
v_and_b32 v72,15,v0
v_lshlrev_b32 v72,7,v72
s_mul_i32 s60,s56,-1792
s_add_u32 s60,s60,40960
v_and_b32 v6,128,v72
v_add_u32 v6,s60,v6
v_cmp_lt_u32 vcc,15,v0
s_nop 1
v_cndmask_b32 v72,v72,v6,vcc
v_min_u32 v6,59,v0
v_lshlrev_b32 v6,2,v6
v_add_u32 v2,135168,v6
v_add_u32 v7,-80,v6
v_cmp_gt_u32 s[78:79],20,v0
s_nop 1
v_cndmask_b32 v2,v7,v2,s[78:79]
s_mov_b32 s51,0
s_mov_b32 s52,0
s_mul_i32 s62,s51,8
s_and_b32 s63,s52,7
s_add_u32 s62,s62,s63
s_mul_i32 s62,s62,46080
s_add_u32 s62,s62,212467712
s_lshl_b32 s63,s56,11
s_add_u32 s62,s62,s63
buffer_load_dword v73,v72,s[8:11],s62 offen sc1
s_mov_b32 s51,0
s_mov_b32 s52,1
s_mul_i32 s62,s51,8
s_and_b32 s63,s52,7
s_add_u32 s62,s62,s63
s_mul_i32 s62,s62,46080
s_add_u32 s62,s62,212467712
s_lshl_b32 s63,s56,11
s_add_u32 s62,s62,s63
buffer_load_dword v73,v72,s[8:11],s62 offen sc1
s_mov_b32 s51,0
s_mov_b32 s52,2
s_mul_i32 s62,s51,8
s_and_b32 s63,s52,7
s_add_u32 s62,s62,s63
s_mul_i32 s62,s62,46080
s_add_u32 s62,s62,212467712
s_lshl_b32 s63,s56,11
s_add_u32 s62,s62,s63
buffer_load_dword v73,v72,s[8:11],s62 offen sc1
s_mov_b32 s51,0
s_mov_b32 s52,3
s_mul_i32 s62,s51,8
s_and_b32 s63,s52,7
s_add_u32 s62,s62,s63
s_mul_i32 s62,s62,46080
s_add_u32 s62,s62,212467712
s_lshl_b32 s63,s56,11
s_add_u32 s62,s62,s63
buffer_load_dword v73,v72,s[8:11],s62 offen sc1
s_mov_b32 s51,0
s_mov_b32 s52,4
s_mul_i32 s62,s51,8
s_and_b32 s63,s52,7
s_add_u32 s62,s62,s63
s_mul_i32 s62,s62,46080
s_add_u32 s62,s62,212467712
s_lshl_b32 s63,s56,11
s_add_u32 s62,s62,s63
buffer_load_dword v73,v72,s[8:11],s62 offen sc1
s_mov_b32 s51,0
s_mov_b32 s52,5
s_mul_i32 s62,s51,8
s_and_b32 s63,s52,7
s_add_u32 s62,s62,s63
s_mul_i32 s62,s62,46080
s_add_u32 s62,s62,212467712
s_lshl_b32 s63,s56,11
s_add_u32 s62,s62,s63
buffer_load_dword v73,v72,s[8:11],s62 offen sc1
s_mov_b32 s51,0
s_mov_b32 s52,6
s_mul_i32 s62,s51,8
s_and_b32 s63,s52,7
s_add_u32 s62,s62,s63
s_mul_i32 s62,s62,46080
s_add_u32 s62,s62,212467712
s_lshl_b32 s63,s56,11
s_add_u32 s62,s62,s63
buffer_load_dword v73,v72,s[8:11],s62 offen sc1
s_mov_b32 s51,0
s_mov_b32 s52,7
s_mul_i32 s62,s51,8
s_and_b32 s63,s52,7
s_add_u32 s62,s62,s63
s_mul_i32 s62,s62,46080
s_add_u32 s62,s62,212467712
s_lshl_b32 s63,s56,11
s_add_u32 s62,s62,s63
buffer_load_dword v73,v72,s[8:11],s62 offen sc1
s_mov_b32 s51,1
s_mov_b32 s52,0
s_mul_i32 s62,s51,8
s_and_b32 s63,s52,7
s_add_u32 s62,s62,s63
s_mul_i32 s62,s62,46080
s_add_u32 s62,s62,212467712
s_lshl_b32 s63,s56,11
s_add_u32 s62,s62,s63
buffer_load_dword v73,v72,s[8:11],s62 offen sc1
s_mov_b32 s51,1
s_mov_b32 s52,1
s_mul_i32 s62,s51,8
s_and_b32 s63,s52,7
s_add_u32 s62,s62,s63
s_mul_i32 s62,s62,46080
s_add_u32 s62,s62,212467712
s_lshl_b32 s63,s56,11
s_add_u32 s62,s62,s63
buffer_load_dword v73,v72,s[8:11],s62 offen sc1
s_mov_b32 s51,1
s_mov_b32 s52,2
s_mul_i32 s62,s51,8
s_and_b32 s63,s52,7
s_add_u32 s62,s62,s63
s_mul_i32 s62,s62,46080
s_add_u32 s62,s62,212467712
s_lshl_b32 s63,s56,11
s_add_u32 s62,s62,s63
buffer_load_dword v73,v72,s[8:11],s62 offen sc1
s_mov_b32 s51,1
s_mov_b32 s52,3
s_mul_i32 s62,s51,8
s_and_b32 s63,s52,7
s_add_u32 s62,s62,s63
s_mul_i32 s62,s62,46080
s_add_u32 s62,s62,212467712
s_lshl_b32 s63,s56,11
s_add_u32 s62,s62,s63
buffer_load_dword v73,v72,s[8:11],s62 offen sc1
s_mov_b32 s51,1
s_mov_b32 s52,4
s_mul_i32 s62,s51,8
s_and_b32 s63,s52,7
s_add_u32 s62,s62,s63
s_mul_i32 s62,s62,46080
s_add_u32 s62,s62,212467712
s_lshl_b32 s63,s56,11
s_add_u32 s62,s62,s63
buffer_load_dword v73,v72,s[8:11],s62 offen sc1
s_mov_b32 s51,1
s_mov_b32 s52,5
s_mul_i32 s62,s51,8
s_and_b32 s63,s52,7
s_add_u32 s62,s62,s63
s_mul_i32 s62,s62,46080
s_add_u32 s62,s62,212467712
s_lshl_b32 s63,s56,11
s_add_u32 s62,s62,s63
buffer_load_dword v73,v72,s[8:11],s62 offen sc1
s_mov_b32 s51,1
s_mov_b32 s52,6
s_mul_i32 s62,s51,8
s_and_b32 s63,s52,7
s_add_u32 s62,s62,s63
s_mul_i32 s62,s62,46080
s_add_u32 s62,s62,212467712
s_lshl_b32 s63,s56,11
s_add_u32 s62,s62,s63
buffer_load_dword v73,v72,s[8:11],s62 offen sc1
s_mov_b32 s51,1
s_mov_b32 s52,7
s_mul_i32 s62,s51,8
s_and_b32 s63,s52,7
s_add_u32 s62,s62,s63
s_mul_i32 s62,s62,46080
s_add_u32 s62,s62,212467712
s_lshl_b32 s63,s56,11
s_add_u32 s62,s62,s63
buffer_load_dword v73,v72,s[8:11],s62 offen sc1
s_waitcnt vmcnt(0)
s_waitcnt lgkmcnt(0)
s_barrier
s_mov_b32 s83,s100
s_min_u32 s62,s32,127
s_sub_u32 s60,s62,16
s_lshr_b32 s34,s60,1
s_and_b32 s33,s60,1
s_cmp_eq_u32 s33,0
s_cselect_b32 s61,16,0
s_add_u32 s34,s34,s61
s_sub_u32 s61,s60,48
s_cmp_ge_u32 s60,96
s_cselect_b32 s34,s61,s34
s_cselect_b32 s33,1,s33
s_cmp_lt_u32 s62,16
s_cselect_b32 s34,s62,s34
s_cselect_b32 s33,0,s33
s_add_u32 s60,s34,1
s_min_u32 s60,s60,63
s_lshl_b32 s35,s33,6
s_add_u32 s35,s35,s60
s_lshl_b32 s35,s35,9
s_add_u32 s35,s35,323584
s_cmp_lt_u32 s60,8
s_cselect_b64 s[76:77],s[78:79],-1
s_sub_u32 s57,40960,s57
v_swap_b32 v16,v18
v_swap_b32 v17,v19
s_add_u32 s62,s32,1
s_min_u32 s62,s62,127
s_sub_u32 s60,s62,16
s_lshr_b32 s41,s60,1
s_and_b32 s40,s60,1
s_cmp_eq_u32 s40,0
s_cselect_b32 s61,16,0
s_add_u32 s41,s41,s61
s_sub_u32 s61,s60,48
s_cmp_ge_u32 s60,96
s_cselect_b32 s41,s61,s41
s_cselect_b32 s40,1,s40
s_cmp_lt_u32 s62,16
s_cselect_b32 s41,s62,s41
s_cselect_b32 s40,0,s40
s_add_u32 s60,s41,1
s_min_u32 s60,s60,63
s_lshl_b32 s42,s40,6
s_add_u32 s42,s42,s60
s_lshl_b32 s42,s42,9
s_add_u32 s42,s42,323584
s_cmp_lt_u32 s60,8
s_cselect_b64 s[80:81],s[78:79],-1
W2_COLD:
s_mov_b32 s37,0
fb_289:
buffer_load_dword v3,v2,s[8:11],s35 offen sc1
s_waitcnt vmcnt(0)
v_cmp_eq_u32 vcc,0,v3
s_and_b64 vcc,vcc,s[76:77]
s_cbranch_scc0 ok_290
s_sleep 1
s_sub_u32 s47,s47,1
s_cbranch_scc1 ABORT
s_branch fb_289
ok_290:
W2_COLD2:
s_sub_u32 s66,40960,s57
s_add_u32 s61,s34,s68
s_and_b32 s62,s61,7
s_cmp_lt_u32 s61,64
s_cselect_b32 s62,s62,8
s_mul_i32 s62,s62,40960
s_and_b32 s61,s34,7
s_mul_i32 s61,s61,40960
v_mad_u32_u24 v112,v76,s62,v74
v_mad_u32_u24 v112,v78,s61,v112
v_mad_u32_u24 v113,v77,s62,v75
v_mad_u32_u24 v113,v79,s61,v113
s_mov_b32 s60,s33
s_mul_i32 s60,s60,368640
s_add_u32 s60,s60,s37
s_mul_i32 s61,s46,10240
s_add_u32 s60,s60,s61
s_add_u32 s60,s60,237371392
s_add_u32 s61,s61,s66
s_add_u32 m0,s61,0
s_add_u32 s63,s60,0
buffer_load_dwordx4 v112,s[8:11],s63 offen sc1 lds
s_add_u32 m0,s61,1024
s_nop 0
buffer_load_dwordx4 v113,s[8:11],s63 offen sc1 lds
s_add_u32 m0,s61,2048
s_add_u32 s63,s60,2048
buffer_load_dwordx4 v112,s[8:11],s63 offen sc1 lds
s_add_u32 m0,s61,3072
s_nop 0
buffer_load_dwordx4 v113,s[8:11],s63 offen sc1 lds
s_add_u32 m0,s61,4096
s_add_u32 s63,s60,4096
buffer_load_dwordx4 v112,s[8:11],s63 offen sc1 lds
s_add_u32 m0,s61,5120
s_nop 0
buffer_load_dwordx4 v113,s[8:11],s63 offen sc1 lds
s_waitcnt vmcnt(5)
s_mov_b64 exec,1
s_cmp_lg_u32 s49,0
s_cbranch_scc0 ls_291
buffer_store_dword v5,v1,s[8:11],s59 offen sc1
s_branch ls_292
ls_291:
buffer_store_dword v5,v1,s[8:11],s59 offen
ls_292:
s_mov_b64 exec,-1
s_mov_b32 s59,2147483648
s_add_u32 m0,s61,6144
s_add_u32 s63,s60,6144
buffer_load_dwordx4 v112,s[8:11],s63 offen sc1 lds
s_add_u32 m0,s61,7168
s_nop 0
buffer_load_dwordx4 v113,s[8:11],s63 offen sc1 lds
s_add_u32 m0,s61,8192
s_add_u32 s63,s60,8192
buffer_load_dwordx4 v112,s[8:11],s63 offen sc1 lds
s_add_u32 m0,s61,9216
s_nop 0
buffer_load_dwordx4 v113,s[8:11],s63 offen sc1 lds
s_mov_b32 s35,s42
s_mov_b32 s53,s33
s_mov_b32 s54,s34
s_add_u32 s32,s32,1
s_mov_b32 s33,s40
s_mov_b32 s34,s41
s_mov_b64 s[76:77],s[80:81]
s_sub_u32 s57,40960,s57
v_swap_b32 v16,v18
v_swap_b32 v17,v19
s_mov_b32 s51,s53
s_mov_b32 s52,s54
s_waitcnt vmcnt(5)
s_branch W2_GO
W2_NEXT:
s_sub_u32 s57,40960,s57
v_swap_b32 v16,v18
v_swap_b32 v17,v19
s_mov_b32 s51,s53
s_mov_b32 s52,s54
s_waitcnt vmcnt(3)
W2_GO:
s_barrier
ds_read_b128 v[24:27],v16 offset:0
ds_read_b128 v[28:31],v17 offset:0
ds_read_b128 v[32:35],v16 offset:10240
ds_read_b128 v[36:39],v17 offset:10240
ds_read_b128 v[40:43],v16 offset:20480
ds_read_b128 v[44:47],v17 offset:20480
ds_read_b128 v[48:51],v16 offset:30720
buffer_load_dword v3,v2,s[8:11],s35 offen sc1
s_waitcnt lgkmcnt(6)
v_mfma_f32_32x32x16_bf16 v[56:71],a[0:3],v[24:27],0
ds_read_b128 v[52:55],v17 offset:30720
s_lshl_b32 s60,s51,6
s_add_u32 s60,s60,s52
s_mul_i32 s60,s60,46080
s_waitcnt lgkmcnt(6)
v_mfma_f32_32x32x16_bf16 v[56:71],a[4:7],v[28:31],v[56:71]
ds_read_b128 v[24:27],v16 offset:2048
s_lshl_b32 s61,s56,11
s_add_u32 s60,s60,s61
s_add_u32 s60,s60,223608832
s_waitcnt lgkmcnt(5)
v_mfma_f32_32x32x16_bf16 v[56:71],a[40:43],v[32:35],v[56:71]
ds_read_b128 v[28:31],v17 offset:2048
buffer_load_dwordx4 v[120:123],v116,s[8:11],s60 offen sc1
buffer_load_dwordx4 v[124:127],v117,s[8:11],s60 offen sc1
v_mfma_f32_32x32x16_bf16 v[56:71],a[44:47],v[36:39],v[56:71]
ds_read_b128 v[32:35],v16 offset:12288
s_add_u32 s62,s32,1
s_min_u32 s62,s62,127
s_sub_u32 s60,s62,16
s_waitcnt lgkmcnt(5)
v_mfma_f32_32x32x16_bf16 v[56:71],a[80:83],v[40:43],v[56:71]
ds_read_b128 v[36:39],v17 offset:12288
s_lshr_b32 s41,s60,1
s_and_b32 s40,s60,1
s_cmp_eq_u32 s40,0
s_cselect_b32 s61,16,0
v_mfma_f32_32x32x16_bf16 v[56:71],a[84:87],v[44:47],v[56:71]
ds_read_b128 v[40:43],v16 offset:22528
s_add_u32 s41,s41,s61
s_sub_u32 s61,s60,48
s_mul_i32 s71,s51,8
s_waitcnt lgkmcnt(5)
v_mfma_f32_32x32x16_bf16 v[56:71],a[120:123],v[48:51],v[56:71]
ds_read_b128 v[44:47],v17 offset:22528
s_cmp_ge_u32 s60,96
s_cselect_b32 s41,s61,s41
s_cselect_b32 s40,1,s40
s_and_b32 s72,s52,7
v_mfma_f32_32x32x16_bf16 v[56:71],a[124:127],v[52:55],v[56:71]
ds_read_b128 v[48:51],v16 offset:32768
s_cmp_lt_u32 s62,16
s_cselect_b32 s41,s62,s41
s_cselect_b32 s40,0,s40
s_waitcnt lgkmcnt(5)
v_mfma_f32_32x32x16_bf16 v[56:71],a[8:11],v[24:27],v[56:71]
ds_read_b128 v[52:55],v17 offset:32768
s_add_u32 s60,s41,1
s_min_u32 s60,s60,63
s_lshl_b32 s42,s40,6
s_add_u32 s42,s42,s60
v_mfma_f32_32x32x16_bf16 v[56:71],a[12:15],v[28:31],v[56:71]
ds_read_b128 v[24:27],v16 offset:4096
s_lshl_b32 s42,s42,9
s_add_u32 s42,s42,323584
s_add_u32 s71,s71,s72
s_waitcnt lgkmcnt(5)
v_mfma_f32_32x32x16_bf16 v[56:71],a[48:51],v[32:35],v[56:71]
ds_read_b128 v[28:31],v17 offset:4096
s_cmp_lt_u32 s60,8
s_cselect_b64 s[80:81],s[78:79],-1
s_mul_i32 s71,s71,46080
s_add_u32 s71,s71,212467712
v_mfma_f32_32x32x16_bf16 v[56:71],a[52:55],v[36:39],v[56:71]
ds_read_b128 v[32:35],v16 offset:14336
s_lshl_b32 s72,s56,8
s_add_u32 s72,s72,s71
s_add_u32 s72,s72,40960
s_waitcnt lgkmcnt(5)
v_mfma_f32_32x32x16_bf16 v[56:71],a[88:91],v[40:43],v[56:71]
ds_read_b128 v[36:39],v17 offset:14336
s_waitcnt vmcnt(2)
s_mov_b64 exec,1
s_cmp_lg_u32 s49,0
s_cbranch_scc0 ls_293
buffer_store_dword v5,v1,s[8:11],s59 offen sc1
s_branch ls_294
ls_293:
buffer_store_dword v5,v1,s[8:11],s59 offen
ls_294:
s_mov_b64 exec,-1
s_mov_b32 s59,2147483648
v_mfma_f32_32x32x16_bf16 v[56:71],a[92:95],v[44:47],v[56:71]
ds_read_b128 v[40:43],v16 offset:24576
v_cmp_eq_u32 vcc,0,v3
s_and_b64 vcc,vcc,s[76:77]
s_cselect_b32 s37,2147483648,0
s_waitcnt lgkmcnt(5)
v_mfma_f32_32x32x16_bf16 v[56:71],a[128:131],v[48:51],v[56:71]
ds_read_b128 v[44:47],v17 offset:24576
s_cmp_lt_u32 s32,128
s_cselect_b32 s37,s37,2147483648
s_sub_u32 s66,40960,s57
s_add_u32 s61,s34,s68
v_mfma_f32_32x32x16_bf16 v[56:71],a[132:135],v[52:55],v[56:71]
ds_read_b128 v[48:51],v16 offset:34816
s_and_b32 s62,s61,7
s_cmp_lt_u32 s61,64
s_cselect_b32 s62,s62,8
s_waitcnt lgkmcnt(5)
v_mfma_f32_32x32x16_bf16 v[56:71],a[16:19],v[24:27],v[56:71]
ds_read_b128 v[52:55],v17 offset:34816
s_mul_i32 s62,s62,40960
s_and_b32 s61,s34,7
s_mul_i32 s61,s61,40960
v_mad_u32_u24 v112,v76,s62,v74
s_barrier
v_mfma_f32_32x32x16_bf16 v[56:71],a[20:23],v[28:31],v[56:71]
ds_read_b128 v[24:27],v16 offset:6144
v_mad_u32_u24 v112,v78,s61,v112
v_mad_u32_u24 v113,v77,s62,v75
v_mad_u32_u24 v113,v79,s61,v113
s_waitcnt lgkmcnt(5)
v_mfma_f32_32x32x16_bf16 v[56:71],a[56:59],v[32:35],v[56:71]
ds_read_b128 v[28:31],v17 offset:6144
s_mov_b32 s60,s33
s_mul_i32 s60,s60,368640
s_add_u32 s60,s60,s37
s_mul_i32 s61,s46,10240
v_mfma_f32_32x32x16_bf16 v[56:71],a[60:63],v[36:39],v[56:71]
ds_read_b128 v[32:35],v16 offset:16384
s_add_u32 s60,s60,s61
s_add_u32 s60,s60,237371392
s_add_u32 s61,s61,s66
s_waitcnt lgkmcnt(5)
v_mfma_f32_32x32x16_bf16 v[56:71],a[96:99],v[40:43],v[56:71]
ds_read_b128 v[36:39],v17 offset:16384
s_add_u32 m0,s61,0
s_add_u32 s63,s60,0
buffer_load_dwordx4 v112,s[8:11],s63 offen sc1 lds
v_mfma_f32_32x32x16_bf16 v[56:71],a[100:103],v[44:47],v[56:71]
ds_read_b128 v[40:43],v16 offset:26624
s_add_u32 m0,s61,1024
s_lshl_b32 s73,s56,11
s_add_u32 s71,s71,s73
s_waitcnt lgkmcnt(5)
v_mfma_f32_32x32x16_bf16 v[56:71],a[136:139],v[48:51],v[56:71]
ds_read_b128 v[44:47],v17 offset:26624
buffer_load_dwordx4 v113,s[8:11],s63 offen sc1 lds
s_add_u32 m0,s61,2048
s_add_u32 s63,s60,2048
v_mfma_f32_32x32x16_bf16 v[56:71],a[140:143],v[52:55],v[56:71]
ds_read_b128 v[48:51],v16 offset:36864
s_lshl_b32 s82,s51,6
s_add_u32 s82,s82,s52
s_lshl_b32 s82,s82,9
s_waitcnt lgkmcnt(5)
v_mfma_f32_32x32x16_bf16 v[56:71],a[24:27],v[24:27],v[56:71]
ds_read_b128 v[52:55],v17 offset:36864
buffer_load_dwordx4 v112,s[8:11],s63 offen sc1 lds
s_add_u32 m0,s61,3072
s_add_u32 s82,s82,524288
v_mfma_f32_32x32x16_bf16 v[56:71],a[28:31],v[28:31],v[56:71]
ds_read_b128 v[24:27],v16 offset:8192
s_lshl_b32 s70,s56,2
s_add_u32 s82,s82,s70
s_waitcnt lgkmcnt(5)
v_mfma_f32_32x32x16_bf16 v[56:71],a[64:67],v[32:35],v[56:71]
ds_read_b128 v[28:31],v17 offset:8192
buffer_load_dwordx4 v113,s[8:11],s63 offen sc1 lds
s_add_u32 m0,s61,4096
s_add_u32 s63,s60,4096
v_mfma_f32_32x32x16_bf16 v[56:71],a[68:71],v[36:39],v[56:71]
ds_read_b128 v[32:35],v16 offset:18432
s_waitcnt lgkmcnt(5)
v_mfma_f32_32x32x16_bf16 v[56:71],a[104:107],v[40:43],v[56:71]
ds_read_b128 v[36:39],v17 offset:18432
buffer_load_dwordx4 v112,s[8:11],s63 offen sc1 lds
s_add_u32 m0,s61,5120
v_mfma_f32_32x32x16_bf16 v[56:71],a[108:111],v[44:47],v[56:71]
ds_read_b128 v[40:43],v16 offset:28672
s_waitcnt lgkmcnt(5)
v_mfma_f32_32x32x16_bf16 v[56:71],a[144:147],v[48:51],v[56:71]
ds_read_b128 v[44:47],v17 offset:28672
buffer_load_dword v3,v2,s[8:11],s35 offen sc1
v_mfma_f32_32x32x16_bf16 v[56:71],a[148:151],v[52:55],v[56:71]
ds_read_b128 v[48:51],v16 offset:38912
buffer_load_dwordx4 v113,s[8:11],s63 offen sc1 lds
s_add_u32 m0,s61,6144
s_waitcnt lgkmcnt(5)
v_mfma_f32_32x32x16_bf16 v[56:71],a[32:35],v[24:27],v[56:71]
ds_read_b128 v[52:55],v17 offset:38912
s_add_u32 s63,s60,6144
v_mfma_f32_32x32x16_bf16 v[56:71],a[36:39],v[28:31],v[56:71]
buffer_load_dwordx4 v112,s[8:11],s63 offen sc1 lds
s_add_u32 m0,s61,7168
s_waitcnt lgkmcnt(4)
v_mfma_f32_32x32x16_bf16 v[56:71],a[72:75],v[32:35],v[56:71]
v_mfma_f32_32x32x16_bf16 v[56:71],a[76:79],v[36:39],v[56:71]
buffer_load_dwordx4 v113,s[8:11],s63 offen sc1 lds
s_add_u32 m0,s61,8192
s_add_u32 s63,s60,8192
s_waitcnt lgkmcnt(2)
v_mfma_f32_32x32x16_bf16 v[56:71],a[112:115],v[40:43],v[56:71]
v_mfma_f32_32x32x16_bf16 v[56:71],a[116:119],v[44:47],v[56:71]
buffer_load_dwordx4 v112,s[8:11],s63 offen sc1 lds
s_add_u32 m0,s61,9216
s_waitcnt lgkmcnt(0)
v_mfma_f32_32x32x16_bf16 v[56:71],a[152:155],v[48:51],v[56:71]
v_mfma_f32_32x32x16_bf16 v[56:71],a[156:159],v[52:55],v[56:71]
buffer_load_dwordx4 v113,s[8:11],s63 offen sc1 lds
s_waitcnt vmcnt(12)
v_lshlrev_b32 v128,16,v120
v_and_b32 v129,0xffff0000,v120
v_lshlrev_b32 v130,16,v121
v_and_b32 v131,0xffff0000,v121
v_lshlrev_b32 v132,16,v122
v_and_b32 v133,0xffff0000,v122
v_lshlrev_b32 v134,16,v123
v_and_b32 v135,0xffff0000,v123
v_lshlrev_b32 v136,16,v124
v_and_b32 v137,0xffff0000,v124
v_lshlrev_b32 v138,16,v125
v_and_b32 v139,0xffff0000,v125
v_lshlrev_b32 v140,16,v126
v_and_b32 v141,0xffff0000,v126
v_lshlrev_b32 v142,16,v127
v_and_b32 v143,0xffff0000,v127
s_cmp_eq_u32 s37,0
s_cbranch_scc0 sec_297
s_mov_b32 s35,s42
s_mov_b32 s53,s33
s_mov_b32 s54,s34
s_add_u32 s32,s32,1
s_mov_b32 s33,s40
s_mov_b32 s34,s41
s_mov_b64 s[76:77],s[80:81]
s_nop 2
ep_295:
v_cvt_pk_bf16_f32 v6,v56,v57
v_lshlrev_b32 v56,16,v6
v_and_b32 v57,0xffff0000,v6
v_cvt_pk_bf16_f32 v6,v58,v59
v_lshlrev_b32 v58,16,v6
v_and_b32 v59,0xffff0000,v6
v_cvt_pk_bf16_f32 v6,v60,v61
v_lshlrev_b32 v60,16,v6
v_and_b32 v61,0xffff0000,v6
v_cvt_pk_bf16_f32 v6,v62,v63
v_lshlrev_b32 v62,16,v6
v_and_b32 v63,0xffff0000,v6
v_cvt_pk_bf16_f32 v6,v64,v65
v_lshlrev_b32 v64,16,v6
v_and_b32 v65,0xffff0000,v6
v_cvt_pk_bf16_f32 v6,v66,v67
v_lshlrev_b32 v66,16,v6
v_and_b32 v67,0xffff0000,v6
v_cvt_pk_bf16_f32 v6,v68,v69
v_lshlrev_b32 v68,16,v6
v_and_b32 v69,0xffff0000,v6
v_cvt_pk_bf16_f32 v6,v70,v71
v_lshlrev_b32 v70,16,v6
v_and_b32 v71,0xffff0000,v6
v_pk_add_f32 v[56:57],v[56:57],v[128:129]
v_pk_add_f32 v[58:59],v[58:59],v[130:131]
v_pk_add_f32 v[60:61],v[60:61],v[132:133]
v_pk_add_f32 v[62:63],v[62:63],v[134:135]
v_pk_add_f32 v[64:65],v[64:65],v[136:137]
v_pk_add_f32 v[66:67],v[66:67],v[138:139]
v_pk_add_f32 v[68:69],v[68:69],v[140:141]
v_pk_add_f32 v[70:71],v[70:71],v[142:143]
v_cvt_pk_bf16_f32 v144,v56,v57
v_lshlrev_b32 v56,16,v144
v_and_b32 v57,0xffff0000,v144
v_cvt_pk_bf16_f32 v145,v58,v59
v_lshlrev_b32 v58,16,v145
v_and_b32 v59,0xffff0000,v145
v_cvt_pk_bf16_f32 v146,v60,v61
v_lshlrev_b32 v60,16,v146
v_and_b32 v61,0xffff0000,v146
v_cvt_pk_bf16_f32 v147,v62,v63
v_lshlrev_b32 v62,16,v147
v_and_b32 v63,0xffff0000,v147
v_cvt_pk_bf16_f32 v148,v64,v65
v_lshlrev_b32 v64,16,v148
v_and_b32 v65,0xffff0000,v148
v_cvt_pk_bf16_f32 v149,v66,v67
v_lshlrev_b32 v66,16,v149
v_and_b32 v67,0xffff0000,v149
v_cvt_pk_bf16_f32 v150,v68,v69
v_lshlrev_b32 v68,16,v150
v_and_b32 v69,0xffff0000,v150
v_cvt_pk_bf16_f32 v151,v70,v71
v_lshlrev_b32 v70,16,v151
v_and_b32 v71,0xffff0000,v151
s_cmp_lg_u32 s49,0
s_cbranch_scc0 ls_298
buffer_store_dwordx4 v[144:147],v20,s[8:11],s71 offen sc1
buffer_store_dwordx4 v[148:151],v21,s[8:11],s71 offen sc1
s_branch ls_299
ls_298:
buffer_store_dwordx4 v[144:147],v20,s[8:11],s71 offen
buffer_store_dwordx4 v[148:151],v21,s[8:11],s71 offen
ls_299:
v_pk_add_f32 v[6:7],v[56:57],v[58:59]
v_pk_mul_f32 v[8:9],v[56:57],v[56:57]
v_pk_fma_f32 v[8:9],v[58:59],v[58:59],v[8:9]
v_pk_add_f32 v[6:7],v[6:7],v[60:61]
v_pk_fma_f32 v[8:9],v[60:61],v[60:61],v[8:9]
v_pk_add_f32 v[6:7],v[6:7],v[62:63]
v_pk_fma_f32 v[8:9],v[62:63],v[62:63],v[8:9]
v_pk_add_f32 v[6:7],v[6:7],v[64:65]
v_pk_fma_f32 v[8:9],v[64:65],v[64:65],v[8:9]
v_pk_add_f32 v[6:7],v[6:7],v[66:67]
v_pk_fma_f32 v[8:9],v[66:67],v[66:67],v[8:9]
v_pk_add_f32 v[6:7],v[6:7],v[68:69]
v_pk_fma_f32 v[8:9],v[68:69],v[68:69],v[8:9]
v_pk_add_f32 v[6:7],v[6:7],v[70:71]
v_pk_fma_f32 v[8:9],v[70:71],v[70:71],v[8:9]
v_add_f32 v6,v6,v7
v_add_f32 v7,v8,v9
v_mov_b32 v8,v6
v_mov_b32 v9,v7
s_nop 0
v_permlane32_swap_b32 v6,v8
v_permlane32_swap_b32 v7,v9
v_pk_add_f32 v[6:7],v[6:7],v[8:9]
s_mov_b32 exec_hi,0
s_cmp_lg_u32 s49,0
s_cbranch_scc0 ls_300
buffer_store_dwordx2 v[6:7],v114,s[8:11],s72 offen sc1
s_branch ls_301
ls_300:
buffer_store_dwordx2 v[6:7],v114,s[8:11],s72 offen
ls_301:
s_mov_b32 exec_hi,-1
s_mov_b32 s59,s82
s_cmp_eq_u32 s37,0
s_cbranch_scc1 W2_NEXT
s_waitcnt vmcnt(3)
v_cmp_eq_u32 vcc,0,v3
s_and_b64 vcc,vcc,s[76:77]
s_cselect_b32 s37,2147483648,0
s_cmp_lt_u32 s32,128
s_cselect_b32 s37,s37,2147483648
s_cmp_eq_u32 s37,0
s_cbranch_scc1 W2_COLD2
s_waitcnt vmcnt(0)
s_mov_b64 exec,1
s_cmp_lg_u32 s49,0
s_cbranch_scc0 ls_302
buffer_store_dword v5,v1,s[8:11],s59 offen sc1
s_branch ls_303
ls_302:
buffer_store_dword v5,v1,s[8:11],s59 offen
ls_303:
s_mov_b64 exec,-1
s_mov_b32 s59,2147483648
s_cmp_lt_u32 s32,128
s_cbranch_scc1 W2_COLD
s_branch W2_END
sec_297:
s_waitcnt vmcnt(5)
v_cmp_eq_u32 vcc,0,v3
s_and_b64 vcc,vcc,s[76:77]
s_cselect_b32 s37,2147483648,0
s_cmp_lt_u32 s32,128
s_cselect_b32 s37,s37,2147483648
s_cmp_lg_u32 s37,0
s_cbranch_scc1 nr_296
s_sub_u32 s66,40960,s57
s_add_u32 s61,s34,s68
s_and_b32 s62,s61,7
s_cmp_lt_u32 s61,64
s_cselect_b32 s62,s62,8
s_mul_i32 s62,s62,40960
s_and_b32 s61,s34,7
s_mul_i32 s61,s61,40960
v_mad_u32_u24 v112,v76,s62,v74
v_mad_u32_u24 v112,v78,s61,v112
v_mad_u32_u24 v113,v77,s62,v75
v_mad_u32_u24 v113,v79,s61,v113
s_mov_b32 s60,s33
s_mul_i32 s60,s60,368640
s_add_u32 s60,s60,s37
s_mul_i32 s61,s46,10240
s_add_u32 s60,s60,s61
s_add_u32 s60,s60,237371392
s_add_u32 s61,s61,s66
s_add_u32 m0,s61,0
s_add_u32 s63,s60,0
buffer_load_dwordx4 v112,s[8:11],s63 offen sc1 lds
v_cvt_pk_bf16_f32 v6,v56,v57
v_lshlrev_b32 v56,16,v6
v_and_b32 v57,0xffff0000,v6
v_cvt_pk_bf16_f32 v6,v58,v59
s_add_u32 m0,s61,1024
s_nop 0
buffer_load_dwordx4 v113,s[8:11],s63 offen sc1 lds
v_lshlrev_b32 v58,16,v6
v_and_b32 v59,0xffff0000,v6
v_cvt_pk_bf16_f32 v6,v60,v61
v_lshlrev_b32 v60,16,v6
s_add_u32 m0,s61,2048
s_add_u32 s63,s60,2048
buffer_load_dwordx4 v112,s[8:11],s63 offen sc1 lds
v_and_b32 v61,0xffff0000,v6
v_cvt_pk_bf16_f32 v6,v62,v63
v_lshlrev_b32 v62,16,v6
v_and_b32 v63,0xffff0000,v6
s_add_u32 m0,s61,3072
s_nop 0
buffer_load_dwordx4 v113,s[8:11],s63 offen sc1 lds
v_cvt_pk_bf16_f32 v6,v64,v65
v_lshlrev_b32 v64,16,v6
v_and_b32 v65,0xffff0000,v6
v_cvt_pk_bf16_f32 v6,v66,v67
s_add_u32 m0,s61,4096
s_add_u32 s63,s60,4096
buffer_load_dwordx4 v112,s[8:11],s63 offen sc1 lds
v_lshlrev_b32 v66,16,v6
v_and_b32 v67,0xffff0000,v6
v_cvt_pk_bf16_f32 v6,v68,v69
v_lshlrev_b32 v68,16,v6
s_add_u32 m0,s61,5120
s_nop 0
buffer_load_dwordx4 v113,s[8:11],s63 offen sc1 lds
v_and_b32 v69,0xffff0000,v6
v_cvt_pk_bf16_f32 v6,v70,v71
v_lshlrev_b32 v70,16,v6
v_and_b32 v71,0xffff0000,v6
s_add_u32 m0,s61,6144
s_add_u32 s63,s60,6144
buffer_load_dwordx4 v112,s[8:11],s63 offen sc1 lds
v_pk_add_f32 v[56:57],v[56:57],v[128:129]
v_pk_add_f32 v[58:59],v[58:59],v[130:131]
v_pk_add_f32 v[60:61],v[60:61],v[132:133]
v_pk_add_f32 v[62:63],v[62:63],v[134:135]
s_add_u32 m0,s61,7168
s_nop 0
buffer_load_dwordx4 v113,s[8:11],s63 offen sc1 lds
v_pk_add_f32 v[64:65],v[64:65],v[136:137]
v_pk_add_f32 v[66:67],v[66:67],v[138:139]
v_pk_add_f32 v[68:69],v[68:69],v[140:141]
v_pk_add_f32 v[70:71],v[70:71],v[142:143]
s_add_u32 m0,s61,8192
s_add_u32 s63,s60,8192
buffer_load_dwordx4 v112,s[8:11],s63 offen sc1 lds
v_cvt_pk_bf16_f32 v144,v56,v57
v_lshlrev_b32 v56,16,v144
v_and_b32 v57,0xffff0000,v144
v_cvt_pk_bf16_f32 v145,v58,v59
s_add_u32 m0,s61,9216
s_nop 0
buffer_load_dwordx4 v113,s[8:11],s63 offen sc1 lds
v_lshlrev_b32 v58,16,v145
v_and_b32 v59,0xffff0000,v145
v_cvt_pk_bf16_f32 v146,v60,v61
v_lshlrev_b32 v60,16,v146
s_mov_b32 s35,s42
s_mov_b32 s53,s33
s_mov_b32 s54,s34
s_add_u32 s32,s32,1
s_mov_b32 s33,s40
s_mov_b32 s34,s41
s_mov_b64 s[76:77],s[80:81]
v_and_b32 v61,0xffff0000,v146
v_cvt_pk_bf16_f32 v147,v62,v63
v_lshlrev_b32 v62,16,v147
v_and_b32 v63,0xffff0000,v147
v_cvt_pk_bf16_f32 v148,v64,v65
v_lshlrev_b32 v64,16,v148
v_and_b32 v65,0xffff0000,v148
v_cvt_pk_bf16_f32 v149,v66,v67
v_lshlrev_b32 v66,16,v149
v_and_b32 v67,0xffff0000,v149
v_cvt_pk_bf16_f32 v150,v68,v69
v_lshlrev_b32 v68,16,v150
v_and_b32 v69,0xffff0000,v150
v_cvt_pk_bf16_f32 v151,v70,v71
v_lshlrev_b32 v70,16,v151
v_and_b32 v71,0xffff0000,v151
s_cmp_lg_u32 s49,0
s_cbranch_scc0 ls_304
buffer_store_dwordx4 v[144:147],v20,s[8:11],s71 offen sc1
buffer_store_dwordx4 v[148:151],v21,s[8:11],s71 offen sc1
s_branch ls_305
ls_304:
buffer_store_dwordx4 v[144:147],v20,s[8:11],s71 offen
buffer_store_dwordx4 v[148:151],v21,s[8:11],s71 offen
ls_305:
v_pk_add_f32 v[6:7],v[56:57],v[58:59]
v_pk_mul_f32 v[8:9],v[56:57],v[56:57]
v_pk_fma_f32 v[8:9],v[58:59],v[58:59],v[8:9]
v_pk_add_f32 v[6:7],v[6:7],v[60:61]
v_pk_fma_f32 v[8:9],v[60:61],v[60:61],v[8:9]
v_pk_add_f32 v[6:7],v[6:7],v[62:63]
v_pk_fma_f32 v[8:9],v[62:63],v[62:63],v[8:9]
v_pk_add_f32 v[6:7],v[6:7],v[64:65]
v_pk_fma_f32 v[8:9],v[64:65],v[64:65],v[8:9]
v_pk_add_f32 v[6:7],v[6:7],v[66:67]
v_pk_fma_f32 v[8:9],v[66:67],v[66:67],v[8:9]
v_pk_add_f32 v[6:7],v[6:7],v[68:69]
v_pk_fma_f32 v[8:9],v[68:69],v[68:69],v[8:9]
v_pk_add_f32 v[6:7],v[6:7],v[70:71]
v_pk_fma_f32 v[8:9],v[70:71],v[70:71],v[8:9]
v_add_f32 v6,v6,v7
v_add_f32 v7,v8,v9
v_mov_b32 v8,v6
v_mov_b32 v9,v7
s_nop 0
v_permlane32_swap_b32 v6,v8
v_permlane32_swap_b32 v7,v9
v_pk_add_f32 v[6:7],v[6:7],v[8:9]
s_mov_b32 exec_hi,0
s_cmp_lg_u32 s49,0
s_cbranch_scc0 ls_306
buffer_store_dwordx2 v[6:7],v114,s[8:11],s72 offen sc1
s_branch ls_307
ls_306:
buffer_store_dwordx2 v[6:7],v114,s[8:11],s72 offen
ls_307:
s_mov_b32 exec_hi,-1
s_mov_b32 s59,s82
s_branch W2_NEXT
nr_296:
buffer_load_dword v3,v2,s[8:11],s35 offen sc1
s_branch ep_295
W2_END:
s_endpgm
ROLE_W3:
v_lshlrev_b32 v1,4,v0
v_mov_b32 v5,1
s_lshl_b32 s56,s48,2
s_add_u32 s56,s56,s46
v_bfe_u32 v6,v0,2,2
v_lshrrev_b32 v7,4,v0
v_add_u32 v7,v6,v7
v_and_b32 v7,3,v7
v_and_b32 v15,3,v0
v_lshlrev_b32 v15,4,v15
v_lshl_add_u32 v15,v7,6,v15
v_lshl_add_u32 v15,v6,8,v15
v_lshrrev_b32 v6,5,v0
v_bfe_u32 v7,v0,4,1
v_lshlrev_b32 v16,10,v7
v_lshl_add_u32 v16,v6,8,v16
v_and_b32 v6,15,v0
v_lshl_add_u32 v16,v6,4,v16
v_add_u32 v18,46080,v16
v_lshrrev_b32 v6,5,v0
v_bfe_u32 v7,v0,4,1
v_lshlrev_b32 v20,10,v7
v_lshl_add_u32 v20,v6,8,v20
v_and_b32 v6,15,v0
v_lshl_add_u32 v20,v6,4,v20
v_lshrrev_b32 v6,5,v0
v_add_u32 v6,2,v6
v_bfe_u32 v7,v0,4,1
v_lshlrev_b32 v17,10,v7
v_lshl_add_u32 v17,v6,8,v17
v_and_b32 v6,15,v0
v_lshl_add_u32 v17,v6,4,v17
v_add_u32 v19,46080,v17
v_lshrrev_b32 v6,5,v0
v_add_u32 v6,2,v6
v_bfe_u32 v7,v0,4,1
v_lshlrev_b32 v21,10,v7
v_lshl_add_u32 v21,v6,8,v21
v_and_b32 v6,15,v0
v_lshl_add_u32 v21,v6,4,v21
v_min_u32 v2,19,v0
v_lshlrev_b32 v2,2,v2
v_mov_b32 v112,0xc0135761
v_mov_b32 v113,0xbdd2d3e8
s_mov_b32 s68,0xbdd2d3e8
v_lshrrev_b32 v6,5,v0
v_mul_u32_u24 v182,2560,v6
v_and_b32 v6,31,v0
v_lshl_add_u32 v182,v6,3,v182
v_add_u32 v182,0xa000,v182
v_mov_b32 v20,v1
v_add_u32 v21,1024,v1
v_mov_b32 v24,-1
v_mov_b32 v25,-1
v_mov_b32 v26,-1
v_mov_b32 v27,-1
s_add_u32 s60,s48,10
s_lshl2_add_u32 s60,s60,s46
s_mul_i32 s60,s60,22528
s_add_u32 s61,s60,24117248
buffer_store_dwordx4 v[24:27],v1,s[8:11],s61 offen sc1
buffer_store_dwordx4 v[24:27],v1,s[8:11],s61 offen offset:1024 sc1
buffer_store_dwordx4 v[24:27],v1,s[8:11],s61 offen offset:2048 sc1
buffer_store_dwordx4 v[24:27],v1,s[8:11],s61 offen offset:3072 sc1
s_add_u32 s61,s60,24121344
buffer_store_dwordx4 v[24:27],v1,s[8:11],s61 offen sc1
buffer_store_dwordx4 v[24:27],v1,s[8:11],s61 offen offset:1024 sc1
buffer_store_dwordx4 v[24:27],v1,s[8:11],s61 offen offset:2048 sc1
buffer_store_dwordx4 v[24:27],v1,s[8:11],s61 offen offset:3072 sc1
s_add_u32 s61,s60,24125440
buffer_store_dwordx4 v[24:27],v1,s[8:11],s61 offen sc1
buffer_store_dwordx4 v[24:27],v1,s[8:11],s61 offen offset:1024 sc1
buffer_store_dwordx4 v[24:27],v1,s[8:11],s61 offen offset:2048 sc1
buffer_store_dwordx4 v[24:27],v1,s[8:11],s61 offen offset:3072 sc1
s_add_u32 s61,s60,24129536
buffer_store_dwordx4 v[24:27],v1,s[8:11],s61 offen sc1
buffer_store_dwordx4 v[24:27],v1,s[8:11],s61 offen offset:1024 sc1
buffer_store_dwordx4 v[24:27],v1,s[8:11],s61 offen offset:2048 sc1
buffer_store_dwordx4 v[24:27],v1,s[8:11],s61 offen offset:3072 sc1
s_add_u32 s61,s60,24133632
buffer_store_dwordx4 v[24:27],v1,s[8:11],s61 offen sc1
buffer_store_dwordx4 v[24:27],v1,s[8:11],s61 offen offset:1024 sc1
buffer_store_dwordx4 v[24:27],v1,s[8:11],s61 offen offset:2048 sc1
buffer_store_dwordx4 v[24:27],v1,s[8:11],s61 offen offset:3072 sc1
s_add_u32 s61,s60,24137728
buffer_store_dwordx4 v[24:27],v1,s[8:11],s61 offen sc1
buffer_store_dwordx4 v[24:27],v1,s[8:11],s61 offen offset:1024 sc1
s_waitcnt vmcnt(0)
s_barrier
s_cmp_lg_u32 s46,0
s_cbranch_scc1 arr_308
v_mov_b32 v6,1
s_lshl_b32 s3,s49,2
v_mov_b32 v7,s3
s_mov_b64 exec,1
buffer_atomic_add v6,v7,s[12:15],0 offen sc1
s_mov_b64 exec,-1
arr_308:
s_lshl_b32 s3,s49,2
v_mov_b32 v7,s3
s_nop 1
ibw_309:
buffer_load_dword v6,v7,s[12:15],0 offen sc1
s_waitcnt vmcnt(0)
v_cmp_ne_u32 vcc,256,v6
s_nop 0
s_cbranch_vccz ok_310
s_sleep 8
s_sub_u32 s47,s47,1
s_cbranch_scc1 ABORT
s_branch ibw_309
ok_310:
s_cmp_lg_u32 s49,0
s_cbranch_scc1 ibok_311
v_and_b32 v7,7,v0
v_lshlrev_b32 v7,2,v7
buffer_load_dword v6,v7,s[12:15],0 offen offset:32 sc1
s_waitcnt vmcnt(0)
v_cmp_ne_u32 vcc,32,v6
s_nop 0
s_cbranch_vccz ibok_311
s_barrier
s_mov_b32 s49,1
s_mov_b32 s3,s2
s_load_dwordx16 s[16:31],s[0:1],0
s_load_dwordx8 s[32:39],s[0:1],64
s_waitcnt lgkmcnt(0)
s_branch DISPATCH
ibok_311:
s_lshl_b32 s58,s56,6
s_mul_i32 s63,s46,40960
s_mov_b32 s4,s36
s_mov_b32 s5,s37
s_mov_b32 s6,1966080
s_mov_b32 s7,0x20000
v_lshrrev_b32 v9,2,v0
s_mov_b32 s64,3072
v_mul_lo_u32 v9,v9,s64
v_and_b32 v10,3,v0
v_lshl_add_u32 v6,v10,4,v9
s_add_u32 m0,s63,0
s_add_u32 s65,s58,0
buffer_load_dwordx4 v6,s[4:7],s65 offen lds
s_add_u32 m0,s63,1024
s_add_u32 s65,s58,49152
buffer_load_dwordx4 v6,s[4:7],s65 offen lds
s_add_u32 m0,s63,2048
s_add_u32 s65,s58,98304
buffer_load_dwordx4 v6,s[4:7],s65 offen lds
s_add_u32 m0,s63,3072
s_add_u32 s65,s58,147456
buffer_load_dwordx4 v6,s[4:7],s65 offen lds
s_add_u32 m0,s63,4096
s_add_u32 s65,s58,196608
buffer_load_dwordx4 v6,s[4:7],s65 offen lds
s_add_u32 m0,s63,5120
s_add_u32 s65,s58,245760
buffer_load_dwordx4 v6,s[4:7],s65 offen lds
s_add_u32 m0,s63,6144
s_add_u32 s65,s58,294912
buffer_load_dwordx4 v6,s[4:7],s65 offen lds
s_add_u32 m0,s63,7168
s_add_u32 s65,s58,344064
buffer_load_dwordx4 v6,s[4:7],s65 offen lds
s_add_u32 m0,s63,8192
s_add_u32 s65,s58,393216
buffer_load_dwordx4 v6,s[4:7],s65 offen lds
s_add_u32 m0,s63,9216
s_add_u32 s65,s58,442368
buffer_load_dwordx4 v6,s[4:7],s65 offen lds
s_add_u32 m0,s63,10240
s_add_u32 s65,s58,491520
buffer_load_dwordx4 v6,s[4:7],s65 offen lds
s_add_u32 m0,s63,11264
s_add_u32 s65,s58,540672
buffer_load_dwordx4 v6,s[4:7],s65 offen lds
s_add_u32 m0,s63,12288
s_add_u32 s65,s58,589824
buffer_load_dwordx4 v6,s[4:7],s65 offen lds
s_add_u32 m0,s63,13312
s_add_u32 s65,s58,638976
buffer_load_dwordx4 v6,s[4:7],s65 offen lds
s_add_u32 m0,s63,14336
s_add_u32 s65,s58,688128
buffer_load_dwordx4 v6,s[4:7],s65 offen lds
s_add_u32 m0,s63,15360
s_add_u32 s65,s58,737280
buffer_load_dwordx4 v6,s[4:7],s65 offen lds
s_add_u32 m0,s63,16384
s_add_u32 s65,s58,786432
buffer_load_dwordx4 v6,s[4:7],s65 offen lds
s_add_u32 m0,s63,17408
s_add_u32 s65,s58,835584
buffer_load_dwordx4 v6,s[4:7],s65 offen lds
s_add_u32 m0,s63,18432
s_add_u32 s65,s58,884736
buffer_load_dwordx4 v6,s[4:7],s65 offen lds
s_add_u32 m0,s63,19456
s_add_u32 s65,s58,933888
buffer_load_dwordx4 v6,s[4:7],s65 offen lds
s_add_u32 m0,s63,20480
s_add_u32 s65,s58,983040
buffer_load_dwordx4 v6,s[4:7],s65 offen lds
s_add_u32 m0,s63,21504
s_add_u32 s65,s58,1032192
buffer_load_dwordx4 v6,s[4:7],s65 offen lds
s_add_u32 m0,s63,22528
s_add_u32 s65,s58,1081344
buffer_load_dwordx4 v6,s[4:7],s65 offen lds
s_add_u32 m0,s63,23552
s_add_u32 s65,s58,1130496
buffer_load_dwordx4 v6,s[4:7],s65 offen lds
s_add_u32 m0,s63,24576
s_add_u32 s65,s58,1179648
buffer_load_dwordx4 v6,s[4:7],s65 offen lds
s_add_u32 m0,s63,25600
s_add_u32 s65,s58,1228800
buffer_load_dwordx4 v6,s[4:7],s65 offen lds
s_add_u32 m0,s63,26624
s_add_u32 s65,s58,1277952
buffer_load_dwordx4 v6,s[4:7],s65 offen lds
s_add_u32 m0,s63,27648
s_add_u32 s65,s58,1327104
buffer_load_dwordx4 v6,s[4:7],s65 offen lds
s_add_u32 m0,s63,28672
s_add_u32 s65,s58,1376256
buffer_load_dwordx4 v6,s[4:7],s65 offen lds
s_add_u32 m0,s63,29696
s_add_u32 s65,s58,1425408
buffer_load_dwordx4 v6,s[4:7],s65 offen lds
s_add_u32 m0,s63,30720
s_add_u32 s65,s58,1474560
buffer_load_dwordx4 v6,s[4:7],s65 offen lds
s_add_u32 m0,s63,31744
s_add_u32 s65,s58,1523712
buffer_load_dwordx4 v6,s[4:7],s65 offen lds
s_add_u32 m0,s63,32768
s_add_u32 s65,s58,1572864
buffer_load_dwordx4 v6,s[4:7],s65 offen lds
s_add_u32 m0,s63,33792
s_add_u32 s65,s58,1622016
buffer_load_dwordx4 v6,s[4:7],s65 offen lds
s_add_u32 m0,s63,34816
s_add_u32 s65,s58,1671168
buffer_load_dwordx4 v6,s[4:7],s65 offen lds
s_add_u32 m0,s63,35840
s_add_u32 s65,s58,1720320
buffer_load_dwordx4 v6,s[4:7],s65 offen lds
s_add_u32 m0,s63,36864
s_add_u32 s65,s58,1769472
buffer_load_dwordx4 v6,s[4:7],s65 offen lds
s_add_u32 m0,s63,37888
s_add_u32 s65,s58,1818624
buffer_load_dwordx4 v6,s[4:7],s65 offen lds
s_add_u32 m0,s63,38912
s_add_u32 s65,s58,1867776
buffer_load_dwordx4 v6,s[4:7],s65 offen lds
s_add_u32 m0,s63,39936
s_add_u32 s65,s58,1916928
buffer_load_dwordx4 v6,s[4:7],s65 offen lds
s_waitcnt vmcnt(20)
v_bfe_u32 v9,v0,2,2
v_lshrrev_b32 v10,5,v0
v_lshl_add_u32 v9,v10,2,v9
v_mul_u32_u24 v9,64,v9
v_and_b32 v10,1,v0
v_lshl_add_u32 v9,v10,3,v9
v_bfe_u32 v10,v0,1,1
v_lshl_add_u32 v9,v10,5,v9
v_bfe_u32 v10,v0,4,1
v_lshl_add_u32 v9,v10,4,v9
v_add_u32 v7,s63,v9
ds_read_b64_tr_b16 a[0:1],v7 offset:0
ds_read_b64_tr_b16 a[2:3],v7 offset:1024
ds_read_b64_tr_b16 a[4:5],v7 offset:512
ds_read_b64_tr_b16 a[6:7],v7 offset:1536
ds_read_b64_tr_b16 a[8:9],v7 offset:2048
ds_read_b64_tr_b16 a[10:11],v7 offset:3072
ds_read_b64_tr_b16 a[12:13],v7 offset:2560
ds_read_b64_tr_b16 a[14:15],v7 offset:3584
ds_read_b64_tr_b16 a[16:17],v7 offset:4096
ds_read_b64_tr_b16 a[18:19],v7 offset:5120
ds_read_b64_tr_b16 a[20:21],v7 offset:4608
ds_read_b64_tr_b16 a[22:23],v7 offset:5632
s_waitcnt lgkmcnt(4)
ds_read_b64_tr_b16 a[24:25],v7 offset:6144
ds_read_b64_tr_b16 a[26:27],v7 offset:7168
ds_read_b64_tr_b16 a[28:29],v7 offset:6656
ds_read_b64_tr_b16 a[30:31],v7 offset:7680
ds_read_b64_tr_b16 a[32:33],v7 offset:8192
ds_read_b64_tr_b16 a[34:35],v7 offset:9216
ds_read_b64_tr_b16 a[36:37],v7 offset:8704
ds_read_b64_tr_b16 a[38:39],v7 offset:9728
ds_read_b64_tr_b16 a[40:41],v7 offset:10240
ds_read_b64_tr_b16 a[42:43],v7 offset:11264
ds_read_b64_tr_b16 a[44:45],v7 offset:10752
ds_read_b64_tr_b16 a[46:47],v7 offset:11776
s_waitcnt lgkmcnt(4)
ds_read_b64_tr_b16 a[48:49],v7 offset:12288
ds_read_b64_tr_b16 a[50:51],v7 offset:13312
ds_read_b64_tr_b16 a[52:53],v7 offset:12800
ds_read_b64_tr_b16 a[54:55],v7 offset:13824
ds_read_b64_tr_b16 a[56:57],v7 offset:14336
ds_read_b64_tr_b16 a[58:59],v7 offset:15360
ds_read_b64_tr_b16 a[60:61],v7 offset:14848
ds_read_b64_tr_b16 a[62:63],v7 offset:15872
ds_read_b64_tr_b16 a[64:65],v7 offset:16384
ds_read_b64_tr_b16 a[66:67],v7 offset:17408
ds_read_b64_tr_b16 a[68:69],v7 offset:16896
ds_read_b64_tr_b16 a[70:71],v7 offset:17920
s_waitcnt lgkmcnt(4)
ds_read_b64_tr_b16 a[72:73],v7 offset:18432
ds_read_b64_tr_b16 a[74:75],v7 offset:19456
ds_read_b64_tr_b16 a[76:77],v7 offset:18944
ds_read_b64_tr_b16 a[78:79],v7 offset:19968
s_waitcnt lgkmcnt(0)
s_waitcnt vmcnt(0)
v_bfe_u32 v9,v0,2,2
v_lshrrev_b32 v10,5,v0
v_lshl_add_u32 v9,v10,2,v9
v_mul_u32_u24 v9,64,v9
v_and_b32 v10,1,v0
v_lshl_add_u32 v9,v10,3,v9
v_bfe_u32 v10,v0,1,1
v_lshl_add_u32 v9,v10,5,v9
v_bfe_u32 v10,v0,4,1
v_lshl_add_u32 v9,v10,4,v9
v_add_u32 v7,s63,v9
ds_read_b64_tr_b16 a[80:81],v7 offset:20480
ds_read_b64_tr_b16 a[82:83],v7 offset:21504
ds_read_b64_tr_b16 a[84:85],v7 offset:20992
ds_read_b64_tr_b16 a[86:87],v7 offset:22016
ds_read_b64_tr_b16 a[88:89],v7 offset:22528
ds_read_b64_tr_b16 a[90:91],v7 offset:23552
ds_read_b64_tr_b16 a[92:93],v7 offset:23040
ds_read_b64_tr_b16 a[94:95],v7 offset:24064
ds_read_b64_tr_b16 a[96:97],v7 offset:24576
ds_read_b64_tr_b16 a[98:99],v7 offset:25600
ds_read_b64_tr_b16 a[100:101],v7 offset:25088
ds_read_b64_tr_b16 a[102:103],v7 offset:26112
s_waitcnt lgkmcnt(4)
ds_read_b64_tr_b16 a[104:105],v7 offset:26624
ds_read_b64_tr_b16 a[106:107],v7 offset:27648
ds_read_b64_tr_b16 a[108:109],v7 offset:27136
ds_read_b64_tr_b16 a[110:111],v7 offset:28160
ds_read_b64_tr_b16 a[112:113],v7 offset:28672
ds_read_b64_tr_b16 a[114:115],v7 offset:29696
ds_read_b64_tr_b16 a[116:117],v7 offset:29184
ds_read_b64_tr_b16 a[118:119],v7 offset:30208
ds_read_b64_tr_b16 a[120:121],v7 offset:30720
ds_read_b64_tr_b16 a[122:123],v7 offset:31744
ds_read_b64_tr_b16 a[124:125],v7 offset:31232
ds_read_b64_tr_b16 a[126:127],v7 offset:32256
s_waitcnt lgkmcnt(4)
ds_read_b64_tr_b16 a[128:129],v7 offset:32768
ds_read_b64_tr_b16 a[130:131],v7 offset:33792
ds_read_b64_tr_b16 a[132:133],v7 offset:33280
ds_read_b64_tr_b16 a[134:135],v7 offset:34304
ds_read_b64_tr_b16 a[136:137],v7 offset:34816
ds_read_b64_tr_b16 a[138:139],v7 offset:35840
ds_read_b64_tr_b16 a[140:141],v7 offset:35328
ds_read_b64_tr_b16 a[142:143],v7 offset:36352
ds_read_b64_tr_b16 a[144:145],v7 offset:36864
ds_read_b64_tr_b16 a[146:147],v7 offset:37888
ds_read_b64_tr_b16 a[148:149],v7 offset:37376
ds_read_b64_tr_b16 a[150:151],v7 offset:38400
s_waitcnt lgkmcnt(4)
ds_read_b64_tr_b16 a[152:153],v7 offset:38912
ds_read_b64_tr_b16 a[154:155],v7 offset:39936
ds_read_b64_tr_b16 a[156:157],v7 offset:39424
ds_read_b64_tr_b16 a[158:159],v7 offset:40448
s_waitcnt lgkmcnt(0)
v_mov_b32 v24,0x3f803f80
v_mov_b32 v25,0x3f803f80
v_mov_b32 v26,0x3f803f80
v_mov_b32 v27,0x3f803f80
s_nop 1
v_mfma_f32_32x32x16_bf16 v[144:159],a[0:3],v[24:27],0
v_mfma_f32_32x32x16_bf16 v[144:159],a[4:7],v[24:27],v[144:159]
v_mfma_f32_32x32x16_bf16 v[144:159],a[8:11],v[24:27],v[144:159]
v_mfma_f32_32x32x16_bf16 v[144:159],a[12:15],v[24:27],v[144:159]
v_mfma_f32_32x32x16_bf16 v[144:159],a[16:19],v[24:27],v[144:159]
v_mfma_f32_32x32x16_bf16 v[144:159],a[20:23],v[24:27],v[144:159]
v_mfma_f32_32x32x16_bf16 v[144:159],a[24:27],v[24:27],v[144:159]
v_mfma_f32_32x32x16_bf16 v[144:159],a[28:31],v[24:27],v[144:159]
v_mfma_f32_32x32x16_bf16 v[144:159],a[32:35],v[24:27],v[144:159]
v_mfma_f32_32x32x16_bf16 v[144:159],a[36:39],v[24:27],v[144:159]
v_mfma_f32_32x32x16_bf16 v[144:159],a[40:43],v[24:27],v[144:159]
v_mfma_f32_32x32x16_bf16 v[144:159],a[44:47],v[24:27],v[144:159]
v_mfma_f32_32x32x16_bf16 v[144:159],a[48:51],v[24:27],v[144:159]
v_mfma_f32_32x32x16_bf16 v[144:159],a[52:55],v[24:27],v[144:159]
v_mfma_f32_32x32x16_bf16 v[144:159],a[56:59],v[24:27],v[144:159]
v_mfma_f32_32x32x16_bf16 v[144:159],a[60:63],v[24:27],v[144:159]
v_mfma_f32_32x32x16_bf16 v[144:159],a[64:67],v[24:27],v[144:159]
v_mfma_f32_32x32x16_bf16 v[144:159],a[68:71],v[24:27],v[144:159]
v_mfma_f32_32x32x16_bf16 v[144:159],a[72:75],v[24:27],v[144:159]
v_mfma_f32_32x32x16_bf16 v[144:159],a[76:79],v[24:27],v[144:159]
v_mfma_f32_32x32x16_bf16 v[144:159],a[80:83],v[24:27],v[144:159]
v_mfma_f32_32x32x16_bf16 v[144:159],a[84:87],v[24:27],v[144:159]
v_mfma_f32_32x32x16_bf16 v[144:159],a[88:91],v[24:27],v[144:159]
v_mfma_f32_32x32x16_bf16 v[144:159],a[92:95],v[24:27],v[144:159]
v_mfma_f32_32x32x16_bf16 v[144:159],a[96:99],v[24:27],v[144:159]
v_mfma_f32_32x32x16_bf16 v[144:159],a[100:103],v[24:27],v[144:159]
v_mfma_f32_32x32x16_bf16 v[144:159],a[104:107],v[24:27],v[144:159]
v_mfma_f32_32x32x16_bf16 v[144:159],a[108:111],v[24:27],v[144:159]
v_mfma_f32_32x32x16_bf16 v[144:159],a[112:115],v[24:27],v[144:159]
v_mfma_f32_32x32x16_bf16 v[144:159],a[116:119],v[24:27],v[144:159]
v_mfma_f32_32x32x16_bf16 v[144:159],a[120:123],v[24:27],v[144:159]
v_mfma_f32_32x32x16_bf16 v[144:159],a[124:127],v[24:27],v[144:159]
v_mfma_f32_32x32x16_bf16 v[144:159],a[128:131],v[24:27],v[144:159]
v_mfma_f32_32x32x16_bf16 v[144:159],a[132:135],v[24:27],v[144:159]
v_mfma_f32_32x32x16_bf16 v[144:159],a[136:139],v[24:27],v[144:159]
v_mfma_f32_32x32x16_bf16 v[144:159],a[140:143],v[24:27],v[144:159]
v_mfma_f32_32x32x16_bf16 v[144:159],a[144:147],v[24:27],v[144:159]
v_mfma_f32_32x32x16_bf16 v[144:159],a[148:151],v[24:27],v[144:159]
v_mfma_f32_32x32x16_bf16 v[144:159],a[152:155],v[24:27],v[144:159]
v_mfma_f32_32x32x16_bf16 v[144:159],a[156:159],v[24:27],v[144:159]
s_barrier
s_mov_b32 s50,0
s_mov_b32 s32,0
s_mov_b32 s57,0
s_mov_b32 s59,2147483648
s_mov_b32 s82,2147483648
s_mov_b32 s39,2147483648
v_mov_b32 v22,94208
v_lshl_add_u32 v22,v0,2,v22
v_mov_b32 v23,0
ds_write_b32 v22,v23
s_mov_b32 s39,1600000
v_and_b32 v72,15,v0
v_lshlrev_b32 v72,7,v72
v_min_u32 v6,59,v0
v_lshlrev_b32 v6,2,v6
v_add_u32 v2,198656,v6
v_add_u32 v7,-80,v6
v_cmp_gt_u32 s[78:79],20,v0
s_nop 1
v_cndmask_b32 v2,v7,v2,s[78:79]
s_mov_b32 s51,0
s_mov_b32 s52,0
s_mul_i32 s62,s51,4
s_and_b32 s63,s52,3
s_add_u32 s62,s62,s63
s_mul_i32 s62,s62,98304
s_add_u32 s62,s62,242778112
s_lshl_b32 s63,s56,11
s_add_u32 s62,s62,s63
buffer_load_dword v73,v72,s[8:11],s62 offen sc1
s_mov_b32 s51,0
s_mov_b32 s52,1
s_mul_i32 s62,s51,4
s_and_b32 s63,s52,3
s_add_u32 s62,s62,s63
s_mul_i32 s62,s62,98304
s_add_u32 s62,s62,242778112
s_lshl_b32 s63,s56,11
s_add_u32 s62,s62,s63
buffer_load_dword v73,v72,s[8:11],s62 offen sc1
s_mov_b32 s51,0
s_mov_b32 s52,2
s_mul_i32 s62,s51,4
s_and_b32 s63,s52,3
s_add_u32 s62,s62,s63
s_mul_i32 s62,s62,98304
s_add_u32 s62,s62,242778112
s_lshl_b32 s63,s56,11
s_add_u32 s62,s62,s63
buffer_load_dword v73,v72,s[8:11],s62 offen sc1
s_mov_b32 s51,0
s_mov_b32 s52,3
s_mul_i32 s62,s51,4
s_and_b32 s63,s52,3
s_add_u32 s62,s62,s63
s_mul_i32 s62,s62,98304
s_add_u32 s62,s62,242778112
s_lshl_b32 s63,s56,11
s_add_u32 s62,s62,s63
buffer_load_dword v73,v72,s[8:11],s62 offen sc1
s_mov_b32 s51,1
s_mov_b32 s52,0
s_mul_i32 s62,s51,4
s_and_b32 s63,s52,3
s_add_u32 s62,s62,s63
s_mul_i32 s62,s62,98304
s_add_u32 s62,s62,242778112
s_lshl_b32 s63,s56,11
s_add_u32 s62,s62,s63
buffer_load_dword v73,v72,s[8:11],s62 offen sc1
s_mov_b32 s51,1
s_mov_b32 s52,1
s_mul_i32 s62,s51,4
s_and_b32 s63,s52,3
s_add_u32 s62,s62,s63
s_mul_i32 s62,s62,98304
s_add_u32 s62,s62,242778112
s_lshl_b32 s63,s56,11
s_add_u32 s62,s62,s63
buffer_load_dword v73,v72,s[8:11],s62 offen sc1
s_mov_b32 s51,1
s_mov_b32 s52,2
s_mul_i32 s62,s51,4
s_and_b32 s63,s52,3
s_add_u32 s62,s62,s63
s_mul_i32 s62,s62,98304
s_add_u32 s62,s62,242778112
s_lshl_b32 s63,s56,11
s_add_u32 s62,s62,s63
buffer_load_dword v73,v72,s[8:11],s62 offen sc1
s_mov_b32 s51,1
s_mov_b32 s52,3
s_mul_i32 s62,s51,4
s_and_b32 s63,s52,3
s_add_u32 s62,s62,s63
s_mul_i32 s62,s62,98304
s_add_u32 s62,s62,242778112
s_lshl_b32 s63,s56,11
s_add_u32 s62,s62,s63
buffer_load_dword v73,v72,s[8:11],s62 offen sc1
s_waitcnt vmcnt(0)
s_waitcnt lgkmcnt(0)
s_barrier
s_mov_b32 s83,s100
s_min_u32 s62,s32,127
s_sub_u32 s60,s62,17
s_lshr_b32 s34,s60,1
s_and_b32 s33,s60,1
s_cmp_eq_u32 s33,0
s_cselect_b32 s61,17,0
s_add_u32 s34,s34,s61
s_sub_u32 s61,s60,47
s_cmp_ge_u32 s60,94
s_cselect_b32 s34,s61,s34
s_cselect_b32 s33,1,s33
s_cmp_lt_u32 s62,17
s_cselect_b32 s34,s62,s34
s_cselect_b32 s33,0,s33
s_lshl_b32 s35,s33,6
s_add_u32 s35,s35,s34
s_lshl_b32 s35,s35,9
s_add_u32 s35,s35,325632
s_cmp_lt_u32 s34,4
s_cselect_b64 s[76:77],s[78:79],-1
s_sub_u32 s57,46080,s57
v_swap_b32 v16,v18
v_swap_b32 v17,v19
s_add_u32 s62,s32,1
s_min_u32 s62,s62,127
s_sub_u32 s60,s62,17
s_lshr_b32 s41,s60,1
s_and_b32 s40,s60,1
s_cmp_eq_u32 s40,0
s_cselect_b32 s61,17,0
s_add_u32 s41,s41,s61
s_sub_u32 s61,s60,47
s_cmp_ge_u32 s60,94
s_cselect_b32 s41,s61,s41
s_cselect_b32 s40,1,s40
s_cmp_lt_u32 s62,17
s_cselect_b32 s41,s62,s41
s_cselect_b32 s40,0,s40
s_lshl_b32 s42,s40,6
s_add_u32 s42,s42,s41
s_lshl_b32 s42,s42,9
s_add_u32 s42,s42,325632
s_cmp_lt_u32 s41,4
s_cselect_b64 s[80:81],s[78:79],-1
W3_COLD:
s_mov_b32 s37,0
fb_312:
buffer_load_dword v3,v2,s[8:11],s35 offen sc1
s_waitcnt vmcnt(0)
v_cmp_eq_u32 vcc,0,v3
s_and_b64 vcc,vcc,s[76:77]
s_cbranch_scc0 ok_313
s_sleep 1
s_sub_u32 s47,s47,1
s_cbranch_scc1 ABORT
s_branch fb_312
ok_313:
W3_COLD2:
s_sub_u32 s66,46080,s57
s_mul_i32 s60,s33,8
s_and_b32 s61,s34,7
s_add_u32 s60,s60,s61
s_mul_i32 s60,s60,46080
s_add_u32 s60,s60,s37
s_add_u32 s60,s60,212467712
s_mov_b32 s67,s60
s_mul_i32 s61,s46,10240
s_add_u32 s60,s60,s61
s_add_u32 s61,s61,s66
s_add_u32 m0,s61,0
s_add_u32 s63,s60,0
buffer_load_dwordx4 v1,s[8:11],s63 offen sc1 lds
buffer_load_dwordx4 v1,s[8:11],s63 offen offset:1024 sc1 lds
buffer_load_dwordx4 v1,s[8:11],s63 offen offset:2048 sc1 lds
buffer_load_dwordx4 v1,s[8:11],s63 offen offset:3072 sc1 lds
s_add_u32 m0,s61,4096
s_add_u32 s63,s60,4096
buffer_load_dwordx4 v1,s[8:11],s63 offen sc1 lds
buffer_load_dwordx4 v1,s[8:11],s63 offen offset:1024 sc1 lds
s_waitcnt vmcnt(5)
s_mov_b64 exec,1
s_cmp_lg_u32 s49,0
s_cbranch_scc0 ls_314
buffer_store_dword v5,v1,s[8:11],s59 offen sc1
s_branch ls_315
ls_314:
buffer_store_dword v5,v1,s[8:11],s59 offen
ls_315:
s_mov_b64 exec,-1
s_mov_b32 s59,2147483648
buffer_load_dwordx4 v1,s[8:11],s63 offen offset:2048 sc1 lds
buffer_load_dwordx4 v1,s[8:11],s63 offen offset:3072 sc1 lds
s_add_u32 m0,s61,8192
s_add_u32 s63,s60,8192
buffer_load_dwordx4 v1,s[8:11],s63 offen sc1 lds
buffer_load_dwordx4 v1,s[8:11],s63 offen offset:1024 sc1 lds
s_lshl_b32 s62,s46,10
s_add_u32 s62,s62,40960
s_add_u32 m0,s66,s62
s_add_u32 s63,s67,s62
buffer_load_dwordx4 v1,s[8:11],s63 offen sc1 lds
s_add_u32 m0,s66,45056
s_add_u32 s63,s67,45056
buffer_load_dwordx4 v1,s[8:11],s63 offen sc1 lds
s_mov_b32 s35,s42
s_mov_b32 s53,s33
s_mov_b32 s54,s34
s_add_u32 s32,s32,1
s_mov_b32 s33,s40
s_mov_b32 s34,s41
s_mov_b64 s[76:77],s[80:81]
s_sub_u32 s57,46080,s57
v_swap_b32 v16,v18
v_swap_b32 v17,v19
s_mov_b32 s51,s53
s_mov_b32 s52,s54
s_waitcnt vmcnt(7)
s_branch W3_GO
W3_NEXT:
s_sub_u32 s57,46080,s57
v_swap_b32 v16,v18
v_swap_b32 v17,v19
s_mov_b32 s51,s53
s_mov_b32 s52,s54
s_waitcnt vmcnt(2)
W3_GO:
s_barrier
ds_read_b128 v[24:27],v16 offset:0
ds_read_b128 v[28:31],v17 offset:0
ds_read_b128 v[32:35],v16 offset:10240
ds_read_b128 v[36:39],v17 offset:10240
ds_read_b128 v[40:43],v16 offset:20480
ds_read_b128 v[44:47],v17 offset:20480
ds_read_b128 v[48:51],v16 offset:30720
buffer_load_dword v3,v2,s[8:11],s35 offen sc1
s_waitcnt lgkmcnt(6)
v_mfma_f32_32x32x16_bf16 v[56:71],a[0:3],v[24:27],0
ds_read_b128 v[52:55],v17 offset:30720
s_add_u32 s62,s32,1
s_min_u32 s62,s62,127
s_sub_u32 s60,s62,17
s_waitcnt lgkmcnt(6)
v_mfma_f32_32x32x16_bf16 v[56:71],a[4:7],v[28:31],v[56:71]
ds_read_b128 v[24:27],v16 offset:2048
s_lshr_b32 s41,s60,1
s_and_b32 s40,s60,1
s_mul_i32 s71,s51,4
s_waitcnt lgkmcnt(5)
v_mfma_f32_32x32x16_bf16 v[56:71],a[40:43],v[32:35],v[56:71]
ds_read_b128 v[28:31],v17 offset:2048
s_cmp_eq_u32 s40,0
s_cselect_b32 s61,17,0
s_add_u32 s41,s41,s61
s_sub_u32 s61,s60,47
v_mfma_f32_32x32x16_bf16 v[56:71],a[44:47],v[36:39],v[56:71]
ds_read_b128 v[32:35],v16 offset:12288
s_cmp_ge_u32 s60,94
s_cselect_b32 s41,s61,s41
s_cselect_b32 s40,1,s40
s_waitcnt lgkmcnt(5)
v_mfma_f32_32x32x16_bf16 v[56:71],a[80:83],v[40:43],v[56:71]
ds_read_b128 v[36:39],v17 offset:12288
s_cmp_lt_u32 s62,17
s_cselect_b32 s41,s62,s41
s_cselect_b32 s40,0,s40
s_lshl_b32 s42,s40,6
v_mfma_f32_32x32x16_bf16 v[56:71],a[84:87],v[44:47],v[56:71]
ds_read_b128 v[40:43],v16 offset:22528
s_add_u32 s42,s42,s41
s_lshl_b32 s42,s42,9
s_add_u32 s42,s42,325632
s_waitcnt lgkmcnt(5)
v_mfma_f32_32x32x16_bf16 v[56:71],a[120:123],v[48:51],v[56:71]
ds_read_b128 v[44:47],v17 offset:22528
s_cmp_lt_u32 s41,4
s_cselect_b64 s[80:81],s[78:79],-1
s_and_b32 s72,s52,3
s_add_u32 s71,s71,s72
v_mfma_f32_32x32x16_bf16 v[56:71],a[124:127],v[52:55],v[56:71]
ds_read_b128 v[48:51],v16 offset:32768
s_mul_i32 s71,s71,98304
s_add_u32 s71,s71,242778112
s_lshl_b32 s72,s56,11
s_waitcnt lgkmcnt(5)
v_mfma_f32_32x32x16_bf16 v[56:71],a[8:11],v[24:27],v[56:71]
ds_read_b128 v[52:55],v17 offset:32768
s_add_u32 s71,s71,s72
s_lshl_b32 s82,s51,6
s_add_u32 s82,s82,s52
s_lshl_b32 s82,s82,9
v_mfma_f32_32x32x16_bf16 v[56:71],a[12:15],v[28:31],v[56:71]
ds_read_b128 v[24:27],v16 offset:4096
s_add_u32 s82,s82,589824
s_lshl_b32 s70,s56,2
s_add_u32 s82,s82,s70
s_waitcnt lgkmcnt(5)
v_mfma_f32_32x32x16_bf16 v[56:71],a[48:51],v[32:35],v[56:71]
ds_read_b128 v[28:31],v17 offset:4096
v_mfma_f32_32x32x16_bf16 v[56:71],a[52:55],v[36:39],v[56:71]
ds_read_b128 v[32:35],v16 offset:14336
s_waitcnt lgkmcnt(5)
v_mfma_f32_32x32x16_bf16 v[56:71],a[88:91],v[40:43],v[56:71]
ds_read_b128 v[36:39],v17 offset:14336
s_waitcnt vmcnt(0)
s_mov_b64 exec,1
s_cmp_lg_u32 s49,0
s_cbranch_scc0 ls_316
buffer_store_dword v5,v1,s[8:11],s59 offen sc1
s_branch ls_317
ls_316:
buffer_store_dword v5,v1,s[8:11],s59 offen
ls_317:
s_mov_b64 exec,-1
s_mov_b32 s59,2147483648
v_mfma_f32_32x32x16_bf16 v[56:71],a[92:95],v[44:47],v[56:71]
ds_read_b128 v[40:43],v16 offset:24576
v_cmp_eq_u32 vcc,0,v3
s_and_b64 vcc,vcc,s[76:77]
s_cselect_b32 s37,2147483648,0
s_waitcnt lgkmcnt(5)
v_mfma_f32_32x32x16_bf16 v[56:71],a[128:131],v[48:51],v[56:71]
ds_read_b128 v[44:47],v17 offset:24576
s_cmp_lt_u32 s32,128
s_cselect_b32 s37,s37,2147483648
s_sub_u32 s66,46080,s57
s_mul_i32 s60,s33,8
v_mfma_f32_32x32x16_bf16 v[56:71],a[132:135],v[52:55],v[56:71]
ds_read_b128 v[48:51],v16 offset:34816
s_and_b32 s61,s34,7
s_add_u32 s60,s60,s61
s_mul_i32 s60,s60,46080
s_waitcnt lgkmcnt(5)
v_mfma_f32_32x32x16_bf16 v[56:71],a[16:19],v[24:27],v[56:71]
ds_read_b128 v[52:55],v17 offset:34816
s_add_u32 s60,s60,s37
s_add_u32 s60,s60,212467712
s_mov_b32 s67,s60
s_mul_i32 s61,s46,10240
s_barrier
v_mfma_f32_32x32x16_bf16 v[56:71],a[20:23],v[28:31],v[56:71]
ds_read_b128 v[24:27],v16 offset:6144
v_add_u32 v183,s57,v182
s_add_u32 s60,s60,s61
s_add_u32 s61,s61,s66
s_waitcnt lgkmcnt(5)
v_mfma_f32_32x32x16_bf16 v[56:71],a[56:59],v[32:35],v[56:71]
ds_read_b128 v[28:31],v17 offset:6144
v_add_u32 v8,0x800,v183
s_add_u32 m0,s61,0
s_add_u32 s63,s60,0
v_mfma_f32_32x32x16_bf16 v[56:71],a[60:63],v[36:39],v[56:71]
ds_read_b128 v[32:35],v16 offset:16384
ds_read2_b64 v[160:163],v183 offset0:0 offset1:32
s_waitcnt lgkmcnt(6)
v_mfma_f32_32x32x16_bf16 v[56:71],a[96:99],v[40:43],v[56:71]
ds_read_b128 v[36:39],v17 offset:16384
ds_read2_b64 v[164:167],v183 offset0:64 offset1:96
buffer_load_dwordx4 v1,s[8:11],s63 offen sc1 lds
v_mfma_f32_32x32x16_bf16 v[56:71],a[100:103],v[44:47],v[56:71]
ds_read_b128 v[40:43],v16 offset:26624
ds_read2_b64 v[168:171],v183 offset0:128 offset1:160
s_waitcnt lgkmcnt(8)
v_mfma_f32_32x32x16_bf16 v[56:71],a[136:139],v[48:51],v[56:71]
ds_read_b128 v[44:47],v17 offset:26624
ds_read2_b64 v[172:175],v183 offset0:192 offset1:224
buffer_load_dwordx4 v1,s[8:11],s63 offen offset:1024 sc1 lds
v_mfma_f32_32x32x16_bf16 v[56:71],a[140:143],v[52:55],v[56:71]
ds_read_b128 v[48:51],v16 offset:36864
ds_read2_b64 v[176:179],v8 offset0:0 offset1:32
s_waitcnt lgkmcnt(10)
v_mfma_f32_32x32x16_bf16 v[56:71],a[24:27],v[24:27],v[56:71]
ds_read_b128 v[52:55],v17 offset:36864
buffer_load_dwordx4 v1,s[8:11],s63 offen offset:2048 sc1 lds
v_mfma_f32_32x32x16_bf16 v[56:71],a[28:31],v[28:31],v[56:71]
ds_read_b128 v[24:27],v16 offset:8192
s_waitcnt lgkmcnt(9)
v_mfma_f32_32x32x16_bf16 v[56:71],a[64:67],v[32:35],v[56:71]
ds_read_b128 v[28:31],v17 offset:8192
buffer_load_dwordx4 v1,s[8:11],s63 offen offset:3072 sc1 lds
s_add_u32 m0,s61,4096
s_add_u32 s63,s60,4096
v_mfma_f32_32x32x16_bf16 v[56:71],a[68:71],v[36:39],v[56:71]
ds_read_b128 v[32:35],v16 offset:18432
s_waitcnt lgkmcnt(4)
v_add_f32 v160,v160,v170
v_add_f32 v161,v161,v171
v_mfma_f32_32x32x16_bf16 v[56:71],a[104:107],v[40:43],v[56:71]
ds_read_b128 v[36:39],v17 offset:18432
buffer_load_dwordx4 v1,s[8:11],s63 offen sc1 lds
v_add_f32 v162,v162,v172
v_add_f32 v163,v163,v173
v_mfma_f32_32x32x16_bf16 v[56:71],a[108:111],v[44:47],v[56:71]
ds_read_b128 v[40:43],v16 offset:28672
v_add_f32 v164,v164,v174
v_add_f32 v165,v165,v175
v_add_f32 v166,v166,v176
s_waitcnt lgkmcnt(5)
v_mfma_f32_32x32x16_bf16 v[56:71],a[144:147],v[48:51],v[56:71]
ds_read_b128 v[44:47],v17 offset:28672
buffer_load_dword v3,v2,s[8:11],s35 offen sc1
v_add_f32 v167,v167,v177
v_mfma_f32_32x32x16_bf16 v[56:71],a[148:151],v[52:55],v[56:71]
ds_read_b128 v[48:51],v16 offset:38912
buffer_load_dwordx4 v1,s[8:11],s63 offen offset:1024 sc1 lds
v_add_f32 v168,v168,v178
s_waitcnt lgkmcnt(5)
v_mfma_f32_32x32x16_bf16 v[56:71],a[32:35],v[24:27],v[56:71]
ds_read_b128 v[52:55],v17 offset:38912
v_add_f32 v169,v169,v179
v_add_f32 v160,v160,v162
v_add_f32 v161,v161,v163
v_add_f32 v164,v164,v166
v_mfma_f32_32x32x16_bf16 v[56:71],a[36:39],v[28:31],v[56:71]
buffer_load_dwordx4 v1,s[8:11],s63 offen offset:2048 sc1 lds
v_add_f32 v165,v165,v167
v_add_f32 v160,v160,v164
v_add_f32 v161,v161,v165
s_waitcnt lgkmcnt(4)
v_mfma_f32_32x32x16_bf16 v[56:71],a[72:75],v[32:35],v[56:71]
v_add_f32 v160,v160,v168
v_add_f32 v161,v161,v169
v_mov_b32 v162,v160
v_mov_b32 v163,v161
s_nop 0
v_permlane32_swap_b32 v160,v162
v_mfma_f32_32x32x16_bf16 v[56:71],a[76:79],v[36:39],v[56:71]
buffer_load_dwordx4 v1,s[8:11],s63 offen offset:3072 sc1 lds
s_add_u32 m0,s61,8192
s_add_u32 s63,s60,8192
v_permlane32_swap_b32 v161,v163
s_waitcnt lgkmcnt(2)
v_mfma_f32_32x32x16_bf16 v[56:71],a[112:115],v[40:43],v[56:71]
v_add_f32 v180,v160,v162
v_add_f32 v181,v161,v163
v_mul_f32 v180,0x3acccccd,v180
v_mul_f32 v181,0x3acccccd,v181
v_fma_f32 v181,-v180,v180,v181
v_mfma_f32_32x32x16_bf16 v[56:71],a[116:119],v[44:47],v[56:71]
buffer_load_dwordx4 v1,s[8:11],s63 offen sc1 lds
v_max_f32 v181,0,v181
v_cvt_pk_bf16_f32 v8,v180,v181
v_lshlrev_b32 v180,16,v8
s_waitcnt lgkmcnt(0)
v_mfma_f32_32x32x16_bf16 v[56:71],a[152:155],v[48:51],v[56:71]
v_and_b32 v181,0xffff0000,v8
v_add_f32 v181,0x3727c5ac,v181
v_cvt_pk_bf16_f32 v8,v181,v181
v_lshlrev_b32 v181,16,v8
v_sqrt_f32 v181,v181
v_mfma_f32_32x32x16_bf16 v[56:71],a[156:159],v[52:55],v[56:71]
buffer_load_dwordx4 v1,s[8:11],s63 offen offset:1024 sc1 lds
s_lshl_b32 s62,s46,10
s_add_u32 s62,s62,40960
s_add_u32 m0,s66,s62
s_add_u32 s63,s67,s62
buffer_load_dwordx4 v1,s[8:11],s63 offen sc1 lds
s_add_u32 m0,s66,45056
s_add_u32 s63,s67,45056
buffer_load_dwordx4 v1,s[8:11],s63 offen sc1 lds
v_cvt_pk_bf16_f32 v8,v181,v181
v_lshlrev_b32 v181,16,v8
v_rcp_f32 v181,v181
s_cmp_eq_u32 s37,0
s_cbranch_scc0 sec_320
s_mov_b32 s35,s42
s_mov_b32 s53,s33
s_mov_b32 s54,s34
s_add_u32 s32,s32,1
s_mov_b32 s33,s40
s_mov_b32 s34,s41
s_mov_b64 s[76:77],s[80:81]
s_nop 2
ep_318:
v_pk_fma_f32 v[56:57],v[144:145],v[180:181],v[56:57] op_sel_hi:[1,0,1] neg_lo:[0,1,0] neg_hi:[0,1,0]
v_pk_fma_f32 v[58:59],v[146:147],v[180:181],v[58:59] op_sel_hi:[1,0,1] neg_lo:[0,1,0] neg_hi:[0,1,0]
v_pk_fma_f32 v[60:61],v[148:149],v[180:181],v[60:61] op_sel_hi:[1,0,1] neg_lo:[0,1,0] neg_hi:[0,1,0]
v_pk_fma_f32 v[62:63],v[150:151],v[180:181],v[62:63] op_sel_hi:[1,0,1] neg_lo:[0,1,0] neg_hi:[0,1,0]
v_pk_fma_f32 v[64:65],v[152:153],v[180:181],v[64:65] op_sel_hi:[1,0,1] neg_lo:[0,1,0] neg_hi:[0,1,0]
v_pk_fma_f32 v[66:67],v[154:155],v[180:181],v[66:67] op_sel_hi:[1,0,1] neg_lo:[0,1,0] neg_hi:[0,1,0]
v_pk_fma_f32 v[68:69],v[156:157],v[180:181],v[68:69] op_sel_hi:[1,0,1] neg_lo:[0,1,0] neg_hi:[0,1,0]
v_pk_fma_f32 v[70:71],v[158:159],v[180:181],v[70:71] op_sel_hi:[1,0,1] neg_lo:[0,1,0] neg_hi:[0,1,0]
v_pk_mul_f32 v[56:57],v[56:57],v[180:181] op_sel:[0,1] op_sel_hi:[1,1]
v_pk_mul_f32 v[58:59],v[58:59],v[180:181] op_sel:[0,1] op_sel_hi:[1,1]
v_pk_mul_f32 v[60:61],v[60:61],v[180:181] op_sel:[0,1] op_sel_hi:[1,1]
v_pk_mul_f32 v[62:63],v[62:63],v[180:181] op_sel:[0,1] op_sel_hi:[1,1]
v_pk_mul_f32 v[64:65],v[64:65],v[180:181] op_sel:[0,1] op_sel_hi:[1,1]
v_pk_mul_f32 v[66:67],v[66:67],v[180:181] op_sel:[0,1] op_sel_hi:[1,1]
v_pk_mul_f32 v[68:69],v[68:69],v[180:181] op_sel:[0,1] op_sel_hi:[1,1]
v_pk_mul_f32 v[70:71],v[70:71],v[180:181] op_sel:[0,1] op_sel_hi:[1,1]
v_pk_mul_f32 v[124:125],v[56:57],v[56:57]
v_pk_mul_f32 v[126:127],v[58:59],v[58:59]
v_pk_mul_f32 v[128:129],v[60:61],v[60:61]
v_pk_mul_f32 v[130:131],v[62:63],v[62:63]
v_pk_mul_f32 v[132:133],v[64:65],v[64:65]
v_pk_mul_f32 v[134:135],v[66:67],v[66:67]
v_pk_mul_f32 v[136:137],v[68:69],v[68:69]
v_pk_mul_f32 v[138:139],v[70:71],v[70:71]
v_pk_fma_f32 v[124:125],v[124:125],v[112:113],v[112:113] op_sel:[0,1,0] op_sel_hi:[1,1,0]
v_pk_fma_f32 v[126:127],v[126:127],v[112:113],v[112:113] op_sel:[0,1,0] op_sel_hi:[1,1,0]
v_pk_fma_f32 v[128:129],v[128:129],v[112:113],v[112:113] op_sel:[0,1,0] op_sel_hi:[1,1,0]
v_pk_fma_f32 v[130:131],v[130:131],v[112:113],v[112:113] op_sel:[0,1,0] op_sel_hi:[1,1,0]
v_pk_fma_f32 v[132:133],v[132:133],v[112:113],v[112:113] op_sel:[0,1,0] op_sel_hi:[1,1,0]
v_pk_fma_f32 v[134:135],v[134:135],v[112:113],v[112:113] op_sel:[0,1,0] op_sel_hi:[1,1,0]
v_pk_fma_f32 v[136:137],v[136:137],v[112:113],v[112:113] op_sel:[0,1,0] op_sel_hi:[1,1,0]
v_pk_fma_f32 v[138:139],v[138:139],v[112:113],v[112:113] op_sel:[0,1,0] op_sel_hi:[1,1,0]
v_pk_mul_f32 v[124:125],v[124:125],v[56:57]
v_pk_mul_f32 v[126:127],v[126:127],v[58:59]
v_pk_mul_f32 v[128:129],v[128:129],v[60:61]
v_pk_mul_f32 v[130:131],v[130:131],v[62:63]
v_pk_mul_f32 v[132:133],v[132:133],v[64:65]
v_pk_mul_f32 v[134:135],v[134:135],v[66:67]
v_pk_mul_f32 v[136:137],v[136:137],v[68:69]
v_pk_mul_f32 v[138:139],v[138:139],v[70:71]
v_exp_f32 v124,v124
v_exp_f32 v125,v125
v_exp_f32 v126,v126
v_exp_f32 v127,v127
v_exp_f32 v128,v128
v_exp_f32 v129,v129
v_exp_f32 v130,v130
v_exp_f32 v131,v131
v_exp_f32 v132,v132
v_exp_f32 v133,v133
v_exp_f32 v134,v134
v_exp_f32 v135,v135
v_exp_f32 v136,v136
v_exp_f32 v137,v137
v_exp_f32 v138,v138
v_exp_f32 v139,v139
v_pk_add_f32 v[124:125],v[124:125],1.0 op_sel_hi:[1,0]
v_pk_add_f32 v[126:127],v[126:127],1.0 op_sel_hi:[1,0]
v_pk_add_f32 v[128:129],v[128:129],1.0 op_sel_hi:[1,0]
v_pk_add_f32 v[130:131],v[130:131],1.0 op_sel_hi:[1,0]
v_pk_add_f32 v[132:133],v[132:133],1.0 op_sel_hi:[1,0]
v_pk_add_f32 v[134:135],v[134:135],1.0 op_sel_hi:[1,0]
v_pk_add_f32 v[136:137],v[136:137],1.0 op_sel_hi:[1,0]
v_pk_add_f32 v[138:139],v[138:139],1.0 op_sel_hi:[1,0]
v_rcp_f32 v124,v124
v_rcp_f32 v125,v125
v_rcp_f32 v126,v126
v_rcp_f32 v127,v127
v_rcp_f32 v128,v128
v_rcp_f32 v129,v129
v_rcp_f32 v130,v130
v_rcp_f32 v131,v131
v_rcp_f32 v132,v132
v_rcp_f32 v133,v133
v_rcp_f32 v134,v134
v_rcp_f32 v135,v135
v_rcp_f32 v136,v136
v_rcp_f32 v137,v137
v_rcp_f32 v138,v138
v_rcp_f32 v139,v139
v_pk_mul_f32 v[56:57],v[56:57],v[124:125]
v_pk_mul_f32 v[58:59],v[58:59],v[126:127]
v_pk_mul_f32 v[60:61],v[60:61],v[128:129]
v_pk_mul_f32 v[62:63],v[62:63],v[130:131]
v_pk_mul_f32 v[64:65],v[64:65],v[132:133]
v_pk_mul_f32 v[66:67],v[66:67],v[134:135]
v_pk_mul_f32 v[68:69],v[68:69],v[136:137]
v_pk_mul_f32 v[70:71],v[70:71],v[138:139]
v_cvt_pk_bf16_f32 v116,v56,v57
v_cvt_pk_bf16_f32 v117,v58,v59
v_cvt_pk_bf16_f32 v118,v60,v61
v_cvt_pk_bf16_f32 v119,v62,v63
v_cvt_pk_bf16_f32 v120,v64,v65
v_cvt_pk_bf16_f32 v121,v66,v67
v_cvt_pk_bf16_f32 v122,v68,v69
v_cvt_pk_bf16_f32 v123,v70,v71
s_cmp_lg_u32 s49,0
s_cbranch_scc0 ls_321
buffer_store_dwordx4 v[116:119],v20,s[8:11],s71 offen sc1
buffer_store_dwordx4 v[120:123],v21,s[8:11],s71 offen sc1
s_branch ls_322
ls_321:
buffer_store_dwordx4 v[116:119],v20,s[8:11],s71 offen
buffer_store_dwordx4 v[120:123],v21,s[8:11],s71 offen
ls_322:
s_mov_b32 s59,s82
s_cmp_eq_u32 s37,0
s_cbranch_scc1 W3_NEXT
s_waitcnt vmcnt(2)
v_cmp_eq_u32 vcc,0,v3
s_and_b64 vcc,vcc,s[76:77]
s_cselect_b32 s37,2147483648,0
s_cmp_lt_u32 s32,128
s_cselect_b32 s37,s37,2147483648
s_cmp_eq_u32 s37,0
s_cbranch_scc1 W3_COLD2
s_waitcnt vmcnt(0)
s_mov_b64 exec,1
s_cmp_lg_u32 s49,0
s_cbranch_scc0 ls_323
buffer_store_dword v5,v1,s[8:11],s59 offen sc1
s_branch ls_324
ls_323:
buffer_store_dword v5,v1,s[8:11],s59 offen
ls_324:
s_mov_b64 exec,-1
s_mov_b32 s59,2147483648
s_cmp_lt_u32 s32,128
s_cbranch_scc1 W3_COLD
s_branch W3_END
sec_320:
s_waitcnt vmcnt(7)
v_cmp_eq_u32 vcc,0,v3
s_and_b64 vcc,vcc,s[76:77]
s_cselect_b32 s37,2147483648,0
s_cmp_lt_u32 s32,128
s_cselect_b32 s37,s37,2147483648
s_cmp_lg_u32 s37,0
s_cbranch_scc1 nr_319
s_sub_u32 s66,46080,s57
s_mul_i32 s60,s33,8
s_and_b32 s61,s34,7
s_add_u32 s60,s60,s61
s_mul_i32 s60,s60,46080
s_add_u32 s60,s60,s37
s_add_u32 s60,s60,212467712
s_mov_b32 s67,s60
s_mul_i32 s61,s46,10240
s_add_u32 s60,s60,s61
s_add_u32 s61,s61,s66
s_add_u32 m0,s61,0
s_add_u32 s63,s60,0
buffer_load_dwordx4 v1,s[8:11],s63 offen sc1 lds
v_pk_fma_f32 v[56:57],v[144:145],v[180:181],v[56:57] op_sel_hi:[1,0,1] neg_lo:[0,1,0] neg_hi:[0,1,0]
v_pk_fma_f32 v[58:59],v[146:147],v[180:181],v[58:59] op_sel_hi:[1,0,1] neg_lo:[0,1,0] neg_hi:[0,1,0]
v_pk_fma_f32 v[60:61],v[148:149],v[180:181],v[60:61] op_sel_hi:[1,0,1] neg_lo:[0,1,0] neg_hi:[0,1,0]
v_pk_fma_f32 v[62:63],v[150:151],v[180:181],v[62:63] op_sel_hi:[1,0,1] neg_lo:[0,1,0] neg_hi:[0,1,0]
v_pk_fma_f32 v[64:65],v[152:153],v[180:181],v[64:65] op_sel_hi:[1,0,1] neg_lo:[0,1,0] neg_hi:[0,1,0]
v_pk_fma_f32 v[66:67],v[154:155],v[180:181],v[66:67] op_sel_hi:[1,0,1] neg_lo:[0,1,0] neg_hi:[0,1,0]
v_pk_fma_f32 v[68:69],v[156:157],v[180:181],v[68:69] op_sel_hi:[1,0,1] neg_lo:[0,1,0] neg_hi:[0,1,0]
buffer_load_dwordx4 v1,s[8:11],s63 offen offset:1024 sc1 lds
v_pk_fma_f32 v[70:71],v[158:159],v[180:181],v[70:71] op_sel_hi:[1,0,1] neg_lo:[0,1,0] neg_hi:[0,1,0]
v_pk_mul_f32 v[56:57],v[56:57],v[180:181] op_sel:[0,1] op_sel_hi:[1,1]
v_pk_mul_f32 v[58:59],v[58:59],v[180:181] op_sel:[0,1] op_sel_hi:[1,1]
v_pk_mul_f32 v[60:61],v[60:61],v[180:181] op_sel:[0,1] op_sel_hi:[1,1]
v_pk_mul_f32 v[62:63],v[62:63],v[180:181] op_sel:[0,1] op_sel_hi:[1,1]
v_pk_mul_f32 v[64:65],v[64:65],v[180:181] op_sel:[0,1] op_sel_hi:[1,1]
v_pk_mul_f32 v[66:67],v[66:67],v[180:181] op_sel:[0,1] op_sel_hi:[1,1]
buffer_load_dwordx4 v1,s[8:11],s63 offen offset:2048 sc1 lds
v_pk_mul_f32 v[68:69],v[68:69],v[180:181] op_sel:[0,1] op_sel_hi:[1,1]
v_pk_mul_f32 v[70:71],v[70:71],v[180:181] op_sel:[0,1] op_sel_hi:[1,1]
v_pk_mul_f32 v[124:125],v[56:57],v[56:57]
v_pk_mul_f32 v[126:127],v[58:59],v[58:59]
v_pk_mul_f32 v[128:129],v[60:61],v[60:61]
v_pk_mul_f32 v[130:131],v[62:63],v[62:63]
v_pk_mul_f32 v[132:133],v[64:65],v[64:65]
buffer_load_dwordx4 v1,s[8:11],s63 offen offset:3072 sc1 lds
v_pk_mul_f32 v[134:135],v[66:67],v[66:67]
v_pk_mul_f32 v[136:137],v[68:69],v[68:69]
v_pk_mul_f32 v[138:139],v[70:71],v[70:71]
v_pk_fma_f32 v[124:125],v[124:125],v[112:113],v[112:113] op_sel:[0,1,0] op_sel_hi:[1,1,0]
v_pk_fma_f32 v[126:127],v[126:127],v[112:113],v[112:113] op_sel:[0,1,0] op_sel_hi:[1,1,0]
v_pk_fma_f32 v[128:129],v[128:129],v[112:113],v[112:113] op_sel:[0,1,0] op_sel_hi:[1,1,0]
v_pk_fma_f32 v[130:131],v[130:131],v[112:113],v[112:113] op_sel:[0,1,0] op_sel_hi:[1,1,0]
s_add_u32 m0,s61,4096
s_add_u32 s63,s60,4096
buffer_load_dwordx4 v1,s[8:11],s63 offen sc1 lds
v_pk_fma_f32 v[132:133],v[132:133],v[112:113],v[112:113] op_sel:[0,1,0] op_sel_hi:[1,1,0]
v_pk_fma_f32 v[134:135],v[134:135],v[112:113],v[112:113] op_sel:[0,1,0] op_sel_hi:[1,1,0]
v_pk_fma_f32 v[136:137],v[136:137],v[112:113],v[112:113] op_sel:[0,1,0] op_sel_hi:[1,1,0]
v_pk_fma_f32 v[138:139],v[138:139],v[112:113],v[112:113] op_sel:[0,1,0] op_sel_hi:[1,1,0]
v_pk_mul_f32 v[124:125],v[124:125],v[56:57]
v_pk_mul_f32 v[126:127],v[126:127],v[58:59]
v_pk_mul_f32 v[128:129],v[128:129],v[60:61]
buffer_load_dwordx4 v1,s[8:11],s63 offen offset:1024 sc1 lds
v_pk_mul_f32 v[130:131],v[130:131],v[62:63]
v_pk_mul_f32 v[132:133],v[132:133],v[64:65]
v_pk_mul_f32 v[134:135],v[134:135],v[66:67]
v_pk_mul_f32 v[136:137],v[136:137],v[68:69]
v_pk_mul_f32 v[138:139],v[138:139],v[70:71]
v_exp_f32 v124,v124
v_exp_f32 v125,v125
buffer_load_dwordx4 v1,s[8:11],s63 offen offset:2048 sc1 lds
v_exp_f32 v126,v126
v_exp_f32 v127,v127
v_exp_f32 v128,v128
v_exp_f32 v129,v129
v_exp_f32 v130,v130
v_exp_f32 v131,v131
v_exp_f32 v132,v132
buffer_load_dwordx4 v1,s[8:11],s63 offen offset:3072 sc1 lds
v_exp_f32 v133,v133
v_exp_f32 v134,v134
v_exp_f32 v135,v135
v_exp_f32 v136,v136
v_exp_f32 v137,v137
v_exp_f32 v138,v138
v_exp_f32 v139,v139
s_add_u32 m0,s61,8192
s_add_u32 s63,s60,8192
buffer_load_dwordx4 v1,s[8:11],s63 offen sc1 lds
v_pk_add_f32 v[124:125],v[124:125],1.0 op_sel_hi:[1,0]
v_pk_add_f32 v[126:127],v[126:127],1.0 op_sel_hi:[1,0]
v_pk_add_f32 v[128:129],v[128:129],1.0 op_sel_hi:[1,0]
v_pk_add_f32 v[130:131],v[130:131],1.0 op_sel_hi:[1,0]
v_pk_add_f32 v[132:133],v[132:133],1.0 op_sel_hi:[1,0]
v_pk_add_f32 v[134:135],v[134:135],1.0 op_sel_hi:[1,0]
v_pk_add_f32 v[136:137],v[136:137],1.0 op_sel_hi:[1,0]
buffer_load_dwordx4 v1,s[8:11],s63 offen offset:1024 sc1 lds
v_pk_add_f32 v[138:139],v[138:139],1.0 op_sel_hi:[1,0]
v_rcp_f32 v124,v124
v_rcp_f32 v125,v125
v_rcp_f32 v126,v126
v_rcp_f32 v127,v127
v_rcp_f32 v128,v128
v_rcp_f32 v129,v129
s_lshl_b32 s62,s46,10
s_add_u32 s62,s62,40960
s_add_u32 m0,s66,s62
s_add_u32 s63,s67,s62
buffer_load_dwordx4 v1,s[8:11],s63 offen sc1 lds
v_rcp_f32 v130,v130
v_rcp_f32 v131,v131
v_rcp_f32 v132,v132
v_rcp_f32 v133,v133
v_rcp_f32 v134,v134
v_rcp_f32 v135,v135
v_rcp_f32 v136,v136
s_add_u32 m0,s66,45056
s_add_u32 s63,s67,45056
buffer_load_dwordx4 v1,s[8:11],s63 offen sc1 lds
v_rcp_f32 v137,v137
v_rcp_f32 v138,v138
v_rcp_f32 v139,v139
v_pk_mul_f32 v[56:57],v[56:57],v[124:125]
v_pk_mul_f32 v[58:59],v[58:59],v[126:127]
v_pk_mul_f32 v[60:61],v[60:61],v[128:129]
v_pk_mul_f32 v[62:63],v[62:63],v[130:131]
s_mov_b32 s35,s42
s_mov_b32 s53,s33
s_mov_b32 s54,s34
s_add_u32 s32,s32,1
s_mov_b32 s33,s40
s_mov_b32 s34,s41
s_mov_b64 s[76:77],s[80:81]
v_pk_mul_f32 v[64:65],v[64:65],v[132:133]
v_pk_mul_f32 v[66:67],v[66:67],v[134:135]
v_pk_mul_f32 v[68:69],v[68:69],v[136:137]
v_pk_mul_f32 v[70:71],v[70:71],v[138:139]
v_cvt_pk_bf16_f32 v116,v56,v57
v_cvt_pk_bf16_f32 v117,v58,v59
v_cvt_pk_bf16_f32 v118,v60,v61
v_cvt_pk_bf16_f32 v119,v62,v63
v_cvt_pk_bf16_f32 v120,v64,v65
v_cvt_pk_bf16_f32 v121,v66,v67
v_cvt_pk_bf16_f32 v122,v68,v69
v_cvt_pk_bf16_f32 v123,v70,v71
s_cmp_lg_u32 s49,0
s_cbranch_scc0 ls_325
buffer_store_dwordx4 v[116:119],v20,s[8:11],s71 offen sc1
buffer_store_dwordx4 v[120:123],v21,s[8:11],s71 offen sc1
s_branch ls_326
ls_325:
buffer_store_dwordx4 v[116:119],v20,s[8:11],s71 offen
buffer_store_dwordx4 v[120:123],v21,s[8:11],s71 offen
ls_326:
s_mov_b32 s59,s82
s_branch W3_NEXT
nr_319:
buffer_load_dword v3,v2,s[8:11],s35 offen sc1
s_branch ep_318
W3_END:
s_endpgm
ROLE_W4:
v_lshlrev_b32 v1,4,v0
v_mov_b32 v5,1
s_lshl_b32 s56,s48,2
s_add_u32 s56,s56,s46
v_bfe_u32 v6,v0,2,2
v_lshrrev_b32 v7,4,v0
v_add_u32 v7,v6,v7
v_and_b32 v7,3,v7
v_and_b32 v15,3,v0
v_lshlrev_b32 v15,4,v15
v_lshl_add_u32 v15,v7,6,v15
v_lshl_add_u32 v15,v6,8,v15
v_lshrrev_b32 v6,5,v0
v_bfe_u32 v7,v0,4,1
v_lshlrev_b32 v208,10,v7
v_lshl_add_u32 v208,v6,8,v208
v_and_b32 v6,15,v0
v_lshl_add_u32 v208,v6,4,v208
v_lshrrev_b32 v6,5,v0
v_add_u32 v6,2,v6
v_bfe_u32 v7,v0,4,1
v_lshlrev_b32 v209,10,v7
v_lshl_add_u32 v209,v6,8,v209
v_and_b32 v6,15,v0
v_lshl_add_u32 v209,v6,4,v209
v_min_u32 v2,11,v0
s_mul_i32 s60,s46,12
v_add_u32 v2,s60,v2
v_lshlrev_b32 v2,2,v2
s_and_b32 s60,s46,1
s_lshl_b32 s68,s48,1
s_add_u32 s68,s68,s60
s_lshr_b32 s69,s46,1
s_mul_i32 s71,s46,24576
s_mul_i32 s58,s46,491520
s_lshl_b32 s61,s48,7
s_add_u32 s58,s58,s61
s_add_u32 s71,s71,242778112
v_and_b32 v6,15,v0
v_lshlrev_b32 v204,3,v6
s_lshl_b32 s60,s69,4
v_add_u32 v6,s60,v6
v_mul_u32_u24 v205,1280,v6
v_bfe_u32 v6,v0,4,1
v_lshl_add_u32 v205,v6,5,v205
v_lshrrev_b32 v6,5,v0
v_lshl_add_u32 v205,v6,4,v205
s_lshl_b32 s60,s68,6
v_add_u32 v205,s60,v205
s_mov_b32 s76,s40
s_mov_b32 s77,s41
s_mov_b32 s78,2621440
s_mov_b32 s79,0x20000
s_lshl_b32 s70,s68,1
s_add_u32 s70,s70,s69
s_lshl_b32 s70,s70,10
v_bfe_u32 v6,v0,4,1
v_lshlrev_b32 v206,14,v6
v_lshrrev_b32 v6,5,v0
v_lshl_add_u32 v206,v6,8,v206
v_and_b32 v6,15,v0
v_lshl_add_u32 v206,v6,4,v206
s_lshl_b32 s60,s46,11
v_add_u32 v206,s60,v206
s_lshl_b32 s60,s46,13
v_add_u32 v207,s60,v1
v_mov_b32 v24,-1
v_mov_b32 v25,-1
v_mov_b32 v26,-1
v_mov_b32 v27,-1
s_add_u32 s60,s48,22
s_lshl2_add_u32 s60,s60,s46
s_mul_i32 s60,s60,22528
s_add_u32 s61,s60,24117248
buffer_store_dwordx4 v[24:27],v1,s[8:11],s61 offen sc1
buffer_store_dwordx4 v[24:27],v1,s[8:11],s61 offen offset:1024 sc1
buffer_store_dwordx4 v[24:27],v1,s[8:11],s61 offen offset:2048 sc1
buffer_store_dwordx4 v[24:27],v1,s[8:11],s61 offen offset:3072 sc1
s_add_u32 s61,s60,24121344
buffer_store_dwordx4 v[24:27],v1,s[8:11],s61 offen sc1
buffer_store_dwordx4 v[24:27],v1,s[8:11],s61 offen offset:1024 sc1
buffer_store_dwordx4 v[24:27],v1,s[8:11],s61 offen offset:2048 sc1
buffer_store_dwordx4 v[24:27],v1,s[8:11],s61 offen offset:3072 sc1
s_add_u32 s61,s60,24125440
buffer_store_dwordx4 v[24:27],v1,s[8:11],s61 offen sc1
buffer_store_dwordx4 v[24:27],v1,s[8:11],s61 offen offset:1024 sc1
buffer_store_dwordx4 v[24:27],v1,s[8:11],s61 offen offset:2048 sc1
buffer_store_dwordx4 v[24:27],v1,s[8:11],s61 offen offset:3072 sc1
s_add_u32 s61,s60,24129536
buffer_store_dwordx4 v[24:27],v1,s[8:11],s61 offen sc1
buffer_store_dwordx4 v[24:27],v1,s[8:11],s61 offen offset:1024 sc1
buffer_store_dwordx4 v[24:27],v1,s[8:11],s61 offen offset:2048 sc1
buffer_store_dwordx4 v[24:27],v1,s[8:11],s61 offen offset:3072 sc1
s_add_u32 s61,s60,24133632
buffer_store_dwordx4 v[24:27],v1,s[8:11],s61 offen sc1
buffer_store_dwordx4 v[24:27],v1,s[8:11],s61 offen offset:1024 sc1
buffer_store_dwordx4 v[24:27],v1,s[8:11],s61 offen offset:2048 sc1
buffer_store_dwordx4 v[24:27],v1,s[8:11],s61 offen offset:3072 sc1
s_add_u32 s61,s60,24137728
buffer_store_dwordx4 v[24:27],v1,s[8:11],s61 offen sc1
buffer_store_dwordx4 v[24:27],v1,s[8:11],s61 offen offset:1024 sc1
s_waitcnt vmcnt(0)
s_barrier
s_cmp_lg_u32 s46,0
s_cbranch_scc1 arr_327
v_mov_b32 v6,1
s_lshl_b32 s3,s49,2
v_mov_b32 v7,s3
s_mov_b64 exec,1
buffer_atomic_add v6,v7,s[12:15],0 offen sc1
s_mov_b64 exec,-1
arr_327:
s_lshl_b32 s3,s49,2
v_mov_b32 v7,s3
s_nop 1
ibw_328:
buffer_load_dword v6,v7,s[12:15],0 offen sc1
s_waitcnt vmcnt(0)
v_cmp_ne_u32 vcc,256,v6
s_nop 0
s_cbranch_vccz ok_329
s_sleep 8
s_sub_u32 s47,s47,1
s_cbranch_scc1 ABORT
s_branch ibw_328
ok_329:
s_cmp_lg_u32 s49,0
s_cbranch_scc1 ibok_330
v_and_b32 v7,7,v0
v_lshlrev_b32 v7,2,v7
buffer_load_dword v6,v7,s[12:15],0 offen offset:32 sc1
s_waitcnt vmcnt(0)
v_cmp_ne_u32 vcc,32,v6
s_nop 0
s_cbranch_vccz ibok_330
s_barrier
s_mov_b32 s49,1
s_mov_b32 s3,s2
s_load_dwordx16 s[16:31],s[0:1],0
s_load_dwordx8 s[32:39],s[0:1],64
s_waitcnt lgkmcnt(0)
s_branch DISPATCH
ibok_330:
s_mul_i32 s63,s46,40960
s_mov_b32 s4,s38
s_mov_b32 s5,s39
s_mov_b32 s6,1966080
s_mov_b32 s7,0x20000
v_lshrrev_b32 v9,3,v0
s_mov_b32 s64,1280
v_mul_lo_u32 v9,v9,s64
v_and_b32 v10,7,v0
v_lshl_add_u32 v6,v10,4,v9
s_add_u32 m0,s63,0
s_add_u32 s65,s58,0
buffer_load_dwordx4 v6,s[4:7],s65 offen lds
s_add_u32 m0,s63,1024
s_add_u32 s65,s58,10240
buffer_load_dwordx4 v6,s[4:7],s65 offen lds
s_add_u32 m0,s63,2048
s_add_u32 s65,s58,20480
buffer_load_dwordx4 v6,s[4:7],s65 offen lds
s_add_u32 m0,s63,3072
s_add_u32 s65,s58,30720
buffer_load_dwordx4 v6,s[4:7],s65 offen lds
s_add_u32 m0,s63,4096
s_add_u32 s65,s58,40960
buffer_load_dwordx4 v6,s[4:7],s65 offen lds
s_add_u32 m0,s63,5120
s_add_u32 s65,s58,51200
buffer_load_dwordx4 v6,s[4:7],s65 offen lds
s_add_u32 m0,s63,6144
s_add_u32 s65,s58,61440
buffer_load_dwordx4 v6,s[4:7],s65 offen lds
s_add_u32 m0,s63,7168
s_add_u32 s65,s58,71680
buffer_load_dwordx4 v6,s[4:7],s65 offen lds
s_add_u32 m0,s63,8192
s_add_u32 s65,s58,81920
buffer_load_dwordx4 v6,s[4:7],s65 offen lds
s_add_u32 m0,s63,9216
s_add_u32 s65,s58,92160
buffer_load_dwordx4 v6,s[4:7],s65 offen lds
s_add_u32 m0,s63,10240
s_add_u32 s65,s58,102400
buffer_load_dwordx4 v6,s[4:7],s65 offen lds
s_add_u32 m0,s63,11264
s_add_u32 s65,s58,112640
buffer_load_dwordx4 v6,s[4:7],s65 offen lds
s_add_u32 m0,s63,12288
s_add_u32 s65,s58,122880
buffer_load_dwordx4 v6,s[4:7],s65 offen lds
s_add_u32 m0,s63,13312
s_add_u32 s65,s58,133120
buffer_load_dwordx4 v6,s[4:7],s65 offen lds
s_add_u32 m0,s63,14336
s_add_u32 s65,s58,143360
buffer_load_dwordx4 v6,s[4:7],s65 offen lds
s_add_u32 m0,s63,15360
s_add_u32 s65,s58,153600
buffer_load_dwordx4 v6,s[4:7],s65 offen lds
s_add_u32 m0,s63,16384
s_add_u32 s65,s58,163840
buffer_load_dwordx4 v6,s[4:7],s65 offen lds
s_add_u32 m0,s63,17408
s_add_u32 s65,s58,174080
buffer_load_dwordx4 v6,s[4:7],s65 offen lds
s_add_u32 m0,s63,18432
s_add_u32 s65,s58,184320
buffer_load_dwordx4 v6,s[4:7],s65 offen lds
s_add_u32 m0,s63,19456
s_add_u32 s65,s58,194560
buffer_load_dwordx4 v6,s[4:7],s65 offen lds
s_add_u32 m0,s63,20480
s_add_u32 s65,s58,204800
buffer_load_dwordx4 v6,s[4:7],s65 offen lds
s_add_u32 m0,s63,21504
s_add_u32 s65,s58,215040
buffer_load_dwordx4 v6,s[4:7],s65 offen lds
s_add_u32 m0,s63,22528
s_add_u32 s65,s58,225280
buffer_load_dwordx4 v6,s[4:7],s65 offen lds
s_add_u32 m0,s63,23552
s_add_u32 s65,s58,235520
buffer_load_dwordx4 v6,s[4:7],s65 offen lds
s_add_u32 m0,s63,24576
s_add_u32 s65,s58,245760
buffer_load_dwordx4 v6,s[4:7],s65 offen lds
s_add_u32 m0,s63,25600
s_add_u32 s65,s58,256000
buffer_load_dwordx4 v6,s[4:7],s65 offen lds
s_add_u32 m0,s63,26624
s_add_u32 s65,s58,266240
buffer_load_dwordx4 v6,s[4:7],s65 offen lds
s_add_u32 m0,s63,27648
s_add_u32 s65,s58,276480
buffer_load_dwordx4 v6,s[4:7],s65 offen lds
s_add_u32 m0,s63,28672
s_add_u32 s65,s58,286720
buffer_load_dwordx4 v6,s[4:7],s65 offen lds
s_add_u32 m0,s63,29696
s_add_u32 s65,s58,296960
buffer_load_dwordx4 v6,s[4:7],s65 offen lds
s_add_u32 m0,s63,30720
s_add_u32 s65,s58,307200
buffer_load_dwordx4 v6,s[4:7],s65 offen lds
s_add_u32 m0,s63,31744
s_add_u32 s65,s58,317440
buffer_load_dwordx4 v6,s[4:7],s65 offen lds
s_add_u32 m0,s63,32768
s_add_u32 s65,s58,327680
buffer_load_dwordx4 v6,s[4:7],s65 offen lds
s_add_u32 m0,s63,33792
s_add_u32 s65,s58,337920
buffer_load_dwordx4 v6,s[4:7],s65 offen lds
s_add_u32 m0,s63,34816
s_add_u32 s65,s58,348160
buffer_load_dwordx4 v6,s[4:7],s65 offen lds
s_add_u32 m0,s63,35840
s_add_u32 s65,s58,358400
buffer_load_dwordx4 v6,s[4:7],s65 offen lds
s_add_u32 m0,s63,36864
s_add_u32 s65,s58,368640
buffer_load_dwordx4 v6,s[4:7],s65 offen lds
s_add_u32 m0,s63,37888
s_add_u32 s65,s58,378880
buffer_load_dwordx4 v6,s[4:7],s65 offen lds
s_add_u32 m0,s63,38912
s_add_u32 s65,s58,389120
buffer_load_dwordx4 v6,s[4:7],s65 offen lds
s_add_u32 m0,s63,39936
s_add_u32 s65,s58,399360
buffer_load_dwordx4 v6,s[4:7],s65 offen lds
s_waitcnt vmcnt(20)
v_bfe_u32 v9,v0,2,2
v_lshrrev_b32 v10,5,v0
v_lshl_add_u32 v9,v10,2,v9
v_mul_u32_u24 v9,128,v9
v_and_b32 v10,1,v0
v_lshl_add_u32 v9,v10,3,v9
v_bfe_u32 v10,v0,1,1
v_lshl_add_u32 v9,v10,5,v9
v_bfe_u32 v10,v0,4,1
v_lshl_add_u32 v9,v10,4,v9
v_add_u32 v7,s63,v9
ds_read_b64_tr_b16 a[0:1],v7 offset:0
ds_read_b64_tr_b16 a[2:3],v7 offset:2048
ds_read_b64_tr_b16 a[4:5],v7 offset:1024
ds_read_b64_tr_b16 a[6:7],v7 offset:3072
ds_read_b64_tr_b16 a[96:97],v7 offset:64
ds_read_b64_tr_b16 a[98:99],v7 offset:2112
ds_read_b64_tr_b16 a[100:101],v7 offset:1088
ds_read_b64_tr_b16 a[102:103],v7 offset:3136
ds_read_b64_tr_b16 a[8:9],v7 offset:4096
ds_read_b64_tr_b16 a[10:11],v7 offset:6144
ds_read_b64_tr_b16 a[12:13],v7 offset:5120
ds_read_b64_tr_b16 a[14:15],v7 offset:7168
s_waitcnt lgkmcnt(4)
ds_read_b64_tr_b16 a[104:105],v7 offset:4160
ds_read_b64_tr_b16 a[106:107],v7 offset:6208
ds_read_b64_tr_b16 a[108:109],v7 offset:5184
ds_read_b64_tr_b16 a[110:111],v7 offset:7232
ds_read_b64_tr_b16 a[16:17],v7 offset:8192
ds_read_b64_tr_b16 a[18:19],v7 offset:10240
ds_read_b64_tr_b16 a[20:21],v7 offset:9216
ds_read_b64_tr_b16 a[22:23],v7 offset:11264
ds_read_b64_tr_b16 a[112:113],v7 offset:8256
ds_read_b64_tr_b16 a[114:115],v7 offset:10304
ds_read_b64_tr_b16 a[116:117],v7 offset:9280
ds_read_b64_tr_b16 a[118:119],v7 offset:11328
s_waitcnt lgkmcnt(4)
ds_read_b64_tr_b16 a[24:25],v7 offset:12288
ds_read_b64_tr_b16 a[26:27],v7 offset:14336
ds_read_b64_tr_b16 a[28:29],v7 offset:13312
ds_read_b64_tr_b16 a[30:31],v7 offset:15360
ds_read_b64_tr_b16 a[120:121],v7 offset:12352
ds_read_b64_tr_b16 a[122:123],v7 offset:14400
ds_read_b64_tr_b16 a[124:125],v7 offset:13376
ds_read_b64_tr_b16 a[126:127],v7 offset:15424
ds_read_b64_tr_b16 a[32:33],v7 offset:16384
ds_read_b64_tr_b16 a[34:35],v7 offset:18432
ds_read_b64_tr_b16 a[36:37],v7 offset:17408
ds_read_b64_tr_b16 a[38:39],v7 offset:19456
s_waitcnt lgkmcnt(4)
ds_read_b64_tr_b16 a[128:129],v7 offset:16448
ds_read_b64_tr_b16 a[130:131],v7 offset:18496
ds_read_b64_tr_b16 a[132:133],v7 offset:17472
ds_read_b64_tr_b16 a[134:135],v7 offset:19520
s_waitcnt lgkmcnt(0)
s_add_u32 m0,s63,0
s_add_u32 s65,s58,409600
buffer_load_dwordx4 v6,s[4:7],s65 offen lds
s_add_u32 m0,s63,1024
s_add_u32 s65,s58,419840
buffer_load_dwordx4 v6,s[4:7],s65 offen lds
s_add_u32 m0,s63,2048
s_add_u32 s65,s58,430080
buffer_load_dwordx4 v6,s[4:7],s65 offen lds
s_add_u32 m0,s63,3072
s_add_u32 s65,s58,440320
buffer_load_dwordx4 v6,s[4:7],s65 offen lds
s_add_u32 m0,s63,4096
s_add_u32 s65,s58,450560
buffer_load_dwordx4 v6,s[4:7],s65 offen lds
s_add_u32 m0,s63,5120
s_add_u32 s65,s58,460800
buffer_load_dwordx4 v6,s[4:7],s65 offen lds
s_add_u32 m0,s63,6144
s_add_u32 s65,s58,471040
buffer_load_dwordx4 v6,s[4:7],s65 offen lds
s_add_u32 m0,s63,7168
s_add_u32 s65,s58,481280
buffer_load_dwordx4 v6,s[4:7],s65 offen lds
s_waitcnt vmcnt(8)
v_bfe_u32 v9,v0,2,2
v_lshrrev_b32 v10,5,v0
v_lshl_add_u32 v9,v10,2,v9
v_mul_u32_u24 v9,128,v9
v_and_b32 v10,1,v0
v_lshl_add_u32 v9,v10,3,v9
v_bfe_u32 v10,v0,1,1
v_lshl_add_u32 v9,v10,5,v9
v_bfe_u32 v10,v0,4,1
v_lshl_add_u32 v9,v10,4,v9
v_add_u32 v7,s63,v9
ds_read_b64_tr_b16 a[40:41],v7 offset:20480
ds_read_b64_tr_b16 a[42:43],v7 offset:22528
ds_read_b64_tr_b16 a[44:45],v7 offset:21504
ds_read_b64_tr_b16 a[46:47],v7 offset:23552
ds_read_b64_tr_b16 a[136:137],v7 offset:20544
ds_read_b64_tr_b16 a[138:139],v7 offset:22592
ds_read_b64_tr_b16 a[140:141],v7 offset:21568
ds_read_b64_tr_b16 a[142:143],v7 offset:23616
ds_read_b64_tr_b16 a[48:49],v7 offset:24576
ds_read_b64_tr_b16 a[50:51],v7 offset:26624
ds_read_b64_tr_b16 a[52:53],v7 offset:25600
ds_read_b64_tr_b16 a[54:55],v7 offset:27648
s_waitcnt lgkmcnt(4)
ds_read_b64_tr_b16 a[144:145],v7 offset:24640
ds_read_b64_tr_b16 a[146:147],v7 offset:26688
ds_read_b64_tr_b16 a[148:149],v7 offset:25664
ds_read_b64_tr_b16 a[150:151],v7 offset:27712
ds_read_b64_tr_b16 a[56:57],v7 offset:28672
ds_read_b64_tr_b16 a[58:59],v7 offset:30720
ds_read_b64_tr_b16 a[60:61],v7 offset:29696
ds_read_b64_tr_b16 a[62:63],v7 offset:31744
ds_read_b64_tr_b16 a[152:153],v7 offset:28736
ds_read_b64_tr_b16 a[154:155],v7 offset:30784
ds_read_b64_tr_b16 a[156:157],v7 offset:29760
ds_read_b64_tr_b16 a[158:159],v7 offset:31808
s_waitcnt lgkmcnt(4)
ds_read_b64_tr_b16 a[64:65],v7 offset:32768
ds_read_b64_tr_b16 a[66:67],v7 offset:34816
ds_read_b64_tr_b16 a[68:69],v7 offset:33792
ds_read_b64_tr_b16 a[70:71],v7 offset:35840
ds_read_b64_tr_b16 a[160:161],v7 offset:32832
ds_read_b64_tr_b16 a[162:163],v7 offset:34880
ds_read_b64_tr_b16 a[164:165],v7 offset:33856
ds_read_b64_tr_b16 a[166:167],v7 offset:35904
ds_read_b64_tr_b16 a[72:73],v7 offset:36864
ds_read_b64_tr_b16 a[74:75],v7 offset:38912
ds_read_b64_tr_b16 a[76:77],v7 offset:37888
ds_read_b64_tr_b16 a[78:79],v7 offset:39936
s_waitcnt lgkmcnt(4)
ds_read_b64_tr_b16 a[168:169],v7 offset:36928
ds_read_b64_tr_b16 a[170:171],v7 offset:38976
ds_read_b64_tr_b16 a[172:173],v7 offset:37952
ds_read_b64_tr_b16 a[174:175],v7 offset:40000
s_waitcnt lgkmcnt(0)
s_waitcnt vmcnt(0)
v_bfe_u32 v9,v0,2,2
v_lshrrev_b32 v10,5,v0
v_lshl_add_u32 v9,v10,2,v9
v_mul_u32_u24 v9,128,v9
v_and_b32 v10,1,v0
v_lshl_add_u32 v9,v10,3,v9
v_bfe_u32 v10,v0,1,1
v_lshl_add_u32 v9,v10,5,v9
v_bfe_u32 v10,v0,4,1
v_lshl_add_u32 v9,v10,4,v9
v_add_u32 v7,s63,v9
ds_read_b64_tr_b16 a[80:81],v7 offset:0
ds_read_b64_tr_b16 a[82:83],v7 offset:2048
ds_read_b64_tr_b16 a[84:85],v7 offset:1024
ds_read_b64_tr_b16 a[86:87],v7 offset:3072
ds_read_b64_tr_b16 a[176:177],v7 offset:64
ds_read_b64_tr_b16 a[178:179],v7 offset:2112
ds_read_b64_tr_b16 a[180:181],v7 offset:1088
ds_read_b64_tr_b16 a[182:183],v7 offset:3136
ds_read_b64_tr_b16 a[88:89],v7 offset:4096
ds_read_b64_tr_b16 a[90:91],v7 offset:6144
ds_read_b64_tr_b16 a[92:93],v7 offset:5120
ds_read_b64_tr_b16 a[94:95],v7 offset:7168
s_waitcnt lgkmcnt(4)
ds_read_b64_tr_b16 a[184:185],v7 offset:4160
ds_read_b64_tr_b16 a[186:187],v7 offset:6208
ds_read_b64_tr_b16 a[188:189],v7 offset:5184
ds_read_b64_tr_b16 a[190:191],v7 offset:7232
s_waitcnt lgkmcnt(0)
s_barrier
s_mov_b32 s83,s100
s_mov_b32 s32,0
s_mov_b32 s59,2147483648
s_min_u32 s62,s32,127
s_sub_u32 s60,s62,18
s_lshr_b32 s34,s60,1
s_and_b32 s33,s60,1
s_cmp_eq_u32 s33,0
s_cselect_b32 s61,18,0
s_add_u32 s34,s34,s61
s_sub_u32 s61,s60,46
s_cmp_ge_u32 s60,92
s_cselect_b32 s34,s61,s34
s_cselect_b32 s33,1,s33
s_cmp_lt_u32 s62,18
s_cselect_b32 s34,s62,s34
s_cselect_b32 s33,0,s33
s_lshl_b32 s35,s33,6
s_add_u32 s35,s35,s34
s_lshl_b32 s35,s35,9
s_add_u32 s35,s35,589824
s_and_b32 s60,s34,3
s_lshl2_add_u32 s60,s33,s60
s_mul_i32 s73,s60,98304
s_add_u32 s73,s73,s71
s_add_u32 s62,s32,1
s_min_u32 s62,s62,127
s_sub_u32 s60,s62,18
s_lshr_b32 s29,s60,1
s_and_b32 s28,s60,1
s_cmp_eq_u32 s28,0
s_cselect_b32 s61,18,0
s_add_u32 s29,s29,s61
s_sub_u32 s61,s60,46
s_cmp_ge_u32 s60,92
s_cselect_b32 s29,s61,s29
s_cselect_b32 s28,1,s28
s_cmp_lt_u32 s62,18
s_cselect_b32 s29,s62,s29
s_cselect_b32 s28,0,s28
s_lshl_b32 s30,s28,6
s_add_u32 s30,s30,s29
s_lshl_b32 s30,s30,9
s_add_u32 s30,s30,589824
s_and_b32 s60,s29,3
s_lshl2_add_u32 s60,s28,s60
s_mul_i32 s31,s60,98304
s_add_u32 s31,s31,s71
W4_COLD:
buffer_load_dword v3,v2,s[8:11],s35 offen sc1
s_waitcnt vmcnt(1)
s_mov_b64 exec,1
buffer_store_dword v5,v1,s[8:11],s59 offen sc1
s_mov_b64 exec,-1
s_mov_b32 s59,2147483648
s_cmp_ge_u32 s32,128
s_cbranch_scc1 W4_END
s_waitcnt vmcnt(1)
v_cmp_eq_u32 vcc,0,v3
s_nop 0
s_cbranch_vccz W4_RDY
fb_331:
buffer_load_dword v3,v2,s[8:11],s35 offen sc1
s_waitcnt vmcnt(0)
v_cmp_eq_u32 vcc,0,v3
s_nop 0
s_cbranch_vccz ok_332
s_sleep 1
s_sub_u32 s47,s47,1
s_cbranch_scc1 ABORT
s_branch fb_331
ok_332:
W4_RDY:
s_add_u32 s63,s73,0
buffer_load_dwordx4 v[16:19],v1,s[8:11],s63 offen sc1
s_nop 7
buffer_load_dwordx4 v[20:23],v1,s[8:11],s63 offen offset:1024 sc1
s_nop 7
buffer_load_dwordx4 v[24:27],v1,s[8:11],s63 offen offset:2048 sc1
s_nop 7
buffer_load_dwordx4 v[28:31],v1,s[8:11],s63 offen offset:3072 sc1
s_nop 7
s_add_u32 s63,s73,4096
buffer_load_dwordx4 v[32:35],v1,s[8:11],s63 offen sc1
s_nop 7
buffer_load_dwordx4 v[36:39],v1,s[8:11],s63 offen offset:1024 sc1
s_nop 7
buffer_load_dwordx4 v[40:43],v1,s[8:11],s63 offen offset:2048 sc1
s_nop 7
buffer_load_dwordx4 v[44:47],v1,s[8:11],s63 offen offset:3072 sc1
W4_C:
s_mov_b32 s51,s33
s_mov_b32 s52,s34
s_mov_b32 s72,s73
s_add_u32 s32,s32,1
s_mov_b32 s33,s28
s_mov_b32 s34,s29
s_mov_b32 s35,s30
s_mov_b32 s73,s31
s_waitcnt vmcnt(7)
v_mfma_f32_32x32x16_bf16 v[112:127],a[0:3],v[16:19],0
s_add_u32 s63,s72,8192
buffer_load_dwordx4 v[48:51],v1,s[8:11],s63 offen sc1
v_xor_b32 v206,0x8000,v206
v_xor_b32 v207,0x8000,v207
s_lshl_b32 s64,s51,6
v_mfma_f32_32x32x16_bf16 v[128:143],a[96:99],v[16:19],0
s_add_u32 s64,s64,s52
s_and_b32 s65,s52,7
s_lshl3_add_u32 s65,s51,s65
s_mul_i32 s65,s65,46080
s_add_u32 s65,s65,s70
s_add_u32 s65,s65,212467712
s_waitcnt vmcnt(7)
v_mfma_f32_32x32x16_bf16 v[112:127],a[4:7],v[20:23],v[112:127]
buffer_load_dwordx4 v[52:55],v1,s[8:11],s63 offen offset:1024 sc1
buffer_load_dwordx4 v[176:179],v1,s[8:11],s65 offen sc1
s_mul_i32 s65,s64,40960
s_add_u32 s65,s65,s70
v_mfma_f32_32x32x16_bf16 v[128:143],a[100:103],v[20:23],v[128:143]
s_add_u32 s65,s65,218365952
s_mov_b32 s43,s65
s_lshl_b32 s82,s64,9
s_lshl2_add_u32 s82,s56,s82
s_add_u32 s42,s82,32768
s_add_u32 s82,s82,327680
s_waitcnt vmcnt(8)
v_mfma_f32_32x32x16_bf16 v[112:127],a[8:11],v[24:27],v[112:127]
buffer_load_dwordx4 v[56:59],v1,s[8:11],s63 offen offset:2048 sc1
s_mul_i32 s41,s52,46080
s_add_u32 s41,s41,209518592
s_add_u32 s40,s41,s70
s_lshr_b32 s64,s70,3
v_mfma_f32_32x32x16_bf16 v[128:143],a[104:107],v[24:27],v[128:143]
s_add_u32 s41,s41,s64
s_add_u32 s41,s41,40960
s_mul_i32 s64,s52,40960
s_cmp_lg_u32 s51,0
s_cselect_b32 s40,s64,s40
s_cselect_b32 s42,2147483648,s42
s_waitcnt vmcnt(8)
v_mfma_f32_32x32x16_bf16 v[112:127],a[12:15],v[28:31],v[112:127]
buffer_load_dwordx4 v[60:63],v1,s[8:11],s63 offen offset:3072 sc1
s_add_u32 s63,s72,12288
s_add_u32 s62,s32,1
s_min_u32 s62,s62,127
s_sub_u32 s60,s62,18
v_mfma_f32_32x32x16_bf16 v[128:143],a[108:111],v[28:31],v[128:143]
s_lshr_b32 s29,s60,1
s_and_b32 s28,s60,1
s_cmp_eq_u32 s28,0
s_cselect_b32 s61,18,0
s_add_u32 s29,s29,s61
s_sub_u32 s61,s60,46
s_waitcnt vmcnt(8)
v_mfma_f32_32x32x16_bf16 v[112:127],a[16:19],v[32:35],v[112:127]
buffer_load_dwordx4 v[64:67],v1,s[8:11],s63 offen sc1
s_cmp_ge_u32 s60,92
s_cselect_b32 s29,s61,s29
s_cselect_b32 s28,1,s28
v_mfma_f32_32x32x16_bf16 v[128:143],a[112:115],v[32:35],v[128:143]
s_cmp_lt_u32 s62,18
s_cselect_b32 s29,s62,s29
s_cselect_b32 s28,0,s28
s_lshl_b32 s30,s28,6
s_add_u32 s30,s30,s29
s_lshl_b32 s30,s30,9
s_waitcnt vmcnt(8)
v_mfma_f32_32x32x16_bf16 v[112:127],a[20:23],v[36:39],v[112:127]
buffer_load_dwordx4 v[68:71],v1,s[8:11],s63 offen offset:1024 sc1
s_add_u32 s30,s30,589824
s_and_b32 s60,s29,3
s_lshl2_add_u32 s60,s28,s60
s_mul_i32 s31,s60,98304
v_mfma_f32_32x32x16_bf16 v[128:143],a[116:119],v[36:39],v[128:143]
s_add_u32 s31,s31,s71
s_waitcnt vmcnt(8)
v_mfma_f32_32x32x16_bf16 v[112:127],a[24:27],v[40:43],v[112:127]
buffer_load_dwordx4 v[72:75],v1,s[8:11],s63 offen offset:2048 sc1
v_mfma_f32_32x32x16_bf16 v[128:143],a[120:123],v[40:43],v[128:143]
s_waitcnt vmcnt(8)
v_mfma_f32_32x32x16_bf16 v[112:127],a[28:31],v[44:47],v[112:127]
buffer_load_dwordx4 v[76:79],v1,s[8:11],s63 offen offset:3072 sc1
s_add_u32 s63,s72,16384
v_mfma_f32_32x32x16_bf16 v[128:143],a[124:127],v[44:47],v[128:143]
s_waitcnt vmcnt(8)
v_mfma_f32_32x32x16_bf16 v[112:127],a[32:35],v[48:51],v[112:127]
buffer_load_dwordx4 v[80:83],v1,s[8:11],s63 offen sc1
s_mov_b64 exec,1
buffer_store_dword v5,v1,s[8:11],s59 offen sc1
s_mov_b64 exec,-1
s_mov_b32 s59,2147483648
v_mfma_f32_32x32x16_bf16 v[128:143],a[128:131],v[48:51],v[128:143]
buffer_load_dword v3,v2,s[8:11],s35 offen sc1
s_waitcnt vmcnt(10)
v_mfma_f32_32x32x16_bf16 v[112:127],a[36:39],v[52:55],v[112:127]
buffer_load_dwordx4 v[84:87],v1,s[8:11],s63 offen offset:1024 sc1
v_mfma_f32_32x32x16_bf16 v[128:143],a[132:135],v[52:55],v[128:143]
s_waitcnt vmcnt(9)
v_mfma_f32_32x32x16_bf16 v[112:127],a[40:43],v[56:59],v[112:127]
buffer_load_dwordx4 v[88:91],v1,s[8:11],s63 offen offset:2048 sc1
v_mfma_f32_32x32x16_bf16 v[128:143],a[136:139],v[56:59],v[128:143]
s_waitcnt vmcnt(9)
v_mfma_f32_32x32x16_bf16 v[112:127],a[44:47],v[60:63],v[112:127]
buffer_load_dwordx4 v[92:95],v1,s[8:11],s63 offen offset:3072 sc1
s_add_u32 s63,s72,20480
v_mfma_f32_32x32x16_bf16 v[128:143],a[140:143],v[60:63],v[128:143]
s_waitcnt vmcnt(9)
v_mfma_f32_32x32x16_bf16 v[112:127],a[48:51],v[64:67],v[112:127]
buffer_load_dwordx4 v[96:99],v1,s[8:11],s63 offen sc1
v_mfma_f32_32x32x16_bf16 v[128:143],a[144:147],v[64:67],v[128:143]
s_waitcnt vmcnt(9)
v_mfma_f32_32x32x16_bf16 v[112:127],a[52:55],v[68:71],v[112:127]
buffer_load_dwordx4 v[100:103],v1,s[8:11],s63 offen offset:1024 sc1
v_mfma_f32_32x32x16_bf16 v[128:143],a[148:151],v[68:71],v[128:143]
s_waitcnt vmcnt(9)
v_mfma_f32_32x32x16_bf16 v[112:127],a[56:59],v[72:75],v[112:127]
buffer_load_dwordx4 v[104:107],v1,s[8:11],s63 offen offset:2048 sc1
v_mfma_f32_32x32x16_bf16 v[128:143],a[152:155],v[72:75],v[128:143]
s_waitcnt vmcnt(6)
v_cmp_eq_u32 vcc,0,v3
s_cmp_eq_u64 vcc,0
s_cselect_b32 s37,0,2147483648
s_cmp_lt_u32 s32,128
s_cselect_b32 s37,s37,2147483648
v_mfma_f32_32x32x16_bf16 v[112:127],a[60:63],v[76:79],v[112:127]
buffer_load_dwordx4 v[108:111],v1,s[8:11],s63 offen offset:3072 sc1
buffer_load_dwordx4 v[180:183],v15,s[8:11],s43 offen sc1
s_cmp_eq_u32 s37,0
v_mfma_f32_32x32x16_bf16 v[128:143],a[156:159],v[76:79],v[128:143]
s_cbranch_scc0 no_333
v_mfma_f32_32x32x16_bf16 v[112:127],a[64:67],v[80:83],v[112:127]
s_add_u32 s63,s73,0
buffer_load_dwordx4 v[16:19],v1,s[8:11],s63 offen sc1
v_mfma_f32_32x32x16_bf16 v[128:143],a[160:163],v[80:83],v[128:143]
s_waitcnt vmcnt(8)
v_mfma_f32_32x32x16_bf16 v[112:127],a[68:71],v[84:87],v[112:127]
buffer_load_dwordx4 v[20:23],v1,s[8:11],s63 offen offset:1024 sc1
v_mfma_f32_32x32x16_bf16 v[128:143],a[164:167],v[84:87],v[128:143]
s_waitcnt vmcnt(8)
v_mfma_f32_32x32x16_bf16 v[112:127],a[72:75],v[88:91],v[112:127]
buffer_load_dwordx4 v[24:27],v1,s[8:11],s63 offen offset:2048 sc1
v_mfma_f32_32x32x16_bf16 v[128:143],a[168:171],v[88:91],v[128:143]
v_lshlrev_b32 v184,16,v176
v_and_b32 v185,0xffff0000,v176
v_lshlrev_b32 v186,16,v177
v_and_b32 v187,0xffff0000,v177
v_lshlrev_b32 v188,16,v178
s_waitcnt vmcnt(8)
v_mfma_f32_32x32x16_bf16 v[112:127],a[76:79],v[92:95],v[112:127]
buffer_load_dwordx4 v[28:31],v1,s[8:11],s63 offen offset:3072 sc1
s_add_u32 s63,s73,4096
v_and_b32 v189,0xffff0000,v178
v_lshlrev_b32 v190,16,v179
v_and_b32 v191,0xffff0000,v179
v_mfma_f32_32x32x16_bf16 v[128:143],a[172:175],v[92:95],v[128:143]
s_waitcnt vmcnt(8)
v_mfma_f32_32x32x16_bf16 v[112:127],a[80:83],v[96:99],v[112:127]
buffer_load_dwordx4 v[32:35],v1,s[8:11],s63 offen sc1
s_waitcnt vmcnt(8)
v_mfma_f32_32x32x16_bf16 v[112:127],a[84:87],v[100:103],v[112:127]
s_waitcnt vmcnt(7)
v_mfma_f32_32x32x16_bf16 v[112:127],a[88:91],v[104:107],v[112:127]
buffer_load_dwordx4 v[36:39],v1,s[8:11],s63 offen offset:1024 sc1
s_waitcnt vmcnt(7)
v_mfma_f32_32x32x16_bf16 v[112:127],a[92:95],v[108:111],v[112:127]
v_mfma_f32_32x32x16_bf16 v[128:143],a[176:179],v[96:99],v[128:143]
buffer_load_dwordx4 v[40:43],v1,s[8:11],s63 offen offset:2048 sc1
s_mov_b64 exec,1
s_cmp_lg_u32 s49,0
s_cbranch_scc0 ls_334
buffer_store_dword v5,v1,s[8:11],s82 offen sc1
s_branch ls_335
ls_334:
buffer_store_dword v5,v1,s[8:11],s82 offen
ls_335:
s_mov_b64 exec,-1
v_mfma_f32_32x32x16_bf16 v[128:143],a[180:183],v[100:103],v[128:143]
ds_write_b128 v206,v[112:115] offset:0
ds_write_b128 v206,v[116:119] offset:1024
ds_write_b128 v206,v[120:123] offset:512
v_mfma_f32_32x32x16_bf16 v[128:143],a[184:187],v[104:107],v[128:143]
buffer_load_dwordx4 v[44:47],v1,s[8:11],s63 offen offset:3072 sc1
ds_write_b128 v206,v[124:127] offset:1536
v_mfma_f32_32x32x16_bf16 v[128:143],a[188:191],v[108:111],v[128:143]
buffer_load_dword v3,v2,s[8:11],s30 offen sc1
s_nop 5
s_branch W4_E1
no_333:
v_mfma_f32_32x32x16_bf16 v[112:127],a[64:67],v[80:83],v[112:127]
v_mfma_f32_32x32x16_bf16 v[128:143],a[160:163],v[80:83],v[128:143]
s_waitcnt vmcnt(7)
v_mfma_f32_32x32x16_bf16 v[112:127],a[68:71],v[84:87],v[112:127]
v_mfma_f32_32x32x16_bf16 v[128:143],a[164:167],v[84:87],v[128:143]
s_waitcnt vmcnt(6)
v_mfma_f32_32x32x16_bf16 v[112:127],a[72:75],v[88:91],v[112:127]
v_mfma_f32_32x32x16_bf16 v[128:143],a[168:171],v[88:91],v[128:143]
v_lshlrev_b32 v184,16,v176
v_and_b32 v185,0xffff0000,v176
v_lshlrev_b32 v186,16,v177
v_and_b32 v187,0xffff0000,v177
v_lshlrev_b32 v188,16,v178
s_waitcnt vmcnt(5)
v_mfma_f32_32x32x16_bf16 v[112:127],a[76:79],v[92:95],v[112:127]
buffer_load_dword v3,v2,s[8:11],s35 offen sc1
v_and_b32 v189,0xffff0000,v178
v_lshlrev_b32 v190,16,v179
v_and_b32 v191,0xffff0000,v179
v_mfma_f32_32x32x16_bf16 v[128:143],a[172:175],v[92:95],v[128:143]
s_waitcnt vmcnt(5)
v_mfma_f32_32x32x16_bf16 v[112:127],a[80:83],v[96:99],v[112:127]
s_waitcnt vmcnt(4)
v_mfma_f32_32x32x16_bf16 v[112:127],a[84:87],v[100:103],v[112:127]
s_waitcnt vmcnt(3)
v_mfma_f32_32x32x16_bf16 v[112:127],a[88:91],v[104:107],v[112:127]
s_waitcnt vmcnt(2)
v_mfma_f32_32x32x16_bf16 v[112:127],a[92:95],v[108:111],v[112:127]
v_mfma_f32_32x32x16_bf16 v[128:143],a[176:179],v[96:99],v[128:143]
s_mov_b64 exec,1
s_cmp_lg_u32 s49,0
s_cbranch_scc0 ls_336
buffer_store_dword v5,v1,s[8:11],s82 offen sc1
s_branch ls_337
ls_336:
buffer_store_dword v5,v1,s[8:11],s82 offen
ls_337:
s_mov_b64 exec,-1
v_mfma_f32_32x32x16_bf16 v[128:143],a[180:183],v[100:103],v[128:143]
ds_write_b128 v206,v[112:115] offset:0
ds_write_b128 v206,v[116:119] offset:1024
ds_write_b128 v206,v[120:123] offset:512
v_mfma_f32_32x32x16_bf16 v[128:143],a[184:187],v[104:107],v[128:143]
ds_write_b128 v206,v[124:127] offset:1536
v_mfma_f32_32x32x16_bf16 v[128:143],a[188:191],v[108:111],v[128:143]
s_waitcnt vmcnt(1)
v_cmp_eq_u32 vcc,0,v3
s_cmp_eq_u64 vcc,0
s_cselect_b32 s37,0,2147483648
s_cmp_lt_u32 s32,128
s_cselect_b32 s37,s37,2147483648
s_cmp_eq_u32 s37,0
s_cbranch_scc1 W4_E2
s_branch W4_E0
W4_E2:
s_add_u32 s63,s73,0
buffer_load_dwordx4 v[16:19],v1,s[8:11],s63 offen sc1
s_nop 2
ds_write_b128 v206,v[128:131] offset:8192
ds_write_b128 v206,v[132:135] offset:9216
buffer_load_dwordx4 v[20:23],v1,s[8:11],s63 offen offset:1024 sc1
ds_write_b128 v206,v[136:139] offset:8704
ds_write_b128 v206,v[140:143] offset:9728
buffer_load_dwordx4 v[24:27],v1,s[8:11],s63 offen offset:2048 sc1
s_waitcnt lgkmcnt(0)
s_barrier
ds_read_b128 v[144:147],v207 offset:0
ds_read_b128 v[148:151],v207 offset:1024
ds_read_b128 v[152:155],v207 offset:2048
ds_read_b128 v[156:159],v207 offset:3072
ds_read_b128 v[160:163],v207 offset:4096
ds_read_b128 v[164:167],v207 offset:5120
ds_read_b128 v[168:171],v207 offset:6144
ds_read_b128 v[172:175],v207 offset:7168
s_waitcnt vmcnt(43)
v_lshlrev_b32 v192,16,v180
v_and_b32 v193,0xffff0000,v180
v_lshlrev_b32 v194,16,v181
v_and_b32 v195,0xffff0000,v181
v_lshlrev_b32 v196,16,v182
v_and_b32 v197,0xffff0000,v182
v_lshlrev_b32 v198,16,v183
v_and_b32 v199,0xffff0000,v183
buffer_load_dwordx4 v[28:31],v1,s[8:11],s63 offen offset:3072 sc1
s_add_u32 s63,s73,4096
buffer_load_dwordx4 v[32:35],v1,s[8:11],s63 offen sc1
buffer_load_dwordx4 v[36:39],v1,s[8:11],s63 offen offset:1024 sc1
s_waitcnt lgkmcnt(4)
v_pk_add_f32 v[144:145],v[144:145],v[152:153]
v_pk_add_f32 v[146:147],v[146:147],v[154:155]
v_pk_add_f32 v[148:149],v[148:149],v[156:157]
v_pk_add_f32 v[150:151],v[150:151],v[158:159]
s_waitcnt lgkmcnt(0)
v_pk_add_f32 v[160:161],v[160:161],v[168:169]
v_pk_add_f32 v[162:163],v[162:163],v[170:171]
v_pk_add_f32 v[164:165],v[164:165],v[172:173]
v_pk_add_f32 v[166:167],v[166:167],v[174:175]
buffer_load_dwordx4 v[40:43],v1,s[8:11],s63 offen offset:2048 sc1
v_pk_add_f32 v[144:145],v[144:145],v[160:161]
v_pk_add_f32 v[146:147],v[146:147],v[162:163]
v_pk_add_f32 v[148:149],v[148:149],v[164:165]
v_pk_add_f32 v[150:151],v[150:151],v[166:167]
v_cvt_pk_bf16_f32 v6,v144,v145
v_lshlrev_b32 v144,16,v6
v_and_b32 v145,0xffff0000,v6
v_cvt_pk_bf16_f32 v6,v146,v147
v_lshlrev_b32 v146,16,v6
v_and_b32 v147,0xffff0000,v6
v_cvt_pk_bf16_f32 v6,v148,v149
v_lshlrev_b32 v148,16,v6
v_and_b32 v149,0xffff0000,v6
v_cvt_pk_bf16_f32 v6,v150,v151
v_lshlrev_b32 v150,16,v6
v_and_b32 v151,0xffff0000,v6
buffer_load_dwordx4 v[44:47],v1,s[8:11],s63 offen offset:3072 sc1
v_pk_add_f32 v[144:145],v[144:145],v[184:185]
v_pk_add_f32 v[146:147],v[146:147],v[186:187]
v_pk_add_f32 v[148:149],v[148:149],v[188:189]
v_pk_add_f32 v[150:151],v[150:151],v[190:191]
v_cvt_pk_bf16_f32 v6,v144,v145
v_lshlrev_b32 v144,16,v6
v_and_b32 v145,0xffff0000,v6
v_cvt_pk_bf16_f32 v6,v146,v147
v_lshlrev_b32 v146,16,v6
v_and_b32 v147,0xffff0000,v6
v_cvt_pk_bf16_f32 v6,v148,v149
v_lshlrev_b32 v148,16,v6
v_and_b32 v149,0xffff0000,v6
v_cvt_pk_bf16_f32 v6,v150,v151
v_lshlrev_b32 v150,16,v6
v_and_b32 v151,0xffff0000,v6
v_pk_add_f32 v[144:145],v[144:145],v[192:193]
v_pk_add_f32 v[146:147],v[146:147],v[194:195]
v_pk_add_f32 v[148:149],v[148:149],v[196:197]
v_pk_add_f32 v[150:151],v[150:151],v[198:199]
v_cvt_pk_bf16_f32 v200,v144,v145
v_cvt_pk_bf16_f32 v201,v146,v147
v_cvt_pk_bf16_f32 v202,v148,v149
v_cvt_pk_bf16_f32 v203,v150,v151
s_cmp_lg_u32 s51,0
s_cbranch_scc1 w4o_338
buffer_store_dwordx4 v[200:203],v15,s[8:11],s40 offen sc1
v_lshlrev_b32 v144,16,v200
v_and_b32 v145,0xffff0000,v200
v_lshlrev_b32 v146,16,v201
v_and_b32 v147,0xffff0000,v201
v_lshlrev_b32 v148,16,v202
v_and_b32 v149,0xffff0000,v202
v_lshlrev_b32 v150,16,v203
v_and_b32 v151,0xffff0000,v203
v_pk_add_f32 v[6:7],v[144:145],v[146:147]
v_pk_mul_f32 v[8:9],v[144:145],v[144:145]
v_pk_fma_f32 v[8:9],v[146:147],v[146:147],v[8:9]
v_pk_add_f32 v[6:7],v[6:7],v[148:149]
v_pk_fma_f32 v[8:9],v[148:149],v[148:149],v[8:9]
v_pk_add_f32 v[6:7],v[6:7],v[150:151]
v_pk_fma_f32 v[8:9],v[150:151],v[150:151],v[8:9]
v_add_f32 v6,v6,v7
v_add_f32 v7,v8,v9
s_nop 1
v_permlane32_swap_b32 v6,v7
v_add_f32 v6,v6,v7
v_mov_b32 v7,v6
s_nop 1
v_permlane16_swap_b32 v6,v7
v_add_f32 v6,v6,v7
v_mov_b32 v7,v6
s_nop 1
v_permlane32_swap_b32 v6,v7
s_mov_b64 exec,0xffff
buffer_store_dwordx2 v[6:7],v204,s[8:11],s41 offen sc1
s_mov_b64 exec,-1
s_branch w4n_339
w4o_338:
v_permlane16_swap_b32 v200,v202
v_permlane16_swap_b32 v201,v203
buffer_store_dwordx4 v[200:203],v205,s[76:79],s40 offen
s_mov_b64 exec,1
buffer_store_dword v5,v1,s[8:11],s42 offen
s_mov_b64 exec,-1
w4n_339:
s_mov_b32 s59,s42
s_branch W4_C
W4_E1:
s_add_u32 s63,s73,8192
buffer_load_dwordx4 v[48:51],v1,s[8:11],s63 offen sc1
s_nop 2
ds_write_b128 v206,v[128:131] offset:8192
ds_write_b128 v206,v[132:135] offset:9216
buffer_load_dwordx4 v[52:55],v1,s[8:11],s63 offen offset:1024 sc1
ds_write_b128 v206,v[136:139] offset:8704
ds_write_b128 v206,v[140:143] offset:9728
buffer_load_dwordx4 v[56:59],v1,s[8:11],s63 offen offset:2048 sc1
s_waitcnt lgkmcnt(0)
s_barrier
ds_read_b128 v[144:147],v207 offset:0
ds_read_b128 v[148:151],v207 offset:1024
ds_read_b128 v[152:155],v207 offset:2048
ds_read_b128 v[156:159],v207 offset:3072
ds_read_b128 v[160:163],v207 offset:4096
ds_read_b128 v[164:167],v207 offset:5120
ds_read_b128 v[168:171],v207 offset:6144
ds_read_b128 v[172:175],v207 offset:7168
s_waitcnt vmcnt(13)
v_lshlrev_b32 v192,16,v180
v_and_b32 v193,0xffff0000,v180
v_lshlrev_b32 v194,16,v181
v_and_b32 v195,0xffff0000,v181
v_lshlrev_b32 v196,16,v182
v_and_b32 v197,0xffff0000,v182
v_lshlrev_b32 v198,16,v183
v_and_b32 v199,0xffff0000,v183
buffer_load_dwordx4 v[60:63],v1,s[8:11],s63 offen offset:3072 sc1
s_add_u32 s63,s73,12288
buffer_load_dwordx4 v[64:67],v1,s[8:11],s63 offen sc1
buffer_load_dwordx4 v[68:71],v1,s[8:11],s63 offen offset:1024 sc1
s_waitcnt lgkmcnt(4)
v_pk_add_f32 v[144:145],v[144:145],v[152:153]
v_pk_add_f32 v[146:147],v[146:147],v[154:155]
v_pk_add_f32 v[148:149],v[148:149],v[156:157]
v_pk_add_f32 v[150:151],v[150:151],v[158:159]
s_waitcnt lgkmcnt(0)
v_pk_add_f32 v[160:161],v[160:161],v[168:169]
v_pk_add_f32 v[162:163],v[162:163],v[170:171]
v_pk_add_f32 v[164:165],v[164:165],v[172:173]
v_pk_add_f32 v[166:167],v[166:167],v[174:175]
v_pk_add_f32 v[144:145],v[144:145],v[160:161]
v_pk_add_f32 v[146:147],v[146:147],v[162:163]
v_pk_add_f32 v[148:149],v[148:149],v[164:165]
v_pk_add_f32 v[150:151],v[150:151],v[166:167]
v_cvt_pk_bf16_f32 v6,v144,v145
v_lshlrev_b32 v144,16,v6
v_and_b32 v145,0xffff0000,v6
v_cvt_pk_bf16_f32 v6,v146,v147
v_lshlrev_b32 v146,16,v6
v_and_b32 v147,0xffff0000,v6
v_cvt_pk_bf16_f32 v6,v148,v149
v_lshlrev_b32 v148,16,v6
v_and_b32 v149,0xffff0000,v6
v_cvt_pk_bf16_f32 v6,v150,v151
v_lshlrev_b32 v150,16,v6
v_and_b32 v151,0xffff0000,v6
v_pk_add_f32 v[144:145],v[144:145],v[184:185]
v_pk_add_f32 v[146:147],v[146:147],v[186:187]
v_pk_add_f32 v[148:149],v[148:149],v[188:189]
v_pk_add_f32 v[150:151],v[150:151],v[190:191]
v_cvt_pk_bf16_f32 v6,v144,v145
v_lshlrev_b32 v144,16,v6
v_and_b32 v145,0xffff0000,v6
v_cvt_pk_bf16_f32 v6,v146,v147
v_lshlrev_b32 v146,16,v6
v_and_b32 v147,0xffff0000,v6
v_cvt_pk_bf16_f32 v6,v148,v149
v_lshlrev_b32 v148,16,v6
v_and_b32 v149,0xffff0000,v6
v_cvt_pk_bf16_f32 v6,v150,v151
v_lshlrev_b32 v150,16,v6
v_and_b32 v151,0xffff0000,v6
v_pk_add_f32 v[144:145],v[144:145],v[192:193]
v_pk_add_f32 v[146:147],v[146:147],v[194:195]
v_pk_add_f32 v[148:149],v[148:149],v[196:197]
v_pk_add_f32 v[150:151],v[150:151],v[198:199]
v_cvt_pk_bf16_f32 v200,v144,v145
v_cvt_pk_bf16_f32 v201,v146,v147
v_cvt_pk_bf16_f32 v202,v148,v149
v_cvt_pk_bf16_f32 v203,v150,v151
s_cmp_lg_u32 s51,0
s_cbranch_scc1 w4o_340
buffer_store_dwordx4 v[200:203],v15,s[8:11],s40 offen sc1
v_lshlrev_b32 v144,16,v200
v_and_b32 v145,0xffff0000,v200
v_lshlrev_b32 v146,16,v201
v_and_b32 v147,0xffff0000,v201
v_lshlrev_b32 v148,16,v202
v_and_b32 v149,0xffff0000,v202
v_lshlrev_b32 v150,16,v203
v_and_b32 v151,0xffff0000,v203
v_pk_add_f32 v[6:7],v[144:145],v[146:147]
v_pk_mul_f32 v[8:9],v[144:145],v[144:145]
v_pk_fma_f32 v[8:9],v[146:147],v[146:147],v[8:9]
v_pk_add_f32 v[6:7],v[6:7],v[148:149]
v_pk_fma_f32 v[8:9],v[148:149],v[148:149],v[8:9]
v_pk_add_f32 v[6:7],v[6:7],v[150:151]
v_pk_fma_f32 v[8:9],v[150:151],v[150:151],v[8:9]
v_add_f32 v6,v6,v7
v_add_f32 v7,v8,v9
s_nop 1
v_permlane32_swap_b32 v6,v7
v_add_f32 v6,v6,v7
v_mov_b32 v7,v6
s_nop 1
v_permlane16_swap_b32 v6,v7
v_add_f32 v6,v6,v7
v_mov_b32 v7,v6
s_nop 1
v_permlane32_swap_b32 v6,v7
s_mov_b64 exec,0xffff
buffer_store_dwordx2 v[6:7],v204,s[8:11],s41 offen sc1
s_mov_b64 exec,-1
s_branch w4n_341
w4o_340:
v_permlane16_swap_b32 v200,v202
v_permlane16_swap_b32 v201,v203
buffer_store_dwordx4 v[200:203],v205,s[76:79],s40 offen
s_mov_b64 exec,1
buffer_store_dword v5,v1,s[8:11],s42 offen
s_mov_b64 exec,-1
w4n_341:
s_mov_b32 s59,s42
s_waitcnt vmcnt(8)
s_branch W4_W
W4_E0:
s_nop 4
ds_write_b128 v206,v[128:131] offset:8192
ds_write_b128 v206,v[132:135] offset:9216
ds_write_b128 v206,v[136:139] offset:8704
ds_write_b128 v206,v[140:143] offset:9728
s_waitcnt lgkmcnt(0)
s_barrier
ds_read_b128 v[144:147],v207 offset:0
ds_read_b128 v[148:151],v207 offset:1024
ds_read_b128 v[152:155],v207 offset:2048
ds_read_b128 v[156:159],v207 offset:3072
ds_read_b128 v[160:163],v207 offset:4096
ds_read_b128 v[164:167],v207 offset:5120
ds_read_b128 v[168:171],v207 offset:6144
ds_read_b128 v[172:175],v207 offset:7168
s_waitcnt vmcnt(16)
v_lshlrev_b32 v192,16,v180
v_and_b32 v193,0xffff0000,v180
v_lshlrev_b32 v194,16,v181
v_and_b32 v195,0xffff0000,v181
v_lshlrev_b32 v196,16,v182
v_and_b32 v197,0xffff0000,v182
v_lshlrev_b32 v198,16,v183
v_and_b32 v199,0xffff0000,v183
s_waitcnt lgkmcnt(4)
v_pk_add_f32 v[144:145],v[144:145],v[152:153]
v_pk_add_f32 v[146:147],v[146:147],v[154:155]
v_pk_add_f32 v[148:149],v[148:149],v[156:157]
v_pk_add_f32 v[150:151],v[150:151],v[158:159]
s_waitcnt lgkmcnt(0)
v_pk_add_f32 v[160:161],v[160:161],v[168:169]
v_pk_add_f32 v[162:163],v[162:163],v[170:171]
v_pk_add_f32 v[164:165],v[164:165],v[172:173]
v_pk_add_f32 v[166:167],v[166:167],v[174:175]
v_pk_add_f32 v[144:145],v[144:145],v[160:161]
v_pk_add_f32 v[146:147],v[146:147],v[162:163]
v_pk_add_f32 v[148:149],v[148:149],v[164:165]
v_pk_add_f32 v[150:151],v[150:151],v[166:167]
v_cvt_pk_bf16_f32 v6,v144,v145
v_lshlrev_b32 v144,16,v6
v_and_b32 v145,0xffff0000,v6
v_cvt_pk_bf16_f32 v6,v146,v147
v_lshlrev_b32 v146,16,v6
v_and_b32 v147,0xffff0000,v6
v_cvt_pk_bf16_f32 v6,v148,v149
v_lshlrev_b32 v148,16,v6
v_and_b32 v149,0xffff0000,v6
v_cvt_pk_bf16_f32 v6,v150,v151
v_lshlrev_b32 v150,16,v6
v_and_b32 v151,0xffff0000,v6
v_pk_add_f32 v[144:145],v[144:145],v[184:185]
v_pk_add_f32 v[146:147],v[146:147],v[186:187]
v_pk_add_f32 v[148:149],v[148:149],v[188:189]
v_pk_add_f32 v[150:151],v[150:151],v[190:191]
v_cvt_pk_bf16_f32 v6,v144,v145
v_lshlrev_b32 v144,16,v6
v_and_b32 v145,0xffff0000,v6
v_cvt_pk_bf16_f32 v6,v146,v147
v_lshlrev_b32 v146,16,v6
v_and_b32 v147,0xffff0000,v6
v_cvt_pk_bf16_f32 v6,v148,v149
v_lshlrev_b32 v148,16,v6
v_and_b32 v149,0xffff0000,v6
v_cvt_pk_bf16_f32 v6,v150,v151
v_lshlrev_b32 v150,16,v6
v_and_b32 v151,0xffff0000,v6
v_pk_add_f32 v[144:145],v[144:145],v[192:193]
v_pk_add_f32 v[146:147],v[146:147],v[194:195]
v_pk_add_f32 v[148:149],v[148:149],v[196:197]
v_pk_add_f32 v[150:151],v[150:151],v[198:199]
v_cvt_pk_bf16_f32 v200,v144,v145
v_cvt_pk_bf16_f32 v201,v146,v147
v_cvt_pk_bf16_f32 v202,v148,v149
v_cvt_pk_bf16_f32 v203,v150,v151
s_cmp_lg_u32 s51,0
s_cbranch_scc1 w4o_342
buffer_store_dwordx4 v[200:203],v15,s[8:11],s40 offen sc1
v_lshlrev_b32 v144,16,v200
v_and_b32 v145,0xffff0000,v200
v_lshlrev_b32 v146,16,v201
v_and_b32 v147,0xffff0000,v201
v_lshlrev_b32 v148,16,v202
v_and_b32 v149,0xffff0000,v202
v_lshlrev_b32 v150,16,v203
v_and_b32 v151,0xffff0000,v203
v_pk_add_f32 v[6:7],v[144:145],v[146:147]
v_pk_mul_f32 v[8:9],v[144:145],v[144:145]
v_pk_fma_f32 v[8:9],v[146:147],v[146:147],v[8:9]
v_pk_add_f32 v[6:7],v[6:7],v[148:149]
v_pk_fma_f32 v[8:9],v[148:149],v[148:149],v[8:9]
v_pk_add_f32 v[6:7],v[6:7],v[150:151]
v_pk_fma_f32 v[8:9],v[150:151],v[150:151],v[8:9]
v_add_f32 v6,v6,v7
v_add_f32 v7,v8,v9
s_nop 1
v_permlane32_swap_b32 v6,v7
v_add_f32 v6,v6,v7
v_mov_b32 v7,v6
s_nop 1
v_permlane16_swap_b32 v6,v7
v_add_f32 v6,v6,v7
v_mov_b32 v7,v6
s_nop 1
v_permlane32_swap_b32 v6,v7
s_mov_b64 exec,0xffff
buffer_store_dwordx2 v[6:7],v204,s[8:11],s41 offen sc1
s_mov_b64 exec,-1
s_branch w4n_343
w4o_342:
v_permlane16_swap_b32 v200,v202
v_permlane16_swap_b32 v201,v203
buffer_store_dwordx4 v[200:203],v205,s[76:79],s40 offen
s_mov_b64 exec,1
buffer_store_dword v5,v1,s[8:11],s42 offen
s_mov_b64 exec,-1
w4n_343:
s_mov_b32 s59,s42
s_cmp_lg_u32 s37,0
s_cbranch_scc1 W4_COLD
s_waitcnt vmcnt(2)
W4_W:
s_mov_b32 s51,s33
s_mov_b32 s52,s34
s_mov_b32 s72,s73
s_add_u32 s32,s32,1
s_mov_b32 s33,s28
s_mov_b32 s34,s29
s_mov_b32 s35,s30
s_mov_b32 s73,s31
v_cmp_eq_u32 vcc,0,v3
s_cmp_eq_u64 vcc,0
s_cselect_b32 s37,0,2147483648
s_cmp_lt_u32 s32,128
s_cselect_b32 s37,s37,2147483648
s_cmp_lg_u32 s37,0
s_cbranch_scc1 W4_W0
s_waitcnt vmcnt(15)
v_mfma_f32_32x32x16_bf16 v[112:127],a[0:3],v[16:19],0
s_add_u32 s63,s72,12288
buffer_load_dwordx4 v[72:75],v1,s[8:11],s63 offen offset:2048 sc1
v_xor_b32 v206,0x8000,v206
v_xor_b32 v207,0x8000,v207
s_lshl_b32 s64,s51,6
v_mfma_f32_32x32x16_bf16 v[128:143],a[96:99],v[16:19],0
s_add_u32 s64,s64,s52
s_and_b32 s65,s52,7
s_lshl3_add_u32 s65,s51,s65
s_mul_i32 s65,s65,46080
s_add_u32 s65,s65,s70
s_add_u32 s65,s65,212467712
s_waitcnt vmcnt(15)
v_mfma_f32_32x32x16_bf16 v[112:127],a[4:7],v[20:23],v[112:127]
buffer_load_dwordx4 v[76:79],v1,s[8:11],s63 offen offset:3072 sc1
s_add_u32 s63,s72,16384
buffer_load_dwordx4 v[176:179],v1,s[8:11],s65 offen sc1
s_mul_i32 s65,s64,40960
v_mfma_f32_32x32x16_bf16 v[128:143],a[100:103],v[20:23],v[128:143]
s_add_u32 s65,s65,s70
s_add_u32 s65,s65,218365952
s_mov_b32 s43,s65
s_lshl_b32 s82,s64,9
s_lshl2_add_u32 s82,s56,s82
s_add_u32 s42,s82,32768
s_waitcnt vmcnt(16)
v_mfma_f32_32x32x16_bf16 v[112:127],a[8:11],v[24:27],v[112:127]
buffer_load_dwordx4 v[80:83],v1,s[8:11],s63 offen sc1
s_add_u32 s82,s82,327680
s_mul_i32 s41,s52,46080
s_add_u32 s41,s41,209518592
s_add_u32 s40,s41,s70
v_mfma_f32_32x32x16_bf16 v[128:143],a[104:107],v[24:27],v[128:143]
s_lshr_b32 s64,s70,3
s_add_u32 s41,s41,s64
s_add_u32 s41,s41,40960
s_mul_i32 s64,s52,40960
s_add_u32 s62,s32,1
s_min_u32 s62,s62,127
s_waitcnt vmcnt(16)
v_mfma_f32_32x32x16_bf16 v[112:127],a[12:15],v[28:31],v[112:127]
buffer_load_dwordx4 v[84:87],v1,s[8:11],s63 offen offset:1024 sc1
s_cmp_lg_u32 s51,0
s_cselect_b32 s40,s64,s40
s_cselect_b32 s42,2147483648,s42
s_sub_u32 s60,s62,18
v_mfma_f32_32x32x16_bf16 v[128:143],a[108:111],v[28:31],v[128:143]
s_lshr_b32 s29,s60,1
s_and_b32 s28,s60,1
s_cmp_eq_u32 s28,0
s_cselect_b32 s61,18,0
s_add_u32 s29,s29,s61
s_sub_u32 s61,s60,46
s_waitcnt vmcnt(16)
v_mfma_f32_32x32x16_bf16 v[112:127],a[16:19],v[32:35],v[112:127]
buffer_load_dwordx4 v[88:91],v1,s[8:11],s63 offen offset:2048 sc1
s_cmp_ge_u32 s60,92
s_cselect_b32 s29,s61,s29
s_cselect_b32 s28,1,s28
v_mfma_f32_32x32x16_bf16 v[128:143],a[112:115],v[32:35],v[128:143]
s_cmp_lt_u32 s62,18
s_cselect_b32 s29,s62,s29
s_cselect_b32 s28,0,s28
s_lshl_b32 s30,s28,6
s_add_u32 s30,s30,s29
s_lshl_b32 s30,s30,9
s_waitcnt vmcnt(16)
v_mfma_f32_32x32x16_bf16 v[112:127],a[20:23],v[36:39],v[112:127]
buffer_load_dwordx4 v[92:95],v1,s[8:11],s63 offen offset:3072 sc1
s_add_u32 s63,s72,20480
s_add_u32 s30,s30,589824
s_and_b32 s60,s29,3
s_lshl2_add_u32 s60,s28,s60
v_mfma_f32_32x32x16_bf16 v[128:143],a[116:119],v[36:39],v[128:143]
s_mul_i32 s31,s60,98304
s_add_u32 s31,s31,s71
s_waitcnt vmcnt(16)
v_mfma_f32_32x32x16_bf16 v[112:127],a[24:27],v[40:43],v[112:127]
buffer_load_dwordx4 v[96:99],v1,s[8:11],s63 offen sc1
v_mfma_f32_32x32x16_bf16 v[128:143],a[120:123],v[40:43],v[128:143]
s_waitcnt vmcnt(16)
v_mfma_f32_32x32x16_bf16 v[112:127],a[28:31],v[44:47],v[112:127]
buffer_load_dwordx4 v[100:103],v1,s[8:11],s63 offen offset:1024 sc1
v_mfma_f32_32x32x16_bf16 v[128:143],a[124:127],v[44:47],v[128:143]
s_waitcnt vmcnt(16)
v_mfma_f32_32x32x16_bf16 v[112:127],a[32:35],v[48:51],v[112:127]
buffer_load_dwordx4 v[104:107],v1,s[8:11],s63 offen offset:2048 sc1
v_mfma_f32_32x32x16_bf16 v[128:143],a[128:131],v[48:51],v[128:143]
s_waitcnt vmcnt(16)
v_mfma_f32_32x32x16_bf16 v[112:127],a[36:39],v[52:55],v[112:127]
buffer_load_dwordx4 v[108:111],v1,s[8:11],s63 offen offset:3072 sc1
buffer_load_dwordx4 v[180:183],v15,s[8:11],s43 offen sc1
s_add_u32 s63,s73,0
v_mfma_f32_32x32x16_bf16 v[128:143],a[132:135],v[52:55],v[128:143]
buffer_load_dwordx4 v[16:19],v1,s[8:11],s63 offen sc1
s_waitcnt vmcnt(18)
v_mfma_f32_32x32x16_bf16 v[112:127],a[40:43],v[56:59],v[112:127]
v_mfma_f32_32x32x16_bf16 v[128:143],a[136:139],v[56:59],v[128:143]
buffer_load_dwordx4 v[20:23],v1,s[8:11],s63 offen offset:1024 sc1
s_waitcnt vmcnt(18)
v_mfma_f32_32x32x16_bf16 v[112:127],a[44:47],v[60:63],v[112:127]
v_mfma_f32_32x32x16_bf16 v[128:143],a[140:143],v[60:63],v[128:143]
buffer_load_dwordx4 v[24:27],v1,s[8:11],s63 offen offset:2048 sc1
s_waitcnt vmcnt(18)
v_mfma_f32_32x32x16_bf16 v[112:127],a[48:51],v[64:67],v[112:127]
v_mfma_f32_32x32x16_bf16 v[128:143],a[144:147],v[64:67],v[128:143]
buffer_load_dwordx4 v[28:31],v1,s[8:11],s63 offen offset:3072 sc1
s_add_u32 s63,s73,4096
s_waitcnt vmcnt(18)
v_mfma_f32_32x32x16_bf16 v[112:127],a[52:55],v[68:71],v[112:127]
s_waitcnt vmcnt(16)
s_mov_b64 exec,1
buffer_store_dword v5,v1,s[8:11],s59 offen sc1
s_mov_b64 exec,-1
s_mov_b32 s59,2147483648
v_mfma_f32_32x32x16_bf16 v[128:143],a[148:151],v[68:71],v[128:143]
buffer_load_dwordx4 v[32:35],v1,s[8:11],s63 offen sc1
s_waitcnt vmcnt(17)
v_mfma_f32_32x32x16_bf16 v[112:127],a[56:59],v[72:75],v[112:127]
v_mfma_f32_32x32x16_bf16 v[128:143],a[152:155],v[72:75],v[128:143]
buffer_load_dwordx4 v[36:39],v1,s[8:11],s63 offen offset:1024 sc1
s_waitcnt vmcnt(17)
v_mfma_f32_32x32x16_bf16 v[112:127],a[60:63],v[76:79],v[112:127]
v_mfma_f32_32x32x16_bf16 v[128:143],a[156:159],v[76:79],v[128:143]
buffer_load_dwordx4 v[40:43],v1,s[8:11],s63 offen offset:2048 sc1
s_waitcnt vmcnt(16)
v_mfma_f32_32x32x16_bf16 v[112:127],a[64:67],v[80:83],v[112:127]
v_mfma_f32_32x32x16_bf16 v[128:143],a[160:163],v[80:83],v[128:143]
buffer_load_dwordx4 v[44:47],v1,s[8:11],s63 offen offset:3072 sc1
s_add_u32 s63,s73,8192
s_waitcnt vmcnt(16)
v_mfma_f32_32x32x16_bf16 v[112:127],a[68:71],v[84:87],v[112:127]
v_mfma_f32_32x32x16_bf16 v[128:143],a[164:167],v[84:87],v[128:143]
buffer_load_dwordx4 v[48:51],v1,s[8:11],s63 offen sc1
s_waitcnt vmcnt(16)
v_mfma_f32_32x32x16_bf16 v[112:127],a[72:75],v[88:91],v[112:127]
v_mfma_f32_32x32x16_bf16 v[128:143],a[168:171],v[88:91],v[128:143]
buffer_load_dwordx4 v[52:55],v1,s[8:11],s63 offen offset:1024 sc1
v_lshlrev_b32 v184,16,v176
v_and_b32 v185,0xffff0000,v176
v_lshlrev_b32 v186,16,v177
s_waitcnt vmcnt(16)
v_mfma_f32_32x32x16_bf16 v[112:127],a[76:79],v[92:95],v[112:127]
v_and_b32 v187,0xffff0000,v177
v_lshlrev_b32 v188,16,v178
v_and_b32 v189,0xffff0000,v178
v_lshlrev_b32 v190,16,v179
v_and_b32 v191,0xffff0000,v179
v_mfma_f32_32x32x16_bf16 v[128:143],a[172:175],v[92:95],v[128:143]
buffer_load_dwordx4 v[56:59],v1,s[8:11],s63 offen offset:2048 sc1
s_waitcnt vmcnt(16)
v_mfma_f32_32x32x16_bf16 v[112:127],a[80:83],v[96:99],v[112:127]
s_waitcnt vmcnt(15)
v_mfma_f32_32x32x16_bf16 v[112:127],a[84:87],v[100:103],v[112:127]
buffer_load_dwordx4 v[60:63],v1,s[8:11],s63 offen offset:3072 sc1
s_add_u32 s63,s73,12288
s_waitcnt vmcnt(15)
v_mfma_f32_32x32x16_bf16 v[112:127],a[88:91],v[104:107],v[112:127]
s_waitcnt vmcnt(14)
v_mfma_f32_32x32x16_bf16 v[112:127],a[92:95],v[108:111],v[112:127]
buffer_load_dwordx4 v[64:67],v1,s[8:11],s63 offen sc1
v_mfma_f32_32x32x16_bf16 v[128:143],a[176:179],v[96:99],v[128:143]
s_mov_b64 exec,1
s_cmp_lg_u32 s49,0
s_cbranch_scc0 ls_344
buffer_store_dword v5,v1,s[8:11],s82 offen sc1
s_branch ls_345
ls_344:
buffer_store_dword v5,v1,s[8:11],s82 offen
ls_345:
s_mov_b64 exec,-1
v_mfma_f32_32x32x16_bf16 v[128:143],a[180:183],v[100:103],v[128:143]
buffer_load_dwordx4 v[68:71],v1,s[8:11],s63 offen offset:1024 sc1
ds_write_b128 v206,v[112:115] offset:0
ds_write_b128 v206,v[116:119] offset:1024
v_mfma_f32_32x32x16_bf16 v[128:143],a[184:187],v[104:107],v[128:143]
ds_write_b128 v206,v[120:123] offset:512
ds_write_b128 v206,v[124:127] offset:1536
v_mfma_f32_32x32x16_bf16 v[128:143],a[188:191],v[108:111],v[128:143]
buffer_load_dword v3,v2,s[8:11],s30 offen sc1
s_nop 5
s_branch W4_E0
s_nop 3
W4_W0:
s_waitcnt vmcnt(15)
v_mfma_f32_32x32x16_bf16 v[112:127],a[0:3],v[16:19],0
s_add_u32 s63,s72,12288
buffer_load_dwordx4 v[72:75],v1,s[8:11],s63 offen offset:2048 sc1
v_xor_b32 v206,0x8000,v206
v_xor_b32 v207,0x8000,v207
s_lshl_b32 s64,s51,6
v_mfma_f32_32x32x16_bf16 v[128:143],a[96:99],v[16:19],0
s_add_u32 s64,s64,s52
s_and_b32 s65,s52,7
s_lshl3_add_u32 s65,s51,s65
s_mul_i32 s65,s65,46080
s_add_u32 s65,s65,s70
s_add_u32 s65,s65,212467712
s_waitcnt vmcnt(15)
v_mfma_f32_32x32x16_bf16 v[112:127],a[4:7],v[20:23],v[112:127]
buffer_load_dwordx4 v[76:79],v1,s[8:11],s63 offen offset:3072 sc1
s_add_u32 s63,s72,16384
buffer_load_dwordx4 v[176:179],v1,s[8:11],s65 offen sc1
s_mul_i32 s65,s64,40960
v_mfma_f32_32x32x16_bf16 v[128:143],a[100:103],v[20:23],v[128:143]
s_add_u32 s65,s65,s70
s_add_u32 s65,s65,218365952
s_mov_b32 s43,s65
s_lshl_b32 s82,s64,9
s_lshl2_add_u32 s82,s56,s82
s_add_u32 s42,s82,32768
s_waitcnt vmcnt(16)
v_mfma_f32_32x32x16_bf16 v[112:127],a[8:11],v[24:27],v[112:127]
buffer_load_dwordx4 v[80:83],v1,s[8:11],s63 offen sc1
s_add_u32 s82,s82,327680
s_mul_i32 s41,s52,46080
s_add_u32 s41,s41,209518592
s_add_u32 s40,s41,s70
v_mfma_f32_32x32x16_bf16 v[128:143],a[104:107],v[24:27],v[128:143]
s_lshr_b32 s64,s70,3
s_add_u32 s41,s41,s64
s_add_u32 s41,s41,40960
s_mul_i32 s64,s52,40960
s_add_u32 s62,s32,1
s_min_u32 s62,s62,127
s_waitcnt vmcnt(16)
v_mfma_f32_32x32x16_bf16 v[112:127],a[12:15],v[28:31],v[112:127]
buffer_load_dwordx4 v[84:87],v1,s[8:11],s63 offen offset:1024 sc1
s_cmp_lg_u32 s51,0
s_cselect_b32 s40,s64,s40
s_cselect_b32 s42,2147483648,s42
s_sub_u32 s60,s62,18
v_mfma_f32_32x32x16_bf16 v[128:143],a[108:111],v[28:31],v[128:143]
s_lshr_b32 s29,s60,1
s_and_b32 s28,s60,1
s_cmp_eq_u32 s28,0
s_cselect_b32 s61,18,0
s_add_u32 s29,s29,s61
s_sub_u32 s61,s60,46
s_waitcnt vmcnt(16)
v_mfma_f32_32x32x16_bf16 v[112:127],a[16:19],v[32:35],v[112:127]
buffer_load_dwordx4 v[88:91],v1,s[8:11],s63 offen offset:2048 sc1
s_cmp_ge_u32 s60,92
s_cselect_b32 s29,s61,s29
s_cselect_b32 s28,1,s28
v_mfma_f32_32x32x16_bf16 v[128:143],a[112:115],v[32:35],v[128:143]
s_cmp_lt_u32 s62,18
s_cselect_b32 s29,s62,s29
s_cselect_b32 s28,0,s28
s_lshl_b32 s30,s28,6
s_add_u32 s30,s30,s29
s_lshl_b32 s30,s30,9
s_waitcnt vmcnt(16)
v_mfma_f32_32x32x16_bf16 v[112:127],a[20:23],v[36:39],v[112:127]
buffer_load_dwordx4 v[92:95],v1,s[8:11],s63 offen offset:3072 sc1
s_add_u32 s63,s72,20480
s_add_u32 s30,s30,589824
s_and_b32 s60,s29,3
s_lshl2_add_u32 s60,s28,s60
v_mfma_f32_32x32x16_bf16 v[128:143],a[116:119],v[36:39],v[128:143]
s_mul_i32 s31,s60,98304
s_add_u32 s31,s31,s71
s_waitcnt vmcnt(16)
v_mfma_f32_32x32x16_bf16 v[112:127],a[24:27],v[40:43],v[112:127]
buffer_load_dwordx4 v[96:99],v1,s[8:11],s63 offen sc1
v_mfma_f32_32x32x16_bf16 v[128:143],a[120:123],v[40:43],v[128:143]
s_waitcnt vmcnt(16)
v_mfma_f32_32x32x16_bf16 v[112:127],a[28:31],v[44:47],v[112:127]
buffer_load_dwordx4 v[100:103],v1,s[8:11],s63 offen offset:1024 sc1
v_mfma_f32_32x32x16_bf16 v[128:143],a[124:127],v[44:47],v[128:143]
s_waitcnt vmcnt(16)
v_mfma_f32_32x32x16_bf16 v[112:127],a[32:35],v[48:51],v[112:127]
buffer_load_dwordx4 v[104:107],v1,s[8:11],s63 offen offset:2048 sc1
v_mfma_f32_32x32x16_bf16 v[128:143],a[128:131],v[48:51],v[128:143]
s_waitcnt vmcnt(16)
v_mfma_f32_32x32x16_bf16 v[112:127],a[36:39],v[52:55],v[112:127]
buffer_load_dwordx4 v[108:111],v1,s[8:11],s63 offen offset:3072 sc1
buffer_load_dwordx4 v[180:183],v15,s[8:11],s43 offen sc1
v_mfma_f32_32x32x16_bf16 v[128:143],a[132:135],v[52:55],v[128:143]
s_waitcnt vmcnt(17)
v_mfma_f32_32x32x16_bf16 v[112:127],a[40:43],v[56:59],v[112:127]
v_mfma_f32_32x32x16_bf16 v[128:143],a[136:139],v[56:59],v[128:143]
s_waitcnt vmcnt(16)
v_mfma_f32_32x32x16_bf16 v[112:127],a[44:47],v[60:63],v[112:127]
v_mfma_f32_32x32x16_bf16 v[128:143],a[140:143],v[60:63],v[128:143]
s_waitcnt vmcnt(15)
v_mfma_f32_32x32x16_bf16 v[112:127],a[48:51],v[64:67],v[112:127]
v_mfma_f32_32x32x16_bf16 v[128:143],a[144:147],v[64:67],v[128:143]
s_waitcnt vmcnt(14)
v_mfma_f32_32x32x16_bf16 v[112:127],a[52:55],v[68:71],v[112:127]
s_waitcnt vmcnt(12)
s_mov_b64 exec,1
buffer_store_dword v5,v1,s[8:11],s59 offen sc1
s_mov_b64 exec,-1
s_mov_b32 s59,2147483648
v_mfma_f32_32x32x16_bf16 v[128:143],a[148:151],v[68:71],v[128:143]
s_waitcnt vmcnt(12)
v_mfma_f32_32x32x16_bf16 v[112:127],a[56:59],v[72:75],v[112:127]
v_mfma_f32_32x32x16_bf16 v[128:143],a[152:155],v[72:75],v[128:143]
s_waitcnt vmcnt(11)
v_mfma_f32_32x32x16_bf16 v[112:127],a[60:63],v[76:79],v[112:127]
v_mfma_f32_32x32x16_bf16 v[128:143],a[156:159],v[76:79],v[128:143]
s_waitcnt vmcnt(9)
v_mfma_f32_32x32x16_bf16 v[112:127],a[64:67],v[80:83],v[112:127]
v_mfma_f32_32x32x16_bf16 v[128:143],a[160:163],v[80:83],v[128:143]
s_waitcnt vmcnt(8)
v_mfma_f32_32x32x16_bf16 v[112:127],a[68:71],v[84:87],v[112:127]
v_mfma_f32_32x32x16_bf16 v[128:143],a[164:167],v[84:87],v[128:143]
s_waitcnt vmcnt(7)
v_mfma_f32_32x32x16_bf16 v[112:127],a[72:75],v[88:91],v[112:127]
v_mfma_f32_32x32x16_bf16 v[128:143],a[168:171],v[88:91],v[128:143]
v_lshlrev_b32 v184,16,v176
v_and_b32 v185,0xffff0000,v176
v_lshlrev_b32 v186,16,v177
v_and_b32 v187,0xffff0000,v177
v_lshlrev_b32 v188,16,v178
s_waitcnt vmcnt(6)
v_mfma_f32_32x32x16_bf16 v[112:127],a[76:79],v[92:95],v[112:127]
buffer_load_dword v3,v2,s[8:11],s35 offen sc1
v_and_b32 v189,0xffff0000,v178
v_lshlrev_b32 v190,16,v179
v_and_b32 v191,0xffff0000,v179
v_mfma_f32_32x32x16_bf16 v[128:143],a[172:175],v[92:95],v[128:143]
s_waitcnt vmcnt(6)
v_mfma_f32_32x32x16_bf16 v[112:127],a[80:83],v[96:99],v[112:127]
s_waitcnt vmcnt(5)
v_mfma_f32_32x32x16_bf16 v[112:127],a[84:87],v[100:103],v[112:127]
s_waitcnt vmcnt(4)
v_mfma_f32_32x32x16_bf16 v[112:127],a[88:91],v[104:107],v[112:127]
s_waitcnt vmcnt(3)
v_mfma_f32_32x32x16_bf16 v[112:127],a[92:95],v[108:111],v[112:127]
v_mfma_f32_32x32x16_bf16 v[128:143],a[176:179],v[96:99],v[128:143]
s_mov_b64 exec,1
s_cmp_lg_u32 s49,0
s_cbranch_scc0 ls_346
buffer_store_dword v5,v1,s[8:11],s82 offen sc1
s_branch ls_347
ls_346:
buffer_store_dword v5,v1,s[8:11],s82 offen
ls_347:
s_mov_b64 exec,-1
v_mfma_f32_32x32x16_bf16 v[128:143],a[180:183],v[100:103],v[128:143]
ds_write_b128 v206,v[112:115] offset:0
ds_write_b128 v206,v[116:119] offset:1024
ds_write_b128 v206,v[120:123] offset:512
v_mfma_f32_32x32x16_bf16 v[128:143],a[184:187],v[104:107],v[128:143]
ds_write_b128 v206,v[124:127] offset:1536
v_mfma_f32_32x32x16_bf16 v[128:143],a[188:191],v[108:111],v[128:143]
s_waitcnt vmcnt(1)
v_cmp_eq_u32 vcc,0,v3
s_cmp_eq_u64 vcc,0
s_cselect_b32 s37,0,2147483648
s_cmp_lt_u32 s32,128
s_cselect_b32 s37,s37,2147483648
s_cmp_eq_u32 s37,0
s_cbranch_scc1 W4_E2
s_branch W4_E0
s_nop 2
W4_END:
s_endpgm
.section .rodata,"a"
.p2align 6
.amdhsa_kernel interleave_layers__memory_aug_recurrent_mem_tr__mixer_s_mlp__prompt_kernel
  .amdhsa_next_free_vgpr 512
  .amdhsa_next_free_sgpr 102
  .amdhsa_accum_offset 256
  .amdhsa_group_segment_fixed_size 0
  .amdhsa_kernarg_size 120
  .amdhsa_user_sgpr_count 2
  .amdhsa_user_sgpr_kernarg_segment_ptr 1
  .amdhsa_system_sgpr_workgroup_id_x 1
.end_amdhsa_kernel
```

```asm
; @launch grid=(256,1,1) block=(256,1,1) lds=163840
.amdgcn_target "amdgcn-amd-amdhsa--gfx950"
.text
.globl interleave_layers__memory_aug_recurrent_mem_tr__mixer_s_mlp__prompt_kernel
.p2align 8
.type interleave_layers__memory_aug_recurrent_mem_tr__mixer_s_mlp__prompt_kernel,@function
interleave_layers__memory_aug_recurrent_mem_tr__mixer_s_mlp__prompt_kernel:
s_cmp_ge_u32 s2,256
s_cbranch_scc1 EXIT
s_load_dwordx16 s[16:31],s[0:1],0
s_load_dwordx8 s[32:39],s[0:1],64
s_load_dwordx4 s[40:43],s[0:1],96
s_load_dwordx2 s[44:45],s[0:1],112
v_lshrrev_b32 v1,6,v0
v_and_b32 v0,63,v0
v_readfirstlane_b32 s46,v1
s_mov_b32 s47,200000
s_mov_b32 s49,0
s_getreg_b32 s4,hwreg(HW_REG_XCC_ID)
s_and_b32 s4,s4,7
s_waitcnt lgkmcnt(0)
s_mov_b32 s8,s44
s_mov_b32 s9,s45
s_mov_b32 s10,268435456
s_mov_b32 s11,0x20000
s_mov_b32 s12,s42
s_mov_b32 s13,s43
s_mov_b32 s14,256
s_mov_b32 s15,0x20000
v_lshlrev_b32 v1,4,v0
v_mov_b32 v4,0
v_mov_b32 v5,0
v_mov_b32 v6,0
v_mov_b32 v7,0
s_lshl_b32 s5,s2,2
s_add_u32 s5,s5,s46
s_lshl_b32 s5,s5,10
buffer_store_dwordx4 v[4:7],v1,s[8:11],s5 offen sc1
v_mov_b32 v2,0
s_cmp_lg_u32 s46,0
s_cbranch_scc1 TK_DONE
s_mov_b64 exec,1
v_mov_b32 v1,1
s_lshl_b32 s5,s4,2
v_mov_b32 v3,s5
buffer_atomic_add v1,v3,s[12:15],0 offen offset:32 sc0 sc1
s_waitcnt vmcnt(0)
v_readfirstlane_b32 s5,v1
s_lshl_b32 s6,s4,5
s_add_u32 s6,s6,s5
s_cmp_lt_u32 s5,32
s_cselect_b32 s6,s6,999
v_mov_b32 v1,s6
ds_write_b32 v2,v1
s_mov_b64 exec,-1
s_waitcnt lgkmcnt(0)
TK_DONE:
s_barrier
ds_read_b32 v1,v2
s_waitcnt lgkmcnt(0)
v_readfirstlane_b32 s3,v1
s_barrier
s_nop 2
s_branch DISPATCH
ROLE_CS:
s_lshr_b32 s28,s48,4
s_and_b32 s29,s48,15
s_mul_i32 s82,s28,2097152
s_add_u32 s82,s82,2097152
v_lshlrev_b32 v1,4,v0
v_and_b32 v12,1,v0
v_mul_u32_u24 v2,0xaaaa,v12
v_or_b32 v2,0x4444,v2
s_add_u32 s60,s46,1
s_and_b32 s60,s60,3
s_lshl_b32 s60,s60,11
s_add_u32 s60,s60,131072
v_add_u32 v3,s60,v1
s_add_u32 s60,s46,2
s_and_b32 s60,s60,3
s_lshl_b32 s60,s60,11
s_add_u32 s60,s60,131072
v_add_u32 v4,s60,v1
s_add_u32 s60,s46,3
s_and_b32 s60,s60,3
s_lshl_b32 s60,s60,11
s_add_u32 s60,s60,131072
v_add_u32 v5,s60,v1
v_add_u32 v59,139264,v1
s_lshl_b32 s60,s46,11
s_add_u32 s60,s60,131072
v_add_u32 v22,s60,v1
s_lshr_b32 s60,s46,1
s_lshl_b32 s60,s60,10
s_and_b32 s61,s46,1
s_lshl_b32 s61,s61,3
s_add_u32 s60,s60,s61
v_add_u32 v23,s60,v59
s_mul_i32 s60,s46,20480
v_add_u32 v21,s60,v1
v_and_b32 v11,7,v0
v_lshlrev_b32 v11,2,v11
v_bfe_u32 v12,v0,3,2
v_lshl_add_u32 v11,v12,7,v11
s_xor_b32 s60,s28,1
s_lshl_b32 s60,s60,19
s_lshl_b32 s61,s46,11
s_add_u32 s83,s60,s61
s_add_u32 s83,s83,10485760
s_mov_b32 s36,0
s_mov_b32 s88,0xcccccccc
s_mov_b32 s89,0xcccccccc
s_mov_b32 s90,0x33333333
s_mov_b32 s91,0x33333333
s_mov_b32 s87,0x3dd53b95
v_lshrrev_b32 v14,4,v0
v_and_b32 v15,15,v0
v_lshrrev_b32 v12,2,v15
v_add_u32 v12,v12,v14
v_and_b32 v12,3,v12
v_lshlrev_b32 v6,3,v12
v_lshl_add_u32 v6,v15,5,v6
s_mul_i32 s60,s46,1536
s_add_u32 s60,s60,141312
v_add_u32 v6,s60,v6
v_add_u32 v12,v0,v14
v_and_b32 v12,3,v12
v_lshlrev_b32 v7,3,v12
v_lshrrev_b32 v12,2,v0
v_lshl_add_u32 v7,v12,5,v7
v_add_u32 v7,141312,v7
s_min_u32 s62,s46,2
v_lshrrev_b32 v12,2,v15
v_and_b32 v13,1,v15
v_lshl_add_u32 v12,v12,1,v13
v_bfe_u32 v13,v15,1,1
v_lshlrev_b32 v8,8,v14
v_lshl_add_u32 v8,v12,5,v8
v_xor_b32 v16,1,v13
v_lshl_add_u32 v8,v16,4,v8
v_lshlrev_b32 v20,8,v14
v_lshl_add_u32 v20,v13,7,v20
v_and_b32 v16,3,v12
v_lshl_add_u32 v20,v16,5,v20
v_lshrrev_b32 v16,2,v12
v_lshl_add_u32 v20,v16,4,v20
v_min_u32 v12,5,v0
s_mul_i32 s60,s48,3
v_add_u32 v9,s60,v12
v_lshlrev_b32 v9,2,v9
v_add_u32 v13,65524,v9
v_cmp_lt_u32 vcc,2,v12
s_nop 1
v_cndmask_b32 v9,v9,v13,vcc
s_mul_i32 s84,s48,12288
s_add_u32 s84,s84,74448896
s_mul_i32 s60,s29,3072
s_lshl_b32 s61,s62,10
s_add_u32 s60,s60,s61
s_add_u32 s60,s60,s82
s_add_u32 s33,s60,163840
s_add_u32 s34,s60,557056
s_mul_i32 s85,s48,6144
s_add_u32 s85,s85,24117248
s_lshl_b32 s86,s48,5
s_lshl_b32 s61,s62,2
s_add_u32 s86,s86,688128
s_lshr_b32 s60,s29,2
s_lshl_b32 s60,s60,7
s_and_b32 s63,s29,3
s_mul_i32 s63,s63,12
s_add_u32 s60,s60,s63
s_add_u32 s60,s60,s61
s_add_u32 s60,s60,s82
s_add_u32 s35,s60,951296
s_cmp_eq_u32 s46,3
s_cbranch_scc1 si_1
v_mov_b32 v12,-1
v_mov_b32 v13,0
s_cmp_lg_u32 s49,0
s_cbranch_scc1 ls_2
s_add_u32 s60,s33,0
buffer_store_dword v12,v1,s[8:11],s60 offen
s_add_u32 s60,s33,49152
buffer_store_dword v12,v1,s[8:11],s60 offen
s_add_u32 s60,s33,98304
buffer_store_dword v12,v1,s[8:11],s60 offen
s_add_u32 s60,s33,147456
buffer_store_dword v12,v1,s[8:11],s60 offen
s_add_u32 s60,s33,196608
buffer_store_dword v12,v1,s[8:11],s60 offen
s_add_u32 s60,s33,245760
buffer_store_dword v12,v1,s[8:11],s60 offen
s_add_u32 s60,s33,294912
buffer_store_dword v12,v1,s[8:11],s60 offen
s_add_u32 s60,s33,344064
buffer_store_dword v12,v1,s[8:11],s60 offen
s_mov_b64 exec,1
buffer_store_dword v13,v1,s[8:11],s35 offen
buffer_store_dword v13,v1,s[8:11],s35 offen offset:512
s_mov_b64 exec,-1
s_branch ls_3
ls_2:
s_add_u32 s60,s33,0
buffer_store_dword v12,v1,s[8:11],s60 offen sc1
s_add_u32 s60,s33,49152
buffer_store_dword v12,v1,s[8:11],s60 offen sc1
s_add_u32 s60,s33,98304
buffer_store_dword v12,v1,s[8:11],s60 offen sc1
s_add_u32 s60,s33,147456
buffer_store_dword v12,v1,s[8:11],s60 offen sc1
s_add_u32 s60,s33,196608
buffer_store_dword v12,v1,s[8:11],s60 offen sc1
s_add_u32 s60,s33,245760
buffer_store_dword v12,v1,s[8:11],s60 offen sc1
s_add_u32 s60,s33,294912
buffer_store_dword v12,v1,s[8:11],s60 offen sc1
s_add_u32 s60,s33,344064
buffer_store_dword v12,v1,s[8:11],s60 offen sc1
s_mov_b64 exec,1
buffer_store_dword v13,v1,s[8:11],s35 offen sc1
buffer_store_dword v13,v1,s[8:11],s35 offen offset:512 sc1
s_mov_b64 exec,-1
ls_3:
si_1:
s_mul_i32 s73,s48,384
s_mov_b32 s74,s73
v_add_u32 v12,0,v0
v_mul_u32_u24 v13,2731,v12
v_lshrrev_b32 v13,16,v13
v_mul_u32_u24 v16,24,v13
v_sub_u32 v12,v12,v16
v_mul_u32_u24 v104,12288,v13
v_lshl_add_u32 v104,v12,4,v104
v_add_u32 v12,64,v0
v_mul_u32_u24 v13,2731,v12
v_lshrrev_b32 v13,16,v13
v_mul_u32_u24 v16,24,v13
v_sub_u32 v12,v12,v16
v_mul_u32_u24 v105,12288,v13
v_lshl_add_u32 v105,v12,4,v105
v_add_u32 v12,128,v0
v_mul_u32_u24 v13,2731,v12
v_lshrrev_b32 v13,16,v13
v_mul_u32_u24 v16,24,v13
v_sub_u32 v12,v12,v16
v_mul_u32_u24 v106,12288,v13
v_lshl_add_u32 v106,v12,4,v106
s_mov_b32 s4,s20
s_mov_b32 s5,s21
s_mov_b32 s6,7864320
s_mov_b32 s7,0x20000
s_mov_b32 s52,s22
s_mov_b32 s53,s23
s_mov_b32 s54,7864320
s_mov_b32 s55,0x20000
s_branch SV_LOAD
ROLE_CV:
s_lshr_b32 s28,s48,3
s_and_b32 s29,s48,7
s_mul_i32 s82,s28,2097152
s_add_u32 s82,s82,2097152
v_lshlrev_b32 v1,4,v0
v_and_b32 v12,1,v0
v_mul_u32_u24 v2,0xaaaa,v12
v_or_b32 v2,0x4444,v2
s_add_u32 s60,s46,1
s_and_b32 s60,s60,3
s_lshl_b32 s60,s60,11
s_add_u32 s60,s60,131072
v_add_u32 v3,s60,v1
s_add_u32 s60,s46,2
s_and_b32 s60,s60,3
s_lshl_b32 s60,s60,11
s_add_u32 s60,s60,131072
v_add_u32 v4,s60,v1
s_add_u32 s60,s46,3
s_and_b32 s60,s60,3
s_lshl_b32 s60,s60,11
s_add_u32 s60,s60,131072
v_add_u32 v5,s60,v1
v_add_u32 v59,139264,v1
s_lshl_b32 s60,s46,11
s_add_u32 s60,s60,131072
v_add_u32 v22,s60,v1
s_lshr_b32 s60,s46,1
s_lshl_b32 s60,s60,10
s_and_b32 s61,s46,1
s_lshl_b32 s61,s61,3
s_add_u32 s60,s60,s61
v_add_u32 v23,s60,v59
s_mul_i32 s60,s46,20480
v_add_u32 v21,s60,v1
v_and_b32 v11,7,v0
v_lshlrev_b32 v11,2,v11
v_bfe_u32 v12,v0,3,2
v_lshl_add_u32 v11,v12,7,v11
s_xor_b32 s60,s28,1
s_lshl_b32 s60,s60,19
s_lshl_b32 s61,s46,11
s_add_u32 s83,s60,s61
s_add_u32 s83,s83,10485760
s_mov_b32 s36,1
v_lshlrev_b32 v8,3,v0
v_lshlrev_b32 v9,3,v0
v_lshlrev_b32 v20,3,v0
s_and_b32 s62,s46,1
s_lshl_b32 s60,s62,11
v_add_u32 v6,s60,v1
s_lshl_b32 s60,s62,3
s_add_u32 s60,s60,1024
v_add_u32 v7,s60,v1
s_lshr_b32 s61,s46,1
s_lshl_b32 s60,s29,1
s_add_u32 s60,s60,s61
s_mul_i32 s60,s60,3072
s_add_u32 s60,s60,s82
s_add_u32 s34,s60,557056
s_lshl_b32 s60,s48,1
s_add_u32 s60,s60,s61
s_mul_i32 s85,s60,6144
s_add_u32 s85,s85,24120320
s_lshl_b32 s86,s60,5
s_lshl_b32 s61,s62,2
s_add_u32 s86,s86,s61
s_add_u32 s86,s86,688132
v_mov_b32 v12,-1
v_mov_b32 v13,-1
v_mov_b32 v14,-1
v_mov_b32 v15,-1
s_cmp_lg_u32 s49,0
s_cbranch_scc1 ls_4
s_add_u32 s60,s34,0
buffer_store_dwordx4 v[12:15],v6,s[8:11],s60 offen
buffer_store_dwordx2 v[12:13],v7,s[8:11],s60 offen
s_add_u32 s60,s34,49152
buffer_store_dwordx4 v[12:15],v6,s[8:11],s60 offen
buffer_store_dwordx2 v[12:13],v7,s[8:11],s60 offen
s_add_u32 s60,s34,98304
buffer_store_dwordx4 v[12:15],v6,s[8:11],s60 offen
buffer_store_dwordx2 v[12:13],v7,s[8:11],s60 offen
s_add_u32 s60,s34,147456
buffer_store_dwordx4 v[12:15],v6,s[8:11],s60 offen
buffer_store_dwordx2 v[12:13],v7,s[8:11],s60 offen
s_add_u32 s60,s34,196608
buffer_store_dwordx4 v[12:15],v6,s[8:11],s60 offen
buffer_store_dwordx2 v[12:13],v7,s[8:11],s60 offen
s_add_u32 s60,s34,245760
buffer_store_dwordx4 v[12:15],v6,s[8:11],s60 offen
buffer_store_dwordx2 v[12:13],v7,s[8:11],s60 offen
s_add_u32 s60,s34,294912
buffer_store_dwordx4 v[12:15],v6,s[8:11],s60 offen
buffer_store_dwordx2 v[12:13],v7,s[8:11],s60 offen
s_add_u32 s60,s34,344064
buffer_store_dwordx4 v[12:15],v6,s[8:11],s60 offen
buffer_store_dwordx2 v[12:13],v7,s[8:11],s60 offen
s_branch ls_5
ls_4:
s_add_u32 s60,s34,0
buffer_store_dwordx4 v[12:15],v6,s[8:11],s60 offen sc1
buffer_store_dwordx2 v[12:13],v7,s[8:11],s60 offen sc1
s_add_u32 s60,s34,49152
buffer_store_dwordx4 v[12:15],v6,s[8:11],s60 offen sc1
buffer_store_dwordx2 v[12:13],v7,s[8:11],s60 offen sc1
s_add_u32 s60,s34,98304
buffer_store_dwordx4 v[12:15],v6,s[8:11],s60 offen sc1
buffer_store_dwordx2 v[12:13],v7,s[8:11],s60 offen sc1
s_add_u32 s60,s34,147456
buffer_store_dwordx4 v[12:15],v6,s[8:11],s60 offen sc1
buffer_store_dwordx2 v[12:13],v7,s[8:11],s60 offen sc1
s_add_u32 s60,s34,196608
buffer_store_dwordx4 v[12:15],v6,s[8:11],s60 offen sc1
buffer_store_dwordx2 v[12:13],v7,s[8:11],s60 offen sc1
s_add_u32 s60,s34,245760
buffer_store_dwordx4 v[12:15],v6,s[8:11],s60 offen sc1
buffer_store_dwordx2 v[12:13],v7,s[8:11],s60 offen sc1
s_add_u32 s60,s34,294912
buffer_store_dwordx4 v[12:15],v6,s[8:11],s60 offen sc1
buffer_store_dwordx2 v[12:13],v7,s[8:11],s60 offen sc1
s_add_u32 s60,s34,344064
buffer_store_dwordx4 v[12:15],v6,s[8:11],s60 offen sc1
buffer_store_dwordx2 v[12:13],v7,s[8:11],s60 offen sc1
s_nop 0
ls_5:
s_mul_i32 s73,s48,768
s_add_u32 s74,s73,96
v_add_u32 v12,0,v0
v_mul_u32_u24 v13,2731,v12
v_lshrrev_b32 v13,16,v13
v_mul_u32_u24 v16,24,v13
v_sub_u32 v12,v12,v16
v_mul_u32_u24 v104,12288,v13
v_lshl_add_u32 v104,v12,4,v104
v_mul_u32_u24 v13,43,v12
v_lshrrev_b32 v13,8,v13
v_mul_u32_u24 v13,96,v13
v_add_u32 v104,v104,v13
v_add_u32 v12,64,v0
v_mul_u32_u24 v13,2731,v12
v_lshrrev_b32 v13,16,v13
v_mul_u32_u24 v16,24,v13
v_sub_u32 v12,v12,v16
v_mul_u32_u24 v105,12288,v13
v_lshl_add_u32 v105,v12,4,v105
v_mul_u32_u24 v13,43,v12
v_lshrrev_b32 v13,8,v13
v_mul_u32_u24 v13,96,v13
v_add_u32 v105,v105,v13
v_add_u32 v12,128,v0
v_mul_u32_u24 v13,2731,v12
v_lshrrev_b32 v13,16,v13
v_mul_u32_u24 v16,24,v13
v_sub_u32 v12,v12,v16
v_mul_u32_u24 v106,12288,v13
v_lshl_add_u32 v106,v12,4,v106
v_mul_u32_u24 v13,43,v12
v_lshrrev_b32 v13,8,v13
v_mul_u32_u24 v13,96,v13
v_add_u32 v106,v106,v13
s_mov_b32 s4,s24
s_mov_b32 s5,s25
s_mov_b32 s6,7864320
s_mov_b32 s7,0x20000
s_mov_b32 s52,s24
s_mov_b32 s53,s25
s_mov_b32 s54,7864320
s_mov_b32 s55,0x20000
SV_LOAD:
s_waitcnt vmcnt(0)
s_barrier
s_cmp_lg_u32 s46,0
s_cbranch_scc1 arr_6
v_mov_b32 v12,1
s_lshl_b32 s3,s49,2
v_mov_b32 v13,s3
s_mov_b64 exec,1
buffer_atomic_add v12,v13,s[12:15],0 offen sc1
s_mov_b64 exec,-1
arr_6:
s_and_b32 s60,s46,1
s_mul_i32 s60,s60,196608
s_lshr_b32 s61,s46,1
s_mul_i32 s75,s61,393216
s_add_u32 s75,s75,s60
s_mul_i32 s76,s61,393216
s_add_u32 s76,s76,s60
s_mul_i32 s77,s46,6144
v_lshrrev_b32 v14,4,v0
v_and_b32 v15,15,v0
v_and_b32 v12,1,v14
v_lshlrev_b32 v12,2,v12
v_lshrrev_b32 v13,1,v14
v_lshl_add_u32 v12,v13,4,v12
v_bfe_u32 v13,v0,2,1
v_add_u32 v12,v12,v13
v_bfe_u32 v13,v0,3,1
v_lshl_add_u32 v12,v13,3,v12
v_mul_u32_u24 v107,384,v12
v_and_b32 v13,3,v0
v_lshl_add_u32 v107,v13,3,v107
s_mul_i32 s60,s46,96
v_add_u32 v107,s60,v107
s_add_u32 s60,s75,s73
s_add_u32 m0,s77,0
s_add_u32 s61,s60,0
buffer_load_dwordx4 v104,s[4:7],s61 offen lds
s_add_u32 m0,s77,1024
s_add_u32 s61,s60,0
buffer_load_dwordx4 v105,s[4:7],s61 offen lds
s_add_u32 m0,s77,2048
s_add_u32 s61,s60,0
buffer_load_dwordx4 v106,s[4:7],s61 offen lds
s_add_u32 m0,s77,3072
s_add_u32 s61,s60,98304
buffer_load_dwordx4 v104,s[4:7],s61 offen lds
s_add_u32 m0,s77,4096
s_add_u32 s61,s60,98304
buffer_load_dwordx4 v105,s[4:7],s61 offen lds
s_add_u32 m0,s77,5120
s_add_u32 s61,s60,98304
buffer_load_dwordx4 v106,s[4:7],s61 offen lds
s_add_u32 s60,s75,s74
s_add_u32 m0,s77,24576
s_add_u32 s61,s60,0
buffer_load_dwordx4 v104,s[52:55],s61 offen lds
s_add_u32 m0,s77,25600
s_add_u32 s61,s60,0
buffer_load_dwordx4 v105,s[52:55],s61 offen lds
s_add_u32 m0,s77,26624
s_add_u32 s61,s60,0
buffer_load_dwordx4 v106,s[52:55],s61 offen lds
s_add_u32 m0,s77,27648
s_add_u32 s61,s60,98304
buffer_load_dwordx4 v104,s[52:55],s61 offen lds
s_add_u32 m0,s77,28672
s_add_u32 s61,s60,98304
buffer_load_dwordx4 v105,s[52:55],s61 offen lds
s_add_u32 m0,s77,29696
s_add_u32 s61,s60,98304
buffer_load_dwordx4 v106,s[52:55],s61 offen lds
s_add_u32 s60,s75,s73
s_add_u32 m0,s77,49152
s_add_u32 s61,s60,786432
buffer_load_dwordx4 v104,s[4:7],s61 offen lds
s_add_u32 m0,s77,50176
s_add_u32 s61,s60,786432
buffer_load_dwordx4 v105,s[4:7],s61 offen lds
s_add_u32 m0,s77,51200
s_add_u32 s61,s60,786432
buffer_load_dwordx4 v106,s[4:7],s61 offen lds
s_add_u32 m0,s77,52224
s_add_u32 s61,s60,884736
buffer_load_dwordx4 v104,s[4:7],s61 offen lds
s_add_u32 m0,s77,53248
s_add_u32 s61,s60,884736
buffer_load_dwordx4 v105,s[4:7],s61 offen lds
s_add_u32 m0,s77,54272
s_add_u32 s61,s60,884736
buffer_load_dwordx4 v106,s[4:7],s61 offen lds
s_add_u32 s60,s75,s74
s_add_u32 m0,s77,73728
s_add_u32 s61,s60,786432
buffer_load_dwordx4 v104,s[52:55],s61 offen lds
s_add_u32 m0,s77,74752
s_add_u32 s61,s60,786432
buffer_load_dwordx4 v105,s[52:55],s61 offen lds
s_add_u32 m0,s77,75776
s_add_u32 s61,s60,786432
buffer_load_dwordx4 v106,s[52:55],s61 offen lds
s_add_u32 m0,s77,76800
s_add_u32 s61,s60,884736
buffer_load_dwordx4 v104,s[52:55],s61 offen lds
s_add_u32 m0,s77,77824
s_add_u32 s61,s60,884736
buffer_load_dwordx4 v105,s[52:55],s61 offen lds
s_add_u32 m0,s77,78848
s_add_u32 s61,s60,884736
buffer_load_dwordx4 v106,s[52:55],s61 offen lds
s_add_u32 s60,s75,s73
s_add_u32 m0,s77,98304
s_add_u32 s61,s60,1572864
buffer_load_dwordx4 v104,s[4:7],s61 offen lds
s_add_u32 m0,s77,99328
s_add_u32 s61,s60,1572864
buffer_load_dwordx4 v105,s[4:7],s61 offen lds
s_add_u32 m0,s77,100352
s_add_u32 s61,s60,1572864
buffer_load_dwordx4 v106,s[4:7],s61 offen lds
s_add_u32 m0,s77,101376
s_add_u32 s61,s60,1671168
buffer_load_dwordx4 v104,s[4:7],s61 offen lds
s_add_u32 m0,s77,102400
s_add_u32 s61,s60,1671168
buffer_load_dwordx4 v105,s[4:7],s61 offen lds
s_add_u32 m0,s77,103424
s_add_u32 s61,s60,1671168
buffer_load_dwordx4 v106,s[4:7],s61 offen lds
s_waitcnt vmcnt(24)
s_barrier
s_add_u32 s60,s75,s74
s_add_u32 m0,s77,122880
s_add_u32 s61,s60,1572864
buffer_load_dwordx4 v104,s[52:55],s61 offen lds
s_add_u32 m0,s77,123904
s_add_u32 s61,s60,1572864
buffer_load_dwordx4 v105,s[52:55],s61 offen lds
s_add_u32 m0,s77,124928
s_add_u32 s61,s60,1572864
buffer_load_dwordx4 v106,s[52:55],s61 offen lds
s_add_u32 m0,s77,125952
s_add_u32 s61,s60,1671168
buffer_load_dwordx4 v104,s[52:55],s61 offen lds
s_add_u32 m0,s77,126976
s_add_u32 s61,s60,1671168
buffer_load_dwordx4 v105,s[52:55],s61 offen lds
s_add_u32 m0,s77,128000
s_add_u32 s61,s60,1671168
buffer_load_dwordx4 v106,s[52:55],s61 offen lds
v_add_u32 v12,0,v107
s_cmp_eq_u32 s46,1
s_cbranch_scc1 lw_9
s_cmp_eq_u32 s46,2
s_cbranch_scc1 lw_10
s_cmp_eq_u32 s46,3
s_cbranch_scc1 lw_11
lw_8:
ds_read_b64_tr_b16 a[0:1],v12 offset:0
ds_read_b64_tr_b16 a[2:3],v12 offset:768
ds_read_b64_tr_b16 a[4:5],v12 offset:12288
ds_read_b64_tr_b16 a[6:7],v12 offset:13056
ds_read_b64_tr_b16 a[8:9],v12 offset:32
ds_read_b64_tr_b16 a[10:11],v12 offset:800
ds_read_b64_tr_b16 a[12:13],v12 offset:12320
ds_read_b64_tr_b16 a[14:15],v12 offset:13088
ds_read_b64_tr_b16 a[16:17],v12 offset:64
ds_read_b64_tr_b16 a[18:19],v12 offset:832
ds_read_b64_tr_b16 a[20:21],v12 offset:12352
ds_read_b64_tr_b16 a[22:23],v12 offset:13120
s_branch ld_7
lw_9:
ds_read_b64_tr_b16 a[240:241],v12 offset:0
ds_read_b64_tr_b16 a[242:243],v12 offset:768
ds_read_b64_tr_b16 a[244:245],v12 offset:12288
ds_read_b64_tr_b16 a[246:247],v12 offset:13056
ds_read_b64_tr_b16 a[248:249],v12 offset:32
ds_read_b64_tr_b16 a[250:251],v12 offset:800
ds_read_b64_tr_b16 a[252:253],v12 offset:12320
ds_read_b64_tr_b16 a[254:255],v12 offset:13088
ds_read_b64_tr_b16 v[112:113],v12 offset:64
ds_read_b64_tr_b16 v[114:115],v12 offset:832
ds_read_b64_tr_b16 v[116:117],v12 offset:12352
ds_read_b64_tr_b16 v[118:119],v12 offset:13120
s_branch ld_7
lw_10:
ds_read_b64_tr_b16 a[160:161],v12 offset:0
ds_read_b64_tr_b16 a[162:163],v12 offset:768
ds_read_b64_tr_b16 a[164:165],v12 offset:12288
ds_read_b64_tr_b16 a[166:167],v12 offset:13056
ds_read_b64_tr_b16 a[168:169],v12 offset:32
ds_read_b64_tr_b16 a[170:171],v12 offset:800
ds_read_b64_tr_b16 a[172:173],v12 offset:12320
ds_read_b64_tr_b16 a[174:175],v12 offset:13088
ds_read_b64_tr_b16 a[176:177],v12 offset:64
ds_read_b64_tr_b16 a[178:179],v12 offset:832
ds_read_b64_tr_b16 a[180:181],v12 offset:12352
ds_read_b64_tr_b16 a[182:183],v12 offset:13120
s_branch ld_7
lw_11:
ds_read_b64_tr_b16 a[80:81],v12 offset:0
ds_read_b64_tr_b16 a[82:83],v12 offset:768
ds_read_b64_tr_b16 a[84:85],v12 offset:12288
ds_read_b64_tr_b16 a[86:87],v12 offset:13056
ds_read_b64_tr_b16 a[88:89],v12 offset:32
ds_read_b64_tr_b16 a[90:91],v12 offset:800
ds_read_b64_tr_b16 a[92:93],v12 offset:12320
ds_read_b64_tr_b16 a[94:95],v12 offset:13088
ds_read_b64_tr_b16 a[96:97],v12 offset:64
ds_read_b64_tr_b16 a[98:99],v12 offset:832
ds_read_b64_tr_b16 a[100:101],v12 offset:12352
ds_read_b64_tr_b16 a[102:103],v12 offset:13120
ld_7:
s_waitcnt lgkmcnt(0)
s_waitcnt vmcnt(24)
s_barrier
s_add_u32 s60,s75,s73
s_add_u32 m0,s77,0
s_add_u32 s61,s60,2359296
buffer_load_dwordx4 v104,s[4:7],s61 offen lds
s_add_u32 m0,s77,1024
s_add_u32 s61,s60,2359296
buffer_load_dwordx4 v105,s[4:7],s61 offen lds
s_add_u32 m0,s77,2048
s_add_u32 s61,s60,2359296
buffer_load_dwordx4 v106,s[4:7],s61 offen lds
s_add_u32 m0,s77,3072
s_add_u32 s61,s60,2457600
buffer_load_dwordx4 v104,s[4:7],s61 offen lds
s_add_u32 m0,s77,4096
s_add_u32 s61,s60,2457600
buffer_load_dwordx4 v105,s[4:7],s61 offen lds
s_add_u32 m0,s77,5120
s_add_u32 s61,s60,2457600
buffer_load_dwordx4 v106,s[4:7],s61 offen lds
v_add_u32 v12,24576,v107
s_cmp_eq_u32 s46,1
s_cbranch_scc1 lw_14
s_cmp_eq_u32 s46,2
s_cbranch_scc1 lw_15
s_cmp_eq_u32 s46,3
s_cbranch_scc1 lw_16
lw_13:
ds_read_b64_tr_b16 a[24:25],v12 offset:0
ds_read_b64_tr_b16 a[26:27],v12 offset:768
ds_read_b64_tr_b16 a[28:29],v12 offset:12288
ds_read_b64_tr_b16 a[30:31],v12 offset:13056
ds_read_b64_tr_b16 a[32:33],v12 offset:32
ds_read_b64_tr_b16 a[34:35],v12 offset:800
ds_read_b64_tr_b16 a[36:37],v12 offset:12320
ds_read_b64_tr_b16 a[38:39],v12 offset:13088
ds_read_b64_tr_b16 v[24:25],v12 offset:64
ds_read_b64_tr_b16 v[26:27],v12 offset:832
ds_read_b64_tr_b16 v[28:29],v12 offset:12352
ds_read_b64_tr_b16 v[30:31],v12 offset:13120
s_branch ld_12
lw_14:
ds_read_b64_tr_b16 v[120:121],v12 offset:0
ds_read_b64_tr_b16 v[122:123],v12 offset:768
ds_read_b64_tr_b16 v[124:125],v12 offset:12288
ds_read_b64_tr_b16 v[126:127],v12 offset:13056
ds_read_b64_tr_b16 v[128:129],v12 offset:32
ds_read_b64_tr_b16 v[130:131],v12 offset:800
ds_read_b64_tr_b16 v[132:133],v12 offset:12320
ds_read_b64_tr_b16 v[134:135],v12 offset:13088
ds_read_b64_tr_b16 v[72:73],v12 offset:64
ds_read_b64_tr_b16 v[74:75],v12 offset:832
ds_read_b64_tr_b16 v[76:77],v12 offset:12352
ds_read_b64_tr_b16 v[78:79],v12 offset:13120
s_branch ld_12
lw_15:
ds_read_b64_tr_b16 a[184:185],v12 offset:0
ds_read_b64_tr_b16 a[186:187],v12 offset:768
ds_read_b64_tr_b16 a[188:189],v12 offset:12288
ds_read_b64_tr_b16 a[190:191],v12 offset:13056
ds_read_b64_tr_b16 a[192:193],v12 offset:32
ds_read_b64_tr_b16 a[194:195],v12 offset:800
ds_read_b64_tr_b16 a[196:197],v12 offset:12320
ds_read_b64_tr_b16 a[198:199],v12 offset:13088
ds_read_b64_tr_b16 v[56:57],v12 offset:64
ds_read_b64_tr_b16 v[58:59],v12 offset:832
ds_read_b64_tr_b16 v[60:61],v12 offset:12352
ds_read_b64_tr_b16 v[62:63],v12 offset:13120
s_branch ld_12
lw_16:
ds_read_b64_tr_b16 a[104:105],v12 offset:0
ds_read_b64_tr_b16 a[106:107],v12 offset:768
ds_read_b64_tr_b16 a[108:109],v12 offset:12288
ds_read_b64_tr_b16 a[110:111],v12 offset:13056
ds_read_b64_tr_b16 a[112:113],v12 offset:32
ds_read_b64_tr_b16 a[114:115],v12 offset:800
ds_read_b64_tr_b16 a[116:117],v12 offset:12320
ds_read_b64_tr_b16 a[118:119],v12 offset:13088
ds_read_b64_tr_b16 v[40:41],v12 offset:64
ds_read_b64_tr_b16 v[42:43],v12 offset:832
ds_read_b64_tr_b16 v[44:45],v12 offset:12352
ds_read_b64_tr_b16 v[46:47],v12 offset:13120
ld_12:
s_waitcnt lgkmcnt(0)
s_waitcnt vmcnt(24)
s_barrier
s_add_u32 s60,s75,s74
s_add_u32 m0,s77,24576
s_add_u32 s61,s60,2359296
buffer_load_dwordx4 v104,s[52:55],s61 offen lds
s_add_u32 m0,s77,25600
s_add_u32 s61,s60,2359296
buffer_load_dwordx4 v105,s[52:55],s61 offen lds
s_add_u32 m0,s77,26624
s_add_u32 s61,s60,2359296
buffer_load_dwordx4 v106,s[52:55],s61 offen lds
s_add_u32 m0,s77,27648
s_add_u32 s61,s60,2457600
buffer_load_dwordx4 v104,s[52:55],s61 offen lds
s_add_u32 m0,s77,28672
s_add_u32 s61,s60,2457600
buffer_load_dwordx4 v105,s[52:55],s61 offen lds
s_add_u32 m0,s77,29696
s_add_u32 s61,s60,2457600
buffer_load_dwordx4 v106,s[52:55],s61 offen lds
v_add_u32 v12,49152,v107
s_cmp_eq_u32 s46,1
s_cbranch_scc1 lw_19
s_cmp_eq_u32 s46,2
s_cbranch_scc1 lw_20
s_cmp_eq_u32 s46,3
s_cbranch_scc1 lw_21
lw_18:
ds_read_b64_tr_b16 a[40:41],v12 offset:0
ds_read_b64_tr_b16 a[42:43],v12 offset:768
ds_read_b64_tr_b16 a[44:45],v12 offset:12288
ds_read_b64_tr_b16 a[46:47],v12 offset:13056
ds_read_b64_tr_b16 a[48:49],v12 offset:32
ds_read_b64_tr_b16 a[50:51],v12 offset:800
ds_read_b64_tr_b16 a[52:53],v12 offset:12320
ds_read_b64_tr_b16 a[54:55],v12 offset:13088
ds_read_b64_tr_b16 a[56:57],v12 offset:64
ds_read_b64_tr_b16 a[58:59],v12 offset:832
ds_read_b64_tr_b16 a[60:61],v12 offset:12352
ds_read_b64_tr_b16 a[62:63],v12 offset:13120
s_branch ld_17
lw_19:
ds_read_b64_tr_b16 v[136:137],v12 offset:0
ds_read_b64_tr_b16 v[138:139],v12 offset:768
ds_read_b64_tr_b16 v[140:141],v12 offset:12288
ds_read_b64_tr_b16 v[142:143],v12 offset:13056
ds_read_b64_tr_b16 v[144:145],v12 offset:32
ds_read_b64_tr_b16 v[146:147],v12 offset:800
ds_read_b64_tr_b16 v[148:149],v12 offset:12320
ds_read_b64_tr_b16 v[150:151],v12 offset:13088
ds_read_b64_tr_b16 v[152:153],v12 offset:64
ds_read_b64_tr_b16 v[154:155],v12 offset:832
ds_read_b64_tr_b16 v[156:157],v12 offset:12352
ds_read_b64_tr_b16 v[158:159],v12 offset:13120
s_branch ld_17
lw_20:
ds_read_b64_tr_b16 a[200:201],v12 offset:0
ds_read_b64_tr_b16 a[202:203],v12 offset:768
ds_read_b64_tr_b16 a[204:205],v12 offset:12288
ds_read_b64_tr_b16 a[206:207],v12 offset:13056
ds_read_b64_tr_b16 a[208:209],v12 offset:32
ds_read_b64_tr_b16 a[210:211],v12 offset:800
ds_read_b64_tr_b16 a[212:213],v12 offset:12320
ds_read_b64_tr_b16 a[214:215],v12 offset:13088
ds_read_b64_tr_b16 a[216:217],v12 offset:64
ds_read_b64_tr_b16 a[218:219],v12 offset:832
ds_read_b64_tr_b16 a[220:221],v12 offset:12352
ds_read_b64_tr_b16 a[222:223],v12 offset:13120
s_branch ld_17
lw_21:
ds_read_b64_tr_b16 a[120:121],v12 offset:0
ds_read_b64_tr_b16 a[122:123],v12 offset:768
ds_read_b64_tr_b16 a[124:125],v12 offset:12288
ds_read_b64_tr_b16 a[126:127],v12 offset:13056
ds_read_b64_tr_b16 a[128:129],v12 offset:32
ds_read_b64_tr_b16 a[130:131],v12 offset:800
ds_read_b64_tr_b16 a[132:133],v12 offset:12320
ds_read_b64_tr_b16 a[134:135],v12 offset:13088
ds_read_b64_tr_b16 a[136:137],v12 offset:64
ds_read_b64_tr_b16 a[138:139],v12 offset:832
ds_read_b64_tr_b16 a[140:141],v12 offset:12352
ds_read_b64_tr_b16 a[142:143],v12 offset:13120
ld_17:
s_waitcnt lgkmcnt(0)
s_waitcnt vmcnt(24)
s_barrier
s_add_u32 s60,s75,s73
s_add_u32 m0,s77,49152
s_add_u32 s61,s60,3145728
buffer_load_dwordx4 v104,s[4:7],s61 offen lds
s_add_u32 m0,s77,50176
s_add_u32 s61,s60,3145728
buffer_load_dwordx4 v105,s[4:7],s61 offen lds
s_add_u32 m0,s77,51200
s_add_u32 s61,s60,3145728
buffer_load_dwordx4 v106,s[4:7],s61 offen lds
s_add_u32 m0,s77,52224
s_add_u32 s61,s60,3244032
buffer_load_dwordx4 v104,s[4:7],s61 offen lds
s_add_u32 m0,s77,53248
s_add_u32 s61,s60,3244032
buffer_load_dwordx4 v105,s[4:7],s61 offen lds
s_add_u32 m0,s77,54272
s_add_u32 s61,s60,3244032
buffer_load_dwordx4 v106,s[4:7],s61 offen lds
v_add_u32 v12,73728,v107
s_cmp_eq_u32 s46,1
s_cbranch_scc1 lw_24
s_cmp_eq_u32 s46,2
s_cbranch_scc1 lw_25
s_cmp_eq_u32 s46,3
s_cbranch_scc1 lw_26
lw_23:
ds_read_b64_tr_b16 a[64:65],v12 offset:0
ds_read_b64_tr_b16 a[66:67],v12 offset:768
ds_read_b64_tr_b16 a[68:69],v12 offset:12288
ds_read_b64_tr_b16 a[70:71],v12 offset:13056
ds_read_b64_tr_b16 a[72:73],v12 offset:32
ds_read_b64_tr_b16 a[74:75],v12 offset:800
ds_read_b64_tr_b16 a[76:77],v12 offset:12320
ds_read_b64_tr_b16 a[78:79],v12 offset:13088
ds_read_b64_tr_b16 v[32:33],v12 offset:64
ds_read_b64_tr_b16 v[34:35],v12 offset:832
ds_read_b64_tr_b16 v[36:37],v12 offset:12352
ds_read_b64_tr_b16 v[38:39],v12 offset:13120
s_branch ld_22
lw_24:
ds_read_b64_tr_b16 v[160:161],v12 offset:0
ds_read_b64_tr_b16 v[162:163],v12 offset:768
ds_read_b64_tr_b16 v[164:165],v12 offset:12288
ds_read_b64_tr_b16 v[166:167],v12 offset:13056
ds_read_b64_tr_b16 v[168:169],v12 offset:32
ds_read_b64_tr_b16 v[170:171],v12 offset:800
ds_read_b64_tr_b16 v[172:173],v12 offset:12320
ds_read_b64_tr_b16 v[174:175],v12 offset:13088
ds_read_b64_tr_b16 v[80:81],v12 offset:64
ds_read_b64_tr_b16 v[82:83],v12 offset:832
ds_read_b64_tr_b16 v[84:85],v12 offset:12352
ds_read_b64_tr_b16 v[86:87],v12 offset:13120
s_branch ld_22
lw_25:
ds_read_b64_tr_b16 a[224:225],v12 offset:0
ds_read_b64_tr_b16 a[226:227],v12 offset:768
ds_read_b64_tr_b16 a[228:229],v12 offset:12288
ds_read_b64_tr_b16 a[230:231],v12 offset:13056
ds_read_b64_tr_b16 a[232:233],v12 offset:32
ds_read_b64_tr_b16 a[234:235],v12 offset:800
ds_read_b64_tr_b16 a[236:237],v12 offset:12320
ds_read_b64_tr_b16 a[238:239],v12 offset:13088
ds_read_b64_tr_b16 v[64:65],v12 offset:64
ds_read_b64_tr_b16 v[66:67],v12 offset:832
ds_read_b64_tr_b16 v[68:69],v12 offset:12352
ds_read_b64_tr_b16 v[70:71],v12 offset:13120
s_branch ld_22
lw_26:
ds_read_b64_tr_b16 a[144:145],v12 offset:0
ds_read_b64_tr_b16 a[146:147],v12 offset:768
ds_read_b64_tr_b16 a[148:149],v12 offset:12288
ds_read_b64_tr_b16 a[150:151],v12 offset:13056
ds_read_b64_tr_b16 a[152:153],v12 offset:32
ds_read_b64_tr_b16 a[154:155],v12 offset:800
ds_read_b64_tr_b16 a[156:157],v12 offset:12320
ds_read_b64_tr_b16 a[158:159],v12 offset:13088
ds_read_b64_tr_b16 v[48:49],v12 offset:64
ds_read_b64_tr_b16 v[50:51],v12 offset:832
ds_read_b64_tr_b16 v[52:53],v12 offset:12352
ds_read_b64_tr_b16 v[54:55],v12 offset:13120
ld_22:
s_waitcnt lgkmcnt(0)
s_waitcnt vmcnt(24)
s_barrier
s_add_u32 s60,s75,s74
s_add_u32 m0,s77,73728
s_add_u32 s61,s60,3145728
buffer_load_dwordx4 v104,s[52:55],s61 offen lds
s_add_u32 m0,s77,74752
s_add_u32 s61,s60,3145728
buffer_load_dwordx4 v105,s[52:55],s61 offen lds
s_add_u32 m0,s77,75776
s_add_u32 s61,s60,3145728
buffer_load_dwordx4 v106,s[52:55],s61 offen lds
s_add_u32 m0,s77,76800
s_add_u32 s61,s60,3244032
buffer_load_dwordx4 v104,s[52:55],s61 offen lds
s_add_u32 m0,s77,77824
s_add_u32 s61,s60,3244032
buffer_load_dwordx4 v105,s[52:55],s61 offen lds
s_add_u32 m0,s77,78848
s_add_u32 s61,s60,3244032
buffer_load_dwordx4 v106,s[52:55],s61 offen lds
v_add_u32 v12,98304,v107
s_cmp_eq_u32 s46,1
s_cbranch_scc1 lw_29
s_cmp_eq_u32 s46,2
s_cbranch_scc1 lw_30
s_cmp_eq_u32 s46,3
s_cbranch_scc1 lw_31
lw_28:
ds_read_b64_tr_b16 a[80:81],v12 offset:0
ds_read_b64_tr_b16 a[82:83],v12 offset:768
ds_read_b64_tr_b16 a[84:85],v12 offset:12288
ds_read_b64_tr_b16 a[86:87],v12 offset:13056
ds_read_b64_tr_b16 a[88:89],v12 offset:32
ds_read_b64_tr_b16 a[90:91],v12 offset:800
ds_read_b64_tr_b16 a[92:93],v12 offset:12320
ds_read_b64_tr_b16 a[94:95],v12 offset:13088
ds_read_b64_tr_b16 a[96:97],v12 offset:64
ds_read_b64_tr_b16 a[98:99],v12 offset:832
ds_read_b64_tr_b16 a[100:101],v12 offset:12352
ds_read_b64_tr_b16 a[102:103],v12 offset:13120
s_branch ld_27
lw_29:
ds_read_b64_tr_b16 a[0:1],v12 offset:0
ds_read_b64_tr_b16 a[2:3],v12 offset:768
ds_read_b64_tr_b16 a[4:5],v12 offset:12288
ds_read_b64_tr_b16 a[6:7],v12 offset:13056
ds_read_b64_tr_b16 a[8:9],v12 offset:32
ds_read_b64_tr_b16 a[10:11],v12 offset:800
ds_read_b64_tr_b16 a[12:13],v12 offset:12320
ds_read_b64_tr_b16 a[14:15],v12 offset:13088
ds_read_b64_tr_b16 a[16:17],v12 offset:64
ds_read_b64_tr_b16 a[18:19],v12 offset:832
ds_read_b64_tr_b16 a[20:21],v12 offset:12352
ds_read_b64_tr_b16 a[22:23],v12 offset:13120
s_branch ld_27
lw_30:
ds_read_b64_tr_b16 a[240:241],v12 offset:0
ds_read_b64_tr_b16 a[242:243],v12 offset:768
ds_read_b64_tr_b16 a[244:245],v12 offset:12288
ds_read_b64_tr_b16 a[246:247],v12 offset:13056
ds_read_b64_tr_b16 a[248:249],v12 offset:32
ds_read_b64_tr_b16 a[250:251],v12 offset:800
ds_read_b64_tr_b16 a[252:253],v12 offset:12320
ds_read_b64_tr_b16 a[254:255],v12 offset:13088
ds_read_b64_tr_b16 v[112:113],v12 offset:64
ds_read_b64_tr_b16 v[114:115],v12 offset:832
ds_read_b64_tr_b16 v[116:117],v12 offset:12352
ds_read_b64_tr_b16 v[118:119],v12 offset:13120
s_branch ld_27
lw_31:
ds_read_b64_tr_b16 a[160:161],v12 offset:0
ds_read_b64_tr_b16 a[162:163],v12 offset:768
ds_read_b64_tr_b16 a[164:165],v12 offset:12288
ds_read_b64_tr_b16 a[166:167],v12 offset:13056
ds_read_b64_tr_b16 a[168:169],v12 offset:32
ds_read_b64_tr_b16 a[170:171],v12 offset:800
ds_read_b64_tr_b16 a[172:173],v12 offset:12320
ds_read_b64_tr_b16 a[174:175],v12 offset:13088
ds_read_b64_tr_b16 a[176:177],v12 offset:64
ds_read_b64_tr_b16 a[178:179],v12 offset:832
ds_read_b64_tr_b16 a[180:181],v12 offset:12352
ds_read_b64_tr_b16 a[182:183],v12 offset:13120
ld_27:
s_waitcnt lgkmcnt(0)
s_waitcnt vmcnt(24)
s_barrier
s_add_u32 s60,s75,s73
s_add_u32 m0,s77,98304
s_add_u32 s61,s60,3932160
buffer_load_dwordx4 v104,s[4:7],s61 offen lds
s_add_u32 m0,s77,99328
s_add_u32 s61,s60,3932160
buffer_load_dwordx4 v105,s[4:7],s61 offen lds
s_add_u32 m0,s77,100352
s_add_u32 s61,s60,3932160
buffer_load_dwordx4 v106,s[4:7],s61 offen lds
s_add_u32 m0,s77,101376
s_add_u32 s61,s60,4030464
buffer_load_dwordx4 v104,s[4:7],s61 offen lds
s_add_u32 m0,s77,102400
s_add_u32 s61,s60,4030464
buffer_load_dwordx4 v105,s[4:7],s61 offen lds
s_add_u32 m0,s77,103424
s_add_u32 s61,s60,4030464
buffer_load_dwordx4 v106,s[4:7],s61 offen lds
v_add_u32 v12,122880,v107
s_cmp_eq_u32 s46,1
s_cbranch_scc1 lw_34
s_cmp_eq_u32 s46,2
s_cbranch_scc1 lw_35
s_cmp_eq_u32 s46,3
s_cbranch_scc1 lw_36
lw_33:
ds_read_b64_tr_b16 a[104:105],v12 offset:0
ds_read_b64_tr_b16 a[106:107],v12 offset:768
ds_read_b64_tr_b16 a[108:109],v12 offset:12288
ds_read_b64_tr_b16 a[110:111],v12 offset:13056
ds_read_b64_tr_b16 a[112:113],v12 offset:32
ds_read_b64_tr_b16 a[114:115],v12 offset:800
ds_read_b64_tr_b16 a[116:117],v12 offset:12320
ds_read_b64_tr_b16 a[118:119],v12 offset:13088
ds_read_b64_tr_b16 v[40:41],v12 offset:64
ds_read_b64_tr_b16 v[42:43],v12 offset:832
ds_read_b64_tr_b16 v[44:45],v12 offset:12352
ds_read_b64_tr_b16 v[46:47],v12 offset:13120
s_branch ld_32
lw_34:
ds_read_b64_tr_b16 a[24:25],v12 offset:0
ds_read_b64_tr_b16 a[26:27],v12 offset:768
ds_read_b64_tr_b16 a[28:29],v12 offset:12288
ds_read_b64_tr_b16 a[30:31],v12 offset:13056
ds_read_b64_tr_b16 a[32:33],v12 offset:32
ds_read_b64_tr_b16 a[34:35],v12 offset:800
ds_read_b64_tr_b16 a[36:37],v12 offset:12320
ds_read_b64_tr_b16 a[38:39],v12 offset:13088
ds_read_b64_tr_b16 v[24:25],v12 offset:64
ds_read_b64_tr_b16 v[26:27],v12 offset:832
ds_read_b64_tr_b16 v[28:29],v12 offset:12352
ds_read_b64_tr_b16 v[30:31],v12 offset:13120
s_branch ld_32
lw_35:
ds_read_b64_tr_b16 v[120:121],v12 offset:0
ds_read_b64_tr_b16 v[122:123],v12 offset:768
ds_read_b64_tr_b16 v[124:125],v12 offset:12288
ds_read_b64_tr_b16 v[126:127],v12 offset:13056
ds_read_b64_tr_b16 v[128:129],v12 offset:32
ds_read_b64_tr_b16 v[130:131],v12 offset:800
ds_read_b64_tr_b16 v[132:133],v12 offset:12320
ds_read_b64_tr_b16 v[134:135],v12 offset:13088
ds_read_b64_tr_b16 v[72:73],v12 offset:64
ds_read_b64_tr_b16 v[74:75],v12 offset:832
ds_read_b64_tr_b16 v[76:77],v12 offset:12352
ds_read_b64_tr_b16 v[78:79],v12 offset:13120
s_branch ld_32
lw_36:
ds_read_b64_tr_b16 a[184:185],v12 offset:0
ds_read_b64_tr_b16 a[186:187],v12 offset:768
ds_read_b64_tr_b16 a[188:189],v12 offset:12288
ds_read_b64_tr_b16 a[190:191],v12 offset:13056
ds_read_b64_tr_b16 a[192:193],v12 offset:32
ds_read_b64_tr_b16 a[194:195],v12 offset:800
ds_read_b64_tr_b16 a[196:197],v12 offset:12320
ds_read_b64_tr_b16 a[198:199],v12 offset:13088
ds_read_b64_tr_b16 v[56:57],v12 offset:64
ds_read_b64_tr_b16 v[58:59],v12 offset:832
ds_read_b64_tr_b16 v[60:61],v12 offset:12352
ds_read_b64_tr_b16 v[62:63],v12 offset:13120
ld_32:
s_waitcnt lgkmcnt(0)
s_waitcnt vmcnt(24)
s_barrier
s_add_u32 s60,s75,s74
s_add_u32 m0,s77,122880
s_add_u32 s61,s60,3932160
buffer_load_dwordx4 v104,s[52:55],s61 offen lds
s_add_u32 m0,s77,123904
s_add_u32 s61,s60,3932160
buffer_load_dwordx4 v105,s[52:55],s61 offen lds
s_add_u32 m0,s77,124928
s_add_u32 s61,s60,3932160
buffer_load_dwordx4 v106,s[52:55],s61 offen lds
s_add_u32 m0,s77,125952
s_add_u32 s61,s60,4030464
buffer_load_dwordx4 v104,s[52:55],s61 offen lds
s_add_u32 m0,s77,126976
s_add_u32 s61,s60,4030464
buffer_load_dwordx4 v105,s[52:55],s61 offen lds
s_add_u32 m0,s77,128000
s_add_u32 s61,s60,4030464
buffer_load_dwordx4 v106,s[52:55],s61 offen lds
v_add_u32 v12,0,v107
s_cmp_eq_u32 s46,1
s_cbranch_scc1 lw_39
s_cmp_eq_u32 s46,2
s_cbranch_scc1 lw_40
s_cmp_eq_u32 s46,3
s_cbranch_scc1 lw_41
lw_38:
ds_read_b64_tr_b16 a[120:121],v12 offset:0
ds_read_b64_tr_b16 a[122:123],v12 offset:768
ds_read_b64_tr_b16 a[124:125],v12 offset:12288
ds_read_b64_tr_b16 a[126:127],v12 offset:13056
ds_read_b64_tr_b16 a[128:129],v12 offset:32
ds_read_b64_tr_b16 a[130:131],v12 offset:800
ds_read_b64_tr_b16 a[132:133],v12 offset:12320
ds_read_b64_tr_b16 a[134:135],v12 offset:13088
ds_read_b64_tr_b16 a[136:137],v12 offset:64
ds_read_b64_tr_b16 a[138:139],v12 offset:832
ds_read_b64_tr_b16 a[140:141],v12 offset:12352
ds_read_b64_tr_b16 a[142:143],v12 offset:13120
s_branch ld_37
lw_39:
ds_read_b64_tr_b16 a[40:41],v12 offset:0
ds_read_b64_tr_b16 a[42:43],v12 offset:768
ds_read_b64_tr_b16 a[44:45],v12 offset:12288
ds_read_b64_tr_b16 a[46:47],v12 offset:13056
ds_read_b64_tr_b16 a[48:49],v12 offset:32
ds_read_b64_tr_b16 a[50:51],v12 offset:800
ds_read_b64_tr_b16 a[52:53],v12 offset:12320
ds_read_b64_tr_b16 a[54:55],v12 offset:13088
ds_read_b64_tr_b16 a[56:57],v12 offset:64
ds_read_b64_tr_b16 a[58:59],v12 offset:832
ds_read_b64_tr_b16 a[60:61],v12 offset:12352
ds_read_b64_tr_b16 a[62:63],v12 offset:13120
s_branch ld_37
lw_40:
ds_read_b64_tr_b16 v[136:137],v12 offset:0
ds_read_b64_tr_b16 v[138:139],v12 offset:768
ds_read_b64_tr_b16 v[140:141],v12 offset:12288
ds_read_b64_tr_b16 v[142:143],v12 offset:13056
ds_read_b64_tr_b16 v[144:145],v12 offset:32
ds_read_b64_tr_b16 v[146:147],v12 offset:800
ds_read_b64_tr_b16 v[148:149],v12 offset:12320
ds_read_b64_tr_b16 v[150:151],v12 offset:13088
ds_read_b64_tr_b16 v[152:153],v12 offset:64
ds_read_b64_tr_b16 v[154:155],v12 offset:832
ds_read_b64_tr_b16 v[156:157],v12 offset:12352
ds_read_b64_tr_b16 v[158:159],v12 offset:13120
s_branch ld_37
lw_41:
ds_read_b64_tr_b16 a[200:201],v12 offset:0
ds_read_b64_tr_b16 a[202:203],v12 offset:768
ds_read_b64_tr_b16 a[204:205],v12 offset:12288
ds_read_b64_tr_b16 a[206:207],v12 offset:13056
ds_read_b64_tr_b16 a[208:209],v12 offset:32
ds_read_b64_tr_b16 a[210:211],v12 offset:800
ds_read_b64_tr_b16 a[212:213],v12 offset:12320
ds_read_b64_tr_b16 a[214:215],v12 offset:13088
ds_read_b64_tr_b16 a[216:217],v12 offset:64
ds_read_b64_tr_b16 a[218:219],v12 offset:832
ds_read_b64_tr_b16 a[220:221],v12 offset:12352
ds_read_b64_tr_b16 a[222:223],v12 offset:13120
ld_37:
s_waitcnt lgkmcnt(0)
s_waitcnt vmcnt(24)
s_barrier
s_add_u32 s60,s75,s73
s_add_u32 m0,s77,0
s_add_u32 s61,s60,4718592
buffer_load_dwordx4 v104,s[4:7],s61 offen lds
s_add_u32 m0,s77,1024
s_add_u32 s61,s60,4718592
buffer_load_dwordx4 v105,s[4:7],s61 offen lds
s_add_u32 m0,s77,2048
s_add_u32 s61,s60,4718592
buffer_load_dwordx4 v106,s[4:7],s61 offen lds
s_add_u32 m0,s77,3072
s_add_u32 s61,s60,4816896
buffer_load_dwordx4 v104,s[4:7],s61 offen lds
s_add_u32 m0,s77,4096
s_add_u32 s61,s60,4816896
buffer_load_dwordx4 v105,s[4:7],s61 offen lds
s_add_u32 m0,s77,5120
s_add_u32 s61,s60,4816896
buffer_load_dwordx4 v106,s[4:7],s61 offen lds
v_add_u32 v12,24576,v107
s_cmp_eq_u32 s46,1
s_cbranch_scc1 lw_44
s_cmp_eq_u32 s46,2
s_cbranch_scc1 lw_45
s_cmp_eq_u32 s46,3
s_cbranch_scc1 lw_46
lw_43:
ds_read_b64_tr_b16 a[144:145],v12 offset:0
ds_read_b64_tr_b16 a[146:147],v12 offset:768
ds_read_b64_tr_b16 a[148:149],v12 offset:12288
ds_read_b64_tr_b16 a[150:151],v12 offset:13056
ds_read_b64_tr_b16 a[152:153],v12 offset:32
ds_read_b64_tr_b16 a[154:155],v12 offset:800
ds_read_b64_tr_b16 a[156:157],v12 offset:12320
ds_read_b64_tr_b16 a[158:159],v12 offset:13088
ds_read_b64_tr_b16 v[48:49],v12 offset:64
ds_read_b64_tr_b16 v[50:51],v12 offset:832
ds_read_b64_tr_b16 v[52:53],v12 offset:12352
ds_read_b64_tr_b16 v[54:55],v12 offset:13120
s_branch ld_42
lw_44:
ds_read_b64_tr_b16 a[64:65],v12 offset:0
ds_read_b64_tr_b16 a[66:67],v12 offset:768
ds_read_b64_tr_b16 a[68:69],v12 offset:12288
ds_read_b64_tr_b16 a[70:71],v12 offset:13056
ds_read_b64_tr_b16 a[72:73],v12 offset:32
ds_read_b64_tr_b16 a[74:75],v12 offset:800
ds_read_b64_tr_b16 a[76:77],v12 offset:12320
ds_read_b64_tr_b16 a[78:79],v12 offset:13088
ds_read_b64_tr_b16 v[32:33],v12 offset:64
ds_read_b64_tr_b16 v[34:35],v12 offset:832
ds_read_b64_tr_b16 v[36:37],v12 offset:12352
ds_read_b64_tr_b16 v[38:39],v12 offset:13120
s_branch ld_42
lw_45:
ds_read_b64_tr_b16 v[160:161],v12 offset:0
ds_read_b64_tr_b16 v[162:163],v12 offset:768
ds_read_b64_tr_b16 v[164:165],v12 offset:12288
ds_read_b64_tr_b16 v[166:167],v12 offset:13056
ds_read_b64_tr_b16 v[168:169],v12 offset:32
ds_read_b64_tr_b16 v[170:171],v12 offset:800
ds_read_b64_tr_b16 v[172:173],v12 offset:12320
ds_read_b64_tr_b16 v[174:175],v12 offset:13088
ds_read_b64_tr_b16 v[80:81],v12 offset:64
ds_read_b64_tr_b16 v[82:83],v12 offset:832
ds_read_b64_tr_b16 v[84:85],v12 offset:12352
ds_read_b64_tr_b16 v[86:87],v12 offset:13120
s_branch ld_42
lw_46:
ds_read_b64_tr_b16 a[224:225],v12 offset:0
ds_read_b64_tr_b16 a[226:227],v12 offset:768
ds_read_b64_tr_b16 a[228:229],v12 offset:12288
ds_read_b64_tr_b16 a[230:231],v12 offset:13056
ds_read_b64_tr_b16 a[232:233],v12 offset:32
ds_read_b64_tr_b16 a[234:235],v12 offset:800
ds_read_b64_tr_b16 a[236:237],v12 offset:12320
ds_read_b64_tr_b16 a[238:239],v12 offset:13088
ds_read_b64_tr_b16 v[64:65],v12 offset:64
ds_read_b64_tr_b16 v[66:67],v12 offset:832
ds_read_b64_tr_b16 v[68:69],v12 offset:12352
ds_read_b64_tr_b16 v[70:71],v12 offset:13120
ld_42:
s_waitcnt lgkmcnt(0)
s_waitcnt vmcnt(24)
s_barrier
s_add_u32 s60,s75,s74
s_add_u32 m0,s77,24576
s_add_u32 s61,s60,4718592
buffer_load_dwordx4 v104,s[52:55],s61 offen lds
s_add_u32 m0,s77,25600
s_add_u32 s61,s60,4718592
buffer_load_dwordx4 v105,s[52:55],s61 offen lds
s_add_u32 m0,s77,26624
s_add_u32 s61,s60,4718592
buffer_load_dwordx4 v106,s[52:55],s61 offen lds
s_add_u32 m0,s77,27648
s_add_u32 s61,s60,4816896
buffer_load_dwordx4 v104,s[52:55],s61 offen lds
s_add_u32 m0,s77,28672
s_add_u32 s61,s60,4816896
buffer_load_dwordx4 v105,s[52:55],s61 offen lds
s_add_u32 m0,s77,29696
s_add_u32 s61,s60,4816896
buffer_load_dwordx4 v106,s[52:55],s61 offen lds
v_add_u32 v12,49152,v107
s_cmp_eq_u32 s46,1
s_cbranch_scc1 lw_49
s_cmp_eq_u32 s46,2
s_cbranch_scc1 lw_50
s_cmp_eq_u32 s46,3
s_cbranch_scc1 lw_51
lw_48:
ds_read_b64_tr_b16 a[160:161],v12 offset:0
ds_read_b64_tr_b16 a[162:163],v12 offset:768
ds_read_b64_tr_b16 a[164:165],v12 offset:12288
ds_read_b64_tr_b16 a[166:167],v12 offset:13056
ds_read_b64_tr_b16 a[168:169],v12 offset:32
ds_read_b64_tr_b16 a[170:171],v12 offset:800
ds_read_b64_tr_b16 a[172:173],v12 offset:12320
ds_read_b64_tr_b16 a[174:175],v12 offset:13088
ds_read_b64_tr_b16 a[176:177],v12 offset:64
ds_read_b64_tr_b16 a[178:179],v12 offset:832
ds_read_b64_tr_b16 a[180:181],v12 offset:12352
ds_read_b64_tr_b16 a[182:183],v12 offset:13120
s_branch ld_47
lw_49:
ds_read_b64_tr_b16 a[80:81],v12 offset:0
ds_read_b64_tr_b16 a[82:83],v12 offset:768
ds_read_b64_tr_b16 a[84:85],v12 offset:12288
ds_read_b64_tr_b16 a[86:87],v12 offset:13056
ds_read_b64_tr_b16 a[88:89],v12 offset:32
ds_read_b64_tr_b16 a[90:91],v12 offset:800
ds_read_b64_tr_b16 a[92:93],v12 offset:12320
ds_read_b64_tr_b16 a[94:95],v12 offset:13088
ds_read_b64_tr_b16 a[96:97],v12 offset:64
ds_read_b64_tr_b16 a[98:99],v12 offset:832
ds_read_b64_tr_b16 a[100:101],v12 offset:12352
ds_read_b64_tr_b16 a[102:103],v12 offset:13120
s_branch ld_47
lw_50:
ds_read_b64_tr_b16 a[0:1],v12 offset:0
ds_read_b64_tr_b16 a[2:3],v12 offset:768
ds_read_b64_tr_b16 a[4:5],v12 offset:12288
ds_read_b64_tr_b16 a[6:7],v12 offset:13056
ds_read_b64_tr_b16 a[8:9],v12 offset:32
ds_read_b64_tr_b16 a[10:11],v12 offset:800
ds_read_b64_tr_b16 a[12:13],v12 offset:12320
ds_read_b64_tr_b16 a[14:15],v12 offset:13088
ds_read_b64_tr_b16 a[16:17],v12 offset:64
ds_read_b64_tr_b16 a[18:19],v12 offset:832
ds_read_b64_tr_b16 a[20:21],v12 offset:12352
ds_read_b64_tr_b16 a[22:23],v12 offset:13120
s_branch ld_47
lw_51:
ds_read_b64_tr_b16 a[240:241],v12 offset:0
ds_read_b64_tr_b16 a[242:243],v12 offset:768
ds_read_b64_tr_b16 a[244:245],v12 offset:12288
ds_read_b64_tr_b16 a[246:247],v12 offset:13056
ds_read_b64_tr_b16 a[248:249],v12 offset:32
ds_read_b64_tr_b16 a[250:251],v12 offset:800
ds_read_b64_tr_b16 a[252:253],v12 offset:12320
ds_read_b64_tr_b16 a[254:255],v12 offset:13088
ds_read_b64_tr_b16 v[112:113],v12 offset:64
ds_read_b64_tr_b16 v[114:115],v12 offset:832
ds_read_b64_tr_b16 v[116:117],v12 offset:12352
ds_read_b64_tr_b16 v[118:119],v12 offset:13120
ld_47:
s_waitcnt lgkmcnt(0)
s_waitcnt vmcnt(24)
s_barrier
s_add_u32 s60,s75,s73
s_add_u32 m0,s77,49152
s_add_u32 s61,s60,5505024
buffer_load_dwordx4 v104,s[4:7],s61 offen lds
s_add_u32 m0,s77,50176
s_add_u32 s61,s60,5505024
buffer_load_dwordx4 v105,s[4:7],s61 offen lds
s_add_u32 m0,s77,51200
s_add_u32 s61,s60,5505024
buffer_load_dwordx4 v106,s[4:7],s61 offen lds
s_add_u32 m0,s77,52224
s_add_u32 s61,s60,5603328
buffer_load_dwordx4 v104,s[4:7],s61 offen lds
s_add_u32 m0,s77,53248
s_add_u32 s61,s60,5603328
buffer_load_dwordx4 v105,s[4:7],s61 offen lds
s_add_u32 m0,s77,54272
s_add_u32 s61,s60,5603328
buffer_load_dwordx4 v106,s[4:7],s61 offen lds
v_add_u32 v12,73728,v107
s_cmp_eq_u32 s46,1
s_cbranch_scc1 lw_54
s_cmp_eq_u32 s46,2
s_cbranch_scc1 lw_55
s_cmp_eq_u32 s46,3
s_cbranch_scc1 lw_56
lw_53:
ds_read_b64_tr_b16 a[184:185],v12 offset:0
ds_read_b64_tr_b16 a[186:187],v12 offset:768
ds_read_b64_tr_b16 a[188:189],v12 offset:12288
ds_read_b64_tr_b16 a[190:191],v12 offset:13056
ds_read_b64_tr_b16 a[192:193],v12 offset:32
ds_read_b64_tr_b16 a[194:195],v12 offset:800
ds_read_b64_tr_b16 a[196:197],v12 offset:12320
ds_read_b64_tr_b16 a[198:199],v12 offset:13088
ds_read_b64_tr_b16 v[56:57],v12 offset:64
ds_read_b64_tr_b16 v[58:59],v12 offset:832
ds_read_b64_tr_b16 v[60:61],v12 offset:12352
ds_read_b64_tr_b16 v[62:63],v12 offset:13120
s_branch ld_52
lw_54:
ds_read_b64_tr_b16 a[104:105],v12 offset:0
ds_read_b64_tr_b16 a[106:107],v12 offset:768
ds_read_b64_tr_b16 a[108:109],v12 offset:12288
ds_read_b64_tr_b16 a[110:111],v12 offset:13056
ds_read_b64_tr_b16 a[112:113],v12 offset:32
ds_read_b64_tr_b16 a[114:115],v12 offset:800
ds_read_b64_tr_b16 a[116:117],v12 offset:12320
ds_read_b64_tr_b16 a[118:119],v12 offset:13088
ds_read_b64_tr_b16 v[40:41],v12 offset:64
ds_read_b64_tr_b16 v[42:43],v12 offset:832
ds_read_b64_tr_b16 v[44:45],v12 offset:12352
ds_read_b64_tr_b16 v[46:47],v12 offset:13120
s_branch ld_52
lw_55:
ds_read_b64_tr_b16 a[24:25],v12 offset:0
ds_read_b64_tr_b16 a[26:27],v12 offset:768
ds_read_b64_tr_b16 a[28:29],v12 offset:12288
ds_read_b64_tr_b16 a[30:31],v12 offset:13056
ds_read_b64_tr_b16 a[32:33],v12 offset:32
ds_read_b64_tr_b16 a[34:35],v12 offset:800
ds_read_b64_tr_b16 a[36:37],v12 offset:12320
ds_read_b64_tr_b16 a[38:39],v12 offset:13088
ds_read_b64_tr_b16 v[24:25],v12 offset:64
ds_read_b64_tr_b16 v[26:27],v12 offset:832
ds_read_b64_tr_b16 v[28:29],v12 offset:12352
ds_read_b64_tr_b16 v[30:31],v12 offset:13120
s_branch ld_52
lw_56:
ds_read_b64_tr_b16 v[120:121],v12 offset:0
ds_read_b64_tr_b16 v[122:123],v12 offset:768
ds_read_b64_tr_b16 v[124:125],v12 offset:12288
ds_read_b64_tr_b16 v[126:127],v12 offset:13056
ds_read_b64_tr_b16 v[128:129],v12 offset:32
ds_read_b64_tr_b16 v[130:131],v12 offset:800
ds_read_b64_tr_b16 v[132:133],v12 offset:12320
ds_read_b64_tr_b16 v[134:135],v12 offset:13088
ds_read_b64_tr_b16 v[72:73],v12 offset:64
ds_read_b64_tr_b16 v[74:75],v12 offset:832
ds_read_b64_tr_b16 v[76:77],v12 offset:12352
ds_read_b64_tr_b16 v[78:79],v12 offset:13120
ld_52:
s_waitcnt lgkmcnt(0)
s_waitcnt vmcnt(24)
s_barrier
s_add_u32 s60,s75,s74
s_add_u32 m0,s77,73728
s_add_u32 s61,s60,5505024
buffer_load_dwordx4 v104,s[52:55],s61 offen lds
s_add_u32 m0,s77,74752
s_add_u32 s61,s60,5505024
buffer_load_dwordx4 v105,s[52:55],s61 offen lds
s_add_u32 m0,s77,75776
s_add_u32 s61,s60,5505024
buffer_load_dwordx4 v106,s[52:55],s61 offen lds
s_add_u32 m0,s77,76800
s_add_u32 s61,s60,5603328
buffer_load_dwordx4 v104,s[52:55],s61 offen lds
s_add_u32 m0,s77,77824
s_add_u32 s61,s60,5603328
buffer_load_dwordx4 v105,s[52:55],s61 offen lds
s_add_u32 m0,s77,78848
s_add_u32 s61,s60,5603328
buffer_load_dwordx4 v106,s[52:55],s61 offen lds
v_add_u32 v12,98304,v107
s_cmp_eq_u32 s46,1
s_cbranch_scc1 lw_59
s_cmp_eq_u32 s46,2
s_cbranch_scc1 lw_60
s_cmp_eq_u32 s46,3
s_cbranch_scc1 lw_61
lw_58:
ds_read_b64_tr_b16 a[200:201],v12 offset:0
ds_read_b64_tr_b16 a[202:203],v12 offset:768
ds_read_b64_tr_b16 a[204:205],v12 offset:12288
ds_read_b64_tr_b16 a[206:207],v12 offset:13056
ds_read_b64_tr_b16 a[208:209],v12 offset:32
ds_read_b64_tr_b16 a[210:211],v12 offset:800
ds_read_b64_tr_b16 a[212:213],v12 offset:12320
ds_read_b64_tr_b16 a[214:215],v12 offset:13088
ds_read_b64_tr_b16 a[216:217],v12 offset:64
ds_read_b64_tr_b16 a[218:219],v12 offset:832
ds_read_b64_tr_b16 a[220:221],v12 offset:12352
ds_read_b64_tr_b16 a[222:223],v12 offset:13120
s_branch ld_57
lw_59:
ds_read_b64_tr_b16 a[120:121],v12 offset:0
ds_read_b64_tr_b16 a[122:123],v12 offset:768
ds_read_b64_tr_b16 a[124:125],v12 offset:12288
ds_read_b64_tr_b16 a[126:127],v12 offset:13056
ds_read_b64_tr_b16 a[128:129],v12 offset:32
ds_read_b64_tr_b16 a[130:131],v12 offset:800
ds_read_b64_tr_b16 a[132:133],v12 offset:12320
ds_read_b64_tr_b16 a[134:135],v12 offset:13088
ds_read_b64_tr_b16 a[136:137],v12 offset:64
ds_read_b64_tr_b16 a[138:139],v12 offset:832
ds_read_b64_tr_b16 a[140:141],v12 offset:12352
ds_read_b64_tr_b16 a[142:143],v12 offset:13120
s_branch ld_57
lw_60:
ds_read_b64_tr_b16 a[40:41],v12 offset:0
ds_read_b64_tr_b16 a[42:43],v12 offset:768
ds_read_b64_tr_b16 a[44:45],v12 offset:12288
ds_read_b64_tr_b16 a[46:47],v12 offset:13056
ds_read_b64_tr_b16 a[48:49],v12 offset:32
ds_read_b64_tr_b16 a[50:51],v12 offset:800
ds_read_b64_tr_b16 a[52:53],v12 offset:12320
ds_read_b64_tr_b16 a[54:55],v12 offset:13088
ds_read_b64_tr_b16 a[56:57],v12 offset:64
ds_read_b64_tr_b16 a[58:59],v12 offset:832
ds_read_b64_tr_b16 a[60:61],v12 offset:12352
ds_read_b64_tr_b16 a[62:63],v12 offset:13120
s_branch ld_57
lw_61:
ds_read_b64_tr_b16 v[136:137],v12 offset:0
ds_read_b64_tr_b16 v[138:139],v12 offset:768
ds_read_b64_tr_b16 v[140:141],v12 offset:12288
ds_read_b64_tr_b16 v[142:143],v12 offset:13056
ds_read_b64_tr_b16 v[144:145],v12 offset:32
ds_read_b64_tr_b16 v[146:147],v12 offset:800
ds_read_b64_tr_b16 v[148:149],v12 offset:12320
ds_read_b64_tr_b16 v[150:151],v12 offset:13088
ds_read_b64_tr_b16 v[152:153],v12 offset:64
ds_read_b64_tr_b16 v[154:155],v12 offset:832
ds_read_b64_tr_b16 v[156:157],v12 offset:12352
ds_read_b64_tr_b16 v[158:159],v12 offset:13120
ld_57:
s_waitcnt lgkmcnt(0)
s_waitcnt vmcnt(24)
s_barrier
s_add_u32 s60,s76,s73
s_add_u32 m0,s77,98304
s_add_u32 s61,s60,6291456
buffer_load_dwordx4 v104,s[4:7],s61 offen lds
s_add_u32 m0,s77,99328
s_add_u32 s61,s60,6291456
buffer_load_dwordx4 v105,s[4:7],s61 offen lds
s_add_u32 m0,s77,100352
s_add_u32 s61,s60,6291456
buffer_load_dwordx4 v106,s[4:7],s61 offen lds
s_add_u32 m0,s77,101376
s_add_u32 s61,s60,6389760
buffer_load_dwordx4 v104,s[4:7],s61 offen lds
s_add_u32 m0,s77,102400
s_add_u32 s61,s60,6389760
buffer_load_dwordx4 v105,s[4:7],s61 offen lds
s_add_u32 m0,s77,103424
s_add_u32 s61,s60,6389760
buffer_load_dwordx4 v106,s[4:7],s61 offen lds
v_add_u32 v12,122880,v107
s_cmp_eq_u32 s46,1
s_cbranch_scc1 lw_64
s_cmp_eq_u32 s46,2
s_cbranch_scc1 lw_65
s_cmp_eq_u32 s46,3
s_cbranch_scc1 lw_66
lw_63:
ds_read_b64_tr_b16 a[224:225],v12 offset:0
ds_read_b64_tr_b16 a[226:227],v12 offset:768
ds_read_b64_tr_b16 a[228:229],v12 offset:12288
ds_read_b64_tr_b16 a[230:231],v12 offset:13056
ds_read_b64_tr_b16 a[232:233],v12 offset:32
ds_read_b64_tr_b16 a[234:235],v12 offset:800
ds_read_b64_tr_b16 a[236:237],v12 offset:12320
ds_read_b64_tr_b16 a[238:239],v12 offset:13088
ds_read_b64_tr_b16 v[64:65],v12 offset:64
ds_read_b64_tr_b16 v[66:67],v12 offset:832
ds_read_b64_tr_b16 v[68:69],v12 offset:12352
ds_read_b64_tr_b16 v[70:71],v12 offset:13120
s_branch ld_62
lw_64:
ds_read_b64_tr_b16 a[144:145],v12 offset:0
ds_read_b64_tr_b16 a[146:147],v12 offset:768
ds_read_b64_tr_b16 a[148:149],v12 offset:12288
ds_read_b64_tr_b16 a[150:151],v12 offset:13056
ds_read_b64_tr_b16 a[152:153],v12 offset:32
ds_read_b64_tr_b16 a[154:155],v12 offset:800
ds_read_b64_tr_b16 a[156:157],v12 offset:12320
ds_read_b64_tr_b16 a[158:159],v12 offset:13088
ds_read_b64_tr_b16 v[48:49],v12 offset:64
ds_read_b64_tr_b16 v[50:51],v12 offset:832
ds_read_b64_tr_b16 v[52:53],v12 offset:12352
ds_read_b64_tr_b16 v[54:55],v12 offset:13120
s_branch ld_62
lw_65:
ds_read_b64_tr_b16 a[64:65],v12 offset:0
ds_read_b64_tr_b16 a[66:67],v12 offset:768
ds_read_b64_tr_b16 a[68:69],v12 offset:12288
ds_read_b64_tr_b16 a[70:71],v12 offset:13056
ds_read_b64_tr_b16 a[72:73],v12 offset:32
ds_read_b64_tr_b16 a[74:75],v12 offset:800
ds_read_b64_tr_b16 a[76:77],v12 offset:12320
ds_read_b64_tr_b16 a[78:79],v12 offset:13088
ds_read_b64_tr_b16 v[32:33],v12 offset:64
ds_read_b64_tr_b16 v[34:35],v12 offset:832
ds_read_b64_tr_b16 v[36:37],v12 offset:12352
ds_read_b64_tr_b16 v[38:39],v12 offset:13120
s_branch ld_62
lw_66:
ds_read_b64_tr_b16 v[160:161],v12 offset:0
ds_read_b64_tr_b16 v[162:163],v12 offset:768
ds_read_b64_tr_b16 v[164:165],v12 offset:12288
ds_read_b64_tr_b16 v[166:167],v12 offset:13056
ds_read_b64_tr_b16 v[168:169],v12 offset:32
ds_read_b64_tr_b16 v[170:171],v12 offset:800
ds_read_b64_tr_b16 v[172:173],v12 offset:12320
ds_read_b64_tr_b16 v[174:175],v12 offset:13088
ds_read_b64_tr_b16 v[80:81],v12 offset:64
ds_read_b64_tr_b16 v[82:83],v12 offset:832
ds_read_b64_tr_b16 v[84:85],v12 offset:12352
ds_read_b64_tr_b16 v[86:87],v12 offset:13120
ld_62:
s_waitcnt lgkmcnt(0)
s_waitcnt vmcnt(24)
s_barrier
s_add_u32 s60,s76,s74
s_add_u32 m0,s77,122880
s_add_u32 s61,s60,6291456
buffer_load_dwordx4 v104,s[52:55],s61 offen lds
s_add_u32 m0,s77,123904
s_add_u32 s61,s60,6291456
buffer_load_dwordx4 v105,s[52:55],s61 offen lds
s_add_u32 m0,s77,124928
s_add_u32 s61,s60,6291456
buffer_load_dwordx4 v106,s[52:55],s61 offen lds
s_add_u32 m0,s77,125952
s_add_u32 s61,s60,6389760
buffer_load_dwordx4 v104,s[52:55],s61 offen lds
s_add_u32 m0,s77,126976
s_add_u32 s61,s60,6389760
buffer_load_dwordx4 v105,s[52:55],s61 offen lds
s_add_u32 m0,s77,128000
s_add_u32 s61,s60,6389760
buffer_load_dwordx4 v106,s[52:55],s61 offen lds
v_add_u32 v12,0,v107
s_cmp_eq_u32 s46,1
s_cbranch_scc1 lw_69
s_cmp_eq_u32 s46,2
s_cbranch_scc1 lw_70
s_cmp_eq_u32 s46,3
s_cbranch_scc1 lw_71
lw_68:
ds_read_b64_tr_b16 a[240:241],v12 offset:0
ds_read_b64_tr_b16 a[242:243],v12 offset:768
ds_read_b64_tr_b16 a[244:245],v12 offset:12288
ds_read_b64_tr_b16 a[246:247],v12 offset:13056
ds_read_b64_tr_b16 a[248:249],v12 offset:32
ds_read_b64_tr_b16 a[250:251],v12 offset:800
ds_read_b64_tr_b16 a[252:253],v12 offset:12320
ds_read_b64_tr_b16 a[254:255],v12 offset:13088
ds_read_b64_tr_b16 v[112:113],v12 offset:64
ds_read_b64_tr_b16 v[114:115],v12 offset:832
ds_read_b64_tr_b16 v[116:117],v12 offset:12352
ds_read_b64_tr_b16 v[118:119],v12 offset:13120
s_branch ld_67
lw_69:
ds_read_b64_tr_b16 a[160:161],v12 offset:0
ds_read_b64_tr_b16 a[162:163],v12 offset:768
ds_read_b64_tr_b16 a[164:165],v12 offset:12288
ds_read_b64_tr_b16 a[166:167],v12 offset:13056
ds_read_b64_tr_b16 a[168:169],v12 offset:32
ds_read_b64_tr_b16 a[170:171],v12 offset:800
ds_read_b64_tr_b16 a[172:173],v12 offset:12320
ds_read_b64_tr_b16 a[174:175],v12 offset:13088
ds_read_b64_tr_b16 a[176:177],v12 offset:64
ds_read_b64_tr_b16 a[178:179],v12 offset:832
ds_read_b64_tr_b16 a[180:181],v12 offset:12352
ds_read_b64_tr_b16 a[182:183],v12 offset:13120
s_branch ld_67
lw_70:
ds_read_b64_tr_b16 a[80:81],v12 offset:0
ds_read_b64_tr_b16 a[82:83],v12 offset:768
ds_read_b64_tr_b16 a[84:85],v12 offset:12288
ds_read_b64_tr_b16 a[86:87],v12 offset:13056
ds_read_b64_tr_b16 a[88:89],v12 offset:32
ds_read_b64_tr_b16 a[90:91],v12 offset:800
ds_read_b64_tr_b16 a[92:93],v12 offset:12320
ds_read_b64_tr_b16 a[94:95],v12 offset:13088
ds_read_b64_tr_b16 a[96:97],v12 offset:64
ds_read_b64_tr_b16 a[98:99],v12 offset:832
ds_read_b64_tr_b16 a[100:101],v12 offset:12352
ds_read_b64_tr_b16 a[102:103],v12 offset:13120
s_branch ld_67
lw_71:
ds_read_b64_tr_b16 a[0:1],v12 offset:0
ds_read_b64_tr_b16 a[2:3],v12 offset:768
ds_read_b64_tr_b16 a[4:5],v12 offset:12288
ds_read_b64_tr_b16 a[6:7],v12 offset:13056
ds_read_b64_tr_b16 a[8:9],v12 offset:32
ds_read_b64_tr_b16 a[10:11],v12 offset:800
ds_read_b64_tr_b16 a[12:13],v12 offset:12320
ds_read_b64_tr_b16 a[14:15],v12 offset:13088
ds_read_b64_tr_b16 a[16:17],v12 offset:64
ds_read_b64_tr_b16 a[18:19],v12 offset:832
ds_read_b64_tr_b16 a[20:21],v12 offset:12352
ds_read_b64_tr_b16 a[22:23],v12 offset:13120
ld_67:
s_waitcnt lgkmcnt(0)
s_waitcnt vmcnt(24)
s_barrier
s_add_u32 s60,s76,s73
s_add_u32 m0,s77,0
s_add_u32 s61,s60,7077888
buffer_load_dwordx4 v104,s[4:7],s61 offen lds
s_add_u32 m0,s77,1024
s_add_u32 s61,s60,7077888
buffer_load_dwordx4 v105,s[4:7],s61 offen lds
s_add_u32 m0,s77,2048
s_add_u32 s61,s60,7077888
buffer_load_dwordx4 v106,s[4:7],s61 offen lds
s_add_u32 m0,s77,3072
s_add_u32 s61,s60,7176192
buffer_load_dwordx4 v104,s[4:7],s61 offen lds
s_add_u32 m0,s77,4096
s_add_u32 s61,s60,7176192
buffer_load_dwordx4 v105,s[4:7],s61 offen lds
s_add_u32 m0,s77,5120
s_add_u32 s61,s60,7176192
buffer_load_dwordx4 v106,s[4:7],s61 offen lds
v_add_u32 v12,24576,v107
s_cmp_eq_u32 s46,1
s_cbranch_scc1 lw_74
s_cmp_eq_u32 s46,2
s_cbranch_scc1 lw_75
s_cmp_eq_u32 s46,3
s_cbranch_scc1 lw_76
lw_73:
ds_read_b64_tr_b16 v[120:121],v12 offset:0
ds_read_b64_tr_b16 v[122:123],v12 offset:768
ds_read_b64_tr_b16 v[124:125],v12 offset:12288
ds_read_b64_tr_b16 v[126:127],v12 offset:13056
ds_read_b64_tr_b16 v[128:129],v12 offset:32
ds_read_b64_tr_b16 v[130:131],v12 offset:800
ds_read_b64_tr_b16 v[132:133],v12 offset:12320
ds_read_b64_tr_b16 v[134:135],v12 offset:13088
ds_read_b64_tr_b16 v[72:73],v12 offset:64
ds_read_b64_tr_b16 v[74:75],v12 offset:832
ds_read_b64_tr_b16 v[76:77],v12 offset:12352
ds_read_b64_tr_b16 v[78:79],v12 offset:13120
s_branch ld_72
lw_74:
ds_read_b64_tr_b16 a[184:185],v12 offset:0
ds_read_b64_tr_b16 a[186:187],v12 offset:768
ds_read_b64_tr_b16 a[188:189],v12 offset:12288
ds_read_b64_tr_b16 a[190:191],v12 offset:13056
ds_read_b64_tr_b16 a[192:193],v12 offset:32
ds_read_b64_tr_b16 a[194:195],v12 offset:800
ds_read_b64_tr_b16 a[196:197],v12 offset:12320
ds_read_b64_tr_b16 a[198:199],v12 offset:13088
ds_read_b64_tr_b16 v[56:57],v12 offset:64
ds_read_b64_tr_b16 v[58:59],v12 offset:832
ds_read_b64_tr_b16 v[60:61],v12 offset:12352
ds_read_b64_tr_b16 v[62:63],v12 offset:13120
s_branch ld_72
lw_75:
ds_read_b64_tr_b16 a[104:105],v12 offset:0
ds_read_b64_tr_b16 a[106:107],v12 offset:768
ds_read_b64_tr_b16 a[108:109],v12 offset:12288
ds_read_b64_tr_b16 a[110:111],v12 offset:13056
ds_read_b64_tr_b16 a[112:113],v12 offset:32
ds_read_b64_tr_b16 a[114:115],v12 offset:800
ds_read_b64_tr_b16 a[116:117],v12 offset:12320
ds_read_b64_tr_b16 a[118:119],v12 offset:13088
ds_read_b64_tr_b16 v[40:41],v12 offset:64
ds_read_b64_tr_b16 v[42:43],v12 offset:832
ds_read_b64_tr_b16 v[44:45],v12 offset:12352
ds_read_b64_tr_b16 v[46:47],v12 offset:13120
s_branch ld_72
lw_76:
ds_read_b64_tr_b16 a[24:25],v12 offset:0
ds_read_b64_tr_b16 a[26:27],v12 offset:768
ds_read_b64_tr_b16 a[28:29],v12 offset:12288
ds_read_b64_tr_b16 a[30:31],v12 offset:13056
ds_read_b64_tr_b16 a[32:33],v12 offset:32
ds_read_b64_tr_b16 a[34:35],v12 offset:800
ds_read_b64_tr_b16 a[36:37],v12 offset:12320
ds_read_b64_tr_b16 a[38:39],v12 offset:13088
ds_read_b64_tr_b16 v[24:25],v12 offset:64
ds_read_b64_tr_b16 v[26:27],v12 offset:832
ds_read_b64_tr_b16 v[28:29],v12 offset:12352
ds_read_b64_tr_b16 v[30:31],v12 offset:13120
ld_72:
s_waitcnt lgkmcnt(0)
s_waitcnt vmcnt(24)
s_barrier
s_add_u32 s60,s76,s74
s_add_u32 m0,s77,24576
s_add_u32 s61,s60,7077888
buffer_load_dwordx4 v104,s[52:55],s61 offen lds
s_add_u32 m0,s77,25600
s_add_u32 s61,s60,7077888
buffer_load_dwordx4 v105,s[52:55],s61 offen lds
s_add_u32 m0,s77,26624
s_add_u32 s61,s60,7077888
buffer_load_dwordx4 v106,s[52:55],s61 offen lds
s_add_u32 m0,s77,27648
s_add_u32 s61,s60,7176192
buffer_load_dwordx4 v104,s[52:55],s61 offen lds
s_add_u32 m0,s77,28672
s_add_u32 s61,s60,7176192
buffer_load_dwordx4 v105,s[52:55],s61 offen lds
s_add_u32 m0,s77,29696
s_add_u32 s61,s60,7176192
buffer_load_dwordx4 v106,s[52:55],s61 offen lds
v_add_u32 v12,49152,v107
s_cmp_eq_u32 s46,1
s_cbranch_scc1 lw_79
s_cmp_eq_u32 s46,2
s_cbranch_scc1 lw_80
s_cmp_eq_u32 s46,3
s_cbranch_scc1 lw_81
lw_78:
ds_read_b64_tr_b16 v[136:137],v12 offset:0
ds_read_b64_tr_b16 v[138:139],v12 offset:768
ds_read_b64_tr_b16 v[140:141],v12 offset:12288
ds_read_b64_tr_b16 v[142:143],v12 offset:13056
ds_read_b64_tr_b16 v[144:145],v12 offset:32
ds_read_b64_tr_b16 v[146:147],v12 offset:800
ds_read_b64_tr_b16 v[148:149],v12 offset:12320
ds_read_b64_tr_b16 v[150:151],v12 offset:13088
ds_read_b64_tr_b16 v[152:153],v12 offset:64
ds_read_b64_tr_b16 v[154:155],v12 offset:832
ds_read_b64_tr_b16 v[156:157],v12 offset:12352
ds_read_b64_tr_b16 v[158:159],v12 offset:13120
s_branch ld_77
lw_79:
ds_read_b64_tr_b16 a[200:201],v12 offset:0
ds_read_b64_tr_b16 a[202:203],v12 offset:768
ds_read_b64_tr_b16 a[204:205],v12 offset:12288
ds_read_b64_tr_b16 a[206:207],v12 offset:13056
ds_read_b64_tr_b16 a[208:209],v12 offset:32
ds_read_b64_tr_b16 a[210:211],v12 offset:800
ds_read_b64_tr_b16 a[212:213],v12 offset:12320
ds_read_b64_tr_b16 a[214:215],v12 offset:13088
ds_read_b64_tr_b16 a[216:217],v12 offset:64
ds_read_b64_tr_b16 a[218:219],v12 offset:832
ds_read_b64_tr_b16 a[220:221],v12 offset:12352
ds_read_b64_tr_b16 a[222:223],v12 offset:13120
s_branch ld_77
lw_80:
ds_read_b64_tr_b16 a[120:121],v12 offset:0
ds_read_b64_tr_b16 a[122:123],v12 offset:768
ds_read_b64_tr_b16 a[124:125],v12 offset:12288
ds_read_b64_tr_b16 a[126:127],v12 offset:13056
ds_read_b64_tr_b16 a[128:129],v12 offset:32
ds_read_b64_tr_b16 a[130:131],v12 offset:800
ds_read_b64_tr_b16 a[132:133],v12 offset:12320
ds_read_b64_tr_b16 a[134:135],v12 offset:13088
ds_read_b64_tr_b16 a[136:137],v12 offset:64
ds_read_b64_tr_b16 a[138:139],v12 offset:832
ds_read_b64_tr_b16 a[140:141],v12 offset:12352
ds_read_b64_tr_b16 a[142:143],v12 offset:13120
s_branch ld_77
lw_81:
ds_read_b64_tr_b16 a[40:41],v12 offset:0
ds_read_b64_tr_b16 a[42:43],v12 offset:768
ds_read_b64_tr_b16 a[44:45],v12 offset:12288
ds_read_b64_tr_b16 a[46:47],v12 offset:13056
ds_read_b64_tr_b16 a[48:49],v12 offset:32
ds_read_b64_tr_b16 a[50:51],v12 offset:800
ds_read_b64_tr_b16 a[52:53],v12 offset:12320
ds_read_b64_tr_b16 a[54:55],v12 offset:13088
ds_read_b64_tr_b16 a[56:57],v12 offset:64
ds_read_b64_tr_b16 a[58:59],v12 offset:832
ds_read_b64_tr_b16 a[60:61],v12 offset:12352
ds_read_b64_tr_b16 a[62:63],v12 offset:13120
ld_77:
s_waitcnt lgkmcnt(0)
s_waitcnt vmcnt(24)
s_barrier
v_add_u32 v12,73728,v107
s_cmp_eq_u32 s46,1
s_cbranch_scc1 lw_84
s_cmp_eq_u32 s46,2
s_cbranch_scc1 lw_85
s_cmp_eq_u32 s46,3
s_cbranch_scc1 lw_86
lw_83:
ds_read_b64_tr_b16 v[160:161],v12 offset:0
ds_read_b64_tr_b16 v[162:163],v12 offset:768
ds_read_b64_tr_b16 v[164:165],v12 offset:12288
ds_read_b64_tr_b16 v[166:167],v12 offset:13056
ds_read_b64_tr_b16 v[168:169],v12 offset:32
ds_read_b64_tr_b16 v[170:171],v12 offset:800
ds_read_b64_tr_b16 v[172:173],v12 offset:12320
ds_read_b64_tr_b16 v[174:175],v12 offset:13088
ds_read_b64_tr_b16 v[80:81],v12 offset:64
ds_read_b64_tr_b16 v[82:83],v12 offset:832
ds_read_b64_tr_b16 v[84:85],v12 offset:12352
ds_read_b64_tr_b16 v[86:87],v12 offset:13120
s_branch ld_82
lw_84:
ds_read_b64_tr_b16 a[224:225],v12 offset:0
ds_read_b64_tr_b16 a[226:227],v12 offset:768
ds_read_b64_tr_b16 a[228:229],v12 offset:12288
ds_read_b64_tr_b16 a[230:231],v12 offset:13056
ds_read_b64_tr_b16 a[232:233],v12 offset:32
ds_read_b64_tr_b16 a[234:235],v12 offset:800
ds_read_b64_tr_b16 a[236:237],v12 offset:12320
ds_read_b64_tr_b16 a[238:239],v12 offset:13088
ds_read_b64_tr_b16 v[64:65],v12 offset:64
ds_read_b64_tr_b16 v[66:67],v12 offset:832
ds_read_b64_tr_b16 v[68:69],v12 offset:12352
ds_read_b64_tr_b16 v[70:71],v12 offset:13120
s_branch ld_82
lw_85:
ds_read_b64_tr_b16 a[144:145],v12 offset:0
ds_read_b64_tr_b16 a[146:147],v12 offset:768
ds_read_b64_tr_b16 a[148:149],v12 offset:12288
ds_read_b64_tr_b16 a[150:151],v12 offset:13056
ds_read_b64_tr_b16 a[152:153],v12 offset:32
ds_read_b64_tr_b16 a[154:155],v12 offset:800
ds_read_b64_tr_b16 a[156:157],v12 offset:12320
ds_read_b64_tr_b16 a[158:159],v12 offset:13088
ds_read_b64_tr_b16 v[48:49],v12 offset:64
ds_read_b64_tr_b16 v[50:51],v12 offset:832
ds_read_b64_tr_b16 v[52:53],v12 offset:12352
ds_read_b64_tr_b16 v[54:55],v12 offset:13120
s_branch ld_82
lw_86:
ds_read_b64_tr_b16 a[64:65],v12 offset:0
ds_read_b64_tr_b16 a[66:67],v12 offset:768
ds_read_b64_tr_b16 a[68:69],v12 offset:12288
ds_read_b64_tr_b16 a[70:71],v12 offset:13056
ds_read_b64_tr_b16 a[72:73],v12 offset:32
ds_read_b64_tr_b16 a[74:75],v12 offset:800
ds_read_b64_tr_b16 a[76:77],v12 offset:12320
ds_read_b64_tr_b16 a[78:79],v12 offset:13088
ds_read_b64_tr_b16 v[32:33],v12 offset:64
ds_read_b64_tr_b16 v[34:35],v12 offset:832
ds_read_b64_tr_b16 v[36:37],v12 offset:12352
ds_read_b64_tr_b16 v[38:39],v12 offset:13120
ld_82:
s_waitcnt lgkmcnt(0)
s_waitcnt vmcnt(18)
s_barrier
v_add_u32 v12,98304,v107
ds_read_b64_tr_b16 v[176:177],v12 offset:0
ds_read_b64_tr_b16 v[178:179],v12 offset:768
ds_read_b64_tr_b16 v[180:181],v12 offset:12288
ds_read_b64_tr_b16 v[182:183],v12 offset:13056
ds_read_b64_tr_b16 v[184:185],v12 offset:32
ds_read_b64_tr_b16 v[186:187],v12 offset:800
ds_read_b64_tr_b16 v[188:189],v12 offset:12320
ds_read_b64_tr_b16 v[190:191],v12 offset:13088
ds_read_b64_tr_b16 v[192:193],v12 offset:64
ds_read_b64_tr_b16 v[194:195],v12 offset:832
ds_read_b64_tr_b16 v[196:197],v12 offset:12352
ds_read_b64_tr_b16 v[198:199],v12 offset:13120
s_waitcnt lgkmcnt(0)
s_waitcnt vmcnt(12)
s_barrier
v_add_u32 v12,122880,v107
ds_read_b64_tr_b16 v[200:201],v12 offset:0
ds_read_b64_tr_b16 v[202:203],v12 offset:768
ds_read_b64_tr_b16 v[204:205],v12 offset:12288
ds_read_b64_tr_b16 v[206:207],v12 offset:13056
ds_read_b64_tr_b16 v[208:209],v12 offset:32
ds_read_b64_tr_b16 v[210:211],v12 offset:800
ds_read_b64_tr_b16 v[212:213],v12 offset:12320
ds_read_b64_tr_b16 v[214:215],v12 offset:13088
ds_read_b64_tr_b16 v[88:89],v12 offset:64
ds_read_b64_tr_b16 v[90:91],v12 offset:832
ds_read_b64_tr_b16 v[92:93],v12 offset:12352
ds_read_b64_tr_b16 v[94:95],v12 offset:13120
s_waitcnt lgkmcnt(0)
s_waitcnt vmcnt(6)
s_barrier
v_add_u32 v12,0,v107
ds_read_b64_tr_b16 v[216:217],v12 offset:0
ds_read_b64_tr_b16 v[218:219],v12 offset:768
ds_read_b64_tr_b16 v[220:221],v12 offset:12288
ds_read_b64_tr_b16 v[222:223],v12 offset:13056
ds_read_b64_tr_b16 v[224:225],v12 offset:32
ds_read_b64_tr_b16 v[226:227],v12 offset:800
ds_read_b64_tr_b16 v[228:229],v12 offset:12320
ds_read_b64_tr_b16 v[230:231],v12 offset:13088
ds_read_b64_tr_b16 v[232:233],v12 offset:64
ds_read_b64_tr_b16 v[234:235],v12 offset:832
ds_read_b64_tr_b16 v[236:237],v12 offset:12352
ds_read_b64_tr_b16 v[238:239],v12 offset:13120
s_waitcnt lgkmcnt(0)
s_waitcnt vmcnt(0)
s_barrier
v_add_u32 v12,24576,v107
ds_read_b64_tr_b16 v[240:241],v12 offset:0
ds_read_b64_tr_b16 v[242:243],v12 offset:768
ds_read_b64_tr_b16 v[244:245],v12 offset:12288
ds_read_b64_tr_b16 v[246:247],v12 offset:13056
ds_read_b64_tr_b16 v[248:249],v12 offset:32
ds_read_b64_tr_b16 v[250:251],v12 offset:800
ds_read_b64_tr_b16 v[252:253],v12 offset:12320
ds_read_b64_tr_b16 v[254:255],v12 offset:13088
ds_read_b64_tr_b16 v[96:97],v12 offset:64
ds_read_b64_tr_b16 v[98:99],v12 offset:832
ds_read_b64_tr_b16 v[100:101],v12 offset:12352
ds_read_b64_tr_b16 v[102:103],v12 offset:13120
s_waitcnt lgkmcnt(0)
s_barrier
ds_write_b128 v21,v[24:27] offset:0
ds_write_b128 v21,v[28:31] offset:1024
ds_write_b128 v21,v[32:35] offset:2048
ds_write_b128 v21,v[36:39] offset:3072
ds_write_b128 v21,v[40:43] offset:4096
ds_write_b128 v21,v[44:47] offset:5120
ds_write_b128 v21,v[48:51] offset:6144
ds_write_b128 v21,v[52:55] offset:7168
ds_write_b128 v21,v[56:59] offset:8192
ds_write_b128 v21,v[60:63] offset:9216
ds_write_b128 v21,v[64:67] offset:10240
ds_write_b128 v21,v[68:71] offset:11264
ds_write_b128 v21,v[72:75] offset:12288
ds_write_b128 v21,v[76:79] offset:13312
ds_write_b128 v21,v[80:83] offset:14336
ds_write_b128 v21,v[84:87] offset:15360
ds_write_b128 v21,v[88:91] offset:16384
ds_write_b128 v21,v[92:95] offset:17408
ds_write_b128 v21,v[96:99] offset:18432
ds_write_b128 v21,v[100:103] offset:19456
s_waitcnt lgkmcnt(0)
v_add_u32 v59,139264,v1
s_barrier
s_lshl_b32 s3,s49,2
v_mov_b32 v13,s3
s_nop 1
ibw_87:
buffer_load_dword v12,v13,s[12:15],0 offen sc1
s_waitcnt vmcnt(0)
v_cmp_ne_u32 vcc,256,v12
s_nop 0
s_cbranch_vccz ok_88
s_sleep 8
s_sub_u32 s47,s47,1
s_cbranch_scc1 ABORT
s_branch ibw_87
ok_88:
s_cmp_lg_u32 s49,0
s_cbranch_scc1 ibok_89
v_and_b32 v13,7,v0
v_lshlrev_b32 v13,2,v13
buffer_load_dword v12,v13,s[12:15],0 offen offset:32 sc1
s_waitcnt vmcnt(0)
v_cmp_ne_u32 vcc,32,v12
s_nop 0
s_cbranch_vccz ibok_89
s_barrier
s_mov_b32 s49,1
s_mov_b32 s3,s2
s_load_dwordx16 s[16:31],s[0:1],0
s_load_dwordx8 s[32:39],s[0:1],64
s_waitcnt lgkmcnt(0)
s_branch DISPATCH
ibok_89:
v_mov_b32 v13,192
s_cmp_lg_u32 s49,0
s_cbranch_scc1 vx_91
vw_90:
buffer_load_dword v12,v13,s[12:15],0 offen sc1
s_waitcnt vmcnt(0)
v_and_b32 v14,0xffff,v12
v_cmp_ne_u32 vcc,32,v14
s_nop 0
s_cbranch_vccz ok_92
s_sleep 4
s_sub_u32 s47,s47,1
s_cbranch_scc1 ABORT
s_branch vw_90
ok_92:
v_readfirstlane_b32 s60,v12
s_cmp_gt_u32 s60,1114112
s_cselect_b32 s60,0x2000,0
s_add_u32 s83,s83,s60
s_nop 1
vx_91:
s_mul_i32 s6,s46,2048
v_sub_u32 v18,v23,v22
v_add_u32 v18,v18,v1
v_add_u32 v18,8192,v18
s_mov_b32 s37,0x3f80
s_mov_b32 s81,0x3f800000
s_add_u32 s6,s6,s82
s_mov_b32 s7,0
s_add_u32 s7,s7,s82
s_add_u32 s7,s7,950272
s_mov_b32 s50,0
s_mov_b32 s4,0
s_mov_b32 s5,0
s_mov_b32 s78,2147483648
s_mov_b32 s79,2147483648
s_mov_b32 s30,2147483648
s_sub_u32 s60,s4,s5
s_cmp_gt_i32 s60,13
s_cselect_b32 s51,1,0
s_cmp_eq_u32 s4,64
s_cselect_b32 s51,1,s51
s_cmp_eq_u32 s51,0
s_cselect_b32 s52,s4,s5
s_addc_u32 s4,s4,0
s_add_u32 s5,s5,s51
s_and_b32 s60,s52,1
s_lshl2_add_u32 s60,s51,s60
s_lshl_b32 s68,s60,16
s_add_u32 s68,s68,s83
s_mul_i32 s59,s60,20480
s_add_u32 s59,s59,s6
s_lshl_b32 s69,s51,9
s_add_u32 s69,s69,s7
s_bfe_u32 s57,s52,65537
s_add_u32 s58,s52,1
s_cmp_lg_u32 s36,0
s_cbranch_scc1 CV_START
s_cmp_eq_u32 s46,3
s_cbranch_scc1 CH_START
s_lshl_b32 s60,s46,2
s_add_u32 s60,s60,147456
v_mov_b32 v20,s60
v_mov_b32 v12,0
ds_write_b32 v20,v12
v_add_u32 v58,106496,v1
v_mov_b32 v9,147468
s_lshl_b32 s85,s46,12
s_add_u32 s84,s84,s85
s_add_u32 s84,s84,25165824
s_add_u32 s74,s85,94208
s_add_u32 s75,s74,s74
s_add_u32 s75,s75,24576
s_mul_i32 s60,s29,3
s_add_u32 s60,s60,s46
v_lshlrev_b32 v13,7,v0
s_add_u32 s61,s60,0
s_min_u32 s61,s61,115
s_lshl_b32 s61,s61,13
s_add_u32 s61,s61,s82
buffer_load_dword v14,v13,s[8:11],s61 offen sc1
s_add_u32 s61,s60,48
s_min_u32 s61,s61,115
s_lshl_b32 s61,s61,13
s_add_u32 s61,s61,s82
buffer_load_dword v14,v13,s[8:11],s61 offen sc1
s_add_u32 s61,s60,96
s_min_u32 s61,s61,115
s_lshl_b32 s61,s61,13
s_add_u32 s61,s61,s82
buffer_load_dword v14,v13,s[8:11],s61 offen sc1
s_waitcnt vmcnt(0)
s_mov_b64 vcc,-1
s_waitcnt lgkmcnt(0)
v_mov_b32 v10,0
v_mov_b32 v11,0
v_mov_b32 v24,0
v_mov_b32 v25,0
v_mov_b32 v26,0
v_mov_b32 v27,0
v_mov_b32 v28,0
v_mov_b32 v29,0
v_mov_b32 v30,0
v_mov_b32 v31,0
v_mov_b32 v32,0
v_mov_b32 v33,0
v_mov_b32 v34,0
v_mov_b32 v35,0
v_mov_b32 v36,0
v_mov_b32 v37,0
v_mov_b32 v38,0
v_mov_b32 v39,0
v_mov_b32 v40,0
v_mov_b32 v41,0
v_mov_b32 v42,0
v_mov_b32 v43,0
v_mov_b32 v44,0
v_mov_b32 v45,0
v_mov_b32 v46,0
v_mov_b32 v47,0
s_cmp_lg_u32 s49,0
s_cbranch_scc1 CS_LOOP_S
CS_LOOP_F:
s_barrier
buffer_load_dwordx2 v[80:81],v18,s[8:11],s59 offen sc1
buffer_load_dwordx4 v[72:75],v1,s[8:11],s59 offen sc1
buffer_load_dwordx4 v[76:79],v1,s[8:11],s59 offen offset:1024 sc1
s_cbranch_vccz fj_95f
fj_95w:
s_waitcnt vmcnt(2)
fj_95f:
buffer_load_dwordx2 v[90:91],v18,s[8:11],s68 offen sc1
buffer_load_dwordx4 v[82:85],v1,s[8:11],s68 offen sc1
buffer_load_dwordx4 v[86:89],v1,s[8:11],s68 offen offset:1024 sc1
fj_95z:
v_mfma_f32_32x32x8_bf16 v[24:39],v[10:11],v[10:11],0
v_mfma_f32_16x16x16_bf16 v[40:43],v[10:11],v[10:11],0
v_mfma_f32_16x16x16_bf16 v[44:47],v[10:11],v[10:11],0
fj_95:
fa_93:
s_waitcnt vmcnt(5)
v_lshlrev_b32 v108,16,v80
v_and_b32 v109,0xffff0000,v80
v_lshlrev_b32 v110,16,v81
v_and_b32 v111,0xffff0000,v81
s_waitcnt vmcnt(4)
v_lshlrev_b32 v92,16,v72
v_and_b32 v93,0xffff0000,v72
v_lshlrev_b32 v94,16,v73
v_and_b32 v95,0xffff0000,v73
v_lshlrev_b32 v96,16,v74
v_and_b32 v97,0xffff0000,v74
v_lshlrev_b32 v98,16,v75
v_and_b32 v99,0xffff0000,v75
s_waitcnt vmcnt(3)
v_lshlrev_b32 v100,16,v76
v_and_b32 v101,0xffff0000,v76
v_lshlrev_b32 v102,16,v77
v_and_b32 v103,0xffff0000,v77
v_lshlrev_b32 v104,16,v78
v_and_b32 v105,0xffff0000,v78
v_lshlrev_b32 v106,16,v79
v_and_b32 v107,0xffff0000,v79
v_bitop3_b32 v16,v72,v76,s57 bitop3:0x7e
v_bitop3_b32 v16,v16,v80,s57 bitop3:0xf6
ec_96:
s_waitcnt vmcnt(2)
v_dot2c_f32_bf16 v108,s37,v90
v_dot2c_f32_bf16 v109,s81,v90
v_dot2c_f32_bf16 v110,s37,v91
v_dot2c_f32_bf16 v111,s81,v91
s_waitcnt vmcnt(1)
v_bitop3_b32 v17,v82,v90,s57 bitop3:0x7e
s_waitcnt vmcnt(0)
v_bitop3_b32 v17,v17,v86,s57 bitop3:0xf6
v_bitop3_b32 v17,v16,v17,1 bitop3:0xa8
v_cmp_ne_u32 vcc,0,v17
v_cvt_pk_bf16_f32 v56,v108,v109
v_cvt_pk_bf16_f32 v57,v110,v111
ds_write_b64 v23,v[56:57]
s_cbranch_vccnz ec_96r
v_dot2c_f32_bf16 v92,s37,v82
v_dot2c_f32_bf16 v93,s81,v82
v_dot2c_f32_bf16 v94,s37,v83
v_dot2c_f32_bf16 v95,s81,v83
v_dot2c_f32_bf16 v96,s37,v84
v_dot2c_f32_bf16 v97,s81,v84
v_dot2c_f32_bf16 v98,s37,v85
v_dot2c_f32_bf16 v99,s81,v85
v_cvt_pk_bf16_f32 v48,v92,v93
v_cvt_pk_bf16_f32 v49,v94,v95
v_cvt_pk_bf16_f32 v50,v96,v97
v_cvt_pk_bf16_f32 v51,v98,v99
ds_write_b128 v22,v[48:51] offset:0
v_dot2c_f32_bf16 v100,s37,v86
v_dot2c_f32_bf16 v101,s81,v86
v_dot2c_f32_bf16 v102,s37,v87
v_dot2c_f32_bf16 v103,s81,v87
v_dot2c_f32_bf16 v104,s37,v88
v_dot2c_f32_bf16 v105,s81,v88
v_dot2c_f32_bf16 v106,s37,v89
v_dot2c_f32_bf16 v107,s81,v89
v_cvt_pk_bf16_f32 v52,v100,v101
v_cvt_pk_bf16_f32 v53,v102,v103
v_cvt_pk_bf16_f32 v54,v104,v105
v_cvt_pk_bf16_f32 v55,v106,v107
ds_write_b128 v22,v[52:55] offset:1024
fj_95g:
v_smfmac_f32_16x16x64_bf16 v[24:27],v[48:51],a[0:7],v2
ds_read_b128 v[72:75],v21 offset:0
v_xor_b32 v58,57344,v58
v_smfmac_f32_16x16x64_bf16 v[28:31],v[48:51],a[8:15],v2
ds_read_b128 v[76:79],v21 offset:1024
s_sub_u32 s60,s4,s5
v_smfmac_f32_16x16x64_bf16 v[32:35],v[48:51],a[16:23],v2
ds_read_b128 v[80:83],v21 offset:2048
s_cmp_gt_i32 s60,13
v_smfmac_f32_16x16x64_bf16 v[36:39],v[48:51],a[24:31],v2
ds_read_b128 v[84:87],v21 offset:3072
s_cselect_b32 s53,1,0
s_waitcnt lgkmcnt(4)
s_barrier
v_smfmac_f32_16x16x64_bf16 v[40:43],v[48:51],a[32:39],v2
ds_read_b128 v[60:63],v3 offset:0
s_cmp_eq_u32 s4,64
v_smfmac_f32_16x16x64_bf16 v[24:27],v[52:55],a[40:47],v2
ds_read_b128 v[64:67],v3 offset:1024
s_cselect_b32 s53,1,s53
v_smfmac_f32_16x16x64_bf16 v[28:31],v[52:55],a[48:55],v2
ds_read_b128 v[68:71],v4 offset:0
s_cmp_eq_u32 s53,0
v_smfmac_f32_16x16x64_bf16 v[32:35],v[52:55],a[56:63],v2
s_cselect_b32 s54,s4,s5
s_addc_u32 s4,s4,0
s_add_u32 s5,s5,s53
v_smfmac_f32_16x16x64_bf16 v[36:39],v[52:55],a[64:71],v2
s_mul_i32 s73,s54,393216
s_add_u32 s73,s73,s84
s_sub_u32 s74,s75,s74
v_smfmac_f32_16x16x64_bf16 v[40:43],v[52:55],a[72:79],v2
s_mov_b32 m0,s74
s_and_b32 s60,s52,1
s_waitcnt lgkmcnt(5)
v_smfmac_f32_16x16x64_bf16 v[44:47],v[48:51],v[72:79],v2
ds_read_b128 v[72:75],v21 offset:4096
s_waitcnt lgkmcnt(4)
v_smfmac_f32_16x16x64_bf16 v[44:47],v[52:55],v[80:87],v2
ds_read_b128 v[76:79],v21 offset:5120
s_waitcnt lgkmcnt(4)
v_smfmac_f32_16x16x64_bf16 v[24:27],v[60:63],a[80:87],v2
ds_read_b128 v[80:83],v21 offset:6144
s_lshl2_add_u32 s60,s51,s60
v_smfmac_f32_16x16x64_bf16 v[28:31],v[60:63],a[88:95],v2
ds_read_b128 v[84:87],v21 offset:7168
s_mul_i32 s60,s60,49152
v_smfmac_f32_16x16x64_bf16 v[32:35],v[60:63],a[96:103],v2
s_add_u32 s71,s60,s34
s_add_u32 s70,s60,s33
s_lshl_b32 s60,s51,9
v_smfmac_f32_16x16x64_bf16 v[36:39],v[60:63],a[104:111],v2
s_add_u32 s72,s60,s35
buffer_load_dwordx4 v1,s[8:11],s73 offen sc1 lds
v_smfmac_f32_16x16x64_bf16 v[40:43],v[60:63],a[112:119],v2
buffer_load_dwordx4 v1,s[8:11],s73 offen offset:1024 sc1 lds
s_waitcnt lgkmcnt(2)
v_smfmac_f32_16x16x64_bf16 v[44:47],v[60:63],v[72:79],v2
ds_read_b128 v[60:63],v4 offset:1024
v_smfmac_f32_16x16x64_bf16 v[24:27],v[64:67],a[120:127],v2
ds_read_b128 v[72:75],v21 offset:8192
v_smfmac_f32_16x16x64_bf16 v[28:31],v[64:67],a[128:135],v2
ds_read_b128 v[76:79],v21 offset:9216
v_smfmac_f32_16x16x64_bf16 v[32:35],v[64:67],a[136:143],v2
buffer_load_dwordx4 v1,s[8:11],s73 offen offset:2048 sc1 lds
v_smfmac_f32_16x16x64_bf16 v[36:39],v[64:67],a[144:151],v2
buffer_load_dwordx4 v1,s[8:11],s73 offen offset:3072 sc1 lds
v_add_u32 v17,s85,v58
v_smfmac_f32_16x16x64_bf16 v[40:43],v[64:67],a[152:159],v2
v_mov_b32 v16,s58
s_and_b32 s60,s54,1
s_waitcnt lgkmcnt(3)
v_smfmac_f32_16x16x64_bf16 v[44:47],v[64:67],v[80:87],v2
ds_read_b128 v[64:67],v5 offset:0
s_lshl2_add_u32 s60,s53,s60
v_smfmac_f32_16x16x64_bf16 v[24:27],v[68:71],a[160:167],v2
ds_read_b128 v[80:83],v21 offset:10240
s_lshl_b32 s68,s60,16
v_smfmac_f32_16x16x64_bf16 v[28:31],v[68:71],a[168:175],v2
ds_read_b128 v[84:87],v21 offset:11264
s_add_u32 s68,s68,s83
v_smfmac_f32_16x16x64_bf16 v[32:35],v[68:71],a[176:183],v2
s_mul_i32 s59,s60,20480
s_add_u32 s59,s59,s6
s_lshl_b32 s69,s53,9
v_smfmac_f32_16x16x64_bf16 v[36:39],v[68:71],a[184:191],v2
s_add_u32 s69,s69,s7
s_bfe_u32 s31,s54,65537
s_add_u32 s32,s54,1
v_smfmac_f32_16x16x64_bf16 v[40:43],v[68:71],a[192:199],v2
s_add_u32 s50,s50,1
s_mov_b32 s51,s53
s_waitcnt lgkmcnt(3)
v_smfmac_f32_16x16x64_bf16 v[44:47],v[68:71],v[72:79],v2
ds_read_b128 v[68:71],v5 offset:1024
s_mov_b32 s52,s54
v_smfmac_f32_16x16x64_bf16 v[24:27],v[60:63],a[200:207],v2
ds_read_b128 v[72:75],v21 offset:12288
s_mov_b32 s58,s32
v_smfmac_f32_16x16x64_bf16 v[28:31],v[60:63],a[208:215],v2
ds_read_b128 v[76:79],v21 offset:13312
s_mov_b64 vcc,s[88:89]
v_smfmac_f32_16x16x64_bf16 v[32:35],v[60:63],a[216:223],v2
ds_read_b128 v[48:51],v58 offset:0
s_and_b32 s76,s50,128
v_smfmac_f32_16x16x64_bf16 v[36:39],v[60:63],a[224:231],v2
v_smfmac_f32_16x16x64_bf16 v[40:43],v[60:63],a[232:239],v2
ds_read_b128 v[52:55],v58 offset:1024
s_waitcnt lgkmcnt(5)
v_smfmac_f32_16x16x64_bf16 v[44:47],v[60:63],v[80:87],v2
ds_read_b128 v[60:63],v59 offset:0
v_smfmac_f32_16x16x64_bf16 v[24:27],v[64:67],a[240:247],v2
ds_read_b128 v[80:83],v21 offset:14336
v_smfmac_f32_16x16x64_bf16 v[28:31],v[64:67],a[248:255],v2
ds_read_b128 v[84:87],v21 offset:15360
v_smfmac_f32_16x16x64_bf16 v[32:35],v[64:67],v[112:119],v2
ds_read_b128 v[88:91],v58 offset:2048
v_smfmac_f32_16x16x64_bf16 v[36:39],v[64:67],v[120:127],v2
v_smfmac_f32_16x16x64_bf16 v[40:43],v[64:67],v[128:135],v2
ds_read_b128 v[92:95],v58 offset:3072
s_waitcnt lgkmcnt(7)
v_smfmac_f32_16x16x64_bf16 v[44:47],v[64:67],v[72:79],v2
ds_read_b128 v[64:67],v59 offset:1024
v_smfmac_f32_16x16x64_bf16 v[24:27],v[68:71],v[136:143],v2
ds_read_b128 v[72:75],v21 offset:16384
v_smfmac_f32_16x16x64_bf16 v[28:31],v[68:71],v[144:151],v2
ds_read_b128 v[76:79],v21 offset:17408
v_smfmac_f32_16x16x64_bf16 v[32:35],v[68:71],v[152:159],v2
ds_read_b128 v[96:99],v58 offset:4096
v_smfmac_f32_16x16x64_bf16 v[36:39],v[68:71],v[160:167],v2
v_smfmac_f32_16x16x64_bf16 v[40:43],v[68:71],v[168:175],v2
ds_read_b128 v[100:103],v58 offset:5120
s_waitcnt lgkmcnt(7)
v_smfmac_f32_16x16x64_bf16 v[44:47],v[68:71],v[80:87],v2
ds_read_b128 v[80:83],v21 offset:18432
v_smfmac_f32_16x16x64_bf16 v[24:27],v[60:63],v[176:183],v2
ds_read_b128 v[84:87],v21 offset:19456
v_smfmac_f32_16x16x64_bf16 v[36:39],v[60:63],v[200:207],v2
ds_read_b128 v[104:107],v58 offset:6144
s_waitcnt lgkmcnt(7)
v_smfmac_f32_16x16x64_bf16 v[24:27],v[64:67],v[216:223],v2
v_smfmac_f32_16x16x64_bf16 v[36:39],v[64:67],v[240:247],v2
ds_read_b128 v[108:111],v58 offset:7168
v_smfmac_f32_16x16x64_bf16 v[28:31],v[60:63],v[184:191],v2
v_smfmac_f32_16x16x64_bf16 v[40:43],v[60:63],v[208:215],v2
v_add_f32 v24,v24,v25
v_smfmac_f32_16x16x64_bf16 v[28:31],v[64:67],v[224:231],v2
v_add_f32 v26,v26,v27
v_smfmac_f32_16x16x64_bf16 v[40:43],v[64:67],v[248:255],v2
v_add_f32 v36,v36,v37
v_smfmac_f32_16x16x64_bf16 v[32:35],v[60:63],v[192:199],v2
v_add_f32 v38,v38,v39
s_waitcnt lgkmcnt(6)
v_smfmac_f32_16x16x64_bf16 v[44:47],v[60:63],v[72:79],v2
v_cvt_pk_bf16_f32 v37,v24,v26
v_smfmac_f32_16x16x64_bf16 v[32:35],v[64:67],v[232:239],v2
v_cvt_pk_bf16_f32 v36,v36,v38
s_waitcnt lgkmcnt(2)
v_smfmac_f32_16x16x64_bf16 v[44:47],v[64:67],v[80:87],v2
ds_write_b64 v6,v[36:37] offset:0
v_add_f32 v28,v28,v29
v_add_f32 v30,v30,v31
v_add_f32 v40,v40,v41
v_add_f32 v42,v42,v43
v_cvt_pk_bf16_f32 v41,v28,v30
v_cvt_pk_bf16_f32 v40,v40,v42
ds_write_b64 v6,v[40:41] offset:512
v_add_f32 v32,v32,v33
v_add_f32 v34,v34,v35
v_add_f32 v44,v44,v45
v_add_f32 v46,v46,v47
v_cvt_pk_bf16_f32 v45,v32,v34
v_cvt_pk_bf16_f32 v44,v44,v46
ds_write_b64 v6,v[44:45] offset:1024
ds_read_b128 v[72:75],v58 offset:8192
ds_read_b128 v[76:79],v58 offset:9216
s_waitcnt lgkmcnt(2)
s_barrier
ds_read_b64_tr_b16 v[24:25],v7 offset:0
ds_read_b64_tr_b16 v[26:27],v7 offset:512
ds_read_b64_tr_b16 v[28:29],v7 offset:1024
ds_read_b64_tr_b16 v[30:31],v7 offset:1536
ds_read_b64_tr_b16 v[32:33],v7 offset:2048
ds_read_b64_tr_b16 v[34:35],v7 offset:2560
ds_read_b64_tr_b16 v[36:37],v7 offset:3072
ds_read_b64_tr_b16 v[38:39],v7 offset:3584
s_waitcnt lgkmcnt(6)
v_mfma_f32_16x16x32_bf16 v[60:63],v[48:51],v[24:27],0
ds_read_b64_tr_b16 v[40:41],v7 offset:4096
v_mfma_f32_16x16x32_bf16 v[64:67],v[52:55],v[24:27],0
ds_read_b64_tr_b16 v[42:43],v7 offset:4608
v_mfma_f32_16x16x32_bf16 v[68:71],v[24:27],v[24:27],0
ds_read_b128 v[80:83],v58 offset:10240
s_waitcnt lgkmcnt(7)
v_mfma_f32_16x16x32_bf16 v[60:63],v[88:91],v[28:31],v[60:63]
ds_read_b128 v[84:87],v58 offset:11264
v_mfma_f32_16x16x32_bf16 v[64:67],v[92:95],v[28:31],v[64:67]
ds_read_b64_tr_b16 v[44:45],v7 offset:5120
v_mfma_f32_16x16x32_bf16 v[68:71],v[28:31],v[28:31],v[68:71]
ds_read_b64_tr_b16 v[46:47],v7 offset:5632
s_waitcnt lgkmcnt(8)
v_mfma_f32_16x16x32_bf16 v[60:63],v[96:99],v[32:35],v[60:63]
ds_read_b128 v[24:27],v17 offset:12288
v_mfma_f32_16x16x32_bf16 v[64:67],v[100:103],v[32:35],v[64:67]
ds_read_b128 v[28:31],v17 offset:13312
v_mfma_f32_16x16x32_bf16 v[68:71],v[32:35],v[32:35],v[68:71]
s_waitcnt lgkmcnt(8)
v_mfma_f32_16x16x32_bf16 v[60:63],v[104:107],v[36:39],v[60:63]
ds_read_b128 v[32:35],v17 offset:14336
v_mfma_f32_16x16x32_bf16 v[64:67],v[108:111],v[36:39],v[64:67]
v_mfma_f32_16x16x32_bf16 v[68:71],v[36:39],v[36:39],v[68:71]
s_waitcnt lgkmcnt(7)
v_mfma_f32_16x16x32_bf16 v[60:63],v[72:75],v[40:43],v[60:63]
ds_read_b128 v[36:39],v17 offset:15360
v_mfma_f32_16x16x32_bf16 v[64:67],v[76:79],v[40:43],v[64:67]
v_mfma_f32_16x16x32_bf16 v[68:71],v[40:43],v[40:43],v[68:71]
s_waitcnt lgkmcnt(4)
v_mfma_f32_16x16x32_bf16 v[60:63],v[80:83],v[44:47],v[60:63]
v_mfma_f32_16x16x32_bf16 v[64:67],v[84:87],v[44:47],v[64:67]
buffer_load_dwordx4 v[48:51],v1,s[8:11],s71 offen sc1
v_mfma_f32_16x16x32_bf16 v[68:71],v[44:47],v[44:47],v[68:71]
s_nop 4
v_cndmask_b32_dpp v60,v64,v60,vcc quad_perm:[2,3,2,3] row_mask:0xf bank_mask:0xf
v_cndmask_b32_dpp v61,v65,v61,vcc quad_perm:[2,3,2,3] row_mask:0xf bank_mask:0xf
v_cndmask_b32_dpp v62,v66,v62,vcc quad_perm:[2,3,2,3] row_mask:0xf bank_mask:0xf
v_cndmask_b32_dpp v63,v67,v63,vcc quad_perm:[2,3,2,3] row_mask:0xf bank_mask:0xf
v_max3_f32 v12,v60,v61,v62
v_cndmask_b32_dpp v68,v69,v68,vcc quad_perm:[2,3,2,3] row_mask:0xf bank_mask:0xf
v_max3_f32 v12,v12,v63,v68
s_nop 1
v_max_f32_dpp v13,v12,v12 quad_perm:[2,3,0,1] row_mask:0xf bank_mask:0xf
v_max_f32_dpp v12,v12,v12 quad_perm:[2,3,0,1] row_mask:0xf bank_mask:0xf
s_nop 1
v_permlane32_swap_b32 v12,v13
v_max_f32 v15,v12,v13
v_max_f32 v12,v12,v13
s_mov_b64 exec,1
buffer_store_dword v16,v1,s[8:11],s72 offen
s_mov_b64 exec,-1
v_permlane16_swap_b32 v12,v15
v_max_f32 v12,v12,v15
v_mul_f32 v12,s87,v12
v_fma_f32 v60,v60,s87,-v12
v_fma_f32 v61,v61,s87,-v12
v_fma_f32 v62,v62,s87,-v12
v_fma_f32 v63,v63,s87,-v12
v_fma_f32 v68,v68,s87,-v12
v_exp_f32 v60,v60
v_exp_f32 v61,v61
v_exp_f32 v62,v62
v_exp_f32 v63,v63
v_exp_f32 v68,v68
v_cvt_pk_bf16_f32 v70,v60,v61
v_cvt_pk_bf16_f32 v71,v62,v63
v_cndmask_b32 v46,v70,v10,vcc
v_cndmask_b32 v47,v71,v10,vcc
v_cndmask_b32_dpp v44,v70,v10,vcc quad_perm:[2,3,0,1] row_mask:0xf bank_mask:0xf
v_cndmask_b32_dpp v45,v71,v10,vcc quad_perm:[2,3,0,1] row_mask:0xf bank_mask:0xf
s_mov_b64 vcc,s[90:91]
s_waitcnt lgkmcnt(0)
v_cndmask_b32 v40,v70,v10,vcc
v_mfma_f32_16x16x32_bf16 v[64:67],v[28:31],v[44:47],0
v_cndmask_b32 v41,v71,v10,vcc
v_cndmask_b32_dpp v42,v70,v10,vcc quad_perm:[2,3,0,1] row_mask:0xf bank_mask:0xf
v_mfma_f32_16x16x32_bf16 v[52:55],v[36:39],v[44:47],0
v_cndmask_b32_dpp v43,v71,v10,vcc quad_perm:[2,3,0,1] row_mask:0xf bank_mask:0xf
v_mov_b32_dpp v14,v68 quad_perm:[2,3,0,1] row_mask:0xf bank_mask:0xf
v_add_f32 v12,v60,v61
v_mfma_f32_16x16x32_bf16 v[64:67],v[24:27],v[40:43],v[64:67]
v_cvt_pk_bf16_f32 v56,v68,v14
v_cvt_pk_bf16_f32 v57,v14,v68
v_mov_b32 v16,s50
v_mfma_f32_16x16x32_bf16 v[52:55],v[32:35],v[40:43],v[52:55]
v_cndmask_b32 v56,v56,v10,vcc
v_cndmask_b32 v57,v10,v57,vcc
v_add_f32 v13,v62,v63
v_add_f32 v12,v12,v68
s_waitcnt vmcnt(1)
v_mfma_f32_16x16x16_bf16 v[64:67],v[48:49],v[56:57],v[64:67]
v_add_f32 v12,v12,v13
v_bitop3_b32 v17,v48,v50,s57 bitop3:0x7e
v_mfma_f32_16x16x16_bf16 v[52:55],v[50:51],v[56:57],v[52:55]
v_add_f32_dpp v13,v12,v12 quad_perm:[2,3,0,1] row_mask:0xf bank_mask:0xf
v_add_f32_dpp v12,v12,v12 quad_perm:[2,3,0,1] row_mask:0xf bank_mask:0xf
v_and_b32 v17,1,v17
v_cmp_ne_u32 vcc,0,v17
v_permlane32_swap_b32 v12,v13
v_add_f32 v15,v12,v13
v_add_f32 v12,v12,v13
s_cmp_lg_u64 vcc,0
s_cselect_b32 s60,1,0
v_permlane16_swap_b32 v12,v15
v_add_f32 v12,v12,v15
v_rcp_f32 v12,v12
s_xor_b32 s61,s57,s60
v_pk_mul_f32 v[64:65],v[64:65],v[12:13] op_sel_hi:[1,0]
v_pk_mul_f32 v[66:67],v[66:67],v[12:13] op_sel_hi:[1,0]
v_pk_mul_f32 v[52:53],v[52:53],v[12:13] op_sel_hi:[1,0]
v_pk_mul_f32 v[54:55],v[54:55],v[12:13] op_sel_hi:[1,0]
v_cvt_pk_bf16_f32 v48,v64,v65
v_cvt_pk_bf16_f32 v49,v66,v67
v_cvt_pk_bf16_f32 v50,v52,v53
v_cvt_pk_bf16_f32 v51,v54,v55
v_and_or_b32 v48,v48,-2,s61
buffer_store_dwordx4 v[48:51],v8,s[8:11],s70 offen
ds_read_b32 v0,v9
ds_write_b32 v20,v16
s_or_b32 s61,s60,s76
s_cbranch_scc1 od_97
ct_98:
s_barrier
buffer_load_dwordx2 v[80:81],v18,s[8:11],s59 offen sc1
buffer_load_dwordx4 v[72:75],v1,s[8:11],s59 offen sc1
buffer_load_dwordx4 v[76:79],v1,s[8:11],s59 offen offset:1024 sc1
s_waitcnt lgkmcnt(0)
v_cmp_ne_u32 vcc,s50,v0
s_mov_b32 s57,s31
s_cbranch_vccnz fj_95w
buffer_load_dwordx2 v[90:91],v18,s[8:11],s68 offen sc1
buffer_load_dwordx4 v[82:85],v1,s[8:11],s68 offen sc1
buffer_load_dwordx4 v[86:89],v1,s[8:11],s68 offen offset:1024 sc1
s_branch fj_95z
fr_94:
v_bitop3_b32 v12,v72,v76,s57 bitop3:0x7e
v_bitop3_b32 v13,v80,v80,s57 bitop3:0x7e
v_xor_b32 v14,s57,v80
v_or3_b32 v12,v12,v13,v14
v_and_b32 v12,1,v12
v_cmp_ne_u32 vcc,0,v12
s_cbranch_vccz sk_100
buffer_load_dwordx2 v[80:81],v18,s[8:11],s59 offen sc1
buffer_load_dwordx4 v[72:75],v1,s[8:11],s59 offen sc1
buffer_load_dwordx4 v[76:79],v1,s[8:11],s59 offen offset:1024 sc1
sk_100:
buffer_load_dwordx2 v[90:91],v18,s[8:11],s68 offen sc1
buffer_load_dwordx4 v[82:85],v1,s[8:11],s68 offen sc1
buffer_load_dwordx4 v[86:89],v1,s[8:11],s68 offen offset:1024 sc1
s_sub_u32 s47,s47,1
s_cbranch_scc1 ABORT
s_waitcnt lgkmcnt(0)
s_branch fa_93
ec_96r:
buffer_load_dwordx2 v[90:91],v18,s[8:11],s68 offen sc1
buffer_load_dwordx4 v[82:85],v1,s[8:11],s68 offen sc1
buffer_load_dwordx4 v[86:89],v1,s[8:11],s68 offen offset:1024 sc1
v_and_b32 v17,1,v16
v_cmp_ne_u32 vcc,0,v17
s_nop 0
s_cbranch_vccnz fr_94
v_lshlrev_b32 v92,16,v72
v_and_b32 v93,0xffff0000,v72
v_lshlrev_b32 v94,16,v73
v_and_b32 v95,0xffff0000,v73
v_lshlrev_b32 v96,16,v74
v_and_b32 v97,0xffff0000,v74
v_lshlrev_b32 v98,16,v75
v_and_b32 v99,0xffff0000,v75
v_lshlrev_b32 v108,16,v80
v_and_b32 v109,0xffff0000,v80
v_lshlrev_b32 v110,16,v81
v_and_b32 v111,0xffff0000,v81
s_sub_u32 s47,s47,1
s_cbranch_scc1 ABORT
s_branch ec_96
od_97:
s_cmp_eq_u32 s60,0
s_cbranch_scc1 CS_DONE
vb_101:
s_sub_u32 s47,s47,1
s_cbranch_scc1 ABORT
buffer_load_dwordx4 v[48:51],v1,s[8:11],s71 offen sc1
s_waitcnt vmcnt(0)
v_bitop3_b32 v17,v48,v50,s57 bitop3:0x7e
v_and_b32 v17,1,v17
v_cmp_ne_u32 vcc,0,v17
s_nop 0
s_cbranch_vccnz vb_101
v_mfma_f32_16x16x32_bf16 v[64:67],v[28:31],v[44:47],0
v_mfma_f32_16x16x32_bf16 v[52:55],v[36:39],v[44:47],0
v_mfma_f32_16x16x32_bf16 v[64:67],v[24:27],v[40:43],v[64:67]
v_mfma_f32_16x16x32_bf16 v[52:55],v[32:35],v[40:43],v[52:55]
v_mfma_f32_16x16x16_bf16 v[64:67],v[48:49],v[56:57],v[64:67]
v_mfma_f32_16x16x16_bf16 v[52:55],v[50:51],v[56:57],v[52:55]
s_nop 4
v_pk_mul_f32 v[64:65],v[64:65],v[12:13] op_sel_hi:[1,0]
v_pk_mul_f32 v[66:67],v[66:67],v[12:13] op_sel_hi:[1,0]
s_nop 0
v_pk_mul_f32 v[52:53],v[52:53],v[12:13] op_sel_hi:[1,0]
v_pk_mul_f32 v[54:55],v[54:55],v[12:13] op_sel_hi:[1,0]
v_cvt_pk_bf16_f32 v48,v64,v65
v_cvt_pk_bf16_f32 v49,v66,v67
v_cvt_pk_bf16_f32 v50,v52,v53
v_cvt_pk_bf16_f32 v51,v54,v55
v_and_or_b32 v48,v48,-2,s57
buffer_store_dwordx4 v[48:51],v8,s[8:11],s70 offen
s_cmp_lg_u32 s76,0
s_cbranch_scc1 CS_DONE
s_branch ct_98
CS_LOOP_S:
s_barrier
buffer_load_dwordx2 v[80:81],v18,s[8:11],s59 offen sc1
buffer_load_dwordx4 v[72:75],v1,s[8:11],s59 offen sc1
buffer_load_dwordx4 v[76:79],v1,s[8:11],s59 offen offset:1024 sc1
s_cbranch_vccz fj_104f
fj_104w:
s_waitcnt vmcnt(2)
fj_104f:
buffer_load_dwordx2 v[90:91],v18,s[8:11],s68 offen sc1
buffer_load_dwordx4 v[82:85],v1,s[8:11],s68 offen sc1
buffer_load_dwordx4 v[86:89],v1,s[8:11],s68 offen offset:1024 sc1
fj_104z:
v_mfma_f32_32x32x8_bf16 v[24:39],v[10:11],v[10:11],0
v_mfma_f32_16x16x16_bf16 v[40:43],v[10:11],v[10:11],0
v_mfma_f32_16x16x16_bf16 v[44:47],v[10:11],v[10:11],0
fj_104:
fa_102:
s_waitcnt vmcnt(5)
v_lshlrev_b32 v108,16,v80
v_and_b32 v109,0xffff0000,v80
v_lshlrev_b32 v110,16,v81
v_and_b32 v111,0xffff0000,v81
s_waitcnt vmcnt(4)
v_lshlrev_b32 v92,16,v72
v_and_b32 v93,0xffff0000,v72
v_lshlrev_b32 v94,16,v73
v_and_b32 v95,0xffff0000,v73
v_lshlrev_b32 v96,16,v74
v_and_b32 v97,0xffff0000,v74
v_lshlrev_b32 v98,16,v75
v_and_b32 v99,0xffff0000,v75
s_waitcnt vmcnt(3)
v_lshlrev_b32 v100,16,v76
v_and_b32 v101,0xffff0000,v76
v_lshlrev_b32 v102,16,v77
v_and_b32 v103,0xffff0000,v77
v_lshlrev_b32 v104,16,v78
v_and_b32 v105,0xffff0000,v78
v_lshlrev_b32 v106,16,v79
v_and_b32 v107,0xffff0000,v79
v_bitop3_b32 v16,v72,v76,s57 bitop3:0x7e
v_bitop3_b32 v16,v16,v80,s57 bitop3:0xf6
ec_105:
s_waitcnt vmcnt(2)
v_dot2c_f32_bf16 v108,s37,v90
v_dot2c_f32_bf16 v109,s81,v90
v_dot2c_f32_bf16 v110,s37,v91
v_dot2c_f32_bf16 v111,s81,v91
s_waitcnt vmcnt(1)
v_bitop3_b32 v17,v82,v90,s57 bitop3:0x7e
s_waitcnt vmcnt(0)
v_bitop3_b32 v17,v17,v86,s57 bitop3:0xf6
v_bitop3_b32 v17,v16,v17,1 bitop3:0xa8
v_cmp_ne_u32 vcc,0,v17
v_cvt_pk_bf16_f32 v56,v108,v109
v_cvt_pk_bf16_f32 v57,v110,v111
ds_write_b64 v23,v[56:57]
s_cbranch_vccnz ec_105r
v_dot2c_f32_bf16 v92,s37,v82
v_dot2c_f32_bf16 v93,s81,v82
v_dot2c_f32_bf16 v94,s37,v83
v_dot2c_f32_bf16 v95,s81,v83
v_dot2c_f32_bf16 v96,s37,v84
v_dot2c_f32_bf16 v97,s81,v84
v_dot2c_f32_bf16 v98,s37,v85
v_dot2c_f32_bf16 v99,s81,v85
v_cvt_pk_bf16_f32 v48,v92,v93
v_cvt_pk_bf16_f32 v49,v94,v95
v_cvt_pk_bf16_f32 v50,v96,v97
v_cvt_pk_bf16_f32 v51,v98,v99
ds_write_b128 v22,v[48:51] offset:0
v_dot2c_f32_bf16 v100,s37,v86
v_dot2c_f32_bf16 v101,s81,v86
v_dot2c_f32_bf16 v102,s37,v87
v_dot2c_f32_bf16 v103,s81,v87
v_dot2c_f32_bf16 v104,s37,v88
v_dot2c_f32_bf16 v105,s81,v88
v_dot2c_f32_bf16 v106,s37,v89
v_dot2c_f32_bf16 v107,s81,v89
v_cvt_pk_bf16_f32 v52,v100,v101
v_cvt_pk_bf16_f32 v53,v102,v103
v_cvt_pk_bf16_f32 v54,v104,v105
v_cvt_pk_bf16_f32 v55,v106,v107
ds_write_b128 v22,v[52:55] offset:1024
fj_104g:
v_smfmac_f32_16x16x64_bf16 v[24:27],v[48:51],a[0:7],v2
ds_read_b128 v[72:75],v21 offset:0
v_xor_b32 v58,57344,v58
v_smfmac_f32_16x16x64_bf16 v[28:31],v[48:51],a[8:15],v2
ds_read_b128 v[76:79],v21 offset:1024
s_sub_u32 s60,s4,s5
v_smfmac_f32_16x16x64_bf16 v[32:35],v[48:51],a[16:23],v2
ds_read_b128 v[80:83],v21 offset:2048
s_cmp_gt_i32 s60,13
v_smfmac_f32_16x16x64_bf16 v[36:39],v[48:51],a[24:31],v2
ds_read_b128 v[84:87],v21 offset:3072
s_cselect_b32 s53,1,0
s_waitcnt lgkmcnt(4)
s_barrier
v_smfmac_f32_16x16x64_bf16 v[40:43],v[48:51],a[32:39],v2
ds_read_b128 v[60:63],v3 offset:0
s_cmp_eq_u32 s4,64
v_smfmac_f32_16x16x64_bf16 v[24:27],v[52:55],a[40:47],v2
ds_read_b128 v[64:67],v3 offset:1024
s_cselect_b32 s53,1,s53
v_smfmac_f32_16x16x64_bf16 v[28:31],v[52:55],a[48:55],v2
ds_read_b128 v[68:71],v4 offset:0
s_cmp_eq_u32 s53,0
v_smfmac_f32_16x16x64_bf16 v[32:35],v[52:55],a[56:63],v2
s_cselect_b32 s54,s4,s5
s_addc_u32 s4,s4,0
s_add_u32 s5,s5,s53
v_smfmac_f32_16x16x64_bf16 v[36:39],v[52:55],a[64:71],v2
s_mul_i32 s73,s54,393216
s_add_u32 s73,s73,s84
s_sub_u32 s74,s75,s74
v_smfmac_f32_16x16x64_bf16 v[40:43],v[52:55],a[72:79],v2
s_mov_b32 m0,s74
s_and_b32 s60,s52,1
s_waitcnt lgkmcnt(5)
v_smfmac_f32_16x16x64_bf16 v[44:47],v[48:51],v[72:79],v2
ds_read_b128 v[72:75],v21 offset:4096
s_waitcnt lgkmcnt(4)
v_smfmac_f32_16x16x64_bf16 v[44:47],v[52:55],v[80:87],v2
ds_read_b128 v[76:79],v21 offset:5120
s_waitcnt lgkmcnt(4)
v_smfmac_f32_16x16x64_bf16 v[24:27],v[60:63],a[80:87],v2
ds_read_b128 v[80:83],v21 offset:6144
s_lshl2_add_u32 s60,s51,s60
v_smfmac_f32_16x16x64_bf16 v[28:31],v[60:63],a[88:95],v2
ds_read_b128 v[84:87],v21 offset:7168
s_mul_i32 s60,s60,49152
v_smfmac_f32_16x16x64_bf16 v[32:35],v[60:63],a[96:103],v2
s_add_u32 s71,s60,s34
s_add_u32 s70,s60,s33
s_lshl_b32 s60,s51,9
v_smfmac_f32_16x16x64_bf16 v[36:39],v[60:63],a[104:111],v2
s_add_u32 s72,s60,s35
buffer_load_dwordx4 v1,s[8:11],s73 offen sc1 lds
v_smfmac_f32_16x16x64_bf16 v[40:43],v[60:63],a[112:119],v2
buffer_load_dwordx4 v1,s[8:11],s73 offen offset:1024 sc1 lds
s_waitcnt lgkmcnt(2)
v_smfmac_f32_16x16x64_bf16 v[44:47],v[60:63],v[72:79],v2
ds_read_b128 v[60:63],v4 offset:1024
v_smfmac_f32_16x16x64_bf16 v[24:27],v[64:67],a[120:127],v2
ds_read_b128 v[72:75],v21 offset:8192
v_smfmac_f32_16x16x64_bf16 v[28:31],v[64:67],a[128:135],v2
ds_read_b128 v[76:79],v21 offset:9216
v_smfmac_f32_16x16x64_bf16 v[32:35],v[64:67],a[136:143],v2
buffer_load_dwordx4 v1,s[8:11],s73 offen offset:2048 sc1 lds
v_smfmac_f32_16x16x64_bf16 v[36:39],v[64:67],a[144:151],v2
buffer_load_dwordx4 v1,s[8:11],s73 offen offset:3072 sc1 lds
v_add_u32 v17,s85,v58
v_smfmac_f32_16x16x64_bf16 v[40:43],v[64:67],a[152:159],v2
v_mov_b32 v16,s58
s_and_b32 s60,s54,1
s_waitcnt lgkmcnt(3)
v_smfmac_f32_16x16x64_bf16 v[44:47],v[64:67],v[80:87],v2
ds_read_b128 v[64:67],v5 offset:0
s_lshl2_add_u32 s60,s53,s60
v_smfmac_f32_16x16x64_bf16 v[24:27],v[68:71],a[160:167],v2
ds_read_b128 v[80:83],v21 offset:10240
s_lshl_b32 s68,s60,16
v_smfmac_f32_16x16x64_bf16 v[28:31],v[68:71],a[168:175],v2
ds_read_b128 v[84:87],v21 offset:11264
s_add_u32 s68,s68,s83
v_smfmac_f32_16x16x64_bf16 v[32:35],v[68:71],a[176:183],v2
s_mul_i32 s59,s60,20480
s_add_u32 s59,s59,s6
s_lshl_b32 s69,s53,9
v_smfmac_f32_16x16x64_bf16 v[36:39],v[68:71],a[184:191],v2
s_add_u32 s69,s69,s7
s_bfe_u32 s31,s54,65537
s_add_u32 s32,s54,1
v_smfmac_f32_16x16x64_bf16 v[40:43],v[68:71],a[192:199],v2
s_add_u32 s50,s50,1
s_mov_b32 s51,s53
s_waitcnt lgkmcnt(3)
v_smfmac_f32_16x16x64_bf16 v[44:47],v[68:71],v[72:79],v2
ds_read_b128 v[68:71],v5 offset:1024
s_mov_b32 s52,s54
v_smfmac_f32_16x16x64_bf16 v[24:27],v[60:63],a[200:207],v2
ds_read_b128 v[72:75],v21 offset:12288
s_mov_b32 s58,s32
v_smfmac_f32_16x16x64_bf16 v[28:31],v[60:63],a[208:215],v2
ds_read_b128 v[76:79],v21 offset:13312
s_mov_b64 vcc,s[88:89]
v_smfmac_f32_16x16x64_bf16 v[32:35],v[60:63],a[216:223],v2
ds_read_b128 v[48:51],v58 offset:0
s_and_b32 s76,s50,128
v_smfmac_f32_16x16x64_bf16 v[36:39],v[60:63],a[224:231],v2
v_smfmac_f32_16x16x64_bf16 v[40:43],v[60:63],a[232:239],v2
ds_read_b128 v[52:55],v58 offset:1024
s_waitcnt lgkmcnt(5)
v_smfmac_f32_16x16x64_bf16 v[44:47],v[60:63],v[80:87],v2
ds_read_b128 v[60:63],v59 offset:0
v_smfmac_f32_16x16x64_bf16 v[24:27],v[64:67],a[240:247],v2
ds_read_b128 v[80:83],v21 offset:14336
v_smfmac_f32_16x16x64_bf16 v[28:31],v[64:67],a[248:255],v2
ds_read_b128 v[84:87],v21 offset:15360
v_smfmac_f32_16x16x64_bf16 v[32:35],v[64:67],v[112:119],v2
ds_read_b128 v[88:91],v58 offset:2048
v_smfmac_f32_16x16x64_bf16 v[36:39],v[64:67],v[120:127],v2
v_smfmac_f32_16x16x64_bf16 v[40:43],v[64:67],v[128:135],v2
ds_read_b128 v[92:95],v58 offset:3072
s_waitcnt lgkmcnt(7)
v_smfmac_f32_16x16x64_bf16 v[44:47],v[64:67],v[72:79],v2
ds_read_b128 v[64:67],v59 offset:1024
v_smfmac_f32_16x16x64_bf16 v[24:27],v[68:71],v[136:143],v2
ds_read_b128 v[72:75],v21 offset:16384
v_smfmac_f32_16x16x64_bf16 v[28:31],v[68:71],v[144:151],v2
ds_read_b128 v[76:79],v21 offset:17408
v_smfmac_f32_16x16x64_bf16 v[32:35],v[68:71],v[152:159],v2
ds_read_b128 v[96:99],v58 offset:4096
v_smfmac_f32_16x16x64_bf16 v[36:39],v[68:71],v[160:167],v2
v_smfmac_f32_16x16x64_bf16 v[40:43],v[68:71],v[168:175],v2
ds_read_b128 v[100:103],v58 offset:5120
s_waitcnt lgkmcnt(7)
v_smfmac_f32_16x16x64_bf16 v[44:47],v[68:71],v[80:87],v2
ds_read_b128 v[80:83],v21 offset:18432
v_smfmac_f32_16x16x64_bf16 v[24:27],v[60:63],v[176:183],v2
ds_read_b128 v[84:87],v21 offset:19456
v_smfmac_f32_16x16x64_bf16 v[36:39],v[60:63],v[200:207],v2
ds_read_b128 v[104:107],v58 offset:6144
s_waitcnt lgkmcnt(7)
v_smfmac_f32_16x16x64_bf16 v[24:27],v[64:67],v[216:223],v2
v_smfmac_f32_16x16x64_bf16 v[36:39],v[64:67],v[240:247],v2
ds_read_b128 v[108:111],v58 offset:7168
v_smfmac_f32_16x16x64_bf16 v[28:31],v[60:63],v[184:191],v2
v_smfmac_f32_16x16x64_bf16 v[40:43],v[60:63],v[208:215],v2
v_add_f32 v24,v24,v25
v_smfmac_f32_16x16x64_bf16 v[28:31],v[64:67],v[224:231],v2
v_add_f32 v26,v26,v27
v_smfmac_f32_16x16x64_bf16 v[40:43],v[64:67],v[248:255],v2
v_add_f32 v36,v36,v37
v_smfmac_f32_16x16x64_bf16 v[32:35],v[60:63],v[192:199],v2
v_add_f32 v38,v38,v39
s_waitcnt lgkmcnt(6)
v_smfmac_f32_16x16x64_bf16 v[44:47],v[60:63],v[72:79],v2
v_cvt_pk_bf16_f32 v37,v24,v26
v_smfmac_f32_16x16x64_bf16 v[32:35],v[64:67],v[232:239],v2
v_cvt_pk_bf16_f32 v36,v36,v38
s_waitcnt lgkmcnt(2)
v_smfmac_f32_16x16x64_bf16 v[44:47],v[64:67],v[80:87],v2
ds_write_b64 v6,v[36:37] offset:0
v_add_f32 v28,v28,v29
v_add_f32 v30,v30,v31
v_add_f32 v40,v40,v41
v_add_f32 v42,v42,v43
v_cvt_pk_bf16_f32 v41,v28,v30
v_cvt_pk_bf16_f32 v40,v40,v42
ds_write_b64 v6,v[40:41] offset:512
v_add_f32 v32,v32,v33
v_add_f32 v34,v34,v35
v_add_f32 v44,v44,v45
v_add_f32 v46,v46,v47
v_cvt_pk_bf16_f32 v45,v32,v34
v_cvt_pk_bf16_f32 v44,v44,v46
ds_write_b64 v6,v[44:45] offset:1024
ds_read_b128 v[72:75],v58 offset:8192
ds_read_b128 v[76:79],v58 offset:9216
s_waitcnt lgkmcnt(2)
s_barrier
ds_read_b64_tr_b16 v[24:25],v7 offset:0
ds_read_b64_tr_b16 v[26:27],v7 offset:512
ds_read_b64_tr_b16 v[28:29],v7 offset:1024
ds_read_b64_tr_b16 v[30:31],v7 offset:1536
ds_read_b64_tr_b16 v[32:33],v7 offset:2048
ds_read_b64_tr_b16 v[34:35],v7 offset:2560
ds_read_b64_tr_b16 v[36:37],v7 offset:3072
ds_read_b64_tr_b16 v[38:39],v7 offset:3584
s_waitcnt lgkmcnt(6)
v_mfma_f32_16x16x32_bf16 v[60:63],v[48:51],v[24:27],0
ds_read_b64_tr_b16 v[40:41],v7 offset:4096
v_mfma_f32_16x16x32_bf16 v[64:67],v[52:55],v[24:27],0
ds_read_b64_tr_b16 v[42:43],v7 offset:4608
v_mfma_f32_16x16x32_bf16 v[68:71],v[24:27],v[24:27],0
ds_read_b128 v[80:83],v58 offset:10240
s_waitcnt lgkmcnt(7)
v_mfma_f32_16x16x32_bf16 v[60:63],v[88:91],v[28:31],v[60:63]
ds_read_b128 v[84:87],v58 offset:11264
v_mfma_f32_16x16x32_bf16 v[64:67],v[92:95],v[28:31],v[64:67]
ds_read_b64_tr_b16 v[44:45],v7 offset:5120
v_mfma_f32_16x16x32_bf16 v[68:71],v[28:31],v[28:31],v[68:71]
ds_read_b64_tr_b16 v[46:47],v7 offset:5632
s_waitcnt lgkmcnt(8)
v_mfma_f32_16x16x32_bf16 v[60:63],v[96:99],v[32:35],v[60:63]
ds_read_b128 v[24:27],v17 offset:12288
v_mfma_f32_16x16x32_bf16 v[64:67],v[100:103],v[32:35],v[64:67]
ds_read_b128 v[28:31],v17 offset:13312
v_mfma_f32_16x16x32_bf16 v[68:71],v[32:35],v[32:35],v[68:71]
s_waitcnt lgkmcnt(8)
v_mfma_f32_16x16x32_bf16 v[60:63],v[104:107],v[36:39],v[60:63]
ds_read_b128 v[32:35],v17 offset:14336
v_mfma_f32_16x16x32_bf16 v[64:67],v[108:111],v[36:39],v[64:67]
v_mfma_f32_16x16x32_bf16 v[68:71],v[36:39],v[36:39],v[68:71]
s_waitcnt lgkmcnt(7)
v_mfma_f32_16x16x32_bf16 v[60:63],v[72:75],v[40:43],v[60:63]
ds_read_b128 v[36:39],v17 offset:15360
v_mfma_f32_16x16x32_bf16 v[64:67],v[76:79],v[40:43],v[64:67]
v_mfma_f32_16x16x32_bf16 v[68:71],v[40:43],v[40:43],v[68:71]
s_waitcnt lgkmcnt(4)
v_mfma_f32_16x16x32_bf16 v[60:63],v[80:83],v[44:47],v[60:63]
v_mfma_f32_16x16x32_bf16 v[64:67],v[84:87],v[44:47],v[64:67]
buffer_load_dwordx4 v[48:51],v1,s[8:11],s71 offen sc1
v_mfma_f32_16x16x32_bf16 v[68:71],v[44:47],v[44:47],v[68:71]
s_nop 4
v_cndmask_b32_dpp v60,v64,v60,vcc quad_perm:[2,3,2,3] row_mask:0xf bank_mask:0xf
v_cndmask_b32_dpp v61,v65,v61,vcc quad_perm:[2,3,2,3] row_mask:0xf bank_mask:0xf
v_cndmask_b32_dpp v62,v66,v62,vcc quad_perm:[2,3,2,3] row_mask:0xf bank_mask:0xf
v_cndmask_b32_dpp v63,v67,v63,vcc quad_perm:[2,3,2,3] row_mask:0xf bank_mask:0xf
v_max3_f32 v12,v60,v61,v62
v_cndmask_b32_dpp v68,v69,v68,vcc quad_perm:[2,3,2,3] row_mask:0xf bank_mask:0xf
v_max3_f32 v12,v12,v63,v68
s_nop 1
v_max_f32_dpp v13,v12,v12 quad_perm:[2,3,0,1] row_mask:0xf bank_mask:0xf
v_max_f32_dpp v12,v12,v12 quad_perm:[2,3,0,1] row_mask:0xf bank_mask:0xf
s_nop 1
v_permlane32_swap_b32 v12,v13
v_max_f32 v15,v12,v13
v_max_f32 v12,v12,v13
s_mov_b64 exec,1
buffer_store_dword v16,v1,s[8:11],s72 offen sc1
s_mov_b64 exec,-1
v_permlane16_swap_b32 v12,v15
v_max_f32 v12,v12,v15
v_mul_f32 v12,s87,v12
v_fma_f32 v60,v60,s87,-v12
v_fma_f32 v61,v61,s87,-v12
v_fma_f32 v62,v62,s87,-v12
v_fma_f32 v63,v63,s87,-v12
v_fma_f32 v68,v68,s87,-v12
v_exp_f32 v60,v60
v_exp_f32 v61,v61
v_exp_f32 v62,v62
v_exp_f32 v63,v63
v_exp_f32 v68,v68
v_cvt_pk_bf16_f32 v70,v60,v61
v_cvt_pk_bf16_f32 v71,v62,v63
v_cndmask_b32 v46,v70,v10,vcc
v_cndmask_b32 v47,v71,v10,vcc
v_cndmask_b32_dpp v44,v70,v10,vcc quad_perm:[2,3,0,1] row_mask:0xf bank_mask:0xf
v_cndmask_b32_dpp v45,v71,v10,vcc quad_perm:[2,3,0,1] row_mask:0xf bank_mask:0xf
s_mov_b64 vcc,s[90:91]
s_waitcnt lgkmcnt(0)
v_cndmask_b32 v40,v70,v10,vcc
v_mfma_f32_16x16x32_bf16 v[64:67],v[28:31],v[44:47],0
v_cndmask_b32 v41,v71,v10,vcc
v_cndmask_b32_dpp v42,v70,v10,vcc quad_perm:[2,3,0,1] row_mask:0xf bank_mask:0xf
v_mfma_f32_16x16x32_bf16 v[52:55],v[36:39],v[44:47],0
v_cndmask_b32_dpp v43,v71,v10,vcc quad_perm:[2,3,0,1] row_mask:0xf bank_mask:0xf
v_mov_b32_dpp v14,v68 quad_perm:[2,3,0,1] row_mask:0xf bank_mask:0xf
v_add_f32 v12,v60,v61
v_mfma_f32_16x16x32_bf16 v[64:67],v[24:27],v[40:43],v[64:67]
v_cvt_pk_bf16_f32 v56,v68,v14
v_cvt_pk_bf16_f32 v57,v14,v68
v_mov_b32 v16,s50
v_mfma_f32_16x16x32_bf16 v[52:55],v[32:35],v[40:43],v[52:55]
v_cndmask_b32 v56,v56,v10,vcc
v_cndmask_b32 v57,v10,v57,vcc
v_add_f32 v13,v62,v63
v_add_f32 v12,v12,v68
s_waitcnt vmcnt(1)
v_mfma_f32_16x16x16_bf16 v[64:67],v[48:49],v[56:57],v[64:67]
v_add_f32 v12,v12,v13
v_bitop3_b32 v17,v48,v50,s57 bitop3:0x7e
v_mfma_f32_16x16x16_bf16 v[52:55],v[50:51],v[56:57],v[52:55]
v_add_f32_dpp v13,v12,v12 quad_perm:[2,3,0,1] row_mask:0xf bank_mask:0xf
v_add_f32_dpp v12,v12,v12 quad_perm:[2,3,0,1] row_mask:0xf bank_mask:0xf
v_and_b32 v17,1,v17
v_cmp_ne_u32 vcc,0,v17
v_permlane32_swap_b32 v12,v13
v_add_f32 v15,v12,v13
v_add_f32 v12,v12,v13
s_cmp_lg_u64 vcc,0
s_cselect_b32 s60,1,0
v_permlane16_swap_b32 v12,v15
v_add_f32 v12,v12,v15
v_rcp_f32 v12,v12
s_xor_b32 s61,s57,s60
v_pk_mul_f32 v[64:65],v[64:65],v[12:13] op_sel_hi:[1,0]
v_pk_mul_f32 v[66:67],v[66:67],v[12:13] op_sel_hi:[1,0]
v_pk_mul_f32 v[52:53],v[52:53],v[12:13] op_sel_hi:[1,0]
v_pk_mul_f32 v[54:55],v[54:55],v[12:13] op_sel_hi:[1,0]
v_cvt_pk_bf16_f32 v48,v64,v65
v_cvt_pk_bf16_f32 v49,v66,v67
v_cvt_pk_bf16_f32 v50,v52,v53
v_cvt_pk_bf16_f32 v51,v54,v55
v_and_or_b32 v48,v48,-2,s61
buffer_store_dwordx4 v[48:51],v8,s[8:11],s70 offen sc1
ds_read_b32 v0,v9
ds_write_b32 v20,v16
s_or_b32 s61,s60,s76
s_cbranch_scc1 od_106
ct_107:
s_barrier
buffer_load_dwordx2 v[80:81],v18,s[8:11],s59 offen sc1
buffer_load_dwordx4 v[72:75],v1,s[8:11],s59 offen sc1
buffer_load_dwordx4 v[76:79],v1,s[8:11],s59 offen offset:1024 sc1
s_waitcnt lgkmcnt(0)
v_cmp_ne_u32 vcc,s50,v0
s_mov_b32 s57,s31
s_cbranch_vccnz fj_104w
buffer_load_dwordx2 v[90:91],v18,s[8:11],s68 offen sc1
buffer_load_dwordx4 v[82:85],v1,s[8:11],s68 offen sc1
buffer_load_dwordx4 v[86:89],v1,s[8:11],s68 offen offset:1024 sc1
s_branch fj_104z
fr_103:
v_bitop3_b32 v12,v72,v76,s57 bitop3:0x7e
v_bitop3_b32 v13,v80,v80,s57 bitop3:0x7e
v_xor_b32 v14,s57,v80
v_or3_b32 v12,v12,v13,v14
v_and_b32 v12,1,v12
v_cmp_ne_u32 vcc,0,v12
s_cbranch_vccz sk_109
buffer_load_dwordx2 v[80:81],v18,s[8:11],s59 offen sc1
buffer_load_dwordx4 v[72:75],v1,s[8:11],s59 offen sc1
buffer_load_dwordx4 v[76:79],v1,s[8:11],s59 offen offset:1024 sc1
sk_109:
buffer_load_dwordx2 v[90:91],v18,s[8:11],s68 offen sc1
buffer_load_dwordx4 v[82:85],v1,s[8:11],s68 offen sc1
buffer_load_dwordx4 v[86:89],v1,s[8:11],s68 offen offset:1024 sc1
s_sub_u32 s47,s47,1
s_cbranch_scc1 ABORT
s_waitcnt lgkmcnt(0)
s_branch fa_102
ec_105r:
buffer_load_dwordx2 v[90:91],v18,s[8:11],s68 offen sc1
buffer_load_dwordx4 v[82:85],v1,s[8:11],s68 offen sc1
buffer_load_dwordx4 v[86:89],v1,s[8:11],s68 offen offset:1024 sc1
v_and_b32 v17,1,v16
v_cmp_ne_u32 vcc,0,v17
s_nop 0
s_cbranch_vccnz fr_103
v_lshlrev_b32 v92,16,v72
v_and_b32 v93,0xffff0000,v72
v_lshlrev_b32 v94,16,v73
v_and_b32 v95,0xffff0000,v73
v_lshlrev_b32 v96,16,v74
v_and_b32 v97,0xffff0000,v74
v_lshlrev_b32 v98,16,v75
v_and_b32 v99,0xffff0000,v75
v_lshlrev_b32 v108,16,v80
v_and_b32 v109,0xffff0000,v80
v_lshlrev_b32 v110,16,v81
v_and_b32 v111,0xffff0000,v81
s_sub_u32 s47,s47,1
s_cbranch_scc1 ABORT
s_branch ec_105
od_106:
s_cmp_eq_u32 s60,0
s_cbranch_scc1 CS_DONE
vb_110:
s_sub_u32 s47,s47,1
s_cbranch_scc1 ABORT
buffer_load_dwordx4 v[48:51],v1,s[8:11],s71 offen sc1
s_waitcnt vmcnt(0)
v_bitop3_b32 v17,v48,v50,s57 bitop3:0x7e
v_and_b32 v17,1,v17
v_cmp_ne_u32 vcc,0,v17
s_nop 0
s_cbranch_vccnz vb_110
v_mfma_f32_16x16x32_bf16 v[64:67],v[28:31],v[44:47],0
v_mfma_f32_16x16x32_bf16 v[52:55],v[36:39],v[44:47],0
v_mfma_f32_16x16x32_bf16 v[64:67],v[24:27],v[40:43],v[64:67]
v_mfma_f32_16x16x32_bf16 v[52:55],v[32:35],v[40:43],v[52:55]
v_mfma_f32_16x16x16_bf16 v[64:67],v[48:49],v[56:57],v[64:67]
v_mfma_f32_16x16x16_bf16 v[52:55],v[50:51],v[56:57],v[52:55]
s_nop 4
v_pk_mul_f32 v[64:65],v[64:65],v[12:13] op_sel_hi:[1,0]
v_pk_mul_f32 v[66:67],v[66:67],v[12:13] op_sel_hi:[1,0]
s_nop 0
v_pk_mul_f32 v[52:53],v[52:53],v[12:13] op_sel_hi:[1,0]
v_pk_mul_f32 v[54:55],v[54:55],v[12:13] op_sel_hi:[1,0]
v_cvt_pk_bf16_f32 v48,v64,v65
v_cvt_pk_bf16_f32 v49,v66,v67
v_cvt_pk_bf16_f32 v50,v52,v53
v_cvt_pk_bf16_f32 v51,v54,v55
v_and_or_b32 v48,v48,-2,s57
buffer_store_dwordx4 v[48:51],v8,s[8:11],s70 offen sc1
s_cmp_lg_u32 s76,0
s_cbranch_scc1 CS_DONE
s_branch ct_107
CH_START:
s_sub_u32 s60,s4,s5
s_cmp_gt_i32 s60,13
s_cselect_b32 s53,1,0
s_cmp_eq_u32 s4,64
s_cselect_b32 s53,1,s53
s_cmp_eq_u32 s53,0
s_cselect_b32 s54,s4,s5
s_addc_u32 s4,s4,0
s_add_u32 s5,s5,s53
s_sub_u32 s60,s4,s5
s_cmp_gt_i32 s60,13
s_cselect_b32 s55,1,0
s_cmp_eq_u32 s4,64
s_cselect_b32 s55,1,s55
s_cmp_eq_u32 s55,0
s_cselect_b32 s56,s4,s5
s_addc_u32 s4,s4,0
s_add_u32 s5,s5,s55
s_mov_b32 s74,81920
s_mul_i32 s73,s52,393216
s_add_u32 s73,s73,s84
s_lshl_b32 s75,s51,6
s_add_u32 s75,s75,s52
s_lshl_b32 s75,s75,9
s_add_u32 s75,s75,131072
fl_111:
buffer_load_dword v12,v9,s[8:11],s75 offen sc1
s_waitcnt vmcnt(0)
v_cmp_eq_u32 vcc,0,v12
s_nop 0
s_cbranch_vccz ok_112
s_sleep 1
s_sub_u32 s47,s47,1
s_cbranch_scc1 ABORT
s_branch fl_111
ok_112:
s_add_u32 m0,s74,0
s_add_u32 s67,s73,0
buffer_load_dwordx4 v1,s[8:11],s67 offen sc1 lds
buffer_load_dwordx4 v1,s[8:11],s67 offen offset:1024 sc1 lds
buffer_load_dwordx4 v1,s[8:11],s67 offen offset:2048 sc1 lds
buffer_load_dwordx4 v1,s[8:11],s67 offen offset:3072 sc1 lds
s_add_u32 m0,s74,4096
s_add_u32 s67,s73,4096
buffer_load_dwordx4 v1,s[8:11],s67 offen sc1 lds
buffer_load_dwordx4 v1,s[8:11],s67 offen offset:1024 sc1 lds
buffer_load_dwordx4 v1,s[8:11],s67 offen offset:2048 sc1 lds
buffer_load_dwordx4 v1,s[8:11],s67 offen offset:3072 sc1 lds
s_add_u32 m0,s74,8192
s_add_u32 s67,s73,8192
buffer_load_dwordx4 v1,s[8:11],s67 offen sc1 lds
buffer_load_dwordx4 v1,s[8:11],s67 offen offset:1024 sc1 lds
buffer_load_dwordx4 v1,s[8:11],s67 offen offset:2048 sc1 lds
buffer_load_dwordx4 v1,s[8:11],s67 offen offset:3072 sc1 lds
s_add_u32 m0,s74,12288
s_add_u32 s67,s73,25165824
buffer_load_dwordx4 v1,s[8:11],s67 offen sc1 lds
buffer_load_dwordx4 v1,s[8:11],s67 offen offset:1024 sc1 lds
buffer_load_dwordx4 v1,s[8:11],s67 offen offset:2048 sc1 lds
buffer_load_dwordx4 v1,s[8:11],s67 offen offset:3072 sc1 lds
s_add_u32 m0,s74,16384
s_add_u32 s67,s73,25169920
buffer_load_dwordx4 v1,s[8:11],s67 offen sc1 lds
buffer_load_dwordx4 v1,s[8:11],s67 offen offset:1024 sc1 lds
buffer_load_dwordx4 v1,s[8:11],s67 offen offset:2048 sc1 lds
buffer_load_dwordx4 v1,s[8:11],s67 offen offset:3072 sc1 lds
s_add_u32 m0,s74,20480
s_add_u32 s67,s73,25174016
buffer_load_dwordx4 v1,s[8:11],s67 offen sc1 lds
buffer_load_dwordx4 v1,s[8:11],s67 offen offset:1024 sc1 lds
buffer_load_dwordx4 v1,s[8:11],s67 offen offset:2048 sc1 lds
buffer_load_dwordx4 v1,s[8:11],s67 offen offset:3072 sc1 lds
s_mov_b32 s74,106496
s_mul_i32 s73,s54,393216
s_add_u32 s73,s73,s84
s_lshl_b32 s75,s53,6
s_add_u32 s75,s75,s54
s_lshl_b32 s75,s75,9
s_add_u32 s75,s75,131072
s_lshl_b32 s76,s55,6
s_add_u32 s76,s76,s56
s_lshl_b32 s76,s76,9
s_add_u32 s76,s76,131072
s_mov_b32 s77,1
v_min_u32 v8,2,v0
v_lshlrev_b32 v8,2,v8
v_add_u32 v8,147456,v8
v_mov_b32 v58,147468
s_mov_b32 s80,0
s_mov_b32 s70,2147483648
s_mov_b32 s71,0
s_mov_b32 s72,2147483648
v_mov_b32 v24,0
v_mov_b32 v25,0
v_mov_b32 v26,0
v_mov_b32 v27,0
v_mov_b32 v28,0
v_mov_b32 v29,0
v_mov_b32 v30,0
v_mov_b32 v31,0
v_mov_b32 v32,0
v_mov_b32 v33,0
v_mov_b32 v34,0
v_mov_b32 v35,0
v_mov_b32 v36,0
v_mov_b32 v37,0
v_mov_b32 v38,0
v_mov_b32 v39,0
v_mov_b32 v40,0
v_mov_b32 v41,0
v_mov_b32 v42,0
v_mov_b32 v43,0
v_mov_b32 v44,0
v_mov_b32 v45,0
v_mov_b32 v46,0
v_mov_b32 v47,0
s_nop 1
CH_LOOP:
v_mov_b32 v14,s50
s_nop 1
db_116:
buffer_load_dword v12,v11,s[8:11],s69 offen sc1
s_waitcnt vmcnt(0)
v_cmp_gt_u32 vcc,s58,v12
s_cbranch_vccz dbok_117
s_sub_u32 s47,s47,1
s_cbranch_scc1 ABORT
s_branch db_116
dbok_117:
ds_write_b32 v58,v14
buffer_load_dwordx2 v[68:69],v18,s[8:11],s59 offen sc1
buffer_load_dwordx4 v[60:63],v1,s[8:11],s59 offen sc1
buffer_load_dwordx4 v[64:67],v1,s[8:11],s59 offen offset:1024 sc1
s_barrier
fj_115w:
s_waitcnt vmcnt(2)
fj_115f:
buffer_load_dwordx2 v[78:79],v18,s[8:11],s68 offen sc1
buffer_load_dwordx4 v[70:73],v1,s[8:11],s68 offen sc1
buffer_load_dwordx4 v[74:77],v1,s[8:11],s68 offen offset:1024 sc1
fj_115z:
s_mov_b64 vcc,s[90:91]
ds_read_b64_tr_b16 v[100:101],v7 offset:0
ds_read_b64_tr_b16 v[102:103],v7 offset:512
ds_read_b64_tr_b16 v[48:49],v7 offset:1024
ds_read_b64_tr_b16 v[50:51],v7 offset:1536
ds_read_b64_tr_b16 v[104:105],v7 offset:2048
ds_read_b64_tr_b16 v[106:107],v7 offset:2560
ds_read_b64_tr_b16 v[52:53],v7 offset:3072
ds_read_b64_tr_b16 v[54:55],v7 offset:3584
ds_read_b64_tr_b16 v[108:109],v7 offset:4096
ds_read_b64_tr_b16 v[110:111],v7 offset:4608
ds_read_b64_tr_b16 v[12:13],v7 offset:5120
ds_read_b64_tr_b16 v[14:15],v7 offset:5632
s_waitcnt lgkmcnt(8)
v_cndmask_b32_dpp v100,v48,v100,vcc quad_perm:[0,1,0,1] row_mask:0xf bank_mask:0xf
v_cndmask_b32_dpp v101,v49,v101,vcc quad_perm:[0,1,0,1] row_mask:0xf bank_mask:0xf
v_cndmask_b32_dpp v102,v50,v102,vcc quad_perm:[0,1,0,1] row_mask:0xf bank_mask:0xf
v_cndmask_b32_dpp v103,v51,v103,vcc quad_perm:[0,1,0,1] row_mask:0xf bank_mask:0xf
v_and_or_b32 v100,v100,-2,s28
s_waitcnt lgkmcnt(4)
v_cndmask_b32_dpp v104,v52,v104,vcc quad_perm:[0,1,0,1] row_mask:0xf bank_mask:0xf
v_cndmask_b32_dpp v105,v53,v105,vcc quad_perm:[0,1,0,1] row_mask:0xf bank_mask:0xf
v_cndmask_b32_dpp v106,v54,v106,vcc quad_perm:[0,1,0,1] row_mask:0xf bank_mask:0xf
v_cndmask_b32_dpp v107,v55,v107,vcc quad_perm:[0,1,0,1] row_mask:0xf bank_mask:0xf
v_and_or_b32 v104,v104,-2,s28
s_waitcnt lgkmcnt(0)
v_cndmask_b32_dpp v108,v12,v108,vcc quad_perm:[0,1,0,1] row_mask:0xf bank_mask:0xf
v_cndmask_b32_dpp v109,v13,v109,vcc quad_perm:[0,1,0,1] row_mask:0xf bank_mask:0xf
v_cndmask_b32_dpp v110,v14,v110,vcc quad_perm:[0,1,0,1] row_mask:0xf bank_mask:0xf
v_cndmask_b32_dpp v111,v15,v111,vcc quad_perm:[0,1,0,1] row_mask:0xf bank_mask:0xf
v_and_or_b32 v108,v108,-2,s28
fj_115:
fa_113:
s_waitcnt vmcnt(5)
v_lshlrev_b32 v96,16,v68
v_and_b32 v97,0xffff0000,v68
v_lshlrev_b32 v98,16,v69
v_and_b32 v99,0xffff0000,v69
s_waitcnt vmcnt(4)
v_lshlrev_b32 v80,16,v60
v_and_b32 v81,0xffff0000,v60
v_lshlrev_b32 v82,16,v61
v_and_b32 v83,0xffff0000,v61
v_lshlrev_b32 v84,16,v62
v_and_b32 v85,0xffff0000,v62
v_lshlrev_b32 v86,16,v63
v_and_b32 v87,0xffff0000,v63
s_waitcnt vmcnt(3)
v_lshlrev_b32 v88,16,v64
v_and_b32 v89,0xffff0000,v64
v_lshlrev_b32 v90,16,v65
v_and_b32 v91,0xffff0000,v65
v_lshlrev_b32 v92,16,v66
v_and_b32 v93,0xffff0000,v66
v_lshlrev_b32 v94,16,v67
v_and_b32 v95,0xffff0000,v67
v_bitop3_b32 v16,v60,v64,s57 bitop3:0x7e
v_bitop3_b32 v16,v16,v68,s57 bitop3:0xf6
ec_118:
s_waitcnt vmcnt(2)
v_dot2c_f32_bf16 v96,s37,v78
v_dot2c_f32_bf16 v97,s81,v78
v_dot2c_f32_bf16 v98,s37,v79
v_dot2c_f32_bf16 v99,s81,v79
s_waitcnt vmcnt(1)
v_bitop3_b32 v17,v70,v78,s57 bitop3:0x7e
s_waitcnt vmcnt(0)
v_bitop3_b32 v17,v17,v74,s57 bitop3:0xf6
v_bitop3_b32 v17,v16,v17,1 bitop3:0xa8
v_cmp_ne_u32 vcc,0,v17
v_cvt_pk_bf16_f32 v56,v96,v97
v_cvt_pk_bf16_f32 v57,v98,v99
ds_write_b64 v23,v[56:57]
s_cbranch_vccnz ec_118r
v_dot2c_f32_bf16 v80,s37,v70
v_dot2c_f32_bf16 v81,s81,v70
v_dot2c_f32_bf16 v82,s37,v71
v_dot2c_f32_bf16 v83,s81,v71
v_dot2c_f32_bf16 v84,s37,v72
v_dot2c_f32_bf16 v85,s81,v72
v_dot2c_f32_bf16 v86,s37,v73
v_dot2c_f32_bf16 v87,s81,v73
v_cvt_pk_bf16_f32 v48,v80,v81
v_cvt_pk_bf16_f32 v49,v82,v83
v_cvt_pk_bf16_f32 v50,v84,v85
v_cvt_pk_bf16_f32 v51,v86,v87
ds_write_b128 v22,v[48:51] offset:0
v_dot2c_f32_bf16 v88,s37,v74
v_dot2c_f32_bf16 v89,s81,v74
v_dot2c_f32_bf16 v90,s37,v75
v_dot2c_f32_bf16 v91,s81,v75
v_dot2c_f32_bf16 v92,s37,v76
v_dot2c_f32_bf16 v93,s81,v76
v_dot2c_f32_bf16 v94,s37,v77
v_dot2c_f32_bf16 v95,s81,v77
v_cvt_pk_bf16_f32 v52,v88,v89
v_cvt_pk_bf16_f32 v53,v90,v91
v_cvt_pk_bf16_f32 v54,v92,v93
v_cvt_pk_bf16_f32 v55,v94,v95
ds_write_b128 v22,v[52:55] offset:1024
fj_115g:
s_cmp_lt_u32 s70,2147483648
s_cbranch_scc1 CH_XV
CH_XVB:
v_smfmac_f32_16x16x64_bf16 v[24:27],v[48:51],a[0:7],v2
ds_read_b128 v[72:75],v21 offset:0
s_and_b32 s60,s54,1
v_smfmac_f32_16x16x64_bf16 v[28:31],v[48:51],a[8:15],v2
ds_read_b128 v[76:79],v21 offset:1024
s_lshl2_add_u32 s60,s53,s60
v_smfmac_f32_16x16x64_bf16 v[32:35],v[48:51],a[16:23],v2
ds_read_b128 v[80:83],v21 offset:2048
s_lshl_b32 s68,s60,16
v_smfmac_f32_16x16x64_bf16 v[36:39],v[48:51],a[24:31],v2
ds_read_b128 v[84:87],v21 offset:3072
s_add_u32 s68,s68,s83
s_waitcnt lgkmcnt(4)
s_barrier
v_smfmac_f32_16x16x64_bf16 v[40:43],v[48:51],a[32:39],v2
ds_read_b128 v[60:63],v3 offset:0
s_mul_i32 s59,s60,20480
v_smfmac_f32_16x16x64_bf16 v[24:27],v[52:55],a[40:47],v2
ds_read_b128 v[64:67],v3 offset:1024
s_add_u32 s59,s59,s6
v_smfmac_f32_16x16x64_bf16 v[28:31],v[52:55],a[48:55],v2
ds_read_b128 v[68:71],v4 offset:0
s_lshl_b32 s69,s53,9
v_smfmac_f32_16x16x64_bf16 v[32:35],v[52:55],a[56:63],v2
s_add_u32 m0,s74,0
s_add_u32 s67,s73,0
s_add_u32 s69,s69,s7
v_smfmac_f32_16x16x64_bf16 v[36:39],v[52:55],a[64:71],v2
buffer_load_dwordx4 v1,s[8:11],s67 offen sc1 lds
s_bfe_u32 s31,s54,65537
v_smfmac_f32_16x16x64_bf16 v[40:43],v[52:55],a[72:79],v2
buffer_load_dwordx4 v1,s[8:11],s67 offen offset:1024 sc1 lds
s_waitcnt lgkmcnt(5)
v_smfmac_f32_16x16x64_bf16 v[44:47],v[48:51],v[72:79],v2
ds_read_b128 v[72:75],v21 offset:4096
s_waitcnt lgkmcnt(4)
v_smfmac_f32_16x16x64_bf16 v[44:47],v[52:55],v[80:87],v2
ds_read_b128 v[76:79],v21 offset:5120
s_waitcnt lgkmcnt(4)
v_smfmac_f32_16x16x64_bf16 v[24:27],v[60:63],a[80:87],v2
ds_read_b128 v[80:83],v21 offset:6144
s_add_u32 s32,s54,1
v_smfmac_f32_16x16x64_bf16 v[28:31],v[60:63],a[88:95],v2
ds_read_b128 v[84:87],v21 offset:7168
v_smfmac_f32_16x16x64_bf16 v[32:35],v[60:63],a[96:103],v2
buffer_load_dwordx4 v1,s[8:11],s67 offen offset:2048 sc1 lds
v_smfmac_f32_16x16x64_bf16 v[36:39],v[60:63],a[104:111],v2
buffer_load_dwordx4 v1,s[8:11],s67 offen offset:3072 sc1 lds
v_smfmac_f32_16x16x64_bf16 v[40:43],v[60:63],a[112:119],v2
s_add_u32 m0,s74,4096
s_add_u32 s67,s73,4096
s_waitcnt lgkmcnt(2)
v_smfmac_f32_16x16x64_bf16 v[44:47],v[60:63],v[72:79],v2
ds_read_b128 v[60:63],v4 offset:1024
v_smfmac_f32_16x16x64_bf16 v[24:27],v[64:67],a[120:127],v2
ds_read_b128 v[72:75],v21 offset:8192
v_smfmac_f32_16x16x64_bf16 v[28:31],v[64:67],a[128:135],v2
ds_read_b128 v[76:79],v21 offset:9216
v_smfmac_f32_16x16x64_bf16 v[32:35],v[64:67],a[136:143],v2
buffer_store_dwordx4 v[100:103],v1,s[8:11],s78 offen sc1
v_smfmac_f32_16x16x64_bf16 v[36:39],v[64:67],a[144:151],v2
buffer_store_dwordx4 v[104:107],v1,s[8:11],s78 offen offset:1024 sc1
v_smfmac_f32_16x16x64_bf16 v[40:43],v[64:67],a[152:159],v2
buffer_store_dwordx4 v[108:111],v1,s[8:11],s78 offen offset:2048 sc1
s_waitcnt lgkmcnt(3)
v_smfmac_f32_16x16x64_bf16 v[44:47],v[64:67],v[80:87],v2
ds_read_b128 v[64:67],v5 offset:0
s_mov_b32 s78,2147483648
v_smfmac_f32_16x16x64_bf16 v[24:27],v[68:71],a[160:167],v2
ds_read_b128 v[80:83],v21 offset:10240
v_smfmac_f32_16x16x64_bf16 v[28:31],v[68:71],a[168:175],v2
ds_read_b128 v[84:87],v21 offset:11264
v_smfmac_f32_16x16x64_bf16 v[32:35],v[68:71],a[176:183],v2
buffer_load_dword v10,v9,s[8:11],s76 offen sc1
v_smfmac_f32_16x16x64_bf16 v[36:39],v[68:71],a[184:191],v2
buffer_load_dwordx4 v1,s[8:11],s67 offen sc1 lds
v_smfmac_f32_16x16x64_bf16 v[40:43],v[68:71],a[192:199],v2
buffer_load_dwordx4 v1,s[8:11],s67 offen offset:1024 sc1 lds
s_waitcnt lgkmcnt(3)
v_smfmac_f32_16x16x64_bf16 v[44:47],v[68:71],v[72:79],v2
ds_read_b128 v[68:71],v5 offset:1024
v_smfmac_f32_16x16x64_bf16 v[24:27],v[60:63],a[200:207],v2
ds_read_b128 v[72:75],v21 offset:12288
v_smfmac_f32_16x16x64_bf16 v[28:31],v[60:63],a[208:215],v2
ds_read_b128 v[76:79],v21 offset:13312
v_smfmac_f32_16x16x64_bf16 v[32:35],v[60:63],a[216:223],v2
buffer_load_dwordx4 v1,s[8:11],s67 offen offset:2048 sc1 lds
v_smfmac_f32_16x16x64_bf16 v[36:39],v[60:63],a[224:231],v2
buffer_load_dwordx4 v1,s[8:11],s67 offen offset:3072 sc1 lds
v_smfmac_f32_16x16x64_bf16 v[40:43],v[60:63],a[232:239],v2
s_add_u32 m0,s74,8192
s_add_u32 s67,s73,8192
s_waitcnt lgkmcnt(3)
v_smfmac_f32_16x16x64_bf16 v[44:47],v[60:63],v[80:87],v2
ds_read_b128 v[60:63],v59 offset:0
v_smfmac_f32_16x16x64_bf16 v[24:27],v[64:67],a[240:247],v2
ds_read_b128 v[80:83],v21 offset:14336
v_smfmac_f32_16x16x64_bf16 v[28:31],v[64:67],a[248:255],v2
ds_read_b128 v[84:87],v21 offset:15360
v_smfmac_f32_16x16x64_bf16 v[32:35],v[64:67],v[112:119],v2
buffer_load_dwordx4 v1,s[8:11],s67 offen sc1 lds
v_smfmac_f32_16x16x64_bf16 v[36:39],v[64:67],v[120:127],v2
buffer_load_dwordx4 v1,s[8:11],s67 offen offset:1024 sc1 lds
v_smfmac_f32_16x16x64_bf16 v[40:43],v[64:67],v[128:135],v2
buffer_load_dwordx4 v1,s[8:11],s67 offen offset:2048 sc1 lds
s_waitcnt lgkmcnt(3)
v_smfmac_f32_16x16x64_bf16 v[44:47],v[64:67],v[72:79],v2
ds_read_b128 v[64:67],v59 offset:1024
v_smfmac_f32_16x16x64_bf16 v[24:27],v[68:71],v[136:143],v2
ds_read_b128 v[72:75],v21 offset:16384
v_smfmac_f32_16x16x64_bf16 v[28:31],v[68:71],v[144:151],v2
ds_read_b128 v[76:79],v21 offset:17408
v_smfmac_f32_16x16x64_bf16 v[32:35],v[68:71],v[152:159],v2
buffer_load_dwordx4 v1,s[8:11],s67 offen offset:3072 sc1 lds
v_smfmac_f32_16x16x64_bf16 v[36:39],v[68:71],v[160:167],v2
buffer_load_dword v0,v9,s[8:11],s72 offen sc1
v_smfmac_f32_16x16x64_bf16 v[40:43],v[68:71],v[168:175],v2
s_waitcnt lgkmcnt(3)
v_smfmac_f32_16x16x64_bf16 v[44:47],v[68:71],v[80:87],v2
ds_read_b128 v[80:83],v21 offset:18432
v_smfmac_f32_16x16x64_bf16 v[24:27],v[60:63],v[176:183],v2
ds_read_b128 v[84:87],v21 offset:19456
v_smfmac_f32_16x16x64_bf16 v[36:39],v[60:63],v[200:207],v2
s_waitcnt lgkmcnt(4)
v_smfmac_f32_16x16x64_bf16 v[24:27],v[64:67],v[216:223],v2
v_smfmac_f32_16x16x64_bf16 v[36:39],v[64:67],v[240:247],v2
v_smfmac_f32_16x16x64_bf16 v[28:31],v[60:63],v[184:191],v2
v_smfmac_f32_16x16x64_bf16 v[40:43],v[60:63],v[208:215],v2
v_add_f32 v24,v24,v25
v_smfmac_f32_16x16x64_bf16 v[28:31],v[64:67],v[224:231],v2
v_add_f32 v26,v26,v27
v_smfmac_f32_16x16x64_bf16 v[40:43],v[64:67],v[248:255],v2
v_add_f32 v36,v36,v37
v_smfmac_f32_16x16x64_bf16 v[32:35],v[60:63],v[192:199],v2
v_add_f32 v38,v38,v39
s_waitcnt lgkmcnt(2)
v_smfmac_f32_16x16x64_bf16 v[44:47],v[60:63],v[72:79],v2
v_cvt_pk_bf16_f32 v37,v24,v26
v_smfmac_f32_16x16x64_bf16 v[32:35],v[64:67],v[232:239],v2
v_cvt_pk_bf16_f32 v36,v36,v38
s_waitcnt lgkmcnt(0)
v_smfmac_f32_16x16x64_bf16 v[44:47],v[64:67],v[80:87],v2
ds_write_b64 v6,v[36:37] offset:0
v_add_f32 v28,v28,v29
v_add_f32 v30,v30,v31
v_add_f32 v40,v40,v41
v_add_f32 v42,v42,v43
v_cvt_pk_bf16_f32 v41,v28,v30
v_cvt_pk_bf16_f32 v40,v40,v42
ds_write_b64 v6,v[40:41] offset:512
v_add_f32 v32,v32,v33
v_add_f32 v34,v34,v35
v_add_f32 v44,v44,v45
v_add_f32 v46,v46,v47
v_cvt_pk_bf16_f32 v45,v32,v34
v_cvt_pk_bf16_f32 v44,v44,v46
ds_write_b64 v6,v[44:45] offset:1024
s_waitcnt vmcnt(17)
s_waitcnt lgkmcnt(0)
s_barrier
buffer_load_dword v16,v11,s[8:11],s69 offen sc1
s_and_b32 s60,s52,15
s_lshl4_add_u32 s60,s51,s60
s_mul_i32 s78,s60,196608
s_add_u32 s78,s78,s85
s_bfe_u32 s28,s52,0x10004
s_cmp_ge_u32 s54,63
s_cselect_b32 s77,0,s77
s_cmp_eq_u32 s53,s51
s_cselect_b32 s60,1,s77
s_cmp_eq_u32 s60,0
s_cbranch_scc0 h1_119
h2_120:
s_add_u32 s50,s50,1
s_mov_b32 s51,s53
s_mov_b32 s52,s54
s_mov_b32 s57,s31
s_mov_b32 s58,s32
s_mov_b32 s53,s55
s_mov_b32 s54,s56
s_mov_b32 s75,s76
s_sub_u32 s60,s4,s5
s_cmp_gt_i32 s60,13
s_cselect_b32 s55,1,0
s_cmp_eq_u32 s4,64
s_cselect_b32 s55,1,s55
s_cmp_eq_u32 s55,0
s_cselect_b32 s56,s4,s5
s_addc_u32 s4,s4,0
s_add_u32 s5,s5,s55
s_lshl_b32 s76,s55,6
s_add_u32 s76,s76,s56
s_lshl_b32 s76,s76,9
s_add_u32 s76,s76,131072
s_mul_i32 s73,s54,393216
s_add_u32 s73,s73,s84
s_xor_b32 s74,s74,57344
v_mov_b32 v24,0
v_mov_b32 v25,0
v_mov_b32 v26,0
v_mov_b32 v27,0
v_mov_b32 v28,0
v_mov_b32 v29,0
v_mov_b32 v30,0
v_mov_b32 v31,0
v_mov_b32 v32,0
v_mov_b32 v33,0
v_mov_b32 v34,0
v_mov_b32 v35,0
v_mov_b32 v36,0
v_mov_b32 v37,0
v_mov_b32 v38,0
v_mov_b32 v39,0
v_mov_b32 v40,0
v_mov_b32 v41,0
v_mov_b32 v42,0
v_mov_b32 v43,0
v_mov_b32 v44,0
v_mov_b32 v45,0
v_mov_b32 v46,0
v_mov_b32 v47,0
s_waitcnt vmcnt(0)
v_cmp_eq_u32 vcc,0,v10
s_cmp_lg_u64 vcc,0
s_cselect_b32 s77,1,0
s_cselect_b32 s72,s75,2147483648
v_cmp_gt_u32 vcc,s58,v16
s_nop 0
s_cbranch_vccz CH_RUNG
s_cmp_lt_u32 s50,128
s_cbranch_scc1 CH_LOOP
s_branch CS_DONE
h1_119:
s_cmp_eq_u32 s53,s51
s_cbranch_scc1 c1_121
s_waitcnt vmcnt(0)
v_cmp_eq_u32 vcc,0,v0
s_nop 0
s_cbranch_vccz c2_122
fl_123:
buffer_load_dword v12,v9,s[8:11],s75 offen sc1
s_waitcnt vmcnt(0)
v_cmp_eq_u32 vcc,0,v12
s_nop 0
s_cbranch_vccz ok_124
s_sleep 1
s_sub_u32 s47,s47,1
s_cbranch_scc1 ABORT
s_branch fl_123
ok_124:
c2_122:
s_add_u32 m0,s74,0
s_add_u32 s67,s73,0
buffer_load_dwordx4 v1,s[8:11],s67 offen sc1 lds
buffer_load_dwordx4 v1,s[8:11],s67 offen offset:1024 sc1 lds
buffer_load_dwordx4 v1,s[8:11],s67 offen offset:2048 sc1 lds
buffer_load_dwordx4 v1,s[8:11],s67 offen offset:3072 sc1 lds
s_add_u32 m0,s74,4096
s_add_u32 s67,s73,4096
buffer_load_dwordx4 v1,s[8:11],s67 offen sc1 lds
buffer_load_dwordx4 v1,s[8:11],s67 offen offset:1024 sc1 lds
buffer_load_dwordx4 v1,s[8:11],s67 offen offset:2048 sc1 lds
buffer_load_dwordx4 v1,s[8:11],s67 offen offset:3072 sc1 lds
s_add_u32 m0,s74,8192
s_add_u32 s67,s73,8192
buffer_load_dwordx4 v1,s[8:11],s67 offen sc1 lds
buffer_load_dwordx4 v1,s[8:11],s67 offen offset:1024 sc1 lds
buffer_load_dwordx4 v1,s[8:11],s67 offen offset:2048 sc1 lds
buffer_load_dwordx4 v1,s[8:11],s67 offen offset:3072 sc1 lds
buffer_load_dword v16,v11,s[8:11],s69 offen sc1
s_mov_b32 s70,s73
s_mov_b32 s71,s74
s_branch h2_120
c1_121:
s_mov_b64 vcc,s[90:91]
ds_read_b64_tr_b16 v[100:101],v7 offset:0
ds_read_b64_tr_b16 v[102:103],v7 offset:512
ds_read_b64_tr_b16 v[48:49],v7 offset:1024
ds_read_b64_tr_b16 v[50:51],v7 offset:1536
ds_read_b64_tr_b16 v[104:105],v7 offset:2048
ds_read_b64_tr_b16 v[106:107],v7 offset:2560
ds_read_b64_tr_b16 v[52:53],v7 offset:3072
ds_read_b64_tr_b16 v[54:55],v7 offset:3584
ds_read_b64_tr_b16 v[108:109],v7 offset:4096
ds_read_b64_tr_b16 v[110:111],v7 offset:4608
ds_read_b64_tr_b16 v[12:13],v7 offset:5120
ds_read_b64_tr_b16 v[14:15],v7 offset:5632
s_waitcnt lgkmcnt(8)
v_cndmask_b32_dpp v100,v48,v100,vcc quad_perm:[0,1,0,1] row_mask:0xf bank_mask:0xf
v_cndmask_b32_dpp v101,v49,v101,vcc quad_perm:[0,1,0,1] row_mask:0xf bank_mask:0xf
v_cndmask_b32_dpp v102,v50,v102,vcc quad_perm:[0,1,0,1] row_mask:0xf bank_mask:0xf
v_cndmask_b32_dpp v103,v51,v103,vcc quad_perm:[0,1,0,1] row_mask:0xf bank_mask:0xf
v_and_or_b32 v100,v100,-2,s28
s_waitcnt lgkmcnt(4)
v_cndmask_b32_dpp v104,v52,v104,vcc quad_perm:[0,1,0,1] row_mask:0xf bank_mask:0xf
v_cndmask_b32_dpp v105,v53,v105,vcc quad_perm:[0,1,0,1] row_mask:0xf bank_mask:0xf
v_cndmask_b32_dpp v106,v54,v106,vcc quad_perm:[0,1,0,1] row_mask:0xf bank_mask:0xf
v_cndmask_b32_dpp v107,v55,v107,vcc quad_perm:[0,1,0,1] row_mask:0xf bank_mask:0xf
v_and_or_b32 v104,v104,-2,s28
s_waitcnt lgkmcnt(0)
v_cndmask_b32_dpp v108,v12,v108,vcc quad_perm:[0,1,0,1] row_mask:0xf bank_mask:0xf
v_cndmask_b32_dpp v109,v13,v109,vcc quad_perm:[0,1,0,1] row_mask:0xf bank_mask:0xf
v_cndmask_b32_dpp v110,v14,v110,vcc quad_perm:[0,1,0,1] row_mask:0xf bank_mask:0xf
v_cndmask_b32_dpp v111,v15,v111,vcc quad_perm:[0,1,0,1] row_mask:0xf bank_mask:0xf
v_and_or_b32 v108,v108,-2,s28
s_cmp_eq_u32 s50,127
s_cbranch_scc1 sp_125x
sp_125:
ds_read_b32 v12,v8
s_waitcnt lgkmcnt(0)
v_cmp_ge_u32 vcc,s50,v12
s_nop 0
s_cbranch_vccz ok_126
s_sleep 1
s_sub_u32 s47,s47,1
s_cbranch_scc1 ABORT
s_branch sp_125
ok_126:
sp_125x:
s_waitcnt vmcnt(0)
s_cmp_ge_u32 s79,2147483648
s_cbranch_scc1 pf_127
v_mov_b32 v17,1
s_mov_b64 exec,1
buffer_store_dword v17,v1,s[8:11],s79 offen sc1
s_mov_b64 exec,-1
s_mov_b32 s79,2147483648
pf_127:
s_cmp_eq_u32 s78,2147483648
s_cbranch_scc1 pk_128
buffer_store_dwordx4 v[100:103],v1,s[8:11],s78 offen sc1
buffer_store_dwordx4 v[104:107],v1,s[8:11],s78 offen offset:1024 sc1
buffer_store_dwordx4 v[108:111],v1,s[8:11],s78 offen offset:2048 sc1
s_mov_b32 s79,s30
s_mov_b32 s78,2147483648
pk_128:
s_waitcnt vmcnt(0)
s_cmp_ge_u32 s79,2147483648
s_cbranch_scc1 pf_129
v_mov_b32 v17,1
s_mov_b64 exec,1
buffer_store_dword v17,v1,s[8:11],s79 offen sc1
s_mov_b64 exec,-1
s_mov_b32 s79,2147483648
pf_129:
s_cmp_eq_u32 s77,0
s_cbranch_scc1 h2_120
fl_130:
buffer_load_dword v12,v9,s[8:11],s75 offen sc1
s_waitcnt vmcnt(0)
v_cmp_eq_u32 vcc,0,v12
s_nop 0
s_cbranch_vccz ok_131
s_sleep 1
s_sub_u32 s47,s47,1
s_cbranch_scc1 ABORT
s_branch fl_130
ok_131:
s_add_u32 m0,s74,0
s_add_u32 s67,s73,0
buffer_load_dwordx4 v1,s[8:11],s67 offen sc1 lds
buffer_load_dwordx4 v1,s[8:11],s67 offen offset:1024 sc1 lds
buffer_load_dwordx4 v1,s[8:11],s67 offen offset:2048 sc1 lds
buffer_load_dwordx4 v1,s[8:11],s67 offen offset:3072 sc1 lds
s_add_u32 m0,s74,4096
s_add_u32 s67,s73,4096
buffer_load_dwordx4 v1,s[8:11],s67 offen sc1 lds
buffer_load_dwordx4 v1,s[8:11],s67 offen offset:1024 sc1 lds
buffer_load_dwordx4 v1,s[8:11],s67 offen offset:2048 sc1 lds
buffer_load_dwordx4 v1,s[8:11],s67 offen offset:3072 sc1 lds
s_add_u32 m0,s74,8192
s_add_u32 s67,s73,8192
buffer_load_dwordx4 v1,s[8:11],s67 offen sc1 lds
buffer_load_dwordx4 v1,s[8:11],s67 offen offset:1024 sc1 lds
buffer_load_dwordx4 v1,s[8:11],s67 offen offset:2048 sc1 lds
buffer_load_dwordx4 v1,s[8:11],s67 offen offset:3072 sc1 lds
s_add_u32 m0,s74,12288
s_add_u32 s67,s73,25165824
buffer_load_dwordx4 v1,s[8:11],s67 offen sc1 lds
buffer_load_dwordx4 v1,s[8:11],s67 offen offset:1024 sc1 lds
buffer_load_dwordx4 v1,s[8:11],s67 offen offset:2048 sc1 lds
buffer_load_dwordx4 v1,s[8:11],s67 offen offset:3072 sc1 lds
s_add_u32 m0,s74,16384
s_add_u32 s67,s73,25169920
buffer_load_dwordx4 v1,s[8:11],s67 offen sc1 lds
buffer_load_dwordx4 v1,s[8:11],s67 offen offset:1024 sc1 lds
buffer_load_dwordx4 v1,s[8:11],s67 offen offset:2048 sc1 lds
buffer_load_dwordx4 v1,s[8:11],s67 offen offset:3072 sc1 lds
s_add_u32 m0,s74,20480
s_add_u32 s67,s73,25174016
buffer_load_dwordx4 v1,s[8:11],s67 offen sc1 lds
buffer_load_dwordx4 v1,s[8:11],s67 offen offset:1024 sc1 lds
buffer_load_dwordx4 v1,s[8:11],s67 offen offset:2048 sc1 lds
buffer_load_dwordx4 v1,s[8:11],s67 offen offset:3072 sc1 lds
s_branch h2_120
fr_114:
v_bitop3_b32 v12,v60,v64,s57 bitop3:0x7e
v_bitop3_b32 v13,v68,v68,s57 bitop3:0x7e
v_xor_b32 v14,s57,v68
v_or3_b32 v12,v12,v13,v14
v_and_b32 v12,1,v12
v_cmp_ne_u32 vcc,0,v12
s_cbranch_vccz sk_132
buffer_load_dwordx2 v[68:69],v18,s[8:11],s59 offen sc1
buffer_load_dwordx4 v[60:63],v1,s[8:11],s59 offen sc1
buffer_load_dwordx4 v[64:67],v1,s[8:11],s59 offen offset:1024 sc1
sk_132:
buffer_load_dwordx2 v[78:79],v18,s[8:11],s68 offen sc1
buffer_load_dwordx4 v[70:73],v1,s[8:11],s68 offen sc1
buffer_load_dwordx4 v[74:77],v1,s[8:11],s68 offen offset:1024 sc1
s_sub_u32 s47,s47,1
s_cbranch_scc1 ABORT
s_waitcnt lgkmcnt(0)
s_branch fa_113
CH_RUNG:
v_mov_b32 v14,s50
ds_write_b32 v58,v14
buffer_load_dwordx2 v[68:69],v18,s[8:11],s59 offen sc1
buffer_load_dwordx4 v[60:63],v1,s[8:11],s59 offen sc1
buffer_load_dwordx4 v[64:67],v1,s[8:11],s59 offen offset:1024 sc1
fj_115e:
buffer_load_dwordx2 v[78:79],v18,s[8:11],s68 offen sc1
buffer_load_dwordx4 v[70:73],v1,s[8:11],s68 offen sc1
buffer_load_dwordx4 v[74:77],v1,s[8:11],s68 offen offset:1024 sc1
s_mov_b64 vcc,s[90:91]
ds_read_b64_tr_b16 v[100:101],v7 offset:0
ds_read_b64_tr_b16 v[102:103],v7 offset:512
ds_read_b64_tr_b16 v[48:49],v7 offset:1024
ds_read_b64_tr_b16 v[50:51],v7 offset:1536
ds_read_b64_tr_b16 v[104:105],v7 offset:2048
ds_read_b64_tr_b16 v[106:107],v7 offset:2560
ds_read_b64_tr_b16 v[52:53],v7 offset:3072
ds_read_b64_tr_b16 v[54:55],v7 offset:3584
ds_read_b64_tr_b16 v[108:109],v7 offset:4096
ds_read_b64_tr_b16 v[110:111],v7 offset:4608
ds_read_b64_tr_b16 v[12:13],v7 offset:5120
ds_read_b64_tr_b16 v[14:15],v7 offset:5632
s_waitcnt lgkmcnt(8)
v_cndmask_b32_dpp v100,v48,v100,vcc quad_perm:[0,1,0,1] row_mask:0xf bank_mask:0xf
v_cndmask_b32_dpp v101,v49,v101,vcc quad_perm:[0,1,0,1] row_mask:0xf bank_mask:0xf
v_cndmask_b32_dpp v102,v50,v102,vcc quad_perm:[0,1,0,1] row_mask:0xf bank_mask:0xf
v_cndmask_b32_dpp v103,v51,v103,vcc quad_perm:[0,1,0,1] row_mask:0xf bank_mask:0xf
v_and_or_b32 v100,v100,-2,s28
s_waitcnt lgkmcnt(4)
v_cndmask_b32_dpp v104,v52,v104,vcc quad_perm:[0,1,0,1] row_mask:0xf bank_mask:0xf
v_cndmask_b32_dpp v105,v53,v105,vcc quad_perm:[0,1,0,1] row_mask:0xf bank_mask:0xf
v_cndmask_b32_dpp v106,v54,v106,vcc quad_perm:[0,1,0,1] row_mask:0xf bank_mask:0xf
v_cndmask_b32_dpp v107,v55,v107,vcc quad_perm:[0,1,0,1] row_mask:0xf bank_mask:0xf
v_and_or_b32 v104,v104,-2,s28
s_waitcnt lgkmcnt(0)
v_cndmask_b32_dpp v108,v12,v108,vcc quad_perm:[0,1,0,1] row_mask:0xf bank_mask:0xf
v_cndmask_b32_dpp v109,v13,v109,vcc quad_perm:[0,1,0,1] row_mask:0xf bank_mask:0xf
v_cndmask_b32_dpp v110,v14,v110,vcc quad_perm:[0,1,0,1] row_mask:0xf bank_mask:0xf
v_cndmask_b32_dpp v111,v15,v111,vcc quad_perm:[0,1,0,1] row_mask:0xf bank_mask:0xf
v_and_or_b32 v108,v108,-2,s28
s_barrier
s_branch fj_115
ec_118r:
buffer_load_dwordx2 v[78:79],v18,s[8:11],s68 offen sc1
buffer_load_dwordx4 v[70:73],v1,s[8:11],s68 offen sc1
buffer_load_dwordx4 v[74:77],v1,s[8:11],s68 offen offset:1024 sc1
v_and_b32 v17,1,v16
v_cmp_ne_u32 vcc,0,v17
s_nop 0
s_cbranch_vccnz fr_114
v_lshlrev_b32 v80,16,v60
v_and_b32 v81,0xffff0000,v60
v_lshlrev_b32 v82,16,v61
v_and_b32 v83,0xffff0000,v61
v_lshlrev_b32 v84,16,v62
v_and_b32 v85,0xffff0000,v62
v_lshlrev_b32 v86,16,v63
v_and_b32 v87,0xffff0000,v63
v_lshlrev_b32 v96,16,v68
v_and_b32 v97,0xffff0000,v68
v_lshlrev_b32 v98,16,v69
v_and_b32 v99,0xffff0000,v69
s_sub_u32 s47,s47,1
s_cbranch_scc1 ABORT
s_branch ec_118
CH_XV:
s_add_u32 m0,s71,12288
s_add_u32 s67,s70,25165824
buffer_load_dwordx4 v1,s[8:11],s67 offen sc1 lds
buffer_load_dwordx4 v1,s[8:11],s67 offen offset:1024 sc1 lds
buffer_load_dwordx4 v1,s[8:11],s67 offen offset:2048 sc1 lds
buffer_load_dwordx4 v1,s[8:11],s67 offen offset:3072 sc1 lds
s_add_u32 m0,s71,16384
s_add_u32 s67,s70,25169920
buffer_load_dwordx4 v1,s[8:11],s67 offen sc1 lds
buffer_load_dwordx4 v1,s[8:11],s67 offen offset:1024 sc1 lds
buffer_load_dwordx4 v1,s[8:11],s67 offen offset:2048 sc1 lds
buffer_load_dwordx4 v1,s[8:11],s67 offen offset:3072 sc1 lds
s_add_u32 m0,s71,20480
s_add_u32 s67,s70,25174016
buffer_load_dwordx4 v1,s[8:11],s67 offen sc1 lds
buffer_load_dwordx4 v1,s[8:11],s67 offen offset:1024 sc1 lds
buffer_load_dwordx4 v1,s[8:11],s67 offen offset:2048 sc1 lds
buffer_load_dwordx4 v1,s[8:11],s67 offen offset:3072 sc1 lds
s_mov_b32 s70,2147483648
s_branch CH_XVB
CS_DONE:
v_lshrrev_b32 v0,4,v1
s_add_u32 s61,s48,0
s_endpgm
CV_START:
s_and_b32 s60,s46,1
s_lshl1_add_u32 s60,s49,s60
s_cmp_eq_u32 s60,1
s_cbranch_scc1 CV_LOOP_F1
s_cmp_eq_u32 s60,2
s_cbranch_scc1 CV_LOOP_S0
s_cmp_eq_u32 s60,3
s_cbranch_scc1 CV_LOOP_S1
CV_LOOP_F0:
v_mov_b32 v24,0
v_mov_b32 v25,0
v_mov_b32 v26,0
v_mov_b32 v27,0
v_mov_b32 v28,0
v_mov_b32 v29,0
v_mov_b32 v30,0
v_mov_b32 v31,0
v_mov_b32 v32,0
v_mov_b32 v33,0
v_mov_b32 v34,0
v_mov_b32 v35,0
v_mov_b32 v36,0
v_mov_b32 v37,0
v_mov_b32 v38,0
v_mov_b32 v39,0
v_mov_b32 v40,0
v_mov_b32 v41,0
v_mov_b32 v42,0
v_mov_b32 v43,0
v_mov_b32 v44,0
v_mov_b32 v45,0
v_mov_b32 v46,0
v_mov_b32 v47,0
s_cmp_lg_u32 s46,0
s_cbranch_scc1 np_136
db_137:
buffer_load_dword v12,v11,s[8:11],s69 offen sc1
s_waitcnt vmcnt(0)
v_cmp_gt_u32 vcc,s58,v12
s_cbranch_vccz dbok_138
s_sub_u32 s47,s47,1
s_cbranch_scc1 ABORT
s_branch db_137
dbok_138:
np_136:
s_barrier
buffer_load_dwordx2 v[68:69],v18,s[8:11],s59 offen sc1
buffer_load_dwordx4 v[60:63],v1,s[8:11],s59 offen sc1
buffer_load_dwordx4 v[64:67],v1,s[8:11],s59 offen offset:1024 sc1
fj_135w:
s_waitcnt vmcnt(2)
fj_135f:
buffer_load_dwordx2 v[78:79],v18,s[8:11],s68 offen sc1
buffer_load_dwordx4 v[70:73],v1,s[8:11],s68 offen sc1
buffer_load_dwordx4 v[74:77],v1,s[8:11],s68 offen offset:1024 sc1
fj_135z:
fj_135:
fa_133:
s_waitcnt vmcnt(5)
v_lshlrev_b32 v96,16,v68
v_and_b32 v97,0xffff0000,v68
v_lshlrev_b32 v98,16,v69
v_and_b32 v99,0xffff0000,v69
s_waitcnt vmcnt(4)
v_lshlrev_b32 v80,16,v60
v_and_b32 v81,0xffff0000,v60
v_lshlrev_b32 v82,16,v61
v_and_b32 v83,0xffff0000,v61
v_lshlrev_b32 v84,16,v62
v_and_b32 v85,0xffff0000,v62
v_lshlrev_b32 v86,16,v63
v_and_b32 v87,0xffff0000,v63
s_waitcnt vmcnt(3)
v_lshlrev_b32 v88,16,v64
v_and_b32 v89,0xffff0000,v64
v_lshlrev_b32 v90,16,v65
v_and_b32 v91,0xffff0000,v65
v_lshlrev_b32 v92,16,v66
v_and_b32 v93,0xffff0000,v66
v_lshlrev_b32 v94,16,v67
v_and_b32 v95,0xffff0000,v67
v_bitop3_b32 v16,v60,v64,s57 bitop3:0x7e
v_bitop3_b32 v16,v16,v68,s57 bitop3:0xf6
ec_139:
s_waitcnt vmcnt(2)
v_dot2c_f32_bf16 v96,s37,v78
v_dot2c_f32_bf16 v97,s81,v78
v_dot2c_f32_bf16 v98,s37,v79
v_dot2c_f32_bf16 v99,s81,v79
s_waitcnt vmcnt(1)
v_bitop3_b32 v17,v70,v78,s57 bitop3:0x7e
s_waitcnt vmcnt(0)
v_bitop3_b32 v17,v17,v74,s57 bitop3:0xf6
v_bitop3_b32 v17,v16,v17,1 bitop3:0xa8
v_cmp_ne_u32 vcc,0,v17
v_cvt_pk_bf16_f32 v56,v96,v97
v_cvt_pk_bf16_f32 v57,v98,v99
ds_write_b64 v23,v[56:57]
s_cbranch_vccnz ec_139r
v_dot2c_f32_bf16 v80,s37,v70
v_dot2c_f32_bf16 v81,s81,v70
v_dot2c_f32_bf16 v82,s37,v71
v_dot2c_f32_bf16 v83,s81,v71
v_dot2c_f32_bf16 v84,s37,v72
v_dot2c_f32_bf16 v85,s81,v72
v_dot2c_f32_bf16 v86,s37,v73
v_dot2c_f32_bf16 v87,s81,v73
v_cvt_pk_bf16_f32 v48,v80,v81
v_cvt_pk_bf16_f32 v49,v82,v83
v_cvt_pk_bf16_f32 v50,v84,v85
v_cvt_pk_bf16_f32 v51,v86,v87
ds_write_b128 v22,v[48:51] offset:0
v_dot2c_f32_bf16 v88,s37,v74
v_dot2c_f32_bf16 v89,s81,v74
v_dot2c_f32_bf16 v90,s37,v75
v_dot2c_f32_bf16 v91,s81,v75
v_dot2c_f32_bf16 v92,s37,v76
v_dot2c_f32_bf16 v93,s81,v76
v_dot2c_f32_bf16 v94,s37,v77
v_dot2c_f32_bf16 v95,s81,v77
v_cvt_pk_bf16_f32 v52,v88,v89
v_cvt_pk_bf16_f32 v53,v90,v91
v_cvt_pk_bf16_f32 v54,v92,v93
v_cvt_pk_bf16_f32 v55,v94,v95
ds_write_b128 v22,v[52:55] offset:1024
fj_135g:
v_smfmac_f32_16x16x64_bf16 v[24:27],v[48:51],a[0:7],v2
ds_read_b128 v[72:75],v21 offset:0
s_and_b32 s60,s52,1
v_smfmac_f32_16x16x64_bf16 v[28:31],v[48:51],a[8:15],v2
ds_read_b128 v[76:79],v21 offset:1024
s_lshl2_add_u32 s60,s51,s60
v_smfmac_f32_16x16x64_bf16 v[32:35],v[48:51],a[16:23],v2
ds_read_b128 v[80:83],v21 offset:2048
s_mul_i32 s60,s60,49152
v_smfmac_f32_16x16x64_bf16 v[36:39],v[48:51],a[24:31],v2
ds_read_b128 v[84:87],v21 offset:3072
s_add_u32 s71,s60,s34
s_waitcnt lgkmcnt(4)
s_barrier
v_smfmac_f32_16x16x64_bf16 v[40:43],v[48:51],a[32:39],v2
ds_read_b128 v[60:63],v3 offset:0
v_smfmac_f32_16x16x64_bf16 v[24:27],v[52:55],a[40:47],v2
ds_read_b128 v[64:67],v3 offset:1024
v_smfmac_f32_16x16x64_bf16 v[28:31],v[52:55],a[48:55],v2
ds_read_b128 v[68:71],v4 offset:0
v_smfmac_f32_16x16x64_bf16 v[32:35],v[52:55],a[56:63],v2
buffer_store_dwordx4 v[100:103],v1,s[8:11],s78 offen sc1
v_smfmac_f32_16x16x64_bf16 v[36:39],v[52:55],a[64:71],v2
buffer_store_dwordx2 v[104:105],v8,s[8:11],s78 offen offset:1024 sc1
s_mov_b32 s78,2147483648
v_smfmac_f32_16x16x64_bf16 v[40:43],v[52:55],a[72:79],v2
s_waitcnt lgkmcnt(5)
v_smfmac_f32_16x16x64_bf16 v[44:47],v[48:51],v[72:79],v2
ds_read_b128 v[72:75],v21 offset:4096
s_waitcnt lgkmcnt(4)
v_smfmac_f32_16x16x64_bf16 v[44:47],v[52:55],v[80:87],v2
ds_read_b128 v[76:79],v21 offset:5120
s_waitcnt lgkmcnt(4)
v_smfmac_f32_16x16x64_bf16 v[24:27],v[60:63],a[80:87],v2
ds_read_b128 v[80:83],v21 offset:6144
v_smfmac_f32_16x16x64_bf16 v[28:31],v[60:63],a[88:95],v2
ds_read_b128 v[84:87],v21 offset:7168
v_smfmac_f32_16x16x64_bf16 v[32:35],v[60:63],a[96:103],v2
v_smfmac_f32_16x16x64_bf16 v[36:39],v[60:63],a[104:111],v2
v_smfmac_f32_16x16x64_bf16 v[40:43],v[60:63],a[112:119],v2
s_waitcnt lgkmcnt(2)
v_smfmac_f32_16x16x64_bf16 v[44:47],v[60:63],v[72:79],v2
ds_read_b128 v[60:63],v4 offset:1024
v_smfmac_f32_16x16x64_bf16 v[24:27],v[64:67],a[120:127],v2
ds_read_b128 v[72:75],v21 offset:8192
v_smfmac_f32_16x16x64_bf16 v[28:31],v[64:67],a[128:135],v2
ds_read_b128 v[76:79],v21 offset:9216
v_smfmac_f32_16x16x64_bf16 v[32:35],v[64:67],a[136:143],v2
v_smfmac_f32_16x16x64_bf16 v[36:39],v[64:67],a[144:151],v2
v_smfmac_f32_16x16x64_bf16 v[40:43],v[64:67],a[152:159],v2
s_waitcnt lgkmcnt(3)
v_smfmac_f32_16x16x64_bf16 v[44:47],v[64:67],v[80:87],v2
ds_read_b128 v[64:67],v5 offset:0
v_smfmac_f32_16x16x64_bf16 v[24:27],v[68:71],a[160:167],v2
ds_read_b128 v[80:83],v21 offset:10240
v_smfmac_f32_16x16x64_bf16 v[28:31],v[68:71],a[168:175],v2
ds_read_b128 v[84:87],v21 offset:11264
v_smfmac_f32_16x16x64_bf16 v[32:35],v[68:71],a[176:183],v2
v_smfmac_f32_16x16x64_bf16 v[36:39],v[68:71],a[184:191],v2
v_smfmac_f32_16x16x64_bf16 v[40:43],v[68:71],a[192:199],v2
s_waitcnt lgkmcnt(3)
v_smfmac_f32_16x16x64_bf16 v[44:47],v[68:71],v[72:79],v2
ds_read_b128 v[68:71],v5 offset:1024
v_smfmac_f32_16x16x64_bf16 v[24:27],v[60:63],a[200:207],v2
ds_read_b128 v[72:75],v21 offset:12288
v_smfmac_f32_16x16x64_bf16 v[28:31],v[60:63],a[208:215],v2
ds_read_b128 v[76:79],v21 offset:13312
v_smfmac_f32_16x16x64_bf16 v[32:35],v[60:63],a[216:223],v2
v_smfmac_f32_16x16x64_bf16 v[36:39],v[60:63],a[224:231],v2
v_smfmac_f32_16x16x64_bf16 v[40:43],v[60:63],a[232:239],v2
s_waitcnt lgkmcnt(3)
v_smfmac_f32_16x16x64_bf16 v[44:47],v[60:63],v[80:87],v2
ds_read_b128 v[60:63],v59 offset:0
v_smfmac_f32_16x16x64_bf16 v[24:27],v[64:67],a[240:247],v2
ds_read_b128 v[80:83],v21 offset:14336
v_smfmac_f32_16x16x64_bf16 v[28:31],v[64:67],a[248:255],v2
ds_read_b128 v[84:87],v21 offset:15360
v_smfmac_f32_16x16x64_bf16 v[32:35],v[64:67],v[112:119],v2
v_smfmac_f32_16x16x64_bf16 v[36:39],v[64:67],v[120:127],v2
v_smfmac_f32_16x16x64_bf16 v[40:43],v[64:67],v[128:135],v2
s_waitcnt lgkmcnt(3)
v_smfmac_f32_16x16x64_bf16 v[44:47],v[64:67],v[72:79],v2
ds_read_b128 v[64:67],v59 offset:1024
v_smfmac_f32_16x16x64_bf16 v[24:27],v[68:71],v[136:143],v2
ds_read_b128 v[72:75],v21 offset:16384
v_smfmac_f32_16x16x64_bf16 v[28:31],v[68:71],v[144:151],v2
ds_read_b128 v[76:79],v21 offset:17408
v_smfmac_f32_16x16x64_bf16 v[32:35],v[68:71],v[152:159],v2
v_smfmac_f32_16x16x64_bf16 v[36:39],v[68:71],v[160:167],v2
v_smfmac_f32_16x16x64_bf16 v[40:43],v[68:71],v[168:175],v2
s_waitcnt lgkmcnt(3)
v_smfmac_f32_16x16x64_bf16 v[44:47],v[68:71],v[80:87],v2
ds_read_b128 v[80:83],v21 offset:18432
v_smfmac_f32_16x16x64_bf16 v[24:27],v[60:63],v[176:183],v2
ds_read_b128 v[84:87],v21 offset:19456
v_smfmac_f32_16x16x64_bf16 v[28:31],v[60:63],v[184:191],v2
s_waitcnt lgkmcnt(4)
v_smfmac_f32_16x16x64_bf16 v[24:27],v[64:67],v[216:223],v2
v_smfmac_f32_16x16x64_bf16 v[28:31],v[64:67],v[224:231],v2
v_smfmac_f32_16x16x64_bf16 v[32:35],v[60:63],v[192:199],v2
v_smfmac_f32_16x16x64_bf16 v[36:39],v[60:63],v[200:207],v2
v_add_f32 v24,v24,v25
v_smfmac_f32_16x16x64_bf16 v[32:35],v[64:67],v[232:239],v2
v_add_f32 v26,v26,v27
v_smfmac_f32_16x16x64_bf16 v[36:39],v[64:67],v[240:247],v2
v_add_f32 v28,v28,v29
v_smfmac_f32_16x16x64_bf16 v[40:43],v[60:63],v[208:215],v2
v_add_f32 v30,v30,v31
s_waitcnt lgkmcnt(2)
v_smfmac_f32_16x16x64_bf16 v[44:47],v[60:63],v[72:79],v2
v_cvt_pk_bf16_f32 v100,v24,v26
v_smfmac_f32_16x16x64_bf16 v[40:43],v[64:67],v[248:255],v2
v_cvt_pk_bf16_f32 v101,v28,v30
s_waitcnt lgkmcnt(0)
v_smfmac_f32_16x16x64_bf16 v[44:47],v[64:67],v[80:87],v2
v_and_or_b32 v100,v100,-2,s57
v_add_f32 v32,v32,v33
v_add_f32 v34,v34,v35
v_add_f32 v36,v36,v37
v_add_f32 v38,v38,v39
v_cvt_pk_bf16_f32 v102,v32,v34
v_cvt_pk_bf16_f32 v103,v36,v38
v_and_or_b32 v102,v102,-2,s57
buffer_store_dwordx4 v[100:103],v6,s[8:11],s71 offen
v_add_f32 v40,v40,v41
v_add_f32 v42,v42,v43
v_add_f32 v44,v44,v45
v_add_f32 v46,v46,v47
v_cvt_pk_bf16_f32 v104,v40,v42
v_cvt_pk_bf16_f32 v105,v44,v46
v_and_or_b32 v104,v104,-2,s57
buffer_store_dwordx2 v[104:105],v7,s[8:11],s71 offen
s_and_b32 s60,s52,15
s_lshl4_add_u32 s60,s51,s60
s_mul_i32 s78,s60,196608
s_add_u32 s78,s78,s85
s_bfe_u32 s28,s52,0x10004
v_and_or_b32 v100,v100,-2,s28
v_and_or_b32 v104,v104,-2,s28
s_sub_u32 s60,s4,s5
s_cmp_gt_i32 s60,13
s_cselect_b32 s53,1,0
s_cmp_eq_u32 s4,64
s_cselect_b32 s53,1,s53
s_cmp_eq_u32 s53,0
s_cselect_b32 s54,s4,s5
s_addc_u32 s4,s4,0
s_add_u32 s5,s5,s53
s_and_b32 s60,s54,1
s_lshl2_add_u32 s60,s53,s60
s_lshl_b32 s68,s60,16
s_add_u32 s68,s68,s83
s_mul_i32 s59,s60,20480
s_add_u32 s59,s59,s6
s_lshl_b32 s69,s53,9
s_add_u32 s69,s69,s7
s_bfe_u32 s31,s54,65537
s_add_u32 s32,s54,1
s_cmp_lg_u32 s53,s51
s_cbranch_scc1 nx_140
s_waitcnt vmcnt(0)
s_cmp_ge_u32 s79,2147483648
s_cbranch_scc1 pf_141
v_mov_b32 v17,1
s_mov_b64 exec,1
buffer_store_dword v17,v1,s[8:11],s79 offen sc1
s_mov_b64 exec,-1
s_mov_b32 s79,2147483648
pf_141:
s_cmp_eq_u32 s78,2147483648
s_cbranch_scc1 pk_142
buffer_store_dwordx4 v[100:103],v1,s[8:11],s78 offen sc1
buffer_store_dwordx2 v[104:105],v8,s[8:11],s78 offen offset:1024 sc1
s_mov_b32 s79,s30
s_mov_b32 s78,2147483648
pk_142:
s_waitcnt vmcnt(0)
s_cmp_ge_u32 s79,2147483648
s_cbranch_scc1 pf_143
v_mov_b32 v17,1
s_mov_b64 exec,1
buffer_store_dword v17,v1,s[8:11],s79 offen sc1
s_mov_b64 exec,-1
s_mov_b32 s79,2147483648
pf_143:
nx_140:
s_add_u32 s50,s50,1
s_mov_b32 s51,s53
s_mov_b32 s52,s54
s_mov_b32 s57,s31
s_mov_b32 s58,s32
s_cmp_lt_u32 s50,128
s_cbranch_scc1 CV_LOOP_F0
s_branch CV_DONE
fr_134:
v_bitop3_b32 v12,v60,v64,s57 bitop3:0x7e
v_bitop3_b32 v13,v68,v68,s57 bitop3:0x7e
v_xor_b32 v14,s57,v68
v_or3_b32 v12,v12,v13,v14
v_and_b32 v12,1,v12
v_cmp_ne_u32 vcc,0,v12
s_cbranch_vccz sk_144
buffer_load_dwordx2 v[68:69],v18,s[8:11],s59 offen sc1
buffer_load_dwordx4 v[60:63],v1,s[8:11],s59 offen sc1
buffer_load_dwordx4 v[64:67],v1,s[8:11],s59 offen offset:1024 sc1
sk_144:
buffer_load_dwordx2 v[78:79],v18,s[8:11],s68 offen sc1
buffer_load_dwordx4 v[70:73],v1,s[8:11],s68 offen sc1
buffer_load_dwordx4 v[74:77],v1,s[8:11],s68 offen offset:1024 sc1
s_sub_u32 s47,s47,1
s_cbranch_scc1 ABORT
s_waitcnt lgkmcnt(0)
s_branch fa_133
ec_139r:
buffer_load_dwordx2 v[78:79],v18,s[8:11],s68 offen sc1
buffer_load_dwordx4 v[70:73],v1,s[8:11],s68 offen sc1
buffer_load_dwordx4 v[74:77],v1,s[8:11],s68 offen offset:1024 sc1
v_and_b32 v17,1,v16
v_cmp_ne_u32 vcc,0,v17
s_nop 0
s_cbranch_vccnz fr_134
v_lshlrev_b32 v80,16,v60
v_and_b32 v81,0xffff0000,v60
v_lshlrev_b32 v82,16,v61
v_and_b32 v83,0xffff0000,v61
v_lshlrev_b32 v84,16,v62
v_and_b32 v85,0xffff0000,v62
v_lshlrev_b32 v86,16,v63
v_and_b32 v87,0xffff0000,v63
v_lshlrev_b32 v96,16,v68
v_and_b32 v97,0xffff0000,v68
v_lshlrev_b32 v98,16,v69
v_and_b32 v99,0xffff0000,v69
s_sub_u32 s47,s47,1
s_cbranch_scc1 ABORT
s_branch ec_139
CV_LOOP_F1:
v_mov_b32 v24,0
v_mov_b32 v25,0
v_mov_b32 v26,0
v_mov_b32 v27,0
v_mov_b32 v28,0
v_mov_b32 v29,0
v_mov_b32 v30,0
v_mov_b32 v31,0
v_mov_b32 v32,0
v_mov_b32 v33,0
v_mov_b32 v34,0
v_mov_b32 v35,0
v_mov_b32 v36,0
v_mov_b32 v37,0
v_mov_b32 v38,0
v_mov_b32 v39,0
v_mov_b32 v40,0
v_mov_b32 v41,0
v_mov_b32 v42,0
v_mov_b32 v43,0
v_mov_b32 v44,0
v_mov_b32 v45,0
v_mov_b32 v46,0
v_mov_b32 v47,0
s_barrier
buffer_load_dwordx2 v[68:69],v18,s[8:11],s59 offen sc1
buffer_load_dwordx4 v[60:63],v1,s[8:11],s59 offen sc1
buffer_load_dwordx4 v[64:67],v1,s[8:11],s59 offen offset:1024 sc1
fj_147w:
s_waitcnt vmcnt(2)
fj_147f:
buffer_load_dwordx2 v[78:79],v18,s[8:11],s68 offen sc1
buffer_load_dwordx4 v[70:73],v1,s[8:11],s68 offen sc1
buffer_load_dwordx4 v[74:77],v1,s[8:11],s68 offen offset:1024 sc1
fj_147z:
fj_147:
fa_145:
s_waitcnt vmcnt(5)
v_lshlrev_b32 v96,16,v68
v_and_b32 v97,0xffff0000,v68
v_lshlrev_b32 v98,16,v69
v_and_b32 v99,0xffff0000,v69
s_waitcnt vmcnt(4)
v_lshlrev_b32 v80,16,v60
v_and_b32 v81,0xffff0000,v60
v_lshlrev_b32 v82,16,v61
v_and_b32 v83,0xffff0000,v61
v_lshlrev_b32 v84,16,v62
v_and_b32 v85,0xffff0000,v62
v_lshlrev_b32 v86,16,v63
v_and_b32 v87,0xffff0000,v63
s_waitcnt vmcnt(3)
v_lshlrev_b32 v88,16,v64
v_and_b32 v89,0xffff0000,v64
v_lshlrev_b32 v90,16,v65
v_and_b32 v91,0xffff0000,v65
v_lshlrev_b32 v92,16,v66
v_and_b32 v93,0xffff0000,v66
v_lshlrev_b32 v94,16,v67
v_and_b32 v95,0xffff0000,v67
v_bitop3_b32 v16,v60,v64,s57 bitop3:0x7e
v_bitop3_b32 v16,v16,v68,s57 bitop3:0xf6
ec_148:
s_waitcnt vmcnt(2)
v_dot2c_f32_bf16 v96,s37,v78
v_dot2c_f32_bf16 v97,s81,v78
v_dot2c_f32_bf16 v98,s37,v79
v_dot2c_f32_bf16 v99,s81,v79
s_waitcnt vmcnt(1)
v_bitop3_b32 v17,v70,v78,s57 bitop3:0x7e
s_waitcnt vmcnt(0)
v_bitop3_b32 v17,v17,v74,s57 bitop3:0xf6
v_bitop3_b32 v17,v16,v17,1 bitop3:0xa8
v_cmp_ne_u32 vcc,0,v17
v_cvt_pk_bf16_f32 v56,v96,v97
v_cvt_pk_bf16_f32 v57,v98,v99
ds_write_b64 v23,v[56:57]
s_cbranch_vccnz ec_148r
v_dot2c_f32_bf16 v80,s37,v70
v_dot2c_f32_bf16 v81,s81,v70
v_dot2c_f32_bf16 v82,s37,v71
v_dot2c_f32_bf16 v83,s81,v71
v_dot2c_f32_bf16 v84,s37,v72
v_dot2c_f32_bf16 v85,s81,v72
v_dot2c_f32_bf16 v86,s37,v73
v_dot2c_f32_bf16 v87,s81,v73
v_cvt_pk_bf16_f32 v48,v80,v81
v_cvt_pk_bf16_f32 v49,v82,v83
v_cvt_pk_bf16_f32 v50,v84,v85
v_cvt_pk_bf16_f32 v51,v86,v87
ds_write_b128 v22,v[48:51] offset:0
v_dot2c_f32_bf16 v88,s37,v74
v_dot2c_f32_bf16 v89,s81,v74
v_dot2c_f32_bf16 v90,s37,v75
v_dot2c_f32_bf16 v91,s81,v75
v_dot2c_f32_bf16 v92,s37,v76
v_dot2c_f32_bf16 v93,s81,v76
v_dot2c_f32_bf16 v94,s37,v77
v_dot2c_f32_bf16 v95,s81,v77
v_cvt_pk_bf16_f32 v52,v88,v89
v_cvt_pk_bf16_f32 v53,v90,v91
v_cvt_pk_bf16_f32 v54,v92,v93
v_cvt_pk_bf16_f32 v55,v94,v95
ds_write_b128 v22,v[52:55] offset:1024
fj_147g:
v_smfmac_f32_16x16x64_bf16 v[24:27],v[48:51],a[0:7],v2
ds_read_b128 v[72:75],v21 offset:0
s_and_b32 s60,s52,1
v_smfmac_f32_16x16x64_bf16 v[28:31],v[48:51],a[8:15],v2
ds_read_b128 v[76:79],v21 offset:1024
s_lshl2_add_u32 s60,s51,s60
v_smfmac_f32_16x16x64_bf16 v[32:35],v[48:51],a[16:23],v2
ds_read_b128 v[80:83],v21 offset:2048
s_mul_i32 s60,s60,49152
v_smfmac_f32_16x16x64_bf16 v[36:39],v[48:51],a[24:31],v2
ds_read_b128 v[84:87],v21 offset:3072
s_add_u32 s71,s60,s34
s_waitcnt lgkmcnt(4)
s_barrier
v_smfmac_f32_16x16x64_bf16 v[40:43],v[48:51],a[32:39],v2
ds_read_b128 v[60:63],v3 offset:0
v_smfmac_f32_16x16x64_bf16 v[24:27],v[52:55],a[40:47],v2
ds_read_b128 v[64:67],v3 offset:1024
v_smfmac_f32_16x16x64_bf16 v[28:31],v[52:55],a[48:55],v2
ds_read_b128 v[68:71],v4 offset:0
v_smfmac_f32_16x16x64_bf16 v[32:35],v[52:55],a[56:63],v2
buffer_store_dwordx4 v[100:103],v1,s[8:11],s78 offen offset:1536 sc1
v_smfmac_f32_16x16x64_bf16 v[36:39],v[52:55],a[64:71],v2
buffer_store_dwordx2 v[104:105],v8,s[8:11],s78 offen offset:2560 sc1
s_mov_b32 s78,2147483648
v_smfmac_f32_16x16x64_bf16 v[40:43],v[52:55],a[72:79],v2
s_waitcnt lgkmcnt(5)
v_smfmac_f32_16x16x64_bf16 v[44:47],v[48:51],v[72:79],v2
ds_read_b128 v[72:75],v21 offset:4096
s_waitcnt lgkmcnt(4)
v_smfmac_f32_16x16x64_bf16 v[44:47],v[52:55],v[80:87],v2
ds_read_b128 v[76:79],v21 offset:5120
s_waitcnt lgkmcnt(4)
v_smfmac_f32_16x16x64_bf16 v[24:27],v[60:63],a[80:87],v2
ds_read_b128 v[80:83],v21 offset:6144
v_smfmac_f32_16x16x64_bf16 v[28:31],v[60:63],a[88:95],v2
ds_read_b128 v[84:87],v21 offset:7168
v_smfmac_f32_16x16x64_bf16 v[32:35],v[60:63],a[96:103],v2
v_smfmac_f32_16x16x64_bf16 v[36:39],v[60:63],a[104:111],v2
v_smfmac_f32_16x16x64_bf16 v[40:43],v[60:63],a[112:119],v2
s_waitcnt lgkmcnt(2)
v_smfmac_f32_16x16x64_bf16 v[44:47],v[60:63],v[72:79],v2
ds_read_b128 v[60:63],v4 offset:1024
v_smfmac_f32_16x16x64_bf16 v[24:27],v[64:67],a[120:127],v2
ds_read_b128 v[72:75],v21 offset:8192
v_smfmac_f32_16x16x64_bf16 v[28:31],v[64:67],a[128:135],v2
ds_read_b128 v[76:79],v21 offset:9216
v_smfmac_f32_16x16x64_bf16 v[32:35],v[64:67],a[136:143],v2
v_smfmac_f32_16x16x64_bf16 v[36:39],v[64:67],a[144:151],v2
v_smfmac_f32_16x16x64_bf16 v[40:43],v[64:67],a[152:159],v2
s_waitcnt lgkmcnt(3)
v_smfmac_f32_16x16x64_bf16 v[44:47],v[64:67],v[80:87],v2
ds_read_b128 v[64:67],v5 offset:0
v_smfmac_f32_16x16x64_bf16 v[24:27],v[68:71],a[160:167],v2
ds_read_b128 v[80:83],v21 offset:10240
v_smfmac_f32_16x16x64_bf16 v[28:31],v[68:71],a[168:175],v2
ds_read_b128 v[84:87],v21 offset:11264
v_smfmac_f32_16x16x64_bf16 v[32:35],v[68:71],a[176:183],v2
v_smfmac_f32_16x16x64_bf16 v[36:39],v[68:71],a[184:191],v2
v_smfmac_f32_16x16x64_bf16 v[40:43],v[68:71],a[192:199],v2
s_waitcnt lgkmcnt(3)
v_smfmac_f32_16x16x64_bf16 v[44:47],v[68:71],v[72:79],v2
ds_read_b128 v[68:71],v5 offset:1024
v_smfmac_f32_16x16x64_bf16 v[24:27],v[60:63],a[200:207],v2
ds_read_b128 v[72:75],v21 offset:12288
v_smfmac_f32_16x16x64_bf16 v[28:31],v[60:63],a[208:215],v2
ds_read_b128 v[76:79],v21 offset:13312
v_smfmac_f32_16x16x64_bf16 v[32:35],v[60:63],a[216:223],v2
v_smfmac_f32_16x16x64_bf16 v[36:39],v[60:63],a[224:231],v2
v_smfmac_f32_16x16x64_bf16 v[40:43],v[60:63],a[232:239],v2
s_waitcnt lgkmcnt(3)
v_smfmac_f32_16x16x64_bf16 v[44:47],v[60:63],v[80:87],v2
ds_read_b128 v[60:63],v59 offset:0
v_smfmac_f32_16x16x64_bf16 v[24:27],v[64:67],a[240:247],v2
ds_read_b128 v[80:83],v21 offset:14336
v_smfmac_f32_16x16x64_bf16 v[28:31],v[64:67],a[248:255],v2
ds_read_b128 v[84:87],v21 offset:15360
v_smfmac_f32_16x16x64_bf16 v[32:35],v[64:67],v[112:119],v2
v_smfmac_f32_16x16x64_bf16 v[36:39],v[64:67],v[120:127],v2
v_smfmac_f32_16x16x64_bf16 v[40:43],v[64:67],v[128:135],v2
s_waitcnt lgkmcnt(3)
v_smfmac_f32_16x16x64_bf16 v[44:47],v[64:67],v[72:79],v2
ds_read_b128 v[64:67],v59 offset:1024
v_smfmac_f32_16x16x64_bf16 v[24:27],v[68:71],v[136:143],v2
ds_read_b128 v[72:75],v21 offset:16384
v_smfmac_f32_16x16x64_bf16 v[28:31],v[68:71],v[144:151],v2
ds_read_b128 v[76:79],v21 offset:17408
v_smfmac_f32_16x16x64_bf16 v[32:35],v[68:71],v[152:159],v2
v_smfmac_f32_16x16x64_bf16 v[36:39],v[68:71],v[160:167],v2
v_smfmac_f32_16x16x64_bf16 v[40:43],v[68:71],v[168:175],v2
s_waitcnt lgkmcnt(3)
v_smfmac_f32_16x16x64_bf16 v[44:47],v[68:71],v[80:87],v2
ds_read_b128 v[80:83],v21 offset:18432
v_smfmac_f32_16x16x64_bf16 v[24:27],v[60:63],v[176:183],v2
ds_read_b128 v[84:87],v21 offset:19456
v_smfmac_f32_16x16x64_bf16 v[28:31],v[60:63],v[184:191],v2
s_waitcnt lgkmcnt(4)
v_smfmac_f32_16x16x64_bf16 v[24:27],v[64:67],v[216:223],v2
v_smfmac_f32_16x16x64_bf16 v[28:31],v[64:67],v[224:231],v2
v_smfmac_f32_16x16x64_bf16 v[32:35],v[60:63],v[192:199],v2
v_smfmac_f32_16x16x64_bf16 v[36:39],v[60:63],v[200:207],v2
v_add_f32 v24,v24,v25
v_smfmac_f32_16x16x64_bf16 v[32:35],v[64:67],v[232:239],v2
v_add_f32 v26,v26,v27
v_smfmac_f32_16x16x64_bf16 v[36:39],v[64:67],v[240:247],v2
v_add_f32 v28,v28,v29
v_smfmac_f32_16x16x64_bf16 v[40:43],v[60:63],v[208:215],v2
v_add_f32 v30,v30,v31
s_waitcnt lgkmcnt(2)
v_smfmac_f32_16x16x64_bf16 v[44:47],v[60:63],v[72:79],v2
v_cvt_pk_bf16_f32 v100,v24,v26
v_smfmac_f32_16x16x64_bf16 v[40:43],v[64:67],v[248:255],v2
v_cvt_pk_bf16_f32 v101,v28,v30
s_waitcnt lgkmcnt(0)
v_smfmac_f32_16x16x64_bf16 v[44:47],v[64:67],v[80:87],v2
v_and_or_b32 v100,v100,-2,s57
buffer_store_dwordx2 v[100:101],v7,s[8:11],s71 offen
v_add_f32 v32,v32,v33
v_add_f32 v34,v34,v35
v_add_f32 v36,v36,v37
v_add_f32 v38,v38,v39
v_cvt_pk_bf16_f32 v102,v32,v34
v_cvt_pk_bf16_f32 v103,v36,v38
v_and_or_b32 v102,v102,-2,s57
v_add_f32 v40,v40,v41
v_add_f32 v42,v42,v43
v_add_f32 v44,v44,v45
v_add_f32 v46,v46,v47
v_cvt_pk_bf16_f32 v104,v40,v42
v_cvt_pk_bf16_f32 v105,v44,v46
v_and_or_b32 v104,v104,-2,s57
buffer_store_dwordx4 v[102:105],v6,s[8:11],s71 offen
s_and_b32 s60,s52,15
s_lshl4_add_u32 s60,s51,s60
s_mul_i32 s78,s60,196608
s_add_u32 s78,s78,s85
s_bfe_u32 s28,s52,0x10004
v_and_or_b32 v100,v100,-2,s28
v_and_or_b32 v104,v104,-2,s28
s_sub_u32 s60,s4,s5
s_cmp_gt_i32 s60,13
s_cselect_b32 s53,1,0
s_cmp_eq_u32 s4,64
s_cselect_b32 s53,1,s53
s_cmp_eq_u32 s53,0
s_cselect_b32 s54,s4,s5
s_addc_u32 s4,s4,0
s_add_u32 s5,s5,s53
s_and_b32 s60,s54,1
s_lshl2_add_u32 s60,s53,s60
s_lshl_b32 s68,s60,16
s_add_u32 s68,s68,s83
s_mul_i32 s59,s60,20480
s_add_u32 s59,s59,s6
s_lshl_b32 s69,s53,9
s_add_u32 s69,s69,s7
s_bfe_u32 s31,s54,65537
s_add_u32 s32,s54,1
s_cmp_lg_u32 s53,s51
s_cbranch_scc1 nx_149
s_waitcnt vmcnt(0)
s_cmp_ge_u32 s79,2147483648
s_cbranch_scc1 pf_150
v_mov_b32 v17,1
s_mov_b64 exec,1
buffer_store_dword v17,v1,s[8:11],s79 offen sc1
s_mov_b64 exec,-1
s_mov_b32 s79,2147483648
pf_150:
s_cmp_eq_u32 s78,2147483648
s_cbranch_scc1 pk_151
buffer_store_dwordx4 v[100:103],v1,s[8:11],s78 offen offset:1536 sc1
buffer_store_dwordx2 v[104:105],v8,s[8:11],s78 offen offset:2560 sc1
s_mov_b32 s79,s30
s_mov_b32 s78,2147483648
pk_151:
s_waitcnt vmcnt(0)
s_cmp_ge_u32 s79,2147483648
s_cbranch_scc1 pf_152
v_mov_b32 v17,1
s_mov_b64 exec,1
buffer_store_dword v17,v1,s[8:11],s79 offen sc1
s_mov_b64 exec,-1
s_mov_b32 s79,2147483648
pf_152:
nx_149:
s_add_u32 s50,s50,1
s_mov_b32 s51,s53
s_mov_b32 s52,s54
s_mov_b32 s57,s31
s_mov_b32 s58,s32
s_cmp_lt_u32 s50,128
s_cbranch_scc1 CV_LOOP_F1
s_branch CV_DONE
fr_146:
v_bitop3_b32 v12,v60,v64,s57 bitop3:0x7e
v_bitop3_b32 v13,v68,v68,s57 bitop3:0x7e
v_xor_b32 v14,s57,v68
v_or3_b32 v12,v12,v13,v14
v_and_b32 v12,1,v12
v_cmp_ne_u32 vcc,0,v12
s_cbranch_vccz sk_153
buffer_load_dwordx2 v[68:69],v18,s[8:11],s59 offen sc1
buffer_load_dwordx4 v[60:63],v1,s[8:11],s59 offen sc1
buffer_load_dwordx4 v[64:67],v1,s[8:11],s59 offen offset:1024 sc1
sk_153:
buffer_load_dwordx2 v[78:79],v18,s[8:11],s68 offen sc1
buffer_load_dwordx4 v[70:73],v1,s[8:11],s68 offen sc1
buffer_load_dwordx4 v[74:77],v1,s[8:11],s68 offen offset:1024 sc1
s_sub_u32 s47,s47,1
s_cbranch_scc1 ABORT
s_waitcnt lgkmcnt(0)
s_branch fa_145
ec_148r:
buffer_load_dwordx2 v[78:79],v18,s[8:11],s68 offen sc1
buffer_load_dwordx4 v[70:73],v1,s[8:11],s68 offen sc1
buffer_load_dwordx4 v[74:77],v1,s[8:11],s68 offen offset:1024 sc1
v_and_b32 v17,1,v16
v_cmp_ne_u32 vcc,0,v17
s_nop 0
s_cbranch_vccnz fr_146
v_lshlrev_b32 v80,16,v60
v_and_b32 v81,0xffff0000,v60
v_lshlrev_b32 v82,16,v61
v_and_b32 v83,0xffff0000,v61
v_lshlrev_b32 v84,16,v62
v_and_b32 v85,0xffff0000,v62
v_lshlrev_b32 v86,16,v63
v_and_b32 v87,0xffff0000,v63
v_lshlrev_b32 v96,16,v68
v_and_b32 v97,0xffff0000,v68
v_lshlrev_b32 v98,16,v69
v_and_b32 v99,0xffff0000,v69
s_sub_u32 s47,s47,1
s_cbranch_scc1 ABORT
s_branch ec_148
CV_LOOP_S0:
v_mov_b32 v24,0
v_mov_b32 v25,0
v_mov_b32 v26,0
v_mov_b32 v27,0
v_mov_b32 v28,0
v_mov_b32 v29,0
v_mov_b32 v30,0
v_mov_b32 v31,0
v_mov_b32 v32,0
v_mov_b32 v33,0
v_mov_b32 v34,0
v_mov_b32 v35,0
v_mov_b32 v36,0
v_mov_b32 v37,0
v_mov_b32 v38,0
v_mov_b32 v39,0
v_mov_b32 v40,0
v_mov_b32 v41,0
v_mov_b32 v42,0
v_mov_b32 v43,0
v_mov_b32 v44,0
v_mov_b32 v45,0
v_mov_b32 v46,0
v_mov_b32 v47,0
s_cmp_lg_u32 s46,0
s_cbranch_scc1 np_157
db_158:
buffer_load_dword v12,v11,s[8:11],s69 offen sc1
s_waitcnt vmcnt(0)
v_cmp_gt_u32 vcc,s58,v12
s_cbranch_vccz dbok_159
s_sub_u32 s47,s47,1
s_cbranch_scc1 ABORT
s_branch db_158
dbok_159:
np_157:
s_barrier
buffer_load_dwordx2 v[68:69],v18,s[8:11],s59 offen sc1
buffer_load_dwordx4 v[60:63],v1,s[8:11],s59 offen sc1
buffer_load_dwordx4 v[64:67],v1,s[8:11],s59 offen offset:1024 sc1
fj_156w:
s_waitcnt vmcnt(2)
fj_156f:
buffer_load_dwordx2 v[78:79],v18,s[8:11],s68 offen sc1
buffer_load_dwordx4 v[70:73],v1,s[8:11],s68 offen sc1
buffer_load_dwordx4 v[74:77],v1,s[8:11],s68 offen offset:1024 sc1
fj_156z:
fj_156:
fa_154:
s_waitcnt vmcnt(5)
v_lshlrev_b32 v96,16,v68
v_and_b32 v97,0xffff0000,v68
v_lshlrev_b32 v98,16,v69
v_and_b32 v99,0xffff0000,v69
s_waitcnt vmcnt(4)
v_lshlrev_b32 v80,16,v60
v_and_b32 v81,0xffff0000,v60
v_lshlrev_b32 v82,16,v61
v_and_b32 v83,0xffff0000,v61
v_lshlrev_b32 v84,16,v62
v_and_b32 v85,0xffff0000,v62
v_lshlrev_b32 v86,16,v63
v_and_b32 v87,0xffff0000,v63
s_waitcnt vmcnt(3)
v_lshlrev_b32 v88,16,v64
v_and_b32 v89,0xffff0000,v64
v_lshlrev_b32 v90,16,v65
v_and_b32 v91,0xffff0000,v65
v_lshlrev_b32 v92,16,v66
v_and_b32 v93,0xffff0000,v66
v_lshlrev_b32 v94,16,v67
v_and_b32 v95,0xffff0000,v67
v_bitop3_b32 v16,v60,v64,s57 bitop3:0x7e
v_bitop3_b32 v16,v16,v68,s57 bitop3:0xf6
ec_160:
s_waitcnt vmcnt(2)
v_dot2c_f32_bf16 v96,s37,v78
v_dot2c_f32_bf16 v97,s81,v78
v_dot2c_f32_bf16 v98,s37,v79
v_dot2c_f32_bf16 v99,s81,v79
s_waitcnt vmcnt(1)
v_bitop3_b32 v17,v70,v78,s57 bitop3:0x7e
s_waitcnt vmcnt(0)
v_bitop3_b32 v17,v17,v74,s57 bitop3:0xf6
v_bitop3_b32 v17,v16,v17,1 bitop3:0xa8
v_cmp_ne_u32 vcc,0,v17
v_cvt_pk_bf16_f32 v56,v96,v97
v_cvt_pk_bf16_f32 v57,v98,v99
ds_write_b64 v23,v[56:57]
s_cbranch_vccnz ec_160r
v_dot2c_f32_bf16 v80,s37,v70
v_dot2c_f32_bf16 v81,s81,v70
v_dot2c_f32_bf16 v82,s37,v71
v_dot2c_f32_bf16 v83,s81,v71
v_dot2c_f32_bf16 v84,s37,v72
v_dot2c_f32_bf16 v85,s81,v72
v_dot2c_f32_bf16 v86,s37,v73
v_dot2c_f32_bf16 v87,s81,v73
v_cvt_pk_bf16_f32 v48,v80,v81
v_cvt_pk_bf16_f32 v49,v82,v83
v_cvt_pk_bf16_f32 v50,v84,v85
v_cvt_pk_bf16_f32 v51,v86,v87
ds_write_b128 v22,v[48:51] offset:0
v_dot2c_f32_bf16 v88,s37,v74
v_dot2c_f32_bf16 v89,s81,v74
v_dot2c_f32_bf16 v90,s37,v75
v_dot2c_f32_bf16 v91,s81,v75
v_dot2c_f32_bf16 v92,s37,v76
v_dot2c_f32_bf16 v93,s81,v76
v_dot2c_f32_bf16 v94,s37,v77
v_dot2c_f32_bf16 v95,s81,v77
v_cvt_pk_bf16_f32 v52,v88,v89
v_cvt_pk_bf16_f32 v53,v90,v91
v_cvt_pk_bf16_f32 v54,v92,v93
v_cvt_pk_bf16_f32 v55,v94,v95
ds_write_b128 v22,v[52:55] offset:1024
fj_156g:
v_smfmac_f32_16x16x64_bf16 v[24:27],v[48:51],a[0:7],v2
ds_read_b128 v[72:75],v21 offset:0
s_and_b32 s60,s52,1
v_smfmac_f32_16x16x64_bf16 v[28:31],v[48:51],a[8:15],v2
ds_read_b128 v[76:79],v21 offset:1024
s_lshl2_add_u32 s60,s51,s60
v_smfmac_f32_16x16x64_bf16 v[32:35],v[48:51],a[16:23],v2
ds_read_b128 v[80:83],v21 offset:2048
s_mul_i32 s60,s60,49152
v_smfmac_f32_16x16x64_bf16 v[36:39],v[48:51],a[24:31],v2
ds_read_b128 v[84:87],v21 offset:3072
s_add_u32 s71,s60,s34
s_waitcnt lgkmcnt(4)
s_barrier
v_smfmac_f32_16x16x64_bf16 v[40:43],v[48:51],a[32:39],v2
ds_read_b128 v[60:63],v3 offset:0
v_smfmac_f32_16x16x64_bf16 v[24:27],v[52:55],a[40:47],v2
ds_read_b128 v[64:67],v3 offset:1024
v_smfmac_f32_16x16x64_bf16 v[28:31],v[52:55],a[48:55],v2
ds_read_b128 v[68:71],v4 offset:0
v_smfmac_f32_16x16x64_bf16 v[32:35],v[52:55],a[56:63],v2
buffer_store_dwordx4 v[100:103],v1,s[8:11],s78 offen sc1
v_smfmac_f32_16x16x64_bf16 v[36:39],v[52:55],a[64:71],v2
buffer_store_dwordx2 v[104:105],v8,s[8:11],s78 offen offset:1024 sc1
s_mov_b32 s78,2147483648
v_smfmac_f32_16x16x64_bf16 v[40:43],v[52:55],a[72:79],v2
s_waitcnt lgkmcnt(5)
v_smfmac_f32_16x16x64_bf16 v[44:47],v[48:51],v[72:79],v2
ds_read_b128 v[72:75],v21 offset:4096
s_waitcnt lgkmcnt(4)
v_smfmac_f32_16x16x64_bf16 v[44:47],v[52:55],v[80:87],v2
ds_read_b128 v[76:79],v21 offset:5120
s_waitcnt lgkmcnt(4)
v_smfmac_f32_16x16x64_bf16 v[24:27],v[60:63],a[80:87],v2
ds_read_b128 v[80:83],v21 offset:6144
v_smfmac_f32_16x16x64_bf16 v[28:31],v[60:63],a[88:95],v2
ds_read_b128 v[84:87],v21 offset:7168
v_smfmac_f32_16x16x64_bf16 v[32:35],v[60:63],a[96:103],v2
v_smfmac_f32_16x16x64_bf16 v[36:39],v[60:63],a[104:111],v2
v_smfmac_f32_16x16x64_bf16 v[40:43],v[60:63],a[112:119],v2
s_waitcnt lgkmcnt(2)
v_smfmac_f32_16x16x64_bf16 v[44:47],v[60:63],v[72:79],v2
ds_read_b128 v[60:63],v4 offset:1024
v_smfmac_f32_16x16x64_bf16 v[24:27],v[64:67],a[120:127],v2
ds_read_b128 v[72:75],v21 offset:8192
v_smfmac_f32_16x16x64_bf16 v[28:31],v[64:67],a[128:135],v2
ds_read_b128 v[76:79],v21 offset:9216
v_smfmac_f32_16x16x64_bf16 v[32:35],v[64:67],a[136:143],v2
v_smfmac_f32_16x16x64_bf16 v[36:39],v[64:67],a[144:151],v2
v_smfmac_f32_16x16x64_bf16 v[40:43],v[64:67],a[152:159],v2
s_waitcnt lgkmcnt(3)
v_smfmac_f32_16x16x64_bf16 v[44:47],v[64:67],v[80:87],v2
ds_read_b128 v[64:67],v5 offset:0
v_smfmac_f32_16x16x64_bf16 v[24:27],v[68:71],a[160:167],v2
ds_read_b128 v[80:83],v21 offset:10240
v_smfmac_f32_16x16x64_bf16 v[28:31],v[68:71],a[168:175],v2
ds_read_b128 v[84:87],v21 offset:11264
v_smfmac_f32_16x16x64_bf16 v[32:35],v[68:71],a[176:183],v2
v_smfmac_f32_16x16x64_bf16 v[36:39],v[68:71],a[184:191],v2
v_smfmac_f32_16x16x64_bf16 v[40:43],v[68:71],a[192:199],v2
s_waitcnt lgkmcnt(3)
v_smfmac_f32_16x16x64_bf16 v[44:47],v[68:71],v[72:79],v2
ds_read_b128 v[68:71],v5 offset:1024
v_smfmac_f32_16x16x64_bf16 v[24:27],v[60:63],a[200:207],v2
ds_read_b128 v[72:75],v21 offset:12288
v_smfmac_f32_16x16x64_bf16 v[28:31],v[60:63],a[208:215],v2
ds_read_b128 v[76:79],v21 offset:13312
v_smfmac_f32_16x16x64_bf16 v[32:35],v[60:63],a[216:223],v2
v_smfmac_f32_16x16x64_bf16 v[36:39],v[60:63],a[224:231],v2
v_smfmac_f32_16x16x64_bf16 v[40:43],v[60:63],a[232:239],v2
s_waitcnt lgkmcnt(3)
v_smfmac_f32_16x16x64_bf16 v[44:47],v[60:63],v[80:87],v2
ds_read_b128 v[60:63],v59 offset:0
v_smfmac_f32_16x16x64_bf16 v[24:27],v[64:67],a[240:247],v2
ds_read_b128 v[80:83],v21 offset:14336
v_smfmac_f32_16x16x64_bf16 v[28:31],v[64:67],a[248:255],v2
ds_read_b128 v[84:87],v21 offset:15360
v_smfmac_f32_16x16x64_bf16 v[32:35],v[64:67],v[112:119],v2
v_smfmac_f32_16x16x64_bf16 v[36:39],v[64:67],v[120:127],v2
v_smfmac_f32_16x16x64_bf16 v[40:43],v[64:67],v[128:135],v2
s_waitcnt lgkmcnt(3)
v_smfmac_f32_16x16x64_bf16 v[44:47],v[64:67],v[72:79],v2
ds_read_b128 v[64:67],v59 offset:1024
v_smfmac_f32_16x16x64_bf16 v[24:27],v[68:71],v[136:143],v2
ds_read_b128 v[72:75],v21 offset:16384
v_smfmac_f32_16x16x64_bf16 v[28:31],v[68:71],v[144:151],v2
ds_read_b128 v[76:79],v21 offset:17408
v_smfmac_f32_16x16x64_bf16 v[32:35],v[68:71],v[152:159],v2
v_smfmac_f32_16x16x64_bf16 v[36:39],v[68:71],v[160:167],v2
v_smfmac_f32_16x16x64_bf16 v[40:43],v[68:71],v[168:175],v2
s_waitcnt lgkmcnt(3)
v_smfmac_f32_16x16x64_bf16 v[44:47],v[68:71],v[80:87],v2
ds_read_b128 v[80:83],v21 offset:18432
v_smfmac_f32_16x16x64_bf16 v[24:27],v[60:63],v[176:183],v2
ds_read_b128 v[84:87],v21 offset:19456
v_smfmac_f32_16x16x64_bf16 v[28:31],v[60:63],v[184:191],v2
s_waitcnt lgkmcnt(4)
v_smfmac_f32_16x16x64_bf16 v[24:27],v[64:67],v[216:223],v2
v_smfmac_f32_16x16x64_bf16 v[28:31],v[64:67],v[224:231],v2
v_smfmac_f32_16x16x64_bf16 v[32:35],v[60:63],v[192:199],v2
v_smfmac_f32_16x16x64_bf16 v[36:39],v[60:63],v[200:207],v2
v_add_f32 v24,v24,v25
v_smfmac_f32_16x16x64_bf16 v[32:35],v[64:67],v[232:239],v2
v_add_f32 v26,v26,v27
v_smfmac_f32_16x16x64_bf16 v[36:39],v[64:67],v[240:247],v2
v_add_f32 v28,v28,v29
v_smfmac_f32_16x16x64_bf16 v[40:43],v[60:63],v[208:215],v2
v_add_f32 v30,v30,v31
s_waitcnt lgkmcnt(2)
v_smfmac_f32_16x16x64_bf16 v[44:47],v[60:63],v[72:79],v2
v_cvt_pk_bf16_f32 v100,v24,v26
v_smfmac_f32_16x16x64_bf16 v[40:43],v[64:67],v[248:255],v2
v_cvt_pk_bf16_f32 v101,v28,v30
s_waitcnt lgkmcnt(0)
v_smfmac_f32_16x16x64_bf16 v[44:47],v[64:67],v[80:87],v2
v_and_or_b32 v100,v100,-2,s57
v_add_f32 v32,v32,v33
v_add_f32 v34,v34,v35
v_add_f32 v36,v36,v37
v_add_f32 v38,v38,v39
v_cvt_pk_bf16_f32 v102,v32,v34
v_cvt_pk_bf16_f32 v103,v36,v38
v_and_or_b32 v102,v102,-2,s57
buffer_store_dwordx4 v[100:103],v6,s[8:11],s71 offen sc1
v_add_f32 v40,v40,v41
v_add_f32 v42,v42,v43
v_add_f32 v44,v44,v45
v_add_f32 v46,v46,v47
v_cvt_pk_bf16_f32 v104,v40,v42
v_cvt_pk_bf16_f32 v105,v44,v46
v_and_or_b32 v104,v104,-2,s57
buffer_store_dwordx2 v[104:105],v7,s[8:11],s71 offen sc1
s_and_b32 s60,s52,15
s_lshl4_add_u32 s60,s51,s60
s_mul_i32 s78,s60,196608
s_add_u32 s78,s78,s85
s_bfe_u32 s28,s52,0x10004
v_and_or_b32 v100,v100,-2,s28
v_and_or_b32 v104,v104,-2,s28
s_sub_u32 s60,s4,s5
s_cmp_gt_i32 s60,13
s_cselect_b32 s53,1,0
s_cmp_eq_u32 s4,64
s_cselect_b32 s53,1,s53
s_cmp_eq_u32 s53,0
s_cselect_b32 s54,s4,s5
s_addc_u32 s4,s4,0
s_add_u32 s5,s5,s53
s_and_b32 s60,s54,1
s_lshl2_add_u32 s60,s53,s60
s_lshl_b32 s68,s60,16
s_add_u32 s68,s68,s83
s_mul_i32 s59,s60,20480
s_add_u32 s59,s59,s6
s_lshl_b32 s69,s53,9
s_add_u32 s69,s69,s7
s_bfe_u32 s31,s54,65537
s_add_u32 s32,s54,1
s_cmp_lg_u32 s53,s51
s_cbranch_scc1 nx_161
s_waitcnt vmcnt(0)
s_cmp_ge_u32 s79,2147483648
s_cbranch_scc1 pf_162
v_mov_b32 v17,1
s_mov_b64 exec,1
buffer_store_dword v17,v1,s[8:11],s79 offen sc1
s_mov_b64 exec,-1
s_mov_b32 s79,2147483648
pf_162:
s_cmp_eq_u32 s78,2147483648
s_cbranch_scc1 pk_163
buffer_store_dwordx4 v[100:103],v1,s[8:11],s78 offen sc1
buffer_store_dwordx2 v[104:105],v8,s[8:11],s78 offen offset:1024 sc1
s_mov_b32 s79,s30
s_mov_b32 s78,2147483648
pk_163:
s_waitcnt vmcnt(0)
s_cmp_ge_u32 s79,2147483648
s_cbranch_scc1 pf_164
v_mov_b32 v17,1
s_mov_b64 exec,1
buffer_store_dword v17,v1,s[8:11],s79 offen sc1
s_mov_b64 exec,-1
s_mov_b32 s79,2147483648
pf_164:
nx_161:
s_add_u32 s50,s50,1
s_mov_b32 s51,s53
s_mov_b32 s52,s54
s_mov_b32 s57,s31
s_mov_b32 s58,s32
s_cmp_lt_u32 s50,128
s_cbranch_scc1 CV_LOOP_S0
s_branch CV_DONE
fr_155:
v_bitop3_b32 v12,v60,v64,s57 bitop3:0x7e
v_bitop3_b32 v13,v68,v68,s57 bitop3:0x7e
v_xor_b32 v14,s57,v68
v_or3_b32 v12,v12,v13,v14
v_and_b32 v12,1,v12
v_cmp_ne_u32 vcc,0,v12
s_cbranch_vccz sk_165
buffer_load_dwordx2 v[68:69],v18,s[8:11],s59 offen sc1
buffer_load_dwordx4 v[60:63],v1,s[8:11],s59 offen sc1
buffer_load_dwordx4 v[64:67],v1,s[8:11],s59 offen offset:1024 sc1
sk_165:
buffer_load_dwordx2 v[78:79],v18,s[8:11],s68 offen sc1
buffer_load_dwordx4 v[70:73],v1,s[8:11],s68 offen sc1
buffer_load_dwordx4 v[74:77],v1,s[8:11],s68 offen offset:1024 sc1
s_sub_u32 s47,s47,1
s_cbranch_scc1 ABORT
s_waitcnt lgkmcnt(0)
s_branch fa_154
ec_160r:
buffer_load_dwordx2 v[78:79],v18,s[8:11],s68 offen sc1
buffer_load_dwordx4 v[70:73],v1,s[8:11],s68 offen sc1
buffer_load_dwordx4 v[74:77],v1,s[8:11],s68 offen offset:1024 sc1
v_and_b32 v17,1,v16
v_cmp_ne_u32 vcc,0,v17
s_nop 0
s_cbranch_vccnz fr_155
v_lshlrev_b32 v80,16,v60
v_and_b32 v81,0xffff0000,v60
v_lshlrev_b32 v82,16,v61
v_and_b32 v83,0xffff0000,v61
v_lshlrev_b32 v84,16,v62
v_and_b32 v85,0xffff0000,v62
v_lshlrev_b32 v86,16,v63
v_and_b32 v87,0xffff0000,v63
v_lshlrev_b32 v96,16,v68
v_and_b32 v97,0xffff0000,v68
v_lshlrev_b32 v98,16,v69
v_and_b32 v99,0xffff0000,v69
s_sub_u32 s47,s47,1
s_cbranch_scc1 ABORT
s_branch ec_160
CV_LOOP_S1:
v_mov_b32 v24,0
v_mov_b32 v25,0
v_mov_b32 v26,0
v_mov_b32 v27,0
v_mov_b32 v28,0
v_mov_b32 v29,0
v_mov_b32 v30,0
v_mov_b32 v31,0
v_mov_b32 v32,0
v_mov_b32 v33,0
v_mov_b32 v34,0
v_mov_b32 v35,0
v_mov_b32 v36,0
v_mov_b32 v37,0
v_mov_b32 v38,0
v_mov_b32 v39,0
v_mov_b32 v40,0
v_mov_b32 v41,0
v_mov_b32 v42,0
v_mov_b32 v43,0
v_mov_b32 v44,0
v_mov_b32 v45,0
v_mov_b32 v46,0
v_mov_b32 v47,0
s_barrier
buffer_load_dwordx2 v[68:69],v18,s[8:11],s59 offen sc1
buffer_load_dwordx4 v[60:63],v1,s[8:11],s59 offen sc1
buffer_load_dwordx4 v[64:67],v1,s[8:11],s59 offen offset:1024 sc1
fj_168w:
s_waitcnt vmcnt(2)
fj_168f:
buffer_load_dwordx2 v[78:79],v18,s[8:11],s68 offen sc1
buffer_load_dwordx4 v[70:73],v1,s[8:11],s68 offen sc1
buffer_load_dwordx4 v[74:77],v1,s[8:11],s68 offen offset:1024 sc1
fj_168z:
fj_168:
fa_166:
s_waitcnt vmcnt(5)
v_lshlrev_b32 v96,16,v68
v_and_b32 v97,0xffff0000,v68
v_lshlrev_b32 v98,16,v69
v_and_b32 v99,0xffff0000,v69
s_waitcnt vmcnt(4)
v_lshlrev_b32 v80,16,v60
v_and_b32 v81,0xffff0000,v60
v_lshlrev_b32 v82,16,v61
v_and_b32 v83,0xffff0000,v61
v_lshlrev_b32 v84,16,v62
v_and_b32 v85,0xffff0000,v62
v_lshlrev_b32 v86,16,v63
v_and_b32 v87,0xffff0000,v63
s_waitcnt vmcnt(3)
v_lshlrev_b32 v88,16,v64
v_and_b32 v89,0xffff0000,v64
v_lshlrev_b32 v90,16,v65
v_and_b32 v91,0xffff0000,v65
v_lshlrev_b32 v92,16,v66
v_and_b32 v93,0xffff0000,v66
v_lshlrev_b32 v94,16,v67
v_and_b32 v95,0xffff0000,v67
v_bitop3_b32 v16,v60,v64,s57 bitop3:0x7e
v_bitop3_b32 v16,v16,v68,s57 bitop3:0xf6
ec_169:
s_waitcnt vmcnt(2)
v_dot2c_f32_bf16 v96,s37,v78
v_dot2c_f32_bf16 v97,s81,v78
v_dot2c_f32_bf16 v98,s37,v79
v_dot2c_f32_bf16 v99,s81,v79
s_waitcnt vmcnt(1)
v_bitop3_b32 v17,v70,v78,s57 bitop3:0x7e
s_waitcnt vmcnt(0)
v_bitop3_b32 v17,v17,v74,s57 bitop3:0xf6
v_bitop3_b32 v17,v16,v17,1 bitop3:0xa8
v_cmp_ne_u32 vcc,0,v17
v_cvt_pk_bf16_f32 v56,v96,v97
v_cvt_pk_bf16_f32 v57,v98,v99
ds_write_b64 v23,v[56:57]
s_cbranch_vccnz ec_169r
v_dot2c_f32_bf16 v80,s37,v70
v_dot2c_f32_bf16 v81,s81,v70
v_dot2c_f32_bf16 v82,s37,v71
v_dot2c_f32_bf16 v83,s81,v71
v_dot2c_f32_bf16 v84,s37,v72
v_dot2c_f32_bf16 v85,s81,v72
v_dot2c_f32_bf16 v86,s37,v73
v_dot2c_f32_bf16 v87,s81,v73
v_cvt_pk_bf16_f32 v48,v80,v81
v_cvt_pk_bf16_f32 v49,v82,v83
v_cvt_pk_bf16_f32 v50,v84,v85
v_cvt_pk_bf16_f32 v51,v86,v87
ds_write_b128 v22,v[48:51] offset:0
v_dot2c_f32_bf16 v88,s37,v74
v_dot2c_f32_bf16 v89,s81,v74
v_dot2c_f32_bf16 v90,s37,v75
v_dot2c_f32_bf16 v91,s81,v75
v_dot2c_f32_bf16 v92,s37,v76
v_dot2c_f32_bf16 v93,s81,v76
v_dot2c_f32_bf16 v94,s37,v77
v_dot2c_f32_bf16 v95,s81,v77
v_cvt_pk_bf16_f32 v52,v88,v89
v_cvt_pk_bf16_f32 v53,v90,v91
v_cvt_pk_bf16_f32 v54,v92,v93
v_cvt_pk_bf16_f32 v55,v94,v95
ds_write_b128 v22,v[52:55] offset:1024
fj_168g:
v_smfmac_f32_16x16x64_bf16 v[24:27],v[48:51],a[0:7],v2
ds_read_b128 v[72:75],v21 offset:0
s_and_b32 s60,s52,1
v_smfmac_f32_16x16x64_bf16 v[28:31],v[48:51],a[8:15],v2
ds_read_b128 v[76:79],v21 offset:1024
s_lshl2_add_u32 s60,s51,s60
v_smfmac_f32_16x16x64_bf16 v[32:35],v[48:51],a[16:23],v2
ds_read_b128 v[80:83],v21 offset:2048
s_mul_i32 s60,s60,49152
v_smfmac_f32_16x16x64_bf16 v[36:39],v[48:51],a[24:31],v2
ds_read_b128 v[84:87],v21 offset:3072
s_add_u32 s71,s60,s34
s_waitcnt lgkmcnt(4)
s_barrier
v_smfmac_f32_16x16x64_bf16 v[40:43],v[48:51],a[32:39],v2
ds_read_b128 v[60:63],v3 offset:0
v_smfmac_f32_16x16x64_bf16 v[24:27],v[52:55],a[40:47],v2
ds_read_b128 v[64:67],v3 offset:1024
v_smfmac_f32_16x16x64_bf16 v[28:31],v[52:55],a[48:55],v2
ds_read_b128 v[68:71],v4 offset:0
v_smfmac_f32_16x16x64_bf16 v[32:35],v[52:55],a[56:63],v2
buffer_store_dwordx4 v[100:103],v1,s[8:11],s78 offen offset:1536 sc1
v_smfmac_f32_16x16x64_bf16 v[36:39],v[52:55],a[64:71],v2
buffer_store_dwordx2 v[104:105],v8,s[8:11],s78 offen offset:2560 sc1
s_mov_b32 s78,2147483648
v_smfmac_f32_16x16x64_bf16 v[40:43],v[52:55],a[72:79],v2
s_waitcnt lgkmcnt(5)
v_smfmac_f32_16x16x64_bf16 v[44:47],v[48:51],v[72:79],v2
ds_read_b128 v[72:75],v21 offset:4096
s_waitcnt lgkmcnt(4)
v_smfmac_f32_16x16x64_bf16 v[44:47],v[52:55],v[80:87],v2
ds_read_b128 v[76:79],v21 offset:5120
s_waitcnt lgkmcnt(4)
v_smfmac_f32_16x16x64_bf16 v[24:27],v[60:63],a[80:87],v2
ds_read_b128 v[80:83],v21 offset:6144
v_smfmac_f32_16x16x64_bf16 v[28:31],v[60:63],a[88:95],v2
ds_read_b128 v[84:87],v21 offset:7168
v_smfmac_f32_16x16x64_bf16 v[32:35],v[60:63],a[96:103],v2
v_smfmac_f32_16x16x64_bf16 v[36:39],v[60:63],a[104:111],v2
v_smfmac_f32_16x16x64_bf16 v[40:43],v[60:63],a[112:119],v2
s_waitcnt lgkmcnt(2)
v_smfmac_f32_16x16x64_bf16 v[44:47],v[60:63],v[72:79],v2
ds_read_b128 v[60:63],v4 offset:1024
v_smfmac_f32_16x16x64_bf16 v[24:27],v[64:67],a[120:127],v2
ds_read_b128 v[72:75],v21 offset:8192
v_smfmac_f32_16x16x64_bf16 v[28:31],v[64:67],a[128:135],v2
ds_read_b128 v[76:79],v21 offset:9216
v_smfmac_f32_16x16x64_bf16 v[32:35],v[64:67],a[136:143],v2
v_smfmac_f32_16x16x64_bf16 v[36:39],v[64:67],a[144:151],v2
v_smfmac_f32_16x16x64_bf16 v[40:43],v[64:67],a[152:159],v2
s_waitcnt lgkmcnt(3)
v_smfmac_f32_16x16x64_bf16 v[44:47],v[64:67],v[80:87],v2
ds_read_b128 v[64:67],v5 offset:0
v_smfmac_f32_16x16x64_bf16 v[24:27],v[68:71],a[160:167],v2
ds_read_b128 v[80:83],v21 offset:10240
v_smfmac_f32_16x16x64_bf16 v[28:31],v[68:71],a[168:175],v2
ds_read_b128 v[84:87],v21 offset:11264
v_smfmac_f32_16x16x64_bf16 v[32:35],v[68:71],a[176:183],v2
v_smfmac_f32_16x16x64_bf16 v[36:39],v[68:71],a[184:191],v2
v_smfmac_f32_16x16x64_bf16 v[40:43],v[68:71],a[192:199],v2
s_waitcnt lgkmcnt(3)
v_smfmac_f32_16x16x64_bf16 v[44:47],v[68:71],v[72:79],v2
ds_read_b128 v[68:71],v5 offset:1024
v_smfmac_f32_16x16x64_bf16 v[24:27],v[60:63],a[200:207],v2
ds_read_b128 v[72:75],v21 offset:12288
v_smfmac_f32_16x16x64_bf16 v[28:31],v[60:63],a[208:215],v2
ds_read_b128 v[76:79],v21 offset:13312
v_smfmac_f32_16x16x64_bf16 v[32:35],v[60:63],a[216:223],v2
v_smfmac_f32_16x16x64_bf16 v[36:39],v[60:63],a[224:231],v2
v_smfmac_f32_16x16x64_bf16 v[40:43],v[60:63],a[232:239],v2
s_waitcnt lgkmcnt(3)
v_smfmac_f32_16x16x64_bf16 v[44:47],v[60:63],v[80:87],v2
ds_read_b128 v[60:63],v59 offset:0
v_smfmac_f32_16x16x64_bf16 v[24:27],v[64:67],a[240:247],v2
ds_read_b128 v[80:83],v21 offset:14336
v_smfmac_f32_16x16x64_bf16 v[28:31],v[64:67],a[248:255],v2
ds_read_b128 v[84:87],v21 offset:15360
v_smfmac_f32_16x16x64_bf16 v[32:35],v[64:67],v[112:119],v2
v_smfmac_f32_16x16x64_bf16 v[36:39],v[64:67],v[120:127],v2
v_smfmac_f32_16x16x64_bf16 v[40:43],v[64:67],v[128:135],v2
s_waitcnt lgkmcnt(3)
v_smfmac_f32_16x16x64_bf16 v[44:47],v[64:67],v[72:79],v2
ds_read_b128 v[64:67],v59 offset:1024
v_smfmac_f32_16x16x64_bf16 v[24:27],v[68:71],v[136:143],v2
ds_read_b128 v[72:75],v21 offset:16384
v_smfmac_f32_16x16x64_bf16 v[28:31],v[68:71],v[144:151],v2
ds_read_b128 v[76:79],v21 offset:17408
v_smfmac_f32_16x16x64_bf16 v[32:35],v[68:71],v[152:159],v2
v_smfmac_f32_16x16x64_bf16 v[36:39],v[68:71],v[160:167],v2
v_smfmac_f32_16x16x64_bf16 v[40:43],v[68:71],v[168:175],v2
s_waitcnt lgkmcnt(3)
v_smfmac_f32_16x16x64_bf16 v[44:47],v[68:71],v[80:87],v2
ds_read_b128 v[80:83],v21 offset:18432
v_smfmac_f32_16x16x64_bf16 v[24:27],v[60:63],v[176:183],v2
ds_read_b128 v[84:87],v21 offset:19456
v_smfmac_f32_16x16x64_bf16 v[28:31],v[60:63],v[184:191],v2
s_waitcnt lgkmcnt(4)
v_smfmac_f32_16x16x64_bf16 v[24:27],v[64:67],v[216:223],v2
v_smfmac_f32_16x16x64_bf16 v[28:31],v[64:67],v[224:231],v2
v_smfmac_f32_16x16x64_bf16 v[32:35],v[60:63],v[192:199],v2
v_smfmac_f32_16x16x64_bf16 v[36:39],v[60:63],v[200:207],v2
v_add_f32 v24,v24,v25
v_smfmac_f32_16x16x64_bf16 v[32:35],v[64:67],v[232:239],v2
v_add_f32 v26,v26,v27
v_smfmac_f32_16x16x64_bf16 v[36:39],v[64:67],v[240:247],v2
v_add_f32 v28,v28,v29
v_smfmac_f32_16x16x64_bf16 v[40:43],v[60:63],v[208:215],v2
v_add_f32 v30,v30,v31
s_waitcnt lgkmcnt(2)
v_smfmac_f32_16x16x64_bf16 v[44:47],v[60:63],v[72:79],v2
v_cvt_pk_bf16_f32 v100,v24,v26
v_smfmac_f32_16x16x64_bf16 v[40:43],v[64:67],v[248:255],v2
v_cvt_pk_bf16_f32 v101,v28,v30
s_waitcnt lgkmcnt(0)
v_smfmac_f32_16x16x64_bf16 v[44:47],v[64:67],v[80:87],v2
v_and_or_b32 v100,v100,-2,s57
buffer_store_dwordx2 v[100:101],v7,s[8:11],s71 offen sc1
v_add_f32 v32,v32,v33
v_add_f32 v34,v34,v35
v_add_f32 v36,v36,v37
v_add_f32 v38,v38,v39
v_cvt_pk_bf16_f32 v102,v32,v34
v_cvt_pk_bf16_f32 v103,v36,v38
v_and_or_b32 v102,v102,-2,s57
v_add_f32 v40,v40,v41
v_add_f32 v42,v42,v43
v_add_f32 v44,v44,v45
v_add_f32 v46,v46,v47
v_cvt_pk_bf16_f32 v104,v40,v42
v_cvt_pk_bf16_f32 v105,v44,v46
v_and_or_b32 v104,v104,-2,s57
buffer_store_dwordx4 v[102:105],v6,s[8:11],s71 offen sc1
s_and_b32 s60,s52,15
s_lshl4_add_u32 s60,s51,s60
s_mul_i32 s78,s60,196608
s_add_u32 s78,s78,s85
s_bfe_u32 s28,s52,0x10004
v_and_or_b32 v100,v100,-2,s28
v_and_or_b32 v104,v104,-2,s28
s_sub_u32 s60,s4,s5
s_cmp_gt_i32 s60,13
s_cselect_b32 s53,1,0
s_cmp_eq_u32 s4,64
s_cselect_b32 s53,1,s53
s_cmp_eq_u32 s53,0
s_cselect_b32 s54,s4,s5
s_addc_u32 s4,s4,0
s_add_u32 s5,s5,s53
s_and_b32 s60,s54,1
s_lshl2_add_u32 s60,s53,s60
s_lshl_b32 s68,s60,16
s_add_u32 s68,s68,s83
s_mul_i32 s59,s60,20480
s_add_u32 s59,s59,s6
s_lshl_b32 s69,s53,9
s_add_u32 s69,s69,s7
s_bfe_u32 s31,s54,65537
s_add_u32 s32,s54,1
s_cmp_lg_u32 s53,s51
s_cbranch_scc1 nx_170
s_waitcnt vmcnt(0)
s_cmp_ge_u32 s79,2147483648
s_cbranch_scc1 pf_171
v_mov_b32 v17,1
s_mov_b64 exec,1
buffer_store_dword v17,v1,s[8:11],s79 offen sc1
s_mov_b64 exec,-1
s_mov_b32 s79,2147483648
pf_171:
s_cmp_eq_u32 s78,2147483648
s_cbranch_scc1 pk_172
buffer_store_dwordx4 v[100:103],v1,s[8:11],s78 offen offset:1536 sc1
buffer_store_dwordx2 v[104:105],v8,s[8:11],s78 offen offset:2560 sc1
s_mov_b32 s79,s30
s_mov_b32 s78,2147483648
pk_172:
s_waitcnt vmcnt(0)
s_cmp_ge_u32 s79,2147483648
s_cbranch_scc1 pf_173
v_mov_b32 v17,1
s_mov_b64 exec,1
buffer_store_dword v17,v1,s[8:11],s79 offen sc1
s_mov_b64 exec,-1
s_mov_b32 s79,2147483648
pf_173:
nx_170:
s_add_u32 s50,s50,1
s_mov_b32 s51,s53
s_mov_b32 s52,s54
s_mov_b32 s57,s31
s_mov_b32 s58,s32
s_cmp_lt_u32 s50,128
s_cbranch_scc1 CV_LOOP_S1
s_branch CV_DONE
fr_167:
v_bitop3_b32 v12,v60,v64,s57 bitop3:0x7e
v_bitop3_b32 v13,v68,v68,s57 bitop3:0x7e
v_xor_b32 v14,s57,v68
v_or3_b32 v12,v12,v13,v14
v_and_b32 v12,1,v12
v_cmp_ne_u32 vcc,0,v12
s_cbranch_vccz sk_174
buffer_load_dwordx2 v[68:69],v18,s[8:11],s59 offen sc1
buffer_load_dwordx4 v[60:63],v1,s[8:11],s59 offen sc1
buffer_load_dwordx4 v[64:67],v1,s[8:11],s59 offen offset:1024 sc1
sk_174:
buffer_load_dwordx2 v[78:79],v18,s[8:11],s68 offen sc1
buffer_load_dwordx4 v[70:73],v1,s[8:11],s68 offen sc1
buffer_load_dwordx4 v[74:77],v1,s[8:11],s68 offen offset:1024 sc1
s_sub_u32 s47,s47,1
s_cbranch_scc1 ABORT
s_waitcnt lgkmcnt(0)
s_branch fa_166
ec_169r:
buffer_load_dwordx2 v[78:79],v18,s[8:11],s68 offen sc1
buffer_load_dwordx4 v[70:73],v1,s[8:11],s68 offen sc1
buffer_load_dwordx4 v[74:77],v1,s[8:11],s68 offen offset:1024 sc1
v_and_b32 v17,1,v16
v_cmp_ne_u32 vcc,0,v17
s_nop 0
s_cbranch_vccnz fr_167
v_lshlrev_b32 v80,16,v60
v_and_b32 v81,0xffff0000,v60
v_lshlrev_b32 v82,16,v61
v_and_b32 v83,0xffff0000,v61
v_lshlrev_b32 v84,16,v62
v_and_b32 v85,0xffff0000,v62
v_lshlrev_b32 v86,16,v63
v_and_b32 v87,0xffff0000,v63
v_lshlrev_b32 v96,16,v68
v_and_b32 v97,0xffff0000,v68
v_lshlrev_b32 v98,16,v69
v_and_b32 v99,0xffff0000,v69
s_sub_u32 s47,s47,1
s_cbranch_scc1 ABORT
s_branch ec_169
CV_DONE:
s_add_u32 s61,s48,32
s_endpgm
ROLE_CW:
s_lshr_b32 s28,s48,3
s_and_b32 s29,s48,7
s_mul_i32 s82,s28,2097152
s_add_u32 s82,s82,2097152
v_lshlrev_b32 v1,4,v0
v_and_b32 v12,1,v0
v_mul_u32_u24 v2,0xaaaa,v12
v_or_b32 v2,0x4444,v2
v_lshrrev_b32 v14,4,v0
v_and_b32 v15,15,v0
v_min_u32 v3,11,v15
v_lshlrev_b32 v3,2,v3
v_lshl_add_u32 v3,v14,7,v3
s_mul_i32 s60,s46,24576
v_add_u32 v4,s60,v1
v_mul_u32_u24 v5,704,v14
v_and_b32 v12,3,v15
v_lshl_add_u32 v5,v12,2,v5
v_bfe_u32 v12,v15,2,1
v_lshl_add_u32 v5,v12,5,v5
v_bfe_u32 v12,v15,3,1
v_lshl_add_u32 v5,v12,4,v5
s_mul_i32 s60,s46,2816
s_add_u32 s60,s60,98304
v_add_u32 v5,s60,v5
s_mul_i32 s60,s46,24
s_min_u32 s60,s60,64
s_cmp_lt_u32 s46,2
s_cselect_b32 s61,23,15
s_mov_b32 s88,0xffff
s_cselect_b32 s88,0xffffff,s88
s_mov_b32 s89,0
v_and_b32 v12,31,v0
v_min_u32 v12,s61,v12
v_add_u32 v12,s60,v12
v_lshrrev_b32 v13,5,v0
v_lshl_add_u32 v12,v12,1,v13
v_bfe_u32 v13,v12,2,3
v_mul_u32_u24 v6,352,v13
v_mul_u32_u24 v17,1280,v13
v_lshrrev_b32 v13,5,v12
v_lshl_add_u32 v6,v13,6,v6
v_lshl_add_u32 v17,v13,5,v17
v_and_b32 v13,3,v12
v_lshl_add_u32 v17,v13,3,v17
v_and_b32 v13,1,v12
v_lshl_add_u32 v6,v13,5,v6
v_bfe_u32 v13,v12,1,1
v_lshl_add_u32 v6,v13,4,v6
v_add_u32 v6,98304,v6
s_mul_i32 s60,s29,1280
v_lshlrev_b32 v9,3,v12
v_add_u32 v9,s60,v9
v_lshrrev_b32 v13,13,v9
v_lshl_add_u32 v9,v13,13,v9
v_xor_b32 v10,1,v12
v_or_b32 v10,v10,v13
v_and_b32 v10,1,v10
s_mov_b32 s4,s18
s_mov_b32 s5,s19
s_mov_b32 s6,10240
s_mov_b32 s7,0x20000
s_mul_i32 s60,s29,160
buffer_load_dwordx2 v[32:33],v17,s[4:7],s60 offen
s_mul_i32 s84,s29,0
s_add_u32 s84,s84,s82
s_lshl_b32 s83,s28,19
s_lshr_b32 s60,s29,1
s_and_b32 s61,s29,1
s_mul_i32 s62,s61,0
s_add_u32 s83,s83,s62
s_add_u32 s83,s83,10485760
s_lshl_b32 s85,s60,7
s_lshl_b32 s61,s61,2
s_add_u32 s61,s61,s46
s_lshl_b32 s61,s61,2
s_add_u32 s85,s85,s61
s_add_u32 s85,s85,s82
s_add_u32 s85,s85,950272
s_mul_i32 s33,s46,12288
s_add_u32 s33,s33,s82
s_add_u32 s33,s33,163840
s_mov_b32 s35,0
s_add_u32 s35,s35,s82
s_add_u32 s35,s35,951296
s_cmp_eq_u32 s28,0
s_cselect_b32 s63,0xffff0000,0
s_waitcnt vmcnt(0)
s_cselect_b64 vcc,-1,0
v_bfi_b32 v36,v10,0,v32
v_lshlrev_b32 v34,16,v32
v_lshlrev_b32 v35,16,v36
v_sub_f32 v34,v34,v35
v_lshrrev_b32 v34,16,v34
v_and_b32 v34,-2,v34
v_cndmask_b32 v36,v34,v36,vcc
v_cndmask_b32 v37,0,v33,vcc
s_nop 0
v_permlane32_swap_b32 v36,v38
v_permlane32_swap_b32 v37,v39
v_mov_b32 v40,-1
v_mov_b32 v41,-1
v_mov_b32 v42,-1
v_mov_b32 v43,-1
v_mov_b32 v44,1
s_mov_b64 exec,s[88:89]
s_add_u32 s60,s83,0
buffer_store_dwordx4 v[36:39],v9,s[8:11],s60 offen sc1
s_add_u32 s60,s83,8192
buffer_store_dwordx4 v[36:39],v9,s[8:11],s60 offen sc1
s_add_u32 s60,s83,65536
buffer_store_dwordx4 v[40:43],v9,s[8:11],s60 offen sc1
s_add_u32 s60,s83,73728
buffer_store_dwordx4 v[40:43],v9,s[8:11],s60 offen sc1
s_add_u32 s60,s83,131072
buffer_store_dwordx4 v[40:43],v9,s[8:11],s60 offen sc1
s_add_u32 s60,s83,139264
buffer_store_dwordx4 v[40:43],v9,s[8:11],s60 offen sc1
s_add_u32 s60,s83,196608
buffer_store_dwordx4 v[40:43],v9,s[8:11],s60 offen sc1
s_add_u32 s60,s83,204800
buffer_store_dwordx4 v[40:43],v9,s[8:11],s60 offen sc1
s_add_u32 s60,s83,262144
buffer_store_dwordx4 v[36:39],v9,s[8:11],s60 offen sc1
s_add_u32 s60,s83,270336
buffer_store_dwordx4 v[36:39],v9,s[8:11],s60 offen sc1
s_add_u32 s60,s83,327680
buffer_store_dwordx4 v[40:43],v9,s[8:11],s60 offen sc1
s_add_u32 s60,s83,335872
buffer_store_dwordx4 v[40:43],v9,s[8:11],s60 offen sc1
s_add_u32 s60,s83,393216
buffer_store_dwordx4 v[40:43],v9,s[8:11],s60 offen sc1
s_add_u32 s60,s83,401408
buffer_store_dwordx4 v[40:43],v9,s[8:11],s60 offen sc1
s_add_u32 s60,s83,458752
buffer_store_dwordx4 v[40:43],v9,s[8:11],s60 offen sc1
s_add_u32 s60,s83,466944
buffer_store_dwordx4 v[40:43],v9,s[8:11],s60 offen sc1
s_cmp_lg_u32 s49,0
s_cbranch_scc1 ls_175
s_add_u32 s60,s84,0
buffer_store_dwordx4 v[36:39],v9,s[8:11],s60 offen
s_add_u32 s60,s84,20480
buffer_store_dwordx4 v[40:43],v9,s[8:11],s60 offen
s_add_u32 s60,s84,40960
buffer_store_dwordx4 v[40:43],v9,s[8:11],s60 offen
s_add_u32 s60,s84,61440
buffer_store_dwordx4 v[40:43],v9,s[8:11],s60 offen
s_add_u32 s60,s84,81920
buffer_store_dwordx4 v[36:39],v9,s[8:11],s60 offen
s_add_u32 s60,s84,102400
buffer_store_dwordx4 v[40:43],v9,s[8:11],s60 offen
s_add_u32 s60,s84,122880
buffer_store_dwordx4 v[40:43],v9,s[8:11],s60 offen
s_add_u32 s60,s84,143360
buffer_store_dwordx4 v[40:43],v9,s[8:11],s60 offen
s_mov_b64 exec,1
buffer_store_dword v44,v1,s[8:11],s85 offen
buffer_store_dword v44,v1,s[8:11],s85 offen offset:512
s_branch ls_176
ls_175:
s_add_u32 s60,s84,0
buffer_store_dwordx4 v[36:39],v9,s[8:11],s60 offen sc1
s_add_u32 s60,s84,20480
buffer_store_dwordx4 v[40:43],v9,s[8:11],s60 offen sc1
s_add_u32 s60,s84,40960
buffer_store_dwordx4 v[40:43],v9,s[8:11],s60 offen sc1
s_add_u32 s60,s84,61440
buffer_store_dwordx4 v[40:43],v9,s[8:11],s60 offen sc1
s_add_u32 s60,s84,81920
buffer_store_dwordx4 v[36:39],v9,s[8:11],s60 offen sc1
s_add_u32 s60,s84,102400
buffer_store_dwordx4 v[40:43],v9,s[8:11],s60 offen sc1
s_add_u32 s60,s84,122880
buffer_store_dwordx4 v[40:43],v9,s[8:11],s60 offen sc1
s_add_u32 s60,s84,143360
buffer_store_dwordx4 v[40:43],v9,s[8:11],s60 offen sc1
s_mov_b64 exec,1
buffer_store_dword v44,v1,s[8:11],s85 offen sc1
buffer_store_dword v44,v1,s[8:11],s85 offen offset:512 sc1
ls_176:
s_mov_b64 exec,-1
s_waitcnt vmcnt(0)
s_barrier
s_cmp_lg_u32 s46,0
s_cbranch_scc1 arr_177
v_mov_b32 v12,1
s_lshl_b32 s3,s49,2
v_mov_b32 v13,s3
s_mov_b64 exec,1
buffer_atomic_add v12,v13,s[12:15],0 offen sc1
s_mov_b64 exec,-1
arr_177:
s_mov_b32 s4,s26
s_mov_b32 s5,s27
s_mov_b32 s6,7864320
s_mov_b32 s7,0x20000
s_lshl_b32 s60,s28,2
s_add_u32 s60,s60,s46
s_mul_i32 s73,s60,983040
s_mul_i32 s60,s29,160
s_add_u32 s73,s73,s60
s_mul_i32 s74,s46,40960
v_add_u32 v12,0,v0
v_mul_u32_u24 v13,6554,v12
v_lshrrev_b32 v13,16,v13
v_mul_u32_u24 v16,10,v13
v_sub_u32 v12,v12,v16
v_mul_u32_u24 v20,1280,v13
v_lshl_add_u32 v20,v12,4,v20
v_add_u32 v12,64,v0
v_mul_u32_u24 v13,6554,v12
v_lshrrev_b32 v13,16,v13
v_mul_u32_u24 v16,10,v13
v_sub_u32 v12,v12,v16
v_mul_u32_u24 v21,1280,v13
v_lshl_add_u32 v21,v12,4,v21
v_add_u32 v12,128,v0
v_mul_u32_u24 v13,6554,v12
v_lshrrev_b32 v13,16,v13
v_mul_u32_u24 v16,10,v13
v_sub_u32 v12,v12,v16
v_mul_u32_u24 v22,1280,v13
v_lshl_add_u32 v22,v12,4,v22
v_add_u32 v12,192,v0
v_mul_u32_u24 v13,6554,v12
v_lshrrev_b32 v13,16,v13
v_mul_u32_u24 v16,10,v13
v_sub_u32 v12,v12,v16
v_mul_u32_u24 v23,1280,v13
v_lshl_add_u32 v23,v12,4,v23
v_add_u32 v12,256,v0
v_mul_u32_u24 v13,6554,v12
v_lshrrev_b32 v13,16,v13
v_mul_u32_u24 v16,10,v13
v_sub_u32 v12,v12,v16
v_mul_u32_u24 v24,1280,v13
v_lshl_add_u32 v24,v12,4,v24
v_add_u32 v12,320,v0
v_mul_u32_u24 v13,6554,v12
v_lshrrev_b32 v13,16,v13
v_mul_u32_u24 v16,10,v13
v_sub_u32 v12,v12,v16
v_mul_u32_u24 v25,1280,v13
v_lshl_add_u32 v25,v12,4,v25
v_add_u32 v12,384,v0
v_mul_u32_u24 v13,6554,v12
v_lshrrev_b32 v13,16,v13
v_mul_u32_u24 v16,10,v13
v_sub_u32 v12,v12,v16
v_mul_u32_u24 v26,1280,v13
v_lshl_add_u32 v26,v12,4,v26
v_add_u32 v12,448,v0
v_mul_u32_u24 v13,6554,v12
v_lshrrev_b32 v13,16,v13
v_mul_u32_u24 v16,10,v13
v_sub_u32 v12,v12,v16
v_mul_u32_u24 v27,1280,v13
v_lshl_add_u32 v27,v12,4,v27
v_add_u32 v12,512,v0
v_mul_u32_u24 v13,6554,v12
v_lshrrev_b32 v13,16,v13
v_mul_u32_u24 v16,10,v13
v_sub_u32 v12,v12,v16
v_mul_u32_u24 v28,1280,v13
v_lshl_add_u32 v28,v12,4,v28
v_add_u32 v12,576,v0
v_mul_u32_u24 v13,6554,v12
v_lshrrev_b32 v13,16,v13
v_mul_u32_u24 v16,10,v13
v_sub_u32 v12,v12,v16
v_mul_u32_u24 v29,1280,v13
v_lshl_add_u32 v29,v12,4,v29
v_lshrrev_b32 v14,4,v0
v_and_b32 v12,1,v14
v_lshlrev_b32 v12,5,v12
v_lshrrev_b32 v13,1,v14
v_lshl_add_u32 v12,v13,2,v12
v_bfe_u32 v13,v0,2,1
v_add_u32 v12,v12,v13
v_bfe_u32 v13,v0,3,1
v_lshl_add_u32 v12,v13,4,v12
v_mul_u32_u24 v30,160,v12
v_and_b32 v13,3,v0
v_lshl_add_u32 v30,v13,3,v30
v_add_u32 v30,s74,v30
s_add_u32 s61,s73,0
s_add_u32 m0,s74,0
s_nop 0
buffer_load_dwordx4 v20,s[4:7],s61 offen lds
s_add_u32 m0,s74,1024
s_nop 0
buffer_load_dwordx4 v21,s[4:7],s61 offen lds
s_add_u32 m0,s74,2048
s_nop 0
buffer_load_dwordx4 v22,s[4:7],s61 offen lds
s_add_u32 m0,s74,3072
s_nop 0
buffer_load_dwordx4 v23,s[4:7],s61 offen lds
s_add_u32 m0,s74,4096
s_nop 0
buffer_load_dwordx4 v24,s[4:7],s61 offen lds
s_add_u32 m0,s74,5120
s_nop 0
buffer_load_dwordx4 v25,s[4:7],s61 offen lds
s_add_u32 m0,s74,6144
s_nop 0
buffer_load_dwordx4 v26,s[4:7],s61 offen lds
s_add_u32 m0,s74,7168
s_nop 0
buffer_load_dwordx4 v27,s[4:7],s61 offen lds
s_add_u32 m0,s74,8192
s_nop 0
buffer_load_dwordx4 v28,s[4:7],s61 offen lds
s_add_u32 m0,s74,9216
s_nop 0
buffer_load_dwordx4 v29,s[4:7],s61 offen lds
s_add_u32 s61,s73,81920
s_add_u32 m0,s74,10240
s_nop 0
buffer_load_dwordx4 v20,s[4:7],s61 offen lds
s_add_u32 m0,s74,11264
s_nop 0
buffer_load_dwordx4 v21,s[4:7],s61 offen lds
s_add_u32 m0,s74,12288
s_nop 0
buffer_load_dwordx4 v22,s[4:7],s61 offen lds
s_add_u32 m0,s74,13312
s_nop 0
buffer_load_dwordx4 v23,s[4:7],s61 offen lds
s_add_u32 m0,s74,14336
s_nop 0
buffer_load_dwordx4 v24,s[4:7],s61 offen lds
s_add_u32 m0,s74,15360
s_nop 0
buffer_load_dwordx4 v25,s[4:7],s61 offen lds
s_add_u32 m0,s74,16384
s_nop 0
buffer_load_dwordx4 v26,s[4:7],s61 offen lds
s_add_u32 m0,s74,17408
s_nop 0
buffer_load_dwordx4 v27,s[4:7],s61 offen lds
s_add_u32 m0,s74,18432
s_nop 0
buffer_load_dwordx4 v28,s[4:7],s61 offen lds
s_add_u32 m0,s74,19456
s_nop 0
buffer_load_dwordx4 v29,s[4:7],s61 offen lds
s_add_u32 s61,s73,163840
s_add_u32 m0,s74,20480
s_nop 0
buffer_load_dwordx4 v20,s[4:7],s61 offen lds
s_add_u32 m0,s74,21504
s_nop 0
buffer_load_dwordx4 v21,s[4:7],s61 offen lds
s_add_u32 m0,s74,22528
s_nop 0
buffer_load_dwordx4 v22,s[4:7],s61 offen lds
s_add_u32 m0,s74,23552
s_nop 0
buffer_load_dwordx4 v23,s[4:7],s61 offen lds
s_add_u32 m0,s74,24576
s_nop 0
buffer_load_dwordx4 v24,s[4:7],s61 offen lds
s_add_u32 m0,s74,25600
s_nop 0
buffer_load_dwordx4 v25,s[4:7],s61 offen lds
s_add_u32 m0,s74,26624
s_nop 0
buffer_load_dwordx4 v26,s[4:7],s61 offen lds
s_add_u32 m0,s74,27648
s_nop 0
buffer_load_dwordx4 v27,s[4:7],s61 offen lds
s_add_u32 m0,s74,28672
s_nop 0
buffer_load_dwordx4 v28,s[4:7],s61 offen lds
s_add_u32 m0,s74,29696
s_nop 0
buffer_load_dwordx4 v29,s[4:7],s61 offen lds
s_add_u32 s61,s73,245760
s_add_u32 m0,s74,30720
s_nop 0
buffer_load_dwordx4 v20,s[4:7],s61 offen lds
s_add_u32 m0,s74,31744
s_nop 0
buffer_load_dwordx4 v21,s[4:7],s61 offen lds
s_add_u32 m0,s74,32768
s_nop 0
buffer_load_dwordx4 v22,s[4:7],s61 offen lds
s_add_u32 m0,s74,33792
s_nop 0
buffer_load_dwordx4 v23,s[4:7],s61 offen lds
s_add_u32 m0,s74,34816
s_nop 0
buffer_load_dwordx4 v24,s[4:7],s61 offen lds
s_add_u32 m0,s74,35840
s_nop 0
buffer_load_dwordx4 v25,s[4:7],s61 offen lds
s_add_u32 m0,s74,36864
s_nop 0
buffer_load_dwordx4 v26,s[4:7],s61 offen lds
s_add_u32 m0,s74,37888
s_nop 0
buffer_load_dwordx4 v27,s[4:7],s61 offen lds
s_add_u32 m0,s74,38912
s_nop 0
buffer_load_dwordx4 v28,s[4:7],s61 offen lds
s_add_u32 m0,s74,39936
s_nop 0
buffer_load_dwordx4 v29,s[4:7],s61 offen lds
s_waitcnt vmcnt(30)
ds_read_b64_tr_b16 a[0:1],v30 offset:0
ds_read_b64_tr_b16 a[2:3],v30 offset:320
ds_read_b64_tr_b16 a[4:5],v30 offset:1280
ds_read_b64_tr_b16 a[6:7],v30 offset:1600
ds_read_b64_tr_b16 a[8:9],v30 offset:32
ds_read_b64_tr_b16 a[10:11],v30 offset:352
ds_read_b64_tr_b16 a[12:13],v30 offset:1312
ds_read_b64_tr_b16 a[14:15],v30 offset:1632
ds_read_b64_tr_b16 a[16:17],v30 offset:64
ds_read_b64_tr_b16 a[18:19],v30 offset:384
ds_read_b64_tr_b16 a[20:21],v30 offset:1344
ds_read_b64_tr_b16 a[22:23],v30 offset:1664
s_waitcnt lgkmcnt(4)
ds_read_b64_tr_b16 a[24:25],v30 offset:96
ds_read_b64_tr_b16 a[26:27],v30 offset:416
ds_read_b64_tr_b16 a[28:29],v30 offset:1376
ds_read_b64_tr_b16 a[30:31],v30 offset:1696
ds_read_b64_tr_b16 v[32:33],v30 offset:128
ds_read_b64_tr_b16 v[34:35],v30 offset:448
ds_read_b64_tr_b16 v[36:37],v30 offset:1408
ds_read_b64_tr_b16 v[38:39],v30 offset:1728
s_waitcnt lgkmcnt(0)
s_add_u32 s61,s73,327680
s_add_u32 m0,s74,0
s_nop 0
buffer_load_dwordx4 v20,s[4:7],s61 offen lds
s_add_u32 m0,s74,1024
s_nop 0
buffer_load_dwordx4 v21,s[4:7],s61 offen lds
s_add_u32 m0,s74,2048
s_nop 0
buffer_load_dwordx4 v22,s[4:7],s61 offen lds
s_add_u32 m0,s74,3072
s_nop 0
buffer_load_dwordx4 v23,s[4:7],s61 offen lds
s_add_u32 m0,s74,4096
s_nop 0
buffer_load_dwordx4 v24,s[4:7],s61 offen lds
s_add_u32 m0,s74,5120
s_nop 0
buffer_load_dwordx4 v25,s[4:7],s61 offen lds
s_add_u32 m0,s74,6144
s_nop 0
buffer_load_dwordx4 v26,s[4:7],s61 offen lds
s_add_u32 m0,s74,7168
s_nop 0
buffer_load_dwordx4 v27,s[4:7],s61 offen lds
s_add_u32 m0,s74,8192
s_nop 0
buffer_load_dwordx4 v28,s[4:7],s61 offen lds
s_add_u32 m0,s74,9216
s_nop 0
buffer_load_dwordx4 v29,s[4:7],s61 offen lds
s_waitcnt vmcnt(30)
ds_read_b64_tr_b16 a[32:33],v30 offset:10240
ds_read_b64_tr_b16 a[34:35],v30 offset:10560
ds_read_b64_tr_b16 a[36:37],v30 offset:11520
ds_read_b64_tr_b16 a[38:39],v30 offset:11840
ds_read_b64_tr_b16 a[40:41],v30 offset:10272
ds_read_b64_tr_b16 a[42:43],v30 offset:10592
ds_read_b64_tr_b16 a[44:45],v30 offset:11552
ds_read_b64_tr_b16 a[46:47],v30 offset:11872
ds_read_b64_tr_b16 a[48:49],v30 offset:10304
ds_read_b64_tr_b16 a[50:51],v30 offset:10624
ds_read_b64_tr_b16 a[52:53],v30 offset:11584
ds_read_b64_tr_b16 a[54:55],v30 offset:11904
s_waitcnt lgkmcnt(4)
ds_read_b64_tr_b16 a[56:57],v30 offset:10336
ds_read_b64_tr_b16 a[58:59],v30 offset:10656
ds_read_b64_tr_b16 a[60:61],v30 offset:11616
ds_read_b64_tr_b16 a[62:63],v30 offset:11936
ds_read_b64_tr_b16 v[40:41],v30 offset:10368
ds_read_b64_tr_b16 v[42:43],v30 offset:10688
ds_read_b64_tr_b16 v[44:45],v30 offset:11648
ds_read_b64_tr_b16 v[46:47],v30 offset:11968
s_waitcnt lgkmcnt(0)
s_add_u32 s61,s73,409600
s_add_u32 m0,s74,10240
s_nop 0
buffer_load_dwordx4 v20,s[4:7],s61 offen lds
s_add_u32 m0,s74,11264
s_nop 0
buffer_load_dwordx4 v21,s[4:7],s61 offen lds
s_add_u32 m0,s74,12288
s_nop 0
buffer_load_dwordx4 v22,s[4:7],s61 offen lds
s_add_u32 m0,s74,13312
s_nop 0
buffer_load_dwordx4 v23,s[4:7],s61 offen lds
s_add_u32 m0,s74,14336
s_nop 0
buffer_load_dwordx4 v24,s[4:7],s61 offen lds
s_add_u32 m0,s74,15360
s_nop 0
buffer_load_dwordx4 v25,s[4:7],s61 offen lds
s_add_u32 m0,s74,16384
s_nop 0
buffer_load_dwordx4 v26,s[4:7],s61 offen lds
s_add_u32 m0,s74,17408
s_nop 0
buffer_load_dwordx4 v27,s[4:7],s61 offen lds
s_add_u32 m0,s74,18432
s_nop 0
buffer_load_dwordx4 v28,s[4:7],s61 offen lds
s_add_u32 m0,s74,19456
s_nop 0
buffer_load_dwordx4 v29,s[4:7],s61 offen lds
s_waitcnt vmcnt(30)
ds_read_b64_tr_b16 a[64:65],v30 offset:20480
ds_read_b64_tr_b16 a[66:67],v30 offset:20800
ds_read_b64_tr_b16 a[68:69],v30 offset:21760
ds_read_b64_tr_b16 a[70:71],v30 offset:22080
ds_read_b64_tr_b16 a[72:73],v30 offset:20512
ds_read_b64_tr_b16 a[74:75],v30 offset:20832
ds_read_b64_tr_b16 a[76:77],v30 offset:21792
ds_read_b64_tr_b16 a[78:79],v30 offset:22112
ds_read_b64_tr_b16 a[80:81],v30 offset:20544
ds_read_b64_tr_b16 a[82:83],v30 offset:20864
ds_read_b64_tr_b16 a[84:85],v30 offset:21824
ds_read_b64_tr_b16 a[86:87],v30 offset:22144
s_waitcnt lgkmcnt(4)
ds_read_b64_tr_b16 a[88:89],v30 offset:20576
ds_read_b64_tr_b16 a[90:91],v30 offset:20896
ds_read_b64_tr_b16 a[92:93],v30 offset:21856
ds_read_b64_tr_b16 a[94:95],v30 offset:22176
ds_read_b64_tr_b16 v[48:49],v30 offset:20608
ds_read_b64_tr_b16 v[50:51],v30 offset:20928
ds_read_b64_tr_b16 v[52:53],v30 offset:21888
ds_read_b64_tr_b16 v[54:55],v30 offset:22208
s_waitcnt lgkmcnt(0)
s_add_u32 s61,s73,491520
s_add_u32 m0,s74,20480
s_nop 0
buffer_load_dwordx4 v20,s[4:7],s61 offen lds
s_add_u32 m0,s74,21504
s_nop 0
buffer_load_dwordx4 v21,s[4:7],s61 offen lds
s_add_u32 m0,s74,22528
s_nop 0
buffer_load_dwordx4 v22,s[4:7],s61 offen lds
s_add_u32 m0,s74,23552
s_nop 0
buffer_load_dwordx4 v23,s[4:7],s61 offen lds
s_add_u32 m0,s74,24576
s_nop 0
buffer_load_dwordx4 v24,s[4:7],s61 offen lds
s_add_u32 m0,s74,25600
s_nop 0
buffer_load_dwordx4 v25,s[4:7],s61 offen lds
s_add_u32 m0,s74,26624
s_nop 0
buffer_load_dwordx4 v26,s[4:7],s61 offen lds
s_add_u32 m0,s74,27648
s_nop 0
buffer_load_dwordx4 v27,s[4:7],s61 offen lds
s_add_u32 m0,s74,28672
s_nop 0
buffer_load_dwordx4 v28,s[4:7],s61 offen lds
s_add_u32 m0,s74,29696
s_nop 0
buffer_load_dwordx4 v29,s[4:7],s61 offen lds
s_waitcnt vmcnt(30)
ds_read_b64_tr_b16 a[96:97],v30 offset:30720
ds_read_b64_tr_b16 a[98:99],v30 offset:31040
ds_read_b64_tr_b16 a[100:101],v30 offset:32000
ds_read_b64_tr_b16 a[102:103],v30 offset:32320
ds_read_b64_tr_b16 a[104:105],v30 offset:30752
ds_read_b64_tr_b16 a[106:107],v30 offset:31072
ds_read_b64_tr_b16 a[108:109],v30 offset:32032
ds_read_b64_tr_b16 a[110:111],v30 offset:32352
ds_read_b64_tr_b16 a[112:113],v30 offset:30784
ds_read_b64_tr_b16 a[114:115],v30 offset:31104
ds_read_b64_tr_b16 a[116:117],v30 offset:32064
ds_read_b64_tr_b16 a[118:119],v30 offset:32384
s_waitcnt lgkmcnt(4)
ds_read_b64_tr_b16 a[120:121],v30 offset:30816
ds_read_b64_tr_b16 a[122:123],v30 offset:31136
ds_read_b64_tr_b16 a[124:125],v30 offset:32096
ds_read_b64_tr_b16 a[126:127],v30 offset:32416
ds_read_b64_tr_b16 v[56:57],v30 offset:30848
ds_read_b64_tr_b16 v[58:59],v30 offset:31168
ds_read_b64_tr_b16 v[60:61],v30 offset:32128
ds_read_b64_tr_b16 v[62:63],v30 offset:32448
s_waitcnt lgkmcnt(0)
s_add_u32 s61,s73,573440
s_add_u32 m0,s74,30720
s_nop 0
buffer_load_dwordx4 v20,s[4:7],s61 offen lds
s_add_u32 m0,s74,31744
s_nop 0
buffer_load_dwordx4 v21,s[4:7],s61 offen lds
s_add_u32 m0,s74,32768
s_nop 0
buffer_load_dwordx4 v22,s[4:7],s61 offen lds
s_add_u32 m0,s74,33792
s_nop 0
buffer_load_dwordx4 v23,s[4:7],s61 offen lds
s_add_u32 m0,s74,34816
s_nop 0
buffer_load_dwordx4 v24,s[4:7],s61 offen lds
s_add_u32 m0,s74,35840
s_nop 0
buffer_load_dwordx4 v25,s[4:7],s61 offen lds
s_add_u32 m0,s74,36864
s_nop 0
buffer_load_dwordx4 v26,s[4:7],s61 offen lds
s_add_u32 m0,s74,37888
s_nop 0
buffer_load_dwordx4 v27,s[4:7],s61 offen lds
s_add_u32 m0,s74,38912
s_nop 0
buffer_load_dwordx4 v28,s[4:7],s61 offen lds
s_add_u32 m0,s74,39936
s_nop 0
buffer_load_dwordx4 v29,s[4:7],s61 offen lds
s_waitcnt vmcnt(30)
ds_read_b64_tr_b16 a[128:129],v30 offset:0
ds_read_b64_tr_b16 a[130:131],v30 offset:320
ds_read_b64_tr_b16 a[132:133],v30 offset:1280
ds_read_b64_tr_b16 a[134:135],v30 offset:1600
ds_read_b64_tr_b16 a[136:137],v30 offset:32
ds_read_b64_tr_b16 a[138:139],v30 offset:352
ds_read_b64_tr_b16 a[140:141],v30 offset:1312
ds_read_b64_tr_b16 a[142:143],v30 offset:1632
ds_read_b64_tr_b16 a[144:145],v30 offset:64
ds_read_b64_tr_b16 a[146:147],v30 offset:384
ds_read_b64_tr_b16 a[148:149],v30 offset:1344
ds_read_b64_tr_b16 a[150:151],v30 offset:1664
s_waitcnt lgkmcnt(4)
ds_read_b64_tr_b16 a[152:153],v30 offset:96
ds_read_b64_tr_b16 a[154:155],v30 offset:416
ds_read_b64_tr_b16 a[156:157],v30 offset:1376
ds_read_b64_tr_b16 a[158:159],v30 offset:1696
ds_read_b64_tr_b16 v[64:65],v30 offset:128
ds_read_b64_tr_b16 v[66:67],v30 offset:448
ds_read_b64_tr_b16 v[68:69],v30 offset:1408
ds_read_b64_tr_b16 v[70:71],v30 offset:1728
s_waitcnt lgkmcnt(0)
s_add_u32 s61,s73,655360
s_add_u32 m0,s74,0
s_nop 0
buffer_load_dwordx4 v20,s[4:7],s61 offen lds
s_add_u32 m0,s74,1024
s_nop 0
buffer_load_dwordx4 v21,s[4:7],s61 offen lds
s_add_u32 m0,s74,2048
s_nop 0
buffer_load_dwordx4 v22,s[4:7],s61 offen lds
s_add_u32 m0,s74,3072
s_nop 0
buffer_load_dwordx4 v23,s[4:7],s61 offen lds
s_add_u32 m0,s74,4096
s_nop 0
buffer_load_dwordx4 v24,s[4:7],s61 offen lds
s_add_u32 m0,s74,5120
s_nop 0
buffer_load_dwordx4 v25,s[4:7],s61 offen lds
s_add_u32 m0,s74,6144
s_nop 0
buffer_load_dwordx4 v26,s[4:7],s61 offen lds
s_add_u32 m0,s74,7168
s_nop 0
buffer_load_dwordx4 v27,s[4:7],s61 offen lds
s_add_u32 m0,s74,8192
s_nop 0
buffer_load_dwordx4 v28,s[4:7],s61 offen lds
s_add_u32 m0,s74,9216
s_nop 0
buffer_load_dwordx4 v29,s[4:7],s61 offen lds
s_waitcnt vmcnt(30)
ds_read_b64_tr_b16 a[160:161],v30 offset:10240
ds_read_b64_tr_b16 a[162:163],v30 offset:10560
ds_read_b64_tr_b16 a[164:165],v30 offset:11520
ds_read_b64_tr_b16 a[166:167],v30 offset:11840
ds_read_b64_tr_b16 a[168:169],v30 offset:10272
ds_read_b64_tr_b16 a[170:171],v30 offset:10592
ds_read_b64_tr_b16 a[172:173],v30 offset:11552
ds_read_b64_tr_b16 a[174:175],v30 offset:11872
ds_read_b64_tr_b16 a[176:177],v30 offset:10304
ds_read_b64_tr_b16 a[178:179],v30 offset:10624
ds_read_b64_tr_b16 a[180:181],v30 offset:11584
ds_read_b64_tr_b16 a[182:183],v30 offset:11904
s_waitcnt lgkmcnt(4)
ds_read_b64_tr_b16 a[184:185],v30 offset:10336
ds_read_b64_tr_b16 a[186:187],v30 offset:10656
ds_read_b64_tr_b16 a[188:189],v30 offset:11616
ds_read_b64_tr_b16 a[190:191],v30 offset:11936
ds_read_b64_tr_b16 v[72:73],v30 offset:10368
ds_read_b64_tr_b16 v[74:75],v30 offset:10688
ds_read_b64_tr_b16 v[76:77],v30 offset:11648
ds_read_b64_tr_b16 v[78:79],v30 offset:11968
s_waitcnt lgkmcnt(0)
s_add_u32 s61,s73,737280
s_add_u32 m0,s74,10240
s_nop 0
buffer_load_dwordx4 v20,s[4:7],s61 offen lds
s_add_u32 m0,s74,11264
s_nop 0
buffer_load_dwordx4 v21,s[4:7],s61 offen lds
s_add_u32 m0,s74,12288
s_nop 0
buffer_load_dwordx4 v22,s[4:7],s61 offen lds
s_add_u32 m0,s74,13312
s_nop 0
buffer_load_dwordx4 v23,s[4:7],s61 offen lds
s_add_u32 m0,s74,14336
s_nop 0
buffer_load_dwordx4 v24,s[4:7],s61 offen lds
s_add_u32 m0,s74,15360
s_nop 0
buffer_load_dwordx4 v25,s[4:7],s61 offen lds
s_add_u32 m0,s74,16384
s_nop 0
buffer_load_dwordx4 v26,s[4:7],s61 offen lds
s_add_u32 m0,s74,17408
s_nop 0
buffer_load_dwordx4 v27,s[4:7],s61 offen lds
s_add_u32 m0,s74,18432
s_nop 0
buffer_load_dwordx4 v28,s[4:7],s61 offen lds
s_add_u32 m0,s74,19456
s_nop 0
buffer_load_dwordx4 v29,s[4:7],s61 offen lds
s_waitcnt vmcnt(30)
ds_read_b64_tr_b16 a[192:193],v30 offset:20480
ds_read_b64_tr_b16 a[194:195],v30 offset:20800
ds_read_b64_tr_b16 a[196:197],v30 offset:21760
ds_read_b64_tr_b16 a[198:199],v30 offset:22080
ds_read_b64_tr_b16 a[200:201],v30 offset:20512
ds_read_b64_tr_b16 a[202:203],v30 offset:20832
ds_read_b64_tr_b16 a[204:205],v30 offset:21792
ds_read_b64_tr_b16 a[206:207],v30 offset:22112
ds_read_b64_tr_b16 a[208:209],v30 offset:20544
ds_read_b64_tr_b16 a[210:211],v30 offset:20864
ds_read_b64_tr_b16 a[212:213],v30 offset:21824
ds_read_b64_tr_b16 a[214:215],v30 offset:22144
s_waitcnt lgkmcnt(4)
ds_read_b64_tr_b16 a[216:217],v30 offset:20576
ds_read_b64_tr_b16 a[218:219],v30 offset:20896
ds_read_b64_tr_b16 a[220:221],v30 offset:21856
ds_read_b64_tr_b16 a[222:223],v30 offset:22176
ds_read_b64_tr_b16 v[80:81],v30 offset:20608
ds_read_b64_tr_b16 v[82:83],v30 offset:20928
ds_read_b64_tr_b16 v[84:85],v30 offset:21888
ds_read_b64_tr_b16 v[86:87],v30 offset:22208
s_waitcnt lgkmcnt(0)
s_add_u32 s61,s73,819200
s_add_u32 m0,s74,20480
s_nop 0
buffer_load_dwordx4 v20,s[4:7],s61 offen lds
s_add_u32 m0,s74,21504
s_nop 0
buffer_load_dwordx4 v21,s[4:7],s61 offen lds
s_add_u32 m0,s74,22528
s_nop 0
buffer_load_dwordx4 v22,s[4:7],s61 offen lds
s_add_u32 m0,s74,23552
s_nop 0
buffer_load_dwordx4 v23,s[4:7],s61 offen lds
s_add_u32 m0,s74,24576
s_nop 0
buffer_load_dwordx4 v24,s[4:7],s61 offen lds
s_add_u32 m0,s74,25600
s_nop 0
buffer_load_dwordx4 v25,s[4:7],s61 offen lds
s_add_u32 m0,s74,26624
s_nop 0
buffer_load_dwordx4 v26,s[4:7],s61 offen lds
s_add_u32 m0,s74,27648
s_nop 0
buffer_load_dwordx4 v27,s[4:7],s61 offen lds
s_add_u32 m0,s74,28672
s_nop 0
buffer_load_dwordx4 v28,s[4:7],s61 offen lds
s_add_u32 m0,s74,29696
s_nop 0
buffer_load_dwordx4 v29,s[4:7],s61 offen lds
s_waitcnt vmcnt(30)
ds_read_b64_tr_b16 a[224:225],v30 offset:30720
ds_read_b64_tr_b16 a[226:227],v30 offset:31040
ds_read_b64_tr_b16 a[228:229],v30 offset:32000
ds_read_b64_tr_b16 a[230:231],v30 offset:32320
ds_read_b64_tr_b16 a[232:233],v30 offset:30752
ds_read_b64_tr_b16 a[234:235],v30 offset:31072
ds_read_b64_tr_b16 a[236:237],v30 offset:32032
ds_read_b64_tr_b16 a[238:239],v30 offset:32352
ds_read_b64_tr_b16 a[240:241],v30 offset:30784
ds_read_b64_tr_b16 a[242:243],v30 offset:31104
ds_read_b64_tr_b16 a[244:245],v30 offset:32064
ds_read_b64_tr_b16 a[246:247],v30 offset:32384
s_waitcnt lgkmcnt(4)
ds_read_b64_tr_b16 a[248:249],v30 offset:30816
ds_read_b64_tr_b16 a[250:251],v30 offset:31136
ds_read_b64_tr_b16 a[252:253],v30 offset:32096
ds_read_b64_tr_b16 a[254:255],v30 offset:32416
ds_read_b64_tr_b16 v[88:89],v30 offset:30848
ds_read_b64_tr_b16 v[90:91],v30 offset:31168
ds_read_b64_tr_b16 v[92:93],v30 offset:32128
ds_read_b64_tr_b16 v[94:95],v30 offset:32448
s_waitcnt lgkmcnt(0)
s_add_u32 s61,s73,901120
s_add_u32 m0,s74,30720
s_nop 0
buffer_load_dwordx4 v20,s[4:7],s61 offen lds
s_add_u32 m0,s74,31744
s_nop 0
buffer_load_dwordx4 v21,s[4:7],s61 offen lds
s_add_u32 m0,s74,32768
s_nop 0
buffer_load_dwordx4 v22,s[4:7],s61 offen lds
s_add_u32 m0,s74,33792
s_nop 0
buffer_load_dwordx4 v23,s[4:7],s61 offen lds
s_add_u32 m0,s74,34816
s_nop 0
buffer_load_dwordx4 v24,s[4:7],s61 offen lds
s_add_u32 m0,s74,35840
s_nop 0
buffer_load_dwordx4 v25,s[4:7],s61 offen lds
s_add_u32 m0,s74,36864
s_nop 0
buffer_load_dwordx4 v26,s[4:7],s61 offen lds
s_add_u32 m0,s74,37888
s_nop 0
buffer_load_dwordx4 v27,s[4:7],s61 offen lds
s_add_u32 m0,s74,38912
s_nop 0
buffer_load_dwordx4 v28,s[4:7],s61 offen lds
s_add_u32 m0,s74,39936
s_nop 0
buffer_load_dwordx4 v29,s[4:7],s61 offen lds
s_waitcnt vmcnt(30)
ds_read_b64_tr_b16 v[128:129],v30 offset:0
ds_read_b64_tr_b16 v[130:131],v30 offset:320
ds_read_b64_tr_b16 v[132:133],v30 offset:1280
ds_read_b64_tr_b16 v[134:135],v30 offset:1600
ds_read_b64_tr_b16 v[136:137],v30 offset:32
ds_read_b64_tr_b16 v[138:139],v30 offset:352
ds_read_b64_tr_b16 v[140:141],v30 offset:1312
ds_read_b64_tr_b16 v[142:143],v30 offset:1632
ds_read_b64_tr_b16 v[144:145],v30 offset:64
ds_read_b64_tr_b16 v[146:147],v30 offset:384
ds_read_b64_tr_b16 v[148:149],v30 offset:1344
ds_read_b64_tr_b16 v[150:151],v30 offset:1664
s_waitcnt lgkmcnt(4)
ds_read_b64_tr_b16 v[152:153],v30 offset:96
ds_read_b64_tr_b16 v[154:155],v30 offset:416
ds_read_b64_tr_b16 v[156:157],v30 offset:1376
ds_read_b64_tr_b16 v[158:159],v30 offset:1696
ds_read_b64_tr_b16 v[96:97],v30 offset:128
ds_read_b64_tr_b16 v[98:99],v30 offset:448
ds_read_b64_tr_b16 v[100:101],v30 offset:1408
ds_read_b64_tr_b16 v[102:103],v30 offset:1728
s_waitcnt lgkmcnt(0)
s_waitcnt vmcnt(20)
ds_read_b64_tr_b16 v[160:161],v30 offset:10240
ds_read_b64_tr_b16 v[162:163],v30 offset:10560
ds_read_b64_tr_b16 v[164:165],v30 offset:11520
ds_read_b64_tr_b16 v[166:167],v30 offset:11840
ds_read_b64_tr_b16 v[168:169],v30 offset:10272
ds_read_b64_tr_b16 v[170:171],v30 offset:10592
ds_read_b64_tr_b16 v[172:173],v30 offset:11552
ds_read_b64_tr_b16 v[174:175],v30 offset:11872
ds_read_b64_tr_b16 v[176:177],v30 offset:10304
ds_read_b64_tr_b16 v[178:179],v30 offset:10624
ds_read_b64_tr_b16 v[180:181],v30 offset:11584
ds_read_b64_tr_b16 v[182:183],v30 offset:11904
s_waitcnt lgkmcnt(4)
ds_read_b64_tr_b16 v[184:185],v30 offset:10336
ds_read_b64_tr_b16 v[186:187],v30 offset:10656
ds_read_b64_tr_b16 v[188:189],v30 offset:11616
ds_read_b64_tr_b16 v[190:191],v30 offset:11936
ds_read_b64_tr_b16 v[104:105],v30 offset:10368
ds_read_b64_tr_b16 v[106:107],v30 offset:10688
ds_read_b64_tr_b16 v[108:109],v30 offset:11648
ds_read_b64_tr_b16 v[110:111],v30 offset:11968
s_waitcnt lgkmcnt(0)
s_waitcnt vmcnt(10)
ds_read_b64_tr_b16 v[192:193],v30 offset:20480
ds_read_b64_tr_b16 v[194:195],v30 offset:20800
ds_read_b64_tr_b16 v[196:197],v30 offset:21760
ds_read_b64_tr_b16 v[198:199],v30 offset:22080
ds_read_b64_tr_b16 v[200:201],v30 offset:20512
ds_read_b64_tr_b16 v[202:203],v30 offset:20832
ds_read_b64_tr_b16 v[204:205],v30 offset:21792
ds_read_b64_tr_b16 v[206:207],v30 offset:22112
ds_read_b64_tr_b16 v[208:209],v30 offset:20544
ds_read_b64_tr_b16 v[210:211],v30 offset:20864
ds_read_b64_tr_b16 v[212:213],v30 offset:21824
ds_read_b64_tr_b16 v[214:215],v30 offset:22144
s_waitcnt lgkmcnt(4)
ds_read_b64_tr_b16 v[216:217],v30 offset:20576
ds_read_b64_tr_b16 v[218:219],v30 offset:20896
ds_read_b64_tr_b16 v[220:221],v30 offset:21856
ds_read_b64_tr_b16 v[222:223],v30 offset:22176
ds_read_b64_tr_b16 v[112:113],v30 offset:20608
ds_read_b64_tr_b16 v[114:115],v30 offset:20928
ds_read_b64_tr_b16 v[116:117],v30 offset:21888
ds_read_b64_tr_b16 v[118:119],v30 offset:22208
s_waitcnt lgkmcnt(0)
s_waitcnt vmcnt(0)
ds_read_b64_tr_b16 v[224:225],v30 offset:30720
ds_read_b64_tr_b16 v[226:227],v30 offset:31040
ds_read_b64_tr_b16 v[228:229],v30 offset:32000
ds_read_b64_tr_b16 v[230:231],v30 offset:32320
ds_read_b64_tr_b16 v[232:233],v30 offset:30752
ds_read_b64_tr_b16 v[234:235],v30 offset:31072
ds_read_b64_tr_b16 v[236:237],v30 offset:32032
ds_read_b64_tr_b16 v[238:239],v30 offset:32352
ds_read_b64_tr_b16 v[240:241],v30 offset:30784
ds_read_b64_tr_b16 v[242:243],v30 offset:31104
ds_read_b64_tr_b16 v[244:245],v30 offset:32064
ds_read_b64_tr_b16 v[246:247],v30 offset:32384
s_waitcnt lgkmcnt(4)
ds_read_b64_tr_b16 v[248:249],v30 offset:30816
ds_read_b64_tr_b16 v[250:251],v30 offset:31136
ds_read_b64_tr_b16 v[252:253],v30 offset:32096
ds_read_b64_tr_b16 v[254:255],v30 offset:32416
ds_read_b64_tr_b16 v[120:121],v30 offset:30848
ds_read_b64_tr_b16 v[122:123],v30 offset:31168
ds_read_b64_tr_b16 v[124:125],v30 offset:32128
ds_read_b64_tr_b16 v[126:127],v30 offset:32448
s_waitcnt lgkmcnt(0)
s_barrier
ds_write_b128 v4,v[32:35] offset:0
ds_write_b128 v4,v[36:39] offset:1024
ds_write_b128 v4,v[40:43] offset:2048
ds_write_b128 v4,v[44:47] offset:3072
ds_write_b128 v4,v[48:51] offset:4096
ds_write_b128 v4,v[52:55] offset:5120
ds_write_b128 v4,v[56:59] offset:6144
ds_write_b128 v4,v[60:63] offset:7168
s_waitcnt lgkmcnt(0)
ds_write_b128 v4,v[64:67] offset:8192
ds_write_b128 v4,v[68:71] offset:9216
ds_write_b128 v4,v[72:75] offset:10240
ds_write_b128 v4,v[76:79] offset:11264
ds_write_b128 v4,v[80:83] offset:12288
ds_write_b128 v4,v[84:87] offset:13312
ds_write_b128 v4,v[88:91] offset:14336
ds_write_b128 v4,v[92:95] offset:15360
s_waitcnt lgkmcnt(0)
ds_write_b128 v4,v[96:99] offset:16384
ds_write_b128 v4,v[100:103] offset:17408
ds_write_b128 v4,v[104:107] offset:18432
ds_write_b128 v4,v[108:111] offset:19456
ds_write_b128 v4,v[112:115] offset:20480
ds_write_b128 v4,v[116:119] offset:21504
ds_write_b128 v4,v[120:123] offset:22528
ds_write_b128 v4,v[124:127] offset:23552
s_waitcnt lgkmcnt(0)
s_barrier
s_lshl_b32 s3,s49,2
v_mov_b32 v13,s3
s_nop 1
ibw_178:
buffer_load_dword v12,v13,s[12:15],0 offen sc1
s_waitcnt vmcnt(0)
v_cmp_ne_u32 vcc,256,v12
s_nop 0
s_cbranch_vccz ok_179
s_sleep 8
s_sub_u32 s47,s47,1
s_cbranch_scc1 ABORT
s_branch ibw_178
ok_179:
s_cmp_lg_u32 s49,0
s_cbranch_scc1 ibok_180
v_and_b32 v13,7,v0
v_lshlrev_b32 v13,2,v13
buffer_load_dword v12,v13,s[12:15],0 offen offset:32 sc1
s_waitcnt vmcnt(0)
v_cmp_ne_u32 vcc,32,v12
s_nop 0
s_cbranch_vccz ibok_180
s_barrier
s_mov_b32 s49,1
s_mov_b32 s3,s2
s_load_dwordx16 s[16:31],s[0:1],0
s_load_dwordx8 s[32:39],s[0:1],64
s_waitcnt lgkmcnt(0)
s_branch DISPATCH
ibok_180:
v_mov_b32 v13,192
s_cmp_lg_u32 s49,0
s_cbranch_scc1 vx_182
vw_181:
buffer_load_dword v12,v13,s[12:15],0 offen sc1
s_waitcnt vmcnt(0)
v_and_b32 v14,0xffff,v12
v_cmp_ne_u32 vcc,32,v14
s_nop 0
s_cbranch_vccz ok_183
s_sleep 4
s_sub_u32 s47,s47,1
s_cbranch_scc1 ABORT
s_branch vw_181
ok_183:
v_readfirstlane_b32 s60,v12
s_cmp_gt_u32 s60,1114112
s_cselect_b32 s60,0x2000,0
s_add_u32 s83,s83,s60
s_nop 1
vx_182:
s_mov_b32 s50,0
s_mov_b32 s77,0
ds_read_b128 v[20:23],v4 offset:12288
ds_read_b128 v[24:27],v4 offset:13312
ds_read_b128 v[116:119],v4 offset:22528
ds_read_b128 v[120:123],v4 offset:23552
s_waitcnt lgkmcnt(0)
s_cmp_lg_u32 s49,0
s_cbranch_scc1 CW_LOOP_S
CW_LOOP_F:
s_sub_u32 s60,s50,13
s_lshr_b32 s52,s60,1
s_and_b32 s51,s60,1
s_cmp_eq_u32 s51,0
s_cselect_b32 s61,13,0
s_add_u32 s52,s52,s61
s_sub_u32 s61,s60,51
s_cmp_ge_u32 s60,102
s_cselect_b32 s52,s61,s52
s_cselect_b32 s51,1,s51
s_cmp_lt_u32 s50,13
s_cselect_b32 s52,s50,s52
s_cselect_b32 s51,0,s51
s_cmp_eq_u32 s52,63
s_cbranch_scc1 CW_NEXT_F
s_add_u32 s58,s52,1
s_lshl_b32 s61,s51,9
s_add_u32 s72,s61,s35
s_add_u32 s69,s61,s85
s_lshl_b32 s61,s51,2
s_and_b32 s60,s52,1
s_add_u32 s60,s60,s61
s_mul_i32 s70,s60,49152
s_add_u32 s70,s70,s33
s_add_u32 s71,s70,4096
s_add_u32 s80,s70,8192
s_bfe_u32 s57,s52,65537
s_bfe_u32 s31,s58,65537
s_and_b32 s60,s58,1
s_add_u32 s60,s60,s61
s_mul_i32 s59,s60,20480
s_add_u32 s59,s59,s84
s_lshl_b32 s68,s60,16
s_add_u32 s68,s68,s83
s_xor_b32 s77,s77,11264
v_add_u32 v7,s77,v5
v_add_u32 v8,s77,v6
s_add_u32 s60,s52,2
v_mov_b32 v16,s60
ds_read_b128 v[100:103],v4 offset:0
ds_read_b128 v[104:107],v4 offset:1024
ds_read_b128 v[108:111],v4 offset:6144
ds_read_b128 v[112:115],v4 offset:7168
s_cmp_lg_u32 s46,0
s_cbranch_scc1 np_184
db_186:
buffer_load_dword v12,v3,s[8:11],s72 offen sc1
s_waitcnt vmcnt(0)
v_cmp_gt_u32 vcc,s58,v12
s_cbranch_vccz dbok_187
s_sub_u32 s47,s47,1
s_cbranch_scc1 ABORT
s_branch db_186
dbok_187:
np_184:
s_barrier
rd_185:
buffer_load_dwordx4 v[32:35],v1,s[8:11],s70 offen sc1
v_mov_b32 v80,0
v_mov_b32 v81,0
v_mov_b32 v82,0
v_mov_b32 v83,0
v_mov_b32 v84,0
buffer_load_dwordx4 v[36:39],v1,s[8:11],s70 offen offset:3072 sc1
v_mov_b32 v85,0
v_mov_b32 v86,0
v_mov_b32 v87,0
v_mov_b32 v88,0
v_mov_b32 v89,0
buffer_load_dwordx4 v[40:43],v1,s[8:11],s71 offen offset:2048 sc1
v_mov_b32 v90,0
v_mov_b32 v91,0
v_mov_b32 v92,0
v_mov_b32 v93,0
v_mov_b32 v94,0
buffer_load_dwordx4 v[44:47],v1,s[8:11],s80 offen offset:1024 sc1
v_mov_b32 v95,0
v_mov_b32 v96,0
v_mov_b32 v97,0
v_mov_b32 v98,0
v_mov_b32 v99,0
buffer_load_dwordx4 v[48:51],v1,s[8:11],s70 offen offset:1024 sc1
s_waitcnt vmcnt(4)
v_and_b32 v12,1,v32
v_cmp_ne_u32 vcc,s57,v12
s_cbranch_vccnz ws_188
wg_192:
v_smfmac_f32_16x16x64_bf16 v[80:83],v[32:35],a[0:7],v2
buffer_load_dwordx4 v[52:55],v1,s[8:11],s71 offen sc1
v_smfmac_f32_16x16x64_bf16 v[84:87],v[32:35],a[8:15],v2
s_waitcnt vmcnt(4)
v_and_b32 v12,1,v36
v_smfmac_f32_16x16x64_bf16 v[88:91],v[32:35],a[16:23],v2
v_cmp_ne_u32 vcc,s57,v12
v_smfmac_f32_16x16x64_bf16 v[92:95],v[32:35],a[24:31],v2
s_waitcnt lgkmcnt(2)
v_smfmac_f32_16x16x64_bf16 v[96:99],v[32:35],v[100:107],v2
s_cbranch_vccnz ws_189
wg_193:
v_smfmac_f32_16x16x64_bf16 v[80:83],v[36:39],a[96:103],v2
buffer_load_dwordx4 v[56:59],v1,s[8:11],s71 offen offset:3072 sc1
v_smfmac_f32_16x16x64_bf16 v[84:87],v[36:39],a[104:111],v2
s_waitcnt vmcnt(4)
v_and_b32 v12,1,v40
v_smfmac_f32_16x16x64_bf16 v[88:91],v[36:39],a[112:119],v2
v_cmp_ne_u32 vcc,s57,v12
v_smfmac_f32_16x16x64_bf16 v[92:95],v[36:39],a[120:127],v2
s_waitcnt lgkmcnt(0)
v_smfmac_f32_16x16x64_bf16 v[96:99],v[36:39],v[108:115],v2
s_cbranch_vccnz ws_190
wg_194:
v_smfmac_f32_16x16x64_bf16 v[80:83],v[40:43],a[192:199],v2
buffer_load_dwordx4 v[60:63],v1,s[8:11],s80 offen offset:2048 sc1
v_smfmac_f32_16x16x64_bf16 v[84:87],v[40:43],a[200:207],v2
s_waitcnt vmcnt(4)
v_and_b32 v12,1,v44
v_smfmac_f32_16x16x64_bf16 v[88:91],v[40:43],a[208:215],v2
v_cmp_ne_u32 vcc,s57,v12
ds_read_b128 v[100:103],v4 offset:18432
v_smfmac_f32_16x16x64_bf16 v[92:95],v[40:43],a[216:223],v2
ds_read_b128 v[104:107],v4 offset:19456
v_smfmac_f32_16x16x64_bf16 v[96:99],v[40:43],v[20:27],v2
s_cbranch_vccnz ws_191
wg_195:
v_smfmac_f32_16x16x64_bf16 v[80:83],v[44:47],v[160:167],v2
buffer_load_dwordx4 v[64:67],v1,s[8:11],s70 offen offset:2048 sc1
v_smfmac_f32_16x16x64_bf16 v[84:87],v[44:47],v[168:175],v2
ds_read_b128 v[108:111],v4 offset:2048
v_smfmac_f32_16x16x64_bf16 v[88:91],v[44:47],v[176:183],v2
ds_read_b128 v[112:115],v4 offset:3072
v_smfmac_f32_16x16x64_bf16 v[92:95],v[44:47],v[184:191],v2
s_waitcnt lgkmcnt(2)
v_smfmac_f32_16x16x64_bf16 v[96:99],v[44:47],v[100:107],v2
buffer_load_dwordx4 v[68:71],v1,s[8:11],s71 offen offset:1024 sc1
s_waitcnt vmcnt(5)
v_smfmac_f32_16x16x64_bf16 v[80:83],v[48:51],a[32:39],v2
ds_read_b128 v[100:103],v4 offset:8192
v_smfmac_f32_16x16x64_bf16 v[84:87],v[48:51],a[40:47],v2
ds_read_b128 v[104:107],v4 offset:9216
v_smfmac_f32_16x16x64_bf16 v[88:91],v[48:51],a[48:55],v2
v_smfmac_f32_16x16x64_bf16 v[92:95],v[48:51],a[56:63],v2
buffer_load_dwordx4 v[72:75],v1,s[8:11],s80 offen sc1
s_waitcnt lgkmcnt(2)
v_smfmac_f32_16x16x64_bf16 v[96:99],v[48:51],v[108:115],v2
s_waitcnt vmcnt(5)
v_smfmac_f32_16x16x64_bf16 v[80:83],v[52:55],a[128:135],v2
ds_read_b128 v[108:111],v4 offset:14336
v_bitop3_b32 v13,v48,v52,s57 bitop3:0x7e
v_smfmac_f32_16x16x64_bf16 v[84:87],v[52:55],a[136:143],v2
ds_read_b128 v[112:115],v4 offset:15360
v_smfmac_f32_16x16x64_bf16 v[88:91],v[52:55],a[144:151],v2
buffer_load_dwordx4 v[76:79],v1,s[8:11],s80 offen offset:3072 sc1
v_smfmac_f32_16x16x64_bf16 v[92:95],v[52:55],a[152:159],v2
s_waitcnt lgkmcnt(2)
v_smfmac_f32_16x16x64_bf16 v[96:99],v[52:55],v[100:107],v2
s_waitcnt vmcnt(5)
v_smfmac_f32_16x16x64_bf16 v[80:83],v[56:59],a[224:231],v2
ds_read_b128 v[100:103],v4 offset:20480
v_smfmac_f32_16x16x64_bf16 v[84:87],v[56:59],a[232:239],v2
ds_read_b128 v[104:107],v4 offset:21504
v_smfmac_f32_16x16x64_bf16 v[88:91],v[56:59],a[240:247],v2
v_smfmac_f32_16x16x64_bf16 v[92:95],v[56:59],a[248:255],v2
s_waitcnt lgkmcnt(2)
v_smfmac_f32_16x16x64_bf16 v[96:99],v[56:59],v[108:115],v2
s_waitcnt vmcnt(4)
v_smfmac_f32_16x16x64_bf16 v[80:83],v[60:63],v[192:199],v2
ds_read_b128 v[108:111],v4 offset:4096
v_bitop3_b32 v14,v56,v60,s57 bitop3:0x7e
v_smfmac_f32_16x16x64_bf16 v[84:87],v[60:63],v[200:207],v2
ds_read_b128 v[112:115],v4 offset:5120
v_or_b32 v13,v13,v14
v_smfmac_f32_16x16x64_bf16 v[88:91],v[60:63],v[208:215],v2
v_smfmac_f32_16x16x64_bf16 v[92:95],v[60:63],v[216:223],v2
s_waitcnt lgkmcnt(2)
v_smfmac_f32_16x16x64_bf16 v[96:99],v[60:63],v[100:107],v2
s_waitcnt vmcnt(3)
v_smfmac_f32_16x16x64_bf16 v[80:83],v[64:67],a[64:71],v2
ds_read_b128 v[100:103],v4 offset:10240
v_smfmac_f32_16x16x64_bf16 v[84:87],v[64:67],a[72:79],v2
ds_read_b128 v[104:107],v4 offset:11264
v_smfmac_f32_16x16x64_bf16 v[88:91],v[64:67],a[80:87],v2
v_smfmac_f32_16x16x64_bf16 v[92:95],v[64:67],a[88:95],v2
s_waitcnt lgkmcnt(2)
v_smfmac_f32_16x16x64_bf16 v[96:99],v[64:67],v[108:115],v2
s_waitcnt vmcnt(0)
v_smfmac_f32_16x16x64_bf16 v[80:83],v[68:71],a[160:167],v2
ds_read_b128 v[108:111],v4 offset:16384
v_bitop3_b32 v14,v64,v68,s57 bitop3:0x7e
v_smfmac_f32_16x16x64_bf16 v[80:83],v[72:75],v[128:135],v2
ds_read_b128 v[112:115],v4 offset:17408
v_or_b32 v13,v13,v14
v_smfmac_f32_16x16x64_bf16 v[80:83],v[76:79],v[224:231],v2
v_bitop3_b32 v14,v72,v76,s57 bitop3:0x7e
v_smfmac_f32_16x16x64_bf16 v[84:87],v[68:71],a[168:175],v2
v_or_b32 v13,v13,v14
v_smfmac_f32_16x16x64_bf16 v[84:87],v[72:75],v[136:143],v2
v_and_b32 v13,1,v13
v_smfmac_f32_16x16x64_bf16 v[84:87],v[76:79],v[232:239],v2
v_cmp_ne_u32 vcc,0,v13
v_smfmac_f32_16x16x64_bf16 v[88:91],v[68:71],a[176:183],v2
s_cbranch_vccnz rd_185x
v_smfmac_f32_16x16x64_bf16 v[88:91],v[72:75],v[144:151],v2
v_add_f32 v80,v80,v81
v_smfmac_f32_16x16x64_bf16 v[88:91],v[76:79],v[240:247],v2
v_add_f32 v82,v82,v83
ds_write2_b32 v7,v80,v82 offset0:0 offset1:88
v_smfmac_f32_16x16x64_bf16 v[92:95],v[68:71],a[184:191],v2
v_add_f32 v84,v84,v85
v_smfmac_f32_16x16x64_bf16 v[92:95],v[72:75],v[152:159],v2
v_add_f32 v86,v86,v87
ds_write2_b32 v7,v84,v86 offset0:16 offset1:104
v_smfmac_f32_16x16x64_bf16 v[92:95],v[76:79],v[248:255],v2
v_add_f32 v88,v88,v89
s_waitcnt lgkmcnt(4)
v_smfmac_f32_16x16x64_bf16 v[96:99],v[68:71],v[100:107],v2
v_add_f32 v90,v90,v91
s_waitcnt lgkmcnt(2)
v_smfmac_f32_16x16x64_bf16 v[96:99],v[72:75],v[108:115],v2
ds_write2_b32 v7,v88,v90 offset0:32 offset1:120
v_smfmac_f32_16x16x64_bf16 v[96:99],v[76:79],v[116:123],v2
v_add_f32 v92,v92,v93
v_add_f32 v94,v94,v95
ds_write2_b32 v7,v92,v94 offset0:48 offset1:136
s_nop 4
v_add_f32 v96,v96,v97
v_add_f32 v98,v98,v99
ds_write2_b32 v7,v96,v98 offset0:64 offset1:152
s_waitcnt lgkmcnt(0)
s_barrier
ds_read_b128 v[32:35],v8 offset:0
ds_read_b128 v[36:39],v8 offset:2816
ds_read_b128 v[40:43],v8 offset:5632
ds_read_b128 v[44:47],v8 offset:8448
s_mov_b64 exec,1
buffer_store_dword v16,v1,s[8:11],s69 offen
s_mov_b64 exec,-1
s_waitcnt lgkmcnt(2)
v_pk_add_f32 v[32:33],v[32:33],v[36:37]
v_pk_add_f32 v[34:35],v[34:35],v[38:39]
s_waitcnt lgkmcnt(0)
v_pk_add_f32 v[40:41],v[40:41],v[44:45]
v_pk_add_f32 v[42:43],v[42:43],v[46:47]
v_pk_add_f32 v[32:33],v[32:33],v[40:41]
v_pk_add_f32 v[34:35],v[34:35],v[42:43]
v_cvt_pk_bf16_f32 v32,v32,v33
v_cvt_pk_bf16_f32 v33,v34,v35
v_bfi_b32 v32,v10,s31,v32
s_nop 0
v_permlane32_swap_b32 v33,v35
v_permlane32_swap_b32 v32,v34
s_mov_b64 exec,s[88:89]
buffer_store_dwordx4 v[32:35],v9,s[8:11],s59 offen
s_barrier
buffer_store_dwordx4 v[32:35],v9,s[8:11],s68 offen sc1
s_mov_b64 exec,-1
s_nop 0
CW_NEXT_F:
s_add_u32 s50,s50,1
s_cmp_lt_u32 s50,128
s_cbranch_scc1 CW_LOOP_F
s_branch CW_DONE
ws_188:
buffer_load_dwordx4 v[32:35],v1,s[8:11],s70 offen sc1
buffer_load_dwordx4 v[36:39],v1,s[8:11],s70 offen offset:3072 sc1
buffer_load_dwordx4 v[40:43],v1,s[8:11],s71 offen offset:2048 sc1
buffer_load_dwordx4 v[44:47],v1,s[8:11],s80 offen offset:1024 sc1
buffer_load_dwordx4 v[48:51],v1,s[8:11],s70 offen offset:1024 sc1
s_sub_u32 s47,s47,1
s_cbranch_scc1 ABORT
s_waitcnt vmcnt(4)
v_and_b32 v12,1,v32
v_cmp_ne_u32 vcc,s57,v12
s_nop 0
s_cbranch_vccnz ws_188
s_branch wg_192
ws_189:
buffer_load_dwordx4 v[36:39],v1,s[8:11],s70 offen offset:3072 sc1
buffer_load_dwordx4 v[40:43],v1,s[8:11],s71 offen offset:2048 sc1
buffer_load_dwordx4 v[44:47],v1,s[8:11],s80 offen offset:1024 sc1
buffer_load_dwordx4 v[48:51],v1,s[8:11],s70 offen offset:1024 sc1
buffer_load_dwordx4 v[52:55],v1,s[8:11],s71 offen sc1
s_sub_u32 s47,s47,1
s_cbranch_scc1 ABORT
s_waitcnt vmcnt(4)
v_and_b32 v12,1,v36
v_cmp_ne_u32 vcc,s57,v12
s_nop 0
s_cbranch_vccnz ws_189
s_branch wg_193
ws_190:
buffer_load_dwordx4 v[40:43],v1,s[8:11],s71 offen offset:2048 sc1
buffer_load_dwordx4 v[44:47],v1,s[8:11],s80 offen offset:1024 sc1
buffer_load_dwordx4 v[48:51],v1,s[8:11],s70 offen offset:1024 sc1
buffer_load_dwordx4 v[52:55],v1,s[8:11],s71 offen sc1
buffer_load_dwordx4 v[56:59],v1,s[8:11],s71 offen offset:3072 sc1
s_sub_u32 s47,s47,1
s_cbranch_scc1 ABORT
s_waitcnt vmcnt(4)
v_and_b32 v12,1,v40
v_cmp_ne_u32 vcc,s57,v12
s_nop 0
s_cbranch_vccnz ws_190
s_branch wg_194
ws_191:
buffer_load_dwordx4 v[44:47],v1,s[8:11],s80 offen offset:1024 sc1
buffer_load_dwordx4 v[48:51],v1,s[8:11],s70 offen offset:1024 sc1
buffer_load_dwordx4 v[52:55],v1,s[8:11],s71 offen sc1
buffer_load_dwordx4 v[56:59],v1,s[8:11],s71 offen offset:3072 sc1
buffer_load_dwordx4 v[60:63],v1,s[8:11],s80 offen offset:2048 sc1
s_sub_u32 s47,s47,1
s_cbranch_scc1 ABORT
s_waitcnt vmcnt(4)
v_and_b32 v12,1,v44
v_cmp_ne_u32 vcc,s57,v12
s_nop 0
s_cbranch_vccnz ws_191
s_branch wg_195
rd_185x:
s_sub_u32 s47,s47,1
s_cbranch_scc1 ABORT
s_waitcnt lgkmcnt(0)
s_nop 7
ds_read_b128 v[100:103],v4 offset:0
ds_read_b128 v[104:107],v4 offset:1024
ds_read_b128 v[108:111],v4 offset:6144
ds_read_b128 v[112:115],v4 offset:7168
s_branch rd_185
CW_LOOP_S:
s_sub_u32 s60,s50,13
s_lshr_b32 s52,s60,1
s_and_b32 s51,s60,1
s_cmp_eq_u32 s51,0
s_cselect_b32 s61,13,0
s_add_u32 s52,s52,s61
s_sub_u32 s61,s60,51
s_cmp_ge_u32 s60,102
s_cselect_b32 s52,s61,s52
s_cselect_b32 s51,1,s51
s_cmp_lt_u32 s50,13
s_cselect_b32 s52,s50,s52
s_cselect_b32 s51,0,s51
s_cmp_eq_u32 s52,63
s_cbranch_scc1 CW_NEXT_S
s_add_u32 s58,s52,1
s_lshl_b32 s61,s51,9
s_add_u32 s72,s61,s35
s_add_u32 s69,s61,s85
s_lshl_b32 s61,s51,2
s_and_b32 s60,s52,1
s_add_u32 s60,s60,s61
s_mul_i32 s70,s60,49152
s_add_u32 s70,s70,s33
s_add_u32 s71,s70,4096
s_add_u32 s80,s70,8192
s_bfe_u32 s57,s52,65537
s_bfe_u32 s31,s58,65537
s_and_b32 s60,s58,1
s_add_u32 s60,s60,s61
s_mul_i32 s59,s60,20480
s_add_u32 s59,s59,s84
s_lshl_b32 s68,s60,16
s_add_u32 s68,s68,s83
s_xor_b32 s77,s77,11264
v_add_u32 v7,s77,v5
v_add_u32 v8,s77,v6
s_add_u32 s60,s52,2
v_mov_b32 v16,s60
ds_read_b128 v[100:103],v4 offset:0
ds_read_b128 v[104:107],v4 offset:1024
ds_read_b128 v[108:111],v4 offset:6144
ds_read_b128 v[112:115],v4 offset:7168
s_cmp_lg_u32 s46,0
s_cbranch_scc1 np_196
db_198:
buffer_load_dword v12,v3,s[8:11],s72 offen sc1
s_waitcnt vmcnt(0)
v_cmp_gt_u32 vcc,s58,v12
s_cbranch_vccz dbok_199
s_sub_u32 s47,s47,1
s_cbranch_scc1 ABORT
s_branch db_198
dbok_199:
np_196:
s_barrier
rd_197:
buffer_load_dwordx4 v[32:35],v1,s[8:11],s70 offen sc1
v_mov_b32 v80,0
v_mov_b32 v81,0
v_mov_b32 v82,0
v_mov_b32 v83,0
v_mov_b32 v84,0
buffer_load_dwordx4 v[36:39],v1,s[8:11],s70 offen offset:3072 sc1
v_mov_b32 v85,0
v_mov_b32 v86,0
v_mov_b32 v87,0
v_mov_b32 v88,0
v_mov_b32 v89,0
buffer_load_dwordx4 v[40:43],v1,s[8:11],s71 offen offset:2048 sc1
v_mov_b32 v90,0
v_mov_b32 v91,0
v_mov_b32 v92,0
v_mov_b32 v93,0
v_mov_b32 v94,0
buffer_load_dwordx4 v[44:47],v1,s[8:11],s80 offen offset:1024 sc1
v_mov_b32 v95,0
v_mov_b32 v96,0
v_mov_b32 v97,0
v_mov_b32 v98,0
v_mov_b32 v99,0
buffer_load_dwordx4 v[48:51],v1,s[8:11],s70 offen offset:1024 sc1
s_waitcnt vmcnt(4)
v_and_b32 v12,1,v32
v_cmp_ne_u32 vcc,s57,v12
s_cbranch_vccnz ws_200
wg_204:
v_smfmac_f32_16x16x64_bf16 v[80:83],v[32:35],a[0:7],v2
buffer_load_dwordx4 v[52:55],v1,s[8:11],s71 offen sc1
v_smfmac_f32_16x16x64_bf16 v[84:87],v[32:35],a[8:15],v2
s_waitcnt vmcnt(4)
v_and_b32 v12,1,v36
v_smfmac_f32_16x16x64_bf16 v[88:91],v[32:35],a[16:23],v2
v_cmp_ne_u32 vcc,s57,v12
v_smfmac_f32_16x16x64_bf16 v[92:95],v[32:35],a[24:31],v2
s_waitcnt lgkmcnt(2)
v_smfmac_f32_16x16x64_bf16 v[96:99],v[32:35],v[100:107],v2
s_cbranch_vccnz ws_201
wg_205:
v_smfmac_f32_16x16x64_bf16 v[80:83],v[36:39],a[96:103],v2
buffer_load_dwordx4 v[56:59],v1,s[8:11],s71 offen offset:3072 sc1
v_smfmac_f32_16x16x64_bf16 v[84:87],v[36:39],a[104:111],v2
s_waitcnt vmcnt(4)
v_and_b32 v12,1,v40
v_smfmac_f32_16x16x64_bf16 v[88:91],v[36:39],a[112:119],v2
v_cmp_ne_u32 vcc,s57,v12
v_smfmac_f32_16x16x64_bf16 v[92:95],v[36:39],a[120:127],v2
s_waitcnt lgkmcnt(0)
v_smfmac_f32_16x16x64_bf16 v[96:99],v[36:39],v[108:115],v2
s_cbranch_vccnz ws_202
wg_206:
v_smfmac_f32_16x16x64_bf16 v[80:83],v[40:43],a[192:199],v2
buffer_load_dwordx4 v[60:63],v1,s[8:11],s80 offen offset:2048 sc1
v_smfmac_f32_16x16x64_bf16 v[84:87],v[40:43],a[200:207],v2
s_waitcnt vmcnt(4)
v_and_b32 v12,1,v44
v_smfmac_f32_16x16x64_bf16 v[88:91],v[40:43],a[208:215],v2
v_cmp_ne_u32 vcc,s57,v12
ds_read_b128 v[100:103],v4 offset:18432
v_smfmac_f32_16x16x64_bf16 v[92:95],v[40:43],a[216:223],v2
ds_read_b128 v[104:107],v4 offset:19456
v_smfmac_f32_16x16x64_bf16 v[96:99],v[40:43],v[20:27],v2
s_cbranch_vccnz ws_203
wg_207:
v_smfmac_f32_16x16x64_bf16 v[80:83],v[44:47],v[160:167],v2
buffer_load_dwordx4 v[64:67],v1,s[8:11],s70 offen offset:2048 sc1
v_smfmac_f32_16x16x64_bf16 v[84:87],v[44:47],v[168:175],v2
ds_read_b128 v[108:111],v4 offset:2048
v_smfmac_f32_16x16x64_bf16 v[88:91],v[44:47],v[176:183],v2
ds_read_b128 v[112:115],v4 offset:3072
v_smfmac_f32_16x16x64_bf16 v[92:95],v[44:47],v[184:191],v2
s_waitcnt lgkmcnt(2)
v_smfmac_f32_16x16x64_bf16 v[96:99],v[44:47],v[100:107],v2
buffer_load_dwordx4 v[68:71],v1,s[8:11],s71 offen offset:1024 sc1
s_waitcnt vmcnt(5)
v_smfmac_f32_16x16x64_bf16 v[80:83],v[48:51],a[32:39],v2
ds_read_b128 v[100:103],v4 offset:8192
v_smfmac_f32_16x16x64_bf16 v[84:87],v[48:51],a[40:47],v2
ds_read_b128 v[104:107],v4 offset:9216
v_smfmac_f32_16x16x64_bf16 v[88:91],v[48:51],a[48:55],v2
v_smfmac_f32_16x16x64_bf16 v[92:95],v[48:51],a[56:63],v2
buffer_load_dwordx4 v[72:75],v1,s[8:11],s80 offen sc1
s_waitcnt lgkmcnt(2)
v_smfmac_f32_16x16x64_bf16 v[96:99],v[48:51],v[108:115],v2
s_waitcnt vmcnt(5)
v_smfmac_f32_16x16x64_bf16 v[80:83],v[52:55],a[128:135],v2
ds_read_b128 v[108:111],v4 offset:14336
v_bitop3_b32 v13,v48,v52,s57 bitop3:0x7e
v_smfmac_f32_16x16x64_bf16 v[84:87],v[52:55],a[136:143],v2
ds_read_b128 v[112:115],v4 offset:15360
v_smfmac_f32_16x16x64_bf16 v[88:91],v[52:55],a[144:151],v2
buffer_load_dwordx4 v[76:79],v1,s[8:11],s80 offen offset:3072 sc1
v_smfmac_f32_16x16x64_bf16 v[92:95],v[52:55],a[152:159],v2
s_waitcnt lgkmcnt(2)
v_smfmac_f32_16x16x64_bf16 v[96:99],v[52:55],v[100:107],v2
s_waitcnt vmcnt(5)
v_smfmac_f32_16x16x64_bf16 v[80:83],v[56:59],a[224:231],v2
ds_read_b128 v[100:103],v4 offset:20480
v_smfmac_f32_16x16x64_bf16 v[84:87],v[56:59],a[232:239],v2
ds_read_b128 v[104:107],v4 offset:21504
v_smfmac_f32_16x16x64_bf16 v[88:91],v[56:59],a[240:247],v2
v_smfmac_f32_16x16x64_bf16 v[92:95],v[56:59],a[248:255],v2
s_waitcnt lgkmcnt(2)
v_smfmac_f32_16x16x64_bf16 v[96:99],v[56:59],v[108:115],v2
s_waitcnt vmcnt(4)
v_smfmac_f32_16x16x64_bf16 v[80:83],v[60:63],v[192:199],v2
ds_read_b128 v[108:111],v4 offset:4096
v_bitop3_b32 v14,v56,v60,s57 bitop3:0x7e
v_smfmac_f32_16x16x64_bf16 v[84:87],v[60:63],v[200:207],v2
ds_read_b128 v[112:115],v4 offset:5120
v_or_b32 v13,v13,v14
v_smfmac_f32_16x16x64_bf16 v[88:91],v[60:63],v[208:215],v2
v_smfmac_f32_16x16x64_bf16 v[92:95],v[60:63],v[216:223],v2
s_waitcnt lgkmcnt(2)
v_smfmac_f32_16x16x64_bf16 v[96:99],v[60:63],v[100:107],v2
s_waitcnt vmcnt(3)
v_smfmac_f32_16x16x64_bf16 v[80:83],v[64:67],a[64:71],v2
ds_read_b128 v[100:103],v4 offset:10240
v_smfmac_f32_16x16x64_bf16 v[84:87],v[64:67],a[72:79],v2
ds_read_b128 v[104:107],v4 offset:11264
v_smfmac_f32_16x16x64_bf16 v[88:91],v[64:67],a[80:87],v2
v_smfmac_f32_16x16x64_bf16 v[92:95],v[64:67],a[88:95],v2
s_waitcnt lgkmcnt(2)
v_smfmac_f32_16x16x64_bf16 v[96:99],v[64:67],v[108:115],v2
s_waitcnt vmcnt(0)
v_smfmac_f32_16x16x64_bf16 v[80:83],v[68:71],a[160:167],v2
ds_read_b128 v[108:111],v4 offset:16384
v_bitop3_b32 v14,v64,v68,s57 bitop3:0x7e
v_smfmac_f32_16x16x64_bf16 v[80:83],v[72:75],v[128:135],v2
ds_read_b128 v[112:115],v4 offset:17408
v_or_b32 v13,v13,v14
v_smfmac_f32_16x16x64_bf16 v[80:83],v[76:79],v[224:231],v2
v_bitop3_b32 v14,v72,v76,s57 bitop3:0x7e
v_smfmac_f32_16x16x64_bf16 v[84:87],v[68:71],a[168:175],v2
v_or_b32 v13,v13,v14
v_smfmac_f32_16x16x64_bf16 v[84:87],v[72:75],v[136:143],v2
v_and_b32 v13,1,v13
v_smfmac_f32_16x16x64_bf16 v[84:87],v[76:79],v[232:239],v2
v_cmp_ne_u32 vcc,0,v13
v_smfmac_f32_16x16x64_bf16 v[88:91],v[68:71],a[176:183],v2
s_cbranch_vccnz rd_197x
v_smfmac_f32_16x16x64_bf16 v[88:91],v[72:75],v[144:151],v2
v_add_f32 v80,v80,v81
v_smfmac_f32_16x16x64_bf16 v[88:91],v[76:79],v[240:247],v2
v_add_f32 v82,v82,v83
ds_write2_b32 v7,v80,v82 offset0:0 offset1:88
v_smfmac_f32_16x16x64_bf16 v[92:95],v[68:71],a[184:191],v2
v_add_f32 v84,v84,v85
v_smfmac_f32_16x16x64_bf16 v[92:95],v[72:75],v[152:159],v2
v_add_f32 v86,v86,v87
ds_write2_b32 v7,v84,v86 offset0:16 offset1:104
v_smfmac_f32_16x16x64_bf16 v[92:95],v[76:79],v[248:255],v2
v_add_f32 v88,v88,v89
s_waitcnt lgkmcnt(4)
v_smfmac_f32_16x16x64_bf16 v[96:99],v[68:71],v[100:107],v2
v_add_f32 v90,v90,v91
s_waitcnt lgkmcnt(2)
v_smfmac_f32_16x16x64_bf16 v[96:99],v[72:75],v[108:115],v2
ds_write2_b32 v7,v88,v90 offset0:32 offset1:120
v_smfmac_f32_16x16x64_bf16 v[96:99],v[76:79],v[116:123],v2
v_add_f32 v92,v92,v93
v_add_f32 v94,v94,v95
ds_write2_b32 v7,v92,v94 offset0:48 offset1:136
s_nop 4
v_add_f32 v96,v96,v97
v_add_f32 v98,v98,v99
ds_write2_b32 v7,v96,v98 offset0:64 offset1:152
s_waitcnt lgkmcnt(0)
s_barrier
ds_read_b128 v[32:35],v8 offset:0
ds_read_b128 v[36:39],v8 offset:2816
ds_read_b128 v[40:43],v8 offset:5632
ds_read_b128 v[44:47],v8 offset:8448
s_mov_b64 exec,1
buffer_store_dword v16,v1,s[8:11],s69 offen sc1
s_mov_b64 exec,-1
s_waitcnt lgkmcnt(2)
v_pk_add_f32 v[32:33],v[32:33],v[36:37]
v_pk_add_f32 v[34:35],v[34:35],v[38:39]
s_waitcnt lgkmcnt(0)
v_pk_add_f32 v[40:41],v[40:41],v[44:45]
v_pk_add_f32 v[42:43],v[42:43],v[46:47]
v_pk_add_f32 v[32:33],v[32:33],v[40:41]
v_pk_add_f32 v[34:35],v[34:35],v[42:43]
v_cvt_pk_bf16_f32 v32,v32,v33
v_cvt_pk_bf16_f32 v33,v34,v35
v_bfi_b32 v32,v10,s31,v32
s_nop 0
v_permlane32_swap_b32 v33,v35
v_permlane32_swap_b32 v32,v34
s_mov_b64 exec,s[88:89]
buffer_store_dwordx4 v[32:35],v9,s[8:11],s59 offen sc1
s_barrier
buffer_store_dwordx4 v[32:35],v9,s[8:11],s68 offen sc1
s_mov_b64 exec,-1
s_nop 0
CW_NEXT_S:
s_add_u32 s50,s50,1
s_cmp_lt_u32 s50,128
s_cbranch_scc1 CW_LOOP_S
s_branch CW_DONE
ws_200:
buffer_load_dwordx4 v[32:35],v1,s[8:11],s70 offen sc1
buffer_load_dwordx4 v[36:39],v1,s[8:11],s70 offen offset:3072 sc1
buffer_load_dwordx4 v[40:43],v1,s[8:11],s71 offen offset:2048 sc1
buffer_load_dwordx4 v[44:47],v1,s[8:11],s80 offen offset:1024 sc1
buffer_load_dwordx4 v[48:51],v1,s[8:11],s70 offen offset:1024 sc1
s_sub_u32 s47,s47,1
s_cbranch_scc1 ABORT
s_waitcnt vmcnt(4)
v_and_b32 v12,1,v32
v_cmp_ne_u32 vcc,s57,v12
s_nop 0
s_cbranch_vccnz ws_200
s_branch wg_204
ws_201:
buffer_load_dwordx4 v[36:39],v1,s[8:11],s70 offen offset:3072 sc1
buffer_load_dwordx4 v[40:43],v1,s[8:11],s71 offen offset:2048 sc1
buffer_load_dwordx4 v[44:47],v1,s[8:11],s80 offen offset:1024 sc1
buffer_load_dwordx4 v[48:51],v1,s[8:11],s70 offen offset:1024 sc1
buffer_load_dwordx4 v[52:55],v1,s[8:11],s71 offen sc1
s_sub_u32 s47,s47,1
s_cbranch_scc1 ABORT
s_waitcnt vmcnt(4)
v_and_b32 v12,1,v36
v_cmp_ne_u32 vcc,s57,v12
s_nop 0
s_cbranch_vccnz ws_201
s_branch wg_205
ws_202:
buffer_load_dwordx4 v[40:43],v1,s[8:11],s71 offen offset:2048 sc1
buffer_load_dwordx4 v[44:47],v1,s[8:11],s80 offen offset:1024 sc1
buffer_load_dwordx4 v[48:51],v1,s[8:11],s70 offen offset:1024 sc1
buffer_load_dwordx4 v[52:55],v1,s[8:11],s71 offen sc1
buffer_load_dwordx4 v[56:59],v1,s[8:11],s71 offen offset:3072 sc1
s_sub_u32 s47,s47,1
s_cbranch_scc1 ABORT
s_waitcnt vmcnt(4)
v_and_b32 v12,1,v40
v_cmp_ne_u32 vcc,s57,v12
s_nop 0
s_cbranch_vccnz ws_202
s_branch wg_206
ws_203:
buffer_load_dwordx4 v[44:47],v1,s[8:11],s80 offen offset:1024 sc1
buffer_load_dwordx4 v[48:51],v1,s[8:11],s70 offen offset:1024 sc1
buffer_load_dwordx4 v[52:55],v1,s[8:11],s71 offen sc1
buffer_load_dwordx4 v[56:59],v1,s[8:11],s71 offen offset:3072 sc1
buffer_load_dwordx4 v[60:63],v1,s[8:11],s80 offen offset:2048 sc1
s_sub_u32 s47,s47,1
s_cbranch_scc1 ABORT
s_waitcnt vmcnt(4)
v_and_b32 v12,1,v44
v_cmp_ne_u32 vcc,s57,v12
s_nop 0
s_cbranch_vccnz ws_203
s_branch wg_207
rd_197x:
s_sub_u32 s47,s47,1
s_cbranch_scc1 ABORT
s_waitcnt lgkmcnt(0)
s_nop 7
ds_read_b128 v[100:103],v4 offset:0
ds_read_b128 v[104:107],v4 offset:1024
ds_read_b128 v[108:111],v4 offset:6144
ds_read_b128 v[112:115],v4 offset:7168
s_branch rd_197
CW_DONE:
s_add_u32 s61,s48,48
s_endpgm
DISPATCH:
s_sub_u32 s48,s3,0
s_cmp_lt_u32 s3,8
s_cbranch_scc1 ROLE_CW
s_sub_u32 s48,s3,8
s_cmp_lt_u32 s3,16
s_cbranch_scc1 ROLE_CV
s_sub_u32 s48,s3,16
s_cmp_lt_u32 s3,32
s_cbranch_scc1 ROLE_CS
s_sub_u32 s48,s3,24
s_cmp_lt_u32 s3,40
s_cbranch_scc1 ROLE_CW
s_sub_u32 s48,s3,32
s_cmp_lt_u32 s3,48
s_cbranch_scc1 ROLE_CV
s_sub_u32 s48,s3,32
s_cmp_lt_u32 s3,64
s_cbranch_scc1 ROLE_CS
s_sub_u32 s48,s3,64
s_cmp_lt_u32 s3,69
s_cbranch_scc1 ROLE_W1
s_sub_u32 s48,s3,69
s_cmp_lt_u32 s3,74
s_cbranch_scc1 ROLE_W2
s_sub_u32 s48,s3,74
s_cmp_lt_u32 s3,86
s_cbranch_scc1 ROLE_W3
s_sub_u32 s48,s3,86
s_cmp_lt_u32 s3,96
s_cbranch_scc1 ROLE_W4
s_sub_u32 s48,s3,96
s_cmp_lt_u32 s3,108
s_cbranch_scc1 ROLE_QKVQ
s_sub_u32 s48,s3,108
s_cmp_lt_u32 s3,116
s_cbranch_scc1 ROLE_QKVV
s_sub_u32 s48,s3,116
s_cmp_lt_u32 s3,128
s_cbranch_scc1 ROLE_R1
s_sub_u32 s48,s3,120
s_cmp_lt_u32 s3,132
s_cbranch_scc1 ROLE_QKVV
s_sub_u32 s48,s3,120
s_cmp_lt_u32 s3,141
s_cbranch_scc1 ROLE_QKVQ
s_sub_u32 s48,s3,141
s_cmp_lt_u32 s3,149
s_cbranch_scc1 ROLE_ATT
s_sub_u32 s48,s3,149
s_cmp_lt_u32 s3,159
s_cbranch_scc1 ROLE_WO
s_sub_u32 s48,s3,147
s_cmp_lt_u32 s3,160
s_cbranch_scc1 ROLE_R1
s_sub_u32 s48,s3,148
s_cmp_lt_u32 s3,164
s_cbranch_scc1 ROLE_QKVV
s_sub_u32 s48,s3,143
s_cmp_lt_u32 s3,173
s_cbranch_scc1 ROLE_QKVQ
s_sub_u32 s48,s3,165
s_cmp_lt_u32 s3,181
s_cbranch_scc1 ROLE_ATT
s_sub_u32 s48,s3,171
s_cmp_lt_u32 s3,191
s_cbranch_scc1 ROLE_WO
s_sub_u32 s48,s3,178
s_cmp_lt_u32 s3,192
s_cbranch_scc1 ROLE_R1
s_sub_u32 s48,s3,176
s_cmp_lt_u32 s3,196
s_cbranch_scc1 ROLE_QKVV
s_sub_u32 s48,s3,166
s_cmp_lt_u32 s3,205
s_cbranch_scc1 ROLE_QKVQ
s_sub_u32 s48,s3,189
s_cmp_lt_u32 s3,213
s_cbranch_scc1 ROLE_ATT
s_sub_u32 s48,s3,193
s_cmp_lt_u32 s3,223
s_cbranch_scc1 ROLE_WO
s_sub_u32 s48,s3,209
s_cmp_lt_u32 s3,224
s_cbranch_scc1 ROLE_R1
s_sub_u32 s48,s3,204
s_cmp_lt_u32 s3,228
s_cbranch_scc1 ROLE_QKVV
s_sub_u32 s48,s3,189
s_cmp_lt_u32 s3,237
s_cbranch_scc1 ROLE_QKVQ
s_sub_u32 s48,s3,213
s_cmp_lt_u32 s3,245
s_cbranch_scc1 ROLE_ATT
s_sub_u32 s48,s3,215
s_cmp_lt_u32 s3,255
s_cbranch_scc1 ROLE_WO
s_sub_u32 s48,s3,240
s_cmp_lt_u32 s3,256
s_cbranch_scc1 ROLE_R1
s_branch ROLE_SPARE
EXIT:
s_endpgm
ABORT:
s_mov_b64 exec,1
v_mov_b32 v1,s2
v_add_u32 v1,0x10000,v1
v_mov_b32 v2,8
buffer_store_dword v1,v2,s[12:15],0 offen
s_endpgm
ROLE_SPARE:
s_waitcnt vmcnt(0)
s_barrier
s_cmp_lg_u32 s46,0
s_cbranch_scc1 arr_208
v_mov_b32 v12,1
s_lshl_b32 s3,s49,2
v_mov_b32 v13,s3
s_mov_b64 exec,1
buffer_atomic_add v12,v13,s[12:15],0 offen sc1
s_mov_b64 exec,-1
arr_208:
s_lshl_b32 s3,s49,2
v_mov_b32 v13,s3
s_nop 1
ibw_209:
buffer_load_dword v12,v13,s[12:15],0 offen sc1
s_waitcnt vmcnt(0)
v_cmp_ne_u32 vcc,256,v12
s_nop 0
s_cbranch_vccz ok_210
s_sleep 8
s_sub_u32 s47,s47,1
s_cbranch_scc1 ABORT
s_branch ibw_209
ok_210:
s_cmp_lg_u32 s49,0
s_cbranch_scc1 ibok_211
v_and_b32 v13,7,v0
v_lshlrev_b32 v13,2,v13
buffer_load_dword v12,v13,s[12:15],0 offen offset:32 sc1
s_waitcnt vmcnt(0)
v_cmp_ne_u32 vcc,32,v12
s_nop 0
s_cbranch_vccz ibok_211
s_barrier
s_mov_b32 s49,1
s_mov_b32 s3,s2
s_load_dwordx16 s[16:31],s[0:1],0
s_load_dwordx8 s[32:39],s[0:1],64
s_waitcnt lgkmcnt(0)
s_branch DISPATCH
ibok_211:
s_endpgm
ROLE_QKVQ:
v_lshlrev_b32 v1,4,v0
v_mov_b32 v5,1
s_lshl_b32 s56,s48,2
s_add_u32 s56,s56,s46
v_bfe_u32 v6,v0,2,2
v_lshrrev_b32 v7,4,v0
v_add_u32 v7,v6,v7
v_and_b32 v7,3,v7
v_and_b32 v15,3,v0
v_lshlrev_b32 v15,4,v15
v_lshl_add_u32 v15,v7,6,v15
v_lshl_add_u32 v15,v6,8,v15
v_lshrrev_b32 v6,5,v0
v_bfe_u32 v7,v0,4,1
v_lshlrev_b32 v16,10,v7
v_bfe_u32 v7,v0,2,2
v_lshl_add_u32 v16,v7,8,v16
v_add_u32 v6,v6,v7
v_and_b32 v6,3,v6
v_lshl_add_u32 v16,v6,6,v16
v_and_b32 v6,3,v0
v_lshl_add_u32 v16,v6,4,v16
v_add_u32 v18,46080,v16
v_lshrrev_b32 v6,5,v0
v_bfe_u32 v7,v0,4,1
v_lshlrev_b32 v20,10,v7
v_lshl_add_u32 v20,v6,8,v20
v_and_b32 v6,15,v0
v_lshl_add_u32 v20,v6,4,v20
v_lshrrev_b32 v6,5,v0
v_add_u32 v6,2,v6
v_bfe_u32 v7,v0,4,1
v_lshlrev_b32 v17,10,v7
v_bfe_u32 v7,v0,2,2
v_lshl_add_u32 v17,v7,8,v17
v_add_u32 v6,v6,v7
v_and_b32 v6,3,v6
v_lshl_add_u32 v17,v6,6,v17
v_and_b32 v6,3,v0
v_lshl_add_u32 v17,v6,4,v17
v_add_u32 v19,46080,v17
v_lshrrev_b32 v6,5,v0
v_add_u32 v6,2,v6
v_bfe_u32 v7,v0,4,1
v_lshlrev_b32 v21,10,v7
v_lshl_add_u32 v21,v6,8,v21
v_and_b32 v6,15,v0
v_lshl_add_u32 v21,v6,4,v21
s_cmp_ge_u32 s48,24
s_cselect_b32 s68,1,0
s_mul_i32 s60,s68,96
s_sub_u32 s69,s56,s60
s_mul_i32 s70,s68,50331648
s_add_u32 s70,s70,74448896
s_mul_i32 s60,s68,65536
s_sub_u32 s71,131072,s60
s_lshl_b32 s60,s69,12
s_add_u32 s70,s70,s60
v_lshrrev_b32 v6,5,v0
v_mul_u32_u24 v188,2560,v6
v_and_b32 v6,31,v0
v_lshl_add_u32 v188,v6,3,v188
v_add_u32 v188,0xa000,v188
v_min_u32 v4,7,v0
v_lshlrev_b32 v4,2,v4
v_min_u32 v2,39,v0
v_lshlrev_b32 v2,2,v2
v_mov_b32 v12,93184
s_waitcnt vmcnt(0)
s_barrier
s_cmp_lg_u32 s46,0
s_cbranch_scc1 arr_212
v_mov_b32 v6,1
s_lshl_b32 s3,s49,2
v_mov_b32 v7,s3
s_mov_b64 exec,1
buffer_atomic_add v6,v7,s[12:15],0 offen sc1
s_mov_b64 exec,-1
arr_212:
s_lshl_b32 s58,s69,7
v_mov_b32 v24,0x3f803f80
v_mov_b32 v25,0x3f803f80
v_mov_b32 v26,0x3f803f80
v_mov_b32 v27,0x3f803f80
s_mul_i32 s63,s46,40960
s_cmp_eq_u32 s68,0
s_cselect_b32 s4,s22,s20
s_cselect_b32 s5,s23,s21
s_mov_b32 s6,7864320
s_mov_b32 s7,0x20000
v_lshrrev_b32 v9,3,v0
s_mov_b32 s64,12288
v_mul_lo_u32 v9,v9,s64
v_and_b32 v10,7,v0
v_lshl_add_u32 v6,v10,4,v9
s_add_u32 m0,s63,0
s_add_u32 s65,s58,0
buffer_load_dwordx4 v6,s[4:7],s65 offen lds
s_add_u32 m0,s63,1024
s_add_u32 s65,s58,98304
buffer_load_dwordx4 v6,s[4:7],s65 offen lds
s_add_u32 m0,s63,2048
s_add_u32 s65,s58,196608
buffer_load_dwordx4 v6,s[4:7],s65 offen lds
s_add_u32 m0,s63,3072
s_add_u32 s65,s58,294912
buffer_load_dwordx4 v6,s[4:7],s65 offen lds
s_add_u32 m0,s63,4096
s_add_u32 s65,s58,393216
buffer_load_dwordx4 v6,s[4:7],s65 offen lds
s_add_u32 m0,s63,5120
s_add_u32 s65,s58,491520
buffer_load_dwordx4 v6,s[4:7],s65 offen lds
s_add_u32 m0,s63,6144
s_add_u32 s65,s58,589824
buffer_load_dwordx4 v6,s[4:7],s65 offen lds
s_add_u32 m0,s63,7168
s_add_u32 s65,s58,688128
buffer_load_dwordx4 v6,s[4:7],s65 offen lds
s_add_u32 m0,s63,8192
s_add_u32 s65,s58,786432
buffer_load_dwordx4 v6,s[4:7],s65 offen lds
s_add_u32 m0,s63,9216
s_add_u32 s65,s58,884736
buffer_load_dwordx4 v6,s[4:7],s65 offen lds
s_add_u32 m0,s63,10240
s_add_u32 s65,s58,983040
buffer_load_dwordx4 v6,s[4:7],s65 offen lds
s_add_u32 m0,s63,11264
s_add_u32 s65,s58,1081344
buffer_load_dwordx4 v6,s[4:7],s65 offen lds
s_add_u32 m0,s63,12288
s_add_u32 s65,s58,1179648
buffer_load_dwordx4 v6,s[4:7],s65 offen lds
s_add_u32 m0,s63,13312
s_add_u32 s65,s58,1277952
buffer_load_dwordx4 v6,s[4:7],s65 offen lds
s_add_u32 m0,s63,14336
s_add_u32 s65,s58,1376256
buffer_load_dwordx4 v6,s[4:7],s65 offen lds
s_add_u32 m0,s63,15360
s_add_u32 s65,s58,1474560
buffer_load_dwordx4 v6,s[4:7],s65 offen lds
s_add_u32 m0,s63,16384
s_add_u32 s65,s58,1572864
buffer_load_dwordx4 v6,s[4:7],s65 offen lds
s_add_u32 m0,s63,17408
s_add_u32 s65,s58,1671168
buffer_load_dwordx4 v6,s[4:7],s65 offen lds
s_add_u32 m0,s63,18432
s_add_u32 s65,s58,1769472
buffer_load_dwordx4 v6,s[4:7],s65 offen lds
s_add_u32 m0,s63,19456
s_add_u32 s65,s58,1867776
buffer_load_dwordx4 v6,s[4:7],s65 offen lds
s_add_u32 m0,s63,20480
s_add_u32 s65,s58,1966080
buffer_load_dwordx4 v6,s[4:7],s65 offen lds
s_add_u32 m0,s63,21504
s_add_u32 s65,s58,2064384
buffer_load_dwordx4 v6,s[4:7],s65 offen lds
s_add_u32 m0,s63,22528
s_add_u32 s65,s58,2162688
buffer_load_dwordx4 v6,s[4:7],s65 offen lds
s_add_u32 m0,s63,23552
s_add_u32 s65,s58,2260992
buffer_load_dwordx4 v6,s[4:7],s65 offen lds
s_add_u32 m0,s63,24576
s_add_u32 s65,s58,2359296
buffer_load_dwordx4 v6,s[4:7],s65 offen lds
s_add_u32 m0,s63,25600
s_add_u32 s65,s58,2457600
buffer_load_dwordx4 v6,s[4:7],s65 offen lds
s_add_u32 m0,s63,26624
s_add_u32 s65,s58,2555904
buffer_load_dwordx4 v6,s[4:7],s65 offen lds
s_add_u32 m0,s63,27648
s_add_u32 s65,s58,2654208
buffer_load_dwordx4 v6,s[4:7],s65 offen lds
s_add_u32 m0,s63,28672
s_add_u32 s65,s58,2752512
buffer_load_dwordx4 v6,s[4:7],s65 offen lds
s_add_u32 m0,s63,29696
s_add_u32 s65,s58,2850816
buffer_load_dwordx4 v6,s[4:7],s65 offen lds
s_add_u32 m0,s63,30720
s_add_u32 s65,s58,2949120
buffer_load_dwordx4 v6,s[4:7],s65 offen lds
s_add_u32 m0,s63,31744
s_add_u32 s65,s58,3047424
buffer_load_dwordx4 v6,s[4:7],s65 offen lds
s_add_u32 m0,s63,32768
s_add_u32 s65,s58,3145728
buffer_load_dwordx4 v6,s[4:7],s65 offen lds
s_add_u32 m0,s63,33792
s_add_u32 s65,s58,3244032
buffer_load_dwordx4 v6,s[4:7],s65 offen lds
s_add_u32 m0,s63,34816
s_add_u32 s65,s58,3342336
buffer_load_dwordx4 v6,s[4:7],s65 offen lds
s_add_u32 m0,s63,35840
s_add_u32 s65,s58,3440640
buffer_load_dwordx4 v6,s[4:7],s65 offen lds
s_add_u32 m0,s63,36864
s_add_u32 s65,s58,3538944
buffer_load_dwordx4 v6,s[4:7],s65 offen lds
s_add_u32 m0,s63,37888
s_add_u32 s65,s58,3637248
buffer_load_dwordx4 v6,s[4:7],s65 offen lds
s_add_u32 m0,s63,38912
s_add_u32 s65,s58,3735552
buffer_load_dwordx4 v6,s[4:7],s65 offen lds
s_add_u32 m0,s63,39936
s_add_u32 s65,s58,3833856
buffer_load_dwordx4 v6,s[4:7],s65 offen lds
s_waitcnt vmcnt(20)
v_bfe_u32 v9,v0,2,2
v_lshrrev_b32 v10,5,v0
v_lshl_add_u32 v9,v10,2,v9
v_mul_u32_u24 v9,128,v9
v_and_b32 v10,1,v0
v_lshl_add_u32 v9,v10,3,v9
v_bfe_u32 v10,v0,1,1
v_lshl_add_u32 v9,v10,5,v9
v_bfe_u32 v10,v0,4,1
v_lshl_add_u32 v9,v10,4,v9
v_add_u32 v7,s63,v9
ds_read_b64_tr_b16 a[0:1],v7 offset:0
ds_read_b64_tr_b16 a[2:3],v7 offset:2048
ds_read_b64_tr_b16 a[4:5],v7 offset:1024
ds_read_b64_tr_b16 a[6:7],v7 offset:3072
ds_read_b64_tr_b16 a[160:161],v7 offset:64
ds_read_b64_tr_b16 a[162:163],v7 offset:2112
ds_read_b64_tr_b16 a[164:165],v7 offset:1088
ds_read_b64_tr_b16 a[166:167],v7 offset:3136
ds_read_b64_tr_b16 a[8:9],v7 offset:4096
ds_read_b64_tr_b16 a[10:11],v7 offset:6144
ds_read_b64_tr_b16 a[12:13],v7 offset:5120
ds_read_b64_tr_b16 a[14:15],v7 offset:7168
s_waitcnt lgkmcnt(4)
ds_read_b64_tr_b16 a[168:169],v7 offset:4160
ds_read_b64_tr_b16 a[170:171],v7 offset:6208
ds_read_b64_tr_b16 a[172:173],v7 offset:5184
ds_read_b64_tr_b16 a[174:175],v7 offset:7232
ds_read_b64_tr_b16 a[16:17],v7 offset:8192
ds_read_b64_tr_b16 a[18:19],v7 offset:10240
ds_read_b64_tr_b16 a[20:21],v7 offset:9216
ds_read_b64_tr_b16 a[22:23],v7 offset:11264
ds_read_b64_tr_b16 a[176:177],v7 offset:8256
ds_read_b64_tr_b16 a[178:179],v7 offset:10304
ds_read_b64_tr_b16 a[180:181],v7 offset:9280
ds_read_b64_tr_b16 a[182:183],v7 offset:11328
s_waitcnt lgkmcnt(4)
ds_read_b64_tr_b16 a[24:25],v7 offset:12288
ds_read_b64_tr_b16 a[26:27],v7 offset:14336
ds_read_b64_tr_b16 a[28:29],v7 offset:13312
ds_read_b64_tr_b16 a[30:31],v7 offset:15360
ds_read_b64_tr_b16 a[184:185],v7 offset:12352
ds_read_b64_tr_b16 a[186:187],v7 offset:14400
ds_read_b64_tr_b16 a[188:189],v7 offset:13376
ds_read_b64_tr_b16 a[190:191],v7 offset:15424
ds_read_b64_tr_b16 a[32:33],v7 offset:16384
ds_read_b64_tr_b16 a[34:35],v7 offset:18432
ds_read_b64_tr_b16 a[36:37],v7 offset:17408
ds_read_b64_tr_b16 a[38:39],v7 offset:19456
s_waitcnt lgkmcnt(4)
ds_read_b64_tr_b16 a[192:193],v7 offset:16448
ds_read_b64_tr_b16 a[194:195],v7 offset:18496
ds_read_b64_tr_b16 a[196:197],v7 offset:17472
ds_read_b64_tr_b16 a[198:199],v7 offset:19520
s_waitcnt lgkmcnt(0)
s_add_u32 m0,s63,0
s_add_u32 s65,s58,3932160
buffer_load_dwordx4 v6,s[4:7],s65 offen lds
s_add_u32 m0,s63,1024
s_add_u32 s65,s58,4030464
buffer_load_dwordx4 v6,s[4:7],s65 offen lds
s_add_u32 m0,s63,2048
s_add_u32 s65,s58,4128768
buffer_load_dwordx4 v6,s[4:7],s65 offen lds
s_add_u32 m0,s63,3072
s_add_u32 s65,s58,4227072
buffer_load_dwordx4 v6,s[4:7],s65 offen lds
s_add_u32 m0,s63,4096
s_add_u32 s65,s58,4325376
buffer_load_dwordx4 v6,s[4:7],s65 offen lds
s_add_u32 m0,s63,5120
s_add_u32 s65,s58,4423680
buffer_load_dwordx4 v6,s[4:7],s65 offen lds
s_add_u32 m0,s63,6144
s_add_u32 s65,s58,4521984
buffer_load_dwordx4 v6,s[4:7],s65 offen lds
s_add_u32 m0,s63,7168
s_add_u32 s65,s58,4620288
buffer_load_dwordx4 v6,s[4:7],s65 offen lds
s_add_u32 m0,s63,8192
s_add_u32 s65,s58,4718592
buffer_load_dwordx4 v6,s[4:7],s65 offen lds
s_add_u32 m0,s63,9216
s_add_u32 s65,s58,4816896
buffer_load_dwordx4 v6,s[4:7],s65 offen lds
s_add_u32 m0,s63,10240
s_add_u32 s65,s58,4915200
buffer_load_dwordx4 v6,s[4:7],s65 offen lds
s_add_u32 m0,s63,11264
s_add_u32 s65,s58,5013504
buffer_load_dwordx4 v6,s[4:7],s65 offen lds
s_add_u32 m0,s63,12288
s_add_u32 s65,s58,5111808
buffer_load_dwordx4 v6,s[4:7],s65 offen lds
s_add_u32 m0,s63,13312
s_add_u32 s65,s58,5210112
buffer_load_dwordx4 v6,s[4:7],s65 offen lds
s_add_u32 m0,s63,14336
s_add_u32 s65,s58,5308416
buffer_load_dwordx4 v6,s[4:7],s65 offen lds
s_add_u32 m0,s63,15360
s_add_u32 s65,s58,5406720
buffer_load_dwordx4 v6,s[4:7],s65 offen lds
s_add_u32 m0,s63,16384
s_add_u32 s65,s58,5505024
buffer_load_dwordx4 v6,s[4:7],s65 offen lds
s_add_u32 m0,s63,17408
s_add_u32 s65,s58,5603328
buffer_load_dwordx4 v6,s[4:7],s65 offen lds
s_add_u32 m0,s63,18432
s_add_u32 s65,s58,5701632
buffer_load_dwordx4 v6,s[4:7],s65 offen lds
s_add_u32 m0,s63,19456
s_add_u32 s65,s58,5799936
buffer_load_dwordx4 v6,s[4:7],s65 offen lds
v_mfma_f32_32x32x16_bf16 v[120:135],a[0:3],v[24:27],0
v_mfma_f32_32x32x16_bf16 v[136:151],a[160:163],v[24:27],0
v_mfma_f32_32x32x16_bf16 v[120:135],a[4:7],v[24:27],v[120:135]
v_mfma_f32_32x32x16_bf16 v[136:151],a[164:167],v[24:27],v[136:151]
v_mfma_f32_32x32x16_bf16 v[120:135],a[8:11],v[24:27],v[120:135]
v_mfma_f32_32x32x16_bf16 v[136:151],a[168:171],v[24:27],v[136:151]
v_mfma_f32_32x32x16_bf16 v[120:135],a[12:15],v[24:27],v[120:135]
v_mfma_f32_32x32x16_bf16 v[136:151],a[172:175],v[24:27],v[136:151]
v_mfma_f32_32x32x16_bf16 v[120:135],a[16:19],v[24:27],v[120:135]
v_mfma_f32_32x32x16_bf16 v[136:151],a[176:179],v[24:27],v[136:151]
v_mfma_f32_32x32x16_bf16 v[120:135],a[20:23],v[24:27],v[120:135]
v_mfma_f32_32x32x16_bf16 v[136:151],a[180:183],v[24:27],v[136:151]
v_mfma_f32_32x32x16_bf16 v[120:135],a[24:27],v[24:27],v[120:135]
v_mfma_f32_32x32x16_bf16 v[136:151],a[184:187],v[24:27],v[136:151]
v_mfma_f32_32x32x16_bf16 v[120:135],a[28:31],v[24:27],v[120:135]
v_mfma_f32_32x32x16_bf16 v[136:151],a[188:191],v[24:27],v[136:151]
v_mfma_f32_32x32x16_bf16 v[120:135],a[32:35],v[24:27],v[120:135]
v_mfma_f32_32x32x16_bf16 v[136:151],a[192:195],v[24:27],v[136:151]
v_mfma_f32_32x32x16_bf16 v[120:135],a[36:39],v[24:27],v[120:135]
v_mfma_f32_32x32x16_bf16 v[136:151],a[196:199],v[24:27],v[136:151]
s_waitcnt vmcnt(20)
v_bfe_u32 v9,v0,2,2
v_lshrrev_b32 v10,5,v0
v_lshl_add_u32 v9,v10,2,v9
v_mul_u32_u24 v9,128,v9
v_and_b32 v10,1,v0
v_lshl_add_u32 v9,v10,3,v9
v_bfe_u32 v10,v0,1,1
v_lshl_add_u32 v9,v10,5,v9
v_bfe_u32 v10,v0,4,1
v_lshl_add_u32 v9,v10,4,v9
v_add_u32 v7,s63,v9
ds_read_b64_tr_b16 a[40:41],v7 offset:20480
ds_read_b64_tr_b16 a[42:43],v7 offset:22528
ds_read_b64_tr_b16 a[44:45],v7 offset:21504
ds_read_b64_tr_b16 a[46:47],v7 offset:23552
ds_read_b64_tr_b16 a[200:201],v7 offset:20544
ds_read_b64_tr_b16 a[202:203],v7 offset:22592
ds_read_b64_tr_b16 a[204:205],v7 offset:21568
ds_read_b64_tr_b16 a[206:207],v7 offset:23616
ds_read_b64_tr_b16 a[48:49],v7 offset:24576
ds_read_b64_tr_b16 a[50:51],v7 offset:26624
ds_read_b64_tr_b16 a[52:53],v7 offset:25600
ds_read_b64_tr_b16 a[54:55],v7 offset:27648
s_waitcnt lgkmcnt(4)
ds_read_b64_tr_b16 a[208:209],v7 offset:24640
ds_read_b64_tr_b16 a[210:211],v7 offset:26688
ds_read_b64_tr_b16 a[212:213],v7 offset:25664
ds_read_b64_tr_b16 a[214:215],v7 offset:27712
ds_read_b64_tr_b16 a[56:57],v7 offset:28672
ds_read_b64_tr_b16 a[58:59],v7 offset:30720
ds_read_b64_tr_b16 a[60:61],v7 offset:29696
ds_read_b64_tr_b16 a[62:63],v7 offset:31744
ds_read_b64_tr_b16 a[216:217],v7 offset:28736
ds_read_b64_tr_b16 a[218:219],v7 offset:30784
ds_read_b64_tr_b16 a[220:221],v7 offset:29760
ds_read_b64_tr_b16 a[222:223],v7 offset:31808
s_waitcnt lgkmcnt(4)
ds_read_b64_tr_b16 a[64:65],v7 offset:32768
ds_read_b64_tr_b16 a[66:67],v7 offset:34816
ds_read_b64_tr_b16 a[68:69],v7 offset:33792
ds_read_b64_tr_b16 a[70:71],v7 offset:35840
ds_read_b64_tr_b16 a[224:225],v7 offset:32832
ds_read_b64_tr_b16 a[226:227],v7 offset:34880
ds_read_b64_tr_b16 a[228:229],v7 offset:33856
ds_read_b64_tr_b16 a[230:231],v7 offset:35904
ds_read_b64_tr_b16 a[72:73],v7 offset:36864
ds_read_b64_tr_b16 a[74:75],v7 offset:38912
ds_read_b64_tr_b16 a[76:77],v7 offset:37888
ds_read_b64_tr_b16 a[78:79],v7 offset:39936
s_waitcnt lgkmcnt(4)
ds_read_b64_tr_b16 a[232:233],v7 offset:36928
ds_read_b64_tr_b16 a[234:235],v7 offset:38976
ds_read_b64_tr_b16 a[236:237],v7 offset:37952
ds_read_b64_tr_b16 a[238:239],v7 offset:40000
s_waitcnt lgkmcnt(0)
s_add_u32 m0,s63,20480
s_add_u32 s65,s58,5898240
buffer_load_dwordx4 v6,s[4:7],s65 offen lds
s_add_u32 m0,s63,21504
s_add_u32 s65,s58,5996544
buffer_load_dwordx4 v6,s[4:7],s65 offen lds
s_add_u32 m0,s63,22528
s_add_u32 s65,s58,6094848
buffer_load_dwordx4 v6,s[4:7],s65 offen lds
s_add_u32 m0,s63,23552
s_add_u32 s65,s58,6193152
buffer_load_dwordx4 v6,s[4:7],s65 offen lds
s_add_u32 m0,s63,24576
s_add_u32 s65,s58,6291456
buffer_load_dwordx4 v6,s[4:7],s65 offen lds
s_add_u32 m0,s63,25600
s_add_u32 s65,s58,6389760
buffer_load_dwordx4 v6,s[4:7],s65 offen lds
s_add_u32 m0,s63,26624
s_add_u32 s65,s58,6488064
buffer_load_dwordx4 v6,s[4:7],s65 offen lds
s_add_u32 m0,s63,27648
s_add_u32 s65,s58,6586368
buffer_load_dwordx4 v6,s[4:7],s65 offen lds
s_add_u32 m0,s63,28672
s_add_u32 s65,s58,6684672
buffer_load_dwordx4 v6,s[4:7],s65 offen lds
s_add_u32 m0,s63,29696
s_add_u32 s65,s58,6782976
buffer_load_dwordx4 v6,s[4:7],s65 offen lds
s_add_u32 m0,s63,30720
s_add_u32 s65,s58,6881280
buffer_load_dwordx4 v6,s[4:7],s65 offen lds
s_add_u32 m0,s63,31744
s_add_u32 s65,s58,6979584
buffer_load_dwordx4 v6,s[4:7],s65 offen lds
s_add_u32 m0,s63,32768
s_add_u32 s65,s58,7077888
buffer_load_dwordx4 v6,s[4:7],s65 offen lds
s_add_u32 m0,s63,33792
s_add_u32 s65,s58,7176192
buffer_load_dwordx4 v6,s[4:7],s65 offen lds
s_add_u32 m0,s63,34816
s_add_u32 s65,s58,7274496
buffer_load_dwordx4 v6,s[4:7],s65 offen lds
s_add_u32 m0,s63,35840
s_add_u32 s65,s58,7372800
buffer_load_dwordx4 v6,s[4:7],s65 offen lds
s_add_u32 m0,s63,36864
s_add_u32 s65,s58,7471104
buffer_load_dwordx4 v6,s[4:7],s65 offen lds
s_add_u32 m0,s63,37888
s_add_u32 s65,s58,7569408
buffer_load_dwordx4 v6,s[4:7],s65 offen lds
s_add_u32 m0,s63,38912
s_add_u32 s65,s58,7667712
buffer_load_dwordx4 v6,s[4:7],s65 offen lds
s_add_u32 m0,s63,39936
s_add_u32 s65,s58,7766016
buffer_load_dwordx4 v6,s[4:7],s65 offen lds
v_mfma_f32_32x32x16_bf16 v[120:135],a[40:43],v[24:27],v[120:135]
v_mfma_f32_32x32x16_bf16 v[136:151],a[200:203],v[24:27],v[136:151]
v_mfma_f32_32x32x16_bf16 v[120:135],a[44:47],v[24:27],v[120:135]
v_mfma_f32_32x32x16_bf16 v[136:151],a[204:207],v[24:27],v[136:151]
v_mfma_f32_32x32x16_bf16 v[120:135],a[48:51],v[24:27],v[120:135]
v_mfma_f32_32x32x16_bf16 v[136:151],a[208:211],v[24:27],v[136:151]
v_mfma_f32_32x32x16_bf16 v[120:135],a[52:55],v[24:27],v[120:135]
v_mfma_f32_32x32x16_bf16 v[136:151],a[212:215],v[24:27],v[136:151]
v_mfma_f32_32x32x16_bf16 v[120:135],a[56:59],v[24:27],v[120:135]
v_mfma_f32_32x32x16_bf16 v[136:151],a[216:219],v[24:27],v[136:151]
v_mfma_f32_32x32x16_bf16 v[120:135],a[60:63],v[24:27],v[120:135]
v_mfma_f32_32x32x16_bf16 v[136:151],a[220:223],v[24:27],v[136:151]
v_mfma_f32_32x32x16_bf16 v[120:135],a[64:67],v[24:27],v[120:135]
v_mfma_f32_32x32x16_bf16 v[136:151],a[224:227],v[24:27],v[136:151]
v_mfma_f32_32x32x16_bf16 v[120:135],a[68:71],v[24:27],v[120:135]
v_mfma_f32_32x32x16_bf16 v[136:151],a[228:231],v[24:27],v[136:151]
v_mfma_f32_32x32x16_bf16 v[120:135],a[72:75],v[24:27],v[120:135]
v_mfma_f32_32x32x16_bf16 v[136:151],a[232:235],v[24:27],v[136:151]
v_mfma_f32_32x32x16_bf16 v[120:135],a[76:79],v[24:27],v[120:135]
v_mfma_f32_32x32x16_bf16 v[136:151],a[236:239],v[24:27],v[136:151]
s_waitcnt vmcnt(20)
v_bfe_u32 v9,v0,2,2
v_lshrrev_b32 v10,5,v0
v_lshl_add_u32 v9,v10,2,v9
v_mul_u32_u24 v9,128,v9
v_and_b32 v10,1,v0
v_lshl_add_u32 v9,v10,3,v9
v_bfe_u32 v10,v0,1,1
v_lshl_add_u32 v9,v10,5,v9
v_bfe_u32 v10,v0,4,1
v_lshl_add_u32 v9,v10,4,v9
v_add_u32 v7,s63,v9
ds_read_b64_tr_b16 a[80:81],v7 offset:0
ds_read_b64_tr_b16 a[82:83],v7 offset:2048
ds_read_b64_tr_b16 a[84:85],v7 offset:1024
ds_read_b64_tr_b16 a[86:87],v7 offset:3072
ds_read_b64_tr_b16 a[240:241],v7 offset:64
ds_read_b64_tr_b16 a[242:243],v7 offset:2112
ds_read_b64_tr_b16 a[244:245],v7 offset:1088
ds_read_b64_tr_b16 a[246:247],v7 offset:3136
ds_read_b64_tr_b16 a[88:89],v7 offset:4096
ds_read_b64_tr_b16 a[90:91],v7 offset:6144
ds_read_b64_tr_b16 a[92:93],v7 offset:5120
ds_read_b64_tr_b16 a[94:95],v7 offset:7168
s_waitcnt lgkmcnt(4)
ds_read_b64_tr_b16 a[248:249],v7 offset:4160
ds_read_b64_tr_b16 a[250:251],v7 offset:6208
ds_read_b64_tr_b16 a[252:253],v7 offset:5184
ds_read_b64_tr_b16 a[254:255],v7 offset:7232
ds_read_b64_tr_b16 a[96:97],v7 offset:8192
ds_read_b64_tr_b16 a[98:99],v7 offset:10240
ds_read_b64_tr_b16 a[100:101],v7 offset:9216
ds_read_b64_tr_b16 a[102:103],v7 offset:11264
ds_read_b64_tr_b16 v[192:193],v7 offset:8256
ds_read_b64_tr_b16 v[194:195],v7 offset:10304
ds_read_b64_tr_b16 v[196:197],v7 offset:9280
ds_read_b64_tr_b16 v[198:199],v7 offset:11328
s_waitcnt lgkmcnt(4)
ds_read_b64_tr_b16 a[104:105],v7 offset:12288
ds_read_b64_tr_b16 a[106:107],v7 offset:14336
ds_read_b64_tr_b16 a[108:109],v7 offset:13312
ds_read_b64_tr_b16 a[110:111],v7 offset:15360
ds_read_b64_tr_b16 v[200:201],v7 offset:12352
ds_read_b64_tr_b16 v[202:203],v7 offset:14400
ds_read_b64_tr_b16 v[204:205],v7 offset:13376
ds_read_b64_tr_b16 v[206:207],v7 offset:15424
ds_read_b64_tr_b16 a[112:113],v7 offset:16384
ds_read_b64_tr_b16 a[114:115],v7 offset:18432
ds_read_b64_tr_b16 a[116:117],v7 offset:17408
ds_read_b64_tr_b16 a[118:119],v7 offset:19456
s_waitcnt lgkmcnt(4)
ds_read_b64_tr_b16 v[208:209],v7 offset:16448
ds_read_b64_tr_b16 v[210:211],v7 offset:18496
ds_read_b64_tr_b16 v[212:213],v7 offset:17472
ds_read_b64_tr_b16 v[214:215],v7 offset:19520
s_waitcnt lgkmcnt(0)
v_mfma_f32_32x32x16_bf16 v[120:135],a[80:83],v[24:27],v[120:135]
v_mfma_f32_32x32x16_bf16 v[136:151],a[240:243],v[24:27],v[136:151]
v_mfma_f32_32x32x16_bf16 v[120:135],a[84:87],v[24:27],v[120:135]
v_mfma_f32_32x32x16_bf16 v[136:151],a[244:247],v[24:27],v[136:151]
v_mfma_f32_32x32x16_bf16 v[120:135],a[88:91],v[24:27],v[120:135]
v_mfma_f32_32x32x16_bf16 v[136:151],a[248:251],v[24:27],v[136:151]
v_mfma_f32_32x32x16_bf16 v[120:135],a[92:95],v[24:27],v[120:135]
v_mfma_f32_32x32x16_bf16 v[136:151],a[252:255],v[24:27],v[136:151]
v_mfma_f32_32x32x16_bf16 v[120:135],a[96:99],v[24:27],v[120:135]
v_mfma_f32_32x32x16_bf16 v[136:151],v[192:195],v[24:27],v[136:151]
v_mfma_f32_32x32x16_bf16 v[120:135],a[100:103],v[24:27],v[120:135]
v_mfma_f32_32x32x16_bf16 v[136:151],v[196:199],v[24:27],v[136:151]
v_mfma_f32_32x32x16_bf16 v[120:135],a[104:107],v[24:27],v[120:135]
v_mfma_f32_32x32x16_bf16 v[136:151],v[200:203],v[24:27],v[136:151]
v_mfma_f32_32x32x16_bf16 v[120:135],a[108:111],v[24:27],v[120:135]
v_mfma_f32_32x32x16_bf16 v[136:151],v[204:207],v[24:27],v[136:151]
v_mfma_f32_32x32x16_bf16 v[120:135],a[112:115],v[24:27],v[120:135]
v_mfma_f32_32x32x16_bf16 v[136:151],v[208:211],v[24:27],v[136:151]
v_mfma_f32_32x32x16_bf16 v[120:135],a[116:119],v[24:27],v[120:135]
v_mfma_f32_32x32x16_bf16 v[136:151],v[212:215],v[24:27],v[136:151]
s_waitcnt vmcnt(0)
v_bfe_u32 v9,v0,2,2
v_lshrrev_b32 v10,5,v0
v_lshl_add_u32 v9,v10,2,v9
v_mul_u32_u24 v9,128,v9
v_and_b32 v10,1,v0
v_lshl_add_u32 v9,v10,3,v9
v_bfe_u32 v10,v0,1,1
v_lshl_add_u32 v9,v10,5,v9
v_bfe_u32 v10,v0,4,1
v_lshl_add_u32 v9,v10,4,v9
v_add_u32 v7,s63,v9
ds_read_b64_tr_b16 a[120:121],v7 offset:20480
ds_read_b64_tr_b16 a[122:123],v7 offset:22528
ds_read_b64_tr_b16 a[124:125],v7 offset:21504
ds_read_b64_tr_b16 a[126:127],v7 offset:23552
ds_read_b64_tr_b16 v[216:217],v7 offset:20544
ds_read_b64_tr_b16 v[218:219],v7 offset:22592
ds_read_b64_tr_b16 v[220:221],v7 offset:21568
ds_read_b64_tr_b16 v[222:223],v7 offset:23616
ds_read_b64_tr_b16 a[128:129],v7 offset:24576
ds_read_b64_tr_b16 a[130:131],v7 offset:26624
ds_read_b64_tr_b16 a[132:133],v7 offset:25600
ds_read_b64_tr_b16 a[134:135],v7 offset:27648
s_waitcnt lgkmcnt(4)
ds_read_b64_tr_b16 v[224:225],v7 offset:24640
ds_read_b64_tr_b16 v[226:227],v7 offset:26688
ds_read_b64_tr_b16 v[228:229],v7 offset:25664
ds_read_b64_tr_b16 v[230:231],v7 offset:27712
ds_read_b64_tr_b16 a[136:137],v7 offset:28672
ds_read_b64_tr_b16 a[138:139],v7 offset:30720
ds_read_b64_tr_b16 a[140:141],v7 offset:29696
ds_read_b64_tr_b16 a[142:143],v7 offset:31744
ds_read_b64_tr_b16 v[232:233],v7 offset:28736
ds_read_b64_tr_b16 v[234:235],v7 offset:30784
ds_read_b64_tr_b16 v[236:237],v7 offset:29760
ds_read_b64_tr_b16 v[238:239],v7 offset:31808
s_waitcnt lgkmcnt(4)
ds_read_b64_tr_b16 a[144:145],v7 offset:32768
ds_read_b64_tr_b16 a[146:147],v7 offset:34816
ds_read_b64_tr_b16 a[148:149],v7 offset:33792
ds_read_b64_tr_b16 a[150:151],v7 offset:35840
ds_read_b64_tr_b16 v[240:241],v7 offset:32832
ds_read_b64_tr_b16 v[242:243],v7 offset:34880
ds_read_b64_tr_b16 v[244:245],v7 offset:33856
ds_read_b64_tr_b16 v[246:247],v7 offset:35904
ds_read_b64_tr_b16 a[152:153],v7 offset:36864
ds_read_b64_tr_b16 a[154:155],v7 offset:38912
ds_read_b64_tr_b16 a[156:157],v7 offset:37888
ds_read_b64_tr_b16 a[158:159],v7 offset:39936
s_waitcnt lgkmcnt(4)
ds_read_b64_tr_b16 v[248:249],v7 offset:36928
ds_read_b64_tr_b16 v[250:251],v7 offset:38976
ds_read_b64_tr_b16 v[252:253],v7 offset:37952
ds_read_b64_tr_b16 v[254:255],v7 offset:40000
s_waitcnt lgkmcnt(0)
v_mfma_f32_32x32x16_bf16 v[120:135],a[120:123],v[24:27],v[120:135]
v_mfma_f32_32x32x16_bf16 v[136:151],v[216:219],v[24:27],v[136:151]
v_mfma_f32_32x32x16_bf16 v[120:135],a[124:127],v[24:27],v[120:135]
v_mfma_f32_32x32x16_bf16 v[136:151],v[220:223],v[24:27],v[136:151]
v_mfma_f32_32x32x16_bf16 v[120:135],a[128:131],v[24:27],v[120:135]
v_mfma_f32_32x32x16_bf16 v[136:151],v[224:227],v[24:27],v[136:151]
v_mfma_f32_32x32x16_bf16 v[120:135],a[132:135],v[24:27],v[120:135]
v_mfma_f32_32x32x16_bf16 v[136:151],v[228:231],v[24:27],v[136:151]
v_mfma_f32_32x32x16_bf16 v[120:135],a[136:139],v[24:27],v[120:135]
v_mfma_f32_32x32x16_bf16 v[136:151],v[232:235],v[24:27],v[136:151]
v_mfma_f32_32x32x16_bf16 v[120:135],a[140:143],v[24:27],v[120:135]
v_mfma_f32_32x32x16_bf16 v[136:151],v[236:239],v[24:27],v[136:151]
v_mfma_f32_32x32x16_bf16 v[120:135],a[144:147],v[24:27],v[120:135]
v_mfma_f32_32x32x16_bf16 v[136:151],v[240:243],v[24:27],v[136:151]
v_mfma_f32_32x32x16_bf16 v[120:135],a[148:151],v[24:27],v[120:135]
v_mfma_f32_32x32x16_bf16 v[136:151],v[244:247],v[24:27],v[136:151]
v_mfma_f32_32x32x16_bf16 v[120:135],a[152:155],v[24:27],v[120:135]
v_mfma_f32_32x32x16_bf16 v[136:151],v[248:251],v[24:27],v[136:151]
v_mfma_f32_32x32x16_bf16 v[120:135],a[156:159],v[24:27],v[120:135]
v_mfma_f32_32x32x16_bf16 v[136:151],v[252:255],v[24:27],v[136:151]
s_barrier
s_lshl_b32 s3,s49,2
v_mov_b32 v7,s3
s_nop 8
ibw_213:
buffer_load_dword v6,v7,s[12:15],0 offen sc1
s_waitcnt vmcnt(0)
v_cmp_ne_u32 vcc,256,v6
s_nop 0
s_cbranch_vccz ok_214
s_sleep 8
s_sub_u32 s47,s47,1
s_cbranch_scc1 ABORT
s_branch ibw_213
ok_214:
s_cmp_lg_u32 s49,0
s_cbranch_scc1 ibok_215
v_and_b32 v7,7,v0
v_lshlrev_b32 v7,2,v7
buffer_load_dword v6,v7,s[12:15],0 offen offset:32 sc1
s_waitcnt vmcnt(0)
v_cmp_ne_u32 vcc,32,v6
s_nop 0
s_cbranch_vccz ibok_215
s_barrier
s_mov_b32 s49,1
s_mov_b32 s3,s2
s_load_dwordx16 s[16:31],s[0:1],0
s_load_dwordx8 s[32:39],s[0:1],64
s_waitcnt lgkmcnt(0)
s_branch DISPATCH
ibok_215:
s_mov_b32 s50,0
s_mov_b32 s32,0
s_mov_b32 s57,0
s_mov_b32 s59,2147483648
s_mov_b32 s82,2147483648
s_mov_b32 s39,2147483648
v_mov_b32 v22,94208
s_mov_b32 s72,0
s_mov_b32 s73,0
s_mov_b32 s78,0
s_mov_b32 s79,0
s_cmp_eq_u32 s46,0
s_cselect_b32 s40,0,2147483648
s_lshl_b32 s60,s46,3
v_add_u32 v13,s60,v22
s_mov_b32 s83,s100
s_lshl_b32 s41,s78,9
s_add_u32 s41,s41,s40
s_lshl_b32 s35,s79,9
s_add_u32 s35,s35,s40
s_add_u32 s35,s35,32768
s_branch QKVQ_COLD0
QKVQ_B0:
s_waitcnt lgkmcnt(3)
v_mfma_f32_32x32x16_bf16 v[56:71],a[0:3],v[24:27],0
ds_read_b128 v[44:47],v17 offset:4096
v_add_u32 v189,s57,v188
v_mfma_f32_32x32x16_bf16 v[72:87],a[160:163],v[24:27],0
v_add_u32 v8,0x800,v189
s_sub_u32 s66,46080,s57
s_lshl_b32 s60,s33,6
s_add_u32 s60,s60,s34
s_mul_i32 s60,s60,46080
s_add_u32 s60,s60,s37
v_mfma_f32_32x32x16_bf16 v[56:71],a[4:7],v[28:31],v[56:71]
ds_read_b128 v[48:51],v16 offset:6144
ds_read2_b64 v[156:159],v189 offset0:0 offset1:32
s_add_u32 s60,s60,206569472
v_mfma_f32_32x32x16_bf16 v[72:87],a[164:167],v[28:31],v[72:87]
ds_read2_b64 v[160:163],v189 offset0:64 offset1:96
s_cmp_eq_u32 s33,0
s_cselect_b32 s67,2147483648,s60
s_mul_i32 s61,s46,10240
s_waitcnt lgkmcnt(5)
v_mfma_f32_32x32x16_bf16 v[56:71],a[8:11],v[32:35],v[56:71]
ds_read_b128 v[52:55],v17 offset:6144
ds_read2_b64 v[164:167],v189 offset0:128 offset1:160
s_add_u32 s60,s60,s61
s_add_u32 s61,s61,s66
v_mfma_f32_32x32x16_bf16 v[72:87],a[168:171],v[32:35],v[72:87]
ds_read2_b64 v[168:171],v189 offset0:192 offset1:224
s_add_u32 m0,s61,0
s_add_u32 s63,s60,0
buffer_load_dwordx4 v1,s[8:11],s63 offen sc1 lds
v_mfma_f32_32x32x16_bf16 v[56:71],a[12:15],v[36:39],v[56:71]
ds_read_b128 v[24:27],v16 offset:8192
ds_read2_b64 v[172:175],v8 offset0:0 offset1:32
s_mul_i32 s74,s73,393216
s_add_u32 s74,s74,s39
v_mfma_f32_32x32x16_bf16 v[72:87],a[172:175],v[36:39],v[72:87]
s_add_u32 s74,s74,s70
v_fma_f32 v88,-v176,v120,v88
v_fma_f32 v89,-v176,v121,v89
v_fma_f32 v90,-v176,v122,v90
v_fma_f32 v91,-v176,v123,v91
s_waitcnt lgkmcnt(8)
v_mfma_f32_32x32x16_bf16 v[56:71],a[16:19],v[40:43],v[56:71]
ds_read_b128 v[28:31],v17 offset:8192
buffer_load_dwordx4 v1,s[8:11],s63 offen offset:1024 sc1 lds
v_fma_f32 v92,-v176,v124,v92
v_fma_f32 v93,-v176,v125,v93
v_mfma_f32_32x32x16_bf16 v[72:87],a[176:179],v[40:43],v[72:87]
v_fma_f32 v94,-v176,v126,v94
v_fma_f32 v95,-v176,v127,v95
v_mul_f32 v88,v88,v177
v_mul_f32 v89,v89,v177
v_mul_f32 v90,v90,v177
v_mfma_f32_32x32x16_bf16 v[56:71],a[20:23],v[44:47],v[56:71]
ds_read_b128 v[32:35],v16 offset:10240
s_mov_b32 s53,s33
s_mov_b32 s54,s34
s_add_u32 s79,s79,s33
s_or_b32 s65,s37,s33
v_mfma_f32_32x32x16_bf16 v[72:87],a[180:183],v[44:47],v[72:87]
buffer_load_dwordx4 v1,s[8:11],s63 offen offset:2048 sc1 lds
s_cmp_eq_u32 s65,0
s_addc_u32 s78,s78,0
s_lshl_b32 s41,s78,9
s_waitcnt lgkmcnt(6)
v_mfma_f32_32x32x16_bf16 v[56:71],a[24:27],v[48:51],v[56:71]
ds_read_b128 v[36:39],v17 offset:10240
s_add_u32 s41,s41,s40
s_lshl_b32 s35,s79,9
s_add_u32 s35,s35,s40
s_add_u32 s35,s35,32768
v_mfma_f32_32x32x16_bf16 v[72:87],a[184:187],v[48:51],v[72:87]
v_mul_f32 v91,v91,v177
v_mul_f32 v92,v92,v177
v_mul_f32 v93,v93,v177
v_mul_f32 v94,v94,v177
v_mul_f32 v95,v95,v177
v_mfma_f32_32x32x16_bf16 v[56:71],a[28:31],v[52:55],v[56:71]
ds_read_b128 v[40:43],v16 offset:12288
buffer_load_dwordx4 v1,s[8:11],s63 offen offset:3072 sc1 lds
s_add_u32 m0,s61,4096
s_add_u32 s63,s60,4096
v_mfma_f32_32x32x16_bf16 v[72:87],a[188:191],v[52:55],v[72:87]
v_cvt_pk_bf16_f32 v88,v88,v89
v_cvt_pk_bf16_f32 v89,v90,v91
v_cvt_pk_bf16_f32 v90,v92,v93
v_cvt_pk_bf16_f32 v91,v94,v95
v_fma_f32 v96,-v176,v128,v96
s_waitcnt lgkmcnt(3)
v_mfma_f32_32x32x16_bf16 v[56:71],a[32:35],v[24:27],v[56:71]
ds_read_b128 v[44:47],v17 offset:12288
v_fma_f32 v97,-v176,v129,v97
v_fma_f32 v98,-v176,v130,v98
v_fma_f32 v99,-v176,v131,v99
v_fma_f32 v100,-v176,v132,v100
v_mfma_f32_32x32x16_bf16 v[72:87],a[192:195],v[24:27],v[72:87]
buffer_load_dwordx4 v1,s[8:11],s63 offen sc1 lds
v_fma_f32 v101,-v176,v133,v101
v_fma_f32 v102,-v176,v134,v102
v_fma_f32 v103,-v176,v135,v103
v_mul_f32 v96,v96,v177
v_mfma_f32_32x32x16_bf16 v[56:71],a[36:39],v[28:31],v[56:71]
ds_read_b128 v[48:51],v16 offset:14336
v_mul_f32 v97,v97,v177
v_mul_f32 v98,v98,v177
v_mul_f32 v99,v99,v177
v_mul_f32 v100,v100,v177
v_mfma_f32_32x32x16_bf16 v[72:87],a[196:199],v[28:31],v[72:87]
v_mul_f32 v101,v101,v177
v_mul_f32 v102,v102,v177
v_mul_f32 v103,v103,v177
v_cvt_pk_bf16_f32 v96,v96,v97
v_cvt_pk_bf16_f32 v97,v98,v99
s_waitcnt lgkmcnt(3)
v_mfma_f32_32x32x16_bf16 v[56:71],a[40:43],v[32:35],v[56:71]
ds_read_b128 v[52:55],v17 offset:14336
buffer_load_dwordx4 v1,s[8:11],s63 offen offset:1024 sc1 lds
v_cvt_pk_bf16_f32 v98,v100,v101
v_cvt_pk_bf16_f32 v99,v102,v103
v_mfma_f32_32x32x16_bf16 v[72:87],a[200:203],v[32:35],v[72:87]
v_fma_f32 v104,-v176,v136,v104
v_fma_f32 v105,-v176,v137,v105
v_fma_f32 v106,-v176,v138,v106
v_fma_f32 v107,-v176,v139,v107
v_fma_f32 v108,-v176,v140,v108
v_mfma_f32_32x32x16_bf16 v[56:71],a[44:47],v[36:39],v[56:71]
ds_read_b128 v[24:27],v16 offset:16384
v_fma_f32 v109,-v176,v141,v109
v_fma_f32 v110,-v176,v142,v110
v_fma_f32 v111,-v176,v143,v111
v_mul_f32 v104,v104,v177
v_mfma_f32_32x32x16_bf16 v[72:87],a[204:207],v[36:39],v[72:87]
buffer_load_dwordx4 v1,s[8:11],s63 offen offset:2048 sc1 lds
v_mul_f32 v105,v105,v177
v_mul_f32 v106,v106,v177
v_mul_f32 v107,v107,v177
s_waitcnt lgkmcnt(3)
v_mfma_f32_32x32x16_bf16 v[56:71],a[48:51],v[40:43],v[56:71]
ds_read_b128 v[28:31],v17 offset:16384
v_mul_f32 v108,v108,v177
v_mul_f32 v109,v109,v177
v_mul_f32 v110,v110,v177
v_mul_f32 v111,v111,v177
v_mfma_f32_32x32x16_bf16 v[72:87],a[208:211],v[40:43],v[72:87]
v_cvt_pk_bf16_f32 v104,v104,v105
v_cvt_pk_bf16_f32 v105,v106,v107
v_cvt_pk_bf16_f32 v106,v108,v109
v_cvt_pk_bf16_f32 v107,v110,v111
v_fma_f32 v112,-v176,v144,v112
v_mfma_f32_32x32x16_bf16 v[56:71],a[52:55],v[44:47],v[56:71]
ds_read_b128 v[32:35],v16 offset:18432
buffer_load_dwordx4 v1,s[8:11],s63 offen offset:3072 sc1 lds
s_add_u32 m0,s61,8192
s_add_u32 s63,s60,8192
v_mfma_f32_32x32x16_bf16 v[72:87],a[212:215],v[44:47],v[72:87]
v_fma_f32 v113,-v176,v145,v113
v_fma_f32 v114,-v176,v146,v114
v_fma_f32 v115,-v176,v147,v115
v_fma_f32 v116,-v176,v148,v116
v_fma_f32 v117,-v176,v149,v117
s_waitcnt lgkmcnt(3)
v_mfma_f32_32x32x16_bf16 v[56:71],a[56:59],v[48:51],v[56:71]
ds_read_b128 v[36:39],v17 offset:18432
v_fma_f32 v118,-v176,v150,v118
v_fma_f32 v119,-v176,v151,v119
v_mul_f32 v112,v112,v177
v_mul_f32 v113,v113,v177
v_mfma_f32_32x32x16_bf16 v[72:87],a[216:219],v[48:51],v[72:87]
buffer_load_dwordx4 v1,s[8:11],s63 offen sc1 lds
v_mul_f32 v114,v114,v177
v_mul_f32 v115,v115,v177
v_mul_f32 v116,v116,v177
v_mul_f32 v117,v117,v177
v_mfma_f32_32x32x16_bf16 v[56:71],a[60:63],v[52:55],v[56:71]
ds_read_b128 v[40:43],v16 offset:20480
s_waitcnt vmcnt(9)
s_mov_b64 exec,1
buffer_store_dword v5,v1,s[8:11],s59 offen sc1
s_mov_b64 exec,-1
s_mov_b32 s59,2147483648
v_mfma_f32_32x32x16_bf16 v[72:87],a[220:223],v[52:55],v[72:87]
v_mul_f32 v118,v118,v177
v_mul_f32 v119,v119,v177
v_cvt_pk_bf16_f32 v112,v112,v113
v_cvt_pk_bf16_f32 v113,v114,v115
v_cvt_pk_bf16_f32 v114,v116,v117
s_waitcnt lgkmcnt(3)
v_mfma_f32_32x32x16_bf16 v[56:71],a[64:67],v[24:27],v[56:71]
ds_read_b128 v[44:47],v17 offset:20480
buffer_load_dwordx4 v1,s[8:11],s63 offen offset:1024 sc1 lds
s_lshl_b32 s62,s46,10
s_add_u32 s62,s62,40960
v_mfma_f32_32x32x16_bf16 v[72:87],a[224:227],v[24:27],v[72:87]
s_add_u32 m0,s66,s62
s_add_u32 s63,s67,s62
v_cvt_pk_bf16_f32 v115,v118,v119
s_lshl_b32 s82,s72,6
s_add_u32 s82,s82,s73
s_lshl_b32 s82,s82,9
v_mfma_f32_32x32x16_bf16 v[56:71],a[68:71],v[28:31],v[56:71]
ds_read_b128 v[48:51],v16 offset:22528
s_add_u32 s82,s82,s71
s_lshl_b32 s75,s69,2
s_add_u32 s82,s82,s75
s_add_u32 s82,s82,s39
v_mfma_f32_32x32x16_bf16 v[72:87],a[228:231],v[28:31],v[72:87]
buffer_load_dwordx4 v1,s[8:11],s63 offen sc1 lds
s_add_u32 m0,s66,45056
s_add_u32 s63,s67,45056
s_waitcnt lgkmcnt(3)
v_mfma_f32_32x32x16_bf16 v[56:71],a[72:75],v[32:35],v[56:71]
ds_read_b128 v[52:55],v17 offset:22528
buffer_load_dword v3,v2,s[8:11],s35 offen sc1
buffer_load_dword v14,v4,s[8:11],s41 offen sc1
v_mfma_f32_32x32x16_bf16 v[72:87],a[232:235],v[32:35],v[72:87]
v_add_f32 v156,v156,v166
v_add_f32 v157,v157,v167
v_add_f32 v158,v158,v168
v_add_f32 v159,v159,v169
v_add_f32 v160,v160,v170
v_mfma_f32_32x32x16_bf16 v[56:71],a[76:79],v[36:39],v[56:71]
ds_read_b128 v[24:27],v16 offset:24576
buffer_load_dwordx4 v1,s[8:11],s63 offen sc1 lds
v_add_f32 v161,v161,v171
v_add_f32 v162,v162,v172
v_mfma_f32_32x32x16_bf16 v[72:87],a[236:239],v[36:39],v[72:87]
v_add_f32 v163,v163,v173
v_add_f32 v164,v164,v174
v_add_f32 v165,v165,v175
v_add_f32 v156,v156,v158
v_add_f32 v157,v157,v159
s_waitcnt lgkmcnt(3)
v_mfma_f32_32x32x16_bf16 v[56:71],a[80:83],v[40:43],v[56:71]
ds_read_b128 v[28:31],v17 offset:24576
buffer_store_dwordx4 v[88:91],v20,s[8:11],s74 offen sc1
v_add_f32 v160,v160,v162
v_add_f32 v161,v161,v163
v_mfma_f32_32x32x16_bf16 v[72:87],a[240:243],v[40:43],v[72:87]
v_add_f32 v156,v156,v160
v_add_f32 v157,v157,v161
v_add_f32 v156,v156,v164
v_add_f32 v157,v157,v165
v_mov_b32 v158,v156
v_mfma_f32_32x32x16_bf16 v[56:71],a[84:87],v[44:47],v[56:71]
ds_read_b128 v[32:35],v16 offset:26624
buffer_store_dwordx4 v[96:99],v21,s[8:11],s74 offen sc1
v_mov_b32 v159,v157
v_permlane32_swap_b32 v156,v158
v_mfma_f32_32x32x16_bf16 v[72:87],a[244:247],v[44:47],v[72:87]
v_permlane32_swap_b32 v157,v159
v_add_f32 v176,v156,v158
v_add_f32 v177,v157,v159
v_mul_f32 v176,0x3acccccd,v176
v_mul_f32 v177,0x3acccccd,v177
s_waitcnt lgkmcnt(3)
v_mfma_f32_32x32x16_bf16 v[56:71],a[88:91],v[48:51],v[56:71]
ds_read_b128 v[36:39],v17 offset:26624
buffer_store_dwordx4 v[104:107],v20,s[8:11],s74 offen offset:2048 sc1
v_fma_f32 v177,-v176,v176,v177
v_max_f32 v177,0,v177
v_mfma_f32_32x32x16_bf16 v[72:87],a[248:251],v[48:51],v[72:87]
v_cvt_pk_bf16_f32 v8,v176,v177
v_lshlrev_b32 v176,16,v8
v_and_b32 v177,0xffff0000,v8
v_add_f32 v177,0x3727c5ac,v177
v_cvt_pk_bf16_f32 v8,v177,v177
v_mfma_f32_32x32x16_bf16 v[56:71],a[92:95],v[52:55],v[56:71]
ds_read_b128 v[40:43],v16 offset:28672
buffer_store_dwordx4 v[112:115],v21,s[8:11],s74 offen offset:2048 sc1
v_lshlrev_b32 v177,16,v8
v_mfma_f32_32x32x16_bf16 v[72:87],a[252:255],v[52:55],v[72:87]
v_sqrt_f32 v177,v177
s_nop 0
v_cvt_pk_bf16_f32 v8,v177,v177
v_lshlrev_b32 v177,16,v8
s_waitcnt lgkmcnt(3)
v_mfma_f32_32x32x16_bf16 v[56:71],a[96:99],v[24:27],v[56:71]
ds_read_b128 v[44:47],v17 offset:28672
v_rcp_f32 v177,v177
s_cmp_eq_u32 s51,0
s_cselect_b64 s[76:77],-1,0
v_mfma_f32_32x32x16_bf16 v[72:87],v[192:195],v[24:27],v[72:87]
v_cndmask_b32 v176,v176,0,s[76:77]
v_cndmask_b32 v177,v177,1.0,s[76:77]
s_mov_b32 s72,s51
s_mov_b32 s73,s52
v_mfma_f32_32x32x16_bf16 v[56:71],a[100:103],v[28:31],v[56:71]
ds_read_b128 v[48:51],v16 offset:30720
v_mfma_f32_32x32x16_bf16 v[72:87],v[196:199],v[28:31],v[72:87]
s_waitcnt lgkmcnt(3)
v_mfma_f32_32x32x16_bf16 v[56:71],a[104:107],v[32:35],v[56:71]
ds_read_b128 v[52:55],v17 offset:30720
v_mfma_f32_32x32x16_bf16 v[72:87],v[200:203],v[32:35],v[72:87]
v_mfma_f32_32x32x16_bf16 v[56:71],a[108:111],v[36:39],v[56:71]
ds_read_b128 v[24:27],v16 offset:32768
v_mfma_f32_32x32x16_bf16 v[72:87],v[204:207],v[36:39],v[72:87]
s_waitcnt lgkmcnt(3)
v_mfma_f32_32x32x16_bf16 v[56:71],a[112:115],v[40:43],v[56:71]
ds_read_b128 v[28:31],v17 offset:32768
v_mfma_f32_32x32x16_bf16 v[72:87],v[208:211],v[40:43],v[72:87]
v_mfma_f32_32x32x16_bf16 v[56:71],a[116:119],v[44:47],v[56:71]
ds_read_b128 v[32:35],v16 offset:34816
v_mfma_f32_32x32x16_bf16 v[72:87],v[212:215],v[44:47],v[72:87]
s_waitcnt lgkmcnt(3)
v_mfma_f32_32x32x16_bf16 v[56:71],a[120:123],v[48:51],v[56:71]
ds_read_b128 v[36:39],v17 offset:34816
v_mfma_f32_32x32x16_bf16 v[72:87],v[216:219],v[48:51],v[72:87]
v_mfma_f32_32x32x16_bf16 v[56:71],a[124:127],v[52:55],v[56:71]
ds_read_b128 v[40:43],v16 offset:36864
v_mfma_f32_32x32x16_bf16 v[72:87],v[220:223],v[52:55],v[72:87]
s_waitcnt lgkmcnt(3)
v_mfma_f32_32x32x16_bf16 v[56:71],a[128:131],v[24:27],v[56:71]
ds_read_b128 v[44:47],v17 offset:36864
s_waitcnt vmcnt(4)
v_cmp_eq_u32 vcc,0,v14
s_cmp_eq_u64 vcc,0
s_cselect_b32 s36,0,2147483648
v_mfma_f32_32x32x16_bf16 v[72:87],v[224:227],v[24:27],v[72:87]
v_cmp_eq_u32 vcc,0,v3
s_cmp_lt_u32 s78,64
s_cselect_b32 s36,s36,2147483648
s_cmp_eq_u64 vcc,0
s_cselect_b32 s60,1,s36
v_mfma_f32_32x32x16_bf16 v[56:71],a[132:135],v[28:31],v[56:71]
ds_read_b128 v[48:51],v16 offset:38912
s_cmp_lt_u32 s79,64
s_cselect_b32 s60,s60,s36
s_sub_u32 s61,s78,s79
s_or_b32 s61,s61,s36
v_mfma_f32_32x32x16_bf16 v[72:87],v[228:231],v[28:31],v[72:87]
s_cmp_lt_u32 s61,16
s_cselect_b32 s36,0,s60
v_mov_b32 v23,s36
s_waitcnt lgkmcnt(3)
v_mfma_f32_32x32x16_bf16 v[56:71],a[136:139],v[32:35],v[56:71]
ds_read_b128 v[52:55],v17 offset:38912
ds_write_b32 v13,v23
v_mfma_f32_32x32x16_bf16 v[72:87],v[232:235],v[32:35],v[72:87]
s_waitcnt lgkmcnt(0)
s_barrier
ds_read_b32 v23,v22
v_mfma_f32_32x32x16_bf16 v[56:71],a[140:143],v[36:39],v[56:71]
ds_read_b128 v[24:27],v18 offset:0
s_cmp_lt_u32 s50,2
s_cselect_b32 s42,1,0
s_cmp_ge_u32 s78,64
s_cselect_b32 s42,1,s42
v_mfma_f32_32x32x16_bf16 v[72:87],v[236:239],v[36:39],v[72:87]
s_or_b32 s42,s42,s37
s_mov_b32 s39,0
s_add_u32 s50,s50,1
s_sub_u32 s57,46080,s57
s_mov_b32 s51,s53
s_mov_b32 s52,s54
v_mfma_f32_32x32x16_bf16 v[56:71],a[144:147],v[40:43],v[56:71]
ds_read_b128 v[28:31],v19 offset:0
v_mfma_f32_32x32x16_bf16 v[72:87],v[240:243],v[40:43],v[72:87]
v_mfma_f32_32x32x16_bf16 v[56:71],a[148:151],v[44:47],v[56:71]
ds_read_b128 v[32:35],v18 offset:2048
s_waitcnt vmcnt(0)
s_mov_b64 exec,1
buffer_store_dword v5,v1,s[8:11],s82 offen sc1
s_mov_b64 exec,-1
s_mov_b32 s82,2147483648
v_mfma_f32_32x32x16_bf16 v[72:87],v[244:247],v[44:47],v[72:87]
s_waitcnt lgkmcnt(3)
v_readfirstlane_b32 s38,v23
s_and_b32 s37,s38,2147483648
s_and_b32 s33,s38,1
s_cselect_b32 s34,s79,s78
s_cmp_lg_u32 s42,0
v_mfma_f32_32x32x16_bf16 v[56:71],a[152:155],v[48:51],v[56:71]
ds_read_b128 v[36:39],v19 offset:2048
v_mfma_f32_32x32x16_bf16 v[72:87],v[248:251],v[48:51],v[72:87]
v_mfma_f32_32x32x16_bf16 v[56:71],a[156:159],v[52:55],v[56:71]
ds_read_b128 v[40:43],v18 offset:4096
v_mfma_f32_32x32x16_bf16 v[72:87],v[252:255],v[52:55],v[72:87]
s_cbranch_scc1 QKVQ_S0
QKVQ_B1:
s_waitcnt lgkmcnt(3)
v_mfma_f32_32x32x16_bf16 v[88:103],a[0:3],v[24:27],0
ds_read_b128 v[44:47],v19 offset:4096
v_add_u32 v189,s57,v188
v_mfma_f32_32x32x16_bf16 v[104:119],a[160:163],v[24:27],0
v_add_u32 v8,0x800,v189
s_sub_u32 s66,46080,s57
s_lshl_b32 s60,s33,6
s_add_u32 s60,s60,s34
s_mul_i32 s60,s60,46080
s_add_u32 s60,s60,s37
v_mfma_f32_32x32x16_bf16 v[88:103],a[4:7],v[28:31],v[88:103]
ds_read_b128 v[48:51],v18 offset:6144
ds_read2_b64 v[156:159],v189 offset0:0 offset1:32
s_add_u32 s60,s60,206569472
v_mfma_f32_32x32x16_bf16 v[104:119],a[164:167],v[28:31],v[104:119]
ds_read2_b64 v[160:163],v189 offset0:64 offset1:96
s_cmp_eq_u32 s33,0
s_cselect_b32 s67,2147483648,s60
s_mul_i32 s61,s46,10240
s_waitcnt lgkmcnt(5)
v_mfma_f32_32x32x16_bf16 v[88:103],a[8:11],v[32:35],v[88:103]
ds_read_b128 v[52:55],v19 offset:6144
ds_read2_b64 v[164:167],v189 offset0:128 offset1:160
s_add_u32 s60,s60,s61
s_add_u32 s61,s61,s66
v_mfma_f32_32x32x16_bf16 v[104:119],a[168:171],v[32:35],v[104:119]
ds_read2_b64 v[168:171],v189 offset0:192 offset1:224
s_add_u32 m0,s61,0
s_add_u32 s63,s60,0
buffer_load_dwordx4 v1,s[8:11],s63 offen sc1 lds
v_mfma_f32_32x32x16_bf16 v[88:103],a[12:15],v[36:39],v[88:103]
ds_read_b128 v[24:27],v18 offset:8192
ds_read2_b64 v[172:175],v8 offset0:0 offset1:32
s_mul_i32 s74,s73,393216
s_add_u32 s74,s74,s39
v_mfma_f32_32x32x16_bf16 v[104:119],a[172:175],v[36:39],v[104:119]
s_add_u32 s74,s74,s70
v_fma_f32 v56,-v176,v120,v56
v_fma_f32 v57,-v176,v121,v57
v_fma_f32 v58,-v176,v122,v58
v_fma_f32 v59,-v176,v123,v59
s_waitcnt lgkmcnt(8)
v_mfma_f32_32x32x16_bf16 v[88:103],a[16:19],v[40:43],v[88:103]
ds_read_b128 v[28:31],v19 offset:8192
buffer_load_dwordx4 v1,s[8:11],s63 offen offset:1024 sc1 lds
v_fma_f32 v60,-v176,v124,v60
v_fma_f32 v61,-v176,v125,v61
v_mfma_f32_32x32x16_bf16 v[104:119],a[176:179],v[40:43],v[104:119]
v_fma_f32 v62,-v176,v126,v62
v_fma_f32 v63,-v176,v127,v63
v_mul_f32 v56,v56,v177
v_mul_f32 v57,v57,v177
v_mul_f32 v58,v58,v177
v_mfma_f32_32x32x16_bf16 v[88:103],a[20:23],v[44:47],v[88:103]
ds_read_b128 v[32:35],v18 offset:10240
s_mov_b32 s53,s33
s_mov_b32 s54,s34
s_add_u32 s79,s79,s33
s_or_b32 s65,s37,s33
v_mfma_f32_32x32x16_bf16 v[104:119],a[180:183],v[44:47],v[104:119]
buffer_load_dwordx4 v1,s[8:11],s63 offen offset:2048 sc1 lds
s_cmp_eq_u32 s65,0
s_addc_u32 s78,s78,0
s_lshl_b32 s41,s78,9
s_waitcnt lgkmcnt(6)
v_mfma_f32_32x32x16_bf16 v[88:103],a[24:27],v[48:51],v[88:103]
ds_read_b128 v[36:39],v19 offset:10240
s_add_u32 s41,s41,s40
s_lshl_b32 s35,s79,9
s_add_u32 s35,s35,s40
s_add_u32 s35,s35,32768
v_mfma_f32_32x32x16_bf16 v[104:119],a[184:187],v[48:51],v[104:119]
v_mul_f32 v59,v59,v177
v_mul_f32 v60,v60,v177
v_mul_f32 v61,v61,v177
v_mul_f32 v62,v62,v177
v_mul_f32 v63,v63,v177
v_mfma_f32_32x32x16_bf16 v[88:103],a[28:31],v[52:55],v[88:103]
ds_read_b128 v[40:43],v18 offset:12288
buffer_load_dwordx4 v1,s[8:11],s63 offen offset:3072 sc1 lds
s_add_u32 m0,s61,4096
s_add_u32 s63,s60,4096
v_mfma_f32_32x32x16_bf16 v[104:119],a[188:191],v[52:55],v[104:119]
v_cvt_pk_bf16_f32 v56,v56,v57
v_cvt_pk_bf16_f32 v57,v58,v59
v_cvt_pk_bf16_f32 v58,v60,v61
v_cvt_pk_bf16_f32 v59,v62,v63
v_fma_f32 v64,-v176,v128,v64
s_waitcnt lgkmcnt(3)
v_mfma_f32_32x32x16_bf16 v[88:103],a[32:35],v[24:27],v[88:103]
ds_read_b128 v[44:47],v19 offset:12288
v_fma_f32 v65,-v176,v129,v65
v_fma_f32 v66,-v176,v130,v66
v_fma_f32 v67,-v176,v131,v67
v_fma_f32 v68,-v176,v132,v68
v_mfma_f32_32x32x16_bf16 v[104:119],a[192:195],v[24:27],v[104:119]
buffer_load_dwordx4 v1,s[8:11],s63 offen sc1 lds
v_fma_f32 v69,-v176,v133,v69
v_fma_f32 v70,-v176,v134,v70
v_fma_f32 v71,-v176,v135,v71
v_mul_f32 v64,v64,v177
v_mfma_f32_32x32x16_bf16 v[88:103],a[36:39],v[28:31],v[88:103]
ds_read_b128 v[48:51],v18 offset:14336
v_mul_f32 v65,v65,v177
v_mul_f32 v66,v66,v177
v_mul_f32 v67,v67,v177
v_mul_f32 v68,v68,v177
v_mfma_f32_32x32x16_bf16 v[104:119],a[196:199],v[28:31],v[104:119]
v_mul_f32 v69,v69,v177
v_mul_f32 v70,v70,v177
v_mul_f32 v71,v71,v177
v_cvt_pk_bf16_f32 v64,v64,v65
v_cvt_pk_bf16_f32 v65,v66,v67
s_waitcnt lgkmcnt(3)
v_mfma_f32_32x32x16_bf16 v[88:103],a[40:43],v[32:35],v[88:103]
ds_read_b128 v[52:55],v19 offset:14336
buffer_load_dwordx4 v1,s[8:11],s63 offen offset:1024 sc1 lds
v_cvt_pk_bf16_f32 v66,v68,v69
v_cvt_pk_bf16_f32 v67,v70,v71
v_mfma_f32_32x32x16_bf16 v[104:119],a[200:203],v[32:35],v[104:119]
v_fma_f32 v72,-v176,v136,v72
v_fma_f32 v73,-v176,v137,v73
v_fma_f32 v74,-v176,v138,v74
v_fma_f32 v75,-v176,v139,v75
v_fma_f32 v76,-v176,v140,v76
v_mfma_f32_32x32x16_bf16 v[88:103],a[44:47],v[36:39],v[88:103]
ds_read_b128 v[24:27],v18 offset:16384
v_fma_f32 v77,-v176,v141,v77
v_fma_f32 v78,-v176,v142,v78
v_fma_f32 v79,-v176,v143,v79
v_mul_f32 v72,v72,v177
v_mfma_f32_32x32x16_bf16 v[104:119],a[204:207],v[36:39],v[104:119]
buffer_load_dwordx4 v1,s[8:11],s63 offen offset:2048 sc1 lds
v_mul_f32 v73,v73,v177
v_mul_f32 v74,v74,v177
v_mul_f32 v75,v75,v177
s_waitcnt lgkmcnt(3)
v_mfma_f32_32x32x16_bf16 v[88:103],a[48:51],v[40:43],v[88:103]
ds_read_b128 v[28:31],v19 offset:16384
v_mul_f32 v76,v76,v177
v_mul_f32 v77,v77,v177
v_mul_f32 v78,v78,v177
v_mul_f32 v79,v79,v177
v_mfma_f32_32x32x16_bf16 v[104:119],a[208:211],v[40:43],v[104:119]
v_cvt_pk_bf16_f32 v72,v72,v73
v_cvt_pk_bf16_f32 v73,v74,v75
v_cvt_pk_bf16_f32 v74,v76,v77
v_cvt_pk_bf16_f32 v75,v78,v79
v_fma_f32 v80,-v176,v144,v80
v_mfma_f32_32x32x16_bf16 v[88:103],a[52:55],v[44:47],v[88:103]
ds_read_b128 v[32:35],v18 offset:18432
buffer_load_dwordx4 v1,s[8:11],s63 offen offset:3072 sc1 lds
s_add_u32 m0,s61,8192
s_add_u32 s63,s60,8192
v_mfma_f32_32x32x16_bf16 v[104:119],a[212:215],v[44:47],v[104:119]
v_fma_f32 v81,-v176,v145,v81
v_fma_f32 v82,-v176,v146,v82
v_fma_f32 v83,-v176,v147,v83
v_fma_f32 v84,-v176,v148,v84
v_fma_f32 v85,-v176,v149,v85
s_waitcnt lgkmcnt(3)
v_mfma_f32_32x32x16_bf16 v[88:103],a[56:59],v[48:51],v[88:103]
ds_read_b128 v[36:39],v19 offset:18432
v_fma_f32 v86,-v176,v150,v86
v_fma_f32 v87,-v176,v151,v87
v_mul_f32 v80,v80,v177
v_mul_f32 v81,v81,v177
v_mfma_f32_32x32x16_bf16 v[104:119],a[216:219],v[48:51],v[104:119]
buffer_load_dwordx4 v1,s[8:11],s63 offen sc1 lds
v_mul_f32 v82,v82,v177
v_mul_f32 v83,v83,v177
v_mul_f32 v84,v84,v177
v_mul_f32 v85,v85,v177
v_mfma_f32_32x32x16_bf16 v[88:103],a[60:63],v[52:55],v[88:103]
ds_read_b128 v[40:43],v18 offset:20480
s_waitcnt vmcnt(9)
s_mov_b64 exec,1
buffer_store_dword v5,v1,s[8:11],s59 offen sc1
s_mov_b64 exec,-1
s_mov_b32 s59,2147483648
v_mfma_f32_32x32x16_bf16 v[104:119],a[220:223],v[52:55],v[104:119]
v_mul_f32 v86,v86,v177
v_mul_f32 v87,v87,v177
v_cvt_pk_bf16_f32 v80,v80,v81
v_cvt_pk_bf16_f32 v81,v82,v83
v_cvt_pk_bf16_f32 v82,v84,v85
s_waitcnt lgkmcnt(3)
v_mfma_f32_32x32x16_bf16 v[88:103],a[64:67],v[24:27],v[88:103]
ds_read_b128 v[44:47],v19 offset:20480
buffer_load_dwordx4 v1,s[8:11],s63 offen offset:1024 sc1 lds
s_lshl_b32 s62,s46,10
s_add_u32 s62,s62,40960
v_mfma_f32_32x32x16_bf16 v[104:119],a[224:227],v[24:27],v[104:119]
s_add_u32 m0,s66,s62
s_add_u32 s63,s67,s62
v_cvt_pk_bf16_f32 v83,v86,v87
s_lshl_b32 s82,s72,6
s_add_u32 s82,s82,s73
s_lshl_b32 s82,s82,9
v_mfma_f32_32x32x16_bf16 v[88:103],a[68:71],v[28:31],v[88:103]
ds_read_b128 v[48:51],v18 offset:22528
s_add_u32 s82,s82,s71
s_lshl_b32 s75,s69,2
s_add_u32 s82,s82,s75
s_add_u32 s82,s82,s39
v_mfma_f32_32x32x16_bf16 v[104:119],a[228:231],v[28:31],v[104:119]
buffer_load_dwordx4 v1,s[8:11],s63 offen sc1 lds
s_add_u32 m0,s66,45056
s_add_u32 s63,s67,45056
s_waitcnt lgkmcnt(3)
v_mfma_f32_32x32x16_bf16 v[88:103],a[72:75],v[32:35],v[88:103]
ds_read_b128 v[52:55],v19 offset:22528
buffer_load_dword v3,v2,s[8:11],s35 offen sc1
buffer_load_dword v14,v4,s[8:11],s41 offen sc1
v_mfma_f32_32x32x16_bf16 v[104:119],a[232:235],v[32:35],v[104:119]
v_add_f32 v156,v156,v166
v_add_f32 v157,v157,v167
v_add_f32 v158,v158,v168
v_add_f32 v159,v159,v169
v_add_f32 v160,v160,v170
v_mfma_f32_32x32x16_bf16 v[88:103],a[76:79],v[36:39],v[88:103]
ds_read_b128 v[24:27],v18 offset:24576
buffer_load_dwordx4 v1,s[8:11],s63 offen sc1 lds
v_add_f32 v161,v161,v171
v_add_f32 v162,v162,v172
v_mfma_f32_32x32x16_bf16 v[104:119],a[236:239],v[36:39],v[104:119]
v_add_f32 v163,v163,v173
v_add_f32 v164,v164,v174
v_add_f32 v165,v165,v175
v_add_f32 v156,v156,v158
v_add_f32 v157,v157,v159
s_waitcnt lgkmcnt(3)
v_mfma_f32_32x32x16_bf16 v[88:103],a[80:83],v[40:43],v[88:103]
ds_read_b128 v[28:31],v19 offset:24576
buffer_store_dwordx4 v[56:59],v20,s[8:11],s74 offen sc1
v_add_f32 v160,v160,v162
v_add_f32 v161,v161,v163
v_mfma_f32_32x32x16_bf16 v[104:119],a[240:243],v[40:43],v[104:119]
v_add_f32 v156,v156,v160
v_add_f32 v157,v157,v161
v_add_f32 v156,v156,v164
v_add_f32 v157,v157,v165
v_mov_b32 v158,v156
v_mfma_f32_32x32x16_bf16 v[88:103],a[84:87],v[44:47],v[88:103]
ds_read_b128 v[32:35],v18 offset:26624
buffer_store_dwordx4 v[64:67],v21,s[8:11],s74 offen sc1
v_mov_b32 v159,v157
v_permlane32_swap_b32 v156,v158
v_mfma_f32_32x32x16_bf16 v[104:119],a[244:247],v[44:47],v[104:119]
v_permlane32_swap_b32 v157,v159
v_add_f32 v176,v156,v158
v_add_f32 v177,v157,v159
v_mul_f32 v176,0x3acccccd,v176
v_mul_f32 v177,0x3acccccd,v177
s_waitcnt lgkmcnt(3)
v_mfma_f32_32x32x16_bf16 v[88:103],a[88:91],v[48:51],v[88:103]
ds_read_b128 v[36:39],v19 offset:26624
buffer_store_dwordx4 v[72:75],v20,s[8:11],s74 offen offset:2048 sc1
v_fma_f32 v177,-v176,v176,v177
v_max_f32 v177,0,v177
v_mfma_f32_32x32x16_bf16 v[104:119],a[248:251],v[48:51],v[104:119]
v_cvt_pk_bf16_f32 v8,v176,v177
v_lshlrev_b32 v176,16,v8
v_and_b32 v177,0xffff0000,v8
v_add_f32 v177,0x3727c5ac,v177
v_cvt_pk_bf16_f32 v8,v177,v177
v_mfma_f32_32x32x16_bf16 v[88:103],a[92:95],v[52:55],v[88:103]
ds_read_b128 v[40:43],v18 offset:28672
buffer_store_dwordx4 v[80:83],v21,s[8:11],s74 offen offset:2048 sc1
v_lshlrev_b32 v177,16,v8
v_mfma_f32_32x32x16_bf16 v[104:119],a[252:255],v[52:55],v[104:119]
v_sqrt_f32 v177,v177
s_nop 0
v_cvt_pk_bf16_f32 v8,v177,v177
v_lshlrev_b32 v177,16,v8
s_waitcnt lgkmcnt(3)
v_mfma_f32_32x32x16_bf16 v[88:103],a[96:99],v[24:27],v[88:103]
ds_read_b128 v[44:47],v19 offset:28672
v_rcp_f32 v177,v177
s_cmp_eq_u32 s51,0
s_cselect_b64 s[76:77],-1,0
v_mfma_f32_32x32x16_bf16 v[104:119],v[192:195],v[24:27],v[104:119]
v_cndmask_b32 v176,v176,0,s[76:77]
v_cndmask_b32 v177,v177,1.0,s[76:77]
s_mov_b32 s72,s51
s_mov_b32 s73,s52
v_mfma_f32_32x32x16_bf16 v[88:103],a[100:103],v[28:31],v[88:103]
ds_read_b128 v[48:51],v18 offset:30720
v_mfma_f32_32x32x16_bf16 v[104:119],v[196:199],v[28:31],v[104:119]
s_waitcnt lgkmcnt(3)
v_mfma_f32_32x32x16_bf16 v[88:103],a[104:107],v[32:35],v[88:103]
ds_read_b128 v[52:55],v19 offset:30720
v_mfma_f32_32x32x16_bf16 v[104:119],v[200:203],v[32:35],v[104:119]
v_mfma_f32_32x32x16_bf16 v[88:103],a[108:111],v[36:39],v[88:103]
ds_read_b128 v[24:27],v18 offset:32768
v_mfma_f32_32x32x16_bf16 v[104:119],v[204:207],v[36:39],v[104:119]
s_waitcnt lgkmcnt(3)
v_mfma_f32_32x32x16_bf16 v[88:103],a[112:115],v[40:43],v[88:103]
ds_read_b128 v[28:31],v19 offset:32768
v_mfma_f32_32x32x16_bf16 v[104:119],v[208:211],v[40:43],v[104:119]
v_mfma_f32_32x32x16_bf16 v[88:103],a[116:119],v[44:47],v[88:103]
ds_read_b128 v[32:35],v18 offset:34816
v_mfma_f32_32x32x16_bf16 v[104:119],v[212:215],v[44:47],v[104:119]
s_waitcnt lgkmcnt(3)
v_mfma_f32_32x32x16_bf16 v[88:103],a[120:123],v[48:51],v[88:103]
ds_read_b128 v[36:39],v19 offset:34816
v_mfma_f32_32x32x16_bf16 v[104:119],v[216:219],v[48:51],v[104:119]
v_mfma_f32_32x32x16_bf16 v[88:103],a[124:127],v[52:55],v[88:103]
ds_read_b128 v[40:43],v18 offset:36864
v_mfma_f32_32x32x16_bf16 v[104:119],v[220:223],v[52:55],v[104:119]
s_waitcnt lgkmcnt(3)
v_mfma_f32_32x32x16_bf16 v[88:103],a[128:131],v[24:27],v[88:103]
ds_read_b128 v[44:47],v19 offset:36864
s_waitcnt vmcnt(4)
v_cmp_eq_u32 vcc,0,v14
s_cmp_eq_u64 vcc,0
s_cselect_b32 s36,0,2147483648
v_mfma_f32_32x32x16_bf16 v[104:119],v[224:227],v[24:27],v[104:119]
v_cmp_eq_u32 vcc,0,v3
s_cmp_lt_u32 s78,64
s_cselect_b32 s36,s36,2147483648
s_cmp_eq_u64 vcc,0
s_cselect_b32 s60,1,s36
v_mfma_f32_32x32x16_bf16 v[88:103],a[132:135],v[28:31],v[88:103]
ds_read_b128 v[48:51],v18 offset:38912
s_cmp_lt_u32 s79,64
s_cselect_b32 s60,s60,s36
s_sub_u32 s61,s78,s79
s_or_b32 s61,s61,s36
v_mfma_f32_32x32x16_bf16 v[104:119],v[228:231],v[28:31],v[104:119]
s_cmp_lt_u32 s61,16
s_cselect_b32 s36,0,s60
v_mov_b32 v23,s36
s_waitcnt lgkmcnt(3)
v_mfma_f32_32x32x16_bf16 v[88:103],a[136:139],v[32:35],v[88:103]
ds_read_b128 v[52:55],v19 offset:38912
ds_write_b32 v13,v23
v_mfma_f32_32x32x16_bf16 v[104:119],v[232:235],v[32:35],v[104:119]
s_waitcnt lgkmcnt(0)
s_barrier
ds_read_b32 v23,v22
v_mfma_f32_32x32x16_bf16 v[88:103],a[140:143],v[36:39],v[88:103]
ds_read_b128 v[24:27],v16 offset:0
s_cmp_lt_u32 s50,2
s_cselect_b32 s42,1,0
s_cmp_ge_u32 s78,64
s_cselect_b32 s42,1,s42
v_mfma_f32_32x32x16_bf16 v[104:119],v[236:239],v[36:39],v[104:119]
s_or_b32 s42,s42,s37
s_mov_b32 s39,0
s_add_u32 s50,s50,1
s_sub_u32 s57,46080,s57
s_mov_b32 s51,s53
s_mov_b32 s52,s54
v_mfma_f32_32x32x16_bf16 v[88:103],a[144:147],v[40:43],v[88:103]
ds_read_b128 v[28:31],v17 offset:0
v_mfma_f32_32x32x16_bf16 v[104:119],v[240:243],v[40:43],v[104:119]
v_mfma_f32_32x32x16_bf16 v[88:103],a[148:151],v[44:47],v[88:103]
ds_read_b128 v[32:35],v16 offset:2048
s_waitcnt vmcnt(0)
s_mov_b64 exec,1
buffer_store_dword v5,v1,s[8:11],s82 offen sc1
s_mov_b64 exec,-1
s_mov_b32 s82,2147483648
v_mfma_f32_32x32x16_bf16 v[104:119],v[244:247],v[44:47],v[104:119]
s_waitcnt lgkmcnt(3)
v_readfirstlane_b32 s38,v23
s_and_b32 s37,s38,2147483648
s_and_b32 s33,s38,1
s_cselect_b32 s34,s79,s78
s_cmp_lg_u32 s42,0
v_mfma_f32_32x32x16_bf16 v[88:103],a[152:155],v[48:51],v[88:103]
ds_read_b128 v[36:39],v17 offset:2048
v_mfma_f32_32x32x16_bf16 v[104:119],v[248:251],v[48:51],v[104:119]
v_mfma_f32_32x32x16_bf16 v[88:103],a[156:159],v[52:55],v[88:103]
ds_read_b128 v[40:43],v16 offset:4096
v_mfma_f32_32x32x16_bf16 v[104:119],v[252:255],v[52:55],v[104:119]
s_cbranch_scc0 QKVQ_B0
s_branch QKVQ_S1
s_nop 9
QKVQ_S0:
s_mov_b32 s55,0
s_cmp_lt_u32 s42,2
s_cbranch_scc1 nt_216
s_mov_b32 s55,2
s_cmp_lg_u32 s37,0
s_cbranch_scc1 nt_216
s_mov_b32 s55,1
s_lshl_b32 s60,s33,6
s_add_u32 s60,s60,s34
s_mul_i32 s60,s60,46080
s_add_u32 s60,s60,206569472
s_cmp_eq_u32 s33,0
s_cselect_b32 s67,2147483648,s60
s_mul_i32 s61,s46,10240
s_add_u32 s60,s60,s61
s_add_u32 s61,s61,s57
s_add_u32 m0,s61,0
s_add_u32 s63,s60,0
buffer_load_dwordx4 v1,s[8:11],s63 offen sc1 lds
buffer_load_dwordx4 v1,s[8:11],s63 offen offset:1024 sc1 lds
buffer_load_dwordx4 v1,s[8:11],s63 offen offset:2048 sc1 lds
buffer_load_dwordx4 v1,s[8:11],s63 offen offset:3072 sc1 lds
s_add_u32 m0,s61,4096
s_add_u32 s63,s60,4096
buffer_load_dwordx4 v1,s[8:11],s63 offen sc1 lds
buffer_load_dwordx4 v1,s[8:11],s63 offen offset:1024 sc1 lds
buffer_load_dwordx4 v1,s[8:11],s63 offen offset:2048 sc1 lds
buffer_load_dwordx4 v1,s[8:11],s63 offen offset:3072 sc1 lds
s_add_u32 m0,s61,8192
s_add_u32 s63,s60,8192
buffer_load_dwordx4 v1,s[8:11],s63 offen sc1 lds
buffer_load_dwordx4 v1,s[8:11],s63 offen offset:1024 sc1 lds
s_lshl_b32 s62,s46,10
s_add_u32 s62,s62,40960
s_add_u32 m0,s57,s62
s_add_u32 s63,s67,s62
buffer_load_dwordx4 v1,s[8:11],s63 offen sc1 lds
s_add_u32 m0,s57,45056
s_add_u32 s63,s67,45056
buffer_load_dwordx4 v1,s[8:11],s63 offen sc1 lds
nt_216:
s_nop 4
s_mul_i32 s74,s73,393216
s_add_u32 s74,s74,s39
s_add_u32 s74,s74,s70
v_fma_f32 v56,-v176,v120,v56
v_fma_f32 v57,-v176,v121,v57
v_fma_f32 v58,-v176,v122,v58
v_fma_f32 v59,-v176,v123,v59
v_fma_f32 v60,-v176,v124,v60
v_fma_f32 v61,-v176,v125,v61
v_fma_f32 v62,-v176,v126,v62
v_fma_f32 v63,-v176,v127,v63
v_mul_f32 v56,v56,v177
v_mul_f32 v57,v57,v177
v_mul_f32 v58,v58,v177
v_mul_f32 v59,v59,v177
v_mul_f32 v60,v60,v177
v_mul_f32 v61,v61,v177
v_mul_f32 v62,v62,v177
v_mul_f32 v63,v63,v177
v_cvt_pk_bf16_f32 v56,v56,v57
v_cvt_pk_bf16_f32 v57,v58,v59
v_cvt_pk_bf16_f32 v58,v60,v61
v_cvt_pk_bf16_f32 v59,v62,v63
buffer_store_dwordx4 v[56:59],v20,s[8:11],s74 offen sc1
v_fma_f32 v64,-v176,v128,v64
v_fma_f32 v65,-v176,v129,v65
v_fma_f32 v66,-v176,v130,v66
v_fma_f32 v67,-v176,v131,v67
v_fma_f32 v68,-v176,v132,v68
v_fma_f32 v69,-v176,v133,v69
v_fma_f32 v70,-v176,v134,v70
v_fma_f32 v71,-v176,v135,v71
v_mul_f32 v64,v64,v177
v_mul_f32 v65,v65,v177
v_mul_f32 v66,v66,v177
v_mul_f32 v67,v67,v177
v_mul_f32 v68,v68,v177
v_mul_f32 v69,v69,v177
v_mul_f32 v70,v70,v177
v_mul_f32 v71,v71,v177
v_cvt_pk_bf16_f32 v64,v64,v65
v_cvt_pk_bf16_f32 v65,v66,v67
v_cvt_pk_bf16_f32 v66,v68,v69
v_cvt_pk_bf16_f32 v67,v70,v71
buffer_store_dwordx4 v[64:67],v21,s[8:11],s74 offen sc1
v_fma_f32 v72,-v176,v136,v72
v_fma_f32 v73,-v176,v137,v73
v_fma_f32 v74,-v176,v138,v74
v_fma_f32 v75,-v176,v139,v75
v_fma_f32 v76,-v176,v140,v76
v_fma_f32 v77,-v176,v141,v77
v_fma_f32 v78,-v176,v142,v78
v_fma_f32 v79,-v176,v143,v79
v_mul_f32 v72,v72,v177
v_mul_f32 v73,v73,v177
v_mul_f32 v74,v74,v177
v_mul_f32 v75,v75,v177
v_mul_f32 v76,v76,v177
v_mul_f32 v77,v77,v177
v_mul_f32 v78,v78,v177
v_mul_f32 v79,v79,v177
v_cvt_pk_bf16_f32 v72,v72,v73
v_cvt_pk_bf16_f32 v73,v74,v75
v_cvt_pk_bf16_f32 v74,v76,v77
v_cvt_pk_bf16_f32 v75,v78,v79
buffer_store_dwordx4 v[72:75],v20,s[8:11],s74 offen offset:2048 sc1
v_fma_f32 v80,-v176,v144,v80
v_fma_f32 v81,-v176,v145,v81
v_fma_f32 v82,-v176,v146,v82
v_fma_f32 v83,-v176,v147,v83
v_fma_f32 v84,-v176,v148,v84
v_fma_f32 v85,-v176,v149,v85
v_fma_f32 v86,-v176,v150,v86
v_fma_f32 v87,-v176,v151,v87
v_mul_f32 v80,v80,v177
v_mul_f32 v81,v81,v177
v_mul_f32 v82,v82,v177
v_mul_f32 v83,v83,v177
v_mul_f32 v84,v84,v177
v_mul_f32 v85,v85,v177
v_mul_f32 v86,v86,v177
v_mul_f32 v87,v87,v177
v_cvt_pk_bf16_f32 v80,v80,v81
v_cvt_pk_bf16_f32 v81,v82,v83
v_cvt_pk_bf16_f32 v82,v84,v85
v_cvt_pk_bf16_f32 v83,v86,v87
buffer_store_dwordx4 v[80:83],v21,s[8:11],s74 offen offset:2048 sc1
s_lshl_b32 s82,s72,6
s_add_u32 s82,s82,s73
s_lshl_b32 s82,s82,9
s_add_u32 s82,s82,s71
s_lshl_b32 s75,s69,2
s_add_u32 s82,s82,s75
s_add_u32 s82,s82,s39
s_mov_b32 s59,s82
s_mov_b32 s82,2147483648
s_mov_b32 s39,2147483648
s_cmp_eq_u32 s55,0
s_cbranch_scc1 QKVQ_B1
s_cmp_eq_u32 s55,1
s_cbranch_scc1 QKVQ_CD1
s_waitcnt vmcnt(0)
s_mov_b64 exec,1
buffer_store_dword v5,v1,s[8:11],s59 offen sc1
s_mov_b64 exec,-1
s_mov_b32 s59,2147483648
s_cmp_eq_u32 s50,128
s_cbranch_scc1 QKVQ_END
s_branch QKVQ_COLD1
QKVQ_COLD0:
s_cmp_lg_u32 s46,0
s_cbranch_scc1 cp_217
ct_218:
buffer_load_dword v3,v2,s[8:11],s35 offen sc1
buffer_load_dword v14,v4,s[8:11],s41 offen sc1
s_waitcnt vmcnt(0)
v_cmp_eq_u32 vcc,0,v14
s_cmp_eq_u64 vcc,0
s_cselect_b32 s36,0,2147483648
v_cmp_eq_u32 vcc,0,v3
s_cmp_lt_u32 s78,64
s_cselect_b32 s36,s36,2147483648
s_cmp_eq_u64 vcc,0
s_cselect_b32 s60,1,s36
s_cmp_lt_u32 s79,64
s_cselect_b32 s60,s60,s36
s_sub_u32 s61,s78,s79
s_or_b32 s61,s61,s36
s_cmp_lt_u32 s61,16
s_cselect_b32 s36,0,s60
v_mov_b32 v23,s36
s_cmp_lt_u32 s36,2
s_cbranch_scc1 ct_218x
s_sleep 3
s_sub_u32 s47,s47,1
s_cbranch_scc1 ABORT
s_branch ct_218
ct_218x:
ds_write_b32 v22,v23 offset:4
s_waitcnt lgkmcnt(0)
cp_217:
s_barrier
ds_read_b32 v23,v22 offset:4
s_waitcnt lgkmcnt(0)
v_readfirstlane_b32 s38,v23
s_and_b32 s38,s38,1
s_and_b32 s37,s38,2147483648
s_and_b32 s33,s38,1
s_cselect_b32 s34,s79,s78
s_lshl_b32 s60,s33,6
s_add_u32 s60,s60,s34
s_mul_i32 s60,s60,46080
s_add_u32 s60,s60,206569472
s_cmp_eq_u32 s33,0
s_cselect_b32 s67,2147483648,s60
s_mul_i32 s61,s46,10240
s_add_u32 s60,s60,s61
s_add_u32 s61,s61,s57
s_add_u32 m0,s61,0
s_add_u32 s63,s60,0
buffer_load_dwordx4 v1,s[8:11],s63 offen sc1 lds
buffer_load_dwordx4 v1,s[8:11],s63 offen offset:1024 sc1 lds
buffer_load_dwordx4 v1,s[8:11],s63 offen offset:2048 sc1 lds
buffer_load_dwordx4 v1,s[8:11],s63 offen offset:3072 sc1 lds
s_add_u32 m0,s61,4096
s_add_u32 s63,s60,4096
buffer_load_dwordx4 v1,s[8:11],s63 offen sc1 lds
buffer_load_dwordx4 v1,s[8:11],s63 offen offset:1024 sc1 lds
buffer_load_dwordx4 v1,s[8:11],s63 offen offset:2048 sc1 lds
buffer_load_dwordx4 v1,s[8:11],s63 offen offset:3072 sc1 lds
s_add_u32 m0,s61,8192
s_add_u32 s63,s60,8192
buffer_load_dwordx4 v1,s[8:11],s63 offen sc1 lds
buffer_load_dwordx4 v1,s[8:11],s63 offen offset:1024 sc1 lds
s_lshl_b32 s62,s46,10
s_add_u32 s62,s62,40960
s_add_u32 m0,s57,s62
s_add_u32 s63,s67,s62
buffer_load_dwordx4 v1,s[8:11],s63 offen sc1 lds
s_add_u32 m0,s57,45056
s_add_u32 s63,s67,45056
buffer_load_dwordx4 v1,s[8:11],s63 offen sc1 lds
QKVQ_CD0:
s_mov_b32 s51,s33
s_mov_b32 s52,s34
s_mov_b32 s53,s33
s_mov_b32 s54,s34
s_add_u32 s79,s79,s33
s_or_b32 s60,s37,s33
s_cmp_eq_u32 s60,0
s_addc_u32 s78,s78,0
s_lshl_b32 s41,s78,9
s_add_u32 s41,s41,s40
s_lshl_b32 s35,s79,9
s_add_u32 s35,s35,s40
s_add_u32 s35,s35,32768
buffer_load_dword v3,v2,s[8:11],s35 offen sc1
buffer_load_dword v14,v4,s[8:11],s41 offen sc1
s_waitcnt vmcnt(0)
s_mov_b64 exec,1
buffer_store_dword v5,v1,s[8:11],s59 offen sc1
s_mov_b64 exec,-1
s_mov_b32 s59,2147483648
v_cmp_eq_u32 vcc,0,v14
s_cmp_eq_u64 vcc,0
s_cselect_b32 s36,0,2147483648
v_cmp_eq_u32 vcc,0,v3
s_cmp_lt_u32 s78,64
s_cselect_b32 s36,s36,2147483648
s_cmp_eq_u64 vcc,0
s_cselect_b32 s60,1,s36
s_cmp_lt_u32 s79,64
s_cselect_b32 s60,s60,s36
s_sub_u32 s61,s78,s79
s_or_b32 s61,s61,s36
s_cmp_lt_u32 s61,16
s_cselect_b32 s36,0,s60
v_mov_b32 v23,s36
ds_write_b32 v13,v23
s_waitcnt lgkmcnt(0)
s_barrier
ds_read_b32 v23,v22
ds_read_b128 v[24:27],v16 offset:0
ds_read_b128 v[28:31],v17 offset:0
ds_read_b128 v[32:35],v16 offset:2048
ds_read_b128 v[36:39],v17 offset:2048
ds_read_b128 v[40:43],v16 offset:4096
s_waitcnt lgkmcnt(5)
v_readfirstlane_b32 s38,v23
s_and_b32 s37,s38,2147483648
s_and_b32 s33,s38,1
s_cselect_b32 s34,s79,s78
s_nop 0
s_branch QKVQ_B0
QKVQ_S1:
s_mov_b32 s55,0
s_cmp_lt_u32 s42,2
s_cbranch_scc1 nt_219
s_mov_b32 s55,2
s_cmp_lg_u32 s37,0
s_cbranch_scc1 nt_219
s_mov_b32 s55,1
s_lshl_b32 s60,s33,6
s_add_u32 s60,s60,s34
s_mul_i32 s60,s60,46080
s_add_u32 s60,s60,206569472
s_cmp_eq_u32 s33,0
s_cselect_b32 s67,2147483648,s60
s_mul_i32 s61,s46,10240
s_add_u32 s60,s60,s61
s_add_u32 s61,s61,s57
s_add_u32 m0,s61,0
s_add_u32 s63,s60,0
buffer_load_dwordx4 v1,s[8:11],s63 offen sc1 lds
buffer_load_dwordx4 v1,s[8:11],s63 offen offset:1024 sc1 lds
buffer_load_dwordx4 v1,s[8:11],s63 offen offset:2048 sc1 lds
buffer_load_dwordx4 v1,s[8:11],s63 offen offset:3072 sc1 lds
s_add_u32 m0,s61,4096
s_add_u32 s63,s60,4096
buffer_load_dwordx4 v1,s[8:11],s63 offen sc1 lds
buffer_load_dwordx4 v1,s[8:11],s63 offen offset:1024 sc1 lds
buffer_load_dwordx4 v1,s[8:11],s63 offen offset:2048 sc1 lds
buffer_load_dwordx4 v1,s[8:11],s63 offen offset:3072 sc1 lds
s_add_u32 m0,s61,8192
s_add_u32 s63,s60,8192
buffer_load_dwordx4 v1,s[8:11],s63 offen sc1 lds
buffer_load_dwordx4 v1,s[8:11],s63 offen offset:1024 sc1 lds
s_lshl_b32 s62,s46,10
s_add_u32 s62,s62,40960
s_add_u32 m0,s57,s62
s_add_u32 s63,s67,s62
buffer_load_dwordx4 v1,s[8:11],s63 offen sc1 lds
s_add_u32 m0,s57,45056
s_add_u32 s63,s67,45056
buffer_load_dwordx4 v1,s[8:11],s63 offen sc1 lds
nt_219:
s_nop 4
s_mul_i32 s74,s73,393216
s_add_u32 s74,s74,s39
s_add_u32 s74,s74,s70
v_fma_f32 v88,-v176,v120,v88
v_fma_f32 v89,-v176,v121,v89
v_fma_f32 v90,-v176,v122,v90
v_fma_f32 v91,-v176,v123,v91
v_fma_f32 v92,-v176,v124,v92
v_fma_f32 v93,-v176,v125,v93
v_fma_f32 v94,-v176,v126,v94
v_fma_f32 v95,-v176,v127,v95
v_mul_f32 v88,v88,v177
v_mul_f32 v89,v89,v177
v_mul_f32 v90,v90,v177
v_mul_f32 v91,v91,v177
v_mul_f32 v92,v92,v177
v_mul_f32 v93,v93,v177
v_mul_f32 v94,v94,v177
v_mul_f32 v95,v95,v177
v_cvt_pk_bf16_f32 v88,v88,v89
v_cvt_pk_bf16_f32 v89,v90,v91
v_cvt_pk_bf16_f32 v90,v92,v93
v_cvt_pk_bf16_f32 v91,v94,v95
buffer_store_dwordx4 v[88:91],v20,s[8:11],s74 offen sc1
v_fma_f32 v96,-v176,v128,v96
v_fma_f32 v97,-v176,v129,v97
v_fma_f32 v98,-v176,v130,v98
v_fma_f32 v99,-v176,v131,v99
v_fma_f32 v100,-v176,v132,v100
v_fma_f32 v101,-v176,v133,v101
v_fma_f32 v102,-v176,v134,v102
v_fma_f32 v103,-v176,v135,v103
v_mul_f32 v96,v96,v177
v_mul_f32 v97,v97,v177
v_mul_f32 v98,v98,v177
v_mul_f32 v99,v99,v177
v_mul_f32 v100,v100,v177
v_mul_f32 v101,v101,v177
v_mul_f32 v102,v102,v177
v_mul_f32 v103,v103,v177
v_cvt_pk_bf16_f32 v96,v96,v97
v_cvt_pk_bf16_f32 v97,v98,v99
v_cvt_pk_bf16_f32 v98,v100,v101
v_cvt_pk_bf16_f32 v99,v102,v103
buffer_store_dwordx4 v[96:99],v21,s[8:11],s74 offen sc1
v_fma_f32 v104,-v176,v136,v104
v_fma_f32 v105,-v176,v137,v105
v_fma_f32 v106,-v176,v138,v106
v_fma_f32 v107,-v176,v139,v107
v_fma_f32 v108,-v176,v140,v108
v_fma_f32 v109,-v176,v141,v109
v_fma_f32 v110,-v176,v142,v110
v_fma_f32 v111,-v176,v143,v111
v_mul_f32 v104,v104,v177
v_mul_f32 v105,v105,v177
v_mul_f32 v106,v106,v177
v_mul_f32 v107,v107,v177
v_mul_f32 v108,v108,v177
v_mul_f32 v109,v109,v177
v_mul_f32 v110,v110,v177
v_mul_f32 v111,v111,v177
v_cvt_pk_bf16_f32 v104,v104,v105
v_cvt_pk_bf16_f32 v105,v106,v107
v_cvt_pk_bf16_f32 v106,v108,v109
v_cvt_pk_bf16_f32 v107,v110,v111
buffer_store_dwordx4 v[104:107],v20,s[8:11],s74 offen offset:2048 sc1
v_fma_f32 v112,-v176,v144,v112
v_fma_f32 v113,-v176,v145,v113
v_fma_f32 v114,-v176,v146,v114
v_fma_f32 v115,-v176,v147,v115
v_fma_f32 v116,-v176,v148,v116
v_fma_f32 v117,-v176,v149,v117
v_fma_f32 v118,-v176,v150,v118
v_fma_f32 v119,-v176,v151,v119
v_mul_f32 v112,v112,v177
v_mul_f32 v113,v113,v177
v_mul_f32 v114,v114,v177
v_mul_f32 v115,v115,v177
v_mul_f32 v116,v116,v177
v_mul_f32 v117,v117,v177
v_mul_f32 v118,v118,v177
v_mul_f32 v119,v119,v177
v_cvt_pk_bf16_f32 v112,v112,v113
v_cvt_pk_bf16_f32 v113,v114,v115
v_cvt_pk_bf16_f32 v114,v116,v117
v_cvt_pk_bf16_f32 v115,v118,v119
buffer_store_dwordx4 v[112:115],v21,s[8:11],s74 offen offset:2048 sc1
s_lshl_b32 s82,s72,6
s_add_u32 s82,s82,s73
s_lshl_b32 s82,s82,9
s_add_u32 s82,s82,s71
s_lshl_b32 s75,s69,2
s_add_u32 s82,s82,s75
s_add_u32 s82,s82,s39
s_mov_b32 s59,s82
s_mov_b32 s82,2147483648
s_mov_b32 s39,2147483648
s_cmp_eq_u32 s55,0
s_cbranch_scc1 QKVQ_B0
s_cmp_eq_u32 s55,1
s_cbranch_scc1 QKVQ_CD0
s_waitcnt vmcnt(0)
s_mov_b64 exec,1
buffer_store_dword v5,v1,s[8:11],s59 offen sc1
s_mov_b64 exec,-1
s_mov_b32 s59,2147483648
s_cmp_eq_u32 s50,128
s_cbranch_scc1 QKVQ_END
s_branch QKVQ_COLD0
QKVQ_COLD1:
s_cmp_lg_u32 s46,0
s_cbranch_scc1 cp_220
ct_221:
buffer_load_dword v3,v2,s[8:11],s35 offen sc1
buffer_load_dword v14,v4,s[8:11],s41 offen sc1
s_waitcnt vmcnt(0)
v_cmp_eq_u32 vcc,0,v14
s_cmp_eq_u64 vcc,0
s_cselect_b32 s36,0,2147483648
v_cmp_eq_u32 vcc,0,v3
s_cmp_lt_u32 s78,64
s_cselect_b32 s36,s36,2147483648
s_cmp_eq_u64 vcc,0
s_cselect_b32 s60,1,s36
s_cmp_lt_u32 s79,64
s_cselect_b32 s60,s60,s36
s_sub_u32 s61,s78,s79
s_or_b32 s61,s61,s36
s_cmp_lt_u32 s61,16
s_cselect_b32 s36,0,s60
v_mov_b32 v23,s36
s_cmp_lt_u32 s36,2
s_cbranch_scc1 ct_221x
s_sleep 3
s_sub_u32 s47,s47,1
s_cbranch_scc1 ABORT
s_branch ct_221
ct_221x:
ds_write_b32 v22,v23 offset:4
s_waitcnt lgkmcnt(0)
cp_220:
s_barrier
ds_read_b32 v23,v22 offset:4
s_waitcnt lgkmcnt(0)
v_readfirstlane_b32 s38,v23
s_and_b32 s38,s38,1
s_and_b32 s37,s38,2147483648
s_and_b32 s33,s38,1
s_cselect_b32 s34,s79,s78
s_lshl_b32 s60,s33,6
s_add_u32 s60,s60,s34
s_mul_i32 s60,s60,46080
s_add_u32 s60,s60,206569472
s_cmp_eq_u32 s33,0
s_cselect_b32 s67,2147483648,s60
s_mul_i32 s61,s46,10240
s_add_u32 s60,s60,s61
s_add_u32 s61,s61,s57
s_add_u32 m0,s61,0
s_add_u32 s63,s60,0
buffer_load_dwordx4 v1,s[8:11],s63 offen sc1 lds
buffer_load_dwordx4 v1,s[8:11],s63 offen offset:1024 sc1 lds
buffer_load_dwordx4 v1,s[8:11],s63 offen offset:2048 sc1 lds
buffer_load_dwordx4 v1,s[8:11],s63 offen offset:3072 sc1 lds
s_add_u32 m0,s61,4096
s_add_u32 s63,s60,4096
buffer_load_dwordx4 v1,s[8:11],s63 offen sc1 lds
buffer_load_dwordx4 v1,s[8:11],s63 offen offset:1024 sc1 lds
buffer_load_dwordx4 v1,s[8:11],s63 offen offset:2048 sc1 lds
buffer_load_dwordx4 v1,s[8:11],s63 offen offset:3072 sc1 lds
s_add_u32 m0,s61,8192
s_add_u32 s63,s60,8192
buffer_load_dwordx4 v1,s[8:11],s63 offen sc1 lds
buffer_load_dwordx4 v1,s[8:11],s63 offen offset:1024 sc1 lds
s_lshl_b32 s62,s46,10
s_add_u32 s62,s62,40960
s_add_u32 m0,s57,s62
s_add_u32 s63,s67,s62
buffer_load_dwordx4 v1,s[8:11],s63 offen sc1 lds
s_add_u32 m0,s57,45056
s_add_u32 s63,s67,45056
buffer_load_dwordx4 v1,s[8:11],s63 offen sc1 lds
QKVQ_CD1:
s_mov_b32 s51,s33
s_mov_b32 s52,s34
s_mov_b32 s53,s33
s_mov_b32 s54,s34
s_add_u32 s79,s79,s33
s_or_b32 s60,s37,s33
s_cmp_eq_u32 s60,0
s_addc_u32 s78,s78,0
s_lshl_b32 s41,s78,9
s_add_u32 s41,s41,s40
s_lshl_b32 s35,s79,9
s_add_u32 s35,s35,s40
s_add_u32 s35,s35,32768
buffer_load_dword v3,v2,s[8:11],s35 offen sc1
buffer_load_dword v14,v4,s[8:11],s41 offen sc1
s_waitcnt vmcnt(0)
s_mov_b64 exec,1
buffer_store_dword v5,v1,s[8:11],s59 offen sc1
s_mov_b64 exec,-1
s_mov_b32 s59,2147483648
v_cmp_eq_u32 vcc,0,v14
s_cmp_eq_u64 vcc,0
s_cselect_b32 s36,0,2147483648
v_cmp_eq_u32 vcc,0,v3
s_cmp_lt_u32 s78,64
s_cselect_b32 s36,s36,2147483648
s_cmp_eq_u64 vcc,0
s_cselect_b32 s60,1,s36
s_cmp_lt_u32 s79,64
s_cselect_b32 s60,s60,s36
s_sub_u32 s61,s78,s79
s_or_b32 s61,s61,s36
s_cmp_lt_u32 s61,16
s_cselect_b32 s36,0,s60
v_mov_b32 v23,s36
ds_write_b32 v13,v23
s_waitcnt lgkmcnt(0)
s_barrier
ds_read_b32 v23,v22
ds_read_b128 v[24:27],v18 offset:0
ds_read_b128 v[28:31],v19 offset:0
ds_read_b128 v[32:35],v18 offset:2048
ds_read_b128 v[36:39],v19 offset:2048
ds_read_b128 v[40:43],v18 offset:4096
s_waitcnt lgkmcnt(5)
v_readfirstlane_b32 s38,v23
s_and_b32 s37,s38,2147483648
s_and_b32 s33,s38,1
s_cselect_b32 s34,s79,s78
s_nop 0
s_branch QKVQ_B1
QKVQ_END:
s_endpgm
ROLE_QKVV:
v_lshlrev_b32 v1,4,v0
v_mov_b32 v5,1
s_lshl_b32 s56,s48,2
s_add_u32 s56,s56,s46
v_bfe_u32 v6,v0,2,2
v_lshrrev_b32 v7,4,v0
v_add_u32 v7,v6,v7
v_and_b32 v7,3,v7
v_and_b32 v15,3,v0
v_lshlrev_b32 v15,4,v15
v_lshl_add_u32 v15,v7,6,v15
v_lshl_add_u32 v15,v6,8,v15
v_lshrrev_b32 v6,5,v0
v_bfe_u32 v7,v0,4,1
v_lshlrev_b32 v16,10,v7
v_bfe_u32 v7,v0,2,2
v_lshl_add_u32 v16,v7,8,v16
v_add_u32 v6,v6,v7
v_and_b32 v6,3,v6
v_lshl_add_u32 v16,v6,6,v16
v_and_b32 v6,3,v0
v_lshl_add_u32 v16,v6,4,v16
v_add_u32 v18,46080,v16
v_lshrrev_b32 v6,5,v0
v_bfe_u32 v7,v0,4,1
v_lshlrev_b32 v20,10,v7
v_lshl_add_u32 v20,v6,8,v20
v_and_b32 v6,15,v0
v_lshl_add_u32 v20,v6,4,v20
v_lshrrev_b32 v6,5,v0
v_add_u32 v6,2,v6
v_bfe_u32 v7,v0,4,1
v_lshlrev_b32 v17,10,v7
v_bfe_u32 v7,v0,2,2
v_lshl_add_u32 v17,v7,8,v17
v_add_u32 v6,v6,v7
v_and_b32 v6,3,v6
v_lshl_add_u32 v17,v6,6,v17
v_and_b32 v6,3,v0
v_lshl_add_u32 v17,v6,4,v17
v_add_u32 v19,46080,v17
v_lshrrev_b32 v6,5,v0
v_add_u32 v6,2,v6
v_bfe_u32 v7,v0,4,1
v_lshlrev_b32 v21,10,v7
v_lshl_add_u32 v21,v6,8,v21
v_and_b32 v6,15,v0
v_lshl_add_u32 v21,v6,4,v21
s_mov_b32 s69,s56
s_mov_b32 s70,99614720
s_mov_b32 s71,196608
s_lshl_b32 s60,s69,12
s_add_u32 s70,s70,s60
v_lshrrev_b32 v6,5,v0
v_mul_u32_u24 v188,2560,v6
v_and_b32 v6,31,v0
v_lshl_add_u32 v188,v6,3,v188
v_add_u32 v188,0xa000,v188
v_min_u32 v4,7,v0
v_lshlrev_b32 v4,2,v4
v_min_u32 v2,39,v0
v_lshlrev_b32 v2,2,v2
v_mov_b32 v12,93184
s_lshl_b32 s60,s46,8
s_add_u32 s60,s60,92160
v_and_b32 v6,31,v0
v_lshlrev_b32 v190,3,v6
v_add_u32 v190,s60,v190
v_lshrrev_b32 v6,5,v0
v_lshlrev_b32 v191,5,v6
v_add_u32 v191,s60,v191
s_waitcnt vmcnt(0)
s_barrier
s_cmp_lg_u32 s46,0
s_cbranch_scc1 arr_222
v_mov_b32 v6,1
s_lshl_b32 s3,s49,2
v_mov_b32 v7,s3
s_mov_b64 exec,1
buffer_atomic_add v6,v7,s[12:15],0 offen sc1
s_mov_b64 exec,-1
arr_222:
s_lshl_b32 s58,s69,7
v_mov_b32 v24,0x3f803f80
v_mov_b32 v25,0x3f803f80
v_mov_b32 v26,0x3f803f80
v_mov_b32 v27,0x3f803f80
s_mul_i32 s63,s46,40960
s_mov_b32 s4,s24
s_mov_b32 s5,s25
s_mov_b32 s6,7864320
s_mov_b32 s7,0x20000
v_lshrrev_b32 v9,3,v0
s_mov_b32 s64,12288
v_mul_lo_u32 v9,v9,s64
v_and_b32 v10,7,v0
v_lshl_add_u32 v6,v10,4,v9
s_add_u32 m0,s63,0
s_add_u32 s65,s58,0
buffer_load_dwordx4 v6,s[4:7],s65 offen lds
s_add_u32 m0,s63,1024
s_add_u32 s65,s58,98304
buffer_load_dwordx4 v6,s[4:7],s65 offen lds
s_add_u32 m0,s63,2048
s_add_u32 s65,s58,196608
buffer_load_dwordx4 v6,s[4:7],s65 offen lds
s_add_u32 m0,s63,3072
s_add_u32 s65,s58,294912
buffer_load_dwordx4 v6,s[4:7],s65 offen lds
s_add_u32 m0,s63,4096
s_add_u32 s65,s58,393216
buffer_load_dwordx4 v6,s[4:7],s65 offen lds
s_add_u32 m0,s63,5120
s_add_u32 s65,s58,491520
buffer_load_dwordx4 v6,s[4:7],s65 offen lds
s_add_u32 m0,s63,6144
s_add_u32 s65,s58,589824
buffer_load_dwordx4 v6,s[4:7],s65 offen lds
s_add_u32 m0,s63,7168
s_add_u32 s65,s58,688128
buffer_load_dwordx4 v6,s[4:7],s65 offen lds
s_add_u32 m0,s63,8192
s_add_u32 s65,s58,786432
buffer_load_dwordx4 v6,s[4:7],s65 offen lds
s_add_u32 m0,s63,9216
s_add_u32 s65,s58,884736
buffer_load_dwordx4 v6,s[4:7],s65 offen lds
s_add_u32 m0,s63,10240
s_add_u32 s65,s58,983040
buffer_load_dwordx4 v6,s[4:7],s65 offen lds
s_add_u32 m0,s63,11264
s_add_u32 s65,s58,1081344
buffer_load_dwordx4 v6,s[4:7],s65 offen lds
s_add_u32 m0,s63,12288
s_add_u32 s65,s58,1179648
buffer_load_dwordx4 v6,s[4:7],s65 offen lds
s_add_u32 m0,s63,13312
s_add_u32 s65,s58,1277952
buffer_load_dwordx4 v6,s[4:7],s65 offen lds
s_add_u32 m0,s63,14336
s_add_u32 s65,s58,1376256
buffer_load_dwordx4 v6,s[4:7],s65 offen lds
s_add_u32 m0,s63,15360
s_add_u32 s65,s58,1474560
buffer_load_dwordx4 v6,s[4:7],s65 offen lds
s_add_u32 m0,s63,16384
s_add_u32 s65,s58,1572864
buffer_load_dwordx4 v6,s[4:7],s65 offen lds
s_add_u32 m0,s63,17408
s_add_u32 s65,s58,1671168
buffer_load_dwordx4 v6,s[4:7],s65 offen lds
s_add_u32 m0,s63,18432
s_add_u32 s65,s58,1769472
buffer_load_dwordx4 v6,s[4:7],s65 offen lds
s_add_u32 m0,s63,19456
s_add_u32 s65,s58,1867776
buffer_load_dwordx4 v6,s[4:7],s65 offen lds
s_add_u32 m0,s63,20480
s_add_u32 s65,s58,1966080
buffer_load_dwordx4 v6,s[4:7],s65 offen lds
s_add_u32 m0,s63,21504
s_add_u32 s65,s58,2064384
buffer_load_dwordx4 v6,s[4:7],s65 offen lds
s_add_u32 m0,s63,22528
s_add_u32 s65,s58,2162688
buffer_load_dwordx4 v6,s[4:7],s65 offen lds
s_add_u32 m0,s63,23552
s_add_u32 s65,s58,2260992
buffer_load_dwordx4 v6,s[4:7],s65 offen lds
s_add_u32 m0,s63,24576
s_add_u32 s65,s58,2359296
buffer_load_dwordx4 v6,s[4:7],s65 offen lds
s_add_u32 m0,s63,25600
s_add_u32 s65,s58,2457600
buffer_load_dwordx4 v6,s[4:7],s65 offen lds
s_add_u32 m0,s63,26624
s_add_u32 s65,s58,2555904
buffer_load_dwordx4 v6,s[4:7],s65 offen lds
s_add_u32 m0,s63,27648
s_add_u32 s65,s58,2654208
buffer_load_dwordx4 v6,s[4:7],s65 offen lds
s_add_u32 m0,s63,28672
s_add_u32 s65,s58,2752512
buffer_load_dwordx4 v6,s[4:7],s65 offen lds
s_add_u32 m0,s63,29696
s_add_u32 s65,s58,2850816
buffer_load_dwordx4 v6,s[4:7],s65 offen lds
s_add_u32 m0,s63,30720
s_add_u32 s65,s58,2949120
buffer_load_dwordx4 v6,s[4:7],s65 offen lds
s_add_u32 m0,s63,31744
s_add_u32 s65,s58,3047424
buffer_load_dwordx4 v6,s[4:7],s65 offen lds
s_add_u32 m0,s63,32768
s_add_u32 s65,s58,3145728
buffer_load_dwordx4 v6,s[4:7],s65 offen lds
s_add_u32 m0,s63,33792
s_add_u32 s65,s58,3244032
buffer_load_dwordx4 v6,s[4:7],s65 offen lds
s_add_u32 m0,s63,34816
s_add_u32 s65,s58,3342336
buffer_load_dwordx4 v6,s[4:7],s65 offen lds
s_add_u32 m0,s63,35840
s_add_u32 s65,s58,3440640
buffer_load_dwordx4 v6,s[4:7],s65 offen lds
s_add_u32 m0,s63,36864
s_add_u32 s65,s58,3538944
buffer_load_dwordx4 v6,s[4:7],s65 offen lds
s_add_u32 m0,s63,37888
s_add_u32 s65,s58,3637248
buffer_load_dwordx4 v6,s[4:7],s65 offen lds
s_add_u32 m0,s63,38912
s_add_u32 s65,s58,3735552
buffer_load_dwordx4 v6,s[4:7],s65 offen lds
s_add_u32 m0,s63,39936
s_add_u32 s65,s58,3833856
buffer_load_dwordx4 v6,s[4:7],s65 offen lds
s_waitcnt vmcnt(20)
v_bfe_u32 v9,v0,2,2
v_lshrrev_b32 v10,5,v0
v_lshl_add_u32 v9,v10,2,v9
v_mul_u32_u24 v9,128,v9
v_and_b32 v10,1,v0
v_lshl_add_u32 v9,v10,3,v9
v_bfe_u32 v10,v0,1,1
v_lshl_add_u32 v9,v10,4,v9
v_bfe_u32 v10,v0,4,1
v_lshl_add_u32 v9,v10,5,v9
v_add_u32 v7,s63,v9
ds_read_b64_tr_b16 a[0:1],v7 offset:0
ds_read_b64_tr_b16 a[2:3],v7 offset:2048
ds_read_b64_tr_b16 a[4:5],v7 offset:1024
ds_read_b64_tr_b16 a[6:7],v7 offset:3072
ds_read_b64_tr_b16 a[160:161],v7 offset:64
ds_read_b64_tr_b16 a[162:163],v7 offset:2112
ds_read_b64_tr_b16 a[164:165],v7 offset:1088
ds_read_b64_tr_b16 a[166:167],v7 offset:3136
ds_read_b64_tr_b16 a[8:9],v7 offset:4096
ds_read_b64_tr_b16 a[10:11],v7 offset:6144
ds_read_b64_tr_b16 a[12:13],v7 offset:5120
ds_read_b64_tr_b16 a[14:15],v7 offset:7168
s_waitcnt lgkmcnt(4)
ds_read_b64_tr_b16 a[168:169],v7 offset:4160
ds_read_b64_tr_b16 a[170:171],v7 offset:6208
ds_read_b64_tr_b16 a[172:173],v7 offset:5184
ds_read_b64_tr_b16 a[174:175],v7 offset:7232
ds_read_b64_tr_b16 a[16:17],v7 offset:8192
ds_read_b64_tr_b16 a[18:19],v7 offset:10240
ds_read_b64_tr_b16 a[20:21],v7 offset:9216
ds_read_b64_tr_b16 a[22:23],v7 offset:11264
ds_read_b64_tr_b16 a[176:177],v7 offset:8256
ds_read_b64_tr_b16 a[178:179],v7 offset:10304
ds_read_b64_tr_b16 a[180:181],v7 offset:9280
ds_read_b64_tr_b16 a[182:183],v7 offset:11328
s_waitcnt lgkmcnt(4)
ds_read_b64_tr_b16 a[24:25],v7 offset:12288
ds_read_b64_tr_b16 a[26:27],v7 offset:14336
ds_read_b64_tr_b16 a[28:29],v7 offset:13312
ds_read_b64_tr_b16 a[30:31],v7 offset:15360
ds_read_b64_tr_b16 a[184:185],v7 offset:12352
ds_read_b64_tr_b16 a[186:187],v7 offset:14400
ds_read_b64_tr_b16 a[188:189],v7 offset:13376
ds_read_b64_tr_b16 a[190:191],v7 offset:15424
ds_read_b64_tr_b16 a[32:33],v7 offset:16384
ds_read_b64_tr_b16 a[34:35],v7 offset:18432
ds_read_b64_tr_b16 a[36:37],v7 offset:17408
ds_read_b64_tr_b16 a[38:39],v7 offset:19456
s_waitcnt lgkmcnt(4)
ds_read_b64_tr_b16 a[192:193],v7 offset:16448
ds_read_b64_tr_b16 a[194:195],v7 offset:18496
ds_read_b64_tr_b16 a[196:197],v7 offset:17472
ds_read_b64_tr_b16 a[198:199],v7 offset:19520
s_waitcnt lgkmcnt(0)
s_add_u32 m0,s63,0
s_add_u32 s65,s58,3932160
buffer_load_dwordx4 v6,s[4:7],s65 offen lds
s_add_u32 m0,s63,1024
s_add_u32 s65,s58,4030464
buffer_load_dwordx4 v6,s[4:7],s65 offen lds
s_add_u32 m0,s63,2048
s_add_u32 s65,s58,4128768
buffer_load_dwordx4 v6,s[4:7],s65 offen lds
s_add_u32 m0,s63,3072
s_add_u32 s65,s58,4227072
buffer_load_dwordx4 v6,s[4:7],s65 offen lds
s_add_u32 m0,s63,4096
s_add_u32 s65,s58,4325376
buffer_load_dwordx4 v6,s[4:7],s65 offen lds
s_add_u32 m0,s63,5120
s_add_u32 s65,s58,4423680
buffer_load_dwordx4 v6,s[4:7],s65 offen lds
s_add_u32 m0,s63,6144
s_add_u32 s65,s58,4521984
buffer_load_dwordx4 v6,s[4:7],s65 offen lds
s_add_u32 m0,s63,7168
s_add_u32 s65,s58,4620288
buffer_load_dwordx4 v6,s[4:7],s65 offen lds
s_add_u32 m0,s63,8192
s_add_u32 s65,s58,4718592
buffer_load_dwordx4 v6,s[4:7],s65 offen lds
s_add_u32 m0,s63,9216
s_add_u32 s65,s58,4816896
buffer_load_dwordx4 v6,s[4:7],s65 offen lds
s_add_u32 m0,s63,10240
s_add_u32 s65,s58,4915200
buffer_load_dwordx4 v6,s[4:7],s65 offen lds
s_add_u32 m0,s63,11264
s_add_u32 s65,s58,5013504
buffer_load_dwordx4 v6,s[4:7],s65 offen lds
s_add_u32 m0,s63,12288
s_add_u32 s65,s58,5111808
buffer_load_dwordx4 v6,s[4:7],s65 offen lds
s_add_u32 m0,s63,13312
s_add_u32 s65,s58,5210112
buffer_load_dwordx4 v6,s[4:7],s65 offen lds
s_add_u32 m0,s63,14336
s_add_u32 s65,s58,5308416
buffer_load_dwordx4 v6,s[4:7],s65 offen lds
s_add_u32 m0,s63,15360
s_add_u32 s65,s58,5406720
buffer_load_dwordx4 v6,s[4:7],s65 offen lds
s_add_u32 m0,s63,16384
s_add_u32 s65,s58,5505024
buffer_load_dwordx4 v6,s[4:7],s65 offen lds
s_add_u32 m0,s63,17408
s_add_u32 s65,s58,5603328
buffer_load_dwordx4 v6,s[4:7],s65 offen lds
s_add_u32 m0,s63,18432
s_add_u32 s65,s58,5701632
buffer_load_dwordx4 v6,s[4:7],s65 offen lds
s_add_u32 m0,s63,19456
s_add_u32 s65,s58,5799936
buffer_load_dwordx4 v6,s[4:7],s65 offen lds
v_mfma_f32_32x32x16_bf16 v[56:71],v[24:27],a[0:3],0
v_mfma_f32_32x32x16_bf16 v[72:87],v[24:27],a[160:163],0
v_mfma_f32_32x32x16_bf16 v[56:71],v[24:27],a[4:7],v[56:71]
v_mfma_f32_32x32x16_bf16 v[72:87],v[24:27],a[164:167],v[72:87]
v_mfma_f32_32x32x16_bf16 v[56:71],v[24:27],a[8:11],v[56:71]
v_mfma_f32_32x32x16_bf16 v[72:87],v[24:27],a[168:171],v[72:87]
v_mfma_f32_32x32x16_bf16 v[56:71],v[24:27],a[12:15],v[56:71]
v_mfma_f32_32x32x16_bf16 v[72:87],v[24:27],a[172:175],v[72:87]
v_mfma_f32_32x32x16_bf16 v[56:71],v[24:27],a[16:19],v[56:71]
v_mfma_f32_32x32x16_bf16 v[72:87],v[24:27],a[176:179],v[72:87]
v_mfma_f32_32x32x16_bf16 v[56:71],v[24:27],a[20:23],v[56:71]
v_mfma_f32_32x32x16_bf16 v[72:87],v[24:27],a[180:183],v[72:87]
v_mfma_f32_32x32x16_bf16 v[56:71],v[24:27],a[24:27],v[56:71]
v_mfma_f32_32x32x16_bf16 v[72:87],v[24:27],a[184:187],v[72:87]
v_mfma_f32_32x32x16_bf16 v[56:71],v[24:27],a[28:31],v[56:71]
v_mfma_f32_32x32x16_bf16 v[72:87],v[24:27],a[188:191],v[72:87]
v_mfma_f32_32x32x16_bf16 v[56:71],v[24:27],a[32:35],v[56:71]
v_mfma_f32_32x32x16_bf16 v[72:87],v[24:27],a[192:195],v[72:87]
v_mfma_f32_32x32x16_bf16 v[56:71],v[24:27],a[36:39],v[56:71]
v_mfma_f32_32x32x16_bf16 v[72:87],v[24:27],a[196:199],v[72:87]
s_waitcnt vmcnt(20)
v_bfe_u32 v9,v0,2,2
v_lshrrev_b32 v10,5,v0
v_lshl_add_u32 v9,v10,2,v9
v_mul_u32_u24 v9,128,v9
v_and_b32 v10,1,v0
v_lshl_add_u32 v9,v10,3,v9
v_bfe_u32 v10,v0,1,1
v_lshl_add_u32 v9,v10,4,v9
v_bfe_u32 v10,v0,4,1
v_lshl_add_u32 v9,v10,5,v9
v_add_u32 v7,s63,v9
ds_read_b64_tr_b16 a[40:41],v7 offset:20480
ds_read_b64_tr_b16 a[42:43],v7 offset:22528
ds_read_b64_tr_b16 a[44:45],v7 offset:21504
ds_read_b64_tr_b16 a[46:47],v7 offset:23552
ds_read_b64_tr_b16 a[200:201],v7 offset:20544
ds_read_b64_tr_b16 a[202:203],v7 offset:22592
ds_read_b64_tr_b16 a[204:205],v7 offset:21568
ds_read_b64_tr_b16 a[206:207],v7 offset:23616
ds_read_b64_tr_b16 a[48:49],v7 offset:24576
ds_read_b64_tr_b16 a[50:51],v7 offset:26624
ds_read_b64_tr_b16 a[52:53],v7 offset:25600
ds_read_b64_tr_b16 a[54:55],v7 offset:27648
s_waitcnt lgkmcnt(4)
ds_read_b64_tr_b16 a[208:209],v7 offset:24640
ds_read_b64_tr_b16 a[210:211],v7 offset:26688
ds_read_b64_tr_b16 a[212:213],v7 offset:25664
ds_read_b64_tr_b16 a[214:215],v7 offset:27712
ds_read_b64_tr_b16 a[56:57],v7 offset:28672
ds_read_b64_tr_b16 a[58:59],v7 offset:30720
ds_read_b64_tr_b16 a[60:61],v7 offset:29696
ds_read_b64_tr_b16 a[62:63],v7 offset:31744
ds_read_b64_tr_b16 a[216:217],v7 offset:28736
ds_read_b64_tr_b16 a[218:219],v7 offset:30784
ds_read_b64_tr_b16 a[220:221],v7 offset:29760
ds_read_b64_tr_b16 a[222:223],v7 offset:31808
s_waitcnt lgkmcnt(4)
ds_read_b64_tr_b16 a[64:65],v7 offset:32768
ds_read_b64_tr_b16 a[66:67],v7 offset:34816
ds_read_b64_tr_b16 a[68:69],v7 offset:33792
ds_read_b64_tr_b16 a[70:71],v7 offset:35840
ds_read_b64_tr_b16 a[224:225],v7 offset:32832
ds_read_b64_tr_b16 a[226:227],v7 offset:34880
ds_read_b64_tr_b16 a[228:229],v7 offset:33856
ds_read_b64_tr_b16 a[230:231],v7 offset:35904
ds_read_b64_tr_b16 a[72:73],v7 offset:36864
ds_read_b64_tr_b16 a[74:75],v7 offset:38912
ds_read_b64_tr_b16 a[76:77],v7 offset:37888
ds_read_b64_tr_b16 a[78:79],v7 offset:39936
s_waitcnt lgkmcnt(4)
ds_read_b64_tr_b16 a[232:233],v7 offset:36928
ds_read_b64_tr_b16 a[234:235],v7 offset:38976
ds_read_b64_tr_b16 a[236:237],v7 offset:37952
ds_read_b64_tr_b16 a[238:239],v7 offset:40000
s_waitcnt lgkmcnt(0)
s_add_u32 m0,s63,20480
s_add_u32 s65,s58,5898240
buffer_load_dwordx4 v6,s[4:7],s65 offen lds
s_add_u32 m0,s63,21504
s_add_u32 s65,s58,5996544
buffer_load_dwordx4 v6,s[4:7],s65 offen lds
s_add_u32 m0,s63,22528
s_add_u32 s65,s58,6094848
buffer_load_dwordx4 v6,s[4:7],s65 offen lds
s_add_u32 m0,s63,23552
s_add_u32 s65,s58,6193152
buffer_load_dwordx4 v6,s[4:7],s65 offen lds
s_add_u32 m0,s63,24576
s_add_u32 s65,s58,6291456
buffer_load_dwordx4 v6,s[4:7],s65 offen lds
s_add_u32 m0,s63,25600
s_add_u32 s65,s58,6389760
buffer_load_dwordx4 v6,s[4:7],s65 offen lds
s_add_u32 m0,s63,26624
s_add_u32 s65,s58,6488064
buffer_load_dwordx4 v6,s[4:7],s65 offen lds
s_add_u32 m0,s63,27648
s_add_u32 s65,s58,6586368
buffer_load_dwordx4 v6,s[4:7],s65 offen lds
s_add_u32 m0,s63,28672
s_add_u32 s65,s58,6684672
buffer_load_dwordx4 v6,s[4:7],s65 offen lds
s_add_u32 m0,s63,29696
s_add_u32 s65,s58,6782976
buffer_load_dwordx4 v6,s[4:7],s65 offen lds
s_add_u32 m0,s63,30720
s_add_u32 s65,s58,6881280
buffer_load_dwordx4 v6,s[4:7],s65 offen lds
s_add_u32 m0,s63,31744
s_add_u32 s65,s58,6979584
buffer_load_dwordx4 v6,s[4:7],s65 offen lds
s_add_u32 m0,s63,32768
s_add_u32 s65,s58,7077888
buffer_load_dwordx4 v6,s[4:7],s65 offen lds
s_add_u32 m0,s63,33792
s_add_u32 s65,s58,7176192
buffer_load_dwordx4 v6,s[4:7],s65 offen lds
s_add_u32 m0,s63,34816
s_add_u32 s65,s58,7274496
buffer_load_dwordx4 v6,s[4:7],s65 offen lds
s_add_u32 m0,s63,35840
s_add_u32 s65,s58,7372800
buffer_load_dwordx4 v6,s[4:7],s65 offen lds
s_add_u32 m0,s63,36864
s_add_u32 s65,s58,7471104
buffer_load_dwordx4 v6,s[4:7],s65 offen lds
s_add_u32 m0,s63,37888
s_add_u32 s65,s58,7569408
buffer_load_dwordx4 v6,s[4:7],s65 offen lds
s_add_u32 m0,s63,38912
s_add_u32 s65,s58,7667712
buffer_load_dwordx4 v6,s[4:7],s65 offen lds
s_add_u32 m0,s63,39936
s_add_u32 s65,s58,7766016
buffer_load_dwordx4 v6,s[4:7],s65 offen lds
v_mfma_f32_32x32x16_bf16 v[56:71],v[24:27],a[40:43],v[56:71]
v_mfma_f32_32x32x16_bf16 v[72:87],v[24:27],a[200:203],v[72:87]
v_mfma_f32_32x32x16_bf16 v[56:71],v[24:27],a[44:47],v[56:71]
v_mfma_f32_32x32x16_bf16 v[72:87],v[24:27],a[204:207],v[72:87]
v_mfma_f32_32x32x16_bf16 v[56:71],v[24:27],a[48:51],v[56:71]
v_mfma_f32_32x32x16_bf16 v[72:87],v[24:27],a[208:211],v[72:87]
v_mfma_f32_32x32x16_bf16 v[56:71],v[24:27],a[52:55],v[56:71]
v_mfma_f32_32x32x16_bf16 v[72:87],v[24:27],a[212:215],v[72:87]
v_mfma_f32_32x32x16_bf16 v[56:71],v[24:27],a[56:59],v[56:71]
v_mfma_f32_32x32x16_bf16 v[72:87],v[24:27],a[216:219],v[72:87]
v_mfma_f32_32x32x16_bf16 v[56:71],v[24:27],a[60:63],v[56:71]
v_mfma_f32_32x32x16_bf16 v[72:87],v[24:27],a[220:223],v[72:87]
v_mfma_f32_32x32x16_bf16 v[56:71],v[24:27],a[64:67],v[56:71]
v_mfma_f32_32x32x16_bf16 v[72:87],v[24:27],a[224:227],v[72:87]
v_mfma_f32_32x32x16_bf16 v[56:71],v[24:27],a[68:71],v[56:71]
v_mfma_f32_32x32x16_bf16 v[72:87],v[24:27],a[228:231],v[72:87]
v_mfma_f32_32x32x16_bf16 v[56:71],v[24:27],a[72:75],v[56:71]
v_mfma_f32_32x32x16_bf16 v[72:87],v[24:27],a[232:235],v[72:87]
v_mfma_f32_32x32x16_bf16 v[56:71],v[24:27],a[76:79],v[56:71]
v_mfma_f32_32x32x16_bf16 v[72:87],v[24:27],a[236:239],v[72:87]
s_waitcnt vmcnt(20)
v_bfe_u32 v9,v0,2,2
v_lshrrev_b32 v10,5,v0
v_lshl_add_u32 v9,v10,2,v9
v_mul_u32_u24 v9,128,v9
v_and_b32 v10,1,v0
v_lshl_add_u32 v9,v10,3,v9
v_bfe_u32 v10,v0,1,1
v_lshl_add_u32 v9,v10,4,v9
v_bfe_u32 v10,v0,4,1
v_lshl_add_u32 v9,v10,5,v9
v_add_u32 v7,s63,v9
ds_read_b64_tr_b16 a[80:81],v7 offset:0
ds_read_b64_tr_b16 a[82:83],v7 offset:2048
ds_read_b64_tr_b16 a[84:85],v7 offset:1024
ds_read_b64_tr_b16 a[86:87],v7 offset:3072
ds_read_b64_tr_b16 a[240:241],v7 offset:64
ds_read_b64_tr_b16 a[242:243],v7 offset:2112
ds_read_b64_tr_b16 a[244:245],v7 offset:1088
ds_read_b64_tr_b16 a[246:247],v7 offset:3136
ds_read_b64_tr_b16 a[88:89],v7 offset:4096
ds_read_b64_tr_b16 a[90:91],v7 offset:6144
ds_read_b64_tr_b16 a[92:93],v7 offset:5120
ds_read_b64_tr_b16 a[94:95],v7 offset:7168
s_waitcnt lgkmcnt(4)
ds_read_b64_tr_b16 a[248:249],v7 offset:4160
ds_read_b64_tr_b16 a[250:251],v7 offset:6208
ds_read_b64_tr_b16 a[252:253],v7 offset:5184
ds_read_b64_tr_b16 a[254:255],v7 offset:7232
ds_read_b64_tr_b16 a[96:97],v7 offset:8192
ds_read_b64_tr_b16 a[98:99],v7 offset:10240
ds_read_b64_tr_b16 a[100:101],v7 offset:9216
ds_read_b64_tr_b16 a[102:103],v7 offset:11264
ds_read_b64_tr_b16 v[192:193],v7 offset:8256
ds_read_b64_tr_b16 v[194:195],v7 offset:10304
ds_read_b64_tr_b16 v[196:197],v7 offset:9280
ds_read_b64_tr_b16 v[198:199],v7 offset:11328
s_waitcnt lgkmcnt(4)
ds_read_b64_tr_b16 a[104:105],v7 offset:12288
ds_read_b64_tr_b16 a[106:107],v7 offset:14336
ds_read_b64_tr_b16 a[108:109],v7 offset:13312
ds_read_b64_tr_b16 a[110:111],v7 offset:15360
ds_read_b64_tr_b16 v[200:201],v7 offset:12352
ds_read_b64_tr_b16 v[202:203],v7 offset:14400
ds_read_b64_tr_b16 v[204:205],v7 offset:13376
ds_read_b64_tr_b16 v[206:207],v7 offset:15424
ds_read_b64_tr_b16 a[112:113],v7 offset:16384
ds_read_b64_tr_b16 a[114:115],v7 offset:18432
ds_read_b64_tr_b16 a[116:117],v7 offset:17408
ds_read_b64_tr_b16 a[118:119],v7 offset:19456
s_waitcnt lgkmcnt(4)
ds_read_b64_tr_b16 v[208:209],v7 offset:16448
ds_read_b64_tr_b16 v[210:211],v7 offset:18496
ds_read_b64_tr_b16 v[212:213],v7 offset:17472
ds_read_b64_tr_b16 v[214:215],v7 offset:19520
s_waitcnt lgkmcnt(0)
v_mfma_f32_32x32x16_bf16 v[56:71],v[24:27],a[80:83],v[56:71]
v_mfma_f32_32x32x16_bf16 v[72:87],v[24:27],a[240:243],v[72:87]
v_mfma_f32_32x32x16_bf16 v[56:71],v[24:27],a[84:87],v[56:71]
v_mfma_f32_32x32x16_bf16 v[72:87],v[24:27],a[244:247],v[72:87]
v_mfma_f32_32x32x16_bf16 v[56:71],v[24:27],a[88:91],v[56:71]
v_mfma_f32_32x32x16_bf16 v[72:87],v[24:27],a[248:251],v[72:87]
v_mfma_f32_32x32x16_bf16 v[56:71],v[24:27],a[92:95],v[56:71]
v_mfma_f32_32x32x16_bf16 v[72:87],v[24:27],a[252:255],v[72:87]
v_mfma_f32_32x32x16_bf16 v[56:71],v[24:27],a[96:99],v[56:71]
v_mfma_f32_32x32x16_bf16 v[72:87],v[24:27],v[192:195],v[72:87]
v_mfma_f32_32x32x16_bf16 v[56:71],v[24:27],a[100:103],v[56:71]
v_mfma_f32_32x32x16_bf16 v[72:87],v[24:27],v[196:199],v[72:87]
v_mfma_f32_32x32x16_bf16 v[56:71],v[24:27],a[104:107],v[56:71]
v_mfma_f32_32x32x16_bf16 v[72:87],v[24:27],v[200:203],v[72:87]
v_mfma_f32_32x32x16_bf16 v[56:71],v[24:27],a[108:111],v[56:71]
v_mfma_f32_32x32x16_bf16 v[72:87],v[24:27],v[204:207],v[72:87]
v_mfma_f32_32x32x16_bf16 v[56:71],v[24:27],a[112:115],v[56:71]
v_mfma_f32_32x32x16_bf16 v[72:87],v[24:27],v[208:211],v[72:87]
v_mfma_f32_32x32x16_bf16 v[56:71],v[24:27],a[116:119],v[56:71]
v_mfma_f32_32x32x16_bf16 v[72:87],v[24:27],v[212:215],v[72:87]
s_waitcnt vmcnt(0)
v_bfe_u32 v9,v0,2,2
v_lshrrev_b32 v10,5,v0
v_lshl_add_u32 v9,v10,2,v9
v_mul_u32_u24 v9,128,v9
v_and_b32 v10,1,v0
v_lshl_add_u32 v9,v10,3,v9
v_bfe_u32 v10,v0,1,1
v_lshl_add_u32 v9,v10,4,v9
v_bfe_u32 v10,v0,4,1
v_lshl_add_u32 v9,v10,5,v9
v_add_u32 v7,s63,v9
ds_read_b64_tr_b16 a[120:121],v7 offset:20480
ds_read_b64_tr_b16 a[122:123],v7 offset:22528
ds_read_b64_tr_b16 a[124:125],v7 offset:21504
ds_read_b64_tr_b16 a[126:127],v7 offset:23552
ds_read_b64_tr_b16 v[216:217],v7 offset:20544
ds_read_b64_tr_b16 v[218:219],v7 offset:22592
ds_read_b64_tr_b16 v[220:221],v7 offset:21568
ds_read_b64_tr_b16 v[222:223],v7 offset:23616
ds_read_b64_tr_b16 a[128:129],v7 offset:24576
ds_read_b64_tr_b16 a[130:131],v7 offset:26624
ds_read_b64_tr_b16 a[132:133],v7 offset:25600
ds_read_b64_tr_b16 a[134:135],v7 offset:27648
s_waitcnt lgkmcnt(4)
ds_read_b64_tr_b16 v[224:225],v7 offset:24640
ds_read_b64_tr_b16 v[226:227],v7 offset:26688
ds_read_b64_tr_b16 v[228:229],v7 offset:25664
ds_read_b64_tr_b16 v[230:231],v7 offset:27712
ds_read_b64_tr_b16 a[136:137],v7 offset:28672
ds_read_b64_tr_b16 a[138:139],v7 offset:30720
ds_read_b64_tr_b16 a[140:141],v7 offset:29696
ds_read_b64_tr_b16 a[142:143],v7 offset:31744
ds_read_b64_tr_b16 v[232:233],v7 offset:28736
ds_read_b64_tr_b16 v[234:235],v7 offset:30784
ds_read_b64_tr_b16 v[236:237],v7 offset:29760
ds_read_b64_tr_b16 v[238:239],v7 offset:31808
s_waitcnt lgkmcnt(4)
ds_read_b64_tr_b16 a[144:145],v7 offset:32768
ds_read_b64_tr_b16 a[146:147],v7 offset:34816
ds_read_b64_tr_b16 a[148:149],v7 offset:33792
ds_read_b64_tr_b16 a[150:151],v7 offset:35840
ds_read_b64_tr_b16 v[240:241],v7 offset:32832
ds_read_b64_tr_b16 v[242:243],v7 offset:34880
ds_read_b64_tr_b16 v[244:245],v7 offset:33856
ds_read_b64_tr_b16 v[246:247],v7 offset:35904
ds_read_b64_tr_b16 a[152:153],v7 offset:36864
ds_read_b64_tr_b16 a[154:155],v7 offset:38912
ds_read_b64_tr_b16 a[156:157],v7 offset:37888
ds_read_b64_tr_b16 a[158:159],v7 offset:39936
s_waitcnt lgkmcnt(4)
ds_read_b64_tr_b16 v[248:249],v7 offset:36928
ds_read_b64_tr_b16 v[250:251],v7 offset:38976
ds_read_b64_tr_b16 v[252:253],v7 offset:37952
ds_read_b64_tr_b16 v[254:255],v7 offset:40000
s_waitcnt lgkmcnt(0)
v_mfma_f32_32x32x16_bf16 v[56:71],v[24:27],a[120:123],v[56:71]
v_mfma_f32_32x32x16_bf16 v[72:87],v[24:27],v[216:219],v[72:87]
v_mfma_f32_32x32x16_bf16 v[56:71],v[24:27],a[124:127],v[56:71]
v_mfma_f32_32x32x16_bf16 v[72:87],v[24:27],v[220:223],v[72:87]
v_mfma_f32_32x32x16_bf16 v[56:71],v[24:27],a[128:131],v[56:71]
v_mfma_f32_32x32x16_bf16 v[72:87],v[24:27],v[224:227],v[72:87]
v_mfma_f32_32x32x16_bf16 v[56:71],v[24:27],a[132:135],v[56:71]
v_mfma_f32_32x32x16_bf16 v[72:87],v[24:27],v[228:231],v[72:87]
v_mfma_f32_32x32x16_bf16 v[56:71],v[24:27],a[136:139],v[56:71]
v_mfma_f32_32x32x16_bf16 v[72:87],v[24:27],v[232:235],v[72:87]
v_mfma_f32_32x32x16_bf16 v[56:71],v[24:27],a[140:143],v[56:71]
v_mfma_f32_32x32x16_bf16 v[72:87],v[24:27],v[236:239],v[72:87]
v_mfma_f32_32x32x16_bf16 v[56:71],v[24:27],a[144:147],v[56:71]
v_mfma_f32_32x32x16_bf16 v[72:87],v[24:27],v[240:243],v[72:87]
v_mfma_f32_32x32x16_bf16 v[56:71],v[24:27],a[148:151],v[56:71]
v_mfma_f32_32x32x16_bf16 v[72:87],v[24:27],v[244:247],v[72:87]
v_mfma_f32_32x32x16_bf16 v[56:71],v[24:27],a[152:155],v[56:71]
v_mfma_f32_32x32x16_bf16 v[72:87],v[24:27],v[248:251],v[72:87]
v_mfma_f32_32x32x16_bf16 v[56:71],v[24:27],a[156:159],v[56:71]
v_mfma_f32_32x32x16_bf16 v[72:87],v[24:27],v[252:255],v[72:87]
s_nop 4
v_mov_b32 v120,v56
s_nop 5
v_mov_b32 v121,v72
s_barrier
s_lshl_b32 s3,s49,2
v_mov_b32 v7,s3
s_nop 1
ibw_223:
buffer_load_dword v6,v7,s[12:15],0 offen sc1
s_waitcnt vmcnt(0)
v_cmp_ne_u32 vcc,256,v6
s_nop 0
s_cbranch_vccz ok_224
s_sleep 8
s_sub_u32 s47,s47,1
s_cbranch_scc1 ABORT
s_branch ibw_223
ok_224:
s_cmp_lg_u32 s49,0
s_cbranch_scc1 ibok_225
v_and_b32 v7,7,v0
v_lshlrev_b32 v7,2,v7
buffer_load_dword v6,v7,s[12:15],0 offen offset:32 sc1
s_waitcnt vmcnt(0)
v_cmp_ne_u32 vcc,32,v6
s_nop 0
s_cbranch_vccz ibok_225
s_barrier
s_mov_b32 s49,1
s_mov_b32 s3,s2
s_load_dwordx16 s[16:31],s[0:1],0
s_load_dwordx8 s[32:39],s[0:1],64
s_waitcnt lgkmcnt(0)
s_branch DISPATCH
ibok_225:
s_mov_b32 s50,0
s_mov_b32 s32,0
s_mov_b32 s57,0
s_mov_b32 s59,2147483648
s_mov_b32 s82,2147483648
s_mov_b32 s39,2147483648
v_mov_b32 v22,94208
s_mov_b32 s72,0
s_mov_b32 s73,0
s_mov_b32 s78,0
s_mov_b32 s79,0
s_cmp_eq_u32 s46,0
s_cselect_b32 s40,0,2147483648
s_lshl_b32 s60,s46,3
v_add_u32 v13,s60,v22
s_mov_b32 s83,s100
s_lshl_b32 s41,s78,9
s_add_u32 s41,s41,s40
s_lshl_b32 s35,s79,9
s_add_u32 s35,s35,s40
s_add_u32 s35,s35,32768
s_branch QKVV_COLD0
QKVV_B0:
s_waitcnt lgkmcnt(3)
v_mfma_f32_32x32x16_bf16 v[56:71],v[24:27],a[0:3],0
ds_read_b128 v[44:47],v17 offset:4096
v_add_u32 v189,s57,v188
v_mfma_f32_32x32x16_bf16 v[72:87],v[24:27],a[160:163],0
v_add_u32 v8,0x800,v189
s_sub_u32 s66,46080,s57
s_lshl_b32 s60,s33,6
s_add_u32 s60,s60,s34
s_mul_i32 s60,s60,46080
s_add_u32 s60,s60,s37
v_mfma_f32_32x32x16_bf16 v[56:71],v[28:31],a[4:7],v[56:71]
ds_read_b128 v[48:51],v16 offset:6144
ds_read2_b64 v[156:159],v189 offset0:0 offset1:32
s_add_u32 s60,s60,206569472
v_mfma_f32_32x32x16_bf16 v[72:87],v[28:31],a[164:167],v[72:87]
ds_read2_b64 v[160:163],v189 offset0:64 offset1:96
s_cmp_eq_u32 s33,0
s_cselect_b32 s67,2147483648,s60
s_mul_i32 s61,s46,10240
s_waitcnt lgkmcnt(5)
v_mfma_f32_32x32x16_bf16 v[56:71],v[32:35],a[8:11],v[56:71]
ds_read_b128 v[52:55],v17 offset:6144
ds_read2_b64 v[164:167],v189 offset0:128 offset1:160
s_add_u32 s60,s60,s61
s_add_u32 s61,s61,s66
v_mfma_f32_32x32x16_bf16 v[72:87],v[32:35],a[168:171],v[72:87]
ds_read2_b64 v[168:171],v189 offset0:192 offset1:224
s_add_u32 m0,s61,0
s_add_u32 s63,s60,0
buffer_load_dwordx4 v1,s[8:11],s63 offen sc1 lds
v_mfma_f32_32x32x16_bf16 v[56:71],v[36:39],a[12:15],v[56:71]
ds_read_b128 v[24:27],v16 offset:8192
ds_read2_b64 v[172:175],v8 offset0:0 offset1:32
s_mul_i32 s74,s73,393216
s_add_u32 s74,s74,s39
v_mfma_f32_32x32x16_bf16 v[72:87],v[36:39],a[172:175],v[72:87]
s_add_u32 s74,s74,s70
v_fma_f32 v88,-v124,v120,v88
v_fma_f32 v89,-v126,v120,v89
v_fma_f32 v90,-v128,v120,v90
v_fma_f32 v91,-v130,v120,v91
s_waitcnt lgkmcnt(8)
v_mfma_f32_32x32x16_bf16 v[56:71],v[40:43],a[16:19],v[56:71]
ds_read_b128 v[28:31],v17 offset:8192
buffer_load_dwordx4 v1,s[8:11],s63 offen offset:1024 sc1 lds
v_fma_f32 v96,-v140,v120,v96
v_fma_f32 v97,-v142,v120,v97
v_mfma_f32_32x32x16_bf16 v[72:87],v[40:43],a[176:179],v[72:87]
v_fma_f32 v98,-v144,v120,v98
v_fma_f32 v99,-v146,v120,v99
v_mul_f32 v88,v88,v125
v_mul_f32 v89,v89,v127
v_mul_f32 v90,v90,v129
v_mfma_f32_32x32x16_bf16 v[56:71],v[44:47],a[20:23],v[56:71]
ds_read_b128 v[32:35],v16 offset:10240
s_mov_b32 s53,s33
s_mov_b32 s54,s34
s_add_u32 s79,s79,s33
s_or_b32 s65,s37,s33
v_mfma_f32_32x32x16_bf16 v[72:87],v[44:47],a[180:183],v[72:87]
buffer_load_dwordx4 v1,s[8:11],s63 offen offset:2048 sc1 lds
s_cmp_eq_u32 s65,0
s_addc_u32 s78,s78,0
s_lshl_b32 s41,s78,9
s_waitcnt lgkmcnt(6)
v_mfma_f32_32x32x16_bf16 v[56:71],v[48:51],a[24:27],v[56:71]
ds_read_b128 v[36:39],v17 offset:10240
s_add_u32 s41,s41,s40
s_lshl_b32 s35,s79,9
s_add_u32 s35,s35,s40
s_add_u32 s35,s35,32768
v_mfma_f32_32x32x16_bf16 v[72:87],v[48:51],a[184:187],v[72:87]
v_mul_f32 v91,v91,v131
v_mul_f32 v96,v96,v141
v_mul_f32 v97,v97,v143
v_mul_f32 v98,v98,v145
v_mul_f32 v99,v99,v147
v_mfma_f32_32x32x16_bf16 v[56:71],v[52:55],a[28:31],v[56:71]
ds_read_b128 v[40:43],v16 offset:12288
buffer_load_dwordx4 v1,s[8:11],s63 offen offset:3072 sc1 lds
s_add_u32 m0,s61,4096
s_add_u32 s63,s60,4096
v_mfma_f32_32x32x16_bf16 v[72:87],v[52:55],a[188:191],v[72:87]
v_cvt_pk_bf16_f32 v88,v88,v89
v_cvt_pk_bf16_f32 v89,v90,v91
v_cvt_pk_bf16_f32 v90,v96,v97
v_cvt_pk_bf16_f32 v91,v98,v99
v_fma_f32 v92,-v132,v120,v92
s_waitcnt lgkmcnt(3)
v_mfma_f32_32x32x16_bf16 v[56:71],v[24:27],a[32:35],v[56:71]
ds_read_b128 v[44:47],v17 offset:12288
v_fma_f32 v93,-v134,v120,v93
v_fma_f32 v94,-v136,v120,v94
v_fma_f32 v95,-v138,v120,v95
v_fma_f32 v100,-v148,v120,v100
v_mfma_f32_32x32x16_bf16 v[72:87],v[24:27],a[192:195],v[72:87]
buffer_load_dwordx4 v1,s[8:11],s63 offen sc1 lds
v_fma_f32 v101,-v150,v120,v101
v_fma_f32 v102,-v152,v120,v102
v_fma_f32 v103,-v154,v120,v103
v_mul_f32 v92,v92,v133
v_mfma_f32_32x32x16_bf16 v[56:71],v[28:31],a[36:39],v[56:71]
ds_read_b128 v[48:51],v16 offset:14336
v_mul_f32 v93,v93,v135
v_mul_f32 v94,v94,v137
v_mul_f32 v95,v95,v139
v_mul_f32 v100,v100,v149
v_mfma_f32_32x32x16_bf16 v[72:87],v[28:31],a[196:199],v[72:87]
v_mul_f32 v101,v101,v151
v_mul_f32 v102,v102,v153
v_mul_f32 v103,v103,v155
v_cvt_pk_bf16_f32 v92,v92,v93
v_cvt_pk_bf16_f32 v93,v94,v95
s_waitcnt lgkmcnt(3)
v_mfma_f32_32x32x16_bf16 v[56:71],v[32:35],a[40:43],v[56:71]
ds_read_b128 v[52:55],v17 offset:14336
buffer_load_dwordx4 v1,s[8:11],s63 offen offset:1024 sc1 lds
v_cvt_pk_bf16_f32 v94,v100,v101
v_cvt_pk_bf16_f32 v95,v102,v103
v_mfma_f32_32x32x16_bf16 v[72:87],v[32:35],a[200:203],v[72:87]
v_fma_f32 v104,-v124,v121,v104
v_fma_f32 v105,-v126,v121,v105
v_fma_f32 v106,-v128,v121,v106
v_fma_f32 v107,-v130,v121,v107
v_fma_f32 v112,-v140,v121,v112
v_mfma_f32_32x32x16_bf16 v[56:71],v[36:39],a[44:47],v[56:71]
ds_read_b128 v[24:27],v16 offset:16384
v_fma_f32 v113,-v142,v121,v113
v_fma_f32 v114,-v144,v121,v114
v_fma_f32 v115,-v146,v121,v115
v_mul_f32 v104,v104,v125
v_mfma_f32_32x32x16_bf16 v[72:87],v[36:39],a[204:207],v[72:87]
buffer_load_dwordx4 v1,s[8:11],s63 offen offset:2048 sc1 lds
v_mul_f32 v105,v105,v127
v_mul_f32 v106,v106,v129
v_mul_f32 v107,v107,v131
s_waitcnt lgkmcnt(3)
v_mfma_f32_32x32x16_bf16 v[56:71],v[40:43],a[48:51],v[56:71]
ds_read_b128 v[28:31],v17 offset:16384
v_mul_f32 v112,v112,v141
v_mul_f32 v113,v113,v143
v_mul_f32 v114,v114,v145
v_mul_f32 v115,v115,v147
v_mfma_f32_32x32x16_bf16 v[72:87],v[40:43],a[208:211],v[72:87]
v_cvt_pk_bf16_f32 v104,v104,v105
v_cvt_pk_bf16_f32 v105,v106,v107
v_cvt_pk_bf16_f32 v106,v112,v113
v_cvt_pk_bf16_f32 v107,v114,v115
v_fma_f32 v108,-v132,v121,v108
v_mfma_f32_32x32x16_bf16 v[56:71],v[44:47],a[52:55],v[56:71]
ds_read_b128 v[32:35],v16 offset:18432
buffer_load_dwordx4 v1,s[8:11],s63 offen offset:3072 sc1 lds
s_add_u32 m0,s61,8192
s_add_u32 s63,s60,8192
v_mfma_f32_32x32x16_bf16 v[72:87],v[44:47],a[212:215],v[72:87]
v_fma_f32 v109,-v134,v121,v109
v_fma_f32 v110,-v136,v121,v110
v_fma_f32 v111,-v138,v121,v111
v_fma_f32 v116,-v148,v121,v116
v_fma_f32 v117,-v150,v121,v117
s_waitcnt lgkmcnt(3)
v_mfma_f32_32x32x16_bf16 v[56:71],v[48:51],a[56:59],v[56:71]
ds_read_b128 v[36:39],v17 offset:18432
v_fma_f32 v118,-v152,v121,v118
v_fma_f32 v119,-v154,v121,v119
v_mul_f32 v108,v108,v133
v_mul_f32 v109,v109,v135
v_mfma_f32_32x32x16_bf16 v[72:87],v[48:51],a[216:219],v[72:87]
buffer_load_dwordx4 v1,s[8:11],s63 offen sc1 lds
v_mul_f32 v110,v110,v137
v_mul_f32 v111,v111,v139
v_mul_f32 v116,v116,v149
v_mul_f32 v117,v117,v151
v_mfma_f32_32x32x16_bf16 v[56:71],v[52:55],a[60:63],v[56:71]
ds_read_b128 v[40:43],v16 offset:20480
s_waitcnt vmcnt(9)
s_mov_b64 exec,1
buffer_store_dword v5,v1,s[8:11],s59 offen sc1
s_mov_b64 exec,-1
s_mov_b32 s59,2147483648
v_mfma_f32_32x32x16_bf16 v[72:87],v[52:55],a[220:223],v[72:87]
v_mul_f32 v118,v118,v153
v_mul_f32 v119,v119,v155
v_cvt_pk_bf16_f32 v108,v108,v109
v_cvt_pk_bf16_f32 v109,v110,v111
v_cvt_pk_bf16_f32 v110,v116,v117
s_waitcnt lgkmcnt(3)
v_mfma_f32_32x32x16_bf16 v[56:71],v[24:27],a[64:67],v[56:71]
ds_read_b128 v[44:47],v17 offset:20480
buffer_load_dwordx4 v1,s[8:11],s63 offen offset:1024 sc1 lds
s_lshl_b32 s62,s46,10
s_add_u32 s62,s62,40960
v_mfma_f32_32x32x16_bf16 v[72:87],v[24:27],a[224:227],v[72:87]
s_add_u32 m0,s66,s62
s_add_u32 s63,s67,s62
v_cvt_pk_bf16_f32 v111,v118,v119
s_lshl_b32 s82,s72,6
s_add_u32 s82,s82,s73
s_lshl_b32 s82,s82,9
v_mfma_f32_32x32x16_bf16 v[56:71],v[28:31],a[68:71],v[56:71]
ds_read_b128 v[48:51],v16 offset:22528
s_add_u32 s82,s82,s71
s_lshl_b32 s75,s69,2
s_add_u32 s82,s82,s75
s_add_u32 s82,s82,s39
v_mfma_f32_32x32x16_bf16 v[72:87],v[28:31],a[228:231],v[72:87]
buffer_load_dwordx4 v1,s[8:11],s63 offen sc1 lds
s_add_u32 m0,s66,45056
s_add_u32 s63,s67,45056
s_waitcnt lgkmcnt(3)
v_mfma_f32_32x32x16_bf16 v[56:71],v[32:35],a[72:75],v[56:71]
ds_read_b128 v[52:55],v17 offset:22528
buffer_load_dword v3,v2,s[8:11],s35 offen sc1
buffer_load_dword v14,v4,s[8:11],s41 offen sc1
v_mfma_f32_32x32x16_bf16 v[72:87],v[32:35],a[232:235],v[72:87]
v_add_f32 v156,v156,v166
v_add_f32 v157,v157,v167
v_add_f32 v158,v158,v168
v_add_f32 v159,v159,v169
v_add_f32 v160,v160,v170
v_mfma_f32_32x32x16_bf16 v[56:71],v[36:39],a[76:79],v[56:71]
ds_read_b128 v[24:27],v16 offset:24576
buffer_load_dwordx4 v1,s[8:11],s63 offen sc1 lds
v_add_f32 v161,v161,v171
v_add_f32 v162,v162,v172
v_mfma_f32_32x32x16_bf16 v[72:87],v[36:39],a[236:239],v[72:87]
v_add_f32 v163,v163,v173
v_add_f32 v164,v164,v174
v_add_f32 v165,v165,v175
v_add_f32 v156,v156,v158
v_add_f32 v157,v157,v159
s_waitcnt lgkmcnt(3)
v_mfma_f32_32x32x16_bf16 v[56:71],v[40:43],a[80:83],v[56:71]
ds_read_b128 v[28:31],v17 offset:24576
buffer_store_dwordx4 v[88:91],v20,s[8:11],s74 offen sc1
v_add_f32 v160,v160,v162
v_add_f32 v161,v161,v163
v_mfma_f32_32x32x16_bf16 v[72:87],v[40:43],a[240:243],v[72:87]
v_add_f32 v156,v156,v160
v_add_f32 v157,v157,v161
v_add_f32 v156,v156,v164
v_add_f32 v157,v157,v165
v_mov_b32 v158,v156
v_mfma_f32_32x32x16_bf16 v[56:71],v[44:47],a[84:87],v[56:71]
ds_read_b128 v[32:35],v16 offset:26624
buffer_store_dwordx4 v[92:95],v21,s[8:11],s74 offen sc1
v_mov_b32 v159,v157
v_permlane32_swap_b32 v156,v158
v_mfma_f32_32x32x16_bf16 v[72:87],v[44:47],a[244:247],v[72:87]
v_permlane32_swap_b32 v157,v159
v_add_f32 v176,v156,v158
v_add_f32 v177,v157,v159
v_mul_f32 v176,0x3acccccd,v176
v_mul_f32 v177,0x3acccccd,v177
s_waitcnt lgkmcnt(3)
v_mfma_f32_32x32x16_bf16 v[56:71],v[48:51],a[88:91],v[56:71]
ds_read_b128 v[36:39],v17 offset:26624
buffer_store_dwordx4 v[104:107],v20,s[8:11],s74 offen offset:2048 sc1
v_fma_f32 v177,-v176,v176,v177
v_max_f32 v177,0,v177
v_mfma_f32_32x32x16_bf16 v[72:87],v[48:51],a[248:251],v[72:87]
v_cvt_pk_bf16_f32 v8,v176,v177
v_lshlrev_b32 v176,16,v8
v_and_b32 v177,0xffff0000,v8
v_add_f32 v177,0x3727c5ac,v177
v_cvt_pk_bf16_f32 v8,v177,v177
v_mfma_f32_32x32x16_bf16 v[56:71],v[52:55],a[92:95],v[56:71]
ds_read_b128 v[40:43],v16 offset:28672
buffer_store_dwordx4 v[108:111],v21,s[8:11],s74 offen offset:2048 sc1
v_lshlrev_b32 v177,16,v8
v_mfma_f32_32x32x16_bf16 v[72:87],v[52:55],a[252:255],v[72:87]
v_sqrt_f32 v177,v177
s_nop 0
v_cvt_pk_bf16_f32 v8,v177,v177
v_lshlrev_b32 v177,16,v8
s_waitcnt lgkmcnt(3)
v_mfma_f32_32x32x16_bf16 v[56:71],v[24:27],a[96:99],v[56:71]
ds_read_b128 v[44:47],v17 offset:28672
v_rcp_f32 v177,v177
s_cmp_eq_u32 s51,0
s_cselect_b64 s[76:77],-1,0
v_mfma_f32_32x32x16_bf16 v[72:87],v[24:27],v[192:195],v[72:87]
v_cndmask_b32 v176,v176,0,s[76:77]
v_cndmask_b32 v177,v177,1.0,s[76:77]
s_mov_b32 s72,s51
s_mov_b32 s73,s52
ds_write_b64 v190,v[176:177]
v_mfma_f32_32x32x16_bf16 v[56:71],v[28:31],a[100:103],v[56:71]
ds_read_b128 v[48:51],v16 offset:30720
ds_read_b128 v[124:127],v191 offset:0
ds_read_b128 v[128:131],v191 offset:16
v_mfma_f32_32x32x16_bf16 v[72:87],v[28:31],v[196:199],v[72:87]
ds_read_b128 v[132:135],v191 offset:64
ds_read_b128 v[136:139],v191 offset:80
s_waitcnt lgkmcnt(8)
v_mfma_f32_32x32x16_bf16 v[56:71],v[32:35],a[104:107],v[56:71]
ds_read_b128 v[52:55],v17 offset:30720
ds_read_b128 v[140:143],v191 offset:128
ds_read_b128 v[144:147],v191 offset:144
v_mfma_f32_32x32x16_bf16 v[72:87],v[32:35],v[200:203],v[72:87]
ds_read_b128 v[148:151],v191 offset:192
ds_read_b128 v[152:155],v191 offset:208
v_mfma_f32_32x32x16_bf16 v[56:71],v[36:39],a[108:111],v[56:71]
ds_read_b128 v[24:27],v16 offset:32768
v_mfma_f32_32x32x16_bf16 v[72:87],v[36:39],v[204:207],v[72:87]
s_waitcnt lgkmcnt(12)
v_mfma_f32_32x32x16_bf16 v[56:71],v[40:43],a[112:115],v[56:71]
ds_read_b128 v[28:31],v17 offset:32768
v_mfma_f32_32x32x16_bf16 v[72:87],v[40:43],v[208:211],v[72:87]
v_mfma_f32_32x32x16_bf16 v[56:71],v[44:47],a[116:119],v[56:71]
ds_read_b128 v[32:35],v16 offset:34816
v_mfma_f32_32x32x16_bf16 v[72:87],v[44:47],v[212:215],v[72:87]
s_waitcnt lgkmcnt(7)
v_mfma_f32_32x32x16_bf16 v[56:71],v[48:51],a[120:123],v[56:71]
ds_read_b128 v[36:39],v17 offset:34816
v_mfma_f32_32x32x16_bf16 v[72:87],v[48:51],v[216:219],v[72:87]
v_mfma_f32_32x32x16_bf16 v[56:71],v[52:55],a[124:127],v[56:71]
ds_read_b128 v[40:43],v16 offset:36864
v_mfma_f32_32x32x16_bf16 v[72:87],v[52:55],v[220:223],v[72:87]
s_waitcnt lgkmcnt(3)
v_mfma_f32_32x32x16_bf16 v[56:71],v[24:27],a[128:131],v[56:71]
ds_read_b128 v[44:47],v17 offset:36864
s_waitcnt vmcnt(4)
v_cmp_eq_u32 vcc,0,v14
s_cmp_eq_u64 vcc,0
s_cselect_b32 s36,0,2147483648
v_mfma_f32_32x32x16_bf16 v[72:87],v[24:27],v[224:227],v[72:87]
v_cmp_eq_u32 vcc,0,v3
s_cmp_lt_u32 s78,64
s_cselect_b32 s36,s36,2147483648
s_cmp_eq_u64 vcc,0
s_cselect_b32 s60,1,s36
v_mfma_f32_32x32x16_bf16 v[56:71],v[28:31],a[132:135],v[56:71]
ds_read_b128 v[48:51],v16 offset:38912
s_cmp_lt_u32 s79,64
s_cselect_b32 s60,s60,s36
s_sub_u32 s61,s78,s79
s_or_b32 s61,s61,s36
v_mfma_f32_32x32x16_bf16 v[72:87],v[28:31],v[228:231],v[72:87]
s_cmp_lt_u32 s61,16
s_cselect_b32 s36,0,s60
v_mov_b32 v23,s36
s_waitcnt lgkmcnt(3)
v_mfma_f32_32x32x16_bf16 v[56:71],v[32:35],a[136:139],v[56:71]
ds_read_b128 v[52:55],v17 offset:38912
ds_write_b32 v13,v23
v_mfma_f32_32x32x16_bf16 v[72:87],v[32:35],v[232:235],v[72:87]
s_waitcnt lgkmcnt(0)
s_barrier
ds_read_b32 v23,v22
v_mfma_f32_32x32x16_bf16 v[56:71],v[36:39],a[140:143],v[56:71]
ds_read_b128 v[24:27],v18 offset:0
s_cmp_lt_u32 s50,2
s_cselect_b32 s42,1,0
s_cmp_ge_u32 s78,64
s_cselect_b32 s42,1,s42
v_mfma_f32_32x32x16_bf16 v[72:87],v[36:39],v[236:239],v[72:87]
s_or_b32 s42,s42,s37
s_mov_b32 s39,0
s_add_u32 s50,s50,1
s_sub_u32 s57,46080,s57
s_mov_b32 s51,s53
s_mov_b32 s52,s54
v_mfma_f32_32x32x16_bf16 v[56:71],v[40:43],a[144:147],v[56:71]
ds_read_b128 v[28:31],v19 offset:0
v_mfma_f32_32x32x16_bf16 v[72:87],v[40:43],v[240:243],v[72:87]
v_mfma_f32_32x32x16_bf16 v[56:71],v[44:47],a[148:151],v[56:71]
ds_read_b128 v[32:35],v18 offset:2048
s_waitcnt vmcnt(0)
s_mov_b64 exec,1
buffer_store_dword v5,v1,s[8:11],s82 offen sc1
s_mov_b64 exec,-1
s_mov_b32 s82,2147483648
v_mfma_f32_32x32x16_bf16 v[72:87],v[44:47],v[244:247],v[72:87]
s_waitcnt lgkmcnt(3)
v_readfirstlane_b32 s38,v23
s_and_b32 s37,s38,2147483648
s_and_b32 s33,s38,1
s_cselect_b32 s34,s79,s78
s_cmp_lg_u32 s42,0
v_mfma_f32_32x32x16_bf16 v[56:71],v[48:51],a[152:155],v[56:71]
ds_read_b128 v[36:39],v19 offset:2048
v_mfma_f32_32x32x16_bf16 v[72:87],v[48:51],v[248:251],v[72:87]
v_mfma_f32_32x32x16_bf16 v[56:71],v[52:55],a[156:159],v[56:71]
ds_read_b128 v[40:43],v18 offset:4096
v_mfma_f32_32x32x16_bf16 v[72:87],v[52:55],v[252:255],v[72:87]
s_cbranch_scc1 QKVV_S0
QKVV_B1:
s_waitcnt lgkmcnt(3)
v_mfma_f32_32x32x16_bf16 v[88:103],v[24:27],a[0:3],0
ds_read_b128 v[44:47],v19 offset:4096
v_add_u32 v189,s57,v188
v_mfma_f32_32x32x16_bf16 v[104:119],v[24:27],a[160:163],0
v_add_u32 v8,0x800,v189
s_sub_u32 s66,46080,s57
s_lshl_b32 s60,s33,6
s_add_u32 s60,s60,s34
s_mul_i32 s60,s60,46080
s_add_u32 s60,s60,s37
v_mfma_f32_32x32x16_bf16 v[88:103],v[28:31],a[4:7],v[88:103]
ds_read_b128 v[48:51],v18 offset:6144
ds_read2_b64 v[156:159],v189 offset0:0 offset1:32
s_add_u32 s60,s60,206569472
v_mfma_f32_32x32x16_bf16 v[104:119],v[28:31],a[164:167],v[104:119]
ds_read2_b64 v[160:163],v189 offset0:64 offset1:96
s_cmp_eq_u32 s33,0
s_cselect_b32 s67,2147483648,s60
s_mul_i32 s61,s46,10240
s_waitcnt lgkmcnt(5)
v_mfma_f32_32x32x16_bf16 v[88:103],v[32:35],a[8:11],v[88:103]
ds_read_b128 v[52:55],v19 offset:6144
ds_read2_b64 v[164:167],v189 offset0:128 offset1:160
s_add_u32 s60,s60,s61
s_add_u32 s61,s61,s66
v_mfma_f32_32x32x16_bf16 v[104:119],v[32:35],a[168:171],v[104:119]
ds_read2_b64 v[168:171],v189 offset0:192 offset1:224
s_add_u32 m0,s61,0
s_add_u32 s63,s60,0
buffer_load_dwordx4 v1,s[8:11],s63 offen sc1 lds
v_mfma_f32_32x32x16_bf16 v[88:103],v[36:39],a[12:15],v[88:103]
ds_read_b128 v[24:27],v18 offset:8192
ds_read2_b64 v[172:175],v8 offset0:0 offset1:32
s_mul_i32 s74,s73,393216
s_add_u32 s74,s74,s39
v_mfma_f32_32x32x16_bf16 v[104:119],v[36:39],a[172:175],v[104:119]
s_add_u32 s74,s74,s70
v_fma_f32 v56,-v124,v120,v56
v_fma_f32 v57,-v126,v120,v57
v_fma_f32 v58,-v128,v120,v58
v_fma_f32 v59,-v130,v120,v59
s_waitcnt lgkmcnt(8)
v_mfma_f32_32x32x16_bf16 v[88:103],v[40:43],a[16:19],v[88:103]
ds_read_b128 v[28:31],v19 offset:8192
buffer_load_dwordx4 v1,s[8:11],s63 offen offset:1024 sc1 lds
v_fma_f32 v64,-v140,v120,v64
v_fma_f32 v65,-v142,v120,v65
v_mfma_f32_32x32x16_bf16 v[104:119],v[40:43],a[176:179],v[104:119]
v_fma_f32 v66,-v144,v120,v66
v_fma_f32 v67,-v146,v120,v67
v_mul_f32 v56,v56,v125
v_mul_f32 v57,v57,v127
v_mul_f32 v58,v58,v129
v_mfma_f32_32x32x16_bf16 v[88:103],v[44:47],a[20:23],v[88:103]
ds_read_b128 v[32:35],v18 offset:10240
s_mov_b32 s53,s33
s_mov_b32 s54,s34
s_add_u32 s79,s79,s33
s_or_b32 s65,s37,s33
v_mfma_f32_32x32x16_bf16 v[104:119],v[44:47],a[180:183],v[104:119]
buffer_load_dwordx4 v1,s[8:11],s63 offen offset:2048 sc1 lds
s_cmp_eq_u32 s65,0
s_addc_u32 s78,s78,0
s_lshl_b32 s41,s78,9
s_waitcnt lgkmcnt(6)
v_mfma_f32_32x32x16_bf16 v[88:103],v[48:51],a[24:27],v[88:103]
ds_read_b128 v[36:39],v19 offset:10240
s_add_u32 s41,s41,s40
s_lshl_b32 s35,s79,9
s_add_u32 s35,s35,s40
s_add_u32 s35,s35,32768
v_mfma_f32_32x32x16_bf16 v[104:119],v[48:51],a[184:187],v[104:119]
v_mul_f32 v59,v59,v131
v_mul_f32 v64,v64,v141
v_mul_f32 v65,v65,v143
v_mul_f32 v66,v66,v145
v_mul_f32 v67,v67,v147
v_mfma_f32_32x32x16_bf16 v[88:103],v[52:55],a[28:31],v[88:103]
ds_read_b128 v[40:43],v18 offset:12288
buffer_load_dwordx4 v1,s[8:11],s63 offen offset:3072 sc1 lds
s_add_u32 m0,s61,4096
s_add_u32 s63,s60,4096
v_mfma_f32_32x32x16_bf16 v[104:119],v[52:55],a[188:191],v[104:119]
v_cvt_pk_bf16_f32 v56,v56,v57
v_cvt_pk_bf16_f32 v57,v58,v59
v_cvt_pk_bf16_f32 v58,v64,v65
v_cvt_pk_bf16_f32 v59,v66,v67
v_fma_f32 v60,-v132,v120,v60
s_waitcnt lgkmcnt(3)
v_mfma_f32_32x32x16_bf16 v[88:103],v[24:27],a[32:35],v[88:103]
ds_read_b128 v[44:47],v19 offset:12288
v_fma_f32 v61,-v134,v120,v61
v_fma_f32 v62,-v136,v120,v62
v_fma_f32 v63,-v138,v120,v63
v_fma_f32 v68,-v148,v120,v68
v_mfma_f32_32x32x16_bf16 v[104:119],v[24:27],a[192:195],v[104:119]
buffer_load_dwordx4 v1,s[8:11],s63 offen sc1 lds
v_fma_f32 v69,-v150,v120,v69
v_fma_f32 v70,-v152,v120,v70
v_fma_f32 v71,-v154,v120,v71
v_mul_f32 v60,v60,v133
v_mfma_f32_32x32x16_bf16 v[88:103],v[28:31],a[36:39],v[88:103]
ds_read_b128 v[48:51],v18 offset:14336
v_mul_f32 v61,v61,v135
v_mul_f32 v62,v62,v137
v_mul_f32 v63,v63,v139
v_mul_f32 v68,v68,v149
v_mfma_f32_32x32x16_bf16 v[104:119],v[28:31],a[196:199],v[104:119]
v_mul_f32 v69,v69,v151
v_mul_f32 v70,v70,v153
v_mul_f32 v71,v71,v155
v_cvt_pk_bf16_f32 v60,v60,v61
v_cvt_pk_bf16_f32 v61,v62,v63
s_waitcnt lgkmcnt(3)
v_mfma_f32_32x32x16_bf16 v[88:103],v[32:35],a[40:43],v[88:103]
ds_read_b128 v[52:55],v19 offset:14336
buffer_load_dwordx4 v1,s[8:11],s63 offen offset:1024 sc1 lds
v_cvt_pk_bf16_f32 v62,v68,v69
v_cvt_pk_bf16_f32 v63,v70,v71
v_mfma_f32_32x32x16_bf16 v[104:119],v[32:35],a[200:203],v[104:119]
v_fma_f32 v72,-v124,v121,v72
v_fma_f32 v73,-v126,v121,v73
v_fma_f32 v74,-v128,v121,v74
v_fma_f32 v75,-v130,v121,v75
v_fma_f32 v80,-v140,v121,v80
v_mfma_f32_32x32x16_bf16 v[88:103],v[36:39],a[44:47],v[88:103]
ds_read_b128 v[24:27],v18 offset:16384
v_fma_f32 v81,-v142,v121,v81
v_fma_f32 v82,-v144,v121,v82
v_fma_f32 v83,-v146,v121,v83
v_mul_f32 v72,v72,v125
v_mfma_f32_32x32x16_bf16 v[104:119],v[36:39],a[204:207],v[104:119]
buffer_load_dwordx4 v1,s[8:11],s63 offen offset:2048 sc1 lds
v_mul_f32 v73,v73,v127
v_mul_f32 v74,v74,v129
v_mul_f32 v75,v75,v131
s_waitcnt lgkmcnt(3)
v_mfma_f32_32x32x16_bf16 v[88:103],v[40:43],a[48:51],v[88:103]
ds_read_b128 v[28:31],v19 offset:16384
v_mul_f32 v80,v80,v141
v_mul_f32 v81,v81,v143
v_mul_f32 v82,v82,v145
v_mul_f32 v83,v83,v147
v_mfma_f32_32x32x16_bf16 v[104:119],v[40:43],a[208:211],v[104:119]
v_cvt_pk_bf16_f32 v72,v72,v73
v_cvt_pk_bf16_f32 v73,v74,v75
v_cvt_pk_bf16_f32 v74,v80,v81
v_cvt_pk_bf16_f32 v75,v82,v83
v_fma_f32 v76,-v132,v121,v76
v_mfma_f32_32x32x16_bf16 v[88:103],v[44:47],a[52:55],v[88:103]
ds_read_b128 v[32:35],v18 offset:18432
buffer_load_dwordx4 v1,s[8:11],s63 offen offset:3072 sc1 lds
s_add_u32 m0,s61,8192
s_add_u32 s63,s60,8192
v_mfma_f32_32x32x16_bf16 v[104:119],v[44:47],a[212:215],v[104:119]
v_fma_f32 v77,-v134,v121,v77
v_fma_f32 v78,-v136,v121,v78
v_fma_f32 v79,-v138,v121,v79
v_fma_f32 v84,-v148,v121,v84
v_fma_f32 v85,-v150,v121,v85
s_waitcnt lgkmcnt(3)
v_mfma_f32_32x32x16_bf16 v[88:103],v[48:51],a[56:59],v[88:103]
ds_read_b128 v[36:39],v19 offset:18432
v_fma_f32 v86,-v152,v121,v86
v_fma_f32 v87,-v154,v121,v87
v_mul_f32 v76,v76,v133
v_mul_f32 v77,v77,v135
v_mfma_f32_32x32x16_bf16 v[104:119],v[48:51],a[216:219],v[104:119]
buffer_load_dwordx4 v1,s[8:11],s63 offen sc1 lds
v_mul_f32 v78,v78,v137
v_mul_f32 v79,v79,v139
v_mul_f32 v84,v84,v149
v_mul_f32 v85,v85,v151
v_mfma_f32_32x32x16_bf16 v[88:103],v[52:55],a[60:63],v[88:103]
ds_read_b128 v[40:43],v18 offset:20480
s_waitcnt vmcnt(9)
s_mov_b64 exec,1
buffer_store_dword v5,v1,s[8:11],s59 offen sc1
s_mov_b64 exec,-1
s_mov_b32 s59,2147483648
v_mfma_f32_32x32x16_bf16 v[104:119],v[52:55],a[220:223],v[104:119]
v_mul_f32 v86,v86,v153
v_mul_f32 v87,v87,v155
v_cvt_pk_bf16_f32 v76,v76,v77
v_cvt_pk_bf16_f32 v77,v78,v79
v_cvt_pk_bf16_f32 v78,v84,v85
s_waitcnt lgkmcnt(3)
v_mfma_f32_32x32x16_bf16 v[88:103],v[24:27],a[64:67],v[88:103]
ds_read_b128 v[44:47],v19 offset:20480
buffer_load_dwordx4 v1,s[8:11],s63 offen offset:1024 sc1 lds
s_lshl_b32 s62,s46,10
s_add_u32 s62,s62,40960
v_mfma_f32_32x32x16_bf16 v[104:119],v[24:27],a[224:227],v[104:119]
s_add_u32 m0,s66,s62
s_add_u32 s63,s67,s62
v_cvt_pk_bf16_f32 v79,v86,v87
s_lshl_b32 s82,s72,6
s_add_u32 s82,s82,s73
s_lshl_b32 s82,s82,9
v_mfma_f32_32x32x16_bf16 v[88:103],v[28:31],a[68:71],v[88:103]
ds_read_b128 v[48:51],v18 offset:22528
s_add_u32 s82,s82,s71
s_lshl_b32 s75,s69,2
s_add_u32 s82,s82,s75
s_add_u32 s82,s82,s39
v_mfma_f32_32x32x16_bf16 v[104:119],v[28:31],a[228:231],v[104:119]
buffer_load_dwordx4 v1,s[8:11],s63 offen sc1 lds
s_add_u32 m0,s66,45056
s_add_u32 s63,s67,45056
s_waitcnt lgkmcnt(3)
v_mfma_f32_32x32x16_bf16 v[88:103],v[32:35],a[72:75],v[88:103]
ds_read_b128 v[52:55],v19 offset:22528
buffer_load_dword v3,v2,s[8:11],s35 offen sc1
buffer_load_dword v14,v4,s[8:11],s41 offen sc1
v_mfma_f32_32x32x16_bf16 v[104:119],v[32:35],a[232:235],v[104:119]
v_add_f32 v156,v156,v166
v_add_f32 v157,v157,v167
v_add_f32 v158,v158,v168
v_add_f32 v159,v159,v169
v_add_f32 v160,v160,v170
v_mfma_f32_32x32x16_bf16 v[88:103],v[36:39],a[76:79],v[88:103]
ds_read_b128 v[24:27],v18 offset:24576
buffer_load_dwordx4 v1,s[8:11],s63 offen sc1 lds
v_add_f32 v161,v161,v171
v_add_f32 v162,v162,v172
v_mfma_f32_32x32x16_bf16 v[104:119],v[36:39],a[236:239],v[104:119]
v_add_f32 v163,v163,v173
v_add_f32 v164,v164,v174
v_add_f32 v165,v165,v175
v_add_f32 v156,v156,v158
v_add_f32 v157,v157,v159
s_waitcnt lgkmcnt(3)
v_mfma_f32_32x32x16_bf16 v[88:103],v[40:43],a[80:83],v[88:103]
ds_read_b128 v[28:31],v19 offset:24576
buffer_store_dwordx4 v[56:59],v20,s[8:11],s74 offen sc1
v_add_f32 v160,v160,v162
v_add_f32 v161,v161,v163
v_mfma_f32_32x32x16_bf16 v[104:119],v[40:43],a[240:243],v[104:119]
v_add_f32 v156,v156,v160
v_add_f32 v157,v157,v161
v_add_f32 v156,v156,v164
v_add_f32 v157,v157,v165
v_mov_b32 v158,v156
v_mfma_f32_32x32x16_bf16 v[88:103],v[44:47],a[84:87],v[88:103]
ds_read_b128 v[32:35],v18 offset:26624
buffer_store_dwordx4 v[60:63],v21,s[8:11],s74 offen sc1
v_mov_b32 v159,v157
v_permlane32_swap_b32 v156,v158
v_mfma_f32_32x32x16_bf16 v[104:119],v[44:47],a[244:247],v[104:119]
v_permlane32_swap_b32 v157,v159
v_add_f32 v176,v156,v158
v_add_f32 v177,v157,v159
v_mul_f32 v176,0x3acccccd,v176
v_mul_f32 v177,0x3acccccd,v177
s_waitcnt lgkmcnt(3)
v_mfma_f32_32x32x16_bf16 v[88:103],v[48:51],a[88:91],v[88:103]
ds_read_b128 v[36:39],v19 offset:26624
buffer_store_dwordx4 v[72:75],v20,s[8:11],s74 offen offset:2048 sc1
v_fma_f32 v177,-v176,v176,v177
v_max_f32 v177,0,v177
v_mfma_f32_32x32x16_bf16 v[104:119],v[48:51],a[248:251],v[104:119]
v_cvt_pk_bf16_f32 v8,v176,v177
v_lshlrev_b32 v176,16,v8
v_and_b32 v177,0xffff0000,v8
v_add_f32 v177,0x3727c5ac,v177
v_cvt_pk_bf16_f32 v8,v177,v177
v_mfma_f32_32x32x16_bf16 v[88:103],v[52:55],a[92:95],v[88:103]
ds_read_b128 v[40:43],v18 offset:28672
buffer_store_dwordx4 v[76:79],v21,s[8:11],s74 offen offset:2048 sc1
v_lshlrev_b32 v177,16,v8
v_mfma_f32_32x32x16_bf16 v[104:119],v[52:55],a[252:255],v[104:119]
v_sqrt_f32 v177,v177
s_nop 0
v_cvt_pk_bf16_f32 v8,v177,v177
v_lshlrev_b32 v177,16,v8
s_waitcnt lgkmcnt(3)
v_mfma_f32_32x32x16_bf16 v[88:103],v[24:27],a[96:99],v[88:103]
ds_read_b128 v[44:47],v19 offset:28672
v_rcp_f32 v177,v177
s_cmp_eq_u32 s51,0
s_cselect_b64 s[76:77],-1,0
v_mfma_f32_32x32x16_bf16 v[104:119],v[24:27],v[192:195],v[104:119]
v_cndmask_b32 v176,v176,0,s[76:77]
v_cndmask_b32 v177,v177,1.0,s[76:77]
s_mov_b32 s72,s51
s_mov_b32 s73,s52
ds_write_b64 v190,v[176:177]
v_mfma_f32_32x32x16_bf16 v[88:103],v[28:31],a[100:103],v[88:103]
ds_read_b128 v[48:51],v18 offset:30720
ds_read_b128 v[124:127],v191 offset:0
ds_read_b128 v[128:131],v191 offset:16
v_mfma_f32_32x32x16_bf16 v[104:119],v[28:31],v[196:199],v[104:119]
ds_read_b128 v[132:135],v191 offset:64
ds_read_b128 v[136:139],v191 offset:80
s_waitcnt lgkmcnt(8)
v_mfma_f32_32x32x16_bf16 v[88:103],v[32:35],a[104:107],v[88:103]
ds_read_b128 v[52:55],v19 offset:30720
ds_read_b128 v[140:143],v191 offset:128
ds_read_b128 v[144:147],v191 offset:144
v_mfma_f32_32x32x16_bf16 v[104:119],v[32:35],v[200:203],v[104:119]
ds_read_b128 v[148:151],v191 offset:192
ds_read_b128 v[152:155],v191 offset:208
v_mfma_f32_32x32x16_bf16 v[88:103],v[36:39],a[108:111],v[88:103]
ds_read_b128 v[24:27],v18 offset:32768
v_mfma_f32_32x32x16_bf16 v[104:119],v[36:39],v[204:207],v[104:119]
s_waitcnt lgkmcnt(12)
v_mfma_f32_32x32x16_bf16 v[88:103],v[40:43],a[112:115],v[88:103]
ds_read_b128 v[28:31],v19 offset:32768
v_mfma_f32_32x32x16_bf16 v[104:119],v[40:43],v[208:211],v[104:119]
v_mfma_f32_32x32x16_bf16 v[88:103],v[44:47],a[116:119],v[88:103]
ds_read_b128 v[32:35],v18 offset:34816
v_mfma_f32_32x32x16_bf16 v[104:119],v[44:47],v[212:215],v[104:119]
s_waitcnt lgkmcnt(7)
v_mfma_f32_32x32x16_bf16 v[88:103],v[48:51],a[120:123],v[88:103]
ds_read_b128 v[36:39],v19 offset:34816
v_mfma_f32_32x32x16_bf16 v[104:119],v[48:51],v[216:219],v[104:119]
v_mfma_f32_32x32x16_bf16 v[88:103],v[52:55],a[124:127],v[88:103]
ds_read_b128 v[40:43],v18 offset:36864
v_mfma_f32_32x32x16_bf16 v[104:119],v[52:55],v[220:223],v[104:119]
s_waitcnt lgkmcnt(3)
v_mfma_f32_32x32x16_bf16 v[88:103],v[24:27],a[128:131],v[88:103]
ds_read_b128 v[44:47],v19 offset:36864
s_waitcnt vmcnt(4)
v_cmp_eq_u32 vcc,0,v14
s_cmp_eq_u64 vcc,0
s_cselect_b32 s36,0,2147483648
v_mfma_f32_32x32x16_bf16 v[104:119],v[24:27],v[224:227],v[104:119]
v_cmp_eq_u32 vcc,0,v3
s_cmp_lt_u32 s78,64
s_cselect_b32 s36,s36,2147483648
s_cmp_eq_u64 vcc,0
s_cselect_b32 s60,1,s36
v_mfma_f32_32x32x16_bf16 v[88:103],v[28:31],a[132:135],v[88:103]
ds_read_b128 v[48:51],v18 offset:38912
s_cmp_lt_u32 s79,64
s_cselect_b32 s60,s60,s36
s_sub_u32 s61,s78,s79
s_or_b32 s61,s61,s36
v_mfma_f32_32x32x16_bf16 v[104:119],v[28:31],v[228:231],v[104:119]
s_cmp_lt_u32 s61,16
s_cselect_b32 s36,0,s60
v_mov_b32 v23,s36
s_waitcnt lgkmcnt(3)
v_mfma_f32_32x32x16_bf16 v[88:103],v[32:35],a[136:139],v[88:103]
ds_read_b128 v[52:55],v19 offset:38912
ds_write_b32 v13,v23
v_mfma_f32_32x32x16_bf16 v[104:119],v[32:35],v[232:235],v[104:119]
s_waitcnt lgkmcnt(0)
s_barrier
ds_read_b32 v23,v22
v_mfma_f32_32x32x16_bf16 v[88:103],v[36:39],a[140:143],v[88:103]
ds_read_b128 v[24:27],v16 offset:0
s_cmp_lt_u32 s50,2
s_cselect_b32 s42,1,0
s_cmp_ge_u32 s78,64
s_cselect_b32 s42,1,s42
v_mfma_f32_32x32x16_bf16 v[104:119],v[36:39],v[236:239],v[104:119]
s_or_b32 s42,s42,s37
s_mov_b32 s39,0
s_add_u32 s50,s50,1
s_sub_u32 s57,46080,s57
s_mov_b32 s51,s53
s_mov_b32 s52,s54
v_mfma_f32_32x32x16_bf16 v[88:103],v[40:43],a[144:147],v[88:103]
ds_read_b128 v[28:31],v17 offset:0
v_mfma_f32_32x32x16_bf16 v[104:119],v[40:43],v[240:243],v[104:119]
v_mfma_f32_32x32x16_bf16 v[88:103],v[44:47],a[148:151],v[88:103]
ds_read_b128 v[32:35],v16 offset:2048
s_waitcnt vmcnt(0)
s_mov_b64 exec,1
buffer_store_dword v5,v1,s[8:11],s82 offen sc1
s_mov_b64 exec,-1
s_mov_b32 s82,2147483648
v_mfma_f32_32x32x16_bf16 v[104:119],v[44:47],v[244:247],v[104:119]
s_waitcnt lgkmcnt(3)
v_readfirstlane_b32 s38,v23
s_and_b32 s37,s38,2147483648
s_and_b32 s33,s38,1
s_cselect_b32 s34,s79,s78
s_cmp_lg_u32 s42,0
v_mfma_f32_32x32x16_bf16 v[88:103],v[48:51],a[152:155],v[88:103]
ds_read_b128 v[36:39],v17 offset:2048
v_mfma_f32_32x32x16_bf16 v[104:119],v[48:51],v[248:251],v[104:119]
v_mfma_f32_32x32x16_bf16 v[88:103],v[52:55],a[156:159],v[88:103]
ds_read_b128 v[40:43],v16 offset:4096
v_mfma_f32_32x32x16_bf16 v[104:119],v[52:55],v[252:255],v[104:119]
s_cbranch_scc0 QKVV_B0
s_branch QKVV_S1
s_nop 9
QKVV_S0:
s_mov_b32 s55,0
s_cmp_lt_u32 s42,2
s_cbranch_scc1 nt_226
s_mov_b32 s55,2
s_cmp_lg_u32 s37,0
s_cbranch_scc1 nt_226
s_mov_b32 s55,1
s_lshl_b32 s60,s33,6
s_add_u32 s60,s60,s34
s_mul_i32 s60,s60,46080
s_add_u32 s60,s60,206569472
s_cmp_eq_u32 s33,0
s_cselect_b32 s67,2147483648,s60
s_mul_i32 s61,s46,10240
s_add_u32 s60,s60,s61
s_add_u32 s61,s61,s57
s_add_u32 m0,s61,0
s_add_u32 s63,s60,0
buffer_load_dwordx4 v1,s[8:11],s63 offen sc1 lds
buffer_load_dwordx4 v1,s[8:11],s63 offen offset:1024 sc1 lds
buffer_load_dwordx4 v1,s[8:11],s63 offen offset:2048 sc1 lds
buffer_load_dwordx4 v1,s[8:11],s63 offen offset:3072 sc1 lds
s_add_u32 m0,s61,4096
s_add_u32 s63,s60,4096
buffer_load_dwordx4 v1,s[8:11],s63 offen sc1 lds
buffer_load_dwordx4 v1,s[8:11],s63 offen offset:1024 sc1 lds
buffer_load_dwordx4 v1,s[8:11],s63 offen offset:2048 sc1 lds
buffer_load_dwordx4 v1,s[8:11],s63 offen offset:3072 sc1 lds
s_add_u32 m0,s61,8192
s_add_u32 s63,s60,8192
buffer_load_dwordx4 v1,s[8:11],s63 offen sc1 lds
buffer_load_dwordx4 v1,s[8:11],s63 offen offset:1024 sc1 lds
s_lshl_b32 s62,s46,10
s_add_u32 s62,s62,40960
s_add_u32 m0,s57,s62
s_add_u32 s63,s67,s62
buffer_load_dwordx4 v1,s[8:11],s63 offen sc1 lds
s_add_u32 m0,s57,45056
s_add_u32 s63,s67,45056
buffer_load_dwordx4 v1,s[8:11],s63 offen sc1 lds
nt_226:
s_nop 4
s_mul_i32 s74,s73,393216
s_add_u32 s74,s74,s39
s_add_u32 s74,s74,s70
v_fma_f32 v56,-v124,v120,v56
v_fma_f32 v57,-v126,v120,v57
v_fma_f32 v58,-v128,v120,v58
v_fma_f32 v59,-v130,v120,v59
v_fma_f32 v64,-v140,v120,v64
v_fma_f32 v65,-v142,v120,v65
v_fma_f32 v66,-v144,v120,v66
v_fma_f32 v67,-v146,v120,v67
v_mul_f32 v56,v56,v125
v_mul_f32 v57,v57,v127
v_mul_f32 v58,v58,v129
v_mul_f32 v59,v59,v131
v_mul_f32 v64,v64,v141
v_mul_f32 v65,v65,v143
v_mul_f32 v66,v66,v145
v_mul_f32 v67,v67,v147
v_cvt_pk_bf16_f32 v56,v56,v57
v_cvt_pk_bf16_f32 v57,v58,v59
v_cvt_pk_bf16_f32 v58,v64,v65
v_cvt_pk_bf16_f32 v59,v66,v67
buffer_store_dwordx4 v[56:59],v20,s[8:11],s74 offen sc1
v_fma_f32 v60,-v132,v120,v60
v_fma_f32 v61,-v134,v120,v61
v_fma_f32 v62,-v136,v120,v62
v_fma_f32 v63,-v138,v120,v63
v_fma_f32 v68,-v148,v120,v68
v_fma_f32 v69,-v150,v120,v69
v_fma_f32 v70,-v152,v120,v70
v_fma_f32 v71,-v154,v120,v71
v_mul_f32 v60,v60,v133
v_mul_f32 v61,v61,v135
v_mul_f32 v62,v62,v137
v_mul_f32 v63,v63,v139
v_mul_f32 v68,v68,v149
v_mul_f32 v69,v69,v151
v_mul_f32 v70,v70,v153
v_mul_f32 v71,v71,v155
v_cvt_pk_bf16_f32 v60,v60,v61
v_cvt_pk_bf16_f32 v61,v62,v63
v_cvt_pk_bf16_f32 v62,v68,v69
v_cvt_pk_bf16_f32 v63,v70,v71
buffer_store_dwordx4 v[60:63],v21,s[8:11],s74 offen sc1
v_fma_f32 v72,-v124,v121,v72
v_fma_f32 v73,-v126,v121,v73
v_fma_f32 v74,-v128,v121,v74
v_fma_f32 v75,-v130,v121,v75
v_fma_f32 v80,-v140,v121,v80
v_fma_f32 v81,-v142,v121,v81
v_fma_f32 v82,-v144,v121,v82
v_fma_f32 v83,-v146,v121,v83
v_mul_f32 v72,v72,v125
v_mul_f32 v73,v73,v127
v_mul_f32 v74,v74,v129
v_mul_f32 v75,v75,v131
v_mul_f32 v80,v80,v141
v_mul_f32 v81,v81,v143
v_mul_f32 v82,v82,v145
v_mul_f32 v83,v83,v147
v_cvt_pk_bf16_f32 v72,v72,v73
v_cvt_pk_bf16_f32 v73,v74,v75
v_cvt_pk_bf16_f32 v74,v80,v81
v_cvt_pk_bf16_f32 v75,v82,v83
buffer_store_dwordx4 v[72:75],v20,s[8:11],s74 offen offset:2048 sc1
v_fma_f32 v76,-v132,v121,v76
v_fma_f32 v77,-v134,v121,v77
v_fma_f32 v78,-v136,v121,v78
v_fma_f32 v79,-v138,v121,v79
v_fma_f32 v84,-v148,v121,v84
v_fma_f32 v85,-v150,v121,v85
v_fma_f32 v86,-v152,v121,v86
v_fma_f32 v87,-v154,v121,v87
v_mul_f32 v76,v76,v133
v_mul_f32 v77,v77,v135
v_mul_f32 v78,v78,v137
v_mul_f32 v79,v79,v139
v_mul_f32 v84,v84,v149
v_mul_f32 v85,v85,v151
v_mul_f32 v86,v86,v153
v_mul_f32 v87,v87,v155
v_cvt_pk_bf16_f32 v76,v76,v77
v_cvt_pk_bf16_f32 v77,v78,v79
v_cvt_pk_bf16_f32 v78,v84,v85
v_cvt_pk_bf16_f32 v79,v86,v87
buffer_store_dwordx4 v[76:79],v21,s[8:11],s74 offen offset:2048 sc1
s_lshl_b32 s82,s72,6
s_add_u32 s82,s82,s73
s_lshl_b32 s82,s82,9
s_add_u32 s82,s82,s71
s_lshl_b32 s75,s69,2
s_add_u32 s82,s82,s75
s_add_u32 s82,s82,s39
s_mov_b32 s59,s82
s_mov_b32 s82,2147483648
s_mov_b32 s39,2147483648
s_cmp_eq_u32 s55,0
s_cbranch_scc1 QKVV_B1
s_cmp_eq_u32 s55,1
s_cbranch_scc1 QKVV_CD1
s_waitcnt vmcnt(0)
s_mov_b64 exec,1
buffer_store_dword v5,v1,s[8:11],s59 offen sc1
s_mov_b64 exec,-1
s_mov_b32 s59,2147483648
s_cmp_eq_u32 s50,128
s_cbranch_scc1 QKVV_END
s_branch QKVV_COLD1
QKVV_COLD0:
s_cmp_lg_u32 s46,0
s_cbranch_scc1 cp_227
ct_228:
buffer_load_dword v3,v2,s[8:11],s35 offen sc1
buffer_load_dword v14,v4,s[8:11],s41 offen sc1
s_waitcnt vmcnt(0)
v_cmp_eq_u32 vcc,0,v14
s_cmp_eq_u64 vcc,0
s_cselect_b32 s36,0,2147483648
v_cmp_eq_u32 vcc,0,v3
s_cmp_lt_u32 s78,64
s_cselect_b32 s36,s36,2147483648
s_cmp_eq_u64 vcc,0
s_cselect_b32 s60,1,s36
s_cmp_lt_u32 s79,64
s_cselect_b32 s60,s60,s36
s_sub_u32 s61,s78,s79
s_or_b32 s61,s61,s36
s_cmp_lt_u32 s61,16
s_cselect_b32 s36,0,s60
v_mov_b32 v23,s36
s_cmp_lt_u32 s36,2
s_cbranch_scc1 ct_228x
s_sleep 3
s_sub_u32 s47,s47,1
s_cbranch_scc1 ABORT
s_branch ct_228
ct_228x:
ds_write_b32 v22,v23 offset:4
s_waitcnt lgkmcnt(0)
cp_227:
s_barrier
ds_read_b32 v23,v22 offset:4
s_waitcnt lgkmcnt(0)
v_readfirstlane_b32 s38,v23
s_and_b32 s38,s38,1
s_and_b32 s37,s38,2147483648
s_and_b32 s33,s38,1
s_cselect_b32 s34,s79,s78
s_lshl_b32 s60,s33,6
s_add_u32 s60,s60,s34
s_mul_i32 s60,s60,46080
s_add_u32 s60,s60,206569472
s_cmp_eq_u32 s33,0
s_cselect_b32 s67,2147483648,s60
s_mul_i32 s61,s46,10240
s_add_u32 s60,s60,s61
s_add_u32 s61,s61,s57
s_add_u32 m0,s61,0
s_add_u32 s63,s60,0
buffer_load_dwordx4 v1,s[8:11],s63 offen sc1 lds
buffer_load_dwordx4 v1,s[8:11],s63 offen offset:1024 sc1 lds
buffer_load_dwordx4 v1,s[8:11],s63 offen offset:2048 sc1 lds
buffer_load_dwordx4 v1,s[8:11],s63 offen offset:3072 sc1 lds
s_add_u32 m0,s61,4096
s_add_u32 s63,s60,4096
buffer_load_dwordx4 v1,s[8:11],s63 offen sc1 lds
buffer_load_dwordx4 v1,s[8:11],s63 offen offset:1024 sc1 lds
buffer_load_dwordx4 v1,s[8:11],s63 offen offset:2048 sc1 lds
buffer_load_dwordx4 v1,s[8:11],s63 offen offset:3072 sc1 lds
s_add_u32 m0,s61,8192
s_add_u32 s63,s60,8192
buffer_load_dwordx4 v1,s[8:11],s63 offen sc1 lds
buffer_load_dwordx4 v1,s[8:11],s63 offen offset:1024 sc1 lds
s_lshl_b32 s62,s46,10
s_add_u32 s62,s62,40960
s_add_u32 m0,s57,s62
s_add_u32 s63,s67,s62
buffer_load_dwordx4 v1,s[8:11],s63 offen sc1 lds
s_add_u32 m0,s57,45056
s_add_u32 s63,s67,45056
buffer_load_dwordx4 v1,s[8:11],s63 offen sc1 lds
QKVV_CD0:
s_mov_b32 s51,s33
s_mov_b32 s52,s34
s_mov_b32 s53,s33
s_mov_b32 s54,s34
s_add_u32 s79,s79,s33
s_or_b32 s60,s37,s33
s_cmp_eq_u32 s60,0
s_addc_u32 s78,s78,0
s_lshl_b32 s41,s78,9
s_add_u32 s41,s41,s40
s_lshl_b32 s35,s79,9
s_add_u32 s35,s35,s40
s_add_u32 s35,s35,32768
buffer_load_dword v3,v2,s[8:11],s35 offen sc1
buffer_load_dword v14,v4,s[8:11],s41 offen sc1
s_waitcnt vmcnt(0)
s_mov_b64 exec,1
buffer_store_dword v5,v1,s[8:11],s59 offen sc1
s_mov_b64 exec,-1
s_mov_b32 s59,2147483648
v_cmp_eq_u32 vcc,0,v14
s_cmp_eq_u64 vcc,0
s_cselect_b32 s36,0,2147483648
v_cmp_eq_u32 vcc,0,v3
s_cmp_lt_u32 s78,64
s_cselect_b32 s36,s36,2147483648
s_cmp_eq_u64 vcc,0
s_cselect_b32 s60,1,s36
s_cmp_lt_u32 s79,64
s_cselect_b32 s60,s60,s36
s_sub_u32 s61,s78,s79
s_or_b32 s61,s61,s36
s_cmp_lt_u32 s61,16
s_cselect_b32 s36,0,s60
v_mov_b32 v23,s36
ds_write_b32 v13,v23
s_waitcnt lgkmcnt(0)
s_barrier
ds_read_b32 v23,v22
ds_read_b128 v[24:27],v16 offset:0
ds_read_b128 v[28:31],v17 offset:0
ds_read_b128 v[32:35],v16 offset:2048
ds_read_b128 v[36:39],v17 offset:2048
ds_read_b128 v[40:43],v16 offset:4096
s_waitcnt lgkmcnt(5)
v_readfirstlane_b32 s38,v23
s_and_b32 s37,s38,2147483648
s_and_b32 s33,s38,1
s_cselect_b32 s34,s79,s78
s_nop 0
s_branch QKVV_B0
QKVV_S1:
s_mov_b32 s55,0
s_cmp_lt_u32 s42,2
s_cbranch_scc1 nt_229
s_mov_b32 s55,2
s_cmp_lg_u32 s37,0
s_cbranch_scc1 nt_229
s_mov_b32 s55,1
s_lshl_b32 s60,s33,6
s_add_u32 s60,s60,s34
s_mul_i32 s60,s60,46080
s_add_u32 s60,s60,206569472
s_cmp_eq_u32 s33,0
s_cselect_b32 s67,2147483648,s60
s_mul_i32 s61,s46,10240
s_add_u32 s60,s60,s61
s_add_u32 s61,s61,s57
s_add_u32 m0,s61,0
s_add_u32 s63,s60,0
buffer_load_dwordx4 v1,s[8:11],s63 offen sc1 lds
buffer_load_dwordx4 v1,s[8:11],s63 offen offset:1024 sc1 lds
buffer_load_dwordx4 v1,s[8:11],s63 offen offset:2048 sc1 lds
buffer_load_dwordx4 v1,s[8:11],s63 offen offset:3072 sc1 lds
s_add_u32 m0,s61,4096
s_add_u32 s63,s60,4096
buffer_load_dwordx4 v1,s[8:11],s63 offen sc1 lds
buffer_load_dwordx4 v1,s[8:11],s63 offen offset:1024 sc1 lds
buffer_load_dwordx4 v1,s[8:11],s63 offen offset:2048 sc1 lds
buffer_load_dwordx4 v1,s[8:11],s63 offen offset:3072 sc1 lds
s_add_u32 m0,s61,8192
s_add_u32 s63,s60,8192
buffer_load_dwordx4 v1,s[8:11],s63 offen sc1 lds
buffer_load_dwordx4 v1,s[8:11],s63 offen offset:1024 sc1 lds
s_lshl_b32 s62,s46,10
s_add_u32 s62,s62,40960
s_add_u32 m0,s57,s62
s_add_u32 s63,s67,s62
buffer_load_dwordx4 v1,s[8:11],s63 offen sc1 lds
s_add_u32 m0,s57,45056
s_add_u32 s63,s67,45056
buffer_load_dwordx4 v1,s[8:11],s63 offen sc1 lds
nt_229:
s_nop 4
s_mul_i32 s74,s73,393216
s_add_u32 s74,s74,s39
s_add_u32 s74,s74,s70
v_fma_f32 v88,-v124,v120,v88
v_fma_f32 v89,-v126,v120,v89
v_fma_f32 v90,-v128,v120,v90
v_fma_f32 v91,-v130,v120,v91
v_fma_f32 v96,-v140,v120,v96
v_fma_f32 v97,-v142,v120,v97
v_fma_f32 v98,-v144,v120,v98
v_fma_f32 v99,-v146,v120,v99
v_mul_f32 v88,v88,v125
v_mul_f32 v89,v89,v127
v_mul_f32 v90,v90,v129
v_mul_f32 v91,v91,v131
v_mul_f32 v96,v96,v141
v_mul_f32 v97,v97,v143
v_mul_f32 v98,v98,v145
v_mul_f32 v99,v99,v147
v_cvt_pk_bf16_f32 v88,v88,v89
v_cvt_pk_bf16_f32 v89,v90,v91
v_cvt_pk_bf16_f32 v90,v96,v97
v_cvt_pk_bf16_f32 v91,v98,v99
buffer_store_dwordx4 v[88:91],v20,s[8:11],s74 offen sc1
v_fma_f32 v92,-v132,v120,v92
v_fma_f32 v93,-v134,v120,v93
v_fma_f32 v94,-v136,v120,v94
v_fma_f32 v95,-v138,v120,v95
v_fma_f32 v100,-v148,v120,v100
v_fma_f32 v101,-v150,v120,v101
v_fma_f32 v102,-v152,v120,v102
v_fma_f32 v103,-v154,v120,v103
v_mul_f32 v92,v92,v133
v_mul_f32 v93,v93,v135
v_mul_f32 v94,v94,v137
v_mul_f32 v95,v95,v139
v_mul_f32 v100,v100,v149
v_mul_f32 v101,v101,v151
v_mul_f32 v102,v102,v153
v_mul_f32 v103,v103,v155
v_cvt_pk_bf16_f32 v92,v92,v93
v_cvt_pk_bf16_f32 v93,v94,v95
v_cvt_pk_bf16_f32 v94,v100,v101
v_cvt_pk_bf16_f32 v95,v102,v103
buffer_store_dwordx4 v[92:95],v21,s[8:11],s74 offen sc1
v_fma_f32 v104,-v124,v121,v104
v_fma_f32 v105,-v126,v121,v105
v_fma_f32 v106,-v128,v121,v106
v_fma_f32 v107,-v130,v121,v107
v_fma_f32 v112,-v140,v121,v112
v_fma_f32 v113,-v142,v121,v113
v_fma_f32 v114,-v144,v121,v114
v_fma_f32 v115,-v146,v121,v115
v_mul_f32 v104,v104,v125
v_mul_f32 v105,v105,v127
v_mul_f32 v106,v106,v129
v_mul_f32 v107,v107,v131
v_mul_f32 v112,v112,v141
v_mul_f32 v113,v113,v143
v_mul_f32 v114,v114,v145
v_mul_f32 v115,v115,v147
v_cvt_pk_bf16_f32 v104,v104,v105
v_cvt_pk_bf16_f32 v105,v106,v107
v_cvt_pk_bf16_f32 v106,v112,v113
v_cvt_pk_bf16_f32 v107,v114,v115
buffer_store_dwordx4 v[104:107],v20,s[8:11],s74 offen offset:2048 sc1
v_fma_f32 v108,-v132,v121,v108
v_fma_f32 v109,-v134,v121,v109
v_fma_f32 v110,-v136,v121,v110
v_fma_f32 v111,-v138,v121,v111
v_fma_f32 v116,-v148,v121,v116
v_fma_f32 v117,-v150,v121,v117
v_fma_f32 v118,-v152,v121,v118
v_fma_f32 v119,-v154,v121,v119
v_mul_f32 v108,v108,v133
v_mul_f32 v109,v109,v135
v_mul_f32 v110,v110,v137
v_mul_f32 v111,v111,v139
v_mul_f32 v116,v116,v149
v_mul_f32 v117,v117,v151
v_mul_f32 v118,v118,v153
v_mul_f32 v119,v119,v155
v_cvt_pk_bf16_f32 v108,v108,v109
v_cvt_pk_bf16_f32 v109,v110,v111
v_cvt_pk_bf16_f32 v110,v116,v117
v_cvt_pk_bf16_f32 v111,v118,v119
buffer_store_dwordx4 v[108:111],v21,s[8:11],s74 offen offset:2048 sc1
s_lshl_b32 s82,s72,6
s_add_u32 s82,s82,s73
s_lshl_b32 s82,s82,9
s_add_u32 s82,s82,s71
s_lshl_b32 s75,s69,2
s_add_u32 s82,s82,s75
s_add_u32 s82,s82,s39
s_mov_b32 s59,s82
s_mov_b32 s82,2147483648
s_mov_b32 s39,2147483648
s_cmp_eq_u32 s55,0
s_cbranch_scc1 QKVV_B0
s_cmp_eq_u32 s55,1
s_cbranch_scc1 QKVV_CD0
s_waitcnt vmcnt(0)
s_mov_b64 exec,1
buffer_store_dword v5,v1,s[8:11],s59 offen sc1
s_mov_b64 exec,-1
s_mov_b32 s59,2147483648
s_cmp_eq_u32 s50,128
s_cbranch_scc1 QKVV_END
s_branch QKVV_COLD0
QKVV_COLD1:
s_cmp_lg_u32 s46,0
s_cbranch_scc1 cp_230
ct_231:
buffer_load_dword v3,v2,s[8:11],s35 offen sc1
buffer_load_dword v14,v4,s[8:11],s41 offen sc1
s_waitcnt vmcnt(0)
v_cmp_eq_u32 vcc,0,v14
s_cmp_eq_u64 vcc,0
s_cselect_b32 s36,0,2147483648
v_cmp_eq_u32 vcc,0,v3
s_cmp_lt_u32 s78,64
s_cselect_b32 s36,s36,2147483648
s_cmp_eq_u64 vcc,0
s_cselect_b32 s60,1,s36
s_cmp_lt_u32 s79,64
s_cselect_b32 s60,s60,s36
s_sub_u32 s61,s78,s79
s_or_b32 s61,s61,s36
s_cmp_lt_u32 s61,16
s_cselect_b32 s36,0,s60
v_mov_b32 v23,s36
s_cmp_lt_u32 s36,2
s_cbranch_scc1 ct_231x
s_sleep 3
s_sub_u32 s47,s47,1
s_cbranch_scc1 ABORT
s_branch ct_231
ct_231x:
ds_write_b32 v22,v23 offset:4
s_waitcnt lgkmcnt(0)
cp_230:
s_barrier
ds_read_b32 v23,v22 offset:4
s_waitcnt lgkmcnt(0)
v_readfirstlane_b32 s38,v23
s_and_b32 s38,s38,1
s_and_b32 s37,s38,2147483648
s_and_b32 s33,s38,1
s_cselect_b32 s34,s79,s78
s_lshl_b32 s60,s33,6
s_add_u32 s60,s60,s34
s_mul_i32 s60,s60,46080
s_add_u32 s60,s60,206569472
s_cmp_eq_u32 s33,0
s_cselect_b32 s67,2147483648,s60
s_mul_i32 s61,s46,10240
s_add_u32 s60,s60,s61
s_add_u32 s61,s61,s57
s_add_u32 m0,s61,0
s_add_u32 s63,s60,0
buffer_load_dwordx4 v1,s[8:11],s63 offen sc1 lds
buffer_load_dwordx4 v1,s[8:11],s63 offen offset:1024 sc1 lds
buffer_load_dwordx4 v1,s[8:11],s63 offen offset:2048 sc1 lds
buffer_load_dwordx4 v1,s[8:11],s63 offen offset:3072 sc1 lds
s_add_u32 m0,s61,4096
s_add_u32 s63,s60,4096
buffer_load_dwordx4 v1,s[8:11],s63 offen sc1 lds
buffer_load_dwordx4 v1,s[8:11],s63 offen offset:1024 sc1 lds
buffer_load_dwordx4 v1,s[8:11],s63 offen offset:2048 sc1 lds
buffer_load_dwordx4 v1,s[8:11],s63 offen offset:3072 sc1 lds
s_add_u32 m0,s61,8192
s_add_u32 s63,s60,8192
buffer_load_dwordx4 v1,s[8:11],s63 offen sc1 lds
buffer_load_dwordx4 v1,s[8:11],s63 offen offset:1024 sc1 lds
s_lshl_b32 s62,s46,10
s_add_u32 s62,s62,40960
s_add_u32 m0,s57,s62
s_add_u32 s63,s67,s62
buffer_load_dwordx4 v1,s[8:11],s63 offen sc1 lds
s_add_u32 m0,s57,45056
s_add_u32 s63,s67,45056
buffer_load_dwordx4 v1,s[8:11],s63 offen sc1 lds
QKVV_CD1:
s_mov_b32 s51,s33
s_mov_b32 s52,s34
s_mov_b32 s53,s33
s_mov_b32 s54,s34
s_add_u32 s79,s79,s33
s_or_b32 s60,s37,s33
s_cmp_eq_u32 s60,0
s_addc_u32 s78,s78,0
s_lshl_b32 s41,s78,9
s_add_u32 s41,s41,s40
s_lshl_b32 s35,s79,9
s_add_u32 s35,s35,s40
s_add_u32 s35,s35,32768
buffer_load_dword v3,v2,s[8:11],s35 offen sc1
buffer_load_dword v14,v4,s[8:11],s41 offen sc1
s_waitcnt vmcnt(0)
s_mov_b64 exec,1
buffer_store_dword v5,v1,s[8:11],s59 offen sc1
s_mov_b64 exec,-1
s_mov_b32 s59,2147483648
v_cmp_eq_u32 vcc,0,v14
s_cmp_eq_u64 vcc,0
s_cselect_b32 s36,0,2147483648
v_cmp_eq_u32 vcc,0,v3
s_cmp_lt_u32 s78,64
s_cselect_b32 s36,s36,2147483648
s_cmp_eq_u64 vcc,0
s_cselect_b32 s60,1,s36
s_cmp_lt_u32 s79,64
s_cselect_b32 s60,s60,s36
s_sub_u32 s61,s78,s79
s_or_b32 s61,s61,s36
s_cmp_lt_u32 s61,16
s_cselect_b32 s36,0,s60
v_mov_b32 v23,s36
ds_write_b32 v13,v23
s_waitcnt lgkmcnt(0)
s_barrier
ds_read_b32 v23,v22
ds_read_b128 v[24:27],v18 offset:0
ds_read_b128 v[28:31],v19 offset:0
ds_read_b128 v[32:35],v18 offset:2048
ds_read_b128 v[36:39],v19 offset:2048
ds_read_b128 v[40:43],v18 offset:4096
s_waitcnt lgkmcnt(5)
v_readfirstlane_b32 s38,v23
s_and_b32 s37,s38,2147483648
s_and_b32 s33,s38,1
s_cselect_b32 s34,s79,s78
s_nop 0
s_branch QKVV_B1
QKVV_END:
s_endpgm
ROLE_ATT:
v_lshlrev_b32 v1,4,v0
v_mov_b32 v5,1
s_lshl_b32 s56,s48,2
s_add_u32 s56,s56,s46
v_bfe_u32 v6,v0,2,2
v_lshrrev_b32 v7,4,v0
v_add_u32 v7,v6,v7
v_and_b32 v7,3,v7
v_and_b32 v15,3,v0
v_lshlrev_b32 v15,4,v15
v_lshl_add_u32 v15,v7,6,v15
v_lshl_add_u32 v15,v6,8,v15
s_mov_b32 s68,s48
s_and_b32 s51,s46,1
s_lshr_b32 s86,s46,1
s_lshr_b32 s87,s68,3
s_lshl_b32 s87,s87,5
s_and_b32 s60,s68,7
s_add_u32 s87,s87,s60
v_lshlrev_b32 v229,3,v0
v_and_b32 v229,0x300,v1
v_add_u32 v229,v229,v1
v_mov_b32 v230,0xff800000
s_mov_b32 s80,-1
s_mov_b32 s81,0
s_mov_b32 s84,0x3d93cd3a
s_mov_b32 s85,0x3fb8aa3b
v_min_u32 v6,8,v0
v_mul_u32_u24 v7,86,v6
v_lshrrev_b32 v7,8,v7
v_mul_u32_u24 v8,3,v7
v_sub_u32 v6,v6,v8
s_mul_i32 s60,s68,3
v_add_u32 v6,s60,v6
v_lshlrev_b32 v2,2,v6
v_lshl_add_u32 v2,v7,16,v2
v_min_u32 v228,2,v0
v_lshlrev_b32 v228,2,v228
v_lshrrev_b32 v6,4,v0
v_lshlrev_b32 v6,2,v6
v_and_b32 v7,15,v0
v_add_u32 v8,0,v6
v_cmp_le_u32 s[72:73],v8,v7
v_add_u32 v8,1,v6
v_cmp_le_u32 s[74:75],v8,v7
v_add_u32 v8,2,v6
v_cmp_le_u32 s[76:77],v8,v7
v_add_u32 v8,3,v6
v_cmp_le_u32 s[78:79],v8,v7
s_mul_i32 s71,s68,12288
s_mul_i32 s60,s51,13
s_mul_i32 s69,s60,589824
s_mul_i32 s61,s68,18432
s_add_u32 s69,s69,s61
s_mul_i32 s61,s51,9216
s_add_u32 s69,s69,s61
s_add_u32 s69,s69,24120320
s_mul_i32 s70,s60,2048
s_lshl_b32 s61,s68,6
s_add_u32 s70,s70,s61
s_add_u32 s70,s70,688128
s_mul_i32 s69,s51,3145728
s_mul_i32 s61,s68,6144
s_add_u32 s69,s69,s61
s_add_u32 s69,s69,24117248
s_mul_i32 s70,s51,65536
s_lshl_b32 s61,s68,5
s_add_u32 s70,s70,s61
s_add_u32 s70,s70,688128
s_waitcnt vmcnt(0)
s_barrier
s_cmp_lg_u32 s46,0
s_cbranch_scc1 arr_232
v_mov_b32 v6,1
s_lshl_b32 s3,s49,2
v_mov_b32 v7,s3
s_mov_b64 exec,1
buffer_atomic_add v6,v7,s[12:15],0 offen sc1
s_mov_b64 exec,-1
arr_232:
s_mov_b32 s66,s56
s_and_b32 s53,s66,7
s_lshr_b32 s54,s66,3
v_lshrrev_b32 v6,4,v0
v_bfe_u32 v7,v0,2,2
v_and_b32 v8,3,v0
s_and_b32 s61,s53,3
s_lshl_b32 s60,s53,8
v_lshlrev_b32 v132,11,v6
v_lshrrev_b32 v9,1,v6
v_lshlrev_b32 v132,11,v9
v_and_b32 v9,1,v6
v_lshl_add_u32 v132,v9,12,v132
v_add_u32 v9,s61,v7
v_and_b32 v9,3,v9
v_lshl_add_u32 v132,v9,6,v132
v_lshl_add_u32 v132,v8,4,v132
v_add_u32 v132,s60,v132
s_lshl_b32 s60,s53,2
v_add_u32 v9,s60,v8
v_mul_u32_u24 v133,1280,v9
v_lshl_add_u32 v133,v6,5,v133
v_lshl_add_u32 v133,v7,3,v133
s_mov_b32 s4,s16
s_mov_b32 s5,s17
s_mov_b32 s6,2621440
s_mov_b32 s7,0x20000
s_mov_b32 s55,0
s_mul_i32 s62,s54,40960
buffer_load_dwordx2 v[32:33],v133,s[4:7],s62 offen offset:0
buffer_load_dwordx2 v[34:35],v133,s[4:7],s62 offen offset:128
buffer_load_dwordx2 v[36:37],v133,s[4:7],s62 offen offset:256
buffer_load_dwordx2 v[38:39],v133,s[4:7],s62 offen offset:384
buffer_load_dwordx2 v[40:41],v133,s[4:7],s62 offen offset:512
buffer_load_dwordx2 v[42:43],v133,s[4:7],s62 offen offset:640
buffer_load_dwordx2 v[44:45],v133,s[4:7],s62 offen offset:768
buffer_load_dwordx2 v[46:47],v133,s[4:7],s62 offen offset:896
buffer_load_dwordx2 v[48:49],v133,s[4:7],s62 offen offset:1024
buffer_load_dwordx2 v[50:51],v133,s[4:7],s62 offen offset:1152
s_add_u32 s66,s54,16
s_min_u32 s66,s66,63
s_mul_i32 s62,s66,40960
buffer_load_dwordx2 v[52:53],v133,s[4:7],s62 offen offset:0
buffer_load_dwordx2 v[54:55],v133,s[4:7],s62 offen offset:128
buffer_load_dwordx2 v[56:57],v133,s[4:7],s62 offen offset:256
buffer_load_dwordx2 v[58:59],v133,s[4:7],s62 offen offset:384
buffer_load_dwordx2 v[60:61],v133,s[4:7],s62 offen offset:512
buffer_load_dwordx2 v[62:63],v133,s[4:7],s62 offen offset:640
buffer_load_dwordx2 v[64:65],v133,s[4:7],s62 offen offset:768
buffer_load_dwordx2 v[66:67],v133,s[4:7],s62 offen offset:896
buffer_load_dwordx2 v[68:69],v133,s[4:7],s62 offen offset:1024
buffer_load_dwordx2 v[70:71],v133,s[4:7],s62 offen offset:1152
s_mul_i32 s64,s54,40960
s_add_u32 s64,s64,234749952
s_mul_i32 s65,s54,46080
s_add_u32 s65,s65,206569472
s_waitcnt vmcnt(10)
v_lshlrev_b32 v72,16,v32
v_and_b32 v73,0xffff0000,v32
v_lshlrev_b32 v74,16,v33
v_and_b32 v75,0xffff0000,v33
v_lshlrev_b32 v76,16,v34
v_and_b32 v77,0xffff0000,v34
v_lshlrev_b32 v78,16,v35
v_and_b32 v79,0xffff0000,v35
v_lshlrev_b32 v80,16,v36
v_and_b32 v81,0xffff0000,v36
v_lshlrev_b32 v82,16,v37
v_and_b32 v83,0xffff0000,v37
v_lshlrev_b32 v84,16,v38
v_and_b32 v85,0xffff0000,v38
v_lshlrev_b32 v86,16,v39
v_and_b32 v87,0xffff0000,v39
v_lshlrev_b32 v88,16,v40
v_and_b32 v89,0xffff0000,v40
v_lshlrev_b32 v90,16,v41
v_and_b32 v91,0xffff0000,v41
v_lshlrev_b32 v92,16,v42
v_and_b32 v93,0xffff0000,v42
v_lshlrev_b32 v94,16,v43
v_and_b32 v95,0xffff0000,v43
v_lshlrev_b32 v96,16,v44
v_and_b32 v97,0xffff0000,v44
v_lshlrev_b32 v98,16,v45
v_and_b32 v99,0xffff0000,v45
v_lshlrev_b32 v100,16,v46
v_and_b32 v101,0xffff0000,v46
v_lshlrev_b32 v102,16,v47
v_and_b32 v103,0xffff0000,v47
v_lshlrev_b32 v104,16,v48
v_and_b32 v105,0xffff0000,v48
v_lshlrev_b32 v106,16,v49
v_and_b32 v107,0xffff0000,v49
v_lshlrev_b32 v108,16,v50
v_and_b32 v109,0xffff0000,v50
v_lshlrev_b32 v110,16,v51
v_and_b32 v111,0xffff0000,v51
v_pk_add_f32 v[28:29],v[72:73],v[74:75]
v_pk_mul_f32 v[26:27],v[72:73],v[72:73]
v_pk_fma_f32 v[26:27],v[74:75],v[74:75],v[26:27]
v_pk_add_f32 v[28:29],v[28:29],v[76:77]
v_pk_fma_f32 v[26:27],v[76:77],v[76:77],v[26:27]
v_pk_add_f32 v[28:29],v[28:29],v[78:79]
v_pk_fma_f32 v[26:27],v[78:79],v[78:79],v[26:27]
v_pk_add_f32 v[28:29],v[28:29],v[80:81]
v_pk_fma_f32 v[26:27],v[80:81],v[80:81],v[26:27]
v_pk_add_f32 v[28:29],v[28:29],v[82:83]
v_pk_fma_f32 v[26:27],v[82:83],v[82:83],v[26:27]
v_pk_add_f32 v[28:29],v[28:29],v[84:85]
v_pk_fma_f32 v[26:27],v[84:85],v[84:85],v[26:27]
v_pk_add_f32 v[28:29],v[28:29],v[86:87]
v_pk_fma_f32 v[26:27],v[86:87],v[86:87],v[26:27]
v_pk_add_f32 v[28:29],v[28:29],v[88:89]
v_pk_fma_f32 v[26:27],v[88:89],v[88:89],v[26:27]
v_pk_add_f32 v[28:29],v[28:29],v[90:91]
v_pk_fma_f32 v[26:27],v[90:91],v[90:91],v[26:27]
v_pk_add_f32 v[28:29],v[28:29],v[92:93]
v_pk_fma_f32 v[26:27],v[92:93],v[92:93],v[26:27]
v_pk_add_f32 v[28:29],v[28:29],v[94:95]
v_pk_fma_f32 v[26:27],v[94:95],v[94:95],v[26:27]
v_pk_add_f32 v[28:29],v[28:29],v[96:97]
v_pk_fma_f32 v[26:27],v[96:97],v[96:97],v[26:27]
v_pk_add_f32 v[28:29],v[28:29],v[98:99]
v_pk_fma_f32 v[26:27],v[98:99],v[98:99],v[26:27]
v_pk_add_f32 v[28:29],v[28:29],v[100:101]
v_pk_fma_f32 v[26:27],v[100:101],v[100:101],v[26:27]
v_pk_add_f32 v[28:29],v[28:29],v[102:103]
v_pk_fma_f32 v[26:27],v[102:103],v[102:103],v[26:27]
v_pk_add_f32 v[28:29],v[28:29],v[104:105]
v_pk_fma_f32 v[26:27],v[104:105],v[104:105],v[26:27]
v_pk_add_f32 v[28:29],v[28:29],v[106:107]
v_pk_fma_f32 v[26:27],v[106:107],v[106:107],v[26:27]
v_pk_add_f32 v[28:29],v[28:29],v[108:109]
v_pk_fma_f32 v[26:27],v[108:109],v[108:109],v[26:27]
v_pk_add_f32 v[28:29],v[28:29],v[110:111]
v_pk_fma_f32 v[26:27],v[110:111],v[110:111],v[26:27]
v_add_f32 v24,v28,v29
v_add_f32 v25,v26,v27
s_nop 0
v_add_f32_dpp v24,v24,v24 row_ror:4 row_mask:0xf bank_mask:0xf
v_add_f32_dpp v25,v25,v25 row_ror:4 row_mask:0xf bank_mask:0xf
s_nop 0
v_add_f32_dpp v24,v24,v24 row_ror:8 row_mask:0xf bank_mask:0xf
v_add_f32_dpp v25,v25,v25 row_ror:8 row_mask:0xf bank_mask:0xf
v_mov_b32 v26,v24
v_mov_b32 v27,v25
s_nop 0
v_permlane32_swap_b32 v24,v26
v_permlane32_swap_b32 v25,v27
v_add_f32 v24,v24,v26
v_add_f32 v25,v25,v27
v_mov_b32 v26,v24
v_mov_b32 v27,v25
s_nop 0
v_permlane16_swap_b32 v24,v26
v_permlane16_swap_b32 v25,v27
v_add_f32 v24,v24,v26
v_add_f32 v25,v25,v27
v_mul_f32 v24,0x3acccccd,v24
v_mul_f32 v25,0x3acccccd,v25
v_fma_f32 v25,-v24,v24,v25
v_max_f32 v25,0,v25
v_cvt_pk_bf16_f32 v6,v24,v25
v_lshlrev_b32 v24,16,v6
v_and_b32 v25,0xffff0000,v6
v_add_f32 v25,0x3727c5ac,v25
v_cvt_pk_bf16_f32 v6,v25,v25
v_lshlrev_b32 v25,16,v6
v_sqrt_f32 v25,v25
s_nop 0
v_cvt_pk_bf16_f32 v6,v25,v25
v_lshlrev_b32 v25,16,v6
v_rcp_f32 v25,v25
s_nop 0
v_pk_add_f32 v[72:73],v[72:73],v[24:25] op_sel_hi:[1,0] neg_lo:[0,1] neg_hi:[0,1]
v_pk_add_f32 v[74:75],v[74:75],v[24:25] op_sel_hi:[1,0] neg_lo:[0,1] neg_hi:[0,1]
v_pk_add_f32 v[76:77],v[76:77],v[24:25] op_sel_hi:[1,0] neg_lo:[0,1] neg_hi:[0,1]
v_pk_add_f32 v[78:79],v[78:79],v[24:25] op_sel_hi:[1,0] neg_lo:[0,1] neg_hi:[0,1]
v_pk_add_f32 v[80:81],v[80:81],v[24:25] op_sel_hi:[1,0] neg_lo:[0,1] neg_hi:[0,1]
v_pk_add_f32 v[82:83],v[82:83],v[24:25] op_sel_hi:[1,0] neg_lo:[0,1] neg_hi:[0,1]
v_pk_add_f32 v[84:85],v[84:85],v[24:25] op_sel_hi:[1,0] neg_lo:[0,1] neg_hi:[0,1]
v_pk_add_f32 v[86:87],v[86:87],v[24:25] op_sel_hi:[1,0] neg_lo:[0,1] neg_hi:[0,1]
v_pk_add_f32 v[88:89],v[88:89],v[24:25] op_sel_hi:[1,0] neg_lo:[0,1] neg_hi:[0,1]
v_pk_add_f32 v[90:91],v[90:91],v[24:25] op_sel_hi:[1,0] neg_lo:[0,1] neg_hi:[0,1]
v_pk_add_f32 v[92:93],v[92:93],v[24:25] op_sel_hi:[1,0] neg_lo:[0,1] neg_hi:[0,1]
v_pk_add_f32 v[94:95],v[94:95],v[24:25] op_sel_hi:[1,0] neg_lo:[0,1] neg_hi:[0,1]
v_pk_add_f32 v[96:97],v[96:97],v[24:25] op_sel_hi:[1,0] neg_lo:[0,1] neg_hi:[0,1]
v_pk_add_f32 v[98:99],v[98:99],v[24:25] op_sel_hi:[1,0] neg_lo:[0,1] neg_hi:[0,1]
v_pk_add_f32 v[100:101],v[100:101],v[24:25] op_sel_hi:[1,0] neg_lo:[0,1] neg_hi:[0,1]
v_pk_add_f32 v[102:103],v[102:103],v[24:25] op_sel_hi:[1,0] neg_lo:[0,1] neg_hi:[0,1]
v_pk_add_f32 v[104:105],v[104:105],v[24:25] op_sel_hi:[1,0] neg_lo:[0,1] neg_hi:[0,1]
v_pk_add_f32 v[106:107],v[106:107],v[24:25] op_sel_hi:[1,0] neg_lo:[0,1] neg_hi:[0,1]
v_pk_add_f32 v[108:109],v[108:109],v[24:25] op_sel_hi:[1,0] neg_lo:[0,1] neg_hi:[0,1]
v_pk_add_f32 v[110:111],v[110:111],v[24:25] op_sel_hi:[1,0] neg_lo:[0,1] neg_hi:[0,1]
v_cvt_pk_bf16_f32 v6,v72,v73
v_lshlrev_b32 v72,16,v6
v_and_b32 v73,0xffff0000,v6
v_cvt_pk_bf16_f32 v8,v74,v75
v_lshlrev_b32 v74,16,v8
v_and_b32 v75,0xffff0000,v8
v_cvt_pk_bf16_f32 v6,v76,v77
v_lshlrev_b32 v76,16,v6
v_and_b32 v77,0xffff0000,v6
v_cvt_pk_bf16_f32 v8,v78,v79
v_lshlrev_b32 v78,16,v8
v_and_b32 v79,0xffff0000,v8
v_cvt_pk_bf16_f32 v6,v80,v81
v_lshlrev_b32 v80,16,v6
v_and_b32 v81,0xffff0000,v6
v_cvt_pk_bf16_f32 v8,v82,v83
v_lshlrev_b32 v82,16,v8
v_and_b32 v83,0xffff0000,v8
v_cvt_pk_bf16_f32 v6,v84,v85
v_lshlrev_b32 v84,16,v6
v_and_b32 v85,0xffff0000,v6
v_cvt_pk_bf16_f32 v8,v86,v87
v_lshlrev_b32 v86,16,v8
v_and_b32 v87,0xffff0000,v8
v_cvt_pk_bf16_f32 v6,v88,v89
v_lshlrev_b32 v88,16,v6
v_and_b32 v89,0xffff0000,v6
v_cvt_pk_bf16_f32 v8,v90,v91
v_lshlrev_b32 v90,16,v8
v_and_b32 v91,0xffff0000,v8
v_cvt_pk_bf16_f32 v6,v92,v93
v_lshlrev_b32 v92,16,v6
v_and_b32 v93,0xffff0000,v6
v_cvt_pk_bf16_f32 v8,v94,v95
v_lshlrev_b32 v94,16,v8
v_and_b32 v95,0xffff0000,v8
v_cvt_pk_bf16_f32 v6,v96,v97
v_lshlrev_b32 v96,16,v6
v_and_b32 v97,0xffff0000,v6
v_cvt_pk_bf16_f32 v8,v98,v99
v_lshlrev_b32 v98,16,v8
v_and_b32 v99,0xffff0000,v8
v_cvt_pk_bf16_f32 v6,v100,v101
v_lshlrev_b32 v100,16,v6
v_and_b32 v101,0xffff0000,v6
v_cvt_pk_bf16_f32 v8,v102,v103
v_lshlrev_b32 v102,16,v8
v_and_b32 v103,0xffff0000,v8
v_cvt_pk_bf16_f32 v6,v104,v105
v_lshlrev_b32 v104,16,v6
v_and_b32 v105,0xffff0000,v6
v_cvt_pk_bf16_f32 v8,v106,v107
v_lshlrev_b32 v106,16,v8
v_and_b32 v107,0xffff0000,v8
v_cvt_pk_bf16_f32 v6,v108,v109
v_lshlrev_b32 v108,16,v6
v_and_b32 v109,0xffff0000,v6
v_cvt_pk_bf16_f32 v8,v110,v111
v_lshlrev_b32 v110,16,v8
v_and_b32 v111,0xffff0000,v8
v_pk_mul_f32 v[72:73],v[72:73],v[24:25] op_sel:[0,1] op_sel_hi:[1,1]
v_pk_mul_f32 v[74:75],v[74:75],v[24:25] op_sel:[0,1] op_sel_hi:[1,1]
v_pk_mul_f32 v[76:77],v[76:77],v[24:25] op_sel:[0,1] op_sel_hi:[1,1]
v_pk_mul_f32 v[78:79],v[78:79],v[24:25] op_sel:[0,1] op_sel_hi:[1,1]
v_pk_mul_f32 v[80:81],v[80:81],v[24:25] op_sel:[0,1] op_sel_hi:[1,1]
v_pk_mul_f32 v[82:83],v[82:83],v[24:25] op_sel:[0,1] op_sel_hi:[1,1]
v_pk_mul_f32 v[84:85],v[84:85],v[24:25] op_sel:[0,1] op_sel_hi:[1,1]
v_pk_mul_f32 v[86:87],v[86:87],v[24:25] op_sel:[0,1] op_sel_hi:[1,1]
v_pk_mul_f32 v[88:89],v[88:89],v[24:25] op_sel:[0,1] op_sel_hi:[1,1]
v_pk_mul_f32 v[90:91],v[90:91],v[24:25] op_sel:[0,1] op_sel_hi:[1,1]
v_pk_mul_f32 v[92:93],v[92:93],v[24:25] op_sel:[0,1] op_sel_hi:[1,1]
v_pk_mul_f32 v[94:95],v[94:95],v[24:25] op_sel:[0,1] op_sel_hi:[1,1]
v_pk_mul_f32 v[96:97],v[96:97],v[24:25] op_sel:[0,1] op_sel_hi:[1,1]
v_pk_mul_f32 v[98:99],v[98:99],v[24:25] op_sel:[0,1] op_sel_hi:[1,1]
v_pk_mul_f32 v[100:101],v[100:101],v[24:25] op_sel:[0,1] op_sel_hi:[1,1]
v_pk_mul_f32 v[102:103],v[102:103],v[24:25] op_sel:[0,1] op_sel_hi:[1,1]
v_pk_mul_f32 v[104:105],v[104:105],v[24:25] op_sel:[0,1] op_sel_hi:[1,1]
v_pk_mul_f32 v[106:107],v[106:107],v[24:25] op_sel:[0,1] op_sel_hi:[1,1]
v_pk_mul_f32 v[108:109],v[108:109],v[24:25] op_sel:[0,1] op_sel_hi:[1,1]
v_pk_mul_f32 v[110:111],v[110:111],v[24:25] op_sel:[0,1] op_sel_hi:[1,1]
v_cvt_pk_bf16_f32 v112,v72,v73
v_lshlrev_b32 v72,16,v112
v_and_b32 v73,0xffff0000,v112
v_cvt_pk_bf16_f32 v113,v74,v75
v_lshlrev_b32 v74,16,v113
v_and_b32 v75,0xffff0000,v113
v_cvt_pk_bf16_f32 v114,v76,v77
v_lshlrev_b32 v76,16,v114
v_and_b32 v77,0xffff0000,v114
v_cvt_pk_bf16_f32 v115,v78,v79
v_lshlrev_b32 v78,16,v115
v_and_b32 v79,0xffff0000,v115
v_cvt_pk_bf16_f32 v116,v80,v81
v_lshlrev_b32 v80,16,v116
v_and_b32 v81,0xffff0000,v116
v_cvt_pk_bf16_f32 v117,v82,v83
v_lshlrev_b32 v82,16,v117
v_and_b32 v83,0xffff0000,v117
v_cvt_pk_bf16_f32 v118,v84,v85
v_lshlrev_b32 v84,16,v118
v_and_b32 v85,0xffff0000,v118
v_cvt_pk_bf16_f32 v119,v86,v87
v_lshlrev_b32 v86,16,v119
v_and_b32 v87,0xffff0000,v119
v_cvt_pk_bf16_f32 v120,v88,v89
v_lshlrev_b32 v88,16,v120
v_and_b32 v89,0xffff0000,v120
v_cvt_pk_bf16_f32 v121,v90,v91
v_lshlrev_b32 v90,16,v121
v_and_b32 v91,0xffff0000,v121
v_cvt_pk_bf16_f32 v122,v92,v93
v_lshlrev_b32 v92,16,v122
v_and_b32 v93,0xffff0000,v122
v_cvt_pk_bf16_f32 v123,v94,v95
v_lshlrev_b32 v94,16,v123
v_and_b32 v95,0xffff0000,v123
v_cvt_pk_bf16_f32 v124,v96,v97
v_lshlrev_b32 v96,16,v124
v_and_b32 v97,0xffff0000,v124
v_cvt_pk_bf16_f32 v125,v98,v99
v_lshlrev_b32 v98,16,v125
v_and_b32 v99,0xffff0000,v125
v_cvt_pk_bf16_f32 v126,v100,v101
v_lshlrev_b32 v100,16,v126
v_and_b32 v101,0xffff0000,v126
v_cvt_pk_bf16_f32 v127,v102,v103
v_lshlrev_b32 v102,16,v127
v_and_b32 v103,0xffff0000,v127
v_cvt_pk_bf16_f32 v128,v104,v105
v_lshlrev_b32 v104,16,v128
v_and_b32 v105,0xffff0000,v128
v_cvt_pk_bf16_f32 v129,v106,v107
v_lshlrev_b32 v106,16,v129
v_and_b32 v107,0xffff0000,v129
v_cvt_pk_bf16_f32 v130,v108,v109
v_lshlrev_b32 v108,16,v130
v_and_b32 v109,0xffff0000,v130
v_cvt_pk_bf16_f32 v131,v110,v111
v_lshlrev_b32 v110,16,v131
v_and_b32 v111,0xffff0000,v131
s_add_u32 s63,s65,0
v_permlane16_swap_b32 v112,v114
v_permlane16_swap_b32 v113,v115
buffer_store_dwordx4 v[112:115],v132,s[8:11],s63 offen sc1
s_add_u32 s63,s65,8192
v_permlane16_swap_b32 v116,v118
v_permlane16_swap_b32 v117,v119
buffer_store_dwordx4 v[116:119],v132,s[8:11],s63 offen sc1
s_add_u32 s63,s65,16384
v_permlane16_swap_b32 v120,v122
v_permlane16_swap_b32 v121,v123
buffer_store_dwordx4 v[120:123],v132,s[8:11],s63 offen sc1
s_add_u32 s63,s65,24576
v_permlane16_swap_b32 v124,v126
v_permlane16_swap_b32 v125,v127
buffer_store_dwordx4 v[124:127],v132,s[8:11],s63 offen sc1
s_add_u32 s63,s65,32768
v_permlane16_swap_b32 v128,v130
v_permlane16_swap_b32 v129,v131
buffer_store_dwordx4 v[128:131],v132,s[8:11],s63 offen sc1
s_add_u32 s63,s64,0
v_permlane16_swap_b32 v32,v34
v_permlane16_swap_b32 v33,v35
buffer_store_dwordx4 v[32:35],v132,s[8:11],s63 offen sc1
s_add_u32 s63,s64,8192
v_permlane16_swap_b32 v36,v38
v_permlane16_swap_b32 v37,v39
buffer_store_dwordx4 v[36:39],v132,s[8:11],s63 offen sc1
s_add_u32 s63,s64,16384
v_permlane16_swap_b32 v40,v42
v_permlane16_swap_b32 v41,v43
buffer_store_dwordx4 v[40:43],v132,s[8:11],s63 offen sc1
s_add_u32 s63,s64,24576
v_permlane16_swap_b32 v44,v46
v_permlane16_swap_b32 v45,v47
buffer_store_dwordx4 v[44:47],v132,s[8:11],s63 offen sc1
s_add_u32 s63,s64,32768
v_permlane16_swap_b32 v48,v50
v_permlane16_swap_b32 v49,v51
buffer_store_dwordx4 v[48:51],v132,s[8:11],s63 offen sc1
s_lshl_b32 s82,s55,6
s_add_u32 s82,s82,s54
s_lshl_b32 s82,s82,9
s_add_u32 s82,s82,0
s_lshl_b32 s61,s53,2
s_add_u32 s82,s82,s61
s_add_u32 s54,s54,16
s_lshl_b32 s3,s49,2
v_mov_b32 v7,s3
s_nop 1
ibw_233:
buffer_load_dword v6,v7,s[12:15],0 offen sc1
s_waitcnt vmcnt(0)
v_cmp_ne_u32 vcc,256,v6
s_nop 0
s_cbranch_vccz ok_234
s_sleep 8
s_sub_u32 s47,s47,1
s_cbranch_scc1 ABORT
s_branch ibw_233
ok_234:
s_cmp_lg_u32 s49,0
s_cbranch_scc1 ibok_235
v_and_b32 v7,7,v0
v_lshlrev_b32 v7,2,v7
buffer_load_dword v6,v7,s[12:15],0 offen offset:32 sc1
s_waitcnt vmcnt(0)
v_cmp_ne_u32 vcc,32,v6
s_nop 0
s_cbranch_vccz ibok_235
s_barrier
s_mov_b32 s49,1
s_mov_b32 s3,s2
s_load_dwordx16 s[16:31],s[0:1],0
s_load_dwordx8 s[32:39],s[0:1],64
s_waitcnt lgkmcnt(0)
s_branch DISPATCH
ibok_235:
s_mov_b64 exec,1
buffer_store_dword v5,v1,s[8:11],s82 offen sc1
s_mov_b64 exec,-1
s_add_u32 s66,s54,16
s_min_u32 s66,s66,63
s_mul_i32 s62,s66,40960
buffer_load_dwordx2 v[32:33],v133,s[4:7],s62 offen offset:0
buffer_load_dwordx2 v[34:35],v133,s[4:7],s62 offen offset:128
buffer_load_dwordx2 v[36:37],v133,s[4:7],s62 offen offset:256
buffer_load_dwordx2 v[38:39],v133,s[4:7],s62 offen offset:384
buffer_load_dwordx2 v[40:41],v133,s[4:7],s62 offen offset:512
buffer_load_dwordx2 v[42:43],v133,s[4:7],s62 offen offset:640
buffer_load_dwordx2 v[44:45],v133,s[4:7],s62 offen offset:768
buffer_load_dwordx2 v[46:47],v133,s[4:7],s62 offen offset:896
buffer_load_dwordx2 v[48:49],v133,s[4:7],s62 offen offset:1024
buffer_load_dwordx2 v[50:51],v133,s[4:7],s62 offen offset:1152
s_mul_i32 s64,s54,40960
s_add_u32 s64,s64,234749952
s_mul_i32 s65,s54,46080
s_add_u32 s65,s65,206569472
s_waitcnt vmcnt(10)
v_lshlrev_b32 v72,16,v52
v_and_b32 v73,0xffff0000,v52
v_lshlrev_b32 v74,16,v53
v_and_b32 v75,0xffff0000,v53
v_lshlrev_b32 v76,16,v54
v_and_b32 v77,0xffff0000,v54
v_lshlrev_b32 v78,16,v55
v_and_b32 v79,0xffff0000,v55
v_lshlrev_b32 v80,16,v56
v_and_b32 v81,0xffff0000,v56
v_lshlrev_b32 v82,16,v57
v_and_b32 v83,0xffff0000,v57
v_lshlrev_b32 v84,16,v58
v_and_b32 v85,0xffff0000,v58
v_lshlrev_b32 v86,16,v59
v_and_b32 v87,0xffff0000,v59
v_lshlrev_b32 v88,16,v60
v_and_b32 v89,0xffff0000,v60
v_lshlrev_b32 v90,16,v61
v_and_b32 v91,0xffff0000,v61
v_lshlrev_b32 v92,16,v62
v_and_b32 v93,0xffff0000,v62
v_lshlrev_b32 v94,16,v63
v_and_b32 v95,0xffff0000,v63
v_lshlrev_b32 v96,16,v64
v_and_b32 v97,0xffff0000,v64
v_lshlrev_b32 v98,16,v65
v_and_b32 v99,0xffff0000,v65
v_lshlrev_b32 v100,16,v66
v_and_b32 v101,0xffff0000,v66
v_lshlrev_b32 v102,16,v67
v_and_b32 v103,0xffff0000,v67
v_lshlrev_b32 v104,16,v68
v_and_b32 v105,0xffff0000,v68
v_lshlrev_b32 v106,16,v69
v_and_b32 v107,0xffff0000,v69
v_lshlrev_b32 v108,16,v70
v_and_b32 v109,0xffff0000,v70
v_lshlrev_b32 v110,16,v71
v_and_b32 v111,0xffff0000,v71
v_pk_add_f32 v[28:29],v[72:73],v[74:75]
v_pk_mul_f32 v[26:27],v[72:73],v[72:73]
v_pk_fma_f32 v[26:27],v[74:75],v[74:75],v[26:27]
v_pk_add_f32 v[28:29],v[28:29],v[76:77]
v_pk_fma_f32 v[26:27],v[76:77],v[76:77],v[26:27]
v_pk_add_f32 v[28:29],v[28:29],v[78:79]
v_pk_fma_f32 v[26:27],v[78:79],v[78:79],v[26:27]
v_pk_add_f32 v[28:29],v[28:29],v[80:81]
v_pk_fma_f32 v[26:27],v[80:81],v[80:81],v[26:27]
v_pk_add_f32 v[28:29],v[28:29],v[82:83]
v_pk_fma_f32 v[26:27],v[82:83],v[82:83],v[26:27]
v_pk_add_f32 v[28:29],v[28:29],v[84:85]
v_pk_fma_f32 v[26:27],v[84:85],v[84:85],v[26:27]
v_pk_add_f32 v[28:29],v[28:29],v[86:87]
v_pk_fma_f32 v[26:27],v[86:87],v[86:87],v[26:27]
v_pk_add_f32 v[28:29],v[28:29],v[88:89]
v_pk_fma_f32 v[26:27],v[88:89],v[88:89],v[26:27]
v_pk_add_f32 v[28:29],v[28:29],v[90:91]
v_pk_fma_f32 v[26:27],v[90:91],v[90:91],v[26:27]
v_pk_add_f32 v[28:29],v[28:29],v[92:93]
v_pk_fma_f32 v[26:27],v[92:93],v[92:93],v[26:27]
v_pk_add_f32 v[28:29],v[28:29],v[94:95]
v_pk_fma_f32 v[26:27],v[94:95],v[94:95],v[26:27]
v_pk_add_f32 v[28:29],v[28:29],v[96:97]
v_pk_fma_f32 v[26:27],v[96:97],v[96:97],v[26:27]
v_pk_add_f32 v[28:29],v[28:29],v[98:99]
v_pk_fma_f32 v[26:27],v[98:99],v[98:99],v[26:27]
v_pk_add_f32 v[28:29],v[28:29],v[100:101]
v_pk_fma_f32 v[26:27],v[100:101],v[100:101],v[26:27]
v_pk_add_f32 v[28:29],v[28:29],v[102:103]
v_pk_fma_f32 v[26:27],v[102:103],v[102:103],v[26:27]
v_pk_add_f32 v[28:29],v[28:29],v[104:105]
v_pk_fma_f32 v[26:27],v[104:105],v[104:105],v[26:27]
v_pk_add_f32 v[28:29],v[28:29],v[106:107]
v_pk_fma_f32 v[26:27],v[106:107],v[106:107],v[26:27]
v_pk_add_f32 v[28:29],v[28:29],v[108:109]
v_pk_fma_f32 v[26:27],v[108:109],v[108:109],v[26:27]
v_pk_add_f32 v[28:29],v[28:29],v[110:111]
v_pk_fma_f32 v[26:27],v[110:111],v[110:111],v[26:27]
v_add_f32 v24,v28,v29
v_add_f32 v25,v26,v27
s_nop 0
v_add_f32_dpp v24,v24,v24 row_ror:4 row_mask:0xf bank_mask:0xf
v_add_f32_dpp v25,v25,v25 row_ror:4 row_mask:0xf bank_mask:0xf
s_nop 0
v_add_f32_dpp v24,v24,v24 row_ror:8 row_mask:0xf bank_mask:0xf
v_add_f32_dpp v25,v25,v25 row_ror:8 row_mask:0xf bank_mask:0xf
v_mov_b32 v26,v24
v_mov_b32 v27,v25
s_nop 0
v_permlane32_swap_b32 v24,v26
v_permlane32_swap_b32 v25,v27
v_add_f32 v24,v24,v26
v_add_f32 v25,v25,v27
v_mov_b32 v26,v24
v_mov_b32 v27,v25
s_nop 0
v_permlane16_swap_b32 v24,v26
v_permlane16_swap_b32 v25,v27
v_add_f32 v24,v24,v26
v_add_f32 v25,v25,v27
v_mul_f32 v24,0x3acccccd,v24
v_mul_f32 v25,0x3acccccd,v25
v_fma_f32 v25,-v24,v24,v25
v_max_f32 v25,0,v25
v_cvt_pk_bf16_f32 v6,v24,v25
v_lshlrev_b32 v24,16,v6
v_and_b32 v25,0xffff0000,v6
v_add_f32 v25,0x3727c5ac,v25
v_cvt_pk_bf16_f32 v6,v25,v25
v_lshlrev_b32 v25,16,v6
v_sqrt_f32 v25,v25
s_nop 0
v_cvt_pk_bf16_f32 v6,v25,v25
v_lshlrev_b32 v25,16,v6
v_rcp_f32 v25,v25
s_nop 0
v_pk_add_f32 v[72:73],v[72:73],v[24:25] op_sel_hi:[1,0] neg_lo:[0,1] neg_hi:[0,1]
v_pk_add_f32 v[74:75],v[74:75],v[24:25] op_sel_hi:[1,0] neg_lo:[0,1] neg_hi:[0,1]
v_pk_add_f32 v[76:77],v[76:77],v[24:25] op_sel_hi:[1,0] neg_lo:[0,1] neg_hi:[0,1]
v_pk_add_f32 v[78:79],v[78:79],v[24:25] op_sel_hi:[1,0] neg_lo:[0,1] neg_hi:[0,1]
v_pk_add_f32 v[80:81],v[80:81],v[24:25] op_sel_hi:[1,0] neg_lo:[0,1] neg_hi:[0,1]
v_pk_add_f32 v[82:83],v[82:83],v[24:25] op_sel_hi:[1,0] neg_lo:[0,1] neg_hi:[0,1]
v_pk_add_f32 v[84:85],v[84:85],v[24:25] op_sel_hi:[1,0] neg_lo:[0,1] neg_hi:[0,1]
v_pk_add_f32 v[86:87],v[86:87],v[24:25] op_sel_hi:[1,0] neg_lo:[0,1] neg_hi:[0,1]
v_pk_add_f32 v[88:89],v[88:89],v[24:25] op_sel_hi:[1,0] neg_lo:[0,1] neg_hi:[0,1]
v_pk_add_f32 v[90:91],v[90:91],v[24:25] op_sel_hi:[1,0] neg_lo:[0,1] neg_hi:[0,1]
v_pk_add_f32 v[92:93],v[92:93],v[24:25] op_sel_hi:[1,0] neg_lo:[0,1] neg_hi:[0,1]
v_pk_add_f32 v[94:95],v[94:95],v[24:25] op_sel_hi:[1,0] neg_lo:[0,1] neg_hi:[0,1]
v_pk_add_f32 v[96:97],v[96:97],v[24:25] op_sel_hi:[1,0] neg_lo:[0,1] neg_hi:[0,1]
v_pk_add_f32 v[98:99],v[98:99],v[24:25] op_sel_hi:[1,0] neg_lo:[0,1] neg_hi:[0,1]
v_pk_add_f32 v[100:101],v[100:101],v[24:25] op_sel_hi:[1,0] neg_lo:[0,1] neg_hi:[0,1]
v_pk_add_f32 v[102:103],v[102:103],v[24:25] op_sel_hi:[1,0] neg_lo:[0,1] neg_hi:[0,1]
v_pk_add_f32 v[104:105],v[104:105],v[24:25] op_sel_hi:[1,0] neg_lo:[0,1] neg_hi:[0,1]
v_pk_add_f32 v[106:107],v[106:107],v[24:25] op_sel_hi:[1,0] neg_lo:[0,1] neg_hi:[0,1]
v_pk_add_f32 v[108:109],v[108:109],v[24:25] op_sel_hi:[1,0] neg_lo:[0,1] neg_hi:[0,1]
v_pk_add_f32 v[110:111],v[110:111],v[24:25] op_sel_hi:[1,0] neg_lo:[0,1] neg_hi:[0,1]
v_cvt_pk_bf16_f32 v6,v72,v73
v_lshlrev_b32 v72,16,v6
v_and_b32 v73,0xffff0000,v6
v_cvt_pk_bf16_f32 v8,v74,v75
v_lshlrev_b32 v74,16,v8
v_and_b32 v75,0xffff0000,v8
v_cvt_pk_bf16_f32 v6,v76,v77
v_lshlrev_b32 v76,16,v6
v_and_b32 v77,0xffff0000,v6
v_cvt_pk_bf16_f32 v8,v78,v79
v_lshlrev_b32 v78,16,v8
v_and_b32 v79,0xffff0000,v8
v_cvt_pk_bf16_f32 v6,v80,v81
v_lshlrev_b32 v80,16,v6
v_and_b32 v81,0xffff0000,v6
v_cvt_pk_bf16_f32 v8,v82,v83
v_lshlrev_b32 v82,16,v8
v_and_b32 v83,0xffff0000,v8
v_cvt_pk_bf16_f32 v6,v84,v85
v_lshlrev_b32 v84,16,v6
v_and_b32 v85,0xffff0000,v6
v_cvt_pk_bf16_f32 v8,v86,v87
v_lshlrev_b32 v86,16,v8
v_and_b32 v87,0xffff0000,v8
v_cvt_pk_bf16_f32 v6,v88,v89
v_lshlrev_b32 v88,16,v6
v_and_b32 v89,0xffff0000,v6
v_cvt_pk_bf16_f32 v8,v90,v91
v_lshlrev_b32 v90,16,v8
v_and_b32 v91,0xffff0000,v8
v_cvt_pk_bf16_f32 v6,v92,v93
v_lshlrev_b32 v92,16,v6
v_and_b32 v93,0xffff0000,v6
v_cvt_pk_bf16_f32 v8,v94,v95
v_lshlrev_b32 v94,16,v8
v_and_b32 v95,0xffff0000,v8
v_cvt_pk_bf16_f32 v6,v96,v97
v_lshlrev_b32 v96,16,v6
v_and_b32 v97,0xffff0000,v6
v_cvt_pk_bf16_f32 v8,v98,v99
v_lshlrev_b32 v98,16,v8
v_and_b32 v99,0xffff0000,v8
v_cvt_pk_bf16_f32 v6,v100,v101
v_lshlrev_b32 v100,16,v6
v_and_b32 v101,0xffff0000,v6
v_cvt_pk_bf16_f32 v8,v102,v103
v_lshlrev_b32 v102,16,v8
v_and_b32 v103,0xffff0000,v8
v_cvt_pk_bf16_f32 v6,v104,v105
v_lshlrev_b32 v104,16,v6
v_and_b32 v105,0xffff0000,v6
v_cvt_pk_bf16_f32 v8,v106,v107
v_lshlrev_b32 v106,16,v8
v_and_b32 v107,0xffff0000,v8
v_cvt_pk_bf16_f32 v6,v108,v109
v_lshlrev_b32 v108,16,v6
v_and_b32 v109,0xffff0000,v6
v_cvt_pk_bf16_f32 v8,v110,v111
v_lshlrev_b32 v110,16,v8
v_and_b32 v111,0xffff0000,v8
v_pk_mul_f32 v[72:73],v[72:73],v[24:25] op_sel:[0,1] op_sel_hi:[1,1]
v_pk_mul_f32 v[74:75],v[74:75],v[24:25] op_sel:[0,1] op_sel_hi:[1,1]
v_pk_mul_f32 v[76:77],v[76:77],v[24:25] op_sel:[0,1] op_sel_hi:[1,1]
v_pk_mul_f32 v[78:79],v[78:79],v[24:25] op_sel:[0,1] op_sel_hi:[1,1]
v_pk_mul_f32 v[80:81],v[80:81],v[24:25] op_sel:[0,1] op_sel_hi:[1,1]
v_pk_mul_f32 v[82:83],v[82:83],v[24:25] op_sel:[0,1] op_sel_hi:[1,1]
v_pk_mul_f32 v[84:85],v[84:85],v[24:25] op_sel:[0,1] op_sel_hi:[1,1]
v_pk_mul_f32 v[86:87],v[86:87],v[24:25] op_sel:[0,1] op_sel_hi:[1,1]
v_pk_mul_f32 v[88:89],v[88:89],v[24:25] op_sel:[0,1] op_sel_hi:[1,1]
v_pk_mul_f32 v[90:91],v[90:91],v[24:25] op_sel:[0,1] op_sel_hi:[1,1]
v_pk_mul_f32 v[92:93],v[92:93],v[24:25] op_sel:[0,1] op_sel_hi:[1,1]
v_pk_mul_f32 v[94:95],v[94:95],v[24:25] op_sel:[0,1] op_sel_hi:[1,1]
v_pk_mul_f32 v[96:97],v[96:97],v[24:25] op_sel:[0,1] op_sel_hi:[1,1]
v_pk_mul_f32 v[98:99],v[98:99],v[24:25] op_sel:[0,1] op_sel_hi:[1,1]
v_pk_mul_f32 v[100:101],v[100:101],v[24:25] op_sel:[0,1] op_sel_hi:[1,1]
v_pk_mul_f32 v[102:103],v[102:103],v[24:25] op_sel:[0,1] op_sel_hi:[1,1]
v_pk_mul_f32 v[104:105],v[104:105],v[24:25] op_sel:[0,1] op_sel_hi:[1,1]
v_pk_mul_f32 v[106:107],v[106:107],v[24:25] op_sel:[0,1] op_sel_hi:[1,1]
v_pk_mul_f32 v[108:109],v[108:109],v[24:25] op_sel:[0,1] op_sel_hi:[1,1]
v_pk_mul_f32 v[110:111],v[110:111],v[24:25] op_sel:[0,1] op_sel_hi:[1,1]
v_cvt_pk_bf16_f32 v112,v72,v73
v_lshlrev_b32 v72,16,v112
v_and_b32 v73,0xffff0000,v112
v_cvt_pk_bf16_f32 v113,v74,v75
v_lshlrev_b32 v74,16,v113
v_and_b32 v75,0xffff0000,v113
v_cvt_pk_bf16_f32 v114,v76,v77
v_lshlrev_b32 v76,16,v114
v_and_b32 v77,0xffff0000,v114
v_cvt_pk_bf16_f32 v115,v78,v79
v_lshlrev_b32 v78,16,v115
v_and_b32 v79,0xffff0000,v115
v_cvt_pk_bf16_f32 v116,v80,v81
v_lshlrev_b32 v80,16,v116
v_and_b32 v81,0xffff0000,v116
v_cvt_pk_bf16_f32 v117,v82,v83
v_lshlrev_b32 v82,16,v117
v_and_b32 v83,0xffff0000,v117
v_cvt_pk_bf16_f32 v118,v84,v85
v_lshlrev_b32 v84,16,v118
v_and_b32 v85,0xffff0000,v118
v_cvt_pk_bf16_f32 v119,v86,v87
v_lshlrev_b32 v86,16,v119
v_and_b32 v87,0xffff0000,v119
v_cvt_pk_bf16_f32 v120,v88,v89
v_lshlrev_b32 v88,16,v120
v_and_b32 v89,0xffff0000,v120
v_cvt_pk_bf16_f32 v121,v90,v91
v_lshlrev_b32 v90,16,v121
v_and_b32 v91,0xffff0000,v121
v_cvt_pk_bf16_f32 v122,v92,v93
v_lshlrev_b32 v92,16,v122
v_and_b32 v93,0xffff0000,v122
v_cvt_pk_bf16_f32 v123,v94,v95
v_lshlrev_b32 v94,16,v123
v_and_b32 v95,0xffff0000,v123
v_cvt_pk_bf16_f32 v124,v96,v97
v_lshlrev_b32 v96,16,v124
v_and_b32 v97,0xffff0000,v124
v_cvt_pk_bf16_f32 v125,v98,v99
v_lshlrev_b32 v98,16,v125
v_and_b32 v99,0xffff0000,v125
v_cvt_pk_bf16_f32 v126,v100,v101
v_lshlrev_b32 v100,16,v126
v_and_b32 v101,0xffff0000,v126
v_cvt_pk_bf16_f32 v127,v102,v103
v_lshlrev_b32 v102,16,v127
v_and_b32 v103,0xffff0000,v127
v_cvt_pk_bf16_f32 v128,v104,v105
v_lshlrev_b32 v104,16,v128
v_and_b32 v105,0xffff0000,v128
v_cvt_pk_bf16_f32 v129,v106,v107
v_lshlrev_b32 v106,16,v129
v_and_b32 v107,0xffff0000,v129
v_cvt_pk_bf16_f32 v130,v108,v109
v_lshlrev_b32 v108,16,v130
v_and_b32 v109,0xffff0000,v130
v_cvt_pk_bf16_f32 v131,v110,v111
v_lshlrev_b32 v110,16,v131
v_and_b32 v111,0xffff0000,v131
s_add_u32 s63,s65,0
v_permlane16_swap_b32 v112,v114
v_permlane16_swap_b32 v113,v115
buffer_store_dwordx4 v[112:115],v132,s[8:11],s63 offen sc1
s_add_u32 s63,s65,8192
v_permlane16_swap_b32 v116,v118
v_permlane16_swap_b32 v117,v119
buffer_store_dwordx4 v[116:119],v132,s[8:11],s63 offen sc1
s_add_u32 s63,s65,16384
v_permlane16_swap_b32 v120,v122
v_permlane16_swap_b32 v121,v123
buffer_store_dwordx4 v[120:123],v132,s[8:11],s63 offen sc1
s_add_u32 s63,s65,24576
v_permlane16_swap_b32 v124,v126
v_permlane16_swap_b32 v125,v127
buffer_store_dwordx4 v[124:127],v132,s[8:11],s63 offen sc1
s_add_u32 s63,s65,32768
v_permlane16_swap_b32 v128,v130
v_permlane16_swap_b32 v129,v131
buffer_store_dwordx4 v[128:131],v132,s[8:11],s63 offen sc1
s_add_u32 s63,s64,0
v_permlane16_swap_b32 v52,v54
v_permlane16_swap_b32 v53,v55
buffer_store_dwordx4 v[52:55],v132,s[8:11],s63 offen sc1
s_add_u32 s63,s64,8192
v_permlane16_swap_b32 v56,v58
v_permlane16_swap_b32 v57,v59
buffer_store_dwordx4 v[56:59],v132,s[8:11],s63 offen sc1
s_add_u32 s63,s64,16384
v_permlane16_swap_b32 v60,v62
v_permlane16_swap_b32 v61,v63
buffer_store_dwordx4 v[60:63],v132,s[8:11],s63 offen sc1
s_add_u32 s63,s64,24576
v_permlane16_swap_b32 v64,v66
v_permlane16_swap_b32 v65,v67
buffer_store_dwordx4 v[64:67],v132,s[8:11],s63 offen sc1
s_add_u32 s63,s64,32768
v_permlane16_swap_b32 v68,v70
v_permlane16_swap_b32 v69,v71
buffer_store_dwordx4 v[68:71],v132,s[8:11],s63 offen sc1
s_lshl_b32 s82,s55,6
s_add_u32 s82,s82,s54
s_lshl_b32 s82,s82,9
s_add_u32 s82,s82,0
s_lshl_b32 s61,s53,2
s_add_u32 s82,s82,s61
s_add_u32 s54,s54,16
R0_LOOPA:
s_add_u32 s66,s54,16
s_min_u32 s66,s66,63
s_mul_i32 s62,s66,40960
buffer_load_dwordx2 v[52:53],v133,s[4:7],s62 offen offset:0
buffer_load_dwordx2 v[54:55],v133,s[4:7],s62 offen offset:128
buffer_load_dwordx2 v[56:57],v133,s[4:7],s62 offen offset:256
buffer_load_dwordx2 v[58:59],v133,s[4:7],s62 offen offset:384
buffer_load_dwordx2 v[60:61],v133,s[4:7],s62 offen offset:512
buffer_load_dwordx2 v[62:63],v133,s[4:7],s62 offen offset:640
buffer_load_dwordx2 v[64:65],v133,s[4:7],s62 offen offset:768
buffer_load_dwordx2 v[66:67],v133,s[4:7],s62 offen offset:896
buffer_load_dwordx2 v[68:69],v133,s[4:7],s62 offen offset:1024
buffer_load_dwordx2 v[70:71],v133,s[4:7],s62 offen offset:1152
s_mul_i32 s64,s54,40960
s_add_u32 s64,s64,234749952
s_mul_i32 s65,s54,46080
s_add_u32 s65,s65,206569472
s_waitcnt vmcnt(10)
s_mov_b64 exec,1
buffer_store_dword v5,v1,s[8:11],s82 offen sc1
s_mov_b64 exec,-1
v_lshlrev_b32 v72,16,v32
v_and_b32 v73,0xffff0000,v32
v_lshlrev_b32 v74,16,v33
v_and_b32 v75,0xffff0000,v33
v_lshlrev_b32 v76,16,v34
v_and_b32 v77,0xffff0000,v34
v_lshlrev_b32 v78,16,v35
v_and_b32 v79,0xffff0000,v35
v_lshlrev_b32 v80,16,v36
v_and_b32 v81,0xffff0000,v36
v_lshlrev_b32 v82,16,v37
v_and_b32 v83,0xffff0000,v37
v_lshlrev_b32 v84,16,v38
v_and_b32 v85,0xffff0000,v38
v_lshlrev_b32 v86,16,v39
v_and_b32 v87,0xffff0000,v39
v_lshlrev_b32 v88,16,v40
v_and_b32 v89,0xffff0000,v40
v_lshlrev_b32 v90,16,v41
v_and_b32 v91,0xffff0000,v41
v_lshlrev_b32 v92,16,v42
v_and_b32 v93,0xffff0000,v42
v_lshlrev_b32 v94,16,v43
v_and_b32 v95,0xffff0000,v43
v_lshlrev_b32 v96,16,v44
v_and_b32 v97,0xffff0000,v44
v_lshlrev_b32 v98,16,v45
v_and_b32 v99,0xffff0000,v45
v_lshlrev_b32 v100,16,v46
v_and_b32 v101,0xffff0000,v46
v_lshlrev_b32 v102,16,v47
v_and_b32 v103,0xffff0000,v47
v_lshlrev_b32 v104,16,v48
v_and_b32 v105,0xffff0000,v48
v_lshlrev_b32 v106,16,v49
v_and_b32 v107,0xffff0000,v49
v_lshlrev_b32 v108,16,v50
v_and_b32 v109,0xffff0000,v50
v_lshlrev_b32 v110,16,v51
v_and_b32 v111,0xffff0000,v51
v_pk_add_f32 v[28:29],v[72:73],v[74:75]
v_pk_mul_f32 v[26:27],v[72:73],v[72:73]
v_pk_fma_f32 v[26:27],v[74:75],v[74:75],v[26:27]
v_pk_add_f32 v[28:29],v[28:29],v[76:77]
v_pk_fma_f32 v[26:27],v[76:77],v[76:77],v[26:27]
v_pk_add_f32 v[28:29],v[28:29],v[78:79]
v_pk_fma_f32 v[26:27],v[78:79],v[78:79],v[26:27]
v_pk_add_f32 v[28:29],v[28:29],v[80:81]
v_pk_fma_f32 v[26:27],v[80:81],v[80:81],v[26:27]
v_pk_add_f32 v[28:29],v[28:29],v[82:83]
v_pk_fma_f32 v[26:27],v[82:83],v[82:83],v[26:27]
v_pk_add_f32 v[28:29],v[28:29],v[84:85]
v_pk_fma_f32 v[26:27],v[84:85],v[84:85],v[26:27]
v_pk_add_f32 v[28:29],v[28:29],v[86:87]
v_pk_fma_f32 v[26:27],v[86:87],v[86:87],v[26:27]
v_pk_add_f32 v[28:29],v[28:29],v[88:89]
v_pk_fma_f32 v[26:27],v[88:89],v[88:89],v[26:27]
v_pk_add_f32 v[28:29],v[28:29],v[90:91]
v_pk_fma_f32 v[26:27],v[90:91],v[90:91],v[26:27]
v_pk_add_f32 v[28:29],v[28:29],v[92:93]
v_pk_fma_f32 v[26:27],v[92:93],v[92:93],v[26:27]
v_pk_add_f32 v[28:29],v[28:29],v[94:95]
v_pk_fma_f32 v[26:27],v[94:95],v[94:95],v[26:27]
v_pk_add_f32 v[28:29],v[28:29],v[96:97]
v_pk_fma_f32 v[26:27],v[96:97],v[96:97],v[26:27]
v_pk_add_f32 v[28:29],v[28:29],v[98:99]
v_pk_fma_f32 v[26:27],v[98:99],v[98:99],v[26:27]
v_pk_add_f32 v[28:29],v[28:29],v[100:101]
v_pk_fma_f32 v[26:27],v[100:101],v[100:101],v[26:27]
v_pk_add_f32 v[28:29],v[28:29],v[102:103]
v_pk_fma_f32 v[26:27],v[102:103],v[102:103],v[26:27]
v_pk_add_f32 v[28:29],v[28:29],v[104:105]
v_pk_fma_f32 v[26:27],v[104:105],v[104:105],v[26:27]
v_pk_add_f32 v[28:29],v[28:29],v[106:107]
v_pk_fma_f32 v[26:27],v[106:107],v[106:107],v[26:27]
v_pk_add_f32 v[28:29],v[28:29],v[108:109]
v_pk_fma_f32 v[26:27],v[108:109],v[108:109],v[26:27]
v_pk_add_f32 v[28:29],v[28:29],v[110:111]
v_pk_fma_f32 v[26:27],v[110:111],v[110:111],v[26:27]
v_add_f32 v24,v28,v29
v_add_f32 v25,v26,v27
s_nop 0
v_add_f32_dpp v24,v24,v24 row_ror:4 row_mask:0xf bank_mask:0xf
v_add_f32_dpp v25,v25,v25 row_ror:4 row_mask:0xf bank_mask:0xf
s_nop 0
v_add_f32_dpp v24,v24,v24 row_ror:8 row_mask:0xf bank_mask:0xf
v_add_f32_dpp v25,v25,v25 row_ror:8 row_mask:0xf bank_mask:0xf
v_mov_b32 v26,v24
v_mov_b32 v27,v25
s_nop 0
v_permlane32_swap_b32 v24,v26
v_permlane32_swap_b32 v25,v27
v_add_f32 v24,v24,v26
v_add_f32 v25,v25,v27
v_mov_b32 v26,v24
v_mov_b32 v27,v25
s_nop 0
v_permlane16_swap_b32 v24,v26
v_permlane16_swap_b32 v25,v27
v_add_f32 v24,v24,v26
v_add_f32 v25,v25,v27
v_mul_f32 v24,0x3acccccd,v24
v_mul_f32 v25,0x3acccccd,v25
v_fma_f32 v25,-v24,v24,v25
v_max_f32 v25,0,v25
v_cvt_pk_bf16_f32 v6,v24,v25
v_lshlrev_b32 v24,16,v6
v_and_b32 v25,0xffff0000,v6
v_add_f32 v25,0x3727c5ac,v25
v_cvt_pk_bf16_f32 v6,v25,v25
v_lshlrev_b32 v25,16,v6
v_sqrt_f32 v25,v25
s_nop 0
v_cvt_pk_bf16_f32 v6,v25,v25
v_lshlrev_b32 v25,16,v6
v_rcp_f32 v25,v25
s_nop 0
v_pk_add_f32 v[72:73],v[72:73],v[24:25] op_sel_hi:[1,0] neg_lo:[0,1] neg_hi:[0,1]
v_pk_add_f32 v[74:75],v[74:75],v[24:25] op_sel_hi:[1,0] neg_lo:[0,1] neg_hi:[0,1]
v_pk_add_f32 v[76:77],v[76:77],v[24:25] op_sel_hi:[1,0] neg_lo:[0,1] neg_hi:[0,1]
v_pk_add_f32 v[78:79],v[78:79],v[24:25] op_sel_hi:[1,0] neg_lo:[0,1] neg_hi:[0,1]
v_pk_add_f32 v[80:81],v[80:81],v[24:25] op_sel_hi:[1,0] neg_lo:[0,1] neg_hi:[0,1]
v_pk_add_f32 v[82:83],v[82:83],v[24:25] op_sel_hi:[1,0] neg_lo:[0,1] neg_hi:[0,1]
v_pk_add_f32 v[84:85],v[84:85],v[24:25] op_sel_hi:[1,0] neg_lo:[0,1] neg_hi:[0,1]
v_pk_add_f32 v[86:87],v[86:87],v[24:25] op_sel_hi:[1,0] neg_lo:[0,1] neg_hi:[0,1]
v_pk_add_f32 v[88:89],v[88:89],v[24:25] op_sel_hi:[1,0] neg_lo:[0,1] neg_hi:[0,1]
v_pk_add_f32 v[90:91],v[90:91],v[24:25] op_sel_hi:[1,0] neg_lo:[0,1] neg_hi:[0,1]
v_pk_add_f32 v[92:93],v[92:93],v[24:25] op_sel_hi:[1,0] neg_lo:[0,1] neg_hi:[0,1]
v_pk_add_f32 v[94:95],v[94:95],v[24:25] op_sel_hi:[1,0] neg_lo:[0,1] neg_hi:[0,1]
v_pk_add_f32 v[96:97],v[96:97],v[24:25] op_sel_hi:[1,0] neg_lo:[0,1] neg_hi:[0,1]
v_pk_add_f32 v[98:99],v[98:99],v[24:25] op_sel_hi:[1,0] neg_lo:[0,1] neg_hi:[0,1]
v_pk_add_f32 v[100:101],v[100:101],v[24:25] op_sel_hi:[1,0] neg_lo:[0,1] neg_hi:[0,1]
v_pk_add_f32 v[102:103],v[102:103],v[24:25] op_sel_hi:[1,0] neg_lo:[0,1] neg_hi:[0,1]
v_pk_add_f32 v[104:105],v[104:105],v[24:25] op_sel_hi:[1,0] neg_lo:[0,1] neg_hi:[0,1]
v_pk_add_f32 v[106:107],v[106:107],v[24:25] op_sel_hi:[1,0] neg_lo:[0,1] neg_hi:[0,1]
v_pk_add_f32 v[108:109],v[108:109],v[24:25] op_sel_hi:[1,0] neg_lo:[0,1] neg_hi:[0,1]
v_pk_add_f32 v[110:111],v[110:111],v[24:25] op_sel_hi:[1,0] neg_lo:[0,1] neg_hi:[0,1]
v_cvt_pk_bf16_f32 v6,v72,v73
v_lshlrev_b32 v72,16,v6
v_and_b32 v73,0xffff0000,v6
v_cvt_pk_bf16_f32 v8,v74,v75
v_lshlrev_b32 v74,16,v8
v_and_b32 v75,0xffff0000,v8
v_cvt_pk_bf16_f32 v6,v76,v77
v_lshlrev_b32 v76,16,v6
v_and_b32 v77,0xffff0000,v6
v_cvt_pk_bf16_f32 v8,v78,v79
v_lshlrev_b32 v78,16,v8
v_and_b32 v79,0xffff0000,v8
v_cvt_pk_bf16_f32 v6,v80,v81
v_lshlrev_b32 v80,16,v6
v_and_b32 v81,0xffff0000,v6
v_cvt_pk_bf16_f32 v8,v82,v83
v_lshlrev_b32 v82,16,v8
v_and_b32 v83,0xffff0000,v8
v_cvt_pk_bf16_f32 v6,v84,v85
v_lshlrev_b32 v84,16,v6
v_and_b32 v85,0xffff0000,v6
v_cvt_pk_bf16_f32 v8,v86,v87
v_lshlrev_b32 v86,16,v8
v_and_b32 v87,0xffff0000,v8
v_cvt_pk_bf16_f32 v6,v88,v89
v_lshlrev_b32 v88,16,v6
v_and_b32 v89,0xffff0000,v6
v_cvt_pk_bf16_f32 v8,v90,v91
v_lshlrev_b32 v90,16,v8
v_and_b32 v91,0xffff0000,v8
v_cvt_pk_bf16_f32 v6,v92,v93
v_lshlrev_b32 v92,16,v6
v_and_b32 v93,0xffff0000,v6
v_cvt_pk_bf16_f32 v8,v94,v95
v_lshlrev_b32 v94,16,v8
v_and_b32 v95,0xffff0000,v8
v_cvt_pk_bf16_f32 v6,v96,v97
v_lshlrev_b32 v96,16,v6
v_and_b32 v97,0xffff0000,v6
v_cvt_pk_bf16_f32 v8,v98,v99
v_lshlrev_b32 v98,16,v8
v_and_b32 v99,0xffff0000,v8
v_cvt_pk_bf16_f32 v6,v100,v101
v_lshlrev_b32 v100,16,v6
v_and_b32 v101,0xffff0000,v6
v_cvt_pk_bf16_f32 v8,v102,v103
v_lshlrev_b32 v102,16,v8
v_and_b32 v103,0xffff0000,v8
v_cvt_pk_bf16_f32 v6,v104,v105
v_lshlrev_b32 v104,16,v6
v_and_b32 v105,0xffff0000,v6
v_cvt_pk_bf16_f32 v8,v106,v107
v_lshlrev_b32 v106,16,v8
v_and_b32 v107,0xffff0000,v8
v_cvt_pk_bf16_f32 v6,v108,v109
v_lshlrev_b32 v108,16,v6
v_and_b32 v109,0xffff0000,v6
v_cvt_pk_bf16_f32 v8,v110,v111
v_lshlrev_b32 v110,16,v8
v_and_b32 v111,0xffff0000,v8
v_pk_mul_f32 v[72:73],v[72:73],v[24:25] op_sel:[0,1] op_sel_hi:[1,1]
v_pk_mul_f32 v[74:75],v[74:75],v[24:25] op_sel:[0,1] op_sel_hi:[1,1]
v_pk_mul_f32 v[76:77],v[76:77],v[24:25] op_sel:[0,1] op_sel_hi:[1,1]
v_pk_mul_f32 v[78:79],v[78:79],v[24:25] op_sel:[0,1] op_sel_hi:[1,1]
v_pk_mul_f32 v[80:81],v[80:81],v[24:25] op_sel:[0,1] op_sel_hi:[1,1]
v_pk_mul_f32 v[82:83],v[82:83],v[24:25] op_sel:[0,1] op_sel_hi:[1,1]
v_pk_mul_f32 v[84:85],v[84:85],v[24:25] op_sel:[0,1] op_sel_hi:[1,1]
v_pk_mul_f32 v[86:87],v[86:87],v[24:25] op_sel:[0,1] op_sel_hi:[1,1]
v_pk_mul_f32 v[88:89],v[88:89],v[24:25] op_sel:[0,1] op_sel_hi:[1,1]
v_pk_mul_f32 v[90:91],v[90:91],v[24:25] op_sel:[0,1] op_sel_hi:[1,1]
v_pk_mul_f32 v[92:93],v[92:93],v[24:25] op_sel:[0,1] op_sel_hi:[1,1]
v_pk_mul_f32 v[94:95],v[94:95],v[24:25] op_sel:[0,1] op_sel_hi:[1,1]
v_pk_mul_f32 v[96:97],v[96:97],v[24:25] op_sel:[0,1] op_sel_hi:[1,1]
v_pk_mul_f32 v[98:99],v[98:99],v[24:25] op_sel:[0,1] op_sel_hi:[1,1]
v_pk_mul_f32 v[100:101],v[100:101],v[24:25] op_sel:[0,1] op_sel_hi:[1,1]
v_pk_mul_f32 v[102:103],v[102:103],v[24:25] op_sel:[0,1] op_sel_hi:[1,1]
v_pk_mul_f32 v[104:105],v[104:105],v[24:25] op_sel:[0,1] op_sel_hi:[1,1]
v_pk_mul_f32 v[106:107],v[106:107],v[24:25] op_sel:[0,1] op_sel_hi:[1,1]
v_pk_mul_f32 v[108:109],v[108:109],v[24:25] op_sel:[0,1] op_sel_hi:[1,1]
v_pk_mul_f32 v[110:111],v[110:111],v[24:25] op_sel:[0,1] op_sel_hi:[1,1]
v_cvt_pk_bf16_f32 v112,v72,v73
v_lshlrev_b32 v72,16,v112
v_and_b32 v73,0xffff0000,v112
v_cvt_pk_bf16_f32 v113,v74,v75
v_lshlrev_b32 v74,16,v113
v_and_b32 v75,0xffff0000,v113
v_cvt_pk_bf16_f32 v114,v76,v77
v_lshlrev_b32 v76,16,v114
v_and_b32 v77,0xffff0000,v114
v_cvt_pk_bf16_f32 v115,v78,v79
v_lshlrev_b32 v78,16,v115
v_and_b32 v79,0xffff0000,v115
v_cvt_pk_bf16_f32 v116,v80,v81
v_lshlrev_b32 v80,16,v116
v_and_b32 v81,0xffff0000,v116
v_cvt_pk_bf16_f32 v117,v82,v83
v_lshlrev_b32 v82,16,v117
v_and_b32 v83,0xffff0000,v117
v_cvt_pk_bf16_f32 v118,v84,v85
v_lshlrev_b32 v84,16,v118
v_and_b32 v85,0xffff0000,v118
v_cvt_pk_bf16_f32 v119,v86,v87
v_lshlrev_b32 v86,16,v119
v_and_b32 v87,0xffff0000,v119
v_cvt_pk_bf16_f32 v120,v88,v89
v_lshlrev_b32 v88,16,v120
v_and_b32 v89,0xffff0000,v120
v_cvt_pk_bf16_f32 v121,v90,v91
v_lshlrev_b32 v90,16,v121
v_and_b32 v91,0xffff0000,v121
v_cvt_pk_bf16_f32 v122,v92,v93
v_lshlrev_b32 v92,16,v122
v_and_b32 v93,0xffff0000,v122
v_cvt_pk_bf16_f32 v123,v94,v95
v_lshlrev_b32 v94,16,v123
v_and_b32 v95,0xffff0000,v123
v_cvt_pk_bf16_f32 v124,v96,v97
v_lshlrev_b32 v96,16,v124
v_and_b32 v97,0xffff0000,v124
v_cvt_pk_bf16_f32 v125,v98,v99
v_lshlrev_b32 v98,16,v125
v_and_b32 v99,0xffff0000,v125
v_cvt_pk_bf16_f32 v126,v100,v101
v_lshlrev_b32 v100,16,v126
v_and_b32 v101,0xffff0000,v126
v_cvt_pk_bf16_f32 v127,v102,v103
v_lshlrev_b32 v102,16,v127
v_and_b32 v103,0xffff0000,v127
v_cvt_pk_bf16_f32 v128,v104,v105
v_lshlrev_b32 v104,16,v128
v_and_b32 v105,0xffff0000,v128
v_cvt_pk_bf16_f32 v129,v106,v107
v_lshlrev_b32 v106,16,v129
v_and_b32 v107,0xffff0000,v129
v_cvt_pk_bf16_f32 v130,v108,v109
v_lshlrev_b32 v108,16,v130
v_and_b32 v109,0xffff0000,v130
v_cvt_pk_bf16_f32 v131,v110,v111
v_lshlrev_b32 v110,16,v131
v_and_b32 v111,0xffff0000,v131
s_add_u32 s63,s65,0
v_permlane16_swap_b32 v112,v114
v_permlane16_swap_b32 v113,v115
buffer_store_dwordx4 v[112:115],v132,s[8:11],s63 offen sc1
s_add_u32 s63,s65,8192
v_permlane16_swap_b32 v116,v118
v_permlane16_swap_b32 v117,v119
buffer_store_dwordx4 v[116:119],v132,s[8:11],s63 offen sc1
s_add_u32 s63,s65,16384
v_permlane16_swap_b32 v120,v122
v_permlane16_swap_b32 v121,v123
buffer_store_dwordx4 v[120:123],v132,s[8:11],s63 offen sc1
s_add_u32 s63,s65,24576
v_permlane16_swap_b32 v124,v126
v_permlane16_swap_b32 v125,v127
buffer_store_dwordx4 v[124:127],v132,s[8:11],s63 offen sc1
s_add_u32 s63,s65,32768
v_permlane16_swap_b32 v128,v130
v_permlane16_swap_b32 v129,v131
buffer_store_dwordx4 v[128:131],v132,s[8:11],s63 offen sc1
s_add_u32 s63,s64,0
v_permlane16_swap_b32 v32,v34
v_permlane16_swap_b32 v33,v35
buffer_store_dwordx4 v[32:35],v132,s[8:11],s63 offen sc1
s_add_u32 s63,s64,8192
v_permlane16_swap_b32 v36,v38
v_permlane16_swap_b32 v37,v39
buffer_store_dwordx4 v[36:39],v132,s[8:11],s63 offen sc1
s_add_u32 s63,s64,16384
v_permlane16_swap_b32 v40,v42
v_permlane16_swap_b32 v41,v43
buffer_store_dwordx4 v[40:43],v132,s[8:11],s63 offen sc1
s_add_u32 s63,s64,24576
v_permlane16_swap_b32 v44,v46
v_permlane16_swap_b32 v45,v47
buffer_store_dwordx4 v[44:47],v132,s[8:11],s63 offen sc1
s_add_u32 s63,s64,32768
v_permlane16_swap_b32 v48,v50
v_permlane16_swap_b32 v49,v51
buffer_store_dwordx4 v[48:51],v132,s[8:11],s63 offen sc1
s_lshl_b32 s82,s55,6
s_add_u32 s82,s82,s54
s_lshl_b32 s82,s82,9
s_add_u32 s82,s82,0
s_lshl_b32 s61,s53,2
s_add_u32 s82,s82,s61
s_add_u32 s54,s54,16
s_cmp_ge_u32 s54,64
s_cbranch_scc1 R0_ENDA
s_add_u32 s66,s54,16
s_min_u32 s66,s66,63
s_mul_i32 s62,s66,40960
buffer_load_dwordx2 v[32:33],v133,s[4:7],s62 offen offset:0
buffer_load_dwordx2 v[34:35],v133,s[4:7],s62 offen offset:128
buffer_load_dwordx2 v[36:37],v133,s[4:7],s62 offen offset:256
buffer_load_dwordx2 v[38:39],v133,s[4:7],s62 offen offset:384
buffer_load_dwordx2 v[40:41],v133,s[4:7],s62 offen offset:512
buffer_load_dwordx2 v[42:43],v133,s[4:7],s62 offen offset:640
buffer_load_dwordx2 v[44:45],v133,s[4:7],s62 offen offset:768
buffer_load_dwordx2 v[46:47],v133,s[4:7],s62 offen offset:896
buffer_load_dwordx2 v[48:49],v133,s[4:7],s62 offen offset:1024
buffer_load_dwordx2 v[50:51],v133,s[4:7],s62 offen offset:1152
s_mul_i32 s64,s54,40960
s_add_u32 s64,s64,234749952
s_mul_i32 s65,s54,46080
s_add_u32 s65,s65,206569472
s_waitcnt vmcnt(10)
s_mov_b64 exec,1
buffer_store_dword v5,v1,s[8:11],s82 offen sc1
s_mov_b64 exec,-1
v_lshlrev_b32 v72,16,v52
v_and_b32 v73,0xffff0000,v52
v_lshlrev_b32 v74,16,v53
v_and_b32 v75,0xffff0000,v53
v_lshlrev_b32 v76,16,v54
v_and_b32 v77,0xffff0000,v54
v_lshlrev_b32 v78,16,v55
v_and_b32 v79,0xffff0000,v55
v_lshlrev_b32 v80,16,v56
v_and_b32 v81,0xffff0000,v56
v_lshlrev_b32 v82,16,v57
v_and_b32 v83,0xffff0000,v57
v_lshlrev_b32 v84,16,v58
v_and_b32 v85,0xffff0000,v58
v_lshlrev_b32 v86,16,v59
v_and_b32 v87,0xffff0000,v59
v_lshlrev_b32 v88,16,v60
v_and_b32 v89,0xffff0000,v60
v_lshlrev_b32 v90,16,v61
v_and_b32 v91,0xffff0000,v61
v_lshlrev_b32 v92,16,v62
v_and_b32 v93,0xffff0000,v62
v_lshlrev_b32 v94,16,v63
v_and_b32 v95,0xffff0000,v63
v_lshlrev_b32 v96,16,v64
v_and_b32 v97,0xffff0000,v64
v_lshlrev_b32 v98,16,v65
v_and_b32 v99,0xffff0000,v65
v_lshlrev_b32 v100,16,v66
v_and_b32 v101,0xffff0000,v66
v_lshlrev_b32 v102,16,v67
v_and_b32 v103,0xffff0000,v67
v_lshlrev_b32 v104,16,v68
v_and_b32 v105,0xffff0000,v68
v_lshlrev_b32 v106,16,v69
v_and_b32 v107,0xffff0000,v69
v_lshlrev_b32 v108,16,v70
v_and_b32 v109,0xffff0000,v70
v_lshlrev_b32 v110,16,v71
v_and_b32 v111,0xffff0000,v71
v_pk_add_f32 v[28:29],v[72:73],v[74:75]
v_pk_mul_f32 v[26:27],v[72:73],v[72:73]
v_pk_fma_f32 v[26:27],v[74:75],v[74:75],v[26:27]
v_pk_add_f32 v[28:29],v[28:29],v[76:77]
v_pk_fma_f32 v[26:27],v[76:77],v[76:77],v[26:27]
v_pk_add_f32 v[28:29],v[28:29],v[78:79]
v_pk_fma_f32 v[26:27],v[78:79],v[78:79],v[26:27]
v_pk_add_f32 v[28:29],v[28:29],v[80:81]
v_pk_fma_f32 v[26:27],v[80:81],v[80:81],v[26:27]
v_pk_add_f32 v[28:29],v[28:29],v[82:83]
v_pk_fma_f32 v[26:27],v[82:83],v[82:83],v[26:27]
v_pk_add_f32 v[28:29],v[28:29],v[84:85]
v_pk_fma_f32 v[26:27],v[84:85],v[84:85],v[26:27]
v_pk_add_f32 v[28:29],v[28:29],v[86:87]
v_pk_fma_f32 v[26:27],v[86:87],v[86:87],v[26:27]
v_pk_add_f32 v[28:29],v[28:29],v[88:89]
v_pk_fma_f32 v[26:27],v[88:89],v[88:89],v[26:27]
v_pk_add_f32 v[28:29],v[28:29],v[90:91]
v_pk_fma_f32 v[26:27],v[90:91],v[90:91],v[26:27]
v_pk_add_f32 v[28:29],v[28:29],v[92:93]
v_pk_fma_f32 v[26:27],v[92:93],v[92:93],v[26:27]
v_pk_add_f32 v[28:29],v[28:29],v[94:95]
v_pk_fma_f32 v[26:27],v[94:95],v[94:95],v[26:27]
v_pk_add_f32 v[28:29],v[28:29],v[96:97]
v_pk_fma_f32 v[26:27],v[96:97],v[96:97],v[26:27]
v_pk_add_f32 v[28:29],v[28:29],v[98:99]
v_pk_fma_f32 v[26:27],v[98:99],v[98:99],v[26:27]
v_pk_add_f32 v[28:29],v[28:29],v[100:101]
v_pk_fma_f32 v[26:27],v[100:101],v[100:101],v[26:27]
v_pk_add_f32 v[28:29],v[28:29],v[102:103]
v_pk_fma_f32 v[26:27],v[102:103],v[102:103],v[26:27]
v_pk_add_f32 v[28:29],v[28:29],v[104:105]
v_pk_fma_f32 v[26:27],v[104:105],v[104:105],v[26:27]
v_pk_add_f32 v[28:29],v[28:29],v[106:107]
v_pk_fma_f32 v[26:27],v[106:107],v[106:107],v[26:27]
v_pk_add_f32 v[28:29],v[28:29],v[108:109]
v_pk_fma_f32 v[26:27],v[108:109],v[108:109],v[26:27]
v_pk_add_f32 v[28:29],v[28:29],v[110:111]
v_pk_fma_f32 v[26:27],v[110:111],v[110:111],v[26:27]
v_add_f32 v24,v28,v29
v_add_f32 v25,v26,v27
s_nop 0
v_add_f32_dpp v24,v24,v24 row_ror:4 row_mask:0xf bank_mask:0xf
v_add_f32_dpp v25,v25,v25 row_ror:4 row_mask:0xf bank_mask:0xf
s_nop 0
v_add_f32_dpp v24,v24,v24 row_ror:8 row_mask:0xf bank_mask:0xf
v_add_f32_dpp v25,v25,v25 row_ror:8 row_mask:0xf bank_mask:0xf
v_mov_b32 v26,v24
v_mov_b32 v27,v25
s_nop 0
v_permlane32_swap_b32 v24,v26
v_permlane32_swap_b32 v25,v27
v_add_f32 v24,v24,v26
v_add_f32 v25,v25,v27
v_mov_b32 v26,v24
v_mov_b32 v27,v25
s_nop 0
v_permlane16_swap_b32 v24,v26
v_permlane16_swap_b32 v25,v27
v_add_f32 v24,v24,v26
v_add_f32 v25,v25,v27
v_mul_f32 v24,0x3acccccd,v24
v_mul_f32 v25,0x3acccccd,v25
v_fma_f32 v25,-v24,v24,v25
v_max_f32 v25,0,v25
v_cvt_pk_bf16_f32 v6,v24,v25
v_lshlrev_b32 v24,16,v6
v_and_b32 v25,0xffff0000,v6
v_add_f32 v25,0x3727c5ac,v25
v_cvt_pk_bf16_f32 v6,v25,v25
v_lshlrev_b32 v25,16,v6
v_sqrt_f32 v25,v25
s_nop 0
v_cvt_pk_bf16_f32 v6,v25,v25
v_lshlrev_b32 v25,16,v6
v_rcp_f32 v25,v25
s_nop 0
v_pk_add_f32 v[72:73],v[72:73],v[24:25] op_sel_hi:[1,0] neg_lo:[0,1] neg_hi:[0,1]
v_pk_add_f32 v[74:75],v[74:75],v[24:25] op_sel_hi:[1,0] neg_lo:[0,1] neg_hi:[0,1]
v_pk_add_f32 v[76:77],v[76:77],v[24:25] op_sel_hi:[1,0] neg_lo:[0,1] neg_hi:[0,1]
v_pk_add_f32 v[78:79],v[78:79],v[24:25] op_sel_hi:[1,0] neg_lo:[0,1] neg_hi:[0,1]
v_pk_add_f32 v[80:81],v[80:81],v[24:25] op_sel_hi:[1,0] neg_lo:[0,1] neg_hi:[0,1]
v_pk_add_f32 v[82:83],v[82:83],v[24:25] op_sel_hi:[1,0] neg_lo:[0,1] neg_hi:[0,1]
v_pk_add_f32 v[84:85],v[84:85],v[24:25] op_sel_hi:[1,0] neg_lo:[0,1] neg_hi:[0,1]
v_pk_add_f32 v[86:87],v[86:87],v[24:25] op_sel_hi:[1,0] neg_lo:[0,1] neg_hi:[0,1]
v_pk_add_f32 v[88:89],v[88:89],v[24:25] op_sel_hi:[1,0] neg_lo:[0,1] neg_hi:[0,1]
v_pk_add_f32 v[90:91],v[90:91],v[24:25] op_sel_hi:[1,0] neg_lo:[0,1] neg_hi:[0,1]
v_pk_add_f32 v[92:93],v[92:93],v[24:25] op_sel_hi:[1,0] neg_lo:[0,1] neg_hi:[0,1]
v_pk_add_f32 v[94:95],v[94:95],v[24:25] op_sel_hi:[1,0] neg_lo:[0,1] neg_hi:[0,1]
v_pk_add_f32 v[96:97],v[96:97],v[24:25] op_sel_hi:[1,0] neg_lo:[0,1] neg_hi:[0,1]
v_pk_add_f32 v[98:99],v[98:99],v[24:25] op_sel_hi:[1,0] neg_lo:[0,1] neg_hi:[0,1]
v_pk_add_f32 v[100:101],v[100:101],v[24:25] op_sel_hi:[1,0] neg_lo:[0,1] neg_hi:[0,1]
v_pk_add_f32 v[102:103],v[102:103],v[24:25] op_sel_hi:[1,0] neg_lo:[0,1] neg_hi:[0,1]
v_pk_add_f32 v[104:105],v[104:105],v[24:25] op_sel_hi:[1,0] neg_lo:[0,1] neg_hi:[0,1]
v_pk_add_f32 v[106:107],v[106:107],v[24:25] op_sel_hi:[1,0] neg_lo:[0,1] neg_hi:[0,1]
v_pk_add_f32 v[108:109],v[108:109],v[24:25] op_sel_hi:[1,0] neg_lo:[0,1] neg_hi:[0,1]
v_pk_add_f32 v[110:111],v[110:111],v[24:25] op_sel_hi:[1,0] neg_lo:[0,1] neg_hi:[0,1]
v_cvt_pk_bf16_f32 v6,v72,v73
v_lshlrev_b32 v72,16,v6
v_and_b32 v73,0xffff0000,v6
v_cvt_pk_bf16_f32 v8,v74,v75
v_lshlrev_b32 v74,16,v8
v_and_b32 v75,0xffff0000,v8
v_cvt_pk_bf16_f32 v6,v76,v77
v_lshlrev_b32 v76,16,v6
v_and_b32 v77,0xffff0000,v6
v_cvt_pk_bf16_f32 v8,v78,v79
v_lshlrev_b32 v78,16,v8
v_and_b32 v79,0xffff0000,v8
v_cvt_pk_bf16_f32 v6,v80,v81
v_lshlrev_b32 v80,16,v6
v_and_b32 v81,0xffff0000,v6
v_cvt_pk_bf16_f32 v8,v82,v83
v_lshlrev_b32 v82,16,v8
v_and_b32 v83,0xffff0000,v8
v_cvt_pk_bf16_f32 v6,v84,v85
v_lshlrev_b32 v84,16,v6
v_and_b32 v85,0xffff0000,v6
v_cvt_pk_bf16_f32 v8,v86,v87
v_lshlrev_b32 v86,16,v8
v_and_b32 v87,0xffff0000,v8
v_cvt_pk_bf16_f32 v6,v88,v89
v_lshlrev_b32 v88,16,v6
v_and_b32 v89,0xffff0000,v6
v_cvt_pk_bf16_f32 v8,v90,v91
v_lshlrev_b32 v90,16,v8
v_and_b32 v91,0xffff0000,v8
v_cvt_pk_bf16_f32 v6,v92,v93
v_lshlrev_b32 v92,16,v6
v_and_b32 v93,0xffff0000,v6
v_cvt_pk_bf16_f32 v8,v94,v95
v_lshlrev_b32 v94,16,v8
v_and_b32 v95,0xffff0000,v8
v_cvt_pk_bf16_f32 v6,v96,v97
v_lshlrev_b32 v96,16,v6
v_and_b32 v97,0xffff0000,v6
v_cvt_pk_bf16_f32 v8,v98,v99
v_lshlrev_b32 v98,16,v8
v_and_b32 v99,0xffff0000,v8
v_cvt_pk_bf16_f32 v6,v100,v101
v_lshlrev_b32 v100,16,v6
v_and_b32 v101,0xffff0000,v6
v_cvt_pk_bf16_f32 v8,v102,v103
v_lshlrev_b32 v102,16,v8
v_and_b32 v103,0xffff0000,v8
v_cvt_pk_bf16_f32 v6,v104,v105
v_lshlrev_b32 v104,16,v6
v_and_b32 v105,0xffff0000,v6
v_cvt_pk_bf16_f32 v8,v106,v107
v_lshlrev_b32 v106,16,v8
v_and_b32 v107,0xffff0000,v8
v_cvt_pk_bf16_f32 v6,v108,v109
v_lshlrev_b32 v108,16,v6
v_and_b32 v109,0xffff0000,v6
v_cvt_pk_bf16_f32 v8,v110,v111
v_lshlrev_b32 v110,16,v8
v_and_b32 v111,0xffff0000,v8
v_pk_mul_f32 v[72:73],v[72:73],v[24:25] op_sel:[0,1] op_sel_hi:[1,1]
v_pk_mul_f32 v[74:75],v[74:75],v[24:25] op_sel:[0,1] op_sel_hi:[1,1]
v_pk_mul_f32 v[76:77],v[76:77],v[24:25] op_sel:[0,1] op_sel_hi:[1,1]
v_pk_mul_f32 v[78:79],v[78:79],v[24:25] op_sel:[0,1] op_sel_hi:[1,1]
v_pk_mul_f32 v[80:81],v[80:81],v[24:25] op_sel:[0,1] op_sel_hi:[1,1]
v_pk_mul_f32 v[82:83],v[82:83],v[24:25] op_sel:[0,1] op_sel_hi:[1,1]
v_pk_mul_f32 v[84:85],v[84:85],v[24:25] op_sel:[0,1] op_sel_hi:[1,1]
v_pk_mul_f32 v[86:87],v[86:87],v[24:25] op_sel:[0,1] op_sel_hi:[1,1]
v_pk_mul_f32 v[88:89],v[88:89],v[24:25] op_sel:[0,1] op_sel_hi:[1,1]
v_pk_mul_f32 v[90:91],v[90:91],v[24:25] op_sel:[0,1] op_sel_hi:[1,1]
v_pk_mul_f32 v[92:93],v[92:93],v[24:25] op_sel:[0,1] op_sel_hi:[1,1]
v_pk_mul_f32 v[94:95],v[94:95],v[24:25] op_sel:[0,1] op_sel_hi:[1,1]
v_pk_mul_f32 v[96:97],v[96:97],v[24:25] op_sel:[0,1] op_sel_hi:[1,1]
v_pk_mul_f32 v[98:99],v[98:99],v[24:25] op_sel:[0,1] op_sel_hi:[1,1]
v_pk_mul_f32 v[100:101],v[100:101],v[24:25] op_sel:[0,1] op_sel_hi:[1,1]
v_pk_mul_f32 v[102:103],v[102:103],v[24:25] op_sel:[0,1] op_sel_hi:[1,1]
v_pk_mul_f32 v[104:105],v[104:105],v[24:25] op_sel:[0,1] op_sel_hi:[1,1]
v_pk_mul_f32 v[106:107],v[106:107],v[24:25] op_sel:[0,1] op_sel_hi:[1,1]
v_pk_mul_f32 v[108:109],v[108:109],v[24:25] op_sel:[0,1] op_sel_hi:[1,1]
v_pk_mul_f32 v[110:111],v[110:111],v[24:25] op_sel:[0,1] op_sel_hi:[1,1]
v_cvt_pk_bf16_f32 v112,v72,v73
v_lshlrev_b32 v72,16,v112
v_and_b32 v73,0xffff0000,v112
v_cvt_pk_bf16_f32 v113,v74,v75
v_lshlrev_b32 v74,16,v113
v_and_b32 v75,0xffff0000,v113
v_cvt_pk_bf16_f32 v114,v76,v77
v_lshlrev_b32 v76,16,v114
v_and_b32 v77,0xffff0000,v114
v_cvt_pk_bf16_f32 v115,v78,v79
v_lshlrev_b32 v78,16,v115
v_and_b32 v79,0xffff0000,v115
v_cvt_pk_bf16_f32 v116,v80,v81
v_lshlrev_b32 v80,16,v116
v_and_b32 v81,0xffff0000,v116
v_cvt_pk_bf16_f32 v117,v82,v83
v_lshlrev_b32 v82,16,v117
v_and_b32 v83,0xffff0000,v117
v_cvt_pk_bf16_f32 v118,v84,v85
v_lshlrev_b32 v84,16,v118
v_and_b32 v85,0xffff0000,v118
v_cvt_pk_bf16_f32 v119,v86,v87
v_lshlrev_b32 v86,16,v119
v_and_b32 v87,0xffff0000,v119
v_cvt_pk_bf16_f32 v120,v88,v89
v_lshlrev_b32 v88,16,v120
v_and_b32 v89,0xffff0000,v120
v_cvt_pk_bf16_f32 v121,v90,v91
v_lshlrev_b32 v90,16,v121
v_and_b32 v91,0xffff0000,v121
v_cvt_pk_bf16_f32 v122,v92,v93
v_lshlrev_b32 v92,16,v122
v_and_b32 v93,0xffff0000,v122
v_cvt_pk_bf16_f32 v123,v94,v95
v_lshlrev_b32 v94,16,v123
v_and_b32 v95,0xffff0000,v123
v_cvt_pk_bf16_f32 v124,v96,v97
v_lshlrev_b32 v96,16,v124
v_and_b32 v97,0xffff0000,v124
v_cvt_pk_bf16_f32 v125,v98,v99
v_lshlrev_b32 v98,16,v125
v_and_b32 v99,0xffff0000,v125
v_cvt_pk_bf16_f32 v126,v100,v101
v_lshlrev_b32 v100,16,v126
v_and_b32 v101,0xffff0000,v126
v_cvt_pk_bf16_f32 v127,v102,v103
v_lshlrev_b32 v102,16,v127
v_and_b32 v103,0xffff0000,v127
v_cvt_pk_bf16_f32 v128,v104,v105
v_lshlrev_b32 v104,16,v128
v_and_b32 v105,0xffff0000,v128
v_cvt_pk_bf16_f32 v129,v106,v107
v_lshlrev_b32 v106,16,v129
v_and_b32 v107,0xffff0000,v129
v_cvt_pk_bf16_f32 v130,v108,v109
v_lshlrev_b32 v108,16,v130
v_and_b32 v109,0xffff0000,v130
v_cvt_pk_bf16_f32 v131,v110,v111
v_lshlrev_b32 v110,16,v131
v_and_b32 v111,0xffff0000,v131
s_add_u32 s63,s65,0
v_permlane16_swap_b32 v112,v114
v_permlane16_swap_b32 v113,v115
buffer_store_dwordx4 v[112:115],v132,s[8:11],s63 offen sc1
s_add_u32 s63,s65,8192
v_permlane16_swap_b32 v116,v118
v_permlane16_swap_b32 v117,v119
buffer_store_dwordx4 v[116:119],v132,s[8:11],s63 offen sc1
s_add_u32 s63,s65,16384
v_permlane16_swap_b32 v120,v122
v_permlane16_swap_b32 v121,v123
buffer_store_dwordx4 v[120:123],v132,s[8:11],s63 offen sc1
s_add_u32 s63,s65,24576
v_permlane16_swap_b32 v124,v126
v_permlane16_swap_b32 v125,v127
buffer_store_dwordx4 v[124:127],v132,s[8:11],s63 offen sc1
s_add_u32 s63,s65,32768
v_permlane16_swap_b32 v128,v130
v_permlane16_swap_b32 v129,v131
buffer_store_dwordx4 v[128:131],v132,s[8:11],s63 offen sc1
s_add_u32 s63,s64,0
v_permlane16_swap_b32 v52,v54
v_permlane16_swap_b32 v53,v55
buffer_store_dwordx4 v[52:55],v132,s[8:11],s63 offen sc1
s_add_u32 s63,s64,8192
v_permlane16_swap_b32 v56,v58
v_permlane16_swap_b32 v57,v59
buffer_store_dwordx4 v[56:59],v132,s[8:11],s63 offen sc1
s_add_u32 s63,s64,16384
v_permlane16_swap_b32 v60,v62
v_permlane16_swap_b32 v61,v63
buffer_store_dwordx4 v[60:63],v132,s[8:11],s63 offen sc1
s_add_u32 s63,s64,24576
v_permlane16_swap_b32 v64,v66
v_permlane16_swap_b32 v65,v67
buffer_store_dwordx4 v[64:67],v132,s[8:11],s63 offen sc1
s_add_u32 s63,s64,32768
v_permlane16_swap_b32 v68,v70
v_permlane16_swap_b32 v69,v71
buffer_store_dwordx4 v[68:71],v132,s[8:11],s63 offen sc1
s_lshl_b32 s82,s55,6
s_add_u32 s82,s82,s54
s_lshl_b32 s82,s82,9
s_add_u32 s82,s82,0
s_lshl_b32 s61,s53,2
s_add_u32 s82,s82,s61
s_add_u32 s54,s54,16
s_cmp_lt_u32 s54,64
s_cbranch_scc1 R0_LOOPA
R0_ENDA:
s_waitcnt vmcnt(0)
s_mov_b64 exec,1
buffer_store_dword v5,v1,s[8:11],s82 offen sc1
s_mov_b64 exec,-1
s_mov_b32 s52,s86
s_mul_i32 s60,s86,196608
s_add_u32 s69,s69,s60
s_mul_i32 s60,s86,1024
s_add_u32 s70,s70,s60
s_mov_b32 s70,s69
v_mov_b32 v231,0
s_mov_b32 s83,s100
s_nop 0
ATT_LOOP:
s_lshl_b32 s67,s51,6
s_add_u32 s67,s67,s52
s_lshl_b32 s67,s67,9
s_add_u32 s67,s67,65536
s_mul_i32 s66,s52,393216
s_add_u32 s66,s66,s71
v_cmp_eq_u32 vcc,0,v231
s_nop 0
s_cbranch_vccz ATT_RDY
fb_236:
buffer_load_dword v3,v2,s[8:11],s67 offen sc1
s_waitcnt vmcnt(0)
v_cmp_eq_u32 vcc,0,v3
s_nop 0
s_cbranch_vccz ok_237
s_sleep 20
s_sub_u32 s47,s47,1
s_cbranch_scc1 ABORT
s_branch fb_236
ok_237:
ATT_RDY:
s_add_u32 s63,s66,124780544
buffer_load_dwordx4 v[16:19],v1,s[8:11],s63 offen nt sc1
buffer_load_dwordx4 v[20:23],v1,s[8:11],s63 offen offset:1024 nt sc1
buffer_load_dwordx4 v[24:27],v1,s[8:11],s63 offen offset:2048 nt sc1
buffer_load_dwordx4 v[28:31],v1,s[8:11],s63 offen offset:3072 nt sc1
s_add_u32 s63,s66,124784640
buffer_load_dwordx4 v[32:35],v1,s[8:11],s63 offen nt sc1
buffer_load_dwordx4 v[36:39],v1,s[8:11],s63 offen offset:1024 nt sc1
buffer_load_dwordx4 v[40:43],v1,s[8:11],s63 offen offset:2048 nt sc1
buffer_load_dwordx4 v[44:47],v1,s[8:11],s63 offen offset:3072 nt sc1
s_add_u32 s63,s66,124788736
buffer_load_dwordx4 v[48:51],v1,s[8:11],s63 offen nt sc1
buffer_load_dwordx4 v[52:55],v1,s[8:11],s63 offen offset:1024 nt sc1
buffer_load_dwordx4 v[56:59],v1,s[8:11],s63 offen offset:2048 nt sc1
buffer_load_dwordx4 v[60:63],v1,s[8:11],s63 offen offset:3072 nt sc1
s_add_u32 s63,s66,74448896
buffer_load_dwordx4 v[64:67],v1,s[8:11],s63 offen sc1
buffer_load_dwordx4 v[68:71],v1,s[8:11],s63 offen offset:1024 sc1
buffer_load_dwordx4 v[72:75],v1,s[8:11],s63 offen offset:2048 sc1
buffer_load_dwordx4 v[76:79],v1,s[8:11],s63 offen offset:3072 sc1
s_add_u32 s63,s66,74452992
buffer_load_dwordx4 v[80:83],v1,s[8:11],s63 offen sc1
buffer_load_dwordx4 v[84:87],v1,s[8:11],s63 offen offset:1024 sc1
buffer_load_dwordx4 v[88:91],v1,s[8:11],s63 offen offset:2048 sc1
buffer_load_dwordx4 v[92:95],v1,s[8:11],s63 offen offset:3072 sc1
s_add_u32 s63,s66,74457088
buffer_load_dwordx4 v[96:99],v1,s[8:11],s63 offen sc1
buffer_load_dwordx4 v[100:103],v1,s[8:11],s63 offen offset:1024 sc1
buffer_load_dwordx4 v[104:107],v1,s[8:11],s63 offen offset:2048 sc1
buffer_load_dwordx4 v[108:111],v1,s[8:11],s63 offen offset:3072 sc1
s_add_u32 s63,s66,99614720
buffer_load_dwordx4 v[112:115],v1,s[8:11],s63 offen sc1
buffer_load_dwordx4 v[116:119],v1,s[8:11],s63 offen offset:1024 sc1
buffer_load_dwordx4 v[120:123],v1,s[8:11],s63 offen offset:2048 sc1
buffer_load_dwordx4 v[124:127],v1,s[8:11],s63 offen offset:3072 sc1
s_add_u32 s63,s66,99618816
buffer_load_dwordx4 v[128:131],v1,s[8:11],s63 offen sc1
buffer_load_dwordx4 v[132:135],v1,s[8:11],s63 offen offset:1024 sc1
buffer_load_dwordx4 v[136:139],v1,s[8:11],s63 offen offset:2048 sc1
buffer_load_dwordx4 v[140:143],v1,s[8:11],s63 offen offset:3072 sc1
s_add_u32 s63,s66,99622912
buffer_load_dwordx4 v[144:147],v1,s[8:11],s63 offen sc1
buffer_load_dwordx4 v[148:151],v1,s[8:11],s63 offen offset:1024 sc1
buffer_load_dwordx4 v[152:155],v1,s[8:11],s63 offen offset:2048 sc1
buffer_load_dwordx4 v[156:159],v1,s[8:11],s63 offen offset:3072 sc1
s_and_b32 s66,s52,3
s_lshl2_add_u32 s66,s51,s66
s_mul_i32 s66,s66,393216
s_add_u32 s66,s66,s71
v_lshlrev_b32 v232,7,v0
s_add_u32 s63,s66,149946368
buffer_load_dword v233,v232,s[8:11],s63 offen sc1
s_add_u32 s63,s66,149950464
buffer_load_dword v233,v232,s[8:11],s63 offen sc1
s_waitcnt vmcnt(14)
v_mfma_f32_16x16x32_bf16 v[184:187],v[64:67],v[16:19],0
v_mfma_f32_16x16x32_bf16 v[188:191],v[64:67],v[20:23],0
v_mfma_f32_16x16x32_bf16 v[192:195],v[68:71],v[20:23],0
v_mfma_f32_16x16x32_bf16 v[184:187],v[72:75],v[24:27],v[184:187]
v_mfma_f32_16x16x32_bf16 v[188:191],v[72:75],v[28:31],v[188:191]
v_mfma_f32_16x16x32_bf16 v[192:195],v[76:79],v[28:31],v[192:195]
v_mfma_f32_16x16x32_bf16 v[184:187],v[80:83],v[32:35],v[184:187]
v_mfma_f32_16x16x32_bf16 v[188:191],v[80:83],v[36:39],v[188:191]
v_mfma_f32_16x16x32_bf16 v[192:195],v[84:87],v[36:39],v[192:195]
v_mfma_f32_16x16x32_bf16 v[184:187],v[88:91],v[40:43],v[184:187]
v_mfma_f32_16x16x32_bf16 v[188:191],v[88:91],v[44:47],v[188:191]
v_mfma_f32_16x16x32_bf16 v[192:195],v[92:95],v[44:47],v[192:195]
v_mfma_f32_16x16x32_bf16 v[184:187],v[96:99],v[48:51],v[184:187]
v_mfma_f32_16x16x32_bf16 v[188:191],v[96:99],v[52:55],v[188:191]
v_mfma_f32_16x16x32_bf16 v[192:195],v[100:103],v[52:55],v[192:195]
v_mfma_f32_16x16x32_bf16 v[184:187],v[104:107],v[56:59],v[184:187]
v_mfma_f32_16x16x32_bf16 v[188:191],v[104:107],v[60:63],v[188:191]
v_mfma_f32_16x16x32_bf16 v[192:195],v[108:111],v[60:63],v[192:195]
s_nop 1
v_cvt_pk_bf16_f32 v6,v184,v185
v_lshlrev_b32 v184,16,v6
v_and_b32 v185,0xffff0000,v6
v_cvt_pk_bf16_f32 v6,v186,v187
v_lshlrev_b32 v186,16,v6
v_and_b32 v187,0xffff0000,v6
v_cvt_pk_bf16_f32 v6,v188,v189
v_lshlrev_b32 v188,16,v6
v_and_b32 v189,0xffff0000,v6
v_cvt_pk_bf16_f32 v6,v190,v191
v_lshlrev_b32 v190,16,v6
v_and_b32 v191,0xffff0000,v6
v_cvt_pk_bf16_f32 v6,v192,v193
v_lshlrev_b32 v192,16,v6
v_and_b32 v193,0xffff0000,v6
v_cvt_pk_bf16_f32 v6,v194,v195
v_lshlrev_b32 v194,16,v6
v_and_b32 v195,0xffff0000,v6
v_mul_f32 v184,s84,v184
v_mul_f32 v185,s84,v185
v_mul_f32 v186,s84,v186
v_mul_f32 v187,s84,v187
v_mul_f32 v188,s84,v188
v_mul_f32 v189,s84,v189
v_mul_f32 v190,s84,v190
v_mul_f32 v191,s84,v191
v_mul_f32 v192,s84,v192
v_mul_f32 v193,s84,v193
v_mul_f32 v194,s84,v194
v_mul_f32 v195,s84,v195
v_cvt_pk_bf16_f32 v6,v184,v185
v_lshlrev_b32 v184,16,v6
v_and_b32 v185,0xffff0000,v6
v_cvt_pk_bf16_f32 v6,v186,v187
v_lshlrev_b32 v186,16,v6
v_and_b32 v187,0xffff0000,v6
v_cvt_pk_bf16_f32 v6,v188,v189
v_lshlrev_b32 v188,16,v6
v_and_b32 v189,0xffff0000,v6
v_cvt_pk_bf16_f32 v6,v190,v191
v_lshlrev_b32 v190,16,v6
v_and_b32 v191,0xffff0000,v6
v_cvt_pk_bf16_f32 v6,v192,v193
v_lshlrev_b32 v192,16,v6
v_and_b32 v193,0xffff0000,v6
v_cvt_pk_bf16_f32 v6,v194,v195
v_lshlrev_b32 v194,16,v6
v_and_b32 v195,0xffff0000,v6
v_cndmask_b32 v184,v230,v184,s[72:73]
v_cndmask_b32 v185,v230,v185,s[74:75]
v_cndmask_b32 v186,v230,v186,s[76:77]
v_cndmask_b32 v187,v230,v187,s[78:79]
v_cndmask_b32 v192,v230,v192,s[72:73]
v_cndmask_b32 v193,v230,v193,s[74:75]
v_cndmask_b32 v194,v230,v194,s[76:77]
v_cndmask_b32 v195,v230,v195,s[78:79]
v_max3_f32 v241,v188,v189,v190
v_max3_f32 v240,v184,v185,v186
v_max3_f32 v241,v241,v191,v192
v_max_f32 v240,v240,v187
v_max3_f32 v241,v241,v193,v194
v_mov_b32 v244,v240
v_max_f32 v241,v241,v195
s_nop 0
v_permlane32_swap_b32 v240,v244
v_mov_b32 v248,v241
v_max_f32 v240,v240,v244
s_nop 0
v_permlane32_swap_b32 v241,v248
v_mov_b32 v244,v240
v_max_f32 v241,v241,v248
s_nop 0
v_permlane16_swap_b32 v240,v244
v_mov_b32 v248,v241
v_max_f32 v240,v240,v244
s_nop 0
v_permlane16_swap_b32 v241,v248
v_mul_f32 v244,s85,v240
v_max_f32 v241,v241,v248
v_fma_f32 v184,v184,s85,-v244
v_mul_f32 v248,s85,v241
v_fma_f32 v185,v185,s85,-v244
v_fma_f32 v188,v188,s85,-v248
v_fma_f32 v186,v186,s85,-v244
v_fma_f32 v189,v189,s85,-v248
v_fma_f32 v187,v187,s85,-v244
v_fma_f32 v190,v190,s85,-v248
v_exp_f32 v184,v184
v_fma_f32 v191,v191,s85,-v248
v_exp_f32 v185,v185
v_fma_f32 v192,v192,s85,-v248
v_exp_f32 v186,v186
v_fma_f32 v193,v193,s85,-v248
v_exp_f32 v187,v187
v_fma_f32 v194,v194,s85,-v248
v_add_f32 v242,v184,v185
v_fma_f32 v195,v195,s85,-v248
v_add_f32 v242,v242,v186
v_exp_f32 v188,v188
v_add_f32 v242,v242,v187
v_exp_f32 v189,v189
v_exp_f32 v190,v190
v_exp_f32 v191,v191
v_exp_f32 v192,v192
v_exp_f32 v193,v193
v_exp_f32 v194,v194
v_exp_f32 v195,v195
v_add_f32 v243,v188,v189
v_add_f32 v243,v243,v190
v_add_f32 v243,v243,v191
v_add_f32 v243,v243,v192
v_add_f32 v243,v243,v193
v_add_f32 v243,v243,v194
v_add_f32 v243,v243,v195
v_mov_b32 v215,0
v_mov_b32 v225,0
v_mov_b32 v226,0
s_add_u32 s66,s66,149946368
s_lshl_b32 s82,s51,6
s_add_u32 s82,s82,s52
s_lshl_b32 s82,s82,9
s_add_u32 s82,s82,262144
s_lshl_b32 s61,s87,2
s_add_u32 s82,s82,s61
s_lshl_b32 s65,s51,5
s_add_u32 s65,s65,s68
s_lshl_b32 s65,s65,5
s_add_u32 s65,s65,983040
s_sub_u32 s64,s52,3
v_min_u32 v244,4,v0
v_lshlrev_b32 v244,2,v244
s_nop 1
ob_238:
buffer_load_dword v3,v244,s[8:11],s65 offen sc1
s_waitcnt vmcnt(0)
v_cmp_gt_i32 vcc,s64,v3
s_nop 0
s_cbranch_vccz ok_239
s_sleep 2
s_sub_u32 s47,s47,1
s_cbranch_scc1 ABORT
s_branch ob_238
ok_239:
s_and_b32 s69,s52,14
s_mul_i32 s69,s69,196608
s_add_u32 s69,s69,s70
s_bfe_u32 s65,s52,0x10004
xk_240:
buffer_load_dwordx4 v[160:163],v1,s[8:11],s69 offen sc1
buffer_load_dwordx4 v[164:167],v1,s[8:11],s69 offen offset:1024 sc1
buffer_load_dwordx4 v[168:171],v1,s[8:11],s69 offen offset:2048 sc1
s_waitcnt vmcnt(0)
v_bitop3_b32 v3,v160,v164,s65 bitop3:0x7e
v_xor_b32 v244,s65,v168
v_bitop3_b32 v3,v3,v244,1 bitop3:0xa8
v_cmp_ne_u32 vcc,0,v3
s_nop 0
s_cbranch_vccz ok_241
s_sleep 4
s_sub_u32 s47,s47,1
s_cbranch_scc1 ABORT
s_branch xk_240
ok_241:
s_add_u32 s63,s69,3072
v_lshlrev_b32 v3,3,v0
buffer_load_dwordx4 v[172:175],v1,s[8:11],s63 offen sc1
buffer_load_dwordx2 v[176:177],v3,s[8:11],s63 offen offset:1024 sc1
buffer_load_dwordx4 v[178:181],v1,s[8:11],s63 offen offset:1536 sc1
buffer_load_dwordx2 v[182:183],v3,s[8:11],s63 offen offset:2560 sc1
buffer_load_dword v231,v2,s[8:11],s67 offen offset:1024 sc1
s_waitcnt vmcnt(5)
v_mfma_f32_16x16x32_bf16 v[196:199],v[160:163],v[16:19],0
v_mfma_f32_16x16x32_bf16 v[200:203],v[160:163],v[24:27],0
v_mfma_f32_16x16x32_bf16 v[204:207],v[160:163],v[20:23],0
v_mfma_f32_16x16x32_bf16 v[208:211],v[160:163],v[28:31],0
v_mfma_f32_16x16x32_bf16 v[196:199],v[164:167],v[32:35],v[196:199]
v_mfma_f32_16x16x32_bf16 v[200:203],v[164:167],v[40:43],v[200:203]
v_mfma_f32_16x16x32_bf16 v[204:207],v[164:167],v[36:39],v[204:207]
v_mfma_f32_16x16x32_bf16 v[208:211],v[164:167],v[44:47],v[208:211]
v_mfma_f32_16x16x32_bf16 v[196:199],v[168:171],v[48:51],v[196:199]
v_mfma_f32_16x16x32_bf16 v[200:203],v[168:171],v[56:59],v[200:203]
v_mfma_f32_16x16x32_bf16 v[204:207],v[168:171],v[52:55],v[204:207]
v_mfma_f32_16x16x32_bf16 v[208:211],v[168:171],v[60:63],v[208:211]
s_nop 7
v_add_f32 v204,v204,v210
v_add_f32 v196,v196,v202
v_add_f32 v205,v205,v211
v_add_f32 v197,v197,v203
v_cvt_pk_bf16_f32 v248,v204,v205
v_cvt_pk_bf16_f32 v244,v196,v197
v_lshlrev_b32 v204,16,v248
v_lshlrev_b32 v196,16,v244
v_and_b32 v205,0xffff0000,v248
v_and_b32 v197,0xffff0000,v244
v_mul_f32 v204,s84,v204
v_mul_f32 v196,s84,v196
v_mul_f32 v205,s84,v205
v_mul_f32 v197,s84,v197
v_cvt_pk_bf16_f32 v248,v204,v205
v_cvt_pk_bf16_f32 v244,v196,v197
v_lshlrev_b32 v204,16,v248
v_lshlrev_b32 v196,16,v244
v_and_b32 v205,0xffff0000,v248
v_and_b32 v197,0xffff0000,v244
v_max3_f32 v248,v204,v205,v241
v_max3_f32 v244,v196,v197,v240
v_mov_b32 v249,v248
v_mov_b32 v245,v244
s_nop 0
v_permlane32_swap_b32 v248,v249
v_permlane32_swap_b32 v244,v245
v_max_f32 v248,v248,v249
v_max_f32 v244,v244,v245
v_mov_b32 v249,v248
v_mov_b32 v245,v244
s_nop 0
v_permlane16_swap_b32 v248,v249
v_permlane16_swap_b32 v244,v245
v_max_f32 v248,v248,v249
v_max_f32 v244,v244,v245
v_mul_f32 v248,s85,v248
v_mul_f32 v244,s85,v244
v_fma_f32 v250,v241,s85,-v248
v_fma_f32 v246,v240,s85,-v244
v_fma_f32 v204,v204,s85,-v248
v_fma_f32 v196,v196,s85,-v244
v_fma_f32 v205,v205,s85,-v248
v_fma_f32 v197,v197,s85,-v244
v_exp_f32 v250,v250
v_exp_f32 v246,v246
v_exp_f32 v204,v204
v_exp_f32 v196,v196
v_exp_f32 v205,v205
v_exp_f32 v197,v197
v_fma_f32 v248,v250,v243,v204
v_fma_f32 v244,v246,v242,v196
v_add_f32 v248,v248,v205
v_add_f32 v244,v244,v197
v_mov_b32 v249,v248
v_mov_b32 v245,v244
s_nop 0
v_permlane32_swap_b32 v248,v249
v_permlane32_swap_b32 v244,v245
v_add_f32 v248,v248,v249
v_add_f32 v244,v244,v245
v_mov_b32 v249,v248
v_mov_b32 v245,v244
s_nop 0
v_permlane16_swap_b32 v248,v249
v_permlane16_swap_b32 v244,v245
v_add_f32 v248,v248,v249
v_add_f32 v244,v244,v245
v_rcp_f32 v248,v248
v_rcp_f32 v244,v244
v_mul_f32 v250,v250,v248
v_mul_f32 v246,v246,v244
v_mul_f32 v188,v188,v250
v_mul_f32 v184,v184,v246
v_mul_f32 v189,v189,v250
v_mul_f32 v185,v185,v246
v_mul_f32 v190,v190,v250
v_mul_f32 v186,v186,v246
v_mul_f32 v191,v191,v250
v_mul_f32 v187,v187,v246
v_mul_f32 v192,v192,v250
v_cvt_pk_bf16_f32 v212,v184,v185
v_mul_f32 v193,v193,v250
v_cvt_pk_bf16_f32 v213,v186,v187
v_mul_f32 v194,v194,v250
v_mul_f32 v196,v196,v244
v_mul_f32 v195,v195,v250
v_mul_f32 v197,v197,v244
v_cvt_pk_bf16_f32 v220,v188,v189
v_cvt_pk_bf16_f32 v214,v196,v197
v_cvt_pk_bf16_f32 v221,v190,v191
v_cvt_pk_bf16_f32 v222,v192,v193
v_cvt_pk_bf16_f32 v223,v194,v195
v_mul_f32 v204,v204,v248
v_mul_f32 v205,v205,v248
v_cvt_pk_bf16_f32 v224,v204,v205
v_cvt_pk_bf16_f32 v227,v204,v205
s_waitcnt vmcnt(1)
s_nop 0
xv_242:
v_bitop3_b32 v244,v172,v176,s65 bitop3:0x7e
v_bitop3_b32 v245,v178,v182,s65 bitop3:0x7e
v_bitop3_b32 v244,v244,v245,1 bitop3:0xa8
v_cmp_ne_u32 vcc,0,v244
s_nop 0
s_cbranch_vccz xo_243
s_sub_u32 s47,s47,1
s_cbranch_scc1 ABORT
buffer_load_dwordx4 v[172:175],v1,s[8:11],s63 offen sc1
buffer_load_dwordx2 v[176:177],v3,s[8:11],s63 offen offset:1024 sc1
buffer_load_dwordx4 v[178:181],v1,s[8:11],s63 offen offset:1536 sc1
buffer_load_dwordx2 v[182:183],v3,s[8:11],s63 offen offset:2560 sc1
s_waitcnt vmcnt(0)
s_branch xv_242
xo_243:
s_cmp_lg_u32 s49,0
s_cbranch_scc1 ATT_OS
v_mfma_f32_16x16x32_bf16 v[64:67],v[112:115],v[220:223],0
v_mfma_f32_16x16x32_bf16 v[68:71],v[116:119],v[220:223],0
v_mfma_f32_16x16x16_bf16 v[64:67],v[172:173],v[224:225],v[64:67]
v_mov_b32 v114,v172
v_mov_b32 v118,v173
v_mfma_f32_16x16x16_bf16 v[68:71],v[172:173],v[226:227],v[68:71]
v_mfma_f32_16x16x32_bf16 v[72:75],v[120:123],v[220:223],0
v_mfma_f32_16x16x32_bf16 v[76:79],v[124:127],v[220:223],0
v_cvt_pk_bf16_f32 v232,v64,v65
v_cvt_pk_bf16_f32 v233,v66,v67
v_mfma_f32_16x16x16_bf16 v[72:75],v[174:175],v[224:225],v[72:75]
v_mov_b32 v122,v174
v_mov_b32 v126,v175
v_mfma_f32_16x16x16_bf16 v[76:79],v[174:175],v[226:227],v[76:79]
v_cvt_pk_bf16_f32 v234,v68,v69
v_cvt_pk_bf16_f32 v235,v70,v71
s_add_u32 s63,s66,256
v_mfma_f32_16x16x32_bf16 v[80:83],v[128:131],v[220:223],0
buffer_store_dwordx4 v[232:235],v229,s[8:11],s63 offen offset:0
v_mfma_f32_16x16x32_bf16 v[84:87],v[132:135],v[220:223],0
v_cvt_pk_bf16_f32 v236,v72,v73
v_cvt_pk_bf16_f32 v237,v74,v75
v_mfma_f32_16x16x16_bf16 v[80:83],v[176:177],v[224:225],v[80:83]
v_mov_b32 v130,v176
v_mov_b32 v134,v177
v_mfma_f32_16x16x16_bf16 v[84:87],v[176:177],v[226:227],v[84:87]
v_cvt_pk_bf16_f32 v238,v76,v77
v_cvt_pk_bf16_f32 v239,v78,v79
v_mfma_f32_16x16x32_bf16 v[88:91],v[136:139],v[220:223],0
buffer_store_dwordx4 v[236:239],v229,s[8:11],s63 offen offset:2048
v_mfma_f32_16x16x32_bf16 v[92:95],v[140:143],v[220:223],0
v_cvt_pk_bf16_f32 v232,v80,v81
v_cvt_pk_bf16_f32 v233,v82,v83
v_mfma_f32_16x16x16_bf16 v[88:91],v[178:179],v[224:225],v[88:91]
v_mov_b32 v138,v178
v_mov_b32 v142,v179
v_mfma_f32_16x16x16_bf16 v[92:95],v[178:179],v[226:227],v[92:95]
v_cvt_pk_bf16_f32 v234,v84,v85
v_cvt_pk_bf16_f32 v235,v86,v87
s_add_u32 s63,s66,4352
v_mfma_f32_16x16x32_bf16 v[96:99],v[144:147],v[220:223],0
buffer_store_dwordx4 v[232:235],v229,s[8:11],s63 offen offset:0
v_mfma_f32_16x16x32_bf16 v[100:103],v[148:151],v[220:223],0
v_cvt_pk_bf16_f32 v236,v88,v89
v_cvt_pk_bf16_f32 v237,v90,v91
v_mfma_f32_16x16x16_bf16 v[96:99],v[180:181],v[224:225],v[96:99]
v_mov_b32 v146,v180
v_mov_b32 v150,v181
v_mfma_f32_16x16x16_bf16 v[100:103],v[180:181],v[226:227],v[100:103]
v_cvt_pk_bf16_f32 v238,v92,v93
v_cvt_pk_bf16_f32 v239,v94,v95
v_mfma_f32_16x16x32_bf16 v[104:107],v[152:155],v[220:223],0
buffer_store_dwordx4 v[236:239],v229,s[8:11],s63 offen offset:2048
v_mfma_f32_16x16x32_bf16 v[108:111],v[156:159],v[220:223],0
v_cvt_pk_bf16_f32 v232,v96,v97
v_cvt_pk_bf16_f32 v233,v98,v99
v_mfma_f32_16x16x16_bf16 v[104:107],v[182:183],v[224:225],v[104:107]
v_mov_b32 v154,v182
v_mov_b32 v158,v183
v_mfma_f32_16x16x16_bf16 v[108:111],v[182:183],v[226:227],v[108:111]
v_cvt_pk_bf16_f32 v234,v100,v101
v_cvt_pk_bf16_f32 v235,v102,v103
s_add_u32 s63,s66,8448
v_mfma_f32_16x16x32_bf16 v[16:19],v[112:115],v[212:215],0
buffer_store_dwordx4 v[232:235],v229,s[8:11],s63 offen offset:0
v_mfma_f32_16x16x32_bf16 v[20:23],v[116:119],v[212:215],0
v_cvt_pk_bf16_f32 v236,v104,v105
v_cvt_pk_bf16_f32 v237,v106,v107
v_mfma_f32_16x16x32_bf16 v[24:27],v[120:123],v[212:215],0
v_cvt_pk_bf16_f32 v238,v108,v109
v_cvt_pk_bf16_f32 v239,v110,v111
v_mfma_f32_16x16x32_bf16 v[28:31],v[124:127],v[212:215],0
buffer_store_dwordx4 v[236:239],v229,s[8:11],s63 offen offset:2048
v_cvt_pk_bf16_f32 v232,v16,v17
v_mfma_f32_16x16x32_bf16 v[32:35],v[128:131],v[212:215],0
v_cvt_pk_bf16_f32 v233,v18,v19
v_cvt_pk_bf16_f32 v234,v20,v21
v_mfma_f32_16x16x32_bf16 v[36:39],v[132:135],v[212:215],0
v_cvt_pk_bf16_f32 v235,v22,v23
s_add_u32 s63,s66,0
v_mfma_f32_16x16x32_bf16 v[40:43],v[136:139],v[212:215],0
buffer_store_dwordx4 v[232:235],v229,s[8:11],s63 offen offset:0
v_cvt_pk_bf16_f32 v236,v24,v25
v_mfma_f32_16x16x32_bf16 v[44:47],v[140:143],v[212:215],0
v_cvt_pk_bf16_f32 v237,v26,v27
v_cvt_pk_bf16_f32 v238,v28,v29
v_mfma_f32_16x16x32_bf16 v[48:51],v[144:147],v[212:215],0
v_cvt_pk_bf16_f32 v239,v30,v31
buffer_store_dwordx4 v[236:239],v229,s[8:11],s63 offen offset:2048
v_mfma_f32_16x16x32_bf16 v[52:55],v[148:151],v[212:215],0
v_cvt_pk_bf16_f32 v232,v32,v33
v_cvt_pk_bf16_f32 v233,v34,v35
v_mfma_f32_16x16x32_bf16 v[56:59],v[152:155],v[212:215],0
v_cvt_pk_bf16_f32 v234,v36,v37
v_cvt_pk_bf16_f32 v235,v38,v39
s_add_u32 s63,s66,4096
v_mfma_f32_16x16x32_bf16 v[60:63],v[156:159],v[212:215],0
buffer_store_dwordx4 v[232:235],v229,s[8:11],s63 offen offset:0
v_cvt_pk_bf16_f32 v236,v40,v41
v_cvt_pk_bf16_f32 v237,v42,v43
v_cvt_pk_bf16_f32 v238,v44,v45
v_cvt_pk_bf16_f32 v239,v46,v47
buffer_store_dwordx4 v[236:239],v229,s[8:11],s63 offen offset:2048
v_cvt_pk_bf16_f32 v232,v48,v49
v_cvt_pk_bf16_f32 v233,v50,v51
v_cvt_pk_bf16_f32 v234,v52,v53
v_cvt_pk_bf16_f32 v235,v54,v55
s_add_u32 s63,s66,8192
buffer_store_dwordx4 v[232:235],v229,s[8:11],s63 offen offset:0
v_cvt_pk_bf16_f32 v236,v56,v57
v_cvt_pk_bf16_f32 v237,v58,v59
v_cvt_pk_bf16_f32 v238,v60,v61
v_cvt_pk_bf16_f32 v239,v62,v63
buffer_store_dwordx4 v[236:239],v229,s[8:11],s63 offen offset:2048
s_waitcnt vmcnt(0)
s_mov_b64 exec,1
buffer_store_dword v5,v1,s[8:11],s82 offen
s_mov_b64 exec,-1
s_branch ATT_OJ
ATT_OS:
v_mfma_f32_16x16x32_bf16 v[64:67],v[112:115],v[220:223],0
v_mfma_f32_16x16x32_bf16 v[68:71],v[116:119],v[220:223],0
v_mfma_f32_16x16x16_bf16 v[64:67],v[172:173],v[224:225],v[64:67]
v_mov_b32 v114,v172
v_mov_b32 v118,v173
v_mfma_f32_16x16x16_bf16 v[68:71],v[172:173],v[226:227],v[68:71]
v_mfma_f32_16x16x32_bf16 v[72:75],v[120:123],v[220:223],0
v_mfma_f32_16x16x32_bf16 v[76:79],v[124:127],v[220:223],0
v_cvt_pk_bf16_f32 v232,v64,v65
v_cvt_pk_bf16_f32 v233,v66,v67
v_mfma_f32_16x16x16_bf16 v[72:75],v[174:175],v[224:225],v[72:75]
v_mov_b32 v122,v174
v_mov_b32 v126,v175
v_mfma_f32_16x16x16_bf16 v[76:79],v[174:175],v[226:227],v[76:79]
v_cvt_pk_bf16_f32 v234,v68,v69
v_cvt_pk_bf16_f32 v235,v70,v71
s_add_u32 s63,s66,256
v_mfma_f32_16x16x32_bf16 v[80:83],v[128:131],v[220:223],0
buffer_store_dwordx4 v[232:235],v229,s[8:11],s63 offen sc1
v_mfma_f32_16x16x32_bf16 v[84:87],v[132:135],v[220:223],0
v_cvt_pk_bf16_f32 v236,v72,v73
v_cvt_pk_bf16_f32 v237,v74,v75
v_mfma_f32_16x16x16_bf16 v[80:83],v[176:177],v[224:225],v[80:83]
v_mov_b32 v130,v176
v_mov_b32 v134,v177
v_mfma_f32_16x16x16_bf16 v[84:87],v[176:177],v[226:227],v[84:87]
v_cvt_pk_bf16_f32 v238,v76,v77
v_cvt_pk_bf16_f32 v239,v78,v79
v_mfma_f32_16x16x32_bf16 v[88:91],v[136:139],v[220:223],0
buffer_store_dwordx4 v[236:239],v229,s[8:11],s63 offen offset:2048 sc1
v_mfma_f32_16x16x32_bf16 v[92:95],v[140:143],v[220:223],0
v_cvt_pk_bf16_f32 v232,v80,v81
v_cvt_pk_bf16_f32 v233,v82,v83
v_mfma_f32_16x16x16_bf16 v[88:91],v[178:179],v[224:225],v[88:91]
v_mov_b32 v138,v178
v_mov_b32 v142,v179
v_mfma_f32_16x16x16_bf16 v[92:95],v[178:179],v[226:227],v[92:95]
v_cvt_pk_bf16_f32 v234,v84,v85
v_cvt_pk_bf16_f32 v235,v86,v87
s_add_u32 s63,s66,4352
v_mfma_f32_16x16x32_bf16 v[96:99],v[144:147],v[220:223],0
buffer_store_dwordx4 v[232:235],v229,s[8:11],s63 offen sc1
v_mfma_f32_16x16x32_bf16 v[100:103],v[148:151],v[220:223],0
v_cvt_pk_bf16_f32 v236,v88,v89
v_cvt_pk_bf16_f32 v237,v90,v91
v_mfma_f32_16x16x16_bf16 v[96:99],v[180:181],v[224:225],v[96:99]
v_mov_b32 v146,v180
v_mov_b32 v150,v181
v_mfma_f32_16x16x16_bf16 v[100:103],v[180:181],v[226:227],v[100:103]
v_cvt_pk_bf16_f32 v238,v92,v93
v_cvt_pk_bf16_f32 v239,v94,v95
v_mfma_f32_16x16x32_bf16 v[104:107],v[152:155],v[220:223],0
buffer_store_dwordx4 v[236:239],v229,s[8:11],s63 offen offset:2048 sc1
v_mfma_f32_16x16x32_bf16 v[108:111],v[156:159],v[220:223],0
v_cvt_pk_bf16_f32 v232,v96,v97
v_cvt_pk_bf16_f32 v233,v98,v99
v_mfma_f32_16x16x16_bf16 v[104:107],v[182:183],v[224:225],v[104:107]
v_mov_b32 v154,v182
v_mov_b32 v158,v183
v_mfma_f32_16x16x16_bf16 v[108:111],v[182:183],v[226:227],v[108:111]
v_cvt_pk_bf16_f32 v234,v100,v101
v_cvt_pk_bf16_f32 v235,v102,v103
s_add_u32 s63,s66,8448
v_mfma_f32_16x16x32_bf16 v[16:19],v[112:115],v[212:215],0
buffer_store_dwordx4 v[232:235],v229,s[8:11],s63 offen sc1
v_mfma_f32_16x16x32_bf16 v[20:23],v[116:119],v[212:215],0
v_cvt_pk_bf16_f32 v236,v104,v105
v_cvt_pk_bf16_f32 v237,v106,v107
v_mfma_f32_16x16x32_bf16 v[24:27],v[120:123],v[212:215],0
v_cvt_pk_bf16_f32 v238,v108,v109
v_cvt_pk_bf16_f32 v239,v110,v111
v_mfma_f32_16x16x32_bf16 v[28:31],v[124:127],v[212:215],0
buffer_store_dwordx4 v[236:239],v229,s[8:11],s63 offen offset:2048 sc1
v_cvt_pk_bf16_f32 v232,v16,v17
v_mfma_f32_16x16x32_bf16 v[32:35],v[128:131],v[212:215],0
v_cvt_pk_bf16_f32 v233,v18,v19
v_cvt_pk_bf16_f32 v234,v20,v21
v_mfma_f32_16x16x32_bf16 v[36:39],v[132:135],v[212:215],0
v_cvt_pk_bf16_f32 v235,v22,v23
s_add_u32 s63,s66,0
v_mfma_f32_16x16x32_bf16 v[40:43],v[136:139],v[212:215],0
buffer_store_dwordx4 v[232:235],v229,s[8:11],s63 offen sc1
v_cvt_pk_bf16_f32 v236,v24,v25
v_mfma_f32_16x16x32_bf16 v[44:47],v[140:143],v[212:215],0
v_cvt_pk_bf16_f32 v237,v26,v27
v_cvt_pk_bf16_f32 v238,v28,v29
v_mfma_f32_16x16x32_bf16 v[48:51],v[144:147],v[212:215],0
v_cvt_pk_bf16_f32 v239,v30,v31
buffer_store_dwordx4 v[236:239],v229,s[8:11],s63 offen offset:2048 sc1
v_mfma_f32_16x16x32_bf16 v[52:55],v[148:151],v[212:215],0
v_cvt_pk_bf16_f32 v232,v32,v33
v_cvt_pk_bf16_f32 v233,v34,v35
v_mfma_f32_16x16x32_bf16 v[56:59],v[152:155],v[212:215],0
v_cvt_pk_bf16_f32 v234,v36,v37
v_cvt_pk_bf16_f32 v235,v38,v39
s_add_u32 s63,s66,4096
v_mfma_f32_16x16x32_bf16 v[60:63],v[156:159],v[212:215],0
buffer_store_dwordx4 v[232:235],v229,s[8:11],s63 offen sc1
v_cvt_pk_bf16_f32 v236,v40,v41
v_cvt_pk_bf16_f32 v237,v42,v43
v_cvt_pk_bf16_f32 v238,v44,v45
v_cvt_pk_bf16_f32 v239,v46,v47
buffer_store_dwordx4 v[236:239],v229,s[8:11],s63 offen offset:2048 sc1
v_cvt_pk_bf16_f32 v232,v48,v49
v_cvt_pk_bf16_f32 v233,v50,v51
v_cvt_pk_bf16_f32 v234,v52,v53
v_cvt_pk_bf16_f32 v235,v54,v55
s_add_u32 s63,s66,8192
buffer_store_dwordx4 v[232:235],v229,s[8:11],s63 offen sc1
v_cvt_pk_bf16_f32 v236,v56,v57
v_cvt_pk_bf16_f32 v237,v58,v59
v_cvt_pk_bf16_f32 v238,v60,v61
v_cvt_pk_bf16_f32 v239,v62,v63
buffer_store_dwordx4 v[236:239],v229,s[8:11],s63 offen offset:2048 sc1
s_waitcnt vmcnt(0)
s_mov_b64 exec,1
buffer_store_dword v5,v1,s[8:11],s82 offen sc1
s_mov_b64 exec,-1
ATT_OJ:
s_add_u32 s52,s52,2
s_cmp_lt_u32 s52,64
s_cbranch_scc1 ATT_LOOP
s_endpgm
ROLE_WO:
v_lshlrev_b32 v1,4,v0
v_mov_b32 v5,1
s_lshl_b32 s56,s48,2
s_add_u32 s56,s56,s46
v_bfe_u32 v6,v0,2,2
v_lshrrev_b32 v7,4,v0
v_add_u32 v7,v6,v7
v_and_b32 v7,3,v7
v_and_b32 v15,3,v0
v_lshlrev_b32 v15,4,v15
v_lshl_add_u32 v15,v7,6,v15
v_lshl_add_u32 v15,v6,8,v15
v_lshrrev_b32 v6,5,v0
v_bfe_u32 v7,v0,4,1
v_lshlrev_b32 v16,10,v7
v_lshl_add_u32 v16,v6,8,v16
v_and_b32 v6,15,v0
v_lshl_add_u32 v16,v6,4,v16
v_add_u32 v18,49152,v16
v_lshrrev_b32 v6,5,v0
v_bfe_u32 v7,v0,4,1
v_lshlrev_b32 v20,10,v7
v_lshl_add_u32 v20,v6,8,v20
v_and_b32 v6,15,v0
v_lshl_add_u32 v20,v6,4,v20
v_lshrrev_b32 v6,5,v0
v_add_u32 v6,2,v6
v_bfe_u32 v7,v0,4,1
v_lshlrev_b32 v17,10,v7
v_lshl_add_u32 v17,v6,8,v17
v_and_b32 v6,15,v0
v_lshl_add_u32 v17,v6,4,v17
v_add_u32 v19,49152,v17
v_lshrrev_b32 v6,5,v0
v_add_u32 v6,2,v6
v_bfe_u32 v7,v0,4,1
v_lshlrev_b32 v21,10,v7
v_lshl_add_u32 v21,v6,8,v21
v_and_b32 v6,15,v0
v_lshl_add_u32 v21,v6,4,v21
v_add_u32 v16,0,v1
v_add_u32 v17,1024,v1
v_add_u32 v18,49152,v1
v_add_u32 v19,50176,v1
s_mul_i32 s68,s48,52429
s_lshr_b32 s68,s68,18
s_mul_i32 s60,s68,20
s_sub_u32 s60,s56,s60
s_lshl2_add_u32 s61,s68,s46
s_lshl_b32 s74,s61,5
s_and_b32 s62,s60,-4
s_add_u32 s74,s74,s62
s_add_u32 s74,s74,983040
s_lshr_b32 s62,s61,3
s_mul_i32 s62,s62,24
s_add_u32 s61,s61,s62
s_lshl_b32 s61,s61,2
v_mov_b32 v2,s61
v_bfe_u32 v6,v0,2,3
v_mul_u32_u24 v20,5120,v6
v_and_b32 v6,3,v0
v_lshl_add_u32 v20,v6,4,v20
v_lshrrev_b32 v6,5,v0
v_lshl_add_u32 v20,v6,6,v20
s_mul_i32 s58,s68,983040
s_lshl_b32 s61,s60,6
s_add_u32 s58,s58,s61
s_mul_i32 s69,s68,40960
s_lshl_b32 s60,s60,8
s_add_u32 s69,s69,s60
s_add_u32 s69,s69,175112192
s_lshl_b32 s75,s56,2
s_add_u32 s75,s75,819200
v_mov_b32 v24,-1
v_mov_b32 v25,-1
v_mov_b32 v26,-1
v_mov_b32 v27,-1
s_add_u32 s60,s48,32
s_lshl2_add_u32 s60,s60,s46
s_mul_i32 s60,s60,22528
s_add_u32 s61,s60,24117248
buffer_store_dwordx4 v[24:27],v1,s[8:11],s61 offen sc1
buffer_store_dwordx4 v[24:27],v1,s[8:11],s61 offen offset:1024 sc1
buffer_store_dwordx4 v[24:27],v1,s[8:11],s61 offen offset:2048 sc1
buffer_store_dwordx4 v[24:27],v1,s[8:11],s61 offen offset:3072 sc1
s_add_u32 s61,s60,24121344
buffer_store_dwordx4 v[24:27],v1,s[8:11],s61 offen sc1
buffer_store_dwordx4 v[24:27],v1,s[8:11],s61 offen offset:1024 sc1
buffer_store_dwordx4 v[24:27],v1,s[8:11],s61 offen offset:2048 sc1
buffer_store_dwordx4 v[24:27],v1,s[8:11],s61 offen offset:3072 sc1
s_add_u32 s61,s60,24125440
buffer_store_dwordx4 v[24:27],v1,s[8:11],s61 offen sc1
buffer_store_dwordx4 v[24:27],v1,s[8:11],s61 offen offset:1024 sc1
buffer_store_dwordx4 v[24:27],v1,s[8:11],s61 offen offset:2048 sc1
buffer_store_dwordx4 v[24:27],v1,s[8:11],s61 offen offset:3072 sc1
s_add_u32 s61,s60,24129536
buffer_store_dwordx4 v[24:27],v1,s[8:11],s61 offen sc1
buffer_store_dwordx4 v[24:27],v1,s[8:11],s61 offen offset:1024 sc1
buffer_store_dwordx4 v[24:27],v1,s[8:11],s61 offen offset:2048 sc1
buffer_store_dwordx4 v[24:27],v1,s[8:11],s61 offen offset:3072 sc1
s_add_u32 s61,s60,24133632
buffer_store_dwordx4 v[24:27],v1,s[8:11],s61 offen sc1
buffer_store_dwordx4 v[24:27],v1,s[8:11],s61 offen offset:1024 sc1
buffer_store_dwordx4 v[24:27],v1,s[8:11],s61 offen offset:2048 sc1
buffer_store_dwordx4 v[24:27],v1,s[8:11],s61 offen offset:3072 sc1
s_add_u32 s61,s60,24137728
buffer_store_dwordx4 v[24:27],v1,s[8:11],s61 offen sc1
buffer_store_dwordx4 v[24:27],v1,s[8:11],s61 offen offset:1024 sc1
s_waitcnt vmcnt(0)
s_barrier
s_cmp_lg_u32 s46,0
s_cbranch_scc1 arr_244
v_mov_b32 v6,1
s_lshl_b32 s3,s49,2
v_mov_b32 v7,s3
s_mov_b64 exec,1
buffer_atomic_add v6,v7,s[12:15],0 offen sc1
s_mov_b64 exec,-1
arr_244:
s_lshl_b32 s3,s49,2
v_mov_b32 v7,s3
s_nop 1
ibw_245:
buffer_load_dword v6,v7,s[12:15],0 offen sc1
s_waitcnt vmcnt(0)
v_cmp_ne_u32 vcc,256,v6
s_nop 0
s_cbranch_vccz ok_246
s_sleep 8
s_sub_u32 s47,s47,1
s_cbranch_scc1 ABORT
s_branch ibw_245
ok_246:
s_cmp_lg_u32 s49,0
s_cbranch_scc1 ibok_247
v_and_b32 v7,7,v0
v_lshlrev_b32 v7,2,v7
buffer_load_dword v6,v7,s[12:15],0 offen offset:32 sc1
s_waitcnt vmcnt(0)
v_cmp_ne_u32 vcc,32,v6
s_nop 0
s_cbranch_vccz ibok_247
s_barrier
s_mov_b32 s49,1
s_mov_b32 s3,s2
s_load_dwordx16 s[16:31],s[0:1],0
s_load_dwordx8 s[32:39],s[0:1],64
s_waitcnt lgkmcnt(0)
s_branch DISPATCH
ibok_247:
s_mul_i32 s63,s46,40960
s_mov_b32 s4,s26
s_mov_b32 s5,s27
s_mov_b32 s6,7864320
s_mov_b32 s7,0x20000
v_lshrrev_b32 v9,2,v0
s_mov_b32 s64,1280
v_mul_lo_u32 v9,v9,s64
v_and_b32 v10,3,v0
v_lshl_add_u32 v6,v10,4,v9
s_add_u32 m0,s63,0
s_add_u32 s65,s58,0
buffer_load_dwordx4 v6,s[4:7],s65 offen lds
s_add_u32 m0,s63,1024
s_add_u32 s65,s58,20480
buffer_load_dwordx4 v6,s[4:7],s65 offen lds
s_add_u32 m0,s63,2048
s_add_u32 s65,s58,40960
buffer_load_dwordx4 v6,s[4:7],s65 offen lds
s_add_u32 m0,s63,3072
s_add_u32 s65,s58,61440
buffer_load_dwordx4 v6,s[4:7],s65 offen lds
s_add_u32 m0,s63,4096
s_add_u32 s65,s58,81920
buffer_load_dwordx4 v6,s[4:7],s65 offen lds
s_add_u32 m0,s63,5120
s_add_u32 s65,s58,102400
buffer_load_dwordx4 v6,s[4:7],s65 offen lds
s_add_u32 m0,s63,6144
s_add_u32 s65,s58,122880
buffer_load_dwordx4 v6,s[4:7],s65 offen lds
s_add_u32 m0,s63,7168
s_add_u32 s65,s58,143360
buffer_load_dwordx4 v6,s[4:7],s65 offen lds
s_add_u32 m0,s63,8192
s_add_u32 s65,s58,163840
buffer_load_dwordx4 v6,s[4:7],s65 offen lds
s_add_u32 m0,s63,9216
s_add_u32 s65,s58,184320
buffer_load_dwordx4 v6,s[4:7],s65 offen lds
s_add_u32 m0,s63,10240
s_add_u32 s65,s58,204800
buffer_load_dwordx4 v6,s[4:7],s65 offen lds
s_add_u32 m0,s63,11264
s_add_u32 s65,s58,225280
buffer_load_dwordx4 v6,s[4:7],s65 offen lds
s_add_u32 m0,s63,12288
s_add_u32 s65,s58,245760
buffer_load_dwordx4 v6,s[4:7],s65 offen lds
s_add_u32 m0,s63,13312
s_add_u32 s65,s58,266240
buffer_load_dwordx4 v6,s[4:7],s65 offen lds
s_add_u32 m0,s63,14336
s_add_u32 s65,s58,286720
buffer_load_dwordx4 v6,s[4:7],s65 offen lds
s_add_u32 m0,s63,15360
s_add_u32 s65,s58,307200
buffer_load_dwordx4 v6,s[4:7],s65 offen lds
s_add_u32 m0,s63,16384
s_add_u32 s65,s58,327680
buffer_load_dwordx4 v6,s[4:7],s65 offen lds
s_add_u32 m0,s63,17408
s_add_u32 s65,s58,348160
buffer_load_dwordx4 v6,s[4:7],s65 offen lds
s_add_u32 m0,s63,18432
s_add_u32 s65,s58,368640
buffer_load_dwordx4 v6,s[4:7],s65 offen lds
s_add_u32 m0,s63,19456
s_add_u32 s65,s58,389120
buffer_load_dwordx4 v6,s[4:7],s65 offen lds
s_add_u32 m0,s63,20480
s_add_u32 s65,s58,409600
buffer_load_dwordx4 v6,s[4:7],s65 offen lds
s_add_u32 m0,s63,21504
s_add_u32 s65,s58,430080
buffer_load_dwordx4 v6,s[4:7],s65 offen lds
s_add_u32 m0,s63,22528
s_add_u32 s65,s58,450560
buffer_load_dwordx4 v6,s[4:7],s65 offen lds
s_add_u32 m0,s63,23552
s_add_u32 s65,s58,471040
buffer_load_dwordx4 v6,s[4:7],s65 offen lds
s_add_u32 m0,s63,24576
s_add_u32 s65,s58,491520
buffer_load_dwordx4 v6,s[4:7],s65 offen lds
s_add_u32 m0,s63,25600
s_add_u32 s65,s58,512000
buffer_load_dwordx4 v6,s[4:7],s65 offen lds
s_add_u32 m0,s63,26624
s_add_u32 s65,s58,532480
buffer_load_dwordx4 v6,s[4:7],s65 offen lds
s_add_u32 m0,s63,27648
s_add_u32 s65,s58,552960
buffer_load_dwordx4 v6,s[4:7],s65 offen lds
s_add_u32 m0,s63,28672
s_add_u32 s65,s58,573440
buffer_load_dwordx4 v6,s[4:7],s65 offen lds
s_add_u32 m0,s63,29696
s_add_u32 s65,s58,593920
buffer_load_dwordx4 v6,s[4:7],s65 offen lds
s_add_u32 m0,s63,30720
s_add_u32 s65,s58,614400
buffer_load_dwordx4 v6,s[4:7],s65 offen lds
s_add_u32 m0,s63,31744
s_add_u32 s65,s58,634880
buffer_load_dwordx4 v6,s[4:7],s65 offen lds
s_add_u32 m0,s63,32768
s_add_u32 s65,s58,655360
buffer_load_dwordx4 v6,s[4:7],s65 offen lds
s_add_u32 m0,s63,33792
s_add_u32 s65,s58,675840
buffer_load_dwordx4 v6,s[4:7],s65 offen lds
s_add_u32 m0,s63,34816
s_add_u32 s65,s58,696320
buffer_load_dwordx4 v6,s[4:7],s65 offen lds
s_add_u32 m0,s63,35840
s_add_u32 s65,s58,716800
buffer_load_dwordx4 v6,s[4:7],s65 offen lds
s_add_u32 m0,s63,36864
s_add_u32 s65,s58,737280
buffer_load_dwordx4 v6,s[4:7],s65 offen lds
s_add_u32 m0,s63,37888
s_add_u32 s65,s58,757760
buffer_load_dwordx4 v6,s[4:7],s65 offen lds
s_add_u32 m0,s63,38912
s_add_u32 s65,s58,778240
buffer_load_dwordx4 v6,s[4:7],s65 offen lds
s_add_u32 m0,s63,39936
s_add_u32 s65,s58,798720
buffer_load_dwordx4 v6,s[4:7],s65 offen lds
s_waitcnt vmcnt(20)
v_bfe_u32 v9,v0,2,2
v_lshrrev_b32 v10,5,v0
v_lshl_add_u32 v9,v10,2,v9
v_mul_u32_u24 v9,64,v9
v_and_b32 v10,1,v0
v_lshl_add_u32 v9,v10,3,v9
v_bfe_u32 v10,v0,1,1
v_lshl_add_u32 v9,v10,5,v9
v_bfe_u32 v10,v0,4,1
v_lshl_add_u32 v9,v10,4,v9
v_add_u32 v7,s63,v9
ds_read_b64_tr_b16 a[0:1],v7 offset:0
ds_read_b64_tr_b16 a[2:3],v7 offset:1024
ds_read_b64_tr_b16 a[4:5],v7 offset:512
ds_read_b64_tr_b16 a[6:7],v7 offset:1536
ds_read_b64_tr_b16 a[8:9],v7 offset:2048
ds_read_b64_tr_b16 a[10:11],v7 offset:3072
ds_read_b64_tr_b16 a[12:13],v7 offset:2560
ds_read_b64_tr_b16 a[14:15],v7 offset:3584
ds_read_b64_tr_b16 a[16:17],v7 offset:4096
ds_read_b64_tr_b16 a[18:19],v7 offset:5120
ds_read_b64_tr_b16 a[20:21],v7 offset:4608
ds_read_b64_tr_b16 a[22:23],v7 offset:5632
s_waitcnt lgkmcnt(4)
ds_read_b64_tr_b16 a[24:25],v7 offset:6144
ds_read_b64_tr_b16 a[26:27],v7 offset:7168
ds_read_b64_tr_b16 a[28:29],v7 offset:6656
ds_read_b64_tr_b16 a[30:31],v7 offset:7680
ds_read_b64_tr_b16 a[32:33],v7 offset:8192
ds_read_b64_tr_b16 a[34:35],v7 offset:9216
ds_read_b64_tr_b16 a[36:37],v7 offset:8704
ds_read_b64_tr_b16 a[38:39],v7 offset:9728
ds_read_b64_tr_b16 a[40:41],v7 offset:10240
ds_read_b64_tr_b16 a[42:43],v7 offset:11264
ds_read_b64_tr_b16 a[44:45],v7 offset:10752
ds_read_b64_tr_b16 a[46:47],v7 offset:11776
s_waitcnt lgkmcnt(4)
ds_read_b64_tr_b16 a[48:49],v7 offset:12288
ds_read_b64_tr_b16 a[50:51],v7 offset:13312
ds_read_b64_tr_b16 a[52:53],v7 offset:12800
ds_read_b64_tr_b16 a[54:55],v7 offset:13824
ds_read_b64_tr_b16 a[56:57],v7 offset:14336
ds_read_b64_tr_b16 a[58:59],v7 offset:15360
ds_read_b64_tr_b16 a[60:61],v7 offset:14848
ds_read_b64_tr_b16 a[62:63],v7 offset:15872
ds_read_b64_tr_b16 a[64:65],v7 offset:16384
ds_read_b64_tr_b16 a[66:67],v7 offset:17408
ds_read_b64_tr_b16 a[68:69],v7 offset:16896
ds_read_b64_tr_b16 a[70:71],v7 offset:17920
s_waitcnt lgkmcnt(4)
ds_read_b64_tr_b16 a[72:73],v7 offset:18432
ds_read_b64_tr_b16 a[74:75],v7 offset:19456
ds_read_b64_tr_b16 a[76:77],v7 offset:18944
ds_read_b64_tr_b16 a[78:79],v7 offset:19968
s_waitcnt lgkmcnt(0)
s_add_u32 m0,s63,0
s_add_u32 s65,s58,819200
buffer_load_dwordx4 v6,s[4:7],s65 offen lds
s_add_u32 m0,s63,1024
s_add_u32 s65,s58,839680
buffer_load_dwordx4 v6,s[4:7],s65 offen lds
s_add_u32 m0,s63,2048
s_add_u32 s65,s58,860160
buffer_load_dwordx4 v6,s[4:7],s65 offen lds
s_add_u32 m0,s63,3072
s_add_u32 s65,s58,880640
buffer_load_dwordx4 v6,s[4:7],s65 offen lds
s_add_u32 m0,s63,4096
s_add_u32 s65,s58,901120
buffer_load_dwordx4 v6,s[4:7],s65 offen lds
s_add_u32 m0,s63,5120
s_add_u32 s65,s58,921600
buffer_load_dwordx4 v6,s[4:7],s65 offen lds
s_add_u32 m0,s63,6144
s_add_u32 s65,s58,942080
buffer_load_dwordx4 v6,s[4:7],s65 offen lds
s_add_u32 m0,s63,7168
s_add_u32 s65,s58,962560
buffer_load_dwordx4 v6,s[4:7],s65 offen lds
s_waitcnt vmcnt(8)
v_bfe_u32 v9,v0,2,2
v_lshrrev_b32 v10,5,v0
v_lshl_add_u32 v9,v10,2,v9
v_mul_u32_u24 v9,64,v9
v_and_b32 v10,1,v0
v_lshl_add_u32 v9,v10,3,v9
v_bfe_u32 v10,v0,1,1
v_lshl_add_u32 v9,v10,5,v9
v_bfe_u32 v10,v0,4,1
v_lshl_add_u32 v9,v10,4,v9
v_add_u32 v7,s63,v9
ds_read_b64_tr_b16 a[80:81],v7 offset:20480
ds_read_b64_tr_b16 a[82:83],v7 offset:21504
ds_read_b64_tr_b16 a[84:85],v7 offset:20992
ds_read_b64_tr_b16 a[86:87],v7 offset:22016
ds_read_b64_tr_b16 a[88:89],v7 offset:22528
ds_read_b64_tr_b16 a[90:91],v7 offset:23552
ds_read_b64_tr_b16 a[92:93],v7 offset:23040
ds_read_b64_tr_b16 a[94:95],v7 offset:24064
ds_read_b64_tr_b16 a[96:97],v7 offset:24576
ds_read_b64_tr_b16 a[98:99],v7 offset:25600
ds_read_b64_tr_b16 a[100:101],v7 offset:25088
ds_read_b64_tr_b16 a[102:103],v7 offset:26112
s_waitcnt lgkmcnt(4)
ds_read_b64_tr_b16 a[104:105],v7 offset:26624
ds_read_b64_tr_b16 a[106:107],v7 offset:27648
ds_read_b64_tr_b16 a[108:109],v7 offset:27136
ds_read_b64_tr_b16 a[110:111],v7 offset:28160
ds_read_b64_tr_b16 a[112:113],v7 offset:28672
ds_read_b64_tr_b16 a[114:115],v7 offset:29696
ds_read_b64_tr_b16 a[116:117],v7 offset:29184
ds_read_b64_tr_b16 a[118:119],v7 offset:30208
ds_read_b64_tr_b16 a[120:121],v7 offset:30720
ds_read_b64_tr_b16 a[122:123],v7 offset:31744
ds_read_b64_tr_b16 a[124:125],v7 offset:31232
ds_read_b64_tr_b16 a[126:127],v7 offset:32256
s_waitcnt lgkmcnt(4)
ds_read_b64_tr_b16 a[128:129],v7 offset:32768
ds_read_b64_tr_b16 a[130:131],v7 offset:33792
ds_read_b64_tr_b16 a[132:133],v7 offset:33280
ds_read_b64_tr_b16 a[134:135],v7 offset:34304
ds_read_b64_tr_b16 a[136:137],v7 offset:34816
ds_read_b64_tr_b16 a[138:139],v7 offset:35840
ds_read_b64_tr_b16 a[140:141],v7 offset:35328
ds_read_b64_tr_b16 a[142:143],v7 offset:36352
ds_read_b64_tr_b16 a[144:145],v7 offset:36864
ds_read_b64_tr_b16 a[146:147],v7 offset:37888
ds_read_b64_tr_b16 a[148:149],v7 offset:37376
ds_read_b64_tr_b16 a[150:151],v7 offset:38400
s_waitcnt lgkmcnt(4)
ds_read_b64_tr_b16 a[152:153],v7 offset:38912
ds_read_b64_tr_b16 a[154:155],v7 offset:39936
ds_read_b64_tr_b16 a[156:157],v7 offset:39424
ds_read_b64_tr_b16 a[158:159],v7 offset:40448
s_waitcnt lgkmcnt(0)
s_waitcnt vmcnt(0)
v_bfe_u32 v9,v0,2,2
v_lshrrev_b32 v10,5,v0
v_lshl_add_u32 v9,v10,2,v9
v_mul_u32_u24 v9,64,v9
v_and_b32 v10,1,v0
v_lshl_add_u32 v9,v10,3,v9
v_bfe_u32 v10,v0,1,1
v_lshl_add_u32 v9,v10,5,v9
v_bfe_u32 v10,v0,4,1
v_lshl_add_u32 v9,v10,4,v9
v_add_u32 v7,s63,v9
ds_read_b64_tr_b16 a[160:161],v7 offset:0
ds_read_b64_tr_b16 a[162:163],v7 offset:1024
ds_read_b64_tr_b16 a[164:165],v7 offset:512
ds_read_b64_tr_b16 a[166:167],v7 offset:1536
ds_read_b64_tr_b16 a[168:169],v7 offset:2048
ds_read_b64_tr_b16 a[170:171],v7 offset:3072
ds_read_b64_tr_b16 a[172:173],v7 offset:2560
ds_read_b64_tr_b16 a[174:175],v7 offset:3584
ds_read_b64_tr_b16 a[176:177],v7 offset:4096
ds_read_b64_tr_b16 a[178:179],v7 offset:5120
ds_read_b64_tr_b16 a[180:181],v7 offset:4608
ds_read_b64_tr_b16 a[182:183],v7 offset:5632
s_waitcnt lgkmcnt(4)
ds_read_b64_tr_b16 a[184:185],v7 offset:6144
ds_read_b64_tr_b16 a[186:187],v7 offset:7168
ds_read_b64_tr_b16 a[188:189],v7 offset:6656
ds_read_b64_tr_b16 a[190:191],v7 offset:7680
s_waitcnt lgkmcnt(0)
s_barrier
s_mov_b32 s50,0
s_mov_b32 s32,0
s_mov_b32 s57,0
s_mov_b32 s59,2147483648
s_mov_b32 s82,2147483648
s_mov_b32 s39,2147483648
v_mov_b32 v22,100352
v_lshl_add_u32 v22,v0,2,v22
v_mov_b32 v23,0
ds_write_b32 v22,v23
s_mov_b32 s39,1600000
v_and_b32 v72,15,v0
v_lshlrev_b32 v72,7,v72
s_mov_b64 s[76:77],-1
s_mov_b64 s[80:81],-1
s_waitcnt lgkmcnt(0)
s_barrier
s_mov_b32 s83,s100
s_min_u32 s62,s32,127
s_sub_u32 s60,s62,14
s_lshr_b32 s34,s60,1
s_and_b32 s33,s60,1
s_cmp_eq_u32 s33,0
s_cselect_b32 s61,14,0
s_add_u32 s34,s34,s61
s_sub_u32 s61,s60,50
s_cmp_ge_u32 s60,100
s_cselect_b32 s34,s61,s34
s_cselect_b32 s33,1,s33
s_cmp_lt_u32 s62,14
s_cselect_b32 s34,s62,s34
s_cselect_b32 s33,0,s33
s_lshl_b32 s35,s33,6
s_add_u32 s35,s35,s34
s_lshl_b32 s35,s35,9
s_add_u32 s35,s35,262144
s_sub_u32 s57,49152,s57
v_swap_b32 v16,v18
v_swap_b32 v17,v19
s_add_u32 s62,s32,1
s_min_u32 s62,s62,127
s_sub_u32 s60,s62,14
s_lshr_b32 s41,s60,1
s_and_b32 s40,s60,1
s_cmp_eq_u32 s40,0
s_cselect_b32 s61,14,0
s_add_u32 s41,s41,s61
s_sub_u32 s61,s60,50
s_cmp_ge_u32 s60,100
s_cselect_b32 s41,s61,s41
s_cselect_b32 s40,1,s40
s_cmp_lt_u32 s62,14
s_cselect_b32 s41,s62,s41
s_cselect_b32 s40,0,s40
s_lshl_b32 s42,s40,6
s_add_u32 s42,s42,s41
s_lshl_b32 s42,s42,9
s_add_u32 s42,s42,262144
WO_COLD:
s_mov_b32 s37,0
fb_248:
buffer_load_dword v3,v2,s[8:11],s35 offen sc1
s_waitcnt vmcnt(0)
v_cmp_eq_u32 vcc,0,v3
s_and_b64 vcc,vcc,s[76:77]
s_cbranch_scc0 ok_249
s_sleep 1
s_sub_u32 s47,s47,1
s_cbranch_scc1 ABORT
s_branch fb_248
ok_249:
WO_COLD2:
buffer_load_dword v3,v2,s[8:11],s42 offen sc1
s_sub_u32 s66,49152,s57
s_and_b32 s60,s34,3
s_lshl2_add_u32 s60,s33,s60
s_mul_i32 s60,s60,393216
s_add_u32 s60,s60,s37
s_mul_i32 s61,s68,49152
s_add_u32 s60,s60,s61
s_mul_i32 s61,s46,12288
s_add_u32 s60,s60,s61
s_add_u32 s60,s60,149946368
s_add_u32 s61,s61,s66
s_add_u32 m0,s61,0
s_add_u32 s63,s60,0
buffer_load_dwordx4 v1,s[8:11],s63 offen sc1 lds
buffer_load_dwordx4 v1,s[8:11],s63 offen offset:1024 sc1 lds
buffer_load_dwordx4 v1,s[8:11],s63 offen offset:2048 sc1 lds
buffer_load_dwordx4 v1,s[8:11],s63 offen offset:3072 sc1 lds
s_add_u32 m0,s61,4096
s_add_u32 s63,s60,4096
buffer_load_dwordx4 v1,s[8:11],s63 offen sc1 lds
buffer_load_dwordx4 v1,s[8:11],s63 offen offset:1024 sc1 lds
buffer_load_dwordx4 v1,s[8:11],s63 offen offset:2048 sc1 lds
buffer_load_dwordx4 v1,s[8:11],s63 offen offset:3072 sc1 lds
s_waitcnt vmcnt(7)
s_mov_b64 exec,1
buffer_store_dword v5,v1,s[8:11],s59 offen sc1
s_mov_b64 exec,-1
s_mov_b32 s59,2147483648
s_add_u32 m0,s61,8192
s_add_u32 s63,s60,8192
buffer_load_dwordx4 v1,s[8:11],s63 offen sc1 lds
buffer_load_dwordx4 v1,s[8:11],s63 offen offset:1024 sc1 lds
buffer_load_dwordx4 v1,s[8:11],s63 offen offset:2048 sc1 lds
buffer_load_dwordx4 v1,s[8:11],s63 offen offset:3072 sc1 lds
s_mov_b32 s35,s42
s_mov_b32 s53,s33
s_mov_b32 s54,s34
s_add_u32 s32,s32,1
s_mov_b32 s33,s40
s_mov_b32 s34,s41
s_mov_b64 s[76:77],s[80:81]
s_sub_u32 s57,49152,s57
v_swap_b32 v16,v18
v_swap_b32 v17,v19
s_mov_b32 s51,s53
s_mov_b32 s52,s54
s_waitcnt vmcnt(5)
v_cmp_eq_u32 vcc,0,v3
s_and_b64 vcc,vcc,s[76:77]
s_cselect_b32 s37,2147483648,0
s_cmp_lt_u32 s32,128
s_cselect_b32 s37,s37,2147483648
s_branch WO_GO
WO_NEXT:
s_sub_u32 s57,49152,s57
v_swap_b32 v16,v18
v_swap_b32 v17,v19
s_mov_b32 s51,s53
s_mov_b32 s52,s54
s_waitcnt vmcnt(2)
v_cmp_eq_u32 vcc,0,v3
s_and_b64 vcc,vcc,s[76:77]
s_cselect_b32 s37,2147483648,0
s_cmp_lt_u32 s32,128
s_cselect_b32 s37,s37,2147483648
WO_GO:
s_barrier
ds_read_b128 v[24:27],v16 offset:0
ds_read_b128 v[28:31],v17 offset:0
ds_read_b128 v[32:35],v16 offset:12288
ds_read_b128 v[36:39],v17 offset:12288
ds_read_b128 v[40:43],v16 offset:24576
ds_read_b128 v[44:47],v17 offset:24576
ds_read_b128 v[48:51],v16 offset:36864
s_waitcnt lgkmcnt(6)
v_mfma_f32_32x32x16_bf16 v[56:71],a[0:3],v[24:27],0
ds_read_b128 v[52:55],v17 offset:36864
s_sub_u32 s66,49152,s57
s_and_b32 s60,s34,3
s_lshl2_add_u32 s60,s33,s60
s_waitcnt lgkmcnt(6)
v_mfma_f32_32x32x16_bf16 v[56:71],a[4:7],v[28:31],v[56:71]
ds_read_b128 v[24:27],v16 offset:2048
s_mul_i32 s60,s60,393216
s_add_u32 s60,s60,s37
s_mul_i32 s61,s68,49152
s_waitcnt lgkmcnt(5)
v_mfma_f32_32x32x16_bf16 v[56:71],a[48:51],v[32:35],v[56:71]
ds_read_b128 v[28:31],v17 offset:2048
s_add_u32 s60,s60,s61
s_mul_i32 s61,s46,12288
s_add_u32 s60,s60,s61
s_add_u32 s60,s60,149946368
v_mfma_f32_32x32x16_bf16 v[56:71],a[52:55],v[36:39],v[56:71]
ds_read_b128 v[32:35],v16 offset:14336
s_add_u32 s61,s61,s66
s_add_u32 m0,s61,0
s_add_u32 s63,s60,0
s_waitcnt lgkmcnt(5)
v_mfma_f32_32x32x16_bf16 v[56:71],a[96:99],v[40:43],v[56:71]
ds_read_b128 v[36:39],v17 offset:14336
buffer_load_dwordx4 v1,s[8:11],s63 offen sc1 lds
s_mul_i32 s71,s52,491520
s_add_u32 s71,s71,s69
v_mfma_f32_32x32x16_bf16 v[56:71],a[100:103],v[44:47],v[56:71]
ds_read_b128 v[40:43],v16 offset:26624
s_lshl_b32 s70,s51,6
s_add_u32 s70,s70,s52
s_mul_i32 s70,s70,640
s_waitcnt lgkmcnt(5)
v_mfma_f32_32x32x16_bf16 v[56:71],a[144:147],v[48:51],v[56:71]
ds_read_b128 v[44:47],v17 offset:26624
buffer_load_dwordx4 v1,s[8:11],s63 offen offset:1024 sc1 lds
s_add_u32 s82,s70,s75
v_mfma_f32_32x32x16_bf16 v[56:71],a[148:151],v[52:55],v[56:71]
ds_read_b128 v[48:51],v16 offset:38912
s_waitcnt lgkmcnt(5)
v_mfma_f32_32x32x16_bf16 v[56:71],a[8:11],v[24:27],v[56:71]
ds_read_b128 v[52:55],v17 offset:38912
buffer_load_dwordx4 v1,s[8:11],s63 offen offset:2048 sc1 lds
v_mfma_f32_32x32x16_bf16 v[56:71],a[12:15],v[28:31],v[56:71]
ds_read_b128 v[24:27],v16 offset:4096
s_waitcnt lgkmcnt(5)
v_mfma_f32_32x32x16_bf16 v[56:71],a[56:59],v[32:35],v[56:71]
ds_read_b128 v[28:31],v17 offset:4096
buffer_load_dwordx4 v1,s[8:11],s63 offen offset:3072 sc1 lds
s_add_u32 m0,s61,4096
s_add_u32 s63,s60,4096
v_mfma_f32_32x32x16_bf16 v[56:71],a[60:63],v[36:39],v[56:71]
ds_read_b128 v[32:35],v16 offset:16384
s_waitcnt lgkmcnt(5)
v_mfma_f32_32x32x16_bf16 v[56:71],a[104:107],v[40:43],v[56:71]
ds_read_b128 v[36:39],v17 offset:16384
buffer_load_dwordx4 v1,s[8:11],s63 offen sc1 lds
v_mfma_f32_32x32x16_bf16 v[56:71],a[108:111],v[44:47],v[56:71]
ds_read_b128 v[40:43],v16 offset:28672
s_waitcnt lgkmcnt(5)
v_mfma_f32_32x32x16_bf16 v[56:71],a[152:155],v[48:51],v[56:71]
ds_read_b128 v[44:47],v17 offset:28672
buffer_load_dwordx4 v1,s[8:11],s63 offen offset:1024 sc1 lds
v_mfma_f32_32x32x16_bf16 v[56:71],a[156:159],v[52:55],v[56:71]
ds_read_b128 v[48:51],v16 offset:40960
s_waitcnt lgkmcnt(5)
v_mfma_f32_32x32x16_bf16 v[56:71],a[16:19],v[24:27],v[56:71]
ds_read_b128 v[52:55],v17 offset:40960
buffer_load_dwordx4 v1,s[8:11],s63 offen offset:2048 sc1 lds
v_mfma_f32_32x32x16_bf16 v[56:71],a[20:23],v[28:31],v[56:71]
ds_read_b128 v[24:27],v16 offset:6144
s_waitcnt lgkmcnt(5)
v_mfma_f32_32x32x16_bf16 v[56:71],a[64:67],v[32:35],v[56:71]
ds_read_b128 v[28:31],v17 offset:6144
buffer_load_dwordx4 v1,s[8:11],s63 offen offset:3072 sc1 lds
s_add_u32 m0,s61,8192
s_add_u32 s63,s60,8192
v_mfma_f32_32x32x16_bf16 v[56:71],a[68:71],v[36:39],v[56:71]
ds_read_b128 v[32:35],v16 offset:18432
s_waitcnt lgkmcnt(5)
v_mfma_f32_32x32x16_bf16 v[56:71],a[112:115],v[40:43],v[56:71]
ds_read_b128 v[36:39],v17 offset:18432
buffer_load_dwordx4 v1,s[8:11],s63 offen sc1 lds
v_mfma_f32_32x32x16_bf16 v[56:71],a[116:119],v[44:47],v[56:71]
ds_read_b128 v[40:43],v16 offset:30720
s_waitcnt lgkmcnt(5)
v_mfma_f32_32x32x16_bf16 v[56:71],a[160:163],v[48:51],v[56:71]
ds_read_b128 v[44:47],v17 offset:30720
buffer_load_dwordx4 v1,s[8:11],s63 offen offset:1024 sc1 lds
v_mfma_f32_32x32x16_bf16 v[56:71],a[164:167],v[52:55],v[56:71]
ds_read_b128 v[48:51],v16 offset:43008
s_waitcnt lgkmcnt(5)
v_mfma_f32_32x32x16_bf16 v[56:71],a[24:27],v[24:27],v[56:71]
ds_read_b128 v[52:55],v17 offset:43008
s_waitcnt vmcnt(10)
s_mov_b64 exec,1
buffer_store_dword v5,v1,s[8:11],s59 offen sc1
s_mov_b64 exec,-1
s_mov_b32 s59,2147483648
s_barrier
v_mfma_f32_32x32x16_bf16 v[56:71],a[28:31],v[28:31],v[56:71]
ds_read_b128 v[24:27],v16 offset:8192
buffer_load_dwordx4 v1,s[8:11],s63 offen offset:2048 sc1 lds
s_waitcnt lgkmcnt(5)
v_mfma_f32_32x32x16_bf16 v[56:71],a[72:75],v[32:35],v[56:71]
ds_read_b128 v[28:31],v17 offset:8192
v_mfma_f32_32x32x16_bf16 v[56:71],a[76:79],v[36:39],v[56:71]
ds_read_b128 v[32:35],v16 offset:20480
s_lshl_b32 s64,s51,10
s_add_u32 s64,s64,s74
s_add_u32 s65,s52,1
v_mov_b32 v73,s65
s_mov_b64 exec,1
s_cmp_lg_u32 s49,0
s_cbranch_scc0 ls_250
buffer_store_dword v73,v1,s[8:11],s64 offen sc1
s_branch ls_251
ls_250:
buffer_store_dword v73,v1,s[8:11],s64 offen
ls_251:
s_mov_b64 exec,-1
s_waitcnt lgkmcnt(5)
v_mfma_f32_32x32x16_bf16 v[56:71],a[120:123],v[40:43],v[56:71]
ds_read_b128 v[36:39],v17 offset:20480
buffer_load_dwordx4 v1,s[8:11],s63 offen offset:3072 sc1 lds
s_add_u32 s62,s32,1
s_min_u32 s62,s62,127
v_mfma_f32_32x32x16_bf16 v[56:71],a[124:127],v[44:47],v[56:71]
ds_read_b128 v[40:43],v16 offset:32768
s_sub_u32 s60,s62,14
s_lshr_b32 s41,s60,1
s_and_b32 s40,s60,1
s_waitcnt lgkmcnt(5)
v_mfma_f32_32x32x16_bf16 v[56:71],a[168:171],v[48:51],v[56:71]
ds_read_b128 v[44:47],v17 offset:32768
s_cmp_eq_u32 s40,0
s_cselect_b32 s61,14,0
s_add_u32 s41,s41,s61
s_sub_u32 s61,s60,50
v_mfma_f32_32x32x16_bf16 v[56:71],a[172:175],v[52:55],v[56:71]
ds_read_b128 v[48:51],v16 offset:45056
s_cmp_ge_u32 s60,100
s_cselect_b32 s41,s61,s41
s_cselect_b32 s40,1,s40
s_waitcnt lgkmcnt(5)
v_mfma_f32_32x32x16_bf16 v[56:71],a[32:35],v[24:27],v[56:71]
ds_read_b128 v[52:55],v17 offset:45056
s_cmp_lt_u32 s62,14
s_cselect_b32 s41,s62,s41
s_cselect_b32 s40,0,s40
s_lshl_b32 s42,s40,6
v_mfma_f32_32x32x16_bf16 v[56:71],a[36:39],v[28:31],v[56:71]
ds_read_b128 v[24:27],v16 offset:10240
s_add_u32 s42,s42,s41
s_lshl_b32 s42,s42,9
s_add_u32 s42,s42,262144
s_waitcnt lgkmcnt(5)
v_mfma_f32_32x32x16_bf16 v[56:71],a[80:83],v[32:35],v[56:71]
ds_read_b128 v[28:31],v17 offset:10240
v_mfma_f32_32x32x16_bf16 v[56:71],a[84:87],v[36:39],v[56:71]
ds_read_b128 v[32:35],v16 offset:22528
s_waitcnt lgkmcnt(5)
v_mfma_f32_32x32x16_bf16 v[56:71],a[128:131],v[40:43],v[56:71]
ds_read_b128 v[36:39],v17 offset:22528
buffer_load_dword v3,v2,s[8:11],s35 offen sc1
v_mfma_f32_32x32x16_bf16 v[56:71],a[132:135],v[44:47],v[56:71]
ds_read_b128 v[40:43],v16 offset:34816
s_waitcnt lgkmcnt(5)
v_mfma_f32_32x32x16_bf16 v[56:71],a[176:179],v[48:51],v[56:71]
ds_read_b128 v[44:47],v17 offset:34816
v_mfma_f32_32x32x16_bf16 v[56:71],a[180:183],v[52:55],v[56:71]
ds_read_b128 v[48:51],v16 offset:47104
s_waitcnt lgkmcnt(5)
v_mfma_f32_32x32x16_bf16 v[56:71],a[40:43],v[24:27],v[56:71]
ds_read_b128 v[52:55],v17 offset:47104
v_mfma_f32_32x32x16_bf16 v[56:71],a[44:47],v[28:31],v[56:71]
s_waitcnt lgkmcnt(4)
v_mfma_f32_32x32x16_bf16 v[56:71],a[88:91],v[32:35],v[56:71]
v_mfma_f32_32x32x16_bf16 v[56:71],a[92:95],v[36:39],v[56:71]
s_waitcnt lgkmcnt(2)
v_mfma_f32_32x32x16_bf16 v[56:71],a[136:139],v[40:43],v[56:71]
v_mfma_f32_32x32x16_bf16 v[56:71],a[140:143],v[44:47],v[56:71]
s_waitcnt lgkmcnt(0)
v_mfma_f32_32x32x16_bf16 v[56:71],a[184:187],v[48:51],v[56:71]
v_mfma_f32_32x32x16_bf16 v[56:71],a[188:191],v[52:55],v[56:71]
s_cmp_eq_u32 s37,0
s_cbranch_scc0 sec_254
s_mov_b32 s35,s42
buffer_load_dword v3,v2,s[8:11],s35 offen sc1
s_mov_b32 s53,s33
s_mov_b32 s54,s34
s_add_u32 s32,s32,1
s_mov_b32 s33,s40
s_mov_b32 s34,s41
s_mov_b64 s[76:77],s[80:81]
s_nop 2
ep_252:
v_cvt_pk_bf16_f32 v112,v56,v57
v_cvt_pk_bf16_f32 v113,v58,v59
v_cvt_pk_bf16_f32 v114,v60,v61
v_cvt_pk_bf16_f32 v115,v62,v63
v_cvt_pk_bf16_f32 v116,v64,v65
v_cvt_pk_bf16_f32 v117,v66,v67
v_cvt_pk_bf16_f32 v118,v68,v69
v_cvt_pk_bf16_f32 v119,v70,v71
buffer_store_dwordx4 v[112:115],v20,s[8:11],s71 offen sc1
buffer_store_dwordx4 v[116:119],v20,s[8:11],s71 offen offset:128 sc1
s_mov_b32 s59,s82
s_cmp_eq_u32 s37,0
s_cbranch_scc1 WO_NEXT
s_waitcnt vmcnt(2)
v_cmp_eq_u32 vcc,0,v3
s_and_b64 vcc,vcc,s[76:77]
s_cselect_b32 s37,2147483648,0
s_cmp_lt_u32 s32,128
s_cselect_b32 s37,s37,2147483648
s_cmp_eq_u32 s37,0
s_cbranch_scc1 WO_COLD2
s_waitcnt vmcnt(0)
s_mov_b64 exec,1
buffer_store_dword v5,v1,s[8:11],s59 offen sc1
s_mov_b64 exec,-1
s_mov_b32 s59,2147483648
s_cmp_lt_u32 s32,128
s_cbranch_scc1 WO_COLD
s_branch WO_END
sec_254:
s_waitcnt vmcnt(0)
v_cmp_eq_u32 vcc,0,v3
s_and_b64 vcc,vcc,s[76:77]
s_cselect_b32 s37,2147483648,0
s_cmp_lt_u32 s32,128
s_cselect_b32 s37,s37,2147483648
s_cmp_lg_u32 s37,0
s_cbranch_scc1 nr_253
s_sub_u32 s66,49152,s57
s_and_b32 s60,s34,3
s_lshl2_add_u32 s60,s33,s60
s_mul_i32 s60,s60,393216
s_add_u32 s60,s60,s37
s_mul_i32 s61,s68,49152
s_add_u32 s60,s60,s61
s_mul_i32 s61,s46,12288
s_add_u32 s60,s60,s61
s_add_u32 s60,s60,149946368
s_add_u32 s61,s61,s66
s_add_u32 m0,s61,0
s_add_u32 s63,s60,0
buffer_load_dwordx4 v1,s[8:11],s63 offen sc1 lds
v_cvt_pk_bf16_f32 v112,v56,v57
buffer_load_dwordx4 v1,s[8:11],s63 offen offset:1024 sc1 lds
v_cvt_pk_bf16_f32 v113,v58,v59
buffer_load_dwordx4 v1,s[8:11],s63 offen offset:2048 sc1 lds
v_cvt_pk_bf16_f32 v114,v60,v61
buffer_load_dwordx4 v1,s[8:11],s63 offen offset:3072 sc1 lds
v_cvt_pk_bf16_f32 v115,v62,v63
s_add_u32 m0,s61,4096
s_add_u32 s63,s60,4096
buffer_load_dwordx4 v1,s[8:11],s63 offen sc1 lds
v_cvt_pk_bf16_f32 v116,v64,v65
buffer_load_dwordx4 v1,s[8:11],s63 offen offset:1024 sc1 lds
v_cvt_pk_bf16_f32 v117,v66,v67
buffer_load_dwordx4 v1,s[8:11],s63 offen offset:2048 sc1 lds
v_cvt_pk_bf16_f32 v118,v68,v69
buffer_load_dwordx4 v1,s[8:11],s63 offen offset:3072 sc1 lds
v_cvt_pk_bf16_f32 v119,v70,v71
s_add_u32 m0,s61,8192
s_add_u32 s63,s60,8192
buffer_load_dwordx4 v1,s[8:11],s63 offen sc1 lds
buffer_load_dwordx4 v1,s[8:11],s63 offen offset:1024 sc1 lds
buffer_load_dwordx4 v1,s[8:11],s63 offen offset:2048 sc1 lds
buffer_load_dwordx4 v1,s[8:11],s63 offen offset:3072 sc1 lds
s_mov_b32 s35,s42
buffer_load_dword v3,v2,s[8:11],s35 offen sc1
s_mov_b32 s53,s33
s_mov_b32 s54,s34
s_add_u32 s32,s32,1
s_mov_b32 s33,s40
s_mov_b32 s34,s41
s_mov_b64 s[76:77],s[80:81]
buffer_store_dwordx4 v[112:115],v20,s[8:11],s71 offen sc1
buffer_store_dwordx4 v[116:119],v20,s[8:11],s71 offen offset:128 sc1
s_mov_b32 s59,s82
s_branch WO_NEXT
nr_253:
buffer_load_dword v3,v2,s[8:11],s35 offen sc1
s_branch ep_252
WO_END:
s_endpgm
ROLE_R1:
s_lshr_b32 s68,s48,3
s_and_b32 s48,s48,7
v_lshlrev_b32 v1,4,v0
v_mov_b32 v5,1
s_lshl_b32 s56,s48,2
s_add_u32 s56,s56,s46
v_bfe_u32 v6,v0,2,2
v_lshrrev_b32 v7,4,v0
v_add_u32 v7,v6,v7
v_and_b32 v7,3,v7
v_and_b32 v15,3,v0
v_lshlrev_b32 v15,4,v15
v_lshl_add_u32 v15,v7,6,v15
v_lshl_add_u32 v15,v6,8,v15
v_lshrrev_b32 v6,4,v0
v_bfe_u32 v7,v0,2,2
v_and_b32 v8,3,v0
v_add_u32 v9,s48,v7
v_and_b32 v9,3,v9
v_lshlrev_b32 v17,6,v9
v_lshl_add_u32 v17,v8,4,v17
s_lshl_b32 s60,s48,8
s_lshl_b32 s61,s46,13
s_add_u32 s61,s61,s60
v_lshl_add_u32 v16,v6,11,v17
v_add_u32 v16,s61,v16
s_lshl_b32 s61,s46,11
s_add_u32 s61,s61,s60
s_add_u32 s61,s61,32768
v_add_u32 v17,s61,v17
v_lshl_add_u32 v18,v6,2,v17
v_mul_u32_u24 v19,40960,v6
v_and_b32 v9,0xff,v1
v_add_u32 v19,v19,v9
s_mul_i32 s60,s46,768
s_sub_u32 s60,4096,s60
v_add_u32 v19,s60,v19
s_mul_i32 s69,s48,5120
s_lshl_b32 s60,s46,10
s_add_u32 s69,s69,s60
s_add_u32 s69,s69,175112192
s_cmp_eq_u32 s68,0
s_mov_b32 s70,209518592
s_cselect_b32 s70,234749952,s70
s_mov_b32 s71,46080
s_cselect_b32 s71,40960,s71
s_mov_b32 s72,0x3f80
s_mov_b32 s73,0x3f800000
v_lshlrev_b32 v21,5,v8
s_lshl_b32 s60,s46,3
v_add_u32 v20,s60,v21
v_min_u32 v2,39,v0
v_lshlrev_b32 v2,4,v2
s_waitcnt vmcnt(0)
s_barrier
s_cmp_lg_u32 s46,0
s_cbranch_scc1 arr_255
v_mov_b32 v6,1
s_lshl_b32 s3,s49,2
v_mov_b32 v7,s3
s_mov_b64 exec,1
buffer_atomic_add v6,v7,s[12:15],0 offen sc1
s_mov_b64 exec,-1
arr_255:
s_cmp_lg_u32 s49,0
s_cbranch_scc1 vr_256
s_lshl_b32 s60,s68,5
s_add_u32 s60,s60,s56
s_cmp_ge_u32 s60,32
s_cbranch_scc1 vr_256
s_mov_b64 exec,1
s_and_b32 s61,s60,7
s_lshl_b32 s61,s61,14
s_lshl_b32 s60,s60,7
s_add_u32 s60,s60,s61
s_add_u32 s60,s60,11796480
s_add_u32 s61,s60,0x2000
s_mov_b32 s62,-1
s_mov_b32 s63,-1
s_mov_b32 s50,6
vr_256l:
buffer_store_dword v5,v1,s[8:11],s60 offen sc1
buffer_store_dword v5,v1,s[8:11],s61 offen sc1
s_waitcnt vmcnt(0)
s_memtime s[64:65]
s_waitcnt lgkmcnt(0)
buffer_load_dword v3,v1,s[8:11],s60 offen sc1
s_waitcnt vmcnt(0)
s_memtime s[66:67]
s_waitcnt lgkmcnt(0)
s_sub_u32 s66,s66,s64
s_min_u32 s62,s62,s66
s_memtime s[64:65]
s_waitcnt lgkmcnt(0)
buffer_load_dword v3,v1,s[8:11],s61 offen sc1
s_waitcnt vmcnt(0)
s_memtime s[66:67]
s_waitcnt lgkmcnt(0)
s_sub_u32 s66,s66,s64
s_min_u32 s63,s63,s66
s_sub_u32 s50,s50,1
s_cmp_lg_u32 s50,0
s_cbranch_scc1 vr_256l
s_cmp_lt_u32 s63,s62
s_cselect_b32 s60,0x10001,1
v_mov_b32 v3,s60
v_mov_b32 v6,192
buffer_atomic_add v3,v6,s[12:15],0 offen sc1
s_mov_b64 exec,-1
vr_256:
s_lshl_b32 s3,s49,2
v_mov_b32 v7,s3
s_nop 1
ibw_257:
buffer_load_dword v6,v7,s[12:15],0 offen sc1
s_waitcnt vmcnt(0)
v_cmp_ne_u32 vcc,256,v6
s_nop 0
s_cbranch_vccz ok_258
s_sleep 8
s_sub_u32 s47,s47,1
s_cbranch_scc1 ABORT
s_branch ibw_257
ok_258:
s_cmp_lg_u32 s49,0
s_cbranch_scc1 ibok_259
v_and_b32 v7,7,v0
v_lshlrev_b32 v7,2,v7
buffer_load_dword v6,v7,s[12:15],0 offen offset:32 sc1
s_waitcnt vmcnt(0)
v_cmp_ne_u32 vcc,32,v6
s_nop 0
s_cbranch_vccz ibok_259
s_barrier
s_mov_b32 s49,1
s_mov_b32 s3,s2
s_load_dwordx16 s[16:31],s[0:1],0
s_load_dwordx8 s[32:39],s[0:1],64
s_waitcnt lgkmcnt(0)
s_branch DISPATCH
ibok_259:
s_mov_b32 s83,s100
s_mov_b32 s51,s68
s_mov_b32 s52,0
s_mul_i32 s35,s68,40960
s_add_u32 s35,s35,819200
R1_LOOP:
s_mul_i32 s66,s52,491520
s_add_u32 s66,s66,s69
s_mul_i32 s65,s52,s71
s_add_u32 s65,s65,s70
s_lshl_b32 s60,s51,6
s_add_u32 s60,s60,s52
s_mul_i32 s74,s60,40960
s_add_u32 s74,s74,218365952
s_mul_i32 s75,s60,46080
s_add_u32 s75,s75,223608832
s_lshl_b32 s82,s51,6
s_add_u32 s82,s82,s52
s_lshl_b32 s82,s82,9
s_add_u32 s82,s82,393216
s_lshl_b32 s61,s56,2
s_add_u32 s82,s82,s61
s_cmp_lg_u32 s46,0
s_cbranch_scc1 rp_260
rt_261:
buffer_load_dwordx4 v[24:27],v2,s[8:11],s35 offen sc1
s_waitcnt vmcnt(0)
v_min3_u32 v24,v24,v25,v26
v_min_u32 v24,v24,v27
v_cmp_eq_u32 vcc,0,v24
s_nop 0
s_cbranch_vccz ok_262
s_sleep 3
s_sub_u32 s47,s47,1
s_cbranch_scc1 ABORT
s_branch rt_261
ok_262:
rp_260:
s_barrier
s_add_u32 s63,s66,0
buffer_load_dwordx4 v[68:71],v19,s[8:11],s63 offen sc1
s_add_u32 s63,s66,163840
buffer_load_dwordx4 v[72:75],v19,s[8:11],s63 offen sc1
buffer_load_dwordx4 v[76:79],v16,s[8:11],s65 offen sc1
buffer_load_dword v80,v18,s[8:11],s65 offen sc1
s_add_u32 s63,s66,0
buffer_load_dwordx4 v[36:39],v1,s[8:11],s63 offen sc1
s_add_u32 s63,s66,40960
buffer_load_dwordx4 v[40:43],v1,s[8:11],s63 offen sc1
s_add_u32 s63,s66,81920
buffer_load_dwordx4 v[44:47],v1,s[8:11],s63 offen sc1
s_add_u32 s63,s66,122880
buffer_load_dwordx4 v[48:51],v1,s[8:11],s63 offen sc1
s_add_u32 s63,s66,163840
buffer_load_dwordx4 v[52:55],v1,s[8:11],s63 offen sc1
s_add_u32 s63,s66,204800
buffer_load_dwordx4 v[56:59],v1,s[8:11],s63 offen sc1
s_add_u32 s63,s66,245760
buffer_load_dwordx4 v[60:63],v1,s[8:11],s63 offen sc1
s_add_u32 s63,s66,286720
buffer_load_dwordx4 v[64:67],v1,s[8:11],s63 offen sc1
s_waitcnt vmcnt(11)
v_lshlrev_b32 v92,16,v68
v_and_b32 v93,0xffff0000,v68
v_lshlrev_b32 v94,16,v69
v_and_b32 v95,0xffff0000,v69
v_lshlrev_b32 v96,16,v70
v_and_b32 v97,0xffff0000,v70
v_lshlrev_b32 v98,16,v71
v_and_b32 v99,0xffff0000,v71
s_waitcnt vmcnt(10)
v_dot2c_f32_bf16 v92,s72,v72
v_dot2c_f32_bf16 v93,s73,v72
v_dot2c_f32_bf16 v94,s72,v73
v_dot2c_f32_bf16 v95,s73,v73
v_dot2c_f32_bf16 v96,s72,v74
v_dot2c_f32_bf16 v97,s73,v74
v_dot2c_f32_bf16 v98,s72,v75
v_dot2c_f32_bf16 v99,s73,v75
v_permlane32_swap_b32 v92,v96
v_permlane32_swap_b32 v93,v97
v_permlane32_swap_b32 v94,v98
v_permlane32_swap_b32 v95,v99
v_add_f32 v92,v92,v96
v_add_f32 v93,v93,v97
v_add_f32 v94,v94,v98
v_add_f32 v95,v95,v99
s_nop 0
v_permlane16_swap_b32 v92,v94
v_permlane16_swap_b32 v93,v95
v_add_f32 v90,v92,v94
v_add_f32 v91,v93,v95
s_waitcnt vmcnt(8)
v_lshlrev_b32 v100,16,v76
v_and_b32 v101,0xffff0000,v76
v_lshlrev_b32 v102,16,v77
v_and_b32 v103,0xffff0000,v77
v_lshlrev_b32 v104,16,v78
v_and_b32 v105,0xffff0000,v78
v_lshlrev_b32 v106,16,v79
v_and_b32 v107,0xffff0000,v79
v_lshlrev_b32 v108,16,v80
v_and_b32 v109,0xffff0000,v80
s_waitcnt vmcnt(7)
v_lshlrev_b32 v82,16,v36
v_and_b32 v83,0xffff0000,v36
v_lshlrev_b32 v84,16,v37
v_and_b32 v85,0xffff0000,v37
v_lshlrev_b32 v86,16,v38
v_and_b32 v87,0xffff0000,v38
v_lshlrev_b32 v88,16,v39
v_and_b32 v89,0xffff0000,v39
s_waitcnt vmcnt(6)
v_dot2c_f32_bf16 v82,s72,v40
v_dot2c_f32_bf16 v83,s73,v40
v_dot2c_f32_bf16 v84,s72,v41
v_dot2c_f32_bf16 v85,s73,v41
v_dot2c_f32_bf16 v86,s72,v42
v_dot2c_f32_bf16 v87,s73,v42
v_dot2c_f32_bf16 v88,s72,v43
v_dot2c_f32_bf16 v89,s73,v43
s_waitcnt vmcnt(5)
v_dot2c_f32_bf16 v82,s72,v44
v_dot2c_f32_bf16 v83,s73,v44
v_dot2c_f32_bf16 v84,s72,v45
v_dot2c_f32_bf16 v85,s73,v45
v_dot2c_f32_bf16 v86,s72,v46
v_dot2c_f32_bf16 v87,s73,v46
v_dot2c_f32_bf16 v88,s72,v47
v_dot2c_f32_bf16 v89,s73,v47
s_waitcnt vmcnt(4)
v_dot2c_f32_bf16 v82,s72,v48
v_dot2c_f32_bf16 v83,s73,v48
v_dot2c_f32_bf16 v84,s72,v49
v_dot2c_f32_bf16 v85,s73,v49
v_dot2c_f32_bf16 v86,s72,v50
v_dot2c_f32_bf16 v87,s73,v50
v_dot2c_f32_bf16 v88,s72,v51
v_dot2c_f32_bf16 v89,s73,v51
s_waitcnt vmcnt(3)
v_dot2c_f32_bf16 v82,s72,v52
v_dot2c_f32_bf16 v83,s73,v52
v_dot2c_f32_bf16 v84,s72,v53
v_dot2c_f32_bf16 v85,s73,v53
v_dot2c_f32_bf16 v86,s72,v54
v_dot2c_f32_bf16 v87,s73,v54
v_dot2c_f32_bf16 v88,s72,v55
v_dot2c_f32_bf16 v89,s73,v55
s_waitcnt vmcnt(2)
v_dot2c_f32_bf16 v82,s72,v56
v_dot2c_f32_bf16 v83,s73,v56
v_dot2c_f32_bf16 v84,s72,v57
v_dot2c_f32_bf16 v85,s73,v57
v_dot2c_f32_bf16 v86,s72,v58
v_dot2c_f32_bf16 v87,s73,v58
v_dot2c_f32_bf16 v88,s72,v59
v_dot2c_f32_bf16 v89,s73,v59
s_waitcnt vmcnt(1)
v_dot2c_f32_bf16 v82,s72,v60
v_dot2c_f32_bf16 v83,s73,v60
v_dot2c_f32_bf16 v84,s72,v61
v_dot2c_f32_bf16 v85,s73,v61
v_dot2c_f32_bf16 v86,s72,v62
v_dot2c_f32_bf16 v87,s73,v62
v_dot2c_f32_bf16 v88,s72,v63
v_dot2c_f32_bf16 v89,s73,v63
s_waitcnt vmcnt(0)
v_dot2c_f32_bf16 v82,s72,v64
v_dot2c_f32_bf16 v83,s73,v64
v_dot2c_f32_bf16 v84,s72,v65
v_dot2c_f32_bf16 v85,s73,v65
v_dot2c_f32_bf16 v86,s72,v66
v_dot2c_f32_bf16 v87,s73,v66
v_dot2c_f32_bf16 v88,s72,v67
v_dot2c_f32_bf16 v89,s73,v67
v_cvt_pk_bf16_f32 v6,v82,v83
v_lshlrev_b32 v82,16,v6
v_and_b32 v83,0xffff0000,v6
v_cvt_pk_bf16_f32 v8,v84,v85
v_lshlrev_b32 v84,16,v8
v_and_b32 v85,0xffff0000,v8
v_cvt_pk_bf16_f32 v6,v86,v87
v_lshlrev_b32 v86,16,v6
v_and_b32 v87,0xffff0000,v6
v_cvt_pk_bf16_f32 v8,v88,v89
v_lshlrev_b32 v88,16,v8
v_and_b32 v89,0xffff0000,v8
v_cvt_pk_bf16_f32 v6,v90,v91
v_lshlrev_b32 v90,16,v6
v_and_b32 v91,0xffff0000,v6
v_pk_add_f32 v[82:83],v[82:83],v[100:101]
v_pk_add_f32 v[84:85],v[84:85],v[102:103]
v_pk_add_f32 v[86:87],v[86:87],v[104:105]
v_pk_add_f32 v[88:89],v[88:89],v[106:107]
v_pk_add_f32 v[90:91],v[90:91],v[108:109]
v_cvt_pk_bf16_f32 v112,v82,v83
v_lshlrev_b32 v82,16,v112
v_and_b32 v83,0xffff0000,v112
v_cvt_pk_bf16_f32 v113,v84,v85
v_lshlrev_b32 v84,16,v113
v_and_b32 v85,0xffff0000,v113
v_cvt_pk_bf16_f32 v114,v86,v87
v_lshlrev_b32 v86,16,v114
v_and_b32 v87,0xffff0000,v114
v_cvt_pk_bf16_f32 v115,v88,v89
v_lshlrev_b32 v88,16,v115
v_and_b32 v89,0xffff0000,v115
v_cvt_pk_bf16_f32 v116,v90,v91
v_lshlrev_b32 v90,16,v116
v_and_b32 v91,0xffff0000,v116
v_pk_add_f32 v[32:33],v[82:83],v[84:85]
v_pk_mul_f32 v[30:31],v[82:83],v[82:83]
v_pk_fma_f32 v[30:31],v[84:85],v[84:85],v[30:31]
v_pk_add_f32 v[32:33],v[32:33],v[86:87]
v_pk_fma_f32 v[30:31],v[86:87],v[86:87],v[30:31]
v_pk_add_f32 v[32:33],v[32:33],v[88:89]
v_pk_fma_f32 v[30:31],v[88:89],v[88:89],v[30:31]
v_pk_add_f32 v[32:33],v[32:33],v[90:91]
v_pk_fma_f32 v[30:31],v[90:91],v[90:91],v[30:31]
v_add_f32 v28,v32,v33
v_add_f32 v29,v30,v31
s_nop 0
v_add_f32_dpp v28,v28,v28 row_ror:4 row_mask:0xf bank_mask:0xf
v_add_f32_dpp v29,v29,v29 row_ror:4 row_mask:0xf bank_mask:0xf
s_nop 0
v_add_f32_dpp v28,v28,v28 row_ror:8 row_mask:0xf bank_mask:0xf
v_add_f32_dpp v29,v29,v29 row_ror:8 row_mask:0xf bank_mask:0xf
v_mov_b32 v30,v28
v_mov_b32 v31,v29
s_nop 0
v_permlane32_swap_b32 v28,v30
v_permlane32_swap_b32 v29,v31
v_add_f32 v28,v28,v30
v_add_f32 v29,v29,v31
v_mov_b32 v30,v28
v_mov_b32 v31,v29
s_nop 0
v_permlane16_swap_b32 v28,v30
v_permlane16_swap_b32 v29,v31
v_add_f32 v28,v28,v30
v_add_f32 v29,v29,v31
ds_write_b64 v20,v[28:29]
s_waitcnt lgkmcnt(0)
s_barrier
ds_read_b128 v[136:139],v21
ds_read_b128 v[140:143],v21 offset:16
buffer_store_dwordx4 v[112:115],v16,s[8:11],s74 offen sc1
v_mov_b32 v117,v116
s_nop 1
v_permlane16_swap_b32 v116,v117
s_nop 1
v_permlane32_swap_b32 v116,v118
v_permlane32_swap_b32 v117,v119
s_mov_b64 exec,0xffff
buffer_store_dwordx4 v[116:119],v17,s[8:11],s74 offen sc1
s_mov_b64 exec,-1
s_waitcnt lgkmcnt(0)
v_pk_add_f32 v[136:137],v[136:137],v[138:139]
v_pk_add_f32 v[140:141],v[140:141],v[142:143]
v_pk_add_f32 v[28:29],v[136:137],v[140:141]
v_mul_f32 v28,0x3acccccd,v28
v_mul_f32 v29,0x3acccccd,v29
v_fma_f32 v29,-v28,v28,v29
v_max_f32 v29,0,v29
v_mov_b32 v32,v28
v_mov_b32 v33,v29
v_cvt_pk_bf16_f32 v6,v28,v29
v_lshlrev_b32 v28,16,v6
v_and_b32 v29,0xffff0000,v6
v_add_f32 v29,0x3727c5ac,v29
v_cvt_pk_bf16_f32 v6,v29,v29
v_lshlrev_b32 v29,16,v6
v_sqrt_f32 v29,v29
s_nop 0
v_cvt_pk_bf16_f32 v6,v29,v29
v_lshlrev_b32 v29,16,v6
v_rcp_f32 v29,v29
s_nop 0
v_pk_add_f32 v[82:83],v[82:83],v[28:29] op_sel_hi:[1,0] neg_lo:[0,1] neg_hi:[0,1]
v_pk_add_f32 v[84:85],v[84:85],v[28:29] op_sel_hi:[1,0] neg_lo:[0,1] neg_hi:[0,1]
v_pk_add_f32 v[86:87],v[86:87],v[28:29] op_sel_hi:[1,0] neg_lo:[0,1] neg_hi:[0,1]
v_pk_add_f32 v[88:89],v[88:89],v[28:29] op_sel_hi:[1,0] neg_lo:[0,1] neg_hi:[0,1]
v_pk_add_f32 v[90:91],v[90:91],v[28:29] op_sel_hi:[1,0] neg_lo:[0,1] neg_hi:[0,1]
v_cvt_pk_bf16_f32 v6,v82,v83
v_lshlrev_b32 v82,16,v6
v_and_b32 v83,0xffff0000,v6
v_cvt_pk_bf16_f32 v8,v84,v85
v_lshlrev_b32 v84,16,v8
v_and_b32 v85,0xffff0000,v8
v_cvt_pk_bf16_f32 v6,v86,v87
v_lshlrev_b32 v86,16,v6
v_and_b32 v87,0xffff0000,v6
v_cvt_pk_bf16_f32 v8,v88,v89
v_lshlrev_b32 v88,16,v8
v_and_b32 v89,0xffff0000,v8
v_cvt_pk_bf16_f32 v6,v90,v91
v_lshlrev_b32 v90,16,v6
v_and_b32 v91,0xffff0000,v6
v_pk_mul_f32 v[82:83],v[82:83],v[28:29] op_sel:[0,1] op_sel_hi:[1,1]
v_pk_mul_f32 v[84:85],v[84:85],v[28:29] op_sel:[0,1] op_sel_hi:[1,1]
v_pk_mul_f32 v[86:87],v[86:87],v[28:29] op_sel:[0,1] op_sel_hi:[1,1]
v_pk_mul_f32 v[88:89],v[88:89],v[28:29] op_sel:[0,1] op_sel_hi:[1,1]
v_pk_mul_f32 v[90:91],v[90:91],v[28:29] op_sel:[0,1] op_sel_hi:[1,1]
v_cvt_pk_bf16_f32 v124,v82,v83
v_cvt_pk_bf16_f32 v125,v84,v85
v_cvt_pk_bf16_f32 v126,v86,v87
v_cvt_pk_bf16_f32 v127,v88,v89
v_cvt_pk_bf16_f32 v128,v90,v91
buffer_store_dwordx4 v[124:127],v16,s[8:11],s75 offen sc1
v_mov_b32 v129,v128
s_nop 1
v_permlane16_swap_b32 v128,v129
s_nop 1
v_permlane32_swap_b32 v128,v130
v_permlane32_swap_b32 v129,v131
s_mov_b64 exec,0xffff
buffer_store_dwordx4 v[128:131],v17,s[8:11],s75 offen sc1
s_mov_b64 exec,-1
s_cmp_lg_u32 s46,3
s_cbranch_scc1 zs_263
v_sub_f32 v32,v32,v28
v_mul_f32 v33,v33,v29
v_mul_f32 v32,v32,v29
v_mul_f32 v33,v33,v29
v_cvt_pk_bf16_f32 v6,v32,v33
v_lshlrev_b32 v32,16,v6
v_and_b32 v33,0xffff0000,v6
v_add_f32 v33,0x3727c5ac,v33
v_cvt_pk_bf16_f32 v6,v33,v33
v_lshlrev_b32 v33,16,v6
v_sqrt_f32 v33,v33
s_nop 0
v_cvt_pk_bf16_f32 v6,v33,v33
v_lshlrev_b32 v33,16,v6
v_rcp_f32 v33,v33
s_lshl_b32 s60,s48,7
s_add_u32 s63,s75,s60
s_add_u32 s63,s63,40960
v_lshlrev_b32 v6,3,v0
s_mov_b64 exec,65535
buffer_store_dwordx2 v[32:33],v6,s[8:11],s63 offen sc1
s_mov_b64 exec,-1
zs_263:
s_add_u32 s52,s52,1
s_add_u32 s35,s35,640
s_waitcnt vmcnt(0)
s_mov_b64 exec,1
buffer_store_dword v5,v1,s[8:11],s82 offen sc1
s_mov_b64 exec,-1
s_cmp_lt_u32 s52,64
s_cbranch_scc1 R1_LOOP
s_endpgm
ROLE_W1:
v_lshlrev_b32 v1,4,v0
v_mov_b32 v5,1
s_lshl_b32 s56,s48,2
s_add_u32 s56,s56,s46
v_bfe_u32 v6,v0,2,2
v_lshrrev_b32 v7,4,v0
v_add_u32 v7,v6,v7
v_and_b32 v7,3,v7
v_and_b32 v15,3,v0
v_lshlrev_b32 v15,4,v15
v_lshl_add_u32 v15,v7,6,v15
v_lshl_add_u32 v15,v6,8,v15
v_lshrrev_b32 v6,5,v0
v_bfe_u32 v7,v0,4,1
v_lshlrev_b32 v16,10,v7
v_bfe_u32 v7,v0,2,2
v_lshl_add_u32 v16,v7,8,v16
v_add_u32 v6,v6,v7
v_and_b32 v6,3,v6
v_lshl_add_u32 v16,v6,6,v16
v_and_b32 v6,3,v0
v_lshl_add_u32 v16,v6,4,v16
v_add_u32 v18,46080,v16
v_lshrrev_b32 v6,5,v0
v_bfe_u32 v7,v0,4,1
v_lshlrev_b32 v20,10,v7
v_lshl_add_u32 v20,v6,8,v20
v_and_b32 v6,15,v0
v_lshl_add_u32 v20,v6,4,v20
v_lshrrev_b32 v6,5,v0
v_add_u32 v6,2,v6
v_bfe_u32 v7,v0,4,1
v_lshlrev_b32 v17,10,v7
v_bfe_u32 v7,v0,2,2
v_lshl_add_u32 v17,v7,8,v17
v_add_u32 v6,v6,v7
v_and_b32 v6,3,v6
v_lshl_add_u32 v17,v6,6,v17
v_and_b32 v6,3,v0
v_lshl_add_u32 v17,v6,4,v17
v_add_u32 v19,46080,v17
v_lshrrev_b32 v6,5,v0
v_add_u32 v6,2,v6
v_bfe_u32 v7,v0,4,1
v_lshlrev_b32 v21,10,v7
v_lshl_add_u32 v21,v6,8,v21
v_and_b32 v6,15,v0
v_lshl_add_u32 v21,v6,4,v21
v_min_u32 v2,31,v0
v_lshlrev_b32 v2,2,v2
v_mov_b32 v112,0xc0135761
v_mov_b32 v113,0xbdd2d3e8
s_mov_b32 s68,0xbdd2d3e8
v_mov_b32 v116,0
v_mov_b32 v117,0
v_mov_b32 v118,0
v_mov_b32 v119,0
s_lshl_b32 s60,s56,11
s_add_u32 s61,s60,237699072
buffer_store_dwordx4 v[116:119],v1,s[8:11],s61 offen sc1
buffer_store_dwordx4 v[116:119],v1,s[8:11],s61 offen offset:1024 sc1
s_add_u32 s61,s60,238067712
buffer_store_dwordx4 v[116:119],v1,s[8:11],s61 offen sc1
buffer_store_dwordx4 v[116:119],v1,s[8:11],s61 offen offset:1024 sc1
v_mov_b32 v24,-1
v_mov_b32 v25,-1
v_mov_b32 v26,-1
v_mov_b32 v27,-1
s_add_u32 s60,s48,0
s_lshl2_add_u32 s60,s60,s46
s_mul_i32 s60,s60,22528
s_add_u32 s61,s60,24117248
buffer_store_dwordx4 v[24:27],v1,s[8:11],s61 offen sc1
buffer_store_dwordx4 v[24:27],v1,s[8:11],s61 offen offset:1024 sc1
buffer_store_dwordx4 v[24:27],v1,s[8:11],s61 offen offset:2048 sc1
buffer_store_dwordx4 v[24:27],v1,s[8:11],s61 offen offset:3072 sc1
s_add_u32 s61,s60,24121344
buffer_store_dwordx4 v[24:27],v1,s[8:11],s61 offen sc1
buffer_store_dwordx4 v[24:27],v1,s[8:11],s61 offen offset:1024 sc1
buffer_store_dwordx4 v[24:27],v1,s[8:11],s61 offen offset:2048 sc1
buffer_store_dwordx4 v[24:27],v1,s[8:11],s61 offen offset:3072 sc1
s_add_u32 s61,s60,24125440
buffer_store_dwordx4 v[24:27],v1,s[8:11],s61 offen sc1
buffer_store_dwordx4 v[24:27],v1,s[8:11],s61 offen offset:1024 sc1
buffer_store_dwordx4 v[24:27],v1,s[8:11],s61 offen offset:2048 sc1
buffer_store_dwordx4 v[24:27],v1,s[8:11],s61 offen offset:3072 sc1
s_add_u32 s61,s60,24129536
buffer_store_dwordx4 v[24:27],v1,s[8:11],s61 offen sc1
buffer_store_dwordx4 v[24:27],v1,s[8:11],s61 offen offset:1024 sc1
buffer_store_dwordx4 v[24:27],v1,s[8:11],s61 offen offset:2048 sc1
buffer_store_dwordx4 v[24:27],v1,s[8:11],s61 offen offset:3072 sc1
s_add_u32 s61,s60,24133632
buffer_store_dwordx4 v[24:27],v1,s[8:11],s61 offen sc1
buffer_store_dwordx4 v[24:27],v1,s[8:11],s61 offen offset:1024 sc1
buffer_store_dwordx4 v[24:27],v1,s[8:11],s61 offen offset:2048 sc1
buffer_store_dwordx4 v[24:27],v1,s[8:11],s61 offen offset:3072 sc1
s_add_u32 s61,s60,24137728
buffer_store_dwordx4 v[24:27],v1,s[8:11],s61 offen sc1
buffer_store_dwordx4 v[24:27],v1,s[8:11],s61 offen offset:1024 sc1
s_waitcnt vmcnt(0)
s_barrier
s_cmp_lg_u32 s46,0
s_cbranch_scc1 arr_264
v_mov_b32 v6,1
s_lshl_b32 s3,s49,2
v_mov_b32 v7,s3
s_mov_b64 exec,1
buffer_atomic_add v6,v7,s[12:15],0 offen sc1
s_mov_b64 exec,-1
arr_264:
s_lshl_b32 s3,s49,2
v_mov_b32 v7,s3
s_nop 1
ibw_265:
buffer_load_dword v6,v7,s[12:15],0 offen sc1
s_waitcnt vmcnt(0)
v_cmp_ne_u32 vcc,256,v6
s_nop 0
s_cbranch_vccz ok_266
s_sleep 8
s_sub_u32 s47,s47,1
s_cbranch_scc1 ABORT
s_branch ibw_265
ok_266:
s_cmp_lg_u32 s49,0
s_cbranch_scc1 ibok_267
v_and_b32 v7,7,v0
v_lshlrev_b32 v7,2,v7
buffer_load_dword v6,v7,s[12:15],0 offen offset:32 sc1
s_waitcnt vmcnt(0)
v_cmp_ne_u32 vcc,32,v6
s_nop 0
s_cbranch_vccz ibok_267
s_barrier
s_mov_b32 s49,1
s_mov_b32 s3,s2
s_load_dwordx16 s[16:31],s[0:1],0
s_load_dwordx8 s[32:39],s[0:1],64
s_waitcnt lgkmcnt(0)
s_branch DISPATCH
ibok_267:
s_lshl_b32 s58,s56,6
s_mul_i32 s63,s46,40960
s_mov_b32 s4,s32
s_mov_b32 s5,s33
s_mov_b32 s6,819200
s_mov_b32 s7,0x20000
v_lshrrev_b32 v9,2,v0
s_mov_b32 s64,1280
v_mul_lo_u32 v9,v9,s64
v_and_b32 v10,3,v0
v_lshl_add_u32 v6,v10,4,v9
s_add_u32 m0,s63,0
s_add_u32 s65,s58,0
buffer_load_dwordx4 v6,s[4:7],s65 offen lds
s_add_u32 m0,s63,1024
s_add_u32 s65,s58,20480
buffer_load_dwordx4 v6,s[4:7],s65 offen lds
s_add_u32 m0,s63,2048
s_add_u32 s65,s58,40960
buffer_load_dwordx4 v6,s[4:7],s65 offen lds
s_add_u32 m0,s63,3072
s_add_u32 s65,s58,61440
buffer_load_dwordx4 v6,s[4:7],s65 offen lds
s_add_u32 m0,s63,4096
s_add_u32 s65,s58,81920
buffer_load_dwordx4 v6,s[4:7],s65 offen lds
s_add_u32 m0,s63,5120
s_add_u32 s65,s58,102400
buffer_load_dwordx4 v6,s[4:7],s65 offen lds
s_add_u32 m0,s63,6144
s_add_u32 s65,s58,122880
buffer_load_dwordx4 v6,s[4:7],s65 offen lds
s_add_u32 m0,s63,7168
s_add_u32 s65,s58,143360
buffer_load_dwordx4 v6,s[4:7],s65 offen lds
s_add_u32 m0,s63,8192
s_add_u32 s65,s58,163840
buffer_load_dwordx4 v6,s[4:7],s65 offen lds
s_add_u32 m0,s63,9216
s_add_u32 s65,s58,184320
buffer_load_dwordx4 v6,s[4:7],s65 offen lds
s_add_u32 m0,s63,10240
s_add_u32 s65,s58,204800
buffer_load_dwordx4 v6,s[4:7],s65 offen lds
s_add_u32 m0,s63,11264
s_add_u32 s65,s58,225280
buffer_load_dwordx4 v6,s[4:7],s65 offen lds
s_add_u32 m0,s63,12288
s_add_u32 s65,s58,245760
buffer_load_dwordx4 v6,s[4:7],s65 offen lds
s_add_u32 m0,s63,13312
s_add_u32 s65,s58,266240
buffer_load_dwordx4 v6,s[4:7],s65 offen lds
s_add_u32 m0,s63,14336
s_add_u32 s65,s58,286720
buffer_load_dwordx4 v6,s[4:7],s65 offen lds
s_add_u32 m0,s63,15360
s_add_u32 s65,s58,307200
buffer_load_dwordx4 v6,s[4:7],s65 offen lds
s_add_u32 m0,s63,16384
s_add_u32 s65,s58,327680
buffer_load_dwordx4 v6,s[4:7],s65 offen lds
s_add_u32 m0,s63,17408
s_add_u32 s65,s58,348160
buffer_load_dwordx4 v6,s[4:7],s65 offen lds
s_add_u32 m0,s63,18432
s_add_u32 s65,s58,368640
buffer_load_dwordx4 v6,s[4:7],s65 offen lds
s_add_u32 m0,s63,19456
s_add_u32 s65,s58,389120
buffer_load_dwordx4 v6,s[4:7],s65 offen lds
s_add_u32 m0,s63,20480
s_add_u32 s65,s58,409600
buffer_load_dwordx4 v6,s[4:7],s65 offen lds
s_add_u32 m0,s63,21504
s_add_u32 s65,s58,430080
buffer_load_dwordx4 v6,s[4:7],s65 offen lds
s_add_u32 m0,s63,22528
s_add_u32 s65,s58,450560
buffer_load_dwordx4 v6,s[4:7],s65 offen lds
s_add_u32 m0,s63,23552
s_add_u32 s65,s58,471040
buffer_load_dwordx4 v6,s[4:7],s65 offen lds
s_add_u32 m0,s63,24576
s_add_u32 s65,s58,491520
buffer_load_dwordx4 v6,s[4:7],s65 offen lds
s_add_u32 m0,s63,25600
s_add_u32 s65,s58,512000
buffer_load_dwordx4 v6,s[4:7],s65 offen lds
s_add_u32 m0,s63,26624
s_add_u32 s65,s58,532480
buffer_load_dwordx4 v6,s[4:7],s65 offen lds
s_add_u32 m0,s63,27648
s_add_u32 s65,s58,552960
buffer_load_dwordx4 v6,s[4:7],s65 offen lds
s_add_u32 m0,s63,28672
s_add_u32 s65,s58,573440
buffer_load_dwordx4 v6,s[4:7],s65 offen lds
s_add_u32 m0,s63,29696
s_add_u32 s65,s58,593920
buffer_load_dwordx4 v6,s[4:7],s65 offen lds
s_add_u32 m0,s63,30720
s_add_u32 s65,s58,614400
buffer_load_dwordx4 v6,s[4:7],s65 offen lds
s_add_u32 m0,s63,31744
s_add_u32 s65,s58,634880
buffer_load_dwordx4 v6,s[4:7],s65 offen lds
s_add_u32 m0,s63,32768
s_add_u32 s65,s58,655360
buffer_load_dwordx4 v6,s[4:7],s65 offen lds
s_add_u32 m0,s63,33792
s_add_u32 s65,s58,675840
buffer_load_dwordx4 v6,s[4:7],s65 offen lds
s_add_u32 m0,s63,34816
s_add_u32 s65,s58,696320
buffer_load_dwordx4 v6,s[4:7],s65 offen lds
s_add_u32 m0,s63,35840
s_add_u32 s65,s58,716800
buffer_load_dwordx4 v6,s[4:7],s65 offen lds
s_add_u32 m0,s63,36864
s_add_u32 s65,s58,737280
buffer_load_dwordx4 v6,s[4:7],s65 offen lds
s_add_u32 m0,s63,37888
s_add_u32 s65,s58,757760
buffer_load_dwordx4 v6,s[4:7],s65 offen lds
s_add_u32 m0,s63,38912
s_add_u32 s65,s58,778240
buffer_load_dwordx4 v6,s[4:7],s65 offen lds
s_add_u32 m0,s63,39936
s_add_u32 s65,s58,798720
buffer_load_dwordx4 v6,s[4:7],s65 offen lds
s_waitcnt vmcnt(20)
v_bfe_u32 v9,v0,2,2
v_lshrrev_b32 v10,5,v0
v_lshl_add_u32 v9,v10,2,v9
v_mul_u32_u24 v9,64,v9
v_and_b32 v10,1,v0
v_lshl_add_u32 v9,v10,3,v9
v_bfe_u32 v10,v0,1,1
v_lshl_add_u32 v9,v10,5,v9
v_bfe_u32 v10,v0,4,1
v_lshl_add_u32 v9,v10,4,v9
v_add_u32 v7,s63,v9
ds_read_b64_tr_b16 a[0:1],v7 offset:0
ds_read_b64_tr_b16 a[2:3],v7 offset:1024
ds_read_b64_tr_b16 a[4:5],v7 offset:512
ds_read_b64_tr_b16 a[6:7],v7 offset:1536
ds_read_b64_tr_b16 a[8:9],v7 offset:2048
ds_read_b64_tr_b16 a[10:11],v7 offset:3072
ds_read_b64_tr_b16 a[12:13],v7 offset:2560
ds_read_b64_tr_b16 a[14:15],v7 offset:3584
ds_read_b64_tr_b16 a[16:17],v7 offset:4096
ds_read_b64_tr_b16 a[18:19],v7 offset:5120
ds_read_b64_tr_b16 a[20:21],v7 offset:4608
ds_read_b64_tr_b16 a[22:23],v7 offset:5632
s_waitcnt lgkmcnt(4)
ds_read_b64_tr_b16 a[24:25],v7 offset:6144
ds_read_b64_tr_b16 a[26:27],v7 offset:7168
ds_read_b64_tr_b16 a[28:29],v7 offset:6656
ds_read_b64_tr_b16 a[30:31],v7 offset:7680
ds_read_b64_tr_b16 a[32:33],v7 offset:8192
ds_read_b64_tr_b16 a[34:35],v7 offset:9216
ds_read_b64_tr_b16 a[36:37],v7 offset:8704
ds_read_b64_tr_b16 a[38:39],v7 offset:9728
ds_read_b64_tr_b16 a[40:41],v7 offset:10240
ds_read_b64_tr_b16 a[42:43],v7 offset:11264
ds_read_b64_tr_b16 a[44:45],v7 offset:10752
ds_read_b64_tr_b16 a[46:47],v7 offset:11776
s_waitcnt lgkmcnt(4)
ds_read_b64_tr_b16 a[48:49],v7 offset:12288
ds_read_b64_tr_b16 a[50:51],v7 offset:13312
ds_read_b64_tr_b16 a[52:53],v7 offset:12800
ds_read_b64_tr_b16 a[54:55],v7 offset:13824
ds_read_b64_tr_b16 a[56:57],v7 offset:14336
ds_read_b64_tr_b16 a[58:59],v7 offset:15360
ds_read_b64_tr_b16 a[60:61],v7 offset:14848
ds_read_b64_tr_b16 a[62:63],v7 offset:15872
ds_read_b64_tr_b16 a[64:65],v7 offset:16384
ds_read_b64_tr_b16 a[66:67],v7 offset:17408
ds_read_b64_tr_b16 a[68:69],v7 offset:16896
ds_read_b64_tr_b16 a[70:71],v7 offset:17920
s_waitcnt lgkmcnt(4)
ds_read_b64_tr_b16 a[72:73],v7 offset:18432
ds_read_b64_tr_b16 a[74:75],v7 offset:19456
ds_read_b64_tr_b16 a[76:77],v7 offset:18944
ds_read_b64_tr_b16 a[78:79],v7 offset:19968
s_waitcnt lgkmcnt(0)
s_waitcnt vmcnt(0)
v_bfe_u32 v9,v0,2,2
v_lshrrev_b32 v10,5,v0
v_lshl_add_u32 v9,v10,2,v9
v_mul_u32_u24 v9,64,v9
v_and_b32 v10,1,v0
v_lshl_add_u32 v9,v10,3,v9
v_bfe_u32 v10,v0,1,1
v_lshl_add_u32 v9,v10,5,v9
v_bfe_u32 v10,v0,4,1
v_lshl_add_u32 v9,v10,4,v9
v_add_u32 v7,s63,v9
ds_read_b64_tr_b16 a[80:81],v7 offset:20480
ds_read_b64_tr_b16 a[82:83],v7 offset:21504
ds_read_b64_tr_b16 a[84:85],v7 offset:20992
ds_read_b64_tr_b16 a[86:87],v7 offset:22016
ds_read_b64_tr_b16 a[88:89],v7 offset:22528
ds_read_b64_tr_b16 a[90:91],v7 offset:23552
ds_read_b64_tr_b16 a[92:93],v7 offset:23040
ds_read_b64_tr_b16 a[94:95],v7 offset:24064
ds_read_b64_tr_b16 a[96:97],v7 offset:24576
ds_read_b64_tr_b16 a[98:99],v7 offset:25600
ds_read_b64_tr_b16 a[100:101],v7 offset:25088
ds_read_b64_tr_b16 a[102:103],v7 offset:26112
s_waitcnt lgkmcnt(4)
ds_read_b64_tr_b16 a[104:105],v7 offset:26624
ds_read_b64_tr_b16 a[106:107],v7 offset:27648
ds_read_b64_tr_b16 a[108:109],v7 offset:27136
ds_read_b64_tr_b16 a[110:111],v7 offset:28160
ds_read_b64_tr_b16 a[112:113],v7 offset:28672
ds_read_b64_tr_b16 a[114:115],v7 offset:29696
ds_read_b64_tr_b16 a[116:117],v7 offset:29184
ds_read_b64_tr_b16 a[118:119],v7 offset:30208
ds_read_b64_tr_b16 a[120:121],v7 offset:30720
ds_read_b64_tr_b16 a[122:123],v7 offset:31744
ds_read_b64_tr_b16 a[124:125],v7 offset:31232
ds_read_b64_tr_b16 a[126:127],v7 offset:32256
s_waitcnt lgkmcnt(4)
ds_read_b64_tr_b16 a[128:129],v7 offset:32768
ds_read_b64_tr_b16 a[130:131],v7 offset:33792
ds_read_b64_tr_b16 a[132:133],v7 offset:33280
ds_read_b64_tr_b16 a[134:135],v7 offset:34304
ds_read_b64_tr_b16 a[136:137],v7 offset:34816
ds_read_b64_tr_b16 a[138:139],v7 offset:35840
ds_read_b64_tr_b16 a[140:141],v7 offset:35328
ds_read_b64_tr_b16 a[142:143],v7 offset:36352
ds_read_b64_tr_b16 a[144:145],v7 offset:36864
ds_read_b64_tr_b16 a[146:147],v7 offset:37888
ds_read_b64_tr_b16 a[148:149],v7 offset:37376
ds_read_b64_tr_b16 a[150:151],v7 offset:38400
s_waitcnt lgkmcnt(4)
ds_read_b64_tr_b16 a[152:153],v7 offset:38912
ds_read_b64_tr_b16 a[154:155],v7 offset:39936
ds_read_b64_tr_b16 a[156:157],v7 offset:39424
ds_read_b64_tr_b16 a[158:159],v7 offset:40448
s_waitcnt lgkmcnt(0)
v_mov_b32 v24,0x3f803f80
v_mov_b32 v25,0x3f803f80
v_mov_b32 v26,0x3f803f80
v_mov_b32 v27,0x3f803f80
s_nop 1
v_mfma_f32_32x32x16_bf16 v[144:159],a[0:3],v[24:27],0
v_mfma_f32_32x32x16_bf16 v[144:159],a[4:7],v[24:27],v[144:159]
v_mfma_f32_32x32x16_bf16 v[144:159],a[8:11],v[24:27],v[144:159]
v_mfma_f32_32x32x16_bf16 v[144:159],a[12:15],v[24:27],v[144:159]
v_mfma_f32_32x32x16_bf16 v[144:159],a[16:19],v[24:27],v[144:159]
v_mfma_f32_32x32x16_bf16 v[144:159],a[20:23],v[24:27],v[144:159]
v_mfma_f32_32x32x16_bf16 v[144:159],a[24:27],v[24:27],v[144:159]
v_mfma_f32_32x32x16_bf16 v[144:159],a[28:31],v[24:27],v[144:159]
v_mfma_f32_32x32x16_bf16 v[144:159],a[32:35],v[24:27],v[144:159]
v_mfma_f32_32x32x16_bf16 v[144:159],a[36:39],v[24:27],v[144:159]
v_mfma_f32_32x32x16_bf16 v[144:159],a[40:43],v[24:27],v[144:159]
v_mfma_f32_32x32x16_bf16 v[144:159],a[44:47],v[24:27],v[144:159]
v_mfma_f32_32x32x16_bf16 v[144:159],a[48:51],v[24:27],v[144:159]
v_mfma_f32_32x32x16_bf16 v[144:159],a[52:55],v[24:27],v[144:159]
v_mfma_f32_32x32x16_bf16 v[144:159],a[56:59],v[24:27],v[144:159]
v_mfma_f32_32x32x16_bf16 v[144:159],a[60:63],v[24:27],v[144:159]
v_mfma_f32_32x32x16_bf16 v[144:159],a[64:67],v[24:27],v[144:159]
v_mfma_f32_32x32x16_bf16 v[144:159],a[68:71],v[24:27],v[144:159]
v_mfma_f32_32x32x16_bf16 v[144:159],a[72:75],v[24:27],v[144:159]
v_mfma_f32_32x32x16_bf16 v[144:159],a[76:79],v[24:27],v[144:159]
v_mfma_f32_32x32x16_bf16 v[144:159],a[80:83],v[24:27],v[144:159]
v_mfma_f32_32x32x16_bf16 v[144:159],a[84:87],v[24:27],v[144:159]
v_mfma_f32_32x32x16_bf16 v[144:159],a[88:91],v[24:27],v[144:159]
v_mfma_f32_32x32x16_bf16 v[144:159],a[92:95],v[24:27],v[144:159]
v_mfma_f32_32x32x16_bf16 v[144:159],a[96:99],v[24:27],v[144:159]
v_mfma_f32_32x32x16_bf16 v[144:159],a[100:103],v[24:27],v[144:159]
v_mfma_f32_32x32x16_bf16 v[144:159],a[104:107],v[24:27],v[144:159]
v_mfma_f32_32x32x16_bf16 v[144:159],a[108:111],v[24:27],v[144:159]
v_mfma_f32_32x32x16_bf16 v[144:159],a[112:115],v[24:27],v[144:159]
v_mfma_f32_32x32x16_bf16 v[144:159],a[116:119],v[24:27],v[144:159]
v_mfma_f32_32x32x16_bf16 v[144:159],a[120:123],v[24:27],v[144:159]
v_mfma_f32_32x32x16_bf16 v[144:159],a[124:127],v[24:27],v[144:159]
v_mfma_f32_32x32x16_bf16 v[144:159],a[128:131],v[24:27],v[144:159]
v_mfma_f32_32x32x16_bf16 v[144:159],a[132:135],v[24:27],v[144:159]
v_mfma_f32_32x32x16_bf16 v[144:159],a[136:139],v[24:27],v[144:159]
v_mfma_f32_32x32x16_bf16 v[144:159],a[140:143],v[24:27],v[144:159]
v_mfma_f32_32x32x16_bf16 v[144:159],a[144:147],v[24:27],v[144:159]
v_mfma_f32_32x32x16_bf16 v[144:159],a[148:151],v[24:27],v[144:159]
v_mfma_f32_32x32x16_bf16 v[144:159],a[152:155],v[24:27],v[144:159]
v_mfma_f32_32x32x16_bf16 v[144:159],a[156:159],v[24:27],v[144:159]
v_and_b32 v182,31,v0
v_lshlrev_b32 v182,3,v182
v_add_u32 v182,0xa000,v182
v_bfe_u32 v6,v0,2,3
v_mul_u32_u24 v6,96,v6
v_add_u32 v182,v182,v6
s_barrier
s_mov_b32 s50,0
s_mov_b32 s32,0
s_mov_b32 s57,0
s_mov_b32 s59,2147483648
s_mov_b32 s82,2147483648
s_mov_b32 s39,2147483648
v_mov_b32 v22,94208
v_lshl_add_u32 v22,v0,2,v22
v_mov_b32 v23,0
ds_write_b32 v22,v23
s_mov_b32 s39,1600000
v_and_b32 v72,15,v0
v_lshlrev_b32 v72,7,v72
v_min_u32 v6,51,v0
v_lshlrev_b32 v6,2,v6
v_add_u32 v2,0,v6
v_add_u32 v7,127360,v6
v_cmp_gt_u32 s[78:79],32,v0
s_nop 1
v_cndmask_b32 v2,v7,v2,s[78:79]
s_mov_b32 s51,0
s_mov_b32 s52,0
s_mul_i32 s62,s51,9
s_and_b32 s63,s52,7
s_add_u32 s62,s62,s63
s_mul_i32 s62,s62,40960
s_add_u32 s62,s62,237371392
s_lshl_b32 s63,s56,11
s_add_u32 s62,s62,s63
buffer_load_dword v73,v72,s[8:11],s62 offen sc1
s_mov_b32 s51,0
s_mov_b32 s52,1
s_mul_i32 s62,s51,9
s_and_b32 s63,s52,7
s_add_u32 s62,s62,s63
s_mul_i32 s62,s62,40960
s_add_u32 s62,s62,237371392
s_lshl_b32 s63,s56,11
s_add_u32 s62,s62,s63
buffer_load_dword v73,v72,s[8:11],s62 offen sc1
s_mov_b32 s51,0
s_mov_b32 s52,2
s_mul_i32 s62,s51,9
s_and_b32 s63,s52,7
s_add_u32 s62,s62,s63
s_mul_i32 s62,s62,40960
s_add_u32 s62,s62,237371392
s_lshl_b32 s63,s56,11
s_add_u32 s62,s62,s63
buffer_load_dword v73,v72,s[8:11],s62 offen sc1
s_mov_b32 s51,0
s_mov_b32 s52,3
s_mul_i32 s62,s51,9
s_and_b32 s63,s52,7
s_add_u32 s62,s62,s63
s_mul_i32 s62,s62,40960
s_add_u32 s62,s62,237371392
s_lshl_b32 s63,s56,11
s_add_u32 s62,s62,s63
buffer_load_dword v73,v72,s[8:11],s62 offen sc1
s_mov_b32 s51,0
s_mov_b32 s52,4
s_mul_i32 s62,s51,9
s_and_b32 s63,s52,7
s_add_u32 s62,s62,s63
s_mul_i32 s62,s62,40960
s_add_u32 s62,s62,237371392
s_lshl_b32 s63,s56,11
s_add_u32 s62,s62,s63
buffer_load_dword v73,v72,s[8:11],s62 offen sc1
s_mov_b32 s51,0
s_mov_b32 s52,5
s_mul_i32 s62,s51,9
s_and_b32 s63,s52,7
s_add_u32 s62,s62,s63
s_mul_i32 s62,s62,40960
s_add_u32 s62,s62,237371392
s_lshl_b32 s63,s56,11
s_add_u32 s62,s62,s63
buffer_load_dword v73,v72,s[8:11],s62 offen sc1
s_mov_b32 s51,0
s_mov_b32 s52,6
s_mul_i32 s62,s51,9
s_and_b32 s63,s52,7
s_add_u32 s62,s62,s63
s_mul_i32 s62,s62,40960
s_add_u32 s62,s62,237371392
s_lshl_b32 s63,s56,11
s_add_u32 s62,s62,s63
buffer_load_dword v73,v72,s[8:11],s62 offen sc1
s_mov_b32 s51,0
s_mov_b32 s52,7
s_mul_i32 s62,s51,9
s_and_b32 s63,s52,7
s_add_u32 s62,s62,s63
s_mul_i32 s62,s62,40960
s_add_u32 s62,s62,237371392
s_lshl_b32 s63,s56,11
s_add_u32 s62,s62,s63
buffer_load_dword v73,v72,s[8:11],s62 offen sc1
s_mov_b32 s51,1
s_mov_b32 s52,0
s_mul_i32 s62,s51,9
s_and_b32 s63,s52,7
s_add_u32 s62,s62,s63
s_mul_i32 s62,s62,40960
s_add_u32 s62,s62,237371392
s_lshl_b32 s63,s56,11
s_add_u32 s62,s62,s63
buffer_load_dword v73,v72,s[8:11],s62 offen sc1
s_mov_b32 s51,1
s_mov_b32 s52,1
s_mul_i32 s62,s51,9
s_and_b32 s63,s52,7
s_add_u32 s62,s62,s63
s_mul_i32 s62,s62,40960
s_add_u32 s62,s62,237371392
s_lshl_b32 s63,s56,11
s_add_u32 s62,s62,s63
buffer_load_dword v73,v72,s[8:11],s62 offen sc1
s_mov_b32 s51,1
s_mov_b32 s52,2
s_mul_i32 s62,s51,9
s_and_b32 s63,s52,7
s_add_u32 s62,s62,s63
s_mul_i32 s62,s62,40960
s_add_u32 s62,s62,237371392
s_lshl_b32 s63,s56,11
s_add_u32 s62,s62,s63
buffer_load_dword v73,v72,s[8:11],s62 offen sc1
s_mov_b32 s51,1
s_mov_b32 s52,3
s_mul_i32 s62,s51,9
s_and_b32 s63,s52,7
s_add_u32 s62,s62,s63
s_mul_i32 s62,s62,40960
s_add_u32 s62,s62,237371392
s_lshl_b32 s63,s56,11
s_add_u32 s62,s62,s63
buffer_load_dword v73,v72,s[8:11],s62 offen sc1
s_mov_b32 s51,1
s_mov_b32 s52,4
s_mul_i32 s62,s51,9
s_and_b32 s63,s52,7
s_add_u32 s62,s62,s63
s_mul_i32 s62,s62,40960
s_add_u32 s62,s62,237371392
s_lshl_b32 s63,s56,11
s_add_u32 s62,s62,s63
buffer_load_dword v73,v72,s[8:11],s62 offen sc1
s_mov_b32 s51,1
s_mov_b32 s52,5
s_mul_i32 s62,s51,9
s_and_b32 s63,s52,7
s_add_u32 s62,s62,s63
s_mul_i32 s62,s62,40960
s_add_u32 s62,s62,237371392
s_lshl_b32 s63,s56,11
s_add_u32 s62,s62,s63
buffer_load_dword v73,v72,s[8:11],s62 offen sc1
s_mov_b32 s51,1
s_mov_b32 s52,6
s_mul_i32 s62,s51,9
s_and_b32 s63,s52,7
s_add_u32 s62,s62,s63
s_mul_i32 s62,s62,40960
s_add_u32 s62,s62,237371392
s_lshl_b32 s63,s56,11
s_add_u32 s62,s62,s63
buffer_load_dword v73,v72,s[8:11],s62 offen sc1
s_mov_b32 s51,1
s_mov_b32 s52,7
s_mul_i32 s62,s51,9
s_and_b32 s63,s52,7
s_add_u32 s62,s62,s63
s_mul_i32 s62,s62,40960
s_add_u32 s62,s62,237371392
s_lshl_b32 s63,s56,11
s_add_u32 s62,s62,s63
buffer_load_dword v73,v72,s[8:11],s62 offen sc1
s_waitcnt vmcnt(0)
s_waitcnt lgkmcnt(0)
s_barrier
s_mov_b32 s83,s100
s_min_u32 s62,s32,127
s_sub_u32 s60,s62,15
s_lshr_b32 s34,s60,1
s_and_b32 s33,s60,1
s_cmp_eq_u32 s33,0
s_cselect_b32 s61,15,0
s_add_u32 s34,s34,s61
s_sub_u32 s61,s60,49
s_cmp_ge_u32 s60,98
s_cselect_b32 s34,s61,s34
s_cselect_b32 s33,1,s33
s_cmp_lt_u32 s62,15
s_cselect_b32 s34,s62,s34
s_cselect_b32 s33,0,s33
s_lshl_b32 s35,s33,6
s_add_u32 s35,s35,s34
s_lshl_b32 s35,s35,9
s_add_u32 s35,s35,393216
s_cmp_lt_u32 s34,7
s_cselect_b64 s[76:77],s[78:79],-1
s_sub_u32 s57,46080,s57
v_swap_b32 v16,v18
v_swap_b32 v17,v19
s_add_u32 s62,s32,1
s_min_u32 s62,s62,127
s_sub_u32 s60,s62,15
s_lshr_b32 s41,s60,1
s_and_b32 s40,s60,1
s_cmp_eq_u32 s40,0
s_cselect_b32 s61,15,0
s_add_u32 s41,s41,s61
s_sub_u32 s61,s60,49
s_cmp_ge_u32 s60,98
s_cselect_b32 s41,s61,s41
s_cselect_b32 s40,1,s40
s_cmp_lt_u32 s62,15
s_cselect_b32 s41,s62,s41
s_cselect_b32 s40,0,s40
s_lshl_b32 s42,s40,6
s_add_u32 s42,s42,s41
s_lshl_b32 s42,s42,9
s_add_u32 s42,s42,393216
s_cmp_lt_u32 s41,7
s_cselect_b64 s[80:81],s[78:79],-1
W1_COLD:
s_mov_b32 s37,0
s_cmp_lg_u32 s46,0
s_cbranch_scc1 wo_268
fb_270:
buffer_load_dword v3,v2,s[8:11],s35 offen sc1
s_waitcnt vmcnt(0)
v_cmp_eq_u32 vcc,0,v3
s_and_b64 vcc,vcc,s[76:77]
s_cbranch_scc0 ok_271
s_sleep 3
s_sub_u32 s47,s47,1
s_cbranch_scc1 ABORT
s_branch fb_270
ok_271:
W1_COLD2:
s_add_u32 s65,s32,1
s_or_b32 s65,s65,s37
v_mov_b32 v23,s65
ds_max_i32 v22,v23
s_branch wd_269
wo_268:
ds_read_b32 v23,v22
s_waitcnt lgkmcnt(0)
v_cmp_ge_u32 vcc,s32,v23
s_nop 0
s_cbranch_vccz wd_269
s_sleep 1
s_sub_u32 s39,s39,1
s_cbranch_scc1 ABORT
s_branch wo_268
wd_269:
buffer_load_dword v3,v2,s[8:11],s42 offen sc1
s_sub_u32 s66,46080,s57
s_lshl_b32 s60,s33,6
s_add_u32 s60,s60,s34
s_mul_i32 s60,s60,46080
s_add_u32 s60,s60,s37
s_add_u32 s60,s60,223608832
s_mov_b32 s67,s60
s_mul_i32 s61,s46,10240
s_add_u32 s60,s60,s61
s_add_u32 s61,s61,s66
s_add_u32 m0,s61,0
s_add_u32 s63,s60,0
buffer_load_dwordx4 v1,s[8:11],s63 offen sc1 lds
buffer_load_dwordx4 v1,s[8:11],s63 offen offset:1024 sc1 lds
buffer_load_dwordx4 v1,s[8:11],s63 offen offset:2048 sc1 lds
buffer_load_dwordx4 v1,s[8:11],s63 offen offset:3072 sc1 lds
s_add_u32 m0,s61,4096
s_add_u32 s63,s60,4096
buffer_load_dwordx4 v1,s[8:11],s63 offen sc1 lds
buffer_load_dwordx4 v1,s[8:11],s63 offen offset:1024 sc1 lds
s_waitcnt vmcnt(7)
s_mov_b64 exec,1
s_cmp_lg_u32 s49,0
s_cbranch_scc0 ls_272
buffer_store_dword v5,v1,s[8:11],s59 offen sc1
s_branch ls_273
ls_272:
buffer_store_dword v5,v1,s[8:11],s59 offen
ls_273:
s_mov_b64 exec,-1
s_mov_b32 s59,2147483648
buffer_load_dwordx4 v1,s[8:11],s63 offen offset:2048 sc1 lds
buffer_load_dwordx4 v1,s[8:11],s63 offen offset:3072 sc1 lds
s_add_u32 m0,s61,8192
s_add_u32 s63,s60,8192
buffer_load_dwordx4 v1,s[8:11],s63 offen sc1 lds
buffer_load_dwordx4 v1,s[8:11],s63 offen offset:1024 sc1 lds
s_add_u32 m0,s66,40960
s_add_u32 s63,s67,40960
buffer_load_dwordx4 v1,s[8:11],s63 offen sc1 lds
s_mov_b32 s35,s42
s_mov_b32 s53,s33
s_mov_b32 s54,s34
s_add_u32 s32,s32,1
s_mov_b32 s33,s40
s_mov_b32 s34,s41
s_mov_b64 s[76:77],s[80:81]
s_sub_u32 s57,46080,s57
v_swap_b32 v16,v18
v_swap_b32 v17,v19
s_mov_b32 s51,s53
s_mov_b32 s52,s54
s_waitcnt vmcnt(6)
v_cmp_eq_u32 vcc,0,v3
s_and_b64 vcc,vcc,s[76:77]
s_cselect_b32 s37,2147483648,0
s_cmp_lt_u32 s32,128
s_cselect_b32 s37,s37,2147483648
s_branch W1_GO
W1_NEXT:
s_sub_u32 s57,46080,s57
v_swap_b32 v16,v18
v_swap_b32 v17,v19
s_mov_b32 s51,s53
s_mov_b32 s52,s54
s_waitcnt vmcnt(2)
v_cmp_eq_u32 vcc,0,v3
s_and_b64 vcc,vcc,s[76:77]
s_cselect_b32 s37,2147483648,0
s_cmp_lt_u32 s32,128
s_cselect_b32 s37,s37,2147483648
W1_GO:
s_barrier
ds_read_b128 v[24:27],v16 offset:0
ds_read_b128 v[28:31],v17 offset:0
ds_read_b128 v[32:35],v16 offset:10240
ds_read_b128 v[36:39],v17 offset:10240
ds_read_b128 v[40:43],v16 offset:20480
ds_read_b128 v[44:47],v17 offset:20480
ds_read_b128 v[48:51],v16 offset:30720
s_waitcnt lgkmcnt(6)
v_mfma_f32_32x32x16_bf16 v[56:71],a[0:3],v[24:27],0
ds_read_b128 v[52:55],v17 offset:30720
s_lshl_b32 s60,s51,6
s_add_u32 s60,s60,s52
s_mul_i32 s60,s60,40960
s_waitcnt lgkmcnt(6)
v_mfma_f32_32x32x16_bf16 v[56:71],a[4:7],v[28:31],v[56:71]
ds_read_b128 v[24:27],v16 offset:2048
s_lshl_b32 s61,s56,11
s_add_u32 s60,s60,s61
s_add_u32 s60,s60,218365952
s_waitcnt lgkmcnt(5)
v_mfma_f32_32x32x16_bf16 v[56:71],a[40:43],v[32:35],v[56:71]
ds_read_b128 v[28:31],v17 offset:2048
buffer_load_dword v73,v72,s[8:11],s60 offen sc1
s_add_u32 s65,s32,1
s_or_b32 s65,s65,s37
v_mfma_f32_32x32x16_bf16 v[56:71],a[44:47],v[36:39],v[56:71]
ds_read_b128 v[32:35],v16 offset:12288
v_mov_b32 v23,s65
ds_max_i32 v22,v23
s_waitcnt lgkmcnt(6)
v_mfma_f32_32x32x16_bf16 v[56:71],a[80:83],v[40:43],v[56:71]
ds_read_b128 v[36:39],v17 offset:12288
s_sub_u32 s66,46080,s57
s_lshl_b32 s60,s33,6
s_add_u32 s60,s60,s34
s_mul_i32 s60,s60,46080
v_mfma_f32_32x32x16_bf16 v[56:71],a[84:87],v[44:47],v[56:71]
ds_read_b128 v[40:43],v16 offset:22528
s_add_u32 s60,s60,s37
s_add_u32 s60,s60,223608832
s_mov_b32 s67,s60
s_waitcnt lgkmcnt(6)
v_mfma_f32_32x32x16_bf16 v[56:71],a[120:123],v[48:51],v[56:71]
ds_read_b128 v[44:47],v17 offset:22528
s_mul_i32 s61,s46,10240
s_add_u32 s60,s60,s61
s_add_u32 s61,s61,s66
s_add_u32 m0,s61,0
v_mfma_f32_32x32x16_bf16 v[56:71],a[124:127],v[52:55],v[56:71]
ds_read_b128 v[48:51],v16 offset:32768
s_add_u32 s63,s60,0
buffer_load_dwordx4 v1,s[8:11],s63 offen sc1 lds
s_waitcnt lgkmcnt(6)
v_mfma_f32_32x32x16_bf16 v[56:71],a[8:11],v[24:27],v[56:71]
ds_read_b128 v[52:55],v17 offset:32768
s_mul_i32 s71,s51,9
s_and_b32 s72,s52,7
s_add_u32 s71,s71,s72
s_mul_i32 s71,s71,40960
v_mfma_f32_32x32x16_bf16 v[56:71],a[12:15],v[28:31],v[56:71]
ds_read_b128 v[24:27],v16 offset:4096
s_add_u32 s71,s71,237371392
s_lshl_b32 s72,s56,11
s_add_u32 s71,s71,s72
s_waitcnt lgkmcnt(5)
v_mfma_f32_32x32x16_bf16 v[56:71],a[48:51],v[32:35],v[56:71]
ds_read_b128 v[28:31],v17 offset:4096
buffer_load_dword v3,v2,s[8:11],s35 offen sc1
s_lshl_b32 s82,s51,6
v_mfma_f32_32x32x16_bf16 v[56:71],a[52:55],v[36:39],v[56:71]
ds_read_b128 v[32:35],v16 offset:14336
buffer_load_dwordx4 v1,s[8:11],s63 offen offset:1024 sc1 lds
s_add_u32 s82,s82,s52
s_waitcnt lgkmcnt(5)
v_mfma_f32_32x32x16_bf16 v[56:71],a[88:91],v[40:43],v[56:71]
ds_read_b128 v[36:39],v17 offset:14336
s_waitcnt vmcnt(4)
s_mov_b64 exec,1
s_cmp_lg_u32 s49,0
s_cbranch_scc0 ls_274
buffer_store_dword v5,v1,s[8:11],s59 offen sc1
s_branch ls_275
ls_274:
buffer_store_dword v5,v1,s[8:11],s59 offen
ls_275:
s_mov_b64 exec,-1
s_mov_b32 s59,2147483648
v_mfma_f32_32x32x16_bf16 v[56:71],a[92:95],v[44:47],v[56:71]
ds_read_b128 v[40:43],v16 offset:24576
s_lshl_b32 s82,s82,9
s_add_u32 s82,s82,458752
s_lshl_b32 s70,s56,2
s_waitcnt lgkmcnt(5)
v_mfma_f32_32x32x16_bf16 v[56:71],a[128:131],v[48:51],v[56:71]
ds_read_b128 v[44:47],v17 offset:24576
buffer_load_dwordx4 v1,s[8:11],s63 offen offset:2048 sc1 lds
s_add_u32 s82,s82,s70
v_mfma_f32_32x32x16_bf16 v[56:71],a[132:135],v[52:55],v[56:71]
ds_read_b128 v[48:51],v16 offset:34816
s_waitcnt lgkmcnt(5)
v_mfma_f32_32x32x16_bf16 v[56:71],a[16:19],v[24:27],v[56:71]
ds_read_b128 v[52:55],v17 offset:34816
s_barrier
v_mfma_f32_32x32x16_bf16 v[56:71],a[20:23],v[28:31],v[56:71]
ds_read_b128 v[24:27],v16 offset:6144
v_add_u32 v183,s57,v182
buffer_load_dwordx4 v1,s[8:11],s63 offen offset:3072 sc1 lds
s_waitcnt lgkmcnt(5)
v_mfma_f32_32x32x16_bf16 v[56:71],a[56:59],v[32:35],v[56:71]
ds_read_b128 v[28:31],v17 offset:6144
ds_read_b64 v[180:181],v183
s_add_u32 m0,s61,4096
s_add_u32 s63,s60,4096
v_mfma_f32_32x32x16_bf16 v[56:71],a[60:63],v[36:39],v[56:71]
ds_read_b128 v[32:35],v16 offset:16384
s_waitcnt lgkmcnt(6)
v_mfma_f32_32x32x16_bf16 v[56:71],a[96:99],v[40:43],v[56:71]
ds_read_b128 v[36:39],v17 offset:16384
buffer_load_dwordx4 v1,s[8:11],s63 offen sc1 lds
v_mfma_f32_32x32x16_bf16 v[56:71],a[100:103],v[44:47],v[56:71]
ds_read_b128 v[40:43],v16 offset:26624
s_waitcnt lgkmcnt(6)
v_mfma_f32_32x32x16_bf16 v[56:71],a[136:139],v[48:51],v[56:71]
ds_read_b128 v[44:47],v17 offset:26624
v_mfma_f32_32x32x16_bf16 v[56:71],a[140:143],v[52:55],v[56:71]
ds_read_b128 v[48:51],v16 offset:36864
buffer_load_dwordx4 v1,s[8:11],s63 offen offset:1024 sc1 lds
s_waitcnt lgkmcnt(6)
v_mfma_f32_32x32x16_bf16 v[56:71],a[24:27],v[24:27],v[56:71]
ds_read_b128 v[52:55],v17 offset:36864
v_mfma_f32_32x32x16_bf16 v[56:71],a[28:31],v[28:31],v[56:71]
ds_read_b128 v[24:27],v16 offset:8192
s_waitcnt lgkmcnt(5)
v_mfma_f32_32x32x16_bf16 v[56:71],a[64:67],v[32:35],v[56:71]
ds_read_b128 v[28:31],v17 offset:8192
buffer_load_dwordx4 v1,s[8:11],s63 offen offset:2048 sc1 lds
v_mfma_f32_32x32x16_bf16 v[56:71],a[68:71],v[36:39],v[56:71]
ds_read_b128 v[32:35],v16 offset:18432
s_waitcnt lgkmcnt(5)
v_mfma_f32_32x32x16_bf16 v[56:71],a[104:107],v[40:43],v[56:71]
ds_read_b128 v[36:39],v17 offset:18432
v_mfma_f32_32x32x16_bf16 v[56:71],a[108:111],v[44:47],v[56:71]
ds_read_b128 v[40:43],v16 offset:28672
buffer_load_dwordx4 v1,s[8:11],s63 offen offset:3072 sc1 lds
s_add_u32 m0,s61,8192
s_waitcnt lgkmcnt(5)
v_mfma_f32_32x32x16_bf16 v[56:71],a[144:147],v[48:51],v[56:71]
ds_read_b128 v[44:47],v17 offset:28672
s_add_u32 s63,s60,8192
v_mfma_f32_32x32x16_bf16 v[56:71],a[148:151],v[52:55],v[56:71]
ds_read_b128 v[48:51],v16 offset:38912
s_waitcnt lgkmcnt(5)
v_mfma_f32_32x32x16_bf16 v[56:71],a[32:35],v[24:27],v[56:71]
ds_read_b128 v[52:55],v17 offset:38912
buffer_load_dwordx4 v1,s[8:11],s63 offen sc1 lds
v_mfma_f32_32x32x16_bf16 v[56:71],a[36:39],v[28:31],v[56:71]
s_waitcnt lgkmcnt(4)
v_mfma_f32_32x32x16_bf16 v[56:71],a[72:75],v[32:35],v[56:71]
v_mfma_f32_32x32x16_bf16 v[56:71],a[76:79],v[36:39],v[56:71]
buffer_load_dwordx4 v1,s[8:11],s63 offen offset:1024 sc1 lds
s_add_u32 m0,s66,40960
s_add_u32 s63,s67,40960
s_waitcnt lgkmcnt(2)
v_mfma_f32_32x32x16_bf16 v[56:71],a[112:115],v[40:43],v[56:71]
v_mfma_f32_32x32x16_bf16 v[56:71],a[116:119],v[44:47],v[56:71]
s_waitcnt lgkmcnt(0)
v_mfma_f32_32x32x16_bf16 v[56:71],a[152:155],v[48:51],v[56:71]
buffer_load_dwordx4 v1,s[8:11],s63 offen sc1 lds
s_add_u32 s62,s32,1
s_min_u32 s62,s62,127
s_sub_u32 s60,s62,15
s_lshr_b32 s41,s60,1
v_mfma_f32_32x32x16_bf16 v[56:71],a[156:159],v[52:55],v[56:71]
s_and_b32 s40,s60,1
s_cmp_eq_u32 s40,0
s_cselect_b32 s61,15,0
s_add_u32 s41,s41,s61
s_sub_u32 s61,s60,49
s_cmp_ge_u32 s60,98
s_cselect_b32 s41,s61,s41
s_cselect_b32 s40,1,s40
s_cmp_lt_u32 s62,15
s_cselect_b32 s41,s62,s41
s_cselect_b32 s40,0,s40
s_lshl_b32 s42,s40,6
s_add_u32 s42,s42,s41
s_lshl_b32 s42,s42,9
s_add_u32 s42,s42,393216
s_cmp_lt_u32 s41,7
s_cselect_b64 s[80:81],s[78:79],-1
s_cmp_eq_u32 s37,0
s_cbranch_scc0 sec_278
s_mov_b32 s35,s42
buffer_load_dword v3,v2,s[8:11],s35 offen sc1
s_mov_b32 s53,s33
s_mov_b32 s54,s34
s_add_u32 s32,s32,1
s_mov_b32 s33,s40
s_mov_b32 s34,s41
s_mov_b64 s[76:77],s[80:81]
s_nop 2
ep_276:
v_pk_fma_f32 v[56:57],v[144:145],v[180:181],v[56:57] op_sel_hi:[1,0,1] neg_lo:[0,1,0] neg_hi:[0,1,0]
v_pk_fma_f32 v[58:59],v[146:147],v[180:181],v[58:59] op_sel_hi:[1,0,1] neg_lo:[0,1,0] neg_hi:[0,1,0]
v_pk_fma_f32 v[60:61],v[148:149],v[180:181],v[60:61] op_sel_hi:[1,0,1] neg_lo:[0,1,0] neg_hi:[0,1,0]
v_pk_fma_f32 v[62:63],v[150:151],v[180:181],v[62:63] op_sel_hi:[1,0,1] neg_lo:[0,1,0] neg_hi:[0,1,0]
v_pk_fma_f32 v[64:65],v[152:153],v[180:181],v[64:65] op_sel_hi:[1,0,1] neg_lo:[0,1,0] neg_hi:[0,1,0]
v_pk_fma_f32 v[66:67],v[154:155],v[180:181],v[66:67] op_sel_hi:[1,0,1] neg_lo:[0,1,0] neg_hi:[0,1,0]
v_pk_fma_f32 v[68:69],v[156:157],v[180:181],v[68:69] op_sel_hi:[1,0,1] neg_lo:[0,1,0] neg_hi:[0,1,0]
v_pk_fma_f32 v[70:71],v[158:159],v[180:181],v[70:71] op_sel_hi:[1,0,1] neg_lo:[0,1,0] neg_hi:[0,1,0]
v_pk_mul_f32 v[56:57],v[56:57],v[180:181] op_sel:[0,1] op_sel_hi:[1,1]
v_pk_mul_f32 v[58:59],v[58:59],v[180:181] op_sel:[0,1] op_sel_hi:[1,1]
v_pk_mul_f32 v[60:61],v[60:61],v[180:181] op_sel:[0,1] op_sel_hi:[1,1]
v_pk_mul_f32 v[62:63],v[62:63],v[180:181] op_sel:[0,1] op_sel_hi:[1,1]
v_pk_mul_f32 v[64:65],v[64:65],v[180:181] op_sel:[0,1] op_sel_hi:[1,1]
v_pk_mul_f32 v[66:67],v[66:67],v[180:181] op_sel:[0,1] op_sel_hi:[1,1]
v_pk_mul_f32 v[68:69],v[68:69],v[180:181] op_sel:[0,1] op_sel_hi:[1,1]
v_pk_mul_f32 v[70:71],v[70:71],v[180:181] op_sel:[0,1] op_sel_hi:[1,1]
v_pk_mul_f32 v[124:125],v[56:57],v[56:57]
v_pk_mul_f32 v[126:127],v[58:59],v[58:59]
v_pk_mul_f32 v[128:129],v[60:61],v[60:61]
v_pk_mul_f32 v[130:131],v[62:63],v[62:63]
v_pk_mul_f32 v[132:133],v[64:65],v[64:65]
v_pk_mul_f32 v[134:135],v[66:67],v[66:67]
v_pk_mul_f32 v[136:137],v[68:69],v[68:69]
v_pk_mul_f32 v[138:139],v[70:71],v[70:71]
v_pk_fma_f32 v[124:125],v[124:125],v[112:113],v[112:113] op_sel:[0,1,0] op_sel_hi:[1,1,0]
v_pk_fma_f32 v[126:127],v[126:127],v[112:113],v[112:113] op_sel:[0,1,0] op_sel_hi:[1,1,0]
v_pk_fma_f32 v[128:129],v[128:129],v[112:113],v[112:113] op_sel:[0,1,0] op_sel_hi:[1,1,0]
v_pk_fma_f32 v[130:131],v[130:131],v[112:113],v[112:113] op_sel:[0,1,0] op_sel_hi:[1,1,0]
v_pk_fma_f32 v[132:133],v[132:133],v[112:113],v[112:113] op_sel:[0,1,0] op_sel_hi:[1,1,0]
v_pk_fma_f32 v[134:135],v[134:135],v[112:113],v[112:113] op_sel:[0,1,0] op_sel_hi:[1,1,0]
v_pk_fma_f32 v[136:137],v[136:137],v[112:113],v[112:113] op_sel:[0,1,0] op_sel_hi:[1,1,0]
v_pk_fma_f32 v[138:139],v[138:139],v[112:113],v[112:113] op_sel:[0,1,0] op_sel_hi:[1,1,0]
v_pk_mul_f32 v[124:125],v[124:125],v[56:57]
v_pk_mul_f32 v[126:127],v[126:127],v[58:59]
v_pk_mul_f32 v[128:129],v[128:129],v[60:61]
v_pk_mul_f32 v[130:131],v[130:131],v[62:63]
v_pk_mul_f32 v[132:133],v[132:133],v[64:65]
v_pk_mul_f32 v[134:135],v[134:135],v[66:67]
v_pk_mul_f32 v[136:137],v[136:137],v[68:69]
v_pk_mul_f32 v[138:139],v[138:139],v[70:71]
v_exp_f32 v124,v124
v_exp_f32 v125,v125
v_exp_f32 v126,v126
v_exp_f32 v127,v127
v_exp_f32 v128,v128
v_exp_f32 v129,v129
v_exp_f32 v130,v130
v_exp_f32 v131,v131
v_exp_f32 v132,v132
v_exp_f32 v133,v133
v_exp_f32 v134,v134
v_exp_f32 v135,v135
v_exp_f32 v136,v136
v_exp_f32 v137,v137
v_exp_f32 v138,v138
v_exp_f32 v139,v139
v_pk_add_f32 v[124:125],v[124:125],1.0 op_sel_hi:[1,0]
v_pk_add_f32 v[126:127],v[126:127],1.0 op_sel_hi:[1,0]
v_pk_add_f32 v[128:129],v[128:129],1.0 op_sel_hi:[1,0]
v_pk_add_f32 v[130:131],v[130:131],1.0 op_sel_hi:[1,0]
v_pk_add_f32 v[132:133],v[132:133],1.0 op_sel_hi:[1,0]
v_pk_add_f32 v[134:135],v[134:135],1.0 op_sel_hi:[1,0]
v_pk_add_f32 v[136:137],v[136:137],1.0 op_sel_hi:[1,0]
v_pk_add_f32 v[138:139],v[138:139],1.0 op_sel_hi:[1,0]
v_rcp_f32 v124,v124
v_rcp_f32 v125,v125
v_rcp_f32 v126,v126
v_rcp_f32 v127,v127
v_rcp_f32 v128,v128
v_rcp_f32 v129,v129
v_rcp_f32 v130,v130
v_rcp_f32 v131,v131
v_rcp_f32 v132,v132
v_rcp_f32 v133,v133
v_rcp_f32 v134,v134
v_rcp_f32 v135,v135
v_rcp_f32 v136,v136
v_rcp_f32 v137,v137
v_rcp_f32 v138,v138
v_rcp_f32 v139,v139
v_pk_mul_f32 v[56:57],v[56:57],v[124:125]
v_pk_mul_f32 v[58:59],v[58:59],v[126:127]
v_pk_mul_f32 v[60:61],v[60:61],v[128:129]
v_pk_mul_f32 v[62:63],v[62:63],v[130:131]
v_pk_mul_f32 v[64:65],v[64:65],v[132:133]
v_pk_mul_f32 v[66:67],v[66:67],v[134:135]
v_pk_mul_f32 v[68:69],v[68:69],v[136:137]
v_pk_mul_f32 v[70:71],v[70:71],v[138:139]
v_cvt_pk_bf16_f32 v116,v56,v57
v_cvt_pk_bf16_f32 v117,v58,v59
v_cvt_pk_bf16_f32 v118,v60,v61
v_cvt_pk_bf16_f32 v119,v62,v63
v_cvt_pk_bf16_f32 v120,v64,v65
v_cvt_pk_bf16_f32 v121,v66,v67
v_cvt_pk_bf16_f32 v122,v68,v69
v_cvt_pk_bf16_f32 v123,v70,v71
s_cmp_lg_u32 s49,0
s_cbranch_scc0 ls_279
buffer_store_dwordx4 v[116:119],v20,s[8:11],s71 offen sc1
buffer_store_dwordx4 v[120:123],v21,s[8:11],s71 offen sc1
s_branch ls_280
ls_279:
buffer_store_dwordx4 v[116:119],v20,s[8:11],s71 offen
buffer_store_dwordx4 v[120:123],v21,s[8:11],s71 offen
ls_280:
s_mov_b32 s59,s82
s_cmp_eq_u32 s37,0
s_cbranch_scc1 W1_NEXT
s_waitcnt vmcnt(2)
v_cmp_eq_u32 vcc,0,v3
s_and_b64 vcc,vcc,s[76:77]
s_cselect_b32 s37,2147483648,0
s_cmp_lt_u32 s32,128
s_cselect_b32 s37,s37,2147483648
s_cmp_eq_u32 s37,0
s_cbranch_scc1 W1_COLD2
s_waitcnt vmcnt(0)
s_mov_b64 exec,1
s_cmp_lg_u32 s49,0
s_cbranch_scc0 ls_281
buffer_store_dword v5,v1,s[8:11],s59 offen sc1
s_branch ls_282
ls_281:
buffer_store_dword v5,v1,s[8:11],s59 offen
ls_282:
s_mov_b64 exec,-1
s_mov_b32 s59,2147483648
s_cmp_lt_u32 s32,128
s_cbranch_scc1 W1_COLD
s_branch W1_END
sec_278:
s_waitcnt vmcnt(11)
v_cmp_eq_u32 vcc,0,v3
s_and_b64 vcc,vcc,s[76:77]
s_cselect_b32 s37,2147483648,0
s_cmp_lt_u32 s32,128
s_cselect_b32 s37,s37,2147483648
s_cmp_lg_u32 s37,0
s_cbranch_scc1 nr_277
s_add_u32 s65,s32,1
s_or_b32 s65,s65,s37
v_mov_b32 v23,s65
ds_max_i32 v22,v23
s_sub_u32 s66,46080,s57
s_lshl_b32 s60,s33,6
s_add_u32 s60,s60,s34
s_mul_i32 s60,s60,46080
s_add_u32 s60,s60,s37
s_add_u32 s60,s60,223608832
s_mov_b32 s67,s60
s_mul_i32 s61,s46,10240
s_add_u32 s60,s60,s61
s_add_u32 s61,s61,s66
s_add_u32 m0,s61,0
s_add_u32 s63,s60,0
buffer_load_dwordx4 v1,s[8:11],s63 offen sc1 lds
v_pk_fma_f32 v[56:57],v[144:145],v[180:181],v[56:57] op_sel_hi:[1,0,1] neg_lo:[0,1,0] neg_hi:[0,1,0]
v_pk_fma_f32 v[58:59],v[146:147],v[180:181],v[58:59] op_sel_hi:[1,0,1] neg_lo:[0,1,0] neg_hi:[0,1,0]
v_pk_fma_f32 v[60:61],v[148:149],v[180:181],v[60:61] op_sel_hi:[1,0,1] neg_lo:[0,1,0] neg_hi:[0,1,0]
v_pk_fma_f32 v[62:63],v[150:151],v[180:181],v[62:63] op_sel_hi:[1,0,1] neg_lo:[0,1,0] neg_hi:[0,1,0]
v_pk_fma_f32 v[64:65],v[152:153],v[180:181],v[64:65] op_sel_hi:[1,0,1] neg_lo:[0,1,0] neg_hi:[0,1,0]
v_pk_fma_f32 v[66:67],v[154:155],v[180:181],v[66:67] op_sel_hi:[1,0,1] neg_lo:[0,1,0] neg_hi:[0,1,0]
v_pk_fma_f32 v[68:69],v[156:157],v[180:181],v[68:69] op_sel_hi:[1,0,1] neg_lo:[0,1,0] neg_hi:[0,1,0]
buffer_load_dwordx4 v1,s[8:11],s63 offen offset:1024 sc1 lds
v_pk_fma_f32 v[70:71],v[158:159],v[180:181],v[70:71] op_sel_hi:[1,0,1] neg_lo:[0,1,0] neg_hi:[0,1,0]
v_pk_mul_f32 v[56:57],v[56:57],v[180:181] op_sel:[0,1] op_sel_hi:[1,1]
v_pk_mul_f32 v[58:59],v[58:59],v[180:181] op_sel:[0,1] op_sel_hi:[1,1]
v_pk_mul_f32 v[60:61],v[60:61],v[180:181] op_sel:[0,1] op_sel_hi:[1,1]
v_pk_mul_f32 v[62:63],v[62:63],v[180:181] op_sel:[0,1] op_sel_hi:[1,1]
v_pk_mul_f32 v[64:65],v[64:65],v[180:181] op_sel:[0,1] op_sel_hi:[1,1]
v_pk_mul_f32 v[66:67],v[66:67],v[180:181] op_sel:[0,1] op_sel_hi:[1,1]
buffer_load_dwordx4 v1,s[8:11],s63 offen offset:2048 sc1 lds
v_pk_mul_f32 v[68:69],v[68:69],v[180:181] op_sel:[0,1] op_sel_hi:[1,1]
v_pk_mul_f32 v[70:71],v[70:71],v[180:181] op_sel:[0,1] op_sel_hi:[1,1]
v_pk_mul_f32 v[124:125],v[56:57],v[56:57]
v_pk_mul_f32 v[126:127],v[58:59],v[58:59]
v_pk_mul_f32 v[128:129],v[60:61],v[60:61]
v_pk_mul_f32 v[130:131],v[62:63],v[62:63]
v_pk_mul_f32 v[132:133],v[64:65],v[64:65]
buffer_load_dwordx4 v1,s[8:11],s63 offen offset:3072 sc1 lds
v_pk_mul_f32 v[134:135],v[66:67],v[66:67]
v_pk_mul_f32 v[136:137],v[68:69],v[68:69]
v_pk_mul_f32 v[138:139],v[70:71],v[70:71]
v_pk_fma_f32 v[124:125],v[124:125],v[112:113],v[112:113] op_sel:[0,1,0] op_sel_hi:[1,1,0]
v_pk_fma_f32 v[126:127],v[126:127],v[112:113],v[112:113] op_sel:[0,1,0] op_sel_hi:[1,1,0]
v_pk_fma_f32 v[128:129],v[128:129],v[112:113],v[112:113] op_sel:[0,1,0] op_sel_hi:[1,1,0]
v_pk_fma_f32 v[130:131],v[130:131],v[112:113],v[112:113] op_sel:[0,1,0] op_sel_hi:[1,1,0]
s_add_u32 m0,s61,4096
s_add_u32 s63,s60,4096
buffer_load_dwordx4 v1,s[8:11],s63 offen sc1 lds
v_pk_fma_f32 v[132:133],v[132:133],v[112:113],v[112:113] op_sel:[0,1,0] op_sel_hi:[1,1,0]
v_pk_fma_f32 v[134:135],v[134:135],v[112:113],v[112:113] op_sel:[0,1,0] op_sel_hi:[1,1,0]
v_pk_fma_f32 v[136:137],v[136:137],v[112:113],v[112:113] op_sel:[0,1,0] op_sel_hi:[1,1,0]
v_pk_fma_f32 v[138:139],v[138:139],v[112:113],v[112:113] op_sel:[0,1,0] op_sel_hi:[1,1,0]
v_pk_mul_f32 v[124:125],v[124:125],v[56:57]
v_pk_mul_f32 v[126:127],v[126:127],v[58:59]
v_pk_mul_f32 v[128:129],v[128:129],v[60:61]
buffer_load_dwordx4 v1,s[8:11],s63 offen offset:1024 sc1 lds
v_pk_mul_f32 v[130:131],v[130:131],v[62:63]
v_pk_mul_f32 v[132:133],v[132:133],v[64:65]
v_pk_mul_f32 v[134:135],v[134:135],v[66:67]
v_pk_mul_f32 v[136:137],v[136:137],v[68:69]
v_pk_mul_f32 v[138:139],v[138:139],v[70:71]
v_exp_f32 v124,v124
v_exp_f32 v125,v125
buffer_load_dwordx4 v1,s[8:11],s63 offen offset:2048 sc1 lds
v_exp_f32 v126,v126
v_exp_f32 v127,v127
v_exp_f32 v128,v128
v_exp_f32 v129,v129
v_exp_f32 v130,v130
v_exp_f32 v131,v131
v_exp_f32 v132,v132
buffer_load_dwordx4 v1,s[8:11],s63 offen offset:3072 sc1 lds
v_exp_f32 v133,v133
v_exp_f32 v134,v134
v_exp_f32 v135,v135
v_exp_f32 v136,v136
v_exp_f32 v137,v137
v_exp_f32 v138,v138
v_exp_f32 v139,v139
s_add_u32 m0,s61,8192
s_add_u32 s63,s60,8192
buffer_load_dwordx4 v1,s[8:11],s63 offen sc1 lds
v_pk_add_f32 v[124:125],v[124:125],1.0 op_sel_hi:[1,0]
v_pk_add_f32 v[126:127],v[126:127],1.0 op_sel_hi:[1,0]
v_pk_add_f32 v[128:129],v[128:129],1.0 op_sel_hi:[1,0]
v_pk_add_f32 v[130:131],v[130:131],1.0 op_sel_hi:[1,0]
v_pk_add_f32 v[132:133],v[132:133],1.0 op_sel_hi:[1,0]
v_pk_add_f32 v[134:135],v[134:135],1.0 op_sel_hi:[1,0]
v_pk_add_f32 v[136:137],v[136:137],1.0 op_sel_hi:[1,0]
buffer_load_dwordx4 v1,s[8:11],s63 offen offset:1024 sc1 lds
v_pk_add_f32 v[138:139],v[138:139],1.0 op_sel_hi:[1,0]
v_rcp_f32 v124,v124
v_rcp_f32 v125,v125
v_rcp_f32 v126,v126
v_rcp_f32 v127,v127
v_rcp_f32 v128,v128
v_rcp_f32 v129,v129
s_add_u32 m0,s66,40960
s_add_u32 s63,s67,40960
buffer_load_dwordx4 v1,s[8:11],s63 offen sc1 lds
v_rcp_f32 v130,v130
v_rcp_f32 v131,v131
v_rcp_f32 v132,v132
v_rcp_f32 v133,v133
v_rcp_f32 v134,v134
v_rcp_f32 v135,v135
v_rcp_f32 v136,v136
s_mov_b32 s35,s42
buffer_load_dword v3,v2,s[8:11],s35 offen sc1
s_mov_b32 s53,s33
s_mov_b32 s54,s34
s_add_u32 s32,s32,1
s_mov_b32 s33,s40
s_mov_b32 s34,s41
s_mov_b64 s[76:77],s[80:81]
v_rcp_f32 v137,v137
v_rcp_f32 v138,v138
v_rcp_f32 v139,v139
v_pk_mul_f32 v[56:57],v[56:57],v[124:125]
v_pk_mul_f32 v[58:59],v[58:59],v[126:127]
v_pk_mul_f32 v[60:61],v[60:61],v[128:129]
v_pk_mul_f32 v[62:63],v[62:63],v[130:131]
v_pk_mul_f32 v[64:65],v[64:65],v[132:133]
v_pk_mul_f32 v[66:67],v[66:67],v[134:135]
v_pk_mul_f32 v[68:69],v[68:69],v[136:137]
v_pk_mul_f32 v[70:71],v[70:71],v[138:139]
v_cvt_pk_bf16_f32 v116,v56,v57
v_cvt_pk_bf16_f32 v117,v58,v59
v_cvt_pk_bf16_f32 v118,v60,v61
v_cvt_pk_bf16_f32 v119,v62,v63
v_cvt_pk_bf16_f32 v120,v64,v65
v_cvt_pk_bf16_f32 v121,v66,v67
v_cvt_pk_bf16_f32 v122,v68,v69
v_cvt_pk_bf16_f32 v123,v70,v71
s_cmp_lg_u32 s49,0
s_cbranch_scc0 ls_283
buffer_store_dwordx4 v[116:119],v20,s[8:11],s71 offen sc1
buffer_store_dwordx4 v[120:123],v21,s[8:11],s71 offen sc1
s_branch ls_284
ls_283:
buffer_store_dwordx4 v[116:119],v20,s[8:11],s71 offen
buffer_store_dwordx4 v[120:123],v21,s[8:11],s71 offen
ls_284:
s_mov_b32 s59,s82
s_branch W1_NEXT
nr_277:
buffer_load_dword v3,v2,s[8:11],s35 offen sc1
s_branch ep_276
W1_END:
s_endpgm
ROLE_W2:
v_lshlrev_b32 v1,4,v0
v_mov_b32 v5,1
s_lshl_b32 s56,s48,2
s_add_u32 s56,s56,s46
v_bfe_u32 v6,v0,2,2
v_lshrrev_b32 v7,4,v0
v_add_u32 v7,v6,v7
v_and_b32 v7,3,v7
v_and_b32 v15,3,v0
v_lshlrev_b32 v15,4,v15
v_lshl_add_u32 v15,v7,6,v15
v_lshl_add_u32 v15,v6,8,v15
v_lshrrev_b32 v6,5,v0
v_bfe_u32 v7,v0,4,1
v_lshlrev_b32 v16,10,v7
v_lshl_add_u32 v16,v6,8,v16
v_and_b32 v6,15,v0
v_lshl_add_u32 v16,v6,4,v16
v_add_u32 v18,40960,v16
v_lshrrev_b32 v6,5,v0
v_bfe_u32 v7,v0,4,1
v_lshlrev_b32 v20,10,v7
v_lshl_add_u32 v20,v6,8,v20
v_and_b32 v6,15,v0
v_lshl_add_u32 v20,v6,4,v20
v_lshrrev_b32 v6,5,v0
v_add_u32 v6,2,v6
v_bfe_u32 v7,v0,4,1
v_lshlrev_b32 v17,10,v7
v_lshl_add_u32 v17,v6,8,v17
v_and_b32 v6,15,v0
v_lshl_add_u32 v17,v6,4,v17
v_add_u32 v19,40960,v17
v_lshrrev_b32 v6,5,v0
v_add_u32 v6,2,v6
v_bfe_u32 v7,v0,4,1
v_lshlrev_b32 v21,10,v7
v_lshl_add_u32 v21,v6,8,v21
v_and_b32 v6,15,v0
v_lshl_add_u32 v21,v6,4,v21
v_min_u32 v2,19,v0
v_lshlrev_b32 v2,2,v2
s_lshr_b32 s60,s46,1
s_add_u32 s60,s60,1
s_sub_u32 s61,32,s60
s_add_u32 s60,s60,32
s_bitcmp1_b32 s46,0
s_cselect_b32 s60,s60,s61
v_and_b32 v6,15,v0
v_add_u32 v6,s60,v6
v_lshrrev_b32 v7,5,v6
v_mul_u32_u24 v112,40960,v7
v_bfe_u32 v7,v6,4,1
v_lshl_add_u32 v112,v7,10,v112
v_and_b32 v7,15,v6
v_lshl_add_u32 v112,v7,4,v112
v_lshrrev_b32 v7,4,v0
v_lshl_add_u32 v112,v7,8,v112
v_and_b32 v6,15,v0
v_add_u32 v6,s60,v6
v_add_u32 v6,16,v6
v_lshrrev_b32 v7,5,v6
v_mul_u32_u24 v113,40960,v7
v_bfe_u32 v7,v6,4,1
v_lshl_add_u32 v113,v7,10,v113
v_and_b32 v7,15,v6
v_lshl_add_u32 v113,v7,4,v113
v_lshrrev_b32 v7,4,v0
v_lshl_add_u32 v113,v7,8,v113
v_lshrrev_b32 v6,5,v0
v_and_b32 v7,15,v0
v_lshlrev_b32 v114,3,v7
v_lshl_add_u32 v114,v6,7,v114
v_and_b32 v114,31,v0
v_lshlrev_b32 v114,3,v114
v_lshrrev_b32 v6,5,v0
v_bfe_u32 v7,v0,4,1
v_lshlrev_b32 v116,10,v7
v_bfe_u32 v7,v0,2,2
v_lshl_add_u32 v116,v7,8,v116
v_add_u32 v6,v6,v7
v_and_b32 v6,3,v6
v_lshl_add_u32 v116,v6,6,v116
v_and_b32 v6,3,v0
v_lshl_add_u32 v116,v6,4,v116
v_lshrrev_b32 v6,5,v0
v_add_u32 v6,2,v6
v_bfe_u32 v7,v0,4,1
v_lshlrev_b32 v117,10,v7
v_bfe_u32 v7,v0,2,2
v_lshl_add_u32 v117,v7,8,v117
v_add_u32 v6,v6,v7
v_and_b32 v6,3,v6
v_lshl_add_u32 v117,v6,6,v117
v_and_b32 v6,3,v0
v_lshl_add_u32 v117,v6,4,v117
v_subrev_u32 v6,40960,v112
v_cmp_gt_u32 vcc,40960,v6
s_nop 1
v_cndmask_b32 v78,0,1,vcc
v_xor_b32 v76,1,v78
v_and_b32 v74,2047,v112
v_subrev_u32 v6,40960,v113
v_cmp_gt_u32 vcc,40960,v6
s_nop 1
v_cndmask_b32 v79,0,1,vcc
v_xor_b32 v77,1,v79
v_and_b32 v75,2047,v113
s_and_b32 s68,s46,1
s_lshl_b32 s68,s68,1
s_sub_u32 s68,s68,1
v_mov_b32 v24,-1
v_mov_b32 v25,-1
v_mov_b32 v26,-1
v_mov_b32 v27,-1
s_add_u32 s60,s48,5
s_lshl2_add_u32 s60,s60,s46
s_mul_i32 s60,s60,22528
s_add_u32 s61,s60,24117248
buffer_store_dwordx4 v[24:27],v1,s[8:11],s61 offen sc1
buffer_store_dwordx4 v[24:27],v1,s[8:11],s61 offen offset:1024 sc1
buffer_store_dwordx4 v[24:27],v1,s[8:11],s61 offen offset:2048 sc1
buffer_store_dwordx4 v[24:27],v1,s[8:11],s61 offen offset:3072 sc1
s_add_u32 s61,s60,24121344
buffer_store_dwordx4 v[24:27],v1,s[8:11],s61 offen sc1
buffer_store_dwordx4 v[24:27],v1,s[8:11],s61 offen offset:1024 sc1
buffer_store_dwordx4 v[24:27],v1,s[8:11],s61 offen offset:2048 sc1
buffer_store_dwordx4 v[24:27],v1,s[8:11],s61 offen offset:3072 sc1
s_add_u32 s61,s60,24125440
buffer_store_dwordx4 v[24:27],v1,s[8:11],s61 offen sc1
buffer_store_dwordx4 v[24:27],v1,s[8:11],s61 offen offset:1024 sc1
buffer_store_dwordx4 v[24:27],v1,s[8:11],s61 offen offset:2048 sc1
buffer_store_dwordx4 v[24:27],v1,s[8:11],s61 offen offset:3072 sc1
s_add_u32 s61,s60,24129536
buffer_store_dwordx4 v[24:27],v1,s[8:11],s61 offen sc1
buffer_store_dwordx4 v[24:27],v1,s[8:11],s61 offen offset:1024 sc1
buffer_store_dwordx4 v[24:27],v1,s[8:11],s61 offen offset:2048 sc1
buffer_store_dwordx4 v[24:27],v1,s[8:11],s61 offen offset:3072 sc1
s_add_u32 s61,s60,24133632
buffer_store_dwordx4 v[24:27],v1,s[8:11],s61 offen sc1
buffer_store_dwordx4 v[24:27],v1,s[8:11],s61 offen offset:1024 sc1
buffer_store_dwordx4 v[24:27],v1,s[8:11],s61 offen offset:2048 sc1
buffer_store_dwordx4 v[24:27],v1,s[8:11],s61 offen offset:3072 sc1
s_add_u32 s61,s60,24137728
buffer_store_dwordx4 v[24:27],v1,s[8:11],s61 offen sc1
buffer_store_dwordx4 v[24:27],v1,s[8:11],s61 offen offset:1024 sc1
s_waitcnt vmcnt(0)
s_barrier
s_cmp_lg_u32 s46,0
s_cbranch_scc1 arr_285
v_mov_b32 v6,1
s_lshl_b32 s3,s49,2
v_mov_b32 v7,s3
s_mov_b64 exec,1
buffer_atomic_add v6,v7,s[12:15],0 offen sc1
s_mov_b64 exec,-1
arr_285:
s_lshl_b32 s3,s49,2
v_mov_b32 v7,s3
s_nop 1
ibw_286:
buffer_load_dword v6,v7,s[12:15],0 offen sc1
s_waitcnt vmcnt(0)
v_cmp_ne_u32 vcc,256,v6
s_nop 0
s_cbranch_vccz ok_287
s_sleep 8
s_sub_u32 s47,s47,1
s_cbranch_scc1 ABORT
s_branch ibw_286
ok_287:
s_cmp_lg_u32 s49,0
s_cbranch_scc1 ibok_288
v_and_b32 v7,7,v0
v_lshlrev_b32 v7,2,v7
buffer_load_dword v6,v7,s[12:15],0 offen offset:32 sc1
s_waitcnt vmcnt(0)
v_cmp_ne_u32 vcc,32,v6
s_nop 0
s_cbranch_vccz ibok_288
s_barrier
s_mov_b32 s49,1
s_mov_b32 s3,s2
s_load_dwordx16 s[16:31],s[0:1],0
s_load_dwordx8 s[32:39],s[0:1],64
s_waitcnt lgkmcnt(0)
s_branch DISPATCH
ibok_288:
s_lshl_b32 s58,s56,6
s_mul_i32 s63,s46,40960
s_mov_b32 s4,s34
s_mov_b32 s5,s35
s_mov_b32 s6,819200
s_mov_b32 s7,0x20000
v_lshrrev_b32 v9,2,v0
s_mov_b32 s64,1280
v_mul_lo_u32 v9,v9,s64
v_and_b32 v10,3,v0
v_lshl_add_u32 v6,v10,4,v9
s_add_u32 m0,s63,0
s_add_u32 s65,s58,0
buffer_load_dwordx4 v6,s[4:7],s65 offen lds
s_add_u32 m0,s63,1024
s_add_u32 s65,s58,20480
buffer_load_dwordx4 v6,s[4:7],s65 offen lds
s_add_u32 m0,s63,2048
s_add_u32 s65,s58,40960
buffer_load_dwordx4 v6,s[4:7],s65 offen lds
s_add_u32 m0,s63,3072
s_add_u32 s65,s58,61440
buffer_load_dwordx4 v6,s[4:7],s65 offen lds
s_add_u32 m0,s63,4096
s_add_u32 s65,s58,81920
buffer_load_dwordx4 v6,s[4:7],s65 offen lds
s_add_u32 m0,s63,5120
s_add_u32 s65,s58,102400
buffer_load_dwordx4 v6,s[4:7],s65 offen lds
s_add_u32 m0,s63,6144
s_add_u32 s65,s58,122880
buffer_load_dwordx4 v6,s[4:7],s65 offen lds
s_add_u32 m0,s63,7168
s_add_u32 s65,s58,143360
buffer_load_dwordx4 v6,s[4:7],s65 offen lds
s_add_u32 m0,s63,8192
s_add_u32 s65,s58,163840
buffer_load_dwordx4 v6,s[4:7],s65 offen lds
s_add_u32 m0,s63,9216
s_add_u32 s65,s58,184320
buffer_load_dwordx4 v6,s[4:7],s65 offen lds
s_add_u32 m0,s63,10240
s_add_u32 s65,s58,204800
buffer_load_dwordx4 v6,s[4:7],s65 offen lds
s_add_u32 m0,s63,11264
s_add_u32 s65,s58,225280
buffer_load_dwordx4 v6,s[4:7],s65 offen lds
s_add_u32 m0,s63,12288
s_add_u32 s65,s58,245760
buffer_load_dwordx4 v6,s[4:7],s65 offen lds
s_add_u32 m0,s63,13312
s_add_u32 s65,s58,266240
buffer_load_dwordx4 v6,s[4:7],s65 offen lds
s_add_u32 m0,s63,14336
s_add_u32 s65,s58,286720
buffer_load_dwordx4 v6,s[4:7],s65 offen lds
s_add_u32 m0,s63,15360
s_add_u32 s65,s58,307200
buffer_load_dwordx4 v6,s[4:7],s65 offen lds
s_add_u32 m0,s63,16384
s_add_u32 s65,s58,327680
buffer_load_dwordx4 v6,s[4:7],s65 offen lds
s_add_u32 m0,s63,17408
s_add_u32 s65,s58,348160
buffer_load_dwordx4 v6,s[4:7],s65 offen lds
s_add_u32 m0,s63,18432
s_add_u32 s65,s58,368640
buffer_load_dwordx4 v6,s[4:7],s65 offen lds
s_add_u32 m0,s63,19456
s_add_u32 s65,s58,389120
buffer_load_dwordx4 v6,s[4:7],s65 offen lds
s_add_u32 m0,s63,20480
s_add_u32 s65,s58,409600
buffer_load_dwordx4 v6,s[4:7],s65 offen lds
s_add_u32 m0,s63,21504
s_add_u32 s65,s58,430080
buffer_load_dwordx4 v6,s[4:7],s65 offen lds
s_add_u32 m0,s63,22528
s_add_u32 s65,s58,450560
buffer_load_dwordx4 v6,s[4:7],s65 offen lds
s_add_u32 m0,s63,23552
s_add_u32 s65,s58,471040
buffer_load_dwordx4 v6,s[4:7],s65 offen lds
s_add_u32 m0,s63,24576
s_add_u32 s65,s58,491520
buffer_load_dwordx4 v6,s[4:7],s65 offen lds
s_add_u32 m0,s63,25600
s_add_u32 s65,s58,512000
buffer_load_dwordx4 v6,s[4:7],s65 offen lds
s_add_u32 m0,s63,26624
s_add_u32 s65,s58,532480
buffer_load_dwordx4 v6,s[4:7],s65 offen lds
s_add_u32 m0,s63,27648
s_add_u32 s65,s58,552960
buffer_load_dwordx4 v6,s[4:7],s65 offen lds
s_add_u32 m0,s63,28672
s_add_u32 s65,s58,573440
buffer_load_dwordx4 v6,s[4:7],s65 offen lds
s_add_u32 m0,s63,29696
s_add_u32 s65,s58,593920
buffer_load_dwordx4 v6,s[4:7],s65 offen lds
s_add_u32 m0,s63,30720
s_add_u32 s65,s58,614400
buffer_load_dwordx4 v6,s[4:7],s65 offen lds
s_add_u32 m0,s63,31744
s_add_u32 s65,s58,634880
buffer_load_dwordx4 v6,s[4:7],s65 offen lds
s_add_u32 m0,s63,32768
s_add_u32 s65,s58,655360
buffer_load_dwordx4 v6,s[4:7],s65 offen lds
s_add_u32 m0,s63,33792
s_add_u32 s65,s58,675840
buffer_load_dwordx4 v6,s[4:7],s65 offen lds
s_add_u32 m0,s63,34816
s_add_u32 s65,s58,696320
buffer_load_dwordx4 v6,s[4:7],s65 offen lds
s_add_u32 m0,s63,35840
s_add_u32 s65,s58,716800
buffer_load_dwordx4 v6,s[4:7],s65 offen lds
s_add_u32 m0,s63,36864
s_add_u32 s65,s58,737280
buffer_load_dwordx4 v6,s[4:7],s65 offen lds
s_add_u32 m0,s63,37888
s_add_u32 s65,s58,757760
buffer_load_dwordx4 v6,s[4:7],s65 offen lds
s_add_u32 m0,s63,38912
s_add_u32 s65,s58,778240
buffer_load_dwordx4 v6,s[4:7],s65 offen lds
s_add_u32 m0,s63,39936
s_add_u32 s65,s58,798720
buffer_load_dwordx4 v6,s[4:7],s65 offen lds
s_waitcnt vmcnt(20)
v_bfe_u32 v9,v0,2,2
v_lshrrev_b32 v10,5,v0
v_lshl_add_u32 v9,v10,2,v9
v_mul_u32_u24 v9,64,v9
v_and_b32 v10,1,v0
v_lshl_add_u32 v9,v10,3,v9
v_bfe_u32 v10,v0,1,1
v_lshl_add_u32 v9,v10,5,v9
v_bfe_u32 v10,v0,4,1
v_lshl_add_u32 v9,v10,4,v9
v_add_u32 v7,s63,v9
ds_read_b64_tr_b16 a[0:1],v7 offset:0
ds_read_b64_tr_b16 a[2:3],v7 offset:1024
ds_read_b64_tr_b16 a[4:5],v7 offset:512
ds_read_b64_tr_b16 a[6:7],v7 offset:1536
ds_read_b64_tr_b16 a[8:9],v7 offset:2048
ds_read_b64_tr_b16 a[10:11],v7 offset:3072
ds_read_b64_tr_b16 a[12:13],v7 offset:2560
ds_read_b64_tr_b16 a[14:15],v7 offset:3584
ds_read_b64_tr_b16 a[16:17],v7 offset:4096
ds_read_b64_tr_b16 a[18:19],v7 offset:5120
ds_read_b64_tr_b16 a[20:21],v7 offset:4608
ds_read_b64_tr_b16 a[22:23],v7 offset:5632
s_waitcnt lgkmcnt(4)
ds_read_b64_tr_b16 a[24:25],v7 offset:6144
ds_read_b64_tr_b16 a[26:27],v7 offset:7168
ds_read_b64_tr_b16 a[28:29],v7 offset:6656
ds_read_b64_tr_b16 a[30:31],v7 offset:7680
ds_read_b64_tr_b16 a[32:33],v7 offset:8192
ds_read_b64_tr_b16 a[34:35],v7 offset:9216
ds_read_b64_tr_b16 a[36:37],v7 offset:8704
ds_read_b64_tr_b16 a[38:39],v7 offset:9728
ds_read_b64_tr_b16 a[40:41],v7 offset:10240
ds_read_b64_tr_b16 a[42:43],v7 offset:11264
ds_read_b64_tr_b16 a[44:45],v7 offset:10752
ds_read_b64_tr_b16 a[46:47],v7 offset:11776
s_waitcnt lgkmcnt(4)
ds_read_b64_tr_b16 a[48:49],v7 offset:12288
ds_read_b64_tr_b16 a[50:51],v7 offset:13312
ds_read_b64_tr_b16 a[52:53],v7 offset:12800
ds_read_b64_tr_b16 a[54:55],v7 offset:13824
ds_read_b64_tr_b16 a[56:57],v7 offset:14336
ds_read_b64_tr_b16 a[58:59],v7 offset:15360
ds_read_b64_tr_b16 a[60:61],v7 offset:14848
ds_read_b64_tr_b16 a[62:63],v7 offset:15872
ds_read_b64_tr_b16 a[64:65],v7 offset:16384
ds_read_b64_tr_b16 a[66:67],v7 offset:17408
ds_read_b64_tr_b16 a[68:69],v7 offset:16896
ds_read_b64_tr_b16 a[70:71],v7 offset:17920
s_waitcnt lgkmcnt(4)
ds_read_b64_tr_b16 a[72:73],v7 offset:18432
ds_read_b64_tr_b16 a[74:75],v7 offset:19456
ds_read_b64_tr_b16 a[76:77],v7 offset:18944
ds_read_b64_tr_b16 a[78:79],v7 offset:19968
s_waitcnt lgkmcnt(0)
s_waitcnt vmcnt(0)
v_bfe_u32 v9,v0,2,2
v_lshrrev_b32 v10,5,v0
v_lshl_add_u32 v9,v10,2,v9
v_mul_u32_u24 v9,64,v9
v_and_b32 v10,1,v0
v_lshl_add_u32 v9,v10,3,v9
v_bfe_u32 v10,v0,1,1
v_lshl_add_u32 v9,v10,5,v9
v_bfe_u32 v10,v0,4,1
v_lshl_add_u32 v9,v10,4,v9
v_add_u32 v7,s63,v9
ds_read_b64_tr_b16 a[80:81],v7 offset:20480
ds_read_b64_tr_b16 a[82:83],v7 offset:21504
ds_read_b64_tr_b16 a[84:85],v7 offset:20992
ds_read_b64_tr_b16 a[86:87],v7 offset:22016
ds_read_b64_tr_b16 a[88:89],v7 offset:22528
ds_read_b64_tr_b16 a[90:91],v7 offset:23552
ds_read_b64_tr_b16 a[92:93],v7 offset:23040
ds_read_b64_tr_b16 a[94:95],v7 offset:24064
ds_read_b64_tr_b16 a[96:97],v7 offset:24576
ds_read_b64_tr_b16 a[98:99],v7 offset:25600
ds_read_b64_tr_b16 a[100:101],v7 offset:25088
ds_read_b64_tr_b16 a[102:103],v7 offset:26112
s_waitcnt lgkmcnt(4)
ds_read_b64_tr_b16 a[104:105],v7 offset:26624
ds_read_b64_tr_b16 a[106:107],v7 offset:27648
ds_read_b64_tr_b16 a[108:109],v7 offset:27136
ds_read_b64_tr_b16 a[110:111],v7 offset:28160
ds_read_b64_tr_b16 a[112:113],v7 offset:28672
ds_read_b64_tr_b16 a[114:115],v7 offset:29696
ds_read_b64_tr_b16 a[116:117],v7 offset:29184
ds_read_b64_tr_b16 a[118:119],v7 offset:30208
ds_read_b64_tr_b16 a[120:121],v7 offset:30720
ds_read_b64_tr_b16 a[122:123],v7 offset:31744
ds_read_b64_tr_b16 a[124:125],v7 offset:31232
ds_read_b64_tr_b16 a[126:127],v7 offset:32256
s_waitcnt lgkmcnt(4)
ds_read_b64_tr_b16 a[128:129],v7 offset:32768
ds_read_b64_tr_b16 a[130:131],v7 offset:33792
ds_read_b64_tr_b16 a[132:133],v7 offset:33280
ds_read_b64_tr_b16 a[134:135],v7 offset:34304
ds_read_b64_tr_b16 a[136:137],v7 offset:34816
ds_read_b64_tr_b16 a[138:139],v7 offset:35840
ds_read_b64_tr_b16 a[140:141],v7 offset:35328
ds_read_b64_tr_b16 a[142:143],v7 offset:36352
ds_read_b64_tr_b16 a[144:145],v7 offset:36864
ds_read_b64_tr_b16 a[146:147],v7 offset:37888
ds_read_b64_tr_b16 a[148:149],v7 offset:37376
ds_read_b64_tr_b16 a[150:151],v7 offset:38400
s_waitcnt lgkmcnt(4)
ds_read_b64_tr_b16 a[152:153],v7 offset:38912
ds_read_b64_tr_b16 a[154:155],v7 offset:39936
ds_read_b64_tr_b16 a[156:157],v7 offset:39424
ds_read_b64_tr_b16 a[158:159],v7 offset:40448
s_waitcnt lgkmcnt(0)
s_barrier
s_mov_b32 s50,0
s_mov_b32 s32,0
s_mov_b32 s57,0
s_mov_b32 s59,2147483648
s_mov_b32 s82,2147483648
s_mov_b32 s39,2147483648
v_mov_b32 v22,83968
v_lshl_add_u32 v22,v0,2,v22
v_mov_b32 v23,0
ds_write_b32 v22,v23
s_mov_b32 s39,1600000
v_and_b32 v72,15,v0
v_lshlrev_b32 v72,7,v72
s_mul_i32 s60,s56,-1792
s_add_u32 s60,s60,40960
v_and_b32 v6,128,v72
v_add_u32 v6,s60,v6
v_cmp_lt_u32 vcc,15,v0
s_nop 1
v_cndmask_b32 v72,v72,v6,vcc
v_min_u32 v6,59,v0
v_lshlrev_b32 v6,2,v6
v_add_u32 v2,135168,v6
v_add_u32 v7,-80,v6
v_cmp_gt_u32 s[78:79],20,v0
s_nop 1
v_cndmask_b32 v2,v7,v2,s[78:79]
s_mov_b32 s51,0
s_mov_b32 s52,0
s_mul_i32 s62,s51,8
s_and_b32 s63,s52,7
s_add_u32 s62,s62,s63
s_mul_i32 s62,s62,46080
s_add_u32 s62,s62,212467712
s_lshl_b32 s63,s56,11
s_add_u32 s62,s62,s63
buffer_load_dword v73,v72,s[8:11],s62 offen sc1
s_mov_b32 s51,0
s_mov_b32 s52,1
s_mul_i32 s62,s51,8
s_and_b32 s63,s52,7
s_add_u32 s62,s62,s63
s_mul_i32 s62,s62,46080
s_add_u32 s62,s62,212467712
s_lshl_b32 s63,s56,11
s_add_u32 s62,s62,s63
buffer_load_dword v73,v72,s[8:11],s62 offen sc1
s_mov_b32 s51,0
s_mov_b32 s52,2
s_mul_i32 s62,s51,8
s_and_b32 s63,s52,7
s_add_u32 s62,s62,s63
s_mul_i32 s62,s62,46080
s_add_u32 s62,s62,212467712
s_lshl_b32 s63,s56,11
s_add_u32 s62,s62,s63
buffer_load_dword v73,v72,s[8:11],s62 offen sc1
s_mov_b32 s51,0
s_mov_b32 s52,3
s_mul_i32 s62,s51,8
s_and_b32 s63,s52,7
s_add_u32 s62,s62,s63
s_mul_i32 s62,s62,46080
s_add_u32 s62,s62,212467712
s_lshl_b32 s63,s56,11
s_add_u32 s62,s62,s63
buffer_load_dword v73,v72,s[8:11],s62 offen sc1
s_mov_b32 s51,0
s_mov_b32 s52,4
s_mul_i32 s62,s51,8
s_and_b32 s63,s52,7
s_add_u32 s62,s62,s63
s_mul_i32 s62,s62,46080
s_add_u32 s62,s62,212467712
s_lshl_b32 s63,s56,11
s_add_u32 s62,s62,s63
buffer_load_dword v73,v72,s[8:11],s62 offen sc1
s_mov_b32 s51,0
s_mov_b32 s52,5
s_mul_i32 s62,s51,8
s_and_b32 s63,s52,7
s_add_u32 s62,s62,s63
s_mul_i32 s62,s62,46080
s_add_u32 s62,s62,212467712
s_lshl_b32 s63,s56,11
s_add_u32 s62,s62,s63
buffer_load_dword v73,v72,s[8:11],s62 offen sc1
s_mov_b32 s51,0
s_mov_b32 s52,6
s_mul_i32 s62,s51,8
s_and_b32 s63,s52,7
s_add_u32 s62,s62,s63
s_mul_i32 s62,s62,46080
s_add_u32 s62,s62,212467712
s_lshl_b32 s63,s56,11
s_add_u32 s62,s62,s63
buffer_load_dword v73,v72,s[8:11],s62 offen sc1
s_mov_b32 s51,0
s_mov_b32 s52,7
s_mul_i32 s62,s51,8
s_and_b32 s63,s52,7
s_add_u32 s62,s62,s63
s_mul_i32 s62,s62,46080
s_add_u32 s62,s62,212467712
s_lshl_b32 s63,s56,11
s_add_u32 s62,s62,s63
buffer_load_dword v73,v72,s[8:11],s62 offen sc1
s_mov_b32 s51,1
s_mov_b32 s52,0
s_mul_i32 s62,s51,8
s_and_b32 s63,s52,7
s_add_u32 s62,s62,s63
s_mul_i32 s62,s62,46080
s_add_u32 s62,s62,212467712
s_lshl_b32 s63,s56,11
s_add_u32 s62,s62,s63
buffer_load_dword v73,v72,s[8:11],s62 offen sc1
s_mov_b32 s51,1
s_mov_b32 s52,1
s_mul_i32 s62,s51,8
s_and_b32 s63,s52,7
s_add_u32 s62,s62,s63
s_mul_i32 s62,s62,46080
s_add_u32 s62,s62,212467712
s_lshl_b32 s63,s56,11
s_add_u32 s62,s62,s63
buffer_load_dword v73,v72,s[8:11],s62 offen sc1
s_mov_b32 s51,1
s_mov_b32 s52,2
s_mul_i32 s62,s51,8
s_and_b32 s63,s52,7
s_add_u32 s62,s62,s63
s_mul_i32 s62,s62,46080
s_add_u32 s62,s62,212467712
s_lshl_b32 s63,s56,11
s_add_u32 s62,s62,s63
buffer_load_dword v73,v72,s[8:11],s62 offen sc1
s_mov_b32 s51,1
s_mov_b32 s52,3
s_mul_i32 s62,s51,8
s_and_b32 s63,s52,7
s_add_u32 s62,s62,s63
s_mul_i32 s62,s62,46080
s_add_u32 s62,s62,212467712
s_lshl_b32 s63,s56,11
s_add_u32 s62,s62,s63
buffer_load_dword v73,v72,s[8:11],s62 offen sc1
s_mov_b32 s51,1
s_mov_b32 s52,4
s_mul_i32 s62,s51,8
s_and_b32 s63,s52,7
s_add_u32 s62,s62,s63
s_mul_i32 s62,s62,46080
s_add_u32 s62,s62,212467712
s_lshl_b32 s63,s56,11
s_add_u32 s62,s62,s63
buffer_load_dword v73,v72,s[8:11],s62 offen sc1
s_mov_b32 s51,1
s_mov_b32 s52,5
s_mul_i32 s62,s51,8
s_and_b32 s63,s52,7
s_add_u32 s62,s62,s63
s_mul_i32 s62,s62,46080
s_add_u32 s62,s62,212467712
s_lshl_b32 s63,s56,11
s_add_u32 s62,s62,s63
buffer_load_dword v73,v72,s[8:11],s62 offen sc1
s_mov_b32 s51,1
s_mov_b32 s52,6
s_mul_i32 s62,s51,8
s_and_b32 s63,s52,7
s_add_u32 s62,s62,s63
s_mul_i32 s62,s62,46080
s_add_u32 s62,s62,212467712
s_lshl_b32 s63,s56,11
s_add_u32 s62,s62,s63
buffer_load_dword v73,v72,s[8:11],s62 offen sc1
s_mov_b32 s51,1
s_mov_b32 s52,7
s_mul_i32 s62,s51,8
s_and_b32 s63,s52,7
s_add_u32 s62,s62,s63
s_mul_i32 s62,s62,46080
s_add_u32 s62,s62,212467712
s_lshl_b32 s63,s56,11
s_add_u32 s62,s62,s63
buffer_load_dword v73,v72,s[8:11],s62 offen sc1
s_waitcnt vmcnt(0)
s_waitcnt lgkmcnt(0)
s_barrier
s_mov_b32 s83,s100
s_min_u32 s62,s32,127
s_sub_u32 s60,s62,16
s_lshr_b32 s34,s60,1
s_and_b32 s33,s60,1
s_cmp_eq_u32 s33,0
s_cselect_b32 s61,16,0
s_add_u32 s34,s34,s61
s_sub_u32 s61,s60,48
s_cmp_ge_u32 s60,96
s_cselect_b32 s34,s61,s34
s_cselect_b32 s33,1,s33
s_cmp_lt_u32 s62,16
s_cselect_b32 s34,s62,s34
s_cselect_b32 s33,0,s33
s_add_u32 s60,s34,1
s_min_u32 s60,s60,63
s_lshl_b32 s35,s33,6
s_add_u32 s35,s35,s60
s_lshl_b32 s35,s35,9
s_add_u32 s35,s35,323584
s_cmp_lt_u32 s60,8
s_cselect_b64 s[76:77],s[78:79],-1
s_sub_u32 s57,40960,s57
v_swap_b32 v16,v18
v_swap_b32 v17,v19
s_add_u32 s62,s32,1
s_min_u32 s62,s62,127
s_sub_u32 s60,s62,16
s_lshr_b32 s41,s60,1
s_and_b32 s40,s60,1
s_cmp_eq_u32 s40,0
s_cselect_b32 s61,16,0
s_add_u32 s41,s41,s61
s_sub_u32 s61,s60,48
s_cmp_ge_u32 s60,96
s_cselect_b32 s41,s61,s41
s_cselect_b32 s40,1,s40
s_cmp_lt_u32 s62,16
s_cselect_b32 s41,s62,s41
s_cselect_b32 s40,0,s40
s_add_u32 s60,s41,1
s_min_u32 s60,s60,63
s_lshl_b32 s42,s40,6
s_add_u32 s42,s42,s60
s_lshl_b32 s42,s42,9
s_add_u32 s42,s42,323584
s_cmp_lt_u32 s60,8
s_cselect_b64 s[80:81],s[78:79],-1
W2_COLD:
s_mov_b32 s37,0
fb_289:
buffer_load_dword v3,v2,s[8:11],s35 offen sc1
s_waitcnt vmcnt(0)
v_cmp_eq_u32 vcc,0,v3
s_and_b64 vcc,vcc,s[76:77]
s_cbranch_scc0 ok_290
s_sleep 1
s_sub_u32 s47,s47,1
s_cbranch_scc1 ABORT
s_branch fb_289
ok_290:
W2_COLD2:
s_sub_u32 s66,40960,s57
s_add_u32 s61,s34,s68
s_and_b32 s62,s61,7
s_cmp_lt_u32 s61,64
s_cselect_b32 s62,s62,8
s_mul_i32 s62,s62,40960
s_and_b32 s61,s34,7
s_mul_i32 s61,s61,40960
v_mad_u32_u24 v112,v76,s62,v74
v_mad_u32_u24 v112,v78,s61,v112
v_mad_u32_u24 v113,v77,s62,v75
v_mad_u32_u24 v113,v79,s61,v113
s_mov_b32 s60,s33
s_mul_i32 s60,s60,368640
s_add_u32 s60,s60,s37
s_mul_i32 s61,s46,10240
s_add_u32 s60,s60,s61
s_add_u32 s60,s60,237371392
s_add_u32 s61,s61,s66
s_add_u32 m0,s61,0
s_add_u32 s63,s60,0
buffer_load_dwordx4 v112,s[8:11],s63 offen sc1 lds
s_add_u32 m0,s61,1024
s_nop 0
buffer_load_dwordx4 v113,s[8:11],s63 offen sc1 lds
s_add_u32 m0,s61,2048
s_add_u32 s63,s60,2048
buffer_load_dwordx4 v112,s[8:11],s63 offen sc1 lds
s_add_u32 m0,s61,3072
s_nop 0
buffer_load_dwordx4 v113,s[8:11],s63 offen sc1 lds
s_add_u32 m0,s61,4096
s_add_u32 s63,s60,4096
buffer_load_dwordx4 v112,s[8:11],s63 offen sc1 lds
s_add_u32 m0,s61,5120
s_nop 0
buffer_load_dwordx4 v113,s[8:11],s63 offen sc1 lds
s_waitcnt vmcnt(5)
s_mov_b64 exec,1
s_cmp_lg_u32 s49,0
s_cbranch_scc0 ls_291
buffer_store_dword v5,v1,s[8:11],s59 offen sc1
s_branch ls_292
ls_291:
buffer_store_dword v5,v1,s[8:11],s59 offen
ls_292:
s_mov_b64 exec,-1
s_mov_b32 s59,2147483648
s_add_u32 m0,s61,6144
s_add_u32 s63,s60,6144
buffer_load_dwordx4 v112,s[8:11],s63 offen sc1 lds
s_add_u32 m0,s61,7168
s_nop 0
buffer_load_dwordx4 v113,s[8:11],s63 offen sc1 lds
s_add_u32 m0,s61,8192
s_add_u32 s63,s60,8192
buffer_load_dwordx4 v112,s[8:11],s63 offen sc1 lds
s_add_u32 m0,s61,9216
s_nop 0
buffer_load_dwordx4 v113,s[8:11],s63 offen sc1 lds
s_mov_b32 s35,s42
s_mov_b32 s53,s33
s_mov_b32 s54,s34
s_add_u32 s32,s32,1
s_mov_b32 s33,s40
s_mov_b32 s34,s41
s_mov_b64 s[76:77],s[80:81]
s_sub_u32 s57,40960,s57
v_swap_b32 v16,v18
v_swap_b32 v17,v19
s_mov_b32 s51,s53
s_mov_b32 s52,s54
s_waitcnt vmcnt(5)
s_branch W2_GO
W2_NEXT:
s_sub_u32 s57,40960,s57
v_swap_b32 v16,v18
v_swap_b32 v17,v19
s_mov_b32 s51,s53
s_mov_b32 s52,s54
s_waitcnt vmcnt(3)
W2_GO:
s_barrier
ds_read_b128 v[24:27],v16 offset:0
ds_read_b128 v[28:31],v17 offset:0
ds_read_b128 v[32:35],v16 offset:10240
ds_read_b128 v[36:39],v17 offset:10240
ds_read_b128 v[40:43],v16 offset:20480
ds_read_b128 v[44:47],v17 offset:20480
ds_read_b128 v[48:51],v16 offset:30720
buffer_load_dword v3,v2,s[8:11],s35 offen sc1
s_waitcnt lgkmcnt(6)
v_mfma_f32_32x32x16_bf16 v[56:71],a[0:3],v[24:27],0
ds_read_b128 v[52:55],v17 offset:30720
s_lshl_b32 s60,s51,6
s_add_u32 s60,s60,s52
s_mul_i32 s60,s60,46080
s_waitcnt lgkmcnt(6)
v_mfma_f32_32x32x16_bf16 v[56:71],a[4:7],v[28:31],v[56:71]
ds_read_b128 v[24:27],v16 offset:2048
s_lshl_b32 s61,s56,11
s_add_u32 s60,s60,s61
s_add_u32 s60,s60,223608832
s_waitcnt lgkmcnt(5)
v_mfma_f32_32x32x16_bf16 v[56:71],a[40:43],v[32:35],v[56:71]
ds_read_b128 v[28:31],v17 offset:2048
buffer_load_dwordx4 v[120:123],v116,s[8:11],s60 offen sc1
buffer_load_dwordx4 v[124:127],v117,s[8:11],s60 offen sc1
v_mfma_f32_32x32x16_bf16 v[56:71],a[44:47],v[36:39],v[56:71]
ds_read_b128 v[32:35],v16 offset:12288
s_add_u32 s62,s32,1
s_min_u32 s62,s62,127
s_sub_u32 s60,s62,16
s_waitcnt lgkmcnt(5)
v_mfma_f32_32x32x16_bf16 v[56:71],a[80:83],v[40:43],v[56:71]
ds_read_b128 v[36:39],v17 offset:12288
s_lshr_b32 s41,s60,1
s_and_b32 s40,s60,1
s_cmp_eq_u32 s40,0
s_cselect_b32 s61,16,0
v_mfma_f32_32x32x16_bf16 v[56:71],a[84:87],v[44:47],v[56:71]
ds_read_b128 v[40:43],v16 offset:22528
s_add_u32 s41,s41,s61
s_sub_u32 s61,s60,48
s_mul_i32 s71,s51,8
s_waitcnt lgkmcnt(5)
v_mfma_f32_32x32x16_bf16 v[56:71],a[120:123],v[48:51],v[56:71]
ds_read_b128 v[44:47],v17 offset:22528
s_cmp_ge_u32 s60,96
s_cselect_b32 s41,s61,s41
s_cselect_b32 s40,1,s40
s_and_b32 s72,s52,7
v_mfma_f32_32x32x16_bf16 v[56:71],a[124:127],v[52:55],v[56:71]
ds_read_b128 v[48:51],v16 offset:32768
s_cmp_lt_u32 s62,16
s_cselect_b32 s41,s62,s41
s_cselect_b32 s40,0,s40
s_waitcnt lgkmcnt(5)
v_mfma_f32_32x32x16_bf16 v[56:71],a[8:11],v[24:27],v[56:71]
ds_read_b128 v[52:55],v17 offset:32768
s_add_u32 s60,s41,1
s_min_u32 s60,s60,63
s_lshl_b32 s42,s40,6
s_add_u32 s42,s42,s60
v_mfma_f32_32x32x16_bf16 v[56:71],a[12:15],v[28:31],v[56:71]
ds_read_b128 v[24:27],v16 offset:4096
s_lshl_b32 s42,s42,9
s_add_u32 s42,s42,323584
s_add_u32 s71,s71,s72
s_waitcnt lgkmcnt(5)
v_mfma_f32_32x32x16_bf16 v[56:71],a[48:51],v[32:35],v[56:71]
ds_read_b128 v[28:31],v17 offset:4096
s_cmp_lt_u32 s60,8
s_cselect_b64 s[80:81],s[78:79],-1
s_mul_i32 s71,s71,46080
s_add_u32 s71,s71,212467712
v_mfma_f32_32x32x16_bf16 v[56:71],a[52:55],v[36:39],v[56:71]
ds_read_b128 v[32:35],v16 offset:14336
s_lshl_b32 s72,s56,8
s_add_u32 s72,s72,s71
s_add_u32 s72,s72,40960
s_waitcnt lgkmcnt(5)
v_mfma_f32_32x32x16_bf16 v[56:71],a[88:91],v[40:43],v[56:71]
ds_read_b128 v[36:39],v17 offset:14336
s_waitcnt vmcnt(2)
s_mov_b64 exec,1
s_cmp_lg_u32 s49,0
s_cbranch_scc0 ls_293
buffer_store_dword v5,v1,s[8:11],s59 offen sc1
s_branch ls_294
ls_293:
buffer_store_dword v5,v1,s[8:11],s59 offen
ls_294:
s_mov_b64 exec,-1
s_mov_b32 s59,2147483648
v_mfma_f32_32x32x16_bf16 v[56:71],a[92:95],v[44:47],v[56:71]
ds_read_b128 v[40:43],v16 offset:24576
v_cmp_eq_u32 vcc,0,v3
s_and_b64 vcc,vcc,s[76:77]
s_cselect_b32 s37,2147483648,0
s_waitcnt lgkmcnt(5)
v_mfma_f32_32x32x16_bf16 v[56:71],a[128:131],v[48:51],v[56:71]
ds_read_b128 v[44:47],v17 offset:24576
s_cmp_lt_u32 s32,128
s_cselect_b32 s37,s37,2147483648
s_sub_u32 s66,40960,s57
s_add_u32 s61,s34,s68
v_mfma_f32_32x32x16_bf16 v[56:71],a[132:135],v[52:55],v[56:71]
ds_read_b128 v[48:51],v16 offset:34816
s_and_b32 s62,s61,7
s_cmp_lt_u32 s61,64
s_cselect_b32 s62,s62,8
s_waitcnt lgkmcnt(5)
v_mfma_f32_32x32x16_bf16 v[56:71],a[16:19],v[24:27],v[56:71]
ds_read_b128 v[52:55],v17 offset:34816
s_mul_i32 s62,s62,40960
s_and_b32 s61,s34,7
s_mul_i32 s61,s61,40960
v_mad_u32_u24 v112,v76,s62,v74
s_barrier
v_mfma_f32_32x32x16_bf16 v[56:71],a[20:23],v[28:31],v[56:71]
ds_read_b128 v[24:27],v16 offset:6144
v_mad_u32_u24 v112,v78,s61,v112
v_mad_u32_u24 v113,v77,s62,v75
v_mad_u32_u24 v113,v79,s61,v113
s_waitcnt lgkmcnt(5)
v_mfma_f32_32x32x16_bf16 v[56:71],a[56:59],v[32:35],v[56:71]
ds_read_b128 v[28:31],v17 offset:6144
s_mov_b32 s60,s33
s_mul_i32 s60,s60,368640
s_add_u32 s60,s60,s37
s_mul_i32 s61,s46,10240
v_mfma_f32_32x32x16_bf16 v[56:71],a[60:63],v[36:39],v[56:71]
ds_read_b128 v[32:35],v16 offset:16384
s_add_u32 s60,s60,s61
s_add_u32 s60,s60,237371392
s_add_u32 s61,s61,s66
s_waitcnt lgkmcnt(5)
v_mfma_f32_32x32x16_bf16 v[56:71],a[96:99],v[40:43],v[56:71]
ds_read_b128 v[36:39],v17 offset:16384
s_add_u32 m0,s61,0
s_add_u32 s63,s60,0
buffer_load_dwordx4 v112,s[8:11],s63 offen sc1 lds
v_mfma_f32_32x32x16_bf16 v[56:71],a[100:103],v[44:47],v[56:71]
ds_read_b128 v[40:43],v16 offset:26624
s_add_u32 m0,s61,1024
s_lshl_b32 s73,s56,11
s_add_u32 s71,s71,s73
s_waitcnt lgkmcnt(5)
v_mfma_f32_32x32x16_bf16 v[56:71],a[136:139],v[48:51],v[56:71]
ds_read_b128 v[44:47],v17 offset:26624
buffer_load_dwordx4 v113,s[8:11],s63 offen sc1 lds
s_add_u32 m0,s61,2048
s_add_u32 s63,s60,2048
v_mfma_f32_32x32x16_bf16 v[56:71],a[140:143],v[52:55],v[56:71]
ds_read_b128 v[48:51],v16 offset:36864
s_lshl_b32 s82,s51,6
s_add_u32 s82,s82,s52
s_lshl_b32 s82,s82,9
s_waitcnt lgkmcnt(5)
v_mfma_f32_32x32x16_bf16 v[56:71],a[24:27],v[24:27],v[56:71]
ds_read_b128 v[52:55],v17 offset:36864
buffer_load_dwordx4 v112,s[8:11],s63 offen sc1 lds
s_add_u32 m0,s61,3072
s_add_u32 s82,s82,524288
v_mfma_f32_32x32x16_bf16 v[56:71],a[28:31],v[28:31],v[56:71]
ds_read_b128 v[24:27],v16 offset:8192
s_lshl_b32 s70,s56,2
s_add_u32 s82,s82,s70
s_waitcnt lgkmcnt(5)
v_mfma_f32_32x32x16_bf16 v[56:71],a[64:67],v[32:35],v[56:71]
ds_read_b128 v[28:31],v17 offset:8192
buffer_load_dwordx4 v113,s[8:11],s63 offen sc1 lds
s_add_u32 m0,s61,4096
s_add_u32 s63,s60,4096
v_mfma_f32_32x32x16_bf16 v[56:71],a[68:71],v[36:39],v[56:71]
ds_read_b128 v[32:35],v16 offset:18432
s_waitcnt lgkmcnt(5)
v_mfma_f32_32x32x16_bf16 v[56:71],a[104:107],v[40:43],v[56:71]
ds_read_b128 v[36:39],v17 offset:18432
buffer_load_dwordx4 v112,s[8:11],s63 offen sc1 lds
s_add_u32 m0,s61,5120
v_mfma_f32_32x32x16_bf16 v[56:71],a[108:111],v[44:47],v[56:71]
ds_read_b128 v[40:43],v16 offset:28672
s_waitcnt lgkmcnt(5)
v_mfma_f32_32x32x16_bf16 v[56:71],a[144:147],v[48:51],v[56:71]
ds_read_b128 v[44:47],v17 offset:28672
buffer_load_dword v3,v2,s[8:11],s35 offen sc1
v_mfma_f32_32x32x16_bf16 v[56:71],a[148:151],v[52:55],v[56:71]
ds_read_b128 v[48:51],v16 offset:38912
buffer_load_dwordx4 v113,s[8:11],s63 offen sc1 lds
s_add_u32 m0,s61,6144
s_waitcnt lgkmcnt(5)
v_mfma_f32_32x32x16_bf16 v[56:71],a[32:35],v[24:27],v[56:71]
ds_read_b128 v[52:55],v17 offset:38912
s_add_u32 s63,s60,6144
v_mfma_f32_32x32x16_bf16 v[56:71],a[36:39],v[28:31],v[56:71]
buffer_load_dwordx4 v112,s[8:11],s63 offen sc1 lds
s_add_u32 m0,s61,7168
s_waitcnt lgkmcnt(4)
v_mfma_f32_32x32x16_bf16 v[56:71],a[72:75],v[32:35],v[56:71]
v_mfma_f32_32x32x16_bf16 v[56:71],a[76:79],v[36:39],v[56:71]
buffer_load_dwordx4 v113,s[8:11],s63 offen sc1 lds
s_add_u32 m0,s61,8192
s_add_u32 s63,s60,8192
s_waitcnt lgkmcnt(2)
v_mfma_f32_32x32x16_bf16 v[56:71],a[112:115],v[40:43],v[56:71]
v_mfma_f32_32x32x16_bf16 v[56:71],a[116:119],v[44:47],v[56:71]
buffer_load_dwordx4 v112,s[8:11],s63 offen sc1 lds
s_add_u32 m0,s61,9216
s_waitcnt lgkmcnt(0)
v_mfma_f32_32x32x16_bf16 v[56:71],a[152:155],v[48:51],v[56:71]
v_mfma_f32_32x32x16_bf16 v[56:71],a[156:159],v[52:55],v[56:71]
buffer_load_dwordx4 v113,s[8:11],s63 offen sc1 lds
s_waitcnt vmcnt(12)
v_lshlrev_b32 v128,16,v120
v_and_b32 v129,0xffff0000,v120
v_lshlrev_b32 v130,16,v121
v_and_b32 v131,0xffff0000,v121
v_lshlrev_b32 v132,16,v122
v_and_b32 v133,0xffff0000,v122
v_lshlrev_b32 v134,16,v123
v_and_b32 v135,0xffff0000,v123
v_lshlrev_b32 v136,16,v124
v_and_b32 v137,0xffff0000,v124
v_lshlrev_b32 v138,16,v125
v_and_b32 v139,0xffff0000,v125
v_lshlrev_b32 v140,16,v126
v_and_b32 v141,0xffff0000,v126
v_lshlrev_b32 v142,16,v127
v_and_b32 v143,0xffff0000,v127
s_cmp_eq_u32 s37,0
s_cbranch_scc0 sec_297
s_mov_b32 s35,s42
s_mov_b32 s53,s33
s_mov_b32 s54,s34
s_add_u32 s32,s32,1
s_mov_b32 s33,s40
s_mov_b32 s34,s41
s_mov_b64 s[76:77],s[80:81]
s_nop 2
ep_295:
v_cvt_pk_bf16_f32 v6,v56,v57
v_lshlrev_b32 v56,16,v6
v_and_b32 v57,0xffff0000,v6
v_cvt_pk_bf16_f32 v6,v58,v59
v_lshlrev_b32 v58,16,v6
v_and_b32 v59,0xffff0000,v6
v_cvt_pk_bf16_f32 v6,v60,v61
v_lshlrev_b32 v60,16,v6
v_and_b32 v61,0xffff0000,v6
v_cvt_pk_bf16_f32 v6,v62,v63
v_lshlrev_b32 v62,16,v6
v_and_b32 v63,0xffff0000,v6
v_cvt_pk_bf16_f32 v6,v64,v65
v_lshlrev_b32 v64,16,v6
v_and_b32 v65,0xffff0000,v6
v_cvt_pk_bf16_f32 v6,v66,v67
v_lshlrev_b32 v66,16,v6
v_and_b32 v67,0xffff0000,v6
v_cvt_pk_bf16_f32 v6,v68,v69
v_lshlrev_b32 v68,16,v6
v_and_b32 v69,0xffff0000,v6
v_cvt_pk_bf16_f32 v6,v70,v71
v_lshlrev_b32 v70,16,v6
v_and_b32 v71,0xffff0000,v6
v_pk_add_f32 v[56:57],v[56:57],v[128:129]
v_pk_add_f32 v[58:59],v[58:59],v[130:131]
v_pk_add_f32 v[60:61],v[60:61],v[132:133]
v_pk_add_f32 v[62:63],v[62:63],v[134:135]
v_pk_add_f32 v[64:65],v[64:65],v[136:137]
v_pk_add_f32 v[66:67],v[66:67],v[138:139]
v_pk_add_f32 v[68:69],v[68:69],v[140:141]
v_pk_add_f32 v[70:71],v[70:71],v[142:143]
v_cvt_pk_bf16_f32 v144,v56,v57
v_lshlrev_b32 v56,16,v144
v_and_b32 v57,0xffff0000,v144
v_cvt_pk_bf16_f32 v145,v58,v59
v_lshlrev_b32 v58,16,v145
v_and_b32 v59,0xffff0000,v145
v_cvt_pk_bf16_f32 v146,v60,v61
v_lshlrev_b32 v60,16,v146
v_and_b32 v61,0xffff0000,v146
v_cvt_pk_bf16_f32 v147,v62,v63
v_lshlrev_b32 v62,16,v147
v_and_b32 v63,0xffff0000,v147
v_cvt_pk_bf16_f32 v148,v64,v65
v_lshlrev_b32 v64,16,v148
v_and_b32 v65,0xffff0000,v148
v_cvt_pk_bf16_f32 v149,v66,v67
v_lshlrev_b32 v66,16,v149
v_and_b32 v67,0xffff0000,v149
v_cvt_pk_bf16_f32 v150,v68,v69
v_lshlrev_b32 v68,16,v150
v_and_b32 v69,0xffff0000,v150
v_cvt_pk_bf16_f32 v151,v70,v71
v_lshlrev_b32 v70,16,v151
v_and_b32 v71,0xffff0000,v151
s_cmp_lg_u32 s49,0
s_cbranch_scc0 ls_298
buffer_store_dwordx4 v[144:147],v20,s[8:11],s71 offen sc1
buffer_store_dwordx4 v[148:151],v21,s[8:11],s71 offen sc1
s_branch ls_299
ls_298:
buffer_store_dwordx4 v[144:147],v20,s[8:11],s71 offen
buffer_store_dwordx4 v[148:151],v21,s[8:11],s71 offen
ls_299:
v_pk_add_f32 v[6:7],v[56:57],v[58:59]
v_pk_mul_f32 v[8:9],v[56:57],v[56:57]
v_pk_fma_f32 v[8:9],v[58:59],v[58:59],v[8:9]
v_pk_add_f32 v[6:7],v[6:7],v[60:61]
v_pk_fma_f32 v[8:9],v[60:61],v[60:61],v[8:9]
v_pk_add_f32 v[6:7],v[6:7],v[62:63]
v_pk_fma_f32 v[8:9],v[62:63],v[62:63],v[8:9]
v_pk_add_f32 v[6:7],v[6:7],v[64:65]
v_pk_fma_f32 v[8:9],v[64:65],v[64:65],v[8:9]
v_pk_add_f32 v[6:7],v[6:7],v[66:67]
v_pk_fma_f32 v[8:9],v[66:67],v[66:67],v[8:9]
v_pk_add_f32 v[6:7],v[6:7],v[68:69]
v_pk_fma_f32 v[8:9],v[68:69],v[68:69],v[8:9]
v_pk_add_f32 v[6:7],v[6:7],v[70:71]
v_pk_fma_f32 v[8:9],v[70:71],v[70:71],v[8:9]
v_add_f32 v6,v6,v7
v_add_f32 v7,v8,v9
v_mov_b32 v8,v6
v_mov_b32 v9,v7
s_nop 0
v_permlane32_swap_b32 v6,v8
v_permlane32_swap_b32 v7,v9
v_pk_add_f32 v[6:7],v[6:7],v[8:9]
s_mov_b32 exec_hi,0
s_cmp_lg_u32 s49,0
s_cbranch_scc0 ls_300
buffer_store_dwordx2 v[6:7],v114,s[8:11],s72 offen sc1
s_branch ls_301
ls_300:
buffer_store_dwordx2 v[6:7],v114,s[8:11],s72 offen
ls_301:
s_mov_b32 exec_hi,-1
s_mov_b32 s59,s82
s_cmp_eq_u32 s37,0
s_cbranch_scc1 W2_NEXT
s_waitcnt vmcnt(3)
v_cmp_eq_u32 vcc,0,v3
s_and_b64 vcc,vcc,s[76:77]
s_cselect_b32 s37,2147483648,0
s_cmp_lt_u32 s32,128
s_cselect_b32 s37,s37,2147483648
s_cmp_eq_u32 s37,0
s_cbranch_scc1 W2_COLD2
s_waitcnt vmcnt(0)
s_mov_b64 exec,1
s_cmp_lg_u32 s49,0
s_cbranch_scc0 ls_302
buffer_store_dword v5,v1,s[8:11],s59 offen sc1
s_branch ls_303
ls_302:
buffer_store_dword v5,v1,s[8:11],s59 offen
ls_303:
s_mov_b64 exec,-1
s_mov_b32 s59,2147483648
s_cmp_lt_u32 s32,128
s_cbranch_scc1 W2_COLD
s_branch W2_END
sec_297:
s_waitcnt vmcnt(5)
v_cmp_eq_u32 vcc,0,v3
s_and_b64 vcc,vcc,s[76:77]
s_cselect_b32 s37,2147483648,0
s_cmp_lt_u32 s32,128
s_cselect_b32 s37,s37,2147483648
s_cmp_lg_u32 s37,0
s_cbranch_scc1 nr_296
s_sub_u32 s66,40960,s57
s_add_u32 s61,s34,s68
s_and_b32 s62,s61,7
s_cmp_lt_u32 s61,64
s_cselect_b32 s62,s62,8
s_mul_i32 s62,s62,40960
s_and_b32 s61,s34,7
s_mul_i32 s61,s61,40960
v_mad_u32_u24 v112,v76,s62,v74
v_mad_u32_u24 v112,v78,s61,v112
v_mad_u32_u24 v113,v77,s62,v75
v_mad_u32_u24 v113,v79,s61,v113
s_mov_b32 s60,s33
s_mul_i32 s60,s60,368640
s_add_u32 s60,s60,s37
s_mul_i32 s61,s46,10240
s_add_u32 s60,s60,s61
s_add_u32 s60,s60,237371392
s_add_u32 s61,s61,s66
s_add_u32 m0,s61,0
s_add_u32 s63,s60,0
buffer_load_dwordx4 v112,s[8:11],s63 offen sc1 lds
v_cvt_pk_bf16_f32 v6,v56,v57
v_lshlrev_b32 v56,16,v6
v_and_b32 v57,0xffff0000,v6
v_cvt_pk_bf16_f32 v6,v58,v59
s_add_u32 m0,s61,1024
s_nop 0
buffer_load_dwordx4 v113,s[8:11],s63 offen sc1 lds
v_lshlrev_b32 v58,16,v6
v_and_b32 v59,0xffff0000,v6
v_cvt_pk_bf16_f32 v6,v60,v61
v_lshlrev_b32 v60,16,v6
s_add_u32 m0,s61,2048
s_add_u32 s63,s60,2048
buffer_load_dwordx4 v112,s[8:11],s63 offen sc1 lds
v_and_b32 v61,0xffff0000,v6
v_cvt_pk_bf16_f32 v6,v62,v63
v_lshlrev_b32 v62,16,v6
v_and_b32 v63,0xffff0000,v6
s_add_u32 m0,s61,3072
s_nop 0
buffer_load_dwordx4 v113,s[8:11],s63 offen sc1 lds
v_cvt_pk_bf16_f32 v6,v64,v65
v_lshlrev_b32 v64,16,v6
v_and_b32 v65,0xffff0000,v6
v_cvt_pk_bf16_f32 v6,v66,v67
s_add_u32 m0,s61,4096
s_add_u32 s63,s60,4096
buffer_load_dwordx4 v112,s[8:11],s63 offen sc1 lds
v_lshlrev_b32 v66,16,v6
v_and_b32 v67,0xffff0000,v6
v_cvt_pk_bf16_f32 v6,v68,v69
v_lshlrev_b32 v68,16,v6
s_add_u32 m0,s61,5120
s_nop 0
buffer_load_dwordx4 v113,s[8:11],s63 offen sc1 lds
v_and_b32 v69,0xffff0000,v6
v_cvt_pk_bf16_f32 v6,v70,v71
v_lshlrev_b32 v70,16,v6
v_and_b32 v71,0xffff0000,v6
s_add_u32 m0,s61,6144
s_add_u32 s63,s60,6144
buffer_load_dwordx4 v112,s[8:11],s63 offen sc1 lds
v_pk_add_f32 v[56:57],v[56:57],v[128:129]
v_pk_add_f32 v[58:59],v[58:59],v[130:131]
v_pk_add_f32 v[60:61],v[60:61],v[132:133]
v_pk_add_f32 v[62:63],v[62:63],v[134:135]
s_add_u32 m0,s61,7168
s_nop 0
buffer_load_dwordx4 v113,s[8:11],s63 offen sc1 lds
v_pk_add_f32 v[64:65],v[64:65],v[136:137]
v_pk_add_f32 v[66:67],v[66:67],v[138:139]
v_pk_add_f32 v[68:69],v[68:69],v[140:141]
v_pk_add_f32 v[70:71],v[70:71],v[142:143]
s_add_u32 m0,s61,8192
s_add_u32 s63,s60,8192
buffer_load_dwordx4 v112,s[8:11],s63 offen sc1 lds
v_cvt_pk_bf16_f32 v144,v56,v57
v_lshlrev_b32 v56,16,v144
v_and_b32 v57,0xffff0000,v144
v_cvt_pk_bf16_f32 v145,v58,v59
s_add_u32 m0,s61,9216
s_nop 0
buffer_load_dwordx4 v113,s[8:11],s63 offen sc1 lds
v_lshlrev_b32 v58,16,v145
v_and_b32 v59,0xffff0000,v145
v_cvt_pk_bf16_f32 v146,v60,v61
v_lshlrev_b32 v60,16,v146
s_mov_b32 s35,s42
s_mov_b32 s53,s33
s_mov_b32 s54,s34
s_add_u32 s32,s32,1
s_mov_b32 s33,s40
s_mov_b32 s34,s41
s_mov_b64 s[76:77],s[80:81]
v_and_b32 v61,0xffff0000,v146
v_cvt_pk_bf16_f32 v147,v62,v63
v_lshlrev_b32 v62,16,v147
v_and_b32 v63,0xffff0000,v147
v_cvt_pk_bf16_f32 v148,v64,v65
v_lshlrev_b32 v64,16,v148
v_and_b32 v65,0xffff0000,v148
v_cvt_pk_bf16_f32 v149,v66,v67
v_lshlrev_b32 v66,16,v149
v_and_b32 v67,0xffff0000,v149
v_cvt_pk_bf16_f32 v150,v68,v69
v_lshlrev_b32 v68,16,v150
v_and_b32 v69,0xffff0000,v150
v_cvt_pk_bf16_f32 v151,v70,v71
v_lshlrev_b32 v70,16,v151
v_and_b32 v71,0xffff0000,v151
s_cmp_lg_u32 s49,0
s_cbranch_scc0 ls_304
buffer_store_dwordx4 v[144:147],v20,s[8:11],s71 offen sc1
buffer_store_dwordx4 v[148:151],v21,s[8:11],s71 offen sc1
s_branch ls_305
ls_304:
buffer_store_dwordx4 v[144:147],v20,s[8:11],s71 offen
buffer_store_dwordx4 v[148:151],v21,s[8:11],s71 offen
ls_305:
v_pk_add_f32 v[6:7],v[56:57],v[58:59]
v_pk_mul_f32 v[8:9],v[56:57],v[56:57]
v_pk_fma_f32 v[8:9],v[58:59],v[58:59],v[8:9]
v_pk_add_f32 v[6:7],v[6:7],v[60:61]
v_pk_fma_f32 v[8:9],v[60:61],v[60:61],v[8:9]
v_pk_add_f32 v[6:7],v[6:7],v[62:63]
v_pk_fma_f32 v[8:9],v[62:63],v[62:63],v[8:9]
v_pk_add_f32 v[6:7],v[6:7],v[64:65]
v_pk_fma_f32 v[8:9],v[64:65],v[64:65],v[8:9]
v_pk_add_f32 v[6:7],v[6:7],v[66:67]
v_pk_fma_f32 v[8:9],v[66:67],v[66:67],v[8:9]
v_pk_add_f32 v[6:7],v[6:7],v[68:69]
v_pk_fma_f32 v[8:9],v[68:69],v[68:69],v[8:9]
v_pk_add_f32 v[6:7],v[6:7],v[70:71]
v_pk_fma_f32 v[8:9],v[70:71],v[70:71],v[8:9]
v_add_f32 v6,v6,v7
v_add_f32 v7,v8,v9
v_mov_b32 v8,v6
v_mov_b32 v9,v7
s_nop 0
v_permlane32_swap_b32 v6,v8
v_permlane32_swap_b32 v7,v9
v_pk_add_f32 v[6:7],v[6:7],v[8:9]
s_mov_b32 exec_hi,0
s_cmp_lg_u32 s49,0
s_cbranch_scc0 ls_306
buffer_store_dwordx2 v[6:7],v114,s[8:11],s72 offen sc1
s_branch ls_307
ls_306:
buffer_store_dwordx2 v[6:7],v114,s[8:11],s72 offen
ls_307:
s_mov_b32 exec_hi,-1
s_mov_b32 s59,s82
s_branch W2_NEXT
nr_296:
buffer_load_dword v3,v2,s[8:11],s35 offen sc1
s_branch ep_295
W2_END:
s_endpgm
ROLE_W3:
v_lshlrev_b32 v1,4,v0
v_mov_b32 v5,1
s_lshl_b32 s56,s48,2
s_add_u32 s56,s56,s46
v_bfe_u32 v6,v0,2,2
v_lshrrev_b32 v7,4,v0
v_add_u32 v7,v6,v7
v_and_b32 v7,3,v7
v_and_b32 v15,3,v0
v_lshlrev_b32 v15,4,v15
v_lshl_add_u32 v15,v7,6,v15
v_lshl_add_u32 v15,v6,8,v15
v_lshrrev_b32 v6,5,v0
v_bfe_u32 v7,v0,4,1
v_lshlrev_b32 v16,10,v7
v_lshl_add_u32 v16,v6,8,v16
v_and_b32 v6,15,v0
v_lshl_add_u32 v16,v6,4,v16
v_add_u32 v18,46080,v16
v_lshrrev_b32 v6,5,v0
v_bfe_u32 v7,v0,4,1
v_lshlrev_b32 v20,10,v7
v_lshl_add_u32 v20,v6,8,v20
v_and_b32 v6,15,v0
v_lshl_add_u32 v20,v6,4,v20
v_lshrrev_b32 v6,5,v0
v_add_u32 v6,2,v6
v_bfe_u32 v7,v0,4,1
v_lshlrev_b32 v17,10,v7
v_lshl_add_u32 v17,v6,8,v17
v_and_b32 v6,15,v0
v_lshl_add_u32 v17,v6,4,v17
v_add_u32 v19,46080,v17
v_lshrrev_b32 v6,5,v0
v_add_u32 v6,2,v6
v_bfe_u32 v7,v0,4,1
v_lshlrev_b32 v21,10,v7
v_lshl_add_u32 v21,v6,8,v21
v_and_b32 v6,15,v0
v_lshl_add_u32 v21,v6,4,v21
v_min_u32 v2,19,v0
v_lshlrev_b32 v2,2,v2
v_mov_b32 v112,0xc0135761
v_mov_b32 v113,0xbdd2d3e8
s_mov_b32 s68,0xbdd2d3e8
v_lshrrev_b32 v6,5,v0
v_mul_u32_u24 v182,2560,v6
v_and_b32 v6,31,v0
v_lshl_add_u32 v182,v6,3,v182
v_add_u32 v182,0xa000,v182
v_mov_b32 v20,v1
v_add_u32 v21,1024,v1
v_mov_b32 v24,-1
v_mov_b32 v25,-1
v_mov_b32 v26,-1
v_mov_b32 v27,-1
s_add_u32 s60,s48,10
s_lshl2_add_u32 s60,s60,s46
s_mul_i32 s60,s60,22528
s_add_u32 s61,s60,24117248
buffer_store_dwordx4 v[24:27],v1,s[8:11],s61 offen sc1
buffer_store_dwordx4 v[24:27],v1,s[8:11],s61 offen offset:1024 sc1
buffer_store_dwordx4 v[24:27],v1,s[8:11],s61 offen offset:2048 sc1
buffer_store_dwordx4 v[24:27],v1,s[8:11],s61 offen offset:3072 sc1
s_add_u32 s61,s60,24121344
buffer_store_dwordx4 v[24:27],v1,s[8:11],s61 offen sc1
buffer_store_dwordx4 v[24:27],v1,s[8:11],s61 offen offset:1024 sc1
buffer_store_dwordx4 v[24:27],v1,s[8:11],s61 offen offset:2048 sc1
buffer_store_dwordx4 v[24:27],v1,s[8:11],s61 offen offset:3072 sc1
s_add_u32 s61,s60,24125440
buffer_store_dwordx4 v[24:27],v1,s[8:11],s61 offen sc1
buffer_store_dwordx4 v[24:27],v1,s[8:11],s61 offen offset:1024 sc1
buffer_store_dwordx4 v[24:27],v1,s[8:11],s61 offen offset:2048 sc1
buffer_store_dwordx4 v[24:27],v1,s[8:11],s61 offen offset:3072 sc1
s_add_u32 s61,s60,24129536
buffer_store_dwordx4 v[24:27],v1,s[8:11],s61 offen sc1
buffer_store_dwordx4 v[24:27],v1,s[8:11],s61 offen offset:1024 sc1
buffer_store_dwordx4 v[24:27],v1,s[8:11],s61 offen offset:2048 sc1
buffer_store_dwordx4 v[24:27],v1,s[8:11],s61 offen offset:3072 sc1
s_add_u32 s61,s60,24133632
buffer_store_dwordx4 v[24:27],v1,s[8:11],s61 offen sc1
buffer_store_dwordx4 v[24:27],v1,s[8:11],s61 offen offset:1024 sc1
buffer_store_dwordx4 v[24:27],v1,s[8:11],s61 offen offset:2048 sc1
buffer_store_dwordx4 v[24:27],v1,s[8:11],s61 offen offset:3072 sc1
s_add_u32 s61,s60,24137728
buffer_store_dwordx4 v[24:27],v1,s[8:11],s61 offen sc1
buffer_store_dwordx4 v[24:27],v1,s[8:11],s61 offen offset:1024 sc1
s_waitcnt vmcnt(0)
s_barrier
s_cmp_lg_u32 s46,0
s_cbranch_scc1 arr_308
v_mov_b32 v6,1
s_lshl_b32 s3,s49,2
v_mov_b32 v7,s3
s_mov_b64 exec,1
buffer_atomic_add v6,v7,s[12:15],0 offen sc1
s_mov_b64 exec,-1
arr_308:
s_lshl_b32 s3,s49,2
v_mov_b32 v7,s3
s_nop 1
ibw_309:
buffer_load_dword v6,v7,s[12:15],0 offen sc1
s_waitcnt vmcnt(0)
v_cmp_ne_u32 vcc,256,v6
s_nop 0
s_cbranch_vccz ok_310
s_sleep 8
s_sub_u32 s47,s47,1
s_cbranch_scc1 ABORT
s_branch ibw_309
ok_310:
s_cmp_lg_u32 s49,0
s_cbranch_scc1 ibok_311
v_and_b32 v7,7,v0
v_lshlrev_b32 v7,2,v7
buffer_load_dword v6,v7,s[12:15],0 offen offset:32 sc1
s_waitcnt vmcnt(0)
v_cmp_ne_u32 vcc,32,v6
s_nop 0
s_cbranch_vccz ibok_311
s_barrier
s_mov_b32 s49,1
s_mov_b32 s3,s2
s_load_dwordx16 s[16:31],s[0:1],0
s_load_dwordx8 s[32:39],s[0:1],64
s_waitcnt lgkmcnt(0)
s_branch DISPATCH
ibok_311:
s_lshl_b32 s58,s56,6
s_mul_i32 s63,s46,40960
s_mov_b32 s4,s36
s_mov_b32 s5,s37
s_mov_b32 s6,1966080
s_mov_b32 s7,0x20000
v_lshrrev_b32 v9,2,v0
s_mov_b32 s64,3072
v_mul_lo_u32 v9,v9,s64
v_and_b32 v10,3,v0
v_lshl_add_u32 v6,v10,4,v9
s_add_u32 m0,s63,0
s_add_u32 s65,s58,0
buffer_load_dwordx4 v6,s[4:7],s65 offen lds
s_add_u32 m0,s63,1024
s_add_u32 s65,s58,49152
buffer_load_dwordx4 v6,s[4:7],s65 offen lds
s_add_u32 m0,s63,2048
s_add_u32 s65,s58,98304
buffer_load_dwordx4 v6,s[4:7],s65 offen lds
s_add_u32 m0,s63,3072
s_add_u32 s65,s58,147456
buffer_load_dwordx4 v6,s[4:7],s65 offen lds
s_add_u32 m0,s63,4096
s_add_u32 s65,s58,196608
buffer_load_dwordx4 v6,s[4:7],s65 offen lds
s_add_u32 m0,s63,5120
s_add_u32 s65,s58,245760
buffer_load_dwordx4 v6,s[4:7],s65 offen lds
s_add_u32 m0,s63,6144
s_add_u32 s65,s58,294912
buffer_load_dwordx4 v6,s[4:7],s65 offen lds
s_add_u32 m0,s63,7168
s_add_u32 s65,s58,344064
buffer_load_dwordx4 v6,s[4:7],s65 offen lds
s_add_u32 m0,s63,8192
s_add_u32 s65,s58,393216
buffer_load_dwordx4 v6,s[4:7],s65 offen lds
s_add_u32 m0,s63,9216
s_add_u32 s65,s58,442368
buffer_load_dwordx4 v6,s[4:7],s65 offen lds
s_add_u32 m0,s63,10240
s_add_u32 s65,s58,491520
buffer_load_dwordx4 v6,s[4:7],s65 offen lds
s_add_u32 m0,s63,11264
s_add_u32 s65,s58,540672
buffer_load_dwordx4 v6,s[4:7],s65 offen lds
s_add_u32 m0,s63,12288
s_add_u32 s65,s58,589824
buffer_load_dwordx4 v6,s[4:7],s65 offen lds
s_add_u32 m0,s63,13312
s_add_u32 s65,s58,638976
buffer_load_dwordx4 v6,s[4:7],s65 offen lds
s_add_u32 m0,s63,14336
s_add_u32 s65,s58,688128
buffer_load_dwordx4 v6,s[4:7],s65 offen lds
s_add_u32 m0,s63,15360
s_add_u32 s65,s58,737280
buffer_load_dwordx4 v6,s[4:7],s65 offen lds
s_add_u32 m0,s63,16384
s_add_u32 s65,s58,786432
buffer_load_dwordx4 v6,s[4:7],s65 offen lds
s_add_u32 m0,s63,17408
s_add_u32 s65,s58,835584
buffer_load_dwordx4 v6,s[4:7],s65 offen lds
s_add_u32 m0,s63,18432
s_add_u32 s65,s58,884736
buffer_load_dwordx4 v6,s[4:7],s65 offen lds
s_add_u32 m0,s63,19456
s_add_u32 s65,s58,933888
buffer_load_dwordx4 v6,s[4:7],s65 offen lds
s_add_u32 m0,s63,20480
s_add_u32 s65,s58,983040
buffer_load_dwordx4 v6,s[4:7],s65 offen lds
s_add_u32 m0,s63,21504
s_add_u32 s65,s58,1032192
buffer_load_dwordx4 v6,s[4:7],s65 offen lds
s_add_u32 m0,s63,22528
s_add_u32 s65,s58,1081344
buffer_load_dwordx4 v6,s[4:7],s65 offen lds
s_add_u32 m0,s63,23552
s_add_u32 s65,s58,1130496
buffer_load_dwordx4 v6,s[4:7],s65 offen lds
s_add_u32 m0,s63,24576
s_add_u32 s65,s58,1179648
buffer_load_dwordx4 v6,s[4:7],s65 offen lds
s_add_u32 m0,s63,25600
s_add_u32 s65,s58,1228800
buffer_load_dwordx4 v6,s[4:7],s65 offen lds
s_add_u32 m0,s63,26624
s_add_u32 s65,s58,1277952
buffer_load_dwordx4 v6,s[4:7],s65 offen lds
s_add_u32 m0,s63,27648
s_add_u32 s65,s58,1327104
buffer_load_dwordx4 v6,s[4:7],s65 offen lds
s_add_u32 m0,s63,28672
s_add_u32 s65,s58,1376256
buffer_load_dwordx4 v6,s[4:7],s65 offen lds
s_add_u32 m0,s63,29696
s_add_u32 s65,s58,1425408
buffer_load_dwordx4 v6,s[4:7],s65 offen lds
s_add_u32 m0,s63,30720
s_add_u32 s65,s58,1474560
buffer_load_dwordx4 v6,s[4:7],s65 offen lds
s_add_u32 m0,s63,31744
s_add_u32 s65,s58,1523712
buffer_load_dwordx4 v6,s[4:7],s65 offen lds
s_add_u32 m0,s63,32768
s_add_u32 s65,s58,1572864
buffer_load_dwordx4 v6,s[4:7],s65 offen lds
s_add_u32 m0,s63,33792
s_add_u32 s65,s58,1622016
buffer_load_dwordx4 v6,s[4:7],s65 offen lds
s_add_u32 m0,s63,34816
s_add_u32 s65,s58,1671168
buffer_load_dwordx4 v6,s[4:7],s65 offen lds
s_add_u32 m0,s63,35840
s_add_u32 s65,s58,1720320
buffer_load_dwordx4 v6,s[4:7],s65 offen lds
s_add_u32 m0,s63,36864
s_add_u32 s65,s58,1769472
buffer_load_dwordx4 v6,s[4:7],s65 offen lds
s_add_u32 m0,s63,37888
s_add_u32 s65,s58,1818624
buffer_load_dwordx4 v6,s[4:7],s65 offen lds
s_add_u32 m0,s63,38912
s_add_u32 s65,s58,1867776
buffer_load_dwordx4 v6,s[4:7],s65 offen lds
s_add_u32 m0,s63,39936
s_add_u32 s65,s58,1916928
buffer_load_dwordx4 v6,s[4:7],s65 offen lds
s_waitcnt vmcnt(20)
v_bfe_u32 v9,v0,2,2
v_lshrrev_b32 v10,5,v0
v_lshl_add_u32 v9,v10,2,v9
v_mul_u32_u24 v9,64,v9
v_and_b32 v10,1,v0
v_lshl_add_u32 v9,v10,3,v9
v_bfe_u32 v10,v0,1,1
v_lshl_add_u32 v9,v10,5,v9
v_bfe_u32 v10,v0,4,1
v_lshl_add_u32 v9,v10,4,v9
v_add_u32 v7,s63,v9
ds_read_b64_tr_b16 a[0:1],v7 offset:0
ds_read_b64_tr_b16 a[2:3],v7 offset:1024
ds_read_b64_tr_b16 a[4:5],v7 offset:512
ds_read_b64_tr_b16 a[6:7],v7 offset:1536
ds_read_b64_tr_b16 a[8:9],v7 offset:2048
ds_read_b64_tr_b16 a[10:11],v7 offset:3072
ds_read_b64_tr_b16 a[12:13],v7 offset:2560
ds_read_b64_tr_b16 a[14:15],v7 offset:3584
ds_read_b64_tr_b16 a[16:17],v7 offset:4096
ds_read_b64_tr_b16 a[18:19],v7 offset:5120
ds_read_b64_tr_b16 a[20:21],v7 offset:4608
ds_read_b64_tr_b16 a[22:23],v7 offset:5632
s_waitcnt lgkmcnt(4)
ds_read_b64_tr_b16 a[24:25],v7 offset:6144
ds_read_b64_tr_b16 a[26:27],v7 offset:7168
ds_read_b64_tr_b16 a[28:29],v7 offset:6656
ds_read_b64_tr_b16 a[30:31],v7 offset:7680
ds_read_b64_tr_b16 a[32:33],v7 offset:8192
ds_read_b64_tr_b16 a[34:35],v7 offset:9216
ds_read_b64_tr_b16 a[36:37],v7 offset:8704
ds_read_b64_tr_b16 a[38:39],v7 offset:9728
ds_read_b64_tr_b16 a[40:41],v7 offset:10240
ds_read_b64_tr_b16 a[42:43],v7 offset:11264
ds_read_b64_tr_b16 a[44:45],v7 offset:10752
ds_read_b64_tr_b16 a[46:47],v7 offset:11776
s_waitcnt lgkmcnt(4)
ds_read_b64_tr_b16 a[48:49],v7 offset:12288
ds_read_b64_tr_b16 a[50:51],v7 offset:13312
ds_read_b64_tr_b16 a[52:53],v7 offset:12800
ds_read_b64_tr_b16 a[54:55],v7 offset:13824
ds_read_b64_tr_b16 a[56:57],v7 offset:14336
ds_read_b64_tr_b16 a[58:59],v7 offset:15360
ds_read_b64_tr_b16 a[60:61],v7 offset:14848
ds_read_b64_tr_b16 a[62:63],v7 offset:15872
ds_read_b64_tr_b16 a[64:65],v7 offset:16384
ds_read_b64_tr_b16 a[66:67],v7 offset:17408
ds_read_b64_tr_b16 a[68:69],v7 offset:16896
ds_read_b64_tr_b16 a[70:71],v7 offset:17920
s_waitcnt lgkmcnt(4)
ds_read_b64_tr_b16 a[72:73],v7 offset:18432
ds_read_b64_tr_b16 a[74:75],v7 offset:19456
ds_read_b64_tr_b16 a[76:77],v7 offset:18944
ds_read_b64_tr_b16 a[78:79],v7 offset:19968
s_waitcnt lgkmcnt(0)
s_waitcnt vmcnt(0)
v_bfe_u32 v9,v0,2,2
v_lshrrev_b32 v10,5,v0
v_lshl_add_u32 v9,v10,2,v9
v_mul_u32_u24 v9,64,v9
v_and_b32 v10,1,v0
v_lshl_add_u32 v9,v10,3,v9
v_bfe_u32 v10,v0,1,1
v_lshl_add_u32 v9,v10,5,v9
v_bfe_u32 v10,v0,4,1
v_lshl_add_u32 v9,v10,4,v9
v_add_u32 v7,s63,v9
ds_read_b64_tr_b16 a[80:81],v7 offset:20480
ds_read_b64_tr_b16 a[82:83],v7 offset:21504
ds_read_b64_tr_b16 a[84:85],v7 offset:20992
ds_read_b64_tr_b16 a[86:87],v7 offset:22016
ds_read_b64_tr_b16 a[88:89],v7 offset:22528
ds_read_b64_tr_b16 a[90:91],v7 offset:23552
ds_read_b64_tr_b16 a[92:93],v7 offset:23040
ds_read_b64_tr_b16 a[94:95],v7 offset:24064
ds_read_b64_tr_b16 a[96:97],v7 offset:24576
ds_read_b64_tr_b16 a[98:99],v7 offset:25600
ds_read_b64_tr_b16 a[100:101],v7 offset:25088
ds_read_b64_tr_b16 a[102:103],v7 offset:26112
s_waitcnt lgkmcnt(4)
ds_read_b64_tr_b16 a[104:105],v7 offset:26624
ds_read_b64_tr_b16 a[106:107],v7 offset:27648
ds_read_b64_tr_b16 a[108:109],v7 offset:27136
ds_read_b64_tr_b16 a[110:111],v7 offset:28160
ds_read_b64_tr_b16 a[112:113],v7 offset:28672
ds_read_b64_tr_b16 a[114:115],v7 offset:29696
ds_read_b64_tr_b16 a[116:117],v7 offset:29184
ds_read_b64_tr_b16 a[118:119],v7 offset:30208
ds_read_b64_tr_b16 a[120:121],v7 offset:30720
ds_read_b64_tr_b16 a[122:123],v7 offset:31744
ds_read_b64_tr_b16 a[124:125],v7 offset:31232
ds_read_b64_tr_b16 a[126:127],v7 offset:32256
s_waitcnt lgkmcnt(4)
ds_read_b64_tr_b16 a[128:129],v7 offset:32768
ds_read_b64_tr_b16 a[130:131],v7 offset:33792
ds_read_b64_tr_b16 a[132:133],v7 offset:33280
ds_read_b64_tr_b16 a[134:135],v7 offset:34304
ds_read_b64_tr_b16 a[136:137],v7 offset:34816
ds_read_b64_tr_b16 a[138:139],v7 offset:35840
ds_read_b64_tr_b16 a[140:141],v7 offset:35328
ds_read_b64_tr_b16 a[142:143],v7 offset:36352
ds_read_b64_tr_b16 a[144:145],v7 offset:36864
ds_read_b64_tr_b16 a[146:147],v7 offset:37888
ds_read_b64_tr_b16 a[148:149],v7 offset:37376
ds_read_b64_tr_b16 a[150:151],v7 offset:38400
s_waitcnt lgkmcnt(4)
ds_read_b64_tr_b16 a[152:153],v7 offset:38912
ds_read_b64_tr_b16 a[154:155],v7 offset:39936
ds_read_b64_tr_b16 a[156:157],v7 offset:39424
ds_read_b64_tr_b16 a[158:159],v7 offset:40448
s_waitcnt lgkmcnt(0)
v_mov_b32 v24,0x3f803f80
v_mov_b32 v25,0x3f803f80
v_mov_b32 v26,0x3f803f80
v_mov_b32 v27,0x3f803f80
s_nop 1
v_mfma_f32_32x32x16_bf16 v[144:159],a[0:3],v[24:27],0
v_mfma_f32_32x32x16_bf16 v[144:159],a[4:7],v[24:27],v[144:159]
v_mfma_f32_32x32x16_bf16 v[144:159],a[8:11],v[24:27],v[144:159]
v_mfma_f32_32x32x16_bf16 v[144:159],a[12:15],v[24:27],v[144:159]
v_mfma_f32_32x32x16_bf16 v[144:159],a[16:19],v[24:27],v[144:159]
v_mfma_f32_32x32x16_bf16 v[144:159],a[20:23],v[24:27],v[144:159]
v_mfma_f32_32x32x16_bf16 v[144:159],a[24:27],v[24:27],v[144:159]
v_mfma_f32_32x32x16_bf16 v[144:159],a[28:31],v[24:27],v[144:159]
v_mfma_f32_32x32x16_bf16 v[144:159],a[32:35],v[24:27],v[144:159]
v_mfma_f32_32x32x16_bf16 v[144:159],a[36:39],v[24:27],v[144:159]
v_mfma_f32_32x32x16_bf16 v[144:159],a[40:43],v[24:27],v[144:159]
v_mfma_f32_32x32x16_bf16 v[144:159],a[44:47],v[24:27],v[144:159]
v_mfma_f32_32x32x16_bf16 v[144:159],a[48:51],v[24:27],v[144:159]
v_mfma_f32_32x32x16_bf16 v[144:159],a[52:55],v[24:27],v[144:159]
v_mfma_f32_32x32x16_bf16 v[144:159],a[56:59],v[24:27],v[144:159]
v_mfma_f32_32x32x16_bf16 v[144:159],a[60:63],v[24:27],v[144:159]
v_mfma_f32_32x32x16_bf16 v[144:159],a[64:67],v[24:27],v[144:159]
v_mfma_f32_32x32x16_bf16 v[144:159],a[68:71],v[24:27],v[144:159]
v_mfma_f32_32x32x16_bf16 v[144:159],a[72:75],v[24:27],v[144:159]
v_mfma_f32_32x32x16_bf16 v[144:159],a[76:79],v[24:27],v[144:159]
v_mfma_f32_32x32x16_bf16 v[144:159],a[80:83],v[24:27],v[144:159]
v_mfma_f32_32x32x16_bf16 v[144:159],a[84:87],v[24:27],v[144:159]
v_mfma_f32_32x32x16_bf16 v[144:159],a[88:91],v[24:27],v[144:159]
v_mfma_f32_32x32x16_bf16 v[144:159],a[92:95],v[24:27],v[144:159]
v_mfma_f32_32x32x16_bf16 v[144:159],a[96:99],v[24:27],v[144:159]
v_mfma_f32_32x32x16_bf16 v[144:159],a[100:103],v[24:27],v[144:159]
v_mfma_f32_32x32x16_bf16 v[144:159],a[104:107],v[24:27],v[144:159]
v_mfma_f32_32x32x16_bf16 v[144:159],a[108:111],v[24:27],v[144:159]
v_mfma_f32_32x32x16_bf16 v[144:159],a[112:115],v[24:27],v[144:159]
v_mfma_f32_32x32x16_bf16 v[144:159],a[116:119],v[24:27],v[144:159]
v_mfma_f32_32x32x16_bf16 v[144:159],a[120:123],v[24:27],v[144:159]
v_mfma_f32_32x32x16_bf16 v[144:159],a[124:127],v[24:27],v[144:159]
v_mfma_f32_32x32x16_bf16 v[144:159],a[128:131],v[24:27],v[144:159]
v_mfma_f32_32x32x16_bf16 v[144:159],a[132:135],v[24:27],v[144:159]
v_mfma_f32_32x32x16_bf16 v[144:159],a[136:139],v[24:27],v[144:159]
v_mfma_f32_32x32x16_bf16 v[144:159],a[140:143],v[24:27],v[144:159]
v_mfma_f32_32x32x16_bf16 v[144:159],a[144:147],v[24:27],v[144:159]
v_mfma_f32_32x32x16_bf16 v[144:159],a[148:151],v[24:27],v[144:159]
v_mfma_f32_32x32x16_bf16 v[144:159],a[152:155],v[24:27],v[144:159]
v_mfma_f32_32x32x16_bf16 v[144:159],a[156:159],v[24:27],v[144:159]
s_barrier
s_mov_b32 s50,0
s_mov_b32 s32,0
s_mov_b32 s57,0
s_mov_b32 s59,2147483648
s_mov_b32 s82,2147483648
s_mov_b32 s39,2147483648
v_mov_b32 v22,94208
v_lshl_add_u32 v22,v0,2,v22
v_mov_b32 v23,0
ds_write_b32 v22,v23
s_mov_b32 s39,1600000
v_and_b32 v72,15,v0
v_lshlrev_b32 v72,7,v72
v_min_u32 v6,59,v0
v_lshlrev_b32 v6,2,v6
v_add_u32 v2,198656,v6
v_add_u32 v7,-80,v6
v_cmp_gt_u32 s[78:79],20,v0
s_nop 1
v_cndmask_b32 v2,v7,v2,s[78:79]
s_mov_b32 s51,0
s_mov_b32 s52,0
s_mul_i32 s62,s51,4
s_and_b32 s63,s52,3
s_add_u32 s62,s62,s63
s_mul_i32 s62,s62,98304
s_add_u32 s62,s62,242778112
s_lshl_b32 s63,s56,11
s_add_u32 s62,s62,s63
buffer_load_dword v73,v72,s[8:11],s62 offen sc1
s_mov_b32 s51,0
s_mov_b32 s52,1
s_mul_i32 s62,s51,4
s_and_b32 s63,s52,3
s_add_u32 s62,s62,s63
s_mul_i32 s62,s62,98304
s_add_u32 s62,s62,242778112
s_lshl_b32 s63,s56,11
s_add_u32 s62,s62,s63
buffer_load_dword v73,v72,s[8:11],s62 offen sc1
s_mov_b32 s51,0
s_mov_b32 s52,2
s_mul_i32 s62,s51,4
s_and_b32 s63,s52,3
s_add_u32 s62,s62,s63
s_mul_i32 s62,s62,98304
s_add_u32 s62,s62,242778112
s_lshl_b32 s63,s56,11
s_add_u32 s62,s62,s63
buffer_load_dword v73,v72,s[8:11],s62 offen sc1
s_mov_b32 s51,0
s_mov_b32 s52,3
s_mul_i32 s62,s51,4
s_and_b32 s63,s52,3
s_add_u32 s62,s62,s63
s_mul_i32 s62,s62,98304
s_add_u32 s62,s62,242778112
s_lshl_b32 s63,s56,11
s_add_u32 s62,s62,s63
buffer_load_dword v73,v72,s[8:11],s62 offen sc1
s_mov_b32 s51,1
s_mov_b32 s52,0
s_mul_i32 s62,s51,4
s_and_b32 s63,s52,3
s_add_u32 s62,s62,s63
s_mul_i32 s62,s62,98304
s_add_u32 s62,s62,242778112
s_lshl_b32 s63,s56,11
s_add_u32 s62,s62,s63
buffer_load_dword v73,v72,s[8:11],s62 offen sc1
s_mov_b32 s51,1
s_mov_b32 s52,1
s_mul_i32 s62,s51,4
s_and_b32 s63,s52,3
s_add_u32 s62,s62,s63
s_mul_i32 s62,s62,98304
s_add_u32 s62,s62,242778112
s_lshl_b32 s63,s56,11
s_add_u32 s62,s62,s63
buffer_load_dword v73,v72,s[8:11],s62 offen sc1
s_mov_b32 s51,1
s_mov_b32 s52,2
s_mul_i32 s62,s51,4
s_and_b32 s63,s52,3
s_add_u32 s62,s62,s63
s_mul_i32 s62,s62,98304
s_add_u32 s62,s62,242778112
s_lshl_b32 s63,s56,11
s_add_u32 s62,s62,s63
buffer_load_dword v73,v72,s[8:11],s62 offen sc1
s_mov_b32 s51,1
s_mov_b32 s52,3
s_mul_i32 s62,s51,4
s_and_b32 s63,s52,3
s_add_u32 s62,s62,s63
s_mul_i32 s62,s62,98304
s_add_u32 s62,s62,242778112
s_lshl_b32 s63,s56,11
s_add_u32 s62,s62,s63
buffer_load_dword v73,v72,s[8:11],s62 offen sc1
s_waitcnt vmcnt(0)
s_waitcnt lgkmcnt(0)
s_barrier
s_mov_b32 s83,s100
s_min_u32 s62,s32,127
s_sub_u32 s60,s62,17
s_lshr_b32 s34,s60,1
s_and_b32 s33,s60,1
s_cmp_eq_u32 s33,0
s_cselect_b32 s61,17,0
s_add_u32 s34,s34,s61
s_sub_u32 s61,s60,47
s_cmp_ge_u32 s60,94
s_cselect_b32 s34,s61,s34
s_cselect_b32 s33,1,s33
s_cmp_lt_u32 s62,17
s_cselect_b32 s34,s62,s34
s_cselect_b32 s33,0,s33
s_lshl_b32 s35,s33,6
s_add_u32 s35,s35,s34
s_lshl_b32 s35,s35,9
s_add_u32 s35,s35,325632
s_cmp_lt_u32 s34,4
s_cselect_b64 s[76:77],s[78:79],-1
s_sub_u32 s57,46080,s57
v_swap_b32 v16,v18
v_swap_b32 v17,v19
s_add_u32 s62,s32,1
s_min_u32 s62,s62,127
s_sub_u32 s60,s62,17
s_lshr_b32 s41,s60,1
s_and_b32 s40,s60,1
s_cmp_eq_u32 s40,0
s_cselect_b32 s61,17,0
s_add_u32 s41,s41,s61
s_sub_u32 s61,s60,47
s_cmp_ge_u32 s60,94
s_cselect_b32 s41,s61,s41
s_cselect_b32 s40,1,s40
s_cmp_lt_u32 s62,17
s_cselect_b32 s41,s62,s41
s_cselect_b32 s40,0,s40
s_lshl_b32 s42,s40,6
s_add_u32 s42,s42,s41
s_lshl_b32 s42,s42,9
s_add_u32 s42,s42,325632
s_cmp_lt_u32 s41,4
s_cselect_b64 s[80:81],s[78:79],-1
W3_COLD:
s_mov_b32 s37,0
fb_312:
buffer_load_dword v3,v2,s[8:11],s35 offen sc1
s_waitcnt vmcnt(0)
v_cmp_eq_u32 vcc,0,v3
s_and_b64 vcc,vcc,s[76:77]
s_cbranch_scc0 ok_313
s_sleep 1
s_sub_u32 s47,s47,1
s_cbranch_scc1 ABORT
s_branch fb_312
ok_313:
W3_COLD2:
s_sub_u32 s66,46080,s57
s_mul_i32 s60,s33,8
s_and_b32 s61,s34,7
s_add_u32 s60,s60,s61
s_mul_i32 s60,s60,46080
s_add_u32 s60,s60,s37
s_add_u32 s60,s60,212467712
s_mov_b32 s67,s60
s_mul_i32 s61,s46,10240
s_add_u32 s60,s60,s61
s_add_u32 s61,s61,s66
s_add_u32 m0,s61,0
s_add_u32 s63,s60,0
buffer_load_dwordx4 v1,s[8:11],s63 offen sc1 lds
buffer_load_dwordx4 v1,s[8:11],s63 offen offset:1024 sc1 lds
buffer_load_dwordx4 v1,s[8:11],s63 offen offset:2048 sc1 lds
buffer_load_dwordx4 v1,s[8:11],s63 offen offset:3072 sc1 lds
s_add_u32 m0,s61,4096
s_add_u32 s63,s60,4096
buffer_load_dwordx4 v1,s[8:11],s63 offen sc1 lds
buffer_load_dwordx4 v1,s[8:11],s63 offen offset:1024 sc1 lds
s_waitcnt vmcnt(5)
s_mov_b64 exec,1
s_cmp_lg_u32 s49,0
s_cbranch_scc0 ls_314
buffer_store_dword v5,v1,s[8:11],s59 offen sc1
s_branch ls_315
ls_314:
buffer_store_dword v5,v1,s[8:11],s59 offen
ls_315:
s_mov_b64 exec,-1
s_mov_b32 s59,2147483648
buffer_load_dwordx4 v1,s[8:11],s63 offen offset:2048 sc1 lds
buffer_load_dwordx4 v1,s[8:11],s63 offen offset:3072 sc1 lds
s_add_u32 m0,s61,8192
s_add_u32 s63,s60,8192
buffer_load_dwordx4 v1,s[8:11],s63 offen sc1 lds
buffer_load_dwordx4 v1,s[8:11],s63 offen offset:1024 sc1 lds
s_lshl_b32 s62,s46,10
s_add_u32 s62,s62,40960
s_add_u32 m0,s66,s62
s_add_u32 s63,s67,s62
buffer_load_dwordx4 v1,s[8:11],s63 offen sc1 lds
s_add_u32 m0,s66,45056
s_add_u32 s63,s67,45056
buffer_load_dwordx4 v1,s[8:11],s63 offen sc1 lds
s_mov_b32 s35,s42
s_mov_b32 s53,s33
s_mov_b32 s54,s34
s_add_u32 s32,s32,1
s_mov_b32 s33,s40
s_mov_b32 s34,s41
s_mov_b64 s[76:77],s[80:81]
s_sub_u32 s57,46080,s57
v_swap_b32 v16,v18
v_swap_b32 v17,v19
s_mov_b32 s51,s53
s_mov_b32 s52,s54
s_waitcnt vmcnt(7)
s_branch W3_GO
W3_NEXT:
s_sub_u32 s57,46080,s57
v_swap_b32 v16,v18
v_swap_b32 v17,v19
s_mov_b32 s51,s53
s_mov_b32 s52,s54
s_waitcnt vmcnt(2)
W3_GO:
s_barrier
ds_read_b128 v[24:27],v16 offset:0
ds_read_b128 v[28:31],v17 offset:0
ds_read_b128 v[32:35],v16 offset:10240
ds_read_b128 v[36:39],v17 offset:10240
ds_read_b128 v[40:43],v16 offset:20480
ds_read_b128 v[44:47],v17 offset:20480
ds_read_b128 v[48:51],v16 offset:30720
buffer_load_dword v3,v2,s[8:11],s35 offen sc1
s_waitcnt lgkmcnt(6)
v_mfma_f32_32x32x16_bf16 v[56:71],a[0:3],v[24:27],0
ds_read_b128 v[52:55],v17 offset:30720
s_add_u32 s62,s32,1
s_min_u32 s62,s62,127
s_sub_u32 s60,s62,17
s_waitcnt lgkmcnt(6)
v_mfma_f32_32x32x16_bf16 v[56:71],a[4:7],v[28:31],v[56:71]
ds_read_b128 v[24:27],v16 offset:2048
s_lshr_b32 s41,s60,1
s_and_b32 s40,s60,1
s_mul_i32 s71,s51,4
s_waitcnt lgkmcnt(5)
v_mfma_f32_32x32x16_bf16 v[56:71],a[40:43],v[32:35],v[56:71]
ds_read_b128 v[28:31],v17 offset:2048
s_cmp_eq_u32 s40,0
s_cselect_b32 s61,17,0
s_add_u32 s41,s41,s61
s_sub_u32 s61,s60,47
v_mfma_f32_32x32x16_bf16 v[56:71],a[44:47],v[36:39],v[56:71]
ds_read_b128 v[32:35],v16 offset:12288
s_cmp_ge_u32 s60,94
s_cselect_b32 s41,s61,s41
s_cselect_b32 s40,1,s40
s_waitcnt lgkmcnt(5)
v_mfma_f32_32x32x16_bf16 v[56:71],a[80:83],v[40:43],v[56:71]
ds_read_b128 v[36:39],v17 offset:12288
s_cmp_lt_u32 s62,17
s_cselect_b32 s41,s62,s41
s_cselect_b32 s40,0,s40
s_lshl_b32 s42,s40,6
v_mfma_f32_32x32x16_bf16 v[56:71],a[84:87],v[44:47],v[56:71]
ds_read_b128 v[40:43],v16 offset:22528
s_add_u32 s42,s42,s41
s_lshl_b32 s42,s42,9
s_add_u32 s42,s42,325632
s_waitcnt lgkmcnt(5)
v_mfma_f32_32x32x16_bf16 v[56:71],a[120:123],v[48:51],v[56:71]
ds_read_b128 v[44:47],v17 offset:22528
s_cmp_lt_u32 s41,4
s_cselect_b64 s[80:81],s[78:79],-1
s_and_b32 s72,s52,3
s_add_u32 s71,s71,s72
v_mfma_f32_32x32x16_bf16 v[56:71],a[124:127],v[52:55],v[56:71]
ds_read_b128 v[48:51],v16 offset:32768
s_mul_i32 s71,s71,98304
s_add_u32 s71,s71,242778112
s_lshl_b32 s72,s56,11
s_waitcnt lgkmcnt(5)
v_mfma_f32_32x32x16_bf16 v[56:71],a[8:11],v[24:27],v[56:71]
ds_read_b128 v[52:55],v17 offset:32768
s_add_u32 s71,s71,s72
s_lshl_b32 s82,s51,6
s_add_u32 s82,s82,s52
s_lshl_b32 s82,s82,9
v_mfma_f32_32x32x16_bf16 v[56:71],a[12:15],v[28:31],v[56:71]
ds_read_b128 v[24:27],v16 offset:4096
s_add_u32 s82,s82,589824
s_lshl_b32 s70,s56,2
s_add_u32 s82,s82,s70
s_waitcnt lgkmcnt(5)
v_mfma_f32_32x32x16_bf16 v[56:71],a[48:51],v[32:35],v[56:71]
ds_read_b128 v[28:31],v17 offset:4096
v_mfma_f32_32x32x16_bf16 v[56:71],a[52:55],v[36:39],v[56:71]
ds_read_b128 v[32:35],v16 offset:14336
s_waitcnt lgkmcnt(5)
v_mfma_f32_32x32x16_bf16 v[56:71],a[88:91],v[40:43],v[56:71]
ds_read_b128 v[36:39],v17 offset:14336
s_waitcnt vmcnt(0)
s_mov_b64 exec,1
s_cmp_lg_u32 s49,0
s_cbranch_scc0 ls_316
buffer_store_dword v5,v1,s[8:11],s59 offen sc1
s_branch ls_317
ls_316:
buffer_store_dword v5,v1,s[8:11],s59 offen
ls_317:
s_mov_b64 exec,-1
s_mov_b32 s59,2147483648
v_mfma_f32_32x32x16_bf16 v[56:71],a[92:95],v[44:47],v[56:71]
ds_read_b128 v[40:43],v16 offset:24576
v_cmp_eq_u32 vcc,0,v3
s_and_b64 vcc,vcc,s[76:77]
s_cselect_b32 s37,2147483648,0
s_waitcnt lgkmcnt(5)
v_mfma_f32_32x32x16_bf16 v[56:71],a[128:131],v[48:51],v[56:71]
ds_read_b128 v[44:47],v17 offset:24576
s_cmp_lt_u32 s32,128
s_cselect_b32 s37,s37,2147483648
s_sub_u32 s66,46080,s57
s_mul_i32 s60,s33,8
v_mfma_f32_32x32x16_bf16 v[56:71],a[132:135],v[52:55],v[56:71]
ds_read_b128 v[48:51],v16 offset:34816
s_and_b32 s61,s34,7
s_add_u32 s60,s60,s61
s_mul_i32 s60,s60,46080
s_waitcnt lgkmcnt(5)
v_mfma_f32_32x32x16_bf16 v[56:71],a[16:19],v[24:27],v[56:71]
ds_read_b128 v[52:55],v17 offset:34816
s_add_u32 s60,s60,s37
s_add_u32 s60,s60,212467712
s_mov_b32 s67,s60
s_mul_i32 s61,s46,10240
s_barrier
v_mfma_f32_32x32x16_bf16 v[56:71],a[20:23],v[28:31],v[56:71]
ds_read_b128 v[24:27],v16 offset:6144
v_add_u32 v183,s57,v182
s_add_u32 s60,s60,s61
s_add_u32 s61,s61,s66
s_waitcnt lgkmcnt(5)
v_mfma_f32_32x32x16_bf16 v[56:71],a[56:59],v[32:35],v[56:71]
ds_read_b128 v[28:31],v17 offset:6144
v_add_u32 v8,0x800,v183
s_add_u32 m0,s61,0
s_add_u32 s63,s60,0
v_mfma_f32_32x32x16_bf16 v[56:71],a[60:63],v[36:39],v[56:71]
ds_read_b128 v[32:35],v16 offset:16384
ds_read2_b64 v[160:163],v183 offset0:0 offset1:32
s_waitcnt lgkmcnt(6)
v_mfma_f32_32x32x16_bf16 v[56:71],a[96:99],v[40:43],v[56:71]
ds_read_b128 v[36:39],v17 offset:16384
ds_read2_b64 v[164:167],v183 offset0:64 offset1:96
buffer_load_dwordx4 v1,s[8:11],s63 offen sc1 lds
v_mfma_f32_32x32x16_bf16 v[56:71],a[100:103],v[44:47],v[56:71]
ds_read_b128 v[40:43],v16 offset:26624
ds_read2_b64 v[168:171],v183 offset0:128 offset1:160
s_waitcnt lgkmcnt(8)
v_mfma_f32_32x32x16_bf16 v[56:71],a[136:139],v[48:51],v[56:71]
ds_read_b128 v[44:47],v17 offset:26624
ds_read2_b64 v[172:175],v183 offset0:192 offset1:224
buffer_load_dwordx4 v1,s[8:11],s63 offen offset:1024 sc1 lds
v_mfma_f32_32x32x16_bf16 v[56:71],a[140:143],v[52:55],v[56:71]
ds_read_b128 v[48:51],v16 offset:36864
ds_read2_b64 v[176:179],v8 offset0:0 offset1:32
s_waitcnt lgkmcnt(10)
v_mfma_f32_32x32x16_bf16 v[56:71],a[24:27],v[24:27],v[56:71]
ds_read_b128 v[52:55],v17 offset:36864
buffer_load_dwordx4 v1,s[8:11],s63 offen offset:2048 sc1 lds
v_mfma_f32_32x32x16_bf16 v[56:71],a[28:31],v[28:31],v[56:71]
ds_read_b128 v[24:27],v16 offset:8192
s_waitcnt lgkmcnt(9)
v_mfma_f32_32x32x16_bf16 v[56:71],a[64:67],v[32:35],v[56:71]
ds_read_b128 v[28:31],v17 offset:8192
buffer_load_dwordx4 v1,s[8:11],s63 offen offset:3072 sc1 lds
s_add_u32 m0,s61,4096
s_add_u32 s63,s60,4096
v_mfma_f32_32x32x16_bf16 v[56:71],a[68:71],v[36:39],v[56:71]
ds_read_b128 v[32:35],v16 offset:18432
s_waitcnt lgkmcnt(4)
v_add_f32 v160,v160,v170
v_add_f32 v161,v161,v171
v_mfma_f32_32x32x16_bf16 v[56:71],a[104:107],v[40:43],v[56:71]
ds_read_b128 v[36:39],v17 offset:18432
buffer_load_dwordx4 v1,s[8:11],s63 offen sc1 lds
v_add_f32 v162,v162,v172
v_add_f32 v163,v163,v173
v_mfma_f32_32x32x16_bf16 v[56:71],a[108:111],v[44:47],v[56:71]
ds_read_b128 v[40:43],v16 offset:28672
v_add_f32 v164,v164,v174
v_add_f32 v165,v165,v175
v_add_f32 v166,v166,v176
s_waitcnt lgkmcnt(5)
v_mfma_f32_32x32x16_bf16 v[56:71],a[144:147],v[48:51],v[56:71]
ds_read_b128 v[44:47],v17 offset:28672
buffer_load_dword v3,v2,s[8:11],s35 offen sc1
v_add_f32 v167,v167,v177
v_mfma_f32_32x32x16_bf16 v[56:71],a[148:151],v[52:55],v[56:71]
ds_read_b128 v[48:51],v16 offset:38912
buffer_load_dwordx4 v1,s[8:11],s63 offen offset:1024 sc1 lds
v_add_f32 v168,v168,v178
s_waitcnt lgkmcnt(5)
v_mfma_f32_32x32x16_bf16 v[56:71],a[32:35],v[24:27],v[56:71]
ds_read_b128 v[52:55],v17 offset:38912
v_add_f32 v169,v169,v179
v_add_f32 v160,v160,v162
v_add_f32 v161,v161,v163
v_add_f32 v164,v164,v166
v_mfma_f32_32x32x16_bf16 v[56:71],a[36:39],v[28:31],v[56:71]
buffer_load_dwordx4 v1,s[8:11],s63 offen offset:2048 sc1 lds
v_add_f32 v165,v165,v167
v_add_f32 v160,v160,v164
v_add_f32 v161,v161,v165
s_waitcnt lgkmcnt(4)
v_mfma_f32_32x32x16_bf16 v[56:71],a[72:75],v[32:35],v[56:71]
v_add_f32 v160,v160,v168
v_add_f32 v161,v161,v169
v_mov_b32 v162,v160
v_mov_b32 v163,v161
s_nop 0
v_permlane32_swap_b32 v160,v162
v_mfma_f32_32x32x16_bf16 v[56:71],a[76:79],v[36:39],v[56:71]
buffer_load_dwordx4 v1,s[8:11],s63 offen offset:3072 sc1 lds
s_add_u32 m0,s61,8192
s_add_u32 s63,s60,8192
v_permlane32_swap_b32 v161,v163
s_waitcnt lgkmcnt(2)
v_mfma_f32_32x32x16_bf16 v[56:71],a[112:115],v[40:43],v[56:71]
v_add_f32 v180,v160,v162
v_add_f32 v181,v161,v163
v_mul_f32 v180,0x3acccccd,v180
v_mul_f32 v181,0x3acccccd,v181
v_fma_f32 v181,-v180,v180,v181
v_mfma_f32_32x32x16_bf16 v[56:71],a[116:119],v[44:47],v[56:71]
buffer_load_dwordx4 v1,s[8:11],s63 offen sc1 lds
v_max_f32 v181,0,v181
v_cvt_pk_bf16_f32 v8,v180,v181
v_lshlrev_b32 v180,16,v8
s_waitcnt lgkmcnt(0)
v_mfma_f32_32x32x16_bf16 v[56:71],a[152:155],v[48:51],v[56:71]
v_and_b32 v181,0xffff0000,v8
v_add_f32 v181,0x3727c5ac,v181
v_cvt_pk_bf16_f32 v8,v181,v181
v_lshlrev_b32 v181,16,v8
v_sqrt_f32 v181,v181
v_mfma_f32_32x32x16_bf16 v[56:71],a[156:159],v[52:55],v[56:71]
buffer_load_dwordx4 v1,s[8:11],s63 offen offset:1024 sc1 lds
s_lshl_b32 s62,s46,10
s_add_u32 s62,s62,40960
s_add_u32 m0,s66,s62
s_add_u32 s63,s67,s62
buffer_load_dwordx4 v1,s[8:11],s63 offen sc1 lds
s_add_u32 m0,s66,45056
s_add_u32 s63,s67,45056
buffer_load_dwordx4 v1,s[8:11],s63 offen sc1 lds
v_cvt_pk_bf16_f32 v8,v181,v181
v_lshlrev_b32 v181,16,v8
v_rcp_f32 v181,v181
s_cmp_eq_u32 s37,0
s_cbranch_scc0 sec_320
s_mov_b32 s35,s42
s_mov_b32 s53,s33
s_mov_b32 s54,s34
s_add_u32 s32,s32,1
s_mov_b32 s33,s40
s_mov_b32 s34,s41
s_mov_b64 s[76:77],s[80:81]
s_nop 2
ep_318:
v_pk_fma_f32 v[56:57],v[144:145],v[180:181],v[56:57] op_sel_hi:[1,0,1] neg_lo:[0,1,0] neg_hi:[0,1,0]
v_pk_fma_f32 v[58:59],v[146:147],v[180:181],v[58:59] op_sel_hi:[1,0,1] neg_lo:[0,1,0] neg_hi:[0,1,0]
v_pk_fma_f32 v[60:61],v[148:149],v[180:181],v[60:61] op_sel_hi:[1,0,1] neg_lo:[0,1,0] neg_hi:[0,1,0]
v_pk_fma_f32 v[62:63],v[150:151],v[180:181],v[62:63] op_sel_hi:[1,0,1] neg_lo:[0,1,0] neg_hi:[0,1,0]
v_pk_fma_f32 v[64:65],v[152:153],v[180:181],v[64:65] op_sel_hi:[1,0,1] neg_lo:[0,1,0] neg_hi:[0,1,0]
v_pk_fma_f32 v[66:67],v[154:155],v[180:181],v[66:67] op_sel_hi:[1,0,1] neg_lo:[0,1,0] neg_hi:[0,1,0]
v_pk_fma_f32 v[68:69],v[156:157],v[180:181],v[68:69] op_sel_hi:[1,0,1] neg_lo:[0,1,0] neg_hi:[0,1,0]
v_pk_fma_f32 v[70:71],v[158:159],v[180:181],v[70:71] op_sel_hi:[1,0,1] neg_lo:[0,1,0] neg_hi:[0,1,0]
v_pk_mul_f32 v[56:57],v[56:57],v[180:181] op_sel:[0,1] op_sel_hi:[1,1]
v_pk_mul_f32 v[58:59],v[58:59],v[180:181] op_sel:[0,1] op_sel_hi:[1,1]
v_pk_mul_f32 v[60:61],v[60:61],v[180:181] op_sel:[0,1] op_sel_hi:[1,1]
v_pk_mul_f32 v[62:63],v[62:63],v[180:181] op_sel:[0,1] op_sel_hi:[1,1]
v_pk_mul_f32 v[64:65],v[64:65],v[180:181] op_sel:[0,1] op_sel_hi:[1,1]
v_pk_mul_f32 v[66:67],v[66:67],v[180:181] op_sel:[0,1] op_sel_hi:[1,1]
v_pk_mul_f32 v[68:69],v[68:69],v[180:181] op_sel:[0,1] op_sel_hi:[1,1]
v_pk_mul_f32 v[70:71],v[70:71],v[180:181] op_sel:[0,1] op_sel_hi:[1,1]
v_pk_mul_f32 v[124:125],v[56:57],v[56:57]
v_pk_mul_f32 v[126:127],v[58:59],v[58:59]
v_pk_mul_f32 v[128:129],v[60:61],v[60:61]
v_pk_mul_f32 v[130:131],v[62:63],v[62:63]
v_pk_mul_f32 v[132:133],v[64:65],v[64:65]
v_pk_mul_f32 v[134:135],v[66:67],v[66:67]
v_pk_mul_f32 v[136:137],v[68:69],v[68:69]
v_pk_mul_f32 v[138:139],v[70:71],v[70:71]
v_pk_fma_f32 v[124:125],v[124:125],v[112:113],v[112:113] op_sel:[0,1,0] op_sel_hi:[1,1,0]
v_pk_fma_f32 v[126:127],v[126:127],v[112:113],v[112:113] op_sel:[0,1,0] op_sel_hi:[1,1,0]
v_pk_fma_f32 v[128:129],v[128:129],v[112:113],v[112:113] op_sel:[0,1,0] op_sel_hi:[1,1,0]
v_pk_fma_f32 v[130:131],v[130:131],v[112:113],v[112:113] op_sel:[0,1,0] op_sel_hi:[1,1,0]
v_pk_fma_f32 v[132:133],v[132:133],v[112:113],v[112:113] op_sel:[0,1,0] op_sel_hi:[1,1,0]
v_pk_fma_f32 v[134:135],v[134:135],v[112:113],v[112:113] op_sel:[0,1,0] op_sel_hi:[1,1,0]
v_pk_fma_f32 v[136:137],v[136:137],v[112:113],v[112:113] op_sel:[0,1,0] op_sel_hi:[1,1,0]
v_pk_fma_f32 v[138:139],v[138:139],v[112:113],v[112:113] op_sel:[0,1,0] op_sel_hi:[1,1,0]
v_pk_mul_f32 v[124:125],v[124:125],v[56:57]
v_pk_mul_f32 v[126:127],v[126:127],v[58:59]
v_pk_mul_f32 v[128:129],v[128:129],v[60:61]
v_pk_mul_f32 v[130:131],v[130:131],v[62:63]
v_pk_mul_f32 v[132:133],v[132:133],v[64:65]
v_pk_mul_f32 v[134:135],v[134:135],v[66:67]
v_pk_mul_f32 v[136:137],v[136:137],v[68:69]
v_pk_mul_f32 v[138:139],v[138:139],v[70:71]
v_exp_f32 v124,v124
v_exp_f32 v125,v125
v_exp_f32 v126,v126
v_exp_f32 v127,v127
v_exp_f32 v128,v128
v_exp_f32 v129,v129
v_exp_f32 v130,v130
v_exp_f32 v131,v131
v_exp_f32 v132,v132
v_exp_f32 v133,v133
v_exp_f32 v134,v134
v_exp_f32 v135,v135
v_exp_f32 v136,v136
v_exp_f32 v137,v137
v_exp_f32 v138,v138
v_exp_f32 v139,v139
v_pk_add_f32 v[124:125],v[124:125],1.0 op_sel_hi:[1,0]
v_pk_add_f32 v[126:127],v[126:127],1.0 op_sel_hi:[1,0]
v_pk_add_f32 v[128:129],v[128:129],1.0 op_sel_hi:[1,0]
v_pk_add_f32 v[130:131],v[130:131],1.0 op_sel_hi:[1,0]
v_pk_add_f32 v[132:133],v[132:133],1.0 op_sel_hi:[1,0]
v_pk_add_f32 v[134:135],v[134:135],1.0 op_sel_hi:[1,0]
v_pk_add_f32 v[136:137],v[136:137],1.0 op_sel_hi:[1,0]
v_pk_add_f32 v[138:139],v[138:139],1.0 op_sel_hi:[1,0]
v_rcp_f32 v124,v124
v_rcp_f32 v125,v125
v_rcp_f32 v126,v126
v_rcp_f32 v127,v127
v_rcp_f32 v128,v128
v_rcp_f32 v129,v129
v_rcp_f32 v130,v130
v_rcp_f32 v131,v131
v_rcp_f32 v132,v132
v_rcp_f32 v133,v133
v_rcp_f32 v134,v134
v_rcp_f32 v135,v135
v_rcp_f32 v136,v136
v_rcp_f32 v137,v137
v_rcp_f32 v138,v138
v_rcp_f32 v139,v139
v_pk_mul_f32 v[56:57],v[56:57],v[124:125]
v_pk_mul_f32 v[58:59],v[58:59],v[126:127]
v_pk_mul_f32 v[60:61],v[60:61],v[128:129]
v_pk_mul_f32 v[62:63],v[62:63],v[130:131]
v_pk_mul_f32 v[64:65],v[64:65],v[132:133]
v_pk_mul_f32 v[66:67],v[66:67],v[134:135]
v_pk_mul_f32 v[68:69],v[68:69],v[136:137]
v_pk_mul_f32 v[70:71],v[70:71],v[138:139]
v_cvt_pk_bf16_f32 v116,v56,v57
v_cvt_pk_bf16_f32 v117,v58,v59
v_cvt_pk_bf16_f32 v118,v60,v61
v_cvt_pk_bf16_f32 v119,v62,v63
v_cvt_pk_bf16_f32 v120,v64,v65
v_cvt_pk_bf16_f32 v121,v66,v67
v_cvt_pk_bf16_f32 v122,v68,v69
v_cvt_pk_bf16_f32 v123,v70,v71
s_cmp_lg_u32 s49,0
s_cbranch_scc0 ls_321
buffer_store_dwordx4 v[116:119],v20,s[8:11],s71 offen sc1
buffer_store_dwordx4 v[120:123],v21,s[8:11],s71 offen sc1
s_branch ls_322
ls_321:
buffer_store_dwordx4 v[116:119],v20,s[8:11],s71 offen
buffer_store_dwordx4 v[120:123],v21,s[8:11],s71 offen
ls_322:
s_mov_b32 s59,s82
s_cmp_eq_u32 s37,0
s_cbranch_scc1 W3_NEXT
s_waitcnt vmcnt(2)
v_cmp_eq_u32 vcc,0,v3
s_and_b64 vcc,vcc,s[76:77]
s_cselect_b32 s37,2147483648,0
s_cmp_lt_u32 s32,128
s_cselect_b32 s37,s37,2147483648
s_cmp_eq_u32 s37,0
s_cbranch_scc1 W3_COLD2
s_waitcnt vmcnt(0)
s_mov_b64 exec,1
s_cmp_lg_u32 s49,0
s_cbranch_scc0 ls_323
buffer_store_dword v5,v1,s[8:11],s59 offen sc1
s_branch ls_324
ls_323:
buffer_store_dword v5,v1,s[8:11],s59 offen
ls_324:
s_mov_b64 exec,-1
s_mov_b32 s59,2147483648
s_cmp_lt_u32 s32,128
s_cbranch_scc1 W3_COLD
s_branch W3_END
sec_320:
s_waitcnt vmcnt(7)
v_cmp_eq_u32 vcc,0,v3
s_and_b64 vcc,vcc,s[76:77]
s_cselect_b32 s37,2147483648,0
s_cmp_lt_u32 s32,128
s_cselect_b32 s37,s37,2147483648
s_cmp_lg_u32 s37,0
s_cbranch_scc1 nr_319
s_sub_u32 s66,46080,s57
s_mul_i32 s60,s33,8
s_and_b32 s61,s34,7
s_add_u32 s60,s60,s61
s_mul_i32 s60,s60,46080
s_add_u32 s60,s60,s37
s_add_u32 s60,s60,212467712
s_mov_b32 s67,s60
s_mul_i32 s61,s46,10240
s_add_u32 s60,s60,s61
s_add_u32 s61,s61,s66
s_add_u32 m0,s61,0
s_add_u32 s63,s60,0
buffer_load_dwordx4 v1,s[8:11],s63 offen sc1 lds
v_pk_fma_f32 v[56:57],v[144:145],v[180:181],v[56:57] op_sel_hi:[1,0,1] neg_lo:[0,1,0] neg_hi:[0,1,0]
v_pk_fma_f32 v[58:59],v[146:147],v[180:181],v[58:59] op_sel_hi:[1,0,1] neg_lo:[0,1,0] neg_hi:[0,1,0]
v_pk_fma_f32 v[60:61],v[148:149],v[180:181],v[60:61] op_sel_hi:[1,0,1] neg_lo:[0,1,0] neg_hi:[0,1,0]
v_pk_fma_f32 v[62:63],v[150:151],v[180:181],v[62:63] op_sel_hi:[1,0,1] neg_lo:[0,1,0] neg_hi:[0,1,0]
v_pk_fma_f32 v[64:65],v[152:153],v[180:181],v[64:65] op_sel_hi:[1,0,1] neg_lo:[0,1,0] neg_hi:[0,1,0]
v_pk_fma_f32 v[66:67],v[154:155],v[180:181],v[66:67] op_sel_hi:[1,0,1] neg_lo:[0,1,0] neg_hi:[0,1,0]
v_pk_fma_f32 v[68:69],v[156:157],v[180:181],v[68:69] op_sel_hi:[1,0,1] neg_lo:[0,1,0] neg_hi:[0,1,0]
buffer_load_dwordx4 v1,s[8:11],s63 offen offset:1024 sc1 lds
v_pk_fma_f32 v[70:71],v[158:159],v[180:181],v[70:71] op_sel_hi:[1,0,1] neg_lo:[0,1,0] neg_hi:[0,1,0]
v_pk_mul_f32 v[56:57],v[56:57],v[180:181] op_sel:[0,1] op_sel_hi:[1,1]
v_pk_mul_f32 v[58:59],v[58:59],v[180:181] op_sel:[0,1] op_sel_hi:[1,1]
v_pk_mul_f32 v[60:61],v[60:61],v[180:181] op_sel:[0,1] op_sel_hi:[1,1]
v_pk_mul_f32 v[62:63],v[62:63],v[180:181] op_sel:[0,1] op_sel_hi:[1,1]
v_pk_mul_f32 v[64:65],v[64:65],v[180:181] op_sel:[0,1] op_sel_hi:[1,1]
v_pk_mul_f32 v[66:67],v[66:67],v[180:181] op_sel:[0,1] op_sel_hi:[1,1]
buffer_load_dwordx4 v1,s[8:11],s63 offen offset:2048 sc1 lds
v_pk_mul_f32 v[68:69],v[68:69],v[180:181] op_sel:[0,1] op_sel_hi:[1,1]
v_pk_mul_f32 v[70:71],v[70:71],v[180:181] op_sel:[0,1] op_sel_hi:[1,1]
v_pk_mul_f32 v[124:125],v[56:57],v[56:57]
v_pk_mul_f32 v[126:127],v[58:59],v[58:59]
v_pk_mul_f32 v[128:129],v[60:61],v[60:61]
v_pk_mul_f32 v[130:131],v[62:63],v[62:63]
v_pk_mul_f32 v[132:133],v[64:65],v[64:65]
buffer_load_dwordx4 v1,s[8:11],s63 offen offset:3072 sc1 lds
v_pk_mul_f32 v[134:135],v[66:67],v[66:67]
v_pk_mul_f32 v[136:137],v[68:69],v[68:69]
v_pk_mul_f32 v[138:139],v[70:71],v[70:71]
v_pk_fma_f32 v[124:125],v[124:125],v[112:113],v[112:113] op_sel:[0,1,0] op_sel_hi:[1,1,0]
v_pk_fma_f32 v[126:127],v[126:127],v[112:113],v[112:113] op_sel:[0,1,0] op_sel_hi:[1,1,0]
v_pk_fma_f32 v[128:129],v[128:129],v[112:113],v[112:113] op_sel:[0,1,0] op_sel_hi:[1,1,0]
v_pk_fma_f32 v[130:131],v[130:131],v[112:113],v[112:113] op_sel:[0,1,0] op_sel_hi:[1,1,0]
s_add_u32 m0,s61,4096
s_add_u32 s63,s60,4096
buffer_load_dwordx4 v1,s[8:11],s63 offen sc1 lds
v_pk_fma_f32 v[132:133],v[132:133],v[112:113],v[112:113] op_sel:[0,1,0] op_sel_hi:[1,1,0]
v_pk_fma_f32 v[134:135],v[134:135],v[112:113],v[112:113] op_sel:[0,1,0] op_sel_hi:[1,1,0]
v_pk_fma_f32 v[136:137],v[136:137],v[112:113],v[112:113] op_sel:[0,1,0] op_sel_hi:[1,1,0]
v_pk_fma_f32 v[138:139],v[138:139],v[112:113],v[112:113] op_sel:[0,1,0] op_sel_hi:[1,1,0]
v_pk_mul_f32 v[124:125],v[124:125],v[56:57]
v_pk_mul_f32 v[126:127],v[126:127],v[58:59]
v_pk_mul_f32 v[128:129],v[128:129],v[60:61]
buffer_load_dwordx4 v1,s[8:11],s63 offen offset:1024 sc1 lds
v_pk_mul_f32 v[130:131],v[130:131],v[62:63]
v_pk_mul_f32 v[132:133],v[132:133],v[64:65]
v_pk_mul_f32 v[134:135],v[134:135],v[66:67]
v_pk_mul_f32 v[136:137],v[136:137],v[68:69]
v_pk_mul_f32 v[138:139],v[138:139],v[70:71]
v_exp_f32 v124,v124
v_exp_f32 v125,v125
buffer_load_dwordx4 v1,s[8:11],s63 offen offset:2048 sc1 lds
v_exp_f32 v126,v126
v_exp_f32 v127,v127
v_exp_f32 v128,v128
v_exp_f32 v129,v129
v_exp_f32 v130,v130
v_exp_f32 v131,v131
v_exp_f32 v132,v132
buffer_load_dwordx4 v1,s[8:11],s63 offen offset:3072 sc1 lds
v_exp_f32 v133,v133
v_exp_f32 v134,v134
v_exp_f32 v135,v135
v_exp_f32 v136,v136
v_exp_f32 v137,v137
v_exp_f32 v138,v138
v_exp_f32 v139,v139
s_add_u32 m0,s61,8192
s_add_u32 s63,s60,8192
buffer_load_dwordx4 v1,s[8:11],s63 offen sc1 lds
v_pk_add_f32 v[124:125],v[124:125],1.0 op_sel_hi:[1,0]
v_pk_add_f32 v[126:127],v[126:127],1.0 op_sel_hi:[1,0]
v_pk_add_f32 v[128:129],v[128:129],1.0 op_sel_hi:[1,0]
v_pk_add_f32 v[130:131],v[130:131],1.0 op_sel_hi:[1,0]
v_pk_add_f32 v[132:133],v[132:133],1.0 op_sel_hi:[1,0]
v_pk_add_f32 v[134:135],v[134:135],1.0 op_sel_hi:[1,0]
v_pk_add_f32 v[136:137],v[136:137],1.0 op_sel_hi:[1,0]
buffer_load_dwordx4 v1,s[8:11],s63 offen offset:1024 sc1 lds
v_pk_add_f32 v[138:139],v[138:139],1.0 op_sel_hi:[1,0]
v_rcp_f32 v124,v124
v_rcp_f32 v125,v125
v_rcp_f32 v126,v126
v_rcp_f32 v127,v127
v_rcp_f32 v128,v128
v_rcp_f32 v129,v129
s_lshl_b32 s62,s46,10
s_add_u32 s62,s62,40960
s_add_u32 m0,s66,s62
s_add_u32 s63,s67,s62
buffer_load_dwordx4 v1,s[8:11],s63 offen sc1 lds
v_rcp_f32 v130,v130
v_rcp_f32 v131,v131
v_rcp_f32 v132,v132
v_rcp_f32 v133,v133
v_rcp_f32 v134,v134
v_rcp_f32 v135,v135
v_rcp_f32 v136,v136
s_add_u32 m0,s66,45056
s_add_u32 s63,s67,45056
buffer_load_dwordx4 v1,s[8:11],s63 offen sc1 lds
v_rcp_f32 v137,v137
v_rcp_f32 v138,v138
v_rcp_f32 v139,v139
v_pk_mul_f32 v[56:57],v[56:57],v[124:125]
v_pk_mul_f32 v[58:59],v[58:59],v[126:127]
v_pk_mul_f32 v[60:61],v[60:61],v[128:129]
v_pk_mul_f32 v[62:63],v[62:63],v[130:131]
s_mov_b32 s35,s42
s_mov_b32 s53,s33
s_mov_b32 s54,s34
s_add_u32 s32,s32,1
s_mov_b32 s33,s40
s_mov_b32 s34,s41
s_mov_b64 s[76:77],s[80:81]
v_pk_mul_f32 v[64:65],v[64:65],v[132:133]
v_pk_mul_f32 v[66:67],v[66:67],v[134:135]
v_pk_mul_f32 v[68:69],v[68:69],v[136:137]
v_pk_mul_f32 v[70:71],v[70:71],v[138:139]
v_cvt_pk_bf16_f32 v116,v56,v57
v_cvt_pk_bf16_f32 v117,v58,v59
v_cvt_pk_bf16_f32 v118,v60,v61
v_cvt_pk_bf16_f32 v119,v62,v63
v_cvt_pk_bf16_f32 v120,v64,v65
v_cvt_pk_bf16_f32 v121,v66,v67
v_cvt_pk_bf16_f32 v122,v68,v69
v_cvt_pk_bf16_f32 v123,v70,v71
s_cmp_lg_u32 s49,0
s_cbranch_scc0 ls_325
buffer_store_dwordx4 v[116:119],v20,s[8:11],s71 offen sc1
buffer_store_dwordx4 v[120:123],v21,s[8:11],s71 offen sc1
s_branch ls_326
ls_325:
buffer_store_dwordx4 v[116:119],v20,s[8:11],s71 offen
buffer_store_dwordx4 v[120:123],v21,s[8:11],s71 offen
ls_326:
s_mov_b32 s59,s82
s_branch W3_NEXT
nr_319:
buffer_load_dword v3,v2,s[8:11],s35 offen sc1
s_branch ep_318
W3_END:
s_endpgm
ROLE_W4:
v_lshlrev_b32 v1,4,v0
v_mov_b32 v5,1
s_lshl_b32 s56,s48,2
s_add_u32 s56,s56,s46
v_bfe_u32 v6,v0,2,2
v_lshrrev_b32 v7,4,v0
v_add_u32 v7,v6,v7
v_and_b32 v7,3,v7
v_and_b32 v15,3,v0
v_lshlrev_b32 v15,4,v15
v_lshl_add_u32 v15,v7,6,v15
v_lshl_add_u32 v15,v6,8,v15
v_lshrrev_b32 v6,5,v0
v_bfe_u32 v7,v0,4,1
v_lshlrev_b32 v208,10,v7
v_lshl_add_u32 v208,v6,8,v208
v_and_b32 v6,15,v0
v_lshl_add_u32 v208,v6,4,v208
v_lshrrev_b32 v6,5,v0
v_add_u32 v6,2,v6
v_bfe_u32 v7,v0,4,1
v_lshlrev_b32 v209,10,v7
v_lshl_add_u32 v209,v6,8,v209
v_and_b32 v6,15,v0
v_lshl_add_u32 v209,v6,4,v209
v_min_u32 v2,11,v0
s_mul_i32 s60,s46,12
v_add_u32 v2,s60,v2
v_lshlrev_b32 v2,2,v2
s_and_b32 s60,s46,1
s_lshl_b32 s68,s48,1
s_add_u32 s68,s68,s60
s_lshr_b32 s69,s46,1
s_mul_i32 s71,s46,24576
s_mul_i32 s58,s46,491520
s_lshl_b32 s61,s48,7
s_add_u32 s58,s58,s61
s_add_u32 s71,s71,242778112
v_and_b32 v6,15,v0
v_lshlrev_b32 v204,3,v6
s_lshl_b32 s60,s69,4
v_add_u32 v6,s60,v6
v_mul_u32_u24 v205,1280,v6
v_bfe_u32 v6,v0,4,1
v_lshl_add_u32 v205,v6,5,v205
v_lshrrev_b32 v6,5,v0
v_lshl_add_u32 v205,v6,4,v205
s_lshl_b32 s60,s68,6
v_add_u32 v205,s60,v205
s_mov_b32 s76,s40
s_mov_b32 s77,s41
s_mov_b32 s78,2621440
s_mov_b32 s79,0x20000
s_lshl_b32 s70,s68,1
s_add_u32 s70,s70,s69
s_lshl_b32 s70,s70,10
v_bfe_u32 v6,v0,4,1
v_lshlrev_b32 v206,14,v6
v_lshrrev_b32 v6,5,v0
v_lshl_add_u32 v206,v6,8,v206
v_and_b32 v6,15,v0
v_lshl_add_u32 v206,v6,4,v206
s_lshl_b32 s60,s46,11
v_add_u32 v206,s60,v206
s_lshl_b32 s60,s46,13
v_add_u32 v207,s60,v1
v_mov_b32 v24,-1
v_mov_b32 v25,-1
v_mov_b32 v26,-1
v_mov_b32 v27,-1
s_add_u32 s60,s48,22
s_lshl2_add_u32 s60,s60,s46
s_mul_i32 s60,s60,22528
s_add_u32 s61,s60,24117248
buffer_store_dwordx4 v[24:27],v1,s[8:11],s61 offen sc1
buffer_store_dwordx4 v[24:27],v1,s[8:11],s61 offen offset:1024 sc1
buffer_store_dwordx4 v[24:27],v1,s[8:11],s61 offen offset:2048 sc1
buffer_store_dwordx4 v[24:27],v1,s[8:11],s61 offen offset:3072 sc1
s_add_u32 s61,s60,24121344
buffer_store_dwordx4 v[24:27],v1,s[8:11],s61 offen sc1
buffer_store_dwordx4 v[24:27],v1,s[8:11],s61 offen offset:1024 sc1
buffer_store_dwordx4 v[24:27],v1,s[8:11],s61 offen offset:2048 sc1
buffer_store_dwordx4 v[24:27],v1,s[8:11],s61 offen offset:3072 sc1
s_add_u32 s61,s60,24125440
buffer_store_dwordx4 v[24:27],v1,s[8:11],s61 offen sc1
buffer_store_dwordx4 v[24:27],v1,s[8:11],s61 offen offset:1024 sc1
buffer_store_dwordx4 v[24:27],v1,s[8:11],s61 offen offset:2048 sc1
buffer_store_dwordx4 v[24:27],v1,s[8:11],s61 offen offset:3072 sc1
s_add_u32 s61,s60,24129536
buffer_store_dwordx4 v[24:27],v1,s[8:11],s61 offen sc1
buffer_store_dwordx4 v[24:27],v1,s[8:11],s61 offen offset:1024 sc1
buffer_store_dwordx4 v[24:27],v1,s[8:11],s61 offen offset:2048 sc1
buffer_store_dwordx4 v[24:27],v1,s[8:11],s61 offen offset:3072 sc1
s_add_u32 s61,s60,24133632
buffer_store_dwordx4 v[24:27],v1,s[8:11],s61 offen sc1
buffer_store_dwordx4 v[24:27],v1,s[8:11],s61 offen offset:1024 sc1
buffer_store_dwordx4 v[24:27],v1,s[8:11],s61 offen offset:2048 sc1
buffer_store_dwordx4 v[24:27],v1,s[8:11],s61 offen offset:3072 sc1
s_add_u32 s61,s60,24137728
buffer_store_dwordx4 v[24:27],v1,s[8:11],s61 offen sc1
buffer_store_dwordx4 v[24:27],v1,s[8:11],s61 offen offset:1024 sc1
s_waitcnt vmcnt(0)
s_barrier
s_cmp_lg_u32 s46,0
s_cbranch_scc1 arr_327
v_mov_b32 v6,1
s_lshl_b32 s3,s49,2
v_mov_b32 v7,s3
s_mov_b64 exec,1
buffer_atomic_add v6,v7,s[12:15],0 offen sc1
s_mov_b64 exec,-1
arr_327:
s_lshl_b32 s3,s49,2
v_mov_b32 v7,s3
s_nop 1
ibw_328:
buffer_load_dword v6,v7,s[12:15],0 offen sc1
s_waitcnt vmcnt(0)
v_cmp_ne_u32 vcc,256,v6
s_nop 0
s_cbranch_vccz ok_329
s_sleep 8
s_sub_u32 s47,s47,1
s_cbranch_scc1 ABORT
s_branch ibw_328
ok_329:
s_cmp_lg_u32 s49,0
s_cbranch_scc1 ibok_330
v_and_b32 v7,7,v0
v_lshlrev_b32 v7,2,v7
buffer_load_dword v6,v7,s[12:15],0 offen offset:32 sc1
s_waitcnt vmcnt(0)
v_cmp_ne_u32 vcc,32,v6
s_nop 0
s_cbranch_vccz ibok_330
s_barrier
s_mov_b32 s49,1
s_mov_b32 s3,s2
s_load_dwordx16 s[16:31],s[0:1],0
s_load_dwordx8 s[32:39],s[0:1],64
s_waitcnt lgkmcnt(0)
s_branch DISPATCH
ibok_330:
s_mul_i32 s63,s46,40960
s_mov_b32 s4,s38
s_mov_b32 s5,s39
s_mov_b32 s6,1966080
s_mov_b32 s7,0x20000
v_lshrrev_b32 v9,3,v0
s_mov_b32 s64,1280
v_mul_lo_u32 v9,v9,s64
v_and_b32 v10,7,v0
v_lshl_add_u32 v6,v10,4,v9
s_add_u32 m0,s63,0
s_add_u32 s65,s58,0
buffer_load_dwordx4 v6,s[4:7],s65 offen lds
s_add_u32 m0,s63,1024
s_add_u32 s65,s58,10240
buffer_load_dwordx4 v6,s[4:7],s65 offen lds
s_add_u32 m0,s63,2048
s_add_u32 s65,s58,20480
buffer_load_dwordx4 v6,s[4:7],s65 offen lds
s_add_u32 m0,s63,3072
s_add_u32 s65,s58,30720
buffer_load_dwordx4 v6,s[4:7],s65 offen lds
s_add_u32 m0,s63,4096
s_add_u32 s65,s58,40960
buffer_load_dwordx4 v6,s[4:7],s65 offen lds
s_add_u32 m0,s63,5120
s_add_u32 s65,s58,51200
buffer_load_dwordx4 v6,s[4:7],s65 offen lds
s_add_u32 m0,s63,6144
s_add_u32 s65,s58,61440
buffer_load_dwordx4 v6,s[4:7],s65 offen lds
s_add_u32 m0,s63,7168
s_add_u32 s65,s58,71680
buffer_load_dwordx4 v6,s[4:7],s65 offen lds
s_add_u32 m0,s63,8192
s_add_u32 s65,s58,81920
buffer_load_dwordx4 v6,s[4:7],s65 offen lds
s_add_u32 m0,s63,9216
s_add_u32 s65,s58,92160
buffer_load_dwordx4 v6,s[4:7],s65 offen lds
s_add_u32 m0,s63,10240
s_add_u32 s65,s58,102400
buffer_load_dwordx4 v6,s[4:7],s65 offen lds
s_add_u32 m0,s63,11264
s_add_u32 s65,s58,112640
buffer_load_dwordx4 v6,s[4:7],s65 offen lds
s_add_u32 m0,s63,12288
s_add_u32 s65,s58,122880
buffer_load_dwordx4 v6,s[4:7],s65 offen lds
s_add_u32 m0,s63,13312
s_add_u32 s65,s58,133120
buffer_load_dwordx4 v6,s[4:7],s65 offen lds
s_add_u32 m0,s63,14336
s_add_u32 s65,s58,143360
buffer_load_dwordx4 v6,s[4:7],s65 offen lds
s_add_u32 m0,s63,15360
s_add_u32 s65,s58,153600
buffer_load_dwordx4 v6,s[4:7],s65 offen lds
s_add_u32 m0,s63,16384
s_add_u32 s65,s58,163840
buffer_load_dwordx4 v6,s[4:7],s65 offen lds
s_add_u32 m0,s63,17408
s_add_u32 s65,s58,174080
buffer_load_dwordx4 v6,s[4:7],s65 offen lds
s_add_u32 m0,s63,18432
s_add_u32 s65,s58,184320
buffer_load_dwordx4 v6,s[4:7],s65 offen lds
s_add_u32 m0,s63,19456
s_add_u32 s65,s58,194560
buffer_load_dwordx4 v6,s[4:7],s65 offen lds
s_add_u32 m0,s63,20480
s_add_u32 s65,s58,204800
buffer_load_dwordx4 v6,s[4:7],s65 offen lds
s_add_u32 m0,s63,21504
s_add_u32 s65,s58,215040
buffer_load_dwordx4 v6,s[4:7],s65 offen lds
s_add_u32 m0,s63,22528
s_add_u32 s65,s58,225280
buffer_load_dwordx4 v6,s[4:7],s65 offen lds
s_add_u32 m0,s63,23552
s_add_u32 s65,s58,235520
buffer_load_dwordx4 v6,s[4:7],s65 offen lds
s_add_u32 m0,s63,24576
s_add_u32 s65,s58,245760
buffer_load_dwordx4 v6,s[4:7],s65 offen lds
s_add_u32 m0,s63,25600
s_add_u32 s65,s58,256000
buffer_load_dwordx4 v6,s[4:7],s65 offen lds
s_add_u32 m0,s63,26624
s_add_u32 s65,s58,266240
buffer_load_dwordx4 v6,s[4:7],s65 offen lds
s_add_u32 m0,s63,27648
s_add_u32 s65,s58,276480
buffer_load_dwordx4 v6,s[4:7],s65 offen lds
s_add_u32 m0,s63,28672
s_add_u32 s65,s58,286720
buffer_load_dwordx4 v6,s[4:7],s65 offen lds
s_add_u32 m0,s63,29696
s_add_u32 s65,s58,296960
buffer_load_dwordx4 v6,s[4:7],s65 offen lds
s_add_u32 m0,s63,30720
s_add_u32 s65,s58,307200
buffer_load_dwordx4 v6,s[4:7],s65 offen lds
s_add_u32 m0,s63,31744
s_add_u32 s65,s58,317440
buffer_load_dwordx4 v6,s[4:7],s65 offen lds
s_add_u32 m0,s63,32768
s_add_u32 s65,s58,327680
buffer_load_dwordx4 v6,s[4:7],s65 offen lds
s_add_u32 m0,s63,33792
s_add_u32 s65,s58,337920
buffer_load_dwordx4 v6,s[4:7],s65 offen lds
s_add_u32 m0,s63,34816
s_add_u32 s65,s58,348160
buffer_load_dwordx4 v6,s[4:7],s65 offen lds
s_add_u32 m0,s63,35840
s_add_u32 s65,s58,358400
buffer_load_dwordx4 v6,s[4:7],s65 offen lds
s_add_u32 m0,s63,36864
s_add_u32 s65,s58,368640
buffer_load_dwordx4 v6,s[4:7],s65 offen lds
s_add_u32 m0,s63,37888
s_add_u32 s65,s58,378880
buffer_load_dwordx4 v6,s[4:7],s65 offen lds
s_add_u32 m0,s63,38912
s_add_u32 s65,s58,389120
buffer_load_dwordx4 v6,s[4:7],s65 offen lds
s_add_u32 m0,s63,39936
s_add_u32 s65,s58,399360
buffer_load_dwordx4 v6,s[4:7],s65 offen lds
s_waitcnt vmcnt(20)
v_bfe_u32 v9,v0,2,2
v_lshrrev_b32 v10,5,v0
v_lshl_add_u32 v9,v10,2,v9
v_mul_u32_u24 v9,128,v9
v_and_b32 v10,1,v0
v_lshl_add_u32 v9,v10,3,v9
v_bfe_u32 v10,v0,1,1
v_lshl_add_u32 v9,v10,5,v9
v_bfe_u32 v10,v0,4,1
v_lshl_add_u32 v9,v10,4,v9
v_add_u32 v7,s63,v9
ds_read_b64_tr_b16 a[0:1],v7 offset:0
ds_read_b64_tr_b16 a[2:3],v7 offset:2048
ds_read_b64_tr_b16 a[4:5],v7 offset:1024
ds_read_b64_tr_b16 a[6:7],v7 offset:3072
ds_read_b64_tr_b16 a[96:97],v7 offset:64
ds_read_b64_tr_b16 a[98:99],v7 offset:2112
ds_read_b64_tr_b16 a[100:101],v7 offset:1088
ds_read_b64_tr_b16 a[102:103],v7 offset:3136
ds_read_b64_tr_b16 a[8:9],v7 offset:4096
ds_read_b64_tr_b16 a[10:11],v7 offset:6144
ds_read_b64_tr_b16 a[12:13],v7 offset:5120
ds_read_b64_tr_b16 a[14:15],v7 offset:7168
s_waitcnt lgkmcnt(4)
ds_read_b64_tr_b16 a[104:105],v7 offset:4160
ds_read_b64_tr_b16 a[106:107],v7 offset:6208
ds_read_b64_tr_b16 a[108:109],v7 offset:5184
ds_read_b64_tr_b16 a[110:111],v7 offset:7232
ds_read_b64_tr_b16 a[16:17],v7 offset:8192
ds_read_b64_tr_b16 a[18:19],v7 offset:10240
ds_read_b64_tr_b16 a[20:21],v7 offset:9216
ds_read_b64_tr_b16 a[22:23],v7 offset:11264
ds_read_b64_tr_b16 a[112:113],v7 offset:8256
ds_read_b64_tr_b16 a[114:115],v7 offset:10304
ds_read_b64_tr_b16 a[116:117],v7 offset:9280
ds_read_b64_tr_b16 a[118:119],v7 offset:11328
s_waitcnt lgkmcnt(4)
ds_read_b64_tr_b16 a[24:25],v7 offset:12288
ds_read_b64_tr_b16 a[26:27],v7 offset:14336
ds_read_b64_tr_b16 a[28:29],v7 offset:13312
ds_read_b64_tr_b16 a[30:31],v7 offset:15360
ds_read_b64_tr_b16 a[120:121],v7 offset:12352
ds_read_b64_tr_b16 a[122:123],v7 offset:14400
ds_read_b64_tr_b16 a[124:125],v7 offset:13376
ds_read_b64_tr_b16 a[126:127],v7 offset:15424
ds_read_b64_tr_b16 a[32:33],v7 offset:16384
ds_read_b64_tr_b16 a[34:35],v7 offset:18432
ds_read_b64_tr_b16 a[36:37],v7 offset:17408
ds_read_b64_tr_b16 a[38:39],v7 offset:19456
s_waitcnt lgkmcnt(4)
ds_read_b64_tr_b16 a[128:129],v7 offset:16448
ds_read_b64_tr_b16 a[130:131],v7 offset:18496
ds_read_b64_tr_b16 a[132:133],v7 offset:17472
ds_read_b64_tr_b16 a[134:135],v7 offset:19520
s_waitcnt lgkmcnt(0)
s_add_u32 m0,s63,0
s_add_u32 s65,s58,409600
buffer_load_dwordx4 v6,s[4:7],s65 offen lds
s_add_u32 m0,s63,1024
s_add_u32 s65,s58,419840
buffer_load_dwordx4 v6,s[4:7],s65 offen lds
s_add_u32 m0,s63,2048
s_add_u32 s65,s58,430080
buffer_load_dwordx4 v6,s[4:7],s65 offen lds
s_add_u32 m0,s63,3072
s_add_u32 s65,s58,440320
buffer_load_dwordx4 v6,s[4:7],s65 offen lds
s_add_u32 m0,s63,4096
s_add_u32 s65,s58,450560
buffer_load_dwordx4 v6,s[4:7],s65 offen lds
s_add_u32 m0,s63,5120
s_add_u32 s65,s58,460800
buffer_load_dwordx4 v6,s[4:7],s65 offen lds
s_add_u32 m0,s63,6144
s_add_u32 s65,s58,471040
buffer_load_dwordx4 v6,s[4:7],s65 offen lds
s_add_u32 m0,s63,7168
s_add_u32 s65,s58,481280
buffer_load_dwordx4 v6,s[4:7],s65 offen lds
s_waitcnt vmcnt(8)
v_bfe_u32 v9,v0,2,2
v_lshrrev_b32 v10,5,v0
v_lshl_add_u32 v9,v10,2,v9
v_mul_u32_u24 v9,128,v9
v_and_b32 v10,1,v0
v_lshl_add_u32 v9,v10,3,v9
v_bfe_u32 v10,v0,1,1
v_lshl_add_u32 v9,v10,5,v9
v_bfe_u32 v10,v0,4,1
v_lshl_add_u32 v9,v10,4,v9
v_add_u32 v7,s63,v9
ds_read_b64_tr_b16 a[40:41],v7 offset:20480
ds_read_b64_tr_b16 a[42:43],v7 offset:22528
ds_read_b64_tr_b16 a[44:45],v7 offset:21504
ds_read_b64_tr_b16 a[46:47],v7 offset:23552
ds_read_b64_tr_b16 a[136:137],v7 offset:20544
ds_read_b64_tr_b16 a[138:139],v7 offset:22592
ds_read_b64_tr_b16 a[140:141],v7 offset:21568
ds_read_b64_tr_b16 a[142:143],v7 offset:23616
ds_read_b64_tr_b16 a[48:49],v7 offset:24576
ds_read_b64_tr_b16 a[50:51],v7 offset:26624
ds_read_b64_tr_b16 a[52:53],v7 offset:25600
ds_read_b64_tr_b16 a[54:55],v7 offset:27648
s_waitcnt lgkmcnt(4)
ds_read_b64_tr_b16 a[144:145],v7 offset:24640
ds_read_b64_tr_b16 a[146:147],v7 offset:26688
ds_read_b64_tr_b16 a[148:149],v7 offset:25664
ds_read_b64_tr_b16 a[150:151],v7 offset:27712
ds_read_b64_tr_b16 a[56:57],v7 offset:28672
ds_read_b64_tr_b16 a[58:59],v7 offset:30720
ds_read_b64_tr_b16 a[60:61],v7 offset:29696
ds_read_b64_tr_b16 a[62:63],v7 offset:31744
ds_read_b64_tr_b16 a[152:153],v7 offset:28736
ds_read_b64_tr_b16 a[154:155],v7 offset:30784
ds_read_b64_tr_b16 a[156:157],v7 offset:29760
ds_read_b64_tr_b16 a[158:159],v7 offset:31808
s_waitcnt lgkmcnt(4)
ds_read_b64_tr_b16 a[64:65],v7 offset:32768
ds_read_b64_tr_b16 a[66:67],v7 offset:34816
ds_read_b64_tr_b16 a[68:69],v7 offset:33792
ds_read_b64_tr_b16 a[70:71],v7 offset:35840
ds_read_b64_tr_b16 a[160:161],v7 offset:32832
ds_read_b64_tr_b16 a[162:163],v7 offset:34880
ds_read_b64_tr_b16 a[164:165],v7 offset:33856
ds_read_b64_tr_b16 a[166:167],v7 offset:35904
ds_read_b64_tr_b16 a[72:73],v7 offset:36864
ds_read_b64_tr_b16 a[74:75],v7 offset:38912
ds_read_b64_tr_b16 a[76:77],v7 offset:37888
ds_read_b64_tr_b16 a[78:79],v7 offset:39936
s_waitcnt lgkmcnt(4)
ds_read_b64_tr_b16 a[168:169],v7 offset:36928
ds_read_b64_tr_b16 a[170:171],v7 offset:38976
ds_read_b64_tr_b16 a[172:173],v7 offset:37952
ds_read_b64_tr_b16 a[174:175],v7 offset:40000
s_waitcnt lgkmcnt(0)
s_waitcnt vmcnt(0)
v_bfe_u32 v9,v0,2,2
v_lshrrev_b32 v10,5,v0
v_lshl_add_u32 v9,v10,2,v9
v_mul_u32_u24 v9,128,v9
v_and_b32 v10,1,v0
v_lshl_add_u32 v9,v10,3,v9
v_bfe_u32 v10,v0,1,1
v_lshl_add_u32 v9,v10,5,v9
v_bfe_u32 v10,v0,4,1
v_lshl_add_u32 v9,v10,4,v9
v_add_u32 v7,s63,v9
ds_read_b64_tr_b16 a[80:81],v7 offset:0
ds_read_b64_tr_b16 a[82:83],v7 offset:2048
ds_read_b64_tr_b16 a[84:85],v7 offset:1024
ds_read_b64_tr_b16 a[86:87],v7 offset:3072
ds_read_b64_tr_b16 a[176:177],v7 offset:64
ds_read_b64_tr_b16 a[178:179],v7 offset:2112
ds_read_b64_tr_b16 a[180:181],v7 offset:1088
ds_read_b64_tr_b16 a[182:183],v7 offset:3136
ds_read_b64_tr_b16 a[88:89],v7 offset:4096
ds_read_b64_tr_b16 a[90:91],v7 offset:6144
ds_read_b64_tr_b16 a[92:93],v7 offset:5120
ds_read_b64_tr_b16 a[94:95],v7 offset:7168
s_waitcnt lgkmcnt(4)
ds_read_b64_tr_b16 a[184:185],v7 offset:4160
ds_read_b64_tr_b16 a[186:187],v7 offset:6208
ds_read_b64_tr_b16 a[188:189],v7 offset:5184
ds_read_b64_tr_b16 a[190:191],v7 offset:7232
s_waitcnt lgkmcnt(0)
s_barrier
s_mov_b32 s83,s100
s_mov_b32 s32,0
s_mov_b32 s59,2147483648
s_min_u32 s62,s32,127
s_sub_u32 s60,s62,18
s_lshr_b32 s34,s60,1
s_and_b32 s33,s60,1
s_cmp_eq_u32 s33,0
s_cselect_b32 s61,18,0
s_add_u32 s34,s34,s61
s_sub_u32 s61,s60,46
s_cmp_ge_u32 s60,92
s_cselect_b32 s34,s61,s34
s_cselect_b32 s33,1,s33
s_cmp_lt_u32 s62,18
s_cselect_b32 s34,s62,s34
s_cselect_b32 s33,0,s33
s_lshl_b32 s35,s33,6
s_add_u32 s35,s35,s34
s_lshl_b32 s35,s35,9
s_add_u32 s35,s35,589824
s_and_b32 s60,s34,3
s_lshl2_add_u32 s60,s33,s60
s_mul_i32 s73,s60,98304
s_add_u32 s73,s73,s71
s_add_u32 s62,s32,1
s_min_u32 s62,s62,127
s_sub_u32 s60,s62,18
s_lshr_b32 s29,s60,1
s_and_b32 s28,s60,1
s_cmp_eq_u32 s28,0
s_cselect_b32 s61,18,0
s_add_u32 s29,s29,s61
s_sub_u32 s61,s60,46
s_cmp_ge_u32 s60,92
s_cselect_b32 s29,s61,s29
s_cselect_b32 s28,1,s28
s_cmp_lt_u32 s62,18
s_cselect_b32 s29,s62,s29
s_cselect_b32 s28,0,s28
s_lshl_b32 s30,s28,6
s_add_u32 s30,s30,s29
s_lshl_b32 s30,s30,9
s_add_u32 s30,s30,589824
s_and_b32 s60,s29,3
s_lshl2_add_u32 s60,s28,s60
s_mul_i32 s31,s60,98304
s_add_u32 s31,s31,s71
W4_COLD:
buffer_load_dword v3,v2,s[8:11],s35 offen sc1
s_waitcnt vmcnt(1)
s_mov_b64 exec,1
buffer_store_dword v5,v1,s[8:11],s59 offen sc1
s_mov_b64 exec,-1
s_mov_b32 s59,2147483648
s_cmp_ge_u32 s32,128
s_cbranch_scc1 W4_END
s_waitcnt vmcnt(1)
v_cmp_eq_u32 vcc,0,v3
s_nop 0
s_cbranch_vccz W4_RDY
fb_331:
buffer_load_dword v3,v2,s[8:11],s35 offen sc1
s_waitcnt vmcnt(0)
v_cmp_eq_u32 vcc,0,v3
s_nop 0
s_cbranch_vccz ok_332
s_sleep 1
s_sub_u32 s47,s47,1
s_cbranch_scc1 ABORT
s_branch fb_331
ok_332:
W4_RDY:
s_add_u32 s63,s73,0
buffer_load_dwordx4 v[16:19],v1,s[8:11],s63 offen sc1
s_nop 7
buffer_load_dwordx4 v[20:23],v1,s[8:11],s63 offen offset:1024 sc1
s_nop 7
buffer_load_dwordx4 v[24:27],v1,s[8:11],s63 offen offset:2048 sc1
s_nop 7
buffer_load_dwordx4 v[28:31],v1,s[8:11],s63 offen offset:3072 sc1
s_nop 7
s_add_u32 s63,s73,4096
buffer_load_dwordx4 v[32:35],v1,s[8:11],s63 offen sc1
s_nop 7
buffer_load_dwordx4 v[36:39],v1,s[8:11],s63 offen offset:1024 sc1
s_nop 7
buffer_load_dwordx4 v[40:43],v1,s[8:11],s63 offen offset:2048 sc1
s_nop 7
buffer_load_dwordx4 v[44:47],v1,s[8:11],s63 offen offset:3072 sc1
W4_C:
s_mov_b32 s51,s33
s_mov_b32 s52,s34
s_mov_b32 s72,s73
s_add_u32 s32,s32,1
s_mov_b32 s33,s28
s_mov_b32 s34,s29
s_mov_b32 s35,s30
s_mov_b32 s73,s31
s_waitcnt vmcnt(7)
v_mfma_f32_32x32x16_bf16 v[112:127],a[0:3],v[16:19],0
s_add_u32 s63,s72,8192
buffer_load_dwordx4 v[48:51],v1,s[8:11],s63 offen sc1
s_lshl_b32 s64,s51,6
s_add_u32 s64,s64,s52
s_and_b32 s65,s52,7
v_mfma_f32_32x32x16_bf16 v[128:143],a[96:99],v[16:19],0
s_lshl3_add_u32 s65,s51,s65
s_mul_i32 s65,s65,46080
s_add_u32 s65,s65,s70
s_add_u32 s65,s65,212467712
buffer_load_dwordx4 v[176:179],v1,s[8:11],s65 offen sc1
s_waitcnt vmcnt(8)
v_mfma_f32_32x32x16_bf16 v[112:127],a[4:7],v[20:23],v[112:127]
buffer_load_dwordx4 v[52:55],v1,s[8:11],s63 offen offset:1024 sc1
s_mul_i32 s43,s64,40960
s_add_u32 s43,s43,s70
s_add_u32 s43,s43,218365952
v_xor_b32 v206,0x8000,v206
v_mfma_f32_32x32x16_bf16 v[128:143],a[100:103],v[20:23],v[128:143]
v_xor_b32 v207,0x8000,v207
s_lshl_b32 s82,s64,9
s_lshl2_add_u32 s82,s56,s82
s_add_u32 s42,s82,32768
s_add_u32 s82,s82,327680
s_mul_i32 s41,s52,46080
s_waitcnt vmcnt(8)
v_mfma_f32_32x32x16_bf16 v[112:127],a[8:11],v[24:27],v[112:127]
buffer_load_dwordx4 v[56:59],v1,s[8:11],s63 offen offset:2048 sc1
s_add_u32 s41,s41,209518592
s_lshl_b32 s65,s51,31
s_or_b32 s41,s41,s65
s_or_b32 s42,s42,s65
v_mfma_f32_32x32x16_bf16 v[128:143],a[104:107],v[24:27],v[128:143]
s_add_u32 s40,s41,s70
s_lshr_b32 s64,s70,3
s_add_u32 s41,s41,s64
s_add_u32 s41,s41,40960
s_mul_i32 s27,s52,40960
s_xor_b32 s65,s65,2147483648
s_waitcnt vmcnt(8)
v_mfma_f32_32x32x16_bf16 v[112:127],a[12:15],v[28:31],v[112:127]
buffer_load_dwordx4 v[60:63],v1,s[8:11],s63 offen offset:3072 sc1
s_add_u32 s63,s72,12288
s_or_b32 s27,s27,s65
s_add_u32 s62,s32,1
s_min_u32 s62,s62,127
v_mfma_f32_32x32x16_bf16 v[128:143],a[108:111],v[28:31],v[128:143]
s_sub_u32 s60,s62,18
s_lshr_b32 s29,s60,1
s_and_b32 s28,s60,1
s_cmp_eq_u32 s28,0
s_cselect_b32 s61,18,0
s_add_u32 s29,s29,s61
s_waitcnt vmcnt(8)
v_mfma_f32_32x32x16_bf16 v[112:127],a[16:19],v[32:35],v[112:127]
buffer_load_dwordx4 v[64:67],v1,s[8:11],s63 offen sc1
s_sub_u32 s61,s60,46
s_cmp_ge_u32 s60,92
s_cselect_b32 s29,s61,s29
s_cselect_b32 s28,1,s28
v_mfma_f32_32x32x16_bf16 v[128:143],a[112:115],v[32:35],v[128:143]
s_cmp_lt_u32 s62,18
s_cselect_b32 s29,s62,s29
s_cselect_b32 s28,0,s28
s_lshl_b32 s30,s28,6
s_add_u32 s30,s30,s29
s_lshl_b32 s30,s30,9
s_waitcnt vmcnt(8)
v_mfma_f32_32x32x16_bf16 v[112:127],a[20:23],v[36:39],v[112:127]
buffer_load_dwordx4 v[68:71],v1,s[8:11],s63 offen offset:1024 sc1
s_add_u32 s30,s30,589824
s_and_b32 s60,s29,3
s_lshl2_add_u32 s60,s28,s60
s_mul_i32 s31,s60,98304
v_mfma_f32_32x32x16_bf16 v[128:143],a[116:119],v[36:39],v[128:143]
s_add_u32 s31,s31,s71
s_waitcnt vmcnt(8)
v_mfma_f32_32x32x16_bf16 v[112:127],a[24:27],v[40:43],v[112:127]
buffer_load_dwordx4 v[72:75],v1,s[8:11],s63 offen offset:2048 sc1
v_mfma_f32_32x32x16_bf16 v[128:143],a[120:123],v[40:43],v[128:143]
s_waitcnt vmcnt(8)
v_mfma_f32_32x32x16_bf16 v[112:127],a[28:31],v[44:47],v[112:127]
buffer_load_dwordx4 v[76:79],v1,s[8:11],s63 offen offset:3072 sc1
s_add_u32 s63,s72,16384
v_mfma_f32_32x32x16_bf16 v[128:143],a[124:127],v[44:47],v[128:143]
s_waitcnt vmcnt(8)
v_mfma_f32_32x32x16_bf16 v[112:127],a[32:35],v[48:51],v[112:127]
buffer_load_dwordx4 v[80:83],v1,s[8:11],s63 offen sc1
s_mov_b64 exec,1
buffer_store_dword v5,v1,s[8:11],s59 offen sc1
s_mov_b64 exec,-1
s_mov_b32 s59,2147483648
v_mfma_f32_32x32x16_bf16 v[128:143],a[128:131],v[48:51],v[128:143]
buffer_load_dword v3,v2,s[8:11],s35 offen sc1
s_waitcnt vmcnt(9)
v_mfma_f32_32x32x16_bf16 v[112:127],a[36:39],v[52:55],v[112:127]
buffer_load_dwordx4 v[84:87],v1,s[8:11],s63 offen offset:1024 sc1
v_mfma_f32_32x32x16_bf16 v[128:143],a[132:135],v[52:55],v[128:143]
s_waitcnt vmcnt(9)
v_mfma_f32_32x32x16_bf16 v[112:127],a[40:43],v[56:59],v[112:127]
buffer_load_dwordx4 v[88:91],v1,s[8:11],s63 offen offset:2048 sc1
v_mfma_f32_32x32x16_bf16 v[128:143],a[136:139],v[56:59],v[128:143]
s_waitcnt vmcnt(9)
v_mfma_f32_32x32x16_bf16 v[112:127],a[44:47],v[60:63],v[112:127]
buffer_load_dwordx4 v[92:95],v1,s[8:11],s63 offen offset:3072 sc1
s_add_u32 s63,s72,20480
v_mfma_f32_32x32x16_bf16 v[128:143],a[140:143],v[60:63],v[128:143]
s_waitcnt vmcnt(9)
v_mfma_f32_32x32x16_bf16 v[112:127],a[48:51],v[64:67],v[112:127]
buffer_load_dwordx4 v[96:99],v1,s[8:11],s63 offen sc1
v_mfma_f32_32x32x16_bf16 v[128:143],a[144:147],v[64:67],v[128:143]
s_waitcnt vmcnt(9)
v_mfma_f32_32x32x16_bf16 v[112:127],a[52:55],v[68:71],v[112:127]
buffer_load_dwordx4 v[100:103],v1,s[8:11],s63 offen offset:1024 sc1
v_mfma_f32_32x32x16_bf16 v[128:143],a[148:151],v[68:71],v[128:143]
s_waitcnt vmcnt(9)
v_mfma_f32_32x32x16_bf16 v[112:127],a[56:59],v[72:75],v[112:127]
buffer_load_dwordx4 v[104:107],v1,s[8:11],s63 offen offset:2048 sc1
v_mfma_f32_32x32x16_bf16 v[128:143],a[152:155],v[72:75],v[128:143]
s_waitcnt vmcnt(6)
v_cmp_eq_u32 vcc,0,v3
s_cmp_eq_u64 vcc,0
s_cselect_b32 s37,0,2147483648
s_cmp_lt_u32 s32,128
s_cselect_b32 s37,s37,2147483648
v_mfma_f32_32x32x16_bf16 v[112:127],a[60:63],v[76:79],v[112:127]
buffer_load_dwordx4 v[108:111],v1,s[8:11],s63 offen offset:3072 sc1
buffer_load_dwordx4 v[180:183],v15,s[8:11],s43 offen sc1
s_cmp_eq_u32 s37,0
v_mfma_f32_32x32x16_bf16 v[128:143],a[156:159],v[76:79],v[128:143]
s_cbranch_scc0 no_333
v_mfma_f32_32x32x16_bf16 v[112:127],a[64:67],v[80:83],v[112:127]
s_add_u32 s63,s73,0
buffer_load_dwordx4 v[16:19],v1,s[8:11],s63 offen sc1
v_mfma_f32_32x32x16_bf16 v[128:143],a[160:163],v[80:83],v[128:143]
s_waitcnt vmcnt(8)
v_mfma_f32_32x32x16_bf16 v[112:127],a[68:71],v[84:87],v[112:127]
buffer_load_dwordx4 v[20:23],v1,s[8:11],s63 offen offset:1024 sc1
v_mfma_f32_32x32x16_bf16 v[128:143],a[164:167],v[84:87],v[128:143]
s_waitcnt vmcnt(8)
v_mfma_f32_32x32x16_bf16 v[112:127],a[72:75],v[88:91],v[112:127]
buffer_load_dwordx4 v[24:27],v1,s[8:11],s63 offen offset:2048 sc1
v_mfma_f32_32x32x16_bf16 v[128:143],a[168:171],v[88:91],v[128:143]
v_lshlrev_b32 v184,16,v176
v_and_b32 v185,0xffff0000,v176
v_lshlrev_b32 v186,16,v177
v_and_b32 v187,0xffff0000,v177
v_lshlrev_b32 v188,16,v178
s_waitcnt vmcnt(8)
v_mfma_f32_32x32x16_bf16 v[112:127],a[76:79],v[92:95],v[112:127]
buffer_load_dwordx4 v[28:31],v1,s[8:11],s63 offen offset:3072 sc1
s_add_u32 s63,s73,4096
v_and_b32 v189,0xffff0000,v178
v_lshlrev_b32 v190,16,v179
v_and_b32 v191,0xffff0000,v179
v_mfma_f32_32x32x16_bf16 v[128:143],a[172:175],v[92:95],v[128:143]
s_waitcnt vmcnt(8)
v_mfma_f32_32x32x16_bf16 v[112:127],a[80:83],v[96:99],v[112:127]
buffer_load_dwordx4 v[32:35],v1,s[8:11],s63 offen sc1
s_waitcnt vmcnt(8)
v_mfma_f32_32x32x16_bf16 v[112:127],a[84:87],v[100:103],v[112:127]
s_waitcnt vmcnt(7)
v_mfma_f32_32x32x16_bf16 v[112:127],a[88:91],v[104:107],v[112:127]
buffer_load_dwordx4 v[36:39],v1,s[8:11],s63 offen offset:1024 sc1
s_waitcnt vmcnt(7)
v_mfma_f32_32x32x16_bf16 v[112:127],a[92:95],v[108:111],v[112:127]
v_mfma_f32_32x32x16_bf16 v[128:143],a[176:179],v[96:99],v[128:143]
buffer_load_dwordx4 v[40:43],v1,s[8:11],s63 offen offset:2048 sc1
s_mov_b64 exec,1
s_cmp_lg_u32 s49,0
s_cbranch_scc0 ls_334
buffer_store_dword v5,v1,s[8:11],s82 offen sc1
s_branch ls_335
ls_334:
buffer_store_dword v5,v1,s[8:11],s82 offen
ls_335:
s_mov_b64 exec,-1
v_mfma_f32_32x32x16_bf16 v[128:143],a[180:183],v[100:103],v[128:143]
ds_write_b128 v206,v[112:115] offset:0
ds_write_b128 v206,v[116:119] offset:1024
ds_write_b128 v206,v[120:123] offset:512
v_mfma_f32_32x32x16_bf16 v[128:143],a[184:187],v[104:107],v[128:143]
buffer_load_dwordx4 v[44:47],v1,s[8:11],s63 offen offset:3072 sc1
ds_write_b128 v206,v[124:127] offset:1536
v_mfma_f32_32x32x16_bf16 v[128:143],a[188:191],v[108:111],v[128:143]
buffer_load_dword v3,v2,s[8:11],s30 offen sc1
s_waitcnt vmcnt(10)
v_lshlrev_b32 v192,16,v180
v_and_b32 v193,0xffff0000,v180
v_lshlrev_b32 v194,16,v181
v_and_b32 v195,0xffff0000,v181
v_lshlrev_b32 v196,16,v182
v_and_b32 v197,0xffff0000,v182
v_lshlrev_b32 v198,16,v183
v_and_b32 v199,0xffff0000,v183
s_nop 1
ds_write_b128 v206,v[128:131] offset:8192
s_add_u32 s63,s73,8192
buffer_load_dwordx4 v[48:51],v1,s[8:11],s63 offen sc1
ds_write_b128 v206,v[132:135] offset:9216
buffer_load_dwordx4 v[52:55],v1,s[8:11],s63 offen offset:1024 sc1
ds_write_b128 v206,v[136:139] offset:8704
buffer_load_dwordx4 v[56:59],v1,s[8:11],s63 offen offset:2048 sc1
ds_write_b128 v206,v[140:143] offset:9728
buffer_load_dwordx4 v[60:63],v1,s[8:11],s63 offen offset:3072 sc1
s_waitcnt lgkmcnt(0)
s_barrier
ds_read_b128 v[144:147],v207 offset:0
ds_read_b128 v[148:151],v207 offset:1024
ds_read_b128 v[152:155],v207 offset:2048
ds_read_b128 v[156:159],v207 offset:3072
ds_read_b128 v[160:163],v207 offset:4096
ds_read_b128 v[164:167],v207 offset:5120
ds_read_b128 v[168:171],v207 offset:6144
ds_read_b128 v[172:175],v207 offset:7168
s_add_u32 s63,s73,12288
buffer_load_dwordx4 v[64:67],v1,s[8:11],s63 offen sc1
buffer_load_dwordx4 v[68:71],v1,s[8:11],s63 offen offset:1024 sc1
s_waitcnt vmcnt(6)
s_branch W4_W
no_333:
v_mfma_f32_32x32x16_bf16 v[112:127],a[64:67],v[80:83],v[112:127]
v_mfma_f32_32x32x16_bf16 v[128:143],a[160:163],v[80:83],v[128:143]
s_waitcnt vmcnt(7)
v_mfma_f32_32x32x16_bf16 v[112:127],a[68:71],v[84:87],v[112:127]
v_mfma_f32_32x32x16_bf16 v[128:143],a[164:167],v[84:87],v[128:143]
s_waitcnt vmcnt(6)
v_mfma_f32_32x32x16_bf16 v[112:127],a[72:75],v[88:91],v[112:127]
v_mfma_f32_32x32x16_bf16 v[128:143],a[168:171],v[88:91],v[128:143]
v_lshlrev_b32 v184,16,v176
v_and_b32 v185,0xffff0000,v176
v_lshlrev_b32 v186,16,v177
v_and_b32 v187,0xffff0000,v177
v_lshlrev_b32 v188,16,v178
s_waitcnt vmcnt(5)
v_mfma_f32_32x32x16_bf16 v[112:127],a[76:79],v[92:95],v[112:127]
v_and_b32 v189,0xffff0000,v178
v_lshlrev_b32 v190,16,v179
v_and_b32 v191,0xffff0000,v179
v_mfma_f32_32x32x16_bf16 v[128:143],a[172:175],v[92:95],v[128:143]
s_waitcnt vmcnt(4)
v_mfma_f32_32x32x16_bf16 v[112:127],a[80:83],v[96:99],v[112:127]
s_waitcnt vmcnt(3)
v_mfma_f32_32x32x16_bf16 v[112:127],a[84:87],v[100:103],v[112:127]
s_waitcnt vmcnt(2)
v_mfma_f32_32x32x16_bf16 v[112:127],a[88:91],v[104:107],v[112:127]
s_waitcnt vmcnt(1)
v_mfma_f32_32x32x16_bf16 v[112:127],a[92:95],v[108:111],v[112:127]
v_mfma_f32_32x32x16_bf16 v[128:143],a[176:179],v[96:99],v[128:143]
buffer_load_dword v3,v2,s[8:11],s35 offen sc1
s_mov_b64 exec,1
s_cmp_lg_u32 s49,0
s_cbranch_scc0 ls_336
buffer_store_dword v5,v1,s[8:11],s82 offen sc1
s_branch ls_337
ls_336:
buffer_store_dword v5,v1,s[8:11],s82 offen
ls_337:
s_mov_b64 exec,-1
v_mfma_f32_32x32x16_bf16 v[128:143],a[180:183],v[100:103],v[128:143]
ds_write_b128 v206,v[112:115] offset:0
ds_write_b128 v206,v[116:119] offset:1024
ds_write_b128 v206,v[120:123] offset:512
v_mfma_f32_32x32x16_bf16 v[128:143],a[184:187],v[104:107],v[128:143]
ds_write_b128 v206,v[124:127] offset:1536
v_mfma_f32_32x32x16_bf16 v[128:143],a[188:191],v[108:111],v[128:143]
s_waitcnt vmcnt(2)
v_lshlrev_b32 v192,16,v180
v_and_b32 v193,0xffff0000,v180
v_lshlrev_b32 v194,16,v181
v_and_b32 v195,0xffff0000,v181
v_lshlrev_b32 v196,16,v182
v_and_b32 v197,0xffff0000,v182
v_lshlrev_b32 v198,16,v183
v_and_b32 v199,0xffff0000,v183
s_nop 2
ds_write_b128 v206,v[128:131] offset:8192
ds_write_b128 v206,v[132:135] offset:9216
ds_write_b128 v206,v[136:139] offset:8704
ds_write_b128 v206,v[140:143] offset:9728
s_waitcnt lgkmcnt(0)
s_barrier
ds_read_b128 v[144:147],v207 offset:0
ds_read_b128 v[148:151],v207 offset:1024
ds_read_b128 v[152:155],v207 offset:2048
ds_read_b128 v[156:159],v207 offset:3072
ds_read_b128 v[160:163],v207 offset:4096
ds_read_b128 v[164:167],v207 offset:5120
ds_read_b128 v[168:171],v207 offset:6144
ds_read_b128 v[172:175],v207 offset:7168
s_waitcnt vmcnt(1)
v_cmp_eq_u32 vcc,0,v3
s_cmp_eq_u64 vcc,0
s_cselect_b32 s37,0,2147483648
s_cmp_lt_u32 s32,128
s_cselect_b32 s37,s37,2147483648
s_cmp_eq_u32 s37,0
s_cbranch_scc1 W4_E2
s_branch W4_E0
W4_E2:
s_add_u32 s63,s73,0
buffer_load_dwordx4 v[16:19],v1,s[8:11],s63 offen sc1
s_waitcnt lgkmcnt(4)
v_pk_add_f32 v[144:145],v[144:145],v[152:153]
v_pk_add_f32 v[146:147],v[146:147],v[154:155]
v_pk_add_f32 v[148:149],v[148:149],v[156:157]
v_pk_add_f32 v[150:151],v[150:151],v[158:159]
s_waitcnt lgkmcnt(0)
buffer_load_dwordx4 v[20:23],v1,s[8:11],s63 offen offset:1024 sc1
v_pk_add_f32 v[160:161],v[160:161],v[168:169]
v_pk_add_f32 v[162:163],v[162:163],v[170:171]
v_pk_add_f32 v[164:165],v[164:165],v[172:173]
v_pk_add_f32 v[166:167],v[166:167],v[174:175]
v_pk_add_f32 v[144:145],v[144:145],v[160:161]
v_pk_add_f32 v[146:147],v[146:147],v[162:163]
buffer_load_dwordx4 v[24:27],v1,s[8:11],s63 offen offset:2048 sc1
v_pk_add_f32 v[148:149],v[148:149],v[164:165]
v_pk_add_f32 v[150:151],v[150:151],v[166:167]
v_cvt_pk_bf16_f32 v6,v144,v145
v_lshlrev_b32 v144,16,v6
v_and_b32 v145,0xffff0000,v6
v_cvt_pk_bf16_f32 v8,v146,v147
buffer_load_dwordx4 v[28:31],v1,s[8:11],s63 offen offset:3072 sc1
v_lshlrev_b32 v146,16,v8
v_and_b32 v147,0xffff0000,v8
v_cvt_pk_bf16_f32 v6,v148,v149
v_lshlrev_b32 v148,16,v6
v_and_b32 v149,0xffff0000,v6
v_cvt_pk_bf16_f32 v8,v150,v151
s_add_u32 s63,s73,4096
buffer_load_dwordx4 v[32:35],v1,s[8:11],s63 offen sc1
v_lshlrev_b32 v150,16,v8
v_and_b32 v151,0xffff0000,v8
v_pk_add_f32 v[144:145],v[144:145],v[184:185]
v_pk_add_f32 v[146:147],v[146:147],v[186:187]
v_pk_add_f32 v[148:149],v[148:149],v[188:189]
v_pk_add_f32 v[150:151],v[150:151],v[190:191]
buffer_load_dwordx4 v[36:39],v1,s[8:11],s63 offen offset:1024 sc1
v_cvt_pk_bf16_f32 v6,v144,v145
v_lshlrev_b32 v144,16,v6
v_and_b32 v145,0xffff0000,v6
v_cvt_pk_bf16_f32 v8,v146,v147
v_lshlrev_b32 v146,16,v8
v_and_b32 v147,0xffff0000,v8
buffer_load_dwordx4 v[40:43],v1,s[8:11],s63 offen offset:2048 sc1
v_cvt_pk_bf16_f32 v6,v148,v149
v_lshlrev_b32 v148,16,v6
v_and_b32 v149,0xffff0000,v6
v_cvt_pk_bf16_f32 v8,v150,v151
v_lshlrev_b32 v150,16,v8
v_and_b32 v151,0xffff0000,v8
buffer_load_dwordx4 v[44:47],v1,s[8:11],s63 offen offset:3072 sc1
v_pk_add_f32 v[144:145],v[144:145],v[192:193]
v_pk_add_f32 v[146:147],v[146:147],v[194:195]
v_pk_add_f32 v[148:149],v[148:149],v[196:197]
v_pk_add_f32 v[150:151],v[150:151],v[198:199]
v_cvt_pk_bf16_f32 v200,v144,v145
v_cvt_pk_bf16_f32 v201,v146,v147
v_cvt_pk_bf16_f32 v202,v148,v149
v_cvt_pk_bf16_f32 v203,v150,v151
s_cmp_lg_u32 s51,0
s_cbranch_scc1 w4o_338
buffer_store_dwordx4 v[200:203],v15,s[8:11],s40 offen sc1
v_lshlrev_b32 v144,16,v200
v_and_b32 v145,0xffff0000,v200
v_lshlrev_b32 v146,16,v201
v_and_b32 v147,0xffff0000,v201
v_lshlrev_b32 v148,16,v202
v_and_b32 v149,0xffff0000,v202
v_lshlrev_b32 v150,16,v203
v_and_b32 v151,0xffff0000,v203
v_pk_add_f32 v[6:7],v[144:145],v[146:147]
v_pk_mul_f32 v[8:9],v[144:145],v[144:145]
v_pk_fma_f32 v[8:9],v[146:147],v[146:147],v[8:9]
v_pk_add_f32 v[6:7],v[6:7],v[148:149]
v_pk_fma_f32 v[8:9],v[148:149],v[148:149],v[8:9]
v_pk_add_f32 v[6:7],v[6:7],v[150:151]
v_pk_fma_f32 v[8:9],v[150:151],v[150:151],v[8:9]
v_add_f32 v6,v6,v7
v_add_f32 v7,v8,v9
s_nop 1
v_permlane32_swap_b32 v6,v7
v_add_f32 v6,v6,v7
v_mov_b32 v7,v6
s_nop 1
v_permlane16_swap_b32 v6,v7
v_add_f32 v6,v6,v7
v_mov_b32 v7,v6
s_nop 1
v_permlane32_swap_b32 v6,v7
s_mov_b64 exec,0xffff
buffer_store_dwordx2 v[6:7],v204,s[8:11],s41 offen sc1
s_mov_b64 exec,-1
s_branch w4n_339
w4o_338:
v_permlane16_swap_b32 v200,v202
v_permlane16_swap_b32 v201,v203
buffer_store_dwordx4 v[200:203],v205,s[76:79],s27 offen
s_nop 1
w4n_339:
s_mov_b32 s59,s42
s_branch W4_C
W4_E0:
s_waitcnt lgkmcnt(4)
v_pk_add_f32 v[144:145],v[144:145],v[152:153]
v_pk_add_f32 v[146:147],v[146:147],v[154:155]
v_pk_add_f32 v[148:149],v[148:149],v[156:157]
v_pk_add_f32 v[150:151],v[150:151],v[158:159]
s_waitcnt lgkmcnt(0)
v_pk_add_f32 v[160:161],v[160:161],v[168:169]
v_pk_add_f32 v[162:163],v[162:163],v[170:171]
v_pk_add_f32 v[164:165],v[164:165],v[172:173]
v_pk_add_f32 v[166:167],v[166:167],v[174:175]
v_pk_add_f32 v[144:145],v[144:145],v[160:161]
v_pk_add_f32 v[146:147],v[146:147],v[162:163]
v_pk_add_f32 v[148:149],v[148:149],v[164:165]
v_pk_add_f32 v[150:151],v[150:151],v[166:167]
v_cvt_pk_bf16_f32 v6,v144,v145
v_lshlrev_b32 v144,16,v6
v_and_b32 v145,0xffff0000,v6
v_cvt_pk_bf16_f32 v8,v146,v147
v_lshlrev_b32 v146,16,v8
v_and_b32 v147,0xffff0000,v8
v_cvt_pk_bf16_f32 v6,v148,v149
v_lshlrev_b32 v148,16,v6
v_and_b32 v149,0xffff0000,v6
v_cvt_pk_bf16_f32 v8,v150,v151
v_lshlrev_b32 v150,16,v8
v_and_b32 v151,0xffff0000,v8
v_pk_add_f32 v[144:145],v[144:145],v[184:185]
v_pk_add_f32 v[146:147],v[146:147],v[186:187]
v_pk_add_f32 v[148:149],v[148:149],v[188:189]
v_pk_add_f32 v[150:151],v[150:151],v[190:191]
v_cvt_pk_bf16_f32 v6,v144,v145
v_lshlrev_b32 v144,16,v6
v_and_b32 v145,0xffff0000,v6
v_cvt_pk_bf16_f32 v8,v146,v147
v_lshlrev_b32 v146,16,v8
v_and_b32 v147,0xffff0000,v8
v_cvt_pk_bf16_f32 v6,v148,v149
v_lshlrev_b32 v148,16,v6
v_and_b32 v149,0xffff0000,v6
v_cvt_pk_bf16_f32 v8,v150,v151
v_lshlrev_b32 v150,16,v8
v_and_b32 v151,0xffff0000,v8
v_pk_add_f32 v[144:145],v[144:145],v[192:193]
v_pk_add_f32 v[146:147],v[146:147],v[194:195]
v_pk_add_f32 v[148:149],v[148:149],v[196:197]
v_pk_add_f32 v[150:151],v[150:151],v[198:199]
v_cvt_pk_bf16_f32 v200,v144,v145
v_cvt_pk_bf16_f32 v201,v146,v147
v_cvt_pk_bf16_f32 v202,v148,v149
v_cvt_pk_bf16_f32 v203,v150,v151
s_cmp_lg_u32 s51,0
s_cbranch_scc1 w4o_340
buffer_store_dwordx4 v[200:203],v15,s[8:11],s40 offen sc1
v_lshlrev_b32 v144,16,v200
v_and_b32 v145,0xffff0000,v200
v_lshlrev_b32 v146,16,v201
v_and_b32 v147,0xffff0000,v201
v_lshlrev_b32 v148,16,v202
v_and_b32 v149,0xffff0000,v202
v_lshlrev_b32 v150,16,v203
v_and_b32 v151,0xffff0000,v203
v_pk_add_f32 v[6:7],v[144:145],v[146:147]
v_pk_mul_f32 v[8:9],v[144:145],v[144:145]
v_pk_fma_f32 v[8:9],v[146:147],v[146:147],v[8:9]
v_pk_add_f32 v[6:7],v[6:7],v[148:149]
v_pk_fma_f32 v[8:9],v[148:149],v[148:149],v[8:9]
v_pk_add_f32 v[6:7],v[6:7],v[150:151]
v_pk_fma_f32 v[8:9],v[150:151],v[150:151],v[8:9]
v_add_f32 v6,v6,v7
v_add_f32 v7,v8,v9
s_nop 1
v_permlane32_swap_b32 v6,v7
v_add_f32 v6,v6,v7
v_mov_b32 v7,v6
s_nop 1
v_permlane16_swap_b32 v6,v7
v_add_f32 v6,v6,v7
v_mov_b32 v7,v6
s_nop 1
v_permlane32_swap_b32 v6,v7
s_mov_b64 exec,0xffff
buffer_store_dwordx2 v[6:7],v204,s[8:11],s41 offen sc1
s_mov_b64 exec,-1
s_branch w4n_341
w4o_340:
v_permlane16_swap_b32 v200,v202
v_permlane16_swap_b32 v201,v203
buffer_store_dwordx4 v[200:203],v205,s[76:79],s27 offen
s_nop 1
w4n_341:
s_mov_b32 s59,s42
s_branch W4_COLD
W4_W:
s_mov_b32 s20,s40
s_mov_b32 s21,s41
s_mov_b32 s22,s42
s_mov_b32 s23,s27
s_mov_b32 s51,s33
s_mov_b32 s52,s34
s_mov_b32 s72,s73
s_add_u32 s32,s32,1
s_mov_b32 s33,s28
s_mov_b32 s34,s29
s_mov_b32 s35,s30
s_mov_b32 s73,s31
v_cmp_eq_u32 vcc,0,v3
s_cmp_eq_u64 vcc,0
s_cselect_b32 s37,0,2147483648
s_cmp_lt_u32 s32,128
s_cselect_b32 s37,s37,2147483648
s_cmp_lg_u32 s37,0
s_cbranch_scc1 W4_W0
s_waitcnt vmcnt(13)
v_mfma_f32_32x32x16_bf16 v[112:127],a[0:3],v[16:19],0
s_add_u32 s63,s72,12288
buffer_load_dwordx4 v[72:75],v1,s[8:11],s63 offen offset:2048 sc1
s_lshl_b32 s64,s51,6
s_add_u32 s64,s64,s52
s_and_b32 s65,s52,7
v_mfma_f32_32x32x16_bf16 v[128:143],a[96:99],v[16:19],0
s_lshl3_add_u32 s65,s51,s65
s_mul_i32 s65,s65,46080
s_add_u32 s65,s65,s70
s_add_u32 s65,s65,212467712
buffer_load_dwordx4 v[176:179],v1,s[8:11],s65 offen sc1
s_waitcnt vmcnt(14)
v_mfma_f32_32x32x16_bf16 v[112:127],a[4:7],v[20:23],v[112:127]
buffer_load_dwordx4 v[76:79],v1,s[8:11],s63 offen offset:3072 sc1
s_add_u32 s63,s72,16384
s_mul_i32 s43,s64,40960
s_add_u32 s43,s43,s70
s_add_u32 s43,s43,218365952
v_mfma_f32_32x32x16_bf16 v[128:143],a[100:103],v[20:23],v[128:143]
s_waitcnt lgkmcnt(4)
v_add_f32 v144,v144,v152
v_add_f32 v145,v145,v153
v_add_f32 v146,v146,v154
v_add_f32 v147,v147,v155
v_add_f32 v148,v148,v156
s_waitcnt vmcnt(14)
v_mfma_f32_32x32x16_bf16 v[112:127],a[8:11],v[24:27],v[112:127]
buffer_load_dwordx4 v[80:83],v1,s[8:11],s63 offen sc1
v_add_f32 v149,v149,v157
v_add_f32 v150,v150,v158
v_add_f32 v151,v151,v159
s_waitcnt lgkmcnt(0)
v_mfma_f32_32x32x16_bf16 v[128:143],a[104:107],v[24:27],v[128:143]
v_add_f32 v160,v160,v168
v_add_f32 v161,v161,v169
v_add_f32 v162,v162,v170
v_add_f32 v163,v163,v171
v_add_f32 v164,v164,v172
s_waitcnt vmcnt(14)
v_mfma_f32_32x32x16_bf16 v[112:127],a[12:15],v[28:31],v[112:127]
buffer_load_dwordx4 v[84:87],v1,s[8:11],s63 offen offset:1024 sc1
v_add_f32 v165,v165,v173
v_add_f32 v166,v166,v174
v_add_f32 v167,v167,v175
v_add_f32 v144,v144,v160
v_mfma_f32_32x32x16_bf16 v[128:143],a[108:111],v[28:31],v[128:143]
v_add_f32 v145,v145,v161
v_add_f32 v146,v146,v162
v_add_f32 v147,v147,v163
v_add_f32 v148,v148,v164
v_add_f32 v149,v149,v165
s_waitcnt vmcnt(14)
v_mfma_f32_32x32x16_bf16 v[112:127],a[16:19],v[32:35],v[112:127]
buffer_load_dwordx4 v[88:91],v1,s[8:11],s63 offen offset:2048 sc1
v_add_f32 v150,v150,v166
v_add_f32 v151,v151,v167
v_cvt_pk_bf16_f32 v6,v144,v145
v_lshlrev_b32 v144,16,v6
v_mfma_f32_32x32x16_bf16 v[128:143],a[112:115],v[32:35],v[128:143]
v_and_b32 v145,0xffff0000,v6
v_cvt_pk_bf16_f32 v8,v146,v147
v_lshlrev_b32 v146,16,v8
v_and_b32 v147,0xffff0000,v8
v_cvt_pk_bf16_f32 v6,v148,v149
s_waitcnt vmcnt(14)
v_mfma_f32_32x32x16_bf16 v[112:127],a[20:23],v[36:39],v[112:127]
buffer_load_dwordx4 v[92:95],v1,s[8:11],s63 offen offset:3072 sc1
s_add_u32 s63,s72,20480
v_lshlrev_b32 v148,16,v6
v_and_b32 v149,0xffff0000,v6
v_cvt_pk_bf16_f32 v8,v150,v151
v_mfma_f32_32x32x16_bf16 v[128:143],a[116:119],v[36:39],v[128:143]
v_lshlrev_b32 v150,16,v8
v_and_b32 v151,0xffff0000,v8
v_add_f32 v144,v144,v184
v_add_f32 v145,v145,v185
v_add_f32 v146,v146,v186
s_waitcnt vmcnt(14)
v_mfma_f32_32x32x16_bf16 v[112:127],a[24:27],v[40:43],v[112:127]
buffer_load_dwordx4 v[96:99],v1,s[8:11],s63 offen sc1
v_add_f32 v147,v147,v187
v_add_f32 v148,v148,v188
v_add_f32 v149,v149,v189
v_add_f32 v150,v150,v190
v_mfma_f32_32x32x16_bf16 v[128:143],a[120:123],v[40:43],v[128:143]
v_add_f32 v151,v151,v191
v_cvt_pk_bf16_f32 v6,v144,v145
v_lshlrev_b32 v144,16,v6
v_and_b32 v145,0xffff0000,v6
v_cvt_pk_bf16_f32 v8,v146,v147
s_waitcnt vmcnt(14)
v_mfma_f32_32x32x16_bf16 v[112:127],a[28:31],v[44:47],v[112:127]
buffer_load_dwordx4 v[100:103],v1,s[8:11],s63 offen offset:1024 sc1
v_lshlrev_b32 v146,16,v8
v_and_b32 v147,0xffff0000,v8
v_cvt_pk_bf16_f32 v6,v148,v149
v_lshlrev_b32 v148,16,v6
v_mfma_f32_32x32x16_bf16 v[128:143],a[124:127],v[44:47],v[128:143]
v_and_b32 v149,0xffff0000,v6
v_cvt_pk_bf16_f32 v8,v150,v151
v_lshlrev_b32 v150,16,v8
v_and_b32 v151,0xffff0000,v8
v_add_f32 v144,v144,v192
s_waitcnt vmcnt(14)
v_mfma_f32_32x32x16_bf16 v[112:127],a[32:35],v[48:51],v[112:127]
buffer_load_dwordx4 v[104:107],v1,s[8:11],s63 offen offset:2048 sc1
v_add_f32 v145,v145,v193
v_add_f32 v146,v146,v194
v_add_f32 v147,v147,v195
v_add_f32 v148,v148,v196
v_mfma_f32_32x32x16_bf16 v[128:143],a[128:131],v[48:51],v[128:143]
v_add_f32 v149,v149,v197
v_add_f32 v150,v150,v198
v_add_f32 v151,v151,v199
v_cvt_pk_bf16_f32 v200,v144,v145
v_cvt_pk_bf16_f32 v201,v146,v147
s_waitcnt vmcnt(14)
v_mfma_f32_32x32x16_bf16 v[112:127],a[36:39],v[52:55],v[112:127]
buffer_load_dwordx4 v[108:111],v1,s[8:11],s63 offen offset:3072 sc1
buffer_load_dwordx4 v[180:183],v15,s[8:11],s43 offen sc1
s_add_u32 s63,s73,0
v_mfma_f32_32x32x16_bf16 v[128:143],a[132:135],v[52:55],v[128:143]
buffer_load_dwordx4 v[16:19],v1,s[8:11],s63 offen sc1
v_cvt_pk_bf16_f32 v202,v148,v149
v_cvt_pk_bf16_f32 v203,v150,v151
buffer_store_dwordx4 v[200:203],v15,s[8:11],s20 offen sc1
s_waitcnt vmcnt(17)
v_mfma_f32_32x32x16_bf16 v[112:127],a[40:43],v[56:59],v[112:127]
v_lshlrev_b32 v144,16,v200
v_and_b32 v145,0xffff0000,v200
v_lshlrev_b32 v146,16,v201
v_and_b32 v147,0xffff0000,v201
v_lshlrev_b32 v148,16,v202
v_mfma_f32_32x32x16_bf16 v[128:143],a[136:139],v[56:59],v[128:143]
buffer_load_dwordx4 v[20:23],v1,s[8:11],s63 offen offset:1024 sc1
v_and_b32 v149,0xffff0000,v202
v_lshlrev_b32 v150,16,v203
v_and_b32 v151,0xffff0000,v203
v_add_f32 v6,v144,v146
s_waitcnt vmcnt(17)
v_mfma_f32_32x32x16_bf16 v[112:127],a[44:47],v[60:63],v[112:127]
v_mul_f32 v8,v144,v144
v_add_f32 v7,v145,v147
v_mul_f32 v9,v145,v145
v_fmac_f32 v8,v146,v146
v_fmac_f32 v9,v147,v147
v_mfma_f32_32x32x16_bf16 v[128:143],a[140:143],v[60:63],v[128:143]
buffer_load_dwordx4 v[24:27],v1,s[8:11],s63 offen offset:2048 sc1
v_add_f32 v6,v6,v148
v_fmac_f32 v8,v148,v148
v_add_f32 v7,v7,v149
v_fmac_f32 v9,v149,v149
s_waitcnt vmcnt(17)
v_mfma_f32_32x32x16_bf16 v[112:127],a[48:51],v[64:67],v[112:127]
v_add_f32 v6,v6,v150
v_fmac_f32 v8,v150,v150
v_add_f32 v7,v7,v151
v_fmac_f32 v9,v151,v151
v_add_f32 v6,v6,v7
v_mfma_f32_32x32x16_bf16 v[128:143],a[144:147],v[64:67],v[128:143]
buffer_load_dwordx4 v[28:31],v1,s[8:11],s63 offen offset:3072 sc1
s_add_u32 s63,s73,4096
v_add_f32 v7,v8,v9
s_nop 1
v_permlane32_swap_b32 v6,v7
v_add_f32 v6,v6,v7
s_waitcnt vmcnt(17)
v_mfma_f32_32x32x16_bf16 v[112:127],a[52:55],v[68:71],v[112:127]
v_mov_b32 v7,v6
s_nop 1
v_permlane16_swap_b32 v6,v7
v_add_f32 v6,v6,v7
v_mov_b32 v7,v6
s_nop 1
v_permlane32_swap_b32 v6,v7
v_mfma_f32_32x32x16_bf16 v[128:143],a[148:151],v[68:71],v[128:143]
buffer_load_dwordx4 v[32:35],v1,s[8:11],s63 offen sc1
s_mov_b64 exec,0xffff
buffer_store_dwordx2 v[6:7],v204,s[8:11],s21 offen sc1
s_mov_b64 exec,-1
s_waitcnt vmcnt(18)
v_mfma_f32_32x32x16_bf16 v[112:127],a[56:59],v[72:75],v[112:127]
v_permlane16_swap_b32 v200,v202
v_permlane16_swap_b32 v201,v203
buffer_store_dwordx4 v[200:203],v205,s[76:79],s23 offen
v_xor_b32 v206,0x8000,v206
v_xor_b32 v207,0x8000,v207
v_mfma_f32_32x32x16_bf16 v[128:143],a[152:155],v[72:75],v[128:143]
buffer_load_dwordx4 v[36:39],v1,s[8:11],s63 offen offset:1024 sc1
s_lshl_b32 s82,s64,9
s_lshl2_add_u32 s82,s56,s82
s_add_u32 s42,s82,32768
s_add_u32 s82,s82,327680
s_waitcnt vmcnt(18)
v_mfma_f32_32x32x16_bf16 v[112:127],a[60:63],v[76:79],v[112:127]
s_mul_i32 s41,s52,46080
s_add_u32 s41,s41,209518592
s_lshl_b32 s65,s51,31
s_or_b32 s41,s41,s65
s_or_b32 s42,s42,s65
s_add_u32 s40,s41,s70
v_mfma_f32_32x32x16_bf16 v[128:143],a[156:159],v[76:79],v[128:143]
buffer_load_dwordx4 v[40:43],v1,s[8:11],s63 offen offset:2048 sc1
s_lshr_b32 s64,s70,3
s_add_u32 s41,s41,s64
s_add_u32 s41,s41,40960
s_mul_i32 s27,s52,40960
s_waitcnt vmcnt(18)
v_mfma_f32_32x32x16_bf16 v[112:127],a[64:67],v[80:83],v[112:127]
s_xor_b32 s65,s65,2147483648
s_or_b32 s27,s27,s65
s_add_u32 s62,s32,1
s_min_u32 s62,s62,127
s_sub_u32 s60,s62,18
s_lshr_b32 s29,s60,1
v_mfma_f32_32x32x16_bf16 v[128:143],a[160:163],v[80:83],v[128:143]
buffer_load_dwordx4 v[44:47],v1,s[8:11],s63 offen offset:3072 sc1
s_add_u32 s63,s73,8192
s_and_b32 s28,s60,1
s_cmp_eq_u32 s28,0
s_cselect_b32 s61,18,0
s_waitcnt vmcnt(18)
v_mfma_f32_32x32x16_bf16 v[112:127],a[68:71],v[84:87],v[112:127]
s_add_u32 s29,s29,s61
s_sub_u32 s61,s60,46
s_cmp_ge_u32 s60,92
s_cselect_b32 s29,s61,s29
s_cselect_b32 s28,1,s28
v_mfma_f32_32x32x16_bf16 v[128:143],a[164:167],v[84:87],v[128:143]
buffer_load_dwordx4 v[48:51],v1,s[8:11],s63 offen sc1
s_cmp_lt_u32 s62,18
s_cselect_b32 s29,s62,s29
s_cselect_b32 s28,0,s28
s_lshl_b32 s30,s28,6
s_waitcnt vmcnt(18)
v_mfma_f32_32x32x16_bf16 v[112:127],a[72:75],v[88:91],v[112:127]
s_add_u32 s30,s30,s29
s_lshl_b32 s30,s30,9
s_add_u32 s30,s30,589824
s_and_b32 s60,s29,3
s_lshl2_add_u32 s60,s28,s60
s_mul_i32 s31,s60,98304
v_mfma_f32_32x32x16_bf16 v[128:143],a[168:171],v[88:91],v[128:143]
buffer_load_dwordx4 v[52:55],v1,s[8:11],s63 offen offset:1024 sc1
s_add_u32 s31,s31,s71
v_lshlrev_b32 v184,16,v176
v_and_b32 v185,0xffff0000,v176
s_waitcnt vmcnt(18)
v_mfma_f32_32x32x16_bf16 v[112:127],a[76:79],v[92:95],v[112:127]
v_lshlrev_b32 v186,16,v177
v_and_b32 v187,0xffff0000,v177
v_lshlrev_b32 v188,16,v178
v_and_b32 v189,0xffff0000,v178
v_lshlrev_b32 v190,16,v179
v_mfma_f32_32x32x16_bf16 v[128:143],a[172:175],v[92:95],v[128:143]
buffer_load_dwordx4 v[56:59],v1,s[8:11],s63 offen offset:2048 sc1
v_and_b32 v191,0xffff0000,v179
s_waitcnt vmcnt(18)
v_mfma_f32_32x32x16_bf16 v[112:127],a[80:83],v[96:99],v[112:127]
s_waitcnt vmcnt(17)
v_mfma_f32_32x32x16_bf16 v[112:127],a[84:87],v[100:103],v[112:127]
buffer_load_dwordx4 v[60:63],v1,s[8:11],s63 offen offset:3072 sc1
s_add_u32 s63,s73,12288
s_waitcnt vmcnt(17)
v_mfma_f32_32x32x16_bf16 v[112:127],a[88:91],v[104:107],v[112:127]
s_waitcnt vmcnt(16)
v_mfma_f32_32x32x16_bf16 v[112:127],a[92:95],v[108:111],v[112:127]
buffer_load_dwordx4 v[64:67],v1,s[8:11],s63 offen sc1
v_mfma_f32_32x32x16_bf16 v[128:143],a[176:179],v[96:99],v[128:143]
s_mov_b64 exec,1
s_cmp_lg_u32 s49,0
s_cbranch_scc0 ls_342
buffer_store_dword v5,v1,s[8:11],s82 offen sc1
s_branch ls_343
ls_342:
buffer_store_dword v5,v1,s[8:11],s82 offen
ls_343:
s_mov_b64 exec,-1
v_mfma_f32_32x32x16_bf16 v[128:143],a[180:183],v[100:103],v[128:143]
buffer_load_dwordx4 v[68:71],v1,s[8:11],s63 offen offset:1024 sc1
ds_write_b128 v206,v[112:115] offset:0
ds_write_b128 v206,v[116:119] offset:1024
v_mfma_f32_32x32x16_bf16 v[128:143],a[184:187],v[104:107],v[128:143]
ds_write_b128 v206,v[120:123] offset:512
ds_write_b128 v206,v[124:127] offset:1536
v_mfma_f32_32x32x16_bf16 v[128:143],a[188:191],v[108:111],v[128:143]
buffer_load_dword v3,v2,s[8:11],s30 offen sc1
s_waitcnt vmcnt(19)
v_lshlrev_b32 v192,16,v180
v_and_b32 v193,0xffff0000,v180
v_lshlrev_b32 v194,16,v181
v_and_b32 v195,0xffff0000,v181
v_lshlrev_b32 v196,16,v182
v_and_b32 v197,0xffff0000,v182
v_lshlrev_b32 v198,16,v183
v_and_b32 v199,0xffff0000,v183
s_nop 1
ds_write_b128 v206,v[128:131] offset:8192
ds_write_b128 v206,v[132:135] offset:9216
ds_write_b128 v206,v[136:139] offset:8704
ds_write_b128 v206,v[140:143] offset:9728
s_waitcnt vmcnt(12)
s_mov_b64 exec,1
buffer_store_dword v5,v1,s[8:11],s22 offen sc1
s_mov_b64 exec,-1
s_waitcnt lgkmcnt(0)
s_barrier
ds_read_b128 v[144:147],v207 offset:0
ds_read_b128 v[148:151],v207 offset:1024
ds_read_b128 v[152:155],v207 offset:2048
ds_read_b128 v[156:159],v207 offset:3072
ds_read_b128 v[160:163],v207 offset:4096
ds_read_b128 v[164:167],v207 offset:5120
ds_read_b128 v[168:171],v207 offset:6144
ds_read_b128 v[172:175],v207 offset:7168
s_waitcnt vmcnt(1)
s_branch W4_W
W4_W0:
s_waitcnt vmcnt(13)
v_mfma_f32_32x32x16_bf16 v[112:127],a[0:3],v[16:19],0
s_add_u32 s63,s72,12288
buffer_load_dwordx4 v[72:75],v1,s[8:11],s63 offen offset:2048 sc1
s_lshl_b32 s64,s51,6
s_add_u32 s64,s64,s52
s_and_b32 s65,s52,7
v_mfma_f32_32x32x16_bf16 v[128:143],a[96:99],v[16:19],0
s_lshl3_add_u32 s65,s51,s65
s_mul_i32 s65,s65,46080
s_add_u32 s65,s65,s70
s_add_u32 s65,s65,212467712
buffer_load_dwordx4 v[176:179],v1,s[8:11],s65 offen sc1
s_waitcnt vmcnt(14)
v_mfma_f32_32x32x16_bf16 v[112:127],a[4:7],v[20:23],v[112:127]
buffer_load_dwordx4 v[76:79],v1,s[8:11],s63 offen offset:3072 sc1
s_add_u32 s63,s72,16384
s_mul_i32 s43,s64,40960
s_add_u32 s43,s43,s70
s_add_u32 s43,s43,218365952
v_mfma_f32_32x32x16_bf16 v[128:143],a[100:103],v[20:23],v[128:143]
s_waitcnt lgkmcnt(4)
v_add_f32 v144,v144,v152
v_add_f32 v145,v145,v153
v_add_f32 v146,v146,v154
v_add_f32 v147,v147,v155
v_add_f32 v148,v148,v156
s_waitcnt vmcnt(14)
v_mfma_f32_32x32x16_bf16 v[112:127],a[8:11],v[24:27],v[112:127]
buffer_load_dwordx4 v[80:83],v1,s[8:11],s63 offen sc1
v_add_f32 v149,v149,v157
v_add_f32 v150,v150,v158
v_add_f32 v151,v151,v159
s_waitcnt lgkmcnt(0)
v_mfma_f32_32x32x16_bf16 v[128:143],a[104:107],v[24:27],v[128:143]
v_add_f32 v160,v160,v168
v_add_f32 v161,v161,v169
v_add_f32 v162,v162,v170
v_add_f32 v163,v163,v171
v_add_f32 v164,v164,v172
s_waitcnt vmcnt(14)
v_mfma_f32_32x32x16_bf16 v[112:127],a[12:15],v[28:31],v[112:127]
buffer_load_dwordx4 v[84:87],v1,s[8:11],s63 offen offset:1024 sc1
v_add_f32 v165,v165,v173
v_add_f32 v166,v166,v174
v_add_f32 v167,v167,v175
v_add_f32 v144,v144,v160
v_mfma_f32_32x32x16_bf16 v[128:143],a[108:111],v[28:31],v[128:143]
v_add_f32 v145,v145,v161
v_add_f32 v146,v146,v162
v_add_f32 v147,v147,v163
v_add_f32 v148,v148,v164
v_add_f32 v149,v149,v165
s_waitcnt vmcnt(14)
v_mfma_f32_32x32x16_bf16 v[112:127],a[16:19],v[32:35],v[112:127]
buffer_load_dwordx4 v[88:91],v1,s[8:11],s63 offen offset:2048 sc1
v_add_f32 v150,v150,v166
v_add_f32 v151,v151,v167
v_cvt_pk_bf16_f32 v6,v144,v145
v_lshlrev_b32 v144,16,v6
v_mfma_f32_32x32x16_bf16 v[128:143],a[112:115],v[32:35],v[128:143]
v_and_b32 v145,0xffff0000,v6
v_cvt_pk_bf16_f32 v8,v146,v147
v_lshlrev_b32 v146,16,v8
v_and_b32 v147,0xffff0000,v8
v_cvt_pk_bf16_f32 v6,v148,v149
s_waitcnt vmcnt(14)
v_mfma_f32_32x32x16_bf16 v[112:127],a[20:23],v[36:39],v[112:127]
buffer_load_dwordx4 v[92:95],v1,s[8:11],s63 offen offset:3072 sc1
s_add_u32 s63,s72,20480
v_lshlrev_b32 v148,16,v6
v_and_b32 v149,0xffff0000,v6
v_cvt_pk_bf16_f32 v8,v150,v151
v_mfma_f32_32x32x16_bf16 v[128:143],a[116:119],v[36:39],v[128:143]
v_lshlrev_b32 v150,16,v8
v_and_b32 v151,0xffff0000,v8
v_add_f32 v144,v144,v184
v_add_f32 v145,v145,v185
v_add_f32 v146,v146,v186
s_waitcnt vmcnt(14)
v_mfma_f32_32x32x16_bf16 v[112:127],a[24:27],v[40:43],v[112:127]
buffer_load_dwordx4 v[96:99],v1,s[8:11],s63 offen sc1
v_add_f32 v147,v147,v187
v_add_f32 v148,v148,v188
v_add_f32 v149,v149,v189
v_add_f32 v150,v150,v190
v_mfma_f32_32x32x16_bf16 v[128:143],a[120:123],v[40:43],v[128:143]
v_add_f32 v151,v151,v191
v_cvt_pk_bf16_f32 v6,v144,v145
v_lshlrev_b32 v144,16,v6
v_and_b32 v145,0xffff0000,v6
v_cvt_pk_bf16_f32 v8,v146,v147
s_waitcnt vmcnt(14)
v_mfma_f32_32x32x16_bf16 v[112:127],a[28:31],v[44:47],v[112:127]
buffer_load_dwordx4 v[100:103],v1,s[8:11],s63 offen offset:1024 sc1
v_lshlrev_b32 v146,16,v8
v_and_b32 v147,0xffff0000,v8
v_cvt_pk_bf16_f32 v6,v148,v149
v_lshlrev_b32 v148,16,v6
v_mfma_f32_32x32x16_bf16 v[128:143],a[124:127],v[44:47],v[128:143]
v_and_b32 v149,0xffff0000,v6
v_cvt_pk_bf16_f32 v8,v150,v151
v_lshlrev_b32 v150,16,v8
v_and_b32 v151,0xffff0000,v8
v_add_f32 v144,v144,v192
s_waitcnt vmcnt(14)
v_mfma_f32_32x32x16_bf16 v[112:127],a[32:35],v[48:51],v[112:127]
buffer_load_dwordx4 v[104:107],v1,s[8:11],s63 offen offset:2048 sc1
v_add_f32 v145,v145,v193
v_add_f32 v146,v146,v194
v_add_f32 v147,v147,v195
v_add_f32 v148,v148,v196
v_mfma_f32_32x32x16_bf16 v[128:143],a[128:131],v[48:51],v[128:143]
v_add_f32 v149,v149,v197
v_add_f32 v150,v150,v198
v_add_f32 v151,v151,v199
v_cvt_pk_bf16_f32 v200,v144,v145
v_cvt_pk_bf16_f32 v201,v146,v147
s_waitcnt vmcnt(14)
v_mfma_f32_32x32x16_bf16 v[112:127],a[36:39],v[52:55],v[112:127]
buffer_load_dwordx4 v[108:111],v1,s[8:11],s63 offen offset:3072 sc1
buffer_load_dwordx4 v[180:183],v15,s[8:11],s43 offen sc1
v_cvt_pk_bf16_f32 v202,v148,v149
v_mfma_f32_32x32x16_bf16 v[128:143],a[132:135],v[52:55],v[128:143]
v_cvt_pk_bf16_f32 v203,v150,v151
buffer_store_dwordx4 v[200:203],v15,s[8:11],s20 offen sc1
v_lshlrev_b32 v144,16,v200
v_and_b32 v145,0xffff0000,v200
v_lshlrev_b32 v146,16,v201
s_waitcnt vmcnt(16)
v_mfma_f32_32x32x16_bf16 v[112:127],a[40:43],v[56:59],v[112:127]
v_and_b32 v147,0xffff0000,v201
v_lshlrev_b32 v148,16,v202
v_and_b32 v149,0xffff0000,v202
v_lshlrev_b32 v150,16,v203
v_and_b32 v151,0xffff0000,v203
v_mfma_f32_32x32x16_bf16 v[128:143],a[136:139],v[56:59],v[128:143]
v_add_f32 v6,v144,v146
v_mul_f32 v8,v144,v144
v_add_f32 v7,v145,v147
v_mul_f32 v9,v145,v145
v_fmac_f32 v8,v146,v146
s_waitcnt vmcnt(15)
v_mfma_f32_32x32x16_bf16 v[112:127],a[44:47],v[60:63],v[112:127]
v_fmac_f32 v9,v147,v147
v_add_f32 v6,v6,v148
v_fmac_f32 v8,v148,v148
v_add_f32 v7,v7,v149
v_fmac_f32 v9,v149,v149
v_mfma_f32_32x32x16_bf16 v[128:143],a[140:143],v[60:63],v[128:143]
v_add_f32 v6,v6,v150
v_fmac_f32 v8,v150,v150
v_add_f32 v7,v7,v151
v_fmac_f32 v9,v151,v151
v_add_f32 v6,v6,v7
s_waitcnt vmcnt(14)
v_mfma_f32_32x32x16_bf16 v[112:127],a[48:51],v[64:67],v[112:127]
v_add_f32 v7,v8,v9
s_nop 1
v_permlane32_swap_b32 v6,v7
v_add_f32 v6,v6,v7
v_mov_b32 v7,v6
s_nop 1
v_permlane16_swap_b32 v6,v7
v_mfma_f32_32x32x16_bf16 v[128:143],a[144:147],v[64:67],v[128:143]
v_add_f32 v6,v6,v7
v_mov_b32 v7,v6
s_nop 1
v_permlane32_swap_b32 v6,v7
s_waitcnt vmcnt(13)
v_mfma_f32_32x32x16_bf16 v[112:127],a[52:55],v[68:71],v[112:127]
s_mov_b64 exec,0xffff
buffer_store_dwordx2 v[6:7],v204,s[8:11],s21 offen sc1
s_mov_b64 exec,-1
v_permlane16_swap_b32 v200,v202
v_permlane16_swap_b32 v201,v203
v_mfma_f32_32x32x16_bf16 v[128:143],a[148:151],v[68:71],v[128:143]
buffer_store_dwordx4 v[200:203],v205,s[76:79],s23 offen
v_xor_b32 v206,0x8000,v206
v_xor_b32 v207,0x8000,v207
s_lshl_b32 s82,s64,9
s_lshl2_add_u32 s82,s56,s82
s_waitcnt vmcnt(14)
v_mfma_f32_32x32x16_bf16 v[112:127],a[56:59],v[72:75],v[112:127]
s_add_u32 s42,s82,32768
s_add_u32 s82,s82,327680
s_mul_i32 s41,s52,46080
s_add_u32 s41,s41,209518592
s_lshl_b32 s65,s51,31
s_or_b32 s41,s41,s65
v_mfma_f32_32x32x16_bf16 v[128:143],a[152:155],v[72:75],v[128:143]
s_or_b32 s42,s42,s65
s_add_u32 s40,s41,s70
s_lshr_b32 s64,s70,3
s_add_u32 s41,s41,s64
s_add_u32 s41,s41,40960
s_mul_i32 s27,s52,40960
s_waitcnt vmcnt(12)
v_mfma_f32_32x32x16_bf16 v[112:127],a[60:63],v[76:79],v[112:127]
s_xor_b32 s65,s65,2147483648
s_or_b32 s27,s27,s65
s_add_u32 s62,s32,1
s_min_u32 s62,s62,127
s_sub_u32 s60,s62,18
s_lshr_b32 s29,s60,1
v_mfma_f32_32x32x16_bf16 v[128:143],a[156:159],v[76:79],v[128:143]
s_and_b32 s28,s60,1
s_cmp_eq_u32 s28,0
s_cselect_b32 s61,18,0
s_add_u32 s29,s29,s61
s_sub_u32 s61,s60,46
s_waitcnt vmcnt(11)
v_mfma_f32_32x32x16_bf16 v[112:127],a[64:67],v[80:83],v[112:127]
s_cmp_ge_u32 s60,92
s_cselect_b32 s29,s61,s29
s_cselect_b32 s28,1,s28
s_cmp_lt_u32 s62,18
s_cselect_b32 s29,s62,s29
s_cselect_b32 s28,0,s28
v_mfma_f32_32x32x16_bf16 v[128:143],a[160:163],v[80:83],v[128:143]
s_lshl_b32 s30,s28,6
s_add_u32 s30,s30,s29
s_lshl_b32 s30,s30,9
s_add_u32 s30,s30,589824
s_and_b32 s60,s29,3
s_lshl2_add_u32 s60,s28,s60
s_waitcnt vmcnt(10)
v_mfma_f32_32x32x16_bf16 v[112:127],a[68:71],v[84:87],v[112:127]
s_mul_i32 s31,s60,98304
s_add_u32 s31,s31,s71
v_mfma_f32_32x32x16_bf16 v[128:143],a[164:167],v[84:87],v[128:143]
s_waitcnt vmcnt(9)
v_mfma_f32_32x32x16_bf16 v[112:127],a[72:75],v[88:91],v[112:127]
v_mfma_f32_32x32x16_bf16 v[128:143],a[168:171],v[88:91],v[128:143]
v_lshlrev_b32 v184,16,v176
v_and_b32 v185,0xffff0000,v176
v_lshlrev_b32 v186,16,v177
v_and_b32 v187,0xffff0000,v177
v_lshlrev_b32 v188,16,v178
s_waitcnt vmcnt(8)
v_mfma_f32_32x32x16_bf16 v[112:127],a[76:79],v[92:95],v[112:127]
v_and_b32 v189,0xffff0000,v178
v_lshlrev_b32 v190,16,v179
v_and_b32 v191,0xffff0000,v179
v_mfma_f32_32x32x16_bf16 v[128:143],a[172:175],v[92:95],v[128:143]
s_waitcnt vmcnt(7)
v_mfma_f32_32x32x16_bf16 v[112:127],a[80:83],v[96:99],v[112:127]
s_waitcnt vmcnt(6)
v_mfma_f32_32x32x16_bf16 v[112:127],a[84:87],v[100:103],v[112:127]
s_waitcnt vmcnt(5)
v_mfma_f32_32x32x16_bf16 v[112:127],a[88:91],v[104:107],v[112:127]
s_waitcnt vmcnt(4)
v_mfma_f32_32x32x16_bf16 v[112:127],a[92:95],v[108:111],v[112:127]
v_mfma_f32_32x32x16_bf16 v[128:143],a[176:179],v[96:99],v[128:143]
buffer_load_dword v3,v2,s[8:11],s35 offen sc1
s_mov_b64 exec,1
s_cmp_lg_u32 s49,0
s_cbranch_scc0 ls_344
buffer_store_dword v5,v1,s[8:11],s82 offen sc1
s_branch ls_345
ls_344:
buffer_store_dword v5,v1,s[8:11],s82 offen
ls_345:
s_mov_b64 exec,-1
v_mfma_f32_32x32x16_bf16 v[128:143],a[180:183],v[100:103],v[128:143]
ds_write_b128 v206,v[112:115] offset:0
ds_write_b128 v206,v[116:119] offset:1024
ds_write_b128 v206,v[120:123] offset:512
v_mfma_f32_32x32x16_bf16 v[128:143],a[184:187],v[104:107],v[128:143]
ds_write_b128 v206,v[124:127] offset:1536
v_mfma_f32_32x32x16_bf16 v[128:143],a[188:191],v[108:111],v[128:143]
s_waitcnt vmcnt(5)
v_lshlrev_b32 v192,16,v180
v_and_b32 v193,0xffff0000,v180
v_lshlrev_b32 v194,16,v181
v_and_b32 v195,0xffff0000,v181
v_lshlrev_b32 v196,16,v182
v_and_b32 v197,0xffff0000,v182
v_lshlrev_b32 v198,16,v183
v_and_b32 v199,0xffff0000,v183
s_nop 2
ds_write_b128 v206,v[128:131] offset:8192
ds_write_b128 v206,v[132:135] offset:9216
ds_write_b128 v206,v[136:139] offset:8704
ds_write_b128 v206,v[140:143] offset:9728
s_waitcnt vmcnt(3)
s_mov_b64 exec,1
buffer_store_dword v5,v1,s[8:11],s22 offen sc1
s_mov_b64 exec,-1
s_waitcnt lgkmcnt(0)
s_barrier
ds_read_b128 v[144:147],v207 offset:0
ds_read_b128 v[148:151],v207 offset:1024
ds_read_b128 v[152:155],v207 offset:2048
ds_read_b128 v[156:159],v207 offset:3072
ds_read_b128 v[160:163],v207 offset:4096
ds_read_b128 v[164:167],v207 offset:5120
ds_read_b128 v[168:171],v207 offset:6144
ds_read_b128 v[172:175],v207 offset:7168
s_waitcnt vmcnt(2)
v_cmp_eq_u32 vcc,0,v3
s_cmp_eq_u64 vcc,0
s_cselect_b32 s37,0,2147483648
s_cmp_lt_u32 s32,128
s_cselect_b32 s37,s37,2147483648
s_cmp_eq_u32 s37,0
s_cbranch_scc1 W4_E2
s_branch W4_E0
W4_END:
s_endpgm
.section .rodata,"a"
.p2align 6
.amdhsa_kernel interleave_layers__memory_aug_recurrent_mem_tr__mixer_s_mlp__prompt_kernel
  .amdhsa_next_free_vgpr 512
  .amdhsa_next_free_sgpr 102
  .amdhsa_accum_offset 256
  .amdhsa_group_segment_fixed_size 0
  .amdhsa_kernarg_size 120
  .amdhsa_user_sgpr_count 2
  .amdhsa_user_sgpr_kernarg_segment_ptr 1
  .amdhsa_system_sgpr_workgroup_id_x 1
.end_amdhsa_kernel
```
